```python
import torch

def _softmax(x, axis=-1):
    return torch.softmax(x, dim=axis)

def _gelu(x):
    return torch.nn.functional.gelu(x, approximate='tanh')

def _silu(x):
    return torch.nn.functional.silu(x)

def _sigmoid(x):
    return torch.sigmoid(x)

def _layernorm(x, axis=-1, eps=1e-05):
    m = x.mean(dim=axis, keepdim=True)
    v = x.var(dim=axis, keepdim=True, unbiased=False)
    return (x - m) / torch.sqrt(v + eps)

def _scatter_add(tgt, idx, src, axis=0):
    return tgt.clone().index_add_(axis, idx, src)

def _segment_sum(src, seg, n):
    out = torch.zeros((n,) + src.shape[1:], dtype=src.dtype)
    return out.index_add_(0, seg, src)

def _pad(x, pw):
    flat = tuple((v for pair in reversed(pw) for v in pair))
    return torch.nn.functional.pad(x, flat)
kernel_name = 'adaLN_cond__memory_aug_recurrent_mem_tr__dense_activation_gelu__prompt'

def setup_inputs():

    _w = lambda a: (lambda t: t.to(torch.bfloat16) if t.is_floating_point() else t)(torch.as_tensor(a))

    def _A_setup():
        B, S, Dm = (1, 2048, 1024)
        H, Dh = (32, 128)
        M, seg = (8, 32)
        seg = min(seg, S)
        S = S // seg * seg
        return {'x': _w((lambda *s: torch.randn(*s, dtype=torch.bfloat16) * 0.05)(B, S, Dm)), 'mem0': _w((lambda *s: torch.randn(*s, dtype=torch.bfloat16) * 0.8)(B, M, Dm)), 'Wq': _w((lambda *s: torch.randn(*s, dtype=torch.bfloat16) * 1.6)(Dm, H, Dh) * Dm ** (-0.5)), 'Wk': _w((lambda *s: torch.randn(*s, dtype=torch.bfloat16) * 1.6)(Dm, H, Dh) * Dm ** (-0.5)), 'Wv': _w((lambda *s: torch.randn(*s, dtype=torch.bfloat16) * 0.8)(Dm, H, Dh) * Dm ** (-0.5)), 'Wo': _w((lambda *s: torch.randn(*s, dtype=torch.bfloat16) * 0.8)(H, Dh, Dm) * (H * Dh) ** (-0.5)), 'seg_len': seg}
    _A_in = _A_setup()

    def _B_setup():
        B, S, D, F = (1, 2048, 1024, 3584)
        return {'x': _w((lambda *s: torch.randn(*s, dtype=torch.bfloat16) * 0.05)(B, S, D)), 'w1': _w((lambda *s: torch.randn(*s, dtype=torch.bfloat16) * 1.6)(D, F) * D ** (-0.5)), 'b1': _w((lambda *s: torch.randn(*s, dtype=torch.bfloat16) * 1.6)(F) * 0.01), 'w2': _w((lambda *s: torch.randn(*s, dtype=torch.bfloat16) * 0.2)(F, D) * F ** (-0.5)), 'b2': _w((lambda *s: torch.randn(*s, dtype=torch.bfloat16) * 0.2)(D) * 0.01)}
    _B_in = _B_setup()
    return {'A_x': _A_in['x'], 'A_mem0': _A_in['mem0'], 'A_Wq': _A_in['Wq'], 'A_Wk': _A_in['Wk'], 'A_Wv': _A_in['Wv'], 'A_Wo': _A_in['Wo'], 'A_seg_len': _A_in['seg_len'], 'B_x': _B_in['x'], 'B_w1': _B_in['w1'], 'B_b1': _B_in['b1'], 'B_w2': _B_in['w2'], 'B_b2': _B_in['b2'], 'c': _w((lambda *s: torch.randn(*s, dtype=torch.bfloat16) * 0.05)(1, 1024) * 8.0), 'w_mod': _w((lambda *s: torch.randn(*s, dtype=torch.bfloat16) * 0.05)(1024, 6 * 1024) * 1024 ** (-0.5) * 8.0)}

def reference(A_x, A_mem0, A_Wq, A_Wk, A_Wv, A_Wo, A_seg_len, B_x, B_w1, B_b1, B_w2, B_b2, c, w_mod):

    def _A_ref(x, mem0, Wq, Wk, Wv, Wo, seg_len):
        B, S, Dm = x.shape
        H, Dh = (Wq.shape[1], Wq.shape[2])
        M = mem0.shape[1]
        scale = Dh ** (-0.5)
        n_seg = S // seg_len
        L = M + seg_len
        idx = torch.arange(L)
        mask = (idx[:, None] < M) | (idx[:, None] >= idx[None, :])
        mem = mem0
        outs = []
        for s in range(n_seg):
            xs = x[:, s * seg_len:(s + 1) * seg_len, :].clone()
            h = torch.concatenate([mem, xs], axis=1)
            q = torch.einsum('btd,dhe->bhte', h, Wq)
            k = torch.einsum('btd,dhe->bhte', h, Wk)
            v = torch.einsum('btd,dhe->bhte', h, Wv)
            scores = torch.einsum('bhqe,bhke->bhqk', q, k) * scale
            scores = torch.where(mask[None, None], scores, -1000000000.0)
            p = _softmax(scores, axis=-1)
            o = torch.einsum('bhqk,bhke->bhqe', p, v)
            o = torch.einsum('bhte,hed->btd', o, Wo)
            mem = o[:, :M, :].clone()
            outs.append(o[:, M:, :])
        return torch.concatenate(outs, axis=1)

    def _B_ref(x, w1, b1, w2, b2):
        h = torch.einsum('bsd,df->bsf', x, w1) + b1
        h = _gelu(h)
        return torch.einsum('bsf,fd->bsd', h, w2) + b2
    x = A_x
    mod = (_silu(c) @ w_mod).reshape(c.shape[0], 6, 1, -1)
    sa, ca, ga, sb, cb, gb = (mod[:, 0].clone(), mod[:, 1].clone(), mod[:, 2].clone(), mod[:, 3].clone(), mod[:, 4].clone(), mod[:, 5].clone())
    h = _layernorm(x, axis=-1) * (1 + ca) + sa
    x = x + ga * _A_ref(h, A_mem0, A_Wq, A_Wk, A_Wv, A_Wo, A_seg_len)
    h = _layernorm(x, axis=-1) * (1 + cb) + sb
    x = x + gb * _B_ref(h, B_w1, B_b1, B_w2, B_b2)
    return x
```

```asm
; @launch kernel=k0_mod_kernel grid=(192,1,1) block=(256,1,1) lds=8192
; @launch kernel=k1_ln_kernel grid=(512,1,1) block=(256,1,1) lds=0
; @launch kernel=k2_qkv_kernel grid=(1536,1,1) block=(256,1,1) lds=65536
; @launch kernel=k3_chain_kernel grid=(256,1,1) block=(256,1,1) lds=163840
; @launch kernel=k4_xattn_kernel grid=(512,1,1) block=(256,1,1) lds=52224
; @launch kernel=k5_wo_kernel grid=(256,1,1) block=(256,1,1) lds=49152
; @launch kernel=k6_ln_kernel grid=(512,1,1) block=(256,1,1) lds=0
; @launch kernel=k7_ffn1_kernel grid=(448,1,1) block=(256,1,1) lds=65536
; @launch kernel=k8_ffn2_kernel grid=(256,1,1) block=(256,1,1) lds=49152
.amdgcn_target "amdgcn-amd-amdhsa--gfx950"
.text
.globl k0_mod_kernel
.p2align 8
.type k0_mod_kernel,@function
k0_mod_kernel:
    s_cmp_ge_u32 s2, 192
    s_cbranch_scc1 L_mod_done_1
    s_load_dwordx2 s[4:5], s[0:1], 96
    s_load_dwordx2 s[6:7], s[0:1], 104
    s_load_dwordx2 s[20:21], s[0:1], 128
    s_load_dwordx2 s[22:23], s[0:1], 8
    v_and_b32 v1, 3, v0
    v_lshrrev_b32 v2, 2, v0
    s_waitcnt lgkmcnt(0)
    s_mov_b32 s8, s4
    s_and_b32 s9, s5, 0xffff
    s_mov_b32 s10, 0x800
    s_mov_b32 s11, 0x00020000
    s_mov_b32 s12, s6
    s_and_b32 s13, s7, 0xffff
    s_mov_b32 s14, 0xc00000
    s_mov_b32 s15, 0x00020000
    s_mov_b32 s16, s20
    s_and_b32 s17, s21, 0xffff
    s_mov_b32 s18, 0x10000000
    s_mov_b32 s19, 0x00020000
    s_mov_b32 s32, s22
    s_and_b32 s33, s23, 0xffff
    s_mov_b32 s34, 0x4000
    s_mov_b32 s35, 0x00020000
    v_lshlrev_b32 v3, 5, v2
    buffer_load_dwordx4 v[8:11], v3, s[8:11], 0 offen
    buffer_load_dwordx4 v[12:15], v3, s[8:11], 0 offen offset:16
    s_mov_b32 s36, 196608
    v_mul_lo_u32 v4, v2, s36
    v_lshlrev_b32 v5, 4, v1
    v_add_u32 v4, v4, v5
    s_lshl_b32 s37, s2, 6
    buffer_load_dwordx4 v[32:35], v4, s[12:15], s37 offen
    v_add_u32 v4, 12288, v4
    buffer_load_dwordx4 v[36:39], v4, s[12:15], s37 offen
    v_add_u32 v4, 12288, v4
    buffer_load_dwordx4 v[40:43], v4, s[12:15], s37 offen
    v_add_u32 v4, 12288, v4
    buffer_load_dwordx4 v[44:47], v4, s[12:15], s37 offen
    v_add_u32 v4, 12288, v4
    buffer_load_dwordx4 v[48:51], v4, s[12:15], s37 offen
    v_add_u32 v4, 12288, v4
    buffer_load_dwordx4 v[52:55], v4, s[12:15], s37 offen
    v_add_u32 v4, 12288, v4
    buffer_load_dwordx4 v[56:59], v4, s[12:15], s37 offen
    v_add_u32 v4, 12288, v4
    buffer_load_dwordx4 v[60:63], v4, s[12:15], s37 offen
    v_add_u32 v4, 12288, v4
    buffer_load_dwordx4 v[64:67], v4, s[12:15], s37 offen
    v_add_u32 v4, 12288, v4
    buffer_load_dwordx4 v[68:71], v4, s[12:15], s37 offen
    v_add_u32 v4, 12288, v4
    buffer_load_dwordx4 v[72:75], v4, s[12:15], s37 offen
    v_add_u32 v4, 12288, v4
    buffer_load_dwordx4 v[76:79], v4, s[12:15], s37 offen
    v_add_u32 v4, 12288, v4
    buffer_load_dwordx4 v[80:83], v4, s[12:15], s37 offen
    v_add_u32 v4, 12288, v4
    buffer_load_dwordx4 v[84:87], v4, s[12:15], s37 offen
    v_add_u32 v4, 12288, v4
    buffer_load_dwordx4 v[88:91], v4, s[12:15], s37 offen
    v_add_u32 v4, 12288, v4
    buffer_load_dwordx4 v[92:95], v4, s[12:15], s37 offen
    s_load_dwordx4 s[40:43], s[0:1], 16
    s_load_dwordx2 s[44:45], s[0:1], 32
    s_lshl_b32 s38, s2, 12
    v_lshlrev_b32 v7, 4, v0
    v_add_u32 v7, s38, v7
    s_waitcnt lgkmcnt(0)
    s_mov_b32 s48, s40
    s_and_b32 s49, s41, 0xffff
    s_mov_b32 s50, 0x800000
    s_mov_b32 s51, 0x00020000
    s_mov_b32 s38, 0
    buffer_load_dwordx4 v[120:123], v7, s[48:51], s38 offen
    s_mov_b32 s38, 786432
    buffer_load_dwordx4 v[124:127], v7, s[48:51], s38 offen
    s_mov_b32 s38, 1572864
    buffer_load_dwordx4 v[120:123], v7, s[48:51], s38 offen
    s_mov_b32 s38, 2359296
    buffer_load_dwordx4 v[124:127], v7, s[48:51], s38 offen
    s_mov_b32 s38, 3145728
    buffer_load_dwordx4 v[120:123], v7, s[48:51], s38 offen
    s_mov_b32 s38, 3932160
    buffer_load_dwordx4 v[124:127], v7, s[48:51], s38 offen
    s_mov_b32 s38, 4718592
    buffer_load_dwordx4 v[120:123], v7, s[48:51], s38 offen
    s_mov_b32 s38, 5505024
    buffer_load_dwordx4 v[124:127], v7, s[48:51], s38 offen
    s_mov_b32 s38, 6291456
    buffer_load_dwordx4 v[120:123], v7, s[48:51], s38 offen
    s_mov_b32 s38, 7077888
    buffer_load_dwordx4 v[124:127], v7, s[48:51], s38 offen
    s_mov_b32 s38, 7864320
    buffer_load_dwordx4 v[120:123], v7, s[48:51], s38 offen
    s_mov_b32 s48, s42
    s_and_b32 s49, s43, 0xffff
    s_mov_b32 s50, 0x800000
    s_mov_b32 s51, 0x00020000
    s_mov_b32 s38, 0
    buffer_load_dwordx4 v[120:123], v7, s[48:51], s38 offen
    s_mov_b32 s38, 786432
    buffer_load_dwordx4 v[124:127], v7, s[48:51], s38 offen
    s_mov_b32 s38, 1572864
    buffer_load_dwordx4 v[120:123], v7, s[48:51], s38 offen
    s_mov_b32 s38, 2359296
    buffer_load_dwordx4 v[124:127], v7, s[48:51], s38 offen
    s_mov_b32 s38, 3145728
    buffer_load_dwordx4 v[120:123], v7, s[48:51], s38 offen
    s_mov_b32 s38, 3932160
    buffer_load_dwordx4 v[124:127], v7, s[48:51], s38 offen
    s_mov_b32 s38, 4718592
    buffer_load_dwordx4 v[120:123], v7, s[48:51], s38 offen
    s_mov_b32 s38, 5505024
    buffer_load_dwordx4 v[124:127], v7, s[48:51], s38 offen
    s_mov_b32 s38, 6291456
    buffer_load_dwordx4 v[120:123], v7, s[48:51], s38 offen
    s_mov_b32 s38, 7077888
    buffer_load_dwordx4 v[124:127], v7, s[48:51], s38 offen
    s_mov_b32 s38, 7864320
    buffer_load_dwordx4 v[120:123], v7, s[48:51], s38 offen
    s_waitcnt vmcnt(0)
    v_lshlrev_b32 v16, 16, v8
    v_and_b32 v17, 0xffff0000, v8
    v_lshlrev_b32 v18, 16, v9
    v_and_b32 v19, 0xffff0000, v9
    v_lshlrev_b32 v20, 16, v10
    v_and_b32 v21, 0xffff0000, v10
    v_lshlrev_b32 v22, 16, v11
    v_and_b32 v23, 0xffff0000, v11
    v_lshlrev_b32 v24, 16, v12
    v_and_b32 v25, 0xffff0000, v12
    v_lshlrev_b32 v26, 16, v13
    v_and_b32 v27, 0xffff0000, v13
    v_lshlrev_b32 v28, 16, v14
    v_and_b32 v29, 0xffff0000, v14
    v_lshlrev_b32 v30, 16, v15
    v_and_b32 v31, 0xffff0000, v15
    v_mul_f32 v110, 0xbfb8aa3b, v16
    v_exp_f32 v110, v110
    s_nop 0
    v_add_f32 v110, 1.0, v110
    v_rcp_f32 v110, v110
    s_nop 0
    v_mul_f32 v16, v16, v110
    v_cvt_pk_bf16_f32 v16, v16, v16
    v_lshlrev_b32 v16, 16, v16
    v_mul_f32 v110, 0xbfb8aa3b, v17
    v_exp_f32 v110, v110
    s_nop 0
    v_add_f32 v110, 1.0, v110
    v_rcp_f32 v110, v110
    s_nop 0
    v_mul_f32 v17, v17, v110
    v_cvt_pk_bf16_f32 v17, v17, v17
    v_lshlrev_b32 v17, 16, v17
    v_mul_f32 v110, 0xbfb8aa3b, v18
    v_exp_f32 v110, v110
    s_nop 0
    v_add_f32 v110, 1.0, v110
    v_rcp_f32 v110, v110
    s_nop 0
    v_mul_f32 v18, v18, v110
    v_cvt_pk_bf16_f32 v18, v18, v18
    v_lshlrev_b32 v18, 16, v18
    v_mul_f32 v110, 0xbfb8aa3b, v19
    v_exp_f32 v110, v110
    s_nop 0
    v_add_f32 v110, 1.0, v110
    v_rcp_f32 v110, v110
    s_nop 0
    v_mul_f32 v19, v19, v110
    v_cvt_pk_bf16_f32 v19, v19, v19
    v_lshlrev_b32 v19, 16, v19
    v_mul_f32 v110, 0xbfb8aa3b, v20
    v_exp_f32 v110, v110
    s_nop 0
    v_add_f32 v110, 1.0, v110
    v_rcp_f32 v110, v110
    s_nop 0
    v_mul_f32 v20, v20, v110
    v_cvt_pk_bf16_f32 v20, v20, v20
    v_lshlrev_b32 v20, 16, v20
    v_mul_f32 v110, 0xbfb8aa3b, v21
    v_exp_f32 v110, v110
    s_nop 0
    v_add_f32 v110, 1.0, v110
    v_rcp_f32 v110, v110
    s_nop 0
    v_mul_f32 v21, v21, v110
    v_cvt_pk_bf16_f32 v21, v21, v21
    v_lshlrev_b32 v21, 16, v21
    v_mul_f32 v110, 0xbfb8aa3b, v22
    v_exp_f32 v110, v110
    s_nop 0
    v_add_f32 v110, 1.0, v110
    v_rcp_f32 v110, v110
    s_nop 0
    v_mul_f32 v22, v22, v110
    v_cvt_pk_bf16_f32 v22, v22, v22
    v_lshlrev_b32 v22, 16, v22
    v_mul_f32 v110, 0xbfb8aa3b, v23
    v_exp_f32 v110, v110
    s_nop 0
    v_add_f32 v110, 1.0, v110
    v_rcp_f32 v110, v110
    s_nop 0
    v_mul_f32 v23, v23, v110
    v_cvt_pk_bf16_f32 v23, v23, v23
    v_lshlrev_b32 v23, 16, v23
    v_mul_f32 v110, 0xbfb8aa3b, v24
    v_exp_f32 v110, v110
    s_nop 0
    v_add_f32 v110, 1.0, v110
    v_rcp_f32 v110, v110
    s_nop 0
    v_mul_f32 v24, v24, v110
    v_cvt_pk_bf16_f32 v24, v24, v24
    v_lshlrev_b32 v24, 16, v24
    v_mul_f32 v110, 0xbfb8aa3b, v25
    v_exp_f32 v110, v110
    s_nop 0
    v_add_f32 v110, 1.0, v110
    v_rcp_f32 v110, v110
    s_nop 0
    v_mul_f32 v25, v25, v110
    v_cvt_pk_bf16_f32 v25, v25, v25
    v_lshlrev_b32 v25, 16, v25
    v_mul_f32 v110, 0xbfb8aa3b, v26
    v_exp_f32 v110, v110
    s_nop 0
    v_add_f32 v110, 1.0, v110
    v_rcp_f32 v110, v110
    s_nop 0
    v_mul_f32 v26, v26, v110
    v_cvt_pk_bf16_f32 v26, v26, v26
    v_lshlrev_b32 v26, 16, v26
    v_mul_f32 v110, 0xbfb8aa3b, v27
    v_exp_f32 v110, v110
    s_nop 0
    v_add_f32 v110, 1.0, v110
    v_rcp_f32 v110, v110
    s_nop 0
    v_mul_f32 v27, v27, v110
    v_cvt_pk_bf16_f32 v27, v27, v27
    v_lshlrev_b32 v27, 16, v27
    v_mul_f32 v110, 0xbfb8aa3b, v28
    v_exp_f32 v110, v110
    s_nop 0
    v_add_f32 v110, 1.0, v110
    v_rcp_f32 v110, v110
    s_nop 0
    v_mul_f32 v28, v28, v110
    v_cvt_pk_bf16_f32 v28, v28, v28
    v_lshlrev_b32 v28, 16, v28
    v_mul_f32 v110, 0xbfb8aa3b, v29
    v_exp_f32 v110, v110
    s_nop 0
    v_add_f32 v110, 1.0, v110
    v_rcp_f32 v110, v110
    s_nop 0
    v_mul_f32 v29, v29, v110
    v_cvt_pk_bf16_f32 v29, v29, v29
    v_lshlrev_b32 v29, 16, v29
    v_mul_f32 v110, 0xbfb8aa3b, v30
    v_exp_f32 v110, v110
    s_nop 0
    v_add_f32 v110, 1.0, v110
    v_rcp_f32 v110, v110
    s_nop 0
    v_mul_f32 v30, v30, v110
    v_cvt_pk_bf16_f32 v30, v30, v30
    v_lshlrev_b32 v30, 16, v30
    v_mul_f32 v110, 0xbfb8aa3b, v31
    v_exp_f32 v110, v110
    s_nop 0
    v_add_f32 v110, 1.0, v110
    v_rcp_f32 v110, v110
    s_nop 0
    v_mul_f32 v31, v31, v110
    v_cvt_pk_bf16_f32 v31, v31, v31
    v_lshlrev_b32 v31, 16, v31
    v_mov_b32 v112, 0
    v_mov_b32 v113, 0
    v_mov_b32 v114, 0
    v_mov_b32 v115, 0
    v_mov_b32 v116, 0
    v_mov_b32 v117, 0
    v_mov_b32 v118, 0
    v_mov_b32 v119, 0
    v_lshlrev_b32 v110, 16, v32
    v_and_b32 v111, 0xffff0000, v32
    v_fmac_f32 v112, v110, v16
    v_fmac_f32 v113, v111, v16
    v_lshlrev_b32 v110, 16, v33
    v_and_b32 v111, 0xffff0000, v33
    v_fmac_f32 v114, v110, v16
    v_fmac_f32 v115, v111, v16
    v_lshlrev_b32 v110, 16, v34
    v_and_b32 v111, 0xffff0000, v34
    v_fmac_f32 v116, v110, v16
    v_fmac_f32 v117, v111, v16
    v_lshlrev_b32 v110, 16, v35
    v_and_b32 v111, 0xffff0000, v35
    v_fmac_f32 v118, v110, v16
    v_fmac_f32 v119, v111, v16
    v_lshlrev_b32 v110, 16, v36
    v_and_b32 v111, 0xffff0000, v36
    v_fmac_f32 v112, v110, v17
    v_fmac_f32 v113, v111, v17
    v_lshlrev_b32 v110, 16, v37
    v_and_b32 v111, 0xffff0000, v37
    v_fmac_f32 v114, v110, v17
    v_fmac_f32 v115, v111, v17
    v_lshlrev_b32 v110, 16, v38
    v_and_b32 v111, 0xffff0000, v38
    v_fmac_f32 v116, v110, v17
    v_fmac_f32 v117, v111, v17
    v_lshlrev_b32 v110, 16, v39
    v_and_b32 v111, 0xffff0000, v39
    v_fmac_f32 v118, v110, v17
    v_fmac_f32 v119, v111, v17
    v_lshlrev_b32 v110, 16, v40
    v_and_b32 v111, 0xffff0000, v40
    v_fmac_f32 v112, v110, v18
    v_fmac_f32 v113, v111, v18
    v_lshlrev_b32 v110, 16, v41
    v_and_b32 v111, 0xffff0000, v41
    v_fmac_f32 v114, v110, v18
    v_fmac_f32 v115, v111, v18
    v_lshlrev_b32 v110, 16, v42
    v_and_b32 v111, 0xffff0000, v42
    v_fmac_f32 v116, v110, v18
    v_fmac_f32 v117, v111, v18
    v_lshlrev_b32 v110, 16, v43
    v_and_b32 v111, 0xffff0000, v43
    v_fmac_f32 v118, v110, v18
    v_fmac_f32 v119, v111, v18
    v_lshlrev_b32 v110, 16, v44
    v_and_b32 v111, 0xffff0000, v44
    v_fmac_f32 v112, v110, v19
    v_fmac_f32 v113, v111, v19
    v_lshlrev_b32 v110, 16, v45
    v_and_b32 v111, 0xffff0000, v45
    v_fmac_f32 v114, v110, v19
    v_fmac_f32 v115, v111, v19
    v_lshlrev_b32 v110, 16, v46
    v_and_b32 v111, 0xffff0000, v46
    v_fmac_f32 v116, v110, v19
    v_fmac_f32 v117, v111, v19
    v_lshlrev_b32 v110, 16, v47
    v_and_b32 v111, 0xffff0000, v47
    v_fmac_f32 v118, v110, v19
    v_fmac_f32 v119, v111, v19
    v_lshlrev_b32 v110, 16, v48
    v_and_b32 v111, 0xffff0000, v48
    v_fmac_f32 v112, v110, v20
    v_fmac_f32 v113, v111, v20
    v_lshlrev_b32 v110, 16, v49
    v_and_b32 v111, 0xffff0000, v49
    v_fmac_f32 v114, v110, v20
    v_fmac_f32 v115, v111, v20
    v_lshlrev_b32 v110, 16, v50
    v_and_b32 v111, 0xffff0000, v50
    v_fmac_f32 v116, v110, v20
    v_fmac_f32 v117, v111, v20
    v_lshlrev_b32 v110, 16, v51
    v_and_b32 v111, 0xffff0000, v51
    v_fmac_f32 v118, v110, v20
    v_fmac_f32 v119, v111, v20
    v_lshlrev_b32 v110, 16, v52
    v_and_b32 v111, 0xffff0000, v52
    v_fmac_f32 v112, v110, v21
    v_fmac_f32 v113, v111, v21
    v_lshlrev_b32 v110, 16, v53
    v_and_b32 v111, 0xffff0000, v53
    v_fmac_f32 v114, v110, v21
    v_fmac_f32 v115, v111, v21
    v_lshlrev_b32 v110, 16, v54
    v_and_b32 v111, 0xffff0000, v54
    v_fmac_f32 v116, v110, v21
    v_fmac_f32 v117, v111, v21
    v_lshlrev_b32 v110, 16, v55
    v_and_b32 v111, 0xffff0000, v55
    v_fmac_f32 v118, v110, v21
    v_fmac_f32 v119, v111, v21
    v_lshlrev_b32 v110, 16, v56
    v_and_b32 v111, 0xffff0000, v56
    v_fmac_f32 v112, v110, v22
    v_fmac_f32 v113, v111, v22
    v_lshlrev_b32 v110, 16, v57
    v_and_b32 v111, 0xffff0000, v57
    v_fmac_f32 v114, v110, v22
    v_fmac_f32 v115, v111, v22
    v_lshlrev_b32 v110, 16, v58
    v_and_b32 v111, 0xffff0000, v58
    v_fmac_f32 v116, v110, v22
    v_fmac_f32 v117, v111, v22
    v_lshlrev_b32 v110, 16, v59
    v_and_b32 v111, 0xffff0000, v59
    v_fmac_f32 v118, v110, v22
    v_fmac_f32 v119, v111, v22
    v_lshlrev_b32 v110, 16, v60
    v_and_b32 v111, 0xffff0000, v60
    v_fmac_f32 v112, v110, v23
    v_fmac_f32 v113, v111, v23
    v_lshlrev_b32 v110, 16, v61
    v_and_b32 v111, 0xffff0000, v61
    v_fmac_f32 v114, v110, v23
    v_fmac_f32 v115, v111, v23
    v_lshlrev_b32 v110, 16, v62
    v_and_b32 v111, 0xffff0000, v62
    v_fmac_f32 v116, v110, v23
    v_fmac_f32 v117, v111, v23
    v_lshlrev_b32 v110, 16, v63
    v_and_b32 v111, 0xffff0000, v63
    v_fmac_f32 v118, v110, v23
    v_fmac_f32 v119, v111, v23
    v_lshlrev_b32 v110, 16, v64
    v_and_b32 v111, 0xffff0000, v64
    v_fmac_f32 v112, v110, v24
    v_fmac_f32 v113, v111, v24
    v_lshlrev_b32 v110, 16, v65
    v_and_b32 v111, 0xffff0000, v65
    v_fmac_f32 v114, v110, v24
    v_fmac_f32 v115, v111, v24
    v_lshlrev_b32 v110, 16, v66
    v_and_b32 v111, 0xffff0000, v66
    v_fmac_f32 v116, v110, v24
    v_fmac_f32 v117, v111, v24
    v_lshlrev_b32 v110, 16, v67
    v_and_b32 v111, 0xffff0000, v67
    v_fmac_f32 v118, v110, v24
    v_fmac_f32 v119, v111, v24
    v_lshlrev_b32 v110, 16, v68
    v_and_b32 v111, 0xffff0000, v68
    v_fmac_f32 v112, v110, v25
    v_fmac_f32 v113, v111, v25
    v_lshlrev_b32 v110, 16, v69
    v_and_b32 v111, 0xffff0000, v69
    v_fmac_f32 v114, v110, v25
    v_fmac_f32 v115, v111, v25
    v_lshlrev_b32 v110, 16, v70
    v_and_b32 v111, 0xffff0000, v70
    v_fmac_f32 v116, v110, v25
    v_fmac_f32 v117, v111, v25
    v_lshlrev_b32 v110, 16, v71
    v_and_b32 v111, 0xffff0000, v71
    v_fmac_f32 v118, v110, v25
    v_fmac_f32 v119, v111, v25
    v_lshlrev_b32 v110, 16, v72
    v_and_b32 v111, 0xffff0000, v72
    v_fmac_f32 v112, v110, v26
    v_fmac_f32 v113, v111, v26
    v_lshlrev_b32 v110, 16, v73
    v_and_b32 v111, 0xffff0000, v73
    v_fmac_f32 v114, v110, v26
    v_fmac_f32 v115, v111, v26
    v_lshlrev_b32 v110, 16, v74
    v_and_b32 v111, 0xffff0000, v74
    v_fmac_f32 v116, v110, v26
    v_fmac_f32 v117, v111, v26
    v_lshlrev_b32 v110, 16, v75
    v_and_b32 v111, 0xffff0000, v75
    v_fmac_f32 v118, v110, v26
    v_fmac_f32 v119, v111, v26
    v_lshlrev_b32 v110, 16, v76
    v_and_b32 v111, 0xffff0000, v76
    v_fmac_f32 v112, v110, v27
    v_fmac_f32 v113, v111, v27
    v_lshlrev_b32 v110, 16, v77
    v_and_b32 v111, 0xffff0000, v77
    v_fmac_f32 v114, v110, v27
    v_fmac_f32 v115, v111, v27
    v_lshlrev_b32 v110, 16, v78
    v_and_b32 v111, 0xffff0000, v78
    v_fmac_f32 v116, v110, v27
    v_fmac_f32 v117, v111, v27
    v_lshlrev_b32 v110, 16, v79
    v_and_b32 v111, 0xffff0000, v79
    v_fmac_f32 v118, v110, v27
    v_fmac_f32 v119, v111, v27
    v_lshlrev_b32 v110, 16, v80
    v_and_b32 v111, 0xffff0000, v80
    v_fmac_f32 v112, v110, v28
    v_fmac_f32 v113, v111, v28
    v_lshlrev_b32 v110, 16, v81
    v_and_b32 v111, 0xffff0000, v81
    v_fmac_f32 v114, v110, v28
    v_fmac_f32 v115, v111, v28
    v_lshlrev_b32 v110, 16, v82
    v_and_b32 v111, 0xffff0000, v82
    v_fmac_f32 v116, v110, v28
    v_fmac_f32 v117, v111, v28
    v_lshlrev_b32 v110, 16, v83
    v_and_b32 v111, 0xffff0000, v83
    v_fmac_f32 v118, v110, v28
    v_fmac_f32 v119, v111, v28
    v_lshlrev_b32 v110, 16, v84
    v_and_b32 v111, 0xffff0000, v84
    v_fmac_f32 v112, v110, v29
    v_fmac_f32 v113, v111, v29
    v_lshlrev_b32 v110, 16, v85
    v_and_b32 v111, 0xffff0000, v85
    v_fmac_f32 v114, v110, v29
    v_fmac_f32 v115, v111, v29
    v_lshlrev_b32 v110, 16, v86
    v_and_b32 v111, 0xffff0000, v86
    v_fmac_f32 v116, v110, v29
    v_fmac_f32 v117, v111, v29
    v_lshlrev_b32 v110, 16, v87
    v_and_b32 v111, 0xffff0000, v87
    v_fmac_f32 v118, v110, v29
    v_fmac_f32 v119, v111, v29
    v_lshlrev_b32 v110, 16, v88
    v_and_b32 v111, 0xffff0000, v88
    v_fmac_f32 v112, v110, v30
    v_fmac_f32 v113, v111, v30
    v_lshlrev_b32 v110, 16, v89
    v_and_b32 v111, 0xffff0000, v89
    v_fmac_f32 v114, v110, v30
    v_fmac_f32 v115, v111, v30
    v_lshlrev_b32 v110, 16, v90
    v_and_b32 v111, 0xffff0000, v90
    v_fmac_f32 v116, v110, v30
    v_fmac_f32 v117, v111, v30
    v_lshlrev_b32 v110, 16, v91
    v_and_b32 v111, 0xffff0000, v91
    v_fmac_f32 v118, v110, v30
    v_fmac_f32 v119, v111, v30
    v_lshlrev_b32 v110, 16, v92
    v_and_b32 v111, 0xffff0000, v92
    v_fmac_f32 v112, v110, v31
    v_fmac_f32 v113, v111, v31
    v_lshlrev_b32 v110, 16, v93
    v_and_b32 v111, 0xffff0000, v93
    v_fmac_f32 v114, v110, v31
    v_fmac_f32 v115, v111, v31
    v_lshlrev_b32 v110, 16, v94
    v_and_b32 v111, 0xffff0000, v94
    v_fmac_f32 v116, v110, v31
    v_fmac_f32 v117, v111, v31
    v_lshlrev_b32 v110, 16, v95
    v_and_b32 v111, 0xffff0000, v95
    v_fmac_f32 v118, v110, v31
    v_fmac_f32 v119, v111, v31
    v_lshlrev_b32 v3, 5, v0
    ds_write_b128 v3, v[112:115]
    ds_write_b128 v3, v[116:119] offset:16
    s_waitcnt lgkmcnt(0)
    s_barrier
    v_cmp_gt_u32 vcc, 32, v0
    s_and_saveexec_b64 s[40:41], vcc
    s_cbranch_execz L_mod_fin_2
    v_lshlrev_b32 v3, 2, v0
    v_mov_b32 v5, 0
    ds_read_b32 v32, v3 offset:0
    ds_read_b32 v33, v3 offset:128
    ds_read_b32 v34, v3 offset:256
    ds_read_b32 v35, v3 offset:384
    ds_read_b32 v36, v3 offset:512
    ds_read_b32 v37, v3 offset:640
    ds_read_b32 v38, v3 offset:768
    ds_read_b32 v39, v3 offset:896
    ds_read_b32 v40, v3 offset:1024
    ds_read_b32 v41, v3 offset:1152
    ds_read_b32 v42, v3 offset:1280
    ds_read_b32 v43, v3 offset:1408
    ds_read_b32 v44, v3 offset:1536
    ds_read_b32 v45, v3 offset:1664
    ds_read_b32 v46, v3 offset:1792
    ds_read_b32 v47, v3 offset:1920
    s_waitcnt lgkmcnt(0)
    v_add_f32 v5, v5, v32
    v_add_f32 v5, v5, v33
    v_add_f32 v5, v5, v34
    v_add_f32 v5, v5, v35
    v_add_f32 v5, v5, v36
    v_add_f32 v5, v5, v37
    v_add_f32 v5, v5, v38
    v_add_f32 v5, v5, v39
    v_add_f32 v5, v5, v40
    v_add_f32 v5, v5, v41
    v_add_f32 v5, v5, v42
    v_add_f32 v5, v5, v43
    v_add_f32 v5, v5, v44
    v_add_f32 v5, v5, v45
    v_add_f32 v5, v5, v46
    v_add_f32 v5, v5, v47
    ds_read_b32 v32, v3 offset:2048
    ds_read_b32 v33, v3 offset:2176
    ds_read_b32 v34, v3 offset:2304
    ds_read_b32 v35, v3 offset:2432
    ds_read_b32 v36, v3 offset:2560
    ds_read_b32 v37, v3 offset:2688
    ds_read_b32 v38, v3 offset:2816
    ds_read_b32 v39, v3 offset:2944
    ds_read_b32 v40, v3 offset:3072
    ds_read_b32 v41, v3 offset:3200
    ds_read_b32 v42, v3 offset:3328
    ds_read_b32 v43, v3 offset:3456
    ds_read_b32 v44, v3 offset:3584
    ds_read_b32 v45, v3 offset:3712
    ds_read_b32 v46, v3 offset:3840
    ds_read_b32 v47, v3 offset:3968
    s_waitcnt lgkmcnt(0)
    v_add_f32 v5, v5, v32
    v_add_f32 v5, v5, v33
    v_add_f32 v5, v5, v34
    v_add_f32 v5, v5, v35
    v_add_f32 v5, v5, v36
    v_add_f32 v5, v5, v37
    v_add_f32 v5, v5, v38
    v_add_f32 v5, v5, v39
    v_add_f32 v5, v5, v40
    v_add_f32 v5, v5, v41
    v_add_f32 v5, v5, v42
    v_add_f32 v5, v5, v43
    v_add_f32 v5, v5, v44
    v_add_f32 v5, v5, v45
    v_add_f32 v5, v5, v46
    v_add_f32 v5, v5, v47
    ds_read_b32 v32, v3 offset:4096
    ds_read_b32 v33, v3 offset:4224
    ds_read_b32 v34, v3 offset:4352
    ds_read_b32 v35, v3 offset:4480
    ds_read_b32 v36, v3 offset:4608
    ds_read_b32 v37, v3 offset:4736
    ds_read_b32 v38, v3 offset:4864
    ds_read_b32 v39, v3 offset:4992
    ds_read_b32 v40, v3 offset:5120
    ds_read_b32 v41, v3 offset:5248
    ds_read_b32 v42, v3 offset:5376
    ds_read_b32 v43, v3 offset:5504
    ds_read_b32 v44, v3 offset:5632
    ds_read_b32 v45, v3 offset:5760
    ds_read_b32 v46, v3 offset:5888
    ds_read_b32 v47, v3 offset:6016
    s_waitcnt lgkmcnt(0)
    v_add_f32 v5, v5, v32
    v_add_f32 v5, v5, v33
    v_add_f32 v5, v5, v34
    v_add_f32 v5, v5, v35
    v_add_f32 v5, v5, v36
    v_add_f32 v5, v5, v37
    v_add_f32 v5, v5, v38
    v_add_f32 v5, v5, v39
    v_add_f32 v5, v5, v40
    v_add_f32 v5, v5, v41
    v_add_f32 v5, v5, v42
    v_add_f32 v5, v5, v43
    v_add_f32 v5, v5, v44
    v_add_f32 v5, v5, v45
    v_add_f32 v5, v5, v46
    v_add_f32 v5, v5, v47
    ds_read_b32 v32, v3 offset:6144
    ds_read_b32 v33, v3 offset:6272
    ds_read_b32 v34, v3 offset:6400
    ds_read_b32 v35, v3 offset:6528
    ds_read_b32 v36, v3 offset:6656
    ds_read_b32 v37, v3 offset:6784
    ds_read_b32 v38, v3 offset:6912
    ds_read_b32 v39, v3 offset:7040
    ds_read_b32 v40, v3 offset:7168
    ds_read_b32 v41, v3 offset:7296
    ds_read_b32 v42, v3 offset:7424
    ds_read_b32 v43, v3 offset:7552
    ds_read_b32 v44, v3 offset:7680
    ds_read_b32 v45, v3 offset:7808
    ds_read_b32 v46, v3 offset:7936
    ds_read_b32 v47, v3 offset:8064
    s_waitcnt lgkmcnt(0)
    v_add_f32 v5, v5, v32
    v_add_f32 v5, v5, v33
    v_add_f32 v5, v5, v34
    v_add_f32 v5, v5, v35
    v_add_f32 v5, v5, v36
    v_add_f32 v5, v5, v37
    v_add_f32 v5, v5, v38
    v_add_f32 v5, v5, v39
    v_add_f32 v5, v5, v40
    v_add_f32 v5, v5, v41
    v_add_f32 v5, v5, v42
    v_add_f32 v5, v5, v43
    v_add_f32 v5, v5, v44
    v_add_f32 v5, v5, v45
    v_add_f32 v5, v5, v46
    v_add_f32 v5, v5, v47
    v_cvt_pk_bf16_f32 v5, v5, v5
    v_lshlrev_b32 v5, 16, v5
    s_lshl_b32 s38, s2, 7
    buffer_store_dword v5, v3, s[16:19], s38 offen
L_mod_fin_2:
    s_mov_b64 exec, s[40:41]
L_mod_done_1:
    s_endpgm
.globl k1_ln_kernel
.p2align 8
.type k1_ln_kernel,@function
k1_ln_kernel:
    s_cmp_ge_u32 s2, 512
    s_cbranch_scc1 L_ln_done_3
    s_load_dwordx2 s[4:5], s[0:1], 0
    s_load_dwordx2 s[20:21], s[0:1], 128
    v_lshrrev_b32 v1, 6, v0
    v_and_b32 v2, 63, v0
    s_waitcnt lgkmcnt(0)
    s_mov_b32 s8, s4
    s_and_b32 s9, s5, 0xffff
    s_mov_b32 s10, 0x400000
    s_mov_b32 s11, 0x00020000
    s_add_u32 s12, s20, 0x400000
    s_addc_u32 s13, s21, 0
    s_and_b32 s13, s13, 0xffff
    s_mov_b32 s14, 0x400000
    s_mov_b32 s15, 0x00020000
    s_mov_b32 s16, s20
    s_and_b32 s17, s21, 0xffff
    s_mov_b32 s18, 0x6000
    s_mov_b32 s19, 0x00020000
    s_lshl_b32 s25, s2, 12
    v_lshlrev_b32 v68, 4, v0
    v_add_u32 v68, s25, v68
    s_load_dwordx4 s[40:43], s[0:1], 16
    s_load_dwordx2 s[44:45], s[0:1], 32
    s_waitcnt lgkmcnt(0)
    s_mov_b32 s48, s44
    s_and_b32 s49, s45, 0xffff
    s_mov_b32 s50, 0x800000
    s_mov_b32 s51, 0x00020000
    s_mov_b32 s25, 0
    buffer_load_dwordx4 v[72:75], v68, s[48:51], s25 offen
    s_mov_b32 s25, 2097152
    buffer_load_dwordx4 v[76:79], v68, s[48:51], s25 offen
    s_mov_b32 s25, 4194304
    buffer_load_dwordx4 v[80:83], v68, s[48:51], s25 offen
    s_mov_b32 s25, 6291456
    buffer_load_dwordx4 v[84:87], v68, s[48:51], s25 offen
    s_lshl_b32 s22, s2, 13
    v_lshlrev_b32 v3, 11, v1
    v_lshlrev_b32 v4, 4, v2
    v_add_u32 v3, v3, v4
    buffer_load_dwordx4 v[8:11], v3, s[8:11], s22 offen
    buffer_load_dwordx4 v[12:15], v3, s[8:11], s22 offen offset:1024
    v_lshlrev_b32 v5, 5, v2
    s_mov_b32 s23, 0
    s_mov_b32 s24, 4096
    buffer_load_dwordx4 v[32:35], v5, s[16:19], s23 offen offset:0
    buffer_load_dwordx4 v[48:51], v5, s[16:19], s24 offen offset:0
    buffer_load_dwordx4 v[36:39], v5, s[16:19], s23 offen offset:16
    buffer_load_dwordx4 v[52:55], v5, s[16:19], s24 offen offset:16
    buffer_load_dwordx4 v[40:43], v5, s[16:19], s23 offen offset:2048
    buffer_load_dwordx4 v[56:59], v5, s[16:19], s24 offen offset:2048
    buffer_load_dwordx4 v[44:47], v5, s[16:19], s23 offen offset:2064
    buffer_load_dwordx4 v[60:63], v5, s[16:19], s24 offen offset:2064
    s_waitcnt vmcnt(8)
    v_lshlrev_b32 v16, 16, v8
    v_and_b32 v17, 0xffff0000, v8
    v_lshlrev_b32 v18, 16, v9
    v_and_b32 v19, 0xffff0000, v9
    v_lshlrev_b32 v20, 16, v10
    v_and_b32 v21, 0xffff0000, v10
    v_lshlrev_b32 v22, 16, v11
    v_and_b32 v23, 0xffff0000, v11
    v_lshlrev_b32 v24, 16, v12
    v_and_b32 v25, 0xffff0000, v12
    v_lshlrev_b32 v26, 16, v13
    v_and_b32 v27, 0xffff0000, v13
    v_lshlrev_b32 v28, 16, v14
    v_and_b32 v29, 0xffff0000, v14
    v_lshlrev_b32 v30, 16, v15
    v_and_b32 v31, 0xffff0000, v15
    v_add_f32 v6, v16, v17
    v_add_f32 v6, v6, v18
    v_add_f32 v6, v6, v19
    v_add_f32 v6, v6, v20
    v_add_f32 v6, v6, v21
    v_add_f32 v6, v6, v22
    v_add_f32 v6, v6, v23
    v_add_f32 v6, v6, v24
    v_add_f32 v6, v6, v25
    v_add_f32 v6, v6, v26
    v_add_f32 v6, v6, v27
    v_add_f32 v6, v6, v28
    v_add_f32 v6, v6, v29
    v_add_f32 v6, v6, v30
    v_add_f32 v6, v6, v31
    s_nop 1
    v_add_f32_dpp v6, v6, v6 row_shr:1 row_mask:0xf bank_mask:0xf bound_ctrl:0
    s_nop 1
    v_add_f32_dpp v6, v6, v6 row_shr:2 row_mask:0xf bank_mask:0xf bound_ctrl:0
    s_nop 1
    v_add_f32_dpp v6, v6, v6 row_shr:4 row_mask:0xf bank_mask:0xf bound_ctrl:0
    s_nop 1
    v_add_f32_dpp v6, v6, v6 row_shr:8 row_mask:0xf bank_mask:0xf bound_ctrl:0
    s_nop 1
    v_add_f32_dpp v6, v6, v6 row_bcast:15 row_mask:0xa bank_mask:0xf
    s_nop 1
    v_add_f32_dpp v6, v6, v6 row_bcast:31 row_mask:0xc bank_mask:0xf
    s_nop 1
    v_readlane_b32 s26, v6, 63
    v_mov_b32 v7, s26
    v_mul_f32 v7, 0x3a800000, v7
    v_mov_b32 v6, 0
    v_sub_f32 v64, v16, v7
    v_fmac_f32 v6, v64, v64
    v_sub_f32 v64, v17, v7
    v_fmac_f32 v6, v64, v64
    v_sub_f32 v64, v18, v7
    v_fmac_f32 v6, v64, v64
    v_sub_f32 v64, v19, v7
    v_fmac_f32 v6, v64, v64
    v_sub_f32 v64, v20, v7
    v_fmac_f32 v6, v64, v64
    v_sub_f32 v64, v21, v7
    v_fmac_f32 v6, v64, v64
    v_sub_f32 v64, v22, v7
    v_fmac_f32 v6, v64, v64
    v_sub_f32 v64, v23, v7
    v_fmac_f32 v6, v64, v64
    v_sub_f32 v64, v24, v7
    v_fmac_f32 v6, v64, v64
    v_sub_f32 v64, v25, v7
    v_fmac_f32 v6, v64, v64
    v_sub_f32 v64, v26, v7
    v_fmac_f32 v6, v64, v64
    v_sub_f32 v64, v27, v7
    v_fmac_f32 v6, v64, v64
    v_sub_f32 v64, v28, v7
    v_fmac_f32 v6, v64, v64
    v_sub_f32 v64, v29, v7
    v_fmac_f32 v6, v64, v64
    v_sub_f32 v64, v30, v7
    v_fmac_f32 v6, v64, v64
    v_sub_f32 v64, v31, v7
    v_fmac_f32 v6, v64, v64
    s_nop 1
    v_add_f32_dpp v6, v6, v6 row_shr:1 row_mask:0xf bank_mask:0xf bound_ctrl:0
    s_nop 1
    v_add_f32_dpp v6, v6, v6 row_shr:2 row_mask:0xf bank_mask:0xf bound_ctrl:0
    s_nop 1
    v_add_f32_dpp v6, v6, v6 row_shr:4 row_mask:0xf bank_mask:0xf bound_ctrl:0
    s_nop 1
    v_add_f32_dpp v6, v6, v6 row_shr:8 row_mask:0xf bank_mask:0xf bound_ctrl:0
    s_nop 1
    v_add_f32_dpp v6, v6, v6 row_bcast:15 row_mask:0xa bank_mask:0xf
    s_nop 1
    v_add_f32_dpp v6, v6, v6 row_bcast:31 row_mask:0xc bank_mask:0xf
    s_nop 1
    v_readlane_b32 s27, v6, 63
    v_mov_b32 v6, s27
    v_mul_f32 v6, 0x3a800000, v6
    v_cvt_pk_bf16_f32 v6, v6, v6
    v_lshlrev_b32 v6, 16, v6
    v_cvt_pk_bf16_f32 v7, v7, v7
    v_lshlrev_b32 v7, 16, v7
    v_add_f32 v6, 0x3727c5ac, v6
    v_cvt_pk_bf16_f32 v6, v6, v6
    v_lshlrev_b32 v6, 16, v6
    v_sqrt_f32 v6, v6
    s_nop 0
    v_cvt_pk_bf16_f32 v6, v6, v6
    v_lshlrev_b32 v6, 16, v6
    v_rcp_f32 v6, v6
    s_waitcnt vmcnt(0)
    v_sub_f32 v16, v16, v7
    v_cvt_pk_bf16_f32 v16, v16, v16
    v_lshlrev_b32 v16, 16, v16
    v_mul_f32 v16, v16, v6
    v_cvt_pk_bf16_f32 v16, v16, v16
    v_lshlrev_b32 v16, 16, v16
    v_add_f32 v64, 1.0, v48
    v_cvt_pk_bf16_f32 v64, v64, v64
    v_lshlrev_b32 v64, 16, v64
    v_mul_f32 v16, v16, v64
    v_cvt_pk_bf16_f32 v16, v16, v16
    v_lshlrev_b32 v16, 16, v16
    v_add_f32 v16, v16, v32
    v_sub_f32 v17, v17, v7
    v_cvt_pk_bf16_f32 v17, v17, v17
    v_lshlrev_b32 v17, 16, v17
    v_mul_f32 v17, v17, v6
    v_cvt_pk_bf16_f32 v17, v17, v17
    v_lshlrev_b32 v17, 16, v17
    v_add_f32 v64, 1.0, v49
    v_cvt_pk_bf16_f32 v64, v64, v64
    v_lshlrev_b32 v64, 16, v64
    v_mul_f32 v17, v17, v64
    v_cvt_pk_bf16_f32 v17, v17, v17
    v_lshlrev_b32 v17, 16, v17
    v_add_f32 v17, v17, v33
    v_sub_f32 v18, v18, v7
    v_cvt_pk_bf16_f32 v18, v18, v18
    v_lshlrev_b32 v18, 16, v18
    v_mul_f32 v18, v18, v6
    v_cvt_pk_bf16_f32 v18, v18, v18
    v_lshlrev_b32 v18, 16, v18
    v_add_f32 v64, 1.0, v50
    v_cvt_pk_bf16_f32 v64, v64, v64
    v_lshlrev_b32 v64, 16, v64
    v_mul_f32 v18, v18, v64
    v_cvt_pk_bf16_f32 v18, v18, v18
    v_lshlrev_b32 v18, 16, v18
    v_add_f32 v18, v18, v34
    v_sub_f32 v19, v19, v7
    v_cvt_pk_bf16_f32 v19, v19, v19
    v_lshlrev_b32 v19, 16, v19
    v_mul_f32 v19, v19, v6
    v_cvt_pk_bf16_f32 v19, v19, v19
    v_lshlrev_b32 v19, 16, v19
    v_add_f32 v64, 1.0, v51
    v_cvt_pk_bf16_f32 v64, v64, v64
    v_lshlrev_b32 v64, 16, v64
    v_mul_f32 v19, v19, v64
    v_cvt_pk_bf16_f32 v19, v19, v19
    v_lshlrev_b32 v19, 16, v19
    v_add_f32 v19, v19, v35
    v_sub_f32 v20, v20, v7
    v_cvt_pk_bf16_f32 v20, v20, v20
    v_lshlrev_b32 v20, 16, v20
    v_mul_f32 v20, v20, v6
    v_cvt_pk_bf16_f32 v20, v20, v20
    v_lshlrev_b32 v20, 16, v20
    v_add_f32 v64, 1.0, v52
    v_cvt_pk_bf16_f32 v64, v64, v64
    v_lshlrev_b32 v64, 16, v64
    v_mul_f32 v20, v20, v64
    v_cvt_pk_bf16_f32 v20, v20, v20
    v_lshlrev_b32 v20, 16, v20
    v_add_f32 v20, v20, v36
    v_sub_f32 v21, v21, v7
    v_cvt_pk_bf16_f32 v21, v21, v21
    v_lshlrev_b32 v21, 16, v21
    v_mul_f32 v21, v21, v6
    v_cvt_pk_bf16_f32 v21, v21, v21
    v_lshlrev_b32 v21, 16, v21
    v_add_f32 v64, 1.0, v53
    v_cvt_pk_bf16_f32 v64, v64, v64
    v_lshlrev_b32 v64, 16, v64
    v_mul_f32 v21, v21, v64
    v_cvt_pk_bf16_f32 v21, v21, v21
    v_lshlrev_b32 v21, 16, v21
    v_add_f32 v21, v21, v37
    v_sub_f32 v22, v22, v7
    v_cvt_pk_bf16_f32 v22, v22, v22
    v_lshlrev_b32 v22, 16, v22
    v_mul_f32 v22, v22, v6
    v_cvt_pk_bf16_f32 v22, v22, v22
    v_lshlrev_b32 v22, 16, v22
    v_add_f32 v64, 1.0, v54
    v_cvt_pk_bf16_f32 v64, v64, v64
    v_lshlrev_b32 v64, 16, v64
    v_mul_f32 v22, v22, v64
    v_cvt_pk_bf16_f32 v22, v22, v22
    v_lshlrev_b32 v22, 16, v22
    v_add_f32 v22, v22, v38
    v_sub_f32 v23, v23, v7
    v_cvt_pk_bf16_f32 v23, v23, v23
    v_lshlrev_b32 v23, 16, v23
    v_mul_f32 v23, v23, v6
    v_cvt_pk_bf16_f32 v23, v23, v23
    v_lshlrev_b32 v23, 16, v23
    v_add_f32 v64, 1.0, v55
    v_cvt_pk_bf16_f32 v64, v64, v64
    v_lshlrev_b32 v64, 16, v64
    v_mul_f32 v23, v23, v64
    v_cvt_pk_bf16_f32 v23, v23, v23
    v_lshlrev_b32 v23, 16, v23
    v_add_f32 v23, v23, v39
    v_sub_f32 v24, v24, v7
    v_cvt_pk_bf16_f32 v24, v24, v24
    v_lshlrev_b32 v24, 16, v24
    v_mul_f32 v24, v24, v6
    v_cvt_pk_bf16_f32 v24, v24, v24
    v_lshlrev_b32 v24, 16, v24
    v_add_f32 v64, 1.0, v56
    v_cvt_pk_bf16_f32 v64, v64, v64
    v_lshlrev_b32 v64, 16, v64
    v_mul_f32 v24, v24, v64
    v_cvt_pk_bf16_f32 v24, v24, v24
    v_lshlrev_b32 v24, 16, v24
    v_add_f32 v24, v24, v40
    v_sub_f32 v25, v25, v7
    v_cvt_pk_bf16_f32 v25, v25, v25
    v_lshlrev_b32 v25, 16, v25
    v_mul_f32 v25, v25, v6
    v_cvt_pk_bf16_f32 v25, v25, v25
    v_lshlrev_b32 v25, 16, v25
    v_add_f32 v64, 1.0, v57
    v_cvt_pk_bf16_f32 v64, v64, v64
    v_lshlrev_b32 v64, 16, v64
    v_mul_f32 v25, v25, v64
    v_cvt_pk_bf16_f32 v25, v25, v25
    v_lshlrev_b32 v25, 16, v25
    v_add_f32 v25, v25, v41
    v_sub_f32 v26, v26, v7
    v_cvt_pk_bf16_f32 v26, v26, v26
    v_lshlrev_b32 v26, 16, v26
    v_mul_f32 v26, v26, v6
    v_cvt_pk_bf16_f32 v26, v26, v26
    v_lshlrev_b32 v26, 16, v26
    v_add_f32 v64, 1.0, v58
    v_cvt_pk_bf16_f32 v64, v64, v64
    v_lshlrev_b32 v64, 16, v64
    v_mul_f32 v26, v26, v64
    v_cvt_pk_bf16_f32 v26, v26, v26
    v_lshlrev_b32 v26, 16, v26
    v_add_f32 v26, v26, v42
    v_sub_f32 v27, v27, v7
    v_cvt_pk_bf16_f32 v27, v27, v27
    v_lshlrev_b32 v27, 16, v27
    v_mul_f32 v27, v27, v6
    v_cvt_pk_bf16_f32 v27, v27, v27
    v_lshlrev_b32 v27, 16, v27
    v_add_f32 v64, 1.0, v59
    v_cvt_pk_bf16_f32 v64, v64, v64
    v_lshlrev_b32 v64, 16, v64
    v_mul_f32 v27, v27, v64
    v_cvt_pk_bf16_f32 v27, v27, v27
    v_lshlrev_b32 v27, 16, v27
    v_add_f32 v27, v27, v43
    v_sub_f32 v28, v28, v7
    v_cvt_pk_bf16_f32 v28, v28, v28
    v_lshlrev_b32 v28, 16, v28
    v_mul_f32 v28, v28, v6
    v_cvt_pk_bf16_f32 v28, v28, v28
    v_lshlrev_b32 v28, 16, v28
    v_add_f32 v64, 1.0, v60
    v_cvt_pk_bf16_f32 v64, v64, v64
    v_lshlrev_b32 v64, 16, v64
    v_mul_f32 v28, v28, v64
    v_cvt_pk_bf16_f32 v28, v28, v28
    v_lshlrev_b32 v28, 16, v28
    v_add_f32 v28, v28, v44
    v_sub_f32 v29, v29, v7
    v_cvt_pk_bf16_f32 v29, v29, v29
    v_lshlrev_b32 v29, 16, v29
    v_mul_f32 v29, v29, v6
    v_cvt_pk_bf16_f32 v29, v29, v29
    v_lshlrev_b32 v29, 16, v29
    v_add_f32 v64, 1.0, v61
    v_cvt_pk_bf16_f32 v64, v64, v64
    v_lshlrev_b32 v64, 16, v64
    v_mul_f32 v29, v29, v64
    v_cvt_pk_bf16_f32 v29, v29, v29
    v_lshlrev_b32 v29, 16, v29
    v_add_f32 v29, v29, v45
    v_sub_f32 v30, v30, v7
    v_cvt_pk_bf16_f32 v30, v30, v30
    v_lshlrev_b32 v30, 16, v30
    v_mul_f32 v30, v30, v6
    v_cvt_pk_bf16_f32 v30, v30, v30
    v_lshlrev_b32 v30, 16, v30
    v_add_f32 v64, 1.0, v62
    v_cvt_pk_bf16_f32 v64, v64, v64
    v_lshlrev_b32 v64, 16, v64
    v_mul_f32 v30, v30, v64
    v_cvt_pk_bf16_f32 v30, v30, v30
    v_lshlrev_b32 v30, 16, v30
    v_add_f32 v30, v30, v46
    v_sub_f32 v31, v31, v7
    v_cvt_pk_bf16_f32 v31, v31, v31
    v_lshlrev_b32 v31, 16, v31
    v_mul_f32 v31, v31, v6
    v_cvt_pk_bf16_f32 v31, v31, v31
    v_lshlrev_b32 v31, 16, v31
    v_add_f32 v64, 1.0, v63
    v_cvt_pk_bf16_f32 v64, v64, v64
    v_lshlrev_b32 v64, 16, v64
    v_mul_f32 v31, v31, v64
    v_cvt_pk_bf16_f32 v31, v31, v31
    v_lshlrev_b32 v31, 16, v31
    v_add_f32 v31, v31, v47
    v_cvt_pk_bf16_f32 v8, v16, v17
    v_cvt_pk_bf16_f32 v9, v18, v19
    v_cvt_pk_bf16_f32 v10, v20, v21
    v_cvt_pk_bf16_f32 v11, v22, v23
    v_cvt_pk_bf16_f32 v12, v24, v25
    v_cvt_pk_bf16_f32 v13, v26, v27
    v_cvt_pk_bf16_f32 v14, v28, v29
    v_cvt_pk_bf16_f32 v15, v30, v31
    buffer_store_dwordx4 v[8:11], v3, s[12:15], s22 offen
    buffer_store_dwordx4 v[12:15], v3, s[12:15], s22 offen offset:1024
L_ln_done_3:
    s_endpgm
.globl k2_qkv_kernel
.p2align 8
.type k2_qkv_kernel,@function
k2_qkv_kernel:
    s_cmp_ge_u32 s2, 1536
    s_cbranch_scc1 L_g_done_4
    s_load_dwordx2 s[20:21], s[0:1], 128
    s_and_b32 s42, s2, 7
    s_lshr_b32 s43, s2, 3
    s_and_b32 s40, s43, 15
    s_lshr_b32 s41, s43, 4
    s_lshl_b32 s41, s41, 3
    s_add_u32 s41, s41, s42
    s_lshr_b32 s42, s41, 5
    s_lshl_b32 s42, s42, 3
    s_add_u32 s42, s42, 16
    s_load_dwordx2 s[6:7], s[0:1], s42
    s_and_b32 s43, s41, 31
    v_and_b32 v1, 63, v0
    v_lshrrev_b32 v2, 6, v0
    s_nop 0
    v_readfirstlane_b32 s44, v2
    s_waitcnt lgkmcnt(0)
    s_add_u32 s8, s20, 0x400000
    s_addc_u32 s9, s21, 0
    s_and_b32 s9, s9, 0xffff
    s_mov_b32 s10, 0x400000
    s_mov_b32 s11, 0x00020000
    s_mov_b32 s12, s6
    s_and_b32 s13, s7, 0xffff
    s_mov_b32 s14, 0x800000
    s_mov_b32 s15, 0x00020000
    s_add_u32 s16, s20, 0x2000000
    s_addc_u32 s17, s21, 0
    s_and_b32 s17, s17, 0xffff
    s_mov_b32 s18, 0x3000000
    s_mov_b32 s19, 0x00020000
    v_lshrrev_b32 v3, 2, v1
    s_lshl_b32 s45, s44, 5
    v_add_u32 v3, s45, v3
    v_and_b32 v4, 3, v1
    s_lshl_b32 s46, s40, 7
    s_mov_b32 s47, 2048
    v_add_u32 v5, 0, v3
    v_lshrrev_b32 v6, 2, v5
    v_and_b32 v6, 3, v6
    v_xor_b32 v6, v6, v4
    v_lshlrev_b32 v6, 4, v6
    v_add_u32 v5, s46, v5
    v_mul_lo_u32 v5, v5, s47
    v_add_u32 v10, v5, v6
    v_add_u32 v5, 16, v3
    v_lshrrev_b32 v6, 2, v5
    v_and_b32 v6, 3, v6
    v_xor_b32 v6, v6, v4
    v_lshlrev_b32 v6, 4, v6
    v_add_u32 v5, s46, v5
    v_mul_lo_u32 v5, v5, s47
    v_add_u32 v11, v5, v6
    v_lshrrev_b32 v3, 4, v1
    s_mul_i32 s45, s44, 8
    v_add_u32 v3, s45, v3
    v_and_b32 v4, 15, v1
    s_lshl_b32 s46, s43, 8
    s_mov_b32 s47, 8192
    v_add_u32 v5, 0, v3
    v_and_b32 v6, 3, v5
    v_lshlrev_b32 v6, 2, v6
    v_xor_b32 v6, v6, v4
    v_lshlrev_b32 v6, 4, v6
    v_mul_lo_u32 v5, v5, s47
    v_add_u32 v5, s46, v5
    v_add_u32 v14, v5, v6
    v_add_u32 v5, 4, v3
    v_and_b32 v6, 3, v5
    v_lshlrev_b32 v6, 2, v6
    v_xor_b32 v6, v6, v4
    v_lshlrev_b32 v6, 4, v6
    v_mul_lo_u32 v5, v5, s47
    v_add_u32 v5, s46, v5
    v_add_u32 v15, v5, v6
    s_lshr_b32 s48, s44, 1
    s_and_b32 s49, s44, 1
    v_and_b32 v3, 31, v1
    s_lshl_b32 s45, s48, 6
    v_add_u32 v3, s45, v3
    v_lshrrev_b32 v4, 2, v3
    v_and_b32 v4, 3, v4
    v_lshrrev_b32 v5, 5, v1
    v_lshlrev_b32 v3, 6, v3
    v_add_u32 v6, 0, v5
    v_xor_b32 v6, v6, v4
    v_lshlrev_b32 v6, 4, v6
    v_add_u32 v18, v3, v6
    v_add_u32 v6, 2, v5
    v_xor_b32 v6, v6, v4
    v_lshlrev_b32 v6, 4, v6
    v_add_u32 v19, v3, v6
    v_lshrrev_b32 v3, 5, v1
    v_lshlrev_b32 v3, 3, v3
    v_bfe_u32 v4, v1, 2, 2
    v_add_u32 v3, v3, v4
    v_bfe_u32 v5, v1, 4, 1
    v_lshlrev_b32 v5, 4, v5
    v_and_b32 v6, 3, v1
    v_lshlrev_b32 v6, 2, v6
    v_add_u32 v5, v5, v6
    s_mul_i32 s45, s49, 64
    v_add_u32 v5, s45, v5
    v_lshlrev_b32 v7, 2, v4
    v_mul_u32_u24 v3, 256, v3
    v_add_u32 v6, 0, v5
    v_lshrrev_b32 v8, 3, v6
    v_xor_b32 v8, v8, v7
    v_lshlrev_b32 v8, 4, v8
    v_and_b32 v6, 4, v6
    v_lshlrev_b32 v6, 1, v6
    v_add_u32 v8, v8, v6
    v_add_u32 v22, v3, v8
    v_add_u32 v6, 32, v5
    v_lshrrev_b32 v8, 3, v6
    v_xor_b32 v8, v8, v7
    v_lshlrev_b32 v8, 4, v8
    v_and_b32 v6, 4, v6
    v_lshlrev_b32 v6, 1, v6
    v_add_u32 v8, v8, v6
    v_add_u32 v23, v3, v8
    v_mov_b32 v64, 0
    v_mov_b32 v65, 0
    v_mov_b32 v66, 0
    v_mov_b32 v67, 0
    v_mov_b32 v68, 0
    v_mov_b32 v69, 0
    v_mov_b32 v70, 0
    v_mov_b32 v71, 0
    v_mov_b32 v72, 0
    v_mov_b32 v73, 0
    v_mov_b32 v74, 0
    v_mov_b32 v75, 0
    v_mov_b32 v76, 0
    v_mov_b32 v77, 0
    v_mov_b32 v78, 0
    v_mov_b32 v79, 0
    v_mov_b32 v80, 0
    v_mov_b32 v81, 0
    v_mov_b32 v82, 0
    v_mov_b32 v83, 0
    v_mov_b32 v84, 0
    v_mov_b32 v85, 0
    v_mov_b32 v86, 0
    v_mov_b32 v87, 0
    v_mov_b32 v88, 0
    v_mov_b32 v89, 0
    v_mov_b32 v90, 0
    v_mov_b32 v91, 0
    v_mov_b32 v92, 0
    v_mov_b32 v93, 0
    v_mov_b32 v94, 0
    v_mov_b32 v95, 0
    v_mov_b32 v96, 0
    v_mov_b32 v97, 0
    v_mov_b32 v98, 0
    v_mov_b32 v99, 0
    v_mov_b32 v100, 0
    v_mov_b32 v101, 0
    v_mov_b32 v102, 0
    v_mov_b32 v103, 0
    v_mov_b32 v104, 0
    v_mov_b32 v105, 0
    v_mov_b32 v106, 0
    v_mov_b32 v107, 0
    v_mov_b32 v108, 0
    v_mov_b32 v109, 0
    v_mov_b32 v110, 0
    v_mov_b32 v111, 0
    v_mov_b32 v112, 0
    v_mov_b32 v113, 0
    v_mov_b32 v114, 0
    v_mov_b32 v115, 0
    v_mov_b32 v116, 0
    v_mov_b32 v117, 0
    v_mov_b32 v118, 0
    v_mov_b32 v119, 0
    v_mov_b32 v120, 0
    v_mov_b32 v121, 0
    v_mov_b32 v122, 0
    v_mov_b32 v123, 0
    v_mov_b32 v124, 0
    v_mov_b32 v125, 0
    v_mov_b32 v126, 0
    v_mov_b32 v127, 0
    s_mov_b32 s50, 0
    s_mov_b32 s51, 0
    s_lshl_b32 s52, s44, 11
    s_mul_i32 s53, s44, 2048
    s_add_u32 s53, s53, 8192
    s_add_u32 m0, s52, 0
    s_nop 0
    buffer_load_dwordx4 v10, s[8:11], s50 offen lds
    s_add_u32 m0, s52, 1024
    s_nop 0
    buffer_load_dwordx4 v11, s[8:11], s50 offen lds
    s_add_u32 m0, s53, 0
    s_nop 0
    buffer_load_dwordx4 v14, s[12:15], s51 offen lds
    s_add_u32 m0, s53, 1024
    s_nop 0
    buffer_load_dwordx4 v15, s[12:15], s51 offen lds
    s_add_u32 s50, s50, 64
    s_add_u32 s51, s51, 262144
    s_add_u32 m0, s52, 16384
    s_nop 0
    buffer_load_dwordx4 v10, s[8:11], s50 offen lds
    s_add_u32 m0, s52, 17408
    s_nop 0
    buffer_load_dwordx4 v11, s[8:11], s50 offen lds
    s_add_u32 m0, s53, 16384
    s_nop 0
    buffer_load_dwordx4 v14, s[12:15], s51 offen lds
    s_add_u32 m0, s53, 17408
    s_nop 0
    buffer_load_dwordx4 v15, s[12:15], s51 offen lds
    s_add_u32 s50, s50, 64
    s_add_u32 s51, s51, 262144
    s_add_u32 m0, s52, 32768
    s_nop 0
    buffer_load_dwordx4 v10, s[8:11], s50 offen lds
    s_add_u32 m0, s52, 33792
    s_nop 0
    buffer_load_dwordx4 v11, s[8:11], s50 offen lds
    s_add_u32 m0, s53, 32768
    s_nop 0
    buffer_load_dwordx4 v14, s[12:15], s51 offen lds
    s_add_u32 m0, s53, 33792
    s_nop 0
    buffer_load_dwordx4 v15, s[12:15], s51 offen lds
    s_add_u32 s50, s50, 64
    s_add_u32 s51, s51, 262144
    s_mov_b32 s54, 0
L_g_loop_5:
    s_waitcnt vmcnt(8)
    s_barrier
    ds_read_b128 v[26:29], v18 offset:0
    ds_read_b128 v[30:33], v18 offset:2048
    ds_read_b64_tr_b16 v[34:35], v22 offset:8192
    ds_read_b64_tr_b16 v[36:37], v22 offset:9216
    ds_read_b64_tr_b16 v[38:39], v23 offset:8192
    ds_read_b64_tr_b16 v[40:41], v23 offset:9216
    ds_read_b128 v[42:45], v19 offset:0
    ds_read_b128 v[46:49], v19 offset:2048
    ds_read_b64_tr_b16 v[50:51], v22 offset:12288
    ds_read_b64_tr_b16 v[52:53], v22 offset:13312
    ds_read_b64_tr_b16 v[54:55], v23 offset:12288
    ds_read_b64_tr_b16 v[56:57], v23 offset:13312
    s_add_u32 m0, s52, 49152
    s_nop 0
    buffer_load_dwordx4 v10, s[8:11], s50 offen lds
    s_add_u32 m0, s52, 50176
    s_nop 0
    buffer_load_dwordx4 v11, s[8:11], s50 offen lds
    s_add_u32 m0, s53, 49152
    s_nop 0
    buffer_load_dwordx4 v14, s[12:15], s51 offen lds
    s_add_u32 m0, s53, 50176
    s_nop 0
    buffer_load_dwordx4 v15, s[12:15], s51 offen lds
    s_add_u32 s50, s50, 64
    s_add_u32 s51, s51, 262144
    s_waitcnt lgkmcnt(6)
    v_mfma_f32_32x32x16_bf16 v[64:79], v[34:37], v[26:29], v[64:79]
    v_mfma_f32_32x32x16_bf16 v[80:95], v[38:41], v[26:29], v[80:95]
    v_mfma_f32_32x32x16_bf16 v[96:111], v[34:37], v[30:33], v[96:111]
    v_mfma_f32_32x32x16_bf16 v[112:127], v[38:41], v[30:33], v[112:127]
    s_waitcnt lgkmcnt(0)
    v_mfma_f32_32x32x16_bf16 v[64:79], v[50:53], v[42:45], v[64:79]
    v_mfma_f32_32x32x16_bf16 v[80:95], v[54:57], v[42:45], v[80:95]
    v_mfma_f32_32x32x16_bf16 v[96:111], v[50:53], v[46:49], v[96:111]
    v_mfma_f32_32x32x16_bf16 v[112:127], v[54:57], v[46:49], v[112:127]
    s_waitcnt vmcnt(8)
    s_barrier
    ds_read_b128 v[26:29], v18 offset:16384
    ds_read_b128 v[30:33], v18 offset:18432
    ds_read_b64_tr_b16 v[34:35], v22 offset:24576
    ds_read_b64_tr_b16 v[36:37], v22 offset:25600
    ds_read_b64_tr_b16 v[38:39], v23 offset:24576
    ds_read_b64_tr_b16 v[40:41], v23 offset:25600
    ds_read_b128 v[42:45], v19 offset:16384
    ds_read_b128 v[46:49], v19 offset:18432
    ds_read_b64_tr_b16 v[50:51], v22 offset:28672
    ds_read_b64_tr_b16 v[52:53], v22 offset:29696
    ds_read_b64_tr_b16 v[54:55], v23 offset:28672
    ds_read_b64_tr_b16 v[56:57], v23 offset:29696
    s_add_u32 m0, s52, 0
    s_nop 0
    buffer_load_dwordx4 v10, s[8:11], s50 offen lds
    s_add_u32 m0, s52, 1024
    s_nop 0
    buffer_load_dwordx4 v11, s[8:11], s50 offen lds
    s_add_u32 m0, s53, 0
    s_nop 0
    buffer_load_dwordx4 v14, s[12:15], s51 offen lds
    s_add_u32 m0, s53, 1024
    s_nop 0
    buffer_load_dwordx4 v15, s[12:15], s51 offen lds
    s_add_u32 s50, s50, 64
    s_add_u32 s51, s51, 262144
    s_waitcnt lgkmcnt(6)
    v_mfma_f32_32x32x16_bf16 v[64:79], v[34:37], v[26:29], v[64:79]
    v_mfma_f32_32x32x16_bf16 v[80:95], v[38:41], v[26:29], v[80:95]
    v_mfma_f32_32x32x16_bf16 v[96:111], v[34:37], v[30:33], v[96:111]
    v_mfma_f32_32x32x16_bf16 v[112:127], v[38:41], v[30:33], v[112:127]
    s_waitcnt lgkmcnt(0)
    v_mfma_f32_32x32x16_bf16 v[64:79], v[50:53], v[42:45], v[64:79]
    v_mfma_f32_32x32x16_bf16 v[80:95], v[54:57], v[42:45], v[80:95]
    v_mfma_f32_32x32x16_bf16 v[96:111], v[50:53], v[46:49], v[96:111]
    v_mfma_f32_32x32x16_bf16 v[112:127], v[54:57], v[46:49], v[112:127]
    s_waitcnt vmcnt(8)
    s_barrier
    ds_read_b128 v[26:29], v18 offset:32768
    ds_read_b128 v[30:33], v18 offset:34816
    ds_read_b64_tr_b16 v[34:35], v22 offset:40960
    ds_read_b64_tr_b16 v[36:37], v22 offset:41984
    ds_read_b64_tr_b16 v[38:39], v23 offset:40960
    ds_read_b64_tr_b16 v[40:41], v23 offset:41984
    ds_read_b128 v[42:45], v19 offset:32768
    ds_read_b128 v[46:49], v19 offset:34816
    ds_read_b64_tr_b16 v[50:51], v22 offset:45056
    ds_read_b64_tr_b16 v[52:53], v22 offset:46080
    ds_read_b64_tr_b16 v[54:55], v23 offset:45056
    ds_read_b64_tr_b16 v[56:57], v23 offset:46080
    s_add_u32 m0, s52, 16384
    s_nop 0
    buffer_load_dwordx4 v10, s[8:11], s50 offen lds
    s_add_u32 m0, s52, 17408
    s_nop 0
    buffer_load_dwordx4 v11, s[8:11], s50 offen lds
    s_add_u32 m0, s53, 16384
    s_nop 0
    buffer_load_dwordx4 v14, s[12:15], s51 offen lds
    s_add_u32 m0, s53, 17408
    s_nop 0
    buffer_load_dwordx4 v15, s[12:15], s51 offen lds
    s_add_u32 s50, s50, 64
    s_add_u32 s51, s51, 262144
    s_waitcnt lgkmcnt(6)
    v_mfma_f32_32x32x16_bf16 v[64:79], v[34:37], v[26:29], v[64:79]
    v_mfma_f32_32x32x16_bf16 v[80:95], v[38:41], v[26:29], v[80:95]
    v_mfma_f32_32x32x16_bf16 v[96:111], v[34:37], v[30:33], v[96:111]
    v_mfma_f32_32x32x16_bf16 v[112:127], v[38:41], v[30:33], v[112:127]
    s_waitcnt lgkmcnt(0)
    v_mfma_f32_32x32x16_bf16 v[64:79], v[50:53], v[42:45], v[64:79]
    v_mfma_f32_32x32x16_bf16 v[80:95], v[54:57], v[42:45], v[80:95]
    v_mfma_f32_32x32x16_bf16 v[96:111], v[50:53], v[46:49], v[96:111]
    v_mfma_f32_32x32x16_bf16 v[112:127], v[54:57], v[46:49], v[112:127]
    s_waitcnt vmcnt(8)
    s_barrier
    ds_read_b128 v[26:29], v18 offset:49152
    ds_read_b128 v[30:33], v18 offset:51200
    ds_read_b64_tr_b16 v[34:35], v22 offset:57344
    ds_read_b64_tr_b16 v[36:37], v22 offset:58368
    ds_read_b64_tr_b16 v[38:39], v23 offset:57344
    ds_read_b64_tr_b16 v[40:41], v23 offset:58368
    ds_read_b128 v[42:45], v19 offset:49152
    ds_read_b128 v[46:49], v19 offset:51200
    ds_read_b64_tr_b16 v[50:51], v22 offset:61440
    ds_read_b64_tr_b16 v[52:53], v22 offset:62464
    ds_read_b64_tr_b16 v[54:55], v23 offset:61440
    ds_read_b64_tr_b16 v[56:57], v23 offset:62464
    s_add_u32 m0, s52, 32768
    s_nop 0
    buffer_load_dwordx4 v10, s[8:11], s50 offen lds
    s_add_u32 m0, s52, 33792
    s_nop 0
    buffer_load_dwordx4 v11, s[8:11], s50 offen lds
    s_add_u32 m0, s53, 32768
    s_nop 0
    buffer_load_dwordx4 v14, s[12:15], s51 offen lds
    s_add_u32 m0, s53, 33792
    s_nop 0
    buffer_load_dwordx4 v15, s[12:15], s51 offen lds
    s_add_u32 s50, s50, 64
    s_add_u32 s51, s51, 262144
    s_waitcnt lgkmcnt(6)
    v_mfma_f32_32x32x16_bf16 v[64:79], v[34:37], v[26:29], v[64:79]
    v_mfma_f32_32x32x16_bf16 v[80:95], v[38:41], v[26:29], v[80:95]
    v_mfma_f32_32x32x16_bf16 v[96:111], v[34:37], v[30:33], v[96:111]
    v_mfma_f32_32x32x16_bf16 v[112:127], v[38:41], v[30:33], v[112:127]
    s_waitcnt lgkmcnt(0)
    v_mfma_f32_32x32x16_bf16 v[64:79], v[50:53], v[42:45], v[64:79]
    v_mfma_f32_32x32x16_bf16 v[80:95], v[54:57], v[42:45], v[80:95]
    v_mfma_f32_32x32x16_bf16 v[96:111], v[50:53], v[46:49], v[96:111]
    v_mfma_f32_32x32x16_bf16 v[112:127], v[54:57], v[46:49], v[112:127]
    s_add_u32 s54, s54, 4
    s_cmp_lt_u32 s54, 32
    s_cbranch_scc1 L_g_loop_5
    s_nop 15
    s_waitcnt vmcnt(0)
    v_and_b32 v3, 31, v1
    s_lshl_b32 s45, s40, 7
    s_lshl_b32 s46, s48, 6
    s_add_u32 s45, s45, s46
    v_add_u32 v3, s45, v3
    v_lshrrev_b32 v4, 5, v1
    v_lshlrev_b32 v4, 2, v4
    s_mul_i32 s45, s41, 128
    s_mul_i32 s46, s49, 64
    s_add_u32 s45, s45, s46
    v_add_u32 v4, s45, v4
    s_mov_b32 s47, 24576
    v_mul_lo_u32 v5, v3, s47
    v_lshlrev_b32 v6, 1, v4
    v_add_u32 v5, v5, v6
    v_lshrrev_b32 v61, 5, v1
    v_lshlrev_b32 v61, 3, v61
    v_add_u32 v61, v61, v5
    s_waitcnt vmcnt(0)
    v_cvt_pk_bf16_f32 v64, v64, v65
    v_cvt_pk_bf16_f32 v65, v66, v67
    v_cvt_pk_bf16_f32 v66, v68, v69
    v_cvt_pk_bf16_f32 v67, v70, v71
    v_cvt_pk_bf16_f32 v72, v72, v73
    v_cvt_pk_bf16_f32 v73, v74, v75
    v_cvt_pk_bf16_f32 v74, v76, v77
    v_cvt_pk_bf16_f32 v75, v78, v79
    v_mov_b32 v9, v61
    s_nop 0
    v_permlane32_swap_b32 v64, v66
    v_permlane32_swap_b32 v65, v67
    v_permlane32_swap_b32 v72, v74
    v_permlane32_swap_b32 v73, v75
    buffer_store_dwordx4 v[64:67], v9, s[16:19], 0 offen offset:0
    buffer_store_dwordx4 v[72:75], v9, s[16:19], 0 offen offset:32
    s_waitcnt vmcnt(0)
    v_cvt_pk_bf16_f32 v96, v96, v97
    v_cvt_pk_bf16_f32 v97, v98, v99
    v_cvt_pk_bf16_f32 v98, v100, v101
    v_cvt_pk_bf16_f32 v99, v102, v103
    v_cvt_pk_bf16_f32 v104, v104, v105
    v_cvt_pk_bf16_f32 v105, v106, v107
    v_cvt_pk_bf16_f32 v106, v108, v109
    v_cvt_pk_bf16_f32 v107, v110, v111
    v_add_u32 v9, 786432, v61
    s_nop 0
    v_permlane32_swap_b32 v96, v98
    v_permlane32_swap_b32 v97, v99
    v_permlane32_swap_b32 v104, v106
    v_permlane32_swap_b32 v105, v107
    buffer_store_dwordx4 v[96:99], v9, s[16:19], 0 offen offset:0
    buffer_store_dwordx4 v[104:107], v9, s[16:19], 0 offen offset:32
    s_waitcnt vmcnt(0)
    v_cvt_pk_bf16_f32 v80, v80, v81
    v_cvt_pk_bf16_f32 v81, v82, v83
    v_cvt_pk_bf16_f32 v82, v84, v85
    v_cvt_pk_bf16_f32 v83, v86, v87
    v_cvt_pk_bf16_f32 v88, v88, v89
    v_cvt_pk_bf16_f32 v89, v90, v91
    v_cvt_pk_bf16_f32 v90, v92, v93
    v_cvt_pk_bf16_f32 v91, v94, v95
    v_mov_b32 v9, v61
    s_nop 0
    v_permlane32_swap_b32 v80, v82
    v_permlane32_swap_b32 v81, v83
    v_permlane32_swap_b32 v88, v90
    v_permlane32_swap_b32 v89, v91
    buffer_store_dwordx4 v[80:83], v9, s[16:19], 0 offen offset:64
    buffer_store_dwordx4 v[88:91], v9, s[16:19], 0 offen offset:96
    s_waitcnt vmcnt(0)
    v_cvt_pk_bf16_f32 v112, v112, v113
    v_cvt_pk_bf16_f32 v113, v114, v115
    v_cvt_pk_bf16_f32 v114, v116, v117
    v_cvt_pk_bf16_f32 v115, v118, v119
    v_cvt_pk_bf16_f32 v120, v120, v121
    v_cvt_pk_bf16_f32 v121, v122, v123
    v_cvt_pk_bf16_f32 v122, v124, v125
    v_cvt_pk_bf16_f32 v123, v126, v127
    v_add_u32 v9, 786432, v61
    s_nop 0
    v_permlane32_swap_b32 v112, v114
    v_permlane32_swap_b32 v113, v115
    v_permlane32_swap_b32 v120, v122
    v_permlane32_swap_b32 v121, v123
    buffer_store_dwordx4 v[112:115], v9, s[16:19], 0 offen offset:64
    buffer_store_dwordx4 v[120:123], v9, s[16:19], 0 offen offset:96
L_g_done_4:
    s_endpgm
.globl k3_chain_kernel
.p2align 8
.type k3_chain_kernel,@function
k3_chain_kernel:
    s_cmp_ge_u32 s2, 256
    s_cbranch_scc1 L_c_done_6
    s_and_b32 s40, s2, 7
    s_cmp_ge_u32 s40, 2
    s_cbranch_scc1 L_c_done_6
    s_load_dwordx4 s[4:7], s[0:1], 16
    s_load_dwordx4 s[8:11], s[0:1], 32
    s_load_dwordx2 s[20:21], s[0:1], 128
    s_load_dwordx2 s[22:23], s[0:1], 120
    s_load_dwordx2 s[50:51], s[0:1], 8
    s_lshr_b32 s41, s2, 3
    s_and_b32 s42, s41, 15
    s_lshl_b32 s43, s40, 4
    s_add_u32 s43, s43, s42
    v_and_b32 v1, 63, v0
    v_lshrrev_b32 v2, 6, v0
    s_nop 0
    v_readfirstlane_b32 s44, v2
    s_waitcnt lgkmcnt(0)
    s_mov_b32 s24, s4
    s_and_b32 s25, s5, 0xffff
    s_mov_b32 s26, 0x800000
    s_mov_b32 s27, 0x00020000
    s_mov_b32 s28, s6
    s_and_b32 s29, s7, 0xffff
    s_mov_b32 s30, 0x800000
    s_mov_b32 s31, 0x00020000
    s_mov_b32 s32, s8
    s_and_b32 s33, s9, 0xffff
    s_mov_b32 s34, 0x800000
    s_mov_b32 s35, 0x00020000
    s_mov_b32 s36, s10
    s_and_b32 s37, s11, 0xffff
    s_mov_b32 s38, 0x800000
    s_mov_b32 s39, 0x00020000
    s_mov_b32 s12, s20
    s_and_b32 s13, s21, 0xffff
    s_mov_b32 s14, 0x10000000
    s_mov_b32 s15, 0x00020000
    s_mov_b32 s16, s22
    s_and_b32 s17, s23, 0xffff
    s_mov_b32 s18, 0x100
    s_mov_b32 s19, 0x00020000
    s_mov_b32 s52, s50
    s_and_b32 s53, s51, 0xffff
    s_mov_b32 s54, 0x4000
    s_mov_b32 s55, 0x00020000
    v_and_b32 v21, 8, v1
    v_cmp_eq_u32 s[56:57], 0, v21
    v_mov_b32 v2, 0xeeee
    v_mov_b32 v3, 0x4444
    v_cndmask_b32 v2, v2, v3, s[56:57]
    v_lshlrev_b32 v68, 4, v1
    s_lshl_b32 s45, s44, 12
    v_add_u32 v3, s45, v68
    v_add_u32 v4, 4096, v3
    v_and_b32 v4, 16383, v4
    v_add_u32 v21, 8192, v3
    v_and_b32 v21, 16383, v21
    v_add_u32 v23, 12288, v3
    v_and_b32 v23, 16383, v23
    s_mul_i32 s45, s44, 24576
    s_add_u32 s45, s45, 65536
    v_add_u32 v5, s45, v68
    v_lshrrev_b32 v63, 4, v1
    s_lshl_b32 s45, s44, 2
    v_add_u32 v64, s45, v63
    s_lshr_b32 s45, s44, 1
    s_lshl_b32 s45, s45, 2
    v_add_u32 v65, s45, v63
    v_bfe_u32 v66, v1, 1, 3
    v_xor_b32 v66, v66, v65
    v_lshrrev_b32 v65, 1, v66
    v_lshlrev_b32 v65, 21, v65
    v_lshlrev_b32 v66, 5, v66
    v_and_b32 v67, 1, v1
    v_lshlrev_b32 v67, 4, v67
    v_add3_u32 v66, v66, v67, v65
    v_lshlrev_b32 v64, 13, v64
    v_add_u32 v82, v64, v66
    s_lshl_b32 s47, s43, 8
    s_lshl_b32 s48, s44, 10
    v_bfe_u32 v64, v1, 2, 2
    v_bfe_u32 v65, v1, 4, 1
    v_lshlrev_b32 v65, 2, v65
    v_add_u32 v65, v65, v64
    v_lshlrev_b32 v66, 3, v63
    v_add_u32 v66, v66, v64
    v_lshlrev_b32 v66, 8, v66
    v_and_b32 v67, 3, v1
    v_lshlrev_b32 v67, 3, v67
    v_add_u32 v66, v66, v67
    s_lshl_b32 s45, s44, 1
    v_xor_b32 v65, s45, v65
    v_lshlrev_b32 v65, 5, v65
    v_add_u32 v80, v66, v65
    v_xor_b32 v81, 32, v80
    v_mov_b32 v40, -1
    v_mov_b32 v41, -1
    v_mov_b32 v42, -1
    v_mov_b32 v43, -1
    v_mov_b32 v44, 0
    s_mov_b32 s68, 0
    s_cmp_ge_u32 s41, 16
    s_cbranch_scc1 L_c_vo_7
    s_lshl_b32 s45, s42, 11
    s_lshr_b32 s46, s44, 1
    s_lshl_b32 s46, s46, 10
    s_add_u32 s45, s45, s46
    s_and_b32 s46, s44, 1
    s_lshl_b32 s46, s46, 7
    s_add_u32 s45, s45, s46
    v_add_u32 v17, s45, v68
    s_lshl_b32 s62, s40, 17
    s_add_u32 s62, s62, 0x7040000
    s_mov_b64 exec, s[56:57]
    s_add_u32 s63, s62, 0
    buffer_store_dwordx4 v[40:43], v17, s[12:15], s63 offen sc1
    s_add_u32 s63, s62, 32768
    buffer_store_dwordx4 v[40:43], v17, s[12:15], s63 offen sc1
    s_add_u32 s63, s62, 65536
    buffer_store_dwordx4 v[40:43], v17, s[12:15], s63 offen sc1
    s_add_u32 s63, s62, 98304
    buffer_store_dwordx4 v[40:43], v17, s[12:15], s63 offen sc1
    s_mov_b64 exec, -1
    s_lshl_b32 s45, s40, 11
    s_lshl_b32 s46, s42, 2
    s_add_u32 s45, s45, s46
    s_add_u32 s45, s45, 0x7080000
    s_lshl_b32 s46, s44, 9
    s_add_u32 s45, s45, s46
    v_and_b32 v20, 3, v1
    v_lshlrev_b32 v20, 7, v20
    v_add_u32 v20, s45, v20
    buffer_store_dword v44, v20, s[12:15], 0 offen sc1
    s_waitcnt vmcnt(0)
    s_barrier
    s_cmp_lg_u32 s44, 0
    s_cbranch_scc1 L_hs_8
    s_getreg_b32 s45, hwreg(HW_REG_XCC_ID)
    s_and_b32 s45, s45, 15
    s_lshl_b32 s45, 1, s45
    v_mov_b32 v40, s45
    s_lshl_b32 s46, s40, 2
    s_add_u32 s46, s46, 4
    v_mov_b32 v41, 0
    v_mov_b32 v42, 1
    v_mov_b32 v43, s68
    s_mov_b64 exec, 1
    buffer_atomic_or v40, v41, s[16:19], s46 offen sc1
    buffer_atomic_add v43, v41, s[16:19], 0 offen offset:12 sc1
    s_waitcnt vmcnt(0)
    buffer_atomic_add v42, v41, s[16:19], 0 offen sc1
    s_waitcnt vmcnt(0)
    s_mov_b64 exec, -1
L_hs_8:
    v_add_u32 v83, 0x0, v82
    v_and_b32 v83, 0x7fffff, v83
    s_add_u32 s46, s47, 0x0
    s_add_u32 m0, s48, 0
    s_nop 0
    buffer_load_dwordx4 v83, s[24:27], s46 offen lds
    s_add_u32 s46, s47, 0x20000
    s_add_u32 m0, s48, 4096
    s_nop 0
    buffer_load_dwordx4 v83, s[24:27], s46 offen lds
    s_add_u32 s46, s47, 0x40000
    s_add_u32 m0, s48, 8192
    s_nop 0
    buffer_load_dwordx4 v83, s[24:27], s46 offen lds
    s_add_u32 s46, s47, 0x60000
    s_add_u32 m0, s48, 12288
    s_nop 0
    buffer_load_dwordx4 v83, s[24:27], s46 offen lds
    v_add_u32 v83, 0x80000, v82
    v_and_b32 v83, 0x7fffff, v83
    s_add_u32 s46, s47, 0x0
    s_add_u32 m0, s48, 16384
    s_nop 0
    buffer_load_dwordx4 v83, s[24:27], s46 offen lds
    s_add_u32 s46, s47, 0x20000
    s_add_u32 m0, s48, 20480
    s_nop 0
    buffer_load_dwordx4 v83, s[24:27], s46 offen lds
    s_add_u32 s46, s47, 0x40000
    s_add_u32 m0, s48, 24576
    s_nop 0
    buffer_load_dwordx4 v83, s[24:27], s46 offen lds
    s_add_u32 s46, s47, 0x60000
    s_add_u32 m0, s48, 28672
    s_nop 0
    buffer_load_dwordx4 v83, s[24:27], s46 offen lds
    v_add_u32 v83, 0x100000, v82
    v_and_b32 v83, 0x7fffff, v83
    s_add_u32 s46, s47, 0x0
    s_add_u32 m0, s48, 32768
    s_nop 0
    buffer_load_dwordx4 v83, s[24:27], s46 offen lds
    s_add_u32 s46, s47, 0x20000
    s_add_u32 m0, s48, 36864
    s_nop 0
    buffer_load_dwordx4 v83, s[24:27], s46 offen lds
    s_add_u32 s46, s47, 0x40000
    s_add_u32 m0, s48, 40960
    s_nop 0
    buffer_load_dwordx4 v83, s[24:27], s46 offen lds
    s_add_u32 s46, s47, 0x60000
    s_add_u32 m0, s48, 45056
    s_nop 0
    buffer_load_dwordx4 v83, s[24:27], s46 offen lds
    s_waitcnt vmcnt(8)
    s_barrier
    v_add_u32 v83, 0x180000, v82
    v_and_b32 v83, 0x7fffff, v83
    s_add_u32 s46, s47, 0x0
    s_add_u32 m0, s48, 49152
    s_nop 0
    buffer_load_dwordx4 v83, s[24:27], s46 offen lds
    s_add_u32 s46, s47, 0x20000
    s_add_u32 m0, s48, 53248
    s_nop 0
    buffer_load_dwordx4 v83, s[24:27], s46 offen lds
    s_add_u32 s46, s47, 0x40000
    s_add_u32 m0, s48, 57344
    s_nop 0
    buffer_load_dwordx4 v83, s[24:27], s46 offen lds
    s_add_u32 s46, s47, 0x60000
    s_add_u32 m0, s48, 61440
    s_nop 0
    buffer_load_dwordx4 v83, s[24:27], s46 offen lds
    ds_read_b64_tr_b16 a[0:1], v80 offset:0
    ds_read_b64_tr_b16 a[2:3], v80 offset:1024
    ds_read_b64_tr_b16 a[4:5], v80 offset:8192
    ds_read_b64_tr_b16 a[6:7], v80 offset:9216
    ds_read_b64_tr_b16 a[8:9], v81 offset:0
    ds_read_b64_tr_b16 a[10:11], v81 offset:1024
    ds_read_b64_tr_b16 a[12:13], v81 offset:8192
    ds_read_b64_tr_b16 a[14:15], v81 offset:9216
    s_waitcnt lgkmcnt(0)
    s_waitcnt vmcnt(8)
    s_barrier
    v_add_u32 v83, 0x200000, v82
    v_and_b32 v83, 0x7fffff, v83
    s_add_u32 s46, s47, 0x0
    s_add_u32 m0, s48, 0
    s_nop 0
    buffer_load_dwordx4 v83, s[24:27], s46 offen lds
    s_add_u32 s46, s47, 0x20000
    s_add_u32 m0, s48, 4096
    s_nop 0
    buffer_load_dwordx4 v83, s[24:27], s46 offen lds
    s_add_u32 s46, s47, 0x40000
    s_add_u32 m0, s48, 8192
    s_nop 0
    buffer_load_dwordx4 v83, s[24:27], s46 offen lds
    s_add_u32 s46, s47, 0x60000
    s_add_u32 m0, s48, 12288
    s_nop 0
    buffer_load_dwordx4 v83, s[24:27], s46 offen lds
    ds_read_b64_tr_b16 a[32:33], v80 offset:16384
    ds_read_b64_tr_b16 a[34:35], v80 offset:17408
    ds_read_b64_tr_b16 a[36:37], v80 offset:24576
    ds_read_b64_tr_b16 a[38:39], v80 offset:25600
    ds_read_b64_tr_b16 a[40:41], v81 offset:16384
    ds_read_b64_tr_b16 a[42:43], v81 offset:17408
    ds_read_b64_tr_b16 a[44:45], v81 offset:24576
    ds_read_b64_tr_b16 a[46:47], v81 offset:25600
    s_waitcnt lgkmcnt(0)
    s_waitcnt vmcnt(8)
    s_barrier
    v_add_u32 v83, 0x280000, v82
    v_and_b32 v83, 0x7fffff, v83
    s_add_u32 s46, s47, 0x0
    s_add_u32 m0, s48, 16384
    s_nop 0
    buffer_load_dwordx4 v83, s[24:27], s46 offen lds
    s_add_u32 s46, s47, 0x20000
    s_add_u32 m0, s48, 20480
    s_nop 0
    buffer_load_dwordx4 v83, s[24:27], s46 offen lds
    s_add_u32 s46, s47, 0x40000
    s_add_u32 m0, s48, 24576
    s_nop 0
    buffer_load_dwordx4 v83, s[24:27], s46 offen lds
    s_add_u32 s46, s47, 0x60000
    s_add_u32 m0, s48, 28672
    s_nop 0
    buffer_load_dwordx4 v83, s[24:27], s46 offen lds
    ds_read_b64_tr_b16 a[64:65], v80 offset:32768
    ds_read_b64_tr_b16 a[66:67], v80 offset:33792
    ds_read_b64_tr_b16 a[68:69], v80 offset:40960
    ds_read_b64_tr_b16 a[70:71], v80 offset:41984
    ds_read_b64_tr_b16 v[56:57], v81 offset:32768
    ds_read_b64_tr_b16 v[58:59], v81 offset:33792
    ds_read_b64_tr_b16 v[60:61], v81 offset:40960
    ds_read_b64_tr_b16 v[62:63], v81 offset:41984
    s_waitcnt lgkmcnt(0)
    ds_write_b128 v5, v[56:59] offset:0
    ds_write_b128 v5, v[60:63] offset:1024
    s_waitcnt lgkmcnt(0)
    s_waitcnt vmcnt(8)
    s_barrier
    v_add_u32 v83, 0x300000, v82
    v_and_b32 v83, 0x7fffff, v83
    s_add_u32 s46, s47, 0x0
    s_add_u32 m0, s48, 32768
    s_nop 0
    buffer_load_dwordx4 v83, s[24:27], s46 offen lds
    s_add_u32 s46, s47, 0x20000
    s_add_u32 m0, s48, 36864
    s_nop 0
    buffer_load_dwordx4 v83, s[24:27], s46 offen lds
    s_add_u32 s46, s47, 0x40000
    s_add_u32 m0, s48, 40960
    s_nop 0
    buffer_load_dwordx4 v83, s[24:27], s46 offen lds
    s_add_u32 s46, s47, 0x60000
    s_add_u32 m0, s48, 45056
    s_nop 0
    buffer_load_dwordx4 v83, s[24:27], s46 offen lds
    ds_read_b64_tr_b16 a[80:81], v80 offset:49152
    ds_read_b64_tr_b16 a[82:83], v80 offset:50176
    ds_read_b64_tr_b16 a[84:85], v80 offset:57344
    ds_read_b64_tr_b16 a[86:87], v80 offset:58368
    ds_read_b64_tr_b16 v[56:57], v81 offset:49152
    ds_read_b64_tr_b16 v[58:59], v81 offset:50176
    ds_read_b64_tr_b16 v[60:61], v81 offset:57344
    ds_read_b64_tr_b16 v[62:63], v81 offset:58368
    s_waitcnt lgkmcnt(0)
    ds_write_b128 v5, v[56:59] offset:4096
    ds_write_b128 v5, v[60:63] offset:5120
    s_waitcnt lgkmcnt(0)
    s_waitcnt vmcnt(8)
    s_barrier
    v_add_u32 v83, 0x380000, v82
    v_and_b32 v83, 0x7fffff, v83
    s_add_u32 s46, s47, 0x0
    s_add_u32 m0, s48, 49152
    s_nop 0
    buffer_load_dwordx4 v83, s[24:27], s46 offen lds
    s_add_u32 s46, s47, 0x20000
    s_add_u32 m0, s48, 53248
    s_nop 0
    buffer_load_dwordx4 v83, s[24:27], s46 offen lds
    s_add_u32 s46, s47, 0x40000
    s_add_u32 m0, s48, 57344
    s_nop 0
    buffer_load_dwordx4 v83, s[24:27], s46 offen lds
    s_add_u32 s46, s47, 0x60000
    s_add_u32 m0, s48, 61440
    s_nop 0
    buffer_load_dwordx4 v83, s[24:27], s46 offen lds
    ds_read_b64_tr_b16 a[104:105], v80 offset:0
    ds_read_b64_tr_b16 a[106:107], v80 offset:1024
    ds_read_b64_tr_b16 a[108:109], v80 offset:8192
    ds_read_b64_tr_b16 a[110:111], v80 offset:9216
    ds_read_b64_tr_b16 v[56:57], v81 offset:0
    ds_read_b64_tr_b16 v[58:59], v81 offset:1024
    ds_read_b64_tr_b16 v[60:61], v81 offset:8192
    ds_read_b64_tr_b16 v[62:63], v81 offset:9216
    s_waitcnt lgkmcnt(0)
    ds_write_b128 v5, v[56:59] offset:6144
    ds_write_b128 v5, v[60:63] offset:7168
    s_waitcnt lgkmcnt(0)
    s_waitcnt vmcnt(8)
    s_barrier
    v_add_u32 v83, 0x400000, v82
    v_and_b32 v83, 0x7fffff, v83
    s_add_u32 s46, s47, 0x0
    s_add_u32 m0, s48, 0
    s_nop 0
    buffer_load_dwordx4 v83, s[24:27], s46 offen lds
    s_add_u32 s46, s47, 0x20000
    s_add_u32 m0, s48, 4096
    s_nop 0
    buffer_load_dwordx4 v83, s[24:27], s46 offen lds
    s_add_u32 s46, s47, 0x40000
    s_add_u32 m0, s48, 8192
    s_nop 0
    buffer_load_dwordx4 v83, s[24:27], s46 offen lds
    s_add_u32 s46, s47, 0x60000
    s_add_u32 m0, s48, 12288
    s_nop 0
    buffer_load_dwordx4 v83, s[24:27], s46 offen lds
    ds_read_b64_tr_b16 a[128:129], v80 offset:16384
    ds_read_b64_tr_b16 a[130:131], v80 offset:17408
    ds_read_b64_tr_b16 a[132:133], v80 offset:24576
    ds_read_b64_tr_b16 a[134:135], v80 offset:25600
    ds_read_b64_tr_b16 v[56:57], v81 offset:16384
    ds_read_b64_tr_b16 v[58:59], v81 offset:17408
    ds_read_b64_tr_b16 v[60:61], v81 offset:24576
    ds_read_b64_tr_b16 v[62:63], v81 offset:25600
    s_waitcnt lgkmcnt(0)
    ds_write_b128 v5, v[56:59] offset:8192
    ds_write_b128 v5, v[60:63] offset:9216
    s_waitcnt lgkmcnt(0)
    s_waitcnt vmcnt(8)
    s_barrier
    v_add_u32 v83, 0x480000, v82
    v_and_b32 v83, 0x7fffff, v83
    s_add_u32 s46, s47, 0x0
    s_add_u32 m0, s48, 16384
    s_nop 0
    buffer_load_dwordx4 v83, s[24:27], s46 offen lds
    s_add_u32 s46, s47, 0x20000
    s_add_u32 m0, s48, 20480
    s_nop 0
    buffer_load_dwordx4 v83, s[24:27], s46 offen lds
    s_add_u32 s46, s47, 0x40000
    s_add_u32 m0, s48, 24576
    s_nop 0
    buffer_load_dwordx4 v83, s[24:27], s46 offen lds
    s_add_u32 s46, s47, 0x60000
    s_add_u32 m0, s48, 28672
    s_nop 0
    buffer_load_dwordx4 v83, s[24:27], s46 offen lds
    ds_read_b64_tr_b16 a[152:153], v80 offset:32768
    ds_read_b64_tr_b16 a[154:155], v80 offset:33792
    ds_read_b64_tr_b16 a[156:157], v80 offset:40960
    ds_read_b64_tr_b16 a[158:159], v80 offset:41984
    ds_read_b64_tr_b16 v[56:57], v81 offset:32768
    ds_read_b64_tr_b16 v[58:59], v81 offset:33792
    ds_read_b64_tr_b16 v[60:61], v81 offset:40960
    ds_read_b64_tr_b16 v[62:63], v81 offset:41984
    s_waitcnt lgkmcnt(0)
    ds_write_b128 v5, v[56:59] offset:10240
    ds_write_b128 v5, v[60:63] offset:11264
    s_waitcnt lgkmcnt(0)
    s_waitcnt vmcnt(8)
    s_barrier
    v_add_u32 v83, 0x500000, v82
    v_and_b32 v83, 0x7fffff, v83
    s_add_u32 s46, s47, 0x0
    s_add_u32 m0, s48, 32768
    s_nop 0
    buffer_load_dwordx4 v83, s[24:27], s46 offen lds
    s_add_u32 s46, s47, 0x20000
    s_add_u32 m0, s48, 36864
    s_nop 0
    buffer_load_dwordx4 v83, s[24:27], s46 offen lds
    s_add_u32 s46, s47, 0x40000
    s_add_u32 m0, s48, 40960
    s_nop 0
    buffer_load_dwordx4 v83, s[24:27], s46 offen lds
    s_add_u32 s46, s47, 0x60000
    s_add_u32 m0, s48, 45056
    s_nop 0
    buffer_load_dwordx4 v83, s[24:27], s46 offen lds
    ds_read_b64_tr_b16 a[176:177], v80 offset:49152
    ds_read_b64_tr_b16 a[178:179], v80 offset:50176
    ds_read_b64_tr_b16 a[180:181], v80 offset:57344
    ds_read_b64_tr_b16 a[182:183], v80 offset:58368
    ds_read_b64_tr_b16 a[184:185], v81 offset:49152
    ds_read_b64_tr_b16 a[186:187], v81 offset:50176
    ds_read_b64_tr_b16 a[188:189], v81 offset:57344
    ds_read_b64_tr_b16 a[190:191], v81 offset:58368
    s_waitcnt lgkmcnt(0)
    s_waitcnt vmcnt(8)
    s_barrier
    v_add_u32 v83, 0x580000, v82
    v_and_b32 v83, 0x7fffff, v83
    s_add_u32 s46, s47, 0x0
    s_add_u32 m0, s48, 49152
    s_nop 0
    buffer_load_dwordx4 v83, s[24:27], s46 offen lds
    s_add_u32 s46, s47, 0x20000
    s_add_u32 m0, s48, 53248
    s_nop 0
    buffer_load_dwordx4 v83, s[24:27], s46 offen lds
    s_add_u32 s46, s47, 0x40000
    s_add_u32 m0, s48, 57344
    s_nop 0
    buffer_load_dwordx4 v83, s[24:27], s46 offen lds
    s_add_u32 s46, s47, 0x60000
    s_add_u32 m0, s48, 61440
    s_nop 0
    buffer_load_dwordx4 v83, s[24:27], s46 offen lds
    ds_read_b64_tr_b16 a[208:209], v80 offset:0
    ds_read_b64_tr_b16 a[210:211], v80 offset:1024
    ds_read_b64_tr_b16 a[212:213], v80 offset:8192
    ds_read_b64_tr_b16 a[214:215], v80 offset:9216
    ds_read_b64_tr_b16 v[56:57], v81 offset:0
    ds_read_b64_tr_b16 v[58:59], v81 offset:1024
    ds_read_b64_tr_b16 v[60:61], v81 offset:8192
    ds_read_b64_tr_b16 v[62:63], v81 offset:9216
    s_waitcnt lgkmcnt(0)
    ds_write_b128 v5, v[56:59] offset:12288
    ds_write_b128 v5, v[60:63] offset:13312
    s_waitcnt lgkmcnt(0)
    s_waitcnt vmcnt(8)
    s_barrier
    v_add_u32 v83, 0x600000, v82
    v_and_b32 v83, 0x7fffff, v83
    s_add_u32 s46, s47, 0x0
    s_add_u32 m0, s48, 0
    s_nop 0
    buffer_load_dwordx4 v83, s[24:27], s46 offen lds
    s_add_u32 s46, s47, 0x20000
    s_add_u32 m0, s48, 4096
    s_nop 0
    buffer_load_dwordx4 v83, s[24:27], s46 offen lds
    s_add_u32 s46, s47, 0x40000
    s_add_u32 m0, s48, 8192
    s_nop 0
    buffer_load_dwordx4 v83, s[24:27], s46 offen lds
    s_add_u32 s46, s47, 0x60000
    s_add_u32 m0, s48, 12288
    s_nop 0
    buffer_load_dwordx4 v83, s[24:27], s46 offen lds
    ds_read_b64_tr_b16 a[232:233], v80 offset:16384
    ds_read_b64_tr_b16 a[234:235], v80 offset:17408
    ds_read_b64_tr_b16 a[236:237], v80 offset:24576
    ds_read_b64_tr_b16 a[238:239], v80 offset:25600
    ds_read_b64_tr_b16 a[240:241], v81 offset:16384
    ds_read_b64_tr_b16 a[242:243], v81 offset:17408
    ds_read_b64_tr_b16 a[244:245], v81 offset:24576
    ds_read_b64_tr_b16 a[246:247], v81 offset:25600
    s_waitcnt lgkmcnt(0)
    s_waitcnt vmcnt(8)
    s_barrier
    v_add_u32 v83, 0x680000, v82
    v_and_b32 v83, 0x7fffff, v83
    s_add_u32 s46, s47, 0x0
    s_add_u32 m0, s48, 16384
    s_nop 0
    buffer_load_dwordx4 v83, s[24:27], s46 offen lds
    s_add_u32 s46, s47, 0x20000
    s_add_u32 m0, s48, 20480
    s_nop 0
    buffer_load_dwordx4 v83, s[24:27], s46 offen lds
    s_add_u32 s46, s47, 0x40000
    s_add_u32 m0, s48, 24576
    s_nop 0
    buffer_load_dwordx4 v83, s[24:27], s46 offen lds
    s_add_u32 s46, s47, 0x60000
    s_add_u32 m0, s48, 28672
    s_nop 0
    buffer_load_dwordx4 v83, s[24:27], s46 offen lds
    ds_read_b64_tr_b16 v[104:105], v80 offset:32768
    ds_read_b64_tr_b16 v[106:107], v80 offset:33792
    ds_read_b64_tr_b16 v[108:109], v80 offset:40960
    ds_read_b64_tr_b16 v[110:111], v80 offset:41984
    ds_read_b64_tr_b16 v[56:57], v81 offset:32768
    ds_read_b64_tr_b16 v[58:59], v81 offset:33792
    ds_read_b64_tr_b16 v[60:61], v81 offset:40960
    ds_read_b64_tr_b16 v[62:63], v81 offset:41984
    s_waitcnt lgkmcnt(0)
    ds_write_b128 v5, v[56:59] offset:14336
    ds_write_b128 v5, v[60:63] offset:15360
    s_waitcnt lgkmcnt(0)
    s_waitcnt vmcnt(8)
    s_barrier
    v_add_u32 v83, 0x700000, v82
    v_and_b32 v83, 0x7fffff, v83
    s_add_u32 s46, s47, 0x0
    s_add_u32 m0, s48, 32768
    s_nop 0
    buffer_load_dwordx4 v83, s[24:27], s46 offen lds
    s_add_u32 s46, s47, 0x20000
    s_add_u32 m0, s48, 36864
    s_nop 0
    buffer_load_dwordx4 v83, s[24:27], s46 offen lds
    s_add_u32 s46, s47, 0x40000
    s_add_u32 m0, s48, 40960
    s_nop 0
    buffer_load_dwordx4 v83, s[24:27], s46 offen lds
    s_add_u32 s46, s47, 0x60000
    s_add_u32 m0, s48, 45056
    s_nop 0
    buffer_load_dwordx4 v83, s[24:27], s46 offen lds
    ds_read_b64_tr_b16 v[128:129], v80 offset:49152
    ds_read_b64_tr_b16 v[130:131], v80 offset:50176
    ds_read_b64_tr_b16 v[132:133], v80 offset:57344
    ds_read_b64_tr_b16 v[134:135], v80 offset:58368
    ds_read_b64_tr_b16 v[136:137], v81 offset:49152
    ds_read_b64_tr_b16 v[138:139], v81 offset:50176
    ds_read_b64_tr_b16 v[140:141], v81 offset:57344
    ds_read_b64_tr_b16 v[142:143], v81 offset:58368
    s_waitcnt lgkmcnt(0)
    s_waitcnt vmcnt(8)
    s_barrier
    v_add_u32 v83, 0x780000, v82
    v_and_b32 v83, 0x7fffff, v83
    s_add_u32 s46, s47, 0x0
    s_add_u32 m0, s48, 49152
    s_nop 0
    buffer_load_dwordx4 v83, s[24:27], s46 offen lds
    s_add_u32 s46, s47, 0x20000
    s_add_u32 m0, s48, 53248
    s_nop 0
    buffer_load_dwordx4 v83, s[24:27], s46 offen lds
    s_add_u32 s46, s47, 0x40000
    s_add_u32 m0, s48, 57344
    s_nop 0
    buffer_load_dwordx4 v83, s[24:27], s46 offen lds
    s_add_u32 s46, s47, 0x60000
    s_add_u32 m0, s48, 61440
    s_nop 0
    buffer_load_dwordx4 v83, s[24:27], s46 offen lds
    ds_read_b64_tr_b16 v[160:161], v80 offset:0
    ds_read_b64_tr_b16 v[162:163], v80 offset:1024
    ds_read_b64_tr_b16 v[164:165], v80 offset:8192
    ds_read_b64_tr_b16 v[166:167], v80 offset:9216
    ds_read_b64_tr_b16 v[56:57], v81 offset:0
    ds_read_b64_tr_b16 v[58:59], v81 offset:1024
    ds_read_b64_tr_b16 v[60:61], v81 offset:8192
    ds_read_b64_tr_b16 v[62:63], v81 offset:9216
    s_waitcnt lgkmcnt(0)
    ds_write_b128 v5, v[56:59] offset:16384
    ds_write_b128 v5, v[60:63] offset:17408
    s_waitcnt lgkmcnt(0)
    s_waitcnt vmcnt(8)
    s_barrier
    v_add_u32 v83, 0x0, v82
    v_and_b32 v83, 0x7fffff, v83
    s_add_u32 s46, s47, 0x0
    s_add_u32 m0, s48, 0
    s_nop 0
    buffer_load_dwordx4 v83, s[28:31], s46 offen lds
    s_add_u32 s46, s47, 0x20000
    s_add_u32 m0, s48, 4096
    s_nop 0
    buffer_load_dwordx4 v83, s[28:31], s46 offen lds
    s_add_u32 s46, s47, 0x40000
    s_add_u32 m0, s48, 8192
    s_nop 0
    buffer_load_dwordx4 v83, s[28:31], s46 offen lds
    s_add_u32 s46, s47, 0x60000
    s_add_u32 m0, s48, 12288
    s_nop 0
    buffer_load_dwordx4 v83, s[28:31], s46 offen lds
    ds_read_b64_tr_b16 v[184:185], v80 offset:16384
    ds_read_b64_tr_b16 v[186:187], v80 offset:17408
    ds_read_b64_tr_b16 v[188:189], v80 offset:24576
    ds_read_b64_tr_b16 v[190:191], v80 offset:25600
    ds_read_b64_tr_b16 v[192:193], v81 offset:16384
    ds_read_b64_tr_b16 v[194:195], v81 offset:17408
    ds_read_b64_tr_b16 v[196:197], v81 offset:24576
    ds_read_b64_tr_b16 v[198:199], v81 offset:25600
    s_waitcnt lgkmcnt(0)
    s_waitcnt vmcnt(8)
    s_barrier
    v_add_u32 v83, 0x80000, v82
    v_and_b32 v83, 0x7fffff, v83
    s_add_u32 s46, s47, 0x0
    s_add_u32 m0, s48, 16384
    s_nop 0
    buffer_load_dwordx4 v83, s[28:31], s46 offen lds
    s_add_u32 s46, s47, 0x20000
    s_add_u32 m0, s48, 20480
    s_nop 0
    buffer_load_dwordx4 v83, s[28:31], s46 offen lds
    s_add_u32 s46, s47, 0x40000
    s_add_u32 m0, s48, 24576
    s_nop 0
    buffer_load_dwordx4 v83, s[28:31], s46 offen lds
    s_add_u32 s46, s47, 0x60000
    s_add_u32 m0, s48, 28672
    s_nop 0
    buffer_load_dwordx4 v83, s[28:31], s46 offen lds
    ds_read_b64_tr_b16 v[208:209], v80 offset:32768
    ds_read_b64_tr_b16 v[210:211], v80 offset:33792
    ds_read_b64_tr_b16 v[212:213], v80 offset:40960
    ds_read_b64_tr_b16 v[214:215], v80 offset:41984
    ds_read_b64_tr_b16 v[56:57], v81 offset:32768
    ds_read_b64_tr_b16 v[58:59], v81 offset:33792
    ds_read_b64_tr_b16 v[60:61], v81 offset:40960
    ds_read_b64_tr_b16 v[62:63], v81 offset:41984
    s_waitcnt lgkmcnt(0)
    ds_write_b128 v5, v[56:59] offset:18432
    ds_write_b128 v5, v[60:63] offset:19456
    s_waitcnt lgkmcnt(0)
    s_waitcnt vmcnt(8)
    s_barrier
    v_add_u32 v83, 0x100000, v82
    v_and_b32 v83, 0x7fffff, v83
    s_add_u32 s46, s47, 0x0
    s_add_u32 m0, s48, 32768
    s_nop 0
    buffer_load_dwordx4 v83, s[28:31], s46 offen lds
    s_add_u32 s46, s47, 0x20000
    s_add_u32 m0, s48, 36864
    s_nop 0
    buffer_load_dwordx4 v83, s[28:31], s46 offen lds
    s_add_u32 s46, s47, 0x40000
    s_add_u32 m0, s48, 40960
    s_nop 0
    buffer_load_dwordx4 v83, s[28:31], s46 offen lds
    s_add_u32 s46, s47, 0x60000
    s_add_u32 m0, s48, 45056
    s_nop 0
    buffer_load_dwordx4 v83, s[28:31], s46 offen lds
    ds_read_b64_tr_b16 v[232:233], v80 offset:49152
    ds_read_b64_tr_b16 v[234:235], v80 offset:50176
    ds_read_b64_tr_b16 v[236:237], v80 offset:57344
    ds_read_b64_tr_b16 v[238:239], v80 offset:58368
    ds_read_b64_tr_b16 v[240:241], v81 offset:49152
    ds_read_b64_tr_b16 v[242:243], v81 offset:50176
    ds_read_b64_tr_b16 v[244:245], v81 offset:57344
    ds_read_b64_tr_b16 v[246:247], v81 offset:58368
    s_waitcnt lgkmcnt(0)
    s_waitcnt vmcnt(8)
    s_barrier
    v_add_u32 v83, 0x180000, v82
    v_and_b32 v83, 0x7fffff, v83
    s_add_u32 s46, s47, 0x0
    s_add_u32 m0, s48, 49152
    s_nop 0
    buffer_load_dwordx4 v83, s[28:31], s46 offen lds
    s_add_u32 s46, s47, 0x20000
    s_add_u32 m0, s48, 53248
    s_nop 0
    buffer_load_dwordx4 v83, s[28:31], s46 offen lds
    s_add_u32 s46, s47, 0x40000
    s_add_u32 m0, s48, 57344
    s_nop 0
    buffer_load_dwordx4 v83, s[28:31], s46 offen lds
    s_add_u32 s46, s47, 0x60000
    s_add_u32 m0, s48, 61440
    s_nop 0
    buffer_load_dwordx4 v83, s[28:31], s46 offen lds
    ds_read_b64_tr_b16 a[16:17], v80 offset:0
    ds_read_b64_tr_b16 a[18:19], v80 offset:1024
    ds_read_b64_tr_b16 a[20:21], v80 offset:8192
    ds_read_b64_tr_b16 a[22:23], v80 offset:9216
    ds_read_b64_tr_b16 a[24:25], v81 offset:0
    ds_read_b64_tr_b16 a[26:27], v81 offset:1024
    ds_read_b64_tr_b16 a[28:29], v81 offset:8192
    ds_read_b64_tr_b16 a[30:31], v81 offset:9216
    s_waitcnt lgkmcnt(0)
    s_waitcnt vmcnt(8)
    s_barrier
    v_add_u32 v83, 0x200000, v82
    v_and_b32 v83, 0x7fffff, v83
    s_add_u32 s46, s47, 0x0
    s_add_u32 m0, s48, 0
    s_nop 0
    buffer_load_dwordx4 v83, s[28:31], s46 offen lds
    s_add_u32 s46, s47, 0x20000
    s_add_u32 m0, s48, 4096
    s_nop 0
    buffer_load_dwordx4 v83, s[28:31], s46 offen lds
    s_add_u32 s46, s47, 0x40000
    s_add_u32 m0, s48, 8192
    s_nop 0
    buffer_load_dwordx4 v83, s[28:31], s46 offen lds
    s_add_u32 s46, s47, 0x60000
    s_add_u32 m0, s48, 12288
    s_nop 0
    buffer_load_dwordx4 v83, s[28:31], s46 offen lds
    ds_read_b64_tr_b16 a[48:49], v80 offset:16384
    ds_read_b64_tr_b16 a[50:51], v80 offset:17408
    ds_read_b64_tr_b16 a[52:53], v80 offset:24576
    ds_read_b64_tr_b16 a[54:55], v80 offset:25600
    ds_read_b64_tr_b16 a[56:57], v81 offset:16384
    ds_read_b64_tr_b16 a[58:59], v81 offset:17408
    ds_read_b64_tr_b16 a[60:61], v81 offset:24576
    ds_read_b64_tr_b16 a[62:63], v81 offset:25600
    s_waitcnt lgkmcnt(0)
    s_waitcnt vmcnt(8)
    s_barrier
    v_add_u32 v83, 0x280000, v82
    v_and_b32 v83, 0x7fffff, v83
    s_add_u32 s46, s47, 0x0
    s_add_u32 m0, s48, 16384
    s_nop 0
    buffer_load_dwordx4 v83, s[28:31], s46 offen lds
    s_add_u32 s46, s47, 0x20000
    s_add_u32 m0, s48, 20480
    s_nop 0
    buffer_load_dwordx4 v83, s[28:31], s46 offen lds
    s_add_u32 s46, s47, 0x40000
    s_add_u32 m0, s48, 24576
    s_nop 0
    buffer_load_dwordx4 v83, s[28:31], s46 offen lds
    s_add_u32 s46, s47, 0x60000
    s_add_u32 m0, s48, 28672
    s_nop 0
    buffer_load_dwordx4 v83, s[28:31], s46 offen lds
    ds_read_b64_tr_b16 a[72:73], v80 offset:32768
    ds_read_b64_tr_b16 a[74:75], v80 offset:33792
    ds_read_b64_tr_b16 a[76:77], v80 offset:40960
    ds_read_b64_tr_b16 a[78:79], v80 offset:41984
    ds_read_b64_tr_b16 v[56:57], v81 offset:32768
    ds_read_b64_tr_b16 v[58:59], v81 offset:33792
    ds_read_b64_tr_b16 v[60:61], v81 offset:40960
    ds_read_b64_tr_b16 v[62:63], v81 offset:41984
    s_waitcnt lgkmcnt(0)
    ds_write_b128 v5, v[56:59] offset:2048
    ds_write_b128 v5, v[60:63] offset:3072
    s_waitcnt lgkmcnt(0)
    s_waitcnt vmcnt(8)
    s_barrier
    v_add_u32 v83, 0x300000, v82
    v_and_b32 v83, 0x7fffff, v83
    s_add_u32 s46, s47, 0x0
    s_add_u32 m0, s48, 32768
    s_nop 0
    buffer_load_dwordx4 v83, s[28:31], s46 offen lds
    s_add_u32 s46, s47, 0x20000
    s_add_u32 m0, s48, 36864
    s_nop 0
    buffer_load_dwordx4 v83, s[28:31], s46 offen lds
    s_add_u32 s46, s47, 0x40000
    s_add_u32 m0, s48, 40960
    s_nop 0
    buffer_load_dwordx4 v83, s[28:31], s46 offen lds
    s_add_u32 s46, s47, 0x60000
    s_add_u32 m0, s48, 45056
    s_nop 0
    buffer_load_dwordx4 v83, s[28:31], s46 offen lds
    ds_read_b64_tr_b16 a[88:89], v80 offset:49152
    ds_read_b64_tr_b16 a[90:91], v80 offset:50176
    ds_read_b64_tr_b16 a[92:93], v80 offset:57344
    ds_read_b64_tr_b16 a[94:95], v80 offset:58368
    ds_read_b64_tr_b16 a[96:97], v81 offset:49152
    ds_read_b64_tr_b16 a[98:99], v81 offset:50176
    ds_read_b64_tr_b16 a[100:101], v81 offset:57344
    ds_read_b64_tr_b16 a[102:103], v81 offset:58368
    s_waitcnt lgkmcnt(0)
    s_waitcnt vmcnt(8)
    s_barrier
    v_add_u32 v83, 0x380000, v82
    v_and_b32 v83, 0x7fffff, v83
    s_add_u32 s46, s47, 0x0
    s_add_u32 m0, s48, 49152
    s_nop 0
    buffer_load_dwordx4 v83, s[28:31], s46 offen lds
    s_add_u32 s46, s47, 0x20000
    s_add_u32 m0, s48, 53248
    s_nop 0
    buffer_load_dwordx4 v83, s[28:31], s46 offen lds
    s_add_u32 s46, s47, 0x40000
    s_add_u32 m0, s48, 57344
    s_nop 0
    buffer_load_dwordx4 v83, s[28:31], s46 offen lds
    s_add_u32 s46, s47, 0x60000
    s_add_u32 m0, s48, 61440
    s_nop 0
    buffer_load_dwordx4 v83, s[28:31], s46 offen lds
    ds_read_b64_tr_b16 a[112:113], v80 offset:0
    ds_read_b64_tr_b16 a[114:115], v80 offset:1024
    ds_read_b64_tr_b16 a[116:117], v80 offset:8192
    ds_read_b64_tr_b16 a[118:119], v80 offset:9216
    ds_read_b64_tr_b16 a[120:121], v81 offset:0
    ds_read_b64_tr_b16 a[122:123], v81 offset:1024
    ds_read_b64_tr_b16 a[124:125], v81 offset:8192
    ds_read_b64_tr_b16 a[126:127], v81 offset:9216
    s_waitcnt lgkmcnt(0)
    s_waitcnt vmcnt(8)
    s_barrier
    v_add_u32 v83, 0x400000, v82
    v_and_b32 v83, 0x7fffff, v83
    s_add_u32 s46, s47, 0x0
    s_add_u32 m0, s48, 0
    s_nop 0
    buffer_load_dwordx4 v83, s[28:31], s46 offen lds
    s_add_u32 s46, s47, 0x20000
    s_add_u32 m0, s48, 4096
    s_nop 0
    buffer_load_dwordx4 v83, s[28:31], s46 offen lds
    s_add_u32 s46, s47, 0x40000
    s_add_u32 m0, s48, 8192
    s_nop 0
    buffer_load_dwordx4 v83, s[28:31], s46 offen lds
    s_add_u32 s46, s47, 0x60000
    s_add_u32 m0, s48, 12288
    s_nop 0
    buffer_load_dwordx4 v83, s[28:31], s46 offen lds
    ds_read_b64_tr_b16 a[136:137], v80 offset:16384
    ds_read_b64_tr_b16 a[138:139], v80 offset:17408
    ds_read_b64_tr_b16 a[140:141], v80 offset:24576
    ds_read_b64_tr_b16 a[142:143], v80 offset:25600
    ds_read_b64_tr_b16 a[144:145], v81 offset:16384
    ds_read_b64_tr_b16 a[146:147], v81 offset:17408
    ds_read_b64_tr_b16 a[148:149], v81 offset:24576
    ds_read_b64_tr_b16 a[150:151], v81 offset:25600
    s_waitcnt lgkmcnt(0)
    s_waitcnt vmcnt(8)
    s_barrier
    v_add_u32 v83, 0x480000, v82
    v_and_b32 v83, 0x7fffff, v83
    s_add_u32 s46, s47, 0x0
    s_add_u32 m0, s48, 16384
    s_nop 0
    buffer_load_dwordx4 v83, s[28:31], s46 offen lds
    s_add_u32 s46, s47, 0x20000
    s_add_u32 m0, s48, 20480
    s_nop 0
    buffer_load_dwordx4 v83, s[28:31], s46 offen lds
    s_add_u32 s46, s47, 0x40000
    s_add_u32 m0, s48, 24576
    s_nop 0
    buffer_load_dwordx4 v83, s[28:31], s46 offen lds
    s_add_u32 s46, s47, 0x60000
    s_add_u32 m0, s48, 28672
    s_nop 0
    buffer_load_dwordx4 v83, s[28:31], s46 offen lds
    ds_read_b64_tr_b16 a[160:161], v80 offset:32768
    ds_read_b64_tr_b16 a[162:163], v80 offset:33792
    ds_read_b64_tr_b16 a[164:165], v80 offset:40960
    ds_read_b64_tr_b16 a[166:167], v80 offset:41984
    ds_read_b64_tr_b16 a[168:169], v81 offset:32768
    ds_read_b64_tr_b16 a[170:171], v81 offset:33792
    ds_read_b64_tr_b16 a[172:173], v81 offset:40960
    ds_read_b64_tr_b16 a[174:175], v81 offset:41984
    s_waitcnt lgkmcnt(0)
    s_waitcnt vmcnt(8)
    s_barrier
    v_add_u32 v83, 0x500000, v82
    v_and_b32 v83, 0x7fffff, v83
    s_add_u32 s46, s47, 0x0
    s_add_u32 m0, s48, 32768
    s_nop 0
    buffer_load_dwordx4 v83, s[28:31], s46 offen lds
    s_add_u32 s46, s47, 0x20000
    s_add_u32 m0, s48, 36864
    s_nop 0
    buffer_load_dwordx4 v83, s[28:31], s46 offen lds
    s_add_u32 s46, s47, 0x40000
    s_add_u32 m0, s48, 40960
    s_nop 0
    buffer_load_dwordx4 v83, s[28:31], s46 offen lds
    s_add_u32 s46, s47, 0x60000
    s_add_u32 m0, s48, 45056
    s_nop 0
    buffer_load_dwordx4 v83, s[28:31], s46 offen lds
    ds_read_b64_tr_b16 a[192:193], v80 offset:49152
    ds_read_b64_tr_b16 a[194:195], v80 offset:50176
    ds_read_b64_tr_b16 a[196:197], v80 offset:57344
    ds_read_b64_tr_b16 a[198:199], v80 offset:58368
    ds_read_b64_tr_b16 a[200:201], v81 offset:49152
    ds_read_b64_tr_b16 a[202:203], v81 offset:50176
    ds_read_b64_tr_b16 a[204:205], v81 offset:57344
    ds_read_b64_tr_b16 a[206:207], v81 offset:58368
    s_waitcnt lgkmcnt(0)
    s_waitcnt vmcnt(8)
    s_barrier
    v_add_u32 v83, 0x580000, v82
    v_and_b32 v83, 0x7fffff, v83
    s_add_u32 s46, s47, 0x0
    s_add_u32 m0, s48, 49152
    s_nop 0
    buffer_load_dwordx4 v83, s[28:31], s46 offen lds
    s_add_u32 s46, s47, 0x20000
    s_add_u32 m0, s48, 53248
    s_nop 0
    buffer_load_dwordx4 v83, s[28:31], s46 offen lds
    s_add_u32 s46, s47, 0x40000
    s_add_u32 m0, s48, 57344
    s_nop 0
    buffer_load_dwordx4 v83, s[28:31], s46 offen lds
    s_add_u32 s46, s47, 0x60000
    s_add_u32 m0, s48, 61440
    s_nop 0
    buffer_load_dwordx4 v83, s[28:31], s46 offen lds
    ds_read_b64_tr_b16 a[216:217], v80 offset:0
    ds_read_b64_tr_b16 a[218:219], v80 offset:1024
    ds_read_b64_tr_b16 a[220:221], v80 offset:8192
    ds_read_b64_tr_b16 a[222:223], v80 offset:9216
    ds_read_b64_tr_b16 a[224:225], v81 offset:0
    ds_read_b64_tr_b16 a[226:227], v81 offset:1024
    ds_read_b64_tr_b16 a[228:229], v81 offset:8192
    ds_read_b64_tr_b16 a[230:231], v81 offset:9216
    s_waitcnt lgkmcnt(0)
    s_waitcnt vmcnt(8)
    s_barrier
    v_add_u32 v83, 0x600000, v82
    v_and_b32 v83, 0x7fffff, v83
    s_add_u32 s46, s47, 0x0
    s_add_u32 m0, s48, 0
    s_nop 0
    buffer_load_dwordx4 v83, s[28:31], s46 offen lds
    s_add_u32 s46, s47, 0x20000
    s_add_u32 m0, s48, 4096
    s_nop 0
    buffer_load_dwordx4 v83, s[28:31], s46 offen lds
    s_add_u32 s46, s47, 0x40000
    s_add_u32 m0, s48, 8192
    s_nop 0
    buffer_load_dwordx4 v83, s[28:31], s46 offen lds
    s_add_u32 s46, s47, 0x60000
    s_add_u32 m0, s48, 12288
    s_nop 0
    buffer_load_dwordx4 v83, s[28:31], s46 offen lds
    ds_read_b64_tr_b16 a[248:249], v80 offset:16384
    ds_read_b64_tr_b16 a[250:251], v80 offset:17408
    ds_read_b64_tr_b16 a[252:253], v80 offset:24576
    ds_read_b64_tr_b16 a[254:255], v80 offset:25600
    ds_read_b64_tr_b16 v[96:97], v81 offset:16384
    ds_read_b64_tr_b16 v[98:99], v81 offset:17408
    ds_read_b64_tr_b16 v[100:101], v81 offset:24576
    ds_read_b64_tr_b16 v[102:103], v81 offset:25600
    s_waitcnt lgkmcnt(0)
    s_waitcnt vmcnt(8)
    s_barrier
    v_add_u32 v83, 0x680000, v82
    v_and_b32 v83, 0x7fffff, v83
    s_add_u32 s46, s47, 0x0
    s_add_u32 m0, s48, 16384
    s_nop 0
    buffer_load_dwordx4 v83, s[28:31], s46 offen lds
    s_add_u32 s46, s47, 0x20000
    s_add_u32 m0, s48, 20480
    s_nop 0
    buffer_load_dwordx4 v83, s[28:31], s46 offen lds
    s_add_u32 s46, s47, 0x40000
    s_add_u32 m0, s48, 24576
    s_nop 0
    buffer_load_dwordx4 v83, s[28:31], s46 offen lds
    s_add_u32 s46, s47, 0x60000
    s_add_u32 m0, s48, 28672
    s_nop 0
    buffer_load_dwordx4 v83, s[28:31], s46 offen lds
    ds_read_b64_tr_b16 v[112:113], v80 offset:32768
    ds_read_b64_tr_b16 v[114:115], v80 offset:33792
    ds_read_b64_tr_b16 v[116:117], v80 offset:40960
    ds_read_b64_tr_b16 v[118:119], v80 offset:41984
    ds_read_b64_tr_b16 v[120:121], v81 offset:32768
    ds_read_b64_tr_b16 v[122:123], v81 offset:33792
    ds_read_b64_tr_b16 v[124:125], v81 offset:40960
    ds_read_b64_tr_b16 v[126:127], v81 offset:41984
    s_waitcnt lgkmcnt(0)
    s_waitcnt vmcnt(8)
    s_barrier
    v_add_u32 v83, 0x700000, v82
    v_and_b32 v83, 0x7fffff, v83
    s_add_u32 s46, s47, 0x0
    s_add_u32 m0, s48, 32768
    s_nop 0
    buffer_load_dwordx4 v83, s[28:31], s46 offen lds
    s_add_u32 s46, s47, 0x20000
    s_add_u32 m0, s48, 36864
    s_nop 0
    buffer_load_dwordx4 v83, s[28:31], s46 offen lds
    s_add_u32 s46, s47, 0x40000
    s_add_u32 m0, s48, 40960
    s_nop 0
    buffer_load_dwordx4 v83, s[28:31], s46 offen lds
    s_add_u32 s46, s47, 0x60000
    s_add_u32 m0, s48, 45056
    s_nop 0
    buffer_load_dwordx4 v83, s[28:31], s46 offen lds
    ds_read_b64_tr_b16 v[144:145], v80 offset:49152
    ds_read_b64_tr_b16 v[146:147], v80 offset:50176
    ds_read_b64_tr_b16 v[148:149], v80 offset:57344
    ds_read_b64_tr_b16 v[150:151], v80 offset:58368
    ds_read_b64_tr_b16 v[152:153], v81 offset:49152
    ds_read_b64_tr_b16 v[154:155], v81 offset:50176
    ds_read_b64_tr_b16 v[156:157], v81 offset:57344
    ds_read_b64_tr_b16 v[158:159], v81 offset:58368
    s_waitcnt lgkmcnt(0)
    s_waitcnt vmcnt(8)
    s_barrier
    v_add_u32 v83, 0x780000, v82
    v_and_b32 v83, 0x7fffff, v83
    s_add_u32 s46, s47, 0x0
    s_add_u32 m0, s48, 49152
    s_nop 0
    buffer_load_dwordx4 v83, s[28:31], s46 offen lds
    s_add_u32 s46, s47, 0x20000
    s_add_u32 m0, s48, 53248
    s_nop 0
    buffer_load_dwordx4 v83, s[28:31], s46 offen lds
    s_add_u32 s46, s47, 0x40000
    s_add_u32 m0, s48, 57344
    s_nop 0
    buffer_load_dwordx4 v83, s[28:31], s46 offen lds
    s_add_u32 s46, s47, 0x60000
    s_add_u32 m0, s48, 61440
    s_nop 0
    buffer_load_dwordx4 v83, s[28:31], s46 offen lds
    ds_read_b64_tr_b16 v[168:169], v80 offset:0
    ds_read_b64_tr_b16 v[170:171], v80 offset:1024
    ds_read_b64_tr_b16 v[172:173], v80 offset:8192
    ds_read_b64_tr_b16 v[174:175], v80 offset:9216
    ds_read_b64_tr_b16 v[176:177], v81 offset:0
    ds_read_b64_tr_b16 v[178:179], v81 offset:1024
    ds_read_b64_tr_b16 v[180:181], v81 offset:8192
    ds_read_b64_tr_b16 v[182:183], v81 offset:9216
    s_waitcnt lgkmcnt(0)
    s_waitcnt vmcnt(8)
    s_barrier
    ds_read_b64_tr_b16 v[200:201], v80 offset:16384
    ds_read_b64_tr_b16 v[202:203], v80 offset:17408
    ds_read_b64_tr_b16 v[204:205], v80 offset:24576
    ds_read_b64_tr_b16 v[206:207], v80 offset:25600
    ds_read_b64_tr_b16 v[56:57], v81 offset:16384
    ds_read_b64_tr_b16 v[58:59], v81 offset:17408
    ds_read_b64_tr_b16 v[60:61], v81 offset:24576
    ds_read_b64_tr_b16 v[62:63], v81 offset:25600
    s_waitcnt lgkmcnt(0)
    ds_write_b128 v5, v[56:59] offset:22528
    ds_write_b128 v5, v[60:63] offset:23552
    s_waitcnt lgkmcnt(0)
    s_waitcnt vmcnt(4)
    s_barrier
    ds_read_b64_tr_b16 v[216:217], v80 offset:32768
    ds_read_b64_tr_b16 v[218:219], v80 offset:33792
    ds_read_b64_tr_b16 v[220:221], v80 offset:40960
    ds_read_b64_tr_b16 v[222:223], v80 offset:41984
    ds_read_b64_tr_b16 v[224:225], v81 offset:32768
    ds_read_b64_tr_b16 v[226:227], v81 offset:33792
    ds_read_b64_tr_b16 v[228:229], v81 offset:40960
    ds_read_b64_tr_b16 v[230:231], v81 offset:41984
    s_waitcnt lgkmcnt(0)
    s_waitcnt vmcnt(0)
    s_barrier
    ds_read_b64_tr_b16 v[248:249], v80 offset:49152
    ds_read_b64_tr_b16 v[250:251], v80 offset:50176
    ds_read_b64_tr_b16 v[252:253], v80 offset:57344
    ds_read_b64_tr_b16 v[254:255], v80 offset:58368
    ds_read_b64_tr_b16 v[56:57], v81 offset:49152
    ds_read_b64_tr_b16 v[58:59], v81 offset:50176
    ds_read_b64_tr_b16 v[60:61], v81 offset:57344
    ds_read_b64_tr_b16 v[62:63], v81 offset:58368
    s_waitcnt lgkmcnt(0)
    ds_write_b128 v5, v[56:59] offset:20480
    ds_write_b128 v5, v[60:63] offset:21504
    s_waitcnt lgkmcnt(0)
    s_barrier
    v_and_b32 v63, 15, v1
    v_lshrrev_b32 v64, 4, v1
    v_lshrrev_b32 v65, 5, v1
    v_lshlrev_b32 v65, 4, v65
    v_add_u32 v65, v65, v63
    v_lshlrev_b32 v65, 4, v65
    v_and_b32 v66, 1, v64
    v_lshlrev_b32 v66, 3, v66
    s_lshl_b32 s45, s44, 9
    s_add_u32 s45, s45, 53248
    v_add3_u32 v6, v65, v66, s45
    v_bfe_u32 v65, v1, 2, 2
    v_lshlrev_b32 v66, 3, v64
    v_add_u32 v65, v65, v66
    v_lshlrev_b32 v65, 4, v65
    v_and_b32 v66, 1, v1
    v_lshlrev_b32 v66, 3, v66
    v_add_u32 v65, v65, v66
    v_add_u32 v7, 53248, v65
    v_bfe_u32 v65, v1, 2, 1
    v_lshlrev_b32 v65, 4, v65
    v_bfe_u32 v66, v1, 3, 1
    v_lshlrev_b32 v66, 2, v66
    v_and_b32 v67, 3, v1
    v_add3_u32 v65, v65, v66, v67
    v_lshlrev_b32 v65, 5, v65
    v_lshlrev_b32 v66, 3, v64
    s_lshl_b32 s45, s44, 10
    s_add_u32 s45, s45, 55296
    v_add3_u32 v18, v65, v66, s45
    v_lshlrev_b32 v16, 3, v1
    v_lshrrev_b32 v65, 2, v63
    v_mul_u32_u24 v65, 1088, v65
    v_and_b32 v66, 3, v63
    v_xor_b32 v67, v66, v64
    v_lshlrev_b32 v66, 8, v66
    v_lshlrev_b32 v67, 4, v67
    v_add3_u32 v8, v65, v66, v67
    v_mul_u32_u24 v65, 1056, v64
    v_bfe_u32 v66, v1, 2, 2
    v_xor_b32 v67, s44, v66
    v_lshlrev_b32 v66, 8, v66
    v_lshlrev_b32 v67, 6, v67
    v_add3_u32 v65, v65, v66, v67
    v_and_b32 v66, 3, v1
    v_lshlrev_b32 v66, 3, v66
    v_add_u32 v9, v65, v66
    s_lshl_b32 s45, s44, 2
    v_add_u32 v65, s45, v64
    s_mov_b32 s46, 24576
    v_mul_lo_u32 v66, v65, s46
    v_xor_b32 v67, v63, v64
    v_lshlrev_b32 v67, 4, v67
    v_add_u32 v14, v66, v67
    v_lshlrev_b32 v67, 2, v64
    v_xor_b32 v67, v63, v67
    v_lshlrev_b32 v67, 4, v67
    v_add_u32 v15, v66, v67
    s_lshl_b32 s45, s43, 11
    s_lshl_b32 s46, s44, 9
    s_add_u32 s45, s45, s46
    s_add_u32 s51, s45, 0x7020000
    s_lshl_b32 s63, s43, 8
    s_add_u32 s63, s63, 0x2002000
    s_mul_i32 s64, s44, 1088
    s_add_u32 s64, s64, 16384
    s_mul_i32 s65, s44, 1056
    s_add_u32 s65, s65, 25088
    s_lshl_b32 s66, s43, 12
    s_add_u32 s66, s66, 0x1000000
    s_mov_b32 s69, 17408
    s_mov_b32 s52, 0x3e0293ee
    v_and_b32 v19, 3, v1
    v_lshlrev_b32 v19, 10, v19
    s_lshl_b32 s45, s44, 12
    s_add_u32 s45, s45, 1020
    v_add_u32 v19, s45, v19
    s_mov_b32 m0, s64
    s_add_u32 s45, s63, 393216
    buffer_load_dwordx4 v14, s[12:15], s63 offen lds
    s_add_u32 m0, s64, 4352
    s_add_u32 s46, s63, 8192
    buffer_load_dwordx4 v14, s[12:15], s45 offen lds
    s_mov_b32 m0, s65
    s_add_u32 s45, s45, 8192
    buffer_load_dwordx4 v15, s[12:15], s46 offen lds
    s_add_u32 m0, s65, 4224
    s_add_u32 s63, s63, 786432
    buffer_load_dwordx4 v15, s[12:15], s45 offen lds
    s_add_u32 s64, s64, 17408
    s_add_u32 s65, s65, 17408
    s_mov_b32 s70, 0
    v_mov_b32 v41, 0
L_hw_9:
    s_sleep 2
    buffer_load_dword v44, v41, s[16:19], 0 offen sc1
    s_add_u32 s70, s70, 1
    s_cmp_ge_u32 s70, 0x100000
    s_cbranch_scc1 L_c_done_6
    s_waitcnt vmcnt(0)
    v_readfirstlane_b32 s45, v44
    s_cmp_lg_u32 s45, 64
    s_cbranch_scc1 L_hw_9
    buffer_load_dwordx4 v[44:47], v41, s[16:19], 0 offen sc1
    s_waitcnt vmcnt(0)
    v_readfirstlane_b32 s45, v45
    v_readfirstlane_b32 s46, v46
    v_readfirstlane_b32 s68, v47
    s_bcnt1_i32_b32 s45, s45
    s_bcnt1_i32_b32 s46, s46
    s_add_u32 s45, s45, s46
    s_cmp_eq_u32 s45, 2
    s_cselect_b32 s67, 1, 0
    s_cmp_ge_u32 s68, 16
    s_cselect_b32 s68, 8192, 0
    s_mov_b32 s60, 0
    s_lshl_b32 s58, s40, 16
    s_add_u32 s58, s58, 0x7000000
    s_mov_b32 s61, s58
    s_lshl_b32 s59, s40, 17
    s_add_u32 s59, s59, 0x7040000
    s_mov_b32 s62, s59
L_q_loop_10:
    ds_read_b128 v[56:59], v5 offset:0
    ds_read_b128 v[60:63], v5 offset:1024
    ds_read_b128 v[64:67], v5 offset:2048
    ds_read_b128 v[68:71], v5 offset:3072
    ds_read_b128 v[72:75], v5 offset:4096
    ds_read_b128 v[76:79], v5 offset:5120
    ds_read_b128 v[80:83], v5 offset:6144
    ds_read_b128 v[84:87], v5 offset:7168
    ds_read_b128 v[88:91], v5 offset:8192
    ds_read_b128 v[92:95], v5 offset:9216
    s_cmp_eq_u32 s60, 0
    s_cbranch_scc1 L_q_first_11
    s_sleep 24
    s_mov_b64 exec, 15
    buffer_load_dword v10, v19, s[12:15], s61 offen sc1
    s_nop 15
    buffer_load_dword v11, v19, s[12:15], s61 offen sc1
    s_nop 15
    buffer_load_dword v12, v19, s[12:15], s61 offen sc1
    s_nop 15
    buffer_load_dword v13, v19, s[12:15], s61 offen sc1
    s_mov_b32 s70, 0
L_pp_12:
    s_waitcnt vmcnt(3)
    v_cmp_eq_u32 vcc, -1, v10
    s_add_u32 s70, s70, 1
    s_nop 0
    s_cbranch_vccz L_ppd_13
    buffer_load_dword v10, v19, s[12:15], s61 offen sc1
    s_waitcnt vmcnt(3)
    v_cmp_eq_u32 vcc, -1, v11
    s_add_u32 s70, s70, 1
    s_nop 0
    s_cbranch_vccz L_ppd_13
    buffer_load_dword v11, v19, s[12:15], s61 offen sc1
    s_waitcnt vmcnt(3)
    v_cmp_eq_u32 vcc, -1, v12
    s_add_u32 s70, s70, 1
    s_nop 0
    s_cbranch_vccz L_ppd_13
    buffer_load_dword v12, v19, s[12:15], s61 offen sc1
    s_waitcnt vmcnt(3)
    v_cmp_eq_u32 vcc, -1, v13
    s_add_u32 s70, s70, 1
    s_nop 0
    s_cbranch_vccz L_ppd_13
    buffer_load_dword v13, v19, s[12:15], s61 offen sc1
    s_cmp_lt_u32 s70, 0x400000
    s_cbranch_scc1 L_pp_12
    s_branch L_c_done_6
L_ppd_13:
    s_mov_b64 exec, -1
L_q_first_11:
    s_waitcnt lgkmcnt(0)
    s_mov_b32 s70, 0
L_mg_14:
    buffer_load_dwordx4 v[40:43], v3, s[12:15], s61 offen offset:0 sc1
    s_nop 9
    buffer_load_dwordx4 v[44:47], v3, s[12:15], s61 offen offset:1024 sc1
    s_nop 9
    buffer_load_dwordx4 v[48:51], v3, s[12:15], s61 offen offset:2048 sc1
    s_nop 9
    buffer_load_dwordx4 v[52:55], v3, s[12:15], s61 offen offset:3072 sc1
    s_add_u32 s70, s70, 1
    s_cmp_ge_u32 s70, 0x100000
    s_cbranch_scc1 L_c_done_6
    s_nop 1
    v_mov_b32 v24, 0
    v_mov_b32 v25, 0
    v_mov_b32 v26, 0
    v_mov_b32 v27, 0
    v_mov_b32 v28, 0
    v_mov_b32 v29, 0
    v_mov_b32 v30, 0
    v_mov_b32 v31, 0
    v_mov_b32 v32, 0
    v_mov_b32 v33, 0
    v_mov_b32 v34, 0
    v_mov_b32 v35, 0
    v_mov_b32 v36, 0
    v_mov_b32 v37, 0
    v_mov_b32 v38, 0
    v_mov_b32 v39, 0
    s_waitcnt vmcnt(3)
    ds_write_b128 v3, v[40:43] offset:0
    v_smfmac_f32_16x16x64_bf16 v[24:27], v[40:43], a[0:7], v2
    v_max3_u32 v22, v40, v41, v42
    v_smfmac_f32_16x16x64_bf16 v[28:31], v[40:43], a[8:15], v2
    v_max_u32 v22, v22, v43
    v_smfmac_f32_16x16x64_bf16 v[32:35], v[40:43], a[16:23], v2
    v_smfmac_f32_16x16x64_bf16 v[36:39], v[40:43], a[24:31], v2
    s_waitcnt vmcnt(2)
    ds_write_b128 v3, v[44:47] offset:1024
    v_smfmac_f32_16x16x64_bf16 v[24:27], v[44:47], a[32:39], v2
    v_max3_u32 v22, v22, v44, v45
    v_smfmac_f32_16x16x64_bf16 v[28:31], v[44:47], a[40:47], v2
    v_max3_u32 v22, v22, v46, v47
    v_smfmac_f32_16x16x64_bf16 v[32:35], v[44:47], a[48:55], v2
    v_smfmac_f32_16x16x64_bf16 v[36:39], v[44:47], a[56:63], v2
    s_waitcnt vmcnt(1)
    ds_write_b128 v3, v[48:51] offset:2048
    s_waitcnt vmcnt(0)
    ds_write_b128 v3, v[52:55] offset:3072
    v_max3_u32 v22, v22, v48, v49
    v_max3_u32 v22, v22, v50, v51
    v_max3_u32 v22, v22, v52, v53
    v_max3_u32 v22, v22, v54, v55
    v_cmp_eq_u32 vcc, -1, v22
    s_waitcnt lgkmcnt(0)
    s_nop 0
    s_cbranch_vccnz L_mg_14
    s_barrier
    ds_read_b128 v[40:43], v4 offset:0
    ds_read_b128 v[44:47], v4 offset:1024
    v_smfmac_f32_16x16x64_bf16 v[24:27], v[48:51], a[64:71], v2
    v_smfmac_f32_16x16x64_bf16 v[28:31], v[48:51], v[56:63], v2
    ds_read_b128 v[56:59], v5 offset:10240
    v_smfmac_f32_16x16x64_bf16 v[32:35], v[48:51], a[72:79], v2
    ds_read_b128 v[60:63], v5 offset:11264
    v_smfmac_f32_16x16x64_bf16 v[36:39], v[48:51], v[64:71], v2
    ds_read_b128 v[48:51], v4 offset:2048
    ds_read_b128 v[64:67], v5 offset:12288
    v_smfmac_f32_16x16x64_bf16 v[24:27], v[52:55], a[80:87], v2
    ds_read_b128 v[68:71], v5 offset:13312
    v_smfmac_f32_16x16x64_bf16 v[28:31], v[52:55], v[72:79], v2
    ds_read_b128 v[72:75], v5 offset:14336
    v_smfmac_f32_16x16x64_bf16 v[32:35], v[52:55], a[88:95], v2
    ds_read_b128 v[76:79], v5 offset:15360
    v_smfmac_f32_16x16x64_bf16 v[36:39], v[52:55], a[96:103], v2
    ds_read_b128 v[52:55], v4 offset:3072
    s_waitcnt lgkmcnt(4)
    v_smfmac_f32_16x16x64_bf16 v[24:27], v[40:43], a[104:111], v2
    v_smfmac_f32_16x16x64_bf16 v[28:31], v[40:43], v[80:87], v2
    ds_read_b128 v[80:83], v5 offset:16384
    v_smfmac_f32_16x16x64_bf16 v[32:35], v[40:43], a[112:119], v2
    ds_read_b128 v[84:87], v5 offset:17408
    v_smfmac_f32_16x16x64_bf16 v[36:39], v[40:43], a[120:127], v2
    ds_read_b128 v[40:43], v21 offset:0
    v_smfmac_f32_16x16x64_bf16 v[24:27], v[44:47], a[128:135], v2
    v_smfmac_f32_16x16x64_bf16 v[28:31], v[44:47], v[88:95], v2
    ds_read_b128 v[88:91], v5 offset:18432
    v_smfmac_f32_16x16x64_bf16 v[32:35], v[44:47], a[136:143], v2
    ds_read_b128 v[92:95], v5 offset:19456
    v_smfmac_f32_16x16x64_bf16 v[36:39], v[44:47], a[144:151], v2
    ds_read_b128 v[44:47], v21 offset:1024
    v_smfmac_f32_16x16x64_bf16 v[24:27], v[48:51], a[152:159], v2
    v_smfmac_f32_16x16x64_bf16 v[28:31], v[48:51], v[56:63], v2
    ds_read_b128 v[48:51], v21 offset:2048
    ds_read_b128 v[56:59], v5 offset:20480
    s_waitcnt lgkmcnt(4)
    v_smfmac_f32_16x16x64_bf16 v[24:27], v[52:55], a[176:183], v2
    ds_read_b128 v[60:63], v5 offset:21504
    v_smfmac_f32_16x16x64_bf16 v[28:31], v[52:55], a[184:191], v2
    ds_read_b128 v[52:55], v21 offset:3072
    v_smfmac_f32_16x16x64_bf16 v[24:27], v[40:43], a[208:215], v2
    v_smfmac_f32_16x16x64_bf16 v[28:31], v[40:43], v[64:71], v2
    ds_read_b128 v[40:43], v23 offset:0
    ds_read_b128 v[64:67], v5 offset:22528
    s_waitcnt lgkmcnt(4)
    v_smfmac_f32_16x16x64_bf16 v[24:27], v[44:47], a[232:239], v2
    ds_read_b128 v[68:71], v5 offset:23552
    v_smfmac_f32_16x16x64_bf16 v[28:31], v[44:47], a[240:247], v2
    ds_read_b128 v[44:47], v23 offset:1024
    v_smfmac_f32_16x16x64_bf16 v[24:27], v[48:51], v[104:111], v2
    v_smfmac_f32_16x16x64_bf16 v[28:31], v[48:51], v[72:79], v2
    ds_read_b128 v[48:51], v23 offset:2048
    s_waitcnt lgkmcnt(3)
    v_smfmac_f32_16x16x64_bf16 v[24:27], v[52:55], v[128:135], v2
    v_smfmac_f32_16x16x64_bf16 v[28:31], v[52:55], v[136:143], v2
    ds_read_b128 v[52:55], v23 offset:3072
    v_smfmac_f32_16x16x64_bf16 v[24:27], v[40:43], v[160:167], v2
    v_smfmac_f32_16x16x64_bf16 v[28:31], v[40:43], v[80:87], v2
    s_waitcnt lgkmcnt(1)
    v_smfmac_f32_16x16x64_bf16 v[24:27], v[44:47], v[184:191], v2
    v_smfmac_f32_16x16x64_bf16 v[28:31], v[44:47], v[192:199], v2
    v_smfmac_f32_16x16x64_bf16 v[24:27], v[48:51], v[208:215], v2
    v_smfmac_f32_16x16x64_bf16 v[28:31], v[48:51], v[88:95], v2
    s_waitcnt lgkmcnt(0)
    v_smfmac_f32_16x16x64_bf16 v[24:27], v[52:55], v[232:239], v2
    v_smfmac_f32_16x16x64_bf16 v[28:31], v[52:55], v[240:247], v2
    v_smfmac_f32_16x16x64_bf16 v[32:35], v[52:55], v[248:255], v2
    ds_read_b128 v[72:75], v8 offset:16512
    v_smfmac_f32_16x16x64_bf16 v[36:39], v[52:55], v[56:63], v2
    ds_read_b128 v[52:55], v21 offset:3072
    v_smfmac_f32_16x16x64_bf16 v[32:35], v[48:51], v[216:223], v2
    ds_read_b128 v[76:79], v8 offset:20864
    s_nop 1
    v_permlane32_swap_b32 v24, v28
    v_smfmac_f32_16x16x64_bf16 v[36:39], v[48:51], v[224:231], v2
    ds_read_b128 v[48:51], v21 offset:2048
    v_permlane32_swap_b32 v25, v29
    v_smfmac_f32_16x16x64_bf16 v[32:35], v[44:47], v[200:207], v2
    v_permlane32_swap_b32 v26, v30
    v_permlane32_swap_b32 v27, v31
    v_smfmac_f32_16x16x64_bf16 v[36:39], v[44:47], v[64:71], v2
    ds_read_b128 v[44:47], v21 offset:1024
    v_pk_add_f32 v[24:25], v[24:25], v[28:29]
    v_smfmac_f32_16x16x64_bf16 v[32:35], v[40:43], v[168:175], v2
    v_pk_add_f32 v[26:27], v[26:27], v[30:31]
    v_cvt_pk_bf16_f32 v24, v24, v25
    v_smfmac_f32_16x16x64_bf16 v[36:39], v[40:43], v[176:183], v2
    ds_read_b128 v[40:43], v21 offset:0
    v_cvt_pk_bf16_f32 v25, v26, v27
    s_waitcnt lgkmcnt(2)
    v_smfmac_f32_16x16x64_bf16 v[32:35], v[52:55], v[144:151], v2
    ds_write_b64 v6, v[24:25]
    ds_read_b128 v[56:59], v8 offset:16384
    v_smfmac_f32_16x16x64_bf16 v[36:39], v[52:55], v[152:159], v2
    ds_read_b128 v[52:55], v4 offset:3072
    ds_read_b128 v[60:63], v8 offset:20736
    v_smfmac_f32_16x16x64_bf16 v[32:35], v[48:51], v[112:119], v2
    ds_read_b128 v[64:67], v8 offset:16448
    v_smfmac_f32_16x16x64_bf16 v[36:39], v[48:51], v[120:127], v2
    ds_read_b128 v[48:51], v4 offset:2048
    s_waitcnt lgkmcnt(6)
    v_smfmac_f32_16x16x64_bf16 v[32:35], v[44:47], a[248:255], v2
    ds_read_b128 v[68:71], v8 offset:20800
    s_waitcnt lgkmcnt(5)
    s_barrier
    v_smfmac_f32_16x16x64_bf16 v[36:39], v[44:47], v[96:103], v2
    ds_read_b64_tr_b16 v[80:81], v7 offset:0
    ds_read_b64_tr_b16 v[82:83], v7 offset:64
    v_smfmac_f32_16x16x64_bf16 v[32:35], v[40:43], a[216:223], v2
    ds_read_b64_tr_b16 v[84:85], v7 offset:512
    ds_read_b64_tr_b16 v[86:87], v7 offset:576
    v_smfmac_f32_16x16x64_bf16 v[36:39], v[40:43], a[224:231], v2
    ds_read_b64_tr_b16 v[88:89], v7 offset:1024
    ds_read_b64_tr_b16 v[90:91], v7 offset:1088
    s_waitcnt lgkmcnt(7)
    v_smfmac_f32_16x16x64_bf16 v[32:35], v[52:55], a[192:199], v2
    ds_read_b64_tr_b16 v[92:93], v7 offset:1536
    v_smfmac_f32_16x16x64_bf16 v[36:39], v[52:55], a[200:207], v2
    ds_read_b64_tr_b16 v[94:95], v7 offset:1600
    v_smfmac_f32_16x16x64_bf16 v[32:35], v[48:51], a[160:167], v2
    v_smfmac_f32_16x16x64_bf16 v[36:39], v[48:51], a[168:175], v2
    s_waitcnt lgkmcnt(2)
    v_mfma_f32_16x16x32_bf16 v[24:27], v[56:59], v[80:83], 0
    ds_read_b128 v[56:59], v8 offset:16576
    v_mfma_f32_16x16x32_bf16 v[28:31], v[60:63], v[80:83], 0
    ds_read_b128 v[60:63], v8 offset:20928
    v_mfma_f32_16x16x32_bf16 v[24:27], v[64:67], v[84:87], v[24:27]
    s_nop 1
    v_cvt_pk_bf16_f32 v32, v32, v33
    v_cvt_pk_bf16_f32 v33, v34, v35
    v_cvt_pk_bf16_f32 v34, v36, v37
    v_cvt_pk_bf16_f32 v35, v38, v39
    ds_write2_b64 v18, v[32:33], v[34:35] offset1:32
    v_mfma_f32_16x16x32_bf16 v[28:31], v[68:71], v[84:87], v[28:31]
    v_mfma_f32_16x16x32_bf16 v[24:27], v[72:75], v[88:91], v[24:27]
    ds_read_b64_tr_b16 v[64:65], v9 offset:25088
    v_mfma_f32_16x16x32_bf16 v[28:31], v[76:79], v[88:91], v[28:31]
    ds_read_b64_tr_b16 v[66:67], v9 offset:29312
    s_waitcnt lgkmcnt(3)
    v_mfma_f32_16x16x32_bf16 v[24:27], v[56:59], v[92:95], v[24:27]
    ds_read_b64_tr_b16 v[68:69], v9 offset:25120
    v_mfma_f32_16x16x32_bf16 v[28:31], v[60:63], v[92:95], v[28:31]
    ds_read_b64_tr_b16 v[70:71], v9 offset:29344
    s_waitcnt lgkmcnt(4)
    s_barrier
    ds_read_b64_tr_b16 v[40:41], v16 offset:55296
    ds_read_b64_tr_b16 v[42:43], v16 offset:55808
    ds_read_b64_tr_b16 v[44:45], v16 offset:56320
    ds_read_b64_tr_b16 v[46:47], v16 offset:56832
    ds_read_b64_tr_b16 v[48:49], v16 offset:57344
    ds_read_b64_tr_b16 v[50:51], v16 offset:57856
    ds_read_b64_tr_b16 v[52:53], v16 offset:58368
    ds_read_b64_tr_b16 v[54:55], v16 offset:58880
    s_cmp_eq_u32 s60, 63
    s_cbranch_scc1 L_q_last_15
    v_max3_f32 v11, v24, v25, v26
    s_waitcnt lgkmcnt(6)
    v_mfma_f32_16x16x32_bf16 v[36:39], v[40:43], v[80:83], 0
    v_max3_f32 v13, v27, v28, v29
    v_max3_f32 v11, v11, v30, v31
    s_waitcnt lgkmcnt(4)
    v_mfma_f32_16x16x32_bf16 v[36:39], v[44:47], v[84:87], v[36:39]
    v_max_f32 v11, v11, v13
    v_mul_f32 v10, s52, v11
    s_waitcnt lgkmcnt(2)
    v_mfma_f32_16x16x32_bf16 v[36:39], v[48:51], v[88:91], v[36:39]
    v_pk_fma_f32 v[24:25], v[24:25], s[52:53], v[10:11] op_sel_hi:[1,0,0] neg_lo:[0,0,1] neg_hi:[0,0,1]
    v_pk_fma_f32 v[26:27], v[26:27], s[52:53], v[10:11] op_sel_hi:[1,0,0] neg_lo:[0,0,1] neg_hi:[0,0,1]
    s_waitcnt lgkmcnt(0)
    v_mfma_f32_16x16x32_bf16 v[36:39], v[52:55], v[92:95], v[36:39]
    v_pk_fma_f32 v[28:29], v[28:29], s[52:53], v[10:11] op_sel_hi:[1,0,0] neg_lo:[0,0,1] neg_hi:[0,0,1]
    v_pk_fma_f32 v[30:31], v[30:31], s[52:53], v[10:11] op_sel_hi:[1,0,0] neg_lo:[0,0,1] neg_hi:[0,0,1]
    buffer_load_dwordx2 v[0:1], v16, s[12:15], s51 offen sc1
    s_add_u32 s46, s60, 1
    v_mov_b32 v74, s46
    v_mov_b32 v57, 0
    v_mov_b32 v58, 0
    v_exp_f32 v24, v24
    v_exp_f32 v25, v25
    v_permlane32_swap_b32 v36, v38
    v_permlane32_swap_b32 v37, v39
    v_pk_add_f32 v[36:37], v[36:37], v[38:39]
    v_max3_f32 v12, v36, v37, v11
    v_max3_f32 v13, v36, v37, v11
    v_exp_f32 v26, v26
    v_exp_f32 v27, v27
    v_permlane32_swap_b32 v12, v13
    v_max_f32 v22, v12, v13
    v_max_f32 v13, v12, v13
    v_exp_f32 v28, v28
    v_exp_f32 v29, v29
    v_permlane16_swap_b32 v22, v13
    v_max_f32 v12, v22, v13
    v_mul_f32 v12, s52, v12
    v_sub_f32 v10, v10, v12
    v_pk_fma_f32 v[36:37], v[36:37], s[52:53], v[12:13] op_sel_hi:[1,0,0] neg_lo:[0,0,1] neg_hi:[0,0,1]
    v_exp_f32 v10, v10
    v_exp_f32 v30, v30
    v_exp_f32 v31, v31
    v_exp_f32 v36, v36
    v_exp_f32 v37, v37
    v_pk_mul_f32 v[24:25], v[24:25], v[10:11] op_sel_hi:[1,0]
    v_pk_mul_f32 v[26:27], v[26:27], v[10:11] op_sel_hi:[1,0]
    v_pk_mul_f32 v[28:29], v[28:29], v[10:11] op_sel_hi:[1,0]
    v_pk_mul_f32 v[30:31], v[30:31], v[10:11] op_sel_hi:[1,0]
    v_cvt_pk_bf16_f32 v60, v24, v25
    v_cvt_pk_bf16_f32 v61, v26, v27
    v_cvt_pk_bf16_f32 v62, v28, v29
    v_cvt_pk_bf16_f32 v63, v30, v31
    v_cvt_pk_bf16_f32 v56, v36, v37
    v_cvt_pk_bf16_f32 v59, v36, v37
    s_mov_b64 exec, 15
    s_cmp_eq_u32 s67, 1
    s_cbranch_scc0 L_ls_16_s
    buffer_store_dword v74, v20, s[12:15], 0 offen
L_ls_16_d:
    s_mov_b64 exec, -1
    v_mfma_f32_16x16x32_bf16 v[72:75], v[64:67], v[60:63], 0
    v_pk_add_f32 v[24:25], v[24:25], v[26:27]
    v_pk_add_f32 v[28:29], v[28:29], v[30:31]
    v_mfma_f32_16x16x32_bf16 v[76:79], v[68:71], v[60:63], 0
    v_pk_add_f32 v[24:25], v[24:25], v[36:37]
    s_waitcnt vmcnt(1)
L_q_vm_17:
    v_max_u32 v22, v0, v1
    v_cmp_eq_u32 vcc, -1, v22
    v_pk_add_f32 v[10:11], v[24:25], v[28:29]
    v_add_f32 v12, v10, v11
    s_cbranch_vccnz L_q_vm_17_r
    v_add_f32 v13, v10, v11
    v_mfma_f32_16x16x16_bf16 v[72:75], v[0:1], v[56:57], v[72:75]
    v_mfma_f32_16x16x16_bf16 v[76:79], v[0:1], v[58:59], v[76:79]
    v_permlane32_swap_b32 v12, v13
    v_add_f32 v22, v12, v13
    v_add_f32 v13, v12, v13
    s_nop 1
    v_permlane16_swap_b32 v22, v13
    v_add_f32 v12, v22, v13
    v_rcp_f32 v12, v12
    s_mov_b64 exec, s[56:57]
    v_pk_mul_f32 v[72:73], v[72:73], v[12:13] op_sel_hi:[1,0]
    v_pk_mul_f32 v[74:75], v[74:75], v[12:13] op_sel_hi:[1,0]
    v_pk_mul_f32 v[76:77], v[76:77], v[12:13] op_sel_hi:[1,0]
    v_pk_mul_f32 v[78:79], v[78:79], v[12:13] op_sel_hi:[1,0]
    v_cvt_pk_bf16_f32 v72, v72, v73
    v_cvt_pk_bf16_f32 v73, v74, v75
    v_cvt_pk_bf16_f32 v74, v76, v77
    v_cvt_pk_bf16_f32 v75, v78, v79
    v_min_u32 v72, -2, v72
    v_min_u32 v73, -2, v73
    v_min_u32 v74, -2, v74
    v_min_u32 v75, -2, v75
    s_cmp_eq_u32 s67, 1
    s_cbranch_scc0 L_ls_18_s
    buffer_store_dwordx4 v[72:75], v17, s[12:15], s62 offen
L_ls_18_d:
    v_mov_b32 v60, -1
    v_mov_b32 v61, -1
    v_mov_b32 v62, -1
    v_mov_b32 v63, -1
    s_add_u32 s45, s60, 3
    s_and_b32 s45, s45, 3
    s_lshl_b32 s45, s45, 15
    s_add_u32 s45, s45, s59
    s_cmp_eq_u32 s67, 1
    s_cbranch_scc0 L_ls_19_s
    buffer_store_dwordx4 v[60:63], v17, s[12:15], s45 offen
L_ls_19_d:
    s_mov_b64 exec, -1
    s_mov_b32 m0, s64
    s_add_u32 s45, s63, 393216
    buffer_load_dwordx4 v14, s[12:15], s63 offen lds
    s_add_u32 m0, s64, 4352
    s_add_u32 s46, s63, 8192
    buffer_load_dwordx4 v14, s[12:15], s45 offen lds
    s_mov_b32 m0, s65
    s_add_u32 s45, s45, 8192
    buffer_load_dwordx4 v15, s[12:15], s46 offen lds
    s_add_u32 m0, s65, 4224
    s_add_u32 s63, s63, 786432
    buffer_load_dwordx4 v15, s[12:15], s45 offen lds
L_q_last_15:
    s_waitcnt lgkmcnt(0)
    v_lshlrev_b32 v22, 1, v16
    s_cmp_lg_u32 s44, 0
    s_cbranch_scc1 L_q_km_20_0
    buffer_store_dwordx4 v[40:43], v22, s[12:15], s66 offen offset:0
L_q_km_20_0:
    s_cmp_lg_u32 s44, 1
    s_cbranch_scc1 L_q_km_20_1
    buffer_store_dwordx4 v[44:47], v22, s[12:15], s66 offen offset:1024
L_q_km_20_1:
    s_cmp_lg_u32 s44, 2
    s_cbranch_scc1 L_q_km_20_2
    buffer_store_dwordx4 v[48:51], v22, s[12:15], s66 offen offset:2048
L_q_km_20_2:
    s_cmp_lg_u32 s44, 3
    s_cbranch_scc1 L_q_km_20_3
    buffer_store_dwordx4 v[52:55], v22, s[12:15], s66 offen offset:3072
L_q_km_20_3:
    s_mov_b64 exec, -1
    v_add_u32 v8, s69, v8
    v_add_u32 v9, s69, v9
    s_sub_u32 s64, s64, s69
    s_sub_u32 s65, s65, s69
    s_sub_u32 s69, 0, s69
    s_add_u32 s66, s66, 131072
    s_xor_b32 s51, s51, 65536
    s_add_u32 s60, s60, 1
    s_and_b32 s45, s60, 3
    s_lshl_b32 s46, s45, 14
    s_add_u32 s61, s58, s46
    s_lshl_b32 s46, s45, 15
    s_add_u32 s62, s59, s46
    s_cmp_lt_u32 s60, 64
    s_cbranch_scc1 L_q_loop_10
    s_endpgm
L_q_vm_17_r:
    buffer_load_dwordx2 v[0:1], v16, s[12:15], s51 offen sc1
    s_add_u32 s70, s70, 1
    s_cmp_lt_u32 s70, 0x100000
    s_waitcnt vmcnt(0)
    s_cbranch_scc1 L_q_vm_17
    s_endpgm
L_ls_16_s:
    buffer_store_dword v74, v20, s[12:15], 0 offen sc1
    s_branch L_ls_16_d
L_ls_18_s:
    buffer_store_dwordx4 v[72:75], v17, s[12:15], s62 offen sc1
    s_branch L_ls_18_d
L_ls_19_s:
    buffer_store_dwordx4 v[60:63], v17, s[12:15], s45 offen sc1
    s_branch L_ls_19_d
L_c_vo_7:
    s_lshl_b32 s45, s43, 11
    s_lshl_b32 s46, s44, 9
    s_add_u32 s45, s45, s46
    v_lshlrev_b32 v10, 3, v1
    v_add_u32 v10, s45, v10
    v_lshlrev_b32 v11, 3, v0
    v_bfe_u32 v69, v1, 4, 1
    v_lshlrev_b32 v69, 2, v69
    v_lshrrev_b32 v63, 5, v1
    v_lshlrev_b32 v63, 1, v63
    v_and_b32 v64, 1, v1
    v_add3_u32 v69, v69, v63, v64
    v_bfe_u32 v63, v1, 1, 1
    v_lshlrev_b32 v63, 3, v63
    v_add_u32 v63, v63, v69
    v_lshlrev_b32 v63, 4, v63
    v_bfe_u32 v64, v1, 2, 2
    v_lshlrev_b32 v64, 2, v64
    s_lshl_b32 s45, s42, 10
    s_lshl_b32 s46, s44, 8
    s_add_u32 s45, s45, s46
    v_add3_u32 v12, v63, v64, s45
    v_and_b32 v64, 1, v1
    v_cmp_eq_u32 vcc, 0, v64
    v_mov_b32 v9, 0x07060302
    v_mov_b32 v63, 0x01000504
    v_cndmask_b32 v9, v9, v63, vcc
    s_lshl_b32 s63, s40, 19
    s_lshl_b32 s45, s42, 15
    s_add_u32 s63, s63, s45
    s_add_u32 s63, s63, 0x7100000
    s_xor_b32 s64, s63, 524288
    s_cmp_lg_u32 s44, 0
    s_cbranch_scc1 L_v_probe_21
    s_mov_b64 exec, 1
    v_mov_b32 v46, 0
    s_mov_b32 s49, -1
    s_mov_b32 s50, -1
    s_add_u32 s51, s63, 8192
    v_mov_b32 v45, 0
    s_memtime s[72:73]
    s_waitcnt lgkmcnt(0)
    buffer_atomic_or v45, v46, s[12:15], s63 offen sc0 sc1
    s_waitcnt vmcnt(0)
    s_memtime s[74:75]
    s_waitcnt lgkmcnt(0)
    s_sub_u32 s45, s74, s72
    s_min_u32 s49, s49, s45
    v_mov_b32 v45, 0
    s_memtime s[72:73]
    s_waitcnt lgkmcnt(0)
    buffer_atomic_or v45, v46, s[12:15], s51 offen sc0 sc1
    s_waitcnt vmcnt(0)
    s_memtime s[74:75]
    s_waitcnt lgkmcnt(0)
    s_sub_u32 s45, s74, s72
    s_min_u32 s50, s50, s45
    v_mov_b32 v45, 0
    s_memtime s[72:73]
    s_waitcnt lgkmcnt(0)
    buffer_atomic_or v45, v46, s[12:15], s63 offen sc0 sc1
    s_waitcnt vmcnt(0)
    s_memtime s[74:75]
    s_waitcnt lgkmcnt(0)
    s_sub_u32 s45, s74, s72
    s_min_u32 s49, s49, s45
    v_mov_b32 v45, 0
    s_memtime s[72:73]
    s_waitcnt lgkmcnt(0)
    buffer_atomic_or v45, v46, s[12:15], s51 offen sc0 sc1
    s_waitcnt vmcnt(0)
    s_memtime s[74:75]
    s_waitcnt lgkmcnt(0)
    s_sub_u32 s45, s74, s72
    s_min_u32 s50, s50, s45
    v_mov_b32 v45, 0
    s_memtime s[72:73]
    s_waitcnt lgkmcnt(0)
    buffer_atomic_or v45, v46, s[12:15], s63 offen sc0 sc1
    s_waitcnt vmcnt(0)
    s_memtime s[74:75]
    s_waitcnt lgkmcnt(0)
    s_sub_u32 s45, s74, s72
    s_min_u32 s49, s49, s45
    v_mov_b32 v45, 0
    s_memtime s[72:73]
    s_waitcnt lgkmcnt(0)
    buffer_atomic_or v45, v46, s[12:15], s51 offen sc0 sc1
    s_waitcnt vmcnt(0)
    s_memtime s[74:75]
    s_waitcnt lgkmcnt(0)
    s_sub_u32 s45, s74, s72
    s_min_u32 s50, s50, s45
    v_mov_b32 v45, 0
    s_memtime s[72:73]
    s_waitcnt lgkmcnt(0)
    buffer_atomic_or v45, v46, s[12:15], s63 offen sc0 sc1
    s_waitcnt vmcnt(0)
    s_memtime s[74:75]
    s_waitcnt lgkmcnt(0)
    s_sub_u32 s45, s74, s72
    s_min_u32 s49, s49, s45
    v_mov_b32 v45, 0
    s_memtime s[72:73]
    s_waitcnt lgkmcnt(0)
    buffer_atomic_or v45, v46, s[12:15], s51 offen sc0 sc1
    s_waitcnt vmcnt(0)
    s_memtime s[74:75]
    s_waitcnt lgkmcnt(0)
    s_sub_u32 s45, s74, s72
    s_min_u32 s50, s50, s45
    s_cmp_lt_u32 s50, s49
    s_cselect_b32 s68, 1, 0
    s_mov_b64 exec, -1
L_v_probe_21:
    s_mov_b32 s45, 0x7020000
    buffer_store_dwordx2 v[40:41], v10, s[12:15], s45 offen sc1
    s_mov_b32 s45, 0x7030000
    buffer_store_dwordx2 v[40:41], v10, s[12:15], s45 offen sc1
    s_add_u32 s45, s63, 0
    buffer_store_dwordx2 v[40:41], v11, s[12:15], s45 offen sc1
    s_add_u32 s45, s63, 4096
    buffer_store_dwordx2 v[40:41], v11, s[12:15], s45 offen sc1
    s_add_u32 s45, s63, 8192
    buffer_store_dwordx2 v[40:41], v11, s[12:15], s45 offen sc1
    s_add_u32 s45, s63, 12288
    buffer_store_dwordx2 v[40:41], v11, s[12:15], s45 offen sc1
    s_add_u32 s45, s63, 16384
    buffer_store_dwordx2 v[40:41], v11, s[12:15], s45 offen sc1
    s_add_u32 s45, s63, 20480
    buffer_store_dwordx2 v[40:41], v11, s[12:15], s45 offen sc1
    s_add_u32 s45, s63, 24576
    buffer_store_dwordx2 v[40:41], v11, s[12:15], s45 offen sc1
    s_add_u32 s45, s63, 28672
    buffer_store_dwordx2 v[40:41], v11, s[12:15], s45 offen sc1
    s_lshl_b32 s61, s40, 16
    s_add_u32 s61, s61, 0x7000000
    s_add_u32 s45, s61, 16384
    buffer_store_dword v40, v12, s[12:15], s45 offen sc1
    s_add_u32 s45, s61, 32768
    buffer_store_dword v40, v12, s[12:15], s45 offen sc1
    s_add_u32 s45, s61, 49152
    buffer_store_dword v40, v12, s[12:15], s45 offen sc1
    v_lshlrev_b32 v63, 11, v69
    v_and_b32 v64, 14, v1
    v_lshlrev_b32 v64, 1, v64
    v_add_u32 v63, v63, v64
    s_lshl_b32 s45, s42, 7
    s_lshl_b32 s46, s44, 5
    s_add_u32 s45, s45, s46
    buffer_load_dword v45, v63, s[52:55], s45 offen
    s_waitcnt vmcnt(0)
    v_min_u32 v45, -2, v45
    buffer_store_dword v45, v12, s[12:15], s61 offen sc1
    s_waitcnt vmcnt(0)
    s_barrier
    s_cmp_lg_u32 s44, 0
    s_cbranch_scc1 L_hs_22
    s_getreg_b32 s45, hwreg(HW_REG_XCC_ID)
    s_and_b32 s45, s45, 15
    s_lshl_b32 s45, 1, s45
    v_mov_b32 v40, s45
    s_lshl_b32 s46, s40, 2
    s_add_u32 s46, s46, 4
    v_mov_b32 v41, 0
    v_mov_b32 v42, 1
    v_mov_b32 v43, s68
    s_mov_b64 exec, 1
    buffer_atomic_or v40, v41, s[16:19], s46 offen sc1
    buffer_atomic_add v43, v41, s[16:19], 0 offen offset:12 sc1
    s_waitcnt vmcnt(0)
    buffer_atomic_add v42, v41, s[16:19], 0 offen sc1
    s_waitcnt vmcnt(0)
    s_mov_b64 exec, -1
L_hs_22:
    v_lshrrev_b32 v63, 3, v1
    v_lshlrev_b32 v63, 11, v63
    v_bfe_u32 v64, v1, 1, 2
    v_and_b32 v65, 1, v1
    v_lshlrev_b32 v65, 4, v65
    v_add_u32 v63, v63, v65
    v_xor_b32 v66, 0, v64
    v_lshlrev_b32 v66, 5, v66
    v_add_u32 v70, v63, v66
    v_xor_b32 v66, 1, v64
    v_lshlrev_b32 v66, 5, v66
    v_add_u32 v71, v63, v66
    v_xor_b32 v66, 2, v64
    v_lshlrev_b32 v66, 5, v66
    v_add_u32 v72, v63, v66
    v_xor_b32 v66, 3, v64
    v_lshlrev_b32 v66, 5, v66
    v_add_u32 v73, v63, v66
    v_bfe_u32 v63, v1, 3, 1
    v_lshlrev_b32 v63, 1, v63
    v_bfe_u32 v64, v1, 4, 1
    v_add_u32 v63, v63, v64
    v_lshlrev_b32 v64, 3, v63
    v_lshrrev_b32 v65, 5, v1
    v_lshlrev_b32 v65, 2, v65
    v_add_u32 v64, v64, v65
    v_bfe_u32 v65, v1, 2, 1
    v_add_u32 v64, v64, v65
    v_lshlrev_b32 v64, 7, v64
    v_and_b32 v65, 3, v1
    v_lshlrev_b32 v65, 3, v65
    v_add_u32 v64, v64, v65
    s_lshl_b32 s45, s44, 12
    v_add_u32 v64, s45, v64
    s_add_u32 s45, s44, 1
    s_and_b32 s45, s45, 3
    v_xor_b32 v65, s45, v63
    v_lshlrev_b32 v65, 5, v65
    v_add_u32 v74, v64, v65
    s_add_u32 s45, s44, 2
    s_and_b32 s45, s45, 3
    v_xor_b32 v65, s45, v63
    v_lshlrev_b32 v65, 5, v65
    v_add_u32 v75, v64, v65
    s_add_u32 s45, s44, 3
    s_and_b32 s45, s45, 3
    v_xor_b32 v65, s45, v63
    v_lshlrev_b32 v65, 5, v65
    v_add_u32 v76, v64, v65
    s_add_u32 s45, s44, 4
    s_and_b32 s45, s45, 3
    v_xor_b32 v65, s45, v63
    v_lshlrev_b32 v65, 5, v65
    v_add_u32 v77, v64, v65
    s_lshl_b32 s49, s40, 22
    s_lshl_b32 s45, s44, 20
    s_add_u32 s49, s49, s45
    s_lshl_b32 s45, s42, 7
    s_add_u32 s49, s49, s45
    s_lshl_b32 s50, s44, 12
    s_mul_i32 s69, s42, 1
    v_add_u32 v83, 0x0, v82
    v_and_b32 v83, 0x7fffff, v83
    s_add_u32 s46, s47, 0x0
    s_add_u32 m0, s48, 0
    s_nop 0
    buffer_load_dwordx4 v83, s[32:35], s46 offen lds
    s_add_u32 s46, s47, 0x20000
    s_add_u32 m0, s48, 4096
    s_nop 0
    buffer_load_dwordx4 v83, s[32:35], s46 offen lds
    s_add_u32 s46, s47, 0x40000
    s_add_u32 m0, s48, 8192
    s_nop 0
    buffer_load_dwordx4 v83, s[32:35], s46 offen lds
    s_add_u32 s46, s47, 0x60000
    s_add_u32 m0, s48, 12288
    s_nop 0
    buffer_load_dwordx4 v83, s[32:35], s46 offen lds
    v_add_u32 v83, 0x80000, v82
    v_and_b32 v83, 0x7fffff, v83
    s_add_u32 s46, s47, 0x0
    s_add_u32 m0, s48, 16384
    s_nop 0
    buffer_load_dwordx4 v83, s[32:35], s46 offen lds
    s_add_u32 s46, s47, 0x20000
    s_add_u32 m0, s48, 20480
    s_nop 0
    buffer_load_dwordx4 v83, s[32:35], s46 offen lds
    s_add_u32 s46, s47, 0x40000
    s_add_u32 m0, s48, 24576
    s_nop 0
    buffer_load_dwordx4 v83, s[32:35], s46 offen lds
    s_add_u32 s46, s47, 0x60000
    s_add_u32 m0, s48, 28672
    s_nop 0
    buffer_load_dwordx4 v83, s[32:35], s46 offen lds
    v_add_u32 v83, 0x100000, v82
    v_and_b32 v83, 0x7fffff, v83
    s_add_u32 s46, s47, 0x0
    s_add_u32 m0, s48, 32768
    s_nop 0
    buffer_load_dwordx4 v83, s[32:35], s46 offen lds
    s_add_u32 s46, s47, 0x20000
    s_add_u32 m0, s48, 36864
    s_nop 0
    buffer_load_dwordx4 v83, s[32:35], s46 offen lds
    s_add_u32 s46, s47, 0x40000
    s_add_u32 m0, s48, 40960
    s_nop 0
    buffer_load_dwordx4 v83, s[32:35], s46 offen lds
    s_add_u32 s46, s47, 0x60000
    s_add_u32 m0, s48, 45056
    s_nop 0
    buffer_load_dwordx4 v83, s[32:35], s46 offen lds
    s_waitcnt vmcnt(8)
    s_barrier
    v_add_u32 v83, 0x180000, v82
    v_and_b32 v83, 0x7fffff, v83
    s_add_u32 s46, s47, 0x0
    s_add_u32 m0, s48, 49152
    s_nop 0
    buffer_load_dwordx4 v83, s[32:35], s46 offen lds
    s_add_u32 s46, s47, 0x20000
    s_add_u32 m0, s48, 53248
    s_nop 0
    buffer_load_dwordx4 v83, s[32:35], s46 offen lds
    s_add_u32 s46, s47, 0x40000
    s_add_u32 m0, s48, 57344
    s_nop 0
    buffer_load_dwordx4 v83, s[32:35], s46 offen lds
    s_add_u32 s46, s47, 0x60000
    s_add_u32 m0, s48, 61440
    s_nop 0
    buffer_load_dwordx4 v83, s[32:35], s46 offen lds
    ds_read_b64_tr_b16 a[0:1], v80 offset:0
    ds_read_b64_tr_b16 a[2:3], v80 offset:1024
    ds_read_b64_tr_b16 a[4:5], v80 offset:8192
    ds_read_b64_tr_b16 a[6:7], v80 offset:9216
    ds_read_b64_tr_b16 a[8:9], v81 offset:0
    ds_read_b64_tr_b16 a[10:11], v81 offset:1024
    ds_read_b64_tr_b16 a[12:13], v81 offset:8192
    ds_read_b64_tr_b16 a[14:15], v81 offset:9216
    s_waitcnt lgkmcnt(0)
    s_waitcnt vmcnt(8)
    s_barrier
    v_add_u32 v83, 0x200000, v82
    v_and_b32 v83, 0x7fffff, v83
    s_add_u32 s46, s47, 0x0
    s_add_u32 m0, s48, 0
    s_nop 0
    buffer_load_dwordx4 v83, s[32:35], s46 offen lds
    s_add_u32 s46, s47, 0x20000
    s_add_u32 m0, s48, 4096
    s_nop 0
    buffer_load_dwordx4 v83, s[32:35], s46 offen lds
    s_add_u32 s46, s47, 0x40000
    s_add_u32 m0, s48, 8192
    s_nop 0
    buffer_load_dwordx4 v83, s[32:35], s46 offen lds
    s_add_u32 s46, s47, 0x60000
    s_add_u32 m0, s48, 12288
    s_nop 0
    buffer_load_dwordx4 v83, s[32:35], s46 offen lds
    ds_read_b64_tr_b16 a[16:17], v80 offset:16384
    ds_read_b64_tr_b16 a[18:19], v80 offset:17408
    ds_read_b64_tr_b16 a[20:21], v80 offset:24576
    ds_read_b64_tr_b16 a[22:23], v80 offset:25600
    ds_read_b64_tr_b16 a[24:25], v81 offset:16384
    ds_read_b64_tr_b16 a[26:27], v81 offset:17408
    ds_read_b64_tr_b16 a[28:29], v81 offset:24576
    ds_read_b64_tr_b16 a[30:31], v81 offset:25600
    s_waitcnt lgkmcnt(0)
    s_waitcnt vmcnt(8)
    s_barrier
    v_add_u32 v83, 0x280000, v82
    v_and_b32 v83, 0x7fffff, v83
    s_add_u32 s46, s47, 0x0
    s_add_u32 m0, s48, 16384
    s_nop 0
    buffer_load_dwordx4 v83, s[32:35], s46 offen lds
    s_add_u32 s46, s47, 0x20000
    s_add_u32 m0, s48, 20480
    s_nop 0
    buffer_load_dwordx4 v83, s[32:35], s46 offen lds
    s_add_u32 s46, s47, 0x40000
    s_add_u32 m0, s48, 24576
    s_nop 0
    buffer_load_dwordx4 v83, s[32:35], s46 offen lds
    s_add_u32 s46, s47, 0x60000
    s_add_u32 m0, s48, 28672
    s_nop 0
    buffer_load_dwordx4 v83, s[32:35], s46 offen lds
    ds_read_b64_tr_b16 a[32:33], v80 offset:32768
    ds_read_b64_tr_b16 a[34:35], v80 offset:33792
    ds_read_b64_tr_b16 a[36:37], v80 offset:40960
    ds_read_b64_tr_b16 a[38:39], v80 offset:41984
    ds_read_b64_tr_b16 v[56:57], v81 offset:32768
    ds_read_b64_tr_b16 v[58:59], v81 offset:33792
    ds_read_b64_tr_b16 v[60:61], v81 offset:40960
    ds_read_b64_tr_b16 v[62:63], v81 offset:41984
    s_waitcnt lgkmcnt(0)
    ds_write_b128 v5, v[56:59] offset:0
    ds_write_b128 v5, v[60:63] offset:1024
    s_waitcnt lgkmcnt(0)
    s_waitcnt vmcnt(8)
    s_barrier
    v_add_u32 v83, 0x300000, v82
    v_and_b32 v83, 0x7fffff, v83
    s_add_u32 s46, s47, 0x0
    s_add_u32 m0, s48, 32768
    s_nop 0
    buffer_load_dwordx4 v83, s[32:35], s46 offen lds
    s_add_u32 s46, s47, 0x20000
    s_add_u32 m0, s48, 36864
    s_nop 0
    buffer_load_dwordx4 v83, s[32:35], s46 offen lds
    s_add_u32 s46, s47, 0x40000
    s_add_u32 m0, s48, 40960
    s_nop 0
    buffer_load_dwordx4 v83, s[32:35], s46 offen lds
    s_add_u32 s46, s47, 0x60000
    s_add_u32 m0, s48, 45056
    s_nop 0
    buffer_load_dwordx4 v83, s[32:35], s46 offen lds
    ds_read_b64_tr_b16 a[40:41], v80 offset:49152
    ds_read_b64_tr_b16 a[42:43], v80 offset:50176
    ds_read_b64_tr_b16 a[44:45], v80 offset:57344
    ds_read_b64_tr_b16 a[46:47], v80 offset:58368
    ds_read_b64_tr_b16 v[56:57], v81 offset:49152
    ds_read_b64_tr_b16 v[58:59], v81 offset:50176
    ds_read_b64_tr_b16 v[60:61], v81 offset:57344
    ds_read_b64_tr_b16 v[62:63], v81 offset:58368
    s_waitcnt lgkmcnt(0)
    ds_write_b128 v5, v[56:59] offset:2048
    ds_write_b128 v5, v[60:63] offset:3072
    s_waitcnt lgkmcnt(0)
    s_waitcnt vmcnt(8)
    s_barrier
    v_add_u32 v83, 0x380000, v82
    v_and_b32 v83, 0x7fffff, v83
    s_add_u32 s46, s47, 0x0
    s_add_u32 m0, s48, 49152
    s_nop 0
    buffer_load_dwordx4 v83, s[32:35], s46 offen lds
    s_add_u32 s46, s47, 0x20000
    s_add_u32 m0, s48, 53248
    s_nop 0
    buffer_load_dwordx4 v83, s[32:35], s46 offen lds
    s_add_u32 s46, s47, 0x40000
    s_add_u32 m0, s48, 57344
    s_nop 0
    buffer_load_dwordx4 v83, s[32:35], s46 offen lds
    s_add_u32 s46, s47, 0x60000
    s_add_u32 m0, s48, 61440
    s_nop 0
    buffer_load_dwordx4 v83, s[32:35], s46 offen lds
    ds_read_b64_tr_b16 a[48:49], v80 offset:0
    ds_read_b64_tr_b16 a[50:51], v80 offset:1024
    ds_read_b64_tr_b16 a[52:53], v80 offset:8192
    ds_read_b64_tr_b16 a[54:55], v80 offset:9216
    ds_read_b64_tr_b16 v[56:57], v81 offset:0
    ds_read_b64_tr_b16 v[58:59], v81 offset:1024
    ds_read_b64_tr_b16 v[60:61], v81 offset:8192
    ds_read_b64_tr_b16 v[62:63], v81 offset:9216
    s_waitcnt lgkmcnt(0)
    ds_write_b128 v5, v[56:59] offset:4096
    ds_write_b128 v5, v[60:63] offset:5120
    s_waitcnt lgkmcnt(0)
    s_waitcnt vmcnt(8)
    s_barrier
    v_add_u32 v83, 0x400000, v82
    v_and_b32 v83, 0x7fffff, v83
    s_add_u32 s46, s47, 0x0
    s_add_u32 m0, s48, 0
    s_nop 0
    buffer_load_dwordx4 v83, s[32:35], s46 offen lds
    s_add_u32 s46, s47, 0x20000
    s_add_u32 m0, s48, 4096
    s_nop 0
    buffer_load_dwordx4 v83, s[32:35], s46 offen lds
    s_add_u32 s46, s47, 0x40000
    s_add_u32 m0, s48, 8192
    s_nop 0
    buffer_load_dwordx4 v83, s[32:35], s46 offen lds
    s_add_u32 s46, s47, 0x60000
    s_add_u32 m0, s48, 12288
    s_nop 0
    buffer_load_dwordx4 v83, s[32:35], s46 offen lds
    ds_read_b64_tr_b16 a[56:57], v80 offset:16384
    ds_read_b64_tr_b16 a[58:59], v80 offset:17408
    ds_read_b64_tr_b16 a[60:61], v80 offset:24576
    ds_read_b64_tr_b16 a[62:63], v80 offset:25600
    ds_read_b64_tr_b16 v[56:57], v81 offset:16384
    ds_read_b64_tr_b16 v[58:59], v81 offset:17408
    ds_read_b64_tr_b16 v[60:61], v81 offset:24576
    ds_read_b64_tr_b16 v[62:63], v81 offset:25600
    s_waitcnt lgkmcnt(0)
    ds_write_b128 v5, v[56:59] offset:6144
    ds_write_b128 v5, v[60:63] offset:7168
    s_waitcnt lgkmcnt(0)
    s_waitcnt vmcnt(8)
    s_barrier
    v_add_u32 v83, 0x480000, v82
    v_and_b32 v83, 0x7fffff, v83
    s_add_u32 s46, s47, 0x0
    s_add_u32 m0, s48, 16384
    s_nop 0
    buffer_load_dwordx4 v83, s[32:35], s46 offen lds
    s_add_u32 s46, s47, 0x20000
    s_add_u32 m0, s48, 20480
    s_nop 0
    buffer_load_dwordx4 v83, s[32:35], s46 offen lds
    s_add_u32 s46, s47, 0x40000
    s_add_u32 m0, s48, 24576
    s_nop 0
    buffer_load_dwordx4 v83, s[32:35], s46 offen lds
    s_add_u32 s46, s47, 0x60000
    s_add_u32 m0, s48, 28672
    s_nop 0
    buffer_load_dwordx4 v83, s[32:35], s46 offen lds
    ds_read_b64_tr_b16 a[64:65], v80 offset:32768
    ds_read_b64_tr_b16 a[66:67], v80 offset:33792
    ds_read_b64_tr_b16 a[68:69], v80 offset:40960
    ds_read_b64_tr_b16 a[70:71], v80 offset:41984
    ds_read_b64_tr_b16 v[56:57], v81 offset:32768
    ds_read_b64_tr_b16 v[58:59], v81 offset:33792
    ds_read_b64_tr_b16 v[60:61], v81 offset:40960
    ds_read_b64_tr_b16 v[62:63], v81 offset:41984
    s_waitcnt lgkmcnt(0)
    ds_write_b128 v5, v[56:59] offset:8192
    ds_write_b128 v5, v[60:63] offset:9216
    s_waitcnt lgkmcnt(0)
    s_waitcnt vmcnt(8)
    s_barrier
    v_add_u32 v83, 0x500000, v82
    v_and_b32 v83, 0x7fffff, v83
    s_add_u32 s46, s47, 0x0
    s_add_u32 m0, s48, 32768
    s_nop 0
    buffer_load_dwordx4 v83, s[32:35], s46 offen lds
    s_add_u32 s46, s47, 0x20000
    s_add_u32 m0, s48, 36864
    s_nop 0
    buffer_load_dwordx4 v83, s[32:35], s46 offen lds
    s_add_u32 s46, s47, 0x40000
    s_add_u32 m0, s48, 40960
    s_nop 0
    buffer_load_dwordx4 v83, s[32:35], s46 offen lds
    s_add_u32 s46, s47, 0x60000
    s_add_u32 m0, s48, 45056
    s_nop 0
    buffer_load_dwordx4 v83, s[32:35], s46 offen lds
    ds_read_b64_tr_b16 a[72:73], v80 offset:49152
    ds_read_b64_tr_b16 a[74:75], v80 offset:50176
    ds_read_b64_tr_b16 a[76:77], v80 offset:57344
    ds_read_b64_tr_b16 a[78:79], v80 offset:58368
    ds_read_b64_tr_b16 v[56:57], v81 offset:49152
    ds_read_b64_tr_b16 v[58:59], v81 offset:50176
    ds_read_b64_tr_b16 v[60:61], v81 offset:57344
    ds_read_b64_tr_b16 v[62:63], v81 offset:58368
    s_waitcnt lgkmcnt(0)
    ds_write_b128 v5, v[56:59] offset:10240
    ds_write_b128 v5, v[60:63] offset:11264
    s_waitcnt lgkmcnt(0)
    s_waitcnt vmcnt(8)
    s_barrier
    v_add_u32 v83, 0x580000, v82
    v_and_b32 v83, 0x7fffff, v83
    s_add_u32 s46, s47, 0x0
    s_add_u32 m0, s48, 49152
    s_nop 0
    buffer_load_dwordx4 v83, s[32:35], s46 offen lds
    s_add_u32 s46, s47, 0x20000
    s_add_u32 m0, s48, 53248
    s_nop 0
    buffer_load_dwordx4 v83, s[32:35], s46 offen lds
    s_add_u32 s46, s47, 0x40000
    s_add_u32 m0, s48, 57344
    s_nop 0
    buffer_load_dwordx4 v83, s[32:35], s46 offen lds
    s_add_u32 s46, s47, 0x60000
    s_add_u32 m0, s48, 61440
    s_nop 0
    buffer_load_dwordx4 v83, s[32:35], s46 offen lds
    ds_read_b64_tr_b16 a[80:81], v80 offset:0
    ds_read_b64_tr_b16 a[82:83], v80 offset:1024
    ds_read_b64_tr_b16 a[84:85], v80 offset:8192
    ds_read_b64_tr_b16 a[86:87], v80 offset:9216
    ds_read_b64_tr_b16 v[56:57], v81 offset:0
    ds_read_b64_tr_b16 v[58:59], v81 offset:1024
    ds_read_b64_tr_b16 v[60:61], v81 offset:8192
    ds_read_b64_tr_b16 v[62:63], v81 offset:9216
    s_waitcnt lgkmcnt(0)
    ds_write_b128 v5, v[56:59] offset:12288
    ds_write_b128 v5, v[60:63] offset:13312
    s_waitcnt lgkmcnt(0)
    s_waitcnt vmcnt(8)
    s_barrier
    v_add_u32 v83, 0x600000, v82
    v_and_b32 v83, 0x7fffff, v83
    s_add_u32 s46, s47, 0x0
    s_add_u32 m0, s48, 0
    s_nop 0
    buffer_load_dwordx4 v83, s[32:35], s46 offen lds
    s_add_u32 s46, s47, 0x20000
    s_add_u32 m0, s48, 4096
    s_nop 0
    buffer_load_dwordx4 v83, s[32:35], s46 offen lds
    s_add_u32 s46, s47, 0x40000
    s_add_u32 m0, s48, 8192
    s_nop 0
    buffer_load_dwordx4 v83, s[32:35], s46 offen lds
    s_add_u32 s46, s47, 0x60000
    s_add_u32 m0, s48, 12288
    s_nop 0
    buffer_load_dwordx4 v83, s[32:35], s46 offen lds
    ds_read_b64_tr_b16 a[88:89], v80 offset:16384
    ds_read_b64_tr_b16 a[90:91], v80 offset:17408
    ds_read_b64_tr_b16 a[92:93], v80 offset:24576
    ds_read_b64_tr_b16 a[94:95], v80 offset:25600
    ds_read_b64_tr_b16 a[96:97], v81 offset:16384
    ds_read_b64_tr_b16 a[98:99], v81 offset:17408
    ds_read_b64_tr_b16 a[100:101], v81 offset:24576
    ds_read_b64_tr_b16 a[102:103], v81 offset:25600
    s_waitcnt lgkmcnt(0)
    s_waitcnt vmcnt(8)
    s_barrier
    v_add_u32 v83, 0x680000, v82
    v_and_b32 v83, 0x7fffff, v83
    s_add_u32 s46, s47, 0x0
    s_add_u32 m0, s48, 16384
    s_nop 0
    buffer_load_dwordx4 v83, s[32:35], s46 offen lds
    s_add_u32 s46, s47, 0x20000
    s_add_u32 m0, s48, 20480
    s_nop 0
    buffer_load_dwordx4 v83, s[32:35], s46 offen lds
    s_add_u32 s46, s47, 0x40000
    s_add_u32 m0, s48, 24576
    s_nop 0
    buffer_load_dwordx4 v83, s[32:35], s46 offen lds
    s_add_u32 s46, s47, 0x60000
    s_add_u32 m0, s48, 28672
    s_nop 0
    buffer_load_dwordx4 v83, s[32:35], s46 offen lds
    ds_read_b64_tr_b16 a[104:105], v80 offset:32768
    ds_read_b64_tr_b16 a[106:107], v80 offset:33792
    ds_read_b64_tr_b16 a[108:109], v80 offset:40960
    ds_read_b64_tr_b16 a[110:111], v80 offset:41984
    ds_read_b64_tr_b16 v[56:57], v81 offset:32768
    ds_read_b64_tr_b16 v[58:59], v81 offset:33792
    ds_read_b64_tr_b16 v[60:61], v81 offset:40960
    ds_read_b64_tr_b16 v[62:63], v81 offset:41984
    s_waitcnt lgkmcnt(0)
    ds_write_b128 v5, v[56:59] offset:14336
    ds_write_b128 v5, v[60:63] offset:15360
    s_waitcnt lgkmcnt(0)
    s_waitcnt vmcnt(8)
    s_barrier
    v_add_u32 v83, 0x700000, v82
    v_and_b32 v83, 0x7fffff, v83
    s_add_u32 s46, s47, 0x0
    s_add_u32 m0, s48, 32768
    s_nop 0
    buffer_load_dwordx4 v83, s[32:35], s46 offen lds
    s_add_u32 s46, s47, 0x20000
    s_add_u32 m0, s48, 36864
    s_nop 0
    buffer_load_dwordx4 v83, s[32:35], s46 offen lds
    s_add_u32 s46, s47, 0x40000
    s_add_u32 m0, s48, 40960
    s_nop 0
    buffer_load_dwordx4 v83, s[32:35], s46 offen lds
    s_add_u32 s46, s47, 0x60000
    s_add_u32 m0, s48, 45056
    s_nop 0
    buffer_load_dwordx4 v83, s[32:35], s46 offen lds
    ds_read_b64_tr_b16 a[112:113], v80 offset:49152
    ds_read_b64_tr_b16 a[114:115], v80 offset:50176
    ds_read_b64_tr_b16 a[116:117], v80 offset:57344
    ds_read_b64_tr_b16 a[118:119], v80 offset:58368
    ds_read_b64_tr_b16 v[56:57], v81 offset:49152
    ds_read_b64_tr_b16 v[58:59], v81 offset:50176
    ds_read_b64_tr_b16 v[60:61], v81 offset:57344
    ds_read_b64_tr_b16 v[62:63], v81 offset:58368
    s_waitcnt lgkmcnt(0)
    ds_write_b128 v5, v[56:59] offset:16384
    ds_write_b128 v5, v[60:63] offset:17408
    s_waitcnt lgkmcnt(0)
    s_waitcnt vmcnt(8)
    s_barrier
    v_add_u32 v83, 0x780000, v82
    v_and_b32 v83, 0x7fffff, v83
    s_add_u32 s46, s47, 0x0
    s_add_u32 m0, s48, 49152
    s_nop 0
    buffer_load_dwordx4 v83, s[32:35], s46 offen lds
    s_add_u32 s46, s47, 0x20000
    s_add_u32 m0, s48, 53248
    s_nop 0
    buffer_load_dwordx4 v83, s[32:35], s46 offen lds
    s_add_u32 s46, s47, 0x40000
    s_add_u32 m0, s48, 57344
    s_nop 0
    buffer_load_dwordx4 v83, s[32:35], s46 offen lds
    s_add_u32 s46, s47, 0x60000
    s_add_u32 m0, s48, 61440
    s_nop 0
    buffer_load_dwordx4 v83, s[32:35], s46 offen lds
    ds_read_b64_tr_b16 a[120:121], v80 offset:0
    ds_read_b64_tr_b16 a[122:123], v80 offset:1024
    ds_read_b64_tr_b16 a[124:125], v80 offset:8192
    ds_read_b64_tr_b16 a[126:127], v80 offset:9216
    ds_read_b64_tr_b16 v[56:57], v81 offset:0
    ds_read_b64_tr_b16 v[58:59], v81 offset:1024
    ds_read_b64_tr_b16 v[60:61], v81 offset:8192
    ds_read_b64_tr_b16 v[62:63], v81 offset:9216
    s_waitcnt lgkmcnt(0)
    ds_write_b128 v5, v[56:59] offset:18432
    ds_write_b128 v5, v[60:63] offset:19456
    s_waitcnt lgkmcnt(0)
    s_waitcnt vmcnt(8)
    s_barrier
    s_add_u32 s51, s69, 0
    s_and_b32 s51, s51, 7
    s_lshl_b32 s51, s51, 17
    s_add_u32 s51, s51, s49
    s_add_u32 s46, s51, 0x0
    s_add_u32 m0, s50, 0
    s_nop 0
    buffer_load_dwordx4 v70, s[36:39], s46 offen lds
    s_add_u32 s46, s51, 0x8000
    s_add_u32 m0, s50, 1024
    s_nop 0
    buffer_load_dwordx4 v71, s[36:39], s46 offen lds
    s_add_u32 s46, s51, 0x10000
    s_add_u32 m0, s50, 2048
    s_nop 0
    buffer_load_dwordx4 v72, s[36:39], s46 offen lds
    s_add_u32 s46, s51, 0x18000
    s_add_u32 m0, s50, 3072
    s_nop 0
    buffer_load_dwordx4 v73, s[36:39], s46 offen lds
    ds_read_b64_tr_b16 a[128:129], v80 offset:16384
    ds_read_b64_tr_b16 a[130:131], v80 offset:17408
    ds_read_b64_tr_b16 a[132:133], v80 offset:24576
    ds_read_b64_tr_b16 a[134:135], v80 offset:25600
    ds_read_b64_tr_b16 a[136:137], v81 offset:16384
    ds_read_b64_tr_b16 a[138:139], v81 offset:17408
    ds_read_b64_tr_b16 a[140:141], v81 offset:24576
    ds_read_b64_tr_b16 a[142:143], v81 offset:25600
    s_waitcnt lgkmcnt(0)
    s_waitcnt vmcnt(8)
    s_barrier
    s_add_u32 s51, s69, 0
    s_and_b32 s51, s51, 7
    s_lshl_b32 s51, s51, 17
    s_add_u32 s51, s51, s49
    s_add_u32 s46, s51, 0x4000
    s_add_u32 m0, s50, 16384
    s_nop 0
    buffer_load_dwordx4 v70, s[36:39], s46 offen lds
    s_add_u32 s46, s51, 0xc000
    s_add_u32 m0, s50, 17408
    s_nop 0
    buffer_load_dwordx4 v71, s[36:39], s46 offen lds
    s_add_u32 s46, s51, 0x14000
    s_add_u32 m0, s50, 18432
    s_nop 0
    buffer_load_dwordx4 v72, s[36:39], s46 offen lds
    s_add_u32 s46, s51, 0x1c000
    s_add_u32 m0, s50, 19456
    s_nop 0
    buffer_load_dwordx4 v73, s[36:39], s46 offen lds
    ds_read_b64_tr_b16 a[144:145], v80 offset:32768
    ds_read_b64_tr_b16 a[146:147], v80 offset:33792
    ds_read_b64_tr_b16 a[148:149], v80 offset:40960
    ds_read_b64_tr_b16 a[150:151], v80 offset:41984
    ds_read_b64_tr_b16 v[56:57], v81 offset:32768
    ds_read_b64_tr_b16 v[58:59], v81 offset:33792
    ds_read_b64_tr_b16 v[60:61], v81 offset:40960
    ds_read_b64_tr_b16 v[62:63], v81 offset:41984
    s_waitcnt lgkmcnt(0)
    ds_write_b128 v5, v[56:59] offset:20480
    ds_write_b128 v5, v[60:63] offset:21504
    s_waitcnt lgkmcnt(0)
    s_waitcnt vmcnt(8)
    s_barrier
    s_add_u32 s51, s69, 1
    s_and_b32 s51, s51, 7
    s_lshl_b32 s51, s51, 17
    s_add_u32 s51, s51, s49
    s_add_u32 s46, s51, 0x0
    s_add_u32 m0, s50, 32768
    s_nop 0
    buffer_load_dwordx4 v70, s[36:39], s46 offen lds
    s_add_u32 s46, s51, 0x8000
    s_add_u32 m0, s50, 33792
    s_nop 0
    buffer_load_dwordx4 v71, s[36:39], s46 offen lds
    s_add_u32 s46, s51, 0x10000
    s_add_u32 m0, s50, 34816
    s_nop 0
    buffer_load_dwordx4 v72, s[36:39], s46 offen lds
    s_add_u32 s46, s51, 0x18000
    s_add_u32 m0, s50, 35840
    s_nop 0
    buffer_load_dwordx4 v73, s[36:39], s46 offen lds
    ds_read_b64_tr_b16 a[152:153], v80 offset:49152
    ds_read_b64_tr_b16 a[154:155], v80 offset:50176
    ds_read_b64_tr_b16 a[156:157], v80 offset:57344
    ds_read_b64_tr_b16 a[158:159], v80 offset:58368
    ds_read_b64_tr_b16 v[56:57], v81 offset:49152
    ds_read_b64_tr_b16 v[58:59], v81 offset:50176
    ds_read_b64_tr_b16 v[60:61], v81 offset:57344
    ds_read_b64_tr_b16 v[62:63], v81 offset:58368
    s_waitcnt lgkmcnt(0)
    ds_write_b128 v5, v[56:59] offset:22528
    ds_write_b128 v5, v[60:63] offset:23552
    s_waitcnt lgkmcnt(0)
    s_waitcnt vmcnt(8)
    s_barrier
    s_add_u32 s51, s69, 1
    s_and_b32 s51, s51, 7
    s_lshl_b32 s51, s51, 17
    s_add_u32 s51, s51, s49
    s_add_u32 s46, s51, 0x4000
    s_add_u32 m0, s50, 49152
    s_nop 0
    buffer_load_dwordx4 v70, s[36:39], s46 offen lds
    s_add_u32 s46, s51, 0xc000
    s_add_u32 m0, s50, 50176
    s_nop 0
    buffer_load_dwordx4 v71, s[36:39], s46 offen lds
    s_add_u32 s46, s51, 0x14000
    s_add_u32 m0, s50, 51200
    s_nop 0
    buffer_load_dwordx4 v72, s[36:39], s46 offen lds
    s_add_u32 s46, s51, 0x1c000
    s_add_u32 m0, s50, 52224
    s_nop 0
    buffer_load_dwordx4 v73, s[36:39], s46 offen lds
    ds_read_b64_tr_b16 a[160:161], v74 offset:0
    ds_read_b64_tr_b16 a[162:163], v74 offset:256
    ds_read_b64_tr_b16 a[168:169], v75 offset:0
    ds_read_b64_tr_b16 a[170:171], v75 offset:256
    ds_read_b64_tr_b16 a[176:177], v76 offset:0
    ds_read_b64_tr_b16 a[178:179], v76 offset:256
    ds_read_b64_tr_b16 a[184:185], v77 offset:0
    ds_read_b64_tr_b16 a[186:187], v77 offset:256
    s_waitcnt lgkmcnt(0)
    s_waitcnt vmcnt(8)
    s_barrier
    s_add_u32 s51, s69, 2
    s_and_b32 s51, s51, 7
    s_lshl_b32 s51, s51, 17
    s_add_u32 s51, s51, s49
    s_add_u32 s46, s51, 0x0
    s_add_u32 m0, s50, 0
    s_nop 0
    buffer_load_dwordx4 v70, s[36:39], s46 offen lds
    s_add_u32 s46, s51, 0x8000
    s_add_u32 m0, s50, 1024
    s_nop 0
    buffer_load_dwordx4 v71, s[36:39], s46 offen lds
    s_add_u32 s46, s51, 0x10000
    s_add_u32 m0, s50, 2048
    s_nop 0
    buffer_load_dwordx4 v72, s[36:39], s46 offen lds
    s_add_u32 s46, s51, 0x18000
    s_add_u32 m0, s50, 3072
    s_nop 0
    buffer_load_dwordx4 v73, s[36:39], s46 offen lds
    ds_read_b64_tr_b16 a[164:165], v74 offset:16384
    ds_read_b64_tr_b16 a[166:167], v74 offset:16640
    ds_read_b64_tr_b16 a[172:173], v75 offset:16384
    ds_read_b64_tr_b16 a[174:175], v75 offset:16640
    ds_read_b64_tr_b16 a[180:181], v76 offset:16384
    ds_read_b64_tr_b16 a[182:183], v76 offset:16640
    ds_read_b64_tr_b16 a[188:189], v77 offset:16384
    ds_read_b64_tr_b16 a[190:191], v77 offset:16640
    s_waitcnt lgkmcnt(0)
    s_waitcnt vmcnt(8)
    s_barrier
    s_add_u32 s51, s69, 2
    s_and_b32 s51, s51, 7
    s_lshl_b32 s51, s51, 17
    s_add_u32 s51, s51, s49
    s_add_u32 s46, s51, 0x4000
    s_add_u32 m0, s50, 16384
    s_nop 0
    buffer_load_dwordx4 v70, s[36:39], s46 offen lds
    s_add_u32 s46, s51, 0xc000
    s_add_u32 m0, s50, 17408
    s_nop 0
    buffer_load_dwordx4 v71, s[36:39], s46 offen lds
    s_add_u32 s46, s51, 0x14000
    s_add_u32 m0, s50, 18432
    s_nop 0
    buffer_load_dwordx4 v72, s[36:39], s46 offen lds
    s_add_u32 s46, s51, 0x1c000
    s_add_u32 m0, s50, 19456
    s_nop 0
    buffer_load_dwordx4 v73, s[36:39], s46 offen lds
    ds_read_b64_tr_b16 a[192:193], v74 offset:32768
    ds_read_b64_tr_b16 a[194:195], v74 offset:33024
    ds_read_b64_tr_b16 a[200:201], v75 offset:32768
    ds_read_b64_tr_b16 a[202:203], v75 offset:33024
    ds_read_b64_tr_b16 a[208:209], v76 offset:32768
    ds_read_b64_tr_b16 a[210:211], v76 offset:33024
    ds_read_b64_tr_b16 a[216:217], v77 offset:32768
    ds_read_b64_tr_b16 a[218:219], v77 offset:33024
    s_waitcnt lgkmcnt(0)
    s_waitcnt vmcnt(8)
    s_barrier
    s_add_u32 s51, s69, 3
    s_and_b32 s51, s51, 7
    s_lshl_b32 s51, s51, 17
    s_add_u32 s51, s51, s49
    s_add_u32 s46, s51, 0x0
    s_add_u32 m0, s50, 32768
    s_nop 0
    buffer_load_dwordx4 v70, s[36:39], s46 offen lds
    s_add_u32 s46, s51, 0x8000
    s_add_u32 m0, s50, 33792
    s_nop 0
    buffer_load_dwordx4 v71, s[36:39], s46 offen lds
    s_add_u32 s46, s51, 0x10000
    s_add_u32 m0, s50, 34816
    s_nop 0
    buffer_load_dwordx4 v72, s[36:39], s46 offen lds
    s_add_u32 s46, s51, 0x18000
    s_add_u32 m0, s50, 35840
    s_nop 0
    buffer_load_dwordx4 v73, s[36:39], s46 offen lds
    ds_read_b64_tr_b16 a[196:197], v74 offset:49152
    ds_read_b64_tr_b16 a[198:199], v74 offset:49408
    ds_read_b64_tr_b16 a[204:205], v75 offset:49152
    ds_read_b64_tr_b16 a[206:207], v75 offset:49408
    ds_read_b64_tr_b16 a[212:213], v76 offset:49152
    ds_read_b64_tr_b16 a[214:215], v76 offset:49408
    ds_read_b64_tr_b16 a[220:221], v77 offset:49152
    ds_read_b64_tr_b16 a[222:223], v77 offset:49408
    s_waitcnt lgkmcnt(0)
    s_waitcnt vmcnt(8)
    s_barrier
    s_add_u32 s51, s69, 3
    s_and_b32 s51, s51, 7
    s_lshl_b32 s51, s51, 17
    s_add_u32 s51, s51, s49
    s_add_u32 s46, s51, 0x4000
    s_add_u32 m0, s50, 49152
    s_nop 0
    buffer_load_dwordx4 v70, s[36:39], s46 offen lds
    s_add_u32 s46, s51, 0xc000
    s_add_u32 m0, s50, 50176
    s_nop 0
    buffer_load_dwordx4 v71, s[36:39], s46 offen lds
    s_add_u32 s46, s51, 0x14000
    s_add_u32 m0, s50, 51200
    s_nop 0
    buffer_load_dwordx4 v72, s[36:39], s46 offen lds
    s_add_u32 s46, s51, 0x1c000
    s_add_u32 m0, s50, 52224
    s_nop 0
    buffer_load_dwordx4 v73, s[36:39], s46 offen lds
    ds_read_b64_tr_b16 a[224:225], v74 offset:0
    ds_read_b64_tr_b16 a[226:227], v74 offset:256
    ds_read_b64_tr_b16 a[232:233], v75 offset:0
    ds_read_b64_tr_b16 a[234:235], v75 offset:256
    ds_read_b64_tr_b16 a[240:241], v76 offset:0
    ds_read_b64_tr_b16 a[242:243], v76 offset:256
    ds_read_b64_tr_b16 a[248:249], v77 offset:0
    ds_read_b64_tr_b16 a[250:251], v77 offset:256
    s_waitcnt lgkmcnt(0)
    s_waitcnt vmcnt(8)
    s_barrier
    s_add_u32 s51, s69, 4
    s_and_b32 s51, s51, 7
    s_lshl_b32 s51, s51, 17
    s_add_u32 s51, s51, s49
    s_add_u32 s46, s51, 0x0
    s_add_u32 m0, s50, 0
    s_nop 0
    buffer_load_dwordx4 v70, s[36:39], s46 offen lds
    s_add_u32 s46, s51, 0x8000
    s_add_u32 m0, s50, 1024
    s_nop 0
    buffer_load_dwordx4 v71, s[36:39], s46 offen lds
    s_add_u32 s46, s51, 0x10000
    s_add_u32 m0, s50, 2048
    s_nop 0
    buffer_load_dwordx4 v72, s[36:39], s46 offen lds
    s_add_u32 s46, s51, 0x18000
    s_add_u32 m0, s50, 3072
    s_nop 0
    buffer_load_dwordx4 v73, s[36:39], s46 offen lds
    ds_read_b64_tr_b16 a[228:229], v74 offset:16384
    ds_read_b64_tr_b16 a[230:231], v74 offset:16640
    ds_read_b64_tr_b16 a[236:237], v75 offset:16384
    ds_read_b64_tr_b16 a[238:239], v75 offset:16640
    ds_read_b64_tr_b16 a[244:245], v76 offset:16384
    ds_read_b64_tr_b16 a[246:247], v76 offset:16640
    ds_read_b64_tr_b16 a[252:253], v77 offset:16384
    ds_read_b64_tr_b16 a[254:255], v77 offset:16640
    s_waitcnt lgkmcnt(0)
    s_waitcnt vmcnt(8)
    s_barrier
    s_add_u32 s51, s69, 4
    s_and_b32 s51, s51, 7
    s_lshl_b32 s51, s51, 17
    s_add_u32 s51, s51, s49
    s_add_u32 s46, s51, 0x4000
    s_add_u32 m0, s50, 16384
    s_nop 0
    buffer_load_dwordx4 v70, s[36:39], s46 offen lds
    s_add_u32 s46, s51, 0xc000
    s_add_u32 m0, s50, 17408
    s_nop 0
    buffer_load_dwordx4 v71, s[36:39], s46 offen lds
    s_add_u32 s46, s51, 0x14000
    s_add_u32 m0, s50, 18432
    s_nop 0
    buffer_load_dwordx4 v72, s[36:39], s46 offen lds
    s_add_u32 s46, s51, 0x1c000
    s_add_u32 m0, s50, 19456
    s_nop 0
    buffer_load_dwordx4 v73, s[36:39], s46 offen lds
    ds_read_b64_tr_b16 v[96:97], v74 offset:32768
    ds_read_b64_tr_b16 v[98:99], v74 offset:33024
    ds_read_b64_tr_b16 v[104:105], v75 offset:32768
    ds_read_b64_tr_b16 v[106:107], v75 offset:33024
    ds_read_b64_tr_b16 v[112:113], v76 offset:32768
    ds_read_b64_tr_b16 v[114:115], v76 offset:33024
    ds_read_b64_tr_b16 v[120:121], v77 offset:32768
    ds_read_b64_tr_b16 v[122:123], v77 offset:33024
    s_waitcnt lgkmcnt(0)
    s_waitcnt vmcnt(8)
    s_barrier
    s_add_u32 s51, s69, 5
    s_and_b32 s51, s51, 7
    s_lshl_b32 s51, s51, 17
    s_add_u32 s51, s51, s49
    s_add_u32 s46, s51, 0x0
    s_add_u32 m0, s50, 32768
    s_nop 0
    buffer_load_dwordx4 v70, s[36:39], s46 offen lds
    s_add_u32 s46, s51, 0x8000
    s_add_u32 m0, s50, 33792
    s_nop 0
    buffer_load_dwordx4 v71, s[36:39], s46 offen lds
    s_add_u32 s46, s51, 0x10000
    s_add_u32 m0, s50, 34816
    s_nop 0
    buffer_load_dwordx4 v72, s[36:39], s46 offen lds
    s_add_u32 s46, s51, 0x18000
    s_add_u32 m0, s50, 35840
    s_nop 0
    buffer_load_dwordx4 v73, s[36:39], s46 offen lds
    ds_read_b64_tr_b16 v[100:101], v74 offset:49152
    ds_read_b64_tr_b16 v[102:103], v74 offset:49408
    ds_read_b64_tr_b16 v[108:109], v75 offset:49152
    ds_read_b64_tr_b16 v[110:111], v75 offset:49408
    ds_read_b64_tr_b16 v[116:117], v76 offset:49152
    ds_read_b64_tr_b16 v[118:119], v76 offset:49408
    ds_read_b64_tr_b16 v[124:125], v77 offset:49152
    ds_read_b64_tr_b16 v[126:127], v77 offset:49408
    s_waitcnt lgkmcnt(0)
    s_waitcnt vmcnt(8)
    s_barrier
    s_add_u32 s51, s69, 5
    s_and_b32 s51, s51, 7
    s_lshl_b32 s51, s51, 17
    s_add_u32 s51, s51, s49
    s_add_u32 s46, s51, 0x4000
    s_add_u32 m0, s50, 49152
    s_nop 0
    buffer_load_dwordx4 v70, s[36:39], s46 offen lds
    s_add_u32 s46, s51, 0xc000
    s_add_u32 m0, s50, 50176
    s_nop 0
    buffer_load_dwordx4 v71, s[36:39], s46 offen lds
    s_add_u32 s46, s51, 0x14000
    s_add_u32 m0, s50, 51200
    s_nop 0
    buffer_load_dwordx4 v72, s[36:39], s46 offen lds
    s_add_u32 s46, s51, 0x1c000
    s_add_u32 m0, s50, 52224
    s_nop 0
    buffer_load_dwordx4 v73, s[36:39], s46 offen lds
    ds_read_b64_tr_b16 v[128:129], v74 offset:0
    ds_read_b64_tr_b16 v[130:131], v74 offset:256
    ds_read_b64_tr_b16 v[136:137], v75 offset:0
    ds_read_b64_tr_b16 v[138:139], v75 offset:256
    ds_read_b64_tr_b16 v[144:145], v76 offset:0
    ds_read_b64_tr_b16 v[146:147], v76 offset:256
    ds_read_b64_tr_b16 v[152:153], v77 offset:0
    ds_read_b64_tr_b16 v[154:155], v77 offset:256
    s_waitcnt lgkmcnt(0)
    s_waitcnt vmcnt(8)
    s_barrier
    s_add_u32 s51, s69, 6
    s_and_b32 s51, s51, 7
    s_lshl_b32 s51, s51, 17
    s_add_u32 s51, s51, s49
    s_add_u32 s46, s51, 0x0
    s_add_u32 m0, s50, 0
    s_nop 0
    buffer_load_dwordx4 v70, s[36:39], s46 offen lds
    s_add_u32 s46, s51, 0x8000
    s_add_u32 m0, s50, 1024
    s_nop 0
    buffer_load_dwordx4 v71, s[36:39], s46 offen lds
    s_add_u32 s46, s51, 0x10000
    s_add_u32 m0, s50, 2048
    s_nop 0
    buffer_load_dwordx4 v72, s[36:39], s46 offen lds
    s_add_u32 s46, s51, 0x18000
    s_add_u32 m0, s50, 3072
    s_nop 0
    buffer_load_dwordx4 v73, s[36:39], s46 offen lds
    ds_read_b64_tr_b16 v[132:133], v74 offset:16384
    ds_read_b64_tr_b16 v[134:135], v74 offset:16640
    ds_read_b64_tr_b16 v[140:141], v75 offset:16384
    ds_read_b64_tr_b16 v[142:143], v75 offset:16640
    ds_read_b64_tr_b16 v[148:149], v76 offset:16384
    ds_read_b64_tr_b16 v[150:151], v76 offset:16640
    ds_read_b64_tr_b16 v[156:157], v77 offset:16384
    ds_read_b64_tr_b16 v[158:159], v77 offset:16640
    s_waitcnt lgkmcnt(0)
    s_waitcnt vmcnt(8)
    s_barrier
    s_add_u32 s51, s69, 6
    s_and_b32 s51, s51, 7
    s_lshl_b32 s51, s51, 17
    s_add_u32 s51, s51, s49
    s_add_u32 s46, s51, 0x4000
    s_add_u32 m0, s50, 16384
    s_nop 0
    buffer_load_dwordx4 v70, s[36:39], s46 offen lds
    s_add_u32 s46, s51, 0xc000
    s_add_u32 m0, s50, 17408
    s_nop 0
    buffer_load_dwordx4 v71, s[36:39], s46 offen lds
    s_add_u32 s46, s51, 0x14000
    s_add_u32 m0, s50, 18432
    s_nop 0
    buffer_load_dwordx4 v72, s[36:39], s46 offen lds
    s_add_u32 s46, s51, 0x1c000
    s_add_u32 m0, s50, 19456
    s_nop 0
    buffer_load_dwordx4 v73, s[36:39], s46 offen lds
    ds_read_b64_tr_b16 v[160:161], v74 offset:32768
    ds_read_b64_tr_b16 v[162:163], v74 offset:33024
    ds_read_b64_tr_b16 v[168:169], v75 offset:32768
    ds_read_b64_tr_b16 v[170:171], v75 offset:33024
    ds_read_b64_tr_b16 v[176:177], v76 offset:32768
    ds_read_b64_tr_b16 v[178:179], v76 offset:33024
    ds_read_b64_tr_b16 v[184:185], v77 offset:32768
    ds_read_b64_tr_b16 v[186:187], v77 offset:33024
    s_waitcnt lgkmcnt(0)
    s_waitcnt vmcnt(8)
    s_barrier
    s_add_u32 s51, s69, 7
    s_and_b32 s51, s51, 7
    s_lshl_b32 s51, s51, 17
    s_add_u32 s51, s51, s49
    s_add_u32 s46, s51, 0x0
    s_add_u32 m0, s50, 32768
    s_nop 0
    buffer_load_dwordx4 v70, s[36:39], s46 offen lds
    s_add_u32 s46, s51, 0x8000
    s_add_u32 m0, s50, 33792
    s_nop 0
    buffer_load_dwordx4 v71, s[36:39], s46 offen lds
    s_add_u32 s46, s51, 0x10000
    s_add_u32 m0, s50, 34816
    s_nop 0
    buffer_load_dwordx4 v72, s[36:39], s46 offen lds
    s_add_u32 s46, s51, 0x18000
    s_add_u32 m0, s50, 35840
    s_nop 0
    buffer_load_dwordx4 v73, s[36:39], s46 offen lds
    ds_read_b64_tr_b16 v[164:165], v74 offset:49152
    ds_read_b64_tr_b16 v[166:167], v74 offset:49408
    ds_read_b64_tr_b16 v[172:173], v75 offset:49152
    ds_read_b64_tr_b16 v[174:175], v75 offset:49408
    ds_read_b64_tr_b16 v[180:181], v76 offset:49152
    ds_read_b64_tr_b16 v[182:183], v76 offset:49408
    ds_read_b64_tr_b16 v[188:189], v77 offset:49152
    ds_read_b64_tr_b16 v[190:191], v77 offset:49408
    s_waitcnt lgkmcnt(0)
    s_waitcnt vmcnt(8)
    s_barrier
    s_add_u32 s51, s69, 7
    s_and_b32 s51, s51, 7
    s_lshl_b32 s51, s51, 17
    s_add_u32 s51, s51, s49
    s_add_u32 s46, s51, 0x4000
    s_add_u32 m0, s50, 49152
    s_nop 0
    buffer_load_dwordx4 v70, s[36:39], s46 offen lds
    s_add_u32 s46, s51, 0xc000
    s_add_u32 m0, s50, 50176
    s_nop 0
    buffer_load_dwordx4 v71, s[36:39], s46 offen lds
    s_add_u32 s46, s51, 0x14000
    s_add_u32 m0, s50, 51200
    s_nop 0
    buffer_load_dwordx4 v72, s[36:39], s46 offen lds
    s_add_u32 s46, s51, 0x1c000
    s_add_u32 m0, s50, 52224
    s_nop 0
    buffer_load_dwordx4 v73, s[36:39], s46 offen lds
    ds_read_b64_tr_b16 v[192:193], v74 offset:0
    ds_read_b64_tr_b16 v[194:195], v74 offset:256
    ds_read_b64_tr_b16 v[200:201], v75 offset:0
    ds_read_b64_tr_b16 v[202:203], v75 offset:256
    ds_read_b64_tr_b16 v[208:209], v76 offset:0
    ds_read_b64_tr_b16 v[210:211], v76 offset:256
    ds_read_b64_tr_b16 v[216:217], v77 offset:0
    ds_read_b64_tr_b16 v[218:219], v77 offset:256
    s_waitcnt lgkmcnt(0)
    s_waitcnt vmcnt(8)
    s_barrier
    ds_read_b64_tr_b16 v[196:197], v74 offset:16384
    ds_read_b64_tr_b16 v[198:199], v74 offset:16640
    ds_read_b64_tr_b16 v[204:205], v75 offset:16384
    ds_read_b64_tr_b16 v[206:207], v75 offset:16640
    ds_read_b64_tr_b16 v[212:213], v76 offset:16384
    ds_read_b64_tr_b16 v[214:215], v76 offset:16640
    ds_read_b64_tr_b16 v[220:221], v77 offset:16384
    ds_read_b64_tr_b16 v[222:223], v77 offset:16640
    s_waitcnt lgkmcnt(0)
    s_waitcnt vmcnt(4)
    s_barrier
    ds_read_b64_tr_b16 v[224:225], v74 offset:32768
    ds_read_b64_tr_b16 v[226:227], v74 offset:33024
    ds_read_b64_tr_b16 v[232:233], v75 offset:32768
    ds_read_b64_tr_b16 v[234:235], v75 offset:33024
    ds_read_b64_tr_b16 v[240:241], v76 offset:32768
    ds_read_b64_tr_b16 v[242:243], v76 offset:33024
    ds_read_b64_tr_b16 v[248:249], v77 offset:32768
    ds_read_b64_tr_b16 v[250:251], v77 offset:33024
    s_waitcnt lgkmcnt(0)
    s_waitcnt vmcnt(0)
    s_barrier
    ds_read_b64_tr_b16 v[228:229], v74 offset:49152
    ds_read_b64_tr_b16 v[230:231], v74 offset:49408
    ds_read_b64_tr_b16 v[236:237], v75 offset:49152
    ds_read_b64_tr_b16 v[238:239], v75 offset:49408
    ds_read_b64_tr_b16 v[244:245], v76 offset:49152
    ds_read_b64_tr_b16 v[246:247], v76 offset:49408
    ds_read_b64_tr_b16 v[252:253], v77 offset:49152
    ds_read_b64_tr_b16 v[254:255], v77 offset:49408
    s_waitcnt lgkmcnt(0)
    s_barrier
    v_lshlrev_b32 v68, 4, v1
    s_mul_i32 s45, s44, 3072
    s_add_u32 s45, s45, 53248
    v_add_u32 v6, s45, v68
    s_sub_u32 s45, s44, 1
    s_and_b32 s45, s45, 3
    s_mul_i32 s45, s45, 3072
    s_add_u32 s45, s45, 53248
    v_add_u32 v7, s45, v68
    s_sub_u32 s45, s44, 2
    s_and_b32 s45, s45, 3
    s_mul_i32 s45, s45, 3072
    s_add_u32 s45, s45, 54272
    v_add_u32 v8, s45, v68
    s_sub_u32 s45, s44, 3
    s_and_b32 s45, s45, 3
    s_mul_i32 s45, s45, 3072
    s_add_u32 s45, s45, 55296
    v_add_u32 v18, s45, v68
    v_lshlrev_b32 v68, 4, v1
    s_add_u32 s45, s69, 0
    s_and_b32 s45, s45, 7
    s_lshl_b32 s45, s45, 10
    s_lshl_b32 s46, s44, 13
    s_add_u32 s45, s45, s46
    v_add_u32 v80, s45, v68
    s_add_u32 s45, s69, 1
    s_and_b32 s45, s45, 7
    s_lshl_b32 s45, s45, 10
    s_lshl_b32 s46, s44, 13
    s_add_u32 s45, s45, s46
    v_add_u32 v81, s45, v68
    s_add_u32 s45, s69, 2
    s_and_b32 s45, s45, 7
    s_lshl_b32 s45, s45, 10
    s_lshl_b32 s46, s44, 13
    s_add_u32 s45, s45, s46
    v_add_u32 v82, s45, v68
    s_add_u32 s45, s69, 3
    s_and_b32 s45, s45, 7
    s_lshl_b32 s45, s45, 10
    s_lshl_b32 s46, s44, 13
    s_add_u32 s45, s45, s46
    v_add_u32 v83, s45, v68
    s_add_u32 s45, s69, 4
    s_and_b32 s45, s45, 7
    s_lshl_b32 s45, s45, 10
    s_lshl_b32 s46, s44, 13
    s_add_u32 s45, s45, s46
    v_add_u32 v84, s45, v68
    s_add_u32 s45, s69, 5
    s_and_b32 s45, s45, 7
    s_lshl_b32 s45, s45, 10
    s_lshl_b32 s46, s44, 13
    s_add_u32 s45, s45, s46
    v_add_u32 v85, s45, v68
    s_add_u32 s45, s69, 6
    s_and_b32 s45, s45, 7
    s_lshl_b32 s45, s45, 10
    s_lshl_b32 s46, s44, 13
    s_add_u32 s45, s45, s46
    v_add_u32 v86, s45, v68
    s_add_u32 s45, s69, 7
    s_and_b32 s45, s45, 7
    s_lshl_b32 s45, s45, 10
    s_lshl_b32 s46, s44, 13
    s_add_u32 s45, s45, s46
    v_add_u32 v87, s45, v68
    s_lshl_b32 s45, s40, 4
    s_add_u32 s45, s45, s42
    s_lshl_b32 s45, s45, 7
    s_lshl_b32 s46, s44, 4
    s_add_u32 s45, s45, s46
    s_add_u32 s45, s45, 0x7080000
    v_and_b32 v13, 3, v1
    v_lshlrev_b32 v13, 2, v13
    v_add_u32 v13, s45, v13
    s_mov_b32 s66, 0x1800000
    v_mov_b32 v14, -1
    v_mov_b32 v15, -1
    s_mov_b32 s70, 0
    v_mov_b32 v41, 0
L_hw_23:
    s_sleep 2
    buffer_load_dword v44, v41, s[16:19], 0 offen sc1
    s_add_u32 s70, s70, 1
    s_cmp_ge_u32 s70, 0x100000
    s_cbranch_scc1 L_c_done_6
    s_waitcnt vmcnt(0)
    v_readfirstlane_b32 s45, v44
    s_cmp_lg_u32 s45, 64
    s_cbranch_scc1 L_hw_23
    buffer_load_dwordx4 v[44:47], v41, s[16:19], 0 offen sc1
    s_waitcnt vmcnt(0)
    v_readfirstlane_b32 s45, v45
    v_readfirstlane_b32 s46, v46
    v_readfirstlane_b32 s68, v47
    s_bcnt1_i32_b32 s45, s45
    s_bcnt1_i32_b32 s46, s46
    s_add_u32 s45, s45, s46
    s_cmp_eq_u32 s45, 2
    s_cselect_b32 s67, 1, 0
    s_cmp_ge_u32 s68, 16
    s_cselect_b32 s68, 8192, 0
    s_mov_b32 s60, 0
    s_lshl_b32 s58, s40, 16
    s_add_u32 s58, s58, 0x7000000
    s_mov_b32 s61, s58
    s_lshl_b32 s59, s40, 17
    s_add_u32 s59, s59, 0x7040000
    s_mov_b32 s62, s59
    s_add_u32 s63, s63, s68
    s_add_u32 s64, s64, s68
    ds_read_b128 v[56:59], v5 offset:0
    ds_read_b128 v[60:63], v5 offset:1024
    ds_read_b128 v[64:67], v5 offset:2048
    ds_read_b128 v[68:71], v5 offset:3072
    ds_read_b128 v[72:75], v5 offset:4096
    ds_read_b128 v[76:79], v5 offset:5120
    ds_read_b128 v[88:91], v5 offset:6144
    ds_read_b128 v[92:95], v5 offset:7168
    ds_read_b128 v[32:35], v5 offset:8192
    ds_read_b128 v[36:39], v5 offset:9216
L_v_loop_24:
    s_nop 15
    s_nop 15
    s_waitcnt lgkmcnt(0)
    s_mov_b32 s70, 0
L_mg_25:
    buffer_load_dwordx4 v[40:43], v3, s[12:15], s61 offen offset:0 sc1
    s_nop 9
    buffer_load_dwordx4 v[44:47], v3, s[12:15], s61 offen offset:1024 sc1
    s_nop 9
    buffer_load_dwordx4 v[48:51], v3, s[12:15], s61 offen offset:2048 sc1
    s_nop 9
    buffer_load_dwordx4 v[52:55], v3, s[12:15], s61 offen offset:3072 sc1
    s_add_u32 s70, s70, 1
    s_cmp_ge_u32 s70, 0x100000
    s_cbranch_scc1 L_c_done_6
    s_nop 1
    v_mov_b32 v24, 0
    v_mov_b32 v25, 0
    v_mov_b32 v26, 0
    v_mov_b32 v27, 0
    v_mov_b32 v28, 0
    v_mov_b32 v29, 0
    v_mov_b32 v30, 0
    v_mov_b32 v31, 0
    s_waitcnt vmcnt(3)
    ds_write_b128 v3, v[40:43] offset:0
    v_smfmac_f32_16x16x64_bf16 v[24:27], v[40:43], a[0:7], v2
    v_max3_u32 v22, v40, v41, v42
    v_max_u32 v22, v22, v43
    v_smfmac_f32_16x16x64_bf16 v[28:31], v[40:43], a[8:15], v2
    s_waitcnt vmcnt(2)
    ds_write_b128 v3, v[44:47] offset:1024
    v_smfmac_f32_16x16x64_bf16 v[24:27], v[44:47], a[16:23], v2
    v_max3_u32 v22, v22, v44, v45
    v_max3_u32 v22, v22, v46, v47
    v_smfmac_f32_16x16x64_bf16 v[28:31], v[44:47], a[24:31], v2
    s_waitcnt vmcnt(1)
    ds_write_b128 v3, v[48:51] offset:2048
    s_waitcnt vmcnt(0)
    ds_write_b128 v3, v[52:55] offset:3072
    v_max3_u32 v22, v22, v48, v49
    v_max3_u32 v22, v22, v50, v51
    v_max3_u32 v22, v22, v52, v53
    v_max3_u32 v22, v22, v54, v55
    v_cmp_eq_u32 vcc, -1, v22
    s_waitcnt lgkmcnt(0)
    s_nop 0
    s_cbranch_vccnz L_mg_25
    s_barrier
    ds_read_b128 v[40:43], v4 offset:0
    ds_read_b128 v[44:47], v4 offset:1024
    v_smfmac_f32_16x16x64_bf16 v[24:27], v[48:51], a[32:39], v2
    v_smfmac_f32_16x16x64_bf16 v[28:31], v[48:51], v[56:63], v2
    ds_read_b128 v[48:51], v4 offset:2048
    ds_read_b128 v[56:59], v5 offset:10240
    v_smfmac_f32_16x16x64_bf16 v[24:27], v[52:55], a[40:47], v2
    ds_read_b128 v[60:63], v5 offset:11264
    v_smfmac_f32_16x16x64_bf16 v[28:31], v[52:55], v[64:71], v2
    ds_read_b128 v[52:55], v4 offset:3072
    ds_read_b128 v[64:67], v5 offset:12288
    s_waitcnt lgkmcnt(5)
    v_smfmac_f32_16x16x64_bf16 v[24:27], v[40:43], a[48:55], v2
    ds_read_b128 v[68:71], v5 offset:13312
    v_smfmac_f32_16x16x64_bf16 v[28:31], v[40:43], v[72:79], v2
    ds_read_b128 v[40:43], v21 offset:0
    ds_read_b128 v[72:75], v5 offset:14336
    v_smfmac_f32_16x16x64_bf16 v[24:27], v[44:47], a[56:63], v2
    ds_read_b128 v[76:79], v5 offset:15360
    v_smfmac_f32_16x16x64_bf16 v[28:31], v[44:47], v[88:95], v2
    ds_read_b128 v[44:47], v21 offset:1024
    ds_read_b128 v[88:91], v5 offset:16384
    s_waitcnt lgkmcnt(6)
    v_smfmac_f32_16x16x64_bf16 v[24:27], v[48:51], a[64:71], v2
    ds_read_b128 v[92:95], v5 offset:17408
    v_smfmac_f32_16x16x64_bf16 v[28:31], v[48:51], v[32:39], v2
    ds_read_b128 v[48:51], v21 offset:2048
    ds_read_b128 v[32:35], v5 offset:18432
    v_smfmac_f32_16x16x64_bf16 v[24:27], v[52:55], a[72:79], v2
    ds_read_b128 v[36:39], v5 offset:19456
    v_smfmac_f32_16x16x64_bf16 v[28:31], v[52:55], v[56:63], v2
    ds_read_b128 v[52:55], v21 offset:3072
    ds_read_b128 v[56:59], v5 offset:20480
    s_waitcnt lgkmcnt(6)
    v_smfmac_f32_16x16x64_bf16 v[24:27], v[40:43], a[80:87], v2
    ds_read_b128 v[60:63], v5 offset:21504
    v_smfmac_f32_16x16x64_bf16 v[28:31], v[40:43], v[64:71], v2
    ds_read_b128 v[40:43], v23 offset:0
    ds_read_b128 v[64:67], v5 offset:22528
    v_smfmac_f32_16x16x64_bf16 v[24:27], v[44:47], a[88:95], v2
    ds_read_b128 v[68:71], v5 offset:23552
    v_smfmac_f32_16x16x64_bf16 v[28:31], v[44:47], a[96:103], v2
    ds_read_b128 v[44:47], v23 offset:1024
    s_waitcnt lgkmcnt(5)
    v_smfmac_f32_16x16x64_bf16 v[24:27], v[48:51], a[104:111], v2
    v_smfmac_f32_16x16x64_bf16 v[28:31], v[48:51], v[72:79], v2
    ds_read_b128 v[48:51], v23 offset:2048
    v_smfmac_f32_16x16x64_bf16 v[24:27], v[52:55], a[112:119], v2
    v_smfmac_f32_16x16x64_bf16 v[28:31], v[52:55], v[88:95], v2
    ds_read_b128 v[52:55], v23 offset:3072
    s_waitcnt lgkmcnt(2)
    v_smfmac_f32_16x16x64_bf16 v[24:27], v[40:43], a[120:127], v2
    v_smfmac_f32_16x16x64_bf16 v[28:31], v[40:43], v[32:39], v2
    v_smfmac_f32_16x16x64_bf16 v[24:27], v[44:47], a[128:135], v2
    v_smfmac_f32_16x16x64_bf16 v[28:31], v[44:47], a[136:143], v2
    s_waitcnt lgkmcnt(0)
    v_smfmac_f32_16x16x64_bf16 v[24:27], v[48:51], a[144:151], v2
    v_smfmac_f32_16x16x64_bf16 v[28:31], v[48:51], v[56:63], v2
    v_smfmac_f32_16x16x64_bf16 v[24:27], v[52:55], a[152:159], v2
    v_smfmac_f32_16x16x64_bf16 v[28:31], v[52:55], v[64:71], v2
    s_and_b32 s45, s60, 1
    s_lshl_b32 s45, s45, 16
    s_add_u32 s45, s45, 0x7020000
    s_xor_b32 s46, s45, 65536
    s_nop 3
    v_permlane32_swap_b32 v24, v26
    v_permlane32_swap_b32 v25, v27
    v_permlane32_swap_b32 v28, v30
    v_permlane32_swap_b32 v29, v31
    v_pk_add_f32 v[24:25], v[24:25], v[26:27]
    v_pk_add_f32 v[28:29], v[28:29], v[30:31]
    v_cvt_pk_bf16_f32 v16, v24, v25
    v_cvt_pk_bf16_f32 v17, v28, v29
    v_min_u32 v16, -2, v16
    v_min_u32 v17, -2, v17
    s_add_u32 s47, s60, 3
    s_and_b32 s47, s47, 3
    s_lshl_b32 s47, s47, 14
    s_add_u32 s47, s47, s58
    s_cmp_eq_u32 s67, 1
    s_cbranch_scc0 L_ls_26_s
    buffer_store_dwordx2 v[16:17], v10, s[12:15], s45 offen
    buffer_store_dwordx2 v[14:15], v10, s[12:15], s46 offen
    buffer_store_dword v14, v12, s[12:15], s47 offen
L_ls_26_d:
    buffer_store_dwordx2 v[16:17], v10, s[12:15], s66 offen
    s_cmp_eq_u32 s60, 63
    s_cbranch_scc1 L_v_fin_27
    s_and_b32 s65, s60, 1
    s_lshl_b32 s65, s65, 12
    s_and_b32 s45, s60, 2
    s_lshl_b32 s45, s45, 13
    s_add_u32 s65, s65, s45
    s_xor_b32 s45, s65, 16384
    s_add_u32 s45, s45, s63
    buffer_store_dwordx2 v[14:15], v11, s[12:15], s45 offen sc1
    s_add_u32 s48, s63, s65
    s_add_u32 s49, s64, s65
    s_sleep 8
    s_mov_b64 exec, 15
    buffer_load_dword v88, v13, s[12:15], 0 offen sc1
    s_nop 15
    buffer_load_dword v89, v13, s[12:15], 0 offen sc1
    s_nop 15
    buffer_load_dword v90, v13, s[12:15], 0 offen sc1
    s_nop 15
    buffer_load_dword v91, v13, s[12:15], 0 offen sc1
    s_mov_b32 s70, 0
L_pp_28:
    s_waitcnt vmcnt(3)
    v_cmp_ge_u32 vcc, s60, v88
    s_add_u32 s70, s70, 1
    s_nop 0
    s_cbranch_vccz L_ppd_29
    buffer_load_dword v88, v13, s[12:15], 0 offen sc1
    s_waitcnt vmcnt(3)
    v_cmp_ge_u32 vcc, s60, v89
    s_add_u32 s70, s70, 1
    s_nop 0
    s_cbranch_vccz L_ppd_29
    buffer_load_dword v89, v13, s[12:15], 0 offen sc1
    s_waitcnt vmcnt(3)
    v_cmp_ge_u32 vcc, s60, v90
    s_add_u32 s70, s70, 1
    s_nop 0
    s_cbranch_vccz L_ppd_29
    buffer_load_dword v90, v13, s[12:15], 0 offen sc1
    s_waitcnt vmcnt(3)
    v_cmp_ge_u32 vcc, s60, v91
    s_add_u32 s70, s70, 1
    s_nop 0
    s_cbranch_vccz L_ppd_29
    buffer_load_dword v91, v13, s[12:15], 0 offen sc1
    s_cmp_lt_u32 s70, 0x400000
    s_cbranch_scc1 L_pp_28
    s_branch L_c_done_6
L_ppd_29:
    s_mov_b64 exec, -1
    s_nop 15
    s_nop 15
    s_mov_b32 s70, 0
    buffer_load_dwordx4 v[40:43], v80, s[12:15], s62 offen sc1
    v_mov_b32 v24, 0
    v_mov_b32 v25, 0
    v_mov_b32 v26, 0
    v_mov_b32 v27, 0
    s_nop 5
    buffer_load_dwordx4 v[44:47], v81, s[12:15], s62 offen sc1
    v_mov_b32 v28, 0
    v_mov_b32 v29, 0
    v_mov_b32 v30, 0
    v_mov_b32 v31, 0
    s_nop 5
    buffer_load_dwordx4 v[48:51], v82, s[12:15], s62 offen sc1
    v_mov_b32 v32, 0
    v_mov_b32 v33, 0
    v_mov_b32 v34, 0
    v_mov_b32 v35, 0
    s_nop 5
    buffer_load_dwordx4 v[52:55], v83, s[12:15], s62 offen sc1
    v_mov_b32 v36, 0
    v_mov_b32 v37, 0
    v_mov_b32 v38, 0
    v_mov_b32 v39, 0
    s_nop 5
    buffer_load_dwordx4 v[56:59], v84, s[12:15], s62 offen sc1
    s_nop 9
    buffer_load_dwordx4 v[60:63], v85, s[12:15], s62 offen sc1
    s_waitcnt vmcnt(5)
    v_max3_u32 v22, v40, v41, v42
    v_max_u32 v22, v22, v43
    v_cmp_eq_u32 vcc, -1, v22
    s_nop 1
    s_cbranch_vccnz L_v_og_30_r0
L_v_og_30_c0:
    v_smfmac_f32_16x16x64_bf16 v[24:27], v[40:43], a[160:167], v2
    s_waitcnt vmcnt(4)
    v_max3_u32 v22, v44, v45, v46
    v_smfmac_f32_16x16x64_bf16 v[28:31], v[40:43], a[168:175], v2
    v_max_u32 v22, v22, v47
    v_smfmac_f32_16x16x64_bf16 v[32:35], v[40:43], a[176:183], v2
    v_cmp_eq_u32 vcc, -1, v22
    v_smfmac_f32_16x16x64_bf16 v[36:39], v[40:43], a[184:191], v2
    buffer_load_dwordx4 v[64:67], v86, s[12:15], s62 offen sc1
    s_cbranch_vccnz L_v_og_30_r1
L_v_og_30_c1:
    v_smfmac_f32_16x16x64_bf16 v[24:27], v[44:47], a[192:199], v2
    s_waitcnt vmcnt(4)
    v_max3_u32 v22, v48, v49, v50
    v_smfmac_f32_16x16x64_bf16 v[28:31], v[44:47], a[200:207], v2
    v_max_u32 v22, v22, v51
    v_smfmac_f32_16x16x64_bf16 v[32:35], v[44:47], a[208:215], v2
    v_cmp_eq_u32 vcc, -1, v22
    v_smfmac_f32_16x16x64_bf16 v[36:39], v[44:47], a[216:223], v2
    buffer_load_dwordx4 v[68:71], v87, s[12:15], s62 offen sc1
    s_cbranch_vccnz L_v_og_30_r2
L_v_og_30_c2:
    v_smfmac_f32_16x16x64_bf16 v[24:27], v[48:51], a[224:231], v2
    s_waitcnt vmcnt(4)
    v_max3_u32 v22, v52, v53, v54
    v_smfmac_f32_16x16x64_bf16 v[28:31], v[48:51], a[232:239], v2
    v_max_u32 v22, v22, v55
    v_smfmac_f32_16x16x64_bf16 v[32:35], v[48:51], a[240:247], v2
    v_cmp_eq_u32 vcc, -1, v22
    v_smfmac_f32_16x16x64_bf16 v[36:39], v[48:51], a[248:255], v2
    s_nop 0
    s_cbranch_vccnz L_v_og_30_r3
L_v_og_30_c3:
    v_smfmac_f32_16x16x64_bf16 v[24:27], v[52:55], v[96:103], v2
    s_waitcnt vmcnt(3)
    v_max3_u32 v22, v56, v57, v58
    v_smfmac_f32_16x16x64_bf16 v[28:31], v[52:55], v[104:111], v2
    v_max_u32 v22, v22, v59
    v_smfmac_f32_16x16x64_bf16 v[32:35], v[52:55], v[112:119], v2
    v_cmp_eq_u32 vcc, -1, v22
    v_smfmac_f32_16x16x64_bf16 v[36:39], v[52:55], v[120:127], v2
    s_nop 0
    s_cbranch_vccnz L_v_og_30_r4
L_v_og_30_c4:
    v_smfmac_f32_16x16x64_bf16 v[24:27], v[56:59], v[128:135], v2
    s_waitcnt vmcnt(2)
    v_max3_u32 v22, v60, v61, v62
    v_smfmac_f32_16x16x64_bf16 v[28:31], v[56:59], v[136:143], v2
    v_max_u32 v22, v22, v63
    v_smfmac_f32_16x16x64_bf16 v[32:35], v[56:59], v[144:151], v2
    v_cmp_eq_u32 vcc, -1, v22
    v_smfmac_f32_16x16x64_bf16 v[36:39], v[56:59], v[152:159], v2
    s_nop 0
    s_cbranch_vccnz L_v_og_30_r5
L_v_og_30_c5:
    v_smfmac_f32_16x16x64_bf16 v[24:27], v[60:63], v[160:167], v2
    s_waitcnt vmcnt(1)
    v_max3_u32 v22, v64, v65, v66
    v_smfmac_f32_16x16x64_bf16 v[28:31], v[60:63], v[168:175], v2
    v_max_u32 v22, v22, v67
    v_smfmac_f32_16x16x64_bf16 v[32:35], v[60:63], v[176:183], v2
    v_cmp_eq_u32 vcc, -1, v22
    v_smfmac_f32_16x16x64_bf16 v[36:39], v[60:63], v[184:191], v2
    s_nop 0
    s_cbranch_vccnz L_v_og_30_r6
L_v_og_30_c6:
    v_smfmac_f32_16x16x64_bf16 v[24:27], v[64:67], v[192:199], v2
    s_waitcnt vmcnt(0)
    v_max3_u32 v22, v68, v69, v70
    v_smfmac_f32_16x16x64_bf16 v[28:31], v[64:67], v[200:207], v2
    v_max_u32 v22, v22, v71
    v_smfmac_f32_16x16x64_bf16 v[32:35], v[64:67], v[208:215], v2
    v_cmp_eq_u32 vcc, -1, v22
    v_smfmac_f32_16x16x64_bf16 v[36:39], v[64:67], v[216:223], v2
    s_nop 0
    s_cbranch_vccnz L_v_og_30_r7
L_v_og_30_c7:
    v_smfmac_f32_16x16x64_bf16 v[24:27], v[68:71], v[224:231], v2
    v_smfmac_f32_16x16x64_bf16 v[28:31], v[68:71], v[232:239], v2
    v_smfmac_f32_16x16x64_bf16 v[32:35], v[68:71], v[240:247], v2
    v_smfmac_f32_16x16x64_bf16 v[36:39], v[68:71], v[248:255], v2
    s_add_u32 s46, s60, 1
    s_nop 3
    ds_write_b128 v6, v[24:27]
    s_and_b32 s45, s46, 3
    ds_write_b128 v6, v[28:31] offset:1024
    s_mov_b32 s60, s46
    ds_write_b128 v6, v[32:35] offset:2048
    s_lshl_b32 s46, s45, 14
    s_add_u32 s61, s58, s46
    s_lshl_b32 s46, s45, 15
    s_add_u32 s62, s59, s46
    s_waitcnt lgkmcnt(0)
    s_barrier
    ds_read_b128 v[40:43], v7
    ds_read_b128 v[44:47], v8
    ds_read_b128 v[48:51], v18
    s_waitcnt lgkmcnt(2)
    v_pk_add_f32 v[36:37], v[36:37], v[40:41]
    v_pk_add_f32 v[38:39], v[38:39], v[42:43]
    s_waitcnt lgkmcnt(1)
    v_pk_add_f32 v[36:37], v[36:37], v[44:45]
    v_pk_add_f32 v[38:39], v[38:39], v[46:47]
    s_waitcnt lgkmcnt(0)
    v_pk_add_f32 v[36:37], v[36:37], v[48:49]
    v_pk_add_f32 v[38:39], v[38:39], v[50:51]
    s_nop 1
    v_permlane32_swap_b32 v36, v38
    v_permlane32_swap_b32 v37, v39
    v_pk_add_f32 v[24:25], v[36:37], v[38:39]
    v_min_u32 v24, -2, v24
    v_min_u32 v25, -2, v25
    buffer_store_dwordx2 v[24:25], v11, s[12:15], s48 offen sc1
    ds_read_b128 v[56:59], v5 offset:0
    ds_read_b128 v[60:63], v5 offset:1024
    ds_read_b128 v[64:67], v5 offset:2048
    ds_read_b128 v[68:71], v5 offset:3072
    ds_read_b128 v[72:75], v5 offset:4096
    ds_read_b128 v[76:79], v5 offset:5120
    ds_read_b128 v[88:91], v5 offset:6144
    ds_read_b128 v[92:95], v5 offset:7168
    ds_read_b128 v[32:35], v5 offset:8192
    ds_read_b128 v[36:39], v5 offset:9216
    s_sleep 2
    buffer_load_dwordx2 v[40:41], v11, s[12:15], s49 offen sc1
    s_nop 15
    s_nop 7
    buffer_load_dwordx2 v[42:43], v11, s[12:15], s49 offen sc1
    s_nop 15
    s_nop 7
    buffer_load_dwordx2 v[44:45], v11, s[12:15], s49 offen sc1
    s_mov_b32 s70, 0
L_v_xp_31:
    s_waitcnt vmcnt(2)
    v_max_u32 v22, v40, v41
    v_cmp_eq_u32 vcc, -1, v22
    v_pk_add_f32 v[28:29], v[24:25], v[40:41]
    v_cvt_pk_bf16_f32 v28, v28, v29
    s_cbranch_vccz L_v_xp_31_ok
    buffer_load_dwordx2 v[40:41], v11, s[12:15], s49 offen sc1
    s_waitcnt vmcnt(2)
    v_max_u32 v22, v42, v43
    v_cmp_eq_u32 vcc, -1, v22
    v_pk_add_f32 v[28:29], v[24:25], v[42:43]
    v_cvt_pk_bf16_f32 v28, v28, v29
    s_cbranch_vccz L_v_xp_31_ok
    buffer_load_dwordx2 v[42:43], v11, s[12:15], s49 offen sc1
    s_waitcnt vmcnt(2)
    v_max_u32 v22, v44, v45
    v_cmp_eq_u32 vcc, -1, v22
    v_pk_add_f32 v[28:29], v[24:25], v[44:45]
    v_cvt_pk_bf16_f32 v28, v28, v29
    s_cbranch_vccz L_v_xp_31_ok
    buffer_load_dwordx2 v[44:45], v11, s[12:15], s49 offen sc1
    s_add_u32 s70, s70, 1
    s_cmp_lt_u32 s70, 0x100000
    s_cbranch_scc1 L_v_xp_31
    s_branch L_c_done_6
L_v_xp_31_ok:
    s_add_u32 s66, s66, 65536
    v_mov_b32_dpp v29, v28 quad_perm:[1,0,3,2] row_mask:0xf bank_mask:0xf
    v_perm_b32 v28, v28, v29, v9
    v_min_u32 v28, -2, v28
    s_cmp_eq_u32 s67, 1
    s_cbranch_scc0 L_ls_32_s
    buffer_store_dword v28, v12, s[12:15], s61 offen
L_ls_32_d:
    s_branch L_v_loop_24
L_v_fin_27:
L_c_done_6:
    s_endpgm
L_v_og_30_r0:
    buffer_load_dwordx4 v[40:43], v80, s[12:15], s62 offen sc1
    buffer_load_dwordx4 v[44:47], v81, s[12:15], s62 offen sc1
    buffer_load_dwordx4 v[48:51], v82, s[12:15], s62 offen sc1
    buffer_load_dwordx4 v[52:55], v83, s[12:15], s62 offen sc1
    buffer_load_dwordx4 v[56:59], v84, s[12:15], s62 offen sc1
    buffer_load_dwordx4 v[60:63], v85, s[12:15], s62 offen sc1
    s_add_u32 s70, s70, 1
    s_cmp_ge_u32 s70, 0x100000
    s_cbranch_scc1 L_c_done_6
    s_waitcnt vmcnt(5)
    v_max3_u32 v22, v40, v41, v42
    v_max_u32 v22, v22, v43
    v_cmp_eq_u32 vcc, -1, v22
    s_nop 1
    s_cbranch_vccnz L_v_og_30_r0
    s_branch L_v_og_30_c0
L_v_og_30_r1:
    buffer_load_dwordx4 v[44:47], v81, s[12:15], s62 offen sc1
    buffer_load_dwordx4 v[48:51], v82, s[12:15], s62 offen sc1
    buffer_load_dwordx4 v[52:55], v83, s[12:15], s62 offen sc1
    buffer_load_dwordx4 v[56:59], v84, s[12:15], s62 offen sc1
    buffer_load_dwordx4 v[60:63], v85, s[12:15], s62 offen sc1
    buffer_load_dwordx4 v[64:67], v86, s[12:15], s62 offen sc1
    s_add_u32 s70, s70, 1
    s_cmp_ge_u32 s70, 0x100000
    s_cbranch_scc1 L_c_done_6
    s_waitcnt vmcnt(5)
    v_max3_u32 v22, v44, v45, v46
    v_max_u32 v22, v22, v47
    v_cmp_eq_u32 vcc, -1, v22
    s_nop 1
    s_cbranch_vccnz L_v_og_30_r1
    s_branch L_v_og_30_c1
L_v_og_30_r2:
    buffer_load_dwordx4 v[48:51], v82, s[12:15], s62 offen sc1
    buffer_load_dwordx4 v[52:55], v83, s[12:15], s62 offen sc1
    buffer_load_dwordx4 v[56:59], v84, s[12:15], s62 offen sc1
    buffer_load_dwordx4 v[60:63], v85, s[12:15], s62 offen sc1
    buffer_load_dwordx4 v[64:67], v86, s[12:15], s62 offen sc1
    buffer_load_dwordx4 v[68:71], v87, s[12:15], s62 offen sc1
    s_add_u32 s70, s70, 1
    s_cmp_ge_u32 s70, 0x100000
    s_cbranch_scc1 L_c_done_6
    s_waitcnt vmcnt(5)
    v_max3_u32 v22, v48, v49, v50
    v_max_u32 v22, v22, v51
    v_cmp_eq_u32 vcc, -1, v22
    s_nop 1
    s_cbranch_vccnz L_v_og_30_r2
    s_branch L_v_og_30_c2
L_v_og_30_r3:
    buffer_load_dwordx4 v[52:55], v83, s[12:15], s62 offen sc1
    buffer_load_dwordx4 v[56:59], v84, s[12:15], s62 offen sc1
    buffer_load_dwordx4 v[60:63], v85, s[12:15], s62 offen sc1
    buffer_load_dwordx4 v[64:67], v86, s[12:15], s62 offen sc1
    buffer_load_dwordx4 v[68:71], v87, s[12:15], s62 offen sc1
    s_add_u32 s70, s70, 1
    s_cmp_ge_u32 s70, 0x100000
    s_cbranch_scc1 L_c_done_6
    s_waitcnt vmcnt(4)
    v_max3_u32 v22, v52, v53, v54
    v_max_u32 v22, v22, v55
    v_cmp_eq_u32 vcc, -1, v22
    s_nop 1
    s_cbranch_vccnz L_v_og_30_r3
    s_branch L_v_og_30_c3
L_v_og_30_r4:
    buffer_load_dwordx4 v[56:59], v84, s[12:15], s62 offen sc1
    buffer_load_dwordx4 v[60:63], v85, s[12:15], s62 offen sc1
    buffer_load_dwordx4 v[64:67], v86, s[12:15], s62 offen sc1
    buffer_load_dwordx4 v[68:71], v87, s[12:15], s62 offen sc1
    s_add_u32 s70, s70, 1
    s_cmp_ge_u32 s70, 0x100000
    s_cbranch_scc1 L_c_done_6
    s_waitcnt vmcnt(3)
    v_max3_u32 v22, v56, v57, v58
    v_max_u32 v22, v22, v59
    v_cmp_eq_u32 vcc, -1, v22
    s_nop 1
    s_cbranch_vccnz L_v_og_30_r4
    s_branch L_v_og_30_c4
L_v_og_30_r5:
    buffer_load_dwordx4 v[60:63], v85, s[12:15], s62 offen sc1
    buffer_load_dwordx4 v[64:67], v86, s[12:15], s62 offen sc1
    buffer_load_dwordx4 v[68:71], v87, s[12:15], s62 offen sc1
    s_add_u32 s70, s70, 1
    s_cmp_ge_u32 s70, 0x100000
    s_cbranch_scc1 L_c_done_6
    s_waitcnt vmcnt(2)
    v_max3_u32 v22, v60, v61, v62
    v_max_u32 v22, v22, v63
    v_cmp_eq_u32 vcc, -1, v22
    s_nop 1
    s_cbranch_vccnz L_v_og_30_r5
    s_branch L_v_og_30_c5
L_v_og_30_r6:
    buffer_load_dwordx4 v[64:67], v86, s[12:15], s62 offen sc1
    buffer_load_dwordx4 v[68:71], v87, s[12:15], s62 offen sc1
    s_add_u32 s70, s70, 1
    s_cmp_ge_u32 s70, 0x100000
    s_cbranch_scc1 L_c_done_6
    s_waitcnt vmcnt(1)
    v_max3_u32 v22, v64, v65, v66
    v_max_u32 v22, v22, v67
    v_cmp_eq_u32 vcc, -1, v22
    s_nop 1
    s_cbranch_vccnz L_v_og_30_r6
    s_branch L_v_og_30_c6
L_v_og_30_r7:
    buffer_load_dwordx4 v[68:71], v87, s[12:15], s62 offen sc1
    s_add_u32 s70, s70, 1
    s_cmp_ge_u32 s70, 0x100000
    s_cbranch_scc1 L_c_done_6
    s_waitcnt vmcnt(0)
    v_max3_u32 v22, v68, v69, v70
    v_max_u32 v22, v22, v71
    v_cmp_eq_u32 vcc, -1, v22
    s_nop 1
    s_cbranch_vccnz L_v_og_30_r7
    s_branch L_v_og_30_c7
L_ls_26_s:
    buffer_store_dwordx2 v[16:17], v10, s[12:15], s45 offen sc1
    buffer_store_dwordx2 v[14:15], v10, s[12:15], s46 offen sc1
    buffer_store_dword v14, v12, s[12:15], s47 offen sc1
    s_branch L_ls_26_d
L_ls_32_s:
    buffer_store_dword v28, v12, s[12:15], s61 offen sc1
    s_branch L_ls_32_d
.globl k4_xattn_kernel
.p2align 8
.type k4_xattn_kernel,@function
k4_xattn_kernel:
    s_cmp_ge_u32 s2, 512
    s_cbranch_scc1 L_x_done_33
    s_load_dwordx2 s[20:21], s[0:1], 128
    v_and_b32 v1, 63, v0
    v_lshrrev_b32 v2, 6, v0
    s_nop 0
    v_readfirstlane_b32 s44, v2
    s_lshl_b32 s40, s2, 2
    s_add_u32 s40, s40, s44
    s_lshr_b32 s41, s40, 5
    s_and_b32 s42, s40, 31
    s_waitcnt lgkmcnt(0)
    s_add_u32 s8, s20, 0x2000000
    s_addc_u32 s9, s21, 0
    s_and_b32 s9, s9, 0xffff
    s_mov_b32 s10, 0x3000000
    s_mov_b32 s11, 0x00020000
    s_add_u32 s12, s20, 0x1000000
    s_addc_u32 s13, s21, 0
    s_and_b32 s13, s13, 0xffff
    s_mov_b32 s14, 0xc00000
    s_mov_b32 s15, 0x00020000
    s_add_u32 s16, s20, 0x5000000
    s_addc_u32 s17, s21, 0
    s_and_b32 s17, s17, 0xffff
    s_mov_b32 s18, 0x1000000
    s_mov_b32 s19, 0x00020000
    s_mul_i32 s45, s41, 786432
    s_lshl_b32 s46, s42, 8
    s_add_u32 s45, s45, s46
    s_lshl_b32 s47, s41, 17
    s_lshl_b32 s46, s42, 12
    s_add_u32 s47, s47, s46
    v_and_b32 v3, 15, v1
    s_mov_b32 s46, 24576
    v_mul_lo_u32 v3, v3, s46
    v_lshrrev_b32 v4, 4, v1
    v_lshlrev_b32 v4, 4, v4
    v_add_u32 v3, v3, v4
    v_add_u32 v5, 393216, v3
    v_lshlrev_b32 v6, 4, v1
    s_add_u32 s48, s45, 8192
    s_add_u32 s49, s45, 16384
    buffer_load_dwordx4 v[16:19], v3, s[8:11], s45 offen offset:0
    buffer_load_dwordx4 v[20:23], v3, s[8:11], s45 offen offset:64
    buffer_load_dwordx4 v[24:27], v3, s[8:11], s45 offen offset:128
    buffer_load_dwordx4 v[28:31], v3, s[8:11], s45 offen offset:192
    buffer_load_dwordx4 v[32:35], v5, s[8:11], s45 offen offset:0
    buffer_load_dwordx4 v[36:39], v5, s[8:11], s45 offen offset:64
    buffer_load_dwordx4 v[40:43], v5, s[8:11], s45 offen offset:128
    buffer_load_dwordx4 v[44:47], v5, s[8:11], s45 offen offset:192
    buffer_load_dwordx4 v[48:51], v3, s[8:11], s48 offen offset:0
    buffer_load_dwordx4 v[52:55], v3, s[8:11], s48 offen offset:64
    buffer_load_dwordx4 v[56:59], v3, s[8:11], s48 offen offset:128
    buffer_load_dwordx4 v[60:63], v3, s[8:11], s48 offen offset:192
    buffer_load_dwordx4 v[64:67], v5, s[8:11], s48 offen offset:0
    buffer_load_dwordx4 v[68:71], v5, s[8:11], s48 offen offset:64
    buffer_load_dwordx4 v[72:75], v5, s[8:11], s48 offen offset:128
    buffer_load_dwordx4 v[76:79], v5, s[8:11], s48 offen offset:192
    buffer_load_dwordx4 v[80:83], v6, s[12:15], s47 offen offset:0
    buffer_load_dwordx4 v[84:87], v6, s[12:15], s47 offen offset:1024
    buffer_load_dwordx4 v[88:91], v6, s[12:15], s47 offen offset:2048
    buffer_load_dwordx4 v[92:95], v6, s[12:15], s47 offen offset:3072
    v_lshrrev_b32 v7, 4, v1
    v_mul_lo_u32 v8, v7, s46
    v_and_b32 v9, 15, v1
    v_lshlrev_b32 v9, 4, v9
    v_add_u32 v8, v8, v9
    v_mul_u32_u24 v10, 272, v7
    v_add_u32 v10, v10, v9
    s_mul_i32 s50, s44, 13056
    v_add_u32 v10, s50, v10
    v_lshlrev_b32 v11, 3, v1
    s_lshr_b32 s51, s47, 1
    s_add_u32 s51, s51, 0x800000
    s_add_u32 s52, s49, 0
    buffer_load_dwordx4 v[96:99], v8, s[8:11], s52 offen
    s_add_u32 s52, s49, 98304
    buffer_load_dwordx4 v[100:103], v8, s[8:11], s52 offen
    s_add_u32 s52, s49, 196608
    buffer_load_dwordx4 v[104:107], v8, s[8:11], s52 offen
    s_add_u32 s52, s49, 294912
    buffer_load_dwordx4 v[108:111], v8, s[8:11], s52 offen
    s_add_u32 s52, s49, 393216
    buffer_load_dwordx4 v[112:115], v8, s[8:11], s52 offen
    s_add_u32 s52, s49, 491520
    buffer_load_dwordx4 v[116:119], v8, s[8:11], s52 offen
    s_add_u32 s52, s49, 589824
    buffer_load_dwordx4 v[120:123], v8, s[8:11], s52 offen
    s_add_u32 s52, s49, 688128
    buffer_load_dwordx4 v[124:127], v8, s[8:11], s52 offen
    buffer_load_dwordx2 v[160:161], v11, s[12:15], s51 offen offset:0
    buffer_load_dwordx2 v[162:163], v11, s[12:15], s51 offen offset:512
    buffer_load_dwordx2 v[164:165], v11, s[12:15], s51 offen offset:1024
    buffer_load_dwordx2 v[166:167], v11, s[12:15], s51 offen offset:1536
    s_waitcnt vmcnt(0)
    ds_write_b128 v10, v[96:99] offset:0
    ds_write_b128 v10, v[100:103] offset:1088
    ds_write_b128 v10, v[104:107] offset:2176
    ds_write_b128 v10, v[108:111] offset:3264
    ds_write_b128 v10, v[112:115] offset:4352
    ds_write_b128 v10, v[116:119] offset:5440
    ds_write_b128 v10, v[120:123] offset:6528
    ds_write_b128 v10, v[124:127] offset:7616
    v_mov_b32 v96, 0
    v_mov_b32 v97, 0
    v_mov_b32 v98, 0
    v_mov_b32 v99, 0
    v_mov_b32 v100, 0
    v_mov_b32 v101, 0
    v_mov_b32 v102, 0
    v_mov_b32 v103, 0
    v_mov_b32 v104, 0
    v_mov_b32 v105, 0
    v_mov_b32 v106, 0
    v_mov_b32 v107, 0
    v_mov_b32 v108, 0
    v_mov_b32 v109, 0
    v_mov_b32 v110, 0
    v_mov_b32 v111, 0
    v_mov_b32 v112, 0
    v_mov_b32 v113, 0
    v_mov_b32 v114, 0
    v_mov_b32 v115, 0
    v_mov_b32 v116, 0
    v_mov_b32 v117, 0
    v_mov_b32 v118, 0
    v_mov_b32 v119, 0
    s_nop 1
    v_mfma_f32_16x16x32_bf16 v[96:99], v[48:51], v[16:19], v[96:99]
    v_mfma_f32_16x16x32_bf16 v[100:103], v[48:51], v[32:35], v[100:103]
    v_mfma_f32_16x16x32_bf16 v[108:111], v[64:67], v[32:35], v[108:111]
    v_mfma_f32_16x16x32_bf16 v[112:115], v[80:83], v[16:19], v[112:115]
    v_mfma_f32_16x16x32_bf16 v[116:119], v[80:83], v[32:35], v[116:119]
    v_mfma_f32_16x16x32_bf16 v[96:99], v[52:55], v[20:23], v[96:99]
    v_mfma_f32_16x16x32_bf16 v[100:103], v[52:55], v[36:39], v[100:103]
    v_mfma_f32_16x16x32_bf16 v[108:111], v[68:71], v[36:39], v[108:111]
    v_mfma_f32_16x16x32_bf16 v[112:115], v[84:87], v[20:23], v[112:115]
    v_mfma_f32_16x16x32_bf16 v[116:119], v[84:87], v[36:39], v[116:119]
    v_mfma_f32_16x16x32_bf16 v[96:99], v[56:59], v[24:27], v[96:99]
    v_mfma_f32_16x16x32_bf16 v[100:103], v[56:59], v[40:43], v[100:103]
    v_mfma_f32_16x16x32_bf16 v[108:111], v[72:75], v[40:43], v[108:111]
    v_mfma_f32_16x16x32_bf16 v[112:115], v[88:91], v[24:27], v[112:115]
    v_mfma_f32_16x16x32_bf16 v[116:119], v[88:91], v[40:43], v[116:119]
    v_mfma_f32_16x16x32_bf16 v[96:99], v[60:63], v[28:31], v[96:99]
    v_mfma_f32_16x16x32_bf16 v[100:103], v[60:63], v[44:47], v[100:103]
    v_mfma_f32_16x16x32_bf16 v[108:111], v[76:79], v[44:47], v[108:111]
    v_mfma_f32_16x16x32_bf16 v[112:115], v[92:95], v[28:31], v[112:115]
    v_mfma_f32_16x16x32_bf16 v[116:119], v[92:95], v[44:47], v[116:119]
    s_waitcnt lgkmcnt(0)
    v_lshrrev_b32 v12, 4, v1
    v_lshlrev_b32 v12, 2, v12
    v_and_b32 v13, 15, v1
    v_mov_b32 v14, 0xff800000
    v_cmp_le_u32 s[52:53], 32, v1
    v_xor_b32 v15, 16, v1
    v_lshlrev_b32 v15, 2, v15
    v_xor_b32 v2, 32, v1
    v_lshlrev_b32 v2, 2, v2
    s_nop 4
    v_add_u32 v120, 0, v12
    v_cmp_gt_u32 vcc, v120, v13
    s_nop 1
    v_cndmask_b32 v96, v96, v14, vcc
    v_cndmask_b32 v108, v108, v14, vcc
    v_add_u32 v120, 1, v12
    v_cmp_gt_u32 vcc, v120, v13
    s_nop 1
    v_cndmask_b32 v97, v97, v14, vcc
    v_cndmask_b32 v109, v109, v14, vcc
    v_add_u32 v120, 2, v12
    v_cmp_gt_u32 vcc, v120, v13
    s_nop 1
    v_cndmask_b32 v98, v98, v14, vcc
    v_cndmask_b32 v110, v110, v14, vcc
    v_add_u32 v120, 3, v12
    v_cmp_gt_u32 vcc, v120, v13
    s_nop 1
    v_cndmask_b32 v99, v99, v14, vcc
    v_cndmask_b32 v111, v111, v14, vcc
    v_permlane32_swap_b32 v112, v114
    v_permlane32_swap_b32 v113, v115
    v_pk_add_f32 v[112:113], v[112:113], v[114:115]
    v_permlane32_swap_b32 v116, v118
    v_permlane32_swap_b32 v117, v119
    v_pk_add_f32 v[116:117], v[116:117], v[118:119]
    v_lshrrev_b32 v12, 4, v1
    v_lshlrev_b32 v12, 2, v12
    v_bfe_u32 v13, v1, 2, 2
    v_add_u32 v12, v12, v13
    v_mul_u32_u24 v12, 272, v12
    v_and_b32 v13, 3, v1
    v_lshlrev_b32 v13, 3, v13
    v_add_u32 v12, v12, v13
    v_add_u32 v12, s50, v12
    ds_read_b64_tr_b16 v[16:17], v12 offset:0
    ds_read_b64_tr_b16 v[18:19], v12 offset:4352
    ds_read_b64_tr_b16 v[22:23], v12 offset:32
    ds_read_b64_tr_b16 v[24:25], v12 offset:4384
    ds_read_b64_tr_b16 v[28:29], v12 offset:64
    ds_read_b64_tr_b16 v[30:31], v12 offset:4416
    ds_read_b64_tr_b16 v[34:35], v12 offset:96
    ds_read_b64_tr_b16 v[36:37], v12 offset:4448
    ds_read_b64_tr_b16 v[40:41], v12 offset:128
    ds_read_b64_tr_b16 v[42:43], v12 offset:4480
    ds_read_b64_tr_b16 v[46:47], v12 offset:160
    ds_read_b64_tr_b16 v[48:49], v12 offset:4512
    ds_read_b64_tr_b16 v[52:53], v12 offset:192
    ds_read_b64_tr_b16 v[54:55], v12 offset:4544
    ds_read_b64_tr_b16 v[58:59], v12 offset:224
    ds_read_b64_tr_b16 v[60:61], v12 offset:4576
    s_mov_b32 s54, 0x3e0293ee
    v_max_f32 v120, v96, v97
    v_max3_f32 v120, v120, v98, v99
    v_max3_f32 v120, v120, v112, v113
    ds_bpermute_b32 v121, v15, v120
    s_waitcnt lgkmcnt(0)
    v_max_f32 v120, v120, v121
    ds_bpermute_b32 v121, v2, v120
    s_waitcnt lgkmcnt(0)
    v_max_f32 v120, v120, v121
    v_mul_f32 v120, s54, v120
    v_fma_f32 v96, v96, s54, -v120
    v_exp_f32 v96, v96
    v_fma_f32 v97, v97, s54, -v120
    v_exp_f32 v97, v97
    v_fma_f32 v98, v98, s54, -v120
    v_exp_f32 v98, v98
    v_fma_f32 v99, v99, s54, -v120
    v_exp_f32 v99, v99
    v_fma_f32 v112, v112, s54, -v120
    v_exp_f32 v112, v112
    v_fma_f32 v113, v113, s54, -v120
    v_exp_f32 v113, v113
    s_nop 0
    v_add_f32 v121, v96, v97
    v_add_f32 v121, v121, v98
    v_add_f32 v121, v121, v99
    v_add_f32 v121, v121, v112
    v_add_f32 v121, v121, v113
    ds_bpermute_b32 v122, v15, v121
    s_waitcnt lgkmcnt(0)
    v_add_f32 v121, v121, v122
    ds_bpermute_b32 v122, v2, v121
    s_waitcnt lgkmcnt(0)
    v_add_f32 v121, v121, v122
    v_rcp_f32 v121, v121
    s_nop 0
    v_mul_f32 v96, v96, v121
    v_mul_f32 v97, v97, v121
    v_mul_f32 v98, v98, v121
    v_mul_f32 v99, v99, v121
    v_mul_f32 v112, v112, v121
    v_mul_f32 v113, v113, v121
    v_cvt_pk_bf16_f32 v64, v96, v97
    v_cvt_pk_bf16_f32 v65, v98, v99
    v_cvt_pk_bf16_f32 v68, v112, v113
    v_mov_b32 v69, 0
    v_mov_b32 v70, 0
    v_cvt_pk_bf16_f32 v71, v112, v113
    v_max_f32 v120, v100, v101
    v_max3_f32 v120, v120, v102, v103
    v_max3_f32 v120, v120, v108, v109
    v_max3_f32 v120, v120, v110, v111
    v_max3_f32 v120, v120, v116, v117
    ds_bpermute_b32 v121, v15, v120
    s_waitcnt lgkmcnt(0)
    v_max_f32 v120, v120, v121
    ds_bpermute_b32 v121, v2, v120
    s_waitcnt lgkmcnt(0)
    v_max_f32 v120, v120, v121
    v_mul_f32 v120, s54, v120
    v_fma_f32 v100, v100, s54, -v120
    v_exp_f32 v100, v100
    v_fma_f32 v101, v101, s54, -v120
    v_exp_f32 v101, v101
    v_fma_f32 v102, v102, s54, -v120
    v_exp_f32 v102, v102
    v_fma_f32 v103, v103, s54, -v120
    v_exp_f32 v103, v103
    v_fma_f32 v108, v108, s54, -v120
    v_exp_f32 v108, v108
    v_fma_f32 v109, v109, s54, -v120
    v_exp_f32 v109, v109
    v_fma_f32 v110, v110, s54, -v120
    v_exp_f32 v110, v110
    v_fma_f32 v111, v111, s54, -v120
    v_exp_f32 v111, v111
    v_fma_f32 v116, v116, s54, -v120
    v_exp_f32 v116, v116
    v_fma_f32 v117, v117, s54, -v120
    v_exp_f32 v117, v117
    s_nop 0
    v_add_f32 v121, v100, v101
    v_add_f32 v121, v121, v102
    v_add_f32 v121, v121, v103
    v_add_f32 v121, v121, v108
    v_add_f32 v121, v121, v109
    v_add_f32 v121, v121, v110
    v_add_f32 v121, v121, v111
    v_add_f32 v121, v121, v116
    v_add_f32 v121, v121, v117
    ds_bpermute_b32 v122, v15, v121
    s_waitcnt lgkmcnt(0)
    v_add_f32 v121, v121, v122
    ds_bpermute_b32 v122, v2, v121
    s_waitcnt lgkmcnt(0)
    v_add_f32 v121, v121, v122
    v_rcp_f32 v121, v121
    s_nop 0
    v_mul_f32 v100, v100, v121
    v_mul_f32 v101, v101, v121
    v_mul_f32 v102, v102, v121
    v_mul_f32 v103, v103, v121
    v_mul_f32 v108, v108, v121
    v_mul_f32 v109, v109, v121
    v_mul_f32 v110, v110, v121
    v_mul_f32 v111, v111, v121
    v_mul_f32 v116, v116, v121
    v_mul_f32 v117, v117, v121
    v_cvt_pk_bf16_f32 v72, v100, v101
    v_cvt_pk_bf16_f32 v73, v102, v103
    v_cvt_pk_bf16_f32 v74, v108, v109
    v_cvt_pk_bf16_f32 v75, v110, v111
    v_cvt_pk_bf16_f32 v76, v116, v117
    v_mov_b32 v77, 0
    v_mov_b32 v78, 0
    v_cvt_pk_bf16_f32 v79, v116, v117
    v_mov_b32 v96, 0
    v_mov_b32 v97, 0
    v_mov_b32 v98, 0
    v_mov_b32 v99, 0
    v_mov_b32 v100, 0
    v_mov_b32 v101, 0
    v_mov_b32 v102, 0
    v_mov_b32 v103, 0
    v_mov_b32 v104, 0
    v_mov_b32 v105, 0
    v_mov_b32 v106, 0
    v_mov_b32 v107, 0
    v_mov_b32 v108, 0
    v_mov_b32 v109, 0
    v_mov_b32 v110, 0
    v_mov_b32 v111, 0
    v_mov_b32 v112, 0
    v_mov_b32 v113, 0
    v_mov_b32 v114, 0
    v_mov_b32 v115, 0
    v_mov_b32 v116, 0
    v_mov_b32 v117, 0
    v_mov_b32 v118, 0
    v_mov_b32 v119, 0
    v_mov_b32 v120, 0
    v_mov_b32 v121, 0
    v_mov_b32 v122, 0
    v_mov_b32 v123, 0
    v_mov_b32 v124, 0
    v_mov_b32 v125, 0
    v_mov_b32 v126, 0
    v_mov_b32 v127, 0
    v_mov_b32 v128, 0
    v_mov_b32 v129, 0
    v_mov_b32 v130, 0
    v_mov_b32 v131, 0
    v_mov_b32 v132, 0
    v_mov_b32 v133, 0
    v_mov_b32 v134, 0
    v_mov_b32 v135, 0
    v_mov_b32 v136, 0
    v_mov_b32 v137, 0
    v_mov_b32 v138, 0
    v_mov_b32 v139, 0
    v_mov_b32 v140, 0
    v_mov_b32 v141, 0
    v_mov_b32 v142, 0
    v_mov_b32 v143, 0
    v_mov_b32 v144, 0
    v_mov_b32 v145, 0
    v_mov_b32 v146, 0
    v_mov_b32 v147, 0
    v_mov_b32 v148, 0
    v_mov_b32 v149, 0
    v_mov_b32 v150, 0
    v_mov_b32 v151, 0
    v_mov_b32 v152, 0
    v_mov_b32 v153, 0
    v_mov_b32 v154, 0
    v_mov_b32 v155, 0
    v_mov_b32 v156, 0
    v_mov_b32 v157, 0
    v_mov_b32 v158, 0
    v_mov_b32 v159, 0
    s_nop 1
    v_mfma_f32_16x16x16_bf16 v[96:99], v[16:17], v[64:65], v[96:99]
    v_mfma_f32_16x16x16_bf16 v[100:103], v[22:23], v[64:65], v[100:103]
    v_mfma_f32_16x16x16_bf16 v[104:107], v[28:29], v[64:65], v[104:107]
    v_mfma_f32_16x16x16_bf16 v[108:111], v[34:35], v[64:65], v[108:111]
    v_mfma_f32_16x16x16_bf16 v[112:115], v[40:41], v[64:65], v[112:115]
    v_mfma_f32_16x16x16_bf16 v[116:119], v[46:47], v[64:65], v[116:119]
    v_mfma_f32_16x16x16_bf16 v[120:123], v[52:53], v[64:65], v[120:123]
    v_mfma_f32_16x16x16_bf16 v[124:127], v[58:59], v[64:65], v[124:127]
    v_mfma_f32_16x16x16_bf16 v[96:99], v[160:161], v[68:69], v[96:99]
    v_mfma_f32_16x16x16_bf16 v[100:103], v[160:161], v[70:71], v[100:103]
    v_mfma_f32_16x16x16_bf16 v[104:107], v[162:163], v[68:69], v[104:107]
    v_mfma_f32_16x16x16_bf16 v[108:111], v[162:163], v[70:71], v[108:111]
    v_mfma_f32_16x16x16_bf16 v[112:115], v[164:165], v[68:69], v[112:115]
    v_mfma_f32_16x16x16_bf16 v[116:119], v[164:165], v[70:71], v[116:119]
    v_mfma_f32_16x16x16_bf16 v[120:123], v[166:167], v[68:69], v[120:123]
    v_mfma_f32_16x16x16_bf16 v[124:127], v[166:167], v[70:71], v[124:127]
    v_mfma_f32_16x16x16_bf16 v[128:131], v[16:17], v[72:73], v[128:131]
    v_mfma_f32_16x16x16_bf16 v[132:135], v[22:23], v[72:73], v[132:135]
    v_mfma_f32_16x16x16_bf16 v[136:139], v[28:29], v[72:73], v[136:139]
    v_mfma_f32_16x16x16_bf16 v[140:143], v[34:35], v[72:73], v[140:143]
    v_mfma_f32_16x16x16_bf16 v[144:147], v[40:41], v[72:73], v[144:147]
    v_mfma_f32_16x16x16_bf16 v[148:151], v[46:47], v[72:73], v[148:151]
    v_mfma_f32_16x16x16_bf16 v[152:155], v[52:53], v[72:73], v[152:155]
    v_mfma_f32_16x16x16_bf16 v[156:159], v[58:59], v[72:73], v[156:159]
    v_mfma_f32_16x16x16_bf16 v[128:131], v[18:19], v[74:75], v[128:131]
    v_mfma_f32_16x16x16_bf16 v[132:135], v[24:25], v[74:75], v[132:135]
    v_mfma_f32_16x16x16_bf16 v[136:139], v[30:31], v[74:75], v[136:139]
    v_mfma_f32_16x16x16_bf16 v[140:143], v[36:37], v[74:75], v[140:143]
    v_mfma_f32_16x16x16_bf16 v[144:147], v[42:43], v[74:75], v[144:147]
    v_mfma_f32_16x16x16_bf16 v[148:151], v[48:49], v[74:75], v[148:151]
    v_mfma_f32_16x16x16_bf16 v[152:155], v[54:55], v[74:75], v[152:155]
    v_mfma_f32_16x16x16_bf16 v[156:159], v[60:61], v[74:75], v[156:159]
    v_mfma_f32_16x16x16_bf16 v[128:131], v[160:161], v[76:77], v[128:131]
    v_mfma_f32_16x16x16_bf16 v[132:135], v[160:161], v[78:79], v[132:135]
    v_mfma_f32_16x16x16_bf16 v[136:139], v[162:163], v[76:77], v[136:139]
    v_mfma_f32_16x16x16_bf16 v[140:143], v[162:163], v[78:79], v[140:143]
    v_mfma_f32_16x16x16_bf16 v[144:147], v[164:165], v[76:77], v[144:147]
    v_mfma_f32_16x16x16_bf16 v[148:151], v[164:165], v[78:79], v[148:151]
    v_mfma_f32_16x16x16_bf16 v[152:155], v[166:167], v[76:77], v[152:155]
    v_mfma_f32_16x16x16_bf16 v[156:159], v[166:167], v[78:79], v[156:159]
    v_and_b32 v3, 15, v1
    v_lshlrev_b32 v3, 13, v3
    v_lshrrev_b32 v4, 4, v1
    v_lshlrev_b32 v4, 3, v4
    v_add_u32 v3, v3, v4
    s_lshl_b32 s45, s41, 18
    s_lshl_b32 s46, s42, 8
    s_add_u32 s45, s45, s46
    s_add_u32 s46, s45, 131072
    s_nop 7
    v_cvt_pk_bf16_f32 v96, v96, v97
    v_cvt_pk_bf16_f32 v97, v98, v99
    buffer_store_dwordx2 v[96:97], v3, s[16:19], s45 offen offset:0
    v_cvt_pk_bf16_f32 v100, v100, v101
    v_cvt_pk_bf16_f32 v101, v102, v103
    buffer_store_dwordx2 v[100:101], v3, s[16:19], s45 offen offset:32
    v_cvt_pk_bf16_f32 v104, v104, v105
    v_cvt_pk_bf16_f32 v105, v106, v107
    buffer_store_dwordx2 v[104:105], v3, s[16:19], s45 offen offset:64
    v_cvt_pk_bf16_f32 v108, v108, v109
    v_cvt_pk_bf16_f32 v109, v110, v111
    buffer_store_dwordx2 v[108:109], v3, s[16:19], s45 offen offset:96
    v_cvt_pk_bf16_f32 v112, v112, v113
    v_cvt_pk_bf16_f32 v113, v114, v115
    buffer_store_dwordx2 v[112:113], v3, s[16:19], s45 offen offset:128
    v_cvt_pk_bf16_f32 v116, v116, v117
    v_cvt_pk_bf16_f32 v117, v118, v119
    buffer_store_dwordx2 v[116:117], v3, s[16:19], s45 offen offset:160
    v_cvt_pk_bf16_f32 v120, v120, v121
    v_cvt_pk_bf16_f32 v121, v122, v123
    buffer_store_dwordx2 v[120:121], v3, s[16:19], s45 offen offset:192
    v_cvt_pk_bf16_f32 v124, v124, v125
    v_cvt_pk_bf16_f32 v125, v126, v127
    buffer_store_dwordx2 v[124:125], v3, s[16:19], s45 offen offset:224
    v_cvt_pk_bf16_f32 v128, v128, v129
    v_cvt_pk_bf16_f32 v129, v130, v131
    buffer_store_dwordx2 v[128:129], v3, s[16:19], s46 offen offset:0
    v_cvt_pk_bf16_f32 v132, v132, v133
    v_cvt_pk_bf16_f32 v133, v134, v135
    buffer_store_dwordx2 v[132:133], v3, s[16:19], s46 offen offset:32
    v_cvt_pk_bf16_f32 v136, v136, v137
    v_cvt_pk_bf16_f32 v137, v138, v139
    buffer_store_dwordx2 v[136:137], v3, s[16:19], s46 offen offset:64
    v_cvt_pk_bf16_f32 v140, v140, v141
    v_cvt_pk_bf16_f32 v141, v142, v143
    buffer_store_dwordx2 v[140:141], v3, s[16:19], s46 offen offset:96
    v_cvt_pk_bf16_f32 v144, v144, v145
    v_cvt_pk_bf16_f32 v145, v146, v147
    buffer_store_dwordx2 v[144:145], v3, s[16:19], s46 offen offset:128
    v_cvt_pk_bf16_f32 v148, v148, v149
    v_cvt_pk_bf16_f32 v149, v150, v151
    buffer_store_dwordx2 v[148:149], v3, s[16:19], s46 offen offset:160
    v_cvt_pk_bf16_f32 v152, v152, v153
    v_cvt_pk_bf16_f32 v153, v154, v155
    buffer_store_dwordx2 v[152:153], v3, s[16:19], s46 offen offset:192
    v_cvt_pk_bf16_f32 v156, v156, v157
    v_cvt_pk_bf16_f32 v157, v158, v159
    buffer_store_dwordx2 v[156:157], v3, s[16:19], s46 offen offset:224
L_x_done_33:
    s_endpgm
.globl k5_wo_kernel
.p2align 8
.type k5_wo_kernel,@function
k5_wo_kernel:
    s_cmp_ge_u32 s2, 256
    s_cbranch_scc1 L_g_done_34
    s_load_dwordx2 s[20:21], s[0:1], 128
    s_and_b32 s42, s2, 7
    s_lshr_b32 s43, s2, 3
    s_and_b32 s40, s43, 1
    s_lshl_b32 s42, s42, 1
    s_add_u32 s40, s40, s42
    s_lshr_b32 s41, s43, 1
    s_load_dwordx2 s[6:7], s[0:1], 40
    s_mov_b32 s43, s41
    s_load_dwordx2 s[4:5], s[0:1], 0
    v_and_b32 v1, 63, v0
    v_lshrrev_b32 v2, 6, v0
    s_nop 0
    v_readfirstlane_b32 s44, v2
    s_waitcnt lgkmcnt(0)
    s_add_u32 s8, s20, 0x5000000
    s_addc_u32 s9, s21, 0
    s_and_b32 s9, s9, 0xffff
    s_mov_b32 s10, 0x1000000
    s_mov_b32 s11, 0x00020000
    s_mov_b32 s12, s6
    s_and_b32 s13, s7, 0xffff
    s_mov_b32 s14, 0x800000
    s_mov_b32 s15, 0x00020000
    s_add_u32 s16, s20, 0x800000
    s_addc_u32 s17, s21, 0
    s_and_b32 s17, s17, 0xffff
    s_mov_b32 s18, 0x400000
    s_mov_b32 s19, 0x00020000
    v_lshrrev_b32 v3, 2, v1
    s_lshl_b32 s45, s44, 5
    v_add_u32 v3, s45, v3
    v_and_b32 v4, 3, v1
    s_lshl_b32 s46, s40, 7
    s_mov_b32 s47, 8192
    v_add_u32 v5, 0, v3
    v_lshrrev_b32 v6, 2, v5
    v_and_b32 v6, 3, v6
    v_xor_b32 v6, v6, v4
    v_lshlrev_b32 v6, 4, v6
    v_add_u32 v5, s46, v5
    v_mul_lo_u32 v5, v5, s47
    v_add_u32 v10, v5, v6
    v_add_u32 v5, 16, v3
    v_lshrrev_b32 v6, 2, v5
    v_and_b32 v6, 3, v6
    v_xor_b32 v6, v6, v4
    v_lshlrev_b32 v6, 4, v6
    v_add_u32 v5, s46, v5
    v_mul_lo_u32 v5, v5, s47
    v_add_u32 v11, v5, v6
    v_lshrrev_b32 v3, 3, v1
    s_mul_i32 s45, s44, 8
    v_add_u32 v3, s45, v3
    v_and_b32 v4, 7, v1
    s_lshl_b32 s46, s43, 7
    s_mov_b32 s47, 2048
    v_add_u32 v5, 0, v3
    v_and_b32 v6, 2, v5
    v_lshlrev_b32 v6, 1, v6
    v_xor_b32 v6, v6, v4
    v_lshlrev_b32 v6, 4, v6
    v_mul_lo_u32 v5, v5, s47
    v_add_u32 v5, s46, v5
    v_add_u32 v14, v5, v6
    s_lshr_b32 s48, s44, 1
    s_and_b32 s49, s44, 1
    v_and_b32 v3, 31, v1
    s_lshl_b32 s45, s48, 6
    v_add_u32 v3, s45, v3
    v_lshrrev_b32 v4, 2, v3
    v_and_b32 v4, 3, v4
    v_lshrrev_b32 v5, 5, v1
    v_lshlrev_b32 v3, 6, v3
    v_add_u32 v6, 0, v5
    v_xor_b32 v6, v6, v4
    v_lshlrev_b32 v6, 4, v6
    v_add_u32 v18, v3, v6
    v_add_u32 v6, 2, v5
    v_xor_b32 v6, v6, v4
    v_lshlrev_b32 v6, 4, v6
    v_add_u32 v19, v3, v6
    v_lshrrev_b32 v3, 5, v1
    v_lshlrev_b32 v3, 3, v3
    v_bfe_u32 v4, v1, 2, 2
    v_add_u32 v3, v3, v4
    v_bfe_u32 v5, v1, 4, 1
    v_lshlrev_b32 v5, 4, v5
    v_and_b32 v6, 3, v1
    v_lshlrev_b32 v6, 2, v6
    v_add_u32 v5, v5, v6
    s_mul_i32 s45, s49, 32
    v_add_u32 v5, s45, v5
    v_and_b32 v7, 2, v4
    v_lshlrev_b32 v7, 1, v7
    v_mul_u32_u24 v3, 128, v3
    v_add_u32 v6, 0, v5
    v_lshrrev_b32 v8, 3, v6
    v_xor_b32 v8, v8, v7
    v_lshlrev_b32 v8, 4, v8
    v_and_b32 v6, 4, v6
    v_lshlrev_b32 v6, 1, v6
    v_add_u32 v8, v8, v6
    v_add_u32 v22, v3, v8
    v_mov_b32 v64, 0
    v_mov_b32 v65, 0
    v_mov_b32 v66, 0
    v_mov_b32 v67, 0
    v_mov_b32 v68, 0
    v_mov_b32 v69, 0
    v_mov_b32 v70, 0
    v_mov_b32 v71, 0
    v_mov_b32 v72, 0
    v_mov_b32 v73, 0
    v_mov_b32 v74, 0
    v_mov_b32 v75, 0
    v_mov_b32 v76, 0
    v_mov_b32 v77, 0
    v_mov_b32 v78, 0
    v_mov_b32 v79, 0
    v_mov_b32 v80, 0
    v_mov_b32 v81, 0
    v_mov_b32 v82, 0
    v_mov_b32 v83, 0
    v_mov_b32 v84, 0
    v_mov_b32 v85, 0
    v_mov_b32 v86, 0
    v_mov_b32 v87, 0
    v_mov_b32 v88, 0
    v_mov_b32 v89, 0
    v_mov_b32 v90, 0
    v_mov_b32 v91, 0
    v_mov_b32 v92, 0
    v_mov_b32 v93, 0
    v_mov_b32 v94, 0
    v_mov_b32 v95, 0
    s_mov_b32 s50, 0
    s_mov_b32 s51, 0
    s_lshl_b32 s52, s44, 11
    s_mul_i32 s53, s44, 1024
    s_add_u32 s53, s53, 8192
    s_add_u32 m0, s52, 0
    s_nop 0
    buffer_load_dwordx4 v10, s[8:11], s50 offen lds
    s_add_u32 m0, s52, 1024
    s_nop 0
    buffer_load_dwordx4 v11, s[8:11], s50 offen lds
    s_add_u32 m0, s53, 0
    s_nop 0
    buffer_load_dwordx4 v14, s[12:15], s51 offen lds
    s_add_u32 s50, s50, 64
    s_add_u32 s51, s51, 65536
    s_add_u32 m0, s52, 12288
    s_nop 0
    buffer_load_dwordx4 v10, s[8:11], s50 offen lds
    s_add_u32 m0, s52, 13312
    s_nop 0
    buffer_load_dwordx4 v11, s[8:11], s50 offen lds
    s_add_u32 m0, s53, 12288
    s_nop 0
    buffer_load_dwordx4 v14, s[12:15], s51 offen lds
    s_add_u32 s50, s50, 64
    s_add_u32 s51, s51, 65536
    s_add_u32 m0, s52, 24576
    s_nop 0
    buffer_load_dwordx4 v10, s[8:11], s50 offen lds
    s_add_u32 m0, s52, 25600
    s_nop 0
    buffer_load_dwordx4 v11, s[8:11], s50 offen lds
    s_add_u32 m0, s53, 24576
    s_nop 0
    buffer_load_dwordx4 v14, s[12:15], s51 offen lds
    s_add_u32 s50, s50, 64
    s_add_u32 s51, s51, 65536
    s_mov_b32 s54, 0
L_g_loop_35:
    s_waitcnt vmcnt(6)
    s_barrier
    ds_read_b128 v[26:29], v18 offset:0
    ds_read_b128 v[30:33], v18 offset:2048
    ds_read_b64_tr_b16 v[34:35], v22 offset:8192
    ds_read_b64_tr_b16 v[36:37], v22 offset:8704
    ds_read_b128 v[38:41], v19 offset:0
    ds_read_b128 v[42:45], v19 offset:2048
    ds_read_b64_tr_b16 v[46:47], v22 offset:10240
    ds_read_b64_tr_b16 v[48:49], v22 offset:10752
    s_add_u32 m0, s52, 36864
    s_nop 0
    buffer_load_dwordx4 v10, s[8:11], s50 offen lds
    s_add_u32 m0, s52, 37888
    s_nop 0
    buffer_load_dwordx4 v11, s[8:11], s50 offen lds
    s_add_u32 m0, s53, 36864
    s_nop 0
    buffer_load_dwordx4 v14, s[12:15], s51 offen lds
    s_add_u32 s50, s50, 64
    s_add_u32 s51, s51, 65536
    s_waitcnt lgkmcnt(4)
    v_mfma_f32_32x32x16_bf16 v[64:79], v[34:37], v[26:29], v[64:79]
    v_mfma_f32_32x32x16_bf16 v[80:95], v[34:37], v[30:33], v[80:95]
    s_waitcnt lgkmcnt(0)
    v_mfma_f32_32x32x16_bf16 v[64:79], v[46:49], v[38:41], v[64:79]
    v_mfma_f32_32x32x16_bf16 v[80:95], v[46:49], v[42:45], v[80:95]
    s_waitcnt vmcnt(6)
    s_barrier
    ds_read_b128 v[26:29], v18 offset:12288
    ds_read_b128 v[30:33], v18 offset:14336
    ds_read_b64_tr_b16 v[34:35], v22 offset:20480
    ds_read_b64_tr_b16 v[36:37], v22 offset:20992
    ds_read_b128 v[38:41], v19 offset:12288
    ds_read_b128 v[42:45], v19 offset:14336
    ds_read_b64_tr_b16 v[46:47], v22 offset:22528
    ds_read_b64_tr_b16 v[48:49], v22 offset:23040
    s_add_u32 m0, s52, 0
    s_nop 0
    buffer_load_dwordx4 v10, s[8:11], s50 offen lds
    s_add_u32 m0, s52, 1024
    s_nop 0
    buffer_load_dwordx4 v11, s[8:11], s50 offen lds
    s_add_u32 m0, s53, 0
    s_nop 0
    buffer_load_dwordx4 v14, s[12:15], s51 offen lds
    s_add_u32 s50, s50, 64
    s_add_u32 s51, s51, 65536
    s_waitcnt lgkmcnt(4)
    v_mfma_f32_32x32x16_bf16 v[64:79], v[34:37], v[26:29], v[64:79]
    v_mfma_f32_32x32x16_bf16 v[80:95], v[34:37], v[30:33], v[80:95]
    s_waitcnt lgkmcnt(0)
    v_mfma_f32_32x32x16_bf16 v[64:79], v[46:49], v[38:41], v[64:79]
    v_mfma_f32_32x32x16_bf16 v[80:95], v[46:49], v[42:45], v[80:95]
    s_waitcnt vmcnt(6)
    s_barrier
    ds_read_b128 v[26:29], v18 offset:24576
    ds_read_b128 v[30:33], v18 offset:26624
    ds_read_b64_tr_b16 v[34:35], v22 offset:32768
    ds_read_b64_tr_b16 v[36:37], v22 offset:33280
    ds_read_b128 v[38:41], v19 offset:24576
    ds_read_b128 v[42:45], v19 offset:26624
    ds_read_b64_tr_b16 v[46:47], v22 offset:34816
    ds_read_b64_tr_b16 v[48:49], v22 offset:35328
    s_add_u32 m0, s52, 12288
    s_nop 0
    buffer_load_dwordx4 v10, s[8:11], s50 offen lds
    s_add_u32 m0, s52, 13312
    s_nop 0
    buffer_load_dwordx4 v11, s[8:11], s50 offen lds
    s_add_u32 m0, s53, 12288
    s_nop 0
    buffer_load_dwordx4 v14, s[12:15], s51 offen lds
    s_add_u32 s50, s50, 64
    s_add_u32 s51, s51, 65536
    s_waitcnt lgkmcnt(4)
    v_mfma_f32_32x32x16_bf16 v[64:79], v[34:37], v[26:29], v[64:79]
    v_mfma_f32_32x32x16_bf16 v[80:95], v[34:37], v[30:33], v[80:95]
    s_waitcnt lgkmcnt(0)
    v_mfma_f32_32x32x16_bf16 v[64:79], v[46:49], v[38:41], v[64:79]
    v_mfma_f32_32x32x16_bf16 v[80:95], v[46:49], v[42:45], v[80:95]
    s_waitcnt vmcnt(6)
    s_barrier
    ds_read_b128 v[26:29], v18 offset:36864
    ds_read_b128 v[30:33], v18 offset:38912
    ds_read_b64_tr_b16 v[34:35], v22 offset:45056
    ds_read_b64_tr_b16 v[36:37], v22 offset:45568
    ds_read_b128 v[38:41], v19 offset:36864
    ds_read_b128 v[42:45], v19 offset:38912
    ds_read_b64_tr_b16 v[46:47], v22 offset:47104
    ds_read_b64_tr_b16 v[48:49], v22 offset:47616
    s_add_u32 m0, s52, 24576
    s_nop 0
    buffer_load_dwordx4 v10, s[8:11], s50 offen lds
    s_add_u32 m0, s52, 25600
    s_nop 0
    buffer_load_dwordx4 v11, s[8:11], s50 offen lds
    s_add_u32 m0, s53, 24576
    s_nop 0
    buffer_load_dwordx4 v14, s[12:15], s51 offen lds
    s_add_u32 s50, s50, 64
    s_add_u32 s51, s51, 65536
    s_waitcnt lgkmcnt(4)
    v_mfma_f32_32x32x16_bf16 v[64:79], v[34:37], v[26:29], v[64:79]
    v_mfma_f32_32x32x16_bf16 v[80:95], v[34:37], v[30:33], v[80:95]
    s_waitcnt lgkmcnt(0)
    v_mfma_f32_32x32x16_bf16 v[64:79], v[46:49], v[38:41], v[64:79]
    v_mfma_f32_32x32x16_bf16 v[80:95], v[46:49], v[42:45], v[80:95]
    s_add_u32 s54, s54, 4
    s_cmp_lt_u32 s54, 128
    s_cbranch_scc1 L_g_loop_35
    s_nop 15
    s_waitcnt vmcnt(0)
    v_and_b32 v3, 31, v1
    s_lshl_b32 s45, s40, 7
    s_lshl_b32 s46, s48, 6
    s_add_u32 s45, s45, s46
    v_add_u32 v3, s45, v3
    v_lshrrev_b32 v4, 5, v1
    v_lshlrev_b32 v4, 2, v4
    s_mul_i32 s45, s41, 64
    s_mul_i32 s46, s49, 32
    s_add_u32 s45, s45, s46
    v_add_u32 v4, s45, v4
    s_mov_b32 s47, 2048
    v_mul_lo_u32 v5, v3, s47
    v_lshlrev_b32 v6, 1, v4
    v_add_u32 v5, v5, v6
    v_lshrrev_b32 v61, 5, v1
    v_lshlrev_b32 v61, 3, v61
    v_add_u32 v61, v61, v5
    s_mov_b32 s24, s20
    s_and_b32 s25, s21, 0xffff
    s_mov_b32 s26, 0x6000
    s_mov_b32 s27, 0x00020000
    s_mov_b32 s55, 8192
    v_lshlrev_b32 v7, 2, v4
    s_mov_b32 s28, s4
    s_and_b32 s29, s5, 0xffff
    s_mov_b32 s30, 0x400000
    s_mov_b32 s31, 0x00020000
    buffer_load_dwordx4 v[26:29], v7, s[24:27], s55 offen offset:0
    buffer_load_dwordx4 v[30:33], v7, s[24:27], s55 offen offset:32
    buffer_load_dwordx4 v[34:37], v7, s[24:27], s55 offen offset:64
    buffer_load_dwordx4 v[38:41], v7, s[24:27], s55 offen offset:96
    v_add_u32 v9, 0, v5
    buffer_load_dwordx2 v[50:51], v9, s[28:31], 0 offen offset:0
    buffer_load_dwordx2 v[52:53], v9, s[28:31], 0 offen offset:16
    buffer_load_dwordx2 v[54:55], v9, s[28:31], 0 offen offset:32
    buffer_load_dwordx2 v[56:57], v9, s[28:31], 0 offen offset:48
    s_waitcnt vmcnt(0)
    v_cvt_pk_bf16_f32 v64, v64, v64
    v_lshlrev_b32 v64, 16, v64
    v_mul_f32 v64, v64, v26
    v_cvt_pk_bf16_f32 v64, v64, v64
    v_lshlrev_b32 v64, 16, v64
    v_lshlrev_b32 v60, 16, v50
    v_add_f32 v64, v64, v60
    v_cvt_pk_bf16_f32 v65, v65, v65
    v_lshlrev_b32 v65, 16, v65
    v_mul_f32 v65, v65, v27
    v_cvt_pk_bf16_f32 v65, v65, v65
    v_lshlrev_b32 v65, 16, v65
    v_and_b32 v60, 0xffff0000, v50
    v_add_f32 v65, v65, v60
    v_cvt_pk_bf16_f32 v66, v66, v66
    v_lshlrev_b32 v66, 16, v66
    v_mul_f32 v66, v66, v28
    v_cvt_pk_bf16_f32 v66, v66, v66
    v_lshlrev_b32 v66, 16, v66
    v_lshlrev_b32 v60, 16, v51
    v_add_f32 v66, v66, v60
    v_cvt_pk_bf16_f32 v67, v67, v67
    v_lshlrev_b32 v67, 16, v67
    v_mul_f32 v67, v67, v29
    v_cvt_pk_bf16_f32 v67, v67, v67
    v_lshlrev_b32 v67, 16, v67
    v_and_b32 v60, 0xffff0000, v51
    v_add_f32 v67, v67, v60
    v_cvt_pk_bf16_f32 v64, v64, v65
    v_cvt_pk_bf16_f32 v65, v66, v67
    v_cvt_pk_bf16_f32 v68, v68, v68
    v_lshlrev_b32 v68, 16, v68
    v_mul_f32 v68, v68, v30
    v_cvt_pk_bf16_f32 v68, v68, v68
    v_lshlrev_b32 v68, 16, v68
    v_lshlrev_b32 v60, 16, v52
    v_add_f32 v68, v68, v60
    v_cvt_pk_bf16_f32 v69, v69, v69
    v_lshlrev_b32 v69, 16, v69
    v_mul_f32 v69, v69, v31
    v_cvt_pk_bf16_f32 v69, v69, v69
    v_lshlrev_b32 v69, 16, v69
    v_and_b32 v60, 0xffff0000, v52
    v_add_f32 v69, v69, v60
    v_cvt_pk_bf16_f32 v70, v70, v70
    v_lshlrev_b32 v70, 16, v70
    v_mul_f32 v70, v70, v32
    v_cvt_pk_bf16_f32 v70, v70, v70
    v_lshlrev_b32 v70, 16, v70
    v_lshlrev_b32 v60, 16, v53
    v_add_f32 v70, v70, v60
    v_cvt_pk_bf16_f32 v71, v71, v71
    v_lshlrev_b32 v71, 16, v71
    v_mul_f32 v71, v71, v33
    v_cvt_pk_bf16_f32 v71, v71, v71
    v_lshlrev_b32 v71, 16, v71
    v_and_b32 v60, 0xffff0000, v53
    v_add_f32 v71, v71, v60
    v_cvt_pk_bf16_f32 v66, v68, v69
    v_cvt_pk_bf16_f32 v67, v70, v71
    v_cvt_pk_bf16_f32 v72, v72, v72
    v_lshlrev_b32 v72, 16, v72
    v_mul_f32 v72, v72, v34
    v_cvt_pk_bf16_f32 v72, v72, v72
    v_lshlrev_b32 v72, 16, v72
    v_lshlrev_b32 v60, 16, v54
    v_add_f32 v72, v72, v60
    v_cvt_pk_bf16_f32 v73, v73, v73
    v_lshlrev_b32 v73, 16, v73
    v_mul_f32 v73, v73, v35
    v_cvt_pk_bf16_f32 v73, v73, v73
    v_lshlrev_b32 v73, 16, v73
    v_and_b32 v60, 0xffff0000, v54
    v_add_f32 v73, v73, v60
    v_cvt_pk_bf16_f32 v74, v74, v74
    v_lshlrev_b32 v74, 16, v74
    v_mul_f32 v74, v74, v36
    v_cvt_pk_bf16_f32 v74, v74, v74
    v_lshlrev_b32 v74, 16, v74
    v_lshlrev_b32 v60, 16, v55
    v_add_f32 v74, v74, v60
    v_cvt_pk_bf16_f32 v75, v75, v75
    v_lshlrev_b32 v75, 16, v75
    v_mul_f32 v75, v75, v37
    v_cvt_pk_bf16_f32 v75, v75, v75
    v_lshlrev_b32 v75, 16, v75
    v_and_b32 v60, 0xffff0000, v55
    v_add_f32 v75, v75, v60
    v_cvt_pk_bf16_f32 v72, v72, v73
    v_cvt_pk_bf16_f32 v73, v74, v75
    v_cvt_pk_bf16_f32 v76, v76, v76
    v_lshlrev_b32 v76, 16, v76
    v_mul_f32 v76, v76, v38
    v_cvt_pk_bf16_f32 v76, v76, v76
    v_lshlrev_b32 v76, 16, v76
    v_lshlrev_b32 v60, 16, v56
    v_add_f32 v76, v76, v60
    v_cvt_pk_bf16_f32 v77, v77, v77
    v_lshlrev_b32 v77, 16, v77
    v_mul_f32 v77, v77, v39
    v_cvt_pk_bf16_f32 v77, v77, v77
    v_lshlrev_b32 v77, 16, v77
    v_and_b32 v60, 0xffff0000, v56
    v_add_f32 v77, v77, v60
    v_cvt_pk_bf16_f32 v78, v78, v78
    v_lshlrev_b32 v78, 16, v78
    v_mul_f32 v78, v78, v40
    v_cvt_pk_bf16_f32 v78, v78, v78
    v_lshlrev_b32 v78, 16, v78
    v_lshlrev_b32 v60, 16, v57
    v_add_f32 v78, v78, v60
    v_cvt_pk_bf16_f32 v79, v79, v79
    v_lshlrev_b32 v79, 16, v79
    v_mul_f32 v79, v79, v41
    v_cvt_pk_bf16_f32 v79, v79, v79
    v_lshlrev_b32 v79, 16, v79
    v_and_b32 v60, 0xffff0000, v57
    v_add_f32 v79, v79, v60
    v_cvt_pk_bf16_f32 v74, v76, v77
    v_cvt_pk_bf16_f32 v75, v78, v79
    v_mov_b32 v9, v61
    s_nop 0
    v_permlane32_swap_b32 v64, v66
    v_permlane32_swap_b32 v65, v67
    v_permlane32_swap_b32 v72, v74
    v_permlane32_swap_b32 v73, v75
    buffer_store_dwordx4 v[64:67], v9, s[16:19], 0 offen offset:0
    buffer_store_dwordx4 v[72:75], v9, s[16:19], 0 offen offset:32
    v_add_u32 v9, 65536, v5
    buffer_load_dwordx2 v[50:51], v9, s[28:31], 0 offen offset:0
    buffer_load_dwordx2 v[52:53], v9, s[28:31], 0 offen offset:16
    buffer_load_dwordx2 v[54:55], v9, s[28:31], 0 offen offset:32
    buffer_load_dwordx2 v[56:57], v9, s[28:31], 0 offen offset:48
    s_waitcnt vmcnt(0)
    v_cvt_pk_bf16_f32 v80, v80, v80
    v_lshlrev_b32 v80, 16, v80
    v_mul_f32 v80, v80, v26
    v_cvt_pk_bf16_f32 v80, v80, v80
    v_lshlrev_b32 v80, 16, v80
    v_lshlrev_b32 v60, 16, v50
    v_add_f32 v80, v80, v60
    v_cvt_pk_bf16_f32 v81, v81, v81
    v_lshlrev_b32 v81, 16, v81
    v_mul_f32 v81, v81, v27
    v_cvt_pk_bf16_f32 v81, v81, v81
    v_lshlrev_b32 v81, 16, v81
    v_and_b32 v60, 0xffff0000, v50
    v_add_f32 v81, v81, v60
    v_cvt_pk_bf16_f32 v82, v82, v82
    v_lshlrev_b32 v82, 16, v82
    v_mul_f32 v82, v82, v28
    v_cvt_pk_bf16_f32 v82, v82, v82
    v_lshlrev_b32 v82, 16, v82
    v_lshlrev_b32 v60, 16, v51
    v_add_f32 v82, v82, v60
    v_cvt_pk_bf16_f32 v83, v83, v83
    v_lshlrev_b32 v83, 16, v83
    v_mul_f32 v83, v83, v29
    v_cvt_pk_bf16_f32 v83, v83, v83
    v_lshlrev_b32 v83, 16, v83
    v_and_b32 v60, 0xffff0000, v51
    v_add_f32 v83, v83, v60
    v_cvt_pk_bf16_f32 v80, v80, v81
    v_cvt_pk_bf16_f32 v81, v82, v83
    v_cvt_pk_bf16_f32 v84, v84, v84
    v_lshlrev_b32 v84, 16, v84
    v_mul_f32 v84, v84, v30
    v_cvt_pk_bf16_f32 v84, v84, v84
    v_lshlrev_b32 v84, 16, v84
    v_lshlrev_b32 v60, 16, v52
    v_add_f32 v84, v84, v60
    v_cvt_pk_bf16_f32 v85, v85, v85
    v_lshlrev_b32 v85, 16, v85
    v_mul_f32 v85, v85, v31
    v_cvt_pk_bf16_f32 v85, v85, v85
    v_lshlrev_b32 v85, 16, v85
    v_and_b32 v60, 0xffff0000, v52
    v_add_f32 v85, v85, v60
    v_cvt_pk_bf16_f32 v86, v86, v86
    v_lshlrev_b32 v86, 16, v86
    v_mul_f32 v86, v86, v32
    v_cvt_pk_bf16_f32 v86, v86, v86
    v_lshlrev_b32 v86, 16, v86
    v_lshlrev_b32 v60, 16, v53
    v_add_f32 v86, v86, v60
    v_cvt_pk_bf16_f32 v87, v87, v87
    v_lshlrev_b32 v87, 16, v87
    v_mul_f32 v87, v87, v33
    v_cvt_pk_bf16_f32 v87, v87, v87
    v_lshlrev_b32 v87, 16, v87
    v_and_b32 v60, 0xffff0000, v53
    v_add_f32 v87, v87, v60
    v_cvt_pk_bf16_f32 v82, v84, v85
    v_cvt_pk_bf16_f32 v83, v86, v87
    v_cvt_pk_bf16_f32 v88, v88, v88
    v_lshlrev_b32 v88, 16, v88
    v_mul_f32 v88, v88, v34
    v_cvt_pk_bf16_f32 v88, v88, v88
    v_lshlrev_b32 v88, 16, v88
    v_lshlrev_b32 v60, 16, v54
    v_add_f32 v88, v88, v60
    v_cvt_pk_bf16_f32 v89, v89, v89
    v_lshlrev_b32 v89, 16, v89
    v_mul_f32 v89, v89, v35
    v_cvt_pk_bf16_f32 v89, v89, v89
    v_lshlrev_b32 v89, 16, v89
    v_and_b32 v60, 0xffff0000, v54
    v_add_f32 v89, v89, v60
    v_cvt_pk_bf16_f32 v90, v90, v90
    v_lshlrev_b32 v90, 16, v90
    v_mul_f32 v90, v90, v36
    v_cvt_pk_bf16_f32 v90, v90, v90
    v_lshlrev_b32 v90, 16, v90
    v_lshlrev_b32 v60, 16, v55
    v_add_f32 v90, v90, v60
    v_cvt_pk_bf16_f32 v91, v91, v91
    v_lshlrev_b32 v91, 16, v91
    v_mul_f32 v91, v91, v37
    v_cvt_pk_bf16_f32 v91, v91, v91
    v_lshlrev_b32 v91, 16, v91
    v_and_b32 v60, 0xffff0000, v55
    v_add_f32 v91, v91, v60
    v_cvt_pk_bf16_f32 v88, v88, v89
    v_cvt_pk_bf16_f32 v89, v90, v91
    v_cvt_pk_bf16_f32 v92, v92, v92
    v_lshlrev_b32 v92, 16, v92
    v_mul_f32 v92, v92, v38
    v_cvt_pk_bf16_f32 v92, v92, v92
    v_lshlrev_b32 v92, 16, v92
    v_lshlrev_b32 v60, 16, v56
    v_add_f32 v92, v92, v60
    v_cvt_pk_bf16_f32 v93, v93, v93
    v_lshlrev_b32 v93, 16, v93
    v_mul_f32 v93, v93, v39
    v_cvt_pk_bf16_f32 v93, v93, v93
    v_lshlrev_b32 v93, 16, v93
    v_and_b32 v60, 0xffff0000, v56
    v_add_f32 v93, v93, v60
    v_cvt_pk_bf16_f32 v94, v94, v94
    v_lshlrev_b32 v94, 16, v94
    v_mul_f32 v94, v94, v40
    v_cvt_pk_bf16_f32 v94, v94, v94
    v_lshlrev_b32 v94, 16, v94
    v_lshlrev_b32 v60, 16, v57
    v_add_f32 v94, v94, v60
    v_cvt_pk_bf16_f32 v95, v95, v95
    v_lshlrev_b32 v95, 16, v95
    v_mul_f32 v95, v95, v41
    v_cvt_pk_bf16_f32 v95, v95, v95
    v_lshlrev_b32 v95, 16, v95
    v_and_b32 v60, 0xffff0000, v57
    v_add_f32 v95, v95, v60
    v_cvt_pk_bf16_f32 v90, v92, v93
    v_cvt_pk_bf16_f32 v91, v94, v95
    v_add_u32 v9, 65536, v61
    s_nop 0
    v_permlane32_swap_b32 v80, v82
    v_permlane32_swap_b32 v81, v83
    v_permlane32_swap_b32 v88, v90
    v_permlane32_swap_b32 v89, v91
    buffer_store_dwordx4 v[80:83], v9, s[16:19], 0 offen offset:0
    buffer_store_dwordx4 v[88:91], v9, s[16:19], 0 offen offset:32
L_g_done_34:
    s_endpgm
.globl k6_ln_kernel
.p2align 8
.type k6_ln_kernel,@function
k6_ln_kernel:
    s_cmp_ge_u32 s2, 512
    s_cbranch_scc1 L_ln_done_36
    s_load_dwordx2 s[4:5], s[0:1], 0
    s_load_dwordx2 s[20:21], s[0:1], 128
    v_lshrrev_b32 v1, 6, v0
    v_and_b32 v2, 63, v0
    s_waitcnt lgkmcnt(0)
    s_add_u32 s8, s20, 0x800000
    s_addc_u32 s9, s21, 0
    s_and_b32 s9, s9, 0xffff
    s_mov_b32 s10, 0x400000
    s_mov_b32 s11, 0x00020000
    s_add_u32 s12, s20, 0xc00000
    s_addc_u32 s13, s21, 0
    s_and_b32 s13, s13, 0xffff
    s_mov_b32 s14, 0x400000
    s_mov_b32 s15, 0x00020000
    s_mov_b32 s16, s20
    s_and_b32 s17, s21, 0xffff
    s_mov_b32 s18, 0x6000
    s_mov_b32 s19, 0x00020000
    s_lshl_b32 s22, s2, 13
    v_lshlrev_b32 v3, 11, v1
    v_lshlrev_b32 v4, 4, v2
    v_add_u32 v3, v3, v4
    buffer_load_dwordx4 v[8:11], v3, s[8:11], s22 offen
    buffer_load_dwordx4 v[12:15], v3, s[8:11], s22 offen offset:1024
    v_lshlrev_b32 v5, 5, v2
    s_mov_b32 s23, 12288
    s_mov_b32 s24, 16384
    buffer_load_dwordx4 v[32:35], v5, s[16:19], s23 offen offset:0
    buffer_load_dwordx4 v[48:51], v5, s[16:19], s24 offen offset:0
    buffer_load_dwordx4 v[36:39], v5, s[16:19], s23 offen offset:16
    buffer_load_dwordx4 v[52:55], v5, s[16:19], s24 offen offset:16
    buffer_load_dwordx4 v[40:43], v5, s[16:19], s23 offen offset:2048
    buffer_load_dwordx4 v[56:59], v5, s[16:19], s24 offen offset:2048
    buffer_load_dwordx4 v[44:47], v5, s[16:19], s23 offen offset:2064
    buffer_load_dwordx4 v[60:63], v5, s[16:19], s24 offen offset:2064
    s_waitcnt vmcnt(8)
    v_lshlrev_b32 v16, 16, v8
    v_and_b32 v17, 0xffff0000, v8
    v_lshlrev_b32 v18, 16, v9
    v_and_b32 v19, 0xffff0000, v9
    v_lshlrev_b32 v20, 16, v10
    v_and_b32 v21, 0xffff0000, v10
    v_lshlrev_b32 v22, 16, v11
    v_and_b32 v23, 0xffff0000, v11
    v_lshlrev_b32 v24, 16, v12
    v_and_b32 v25, 0xffff0000, v12
    v_lshlrev_b32 v26, 16, v13
    v_and_b32 v27, 0xffff0000, v13
    v_lshlrev_b32 v28, 16, v14
    v_and_b32 v29, 0xffff0000, v14
    v_lshlrev_b32 v30, 16, v15
    v_and_b32 v31, 0xffff0000, v15
    v_add_f32 v6, v16, v17
    v_add_f32 v6, v6, v18
    v_add_f32 v6, v6, v19
    v_add_f32 v6, v6, v20
    v_add_f32 v6, v6, v21
    v_add_f32 v6, v6, v22
    v_add_f32 v6, v6, v23
    v_add_f32 v6, v6, v24
    v_add_f32 v6, v6, v25
    v_add_f32 v6, v6, v26
    v_add_f32 v6, v6, v27
    v_add_f32 v6, v6, v28
    v_add_f32 v6, v6, v29
    v_add_f32 v6, v6, v30
    v_add_f32 v6, v6, v31
    s_nop 1
    v_add_f32_dpp v6, v6, v6 row_shr:1 row_mask:0xf bank_mask:0xf bound_ctrl:0
    s_nop 1
    v_add_f32_dpp v6, v6, v6 row_shr:2 row_mask:0xf bank_mask:0xf bound_ctrl:0
    s_nop 1
    v_add_f32_dpp v6, v6, v6 row_shr:4 row_mask:0xf bank_mask:0xf bound_ctrl:0
    s_nop 1
    v_add_f32_dpp v6, v6, v6 row_shr:8 row_mask:0xf bank_mask:0xf bound_ctrl:0
    s_nop 1
    v_add_f32_dpp v6, v6, v6 row_bcast:15 row_mask:0xa bank_mask:0xf
    s_nop 1
    v_add_f32_dpp v6, v6, v6 row_bcast:31 row_mask:0xc bank_mask:0xf
    s_nop 1
    v_readlane_b32 s26, v6, 63
    v_mov_b32 v7, s26
    v_mul_f32 v7, 0x3a800000, v7
    v_mov_b32 v6, 0
    v_sub_f32 v64, v16, v7
    v_fmac_f32 v6, v64, v64
    v_sub_f32 v64, v17, v7
    v_fmac_f32 v6, v64, v64
    v_sub_f32 v64, v18, v7
    v_fmac_f32 v6, v64, v64
    v_sub_f32 v64, v19, v7
    v_fmac_f32 v6, v64, v64
    v_sub_f32 v64, v20, v7
    v_fmac_f32 v6, v64, v64
    v_sub_f32 v64, v21, v7
    v_fmac_f32 v6, v64, v64
    v_sub_f32 v64, v22, v7
    v_fmac_f32 v6, v64, v64
    v_sub_f32 v64, v23, v7
    v_fmac_f32 v6, v64, v64
    v_sub_f32 v64, v24, v7
    v_fmac_f32 v6, v64, v64
    v_sub_f32 v64, v25, v7
    v_fmac_f32 v6, v64, v64
    v_sub_f32 v64, v26, v7
    v_fmac_f32 v6, v64, v64
    v_sub_f32 v64, v27, v7
    v_fmac_f32 v6, v64, v64
    v_sub_f32 v64, v28, v7
    v_fmac_f32 v6, v64, v64
    v_sub_f32 v64, v29, v7
    v_fmac_f32 v6, v64, v64
    v_sub_f32 v64, v30, v7
    v_fmac_f32 v6, v64, v64
    v_sub_f32 v64, v31, v7
    v_fmac_f32 v6, v64, v64
    s_nop 1
    v_add_f32_dpp v6, v6, v6 row_shr:1 row_mask:0xf bank_mask:0xf bound_ctrl:0
    s_nop 1
    v_add_f32_dpp v6, v6, v6 row_shr:2 row_mask:0xf bank_mask:0xf bound_ctrl:0
    s_nop 1
    v_add_f32_dpp v6, v6, v6 row_shr:4 row_mask:0xf bank_mask:0xf bound_ctrl:0
    s_nop 1
    v_add_f32_dpp v6, v6, v6 row_shr:8 row_mask:0xf bank_mask:0xf bound_ctrl:0
    s_nop 1
    v_add_f32_dpp v6, v6, v6 row_bcast:15 row_mask:0xa bank_mask:0xf
    s_nop 1
    v_add_f32_dpp v6, v6, v6 row_bcast:31 row_mask:0xc bank_mask:0xf
    s_nop 1
    v_readlane_b32 s27, v6, 63
    v_mov_b32 v6, s27
    v_mul_f32 v6, 0x3a800000, v6
    v_cvt_pk_bf16_f32 v6, v6, v6
    v_lshlrev_b32 v6, 16, v6
    v_cvt_pk_bf16_f32 v7, v7, v7
    v_lshlrev_b32 v7, 16, v7
    v_add_f32 v6, 0x3727c5ac, v6
    v_cvt_pk_bf16_f32 v6, v6, v6
    v_lshlrev_b32 v6, 16, v6
    v_sqrt_f32 v6, v6
    s_nop 0
    v_cvt_pk_bf16_f32 v6, v6, v6
    v_lshlrev_b32 v6, 16, v6
    v_rcp_f32 v6, v6
    s_waitcnt vmcnt(0)
    v_sub_f32 v16, v16, v7
    v_cvt_pk_bf16_f32 v16, v16, v16
    v_lshlrev_b32 v16, 16, v16
    v_mul_f32 v16, v16, v6
    v_cvt_pk_bf16_f32 v16, v16, v16
    v_lshlrev_b32 v16, 16, v16
    v_add_f32 v64, 1.0, v48
    v_cvt_pk_bf16_f32 v64, v64, v64
    v_lshlrev_b32 v64, 16, v64
    v_mul_f32 v16, v16, v64
    v_cvt_pk_bf16_f32 v16, v16, v16
    v_lshlrev_b32 v16, 16, v16
    v_add_f32 v16, v16, v32
    v_sub_f32 v17, v17, v7
    v_cvt_pk_bf16_f32 v17, v17, v17
    v_lshlrev_b32 v17, 16, v17
    v_mul_f32 v17, v17, v6
    v_cvt_pk_bf16_f32 v17, v17, v17
    v_lshlrev_b32 v17, 16, v17
    v_add_f32 v64, 1.0, v49
    v_cvt_pk_bf16_f32 v64, v64, v64
    v_lshlrev_b32 v64, 16, v64
    v_mul_f32 v17, v17, v64
    v_cvt_pk_bf16_f32 v17, v17, v17
    v_lshlrev_b32 v17, 16, v17
    v_add_f32 v17, v17, v33
    v_sub_f32 v18, v18, v7
    v_cvt_pk_bf16_f32 v18, v18, v18
    v_lshlrev_b32 v18, 16, v18
    v_mul_f32 v18, v18, v6
    v_cvt_pk_bf16_f32 v18, v18, v18
    v_lshlrev_b32 v18, 16, v18
    v_add_f32 v64, 1.0, v50
    v_cvt_pk_bf16_f32 v64, v64, v64
    v_lshlrev_b32 v64, 16, v64
    v_mul_f32 v18, v18, v64
    v_cvt_pk_bf16_f32 v18, v18, v18
    v_lshlrev_b32 v18, 16, v18
    v_add_f32 v18, v18, v34
    v_sub_f32 v19, v19, v7
    v_cvt_pk_bf16_f32 v19, v19, v19
    v_lshlrev_b32 v19, 16, v19
    v_mul_f32 v19, v19, v6
    v_cvt_pk_bf16_f32 v19, v19, v19
    v_lshlrev_b32 v19, 16, v19
    v_add_f32 v64, 1.0, v51
    v_cvt_pk_bf16_f32 v64, v64, v64
    v_lshlrev_b32 v64, 16, v64
    v_mul_f32 v19, v19, v64
    v_cvt_pk_bf16_f32 v19, v19, v19
    v_lshlrev_b32 v19, 16, v19
    v_add_f32 v19, v19, v35
    v_sub_f32 v20, v20, v7
    v_cvt_pk_bf16_f32 v20, v20, v20
    v_lshlrev_b32 v20, 16, v20
    v_mul_f32 v20, v20, v6
    v_cvt_pk_bf16_f32 v20, v20, v20
    v_lshlrev_b32 v20, 16, v20
    v_add_f32 v64, 1.0, v52
    v_cvt_pk_bf16_f32 v64, v64, v64
    v_lshlrev_b32 v64, 16, v64
    v_mul_f32 v20, v20, v64
    v_cvt_pk_bf16_f32 v20, v20, v20
    v_lshlrev_b32 v20, 16, v20
    v_add_f32 v20, v20, v36
    v_sub_f32 v21, v21, v7
    v_cvt_pk_bf16_f32 v21, v21, v21
    v_lshlrev_b32 v21, 16, v21
    v_mul_f32 v21, v21, v6
    v_cvt_pk_bf16_f32 v21, v21, v21
    v_lshlrev_b32 v21, 16, v21
    v_add_f32 v64, 1.0, v53
    v_cvt_pk_bf16_f32 v64, v64, v64
    v_lshlrev_b32 v64, 16, v64
    v_mul_f32 v21, v21, v64
    v_cvt_pk_bf16_f32 v21, v21, v21
    v_lshlrev_b32 v21, 16, v21
    v_add_f32 v21, v21, v37
    v_sub_f32 v22, v22, v7
    v_cvt_pk_bf16_f32 v22, v22, v22
    v_lshlrev_b32 v22, 16, v22
    v_mul_f32 v22, v22, v6
    v_cvt_pk_bf16_f32 v22, v22, v22
    v_lshlrev_b32 v22, 16, v22
    v_add_f32 v64, 1.0, v54
    v_cvt_pk_bf16_f32 v64, v64, v64
    v_lshlrev_b32 v64, 16, v64
    v_mul_f32 v22, v22, v64
    v_cvt_pk_bf16_f32 v22, v22, v22
    v_lshlrev_b32 v22, 16, v22
    v_add_f32 v22, v22, v38
    v_sub_f32 v23, v23, v7
    v_cvt_pk_bf16_f32 v23, v23, v23
    v_lshlrev_b32 v23, 16, v23
    v_mul_f32 v23, v23, v6
    v_cvt_pk_bf16_f32 v23, v23, v23
    v_lshlrev_b32 v23, 16, v23
    v_add_f32 v64, 1.0, v55
    v_cvt_pk_bf16_f32 v64, v64, v64
    v_lshlrev_b32 v64, 16, v64
    v_mul_f32 v23, v23, v64
    v_cvt_pk_bf16_f32 v23, v23, v23
    v_lshlrev_b32 v23, 16, v23
    v_add_f32 v23, v23, v39
    v_sub_f32 v24, v24, v7
    v_cvt_pk_bf16_f32 v24, v24, v24
    v_lshlrev_b32 v24, 16, v24
    v_mul_f32 v24, v24, v6
    v_cvt_pk_bf16_f32 v24, v24, v24
    v_lshlrev_b32 v24, 16, v24
    v_add_f32 v64, 1.0, v56
    v_cvt_pk_bf16_f32 v64, v64, v64
    v_lshlrev_b32 v64, 16, v64
    v_mul_f32 v24, v24, v64
    v_cvt_pk_bf16_f32 v24, v24, v24
    v_lshlrev_b32 v24, 16, v24
    v_add_f32 v24, v24, v40
    v_sub_f32 v25, v25, v7
    v_cvt_pk_bf16_f32 v25, v25, v25
    v_lshlrev_b32 v25, 16, v25
    v_mul_f32 v25, v25, v6
    v_cvt_pk_bf16_f32 v25, v25, v25
    v_lshlrev_b32 v25, 16, v25
    v_add_f32 v64, 1.0, v57
    v_cvt_pk_bf16_f32 v64, v64, v64
    v_lshlrev_b32 v64, 16, v64
    v_mul_f32 v25, v25, v64
    v_cvt_pk_bf16_f32 v25, v25, v25
    v_lshlrev_b32 v25, 16, v25
    v_add_f32 v25, v25, v41
    v_sub_f32 v26, v26, v7
    v_cvt_pk_bf16_f32 v26, v26, v26
    v_lshlrev_b32 v26, 16, v26
    v_mul_f32 v26, v26, v6
    v_cvt_pk_bf16_f32 v26, v26, v26
    v_lshlrev_b32 v26, 16, v26
    v_add_f32 v64, 1.0, v58
    v_cvt_pk_bf16_f32 v64, v64, v64
    v_lshlrev_b32 v64, 16, v64
    v_mul_f32 v26, v26, v64
    v_cvt_pk_bf16_f32 v26, v26, v26
    v_lshlrev_b32 v26, 16, v26
    v_add_f32 v26, v26, v42
    v_sub_f32 v27, v27, v7
    v_cvt_pk_bf16_f32 v27, v27, v27
    v_lshlrev_b32 v27, 16, v27
    v_mul_f32 v27, v27, v6
    v_cvt_pk_bf16_f32 v27, v27, v27
    v_lshlrev_b32 v27, 16, v27
    v_add_f32 v64, 1.0, v59
    v_cvt_pk_bf16_f32 v64, v64, v64
    v_lshlrev_b32 v64, 16, v64
    v_mul_f32 v27, v27, v64
    v_cvt_pk_bf16_f32 v27, v27, v27
    v_lshlrev_b32 v27, 16, v27
    v_add_f32 v27, v27, v43
    v_sub_f32 v28, v28, v7
    v_cvt_pk_bf16_f32 v28, v28, v28
    v_lshlrev_b32 v28, 16, v28
    v_mul_f32 v28, v28, v6
    v_cvt_pk_bf16_f32 v28, v28, v28
    v_lshlrev_b32 v28, 16, v28
    v_add_f32 v64, 1.0, v60
    v_cvt_pk_bf16_f32 v64, v64, v64
    v_lshlrev_b32 v64, 16, v64
    v_mul_f32 v28, v28, v64
    v_cvt_pk_bf16_f32 v28, v28, v28
    v_lshlrev_b32 v28, 16, v28
    v_add_f32 v28, v28, v44
    v_sub_f32 v29, v29, v7
    v_cvt_pk_bf16_f32 v29, v29, v29
    v_lshlrev_b32 v29, 16, v29
    v_mul_f32 v29, v29, v6
    v_cvt_pk_bf16_f32 v29, v29, v29
    v_lshlrev_b32 v29, 16, v29
    v_add_f32 v64, 1.0, v61
    v_cvt_pk_bf16_f32 v64, v64, v64
    v_lshlrev_b32 v64, 16, v64
    v_mul_f32 v29, v29, v64
    v_cvt_pk_bf16_f32 v29, v29, v29
    v_lshlrev_b32 v29, 16, v29
    v_add_f32 v29, v29, v45
    v_sub_f32 v30, v30, v7
    v_cvt_pk_bf16_f32 v30, v30, v30
    v_lshlrev_b32 v30, 16, v30
    v_mul_f32 v30, v30, v6
    v_cvt_pk_bf16_f32 v30, v30, v30
    v_lshlrev_b32 v30, 16, v30
    v_add_f32 v64, 1.0, v62
    v_cvt_pk_bf16_f32 v64, v64, v64
    v_lshlrev_b32 v64, 16, v64
    v_mul_f32 v30, v30, v64
    v_cvt_pk_bf16_f32 v30, v30, v30
    v_lshlrev_b32 v30, 16, v30
    v_add_f32 v30, v30, v46
    v_sub_f32 v31, v31, v7
    v_cvt_pk_bf16_f32 v31, v31, v31
    v_lshlrev_b32 v31, 16, v31
    v_mul_f32 v31, v31, v6
    v_cvt_pk_bf16_f32 v31, v31, v31
    v_lshlrev_b32 v31, 16, v31
    v_add_f32 v64, 1.0, v63
    v_cvt_pk_bf16_f32 v64, v64, v64
    v_lshlrev_b32 v64, 16, v64
    v_mul_f32 v31, v31, v64
    v_cvt_pk_bf16_f32 v31, v31, v31
    v_lshlrev_b32 v31, 16, v31
    v_add_f32 v31, v31, v47
    v_cvt_pk_bf16_f32 v8, v16, v17
    v_cvt_pk_bf16_f32 v9, v18, v19
    v_cvt_pk_bf16_f32 v10, v20, v21
    v_cvt_pk_bf16_f32 v11, v22, v23
    v_cvt_pk_bf16_f32 v12, v24, v25
    v_cvt_pk_bf16_f32 v13, v26, v27
    v_cvt_pk_bf16_f32 v14, v28, v29
    v_cvt_pk_bf16_f32 v15, v30, v31
    buffer_store_dwordx4 v[8:11], v3, s[12:15], s22 offen
    buffer_store_dwordx4 v[12:15], v3, s[12:15], s22 offen offset:1024
L_ln_done_36:
    s_endpgm
.globl k7_ffn1_kernel
.p2align 8
.type k7_ffn1_kernel,@function
k7_ffn1_kernel:
    s_cmp_ge_u32 s2, 448
    s_cbranch_scc1 L_g_done_37
    s_load_dwordx2 s[20:21], s[0:1], 128
    s_and_b32 s42, s2, 7
    s_lshr_b32 s43, s2, 3
    s_and_b32 s40, s43, 1
    s_lshl_b32 s42, s42, 1
    s_add_u32 s40, s40, s42
    s_lshr_b32 s41, s43, 1
    s_load_dwordx2 s[6:7], s[0:1], 64
    s_mov_b32 s43, s41
    s_load_dwordx2 s[4:5], s[0:1], 72
    v_and_b32 v1, 63, v0
    v_lshrrev_b32 v2, 6, v0
    s_nop 0
    v_readfirstlane_b32 s44, v2
    s_waitcnt lgkmcnt(0)
    s_add_u32 s8, s20, 0xc00000
    s_addc_u32 s9, s21, 0
    s_and_b32 s9, s9, 0xffff
    s_mov_b32 s10, 0x400000
    s_mov_b32 s11, 0x00020000
    s_mov_b32 s12, s6
    s_and_b32 s13, s7, 0xffff
    s_mov_b32 s14, 0x700000
    s_mov_b32 s15, 0x00020000
    s_add_u32 s16, s20, 0x6000000
    s_addc_u32 s17, s21, 0
    s_and_b32 s17, s17, 0xffff
    s_mov_b32 s18, 0xe00000
    s_mov_b32 s19, 0x00020000
    v_lshrrev_b32 v3, 2, v1
    s_lshl_b32 s45, s44, 5
    v_add_u32 v3, s45, v3
    v_and_b32 v4, 3, v1
    s_lshl_b32 s46, s40, 7
    s_mov_b32 s47, 2048
    v_add_u32 v5, 0, v3
    v_lshrrev_b32 v6, 2, v5
    v_and_b32 v6, 3, v6
    v_xor_b32 v6, v6, v4
    v_lshlrev_b32 v6, 4, v6
    v_add_u32 v5, s46, v5
    v_mul_lo_u32 v5, v5, s47
    v_add_u32 v10, v5, v6
    v_add_u32 v5, 16, v3
    v_lshrrev_b32 v6, 2, v5
    v_and_b32 v6, 3, v6
    v_xor_b32 v6, v6, v4
    v_lshlrev_b32 v6, 4, v6
    v_add_u32 v5, s46, v5
    v_mul_lo_u32 v5, v5, s47
    v_add_u32 v11, v5, v6
    v_lshrrev_b32 v3, 4, v1
    s_mul_i32 s45, s44, 8
    v_add_u32 v3, s45, v3
    v_and_b32 v4, 15, v1
    s_lshl_b32 s46, s43, 8
    s_mov_b32 s47, 7168
    v_add_u32 v5, 0, v3
    v_and_b32 v6, 3, v5
    v_lshlrev_b32 v6, 2, v6
    v_xor_b32 v6, v6, v4
    v_lshlrev_b32 v6, 4, v6
    v_mul_lo_u32 v5, v5, s47
    v_add_u32 v5, s46, v5
    v_add_u32 v14, v5, v6
    v_add_u32 v5, 4, v3
    v_and_b32 v6, 3, v5
    v_lshlrev_b32 v6, 2, v6
    v_xor_b32 v6, v6, v4
    v_lshlrev_b32 v6, 4, v6
    v_mul_lo_u32 v5, v5, s47
    v_add_u32 v5, s46, v5
    v_add_u32 v15, v5, v6
    s_lshr_b32 s48, s44, 1
    s_and_b32 s49, s44, 1
    v_and_b32 v3, 31, v1
    s_lshl_b32 s45, s48, 6
    v_add_u32 v3, s45, v3
    v_lshrrev_b32 v4, 2, v3
    v_and_b32 v4, 3, v4
    v_lshrrev_b32 v5, 5, v1
    v_lshlrev_b32 v3, 6, v3
    v_add_u32 v6, 0, v5
    v_xor_b32 v6, v6, v4
    v_lshlrev_b32 v6, 4, v6
    v_add_u32 v18, v3, v6
    v_add_u32 v6, 2, v5
    v_xor_b32 v6, v6, v4
    v_lshlrev_b32 v6, 4, v6
    v_add_u32 v19, v3, v6
    v_lshrrev_b32 v3, 5, v1
    v_lshlrev_b32 v3, 3, v3
    v_bfe_u32 v4, v1, 2, 2
    v_add_u32 v3, v3, v4
    v_bfe_u32 v5, v1, 4, 1
    v_lshlrev_b32 v5, 4, v5
    v_and_b32 v6, 3, v1
    v_lshlrev_b32 v6, 2, v6
    v_add_u32 v5, v5, v6
    s_mul_i32 s45, s49, 64
    v_add_u32 v5, s45, v5
    v_lshlrev_b32 v7, 2, v4
    v_mul_u32_u24 v3, 256, v3
    v_add_u32 v6, 0, v5
    v_lshrrev_b32 v8, 3, v6
    v_xor_b32 v8, v8, v7
    v_lshlrev_b32 v8, 4, v8
    v_and_b32 v6, 4, v6
    v_lshlrev_b32 v6, 1, v6
    v_add_u32 v8, v8, v6
    v_add_u32 v22, v3, v8
    v_add_u32 v6, 32, v5
    v_lshrrev_b32 v8, 3, v6
    v_xor_b32 v8, v8, v7
    v_lshlrev_b32 v8, 4, v8
    v_and_b32 v6, 4, v6
    v_lshlrev_b32 v6, 1, v6
    v_add_u32 v8, v8, v6
    v_add_u32 v23, v3, v8
    v_mov_b32 v64, 0
    v_mov_b32 v65, 0
    v_mov_b32 v66, 0
    v_mov_b32 v67, 0
    v_mov_b32 v68, 0
    v_mov_b32 v69, 0
    v_mov_b32 v70, 0
    v_mov_b32 v71, 0
    v_mov_b32 v72, 0
    v_mov_b32 v73, 0
    v_mov_b32 v74, 0
    v_mov_b32 v75, 0
    v_mov_b32 v76, 0
    v_mov_b32 v77, 0
    v_mov_b32 v78, 0
    v_mov_b32 v79, 0
    v_mov_b32 v80, 0
    v_mov_b32 v81, 0
    v_mov_b32 v82, 0
    v_mov_b32 v83, 0
    v_mov_b32 v84, 0
    v_mov_b32 v85, 0
    v_mov_b32 v86, 0
    v_mov_b32 v87, 0
    v_mov_b32 v88, 0
    v_mov_b32 v89, 0
    v_mov_b32 v90, 0
    v_mov_b32 v91, 0
    v_mov_b32 v92, 0
    v_mov_b32 v93, 0
    v_mov_b32 v94, 0
    v_mov_b32 v95, 0
    v_mov_b32 v96, 0
    v_mov_b32 v97, 0
    v_mov_b32 v98, 0
    v_mov_b32 v99, 0
    v_mov_b32 v100, 0
    v_mov_b32 v101, 0
    v_mov_b32 v102, 0
    v_mov_b32 v103, 0
    v_mov_b32 v104, 0
    v_mov_b32 v105, 0
    v_mov_b32 v106, 0
    v_mov_b32 v107, 0
    v_mov_b32 v108, 0
    v_mov_b32 v109, 0
    v_mov_b32 v110, 0
    v_mov_b32 v111, 0
    v_mov_b32 v112, 0
    v_mov_b32 v113, 0
    v_mov_b32 v114, 0
    v_mov_b32 v115, 0
    v_mov_b32 v116, 0
    v_mov_b32 v117, 0
    v_mov_b32 v118, 0
    v_mov_b32 v119, 0
    v_mov_b32 v120, 0
    v_mov_b32 v121, 0
    v_mov_b32 v122, 0
    v_mov_b32 v123, 0
    v_mov_b32 v124, 0
    v_mov_b32 v125, 0
    v_mov_b32 v126, 0
    v_mov_b32 v127, 0
    s_mov_b32 s50, 0
    s_mov_b32 s51, 0
    s_lshl_b32 s52, s44, 11
    s_mul_i32 s53, s44, 2048
    s_add_u32 s53, s53, 8192
    s_add_u32 m0, s52, 0
    s_nop 0
    buffer_load_dwordx4 v10, s[8:11], s50 offen lds
    s_add_u32 m0, s52, 1024
    s_nop 0
    buffer_load_dwordx4 v11, s[8:11], s50 offen lds
    s_add_u32 m0, s53, 0
    s_nop 0
    buffer_load_dwordx4 v14, s[12:15], s51 offen lds
    s_add_u32 m0, s53, 1024
    s_nop 0
    buffer_load_dwordx4 v15, s[12:15], s51 offen lds
    s_add_u32 s50, s50, 64
    s_add_u32 s51, s51, 229376
    s_add_u32 m0, s52, 16384
    s_nop 0
    buffer_load_dwordx4 v10, s[8:11], s50 offen lds
    s_add_u32 m0, s52, 17408
    s_nop 0
    buffer_load_dwordx4 v11, s[8:11], s50 offen lds
    s_add_u32 m0, s53, 16384
    s_nop 0
    buffer_load_dwordx4 v14, s[12:15], s51 offen lds
    s_add_u32 m0, s53, 17408
    s_nop 0
    buffer_load_dwordx4 v15, s[12:15], s51 offen lds
    s_add_u32 s50, s50, 64
    s_add_u32 s51, s51, 229376
    s_add_u32 m0, s52, 32768
    s_nop 0
    buffer_load_dwordx4 v10, s[8:11], s50 offen lds
    s_add_u32 m0, s52, 33792
    s_nop 0
    buffer_load_dwordx4 v11, s[8:11], s50 offen lds
    s_add_u32 m0, s53, 32768
    s_nop 0
    buffer_load_dwordx4 v14, s[12:15], s51 offen lds
    s_add_u32 m0, s53, 33792
    s_nop 0
    buffer_load_dwordx4 v15, s[12:15], s51 offen lds
    s_add_u32 s50, s50, 64
    s_add_u32 s51, s51, 229376
    s_mov_b32 s54, 0
L_g_loop_38:
    s_waitcnt vmcnt(8)
    s_barrier
    ds_read_b128 v[26:29], v18 offset:0
    ds_read_b128 v[30:33], v18 offset:2048
    ds_read_b64_tr_b16 v[34:35], v22 offset:8192
    ds_read_b64_tr_b16 v[36:37], v22 offset:9216
    ds_read_b64_tr_b16 v[38:39], v23 offset:8192
    ds_read_b64_tr_b16 v[40:41], v23 offset:9216
    ds_read_b128 v[42:45], v19 offset:0
    ds_read_b128 v[46:49], v19 offset:2048
    ds_read_b64_tr_b16 v[50:51], v22 offset:12288
    ds_read_b64_tr_b16 v[52:53], v22 offset:13312
    ds_read_b64_tr_b16 v[54:55], v23 offset:12288
    ds_read_b64_tr_b16 v[56:57], v23 offset:13312
    s_add_u32 m0, s52, 49152
    s_nop 0
    buffer_load_dwordx4 v10, s[8:11], s50 offen lds
    s_add_u32 m0, s52, 50176
    s_nop 0
    buffer_load_dwordx4 v11, s[8:11], s50 offen lds
    s_add_u32 m0, s53, 49152
    s_nop 0
    buffer_load_dwordx4 v14, s[12:15], s51 offen lds
    s_add_u32 m0, s53, 50176
    s_nop 0
    buffer_load_dwordx4 v15, s[12:15], s51 offen lds
    s_add_u32 s50, s50, 64
    s_add_u32 s51, s51, 229376
    s_waitcnt lgkmcnt(6)
    v_mfma_f32_32x32x16_bf16 v[64:79], v[34:37], v[26:29], v[64:79]
    v_mfma_f32_32x32x16_bf16 v[80:95], v[38:41], v[26:29], v[80:95]
    v_mfma_f32_32x32x16_bf16 v[96:111], v[34:37], v[30:33], v[96:111]
    v_mfma_f32_32x32x16_bf16 v[112:127], v[38:41], v[30:33], v[112:127]
    s_waitcnt lgkmcnt(0)
    v_mfma_f32_32x32x16_bf16 v[64:79], v[50:53], v[42:45], v[64:79]
    v_mfma_f32_32x32x16_bf16 v[80:95], v[54:57], v[42:45], v[80:95]
    v_mfma_f32_32x32x16_bf16 v[96:111], v[50:53], v[46:49], v[96:111]
    v_mfma_f32_32x32x16_bf16 v[112:127], v[54:57], v[46:49], v[112:127]
    s_waitcnt vmcnt(8)
    s_barrier
    ds_read_b128 v[26:29], v18 offset:16384
    ds_read_b128 v[30:33], v18 offset:18432
    ds_read_b64_tr_b16 v[34:35], v22 offset:24576
    ds_read_b64_tr_b16 v[36:37], v22 offset:25600
    ds_read_b64_tr_b16 v[38:39], v23 offset:24576
    ds_read_b64_tr_b16 v[40:41], v23 offset:25600
    ds_read_b128 v[42:45], v19 offset:16384
    ds_read_b128 v[46:49], v19 offset:18432
    ds_read_b64_tr_b16 v[50:51], v22 offset:28672
    ds_read_b64_tr_b16 v[52:53], v22 offset:29696
    ds_read_b64_tr_b16 v[54:55], v23 offset:28672
    ds_read_b64_tr_b16 v[56:57], v23 offset:29696
    s_add_u32 m0, s52, 0
    s_nop 0
    buffer_load_dwordx4 v10, s[8:11], s50 offen lds
    s_add_u32 m0, s52, 1024
    s_nop 0
    buffer_load_dwordx4 v11, s[8:11], s50 offen lds
    s_add_u32 m0, s53, 0
    s_nop 0
    buffer_load_dwordx4 v14, s[12:15], s51 offen lds
    s_add_u32 m0, s53, 1024
    s_nop 0
    buffer_load_dwordx4 v15, s[12:15], s51 offen lds
    s_add_u32 s50, s50, 64
    s_add_u32 s51, s51, 229376
    s_waitcnt lgkmcnt(6)
    v_mfma_f32_32x32x16_bf16 v[64:79], v[34:37], v[26:29], v[64:79]
    v_mfma_f32_32x32x16_bf16 v[80:95], v[38:41], v[26:29], v[80:95]
    v_mfma_f32_32x32x16_bf16 v[96:111], v[34:37], v[30:33], v[96:111]
    v_mfma_f32_32x32x16_bf16 v[112:127], v[38:41], v[30:33], v[112:127]
    s_waitcnt lgkmcnt(0)
    v_mfma_f32_32x32x16_bf16 v[64:79], v[50:53], v[42:45], v[64:79]
    v_mfma_f32_32x32x16_bf16 v[80:95], v[54:57], v[42:45], v[80:95]
    v_mfma_f32_32x32x16_bf16 v[96:111], v[50:53], v[46:49], v[96:111]
    v_mfma_f32_32x32x16_bf16 v[112:127], v[54:57], v[46:49], v[112:127]
    s_waitcnt vmcnt(8)
    s_barrier
    ds_read_b128 v[26:29], v18 offset:32768
    ds_read_b128 v[30:33], v18 offset:34816
    ds_read_b64_tr_b16 v[34:35], v22 offset:40960
    ds_read_b64_tr_b16 v[36:37], v22 offset:41984
    ds_read_b64_tr_b16 v[38:39], v23 offset:40960
    ds_read_b64_tr_b16 v[40:41], v23 offset:41984
    ds_read_b128 v[42:45], v19 offset:32768
    ds_read_b128 v[46:49], v19 offset:34816
    ds_read_b64_tr_b16 v[50:51], v22 offset:45056
    ds_read_b64_tr_b16 v[52:53], v22 offset:46080
    ds_read_b64_tr_b16 v[54:55], v23 offset:45056
    ds_read_b64_tr_b16 v[56:57], v23 offset:46080
    s_add_u32 m0, s52, 16384
    s_nop 0
    buffer_load_dwordx4 v10, s[8:11], s50 offen lds
    s_add_u32 m0, s52, 17408
    s_nop 0
    buffer_load_dwordx4 v11, s[8:11], s50 offen lds
    s_add_u32 m0, s53, 16384
    s_nop 0
    buffer_load_dwordx4 v14, s[12:15], s51 offen lds
    s_add_u32 m0, s53, 17408
    s_nop 0
    buffer_load_dwordx4 v15, s[12:15], s51 offen lds
    s_add_u32 s50, s50, 64
    s_add_u32 s51, s51, 229376
    s_waitcnt lgkmcnt(6)
    v_mfma_f32_32x32x16_bf16 v[64:79], v[34:37], v[26:29], v[64:79]
    v_mfma_f32_32x32x16_bf16 v[80:95], v[38:41], v[26:29], v[80:95]
    v_mfma_f32_32x32x16_bf16 v[96:111], v[34:37], v[30:33], v[96:111]
    v_mfma_f32_32x32x16_bf16 v[112:127], v[38:41], v[30:33], v[112:127]
    s_waitcnt lgkmcnt(0)
    v_mfma_f32_32x32x16_bf16 v[64:79], v[50:53], v[42:45], v[64:79]
    v_mfma_f32_32x32x16_bf16 v[80:95], v[54:57], v[42:45], v[80:95]
    v_mfma_f32_32x32x16_bf16 v[96:111], v[50:53], v[46:49], v[96:111]
    v_mfma_f32_32x32x16_bf16 v[112:127], v[54:57], v[46:49], v[112:127]
    s_waitcnt vmcnt(8)
    s_barrier
    ds_read_b128 v[26:29], v18 offset:49152
    ds_read_b128 v[30:33], v18 offset:51200
    ds_read_b64_tr_b16 v[34:35], v22 offset:57344
    ds_read_b64_tr_b16 v[36:37], v22 offset:58368
    ds_read_b64_tr_b16 v[38:39], v23 offset:57344
    ds_read_b64_tr_b16 v[40:41], v23 offset:58368
    ds_read_b128 v[42:45], v19 offset:49152
    ds_read_b128 v[46:49], v19 offset:51200
    ds_read_b64_tr_b16 v[50:51], v22 offset:61440
    ds_read_b64_tr_b16 v[52:53], v22 offset:62464
    ds_read_b64_tr_b16 v[54:55], v23 offset:61440
    ds_read_b64_tr_b16 v[56:57], v23 offset:62464
    s_add_u32 m0, s52, 32768
    s_nop 0
    buffer_load_dwordx4 v10, s[8:11], s50 offen lds
    s_add_u32 m0, s52, 33792
    s_nop 0
    buffer_load_dwordx4 v11, s[8:11], s50 offen lds
    s_add_u32 m0, s53, 32768
    s_nop 0
    buffer_load_dwordx4 v14, s[12:15], s51 offen lds
    s_add_u32 m0, s53, 33792
    s_nop 0
    buffer_load_dwordx4 v15, s[12:15], s51 offen lds
    s_add_u32 s50, s50, 64
    s_add_u32 s51, s51, 229376
    s_waitcnt lgkmcnt(6)
    v_mfma_f32_32x32x16_bf16 v[64:79], v[34:37], v[26:29], v[64:79]
    v_mfma_f32_32x32x16_bf16 v[80:95], v[38:41], v[26:29], v[80:95]
    v_mfma_f32_32x32x16_bf16 v[96:111], v[34:37], v[30:33], v[96:111]
    v_mfma_f32_32x32x16_bf16 v[112:127], v[38:41], v[30:33], v[112:127]
    s_waitcnt lgkmcnt(0)
    v_mfma_f32_32x32x16_bf16 v[64:79], v[50:53], v[42:45], v[64:79]
    v_mfma_f32_32x32x16_bf16 v[80:95], v[54:57], v[42:45], v[80:95]
    v_mfma_f32_32x32x16_bf16 v[96:111], v[50:53], v[46:49], v[96:111]
    v_mfma_f32_32x32x16_bf16 v[112:127], v[54:57], v[46:49], v[112:127]
    s_add_u32 s54, s54, 4
    s_cmp_lt_u32 s54, 32
    s_cbranch_scc1 L_g_loop_38
    s_nop 15
    s_waitcnt vmcnt(0)
    v_and_b32 v3, 31, v1
    s_lshl_b32 s45, s40, 7
    s_lshl_b32 s46, s48, 6
    s_add_u32 s45, s45, s46
    v_add_u32 v3, s45, v3
    v_lshrrev_b32 v4, 5, v1
    v_lshlrev_b32 v4, 2, v4
    s_mul_i32 s45, s41, 128
    s_mul_i32 s46, s49, 64
    s_add_u32 s45, s45, s46
    v_add_u32 v4, s45, v4
    s_mov_b32 s47, 7168
    v_mul_lo_u32 v5, v3, s47
    v_lshlrev_b32 v6, 1, v4
    v_add_u32 v5, v5, v6
    v_lshrrev_b32 v61, 5, v1
    v_lshlrev_b32 v61, 3, v61
    v_add_u32 v61, v61, v5
    s_mov_b32 s32, s4
    s_and_b32 s33, s5, 0xffff
    s_mov_b32 s34, 0x1c00
    s_mov_b32 s35, 0x00020000
    v_lshlrev_b32 v8, 1, v4
    buffer_load_dwordx2 v[42:43], v8, s[32:35], 0 offen offset:0
    buffer_load_dwordx2 v[44:45], v8, s[32:35], 0 offen offset:16
    buffer_load_dwordx2 v[46:47], v8, s[32:35], 0 offen offset:32
    buffer_load_dwordx2 v[48:49], v8, s[32:35], 0 offen offset:48
    s_waitcnt vmcnt(0)
    v_cvt_pk_bf16_f32 v64, v64, v64
    v_lshlrev_b32 v64, 16, v64
    v_lshlrev_b32 v60, 16, v42
    v_add_f32 v64, v64, v60
    v_cvt_pk_bf16_f32 v64, v64, v64
    v_lshlrev_b32 v64, 16, v64
    v_mul_f32 v60, v64, v64
    v_mul_f32 v60, 0x3d372713, v60
    v_add_f32 v60, 1.0, v60
    v_mul_f32 v60, v60, v64
    v_mul_f32 v60, 0xc0135761, v60
    v_exp_f32 v60, v60
    s_nop 0
    v_add_f32 v60, 1.0, v60
    v_rcp_f32 v60, v60
    s_nop 0
    v_mul_f32 v64, v64, v60
    v_cvt_pk_bf16_f32 v65, v65, v65
    v_lshlrev_b32 v65, 16, v65
    v_and_b32 v60, 0xffff0000, v42
    v_add_f32 v65, v65, v60
    v_cvt_pk_bf16_f32 v65, v65, v65
    v_lshlrev_b32 v65, 16, v65
    v_mul_f32 v60, v65, v65
    v_mul_f32 v60, 0x3d372713, v60
    v_add_f32 v60, 1.0, v60
    v_mul_f32 v60, v60, v65
    v_mul_f32 v60, 0xc0135761, v60
    v_exp_f32 v60, v60
    s_nop 0
    v_add_f32 v60, 1.0, v60
    v_rcp_f32 v60, v60
    s_nop 0
    v_mul_f32 v65, v65, v60
    v_cvt_pk_bf16_f32 v66, v66, v66
    v_lshlrev_b32 v66, 16, v66
    v_lshlrev_b32 v60, 16, v43
    v_add_f32 v66, v66, v60
    v_cvt_pk_bf16_f32 v66, v66, v66
    v_lshlrev_b32 v66, 16, v66
    v_mul_f32 v60, v66, v66
    v_mul_f32 v60, 0x3d372713, v60
    v_add_f32 v60, 1.0, v60
    v_mul_f32 v60, v60, v66
    v_mul_f32 v60, 0xc0135761, v60
    v_exp_f32 v60, v60
    s_nop 0
    v_add_f32 v60, 1.0, v60
    v_rcp_f32 v60, v60
    s_nop 0
    v_mul_f32 v66, v66, v60
    v_cvt_pk_bf16_f32 v67, v67, v67
    v_lshlrev_b32 v67, 16, v67
    v_and_b32 v60, 0xffff0000, v43
    v_add_f32 v67, v67, v60
    v_cvt_pk_bf16_f32 v67, v67, v67
    v_lshlrev_b32 v67, 16, v67
    v_mul_f32 v60, v67, v67
    v_mul_f32 v60, 0x3d372713, v60
    v_add_f32 v60, 1.0, v60
    v_mul_f32 v60, v60, v67
    v_mul_f32 v60, 0xc0135761, v60
    v_exp_f32 v60, v60
    s_nop 0
    v_add_f32 v60, 1.0, v60
    v_rcp_f32 v60, v60
    s_nop 0
    v_mul_f32 v67, v67, v60
    v_cvt_pk_bf16_f32 v64, v64, v65
    v_cvt_pk_bf16_f32 v65, v66, v67
    v_cvt_pk_bf16_f32 v68, v68, v68
    v_lshlrev_b32 v68, 16, v68
    v_lshlrev_b32 v60, 16, v44
    v_add_f32 v68, v68, v60
    v_cvt_pk_bf16_f32 v68, v68, v68
    v_lshlrev_b32 v68, 16, v68
    v_mul_f32 v60, v68, v68
    v_mul_f32 v60, 0x3d372713, v60
    v_add_f32 v60, 1.0, v60
    v_mul_f32 v60, v60, v68
    v_mul_f32 v60, 0xc0135761, v60
    v_exp_f32 v60, v60
    s_nop 0
    v_add_f32 v60, 1.0, v60
    v_rcp_f32 v60, v60
    s_nop 0
    v_mul_f32 v68, v68, v60
    v_cvt_pk_bf16_f32 v69, v69, v69
    v_lshlrev_b32 v69, 16, v69
    v_and_b32 v60, 0xffff0000, v44
    v_add_f32 v69, v69, v60
    v_cvt_pk_bf16_f32 v69, v69, v69
    v_lshlrev_b32 v69, 16, v69
    v_mul_f32 v60, v69, v69
    v_mul_f32 v60, 0x3d372713, v60
    v_add_f32 v60, 1.0, v60
    v_mul_f32 v60, v60, v69
    v_mul_f32 v60, 0xc0135761, v60
    v_exp_f32 v60, v60
    s_nop 0
    v_add_f32 v60, 1.0, v60
    v_rcp_f32 v60, v60
    s_nop 0
    v_mul_f32 v69, v69, v60
    v_cvt_pk_bf16_f32 v70, v70, v70
    v_lshlrev_b32 v70, 16, v70
    v_lshlrev_b32 v60, 16, v45
    v_add_f32 v70, v70, v60
    v_cvt_pk_bf16_f32 v70, v70, v70
    v_lshlrev_b32 v70, 16, v70
    v_mul_f32 v60, v70, v70
    v_mul_f32 v60, 0x3d372713, v60
    v_add_f32 v60, 1.0, v60
    v_mul_f32 v60, v60, v70
    v_mul_f32 v60, 0xc0135761, v60
    v_exp_f32 v60, v60
    s_nop 0
    v_add_f32 v60, 1.0, v60
    v_rcp_f32 v60, v60
    s_nop 0
    v_mul_f32 v70, v70, v60
    v_cvt_pk_bf16_f32 v71, v71, v71
    v_lshlrev_b32 v71, 16, v71
    v_and_b32 v60, 0xffff0000, v45
    v_add_f32 v71, v71, v60
    v_cvt_pk_bf16_f32 v71, v71, v71
    v_lshlrev_b32 v71, 16, v71
    v_mul_f32 v60, v71, v71
    v_mul_f32 v60, 0x3d372713, v60
    v_add_f32 v60, 1.0, v60
    v_mul_f32 v60, v60, v71
    v_mul_f32 v60, 0xc0135761, v60
    v_exp_f32 v60, v60
    s_nop 0
    v_add_f32 v60, 1.0, v60
    v_rcp_f32 v60, v60
    s_nop 0
    v_mul_f32 v71, v71, v60
    v_cvt_pk_bf16_f32 v66, v68, v69
    v_cvt_pk_bf16_f32 v67, v70, v71
    v_cvt_pk_bf16_f32 v72, v72, v72
    v_lshlrev_b32 v72, 16, v72
    v_lshlrev_b32 v60, 16, v46
    v_add_f32 v72, v72, v60
    v_cvt_pk_bf16_f32 v72, v72, v72
    v_lshlrev_b32 v72, 16, v72
    v_mul_f32 v60, v72, v72
    v_mul_f32 v60, 0x3d372713, v60
    v_add_f32 v60, 1.0, v60
    v_mul_f32 v60, v60, v72
    v_mul_f32 v60, 0xc0135761, v60
    v_exp_f32 v60, v60
    s_nop 0
    v_add_f32 v60, 1.0, v60
    v_rcp_f32 v60, v60
    s_nop 0
    v_mul_f32 v72, v72, v60
    v_cvt_pk_bf16_f32 v73, v73, v73
    v_lshlrev_b32 v73, 16, v73
    v_and_b32 v60, 0xffff0000, v46
    v_add_f32 v73, v73, v60
    v_cvt_pk_bf16_f32 v73, v73, v73
    v_lshlrev_b32 v73, 16, v73
    v_mul_f32 v60, v73, v73
    v_mul_f32 v60, 0x3d372713, v60
    v_add_f32 v60, 1.0, v60
    v_mul_f32 v60, v60, v73
    v_mul_f32 v60, 0xc0135761, v60
    v_exp_f32 v60, v60
    s_nop 0
    v_add_f32 v60, 1.0, v60
    v_rcp_f32 v60, v60
    s_nop 0
    v_mul_f32 v73, v73, v60
    v_cvt_pk_bf16_f32 v74, v74, v74
    v_lshlrev_b32 v74, 16, v74
    v_lshlrev_b32 v60, 16, v47
    v_add_f32 v74, v74, v60
    v_cvt_pk_bf16_f32 v74, v74, v74
    v_lshlrev_b32 v74, 16, v74
    v_mul_f32 v60, v74, v74
    v_mul_f32 v60, 0x3d372713, v60
    v_add_f32 v60, 1.0, v60
    v_mul_f32 v60, v60, v74
    v_mul_f32 v60, 0xc0135761, v60
    v_exp_f32 v60, v60
    s_nop 0
    v_add_f32 v60, 1.0, v60
    v_rcp_f32 v60, v60
    s_nop 0
    v_mul_f32 v74, v74, v60
    v_cvt_pk_bf16_f32 v75, v75, v75
    v_lshlrev_b32 v75, 16, v75
    v_and_b32 v60, 0xffff0000, v47
    v_add_f32 v75, v75, v60
    v_cvt_pk_bf16_f32 v75, v75, v75
    v_lshlrev_b32 v75, 16, v75
    v_mul_f32 v60, v75, v75
    v_mul_f32 v60, 0x3d372713, v60
    v_add_f32 v60, 1.0, v60
    v_mul_f32 v60, v60, v75
    v_mul_f32 v60, 0xc0135761, v60
    v_exp_f32 v60, v60
    s_nop 0
    v_add_f32 v60, 1.0, v60
    v_rcp_f32 v60, v60
    s_nop 0
    v_mul_f32 v75, v75, v60
    v_cvt_pk_bf16_f32 v72, v72, v73
    v_cvt_pk_bf16_f32 v73, v74, v75
    v_cvt_pk_bf16_f32 v76, v76, v76
    v_lshlrev_b32 v76, 16, v76
    v_lshlrev_b32 v60, 16, v48
    v_add_f32 v76, v76, v60
    v_cvt_pk_bf16_f32 v76, v76, v76
    v_lshlrev_b32 v76, 16, v76
    v_mul_f32 v60, v76, v76
    v_mul_f32 v60, 0x3d372713, v60
    v_add_f32 v60, 1.0, v60
    v_mul_f32 v60, v60, v76
    v_mul_f32 v60, 0xc0135761, v60
    v_exp_f32 v60, v60
    s_nop 0
    v_add_f32 v60, 1.0, v60
    v_rcp_f32 v60, v60
    s_nop 0
    v_mul_f32 v76, v76, v60
    v_cvt_pk_bf16_f32 v77, v77, v77
    v_lshlrev_b32 v77, 16, v77
    v_and_b32 v60, 0xffff0000, v48
    v_add_f32 v77, v77, v60
    v_cvt_pk_bf16_f32 v77, v77, v77
    v_lshlrev_b32 v77, 16, v77
    v_mul_f32 v60, v77, v77
    v_mul_f32 v60, 0x3d372713, v60
    v_add_f32 v60, 1.0, v60
    v_mul_f32 v60, v60, v77
    v_mul_f32 v60, 0xc0135761, v60
    v_exp_f32 v60, v60
    s_nop 0
    v_add_f32 v60, 1.0, v60
    v_rcp_f32 v60, v60
    s_nop 0
    v_mul_f32 v77, v77, v60
    v_cvt_pk_bf16_f32 v78, v78, v78
    v_lshlrev_b32 v78, 16, v78
    v_lshlrev_b32 v60, 16, v49
    v_add_f32 v78, v78, v60
    v_cvt_pk_bf16_f32 v78, v78, v78
    v_lshlrev_b32 v78, 16, v78
    v_mul_f32 v60, v78, v78
    v_mul_f32 v60, 0x3d372713, v60
    v_add_f32 v60, 1.0, v60
    v_mul_f32 v60, v60, v78
    v_mul_f32 v60, 0xc0135761, v60
    v_exp_f32 v60, v60
    s_nop 0
    v_add_f32 v60, 1.0, v60
    v_rcp_f32 v60, v60
    s_nop 0
    v_mul_f32 v78, v78, v60
    v_cvt_pk_bf16_f32 v79, v79, v79
    v_lshlrev_b32 v79, 16, v79
    v_and_b32 v60, 0xffff0000, v49
    v_add_f32 v79, v79, v60
    v_cvt_pk_bf16_f32 v79, v79, v79
    v_lshlrev_b32 v79, 16, v79
    v_mul_f32 v60, v79, v79
    v_mul_f32 v60, 0x3d372713, v60
    v_add_f32 v60, 1.0, v60
    v_mul_f32 v60, v60, v79
    v_mul_f32 v60, 0xc0135761, v60
    v_exp_f32 v60, v60
    s_nop 0
    v_add_f32 v60, 1.0, v60
    v_rcp_f32 v60, v60
    s_nop 0
    v_mul_f32 v79, v79, v60
    v_cvt_pk_bf16_f32 v74, v76, v77
    v_cvt_pk_bf16_f32 v75, v78, v79
    v_mov_b32 v9, v61
    s_nop 0
    v_permlane32_swap_b32 v64, v66
    v_permlane32_swap_b32 v65, v67
    v_permlane32_swap_b32 v72, v74
    v_permlane32_swap_b32 v73, v75
    buffer_store_dwordx4 v[64:67], v9, s[16:19], 0 offen offset:0
    buffer_store_dwordx4 v[72:75], v9, s[16:19], 0 offen offset:32
    s_waitcnt vmcnt(0)
    v_cvt_pk_bf16_f32 v96, v96, v96
    v_lshlrev_b32 v96, 16, v96
    v_lshlrev_b32 v60, 16, v42
    v_add_f32 v96, v96, v60
    v_cvt_pk_bf16_f32 v96, v96, v96
    v_lshlrev_b32 v96, 16, v96
    v_mul_f32 v60, v96, v96
    v_mul_f32 v60, 0x3d372713, v60
    v_add_f32 v60, 1.0, v60
    v_mul_f32 v60, v60, v96
    v_mul_f32 v60, 0xc0135761, v60
    v_exp_f32 v60, v60
    s_nop 0
    v_add_f32 v60, 1.0, v60
    v_rcp_f32 v60, v60
    s_nop 0
    v_mul_f32 v96, v96, v60
    v_cvt_pk_bf16_f32 v97, v97, v97
    v_lshlrev_b32 v97, 16, v97
    v_and_b32 v60, 0xffff0000, v42
    v_add_f32 v97, v97, v60
    v_cvt_pk_bf16_f32 v97, v97, v97
    v_lshlrev_b32 v97, 16, v97
    v_mul_f32 v60, v97, v97
    v_mul_f32 v60, 0x3d372713, v60
    v_add_f32 v60, 1.0, v60
    v_mul_f32 v60, v60, v97
    v_mul_f32 v60, 0xc0135761, v60
    v_exp_f32 v60, v60
    s_nop 0
    v_add_f32 v60, 1.0, v60
    v_rcp_f32 v60, v60
    s_nop 0
    v_mul_f32 v97, v97, v60
    v_cvt_pk_bf16_f32 v98, v98, v98
    v_lshlrev_b32 v98, 16, v98
    v_lshlrev_b32 v60, 16, v43
    v_add_f32 v98, v98, v60
    v_cvt_pk_bf16_f32 v98, v98, v98
    v_lshlrev_b32 v98, 16, v98
    v_mul_f32 v60, v98, v98
    v_mul_f32 v60, 0x3d372713, v60
    v_add_f32 v60, 1.0, v60
    v_mul_f32 v60, v60, v98
    v_mul_f32 v60, 0xc0135761, v60
    v_exp_f32 v60, v60
    s_nop 0
    v_add_f32 v60, 1.0, v60
    v_rcp_f32 v60, v60
    s_nop 0
    v_mul_f32 v98, v98, v60
    v_cvt_pk_bf16_f32 v99, v99, v99
    v_lshlrev_b32 v99, 16, v99
    v_and_b32 v60, 0xffff0000, v43
    v_add_f32 v99, v99, v60
    v_cvt_pk_bf16_f32 v99, v99, v99
    v_lshlrev_b32 v99, 16, v99
    v_mul_f32 v60, v99, v99
    v_mul_f32 v60, 0x3d372713, v60
    v_add_f32 v60, 1.0, v60
    v_mul_f32 v60, v60, v99
    v_mul_f32 v60, 0xc0135761, v60
    v_exp_f32 v60, v60
    s_nop 0
    v_add_f32 v60, 1.0, v60
    v_rcp_f32 v60, v60
    s_nop 0
    v_mul_f32 v99, v99, v60
    v_cvt_pk_bf16_f32 v96, v96, v97
    v_cvt_pk_bf16_f32 v97, v98, v99
    v_cvt_pk_bf16_f32 v100, v100, v100
    v_lshlrev_b32 v100, 16, v100
    v_lshlrev_b32 v60, 16, v44
    v_add_f32 v100, v100, v60
    v_cvt_pk_bf16_f32 v100, v100, v100
    v_lshlrev_b32 v100, 16, v100
    v_mul_f32 v60, v100, v100
    v_mul_f32 v60, 0x3d372713, v60
    v_add_f32 v60, 1.0, v60
    v_mul_f32 v60, v60, v100
    v_mul_f32 v60, 0xc0135761, v60
    v_exp_f32 v60, v60
    s_nop 0
    v_add_f32 v60, 1.0, v60
    v_rcp_f32 v60, v60
    s_nop 0
    v_mul_f32 v100, v100, v60
    v_cvt_pk_bf16_f32 v101, v101, v101
    v_lshlrev_b32 v101, 16, v101
    v_and_b32 v60, 0xffff0000, v44
    v_add_f32 v101, v101, v60
    v_cvt_pk_bf16_f32 v101, v101, v101
    v_lshlrev_b32 v101, 16, v101
    v_mul_f32 v60, v101, v101
    v_mul_f32 v60, 0x3d372713, v60
    v_add_f32 v60, 1.0, v60
    v_mul_f32 v60, v60, v101
    v_mul_f32 v60, 0xc0135761, v60
    v_exp_f32 v60, v60
    s_nop 0
    v_add_f32 v60, 1.0, v60
    v_rcp_f32 v60, v60
    s_nop 0
    v_mul_f32 v101, v101, v60
    v_cvt_pk_bf16_f32 v102, v102, v102
    v_lshlrev_b32 v102, 16, v102
    v_lshlrev_b32 v60, 16, v45
    v_add_f32 v102, v102, v60
    v_cvt_pk_bf16_f32 v102, v102, v102
    v_lshlrev_b32 v102, 16, v102
    v_mul_f32 v60, v102, v102
    v_mul_f32 v60, 0x3d372713, v60
    v_add_f32 v60, 1.0, v60
    v_mul_f32 v60, v60, v102
    v_mul_f32 v60, 0xc0135761, v60
    v_exp_f32 v60, v60
    s_nop 0
    v_add_f32 v60, 1.0, v60
    v_rcp_f32 v60, v60
    s_nop 0
    v_mul_f32 v102, v102, v60
    v_cvt_pk_bf16_f32 v103, v103, v103
    v_lshlrev_b32 v103, 16, v103
    v_and_b32 v60, 0xffff0000, v45
    v_add_f32 v103, v103, v60
    v_cvt_pk_bf16_f32 v103, v103, v103
    v_lshlrev_b32 v103, 16, v103
    v_mul_f32 v60, v103, v103
    v_mul_f32 v60, 0x3d372713, v60
    v_add_f32 v60, 1.0, v60
    v_mul_f32 v60, v60, v103
    v_mul_f32 v60, 0xc0135761, v60
    v_exp_f32 v60, v60
    s_nop 0
    v_add_f32 v60, 1.0, v60
    v_rcp_f32 v60, v60
    s_nop 0
    v_mul_f32 v103, v103, v60
    v_cvt_pk_bf16_f32 v98, v100, v101
    v_cvt_pk_bf16_f32 v99, v102, v103
    v_cvt_pk_bf16_f32 v104, v104, v104
    v_lshlrev_b32 v104, 16, v104
    v_lshlrev_b32 v60, 16, v46
    v_add_f32 v104, v104, v60
    v_cvt_pk_bf16_f32 v104, v104, v104
    v_lshlrev_b32 v104, 16, v104
    v_mul_f32 v60, v104, v104
    v_mul_f32 v60, 0x3d372713, v60
    v_add_f32 v60, 1.0, v60
    v_mul_f32 v60, v60, v104
    v_mul_f32 v60, 0xc0135761, v60
    v_exp_f32 v60, v60
    s_nop 0
    v_add_f32 v60, 1.0, v60
    v_rcp_f32 v60, v60
    s_nop 0
    v_mul_f32 v104, v104, v60
    v_cvt_pk_bf16_f32 v105, v105, v105
    v_lshlrev_b32 v105, 16, v105
    v_and_b32 v60, 0xffff0000, v46
    v_add_f32 v105, v105, v60
    v_cvt_pk_bf16_f32 v105, v105, v105
    v_lshlrev_b32 v105, 16, v105
    v_mul_f32 v60, v105, v105
    v_mul_f32 v60, 0x3d372713, v60
    v_add_f32 v60, 1.0, v60
    v_mul_f32 v60, v60, v105
    v_mul_f32 v60, 0xc0135761, v60
    v_exp_f32 v60, v60
    s_nop 0
    v_add_f32 v60, 1.0, v60
    v_rcp_f32 v60, v60
    s_nop 0
    v_mul_f32 v105, v105, v60
    v_cvt_pk_bf16_f32 v106, v106, v106
    v_lshlrev_b32 v106, 16, v106
    v_lshlrev_b32 v60, 16, v47
    v_add_f32 v106, v106, v60
    v_cvt_pk_bf16_f32 v106, v106, v106
    v_lshlrev_b32 v106, 16, v106
    v_mul_f32 v60, v106, v106
    v_mul_f32 v60, 0x3d372713, v60
    v_add_f32 v60, 1.0, v60
    v_mul_f32 v60, v60, v106
    v_mul_f32 v60, 0xc0135761, v60
    v_exp_f32 v60, v60
    s_nop 0
    v_add_f32 v60, 1.0, v60
    v_rcp_f32 v60, v60
    s_nop 0
    v_mul_f32 v106, v106, v60
    v_cvt_pk_bf16_f32 v107, v107, v107
    v_lshlrev_b32 v107, 16, v107
    v_and_b32 v60, 0xffff0000, v47
    v_add_f32 v107, v107, v60
    v_cvt_pk_bf16_f32 v107, v107, v107
    v_lshlrev_b32 v107, 16, v107
    v_mul_f32 v60, v107, v107
    v_mul_f32 v60, 0x3d372713, v60
    v_add_f32 v60, 1.0, v60
    v_mul_f32 v60, v60, v107
    v_mul_f32 v60, 0xc0135761, v60
    v_exp_f32 v60, v60
    s_nop 0
    v_add_f32 v60, 1.0, v60
    v_rcp_f32 v60, v60
    s_nop 0
    v_mul_f32 v107, v107, v60
    v_cvt_pk_bf16_f32 v104, v104, v105
    v_cvt_pk_bf16_f32 v105, v106, v107
    v_cvt_pk_bf16_f32 v108, v108, v108
    v_lshlrev_b32 v108, 16, v108
    v_lshlrev_b32 v60, 16, v48
    v_add_f32 v108, v108, v60
    v_cvt_pk_bf16_f32 v108, v108, v108
    v_lshlrev_b32 v108, 16, v108
    v_mul_f32 v60, v108, v108
    v_mul_f32 v60, 0x3d372713, v60
    v_add_f32 v60, 1.0, v60
    v_mul_f32 v60, v60, v108
    v_mul_f32 v60, 0xc0135761, v60
    v_exp_f32 v60, v60
    s_nop 0
    v_add_f32 v60, 1.0, v60
    v_rcp_f32 v60, v60
    s_nop 0
    v_mul_f32 v108, v108, v60
    v_cvt_pk_bf16_f32 v109, v109, v109
    v_lshlrev_b32 v109, 16, v109
    v_and_b32 v60, 0xffff0000, v48
    v_add_f32 v109, v109, v60
    v_cvt_pk_bf16_f32 v109, v109, v109
    v_lshlrev_b32 v109, 16, v109
    v_mul_f32 v60, v109, v109
    v_mul_f32 v60, 0x3d372713, v60
    v_add_f32 v60, 1.0, v60
    v_mul_f32 v60, v60, v109
    v_mul_f32 v60, 0xc0135761, v60
    v_exp_f32 v60, v60
    s_nop 0
    v_add_f32 v60, 1.0, v60
    v_rcp_f32 v60, v60
    s_nop 0
    v_mul_f32 v109, v109, v60
    v_cvt_pk_bf16_f32 v110, v110, v110
    v_lshlrev_b32 v110, 16, v110
    v_lshlrev_b32 v60, 16, v49
    v_add_f32 v110, v110, v60
    v_cvt_pk_bf16_f32 v110, v110, v110
    v_lshlrev_b32 v110, 16, v110
    v_mul_f32 v60, v110, v110
    v_mul_f32 v60, 0x3d372713, v60
    v_add_f32 v60, 1.0, v60
    v_mul_f32 v60, v60, v110
    v_mul_f32 v60, 0xc0135761, v60
    v_exp_f32 v60, v60
    s_nop 0
    v_add_f32 v60, 1.0, v60
    v_rcp_f32 v60, v60
    s_nop 0
    v_mul_f32 v110, v110, v60
    v_cvt_pk_bf16_f32 v111, v111, v111
    v_lshlrev_b32 v111, 16, v111
    v_and_b32 v60, 0xffff0000, v49
    v_add_f32 v111, v111, v60
    v_cvt_pk_bf16_f32 v111, v111, v111
    v_lshlrev_b32 v111, 16, v111
    v_mul_f32 v60, v111, v111
    v_mul_f32 v60, 0x3d372713, v60
    v_add_f32 v60, 1.0, v60
    v_mul_f32 v60, v60, v111
    v_mul_f32 v60, 0xc0135761, v60
    v_exp_f32 v60, v60
    s_nop 0
    v_add_f32 v60, 1.0, v60
    v_rcp_f32 v60, v60
    s_nop 0
    v_mul_f32 v111, v111, v60
    v_cvt_pk_bf16_f32 v106, v108, v109
    v_cvt_pk_bf16_f32 v107, v110, v111
    v_add_u32 v9, 229376, v61
    s_nop 0
    v_permlane32_swap_b32 v96, v98
    v_permlane32_swap_b32 v97, v99
    v_permlane32_swap_b32 v104, v106
    v_permlane32_swap_b32 v105, v107
    buffer_store_dwordx4 v[96:99], v9, s[16:19], 0 offen offset:0
    buffer_store_dwordx4 v[104:107], v9, s[16:19], 0 offen offset:32
    v_lshlrev_b32 v8, 1, v4
    buffer_load_dwordx2 v[42:43], v8, s[32:35], 0 offen offset:64
    buffer_load_dwordx2 v[44:45], v8, s[32:35], 0 offen offset:80
    buffer_load_dwordx2 v[46:47], v8, s[32:35], 0 offen offset:96
    buffer_load_dwordx2 v[48:49], v8, s[32:35], 0 offen offset:112
    s_waitcnt vmcnt(0)
    v_cvt_pk_bf16_f32 v80, v80, v80
    v_lshlrev_b32 v80, 16, v80
    v_lshlrev_b32 v60, 16, v42
    v_add_f32 v80, v80, v60
    v_cvt_pk_bf16_f32 v80, v80, v80
    v_lshlrev_b32 v80, 16, v80
    v_mul_f32 v60, v80, v80
    v_mul_f32 v60, 0x3d372713, v60
    v_add_f32 v60, 1.0, v60
    v_mul_f32 v60, v60, v80
    v_mul_f32 v60, 0xc0135761, v60
    v_exp_f32 v60, v60
    s_nop 0
    v_add_f32 v60, 1.0, v60
    v_rcp_f32 v60, v60
    s_nop 0
    v_mul_f32 v80, v80, v60
    v_cvt_pk_bf16_f32 v81, v81, v81
    v_lshlrev_b32 v81, 16, v81
    v_and_b32 v60, 0xffff0000, v42
    v_add_f32 v81, v81, v60
    v_cvt_pk_bf16_f32 v81, v81, v81
    v_lshlrev_b32 v81, 16, v81
    v_mul_f32 v60, v81, v81
    v_mul_f32 v60, 0x3d372713, v60
    v_add_f32 v60, 1.0, v60
    v_mul_f32 v60, v60, v81
    v_mul_f32 v60, 0xc0135761, v60
    v_exp_f32 v60, v60
    s_nop 0
    v_add_f32 v60, 1.0, v60
    v_rcp_f32 v60, v60
    s_nop 0
    v_mul_f32 v81, v81, v60
    v_cvt_pk_bf16_f32 v82, v82, v82
    v_lshlrev_b32 v82, 16, v82
    v_lshlrev_b32 v60, 16, v43
    v_add_f32 v82, v82, v60
    v_cvt_pk_bf16_f32 v82, v82, v82
    v_lshlrev_b32 v82, 16, v82
    v_mul_f32 v60, v82, v82
    v_mul_f32 v60, 0x3d372713, v60
    v_add_f32 v60, 1.0, v60
    v_mul_f32 v60, v60, v82
    v_mul_f32 v60, 0xc0135761, v60
    v_exp_f32 v60, v60
    s_nop 0
    v_add_f32 v60, 1.0, v60
    v_rcp_f32 v60, v60
    s_nop 0
    v_mul_f32 v82, v82, v60
    v_cvt_pk_bf16_f32 v83, v83, v83
    v_lshlrev_b32 v83, 16, v83
    v_and_b32 v60, 0xffff0000, v43
    v_add_f32 v83, v83, v60
    v_cvt_pk_bf16_f32 v83, v83, v83
    v_lshlrev_b32 v83, 16, v83
    v_mul_f32 v60, v83, v83
    v_mul_f32 v60, 0x3d372713, v60
    v_add_f32 v60, 1.0, v60
    v_mul_f32 v60, v60, v83
    v_mul_f32 v60, 0xc0135761, v60
    v_exp_f32 v60, v60
    s_nop 0
    v_add_f32 v60, 1.0, v60
    v_rcp_f32 v60, v60
    s_nop 0
    v_mul_f32 v83, v83, v60
    v_cvt_pk_bf16_f32 v80, v80, v81
    v_cvt_pk_bf16_f32 v81, v82, v83
    v_cvt_pk_bf16_f32 v84, v84, v84
    v_lshlrev_b32 v84, 16, v84
    v_lshlrev_b32 v60, 16, v44
    v_add_f32 v84, v84, v60
    v_cvt_pk_bf16_f32 v84, v84, v84
    v_lshlrev_b32 v84, 16, v84
    v_mul_f32 v60, v84, v84
    v_mul_f32 v60, 0x3d372713, v60
    v_add_f32 v60, 1.0, v60
    v_mul_f32 v60, v60, v84
    v_mul_f32 v60, 0xc0135761, v60
    v_exp_f32 v60, v60
    s_nop 0
    v_add_f32 v60, 1.0, v60
    v_rcp_f32 v60, v60
    s_nop 0
    v_mul_f32 v84, v84, v60
    v_cvt_pk_bf16_f32 v85, v85, v85
    v_lshlrev_b32 v85, 16, v85
    v_and_b32 v60, 0xffff0000, v44
    v_add_f32 v85, v85, v60
    v_cvt_pk_bf16_f32 v85, v85, v85
    v_lshlrev_b32 v85, 16, v85
    v_mul_f32 v60, v85, v85
    v_mul_f32 v60, 0x3d372713, v60
    v_add_f32 v60, 1.0, v60
    v_mul_f32 v60, v60, v85
    v_mul_f32 v60, 0xc0135761, v60
    v_exp_f32 v60, v60
    s_nop 0
    v_add_f32 v60, 1.0, v60
    v_rcp_f32 v60, v60
    s_nop 0
    v_mul_f32 v85, v85, v60
    v_cvt_pk_bf16_f32 v86, v86, v86
    v_lshlrev_b32 v86, 16, v86
    v_lshlrev_b32 v60, 16, v45
    v_add_f32 v86, v86, v60
    v_cvt_pk_bf16_f32 v86, v86, v86
    v_lshlrev_b32 v86, 16, v86
    v_mul_f32 v60, v86, v86
    v_mul_f32 v60, 0x3d372713, v60
    v_add_f32 v60, 1.0, v60
    v_mul_f32 v60, v60, v86
    v_mul_f32 v60, 0xc0135761, v60
    v_exp_f32 v60, v60
    s_nop 0
    v_add_f32 v60, 1.0, v60
    v_rcp_f32 v60, v60
    s_nop 0
    v_mul_f32 v86, v86, v60
    v_cvt_pk_bf16_f32 v87, v87, v87
    v_lshlrev_b32 v87, 16, v87
    v_and_b32 v60, 0xffff0000, v45
    v_add_f32 v87, v87, v60
    v_cvt_pk_bf16_f32 v87, v87, v87
    v_lshlrev_b32 v87, 16, v87
    v_mul_f32 v60, v87, v87
    v_mul_f32 v60, 0x3d372713, v60
    v_add_f32 v60, 1.0, v60
    v_mul_f32 v60, v60, v87
    v_mul_f32 v60, 0xc0135761, v60
    v_exp_f32 v60, v60
    s_nop 0
    v_add_f32 v60, 1.0, v60
    v_rcp_f32 v60, v60
    s_nop 0
    v_mul_f32 v87, v87, v60
    v_cvt_pk_bf16_f32 v82, v84, v85
    v_cvt_pk_bf16_f32 v83, v86, v87
    v_cvt_pk_bf16_f32 v88, v88, v88
    v_lshlrev_b32 v88, 16, v88
    v_lshlrev_b32 v60, 16, v46
    v_add_f32 v88, v88, v60
    v_cvt_pk_bf16_f32 v88, v88, v88
    v_lshlrev_b32 v88, 16, v88
    v_mul_f32 v60, v88, v88
    v_mul_f32 v60, 0x3d372713, v60
    v_add_f32 v60, 1.0, v60
    v_mul_f32 v60, v60, v88
    v_mul_f32 v60, 0xc0135761, v60
    v_exp_f32 v60, v60
    s_nop 0
    v_add_f32 v60, 1.0, v60
    v_rcp_f32 v60, v60
    s_nop 0
    v_mul_f32 v88, v88, v60
    v_cvt_pk_bf16_f32 v89, v89, v89
    v_lshlrev_b32 v89, 16, v89
    v_and_b32 v60, 0xffff0000, v46
    v_add_f32 v89, v89, v60
    v_cvt_pk_bf16_f32 v89, v89, v89
    v_lshlrev_b32 v89, 16, v89
    v_mul_f32 v60, v89, v89
    v_mul_f32 v60, 0x3d372713, v60
    v_add_f32 v60, 1.0, v60
    v_mul_f32 v60, v60, v89
    v_mul_f32 v60, 0xc0135761, v60
    v_exp_f32 v60, v60
    s_nop 0
    v_add_f32 v60, 1.0, v60
    v_rcp_f32 v60, v60
    s_nop 0
    v_mul_f32 v89, v89, v60
    v_cvt_pk_bf16_f32 v90, v90, v90
    v_lshlrev_b32 v90, 16, v90
    v_lshlrev_b32 v60, 16, v47
    v_add_f32 v90, v90, v60
    v_cvt_pk_bf16_f32 v90, v90, v90
    v_lshlrev_b32 v90, 16, v90
    v_mul_f32 v60, v90, v90
    v_mul_f32 v60, 0x3d372713, v60
    v_add_f32 v60, 1.0, v60
    v_mul_f32 v60, v60, v90
    v_mul_f32 v60, 0xc0135761, v60
    v_exp_f32 v60, v60
    s_nop 0
    v_add_f32 v60, 1.0, v60
    v_rcp_f32 v60, v60
    s_nop 0
    v_mul_f32 v90, v90, v60
    v_cvt_pk_bf16_f32 v91, v91, v91
    v_lshlrev_b32 v91, 16, v91
    v_and_b32 v60, 0xffff0000, v47
    v_add_f32 v91, v91, v60
    v_cvt_pk_bf16_f32 v91, v91, v91
    v_lshlrev_b32 v91, 16, v91
    v_mul_f32 v60, v91, v91
    v_mul_f32 v60, 0x3d372713, v60
    v_add_f32 v60, 1.0, v60
    v_mul_f32 v60, v60, v91
    v_mul_f32 v60, 0xc0135761, v60
    v_exp_f32 v60, v60
    s_nop 0
    v_add_f32 v60, 1.0, v60
    v_rcp_f32 v60, v60
    s_nop 0
    v_mul_f32 v91, v91, v60
    v_cvt_pk_bf16_f32 v88, v88, v89
    v_cvt_pk_bf16_f32 v89, v90, v91
    v_cvt_pk_bf16_f32 v92, v92, v92
    v_lshlrev_b32 v92, 16, v92
    v_lshlrev_b32 v60, 16, v48
    v_add_f32 v92, v92, v60
    v_cvt_pk_bf16_f32 v92, v92, v92
    v_lshlrev_b32 v92, 16, v92
    v_mul_f32 v60, v92, v92
    v_mul_f32 v60, 0x3d372713, v60
    v_add_f32 v60, 1.0, v60
    v_mul_f32 v60, v60, v92
    v_mul_f32 v60, 0xc0135761, v60
    v_exp_f32 v60, v60
    s_nop 0
    v_add_f32 v60, 1.0, v60
    v_rcp_f32 v60, v60
    s_nop 0
    v_mul_f32 v92, v92, v60
    v_cvt_pk_bf16_f32 v93, v93, v93
    v_lshlrev_b32 v93, 16, v93
    v_and_b32 v60, 0xffff0000, v48
    v_add_f32 v93, v93, v60
    v_cvt_pk_bf16_f32 v93, v93, v93
    v_lshlrev_b32 v93, 16, v93
    v_mul_f32 v60, v93, v93
    v_mul_f32 v60, 0x3d372713, v60
    v_add_f32 v60, 1.0, v60
    v_mul_f32 v60, v60, v93
    v_mul_f32 v60, 0xc0135761, v60
    v_exp_f32 v60, v60
    s_nop 0
    v_add_f32 v60, 1.0, v60
    v_rcp_f32 v60, v60
    s_nop 0
    v_mul_f32 v93, v93, v60
    v_cvt_pk_bf16_f32 v94, v94, v94
    v_lshlrev_b32 v94, 16, v94
    v_lshlrev_b32 v60, 16, v49
    v_add_f32 v94, v94, v60
    v_cvt_pk_bf16_f32 v94, v94, v94
    v_lshlrev_b32 v94, 16, v94
    v_mul_f32 v60, v94, v94
    v_mul_f32 v60, 0x3d372713, v60
    v_add_f32 v60, 1.0, v60
    v_mul_f32 v60, v60, v94
    v_mul_f32 v60, 0xc0135761, v60
    v_exp_f32 v60, v60
    s_nop 0
    v_add_f32 v60, 1.0, v60
    v_rcp_f32 v60, v60
    s_nop 0
    v_mul_f32 v94, v94, v60
    v_cvt_pk_bf16_f32 v95, v95, v95
    v_lshlrev_b32 v95, 16, v95
    v_and_b32 v60, 0xffff0000, v49
    v_add_f32 v95, v95, v60
    v_cvt_pk_bf16_f32 v95, v95, v95
    v_lshlrev_b32 v95, 16, v95
    v_mul_f32 v60, v95, v95
    v_mul_f32 v60, 0x3d372713, v60
    v_add_f32 v60, 1.0, v60
    v_mul_f32 v60, v60, v95
    v_mul_f32 v60, 0xc0135761, v60
    v_exp_f32 v60, v60
    s_nop 0
    v_add_f32 v60, 1.0, v60
    v_rcp_f32 v60, v60
    s_nop 0
    v_mul_f32 v95, v95, v60
    v_cvt_pk_bf16_f32 v90, v92, v93
    v_cvt_pk_bf16_f32 v91, v94, v95
    v_mov_b32 v9, v61
    s_nop 0
    v_permlane32_swap_b32 v80, v82
    v_permlane32_swap_b32 v81, v83
    v_permlane32_swap_b32 v88, v90
    v_permlane32_swap_b32 v89, v91
    buffer_store_dwordx4 v[80:83], v9, s[16:19], 0 offen offset:64
    buffer_store_dwordx4 v[88:91], v9, s[16:19], 0 offen offset:96
    s_waitcnt vmcnt(0)
    v_cvt_pk_bf16_f32 v112, v112, v112
    v_lshlrev_b32 v112, 16, v112
    v_lshlrev_b32 v60, 16, v42
    v_add_f32 v112, v112, v60
    v_cvt_pk_bf16_f32 v112, v112, v112
    v_lshlrev_b32 v112, 16, v112
    v_mul_f32 v60, v112, v112
    v_mul_f32 v60, 0x3d372713, v60
    v_add_f32 v60, 1.0, v60
    v_mul_f32 v60, v60, v112
    v_mul_f32 v60, 0xc0135761, v60
    v_exp_f32 v60, v60
    s_nop 0
    v_add_f32 v60, 1.0, v60
    v_rcp_f32 v60, v60
    s_nop 0
    v_mul_f32 v112, v112, v60
    v_cvt_pk_bf16_f32 v113, v113, v113
    v_lshlrev_b32 v113, 16, v113
    v_and_b32 v60, 0xffff0000, v42
    v_add_f32 v113, v113, v60
    v_cvt_pk_bf16_f32 v113, v113, v113
    v_lshlrev_b32 v113, 16, v113
    v_mul_f32 v60, v113, v113
    v_mul_f32 v60, 0x3d372713, v60
    v_add_f32 v60, 1.0, v60
    v_mul_f32 v60, v60, v113
    v_mul_f32 v60, 0xc0135761, v60
    v_exp_f32 v60, v60
    s_nop 0
    v_add_f32 v60, 1.0, v60
    v_rcp_f32 v60, v60
    s_nop 0
    v_mul_f32 v113, v113, v60
    v_cvt_pk_bf16_f32 v114, v114, v114
    v_lshlrev_b32 v114, 16, v114
    v_lshlrev_b32 v60, 16, v43
    v_add_f32 v114, v114, v60
    v_cvt_pk_bf16_f32 v114, v114, v114
    v_lshlrev_b32 v114, 16, v114
    v_mul_f32 v60, v114, v114
    v_mul_f32 v60, 0x3d372713, v60
    v_add_f32 v60, 1.0, v60
    v_mul_f32 v60, v60, v114
    v_mul_f32 v60, 0xc0135761, v60
    v_exp_f32 v60, v60
    s_nop 0
    v_add_f32 v60, 1.0, v60
    v_rcp_f32 v60, v60
    s_nop 0
    v_mul_f32 v114, v114, v60
    v_cvt_pk_bf16_f32 v115, v115, v115
    v_lshlrev_b32 v115, 16, v115
    v_and_b32 v60, 0xffff0000, v43
    v_add_f32 v115, v115, v60
    v_cvt_pk_bf16_f32 v115, v115, v115
    v_lshlrev_b32 v115, 16, v115
    v_mul_f32 v60, v115, v115
    v_mul_f32 v60, 0x3d372713, v60
    v_add_f32 v60, 1.0, v60
    v_mul_f32 v60, v60, v115
    v_mul_f32 v60, 0xc0135761, v60
    v_exp_f32 v60, v60
    s_nop 0
    v_add_f32 v60, 1.0, v60
    v_rcp_f32 v60, v60
    s_nop 0
    v_mul_f32 v115, v115, v60
    v_cvt_pk_bf16_f32 v112, v112, v113
    v_cvt_pk_bf16_f32 v113, v114, v115
    v_cvt_pk_bf16_f32 v116, v116, v116
    v_lshlrev_b32 v116, 16, v116
    v_lshlrev_b32 v60, 16, v44
    v_add_f32 v116, v116, v60
    v_cvt_pk_bf16_f32 v116, v116, v116
    v_lshlrev_b32 v116, 16, v116
    v_mul_f32 v60, v116, v116
    v_mul_f32 v60, 0x3d372713, v60
    v_add_f32 v60, 1.0, v60
    v_mul_f32 v60, v60, v116
    v_mul_f32 v60, 0xc0135761, v60
    v_exp_f32 v60, v60
    s_nop 0
    v_add_f32 v60, 1.0, v60
    v_rcp_f32 v60, v60
    s_nop 0
    v_mul_f32 v116, v116, v60
    v_cvt_pk_bf16_f32 v117, v117, v117
    v_lshlrev_b32 v117, 16, v117
    v_and_b32 v60, 0xffff0000, v44
    v_add_f32 v117, v117, v60
    v_cvt_pk_bf16_f32 v117, v117, v117
    v_lshlrev_b32 v117, 16, v117
    v_mul_f32 v60, v117, v117
    v_mul_f32 v60, 0x3d372713, v60
    v_add_f32 v60, 1.0, v60
    v_mul_f32 v60, v60, v117
    v_mul_f32 v60, 0xc0135761, v60
    v_exp_f32 v60, v60
    s_nop 0
    v_add_f32 v60, 1.0, v60
    v_rcp_f32 v60, v60
    s_nop 0
    v_mul_f32 v117, v117, v60
    v_cvt_pk_bf16_f32 v118, v118, v118
    v_lshlrev_b32 v118, 16, v118
    v_lshlrev_b32 v60, 16, v45
    v_add_f32 v118, v118, v60
    v_cvt_pk_bf16_f32 v118, v118, v118
    v_lshlrev_b32 v118, 16, v118
    v_mul_f32 v60, v118, v118
    v_mul_f32 v60, 0x3d372713, v60
    v_add_f32 v60, 1.0, v60
    v_mul_f32 v60, v60, v118
    v_mul_f32 v60, 0xc0135761, v60
    v_exp_f32 v60, v60
    s_nop 0
    v_add_f32 v60, 1.0, v60
    v_rcp_f32 v60, v60
    s_nop 0
    v_mul_f32 v118, v118, v60
    v_cvt_pk_bf16_f32 v119, v119, v119
    v_lshlrev_b32 v119, 16, v119
    v_and_b32 v60, 0xffff0000, v45
    v_add_f32 v119, v119, v60
    v_cvt_pk_bf16_f32 v119, v119, v119
    v_lshlrev_b32 v119, 16, v119
    v_mul_f32 v60, v119, v119
    v_mul_f32 v60, 0x3d372713, v60
    v_add_f32 v60, 1.0, v60
    v_mul_f32 v60, v60, v119
    v_mul_f32 v60, 0xc0135761, v60
    v_exp_f32 v60, v60
    s_nop 0
    v_add_f32 v60, 1.0, v60
    v_rcp_f32 v60, v60
    s_nop 0
    v_mul_f32 v119, v119, v60
    v_cvt_pk_bf16_f32 v114, v116, v117
    v_cvt_pk_bf16_f32 v115, v118, v119
    v_cvt_pk_bf16_f32 v120, v120, v120
    v_lshlrev_b32 v120, 16, v120
    v_lshlrev_b32 v60, 16, v46
    v_add_f32 v120, v120, v60
    v_cvt_pk_bf16_f32 v120, v120, v120
    v_lshlrev_b32 v120, 16, v120
    v_mul_f32 v60, v120, v120
    v_mul_f32 v60, 0x3d372713, v60
    v_add_f32 v60, 1.0, v60
    v_mul_f32 v60, v60, v120
    v_mul_f32 v60, 0xc0135761, v60
    v_exp_f32 v60, v60
    s_nop 0
    v_add_f32 v60, 1.0, v60
    v_rcp_f32 v60, v60
    s_nop 0
    v_mul_f32 v120, v120, v60
    v_cvt_pk_bf16_f32 v121, v121, v121
    v_lshlrev_b32 v121, 16, v121
    v_and_b32 v60, 0xffff0000, v46
    v_add_f32 v121, v121, v60
    v_cvt_pk_bf16_f32 v121, v121, v121
    v_lshlrev_b32 v121, 16, v121
    v_mul_f32 v60, v121, v121
    v_mul_f32 v60, 0x3d372713, v60
    v_add_f32 v60, 1.0, v60
    v_mul_f32 v60, v60, v121
    v_mul_f32 v60, 0xc0135761, v60
    v_exp_f32 v60, v60
    s_nop 0
    v_add_f32 v60, 1.0, v60
    v_rcp_f32 v60, v60
    s_nop 0
    v_mul_f32 v121, v121, v60
    v_cvt_pk_bf16_f32 v122, v122, v122
    v_lshlrev_b32 v122, 16, v122
    v_lshlrev_b32 v60, 16, v47
    v_add_f32 v122, v122, v60
    v_cvt_pk_bf16_f32 v122, v122, v122
    v_lshlrev_b32 v122, 16, v122
    v_mul_f32 v60, v122, v122
    v_mul_f32 v60, 0x3d372713, v60
    v_add_f32 v60, 1.0, v60
    v_mul_f32 v60, v60, v122
    v_mul_f32 v60, 0xc0135761, v60
    v_exp_f32 v60, v60
    s_nop 0
    v_add_f32 v60, 1.0, v60
    v_rcp_f32 v60, v60
    s_nop 0
    v_mul_f32 v122, v122, v60
    v_cvt_pk_bf16_f32 v123, v123, v123
    v_lshlrev_b32 v123, 16, v123
    v_and_b32 v60, 0xffff0000, v47
    v_add_f32 v123, v123, v60
    v_cvt_pk_bf16_f32 v123, v123, v123
    v_lshlrev_b32 v123, 16, v123
    v_mul_f32 v60, v123, v123
    v_mul_f32 v60, 0x3d372713, v60
    v_add_f32 v60, 1.0, v60
    v_mul_f32 v60, v60, v123
    v_mul_f32 v60, 0xc0135761, v60
    v_exp_f32 v60, v60
    s_nop 0
    v_add_f32 v60, 1.0, v60
    v_rcp_f32 v60, v60
    s_nop 0
    v_mul_f32 v123, v123, v60
    v_cvt_pk_bf16_f32 v120, v120, v121
    v_cvt_pk_bf16_f32 v121, v122, v123
    v_cvt_pk_bf16_f32 v124, v124, v124
    v_lshlrev_b32 v124, 16, v124
    v_lshlrev_b32 v60, 16, v48
    v_add_f32 v124, v124, v60
    v_cvt_pk_bf16_f32 v124, v124, v124
    v_lshlrev_b32 v124, 16, v124
    v_mul_f32 v60, v124, v124
    v_mul_f32 v60, 0x3d372713, v60
    v_add_f32 v60, 1.0, v60
    v_mul_f32 v60, v60, v124
    v_mul_f32 v60, 0xc0135761, v60
    v_exp_f32 v60, v60
    s_nop 0
    v_add_f32 v60, 1.0, v60
    v_rcp_f32 v60, v60
    s_nop 0
    v_mul_f32 v124, v124, v60
    v_cvt_pk_bf16_f32 v125, v125, v125
    v_lshlrev_b32 v125, 16, v125
    v_and_b32 v60, 0xffff0000, v48
    v_add_f32 v125, v125, v60
    v_cvt_pk_bf16_f32 v125, v125, v125
    v_lshlrev_b32 v125, 16, v125
    v_mul_f32 v60, v125, v125
    v_mul_f32 v60, 0x3d372713, v60
    v_add_f32 v60, 1.0, v60
    v_mul_f32 v60, v60, v125
    v_mul_f32 v60, 0xc0135761, v60
    v_exp_f32 v60, v60
    s_nop 0
    v_add_f32 v60, 1.0, v60
    v_rcp_f32 v60, v60
    s_nop 0
    v_mul_f32 v125, v125, v60
    v_cvt_pk_bf16_f32 v126, v126, v126
    v_lshlrev_b32 v126, 16, v126
    v_lshlrev_b32 v60, 16, v49
    v_add_f32 v126, v126, v60
    v_cvt_pk_bf16_f32 v126, v126, v126
    v_lshlrev_b32 v126, 16, v126
    v_mul_f32 v60, v126, v126
    v_mul_f32 v60, 0x3d372713, v60
    v_add_f32 v60, 1.0, v60
    v_mul_f32 v60, v60, v126
    v_mul_f32 v60, 0xc0135761, v60
    v_exp_f32 v60, v60
    s_nop 0
    v_add_f32 v60, 1.0, v60
    v_rcp_f32 v60, v60
    s_nop 0
    v_mul_f32 v126, v126, v60
    v_cvt_pk_bf16_f32 v127, v127, v127
    v_lshlrev_b32 v127, 16, v127
    v_and_b32 v60, 0xffff0000, v49
    v_add_f32 v127, v127, v60
    v_cvt_pk_bf16_f32 v127, v127, v127
    v_lshlrev_b32 v127, 16, v127
    v_mul_f32 v60, v127, v127
    v_mul_f32 v60, 0x3d372713, v60
    v_add_f32 v60, 1.0, v60
    v_mul_f32 v60, v60, v127
    v_mul_f32 v60, 0xc0135761, v60
    v_exp_f32 v60, v60
    s_nop 0
    v_add_f32 v60, 1.0, v60
    v_rcp_f32 v60, v60
    s_nop 0
    v_mul_f32 v127, v127, v60
    v_cvt_pk_bf16_f32 v122, v124, v125
    v_cvt_pk_bf16_f32 v123, v126, v127
    v_add_u32 v9, 229376, v61
    s_nop 0
    v_permlane32_swap_b32 v112, v114
    v_permlane32_swap_b32 v113, v115
    v_permlane32_swap_b32 v120, v122
    v_permlane32_swap_b32 v121, v123
    buffer_store_dwordx4 v[112:115], v9, s[16:19], 0 offen offset:64
    buffer_store_dwordx4 v[120:123], v9, s[16:19], 0 offen offset:96
L_g_done_37:
    s_endpgm
.globl k8_ffn2_kernel
.p2align 8
.type k8_ffn2_kernel,@function
k8_ffn2_kernel:
    s_cmp_ge_u32 s2, 256
    s_cbranch_scc1 L_g_done_39
    s_load_dwordx2 s[20:21], s[0:1], 128
    s_and_b32 s42, s2, 7
    s_lshr_b32 s43, s2, 3
    s_and_b32 s40, s43, 1
    s_lshl_b32 s42, s42, 1
    s_add_u32 s40, s40, s42
    s_lshr_b32 s41, s43, 1
    s_load_dwordx2 s[6:7], s[0:1], 80
    s_mov_b32 s43, s41
    s_load_dwordx2 s[4:5], s[0:1], 88
    s_load_dwordx2 s[22:23], s[0:1], 112
    v_and_b32 v1, 63, v0
    v_lshrrev_b32 v2, 6, v0
    s_nop 0
    v_readfirstlane_b32 s44, v2
    s_waitcnt lgkmcnt(0)
    s_add_u32 s8, s20, 0x6000000
    s_addc_u32 s9, s21, 0
    s_and_b32 s9, s9, 0xffff
    s_mov_b32 s10, 0xe00000
    s_mov_b32 s11, 0x00020000
    s_mov_b32 s12, s6
    s_and_b32 s13, s7, 0xffff
    s_mov_b32 s14, 0x700000
    s_mov_b32 s15, 0x00020000
    s_mov_b32 s16, s22
    s_and_b32 s17, s23, 0xffff
    s_mov_b32 s18, 0x400000
    s_mov_b32 s19, 0x00020000
    v_lshrrev_b32 v3, 2, v1
    s_lshl_b32 s45, s44, 5
    v_add_u32 v3, s45, v3
    v_and_b32 v4, 3, v1
    s_lshl_b32 s46, s40, 7
    s_mov_b32 s47, 7168
    v_add_u32 v5, 0, v3
    v_lshrrev_b32 v6, 2, v5
    v_and_b32 v6, 3, v6
    v_xor_b32 v6, v6, v4
    v_lshlrev_b32 v6, 4, v6
    v_add_u32 v5, s46, v5
    v_mul_lo_u32 v5, v5, s47
    v_add_u32 v10, v5, v6
    v_add_u32 v5, 16, v3
    v_lshrrev_b32 v6, 2, v5
    v_and_b32 v6, 3, v6
    v_xor_b32 v6, v6, v4
    v_lshlrev_b32 v6, 4, v6
    v_add_u32 v5, s46, v5
    v_mul_lo_u32 v5, v5, s47
    v_add_u32 v11, v5, v6
    v_lshrrev_b32 v3, 3, v1
    s_mul_i32 s45, s44, 8
    v_add_u32 v3, s45, v3
    v_and_b32 v4, 7, v1
    s_lshl_b32 s46, s43, 7
    s_mov_b32 s47, 2048
    v_add_u32 v5, 0, v3
    v_and_b32 v6, 2, v5
    v_lshlrev_b32 v6, 1, v6
    v_xor_b32 v6, v6, v4
    v_lshlrev_b32 v6, 4, v6
    v_mul_lo_u32 v5, v5, s47
    v_add_u32 v5, s46, v5
    v_add_u32 v14, v5, v6
    s_lshr_b32 s48, s44, 1
    s_and_b32 s49, s44, 1
    v_and_b32 v3, 31, v1
    s_lshl_b32 s45, s48, 6
    v_add_u32 v3, s45, v3
    v_lshrrev_b32 v4, 2, v3
    v_and_b32 v4, 3, v4
    v_lshrrev_b32 v5, 5, v1
    v_lshlrev_b32 v3, 6, v3
    v_add_u32 v6, 0, v5
    v_xor_b32 v6, v6, v4
    v_lshlrev_b32 v6, 4, v6
    v_add_u32 v18, v3, v6
    v_add_u32 v6, 2, v5
    v_xor_b32 v6, v6, v4
    v_lshlrev_b32 v6, 4, v6
    v_add_u32 v19, v3, v6
    v_lshrrev_b32 v3, 5, v1
    v_lshlrev_b32 v3, 3, v3
    v_bfe_u32 v4, v1, 2, 2
    v_add_u32 v3, v3, v4
    v_bfe_u32 v5, v1, 4, 1
    v_lshlrev_b32 v5, 4, v5
    v_and_b32 v6, 3, v1
    v_lshlrev_b32 v6, 2, v6
    v_add_u32 v5, v5, v6
    s_mul_i32 s45, s49, 32
    v_add_u32 v5, s45, v5
    v_and_b32 v7, 2, v4
    v_lshlrev_b32 v7, 1, v7
    v_mul_u32_u24 v3, 128, v3
    v_add_u32 v6, 0, v5
    v_lshrrev_b32 v8, 3, v6
    v_xor_b32 v8, v8, v7
    v_lshlrev_b32 v8, 4, v8
    v_and_b32 v6, 4, v6
    v_lshlrev_b32 v6, 1, v6
    v_add_u32 v8, v8, v6
    v_add_u32 v22, v3, v8
    v_mov_b32 v64, 0
    v_mov_b32 v65, 0
    v_mov_b32 v66, 0
    v_mov_b32 v67, 0
    v_mov_b32 v68, 0
    v_mov_b32 v69, 0
    v_mov_b32 v70, 0
    v_mov_b32 v71, 0
    v_mov_b32 v72, 0
    v_mov_b32 v73, 0
    v_mov_b32 v74, 0
    v_mov_b32 v75, 0
    v_mov_b32 v76, 0
    v_mov_b32 v77, 0
    v_mov_b32 v78, 0
    v_mov_b32 v79, 0
    v_mov_b32 v80, 0
    v_mov_b32 v81, 0
    v_mov_b32 v82, 0
    v_mov_b32 v83, 0
    v_mov_b32 v84, 0
    v_mov_b32 v85, 0
    v_mov_b32 v86, 0
    v_mov_b32 v87, 0
    v_mov_b32 v88, 0
    v_mov_b32 v89, 0
    v_mov_b32 v90, 0
    v_mov_b32 v91, 0
    v_mov_b32 v92, 0
    v_mov_b32 v93, 0
    v_mov_b32 v94, 0
    v_mov_b32 v95, 0
    s_mov_b32 s50, 0
    s_mov_b32 s51, 0
    s_lshl_b32 s52, s44, 11
    s_mul_i32 s53, s44, 1024
    s_add_u32 s53, s53, 8192
    s_add_u32 m0, s52, 0
    s_nop 0
    buffer_load_dwordx4 v10, s[8:11], s50 offen lds
    s_add_u32 m0, s52, 1024
    s_nop 0
    buffer_load_dwordx4 v11, s[8:11], s50 offen lds
    s_add_u32 m0, s53, 0
    s_nop 0
    buffer_load_dwordx4 v14, s[12:15], s51 offen lds
    s_add_u32 s50, s50, 64
    s_add_u32 s51, s51, 65536
    s_add_u32 m0, s52, 12288
    s_nop 0
    buffer_load_dwordx4 v10, s[8:11], s50 offen lds
    s_add_u32 m0, s52, 13312
    s_nop 0
    buffer_load_dwordx4 v11, s[8:11], s50 offen lds
    s_add_u32 m0, s53, 12288
    s_nop 0
    buffer_load_dwordx4 v14, s[12:15], s51 offen lds
    s_add_u32 s50, s50, 64
    s_add_u32 s51, s51, 65536
    s_add_u32 m0, s52, 24576
    s_nop 0
    buffer_load_dwordx4 v10, s[8:11], s50 offen lds
    s_add_u32 m0, s52, 25600
    s_nop 0
    buffer_load_dwordx4 v11, s[8:11], s50 offen lds
    s_add_u32 m0, s53, 24576
    s_nop 0
    buffer_load_dwordx4 v14, s[12:15], s51 offen lds
    s_add_u32 s50, s50, 64
    s_add_u32 s51, s51, 65536
    s_mov_b32 s54, 0
L_g_loop_40:
    s_waitcnt vmcnt(6)
    s_barrier
    ds_read_b128 v[26:29], v18 offset:0
    ds_read_b128 v[30:33], v18 offset:2048
    ds_read_b64_tr_b16 v[34:35], v22 offset:8192
    ds_read_b64_tr_b16 v[36:37], v22 offset:8704
    ds_read_b128 v[38:41], v19 offset:0
    ds_read_b128 v[42:45], v19 offset:2048
    ds_read_b64_tr_b16 v[46:47], v22 offset:10240
    ds_read_b64_tr_b16 v[48:49], v22 offset:10752
    s_add_u32 m0, s52, 36864
    s_nop 0
    buffer_load_dwordx4 v10, s[8:11], s50 offen lds
    s_add_u32 m0, s52, 37888
    s_nop 0
    buffer_load_dwordx4 v11, s[8:11], s50 offen lds
    s_add_u32 m0, s53, 36864
    s_nop 0
    buffer_load_dwordx4 v14, s[12:15], s51 offen lds
    s_add_u32 s50, s50, 64
    s_add_u32 s51, s51, 65536
    s_waitcnt lgkmcnt(4)
    v_mfma_f32_32x32x16_bf16 v[64:79], v[34:37], v[26:29], v[64:79]
    v_mfma_f32_32x32x16_bf16 v[80:95], v[34:37], v[30:33], v[80:95]
    s_waitcnt lgkmcnt(0)
    v_mfma_f32_32x32x16_bf16 v[64:79], v[46:49], v[38:41], v[64:79]
    v_mfma_f32_32x32x16_bf16 v[80:95], v[46:49], v[42:45], v[80:95]
    s_waitcnt vmcnt(6)
    s_barrier
    ds_read_b128 v[26:29], v18 offset:12288
    ds_read_b128 v[30:33], v18 offset:14336
    ds_read_b64_tr_b16 v[34:35], v22 offset:20480
    ds_read_b64_tr_b16 v[36:37], v22 offset:20992
    ds_read_b128 v[38:41], v19 offset:12288
    ds_read_b128 v[42:45], v19 offset:14336
    ds_read_b64_tr_b16 v[46:47], v22 offset:22528
    ds_read_b64_tr_b16 v[48:49], v22 offset:23040
    s_add_u32 m0, s52, 0
    s_nop 0
    buffer_load_dwordx4 v10, s[8:11], s50 offen lds
    s_add_u32 m0, s52, 1024
    s_nop 0
    buffer_load_dwordx4 v11, s[8:11], s50 offen lds
    s_add_u32 m0, s53, 0
    s_nop 0
    buffer_load_dwordx4 v14, s[12:15], s51 offen lds
    s_add_u32 s50, s50, 64
    s_add_u32 s51, s51, 65536
    s_waitcnt lgkmcnt(4)
    v_mfma_f32_32x32x16_bf16 v[64:79], v[34:37], v[26:29], v[64:79]
    v_mfma_f32_32x32x16_bf16 v[80:95], v[34:37], v[30:33], v[80:95]
    s_waitcnt lgkmcnt(0)
    v_mfma_f32_32x32x16_bf16 v[64:79], v[46:49], v[38:41], v[64:79]
    v_mfma_f32_32x32x16_bf16 v[80:95], v[46:49], v[42:45], v[80:95]
    s_waitcnt vmcnt(6)
    s_barrier
    ds_read_b128 v[26:29], v18 offset:24576
    ds_read_b128 v[30:33], v18 offset:26624
    ds_read_b64_tr_b16 v[34:35], v22 offset:32768
    ds_read_b64_tr_b16 v[36:37], v22 offset:33280
    ds_read_b128 v[38:41], v19 offset:24576
    ds_read_b128 v[42:45], v19 offset:26624
    ds_read_b64_tr_b16 v[46:47], v22 offset:34816
    ds_read_b64_tr_b16 v[48:49], v22 offset:35328
    s_add_u32 m0, s52, 12288
    s_nop 0
    buffer_load_dwordx4 v10, s[8:11], s50 offen lds
    s_add_u32 m0, s52, 13312
    s_nop 0
    buffer_load_dwordx4 v11, s[8:11], s50 offen lds
    s_add_u32 m0, s53, 12288
    s_nop 0
    buffer_load_dwordx4 v14, s[12:15], s51 offen lds
    s_add_u32 s50, s50, 64
    s_add_u32 s51, s51, 65536
    s_waitcnt lgkmcnt(4)
    v_mfma_f32_32x32x16_bf16 v[64:79], v[34:37], v[26:29], v[64:79]
    v_mfma_f32_32x32x16_bf16 v[80:95], v[34:37], v[30:33], v[80:95]
    s_waitcnt lgkmcnt(0)
    v_mfma_f32_32x32x16_bf16 v[64:79], v[46:49], v[38:41], v[64:79]
    v_mfma_f32_32x32x16_bf16 v[80:95], v[46:49], v[42:45], v[80:95]
    s_waitcnt vmcnt(6)
    s_barrier
    ds_read_b128 v[26:29], v18 offset:36864
    ds_read_b128 v[30:33], v18 offset:38912
    ds_read_b64_tr_b16 v[34:35], v22 offset:45056
    ds_read_b64_tr_b16 v[36:37], v22 offset:45568
    ds_read_b128 v[38:41], v19 offset:36864
    ds_read_b128 v[42:45], v19 offset:38912
    ds_read_b64_tr_b16 v[46:47], v22 offset:47104
    ds_read_b64_tr_b16 v[48:49], v22 offset:47616
    s_add_u32 m0, s52, 24576
    s_nop 0
    buffer_load_dwordx4 v10, s[8:11], s50 offen lds
    s_add_u32 m0, s52, 25600
    s_nop 0
    buffer_load_dwordx4 v11, s[8:11], s50 offen lds
    s_add_u32 m0, s53, 24576
    s_nop 0
    buffer_load_dwordx4 v14, s[12:15], s51 offen lds
    s_add_u32 s50, s50, 64
    s_add_u32 s51, s51, 65536
    s_waitcnt lgkmcnt(4)
    v_mfma_f32_32x32x16_bf16 v[64:79], v[34:37], v[26:29], v[64:79]
    v_mfma_f32_32x32x16_bf16 v[80:95], v[34:37], v[30:33], v[80:95]
    s_waitcnt lgkmcnt(0)
    v_mfma_f32_32x32x16_bf16 v[64:79], v[46:49], v[38:41], v[64:79]
    v_mfma_f32_32x32x16_bf16 v[80:95], v[46:49], v[42:45], v[80:95]
    s_add_u32 s54, s54, 4
    s_cmp_lt_u32 s54, 112
    s_cbranch_scc1 L_g_loop_40
    s_nop 15
    s_waitcnt vmcnt(0)
    v_and_b32 v3, 31, v1
    s_lshl_b32 s45, s40, 7
    s_lshl_b32 s46, s48, 6
    s_add_u32 s45, s45, s46
    v_add_u32 v3, s45, v3
    v_lshrrev_b32 v4, 5, v1
    v_lshlrev_b32 v4, 2, v4
    s_mul_i32 s45, s41, 64
    s_mul_i32 s46, s49, 32
    s_add_u32 s45, s45, s46
    v_add_u32 v4, s45, v4
    s_mov_b32 s47, 2048
    v_mul_lo_u32 v5, v3, s47
    v_lshlrev_b32 v6, 1, v4
    v_add_u32 v5, v5, v6
    v_lshrrev_b32 v61, 5, v1
    v_lshlrev_b32 v61, 3, v61
    v_add_u32 v61, v61, v5
    s_mov_b32 s24, s20
    s_and_b32 s25, s21, 0xffff
    s_mov_b32 s26, 0x6000
    s_mov_b32 s27, 0x00020000
    s_mov_b32 s55, 20480
    v_lshlrev_b32 v7, 2, v4
    s_add_u32 s28, s20, 0x800000
    s_addc_u32 s29, s21, 0
    s_and_b32 s29, s29, 0xffff
    s_mov_b32 s30, 0x400000
    s_mov_b32 s31, 0x00020000
    s_mov_b32 s32, s4
    s_and_b32 s33, s5, 0xffff
    s_mov_b32 s34, 0x800
    s_mov_b32 s35, 0x00020000
    buffer_load_dwordx4 v[26:29], v7, s[24:27], s55 offen offset:0
    buffer_load_dwordx4 v[30:33], v7, s[24:27], s55 offen offset:32
    buffer_load_dwordx4 v[34:37], v7, s[24:27], s55 offen offset:64
    buffer_load_dwordx4 v[38:41], v7, s[24:27], s55 offen offset:96
    v_lshlrev_b32 v8, 1, v4
    buffer_load_dwordx2 v[42:43], v8, s[32:35], 0 offen offset:0
    buffer_load_dwordx2 v[44:45], v8, s[32:35], 0 offen offset:16
    buffer_load_dwordx2 v[46:47], v8, s[32:35], 0 offen offset:32
    buffer_load_dwordx2 v[48:49], v8, s[32:35], 0 offen offset:48
    v_add_u32 v9, 0, v5
    buffer_load_dwordx2 v[50:51], v9, s[28:31], 0 offen offset:0
    buffer_load_dwordx2 v[52:53], v9, s[28:31], 0 offen offset:16
    buffer_load_dwordx2 v[54:55], v9, s[28:31], 0 offen offset:32
    buffer_load_dwordx2 v[56:57], v9, s[28:31], 0 offen offset:48
    s_waitcnt vmcnt(0)
    v_cvt_pk_bf16_f32 v64, v64, v64
    v_lshlrev_b32 v64, 16, v64
    v_lshlrev_b32 v60, 16, v42
    v_add_f32 v64, v64, v60
    v_cvt_pk_bf16_f32 v64, v64, v64
    v_lshlrev_b32 v64, 16, v64
    v_mul_f32 v64, v64, v26
    v_cvt_pk_bf16_f32 v64, v64, v64
    v_lshlrev_b32 v64, 16, v64
    v_lshlrev_b32 v60, 16, v50
    v_add_f32 v64, v64, v60
    v_cvt_pk_bf16_f32 v65, v65, v65
    v_lshlrev_b32 v65, 16, v65
    v_and_b32 v60, 0xffff0000, v42
    v_add_f32 v65, v65, v60
    v_cvt_pk_bf16_f32 v65, v65, v65
    v_lshlrev_b32 v65, 16, v65
    v_mul_f32 v65, v65, v27
    v_cvt_pk_bf16_f32 v65, v65, v65
    v_lshlrev_b32 v65, 16, v65
    v_and_b32 v60, 0xffff0000, v50
    v_add_f32 v65, v65, v60
    v_cvt_pk_bf16_f32 v66, v66, v66
    v_lshlrev_b32 v66, 16, v66
    v_lshlrev_b32 v60, 16, v43
    v_add_f32 v66, v66, v60
    v_cvt_pk_bf16_f32 v66, v66, v66
    v_lshlrev_b32 v66, 16, v66
    v_mul_f32 v66, v66, v28
    v_cvt_pk_bf16_f32 v66, v66, v66
    v_lshlrev_b32 v66, 16, v66
    v_lshlrev_b32 v60, 16, v51
    v_add_f32 v66, v66, v60
    v_cvt_pk_bf16_f32 v67, v67, v67
    v_lshlrev_b32 v67, 16, v67
    v_and_b32 v60, 0xffff0000, v43
    v_add_f32 v67, v67, v60
    v_cvt_pk_bf16_f32 v67, v67, v67
    v_lshlrev_b32 v67, 16, v67
    v_mul_f32 v67, v67, v29
    v_cvt_pk_bf16_f32 v67, v67, v67
    v_lshlrev_b32 v67, 16, v67
    v_and_b32 v60, 0xffff0000, v51
    v_add_f32 v67, v67, v60
    v_cvt_pk_bf16_f32 v64, v64, v65
    v_cvt_pk_bf16_f32 v65, v66, v67
    v_cvt_pk_bf16_f32 v68, v68, v68
    v_lshlrev_b32 v68, 16, v68
    v_lshlrev_b32 v60, 16, v44
    v_add_f32 v68, v68, v60
    v_cvt_pk_bf16_f32 v68, v68, v68
    v_lshlrev_b32 v68, 16, v68
    v_mul_f32 v68, v68, v30
    v_cvt_pk_bf16_f32 v68, v68, v68
    v_lshlrev_b32 v68, 16, v68
    v_lshlrev_b32 v60, 16, v52
    v_add_f32 v68, v68, v60
    v_cvt_pk_bf16_f32 v69, v69, v69
    v_lshlrev_b32 v69, 16, v69
    v_and_b32 v60, 0xffff0000, v44
    v_add_f32 v69, v69, v60
    v_cvt_pk_bf16_f32 v69, v69, v69
    v_lshlrev_b32 v69, 16, v69
    v_mul_f32 v69, v69, v31
    v_cvt_pk_bf16_f32 v69, v69, v69
    v_lshlrev_b32 v69, 16, v69
    v_and_b32 v60, 0xffff0000, v52
    v_add_f32 v69, v69, v60
    v_cvt_pk_bf16_f32 v70, v70, v70
    v_lshlrev_b32 v70, 16, v70
    v_lshlrev_b32 v60, 16, v45
    v_add_f32 v70, v70, v60
    v_cvt_pk_bf16_f32 v70, v70, v70
    v_lshlrev_b32 v70, 16, v70
    v_mul_f32 v70, v70, v32
    v_cvt_pk_bf16_f32 v70, v70, v70
    v_lshlrev_b32 v70, 16, v70
    v_lshlrev_b32 v60, 16, v53
    v_add_f32 v70, v70, v60
    v_cvt_pk_bf16_f32 v71, v71, v71
    v_lshlrev_b32 v71, 16, v71
    v_and_b32 v60, 0xffff0000, v45
    v_add_f32 v71, v71, v60
    v_cvt_pk_bf16_f32 v71, v71, v71
    v_lshlrev_b32 v71, 16, v71
    v_mul_f32 v71, v71, v33
    v_cvt_pk_bf16_f32 v71, v71, v71
    v_lshlrev_b32 v71, 16, v71
    v_and_b32 v60, 0xffff0000, v53
    v_add_f32 v71, v71, v60
    v_cvt_pk_bf16_f32 v66, v68, v69
    v_cvt_pk_bf16_f32 v67, v70, v71
    v_cvt_pk_bf16_f32 v72, v72, v72
    v_lshlrev_b32 v72, 16, v72
    v_lshlrev_b32 v60, 16, v46
    v_add_f32 v72, v72, v60
    v_cvt_pk_bf16_f32 v72, v72, v72
    v_lshlrev_b32 v72, 16, v72
    v_mul_f32 v72, v72, v34
    v_cvt_pk_bf16_f32 v72, v72, v72
    v_lshlrev_b32 v72, 16, v72
    v_lshlrev_b32 v60, 16, v54
    v_add_f32 v72, v72, v60
    v_cvt_pk_bf16_f32 v73, v73, v73
    v_lshlrev_b32 v73, 16, v73
    v_and_b32 v60, 0xffff0000, v46
    v_add_f32 v73, v73, v60
    v_cvt_pk_bf16_f32 v73, v73, v73
    v_lshlrev_b32 v73, 16, v73
    v_mul_f32 v73, v73, v35
    v_cvt_pk_bf16_f32 v73, v73, v73
    v_lshlrev_b32 v73, 16, v73
    v_and_b32 v60, 0xffff0000, v54
    v_add_f32 v73, v73, v60
    v_cvt_pk_bf16_f32 v74, v74, v74
    v_lshlrev_b32 v74, 16, v74
    v_lshlrev_b32 v60, 16, v47
    v_add_f32 v74, v74, v60
    v_cvt_pk_bf16_f32 v74, v74, v74
    v_lshlrev_b32 v74, 16, v74
    v_mul_f32 v74, v74, v36
    v_cvt_pk_bf16_f32 v74, v74, v74
    v_lshlrev_b32 v74, 16, v74
    v_lshlrev_b32 v60, 16, v55
    v_add_f32 v74, v74, v60
    v_cvt_pk_bf16_f32 v75, v75, v75
    v_lshlrev_b32 v75, 16, v75
    v_and_b32 v60, 0xffff0000, v47
    v_add_f32 v75, v75, v60
    v_cvt_pk_bf16_f32 v75, v75, v75
    v_lshlrev_b32 v75, 16, v75
    v_mul_f32 v75, v75, v37
    v_cvt_pk_bf16_f32 v75, v75, v75
    v_lshlrev_b32 v75, 16, v75
    v_and_b32 v60, 0xffff0000, v55
    v_add_f32 v75, v75, v60
    v_cvt_pk_bf16_f32 v72, v72, v73
    v_cvt_pk_bf16_f32 v73, v74, v75
    v_cvt_pk_bf16_f32 v76, v76, v76
    v_lshlrev_b32 v76, 16, v76
    v_lshlrev_b32 v60, 16, v48
    v_add_f32 v76, v76, v60
    v_cvt_pk_bf16_f32 v76, v76, v76
    v_lshlrev_b32 v76, 16, v76
    v_mul_f32 v76, v76, v38
    v_cvt_pk_bf16_f32 v76, v76, v76
    v_lshlrev_b32 v76, 16, v76
    v_lshlrev_b32 v60, 16, v56
    v_add_f32 v76, v76, v60
    v_cvt_pk_bf16_f32 v77, v77, v77
    v_lshlrev_b32 v77, 16, v77
    v_and_b32 v60, 0xffff0000, v48
    v_add_f32 v77, v77, v60
    v_cvt_pk_bf16_f32 v77, v77, v77
    v_lshlrev_b32 v77, 16, v77
    v_mul_f32 v77, v77, v39
    v_cvt_pk_bf16_f32 v77, v77, v77
    v_lshlrev_b32 v77, 16, v77
    v_and_b32 v60, 0xffff0000, v56
    v_add_f32 v77, v77, v60
    v_cvt_pk_bf16_f32 v78, v78, v78
    v_lshlrev_b32 v78, 16, v78
    v_lshlrev_b32 v60, 16, v49
    v_add_f32 v78, v78, v60
    v_cvt_pk_bf16_f32 v78, v78, v78
    v_lshlrev_b32 v78, 16, v78
    v_mul_f32 v78, v78, v40
    v_cvt_pk_bf16_f32 v78, v78, v78
    v_lshlrev_b32 v78, 16, v78
    v_lshlrev_b32 v60, 16, v57
    v_add_f32 v78, v78, v60
    v_cvt_pk_bf16_f32 v79, v79, v79
    v_lshlrev_b32 v79, 16, v79
    v_and_b32 v60, 0xffff0000, v49
    v_add_f32 v79, v79, v60
    v_cvt_pk_bf16_f32 v79, v79, v79
    v_lshlrev_b32 v79, 16, v79
    v_mul_f32 v79, v79, v41
    v_cvt_pk_bf16_f32 v79, v79, v79
    v_lshlrev_b32 v79, 16, v79
    v_and_b32 v60, 0xffff0000, v57
    v_add_f32 v79, v79, v60
    v_cvt_pk_bf16_f32 v74, v76, v77
    v_cvt_pk_bf16_f32 v75, v78, v79
    v_mov_b32 v9, v61
    s_nop 0
    v_permlane32_swap_b32 v64, v66
    v_permlane32_swap_b32 v65, v67
    v_permlane32_swap_b32 v72, v74
    v_permlane32_swap_b32 v73, v75
    buffer_store_dwordx4 v[64:67], v9, s[16:19], 0 offen offset:0
    buffer_store_dwordx4 v[72:75], v9, s[16:19], 0 offen offset:32
    v_add_u32 v9, 65536, v5
    buffer_load_dwordx2 v[50:51], v9, s[28:31], 0 offen offset:0
    buffer_load_dwordx2 v[52:53], v9, s[28:31], 0 offen offset:16
    buffer_load_dwordx2 v[54:55], v9, s[28:31], 0 offen offset:32
    buffer_load_dwordx2 v[56:57], v9, s[28:31], 0 offen offset:48
    s_waitcnt vmcnt(0)
    v_cvt_pk_bf16_f32 v80, v80, v80
    v_lshlrev_b32 v80, 16, v80
    v_lshlrev_b32 v60, 16, v42
    v_add_f32 v80, v80, v60
    v_cvt_pk_bf16_f32 v80, v80, v80
    v_lshlrev_b32 v80, 16, v80
    v_mul_f32 v80, v80, v26
    v_cvt_pk_bf16_f32 v80, v80, v80
    v_lshlrev_b32 v80, 16, v80
    v_lshlrev_b32 v60, 16, v50
    v_add_f32 v80, v80, v60
    v_cvt_pk_bf16_f32 v81, v81, v81
    v_lshlrev_b32 v81, 16, v81
    v_and_b32 v60, 0xffff0000, v42
    v_add_f32 v81, v81, v60
    v_cvt_pk_bf16_f32 v81, v81, v81
    v_lshlrev_b32 v81, 16, v81
    v_mul_f32 v81, v81, v27
    v_cvt_pk_bf16_f32 v81, v81, v81
    v_lshlrev_b32 v81, 16, v81
    v_and_b32 v60, 0xffff0000, v50
    v_add_f32 v81, v81, v60
    v_cvt_pk_bf16_f32 v82, v82, v82
    v_lshlrev_b32 v82, 16, v82
    v_lshlrev_b32 v60, 16, v43
    v_add_f32 v82, v82, v60
    v_cvt_pk_bf16_f32 v82, v82, v82
    v_lshlrev_b32 v82, 16, v82
    v_mul_f32 v82, v82, v28
    v_cvt_pk_bf16_f32 v82, v82, v82
    v_lshlrev_b32 v82, 16, v82
    v_lshlrev_b32 v60, 16, v51
    v_add_f32 v82, v82, v60
    v_cvt_pk_bf16_f32 v83, v83, v83
    v_lshlrev_b32 v83, 16, v83
    v_and_b32 v60, 0xffff0000, v43
    v_add_f32 v83, v83, v60
    v_cvt_pk_bf16_f32 v83, v83, v83
    v_lshlrev_b32 v83, 16, v83
    v_mul_f32 v83, v83, v29
    v_cvt_pk_bf16_f32 v83, v83, v83
    v_lshlrev_b32 v83, 16, v83
    v_and_b32 v60, 0xffff0000, v51
    v_add_f32 v83, v83, v60
    v_cvt_pk_bf16_f32 v80, v80, v81
    v_cvt_pk_bf16_f32 v81, v82, v83
    v_cvt_pk_bf16_f32 v84, v84, v84
    v_lshlrev_b32 v84, 16, v84
    v_lshlrev_b32 v60, 16, v44
    v_add_f32 v84, v84, v60
    v_cvt_pk_bf16_f32 v84, v84, v84
    v_lshlrev_b32 v84, 16, v84
    v_mul_f32 v84, v84, v30
    v_cvt_pk_bf16_f32 v84, v84, v84
    v_lshlrev_b32 v84, 16, v84
    v_lshlrev_b32 v60, 16, v52
    v_add_f32 v84, v84, v60
    v_cvt_pk_bf16_f32 v85, v85, v85
    v_lshlrev_b32 v85, 16, v85
    v_and_b32 v60, 0xffff0000, v44
    v_add_f32 v85, v85, v60
    v_cvt_pk_bf16_f32 v85, v85, v85
    v_lshlrev_b32 v85, 16, v85
    v_mul_f32 v85, v85, v31
    v_cvt_pk_bf16_f32 v85, v85, v85
    v_lshlrev_b32 v85, 16, v85
    v_and_b32 v60, 0xffff0000, v52
    v_add_f32 v85, v85, v60
    v_cvt_pk_bf16_f32 v86, v86, v86
    v_lshlrev_b32 v86, 16, v86
    v_lshlrev_b32 v60, 16, v45
    v_add_f32 v86, v86, v60
    v_cvt_pk_bf16_f32 v86, v86, v86
    v_lshlrev_b32 v86, 16, v86
    v_mul_f32 v86, v86, v32
    v_cvt_pk_bf16_f32 v86, v86, v86
    v_lshlrev_b32 v86, 16, v86
    v_lshlrev_b32 v60, 16, v53
    v_add_f32 v86, v86, v60
    v_cvt_pk_bf16_f32 v87, v87, v87
    v_lshlrev_b32 v87, 16, v87
    v_and_b32 v60, 0xffff0000, v45
    v_add_f32 v87, v87, v60
    v_cvt_pk_bf16_f32 v87, v87, v87
    v_lshlrev_b32 v87, 16, v87
    v_mul_f32 v87, v87, v33
    v_cvt_pk_bf16_f32 v87, v87, v87
    v_lshlrev_b32 v87, 16, v87
    v_and_b32 v60, 0xffff0000, v53
    v_add_f32 v87, v87, v60
    v_cvt_pk_bf16_f32 v82, v84, v85
    v_cvt_pk_bf16_f32 v83, v86, v87
    v_cvt_pk_bf16_f32 v88, v88, v88
    v_lshlrev_b32 v88, 16, v88
    v_lshlrev_b32 v60, 16, v46
    v_add_f32 v88, v88, v60
    v_cvt_pk_bf16_f32 v88, v88, v88
    v_lshlrev_b32 v88, 16, v88
    v_mul_f32 v88, v88, v34
    v_cvt_pk_bf16_f32 v88, v88, v88
    v_lshlrev_b32 v88, 16, v88
    v_lshlrev_b32 v60, 16, v54
    v_add_f32 v88, v88, v60
    v_cvt_pk_bf16_f32 v89, v89, v89
    v_lshlrev_b32 v89, 16, v89
    v_and_b32 v60, 0xffff0000, v46
    v_add_f32 v89, v89, v60
    v_cvt_pk_bf16_f32 v89, v89, v89
    v_lshlrev_b32 v89, 16, v89
    v_mul_f32 v89, v89, v35
    v_cvt_pk_bf16_f32 v89, v89, v89
    v_lshlrev_b32 v89, 16, v89
    v_and_b32 v60, 0xffff0000, v54
    v_add_f32 v89, v89, v60
    v_cvt_pk_bf16_f32 v90, v90, v90
    v_lshlrev_b32 v90, 16, v90
    v_lshlrev_b32 v60, 16, v47
    v_add_f32 v90, v90, v60
    v_cvt_pk_bf16_f32 v90, v90, v90
    v_lshlrev_b32 v90, 16, v90
    v_mul_f32 v90, v90, v36
    v_cvt_pk_bf16_f32 v90, v90, v90
    v_lshlrev_b32 v90, 16, v90
    v_lshlrev_b32 v60, 16, v55
    v_add_f32 v90, v90, v60
    v_cvt_pk_bf16_f32 v91, v91, v91
    v_lshlrev_b32 v91, 16, v91
    v_and_b32 v60, 0xffff0000, v47
    v_add_f32 v91, v91, v60
    v_cvt_pk_bf16_f32 v91, v91, v91
    v_lshlrev_b32 v91, 16, v91
    v_mul_f32 v91, v91, v37
    v_cvt_pk_bf16_f32 v91, v91, v91
    v_lshlrev_b32 v91, 16, v91
    v_and_b32 v60, 0xffff0000, v55
    v_add_f32 v91, v91, v60
    v_cvt_pk_bf16_f32 v88, v88, v89
    v_cvt_pk_bf16_f32 v89, v90, v91
    v_cvt_pk_bf16_f32 v92, v92, v92
    v_lshlrev_b32 v92, 16, v92
    v_lshlrev_b32 v60, 16, v48
    v_add_f32 v92, v92, v60
    v_cvt_pk_bf16_f32 v92, v92, v92
    v_lshlrev_b32 v92, 16, v92
    v_mul_f32 v92, v92, v38
    v_cvt_pk_bf16_f32 v92, v92, v92
    v_lshlrev_b32 v92, 16, v92
    v_lshlrev_b32 v60, 16, v56
    v_add_f32 v92, v92, v60
    v_cvt_pk_bf16_f32 v93, v93, v93
    v_lshlrev_b32 v93, 16, v93
    v_and_b32 v60, 0xffff0000, v48
    v_add_f32 v93, v93, v60
    v_cvt_pk_bf16_f32 v93, v93, v93
    v_lshlrev_b32 v93, 16, v93
    v_mul_f32 v93, v93, v39
    v_cvt_pk_bf16_f32 v93, v93, v93
    v_lshlrev_b32 v93, 16, v93
    v_and_b32 v60, 0xffff0000, v56
    v_add_f32 v93, v93, v60
    v_cvt_pk_bf16_f32 v94, v94, v94
    v_lshlrev_b32 v94, 16, v94
    v_lshlrev_b32 v60, 16, v49
    v_add_f32 v94, v94, v60
    v_cvt_pk_bf16_f32 v94, v94, v94
    v_lshlrev_b32 v94, 16, v94
    v_mul_f32 v94, v94, v40
    v_cvt_pk_bf16_f32 v94, v94, v94
    v_lshlrev_b32 v94, 16, v94
    v_lshlrev_b32 v60, 16, v57
    v_add_f32 v94, v94, v60
    v_cvt_pk_bf16_f32 v95, v95, v95
    v_lshlrev_b32 v95, 16, v95
    v_and_b32 v60, 0xffff0000, v49
    v_add_f32 v95, v95, v60
    v_cvt_pk_bf16_f32 v95, v95, v95
    v_lshlrev_b32 v95, 16, v95
    v_mul_f32 v95, v95, v41
    v_cvt_pk_bf16_f32 v95, v95, v95
    v_lshlrev_b32 v95, 16, v95
    v_and_b32 v60, 0xffff0000, v57
    v_add_f32 v95, v95, v60
    v_cvt_pk_bf16_f32 v90, v92, v93
    v_cvt_pk_bf16_f32 v91, v94, v95
    v_add_u32 v9, 65536, v61
    s_nop 0
    v_permlane32_swap_b32 v80, v82
    v_permlane32_swap_b32 v81, v83
    v_permlane32_swap_b32 v88, v90
    v_permlane32_swap_b32 v89, v91
    buffer_store_dwordx4 v[80:83], v9, s[16:19], 0 offen offset:0
    buffer_store_dwordx4 v[88:91], v9, s[16:19], 0 offen offset:32
L_g_done_39:
    s_endpgm
.section .rodata,"a"
.p2align 6
.amdhsa_kernel k0_mod_kernel
  .amdhsa_next_free_vgpr 128
  .amdhsa_next_free_sgpr 102
  .amdhsa_accum_offset 128
  .amdhsa_group_segment_fixed_size 0
  .amdhsa_kernarg_size 136
  .amdhsa_user_sgpr_count 2
  .amdhsa_user_sgpr_kernarg_segment_ptr 1
  .amdhsa_system_sgpr_workgroup_id_x 1
.end_amdhsa_kernel
.p2align 6
.amdhsa_kernel k1_ln_kernel
  .amdhsa_next_free_vgpr 88
  .amdhsa_next_free_sgpr 102
  .amdhsa_accum_offset 88
  .amdhsa_group_segment_fixed_size 0
  .amdhsa_kernarg_size 136
  .amdhsa_user_sgpr_count 2
  .amdhsa_user_sgpr_kernarg_segment_ptr 1
  .amdhsa_system_sgpr_workgroup_id_x 1
.end_amdhsa_kernel
.p2align 6
.amdhsa_kernel k2_qkv_kernel
  .amdhsa_next_free_vgpr 128
  .amdhsa_next_free_sgpr 102
  .amdhsa_accum_offset 128
  .amdhsa_group_segment_fixed_size 0
  .amdhsa_kernarg_size 136
  .amdhsa_user_sgpr_count 2
  .amdhsa_user_sgpr_kernarg_segment_ptr 1
  .amdhsa_system_sgpr_workgroup_id_x 1
.end_amdhsa_kernel
.p2align 6
.amdhsa_kernel k3_chain_kernel
  .amdhsa_next_free_vgpr 512
  .amdhsa_next_free_sgpr 102
  .amdhsa_accum_offset 256
  .amdhsa_group_segment_fixed_size 0
  .amdhsa_kernarg_size 136
  .amdhsa_user_sgpr_count 2
  .amdhsa_user_sgpr_kernarg_segment_ptr 1
  .amdhsa_system_sgpr_workgroup_id_x 1
.end_amdhsa_kernel
.p2align 6
.amdhsa_kernel k4_xattn_kernel
  .amdhsa_next_free_vgpr 176
  .amdhsa_next_free_sgpr 102
  .amdhsa_accum_offset 176
  .amdhsa_group_segment_fixed_size 0
  .amdhsa_kernarg_size 136
  .amdhsa_user_sgpr_count 2
  .amdhsa_user_sgpr_kernarg_segment_ptr 1
  .amdhsa_system_sgpr_workgroup_id_x 1
.end_amdhsa_kernel
.p2align 6
.amdhsa_kernel k5_wo_kernel
  .amdhsa_next_free_vgpr 96
  .amdhsa_next_free_sgpr 102
  .amdhsa_accum_offset 96
  .amdhsa_group_segment_fixed_size 0
  .amdhsa_kernarg_size 136
  .amdhsa_user_sgpr_count 2
  .amdhsa_user_sgpr_kernarg_segment_ptr 1
  .amdhsa_system_sgpr_workgroup_id_x 1
.end_amdhsa_kernel
.p2align 6
.amdhsa_kernel k6_ln_kernel
  .amdhsa_next_free_vgpr 88
  .amdhsa_next_free_sgpr 102
  .amdhsa_accum_offset 88
  .amdhsa_group_segment_fixed_size 0
  .amdhsa_kernarg_size 136
  .amdhsa_user_sgpr_count 2
  .amdhsa_user_sgpr_kernarg_segment_ptr 1
  .amdhsa_system_sgpr_workgroup_id_x 1
.end_amdhsa_kernel
.p2align 6
.amdhsa_kernel k7_ffn1_kernel
  .amdhsa_next_free_vgpr 128
  .amdhsa_next_free_sgpr 102
  .amdhsa_accum_offset 128
  .amdhsa_group_segment_fixed_size 0
  .amdhsa_kernarg_size 136
  .amdhsa_user_sgpr_count 2
  .amdhsa_user_sgpr_kernarg_segment_ptr 1
  .amdhsa_system_sgpr_workgroup_id_x 1
.end_amdhsa_kernel
.p2align 6
.amdhsa_kernel k8_ffn2_kernel
  .amdhsa_next_free_vgpr 96
  .amdhsa_next_free_sgpr 102
  .amdhsa_accum_offset 96
  .amdhsa_group_segment_fixed_size 0
  .amdhsa_kernarg_size 136
  .amdhsa_user_sgpr_count 2
  .amdhsa_user_sgpr_kernarg_segment_ptr 1
  .amdhsa_system_sgpr_workgroup_id_x 1
.end_amdhsa_kernel
```

```asm
; @launch kernel=adaLN_cond__memory_aug_recurrent_mem_tr__dense_activation_gelu__prompt_kernel grid=(256,1,1) block=(256,1,1) lds=163840
.amdgcn_target "amdgcn-amd-amdhsa--gfx950"
.text
.globl adaLN_cond__memory_aug_recurrent_mem_tr__dense_activation_gelu__prompt_kernel
.p2align 8
.type adaLN_cond__memory_aug_recurrent_mem_tr__dense_activation_gelu__prompt_kernel,@function
adaLN_cond__memory_aug_recurrent_mem_tr__dense_activation_gelu__prompt_kernel:
    s_cmp_lt_u32 s2, 256
    s_cbranch_scc1 L_c_done_1_go
    s_endpgm
L_c_done_1_go:
    s_and_b32 s40, s2, 7
    s_load_dwordx4 s[4:7], s[0:1], 16
    s_load_dwordx4 s[8:11], s[0:1], 32
    s_load_dwordx2 s[20:21], s[0:1], 128
    s_load_dwordx2 s[22:23], s[0:1], 120
    s_load_dwordx2 s[50:51], s[0:1], 8
    s_lshr_b32 s41, s2, 3
    s_and_b32 s42, s41, 15
    s_lshl_b32 s43, s40, 4
    s_add_u32 s43, s43, s42
    v_and_b32 v1, 63, v0
    v_lshrrev_b32 v2, 6, v0
    s_nop 0
    v_readfirstlane_b32 s44, v2
    s_waitcnt lgkmcnt(0)
    s_mov_b32 s24, s4
    s_and_b32 s25, s5, 0xffff
    s_mov_b32 s26, 0x800000
    s_mov_b32 s27, 0x00020000
    s_mov_b32 s28, s6
    s_and_b32 s29, s7, 0xffff
    s_mov_b32 s30, 0x800000
    s_mov_b32 s31, 0x00020000
    s_mov_b32 s32, s8
    s_and_b32 s33, s9, 0xffff
    s_mov_b32 s34, 0x800000
    s_mov_b32 s35, 0x00020000
    s_mov_b32 s36, s10
    s_and_b32 s37, s11, 0xffff
    s_mov_b32 s38, 0x800000
    s_mov_b32 s39, 0x00020000
    s_mov_b32 s12, s20
    s_and_b32 s13, s21, 0xffff
    s_mov_b32 s14, 0x10000000
    s_mov_b32 s15, 0x00020000
    s_mov_b32 s16, s22
    s_and_b32 s17, s23, 0xffff
    s_mov_b32 s18, 0x100
    s_mov_b32 s19, 0x00020000
    s_mov_b32 s52, s50
    s_and_b32 s53, s51, 0xffff
    s_mov_b32 s54, 0x4000
    s_mov_b32 s55, 0x00020000
    s_cmp_lt_u32 s40, 2
    s_cbranch_scc1 L_worker_3_no
    s_branch L_worker_3
L_worker_3_no:
    s_lshl_b32 s3, s43, 7
    s_lshr_b32 s45, s41, 4
    s_lshl_b32 s45, s45, 4
    s_add_u32 s3, s3, s45
    s_lshl_b32 s45, s44, 2
    s_add_u32 s3, s3, s45
    s_add_u32 s3, s3, 0x11000
    v_mov_b32 v40, 0
    s_mov_b64 exec, 1
    buffer_store_dword v40, v40, s[12:15], s3 offen sc1
    s_mov_b64 exec, -1
    v_and_b32 v21, 8, v1
    v_cmp_eq_u32 s[56:57], 0, v21
    v_mov_b32 v2, 0xeeee
    v_mov_b32 v3, 0x4444
    v_cndmask_b32 v2, v2, v3, s[56:57]
    v_lshlrev_b32 v68, 4, v1
    s_lshl_b32 s45, s44, 12
    v_add_u32 v3, s45, v68
    v_add_u32 v4, 4096, v3
    v_and_b32 v4, 16383, v4
    v_add_u32 v21, 8192, v3
    v_and_b32 v21, 16383, v21
    v_add_u32 v23, 12288, v3
    v_and_b32 v23, 16383, v23
    s_mul_i32 s45, s44, 24576
    s_add_u32 s45, s45, 65536
    v_add_u32 v5, s45, v68
    v_lshrrev_b32 v63, 4, v1
    s_lshl_b32 s45, s44, 2
    v_add_u32 v64, s45, v63
    s_lshr_b32 s45, s44, 1
    s_lshl_b32 s45, s45, 2
    v_add_u32 v65, s45, v63
    v_bfe_u32 v66, v1, 1, 3
    v_xor_b32 v66, v66, v65
    v_lshrrev_b32 v65, 1, v66
    v_lshlrev_b32 v65, 21, v65
    v_lshlrev_b32 v66, 5, v66
    v_and_b32 v67, 1, v1
    v_lshlrev_b32 v67, 4, v67
    v_add3_u32 v66, v66, v67, v65
    v_lshlrev_b32 v64, 13, v64
    v_add_u32 v82, v64, v66
    s_lshl_b32 s47, s43, 8
    s_lshl_b32 s48, s44, 10
    v_bfe_u32 v64, v1, 2, 2
    v_bfe_u32 v65, v1, 4, 1
    v_lshlrev_b32 v65, 2, v65
    v_add_u32 v65, v65, v64
    v_lshlrev_b32 v66, 3, v63
    v_add_u32 v66, v66, v64
    v_lshlrev_b32 v66, 8, v66
    v_and_b32 v67, 3, v1
    v_lshlrev_b32 v67, 3, v67
    v_add_u32 v66, v66, v67
    s_lshl_b32 s45, s44, 1
    v_xor_b32 v65, s45, v65
    v_lshlrev_b32 v65, 5, v65
    v_add_u32 v80, v66, v65
    v_xor_b32 v81, 32, v80
    v_mov_b32 v40, -1
    v_mov_b32 v41, -1
    v_mov_b32 v42, -1
    v_mov_b32 v43, -1
    v_mov_b32 v44, 0
    s_mov_b32 s68, 0
    s_cmp_ge_u32 s41, 16
    s_cbranch_scc1 L_c_vo_2
    s_lshl_b32 s45, s42, 11
    s_lshr_b32 s46, s44, 1
    s_lshl_b32 s46, s46, 10
    s_add_u32 s45, s45, s46
    s_and_b32 s46, s44, 1
    s_lshl_b32 s46, s46, 7
    s_add_u32 s45, s45, s46
    v_add_u32 v17, s45, v68
    s_lshl_b32 s62, s40, 17
    s_add_u32 s62, s62, 0x7040000
    s_mov_b64 exec, s[56:57]
    s_add_u32 s63, s62, 0
    buffer_store_dwordx4 v[40:43], v17, s[12:15], s63 offen sc1
    s_add_u32 s63, s62, 32768
    buffer_store_dwordx4 v[40:43], v17, s[12:15], s63 offen sc1
    s_add_u32 s63, s62, 65536
    buffer_store_dwordx4 v[40:43], v17, s[12:15], s63 offen sc1
    s_add_u32 s63, s62, 98304
    buffer_store_dwordx4 v[40:43], v17, s[12:15], s63 offen sc1
    s_mov_b64 exec, -1
    s_lshl_b32 s45, s40, 11
    s_lshl_b32 s46, s42, 2
    s_add_u32 s45, s45, s46
    s_add_u32 s45, s45, 0x7080000
    s_lshl_b32 s46, s44, 9
    s_add_u32 s45, s45, s46
    v_and_b32 v20, 3, v1
    v_lshlrev_b32 v20, 7, v20
    v_add_u32 v20, s45, v20
    buffer_store_dword v44, v20, s[12:15], 0 offen sc1
    s_waitcnt vmcnt(0)
    s_barrier
    s_cmp_lg_u32 s44, 0
    s_cbranch_scc1 L_hs_4
    s_getreg_b32 s45, hwreg(HW_REG_XCC_ID)
    s_and_b32 s45, s45, 15
    s_lshl_b32 s45, 1, s45
    v_mov_b32 v40, s45
    s_lshl_b32 s46, s40, 2
    s_add_u32 s46, s46, 4
    v_mov_b32 v41, 0
    v_mov_b32 v42, 1
    v_mov_b32 v43, s68
    s_mov_b64 exec, 1
    buffer_atomic_or v40, v41, s[16:19], s46 offen sc1
    buffer_atomic_add v43, v41, s[16:19], 0 offen offset:12 sc1
    s_waitcnt vmcnt(0)
    buffer_atomic_add v42, v41, s[16:19], 0 offen sc1
    s_waitcnt vmcnt(0)
    s_mov_b64 exec, -1
L_hs_4:
    v_add_u32 v83, 0x0, v82
    v_and_b32 v83, 0x7fffff, v83
    s_add_u32 s46, s47, 0x0
    s_add_u32 m0, s48, 0
    s_nop 0
    buffer_load_dwordx4 v83, s[24:27], s46 offen lds
    s_add_u32 s46, s47, 0x20000
    s_add_u32 m0, s48, 4096
    s_nop 0
    buffer_load_dwordx4 v83, s[24:27], s46 offen lds
    s_add_u32 s46, s47, 0x40000
    s_add_u32 m0, s48, 8192
    s_nop 0
    buffer_load_dwordx4 v83, s[24:27], s46 offen lds
    s_add_u32 s46, s47, 0x60000
    s_add_u32 m0, s48, 12288
    s_nop 0
    buffer_load_dwordx4 v83, s[24:27], s46 offen lds
    v_add_u32 v83, 0x80000, v82
    v_and_b32 v83, 0x7fffff, v83
    s_add_u32 s46, s47, 0x0
    s_add_u32 m0, s48, 16384
    s_nop 0
    buffer_load_dwordx4 v83, s[24:27], s46 offen lds
    s_add_u32 s46, s47, 0x20000
    s_add_u32 m0, s48, 20480
    s_nop 0
    buffer_load_dwordx4 v83, s[24:27], s46 offen lds
    s_add_u32 s46, s47, 0x40000
    s_add_u32 m0, s48, 24576
    s_nop 0
    buffer_load_dwordx4 v83, s[24:27], s46 offen lds
    s_add_u32 s46, s47, 0x60000
    s_add_u32 m0, s48, 28672
    s_nop 0
    buffer_load_dwordx4 v83, s[24:27], s46 offen lds
    v_add_u32 v83, 0x100000, v82
    v_and_b32 v83, 0x7fffff, v83
    s_add_u32 s46, s47, 0x0
    s_add_u32 m0, s48, 32768
    s_nop 0
    buffer_load_dwordx4 v83, s[24:27], s46 offen lds
    s_add_u32 s46, s47, 0x20000
    s_add_u32 m0, s48, 36864
    s_nop 0
    buffer_load_dwordx4 v83, s[24:27], s46 offen lds
    s_add_u32 s46, s47, 0x40000
    s_add_u32 m0, s48, 40960
    s_nop 0
    buffer_load_dwordx4 v83, s[24:27], s46 offen lds
    s_add_u32 s46, s47, 0x60000
    s_add_u32 m0, s48, 45056
    s_nop 0
    buffer_load_dwordx4 v83, s[24:27], s46 offen lds
    s_waitcnt vmcnt(8)
    s_barrier
    v_add_u32 v83, 0x180000, v82
    v_and_b32 v83, 0x7fffff, v83
    s_add_u32 s46, s47, 0x0
    s_add_u32 m0, s48, 49152
    s_nop 0
    buffer_load_dwordx4 v83, s[24:27], s46 offen lds
    s_add_u32 s46, s47, 0x20000
    s_add_u32 m0, s48, 53248
    s_nop 0
    buffer_load_dwordx4 v83, s[24:27], s46 offen lds
    s_add_u32 s46, s47, 0x40000
    s_add_u32 m0, s48, 57344
    s_nop 0
    buffer_load_dwordx4 v83, s[24:27], s46 offen lds
    s_add_u32 s46, s47, 0x60000
    s_add_u32 m0, s48, 61440
    s_nop 0
    buffer_load_dwordx4 v83, s[24:27], s46 offen lds
    ds_read_b64_tr_b16 a[0:1], v80 offset:0
    ds_read_b64_tr_b16 a[2:3], v80 offset:1024
    ds_read_b64_tr_b16 a[4:5], v80 offset:8192
    ds_read_b64_tr_b16 a[6:7], v80 offset:9216
    ds_read_b64_tr_b16 a[8:9], v81 offset:0
    ds_read_b64_tr_b16 a[10:11], v81 offset:1024
    ds_read_b64_tr_b16 a[12:13], v81 offset:8192
    ds_read_b64_tr_b16 a[14:15], v81 offset:9216
    s_waitcnt lgkmcnt(0)
    s_waitcnt vmcnt(8)
    s_barrier
    v_add_u32 v83, 0x200000, v82
    v_and_b32 v83, 0x7fffff, v83
    s_add_u32 s46, s47, 0x0
    s_add_u32 m0, s48, 0
    s_nop 0
    buffer_load_dwordx4 v83, s[24:27], s46 offen lds
    s_add_u32 s46, s47, 0x20000
    s_add_u32 m0, s48, 4096
    s_nop 0
    buffer_load_dwordx4 v83, s[24:27], s46 offen lds
    s_add_u32 s46, s47, 0x40000
    s_add_u32 m0, s48, 8192
    s_nop 0
    buffer_load_dwordx4 v83, s[24:27], s46 offen lds
    s_add_u32 s46, s47, 0x60000
    s_add_u32 m0, s48, 12288
    s_nop 0
    buffer_load_dwordx4 v83, s[24:27], s46 offen lds
    ds_read_b64_tr_b16 a[32:33], v80 offset:16384
    ds_read_b64_tr_b16 a[34:35], v80 offset:17408
    ds_read_b64_tr_b16 a[36:37], v80 offset:24576
    ds_read_b64_tr_b16 a[38:39], v80 offset:25600
    ds_read_b64_tr_b16 a[40:41], v81 offset:16384
    ds_read_b64_tr_b16 a[42:43], v81 offset:17408
    ds_read_b64_tr_b16 a[44:45], v81 offset:24576
    ds_read_b64_tr_b16 a[46:47], v81 offset:25600
    s_waitcnt lgkmcnt(0)
    s_waitcnt vmcnt(8)
    s_barrier
    v_add_u32 v83, 0x280000, v82
    v_and_b32 v83, 0x7fffff, v83
    s_add_u32 s46, s47, 0x0
    s_add_u32 m0, s48, 16384
    s_nop 0
    buffer_load_dwordx4 v83, s[24:27], s46 offen lds
    s_add_u32 s46, s47, 0x20000
    s_add_u32 m0, s48, 20480
    s_nop 0
    buffer_load_dwordx4 v83, s[24:27], s46 offen lds
    s_add_u32 s46, s47, 0x40000
    s_add_u32 m0, s48, 24576
    s_nop 0
    buffer_load_dwordx4 v83, s[24:27], s46 offen lds
    s_add_u32 s46, s47, 0x60000
    s_add_u32 m0, s48, 28672
    s_nop 0
    buffer_load_dwordx4 v83, s[24:27], s46 offen lds
    ds_read_b64_tr_b16 a[64:65], v80 offset:32768
    ds_read_b64_tr_b16 a[66:67], v80 offset:33792
    ds_read_b64_tr_b16 a[68:69], v80 offset:40960
    ds_read_b64_tr_b16 a[70:71], v80 offset:41984
    ds_read_b64_tr_b16 v[56:57], v81 offset:32768
    ds_read_b64_tr_b16 v[58:59], v81 offset:33792
    ds_read_b64_tr_b16 v[60:61], v81 offset:40960
    ds_read_b64_tr_b16 v[62:63], v81 offset:41984
    s_waitcnt lgkmcnt(0)
    ds_write_b128 v5, v[56:59] offset:0
    ds_write_b128 v5, v[60:63] offset:1024
    s_waitcnt lgkmcnt(0)
    s_waitcnt vmcnt(8)
    s_barrier
    v_add_u32 v83, 0x300000, v82
    v_and_b32 v83, 0x7fffff, v83
    s_add_u32 s46, s47, 0x0
    s_add_u32 m0, s48, 32768
    s_nop 0
    buffer_load_dwordx4 v83, s[24:27], s46 offen lds
    s_add_u32 s46, s47, 0x20000
    s_add_u32 m0, s48, 36864
    s_nop 0
    buffer_load_dwordx4 v83, s[24:27], s46 offen lds
    s_add_u32 s46, s47, 0x40000
    s_add_u32 m0, s48, 40960
    s_nop 0
    buffer_load_dwordx4 v83, s[24:27], s46 offen lds
    s_add_u32 s46, s47, 0x60000
    s_add_u32 m0, s48, 45056
    s_nop 0
    buffer_load_dwordx4 v83, s[24:27], s46 offen lds
    ds_read_b64_tr_b16 a[80:81], v80 offset:49152
    ds_read_b64_tr_b16 a[82:83], v80 offset:50176
    ds_read_b64_tr_b16 a[84:85], v80 offset:57344
    ds_read_b64_tr_b16 a[86:87], v80 offset:58368
    ds_read_b64_tr_b16 v[56:57], v81 offset:49152
    ds_read_b64_tr_b16 v[58:59], v81 offset:50176
    ds_read_b64_tr_b16 v[60:61], v81 offset:57344
    ds_read_b64_tr_b16 v[62:63], v81 offset:58368
    s_waitcnt lgkmcnt(0)
    ds_write_b128 v5, v[56:59] offset:4096
    ds_write_b128 v5, v[60:63] offset:5120
    s_waitcnt lgkmcnt(0)
    s_waitcnt vmcnt(8)
    s_barrier
    v_add_u32 v83, 0x380000, v82
    v_and_b32 v83, 0x7fffff, v83
    s_add_u32 s46, s47, 0x0
    s_add_u32 m0, s48, 49152
    s_nop 0
    buffer_load_dwordx4 v83, s[24:27], s46 offen lds
    s_add_u32 s46, s47, 0x20000
    s_add_u32 m0, s48, 53248
    s_nop 0
    buffer_load_dwordx4 v83, s[24:27], s46 offen lds
    s_add_u32 s46, s47, 0x40000
    s_add_u32 m0, s48, 57344
    s_nop 0
    buffer_load_dwordx4 v83, s[24:27], s46 offen lds
    s_add_u32 s46, s47, 0x60000
    s_add_u32 m0, s48, 61440
    s_nop 0
    buffer_load_dwordx4 v83, s[24:27], s46 offen lds
    ds_read_b64_tr_b16 a[104:105], v80 offset:0
    ds_read_b64_tr_b16 a[106:107], v80 offset:1024
    ds_read_b64_tr_b16 a[108:109], v80 offset:8192
    ds_read_b64_tr_b16 a[110:111], v80 offset:9216
    ds_read_b64_tr_b16 v[56:57], v81 offset:0
    ds_read_b64_tr_b16 v[58:59], v81 offset:1024
    ds_read_b64_tr_b16 v[60:61], v81 offset:8192
    ds_read_b64_tr_b16 v[62:63], v81 offset:9216
    s_waitcnt lgkmcnt(0)
    ds_write_b128 v5, v[56:59] offset:6144
    ds_write_b128 v5, v[60:63] offset:7168
    s_waitcnt lgkmcnt(0)
    s_waitcnt vmcnt(8)
    s_barrier
    v_add_u32 v83, 0x400000, v82
    v_and_b32 v83, 0x7fffff, v83
    s_add_u32 s46, s47, 0x0
    s_add_u32 m0, s48, 0
    s_nop 0
    buffer_load_dwordx4 v83, s[24:27], s46 offen lds
    s_add_u32 s46, s47, 0x20000
    s_add_u32 m0, s48, 4096
    s_nop 0
    buffer_load_dwordx4 v83, s[24:27], s46 offen lds
    s_add_u32 s46, s47, 0x40000
    s_add_u32 m0, s48, 8192
    s_nop 0
    buffer_load_dwordx4 v83, s[24:27], s46 offen lds
    s_add_u32 s46, s47, 0x60000
    s_add_u32 m0, s48, 12288
    s_nop 0
    buffer_load_dwordx4 v83, s[24:27], s46 offen lds
    ds_read_b64_tr_b16 a[128:129], v80 offset:16384
    ds_read_b64_tr_b16 a[130:131], v80 offset:17408
    ds_read_b64_tr_b16 a[132:133], v80 offset:24576
    ds_read_b64_tr_b16 a[134:135], v80 offset:25600
    ds_read_b64_tr_b16 v[56:57], v81 offset:16384
    ds_read_b64_tr_b16 v[58:59], v81 offset:17408
    ds_read_b64_tr_b16 v[60:61], v81 offset:24576
    ds_read_b64_tr_b16 v[62:63], v81 offset:25600
    s_waitcnt lgkmcnt(0)
    ds_write_b128 v5, v[56:59] offset:8192
    ds_write_b128 v5, v[60:63] offset:9216
    s_waitcnt lgkmcnt(0)
    s_waitcnt vmcnt(8)
    s_barrier
    v_add_u32 v83, 0x480000, v82
    v_and_b32 v83, 0x7fffff, v83
    s_add_u32 s46, s47, 0x0
    s_add_u32 m0, s48, 16384
    s_nop 0
    buffer_load_dwordx4 v83, s[24:27], s46 offen lds
    s_add_u32 s46, s47, 0x20000
    s_add_u32 m0, s48, 20480
    s_nop 0
    buffer_load_dwordx4 v83, s[24:27], s46 offen lds
    s_add_u32 s46, s47, 0x40000
    s_add_u32 m0, s48, 24576
    s_nop 0
    buffer_load_dwordx4 v83, s[24:27], s46 offen lds
    s_add_u32 s46, s47, 0x60000
    s_add_u32 m0, s48, 28672
    s_nop 0
    buffer_load_dwordx4 v83, s[24:27], s46 offen lds
    ds_read_b64_tr_b16 a[152:153], v80 offset:32768
    ds_read_b64_tr_b16 a[154:155], v80 offset:33792
    ds_read_b64_tr_b16 a[156:157], v80 offset:40960
    ds_read_b64_tr_b16 a[158:159], v80 offset:41984
    ds_read_b64_tr_b16 v[56:57], v81 offset:32768
    ds_read_b64_tr_b16 v[58:59], v81 offset:33792
    ds_read_b64_tr_b16 v[60:61], v81 offset:40960
    ds_read_b64_tr_b16 v[62:63], v81 offset:41984
    s_waitcnt lgkmcnt(0)
    ds_write_b128 v5, v[56:59] offset:10240
    ds_write_b128 v5, v[60:63] offset:11264
    s_waitcnt lgkmcnt(0)
    s_waitcnt vmcnt(8)
    s_barrier
    v_add_u32 v83, 0x500000, v82
    v_and_b32 v83, 0x7fffff, v83
    s_add_u32 s46, s47, 0x0
    s_add_u32 m0, s48, 32768
    s_nop 0
    buffer_load_dwordx4 v83, s[24:27], s46 offen lds
    s_add_u32 s46, s47, 0x20000
    s_add_u32 m0, s48, 36864
    s_nop 0
    buffer_load_dwordx4 v83, s[24:27], s46 offen lds
    s_add_u32 s46, s47, 0x40000
    s_add_u32 m0, s48, 40960
    s_nop 0
    buffer_load_dwordx4 v83, s[24:27], s46 offen lds
    s_add_u32 s46, s47, 0x60000
    s_add_u32 m0, s48, 45056
    s_nop 0
    buffer_load_dwordx4 v83, s[24:27], s46 offen lds
    ds_read_b64_tr_b16 a[176:177], v80 offset:49152
    ds_read_b64_tr_b16 a[178:179], v80 offset:50176
    ds_read_b64_tr_b16 a[180:181], v80 offset:57344
    ds_read_b64_tr_b16 a[182:183], v80 offset:58368
    ds_read_b64_tr_b16 a[184:185], v81 offset:49152
    ds_read_b64_tr_b16 a[186:187], v81 offset:50176
    ds_read_b64_tr_b16 a[188:189], v81 offset:57344
    ds_read_b64_tr_b16 a[190:191], v81 offset:58368
    s_waitcnt lgkmcnt(0)
    s_waitcnt vmcnt(8)
    s_barrier
    v_add_u32 v83, 0x580000, v82
    v_and_b32 v83, 0x7fffff, v83
    s_add_u32 s46, s47, 0x0
    s_add_u32 m0, s48, 49152
    s_nop 0
    buffer_load_dwordx4 v83, s[24:27], s46 offen lds
    s_add_u32 s46, s47, 0x20000
    s_add_u32 m0, s48, 53248
    s_nop 0
    buffer_load_dwordx4 v83, s[24:27], s46 offen lds
    s_add_u32 s46, s47, 0x40000
    s_add_u32 m0, s48, 57344
    s_nop 0
    buffer_load_dwordx4 v83, s[24:27], s46 offen lds
    s_add_u32 s46, s47, 0x60000
    s_add_u32 m0, s48, 61440
    s_nop 0
    buffer_load_dwordx4 v83, s[24:27], s46 offen lds
    ds_read_b64_tr_b16 a[208:209], v80 offset:0
    ds_read_b64_tr_b16 a[210:211], v80 offset:1024
    ds_read_b64_tr_b16 a[212:213], v80 offset:8192
    ds_read_b64_tr_b16 a[214:215], v80 offset:9216
    ds_read_b64_tr_b16 v[56:57], v81 offset:0
    ds_read_b64_tr_b16 v[58:59], v81 offset:1024
    ds_read_b64_tr_b16 v[60:61], v81 offset:8192
    ds_read_b64_tr_b16 v[62:63], v81 offset:9216
    s_waitcnt lgkmcnt(0)
    ds_write_b128 v5, v[56:59] offset:12288
    ds_write_b128 v5, v[60:63] offset:13312
    s_waitcnt lgkmcnt(0)
    s_waitcnt vmcnt(8)
    s_barrier
    v_add_u32 v83, 0x600000, v82
    v_and_b32 v83, 0x7fffff, v83
    s_add_u32 s46, s47, 0x0
    s_add_u32 m0, s48, 0
    s_nop 0
    buffer_load_dwordx4 v83, s[24:27], s46 offen lds
    s_add_u32 s46, s47, 0x20000
    s_add_u32 m0, s48, 4096
    s_nop 0
    buffer_load_dwordx4 v83, s[24:27], s46 offen lds
    s_add_u32 s46, s47, 0x40000
    s_add_u32 m0, s48, 8192
    s_nop 0
    buffer_load_dwordx4 v83, s[24:27], s46 offen lds
    s_add_u32 s46, s47, 0x60000
    s_add_u32 m0, s48, 12288
    s_nop 0
    buffer_load_dwordx4 v83, s[24:27], s46 offen lds
    ds_read_b64_tr_b16 a[232:233], v80 offset:16384
    ds_read_b64_tr_b16 a[234:235], v80 offset:17408
    ds_read_b64_tr_b16 a[236:237], v80 offset:24576
    ds_read_b64_tr_b16 a[238:239], v80 offset:25600
    ds_read_b64_tr_b16 a[240:241], v81 offset:16384
    ds_read_b64_tr_b16 a[242:243], v81 offset:17408
    ds_read_b64_tr_b16 a[244:245], v81 offset:24576
    ds_read_b64_tr_b16 a[246:247], v81 offset:25600
    s_waitcnt lgkmcnt(0)
    s_waitcnt vmcnt(8)
    s_barrier
    v_add_u32 v83, 0x680000, v82
    v_and_b32 v83, 0x7fffff, v83
    s_add_u32 s46, s47, 0x0
    s_add_u32 m0, s48, 16384
    s_nop 0
    buffer_load_dwordx4 v83, s[24:27], s46 offen lds
    s_add_u32 s46, s47, 0x20000
    s_add_u32 m0, s48, 20480
    s_nop 0
    buffer_load_dwordx4 v83, s[24:27], s46 offen lds
    s_add_u32 s46, s47, 0x40000
    s_add_u32 m0, s48, 24576
    s_nop 0
    buffer_load_dwordx4 v83, s[24:27], s46 offen lds
    s_add_u32 s46, s47, 0x60000
    s_add_u32 m0, s48, 28672
    s_nop 0
    buffer_load_dwordx4 v83, s[24:27], s46 offen lds
    ds_read_b64_tr_b16 v[104:105], v80 offset:32768
    ds_read_b64_tr_b16 v[106:107], v80 offset:33792
    ds_read_b64_tr_b16 v[108:109], v80 offset:40960
    ds_read_b64_tr_b16 v[110:111], v80 offset:41984
    ds_read_b64_tr_b16 v[56:57], v81 offset:32768
    ds_read_b64_tr_b16 v[58:59], v81 offset:33792
    ds_read_b64_tr_b16 v[60:61], v81 offset:40960
    ds_read_b64_tr_b16 v[62:63], v81 offset:41984
    s_waitcnt lgkmcnt(0)
    ds_write_b128 v5, v[56:59] offset:14336
    ds_write_b128 v5, v[60:63] offset:15360
    s_waitcnt lgkmcnt(0)
    s_waitcnt vmcnt(8)
    s_barrier
    v_add_u32 v83, 0x700000, v82
    v_and_b32 v83, 0x7fffff, v83
    s_add_u32 s46, s47, 0x0
    s_add_u32 m0, s48, 32768
    s_nop 0
    buffer_load_dwordx4 v83, s[24:27], s46 offen lds
    s_add_u32 s46, s47, 0x20000
    s_add_u32 m0, s48, 36864
    s_nop 0
    buffer_load_dwordx4 v83, s[24:27], s46 offen lds
    s_add_u32 s46, s47, 0x40000
    s_add_u32 m0, s48, 40960
    s_nop 0
    buffer_load_dwordx4 v83, s[24:27], s46 offen lds
    s_add_u32 s46, s47, 0x60000
    s_add_u32 m0, s48, 45056
    s_nop 0
    buffer_load_dwordx4 v83, s[24:27], s46 offen lds
    ds_read_b64_tr_b16 v[128:129], v80 offset:49152
    ds_read_b64_tr_b16 v[130:131], v80 offset:50176
    ds_read_b64_tr_b16 v[132:133], v80 offset:57344
    ds_read_b64_tr_b16 v[134:135], v80 offset:58368
    ds_read_b64_tr_b16 v[136:137], v81 offset:49152
    ds_read_b64_tr_b16 v[138:139], v81 offset:50176
    ds_read_b64_tr_b16 v[140:141], v81 offset:57344
    ds_read_b64_tr_b16 v[142:143], v81 offset:58368
    s_waitcnt lgkmcnt(0)
    s_waitcnt vmcnt(8)
    s_barrier
    v_add_u32 v83, 0x780000, v82
    v_and_b32 v83, 0x7fffff, v83
    s_add_u32 s46, s47, 0x0
    s_add_u32 m0, s48, 49152
    s_nop 0
    buffer_load_dwordx4 v83, s[24:27], s46 offen lds
    s_add_u32 s46, s47, 0x20000
    s_add_u32 m0, s48, 53248
    s_nop 0
    buffer_load_dwordx4 v83, s[24:27], s46 offen lds
    s_add_u32 s46, s47, 0x40000
    s_add_u32 m0, s48, 57344
    s_nop 0
    buffer_load_dwordx4 v83, s[24:27], s46 offen lds
    s_add_u32 s46, s47, 0x60000
    s_add_u32 m0, s48, 61440
    s_nop 0
    buffer_load_dwordx4 v83, s[24:27], s46 offen lds
    ds_read_b64_tr_b16 v[160:161], v80 offset:0
    ds_read_b64_tr_b16 v[162:163], v80 offset:1024
    ds_read_b64_tr_b16 v[164:165], v80 offset:8192
    ds_read_b64_tr_b16 v[166:167], v80 offset:9216
    ds_read_b64_tr_b16 v[56:57], v81 offset:0
    ds_read_b64_tr_b16 v[58:59], v81 offset:1024
    ds_read_b64_tr_b16 v[60:61], v81 offset:8192
    ds_read_b64_tr_b16 v[62:63], v81 offset:9216
    s_waitcnt lgkmcnt(0)
    ds_write_b128 v5, v[56:59] offset:16384
    ds_write_b128 v5, v[60:63] offset:17408
    s_waitcnt lgkmcnt(0)
    s_waitcnt vmcnt(8)
    s_barrier
    v_add_u32 v83, 0x0, v82
    v_and_b32 v83, 0x7fffff, v83
    s_add_u32 s46, s47, 0x0
    s_add_u32 m0, s48, 0
    s_nop 0
    buffer_load_dwordx4 v83, s[28:31], s46 offen lds
    s_add_u32 s46, s47, 0x20000
    s_add_u32 m0, s48, 4096
    s_nop 0
    buffer_load_dwordx4 v83, s[28:31], s46 offen lds
    s_add_u32 s46, s47, 0x40000
    s_add_u32 m0, s48, 8192
    s_nop 0
    buffer_load_dwordx4 v83, s[28:31], s46 offen lds
    s_add_u32 s46, s47, 0x60000
    s_add_u32 m0, s48, 12288
    s_nop 0
    buffer_load_dwordx4 v83, s[28:31], s46 offen lds
    ds_read_b64_tr_b16 v[184:185], v80 offset:16384
    ds_read_b64_tr_b16 v[186:187], v80 offset:17408
    ds_read_b64_tr_b16 v[188:189], v80 offset:24576
    ds_read_b64_tr_b16 v[190:191], v80 offset:25600
    ds_read_b64_tr_b16 v[192:193], v81 offset:16384
    ds_read_b64_tr_b16 v[194:195], v81 offset:17408
    ds_read_b64_tr_b16 v[196:197], v81 offset:24576
    ds_read_b64_tr_b16 v[198:199], v81 offset:25600
    s_waitcnt lgkmcnt(0)
    s_waitcnt vmcnt(8)
    s_barrier
    v_add_u32 v83, 0x80000, v82
    v_and_b32 v83, 0x7fffff, v83
    s_add_u32 s46, s47, 0x0
    s_add_u32 m0, s48, 16384
    s_nop 0
    buffer_load_dwordx4 v83, s[28:31], s46 offen lds
    s_add_u32 s46, s47, 0x20000
    s_add_u32 m0, s48, 20480
    s_nop 0
    buffer_load_dwordx4 v83, s[28:31], s46 offen lds
    s_add_u32 s46, s47, 0x40000
    s_add_u32 m0, s48, 24576
    s_nop 0
    buffer_load_dwordx4 v83, s[28:31], s46 offen lds
    s_add_u32 s46, s47, 0x60000
    s_add_u32 m0, s48, 28672
    s_nop 0
    buffer_load_dwordx4 v83, s[28:31], s46 offen lds
    ds_read_b64_tr_b16 v[208:209], v80 offset:32768
    ds_read_b64_tr_b16 v[210:211], v80 offset:33792
    ds_read_b64_tr_b16 v[212:213], v80 offset:40960
    ds_read_b64_tr_b16 v[214:215], v80 offset:41984
    ds_read_b64_tr_b16 v[56:57], v81 offset:32768
    ds_read_b64_tr_b16 v[58:59], v81 offset:33792
    ds_read_b64_tr_b16 v[60:61], v81 offset:40960
    ds_read_b64_tr_b16 v[62:63], v81 offset:41984
    s_waitcnt lgkmcnt(0)
    ds_write_b128 v5, v[56:59] offset:18432
    ds_write_b128 v5, v[60:63] offset:19456
    s_waitcnt lgkmcnt(0)
    s_waitcnt vmcnt(8)
    s_barrier
    v_add_u32 v83, 0x100000, v82
    v_and_b32 v83, 0x7fffff, v83
    s_add_u32 s46, s47, 0x0
    s_add_u32 m0, s48, 32768
    s_nop 0
    buffer_load_dwordx4 v83, s[28:31], s46 offen lds
    s_add_u32 s46, s47, 0x20000
    s_add_u32 m0, s48, 36864
    s_nop 0
    buffer_load_dwordx4 v83, s[28:31], s46 offen lds
    s_add_u32 s46, s47, 0x40000
    s_add_u32 m0, s48, 40960
    s_nop 0
    buffer_load_dwordx4 v83, s[28:31], s46 offen lds
    s_add_u32 s46, s47, 0x60000
    s_add_u32 m0, s48, 45056
    s_nop 0
    buffer_load_dwordx4 v83, s[28:31], s46 offen lds
    ds_read_b64_tr_b16 v[232:233], v80 offset:49152
    ds_read_b64_tr_b16 v[234:235], v80 offset:50176
    ds_read_b64_tr_b16 v[236:237], v80 offset:57344
    ds_read_b64_tr_b16 v[238:239], v80 offset:58368
    ds_read_b64_tr_b16 v[240:241], v81 offset:49152
    ds_read_b64_tr_b16 v[242:243], v81 offset:50176
    ds_read_b64_tr_b16 v[244:245], v81 offset:57344
    ds_read_b64_tr_b16 v[246:247], v81 offset:58368
    s_waitcnt lgkmcnt(0)
    s_waitcnt vmcnt(8)
    s_barrier
    v_add_u32 v83, 0x180000, v82
    v_and_b32 v83, 0x7fffff, v83
    s_add_u32 s46, s47, 0x0
    s_add_u32 m0, s48, 49152
    s_nop 0
    buffer_load_dwordx4 v83, s[28:31], s46 offen lds
    s_add_u32 s46, s47, 0x20000
    s_add_u32 m0, s48, 53248
    s_nop 0
    buffer_load_dwordx4 v83, s[28:31], s46 offen lds
    s_add_u32 s46, s47, 0x40000
    s_add_u32 m0, s48, 57344
    s_nop 0
    buffer_load_dwordx4 v83, s[28:31], s46 offen lds
    s_add_u32 s46, s47, 0x60000
    s_add_u32 m0, s48, 61440
    s_nop 0
    buffer_load_dwordx4 v83, s[28:31], s46 offen lds
    ds_read_b64_tr_b16 a[16:17], v80 offset:0
    ds_read_b64_tr_b16 a[18:19], v80 offset:1024
    ds_read_b64_tr_b16 a[20:21], v80 offset:8192
    ds_read_b64_tr_b16 a[22:23], v80 offset:9216
    ds_read_b64_tr_b16 a[24:25], v81 offset:0
    ds_read_b64_tr_b16 a[26:27], v81 offset:1024
    ds_read_b64_tr_b16 a[28:29], v81 offset:8192
    ds_read_b64_tr_b16 a[30:31], v81 offset:9216
    s_waitcnt lgkmcnt(0)
    s_waitcnt vmcnt(8)
    s_barrier
    v_add_u32 v83, 0x200000, v82
    v_and_b32 v83, 0x7fffff, v83
    s_add_u32 s46, s47, 0x0
    s_add_u32 m0, s48, 0
    s_nop 0
    buffer_load_dwordx4 v83, s[28:31], s46 offen lds
    s_add_u32 s46, s47, 0x20000
    s_add_u32 m0, s48, 4096
    s_nop 0
    buffer_load_dwordx4 v83, s[28:31], s46 offen lds
    s_add_u32 s46, s47, 0x40000
    s_add_u32 m0, s48, 8192
    s_nop 0
    buffer_load_dwordx4 v83, s[28:31], s46 offen lds
    s_add_u32 s46, s47, 0x60000
    s_add_u32 m0, s48, 12288
    s_nop 0
    buffer_load_dwordx4 v83, s[28:31], s46 offen lds
    ds_read_b64_tr_b16 a[48:49], v80 offset:16384
    ds_read_b64_tr_b16 a[50:51], v80 offset:17408
    ds_read_b64_tr_b16 a[52:53], v80 offset:24576
    ds_read_b64_tr_b16 a[54:55], v80 offset:25600
    ds_read_b64_tr_b16 a[56:57], v81 offset:16384
    ds_read_b64_tr_b16 a[58:59], v81 offset:17408
    ds_read_b64_tr_b16 a[60:61], v81 offset:24576
    ds_read_b64_tr_b16 a[62:63], v81 offset:25600
    s_waitcnt lgkmcnt(0)
    s_waitcnt vmcnt(8)
    s_barrier
    v_add_u32 v83, 0x280000, v82
    v_and_b32 v83, 0x7fffff, v83
    s_add_u32 s46, s47, 0x0
    s_add_u32 m0, s48, 16384
    s_nop 0
    buffer_load_dwordx4 v83, s[28:31], s46 offen lds
    s_add_u32 s46, s47, 0x20000
    s_add_u32 m0, s48, 20480
    s_nop 0
    buffer_load_dwordx4 v83, s[28:31], s46 offen lds
    s_add_u32 s46, s47, 0x40000
    s_add_u32 m0, s48, 24576
    s_nop 0
    buffer_load_dwordx4 v83, s[28:31], s46 offen lds
    s_add_u32 s46, s47, 0x60000
    s_add_u32 m0, s48, 28672
    s_nop 0
    buffer_load_dwordx4 v83, s[28:31], s46 offen lds
    ds_read_b64_tr_b16 a[72:73], v80 offset:32768
    ds_read_b64_tr_b16 a[74:75], v80 offset:33792
    ds_read_b64_tr_b16 a[76:77], v80 offset:40960
    ds_read_b64_tr_b16 a[78:79], v80 offset:41984
    ds_read_b64_tr_b16 v[56:57], v81 offset:32768
    ds_read_b64_tr_b16 v[58:59], v81 offset:33792
    ds_read_b64_tr_b16 v[60:61], v81 offset:40960
    ds_read_b64_tr_b16 v[62:63], v81 offset:41984
    s_waitcnt lgkmcnt(0)
    ds_write_b128 v5, v[56:59] offset:2048
    ds_write_b128 v5, v[60:63] offset:3072
    s_waitcnt lgkmcnt(0)
    s_waitcnt vmcnt(8)
    s_barrier
    v_add_u32 v83, 0x300000, v82
    v_and_b32 v83, 0x7fffff, v83
    s_add_u32 s46, s47, 0x0
    s_add_u32 m0, s48, 32768
    s_nop 0
    buffer_load_dwordx4 v83, s[28:31], s46 offen lds
    s_add_u32 s46, s47, 0x20000
    s_add_u32 m0, s48, 36864
    s_nop 0
    buffer_load_dwordx4 v83, s[28:31], s46 offen lds
    s_add_u32 s46, s47, 0x40000
    s_add_u32 m0, s48, 40960
    s_nop 0
    buffer_load_dwordx4 v83, s[28:31], s46 offen lds
    s_add_u32 s46, s47, 0x60000
    s_add_u32 m0, s48, 45056
    s_nop 0
    buffer_load_dwordx4 v83, s[28:31], s46 offen lds
    ds_read_b64_tr_b16 a[88:89], v80 offset:49152
    ds_read_b64_tr_b16 a[90:91], v80 offset:50176
    ds_read_b64_tr_b16 a[92:93], v80 offset:57344
    ds_read_b64_tr_b16 a[94:95], v80 offset:58368
    ds_read_b64_tr_b16 a[96:97], v81 offset:49152
    ds_read_b64_tr_b16 a[98:99], v81 offset:50176
    ds_read_b64_tr_b16 a[100:101], v81 offset:57344
    ds_read_b64_tr_b16 a[102:103], v81 offset:58368
    s_waitcnt lgkmcnt(0)
    s_waitcnt vmcnt(8)
    s_barrier
    v_add_u32 v83, 0x380000, v82
    v_and_b32 v83, 0x7fffff, v83
    s_add_u32 s46, s47, 0x0
    s_add_u32 m0, s48, 49152
    s_nop 0
    buffer_load_dwordx4 v83, s[28:31], s46 offen lds
    s_add_u32 s46, s47, 0x20000
    s_add_u32 m0, s48, 53248
    s_nop 0
    buffer_load_dwordx4 v83, s[28:31], s46 offen lds
    s_add_u32 s46, s47, 0x40000
    s_add_u32 m0, s48, 57344
    s_nop 0
    buffer_load_dwordx4 v83, s[28:31], s46 offen lds
    s_add_u32 s46, s47, 0x60000
    s_add_u32 m0, s48, 61440
    s_nop 0
    buffer_load_dwordx4 v83, s[28:31], s46 offen lds
    ds_read_b64_tr_b16 a[112:113], v80 offset:0
    ds_read_b64_tr_b16 a[114:115], v80 offset:1024
    ds_read_b64_tr_b16 a[116:117], v80 offset:8192
    ds_read_b64_tr_b16 a[118:119], v80 offset:9216
    ds_read_b64_tr_b16 a[120:121], v81 offset:0
    ds_read_b64_tr_b16 a[122:123], v81 offset:1024
    ds_read_b64_tr_b16 a[124:125], v81 offset:8192
    ds_read_b64_tr_b16 a[126:127], v81 offset:9216
    s_waitcnt lgkmcnt(0)
    s_waitcnt vmcnt(8)
    s_barrier
    v_add_u32 v83, 0x400000, v82
    v_and_b32 v83, 0x7fffff, v83
    s_add_u32 s46, s47, 0x0
    s_add_u32 m0, s48, 0
    s_nop 0
    buffer_load_dwordx4 v83, s[28:31], s46 offen lds
    s_add_u32 s46, s47, 0x20000
    s_add_u32 m0, s48, 4096
    s_nop 0
    buffer_load_dwordx4 v83, s[28:31], s46 offen lds
    s_add_u32 s46, s47, 0x40000
    s_add_u32 m0, s48, 8192
    s_nop 0
    buffer_load_dwordx4 v83, s[28:31], s46 offen lds
    s_add_u32 s46, s47, 0x60000
    s_add_u32 m0, s48, 12288
    s_nop 0
    buffer_load_dwordx4 v83, s[28:31], s46 offen lds
    ds_read_b64_tr_b16 a[136:137], v80 offset:16384
    ds_read_b64_tr_b16 a[138:139], v80 offset:17408
    ds_read_b64_tr_b16 a[140:141], v80 offset:24576
    ds_read_b64_tr_b16 a[142:143], v80 offset:25600
    ds_read_b64_tr_b16 a[144:145], v81 offset:16384
    ds_read_b64_tr_b16 a[146:147], v81 offset:17408
    ds_read_b64_tr_b16 a[148:149], v81 offset:24576
    ds_read_b64_tr_b16 a[150:151], v81 offset:25600
    s_waitcnt lgkmcnt(0)
    s_waitcnt vmcnt(8)
    s_barrier
    v_add_u32 v83, 0x480000, v82
    v_and_b32 v83, 0x7fffff, v83
    s_add_u32 s46, s47, 0x0
    s_add_u32 m0, s48, 16384
    s_nop 0
    buffer_load_dwordx4 v83, s[28:31], s46 offen lds
    s_add_u32 s46, s47, 0x20000
    s_add_u32 m0, s48, 20480
    s_nop 0
    buffer_load_dwordx4 v83, s[28:31], s46 offen lds
    s_add_u32 s46, s47, 0x40000
    s_add_u32 m0, s48, 24576
    s_nop 0
    buffer_load_dwordx4 v83, s[28:31], s46 offen lds
    s_add_u32 s46, s47, 0x60000
    s_add_u32 m0, s48, 28672
    s_nop 0
    buffer_load_dwordx4 v83, s[28:31], s46 offen lds
    ds_read_b64_tr_b16 a[160:161], v80 offset:32768
    ds_read_b64_tr_b16 a[162:163], v80 offset:33792
    ds_read_b64_tr_b16 a[164:165], v80 offset:40960
    ds_read_b64_tr_b16 a[166:167], v80 offset:41984
    ds_read_b64_tr_b16 a[168:169], v81 offset:32768
    ds_read_b64_tr_b16 a[170:171], v81 offset:33792
    ds_read_b64_tr_b16 a[172:173], v81 offset:40960
    ds_read_b64_tr_b16 a[174:175], v81 offset:41984
    s_waitcnt lgkmcnt(0)
    s_waitcnt vmcnt(8)
    s_barrier
    v_add_u32 v83, 0x500000, v82
    v_and_b32 v83, 0x7fffff, v83
    s_add_u32 s46, s47, 0x0
    s_add_u32 m0, s48, 32768
    s_nop 0
    buffer_load_dwordx4 v83, s[28:31], s46 offen lds
    s_add_u32 s46, s47, 0x20000
    s_add_u32 m0, s48, 36864
    s_nop 0
    buffer_load_dwordx4 v83, s[28:31], s46 offen lds
    s_add_u32 s46, s47, 0x40000
    s_add_u32 m0, s48, 40960
    s_nop 0
    buffer_load_dwordx4 v83, s[28:31], s46 offen lds
    s_add_u32 s46, s47, 0x60000
    s_add_u32 m0, s48, 45056
    s_nop 0
    buffer_load_dwordx4 v83, s[28:31], s46 offen lds
    ds_read_b64_tr_b16 a[192:193], v80 offset:49152
    ds_read_b64_tr_b16 a[194:195], v80 offset:50176
    ds_read_b64_tr_b16 a[196:197], v80 offset:57344
    ds_read_b64_tr_b16 a[198:199], v80 offset:58368
    ds_read_b64_tr_b16 a[200:201], v81 offset:49152
    ds_read_b64_tr_b16 a[202:203], v81 offset:50176
    ds_read_b64_tr_b16 a[204:205], v81 offset:57344
    ds_read_b64_tr_b16 a[206:207], v81 offset:58368
    s_waitcnt lgkmcnt(0)
    s_waitcnt vmcnt(8)
    s_barrier
    v_add_u32 v83, 0x580000, v82
    v_and_b32 v83, 0x7fffff, v83
    s_add_u32 s46, s47, 0x0
    s_add_u32 m0, s48, 49152
    s_nop 0
    buffer_load_dwordx4 v83, s[28:31], s46 offen lds
    s_add_u32 s46, s47, 0x20000
    s_add_u32 m0, s48, 53248
    s_nop 0
    buffer_load_dwordx4 v83, s[28:31], s46 offen lds
    s_add_u32 s46, s47, 0x40000
    s_add_u32 m0, s48, 57344
    s_nop 0
    buffer_load_dwordx4 v83, s[28:31], s46 offen lds
    s_add_u32 s46, s47, 0x60000
    s_add_u32 m0, s48, 61440
    s_nop 0
    buffer_load_dwordx4 v83, s[28:31], s46 offen lds
    ds_read_b64_tr_b16 a[216:217], v80 offset:0
    ds_read_b64_tr_b16 a[218:219], v80 offset:1024
    ds_read_b64_tr_b16 a[220:221], v80 offset:8192
    ds_read_b64_tr_b16 a[222:223], v80 offset:9216
    ds_read_b64_tr_b16 a[224:225], v81 offset:0
    ds_read_b64_tr_b16 a[226:227], v81 offset:1024
    ds_read_b64_tr_b16 a[228:229], v81 offset:8192
    ds_read_b64_tr_b16 a[230:231], v81 offset:9216
    s_waitcnt lgkmcnt(0)
    s_waitcnt vmcnt(8)
    s_barrier
    v_add_u32 v83, 0x600000, v82
    v_and_b32 v83, 0x7fffff, v83
    s_add_u32 s46, s47, 0x0
    s_add_u32 m0, s48, 0
    s_nop 0
    buffer_load_dwordx4 v83, s[28:31], s46 offen lds
    s_add_u32 s46, s47, 0x20000
    s_add_u32 m0, s48, 4096
    s_nop 0
    buffer_load_dwordx4 v83, s[28:31], s46 offen lds
    s_add_u32 s46, s47, 0x40000
    s_add_u32 m0, s48, 8192
    s_nop 0
    buffer_load_dwordx4 v83, s[28:31], s46 offen lds
    s_add_u32 s46, s47, 0x60000
    s_add_u32 m0, s48, 12288
    s_nop 0
    buffer_load_dwordx4 v83, s[28:31], s46 offen lds
    ds_read_b64_tr_b16 a[248:249], v80 offset:16384
    ds_read_b64_tr_b16 a[250:251], v80 offset:17408
    ds_read_b64_tr_b16 a[252:253], v80 offset:24576
    ds_read_b64_tr_b16 a[254:255], v80 offset:25600
    ds_read_b64_tr_b16 v[96:97], v81 offset:16384
    ds_read_b64_tr_b16 v[98:99], v81 offset:17408
    ds_read_b64_tr_b16 v[100:101], v81 offset:24576
    ds_read_b64_tr_b16 v[102:103], v81 offset:25600
    s_waitcnt lgkmcnt(0)
    s_waitcnt vmcnt(8)
    s_barrier
    v_add_u32 v83, 0x680000, v82
    v_and_b32 v83, 0x7fffff, v83
    s_add_u32 s46, s47, 0x0
    s_add_u32 m0, s48, 16384
    s_nop 0
    buffer_load_dwordx4 v83, s[28:31], s46 offen lds
    s_add_u32 s46, s47, 0x20000
    s_add_u32 m0, s48, 20480
    s_nop 0
    buffer_load_dwordx4 v83, s[28:31], s46 offen lds
    s_add_u32 s46, s47, 0x40000
    s_add_u32 m0, s48, 24576
    s_nop 0
    buffer_load_dwordx4 v83, s[28:31], s46 offen lds
    s_add_u32 s46, s47, 0x60000
    s_add_u32 m0, s48, 28672
    s_nop 0
    buffer_load_dwordx4 v83, s[28:31], s46 offen lds
    ds_read_b64_tr_b16 v[112:113], v80 offset:32768
    ds_read_b64_tr_b16 v[114:115], v80 offset:33792
    ds_read_b64_tr_b16 v[116:117], v80 offset:40960
    ds_read_b64_tr_b16 v[118:119], v80 offset:41984
    ds_read_b64_tr_b16 v[120:121], v81 offset:32768
    ds_read_b64_tr_b16 v[122:123], v81 offset:33792
    ds_read_b64_tr_b16 v[124:125], v81 offset:40960
    ds_read_b64_tr_b16 v[126:127], v81 offset:41984
    s_waitcnt lgkmcnt(0)
    s_waitcnt vmcnt(8)
    s_barrier
    v_add_u32 v83, 0x700000, v82
    v_and_b32 v83, 0x7fffff, v83
    s_add_u32 s46, s47, 0x0
    s_add_u32 m0, s48, 32768
    s_nop 0
    buffer_load_dwordx4 v83, s[28:31], s46 offen lds
    s_add_u32 s46, s47, 0x20000
    s_add_u32 m0, s48, 36864
    s_nop 0
    buffer_load_dwordx4 v83, s[28:31], s46 offen lds
    s_add_u32 s46, s47, 0x40000
    s_add_u32 m0, s48, 40960
    s_nop 0
    buffer_load_dwordx4 v83, s[28:31], s46 offen lds
    s_add_u32 s46, s47, 0x60000
    s_add_u32 m0, s48, 45056
    s_nop 0
    buffer_load_dwordx4 v83, s[28:31], s46 offen lds
    ds_read_b64_tr_b16 v[144:145], v80 offset:49152
    ds_read_b64_tr_b16 v[146:147], v80 offset:50176
    ds_read_b64_tr_b16 v[148:149], v80 offset:57344
    ds_read_b64_tr_b16 v[150:151], v80 offset:58368
    ds_read_b64_tr_b16 v[152:153], v81 offset:49152
    ds_read_b64_tr_b16 v[154:155], v81 offset:50176
    ds_read_b64_tr_b16 v[156:157], v81 offset:57344
    ds_read_b64_tr_b16 v[158:159], v81 offset:58368
    s_waitcnt lgkmcnt(0)
    s_waitcnt vmcnt(8)
    s_barrier
    v_add_u32 v83, 0x780000, v82
    v_and_b32 v83, 0x7fffff, v83
    s_add_u32 s46, s47, 0x0
    s_add_u32 m0, s48, 49152
    s_nop 0
    buffer_load_dwordx4 v83, s[28:31], s46 offen lds
    s_add_u32 s46, s47, 0x20000
    s_add_u32 m0, s48, 53248
    s_nop 0
    buffer_load_dwordx4 v83, s[28:31], s46 offen lds
    s_add_u32 s46, s47, 0x40000
    s_add_u32 m0, s48, 57344
    s_nop 0
    buffer_load_dwordx4 v83, s[28:31], s46 offen lds
    s_add_u32 s46, s47, 0x60000
    s_add_u32 m0, s48, 61440
    s_nop 0
    buffer_load_dwordx4 v83, s[28:31], s46 offen lds
    ds_read_b64_tr_b16 v[168:169], v80 offset:0
    ds_read_b64_tr_b16 v[170:171], v80 offset:1024
    ds_read_b64_tr_b16 v[172:173], v80 offset:8192
    ds_read_b64_tr_b16 v[174:175], v80 offset:9216
    ds_read_b64_tr_b16 v[176:177], v81 offset:0
    ds_read_b64_tr_b16 v[178:179], v81 offset:1024
    ds_read_b64_tr_b16 v[180:181], v81 offset:8192
    ds_read_b64_tr_b16 v[182:183], v81 offset:9216
    s_waitcnt lgkmcnt(0)
    s_waitcnt vmcnt(8)
    s_barrier
    ds_read_b64_tr_b16 v[200:201], v80 offset:16384
    ds_read_b64_tr_b16 v[202:203], v80 offset:17408
    ds_read_b64_tr_b16 v[204:205], v80 offset:24576
    ds_read_b64_tr_b16 v[206:207], v80 offset:25600
    ds_read_b64_tr_b16 v[56:57], v81 offset:16384
    ds_read_b64_tr_b16 v[58:59], v81 offset:17408
    ds_read_b64_tr_b16 v[60:61], v81 offset:24576
    ds_read_b64_tr_b16 v[62:63], v81 offset:25600
    s_waitcnt lgkmcnt(0)
    ds_write_b128 v5, v[56:59] offset:22528
    ds_write_b128 v5, v[60:63] offset:23552
    s_waitcnt lgkmcnt(0)
    s_waitcnt vmcnt(4)
    s_barrier
    ds_read_b64_tr_b16 v[216:217], v80 offset:32768
    ds_read_b64_tr_b16 v[218:219], v80 offset:33792
    ds_read_b64_tr_b16 v[220:221], v80 offset:40960
    ds_read_b64_tr_b16 v[222:223], v80 offset:41984
    ds_read_b64_tr_b16 v[224:225], v81 offset:32768
    ds_read_b64_tr_b16 v[226:227], v81 offset:33792
    ds_read_b64_tr_b16 v[228:229], v81 offset:40960
    ds_read_b64_tr_b16 v[230:231], v81 offset:41984
    s_waitcnt lgkmcnt(0)
    s_waitcnt vmcnt(0)
    s_barrier
    ds_read_b64_tr_b16 v[248:249], v80 offset:49152
    ds_read_b64_tr_b16 v[250:251], v80 offset:50176
    ds_read_b64_tr_b16 v[252:253], v80 offset:57344
    ds_read_b64_tr_b16 v[254:255], v80 offset:58368
    ds_read_b64_tr_b16 v[56:57], v81 offset:49152
    ds_read_b64_tr_b16 v[58:59], v81 offset:50176
    ds_read_b64_tr_b16 v[60:61], v81 offset:57344
    ds_read_b64_tr_b16 v[62:63], v81 offset:58368
    s_waitcnt lgkmcnt(0)
    ds_write_b128 v5, v[56:59] offset:20480
    ds_write_b128 v5, v[60:63] offset:21504
    s_waitcnt lgkmcnt(0)
    s_barrier
    v_and_b32 v63, 15, v1
    v_lshrrev_b32 v64, 4, v1
    v_lshrrev_b32 v65, 5, v1
    v_lshlrev_b32 v65, 4, v65
    v_add_u32 v65, v65, v63
    v_lshlrev_b32 v65, 4, v65
    v_and_b32 v66, 1, v64
    v_lshlrev_b32 v66, 3, v66
    s_lshl_b32 s45, s44, 9
    s_add_u32 s45, s45, 53248
    v_add3_u32 v6, v65, v66, s45
    v_bfe_u32 v65, v1, 2, 2
    v_lshlrev_b32 v66, 3, v64
    v_add_u32 v65, v65, v66
    v_lshlrev_b32 v65, 4, v65
    v_and_b32 v66, 1, v1
    v_lshlrev_b32 v66, 3, v66
    v_add_u32 v65, v65, v66
    v_add_u32 v7, 53248, v65
    v_bfe_u32 v65, v1, 2, 1
    v_lshlrev_b32 v65, 4, v65
    v_bfe_u32 v66, v1, 3, 1
    v_lshlrev_b32 v66, 2, v66
    v_and_b32 v67, 3, v1
    v_add3_u32 v65, v65, v66, v67
    v_lshlrev_b32 v65, 5, v65
    v_lshlrev_b32 v66, 3, v64
    s_lshl_b32 s45, s44, 10
    s_add_u32 s45, s45, 55296
    v_add3_u32 v18, v65, v66, s45
    v_lshlrev_b32 v16, 3, v1
    v_lshrrev_b32 v65, 2, v63
    v_mul_u32_u24 v65, 1088, v65
    v_and_b32 v66, 3, v63
    v_xor_b32 v67, v66, v64
    v_lshlrev_b32 v66, 8, v66
    v_lshlrev_b32 v67, 4, v67
    v_add3_u32 v8, v65, v66, v67
    v_mul_u32_u24 v65, 1056, v64
    v_bfe_u32 v66, v1, 2, 2
    v_xor_b32 v67, s44, v66
    v_lshlrev_b32 v66, 8, v66
    v_lshlrev_b32 v67, 6, v67
    v_add3_u32 v65, v65, v66, v67
    v_and_b32 v66, 3, v1
    v_lshlrev_b32 v66, 3, v66
    v_add_u32 v9, v65, v66
    s_lshl_b32 s45, s44, 2
    v_add_u32 v65, s45, v64
    v_lshlrev_b32 v66, 8, v65
    v_xor_b32 v67, v63, v64
    v_lshlrev_b32 v67, 4, v67
    v_add_u32 v14, v66, v67
    v_lshlrev_b32 v67, 2, v64
    v_xor_b32 v67, v63, v67
    v_lshlrev_b32 v67, 4, v67
    v_add_u32 v15, v66, v67
    s_lshl_b32 s45, s43, 11
    s_lshl_b32 s46, s44, 9
    s_add_u32 s45, s45, s46
    s_add_u32 s51, s45, 0x7020000
    s_lshl_b32 s63, s43, 19
    s_add_u32 s63, s63, 0x3000000
    s_mov_b32 s50, 0
    s_mul_i32 s64, s44, 1088
    s_add_u32 s64, s64, 16384
    s_mul_i32 s65, s44, 1056
    s_add_u32 s65, s65, 25088
    s_lshl_b32 s66, s43, 12
    s_add_u32 s66, s66, 0x1000000
    s_mov_b32 s69, 17408
    s_mov_b32 s52, 0x3e0293ee
    v_and_b32 v19, 3, v1
    v_lshlrev_b32 v19, 10, v19
    s_lshl_b32 s45, s44, 12
    s_add_u32 s45, s45, 1020
    v_add_u32 v19, s45, v19
    v_mov_b32 v29, 128
    s_mov_b32 s46, 192
    s_mov_b64 exec, 1
    s_mov_b32 s70, 0
L_wp_5:
    buffer_load_dword v31, v29, s[16:19], 0 offen sc1
    s_add_u32 s70, s70, 1
    s_cmp_ge_u32 s70, 0x200000
    s_cbranch_scc1 L_c_done_1
    s_waitcnt vmcnt(0)
    v_cmp_gt_u32 vcc, s46, v31
    s_nop 1
    s_cbranch_vccz L_wp_5_ok
    s_sleep 2
    s_branch L_wp_5
L_wp_5_ok:
    s_mov_b64 exec, -1
    s_mov_b32 s47, 0
    s_cmp_lt_u32 s47, s50
    s_cbranch_scc1 L_kv_rdy_6
    s_lshl_b32 s45, s43, 7
    s_add_u32 s45, s45, 0x10008
    v_mov_b32 v0, 0
    s_mov_b32 s70, 0
L_kv_rdy_6_p:
    buffer_load_dwordx4 v[10:13], v0, s[12:15], s45 offen sc1
    s_add_u32 s70, s70, 1
    s_cmp_ge_u32 s70, 0x200000
    s_cbranch_scc1 L_c_done_1
    s_waitcnt vmcnt(0)
    v_min_u32 v10, v10, v12
    v_min_u32 v11, v11, v13
    v_lshlrev_b32 v10, 1, v10
    v_lshlrev_b32 v11, 1, v11
    v_add_u32 v11, 1, v11
    v_min_u32 v10, v10, v11
    s_nop 0
    v_readfirstlane_b32 s50, v10
    s_nop 3
    s_cmp_lt_u32 s47, s50
    s_cbranch_scc1 L_kv_rdy_6
    s_sleep 2
    s_branch L_kv_rdy_6_p
L_kv_rdy_6:
    s_mov_b32 m0, s64
    s_add_u32 s45, s63, 4096
    buffer_load_dwordx4 v14, s[12:15], s63 offen sc1 lds
    s_add_u32 m0, s64, 4352
    s_add_u32 s46, s63, 0x1000000
    buffer_load_dwordx4 v14, s[12:15], s45 offen sc1 lds
    s_mov_b32 m0, s65
    s_add_u32 s45, s45, 0x1000000
    buffer_load_dwordx4 v15, s[12:15], s46 offen sc1 lds
    s_add_u32 m0, s65, 4224
    s_add_u32 s63, s63, 8192
    buffer_load_dwordx4 v15, s[12:15], s45 offen sc1 lds
    s_add_u32 s64, s64, 17408
    s_add_u32 s65, s65, 17408
    s_mov_b32 s70, 0
    v_mov_b32 v41, 0
L_hw_7:
    s_sleep 2
    buffer_load_dword v44, v41, s[16:19], 0 offen sc1
    s_add_u32 s70, s70, 1
    s_cmp_ge_u32 s70, 0x100000
    s_cbranch_scc1 L_c_done_1
    s_waitcnt vmcnt(0)
    v_readfirstlane_b32 s45, v44
    s_cmp_lg_u32 s45, 64
    s_cbranch_scc1 L_hw_7
    buffer_load_dwordx4 v[44:47], v41, s[16:19], 0 offen sc1
    s_waitcnt vmcnt(0)
    v_readfirstlane_b32 s45, v45
    v_readfirstlane_b32 s46, v46
    v_readfirstlane_b32 s68, v47
    s_bcnt1_i32_b32 s45, s45
    s_bcnt1_i32_b32 s46, s46
    s_add_u32 s45, s45, s46
    s_cmp_eq_u32 s45, 2
    s_cselect_b32 s67, 1, 0
    s_cmp_ge_u32 s68, 16
    s_cselect_b32 s68, 8192, 0
    s_mov_b32 s60, 0
    s_lshl_b32 s58, s40, 16
    s_add_u32 s58, s58, 0x7000000
    s_mov_b32 s61, s58
    s_lshl_b32 s59, s40, 17
    s_add_u32 s59, s59, 0x7040000
    s_mov_b32 s62, s59
L_q_loop_8:
    ds_read_b128 v[56:59], v5 offset:0
    ds_read_b128 v[60:63], v5 offset:1024
    ds_read_b128 v[64:67], v5 offset:2048
    ds_read_b128 v[68:71], v5 offset:3072
    ds_read_b128 v[72:75], v5 offset:4096
    ds_read_b128 v[76:79], v5 offset:5120
    ds_read_b128 v[80:83], v5 offset:6144
    ds_read_b128 v[84:87], v5 offset:7168
    ds_read_b128 v[88:91], v5 offset:8192
    ds_read_b128 v[92:95], v5 offset:9216
    s_cmp_eq_u32 s60, 0
    s_cbranch_scc1 L_q_first_9
    s_sleep 24
    s_mov_b64 exec, 15
    buffer_load_dword v10, v19, s[12:15], s61 offen sc1
    s_nop 15
    buffer_load_dword v11, v19, s[12:15], s61 offen sc1
    s_nop 15
    buffer_load_dword v12, v19, s[12:15], s61 offen sc1
    s_nop 15
    buffer_load_dword v13, v19, s[12:15], s61 offen sc1
    s_mov_b32 s70, 0
L_pp_10:
    s_waitcnt vmcnt(3)
    v_cmp_eq_u32 vcc, -1, v10
    s_add_u32 s70, s70, 1
    s_nop 0
    s_cbranch_vccz L_ppd_11
    buffer_load_dword v10, v19, s[12:15], s61 offen sc1
    s_waitcnt vmcnt(3)
    v_cmp_eq_u32 vcc, -1, v11
    s_add_u32 s70, s70, 1
    s_nop 0
    s_cbranch_vccz L_ppd_11
    buffer_load_dword v11, v19, s[12:15], s61 offen sc1
    s_waitcnt vmcnt(3)
    v_cmp_eq_u32 vcc, -1, v12
    s_add_u32 s70, s70, 1
    s_nop 0
    s_cbranch_vccz L_ppd_11
    buffer_load_dword v12, v19, s[12:15], s61 offen sc1
    s_waitcnt vmcnt(3)
    v_cmp_eq_u32 vcc, -1, v13
    s_add_u32 s70, s70, 1
    s_nop 0
    s_cbranch_vccz L_ppd_11
    buffer_load_dword v13, v19, s[12:15], s61 offen sc1
    s_cmp_lt_u32 s70, 0x400000
    s_cbranch_scc1 L_pp_10
    s_branch L_c_done_1
L_ppd_11:
    s_mov_b64 exec, -1
L_q_first_9:
    s_waitcnt lgkmcnt(0)
    s_mov_b32 s70, 0
L_mg_12:
    buffer_load_dwordx4 v[40:43], v3, s[12:15], s61 offen offset:0 sc1
    s_nop 9
    buffer_load_dwordx4 v[44:47], v3, s[12:15], s61 offen offset:1024 sc1
    s_nop 9
    buffer_load_dwordx4 v[48:51], v3, s[12:15], s61 offen offset:2048 sc1
    s_nop 9
    buffer_load_dwordx4 v[52:55], v3, s[12:15], s61 offen offset:3072 sc1
    s_add_u32 s70, s70, 1
    s_cmp_ge_u32 s70, 0x100000
    s_cbranch_scc1 L_c_done_1
    s_nop 1
    v_mov_b32 v24, 0
    v_mov_b32 v25, 0
    v_mov_b32 v26, 0
    v_mov_b32 v27, 0
    v_mov_b32 v28, 0
    v_mov_b32 v29, 0
    v_mov_b32 v30, 0
    v_mov_b32 v31, 0
    v_mov_b32 v32, 0
    v_mov_b32 v33, 0
    v_mov_b32 v34, 0
    v_mov_b32 v35, 0
    v_mov_b32 v36, 0
    v_mov_b32 v37, 0
    v_mov_b32 v38, 0
    v_mov_b32 v39, 0
    s_waitcnt vmcnt(3)
    ds_write_b128 v3, v[40:43] offset:0
    v_smfmac_f32_16x16x64_bf16 v[24:27], v[40:43], a[0:7], v2
    v_max3_u32 v22, v40, v41, v42
    v_smfmac_f32_16x16x64_bf16 v[28:31], v[40:43], a[8:15], v2
    v_max_u32 v22, v22, v43
    v_smfmac_f32_16x16x64_bf16 v[32:35], v[40:43], a[16:23], v2
    v_smfmac_f32_16x16x64_bf16 v[36:39], v[40:43], a[24:31], v2
    s_waitcnt vmcnt(2)
    ds_write_b128 v3, v[44:47] offset:1024
    v_smfmac_f32_16x16x64_bf16 v[24:27], v[44:47], a[32:39], v2
    v_max3_u32 v22, v22, v44, v45
    v_smfmac_f32_16x16x64_bf16 v[28:31], v[44:47], a[40:47], v2
    v_max3_u32 v22, v22, v46, v47
    v_smfmac_f32_16x16x64_bf16 v[32:35], v[44:47], a[48:55], v2
    v_smfmac_f32_16x16x64_bf16 v[36:39], v[44:47], a[56:63], v2
    s_waitcnt vmcnt(1)
    ds_write_b128 v3, v[48:51] offset:2048
    s_waitcnt vmcnt(0)
    ds_write_b128 v3, v[52:55] offset:3072
    v_max3_u32 v22, v22, v48, v49
    v_max3_u32 v22, v22, v50, v51
    v_max3_u32 v22, v22, v52, v53
    v_max3_u32 v22, v22, v54, v55
    v_cmp_eq_u32 vcc, -1, v22
    s_waitcnt lgkmcnt(0)
    s_nop 0
    s_cbranch_vccnz L_mg_12
    s_barrier
    ds_read_b128 v[40:43], v4 offset:0
    ds_read_b128 v[44:47], v4 offset:1024
    v_smfmac_f32_16x16x64_bf16 v[24:27], v[48:51], a[64:71], v2
    v_smfmac_f32_16x16x64_bf16 v[28:31], v[48:51], v[56:63], v2
    ds_read_b128 v[56:59], v5 offset:10240
    v_smfmac_f32_16x16x64_bf16 v[32:35], v[48:51], a[72:79], v2
    ds_read_b128 v[60:63], v5 offset:11264
    v_smfmac_f32_16x16x64_bf16 v[36:39], v[48:51], v[64:71], v2
    ds_read_b128 v[48:51], v4 offset:2048
    ds_read_b128 v[64:67], v5 offset:12288
    v_smfmac_f32_16x16x64_bf16 v[24:27], v[52:55], a[80:87], v2
    ds_read_b128 v[68:71], v5 offset:13312
    v_smfmac_f32_16x16x64_bf16 v[28:31], v[52:55], v[72:79], v2
    ds_read_b128 v[72:75], v5 offset:14336
    v_smfmac_f32_16x16x64_bf16 v[32:35], v[52:55], a[88:95], v2
    ds_read_b128 v[76:79], v5 offset:15360
    v_smfmac_f32_16x16x64_bf16 v[36:39], v[52:55], a[96:103], v2
    ds_read_b128 v[52:55], v4 offset:3072
    s_waitcnt lgkmcnt(4)
    v_smfmac_f32_16x16x64_bf16 v[24:27], v[40:43], a[104:111], v2
    v_smfmac_f32_16x16x64_bf16 v[28:31], v[40:43], v[80:87], v2
    ds_read_b128 v[80:83], v5 offset:16384
    v_smfmac_f32_16x16x64_bf16 v[32:35], v[40:43], a[112:119], v2
    ds_read_b128 v[84:87], v5 offset:17408
    v_smfmac_f32_16x16x64_bf16 v[36:39], v[40:43], a[120:127], v2
    ds_read_b128 v[40:43], v21 offset:0
    v_smfmac_f32_16x16x64_bf16 v[24:27], v[44:47], a[128:135], v2
    v_smfmac_f32_16x16x64_bf16 v[28:31], v[44:47], v[88:95], v2
    ds_read_b128 v[88:91], v5 offset:18432
    v_smfmac_f32_16x16x64_bf16 v[32:35], v[44:47], a[136:143], v2
    ds_read_b128 v[92:95], v5 offset:19456
    v_smfmac_f32_16x16x64_bf16 v[36:39], v[44:47], a[144:151], v2
    ds_read_b128 v[44:47], v21 offset:1024
    v_smfmac_f32_16x16x64_bf16 v[24:27], v[48:51], a[152:159], v2
    v_smfmac_f32_16x16x64_bf16 v[28:31], v[48:51], v[56:63], v2
    ds_read_b128 v[48:51], v21 offset:2048
    ds_read_b128 v[56:59], v5 offset:20480
    s_waitcnt lgkmcnt(4)
    v_smfmac_f32_16x16x64_bf16 v[24:27], v[52:55], a[176:183], v2
    ds_read_b128 v[60:63], v5 offset:21504
    v_smfmac_f32_16x16x64_bf16 v[28:31], v[52:55], a[184:191], v2
    ds_read_b128 v[52:55], v21 offset:3072
    v_smfmac_f32_16x16x64_bf16 v[24:27], v[40:43], a[208:215], v2
    v_smfmac_f32_16x16x64_bf16 v[28:31], v[40:43], v[64:71], v2
    ds_read_b128 v[40:43], v23 offset:0
    ds_read_b128 v[64:67], v5 offset:22528
    s_waitcnt lgkmcnt(4)
    v_smfmac_f32_16x16x64_bf16 v[24:27], v[44:47], a[232:239], v2
    ds_read_b128 v[68:71], v5 offset:23552
    v_smfmac_f32_16x16x64_bf16 v[28:31], v[44:47], a[240:247], v2
    ds_read_b128 v[44:47], v23 offset:1024
    v_smfmac_f32_16x16x64_bf16 v[24:27], v[48:51], v[104:111], v2
    v_smfmac_f32_16x16x64_bf16 v[28:31], v[48:51], v[72:79], v2
    ds_read_b128 v[48:51], v23 offset:2048
    s_waitcnt lgkmcnt(3)
    v_smfmac_f32_16x16x64_bf16 v[24:27], v[52:55], v[128:135], v2
    v_smfmac_f32_16x16x64_bf16 v[28:31], v[52:55], v[136:143], v2
    ds_read_b128 v[52:55], v23 offset:3072
    v_smfmac_f32_16x16x64_bf16 v[24:27], v[40:43], v[160:167], v2
    v_smfmac_f32_16x16x64_bf16 v[28:31], v[40:43], v[80:87], v2
    s_waitcnt lgkmcnt(1)
    v_smfmac_f32_16x16x64_bf16 v[24:27], v[44:47], v[184:191], v2
    v_smfmac_f32_16x16x64_bf16 v[28:31], v[44:47], v[192:199], v2
    v_smfmac_f32_16x16x64_bf16 v[24:27], v[48:51], v[208:215], v2
    v_smfmac_f32_16x16x64_bf16 v[28:31], v[48:51], v[88:95], v2
    s_waitcnt lgkmcnt(0)
    v_smfmac_f32_16x16x64_bf16 v[24:27], v[52:55], v[232:239], v2
    v_smfmac_f32_16x16x64_bf16 v[28:31], v[52:55], v[240:247], v2
    v_smfmac_f32_16x16x64_bf16 v[32:35], v[52:55], v[248:255], v2
    ds_read_b128 v[72:75], v8 offset:16512
    v_smfmac_f32_16x16x64_bf16 v[36:39], v[52:55], v[56:63], v2
    ds_read_b128 v[52:55], v21 offset:3072
    v_smfmac_f32_16x16x64_bf16 v[32:35], v[48:51], v[216:223], v2
    ds_read_b128 v[76:79], v8 offset:20864
    s_nop 1
    v_permlane32_swap_b32 v24, v28
    v_smfmac_f32_16x16x64_bf16 v[36:39], v[48:51], v[224:231], v2
    ds_read_b128 v[48:51], v21 offset:2048
    v_permlane32_swap_b32 v25, v29
    v_smfmac_f32_16x16x64_bf16 v[32:35], v[44:47], v[200:207], v2
    v_permlane32_swap_b32 v26, v30
    v_permlane32_swap_b32 v27, v31
    v_smfmac_f32_16x16x64_bf16 v[36:39], v[44:47], v[64:71], v2
    ds_read_b128 v[44:47], v21 offset:1024
    v_pk_add_f32 v[24:25], v[24:25], v[28:29]
    v_smfmac_f32_16x16x64_bf16 v[32:35], v[40:43], v[168:175], v2
    v_pk_add_f32 v[26:27], v[26:27], v[30:31]
    v_cvt_pk_bf16_f32 v24, v24, v25
    v_smfmac_f32_16x16x64_bf16 v[36:39], v[40:43], v[176:183], v2
    ds_read_b128 v[40:43], v21 offset:0
    v_cvt_pk_bf16_f32 v25, v26, v27
    s_waitcnt lgkmcnt(2)
    v_smfmac_f32_16x16x64_bf16 v[32:35], v[52:55], v[144:151], v2
    ds_write_b64 v6, v[24:25]
    ds_read_b128 v[56:59], v8 offset:16384
    v_smfmac_f32_16x16x64_bf16 v[36:39], v[52:55], v[152:159], v2
    ds_read_b128 v[52:55], v4 offset:3072
    ds_read_b128 v[60:63], v8 offset:20736
    v_smfmac_f32_16x16x64_bf16 v[32:35], v[48:51], v[112:119], v2
    ds_read_b128 v[64:67], v8 offset:16448
    v_smfmac_f32_16x16x64_bf16 v[36:39], v[48:51], v[120:127], v2
    ds_read_b128 v[48:51], v4 offset:2048
    s_waitcnt lgkmcnt(6)
    v_smfmac_f32_16x16x64_bf16 v[32:35], v[44:47], a[248:255], v2
    ds_read_b128 v[68:71], v8 offset:20800
    s_waitcnt lgkmcnt(5)
    s_barrier
    v_smfmac_f32_16x16x64_bf16 v[36:39], v[44:47], v[96:103], v2
    ds_read_b64_tr_b16 v[80:81], v7 offset:0
    ds_read_b64_tr_b16 v[82:83], v7 offset:64
    v_smfmac_f32_16x16x64_bf16 v[32:35], v[40:43], a[216:223], v2
    ds_read_b64_tr_b16 v[84:85], v7 offset:512
    ds_read_b64_tr_b16 v[86:87], v7 offset:576
    v_smfmac_f32_16x16x64_bf16 v[36:39], v[40:43], a[224:231], v2
    ds_read_b64_tr_b16 v[88:89], v7 offset:1024
    ds_read_b64_tr_b16 v[90:91], v7 offset:1088
    s_waitcnt lgkmcnt(7)
    v_smfmac_f32_16x16x64_bf16 v[32:35], v[52:55], a[192:199], v2
    ds_read_b64_tr_b16 v[92:93], v7 offset:1536
    v_smfmac_f32_16x16x64_bf16 v[36:39], v[52:55], a[200:207], v2
    ds_read_b64_tr_b16 v[94:95], v7 offset:1600
    v_smfmac_f32_16x16x64_bf16 v[32:35], v[48:51], a[160:167], v2
    v_smfmac_f32_16x16x64_bf16 v[36:39], v[48:51], a[168:175], v2
    s_waitcnt lgkmcnt(2)
    v_mfma_f32_16x16x32_bf16 v[24:27], v[56:59], v[80:83], 0
    ds_read_b128 v[56:59], v8 offset:16576
    v_mfma_f32_16x16x32_bf16 v[28:31], v[60:63], v[80:83], 0
    ds_read_b128 v[60:63], v8 offset:20928
    v_mfma_f32_16x16x32_bf16 v[24:27], v[64:67], v[84:87], v[24:27]
    s_nop 1
    v_cvt_pk_bf16_f32 v32, v32, v33
    v_cvt_pk_bf16_f32 v33, v34, v35
    v_cvt_pk_bf16_f32 v34, v36, v37
    v_cvt_pk_bf16_f32 v35, v38, v39
    ds_write2_b64 v18, v[32:33], v[34:35] offset1:32
    v_mfma_f32_16x16x32_bf16 v[28:31], v[68:71], v[84:87], v[28:31]
    v_mfma_f32_16x16x32_bf16 v[24:27], v[72:75], v[88:91], v[24:27]
    ds_read_b64_tr_b16 v[64:65], v9 offset:25088
    v_mfma_f32_16x16x32_bf16 v[28:31], v[76:79], v[88:91], v[28:31]
    ds_read_b64_tr_b16 v[66:67], v9 offset:29312
    s_waitcnt lgkmcnt(3)
    v_mfma_f32_16x16x32_bf16 v[24:27], v[56:59], v[92:95], v[24:27]
    ds_read_b64_tr_b16 v[68:69], v9 offset:25120
    v_mfma_f32_16x16x32_bf16 v[28:31], v[60:63], v[92:95], v[28:31]
    ds_read_b64_tr_b16 v[70:71], v9 offset:29344
    s_waitcnt lgkmcnt(4)
    s_barrier
    ds_read_b64_tr_b16 v[40:41], v16 offset:55296
    ds_read_b64_tr_b16 v[42:43], v16 offset:55808
    ds_read_b64_tr_b16 v[44:45], v16 offset:56320
    ds_read_b64_tr_b16 v[46:47], v16 offset:56832
    ds_read_b64_tr_b16 v[48:49], v16 offset:57344
    ds_read_b64_tr_b16 v[50:51], v16 offset:57856
    ds_read_b64_tr_b16 v[52:53], v16 offset:58368
    ds_read_b64_tr_b16 v[54:55], v16 offset:58880
    s_cmp_eq_u32 s60, 63
    s_cbranch_scc1 L_q_last_13
    v_max3_f32 v11, v24, v25, v26
    s_waitcnt lgkmcnt(6)
    v_mfma_f32_16x16x32_bf16 v[36:39], v[40:43], v[80:83], 0
    v_max3_f32 v13, v27, v28, v29
    v_max3_f32 v11, v11, v30, v31
    s_waitcnt lgkmcnt(4)
    v_mfma_f32_16x16x32_bf16 v[36:39], v[44:47], v[84:87], v[36:39]
    v_max_f32 v11, v11, v13
    v_mul_f32 v10, s52, v11
    s_waitcnt lgkmcnt(2)
    v_mfma_f32_16x16x32_bf16 v[36:39], v[48:51], v[88:91], v[36:39]
    v_pk_fma_f32 v[24:25], v[24:25], s[52:53], v[10:11] op_sel_hi:[1,0,0] neg_lo:[0,0,1] neg_hi:[0,0,1]
    v_pk_fma_f32 v[26:27], v[26:27], s[52:53], v[10:11] op_sel_hi:[1,0,0] neg_lo:[0,0,1] neg_hi:[0,0,1]
    s_waitcnt lgkmcnt(0)
    v_mfma_f32_16x16x32_bf16 v[36:39], v[52:55], v[92:95], v[36:39]
    v_pk_fma_f32 v[28:29], v[28:29], s[52:53], v[10:11] op_sel_hi:[1,0,0] neg_lo:[0,0,1] neg_hi:[0,0,1]
    v_pk_fma_f32 v[30:31], v[30:31], s[52:53], v[10:11] op_sel_hi:[1,0,0] neg_lo:[0,0,1] neg_hi:[0,0,1]
    buffer_load_dwordx2 v[0:1], v16, s[12:15], s51 offen sc1
    s_add_u32 s46, s60, 1
    v_mov_b32 v74, s46
    v_mov_b32 v57, 0
    v_mov_b32 v58, 0
    v_exp_f32 v24, v24
    v_exp_f32 v25, v25
    v_permlane32_swap_b32 v36, v38
    v_permlane32_swap_b32 v37, v39
    v_pk_add_f32 v[36:37], v[36:37], v[38:39]
    v_max3_f32 v12, v36, v37, v11
    v_max3_f32 v13, v36, v37, v11
    v_exp_f32 v26, v26
    v_exp_f32 v27, v27
    v_permlane32_swap_b32 v12, v13
    v_max_f32 v22, v12, v13
    v_max_f32 v13, v12, v13
    v_exp_f32 v28, v28
    v_exp_f32 v29, v29
    v_permlane16_swap_b32 v22, v13
    v_max_f32 v12, v22, v13
    v_mul_f32 v12, s52, v12
    v_sub_f32 v10, v10, v12
    v_pk_fma_f32 v[36:37], v[36:37], s[52:53], v[12:13] op_sel_hi:[1,0,0] neg_lo:[0,0,1] neg_hi:[0,0,1]
    v_exp_f32 v10, v10
    v_exp_f32 v30, v30
    v_exp_f32 v31, v31
    v_exp_f32 v36, v36
    v_exp_f32 v37, v37
    v_pk_mul_f32 v[24:25], v[24:25], v[10:11] op_sel_hi:[1,0]
    v_pk_mul_f32 v[26:27], v[26:27], v[10:11] op_sel_hi:[1,0]
    v_pk_mul_f32 v[28:29], v[28:29], v[10:11] op_sel_hi:[1,0]
    v_pk_mul_f32 v[30:31], v[30:31], v[10:11] op_sel_hi:[1,0]
    v_cvt_pk_bf16_f32 v60, v24, v25
    v_cvt_pk_bf16_f32 v61, v26, v27
    v_cvt_pk_bf16_f32 v62, v28, v29
    v_cvt_pk_bf16_f32 v63, v30, v31
    v_cvt_pk_bf16_f32 v56, v36, v37
    v_cvt_pk_bf16_f32 v59, v36, v37
    s_mov_b64 exec, 15
    s_cmp_eq_u32 s67, 1
    s_cbranch_scc0 L_ls_14_s
    buffer_store_dword v74, v20, s[12:15], 0 offen
L_ls_14_d:
    s_mov_b64 exec, -1
    v_mfma_f32_16x16x32_bf16 v[72:75], v[64:67], v[60:63], 0
    v_pk_add_f32 v[24:25], v[24:25], v[26:27]
    v_pk_add_f32 v[28:29], v[28:29], v[30:31]
    v_mfma_f32_16x16x32_bf16 v[76:79], v[68:71], v[60:63], 0
    v_pk_add_f32 v[24:25], v[24:25], v[36:37]
    s_waitcnt vmcnt(1)
L_q_vm_15:
    v_max_u32 v22, v0, v1
    v_cmp_eq_u32 vcc, -1, v22
    v_pk_add_f32 v[10:11], v[24:25], v[28:29]
    v_add_f32 v12, v10, v11
    s_cbranch_vccnz L_q_vm_15_r
    v_add_f32 v13, v10, v11
    v_mfma_f32_16x16x16_bf16 v[72:75], v[0:1], v[56:57], v[72:75]
    v_mfma_f32_16x16x16_bf16 v[76:79], v[0:1], v[58:59], v[76:79]
    v_permlane32_swap_b32 v12, v13
    v_add_f32 v22, v12, v13
    v_add_f32 v13, v12, v13
    s_nop 1
    v_permlane16_swap_b32 v22, v13
    v_add_f32 v12, v22, v13
    v_rcp_f32 v12, v12
    s_mov_b64 exec, s[56:57]
    v_pk_mul_f32 v[72:73], v[72:73], v[12:13] op_sel_hi:[1,0]
    v_pk_mul_f32 v[74:75], v[74:75], v[12:13] op_sel_hi:[1,0]
    v_pk_mul_f32 v[76:77], v[76:77], v[12:13] op_sel_hi:[1,0]
    v_pk_mul_f32 v[78:79], v[78:79], v[12:13] op_sel_hi:[1,0]
    v_cvt_pk_bf16_f32 v72, v72, v73
    v_cvt_pk_bf16_f32 v73, v74, v75
    v_cvt_pk_bf16_f32 v74, v76, v77
    v_cvt_pk_bf16_f32 v75, v78, v79
    v_min_u32 v72, -2, v72
    v_min_u32 v73, -2, v73
    v_min_u32 v74, -2, v74
    v_min_u32 v75, -2, v75
    s_cmp_eq_u32 s67, 1
    s_cbranch_scc0 L_ls_16_s
    buffer_store_dwordx4 v[72:75], v17, s[12:15], s62 offen
L_ls_16_d:
    v_mov_b32 v60, -1
    v_mov_b32 v61, -1
    v_mov_b32 v62, -1
    v_mov_b32 v63, -1
    s_add_u32 s45, s60, 3
    s_and_b32 s45, s45, 3
    s_lshl_b32 s45, s45, 15
    s_add_u32 s45, s45, s59
    s_cmp_eq_u32 s67, 1
    s_cbranch_scc0 L_ls_17_s
    buffer_store_dwordx4 v[60:63], v17, s[12:15], s45 offen
L_ls_17_d:
    s_mov_b64 exec, -1
L_q_last_13:
    s_waitcnt lgkmcnt(0)
    v_lshlrev_b32 v22, 1, v16
    s_cmp_lg_u32 s44, 0
    s_cbranch_scc1 L_q_km_18_0
    buffer_store_dwordx4 v[40:43], v22, s[12:15], s66 offen offset:0 sc1
L_q_km_18_0:
    s_cmp_lg_u32 s44, 1
    s_cbranch_scc1 L_q_km_18_1
    buffer_store_dwordx4 v[44:47], v22, s[12:15], s66 offen offset:1024 sc1
L_q_km_18_1:
    s_cmp_lg_u32 s44, 2
    s_cbranch_scc1 L_q_km_18_2
    buffer_store_dwordx4 v[48:51], v22, s[12:15], s66 offen offset:2048 sc1
L_q_km_18_2:
    s_cmp_lg_u32 s44, 3
    s_cbranch_scc1 L_q_km_18_3
    buffer_store_dwordx4 v[52:55], v22, s[12:15], s66 offen offset:3072 sc1
L_q_km_18_3:
    s_cmp_eq_u32 s60, 63
    s_cbranch_scc1 L_q_fin_19
    v_mov_b32 v22, s60
    v_mov_b32 v0, 0
    s_mov_b64 exec, 1
    buffer_store_dword v22, v0, s[12:15], s3 offen sc1
    s_mov_b64 exec, -1
    s_cmp_eq_u32 s60, 62
    s_cbranch_scc1 L_q_fin_19_n
    s_add_u32 s47, s60, 1
    s_cmp_lt_u32 s47, s50
    s_cbranch_scc1 L_kv_rdy_20
    s_lshl_b32 s45, s43, 7
    s_add_u32 s45, s45, 0x10008
    v_mov_b32 v0, 0
    s_mov_b32 s70, 0
L_kv_rdy_20_p:
    buffer_load_dwordx4 v[10:13], v0, s[12:15], s45 offen sc1
    s_add_u32 s70, s70, 1
    s_cmp_ge_u32 s70, 0x200000
    s_cbranch_scc1 L_c_done_1
    s_waitcnt vmcnt(0)
    v_min_u32 v10, v10, v12
    v_min_u32 v11, v11, v13
    v_lshlrev_b32 v10, 1, v10
    v_lshlrev_b32 v11, 1, v11
    v_add_u32 v11, 1, v11
    v_min_u32 v10, v10, v11
    s_nop 0
    v_readfirstlane_b32 s50, v10
    s_nop 3
    s_cmp_lt_u32 s47, s50
    s_cbranch_scc1 L_kv_rdy_20
    s_sleep 2
    s_branch L_kv_rdy_20_p
L_kv_rdy_20:
    s_mov_b32 m0, s64
    s_add_u32 s45, s63, 4096
    buffer_load_dwordx4 v14, s[12:15], s63 offen sc1 lds
    s_add_u32 m0, s64, 4352
    s_add_u32 s46, s63, 0x1000000
    buffer_load_dwordx4 v14, s[12:15], s45 offen sc1 lds
    s_mov_b32 m0, s65
    s_add_u32 s45, s45, 0x1000000
    buffer_load_dwordx4 v15, s[12:15], s46 offen sc1 lds
    s_add_u32 m0, s65, 4224
    s_add_u32 s63, s63, 8192
    buffer_load_dwordx4 v15, s[12:15], s45 offen sc1 lds
L_q_fin_19_n:
    s_mov_b64 exec, -1
    v_add_u32 v8, s69, v8
    v_add_u32 v9, s69, v9
    s_sub_u32 s64, s64, s69
    s_sub_u32 s65, s65, s69
    s_sub_u32 s69, 0, s69
    s_add_u32 s66, s66, 131072
    s_xor_b32 s51, s51, 65536
    s_add_u32 s60, s60, 1
    s_and_b32 s45, s60, 3
    s_lshl_b32 s46, s45, 14
    s_add_u32 s61, s58, s46
    s_lshl_b32 s46, s45, 15
    s_add_u32 s62, s59, s46
    s_branch L_q_loop_8
L_q_fin_19:
    s_waitcnt vmcnt(0)
    v_mov_b32 v22, 64
    v_mov_b32 v0, 0
    s_mov_b64 exec, 1
    buffer_store_dword v22, v0, s[12:15], s3 offen sc1
    s_mov_b64 exec, -1
    s_endpgm
L_q_vm_15_r:
    buffer_load_dwordx2 v[0:1], v16, s[12:15], s51 offen sc1
    s_add_u32 s70, s70, 1
    s_cmp_lt_u32 s70, 0x100000
    s_waitcnt vmcnt(0)
    s_cbranch_scc1 L_q_vm_15
    s_endpgm
L_ls_14_s:
    buffer_store_dword v74, v20, s[12:15], 0 offen sc1
    s_branch L_ls_14_d
L_ls_16_s:
    buffer_store_dwordx4 v[72:75], v17, s[12:15], s62 offen sc1
    s_branch L_ls_16_d
L_ls_17_s:
    buffer_store_dwordx4 v[60:63], v17, s[12:15], s45 offen sc1
    s_branch L_ls_17_d
L_c_vo_2:
    s_lshl_b32 s45, s43, 11
    s_lshl_b32 s46, s44, 9
    s_add_u32 s45, s45, s46
    v_lshlrev_b32 v10, 3, v1
    v_add_u32 v10, s45, v10
    v_lshlrev_b32 v11, 3, v0
    v_bfe_u32 v69, v1, 4, 1
    v_lshlrev_b32 v69, 2, v69
    v_lshrrev_b32 v63, 5, v1
    v_lshlrev_b32 v63, 1, v63
    v_and_b32 v64, 1, v1
    v_add3_u32 v69, v69, v63, v64
    v_bfe_u32 v63, v1, 1, 1
    v_lshlrev_b32 v63, 3, v63
    v_add_u32 v63, v63, v69
    v_lshlrev_b32 v63, 4, v63
    v_bfe_u32 v64, v1, 2, 2
    v_lshlrev_b32 v64, 2, v64
    s_lshl_b32 s45, s42, 10
    s_lshl_b32 s46, s44, 8
    s_add_u32 s45, s45, s46
    v_add3_u32 v12, v63, v64, s45
    v_and_b32 v64, 1, v1
    v_cmp_eq_u32 vcc, 0, v64
    v_mov_b32 v9, 0x07060302
    v_mov_b32 v63, 0x01000504
    v_cndmask_b32 v9, v9, v63, vcc
    s_lshl_b32 s63, s40, 19
    s_lshl_b32 s45, s42, 15
    s_add_u32 s63, s63, s45
    s_add_u32 s63, s63, 0x7100000
    s_xor_b32 s64, s63, 524288
    s_cmp_lg_u32 s44, 0
    s_cbranch_scc1 L_v_probe_21
    s_mov_b64 exec, 1
    v_mov_b32 v46, 0
    s_mov_b32 s49, -1
    s_mov_b32 s50, -1
    s_add_u32 s51, s63, 8192
    v_mov_b32 v45, 0
    s_memtime s[72:73]
    s_waitcnt lgkmcnt(0)
    buffer_atomic_or v45, v46, s[12:15], s63 offen sc0 sc1
    s_waitcnt vmcnt(0)
    s_memtime s[74:75]
    s_waitcnt lgkmcnt(0)
    s_sub_u32 s45, s74, s72
    s_min_u32 s49, s49, s45
    v_mov_b32 v45, 0
    s_memtime s[72:73]
    s_waitcnt lgkmcnt(0)
    buffer_atomic_or v45, v46, s[12:15], s51 offen sc0 sc1
    s_waitcnt vmcnt(0)
    s_memtime s[74:75]
    s_waitcnt lgkmcnt(0)
    s_sub_u32 s45, s74, s72
    s_min_u32 s50, s50, s45
    v_mov_b32 v45, 0
    s_memtime s[72:73]
    s_waitcnt lgkmcnt(0)
    buffer_atomic_or v45, v46, s[12:15], s63 offen sc0 sc1
    s_waitcnt vmcnt(0)
    s_memtime s[74:75]
    s_waitcnt lgkmcnt(0)
    s_sub_u32 s45, s74, s72
    s_min_u32 s49, s49, s45
    v_mov_b32 v45, 0
    s_memtime s[72:73]
    s_waitcnt lgkmcnt(0)
    buffer_atomic_or v45, v46, s[12:15], s51 offen sc0 sc1
    s_waitcnt vmcnt(0)
    s_memtime s[74:75]
    s_waitcnt lgkmcnt(0)
    s_sub_u32 s45, s74, s72
    s_min_u32 s50, s50, s45
    v_mov_b32 v45, 0
    s_memtime s[72:73]
    s_waitcnt lgkmcnt(0)
    buffer_atomic_or v45, v46, s[12:15], s63 offen sc0 sc1
    s_waitcnt vmcnt(0)
    s_memtime s[74:75]
    s_waitcnt lgkmcnt(0)
    s_sub_u32 s45, s74, s72
    s_min_u32 s49, s49, s45
    v_mov_b32 v45, 0
    s_memtime s[72:73]
    s_waitcnt lgkmcnt(0)
    buffer_atomic_or v45, v46, s[12:15], s51 offen sc0 sc1
    s_waitcnt vmcnt(0)
    s_memtime s[74:75]
    s_waitcnt lgkmcnt(0)
    s_sub_u32 s45, s74, s72
    s_min_u32 s50, s50, s45
    v_mov_b32 v45, 0
    s_memtime s[72:73]
    s_waitcnt lgkmcnt(0)
    buffer_atomic_or v45, v46, s[12:15], s63 offen sc0 sc1
    s_waitcnt vmcnt(0)
    s_memtime s[74:75]
    s_waitcnt lgkmcnt(0)
    s_sub_u32 s45, s74, s72
    s_min_u32 s49, s49, s45
    v_mov_b32 v45, 0
    s_memtime s[72:73]
    s_waitcnt lgkmcnt(0)
    buffer_atomic_or v45, v46, s[12:15], s51 offen sc0 sc1
    s_waitcnt vmcnt(0)
    s_memtime s[74:75]
    s_waitcnt lgkmcnt(0)
    s_sub_u32 s45, s74, s72
    s_min_u32 s50, s50, s45
    s_cmp_lt_u32 s50, s49
    s_cselect_b32 s68, 1, 0
    s_mov_b64 exec, -1
L_v_probe_21:
    s_mov_b32 s45, 0x7020000
    buffer_store_dwordx2 v[40:41], v10, s[12:15], s45 offen sc1
    s_mov_b32 s45, 0x7030000
    buffer_store_dwordx2 v[40:41], v10, s[12:15], s45 offen sc1
    s_add_u32 s45, s63, 0
    buffer_store_dwordx2 v[40:41], v11, s[12:15], s45 offen sc1
    s_add_u32 s45, s63, 4096
    buffer_store_dwordx2 v[40:41], v11, s[12:15], s45 offen sc1
    s_add_u32 s45, s63, 8192
    buffer_store_dwordx2 v[40:41], v11, s[12:15], s45 offen sc1
    s_add_u32 s45, s63, 12288
    buffer_store_dwordx2 v[40:41], v11, s[12:15], s45 offen sc1
    s_add_u32 s45, s63, 16384
    buffer_store_dwordx2 v[40:41], v11, s[12:15], s45 offen sc1
    s_add_u32 s45, s63, 20480
    buffer_store_dwordx2 v[40:41], v11, s[12:15], s45 offen sc1
    s_add_u32 s45, s63, 24576
    buffer_store_dwordx2 v[40:41], v11, s[12:15], s45 offen sc1
    s_add_u32 s45, s63, 28672
    buffer_store_dwordx2 v[40:41], v11, s[12:15], s45 offen sc1
    s_lshl_b32 s61, s40, 16
    s_add_u32 s61, s61, 0x7000000
    s_add_u32 s45, s61, 16384
    buffer_store_dword v40, v12, s[12:15], s45 offen sc1
    s_add_u32 s45, s61, 32768
    buffer_store_dword v40, v12, s[12:15], s45 offen sc1
    s_add_u32 s45, s61, 49152
    buffer_store_dword v40, v12, s[12:15], s45 offen sc1
    v_lshlrev_b32 v63, 11, v69
    v_and_b32 v64, 14, v1
    v_lshlrev_b32 v64, 1, v64
    v_add_u32 v63, v63, v64
    s_lshl_b32 s45, s42, 7
    s_lshl_b32 s46, s44, 5
    s_add_u32 s45, s45, s46
    buffer_load_dword v45, v63, s[52:55], s45 offen
    s_waitcnt vmcnt(0)
    v_min_u32 v45, -2, v45
    buffer_store_dword v45, v12, s[12:15], s61 offen sc1
    s_waitcnt vmcnt(0)
    s_barrier
    s_cmp_lg_u32 s44, 0
    s_cbranch_scc1 L_hs_22
    s_getreg_b32 s45, hwreg(HW_REG_XCC_ID)
    s_and_b32 s45, s45, 15
    s_lshl_b32 s45, 1, s45
    v_mov_b32 v40, s45
    s_lshl_b32 s46, s40, 2
    s_add_u32 s46, s46, 4
    v_mov_b32 v41, 0
    v_mov_b32 v42, 1
    v_mov_b32 v43, s68
    s_mov_b64 exec, 1
    buffer_atomic_or v40, v41, s[16:19], s46 offen sc1
    buffer_atomic_add v43, v41, s[16:19], 0 offen offset:12 sc1
    s_waitcnt vmcnt(0)
    buffer_atomic_add v42, v41, s[16:19], 0 offen sc1
    s_waitcnt vmcnt(0)
    s_mov_b64 exec, -1
L_hs_22:
    v_lshrrev_b32 v63, 3, v1
    v_lshlrev_b32 v63, 11, v63
    v_bfe_u32 v64, v1, 1, 2
    v_and_b32 v65, 1, v1
    v_lshlrev_b32 v65, 4, v65
    v_add_u32 v63, v63, v65
    v_xor_b32 v66, 0, v64
    v_lshlrev_b32 v66, 5, v66
    v_add_u32 v70, v63, v66
    v_xor_b32 v66, 1, v64
    v_lshlrev_b32 v66, 5, v66
    v_add_u32 v71, v63, v66
    v_xor_b32 v66, 2, v64
    v_lshlrev_b32 v66, 5, v66
    v_add_u32 v72, v63, v66
    v_xor_b32 v66, 3, v64
    v_lshlrev_b32 v66, 5, v66
    v_add_u32 v73, v63, v66
    v_bfe_u32 v63, v1, 3, 1
    v_lshlrev_b32 v63, 1, v63
    v_bfe_u32 v64, v1, 4, 1
    v_add_u32 v63, v63, v64
    v_lshlrev_b32 v64, 3, v63
    v_lshrrev_b32 v65, 5, v1
    v_lshlrev_b32 v65, 2, v65
    v_add_u32 v64, v64, v65
    v_bfe_u32 v65, v1, 2, 1
    v_add_u32 v64, v64, v65
    v_lshlrev_b32 v64, 7, v64
    v_and_b32 v65, 3, v1
    v_lshlrev_b32 v65, 3, v65
    v_add_u32 v64, v64, v65
    s_lshl_b32 s45, s44, 12
    v_add_u32 v64, s45, v64
    s_add_u32 s45, s44, 1
    s_and_b32 s45, s45, 3
    v_xor_b32 v65, s45, v63
    v_lshlrev_b32 v65, 5, v65
    v_add_u32 v74, v64, v65
    s_add_u32 s45, s44, 2
    s_and_b32 s45, s45, 3
    v_xor_b32 v65, s45, v63
    v_lshlrev_b32 v65, 5, v65
    v_add_u32 v75, v64, v65
    s_add_u32 s45, s44, 3
    s_and_b32 s45, s45, 3
    v_xor_b32 v65, s45, v63
    v_lshlrev_b32 v65, 5, v65
    v_add_u32 v76, v64, v65
    s_add_u32 s45, s44, 4
    s_and_b32 s45, s45, 3
    v_xor_b32 v65, s45, v63
    v_lshlrev_b32 v65, 5, v65
    v_add_u32 v77, v64, v65
    s_lshl_b32 s49, s40, 22
    s_lshl_b32 s45, s44, 20
    s_add_u32 s49, s49, s45
    s_lshl_b32 s45, s42, 7
    s_add_u32 s49, s49, s45
    s_lshl_b32 s50, s44, 12
    s_mul_i32 s69, s42, 1
    v_add_u32 v83, 0x0, v82
    v_and_b32 v83, 0x7fffff, v83
    s_add_u32 s46, s47, 0x0
    s_add_u32 m0, s48, 0
    s_nop 0
    buffer_load_dwordx4 v83, s[32:35], s46 offen lds
    s_add_u32 s46, s47, 0x20000
    s_add_u32 m0, s48, 4096
    s_nop 0
    buffer_load_dwordx4 v83, s[32:35], s46 offen lds
    s_add_u32 s46, s47, 0x40000
    s_add_u32 m0, s48, 8192
    s_nop 0
    buffer_load_dwordx4 v83, s[32:35], s46 offen lds
    s_add_u32 s46, s47, 0x60000
    s_add_u32 m0, s48, 12288
    s_nop 0
    buffer_load_dwordx4 v83, s[32:35], s46 offen lds
    v_add_u32 v83, 0x80000, v82
    v_and_b32 v83, 0x7fffff, v83
    s_add_u32 s46, s47, 0x0
    s_add_u32 m0, s48, 16384
    s_nop 0
    buffer_load_dwordx4 v83, s[32:35], s46 offen lds
    s_add_u32 s46, s47, 0x20000
    s_add_u32 m0, s48, 20480
    s_nop 0
    buffer_load_dwordx4 v83, s[32:35], s46 offen lds
    s_add_u32 s46, s47, 0x40000
    s_add_u32 m0, s48, 24576
    s_nop 0
    buffer_load_dwordx4 v83, s[32:35], s46 offen lds
    s_add_u32 s46, s47, 0x60000
    s_add_u32 m0, s48, 28672
    s_nop 0
    buffer_load_dwordx4 v83, s[32:35], s46 offen lds
    v_add_u32 v83, 0x100000, v82
    v_and_b32 v83, 0x7fffff, v83
    s_add_u32 s46, s47, 0x0
    s_add_u32 m0, s48, 32768
    s_nop 0
    buffer_load_dwordx4 v83, s[32:35], s46 offen lds
    s_add_u32 s46, s47, 0x20000
    s_add_u32 m0, s48, 36864
    s_nop 0
    buffer_load_dwordx4 v83, s[32:35], s46 offen lds
    s_add_u32 s46, s47, 0x40000
    s_add_u32 m0, s48, 40960
    s_nop 0
    buffer_load_dwordx4 v83, s[32:35], s46 offen lds
    s_add_u32 s46, s47, 0x60000
    s_add_u32 m0, s48, 45056
    s_nop 0
    buffer_load_dwordx4 v83, s[32:35], s46 offen lds
    s_waitcnt vmcnt(8)
    s_barrier
    v_add_u32 v83, 0x180000, v82
    v_and_b32 v83, 0x7fffff, v83
    s_add_u32 s46, s47, 0x0
    s_add_u32 m0, s48, 49152
    s_nop 0
    buffer_load_dwordx4 v83, s[32:35], s46 offen lds
    s_add_u32 s46, s47, 0x20000
    s_add_u32 m0, s48, 53248
    s_nop 0
    buffer_load_dwordx4 v83, s[32:35], s46 offen lds
    s_add_u32 s46, s47, 0x40000
    s_add_u32 m0, s48, 57344
    s_nop 0
    buffer_load_dwordx4 v83, s[32:35], s46 offen lds
    s_add_u32 s46, s47, 0x60000
    s_add_u32 m0, s48, 61440
    s_nop 0
    buffer_load_dwordx4 v83, s[32:35], s46 offen lds
    ds_read_b64_tr_b16 a[0:1], v80 offset:0
    ds_read_b64_tr_b16 a[2:3], v80 offset:1024
    ds_read_b64_tr_b16 a[4:5], v80 offset:8192
    ds_read_b64_tr_b16 a[6:7], v80 offset:9216
    ds_read_b64_tr_b16 a[8:9], v81 offset:0
    ds_read_b64_tr_b16 a[10:11], v81 offset:1024
    ds_read_b64_tr_b16 a[12:13], v81 offset:8192
    ds_read_b64_tr_b16 a[14:15], v81 offset:9216
    s_waitcnt lgkmcnt(0)
    s_waitcnt vmcnt(8)
    s_barrier
    v_add_u32 v83, 0x200000, v82
    v_and_b32 v83, 0x7fffff, v83
    s_add_u32 s46, s47, 0x0
    s_add_u32 m0, s48, 0
    s_nop 0
    buffer_load_dwordx4 v83, s[32:35], s46 offen lds
    s_add_u32 s46, s47, 0x20000
    s_add_u32 m0, s48, 4096
    s_nop 0
    buffer_load_dwordx4 v83, s[32:35], s46 offen lds
    s_add_u32 s46, s47, 0x40000
    s_add_u32 m0, s48, 8192
    s_nop 0
    buffer_load_dwordx4 v83, s[32:35], s46 offen lds
    s_add_u32 s46, s47, 0x60000
    s_add_u32 m0, s48, 12288
    s_nop 0
    buffer_load_dwordx4 v83, s[32:35], s46 offen lds
    ds_read_b64_tr_b16 a[16:17], v80 offset:16384
    ds_read_b64_tr_b16 a[18:19], v80 offset:17408
    ds_read_b64_tr_b16 a[20:21], v80 offset:24576
    ds_read_b64_tr_b16 a[22:23], v80 offset:25600
    ds_read_b64_tr_b16 a[24:25], v81 offset:16384
    ds_read_b64_tr_b16 a[26:27], v81 offset:17408
    ds_read_b64_tr_b16 a[28:29], v81 offset:24576
    ds_read_b64_tr_b16 a[30:31], v81 offset:25600
    s_waitcnt lgkmcnt(0)
    s_waitcnt vmcnt(8)
    s_barrier
    v_add_u32 v83, 0x280000, v82
    v_and_b32 v83, 0x7fffff, v83
    s_add_u32 s46, s47, 0x0
    s_add_u32 m0, s48, 16384
    s_nop 0
    buffer_load_dwordx4 v83, s[32:35], s46 offen lds
    s_add_u32 s46, s47, 0x20000
    s_add_u32 m0, s48, 20480
    s_nop 0
    buffer_load_dwordx4 v83, s[32:35], s46 offen lds
    s_add_u32 s46, s47, 0x40000
    s_add_u32 m0, s48, 24576
    s_nop 0
    buffer_load_dwordx4 v83, s[32:35], s46 offen lds
    s_add_u32 s46, s47, 0x60000
    s_add_u32 m0, s48, 28672
    s_nop 0
    buffer_load_dwordx4 v83, s[32:35], s46 offen lds
    ds_read_b64_tr_b16 a[32:33], v80 offset:32768
    ds_read_b64_tr_b16 a[34:35], v80 offset:33792
    ds_read_b64_tr_b16 a[36:37], v80 offset:40960
    ds_read_b64_tr_b16 a[38:39], v80 offset:41984
    ds_read_b64_tr_b16 v[56:57], v81 offset:32768
    ds_read_b64_tr_b16 v[58:59], v81 offset:33792
    ds_read_b64_tr_b16 v[60:61], v81 offset:40960
    ds_read_b64_tr_b16 v[62:63], v81 offset:41984
    s_waitcnt lgkmcnt(0)
    ds_write_b128 v5, v[56:59] offset:0
    ds_write_b128 v5, v[60:63] offset:1024
    s_waitcnt lgkmcnt(0)
    s_waitcnt vmcnt(8)
    s_barrier
    v_add_u32 v83, 0x300000, v82
    v_and_b32 v83, 0x7fffff, v83
    s_add_u32 s46, s47, 0x0
    s_add_u32 m0, s48, 32768
    s_nop 0
    buffer_load_dwordx4 v83, s[32:35], s46 offen lds
    s_add_u32 s46, s47, 0x20000
    s_add_u32 m0, s48, 36864
    s_nop 0
    buffer_load_dwordx4 v83, s[32:35], s46 offen lds
    s_add_u32 s46, s47, 0x40000
    s_add_u32 m0, s48, 40960
    s_nop 0
    buffer_load_dwordx4 v83, s[32:35], s46 offen lds
    s_add_u32 s46, s47, 0x60000
    s_add_u32 m0, s48, 45056
    s_nop 0
    buffer_load_dwordx4 v83, s[32:35], s46 offen lds
    ds_read_b64_tr_b16 a[40:41], v80 offset:49152
    ds_read_b64_tr_b16 a[42:43], v80 offset:50176
    ds_read_b64_tr_b16 a[44:45], v80 offset:57344
    ds_read_b64_tr_b16 a[46:47], v80 offset:58368
    ds_read_b64_tr_b16 v[56:57], v81 offset:49152
    ds_read_b64_tr_b16 v[58:59], v81 offset:50176
    ds_read_b64_tr_b16 v[60:61], v81 offset:57344
    ds_read_b64_tr_b16 v[62:63], v81 offset:58368
    s_waitcnt lgkmcnt(0)
    ds_write_b128 v5, v[56:59] offset:2048
    ds_write_b128 v5, v[60:63] offset:3072
    s_waitcnt lgkmcnt(0)
    s_waitcnt vmcnt(8)
    s_barrier
    v_add_u32 v83, 0x380000, v82
    v_and_b32 v83, 0x7fffff, v83
    s_add_u32 s46, s47, 0x0
    s_add_u32 m0, s48, 49152
    s_nop 0
    buffer_load_dwordx4 v83, s[32:35], s46 offen lds
    s_add_u32 s46, s47, 0x20000
    s_add_u32 m0, s48, 53248
    s_nop 0
    buffer_load_dwordx4 v83, s[32:35], s46 offen lds
    s_add_u32 s46, s47, 0x40000
    s_add_u32 m0, s48, 57344
    s_nop 0
    buffer_load_dwordx4 v83, s[32:35], s46 offen lds
    s_add_u32 s46, s47, 0x60000
    s_add_u32 m0, s48, 61440
    s_nop 0
    buffer_load_dwordx4 v83, s[32:35], s46 offen lds
    ds_read_b64_tr_b16 a[48:49], v80 offset:0
    ds_read_b64_tr_b16 a[50:51], v80 offset:1024
    ds_read_b64_tr_b16 a[52:53], v80 offset:8192
    ds_read_b64_tr_b16 a[54:55], v80 offset:9216
    ds_read_b64_tr_b16 v[56:57], v81 offset:0
    ds_read_b64_tr_b16 v[58:59], v81 offset:1024
    ds_read_b64_tr_b16 v[60:61], v81 offset:8192
    ds_read_b64_tr_b16 v[62:63], v81 offset:9216
    s_waitcnt lgkmcnt(0)
    ds_write_b128 v5, v[56:59] offset:4096
    ds_write_b128 v5, v[60:63] offset:5120
    s_waitcnt lgkmcnt(0)
    s_waitcnt vmcnt(8)
    s_barrier
    v_add_u32 v83, 0x400000, v82
    v_and_b32 v83, 0x7fffff, v83
    s_add_u32 s46, s47, 0x0
    s_add_u32 m0, s48, 0
    s_nop 0
    buffer_load_dwordx4 v83, s[32:35], s46 offen lds
    s_add_u32 s46, s47, 0x20000
    s_add_u32 m0, s48, 4096
    s_nop 0
    buffer_load_dwordx4 v83, s[32:35], s46 offen lds
    s_add_u32 s46, s47, 0x40000
    s_add_u32 m0, s48, 8192
    s_nop 0
    buffer_load_dwordx4 v83, s[32:35], s46 offen lds
    s_add_u32 s46, s47, 0x60000
    s_add_u32 m0, s48, 12288
    s_nop 0
    buffer_load_dwordx4 v83, s[32:35], s46 offen lds
    ds_read_b64_tr_b16 a[56:57], v80 offset:16384
    ds_read_b64_tr_b16 a[58:59], v80 offset:17408
    ds_read_b64_tr_b16 a[60:61], v80 offset:24576
    ds_read_b64_tr_b16 a[62:63], v80 offset:25600
    ds_read_b64_tr_b16 v[56:57], v81 offset:16384
    ds_read_b64_tr_b16 v[58:59], v81 offset:17408
    ds_read_b64_tr_b16 v[60:61], v81 offset:24576
    ds_read_b64_tr_b16 v[62:63], v81 offset:25600
    s_waitcnt lgkmcnt(0)
    ds_write_b128 v5, v[56:59] offset:6144
    ds_write_b128 v5, v[60:63] offset:7168
    s_waitcnt lgkmcnt(0)
    s_waitcnt vmcnt(8)
    s_barrier
    v_add_u32 v83, 0x480000, v82
    v_and_b32 v83, 0x7fffff, v83
    s_add_u32 s46, s47, 0x0
    s_add_u32 m0, s48, 16384
    s_nop 0
    buffer_load_dwordx4 v83, s[32:35], s46 offen lds
    s_add_u32 s46, s47, 0x20000
    s_add_u32 m0, s48, 20480
    s_nop 0
    buffer_load_dwordx4 v83, s[32:35], s46 offen lds
    s_add_u32 s46, s47, 0x40000
    s_add_u32 m0, s48, 24576
    s_nop 0
    buffer_load_dwordx4 v83, s[32:35], s46 offen lds
    s_add_u32 s46, s47, 0x60000
    s_add_u32 m0, s48, 28672
    s_nop 0
    buffer_load_dwordx4 v83, s[32:35], s46 offen lds
    ds_read_b64_tr_b16 a[64:65], v80 offset:32768
    ds_read_b64_tr_b16 a[66:67], v80 offset:33792
    ds_read_b64_tr_b16 a[68:69], v80 offset:40960
    ds_read_b64_tr_b16 a[70:71], v80 offset:41984
    ds_read_b64_tr_b16 v[56:57], v81 offset:32768
    ds_read_b64_tr_b16 v[58:59], v81 offset:33792
    ds_read_b64_tr_b16 v[60:61], v81 offset:40960
    ds_read_b64_tr_b16 v[62:63], v81 offset:41984
    s_waitcnt lgkmcnt(0)
    ds_write_b128 v5, v[56:59] offset:8192
    ds_write_b128 v5, v[60:63] offset:9216
    s_waitcnt lgkmcnt(0)
    s_waitcnt vmcnt(8)
    s_barrier
    v_add_u32 v83, 0x500000, v82
    v_and_b32 v83, 0x7fffff, v83
    s_add_u32 s46, s47, 0x0
    s_add_u32 m0, s48, 32768
    s_nop 0
    buffer_load_dwordx4 v83, s[32:35], s46 offen lds
    s_add_u32 s46, s47, 0x20000
    s_add_u32 m0, s48, 36864
    s_nop 0
    buffer_load_dwordx4 v83, s[32:35], s46 offen lds
    s_add_u32 s46, s47, 0x40000
    s_add_u32 m0, s48, 40960
    s_nop 0
    buffer_load_dwordx4 v83, s[32:35], s46 offen lds
    s_add_u32 s46, s47, 0x60000
    s_add_u32 m0, s48, 45056
    s_nop 0
    buffer_load_dwordx4 v83, s[32:35], s46 offen lds
    ds_read_b64_tr_b16 a[72:73], v80 offset:49152
    ds_read_b64_tr_b16 a[74:75], v80 offset:50176
    ds_read_b64_tr_b16 a[76:77], v80 offset:57344
    ds_read_b64_tr_b16 a[78:79], v80 offset:58368
    ds_read_b64_tr_b16 v[56:57], v81 offset:49152
    ds_read_b64_tr_b16 v[58:59], v81 offset:50176
    ds_read_b64_tr_b16 v[60:61], v81 offset:57344
    ds_read_b64_tr_b16 v[62:63], v81 offset:58368
    s_waitcnt lgkmcnt(0)
    ds_write_b128 v5, v[56:59] offset:10240
    ds_write_b128 v5, v[60:63] offset:11264
    s_waitcnt lgkmcnt(0)
    s_waitcnt vmcnt(8)
    s_barrier
    v_add_u32 v83, 0x580000, v82
    v_and_b32 v83, 0x7fffff, v83
    s_add_u32 s46, s47, 0x0
    s_add_u32 m0, s48, 49152
    s_nop 0
    buffer_load_dwordx4 v83, s[32:35], s46 offen lds
    s_add_u32 s46, s47, 0x20000
    s_add_u32 m0, s48, 53248
    s_nop 0
    buffer_load_dwordx4 v83, s[32:35], s46 offen lds
    s_add_u32 s46, s47, 0x40000
    s_add_u32 m0, s48, 57344
    s_nop 0
    buffer_load_dwordx4 v83, s[32:35], s46 offen lds
    s_add_u32 s46, s47, 0x60000
    s_add_u32 m0, s48, 61440
    s_nop 0
    buffer_load_dwordx4 v83, s[32:35], s46 offen lds
    ds_read_b64_tr_b16 a[80:81], v80 offset:0
    ds_read_b64_tr_b16 a[82:83], v80 offset:1024
    ds_read_b64_tr_b16 a[84:85], v80 offset:8192
    ds_read_b64_tr_b16 a[86:87], v80 offset:9216
    ds_read_b64_tr_b16 v[56:57], v81 offset:0
    ds_read_b64_tr_b16 v[58:59], v81 offset:1024
    ds_read_b64_tr_b16 v[60:61], v81 offset:8192
    ds_read_b64_tr_b16 v[62:63], v81 offset:9216
    s_waitcnt lgkmcnt(0)
    ds_write_b128 v5, v[56:59] offset:12288
    ds_write_b128 v5, v[60:63] offset:13312
    s_waitcnt lgkmcnt(0)
    s_waitcnt vmcnt(8)
    s_barrier
    v_add_u32 v83, 0x600000, v82
    v_and_b32 v83, 0x7fffff, v83
    s_add_u32 s46, s47, 0x0
    s_add_u32 m0, s48, 0
    s_nop 0
    buffer_load_dwordx4 v83, s[32:35], s46 offen lds
    s_add_u32 s46, s47, 0x20000
    s_add_u32 m0, s48, 4096
    s_nop 0
    buffer_load_dwordx4 v83, s[32:35], s46 offen lds
    s_add_u32 s46, s47, 0x40000
    s_add_u32 m0, s48, 8192
    s_nop 0
    buffer_load_dwordx4 v83, s[32:35], s46 offen lds
    s_add_u32 s46, s47, 0x60000
    s_add_u32 m0, s48, 12288
    s_nop 0
    buffer_load_dwordx4 v83, s[32:35], s46 offen lds
    ds_read_b64_tr_b16 a[88:89], v80 offset:16384
    ds_read_b64_tr_b16 a[90:91], v80 offset:17408
    ds_read_b64_tr_b16 a[92:93], v80 offset:24576
    ds_read_b64_tr_b16 a[94:95], v80 offset:25600
    ds_read_b64_tr_b16 a[96:97], v81 offset:16384
    ds_read_b64_tr_b16 a[98:99], v81 offset:17408
    ds_read_b64_tr_b16 a[100:101], v81 offset:24576
    ds_read_b64_tr_b16 a[102:103], v81 offset:25600
    s_waitcnt lgkmcnt(0)
    s_waitcnt vmcnt(8)
    s_barrier
    v_add_u32 v83, 0x680000, v82
    v_and_b32 v83, 0x7fffff, v83
    s_add_u32 s46, s47, 0x0
    s_add_u32 m0, s48, 16384
    s_nop 0
    buffer_load_dwordx4 v83, s[32:35], s46 offen lds
    s_add_u32 s46, s47, 0x20000
    s_add_u32 m0, s48, 20480
    s_nop 0
    buffer_load_dwordx4 v83, s[32:35], s46 offen lds
    s_add_u32 s46, s47, 0x40000
    s_add_u32 m0, s48, 24576
    s_nop 0
    buffer_load_dwordx4 v83, s[32:35], s46 offen lds
    s_add_u32 s46, s47, 0x60000
    s_add_u32 m0, s48, 28672
    s_nop 0
    buffer_load_dwordx4 v83, s[32:35], s46 offen lds
    ds_read_b64_tr_b16 a[104:105], v80 offset:32768
    ds_read_b64_tr_b16 a[106:107], v80 offset:33792
    ds_read_b64_tr_b16 a[108:109], v80 offset:40960
    ds_read_b64_tr_b16 a[110:111], v80 offset:41984
    ds_read_b64_tr_b16 v[56:57], v81 offset:32768
    ds_read_b64_tr_b16 v[58:59], v81 offset:33792
    ds_read_b64_tr_b16 v[60:61], v81 offset:40960
    ds_read_b64_tr_b16 v[62:63], v81 offset:41984
    s_waitcnt lgkmcnt(0)
    ds_write_b128 v5, v[56:59] offset:14336
    ds_write_b128 v5, v[60:63] offset:15360
    s_waitcnt lgkmcnt(0)
    s_waitcnt vmcnt(8)
    s_barrier
    v_add_u32 v83, 0x700000, v82
    v_and_b32 v83, 0x7fffff, v83
    s_add_u32 s46, s47, 0x0
    s_add_u32 m0, s48, 32768
    s_nop 0
    buffer_load_dwordx4 v83, s[32:35], s46 offen lds
    s_add_u32 s46, s47, 0x20000
    s_add_u32 m0, s48, 36864
    s_nop 0
    buffer_load_dwordx4 v83, s[32:35], s46 offen lds
    s_add_u32 s46, s47, 0x40000
    s_add_u32 m0, s48, 40960
    s_nop 0
    buffer_load_dwordx4 v83, s[32:35], s46 offen lds
    s_add_u32 s46, s47, 0x60000
    s_add_u32 m0, s48, 45056
    s_nop 0
    buffer_load_dwordx4 v83, s[32:35], s46 offen lds
    ds_read_b64_tr_b16 a[112:113], v80 offset:49152
    ds_read_b64_tr_b16 a[114:115], v80 offset:50176
    ds_read_b64_tr_b16 a[116:117], v80 offset:57344
    ds_read_b64_tr_b16 a[118:119], v80 offset:58368
    ds_read_b64_tr_b16 v[56:57], v81 offset:49152
    ds_read_b64_tr_b16 v[58:59], v81 offset:50176
    ds_read_b64_tr_b16 v[60:61], v81 offset:57344
    ds_read_b64_tr_b16 v[62:63], v81 offset:58368
    s_waitcnt lgkmcnt(0)
    ds_write_b128 v5, v[56:59] offset:16384
    ds_write_b128 v5, v[60:63] offset:17408
    s_waitcnt lgkmcnt(0)
    s_waitcnt vmcnt(8)
    s_barrier
    v_add_u32 v83, 0x780000, v82
    v_and_b32 v83, 0x7fffff, v83
    s_add_u32 s46, s47, 0x0
    s_add_u32 m0, s48, 49152
    s_nop 0
    buffer_load_dwordx4 v83, s[32:35], s46 offen lds
    s_add_u32 s46, s47, 0x20000
    s_add_u32 m0, s48, 53248
    s_nop 0
    buffer_load_dwordx4 v83, s[32:35], s46 offen lds
    s_add_u32 s46, s47, 0x40000
    s_add_u32 m0, s48, 57344
    s_nop 0
    buffer_load_dwordx4 v83, s[32:35], s46 offen lds
    s_add_u32 s46, s47, 0x60000
    s_add_u32 m0, s48, 61440
    s_nop 0
    buffer_load_dwordx4 v83, s[32:35], s46 offen lds
    ds_read_b64_tr_b16 a[120:121], v80 offset:0
    ds_read_b64_tr_b16 a[122:123], v80 offset:1024
    ds_read_b64_tr_b16 a[124:125], v80 offset:8192
    ds_read_b64_tr_b16 a[126:127], v80 offset:9216
    ds_read_b64_tr_b16 v[56:57], v81 offset:0
    ds_read_b64_tr_b16 v[58:59], v81 offset:1024
    ds_read_b64_tr_b16 v[60:61], v81 offset:8192
    ds_read_b64_tr_b16 v[62:63], v81 offset:9216
    s_waitcnt lgkmcnt(0)
    ds_write_b128 v5, v[56:59] offset:18432
    ds_write_b128 v5, v[60:63] offset:19456
    s_waitcnt lgkmcnt(0)
    s_waitcnt vmcnt(8)
    s_barrier
    s_add_u32 s51, s69, 0
    s_and_b32 s51, s51, 7
    s_lshl_b32 s51, s51, 17
    s_add_u32 s51, s51, s49
    s_add_u32 s46, s51, 0x0
    s_add_u32 m0, s50, 0
    s_nop 0
    buffer_load_dwordx4 v70, s[36:39], s46 offen lds
    s_add_u32 s46, s51, 0x8000
    s_add_u32 m0, s50, 1024
    s_nop 0
    buffer_load_dwordx4 v71, s[36:39], s46 offen lds
    s_add_u32 s46, s51, 0x10000
    s_add_u32 m0, s50, 2048
    s_nop 0
    buffer_load_dwordx4 v72, s[36:39], s46 offen lds
    s_add_u32 s46, s51, 0x18000
    s_add_u32 m0, s50, 3072
    s_nop 0
    buffer_load_dwordx4 v73, s[36:39], s46 offen lds
    ds_read_b64_tr_b16 a[128:129], v80 offset:16384
    ds_read_b64_tr_b16 a[130:131], v80 offset:17408
    ds_read_b64_tr_b16 a[132:133], v80 offset:24576
    ds_read_b64_tr_b16 a[134:135], v80 offset:25600
    ds_read_b64_tr_b16 a[136:137], v81 offset:16384
    ds_read_b64_tr_b16 a[138:139], v81 offset:17408
    ds_read_b64_tr_b16 a[140:141], v81 offset:24576
    ds_read_b64_tr_b16 a[142:143], v81 offset:25600
    s_waitcnt lgkmcnt(0)
    s_waitcnt vmcnt(8)
    s_barrier
    s_add_u32 s51, s69, 0
    s_and_b32 s51, s51, 7
    s_lshl_b32 s51, s51, 17
    s_add_u32 s51, s51, s49
    s_add_u32 s46, s51, 0x4000
    s_add_u32 m0, s50, 16384
    s_nop 0
    buffer_load_dwordx4 v70, s[36:39], s46 offen lds
    s_add_u32 s46, s51, 0xc000
    s_add_u32 m0, s50, 17408
    s_nop 0
    buffer_load_dwordx4 v71, s[36:39], s46 offen lds
    s_add_u32 s46, s51, 0x14000
    s_add_u32 m0, s50, 18432
    s_nop 0
    buffer_load_dwordx4 v72, s[36:39], s46 offen lds
    s_add_u32 s46, s51, 0x1c000
    s_add_u32 m0, s50, 19456
    s_nop 0
    buffer_load_dwordx4 v73, s[36:39], s46 offen lds
    ds_read_b64_tr_b16 a[144:145], v80 offset:32768
    ds_read_b64_tr_b16 a[146:147], v80 offset:33792
    ds_read_b64_tr_b16 a[148:149], v80 offset:40960
    ds_read_b64_tr_b16 a[150:151], v80 offset:41984
    ds_read_b64_tr_b16 v[56:57], v81 offset:32768
    ds_read_b64_tr_b16 v[58:59], v81 offset:33792
    ds_read_b64_tr_b16 v[60:61], v81 offset:40960
    ds_read_b64_tr_b16 v[62:63], v81 offset:41984
    s_waitcnt lgkmcnt(0)
    ds_write_b128 v5, v[56:59] offset:20480
    ds_write_b128 v5, v[60:63] offset:21504
    s_waitcnt lgkmcnt(0)
    s_waitcnt vmcnt(8)
    s_barrier
    s_add_u32 s51, s69, 1
    s_and_b32 s51, s51, 7
    s_lshl_b32 s51, s51, 17
    s_add_u32 s51, s51, s49
    s_add_u32 s46, s51, 0x0
    s_add_u32 m0, s50, 32768
    s_nop 0
    buffer_load_dwordx4 v70, s[36:39], s46 offen lds
    s_add_u32 s46, s51, 0x8000
    s_add_u32 m0, s50, 33792
    s_nop 0
    buffer_load_dwordx4 v71, s[36:39], s46 offen lds
    s_add_u32 s46, s51, 0x10000
    s_add_u32 m0, s50, 34816
    s_nop 0
    buffer_load_dwordx4 v72, s[36:39], s46 offen lds
    s_add_u32 s46, s51, 0x18000
    s_add_u32 m0, s50, 35840
    s_nop 0
    buffer_load_dwordx4 v73, s[36:39], s46 offen lds
    ds_read_b64_tr_b16 a[152:153], v80 offset:49152
    ds_read_b64_tr_b16 a[154:155], v80 offset:50176
    ds_read_b64_tr_b16 a[156:157], v80 offset:57344
    ds_read_b64_tr_b16 a[158:159], v80 offset:58368
    ds_read_b64_tr_b16 v[56:57], v81 offset:49152
    ds_read_b64_tr_b16 v[58:59], v81 offset:50176
    ds_read_b64_tr_b16 v[60:61], v81 offset:57344
    ds_read_b64_tr_b16 v[62:63], v81 offset:58368
    s_waitcnt lgkmcnt(0)
    ds_write_b128 v5, v[56:59] offset:22528
    ds_write_b128 v5, v[60:63] offset:23552
    s_waitcnt lgkmcnt(0)
    s_waitcnt vmcnt(8)
    s_barrier
    s_add_u32 s51, s69, 1
    s_and_b32 s51, s51, 7
    s_lshl_b32 s51, s51, 17
    s_add_u32 s51, s51, s49
    s_add_u32 s46, s51, 0x4000
    s_add_u32 m0, s50, 49152
    s_nop 0
    buffer_load_dwordx4 v70, s[36:39], s46 offen lds
    s_add_u32 s46, s51, 0xc000
    s_add_u32 m0, s50, 50176
    s_nop 0
    buffer_load_dwordx4 v71, s[36:39], s46 offen lds
    s_add_u32 s46, s51, 0x14000
    s_add_u32 m0, s50, 51200
    s_nop 0
    buffer_load_dwordx4 v72, s[36:39], s46 offen lds
    s_add_u32 s46, s51, 0x1c000
    s_add_u32 m0, s50, 52224
    s_nop 0
    buffer_load_dwordx4 v73, s[36:39], s46 offen lds
    ds_read_b64_tr_b16 a[160:161], v74 offset:0
    ds_read_b64_tr_b16 a[162:163], v74 offset:256
    ds_read_b64_tr_b16 a[168:169], v75 offset:0
    ds_read_b64_tr_b16 a[170:171], v75 offset:256
    ds_read_b64_tr_b16 a[176:177], v76 offset:0
    ds_read_b64_tr_b16 a[178:179], v76 offset:256
    ds_read_b64_tr_b16 a[184:185], v77 offset:0
    ds_read_b64_tr_b16 a[186:187], v77 offset:256
    s_waitcnt lgkmcnt(0)
    s_waitcnt vmcnt(8)
    s_barrier
    s_add_u32 s51, s69, 2
    s_and_b32 s51, s51, 7
    s_lshl_b32 s51, s51, 17
    s_add_u32 s51, s51, s49
    s_add_u32 s46, s51, 0x0
    s_add_u32 m0, s50, 0
    s_nop 0
    buffer_load_dwordx4 v70, s[36:39], s46 offen lds
    s_add_u32 s46, s51, 0x8000
    s_add_u32 m0, s50, 1024
    s_nop 0
    buffer_load_dwordx4 v71, s[36:39], s46 offen lds
    s_add_u32 s46, s51, 0x10000
    s_add_u32 m0, s50, 2048
    s_nop 0
    buffer_load_dwordx4 v72, s[36:39], s46 offen lds
    s_add_u32 s46, s51, 0x18000
    s_add_u32 m0, s50, 3072
    s_nop 0
    buffer_load_dwordx4 v73, s[36:39], s46 offen lds
    ds_read_b64_tr_b16 a[164:165], v74 offset:16384
    ds_read_b64_tr_b16 a[166:167], v74 offset:16640
    ds_read_b64_tr_b16 a[172:173], v75 offset:16384
    ds_read_b64_tr_b16 a[174:175], v75 offset:16640
    ds_read_b64_tr_b16 a[180:181], v76 offset:16384
    ds_read_b64_tr_b16 a[182:183], v76 offset:16640
    ds_read_b64_tr_b16 a[188:189], v77 offset:16384
    ds_read_b64_tr_b16 a[190:191], v77 offset:16640
    s_waitcnt lgkmcnt(0)
    s_waitcnt vmcnt(8)
    s_barrier
    s_add_u32 s51, s69, 2
    s_and_b32 s51, s51, 7
    s_lshl_b32 s51, s51, 17
    s_add_u32 s51, s51, s49
    s_add_u32 s46, s51, 0x4000
    s_add_u32 m0, s50, 16384
    s_nop 0
    buffer_load_dwordx4 v70, s[36:39], s46 offen lds
    s_add_u32 s46, s51, 0xc000
    s_add_u32 m0, s50, 17408
    s_nop 0
    buffer_load_dwordx4 v71, s[36:39], s46 offen lds
    s_add_u32 s46, s51, 0x14000
    s_add_u32 m0, s50, 18432
    s_nop 0
    buffer_load_dwordx4 v72, s[36:39], s46 offen lds
    s_add_u32 s46, s51, 0x1c000
    s_add_u32 m0, s50, 19456
    s_nop 0
    buffer_load_dwordx4 v73, s[36:39], s46 offen lds
    ds_read_b64_tr_b16 a[192:193], v74 offset:32768
    ds_read_b64_tr_b16 a[194:195], v74 offset:33024
    ds_read_b64_tr_b16 a[200:201], v75 offset:32768
    ds_read_b64_tr_b16 a[202:203], v75 offset:33024
    ds_read_b64_tr_b16 a[208:209], v76 offset:32768
    ds_read_b64_tr_b16 a[210:211], v76 offset:33024
    ds_read_b64_tr_b16 a[216:217], v77 offset:32768
    ds_read_b64_tr_b16 a[218:219], v77 offset:33024
    s_waitcnt lgkmcnt(0)
    s_waitcnt vmcnt(8)
    s_barrier
    s_add_u32 s51, s69, 3
    s_and_b32 s51, s51, 7
    s_lshl_b32 s51, s51, 17
    s_add_u32 s51, s51, s49
    s_add_u32 s46, s51, 0x0
    s_add_u32 m0, s50, 32768
    s_nop 0
    buffer_load_dwordx4 v70, s[36:39], s46 offen lds
    s_add_u32 s46, s51, 0x8000
    s_add_u32 m0, s50, 33792
    s_nop 0
    buffer_load_dwordx4 v71, s[36:39], s46 offen lds
    s_add_u32 s46, s51, 0x10000
    s_add_u32 m0, s50, 34816
    s_nop 0
    buffer_load_dwordx4 v72, s[36:39], s46 offen lds
    s_add_u32 s46, s51, 0x18000
    s_add_u32 m0, s50, 35840
    s_nop 0
    buffer_load_dwordx4 v73, s[36:39], s46 offen lds
    ds_read_b64_tr_b16 a[196:197], v74 offset:49152
    ds_read_b64_tr_b16 a[198:199], v74 offset:49408
    ds_read_b64_tr_b16 a[204:205], v75 offset:49152
    ds_read_b64_tr_b16 a[206:207], v75 offset:49408
    ds_read_b64_tr_b16 a[212:213], v76 offset:49152
    ds_read_b64_tr_b16 a[214:215], v76 offset:49408
    ds_read_b64_tr_b16 a[220:221], v77 offset:49152
    ds_read_b64_tr_b16 a[222:223], v77 offset:49408
    s_waitcnt lgkmcnt(0)
    s_waitcnt vmcnt(8)
    s_barrier
    s_add_u32 s51, s69, 3
    s_and_b32 s51, s51, 7
    s_lshl_b32 s51, s51, 17
    s_add_u32 s51, s51, s49
    s_add_u32 s46, s51, 0x4000
    s_add_u32 m0, s50, 49152
    s_nop 0
    buffer_load_dwordx4 v70, s[36:39], s46 offen lds
    s_add_u32 s46, s51, 0xc000
    s_add_u32 m0, s50, 50176
    s_nop 0
    buffer_load_dwordx4 v71, s[36:39], s46 offen lds
    s_add_u32 s46, s51, 0x14000
    s_add_u32 m0, s50, 51200
    s_nop 0
    buffer_load_dwordx4 v72, s[36:39], s46 offen lds
    s_add_u32 s46, s51, 0x1c000
    s_add_u32 m0, s50, 52224
    s_nop 0
    buffer_load_dwordx4 v73, s[36:39], s46 offen lds
    ds_read_b64_tr_b16 a[224:225], v74 offset:0
    ds_read_b64_tr_b16 a[226:227], v74 offset:256
    ds_read_b64_tr_b16 a[232:233], v75 offset:0
    ds_read_b64_tr_b16 a[234:235], v75 offset:256
    ds_read_b64_tr_b16 a[240:241], v76 offset:0
    ds_read_b64_tr_b16 a[242:243], v76 offset:256
    ds_read_b64_tr_b16 a[248:249], v77 offset:0
    ds_read_b64_tr_b16 a[250:251], v77 offset:256
    s_waitcnt lgkmcnt(0)
    s_waitcnt vmcnt(8)
    s_barrier
    s_add_u32 s51, s69, 4
    s_and_b32 s51, s51, 7
    s_lshl_b32 s51, s51, 17
    s_add_u32 s51, s51, s49
    s_add_u32 s46, s51, 0x0
    s_add_u32 m0, s50, 0
    s_nop 0
    buffer_load_dwordx4 v70, s[36:39], s46 offen lds
    s_add_u32 s46, s51, 0x8000
    s_add_u32 m0, s50, 1024
    s_nop 0
    buffer_load_dwordx4 v71, s[36:39], s46 offen lds
    s_add_u32 s46, s51, 0x10000
    s_add_u32 m0, s50, 2048
    s_nop 0
    buffer_load_dwordx4 v72, s[36:39], s46 offen lds
    s_add_u32 s46, s51, 0x18000
    s_add_u32 m0, s50, 3072
    s_nop 0
    buffer_load_dwordx4 v73, s[36:39], s46 offen lds
    ds_read_b64_tr_b16 a[228:229], v74 offset:16384
    ds_read_b64_tr_b16 a[230:231], v74 offset:16640
    ds_read_b64_tr_b16 a[236:237], v75 offset:16384
    ds_read_b64_tr_b16 a[238:239], v75 offset:16640
    ds_read_b64_tr_b16 a[244:245], v76 offset:16384
    ds_read_b64_tr_b16 a[246:247], v76 offset:16640
    ds_read_b64_tr_b16 a[252:253], v77 offset:16384
    ds_read_b64_tr_b16 a[254:255], v77 offset:16640
    s_waitcnt lgkmcnt(0)
    s_waitcnt vmcnt(8)
    s_barrier
    s_add_u32 s51, s69, 4
    s_and_b32 s51, s51, 7
    s_lshl_b32 s51, s51, 17
    s_add_u32 s51, s51, s49
    s_add_u32 s46, s51, 0x4000
    s_add_u32 m0, s50, 16384
    s_nop 0
    buffer_load_dwordx4 v70, s[36:39], s46 offen lds
    s_add_u32 s46, s51, 0xc000
    s_add_u32 m0, s50, 17408
    s_nop 0
    buffer_load_dwordx4 v71, s[36:39], s46 offen lds
    s_add_u32 s46, s51, 0x14000
    s_add_u32 m0, s50, 18432
    s_nop 0
    buffer_load_dwordx4 v72, s[36:39], s46 offen lds
    s_add_u32 s46, s51, 0x1c000
    s_add_u32 m0, s50, 19456
    s_nop 0
    buffer_load_dwordx4 v73, s[36:39], s46 offen lds
    ds_read_b64_tr_b16 v[96:97], v74 offset:32768
    ds_read_b64_tr_b16 v[98:99], v74 offset:33024
    ds_read_b64_tr_b16 v[104:105], v75 offset:32768
    ds_read_b64_tr_b16 v[106:107], v75 offset:33024
    ds_read_b64_tr_b16 v[112:113], v76 offset:32768
    ds_read_b64_tr_b16 v[114:115], v76 offset:33024
    ds_read_b64_tr_b16 v[120:121], v77 offset:32768
    ds_read_b64_tr_b16 v[122:123], v77 offset:33024
    s_waitcnt lgkmcnt(0)
    s_waitcnt vmcnt(8)
    s_barrier
    s_add_u32 s51, s69, 5
    s_and_b32 s51, s51, 7
    s_lshl_b32 s51, s51, 17
    s_add_u32 s51, s51, s49
    s_add_u32 s46, s51, 0x0
    s_add_u32 m0, s50, 32768
    s_nop 0
    buffer_load_dwordx4 v70, s[36:39], s46 offen lds
    s_add_u32 s46, s51, 0x8000
    s_add_u32 m0, s50, 33792
    s_nop 0
    buffer_load_dwordx4 v71, s[36:39], s46 offen lds
    s_add_u32 s46, s51, 0x10000
    s_add_u32 m0, s50, 34816
    s_nop 0
    buffer_load_dwordx4 v72, s[36:39], s46 offen lds
    s_add_u32 s46, s51, 0x18000
    s_add_u32 m0, s50, 35840
    s_nop 0
    buffer_load_dwordx4 v73, s[36:39], s46 offen lds
    ds_read_b64_tr_b16 v[100:101], v74 offset:49152
    ds_read_b64_tr_b16 v[102:103], v74 offset:49408
    ds_read_b64_tr_b16 v[108:109], v75 offset:49152
    ds_read_b64_tr_b16 v[110:111], v75 offset:49408
    ds_read_b64_tr_b16 v[116:117], v76 offset:49152
    ds_read_b64_tr_b16 v[118:119], v76 offset:49408
    ds_read_b64_tr_b16 v[124:125], v77 offset:49152
    ds_read_b64_tr_b16 v[126:127], v77 offset:49408
    s_waitcnt lgkmcnt(0)
    s_waitcnt vmcnt(8)
    s_barrier
    s_add_u32 s51, s69, 5
    s_and_b32 s51, s51, 7
    s_lshl_b32 s51, s51, 17
    s_add_u32 s51, s51, s49
    s_add_u32 s46, s51, 0x4000
    s_add_u32 m0, s50, 49152
    s_nop 0
    buffer_load_dwordx4 v70, s[36:39], s46 offen lds
    s_add_u32 s46, s51, 0xc000
    s_add_u32 m0, s50, 50176
    s_nop 0
    buffer_load_dwordx4 v71, s[36:39], s46 offen lds
    s_add_u32 s46, s51, 0x14000
    s_add_u32 m0, s50, 51200
    s_nop 0
    buffer_load_dwordx4 v72, s[36:39], s46 offen lds
    s_add_u32 s46, s51, 0x1c000
    s_add_u32 m0, s50, 52224
    s_nop 0
    buffer_load_dwordx4 v73, s[36:39], s46 offen lds
    ds_read_b64_tr_b16 v[128:129], v74 offset:0
    ds_read_b64_tr_b16 v[130:131], v74 offset:256
    ds_read_b64_tr_b16 v[136:137], v75 offset:0
    ds_read_b64_tr_b16 v[138:139], v75 offset:256
    ds_read_b64_tr_b16 v[144:145], v76 offset:0
    ds_read_b64_tr_b16 v[146:147], v76 offset:256
    ds_read_b64_tr_b16 v[152:153], v77 offset:0
    ds_read_b64_tr_b16 v[154:155], v77 offset:256
    s_waitcnt lgkmcnt(0)
    s_waitcnt vmcnt(8)
    s_barrier
    s_add_u32 s51, s69, 6
    s_and_b32 s51, s51, 7
    s_lshl_b32 s51, s51, 17
    s_add_u32 s51, s51, s49
    s_add_u32 s46, s51, 0x0
    s_add_u32 m0, s50, 0
    s_nop 0
    buffer_load_dwordx4 v70, s[36:39], s46 offen lds
    s_add_u32 s46, s51, 0x8000
    s_add_u32 m0, s50, 1024
    s_nop 0
    buffer_load_dwordx4 v71, s[36:39], s46 offen lds
    s_add_u32 s46, s51, 0x10000
    s_add_u32 m0, s50, 2048
    s_nop 0
    buffer_load_dwordx4 v72, s[36:39], s46 offen lds
    s_add_u32 s46, s51, 0x18000
    s_add_u32 m0, s50, 3072
    s_nop 0
    buffer_load_dwordx4 v73, s[36:39], s46 offen lds
    ds_read_b64_tr_b16 v[132:133], v74 offset:16384
    ds_read_b64_tr_b16 v[134:135], v74 offset:16640
    ds_read_b64_tr_b16 v[140:141], v75 offset:16384
    ds_read_b64_tr_b16 v[142:143], v75 offset:16640
    ds_read_b64_tr_b16 v[148:149], v76 offset:16384
    ds_read_b64_tr_b16 v[150:151], v76 offset:16640
    ds_read_b64_tr_b16 v[156:157], v77 offset:16384
    ds_read_b64_tr_b16 v[158:159], v77 offset:16640
    s_waitcnt lgkmcnt(0)
    s_waitcnt vmcnt(8)
    s_barrier
    s_add_u32 s51, s69, 6
    s_and_b32 s51, s51, 7
    s_lshl_b32 s51, s51, 17
    s_add_u32 s51, s51, s49
    s_add_u32 s46, s51, 0x4000
    s_add_u32 m0, s50, 16384
    s_nop 0
    buffer_load_dwordx4 v70, s[36:39], s46 offen lds
    s_add_u32 s46, s51, 0xc000
    s_add_u32 m0, s50, 17408
    s_nop 0
    buffer_load_dwordx4 v71, s[36:39], s46 offen lds
    s_add_u32 s46, s51, 0x14000
    s_add_u32 m0, s50, 18432
    s_nop 0
    buffer_load_dwordx4 v72, s[36:39], s46 offen lds
    s_add_u32 s46, s51, 0x1c000
    s_add_u32 m0, s50, 19456
    s_nop 0
    buffer_load_dwordx4 v73, s[36:39], s46 offen lds
    ds_read_b64_tr_b16 v[160:161], v74 offset:32768
    ds_read_b64_tr_b16 v[162:163], v74 offset:33024
    ds_read_b64_tr_b16 v[168:169], v75 offset:32768
    ds_read_b64_tr_b16 v[170:171], v75 offset:33024
    ds_read_b64_tr_b16 v[176:177], v76 offset:32768
    ds_read_b64_tr_b16 v[178:179], v76 offset:33024
    ds_read_b64_tr_b16 v[184:185], v77 offset:32768
    ds_read_b64_tr_b16 v[186:187], v77 offset:33024
    s_waitcnt lgkmcnt(0)
    s_waitcnt vmcnt(8)
    s_barrier
    s_add_u32 s51, s69, 7
    s_and_b32 s51, s51, 7
    s_lshl_b32 s51, s51, 17
    s_add_u32 s51, s51, s49
    s_add_u32 s46, s51, 0x0
    s_add_u32 m0, s50, 32768
    s_nop 0
    buffer_load_dwordx4 v70, s[36:39], s46 offen lds
    s_add_u32 s46, s51, 0x8000
    s_add_u32 m0, s50, 33792
    s_nop 0
    buffer_load_dwordx4 v71, s[36:39], s46 offen lds
    s_add_u32 s46, s51, 0x10000
    s_add_u32 m0, s50, 34816
    s_nop 0
    buffer_load_dwordx4 v72, s[36:39], s46 offen lds
    s_add_u32 s46, s51, 0x18000
    s_add_u32 m0, s50, 35840
    s_nop 0
    buffer_load_dwordx4 v73, s[36:39], s46 offen lds
    ds_read_b64_tr_b16 v[164:165], v74 offset:49152
    ds_read_b64_tr_b16 v[166:167], v74 offset:49408
    ds_read_b64_tr_b16 v[172:173], v75 offset:49152
    ds_read_b64_tr_b16 v[174:175], v75 offset:49408
    ds_read_b64_tr_b16 v[180:181], v76 offset:49152
    ds_read_b64_tr_b16 v[182:183], v76 offset:49408
    ds_read_b64_tr_b16 v[188:189], v77 offset:49152
    ds_read_b64_tr_b16 v[190:191], v77 offset:49408
    s_waitcnt lgkmcnt(0)
    s_waitcnt vmcnt(8)
    s_barrier
    s_add_u32 s51, s69, 7
    s_and_b32 s51, s51, 7
    s_lshl_b32 s51, s51, 17
    s_add_u32 s51, s51, s49
    s_add_u32 s46, s51, 0x4000
    s_add_u32 m0, s50, 49152
    s_nop 0
    buffer_load_dwordx4 v70, s[36:39], s46 offen lds
    s_add_u32 s46, s51, 0xc000
    s_add_u32 m0, s50, 50176
    s_nop 0
    buffer_load_dwordx4 v71, s[36:39], s46 offen lds
    s_add_u32 s46, s51, 0x14000
    s_add_u32 m0, s50, 51200
    s_nop 0
    buffer_load_dwordx4 v72, s[36:39], s46 offen lds
    s_add_u32 s46, s51, 0x1c000
    s_add_u32 m0, s50, 52224
    s_nop 0
    buffer_load_dwordx4 v73, s[36:39], s46 offen lds
    ds_read_b64_tr_b16 v[192:193], v74 offset:0
    ds_read_b64_tr_b16 v[194:195], v74 offset:256
    ds_read_b64_tr_b16 v[200:201], v75 offset:0
    ds_read_b64_tr_b16 v[202:203], v75 offset:256
    ds_read_b64_tr_b16 v[208:209], v76 offset:0
    ds_read_b64_tr_b16 v[210:211], v76 offset:256
    ds_read_b64_tr_b16 v[216:217], v77 offset:0
    ds_read_b64_tr_b16 v[218:219], v77 offset:256
    s_waitcnt lgkmcnt(0)
    s_waitcnt vmcnt(8)
    s_barrier
    ds_read_b64_tr_b16 v[196:197], v74 offset:16384
    ds_read_b64_tr_b16 v[198:199], v74 offset:16640
    ds_read_b64_tr_b16 v[204:205], v75 offset:16384
    ds_read_b64_tr_b16 v[206:207], v75 offset:16640
    ds_read_b64_tr_b16 v[212:213], v76 offset:16384
    ds_read_b64_tr_b16 v[214:215], v76 offset:16640
    ds_read_b64_tr_b16 v[220:221], v77 offset:16384
    ds_read_b64_tr_b16 v[222:223], v77 offset:16640
    s_waitcnt lgkmcnt(0)
    s_waitcnt vmcnt(4)
    s_barrier
    ds_read_b64_tr_b16 v[224:225], v74 offset:32768
    ds_read_b64_tr_b16 v[226:227], v74 offset:33024
    ds_read_b64_tr_b16 v[232:233], v75 offset:32768
    ds_read_b64_tr_b16 v[234:235], v75 offset:33024
    ds_read_b64_tr_b16 v[240:241], v76 offset:32768
    ds_read_b64_tr_b16 v[242:243], v76 offset:33024
    ds_read_b64_tr_b16 v[248:249], v77 offset:32768
    ds_read_b64_tr_b16 v[250:251], v77 offset:33024
    s_waitcnt lgkmcnt(0)
    s_waitcnt vmcnt(0)
    s_barrier
    ds_read_b64_tr_b16 v[228:229], v74 offset:49152
    ds_read_b64_tr_b16 v[230:231], v74 offset:49408
    ds_read_b64_tr_b16 v[236:237], v75 offset:49152
    ds_read_b64_tr_b16 v[238:239], v75 offset:49408
    ds_read_b64_tr_b16 v[244:245], v76 offset:49152
    ds_read_b64_tr_b16 v[246:247], v76 offset:49408
    ds_read_b64_tr_b16 v[252:253], v77 offset:49152
    ds_read_b64_tr_b16 v[254:255], v77 offset:49408
    s_waitcnt lgkmcnt(0)
    s_barrier
    v_lshlrev_b32 v68, 4, v1
    s_mul_i32 s45, s44, 3072
    s_add_u32 s45, s45, 53248
    v_add_u32 v6, s45, v68
    s_sub_u32 s45, s44, 1
    s_and_b32 s45, s45, 3
    s_mul_i32 s45, s45, 3072
    s_add_u32 s45, s45, 53248
    v_add_u32 v7, s45, v68
    s_sub_u32 s45, s44, 2
    s_and_b32 s45, s45, 3
    s_mul_i32 s45, s45, 3072
    s_add_u32 s45, s45, 54272
    v_add_u32 v8, s45, v68
    s_sub_u32 s45, s44, 3
    s_and_b32 s45, s45, 3
    s_mul_i32 s45, s45, 3072
    s_add_u32 s45, s45, 55296
    v_add_u32 v18, s45, v68
    v_lshlrev_b32 v68, 4, v1
    s_add_u32 s45, s69, 0
    s_and_b32 s45, s45, 7
    s_lshl_b32 s45, s45, 10
    s_lshl_b32 s46, s44, 13
    s_add_u32 s45, s45, s46
    v_add_u32 v80, s45, v68
    s_add_u32 s45, s69, 1
    s_and_b32 s45, s45, 7
    s_lshl_b32 s45, s45, 10
    s_lshl_b32 s46, s44, 13
    s_add_u32 s45, s45, s46
    v_add_u32 v81, s45, v68
    s_add_u32 s45, s69, 2
    s_and_b32 s45, s45, 7
    s_lshl_b32 s45, s45, 10
    s_lshl_b32 s46, s44, 13
    s_add_u32 s45, s45, s46
    v_add_u32 v82, s45, v68
    s_add_u32 s45, s69, 3
    s_and_b32 s45, s45, 7
    s_lshl_b32 s45, s45, 10
    s_lshl_b32 s46, s44, 13
    s_add_u32 s45, s45, s46
    v_add_u32 v83, s45, v68
    s_add_u32 s45, s69, 4
    s_and_b32 s45, s45, 7
    s_lshl_b32 s45, s45, 10
    s_lshl_b32 s46, s44, 13
    s_add_u32 s45, s45, s46
    v_add_u32 v84, s45, v68
    s_add_u32 s45, s69, 5
    s_and_b32 s45, s45, 7
    s_lshl_b32 s45, s45, 10
    s_lshl_b32 s46, s44, 13
    s_add_u32 s45, s45, s46
    v_add_u32 v85, s45, v68
    s_add_u32 s45, s69, 6
    s_and_b32 s45, s45, 7
    s_lshl_b32 s45, s45, 10
    s_lshl_b32 s46, s44, 13
    s_add_u32 s45, s45, s46
    v_add_u32 v86, s45, v68
    s_add_u32 s45, s69, 7
    s_and_b32 s45, s45, 7
    s_lshl_b32 s45, s45, 10
    s_lshl_b32 s46, s44, 13
    s_add_u32 s45, s45, s46
    v_add_u32 v87, s45, v68
    s_lshl_b32 s45, s40, 4
    s_add_u32 s45, s45, s42
    s_lshl_b32 s45, s45, 7
    s_lshl_b32 s46, s44, 4
    s_add_u32 s45, s45, s46
    s_add_u32 s45, s45, 0x7080000
    v_and_b32 v13, 3, v1
    v_lshlrev_b32 v13, 2, v13
    v_add_u32 v13, s45, v13
    s_mov_b32 s66, 0x1800000
    v_mov_b32 v14, -1
    v_mov_b32 v15, -1
    s_mov_b32 s70, 0
    v_mov_b32 v41, 0
L_hw_23:
    s_sleep 2
    buffer_load_dword v44, v41, s[16:19], 0 offen sc1
    s_add_u32 s70, s70, 1
    s_cmp_ge_u32 s70, 0x100000
    s_cbranch_scc1 L_c_done_1
    s_waitcnt vmcnt(0)
    v_readfirstlane_b32 s45, v44
    s_cmp_lg_u32 s45, 64
    s_cbranch_scc1 L_hw_23
    buffer_load_dwordx4 v[44:47], v41, s[16:19], 0 offen sc1
    s_waitcnt vmcnt(0)
    v_readfirstlane_b32 s45, v45
    v_readfirstlane_b32 s46, v46
    v_readfirstlane_b32 s68, v47
    s_bcnt1_i32_b32 s45, s45
    s_bcnt1_i32_b32 s46, s46
    s_add_u32 s45, s45, s46
    s_cmp_eq_u32 s45, 2
    s_cselect_b32 s67, 1, 0
    s_cmp_ge_u32 s68, 16
    s_cselect_b32 s68, 8192, 0
    s_mov_b32 s60, 0
    s_lshl_b32 s58, s40, 16
    s_add_u32 s58, s58, 0x7000000
    s_mov_b32 s61, s58
    s_lshl_b32 s59, s40, 17
    s_add_u32 s59, s59, 0x7040000
    s_mov_b32 s62, s59
    s_add_u32 s63, s63, s68
    s_add_u32 s64, s64, s68
    ds_read_b128 v[56:59], v5 offset:0
    ds_read_b128 v[60:63], v5 offset:1024
    ds_read_b128 v[64:67], v5 offset:2048
    ds_read_b128 v[68:71], v5 offset:3072
    ds_read_b128 v[72:75], v5 offset:4096
    ds_read_b128 v[76:79], v5 offset:5120
    ds_read_b128 v[88:91], v5 offset:6144
    ds_read_b128 v[92:95], v5 offset:7168
    ds_read_b128 v[32:35], v5 offset:8192
    ds_read_b128 v[36:39], v5 offset:9216
L_v_loop_24:
    s_nop 15
    s_nop 15
    s_waitcnt lgkmcnt(0)
    s_mov_b32 s70, 0
L_mg_25:
    buffer_load_dwordx4 v[40:43], v3, s[12:15], s61 offen offset:0 sc1
    s_nop 9
    buffer_load_dwordx4 v[44:47], v3, s[12:15], s61 offen offset:1024 sc1
    s_nop 9
    buffer_load_dwordx4 v[48:51], v3, s[12:15], s61 offen offset:2048 sc1
    s_nop 9
    buffer_load_dwordx4 v[52:55], v3, s[12:15], s61 offen offset:3072 sc1
    s_add_u32 s70, s70, 1
    s_cmp_ge_u32 s70, 0x100000
    s_cbranch_scc1 L_c_done_1
    s_nop 1
    v_mov_b32 v24, 0
    v_mov_b32 v25, 0
    v_mov_b32 v26, 0
    v_mov_b32 v27, 0
    v_mov_b32 v28, 0
    v_mov_b32 v29, 0
    v_mov_b32 v30, 0
    v_mov_b32 v31, 0
    s_waitcnt vmcnt(3)
    ds_write_b128 v3, v[40:43] offset:0
    v_smfmac_f32_16x16x64_bf16 v[24:27], v[40:43], a[0:7], v2
    v_max3_u32 v22, v40, v41, v42
    v_max_u32 v22, v22, v43
    v_smfmac_f32_16x16x64_bf16 v[28:31], v[40:43], a[8:15], v2
    s_waitcnt vmcnt(2)
    ds_write_b128 v3, v[44:47] offset:1024
    v_smfmac_f32_16x16x64_bf16 v[24:27], v[44:47], a[16:23], v2
    v_max3_u32 v22, v22, v44, v45
    v_max3_u32 v22, v22, v46, v47
    v_smfmac_f32_16x16x64_bf16 v[28:31], v[44:47], a[24:31], v2
    s_waitcnt vmcnt(1)
    ds_write_b128 v3, v[48:51] offset:2048
    s_waitcnt vmcnt(0)
    ds_write_b128 v3, v[52:55] offset:3072
    v_max3_u32 v22, v22, v48, v49
    v_max3_u32 v22, v22, v50, v51
    v_max3_u32 v22, v22, v52, v53
    v_max3_u32 v22, v22, v54, v55
    v_cmp_eq_u32 vcc, -1, v22
    s_waitcnt lgkmcnt(0)
    s_nop 0
    s_cbranch_vccnz L_mg_25
    s_barrier
    ds_read_b128 v[40:43], v4 offset:0
    ds_read_b128 v[44:47], v4 offset:1024
    v_smfmac_f32_16x16x64_bf16 v[24:27], v[48:51], a[32:39], v2
    v_smfmac_f32_16x16x64_bf16 v[28:31], v[48:51], v[56:63], v2
    ds_read_b128 v[48:51], v4 offset:2048
    ds_read_b128 v[56:59], v5 offset:10240
    v_smfmac_f32_16x16x64_bf16 v[24:27], v[52:55], a[40:47], v2
    ds_read_b128 v[60:63], v5 offset:11264
    v_smfmac_f32_16x16x64_bf16 v[28:31], v[52:55], v[64:71], v2
    ds_read_b128 v[52:55], v4 offset:3072
    ds_read_b128 v[64:67], v5 offset:12288
    s_waitcnt lgkmcnt(5)
    v_smfmac_f32_16x16x64_bf16 v[24:27], v[40:43], a[48:55], v2
    ds_read_b128 v[68:71], v5 offset:13312
    v_smfmac_f32_16x16x64_bf16 v[28:31], v[40:43], v[72:79], v2
    ds_read_b128 v[40:43], v21 offset:0
    ds_read_b128 v[72:75], v5 offset:14336
    v_smfmac_f32_16x16x64_bf16 v[24:27], v[44:47], a[56:63], v2
    ds_read_b128 v[76:79], v5 offset:15360
    v_smfmac_f32_16x16x64_bf16 v[28:31], v[44:47], v[88:95], v2
    ds_read_b128 v[44:47], v21 offset:1024
    ds_read_b128 v[88:91], v5 offset:16384
    s_waitcnt lgkmcnt(6)
    v_smfmac_f32_16x16x64_bf16 v[24:27], v[48:51], a[64:71], v2
    ds_read_b128 v[92:95], v5 offset:17408
    v_smfmac_f32_16x16x64_bf16 v[28:31], v[48:51], v[32:39], v2
    ds_read_b128 v[48:51], v21 offset:2048
    ds_read_b128 v[32:35], v5 offset:18432
    v_smfmac_f32_16x16x64_bf16 v[24:27], v[52:55], a[72:79], v2
    ds_read_b128 v[36:39], v5 offset:19456
    v_smfmac_f32_16x16x64_bf16 v[28:31], v[52:55], v[56:63], v2
    ds_read_b128 v[52:55], v21 offset:3072
    ds_read_b128 v[56:59], v5 offset:20480
    s_waitcnt lgkmcnt(6)
    v_smfmac_f32_16x16x64_bf16 v[24:27], v[40:43], a[80:87], v2
    ds_read_b128 v[60:63], v5 offset:21504
    v_smfmac_f32_16x16x64_bf16 v[28:31], v[40:43], v[64:71], v2
    ds_read_b128 v[40:43], v23 offset:0
    ds_read_b128 v[64:67], v5 offset:22528
    v_smfmac_f32_16x16x64_bf16 v[24:27], v[44:47], a[88:95], v2
    ds_read_b128 v[68:71], v5 offset:23552
    v_smfmac_f32_16x16x64_bf16 v[28:31], v[44:47], a[96:103], v2
    ds_read_b128 v[44:47], v23 offset:1024
    s_waitcnt lgkmcnt(5)
    v_smfmac_f32_16x16x64_bf16 v[24:27], v[48:51], a[104:111], v2
    v_smfmac_f32_16x16x64_bf16 v[28:31], v[48:51], v[72:79], v2
    ds_read_b128 v[48:51], v23 offset:2048
    v_smfmac_f32_16x16x64_bf16 v[24:27], v[52:55], a[112:119], v2
    v_smfmac_f32_16x16x64_bf16 v[28:31], v[52:55], v[88:95], v2
    ds_read_b128 v[52:55], v23 offset:3072
    s_waitcnt lgkmcnt(2)
    v_smfmac_f32_16x16x64_bf16 v[24:27], v[40:43], a[120:127], v2
    v_smfmac_f32_16x16x64_bf16 v[28:31], v[40:43], v[32:39], v2
    v_smfmac_f32_16x16x64_bf16 v[24:27], v[44:47], a[128:135], v2
    v_smfmac_f32_16x16x64_bf16 v[28:31], v[44:47], a[136:143], v2
    s_waitcnt lgkmcnt(0)
    v_smfmac_f32_16x16x64_bf16 v[24:27], v[48:51], a[144:151], v2
    v_smfmac_f32_16x16x64_bf16 v[28:31], v[48:51], v[56:63], v2
    v_smfmac_f32_16x16x64_bf16 v[24:27], v[52:55], a[152:159], v2
    v_smfmac_f32_16x16x64_bf16 v[28:31], v[52:55], v[64:71], v2
    s_and_b32 s45, s60, 1
    s_lshl_b32 s45, s45, 16
    s_add_u32 s45, s45, 0x7020000
    s_xor_b32 s46, s45, 65536
    s_nop 3
    v_permlane32_swap_b32 v24, v26
    v_permlane32_swap_b32 v25, v27
    v_permlane32_swap_b32 v28, v30
    v_permlane32_swap_b32 v29, v31
    v_pk_add_f32 v[24:25], v[24:25], v[26:27]
    v_pk_add_f32 v[28:29], v[28:29], v[30:31]
    v_cvt_pk_bf16_f32 v16, v24, v25
    v_cvt_pk_bf16_f32 v17, v28, v29
    v_min_u32 v16, -2, v16
    v_min_u32 v17, -2, v17
    s_add_u32 s47, s60, 3
    s_and_b32 s47, s47, 3
    s_lshl_b32 s47, s47, 14
    s_add_u32 s47, s47, s58
    s_cmp_eq_u32 s67, 1
    s_cbranch_scc0 L_ls_26_s
    buffer_store_dwordx2 v[16:17], v10, s[12:15], s45 offen
    buffer_store_dwordx2 v[14:15], v10, s[12:15], s46 offen
    buffer_store_dword v14, v12, s[12:15], s47 offen
L_ls_26_d:
    buffer_store_dwordx2 v[16:17], v10, s[12:15], s66 offen sc1
    s_cmp_eq_u32 s60, 63
    s_cbranch_scc1 L_v_fin_27
    v_mov_b32 v22, s60
    v_mov_b32 v0, 0
    s_mov_b64 exec, 1
    buffer_store_dword v22, v0, s[12:15], s3 offen sc1
    s_mov_b64 exec, -1
    s_and_b32 s65, s60, 1
    s_lshl_b32 s65, s65, 12
    s_and_b32 s45, s60, 2
    s_lshl_b32 s45, s45, 13
    s_add_u32 s65, s65, s45
    s_xor_b32 s45, s65, 16384
    s_add_u32 s45, s45, s63
    buffer_store_dwordx2 v[14:15], v11, s[12:15], s45 offen sc1
    s_add_u32 s48, s63, s65
    s_add_u32 s49, s64, s65
    s_sleep 8
    s_mov_b64 exec, 15
    buffer_load_dword v88, v13, s[12:15], 0 offen sc1
    s_nop 15
    buffer_load_dword v89, v13, s[12:15], 0 offen sc1
    s_nop 15
    buffer_load_dword v90, v13, s[12:15], 0 offen sc1
    s_nop 15
    buffer_load_dword v91, v13, s[12:15], 0 offen sc1
    s_mov_b32 s70, 0
L_pp_28:
    s_waitcnt vmcnt(3)
    v_cmp_ge_u32 vcc, s60, v88
    s_add_u32 s70, s70, 1
    s_nop 0
    s_cbranch_vccz L_ppd_29
    buffer_load_dword v88, v13, s[12:15], 0 offen sc1
    s_waitcnt vmcnt(3)
    v_cmp_ge_u32 vcc, s60, v89
    s_add_u32 s70, s70, 1
    s_nop 0
    s_cbranch_vccz L_ppd_29
    buffer_load_dword v89, v13, s[12:15], 0 offen sc1
    s_waitcnt vmcnt(3)
    v_cmp_ge_u32 vcc, s60, v90
    s_add_u32 s70, s70, 1
    s_nop 0
    s_cbranch_vccz L_ppd_29
    buffer_load_dword v90, v13, s[12:15], 0 offen sc1
    s_waitcnt vmcnt(3)
    v_cmp_ge_u32 vcc, s60, v91
    s_add_u32 s70, s70, 1
    s_nop 0
    s_cbranch_vccz L_ppd_29
    buffer_load_dword v91, v13, s[12:15], 0 offen sc1
    s_cmp_lt_u32 s70, 0x400000
    s_cbranch_scc1 L_pp_28
    s_branch L_c_done_1
L_ppd_29:
    s_mov_b64 exec, -1
    s_nop 15
    s_nop 15
    s_mov_b32 s70, 0
    buffer_load_dwordx4 v[40:43], v80, s[12:15], s62 offen sc1
    v_mov_b32 v24, 0
    v_mov_b32 v25, 0
    v_mov_b32 v26, 0
    v_mov_b32 v27, 0
    s_nop 5
    buffer_load_dwordx4 v[44:47], v81, s[12:15], s62 offen sc1
    v_mov_b32 v28, 0
    v_mov_b32 v29, 0
    v_mov_b32 v30, 0
    v_mov_b32 v31, 0
    s_nop 5
    buffer_load_dwordx4 v[48:51], v82, s[12:15], s62 offen sc1
    v_mov_b32 v32, 0
    v_mov_b32 v33, 0
    v_mov_b32 v34, 0
    v_mov_b32 v35, 0
    s_nop 5
    buffer_load_dwordx4 v[52:55], v83, s[12:15], s62 offen sc1
    v_mov_b32 v36, 0
    v_mov_b32 v37, 0
    v_mov_b32 v38, 0
    v_mov_b32 v39, 0
    s_nop 5
    buffer_load_dwordx4 v[56:59], v84, s[12:15], s62 offen sc1
    s_nop 9
    buffer_load_dwordx4 v[60:63], v85, s[12:15], s62 offen sc1
    s_waitcnt vmcnt(5)
    v_max3_u32 v22, v40, v41, v42
    v_max_u32 v22, v22, v43
    v_cmp_eq_u32 vcc, -1, v22
    s_nop 1
    s_cbranch_vccnz L_v_og_30_r0
L_v_og_30_c0:
    v_smfmac_f32_16x16x64_bf16 v[24:27], v[40:43], a[160:167], v2
    s_waitcnt vmcnt(4)
    v_max3_u32 v22, v44, v45, v46
    v_smfmac_f32_16x16x64_bf16 v[28:31], v[40:43], a[168:175], v2
    v_max_u32 v22, v22, v47
    v_smfmac_f32_16x16x64_bf16 v[32:35], v[40:43], a[176:183], v2
    v_cmp_eq_u32 vcc, -1, v22
    v_smfmac_f32_16x16x64_bf16 v[36:39], v[40:43], a[184:191], v2
    buffer_load_dwordx4 v[64:67], v86, s[12:15], s62 offen sc1
    s_cbranch_vccnz L_v_og_30_r1
L_v_og_30_c1:
    v_smfmac_f32_16x16x64_bf16 v[24:27], v[44:47], a[192:199], v2
    s_waitcnt vmcnt(4)
    v_max3_u32 v22, v48, v49, v50
    v_smfmac_f32_16x16x64_bf16 v[28:31], v[44:47], a[200:207], v2
    v_max_u32 v22, v22, v51
    v_smfmac_f32_16x16x64_bf16 v[32:35], v[44:47], a[208:215], v2
    v_cmp_eq_u32 vcc, -1, v22
    v_smfmac_f32_16x16x64_bf16 v[36:39], v[44:47], a[216:223], v2
    buffer_load_dwordx4 v[68:71], v87, s[12:15], s62 offen sc1
    s_cbranch_vccnz L_v_og_30_r2
L_v_og_30_c2:
    v_smfmac_f32_16x16x64_bf16 v[24:27], v[48:51], a[224:231], v2
    s_waitcnt vmcnt(4)
    v_max3_u32 v22, v52, v53, v54
    v_smfmac_f32_16x16x64_bf16 v[28:31], v[48:51], a[232:239], v2
    v_max_u32 v22, v22, v55
    v_smfmac_f32_16x16x64_bf16 v[32:35], v[48:51], a[240:247], v2
    v_cmp_eq_u32 vcc, -1, v22
    v_smfmac_f32_16x16x64_bf16 v[36:39], v[48:51], a[248:255], v2
    s_nop 0
    s_cbranch_vccnz L_v_og_30_r3
L_v_og_30_c3:
    v_smfmac_f32_16x16x64_bf16 v[24:27], v[52:55], v[96:103], v2
    s_waitcnt vmcnt(3)
    v_max3_u32 v22, v56, v57, v58
    v_smfmac_f32_16x16x64_bf16 v[28:31], v[52:55], v[104:111], v2
    v_max_u32 v22, v22, v59
    v_smfmac_f32_16x16x64_bf16 v[32:35], v[52:55], v[112:119], v2
    v_cmp_eq_u32 vcc, -1, v22
    v_smfmac_f32_16x16x64_bf16 v[36:39], v[52:55], v[120:127], v2
    s_nop 0
    s_cbranch_vccnz L_v_og_30_r4
L_v_og_30_c4:
    v_smfmac_f32_16x16x64_bf16 v[24:27], v[56:59], v[128:135], v2
    s_waitcnt vmcnt(2)
    v_max3_u32 v22, v60, v61, v62
    v_smfmac_f32_16x16x64_bf16 v[28:31], v[56:59], v[136:143], v2
    v_max_u32 v22, v22, v63
    v_smfmac_f32_16x16x64_bf16 v[32:35], v[56:59], v[144:151], v2
    v_cmp_eq_u32 vcc, -1, v22
    v_smfmac_f32_16x16x64_bf16 v[36:39], v[56:59], v[152:159], v2
    s_nop 0
    s_cbranch_vccnz L_v_og_30_r5
L_v_og_30_c5:
    v_smfmac_f32_16x16x64_bf16 v[24:27], v[60:63], v[160:167], v2
    s_waitcnt vmcnt(1)
    v_max3_u32 v22, v64, v65, v66
    v_smfmac_f32_16x16x64_bf16 v[28:31], v[60:63], v[168:175], v2
    v_max_u32 v22, v22, v67
    v_smfmac_f32_16x16x64_bf16 v[32:35], v[60:63], v[176:183], v2
    v_cmp_eq_u32 vcc, -1, v22
    v_smfmac_f32_16x16x64_bf16 v[36:39], v[60:63], v[184:191], v2
    s_nop 0
    s_cbranch_vccnz L_v_og_30_r6
L_v_og_30_c6:
    v_smfmac_f32_16x16x64_bf16 v[24:27], v[64:67], v[192:199], v2
    s_waitcnt vmcnt(0)
    v_max3_u32 v22, v68, v69, v70
    v_smfmac_f32_16x16x64_bf16 v[28:31], v[64:67], v[200:207], v2
    v_max_u32 v22, v22, v71
    v_smfmac_f32_16x16x64_bf16 v[32:35], v[64:67], v[208:215], v2
    v_cmp_eq_u32 vcc, -1, v22
    v_smfmac_f32_16x16x64_bf16 v[36:39], v[64:67], v[216:223], v2
    s_nop 0
    s_cbranch_vccnz L_v_og_30_r7
L_v_og_30_c7:
    v_smfmac_f32_16x16x64_bf16 v[24:27], v[68:71], v[224:231], v2
    v_smfmac_f32_16x16x64_bf16 v[28:31], v[68:71], v[232:239], v2
    v_smfmac_f32_16x16x64_bf16 v[32:35], v[68:71], v[240:247], v2
    v_smfmac_f32_16x16x64_bf16 v[36:39], v[68:71], v[248:255], v2
    s_add_u32 s46, s60, 1
    s_nop 3
    ds_write_b128 v6, v[24:27]
    s_and_b32 s45, s46, 3
    ds_write_b128 v6, v[28:31] offset:1024
    s_mov_b32 s60, s46
    ds_write_b128 v6, v[32:35] offset:2048
    s_lshl_b32 s46, s45, 14
    s_add_u32 s61, s58, s46
    s_lshl_b32 s46, s45, 15
    s_add_u32 s62, s59, s46
    s_waitcnt lgkmcnt(0)
    s_barrier
    ds_read_b128 v[40:43], v7
    ds_read_b128 v[44:47], v8
    ds_read_b128 v[48:51], v18
    s_waitcnt lgkmcnt(2)
    v_pk_add_f32 v[36:37], v[36:37], v[40:41]
    v_pk_add_f32 v[38:39], v[38:39], v[42:43]
    s_waitcnt lgkmcnt(1)
    v_pk_add_f32 v[36:37], v[36:37], v[44:45]
    v_pk_add_f32 v[38:39], v[38:39], v[46:47]
    s_waitcnt lgkmcnt(0)
    v_pk_add_f32 v[36:37], v[36:37], v[48:49]
    v_pk_add_f32 v[38:39], v[38:39], v[50:51]
    s_nop 1
    v_permlane32_swap_b32 v36, v38
    v_permlane32_swap_b32 v37, v39
    v_pk_add_f32 v[24:25], v[36:37], v[38:39]
    v_min_u32 v24, -2, v24
    v_min_u32 v25, -2, v25
    buffer_store_dwordx2 v[24:25], v11, s[12:15], s48 offen sc1
    ds_read_b128 v[56:59], v5 offset:0
    ds_read_b128 v[60:63], v5 offset:1024
    ds_read_b128 v[64:67], v5 offset:2048
    ds_read_b128 v[68:71], v5 offset:3072
    ds_read_b128 v[72:75], v5 offset:4096
    ds_read_b128 v[76:79], v5 offset:5120
    ds_read_b128 v[88:91], v5 offset:6144
    ds_read_b128 v[92:95], v5 offset:7168
    ds_read_b128 v[32:35], v5 offset:8192
    ds_read_b128 v[36:39], v5 offset:9216
    s_sleep 2
    buffer_load_dwordx2 v[40:41], v11, s[12:15], s49 offen sc1
    s_nop 15
    s_nop 7
    buffer_load_dwordx2 v[42:43], v11, s[12:15], s49 offen sc1
    s_nop 15
    s_nop 7
    buffer_load_dwordx2 v[44:45], v11, s[12:15], s49 offen sc1
    s_mov_b32 s70, 0
L_v_xp_31:
    s_waitcnt vmcnt(2)
    v_max_u32 v22, v40, v41
    v_cmp_eq_u32 vcc, -1, v22
    v_pk_add_f32 v[28:29], v[24:25], v[40:41]
    v_cvt_pk_bf16_f32 v28, v28, v29
    s_cbranch_vccz L_v_xp_31_ok
    buffer_load_dwordx2 v[40:41], v11, s[12:15], s49 offen sc1
    s_waitcnt vmcnt(2)
    v_max_u32 v22, v42, v43
    v_cmp_eq_u32 vcc, -1, v22
    v_pk_add_f32 v[28:29], v[24:25], v[42:43]
    v_cvt_pk_bf16_f32 v28, v28, v29
    s_cbranch_vccz L_v_xp_31_ok
    buffer_load_dwordx2 v[42:43], v11, s[12:15], s49 offen sc1
    s_waitcnt vmcnt(2)
    v_max_u32 v22, v44, v45
    v_cmp_eq_u32 vcc, -1, v22
    v_pk_add_f32 v[28:29], v[24:25], v[44:45]
    v_cvt_pk_bf16_f32 v28, v28, v29
    s_cbranch_vccz L_v_xp_31_ok
    buffer_load_dwordx2 v[44:45], v11, s[12:15], s49 offen sc1
    s_add_u32 s70, s70, 1
    s_cmp_lt_u32 s70, 0x100000
    s_cbranch_scc1 L_v_xp_31
    s_branch L_c_done_1
L_v_xp_31_ok:
    s_add_u32 s66, s66, 65536
    v_mov_b32_dpp v29, v28 quad_perm:[1,0,3,2] row_mask:0xf bank_mask:0xf
    v_perm_b32 v28, v28, v29, v9
    v_min_u32 v28, -2, v28
    s_cmp_eq_u32 s67, 1
    s_cbranch_scc0 L_ls_32_s
    buffer_store_dword v28, v12, s[12:15], s61 offen
L_ls_32_d:
    s_branch L_v_loop_24
L_v_fin_27:
    s_waitcnt vmcnt(0)
    v_mov_b32 v22, 64
    v_mov_b32 v0, 0
    s_mov_b64 exec, 1
    buffer_store_dword v22, v0, s[12:15], s3 offen sc1
    s_mov_b64 exec, -1
L_c_done_1:
    s_endpgm
L_v_og_30_r0:
    buffer_load_dwordx4 v[40:43], v80, s[12:15], s62 offen sc1
    buffer_load_dwordx4 v[44:47], v81, s[12:15], s62 offen sc1
    buffer_load_dwordx4 v[48:51], v82, s[12:15], s62 offen sc1
    buffer_load_dwordx4 v[52:55], v83, s[12:15], s62 offen sc1
    buffer_load_dwordx4 v[56:59], v84, s[12:15], s62 offen sc1
    buffer_load_dwordx4 v[60:63], v85, s[12:15], s62 offen sc1
    s_add_u32 s70, s70, 1
    s_cmp_ge_u32 s70, 0x100000
    s_cbranch_scc1 L_c_done_1
    s_waitcnt vmcnt(5)
    v_max3_u32 v22, v40, v41, v42
    v_max_u32 v22, v22, v43
    v_cmp_eq_u32 vcc, -1, v22
    s_nop 1
    s_cbranch_vccnz L_v_og_30_r0
    s_branch L_v_og_30_c0
L_v_og_30_r1:
    buffer_load_dwordx4 v[44:47], v81, s[12:15], s62 offen sc1
    buffer_load_dwordx4 v[48:51], v82, s[12:15], s62 offen sc1
    buffer_load_dwordx4 v[52:55], v83, s[12:15], s62 offen sc1
    buffer_load_dwordx4 v[56:59], v84, s[12:15], s62 offen sc1
    buffer_load_dwordx4 v[60:63], v85, s[12:15], s62 offen sc1
    buffer_load_dwordx4 v[64:67], v86, s[12:15], s62 offen sc1
    s_add_u32 s70, s70, 1
    s_cmp_ge_u32 s70, 0x100000
    s_cbranch_scc1 L_c_done_1
    s_waitcnt vmcnt(5)
    v_max3_u32 v22, v44, v45, v46
    v_max_u32 v22, v22, v47
    v_cmp_eq_u32 vcc, -1, v22
    s_nop 1
    s_cbranch_vccnz L_v_og_30_r1
    s_branch L_v_og_30_c1
L_v_og_30_r2:
    buffer_load_dwordx4 v[48:51], v82, s[12:15], s62 offen sc1
    buffer_load_dwordx4 v[52:55], v83, s[12:15], s62 offen sc1
    buffer_load_dwordx4 v[56:59], v84, s[12:15], s62 offen sc1
    buffer_load_dwordx4 v[60:63], v85, s[12:15], s62 offen sc1
    buffer_load_dwordx4 v[64:67], v86, s[12:15], s62 offen sc1
    buffer_load_dwordx4 v[68:71], v87, s[12:15], s62 offen sc1
    s_add_u32 s70, s70, 1
    s_cmp_ge_u32 s70, 0x100000
    s_cbranch_scc1 L_c_done_1
    s_waitcnt vmcnt(5)
    v_max3_u32 v22, v48, v49, v50
    v_max_u32 v22, v22, v51
    v_cmp_eq_u32 vcc, -1, v22
    s_nop 1
    s_cbranch_vccnz L_v_og_30_r2
    s_branch L_v_og_30_c2
L_v_og_30_r3:
    buffer_load_dwordx4 v[52:55], v83, s[12:15], s62 offen sc1
    buffer_load_dwordx4 v[56:59], v84, s[12:15], s62 offen sc1
    buffer_load_dwordx4 v[60:63], v85, s[12:15], s62 offen sc1
    buffer_load_dwordx4 v[64:67], v86, s[12:15], s62 offen sc1
    buffer_load_dwordx4 v[68:71], v87, s[12:15], s62 offen sc1
    s_add_u32 s70, s70, 1
    s_cmp_ge_u32 s70, 0x100000
    s_cbranch_scc1 L_c_done_1
    s_waitcnt vmcnt(4)
    v_max3_u32 v22, v52, v53, v54
    v_max_u32 v22, v22, v55
    v_cmp_eq_u32 vcc, -1, v22
    s_nop 1
    s_cbranch_vccnz L_v_og_30_r3
    s_branch L_v_og_30_c3
L_v_og_30_r4:
    buffer_load_dwordx4 v[56:59], v84, s[12:15], s62 offen sc1
    buffer_load_dwordx4 v[60:63], v85, s[12:15], s62 offen sc1
    buffer_load_dwordx4 v[64:67], v86, s[12:15], s62 offen sc1
    buffer_load_dwordx4 v[68:71], v87, s[12:15], s62 offen sc1
    s_add_u32 s70, s70, 1
    s_cmp_ge_u32 s70, 0x100000
    s_cbranch_scc1 L_c_done_1
    s_waitcnt vmcnt(3)
    v_max3_u32 v22, v56, v57, v58
    v_max_u32 v22, v22, v59
    v_cmp_eq_u32 vcc, -1, v22
    s_nop 1
    s_cbranch_vccnz L_v_og_30_r4
    s_branch L_v_og_30_c4
L_v_og_30_r5:
    buffer_load_dwordx4 v[60:63], v85, s[12:15], s62 offen sc1
    buffer_load_dwordx4 v[64:67], v86, s[12:15], s62 offen sc1
    buffer_load_dwordx4 v[68:71], v87, s[12:15], s62 offen sc1
    s_add_u32 s70, s70, 1
    s_cmp_ge_u32 s70, 0x100000
    s_cbranch_scc1 L_c_done_1
    s_waitcnt vmcnt(2)
    v_max3_u32 v22, v60, v61, v62
    v_max_u32 v22, v22, v63
    v_cmp_eq_u32 vcc, -1, v22
    s_nop 1
    s_cbranch_vccnz L_v_og_30_r5
    s_branch L_v_og_30_c5
L_v_og_30_r6:
    buffer_load_dwordx4 v[64:67], v86, s[12:15], s62 offen sc1
    buffer_load_dwordx4 v[68:71], v87, s[12:15], s62 offen sc1
    s_add_u32 s70, s70, 1
    s_cmp_ge_u32 s70, 0x100000
    s_cbranch_scc1 L_c_done_1
    s_waitcnt vmcnt(1)
    v_max3_u32 v22, v64, v65, v66
    v_max_u32 v22, v22, v67
    v_cmp_eq_u32 vcc, -1, v22
    s_nop 1
    s_cbranch_vccnz L_v_og_30_r6
    s_branch L_v_og_30_c6
L_v_og_30_r7:
    buffer_load_dwordx4 v[68:71], v87, s[12:15], s62 offen sc1
    s_add_u32 s70, s70, 1
    s_cmp_ge_u32 s70, 0x100000
    s_cbranch_scc1 L_c_done_1
    s_waitcnt vmcnt(0)
    v_max3_u32 v22, v68, v69, v70
    v_max_u32 v22, v22, v71
    v_cmp_eq_u32 vcc, -1, v22
    s_nop 1
    s_cbranch_vccnz L_v_og_30_r7
    s_branch L_v_og_30_c7
L_ls_26_s:
    buffer_store_dwordx2 v[16:17], v10, s[12:15], s45 offen sc1
    buffer_store_dwordx2 v[14:15], v10, s[12:15], s46 offen sc1
    buffer_store_dword v14, v12, s[12:15], s47 offen sc1
    s_branch L_ls_26_d
L_ls_32_s:
    buffer_store_dword v28, v12, s[12:15], s61 offen sc1
    s_branch L_ls_32_d
L_worker_3:
    s_and_b32 s40, s2, 7
    s_sub_u32 s40, s40, 2
    s_lshr_b32 s41, s2, 3
    s_cmp_ge_u32 s40, 3
    s_cselect_b32 s42, 1, 0
    s_mul_i32 s45, s42, 3
    s_sub_u32 s43, s40, s45
    s_lshl_b32 s39, s40, 5
    s_add_u32 s39, s39, s41
    v_lshrrev_b32 v2, 4, v1
    v_lshlrev_b32 v2, 13, v2
    v_and_b32 v3, 15, v1
    v_lshlrev_b32 v3, 4, v3
    v_add_u32 v2, v2, v3
    v_and_b32 v3, 31, v1
    v_mul_u32_u24 v4, 1040, v3
    v_lshrrev_b32 v5, 5, v1
    v_lshlrev_b32 v6, 4, v5
    v_add_u32 v4, v4, v6
    v_mul_u32_u24 v6, 272, v3
    v_lshlrev_b32 v7, 5, v5
    s_lshl_b32 s45, s44, 6
    s_add_u32 s45, s45, 133120
    v_add3_u32 v6, v6, v7, s45
    v_mul_u32_u24 v7, 528, v3
    v_lshlrev_b32 v8, 6, v5
    s_lshl_b32 s45, s44, 7
    s_add_u32 s45, s45, 133120
    v_add3_u32 v7, v7, v8, s45
    v_lshrrev_b32 v8, 4, v1
    v_mul_u32_u24 v8, 272, v8
    v_and_b32 v9, 15, v1
    v_lshlrev_b32 v9, 4, v9
    s_mul_i32 s45, s44, 2176
    s_add_u32 s45, s45, 133120
    v_add3_u32 v8, v8, v9, s45
    v_mul_u32_u24 v9, 528, v5
    v_lshlrev_b32 v10, 4, v3
    s_mul_i32 s45, s44, 4224
    s_add_u32 s45, s45, 133120
    v_add3_u32 v9, v9, v10, s45
    v_lshlrev_b32 v11, 12, v5
    v_add_u32 v11, v11, v10
    v_lshlrev_b32 v10, 4, v1
    v_lshlrev_b32 v12, 2, v1
    s_lshl_b32 s61, s41, 7
    s_lshl_b32 s45, s43, 3
    s_add_u32 s61, s61, s45
    s_lshl_b32 s45, s42, 2
    s_add_u32 s61, s61, s45
    s_add_u32 s61, s61, 0x10000
    s_lshl_b32 s64, s42, 7
    s_add_u32 s64, s64, 0x12000
    s_lshl_b32 s45, s41, 2
    s_add_u32 s65, s64, s45
    s_lshl_b32 s45, s43, 9
    s_add_u32 s65, s65, s45
    v_mov_b32 v30, 0
    v_mov_b32 v31, 0
    s_mov_b64 exec, 1
    buffer_store_dword v30, v31, s[12:15], s61 offen sc1
    buffer_store_dword v30, v31, s[12:15], s65 offen sc1
    buffer_store_dword v30, v31, s[12:15], s65 offen offset:256 sc1
    s_mov_b64 exec, -1
    s_load_dwordx2 s[4:5], s[0:1], 96
    s_load_dwordx2 s[6:7], s[0:1], 104
    v_and_b32 v14, 3, v0
    v_lshrrev_b32 v15, 2, v0
    s_waitcnt lgkmcnt(0)
    s_mov_b32 s28, s4
    s_and_b32 s29, s5, 0xffff
    s_mov_b32 s30, 0x800
    s_mov_b32 s31, 0x00020000
    s_mov_b32 s24, s6
    s_and_b32 s25, s7, 0xffff
    s_mov_b32 s26, 0xc00000
    s_mov_b32 s27, 0x00020000
    v_lshlrev_b32 v16, 5, v15
    buffer_load_dwordx4 v[104:107], v16, s[28:31], 0 offen
    buffer_load_dwordx4 v[108:111], v16, s[28:31], 0 offen offset:16
    s_mov_b32 s45, 196608
    v_mul_lo_u32 v17, v15, s45
    v_lshlrev_b32 v18, 4, v14
    v_add_u32 v17, v17, v18
    s_lshl_b32 s46, s39, 6
    buffer_load_dwordx4 v[32:35], v17, s[24:27], s46 offen
    v_add_u32 v17, 12288, v17
    buffer_load_dwordx4 v[36:39], v17, s[24:27], s46 offen
    v_add_u32 v17, 12288, v17
    buffer_load_dwordx4 v[40:43], v17, s[24:27], s46 offen
    v_add_u32 v17, 12288, v17
    buffer_load_dwordx4 v[44:47], v17, s[24:27], s46 offen
    v_add_u32 v17, 12288, v17
    buffer_load_dwordx4 v[48:51], v17, s[24:27], s46 offen
    v_add_u32 v17, 12288, v17
    buffer_load_dwordx4 v[52:55], v17, s[24:27], s46 offen
    v_add_u32 v17, 12288, v17
    buffer_load_dwordx4 v[56:59], v17, s[24:27], s46 offen
    v_add_u32 v17, 12288, v17
    buffer_load_dwordx4 v[60:63], v17, s[24:27], s46 offen
    v_add_u32 v17, 12288, v17
    buffer_load_dwordx4 v[64:67], v17, s[24:27], s46 offen
    v_add_u32 v17, 12288, v17
    buffer_load_dwordx4 v[68:71], v17, s[24:27], s46 offen
    v_add_u32 v17, 12288, v17
    buffer_load_dwordx4 v[72:75], v17, s[24:27], s46 offen
    v_add_u32 v17, 12288, v17
    buffer_load_dwordx4 v[76:79], v17, s[24:27], s46 offen
    v_add_u32 v17, 12288, v17
    buffer_load_dwordx4 v[80:83], v17, s[24:27], s46 offen
    v_add_u32 v17, 12288, v17
    buffer_load_dwordx4 v[84:87], v17, s[24:27], s46 offen
    v_add_u32 v17, 12288, v17
    buffer_load_dwordx4 v[88:91], v17, s[24:27], s46 offen
    v_add_u32 v17, 12288, v17
    buffer_load_dwordx4 v[92:95], v17, s[24:27], s46 offen
    s_waitcnt vmcnt(16)
    v_lshlrev_b32 v112, 16, v104
    v_and_b32 v113, 0xffff0000, v104
    v_lshlrev_b32 v114, 16, v105
    v_and_b32 v115, 0xffff0000, v105
    v_lshlrev_b32 v116, 16, v106
    v_and_b32 v117, 0xffff0000, v106
    v_lshlrev_b32 v118, 16, v107
    v_and_b32 v119, 0xffff0000, v107
    v_lshlrev_b32 v120, 16, v108
    v_and_b32 v121, 0xffff0000, v108
    v_lshlrev_b32 v122, 16, v109
    v_and_b32 v123, 0xffff0000, v109
    v_lshlrev_b32 v124, 16, v110
    v_and_b32 v125, 0xffff0000, v110
    v_lshlrev_b32 v126, 16, v111
    v_and_b32 v127, 0xffff0000, v111
    v_mul_f32 v18, 0xbfb8aa3b, v112
    v_exp_f32 v18, v18
    s_nop 0
    v_add_f32 v18, 1.0, v18
    v_rcp_f32 v18, v18
    s_nop 0
    v_mul_f32 v112, v112, v18
    v_cvt_pk_bf16_f32 v112, v112, v112
    v_lshlrev_b32 v112, 16, v112
    v_mul_f32 v18, 0xbfb8aa3b, v113
    v_exp_f32 v18, v18
    s_nop 0
    v_add_f32 v18, 1.0, v18
    v_rcp_f32 v18, v18
    s_nop 0
    v_mul_f32 v113, v113, v18
    v_cvt_pk_bf16_f32 v113, v113, v113
    v_lshlrev_b32 v113, 16, v113
    v_mul_f32 v18, 0xbfb8aa3b, v114
    v_exp_f32 v18, v18
    s_nop 0
    v_add_f32 v18, 1.0, v18
    v_rcp_f32 v18, v18
    s_nop 0
    v_mul_f32 v114, v114, v18
    v_cvt_pk_bf16_f32 v114, v114, v114
    v_lshlrev_b32 v114, 16, v114
    v_mul_f32 v18, 0xbfb8aa3b, v115
    v_exp_f32 v18, v18
    s_nop 0
    v_add_f32 v18, 1.0, v18
    v_rcp_f32 v18, v18
    s_nop 0
    v_mul_f32 v115, v115, v18
    v_cvt_pk_bf16_f32 v115, v115, v115
    v_lshlrev_b32 v115, 16, v115
    v_mul_f32 v18, 0xbfb8aa3b, v116
    v_exp_f32 v18, v18
    s_nop 0
    v_add_f32 v18, 1.0, v18
    v_rcp_f32 v18, v18
    s_nop 0
    v_mul_f32 v116, v116, v18
    v_cvt_pk_bf16_f32 v116, v116, v116
    v_lshlrev_b32 v116, 16, v116
    v_mul_f32 v18, 0xbfb8aa3b, v117
    v_exp_f32 v18, v18
    s_nop 0
    v_add_f32 v18, 1.0, v18
    v_rcp_f32 v18, v18
    s_nop 0
    v_mul_f32 v117, v117, v18
    v_cvt_pk_bf16_f32 v117, v117, v117
    v_lshlrev_b32 v117, 16, v117
    v_mul_f32 v18, 0xbfb8aa3b, v118
    v_exp_f32 v18, v18
    s_nop 0
    v_add_f32 v18, 1.0, v18
    v_rcp_f32 v18, v18
    s_nop 0
    v_mul_f32 v118, v118, v18
    v_cvt_pk_bf16_f32 v118, v118, v118
    v_lshlrev_b32 v118, 16, v118
    v_mul_f32 v18, 0xbfb8aa3b, v119
    v_exp_f32 v18, v18
    s_nop 0
    v_add_f32 v18, 1.0, v18
    v_rcp_f32 v18, v18
    s_nop 0
    v_mul_f32 v119, v119, v18
    v_cvt_pk_bf16_f32 v119, v119, v119
    v_lshlrev_b32 v119, 16, v119
    v_mul_f32 v18, 0xbfb8aa3b, v120
    v_exp_f32 v18, v18
    s_nop 0
    v_add_f32 v18, 1.0, v18
    v_rcp_f32 v18, v18
    s_nop 0
    v_mul_f32 v120, v120, v18
    v_cvt_pk_bf16_f32 v120, v120, v120
    v_lshlrev_b32 v120, 16, v120
    v_mul_f32 v18, 0xbfb8aa3b, v121
    v_exp_f32 v18, v18
    s_nop 0
    v_add_f32 v18, 1.0, v18
    v_rcp_f32 v18, v18
    s_nop 0
    v_mul_f32 v121, v121, v18
    v_cvt_pk_bf16_f32 v121, v121, v121
    v_lshlrev_b32 v121, 16, v121
    v_mul_f32 v18, 0xbfb8aa3b, v122
    v_exp_f32 v18, v18
    s_nop 0
    v_add_f32 v18, 1.0, v18
    v_rcp_f32 v18, v18
    s_nop 0
    v_mul_f32 v122, v122, v18
    v_cvt_pk_bf16_f32 v122, v122, v122
    v_lshlrev_b32 v122, 16, v122
    v_mul_f32 v18, 0xbfb8aa3b, v123
    v_exp_f32 v18, v18
    s_nop 0
    v_add_f32 v18, 1.0, v18
    v_rcp_f32 v18, v18
    s_nop 0
    v_mul_f32 v123, v123, v18
    v_cvt_pk_bf16_f32 v123, v123, v123
    v_lshlrev_b32 v123, 16, v123
    v_mul_f32 v18, 0xbfb8aa3b, v124
    v_exp_f32 v18, v18
    s_nop 0
    v_add_f32 v18, 1.0, v18
    v_rcp_f32 v18, v18
    s_nop 0
    v_mul_f32 v124, v124, v18
    v_cvt_pk_bf16_f32 v124, v124, v124
    v_lshlrev_b32 v124, 16, v124
    v_mul_f32 v18, 0xbfb8aa3b, v125
    v_exp_f32 v18, v18
    s_nop 0
    v_add_f32 v18, 1.0, v18
    v_rcp_f32 v18, v18
    s_nop 0
    v_mul_f32 v125, v125, v18
    v_cvt_pk_bf16_f32 v125, v125, v125
    v_lshlrev_b32 v125, 16, v125
    v_mul_f32 v18, 0xbfb8aa3b, v126
    v_exp_f32 v18, v18
    s_nop 0
    v_add_f32 v18, 1.0, v18
    v_rcp_f32 v18, v18
    s_nop 0
    v_mul_f32 v126, v126, v18
    v_cvt_pk_bf16_f32 v126, v126, v126
    v_lshlrev_b32 v126, 16, v126
    v_mul_f32 v18, 0xbfb8aa3b, v127
    v_exp_f32 v18, v18
    s_nop 0
    v_add_f32 v18, 1.0, v18
    v_rcp_f32 v18, v18
    s_nop 0
    v_mul_f32 v127, v127, v18
    v_cvt_pk_bf16_f32 v127, v127, v127
    v_lshlrev_b32 v127, 16, v127
    v_mov_b32 v96, 0
    v_mov_b32 v97, 0
    v_mov_b32 v98, 0
    v_mov_b32 v99, 0
    v_mov_b32 v100, 0
    v_mov_b32 v101, 0
    v_mov_b32 v102, 0
    v_mov_b32 v103, 0
    s_waitcnt vmcnt(15)
    v_lshlrev_b32 v18, 16, v32
    v_and_b32 v19, 0xffff0000, v32
    v_fmac_f32 v96, v18, v112
    v_fmac_f32 v97, v19, v112
    v_lshlrev_b32 v18, 16, v33
    v_and_b32 v19, 0xffff0000, v33
    v_fmac_f32 v98, v18, v112
    v_fmac_f32 v99, v19, v112
    v_lshlrev_b32 v18, 16, v34
    v_and_b32 v19, 0xffff0000, v34
    v_fmac_f32 v100, v18, v112
    v_fmac_f32 v101, v19, v112
    v_lshlrev_b32 v18, 16, v35
    v_and_b32 v19, 0xffff0000, v35
    v_fmac_f32 v102, v18, v112
    v_fmac_f32 v103, v19, v112
    s_waitcnt vmcnt(14)
    v_lshlrev_b32 v18, 16, v36
    v_and_b32 v19, 0xffff0000, v36
    v_fmac_f32 v96, v18, v113
    v_fmac_f32 v97, v19, v113
    v_lshlrev_b32 v18, 16, v37
    v_and_b32 v19, 0xffff0000, v37
    v_fmac_f32 v98, v18, v113
    v_fmac_f32 v99, v19, v113
    v_lshlrev_b32 v18, 16, v38
    v_and_b32 v19, 0xffff0000, v38
    v_fmac_f32 v100, v18, v113
    v_fmac_f32 v101, v19, v113
    v_lshlrev_b32 v18, 16, v39
    v_and_b32 v19, 0xffff0000, v39
    v_fmac_f32 v102, v18, v113
    v_fmac_f32 v103, v19, v113
    s_waitcnt vmcnt(13)
    v_lshlrev_b32 v18, 16, v40
    v_and_b32 v19, 0xffff0000, v40
    v_fmac_f32 v96, v18, v114
    v_fmac_f32 v97, v19, v114
    v_lshlrev_b32 v18, 16, v41
    v_and_b32 v19, 0xffff0000, v41
    v_fmac_f32 v98, v18, v114
    v_fmac_f32 v99, v19, v114
    v_lshlrev_b32 v18, 16, v42
    v_and_b32 v19, 0xffff0000, v42
    v_fmac_f32 v100, v18, v114
    v_fmac_f32 v101, v19, v114
    v_lshlrev_b32 v18, 16, v43
    v_and_b32 v19, 0xffff0000, v43
    v_fmac_f32 v102, v18, v114
    v_fmac_f32 v103, v19, v114
    s_waitcnt vmcnt(12)
    v_lshlrev_b32 v18, 16, v44
    v_and_b32 v19, 0xffff0000, v44
    v_fmac_f32 v96, v18, v115
    v_fmac_f32 v97, v19, v115
    v_lshlrev_b32 v18, 16, v45
    v_and_b32 v19, 0xffff0000, v45
    v_fmac_f32 v98, v18, v115
    v_fmac_f32 v99, v19, v115
    v_lshlrev_b32 v18, 16, v46
    v_and_b32 v19, 0xffff0000, v46
    v_fmac_f32 v100, v18, v115
    v_fmac_f32 v101, v19, v115
    v_lshlrev_b32 v18, 16, v47
    v_and_b32 v19, 0xffff0000, v47
    v_fmac_f32 v102, v18, v115
    v_fmac_f32 v103, v19, v115
    s_waitcnt vmcnt(11)
    v_lshlrev_b32 v18, 16, v48
    v_and_b32 v19, 0xffff0000, v48
    v_fmac_f32 v96, v18, v116
    v_fmac_f32 v97, v19, v116
    v_lshlrev_b32 v18, 16, v49
    v_and_b32 v19, 0xffff0000, v49
    v_fmac_f32 v98, v18, v116
    v_fmac_f32 v99, v19, v116
    v_lshlrev_b32 v18, 16, v50
    v_and_b32 v19, 0xffff0000, v50
    v_fmac_f32 v100, v18, v116
    v_fmac_f32 v101, v19, v116
    v_lshlrev_b32 v18, 16, v51
    v_and_b32 v19, 0xffff0000, v51
    v_fmac_f32 v102, v18, v116
    v_fmac_f32 v103, v19, v116
    s_waitcnt vmcnt(10)
    v_lshlrev_b32 v18, 16, v52
    v_and_b32 v19, 0xffff0000, v52
    v_fmac_f32 v96, v18, v117
    v_fmac_f32 v97, v19, v117
    v_lshlrev_b32 v18, 16, v53
    v_and_b32 v19, 0xffff0000, v53
    v_fmac_f32 v98, v18, v117
    v_fmac_f32 v99, v19, v117
    v_lshlrev_b32 v18, 16, v54
    v_and_b32 v19, 0xffff0000, v54
    v_fmac_f32 v100, v18, v117
    v_fmac_f32 v101, v19, v117
    v_lshlrev_b32 v18, 16, v55
    v_and_b32 v19, 0xffff0000, v55
    v_fmac_f32 v102, v18, v117
    v_fmac_f32 v103, v19, v117
    s_waitcnt vmcnt(9)
    v_lshlrev_b32 v18, 16, v56
    v_and_b32 v19, 0xffff0000, v56
    v_fmac_f32 v96, v18, v118
    v_fmac_f32 v97, v19, v118
    v_lshlrev_b32 v18, 16, v57
    v_and_b32 v19, 0xffff0000, v57
    v_fmac_f32 v98, v18, v118
    v_fmac_f32 v99, v19, v118
    v_lshlrev_b32 v18, 16, v58
    v_and_b32 v19, 0xffff0000, v58
    v_fmac_f32 v100, v18, v118
    v_fmac_f32 v101, v19, v118
    v_lshlrev_b32 v18, 16, v59
    v_and_b32 v19, 0xffff0000, v59
    v_fmac_f32 v102, v18, v118
    v_fmac_f32 v103, v19, v118
    s_waitcnt vmcnt(8)
    v_lshlrev_b32 v18, 16, v60
    v_and_b32 v19, 0xffff0000, v60
    v_fmac_f32 v96, v18, v119
    v_fmac_f32 v97, v19, v119
    v_lshlrev_b32 v18, 16, v61
    v_and_b32 v19, 0xffff0000, v61
    v_fmac_f32 v98, v18, v119
    v_fmac_f32 v99, v19, v119
    v_lshlrev_b32 v18, 16, v62
    v_and_b32 v19, 0xffff0000, v62
    v_fmac_f32 v100, v18, v119
    v_fmac_f32 v101, v19, v119
    v_lshlrev_b32 v18, 16, v63
    v_and_b32 v19, 0xffff0000, v63
    v_fmac_f32 v102, v18, v119
    v_fmac_f32 v103, v19, v119
    s_waitcnt vmcnt(7)
    v_lshlrev_b32 v18, 16, v64
    v_and_b32 v19, 0xffff0000, v64
    v_fmac_f32 v96, v18, v120
    v_fmac_f32 v97, v19, v120
    v_lshlrev_b32 v18, 16, v65
    v_and_b32 v19, 0xffff0000, v65
    v_fmac_f32 v98, v18, v120
    v_fmac_f32 v99, v19, v120
    v_lshlrev_b32 v18, 16, v66
    v_and_b32 v19, 0xffff0000, v66
    v_fmac_f32 v100, v18, v120
    v_fmac_f32 v101, v19, v120
    v_lshlrev_b32 v18, 16, v67
    v_and_b32 v19, 0xffff0000, v67
    v_fmac_f32 v102, v18, v120
    v_fmac_f32 v103, v19, v120
    s_waitcnt vmcnt(6)
    v_lshlrev_b32 v18, 16, v68
    v_and_b32 v19, 0xffff0000, v68
    v_fmac_f32 v96, v18, v121
    v_fmac_f32 v97, v19, v121
    v_lshlrev_b32 v18, 16, v69
    v_and_b32 v19, 0xffff0000, v69
    v_fmac_f32 v98, v18, v121
    v_fmac_f32 v99, v19, v121
    v_lshlrev_b32 v18, 16, v70
    v_and_b32 v19, 0xffff0000, v70
    v_fmac_f32 v100, v18, v121
    v_fmac_f32 v101, v19, v121
    v_lshlrev_b32 v18, 16, v71
    v_and_b32 v19, 0xffff0000, v71
    v_fmac_f32 v102, v18, v121
    v_fmac_f32 v103, v19, v121
    s_waitcnt vmcnt(5)
    v_lshlrev_b32 v18, 16, v72
    v_and_b32 v19, 0xffff0000, v72
    v_fmac_f32 v96, v18, v122
    v_fmac_f32 v97, v19, v122
    v_lshlrev_b32 v18, 16, v73
    v_and_b32 v19, 0xffff0000, v73
    v_fmac_f32 v98, v18, v122
    v_fmac_f32 v99, v19, v122
    v_lshlrev_b32 v18, 16, v74
    v_and_b32 v19, 0xffff0000, v74
    v_fmac_f32 v100, v18, v122
    v_fmac_f32 v101, v19, v122
    v_lshlrev_b32 v18, 16, v75
    v_and_b32 v19, 0xffff0000, v75
    v_fmac_f32 v102, v18, v122
    v_fmac_f32 v103, v19, v122
    s_waitcnt vmcnt(4)
    v_lshlrev_b32 v18, 16, v76
    v_and_b32 v19, 0xffff0000, v76
    v_fmac_f32 v96, v18, v123
    v_fmac_f32 v97, v19, v123
    v_lshlrev_b32 v18, 16, v77
    v_and_b32 v19, 0xffff0000, v77
    v_fmac_f32 v98, v18, v123
    v_fmac_f32 v99, v19, v123
    v_lshlrev_b32 v18, 16, v78
    v_and_b32 v19, 0xffff0000, v78
    v_fmac_f32 v100, v18, v123
    v_fmac_f32 v101, v19, v123
    v_lshlrev_b32 v18, 16, v79
    v_and_b32 v19, 0xffff0000, v79
    v_fmac_f32 v102, v18, v123
    v_fmac_f32 v103, v19, v123
    s_waitcnt vmcnt(3)
    v_lshlrev_b32 v18, 16, v80
    v_and_b32 v19, 0xffff0000, v80
    v_fmac_f32 v96, v18, v124
    v_fmac_f32 v97, v19, v124
    v_lshlrev_b32 v18, 16, v81
    v_and_b32 v19, 0xffff0000, v81
    v_fmac_f32 v98, v18, v124
    v_fmac_f32 v99, v19, v124
    v_lshlrev_b32 v18, 16, v82
    v_and_b32 v19, 0xffff0000, v82
    v_fmac_f32 v100, v18, v124
    v_fmac_f32 v101, v19, v124
    v_lshlrev_b32 v18, 16, v83
    v_and_b32 v19, 0xffff0000, v83
    v_fmac_f32 v102, v18, v124
    v_fmac_f32 v103, v19, v124
    s_waitcnt vmcnt(2)
    v_lshlrev_b32 v18, 16, v84
    v_and_b32 v19, 0xffff0000, v84
    v_fmac_f32 v96, v18, v125
    v_fmac_f32 v97, v19, v125
    v_lshlrev_b32 v18, 16, v85
    v_and_b32 v19, 0xffff0000, v85
    v_fmac_f32 v98, v18, v125
    v_fmac_f32 v99, v19, v125
    v_lshlrev_b32 v18, 16, v86
    v_and_b32 v19, 0xffff0000, v86
    v_fmac_f32 v100, v18, v125
    v_fmac_f32 v101, v19, v125
    v_lshlrev_b32 v18, 16, v87
    v_and_b32 v19, 0xffff0000, v87
    v_fmac_f32 v102, v18, v125
    v_fmac_f32 v103, v19, v125
    s_waitcnt vmcnt(1)
    v_lshlrev_b32 v18, 16, v88
    v_and_b32 v19, 0xffff0000, v88
    v_fmac_f32 v96, v18, v126
    v_fmac_f32 v97, v19, v126
    v_lshlrev_b32 v18, 16, v89
    v_and_b32 v19, 0xffff0000, v89
    v_fmac_f32 v98, v18, v126
    v_fmac_f32 v99, v19, v126
    v_lshlrev_b32 v18, 16, v90
    v_and_b32 v19, 0xffff0000, v90
    v_fmac_f32 v100, v18, v126
    v_fmac_f32 v101, v19, v126
    v_lshlrev_b32 v18, 16, v91
    v_and_b32 v19, 0xffff0000, v91
    v_fmac_f32 v102, v18, v126
    v_fmac_f32 v103, v19, v126
    s_waitcnt vmcnt(0)
    v_lshlrev_b32 v18, 16, v92
    v_and_b32 v19, 0xffff0000, v92
    v_fmac_f32 v96, v18, v127
    v_fmac_f32 v97, v19, v127
    v_lshlrev_b32 v18, 16, v93
    v_and_b32 v19, 0xffff0000, v93
    v_fmac_f32 v98, v18, v127
    v_fmac_f32 v99, v19, v127
    v_lshlrev_b32 v18, 16, v94
    v_and_b32 v19, 0xffff0000, v94
    v_fmac_f32 v100, v18, v127
    v_fmac_f32 v101, v19, v127
    v_lshlrev_b32 v18, 16, v95
    v_and_b32 v19, 0xffff0000, v95
    v_fmac_f32 v102, v18, v127
    v_fmac_f32 v103, v19, v127
    v_lshlrev_b32 v16, 5, v0
    ds_write_b128 v16, v[96:99]
    ds_write_b128 v16, v[100:103] offset:16
    s_waitcnt lgkmcnt(0)
    s_barrier
    s_cmp_lg_u32 s44, 0
    s_cbranch_scc1 L_mod_fin_34
    v_and_b32 v16, 31, v1
    v_lshlrev_b32 v16, 2, v16
    v_lshrrev_b32 v17, 5, v1
    v_lshlrev_b32 v17, 12, v17
    v_add_u32 v17, v17, v16
    v_mov_b32 v18, 0
    ds_read_b32 v32, v17 offset:0
    ds_read_b32 v33, v17 offset:128
    ds_read_b32 v34, v17 offset:256
    ds_read_b32 v35, v17 offset:384
    ds_read_b32 v36, v17 offset:512
    ds_read_b32 v37, v17 offset:640
    ds_read_b32 v38, v17 offset:768
    ds_read_b32 v39, v17 offset:896
    ds_read_b32 v40, v17 offset:1024
    ds_read_b32 v41, v17 offset:1152
    ds_read_b32 v42, v17 offset:1280
    ds_read_b32 v43, v17 offset:1408
    ds_read_b32 v44, v17 offset:1536
    ds_read_b32 v45, v17 offset:1664
    ds_read_b32 v46, v17 offset:1792
    ds_read_b32 v47, v17 offset:1920
    s_waitcnt lgkmcnt(0)
    v_add_f32 v18, v18, v32
    v_add_f32 v18, v18, v33
    v_add_f32 v18, v18, v34
    v_add_f32 v18, v18, v35
    v_add_f32 v18, v18, v36
    v_add_f32 v18, v18, v37
    v_add_f32 v18, v18, v38
    v_add_f32 v18, v18, v39
    v_add_f32 v18, v18, v40
    v_add_f32 v18, v18, v41
    v_add_f32 v18, v18, v42
    v_add_f32 v18, v18, v43
    v_add_f32 v18, v18, v44
    v_add_f32 v18, v18, v45
    v_add_f32 v18, v18, v46
    v_add_f32 v18, v18, v47
    ds_read_b32 v32, v17 offset:2048
    ds_read_b32 v33, v17 offset:2176
    ds_read_b32 v34, v17 offset:2304
    ds_read_b32 v35, v17 offset:2432
    ds_read_b32 v36, v17 offset:2560
    ds_read_b32 v37, v17 offset:2688
    ds_read_b32 v38, v17 offset:2816
    ds_read_b32 v39, v17 offset:2944
    ds_read_b32 v40, v17 offset:3072
    ds_read_b32 v41, v17 offset:3200
    ds_read_b32 v42, v17 offset:3328
    ds_read_b32 v43, v17 offset:3456
    ds_read_b32 v44, v17 offset:3584
    ds_read_b32 v45, v17 offset:3712
    ds_read_b32 v46, v17 offset:3840
    ds_read_b32 v47, v17 offset:3968
    s_waitcnt lgkmcnt(0)
    v_add_f32 v18, v18, v32
    v_add_f32 v18, v18, v33
    v_add_f32 v18, v18, v34
    v_add_f32 v18, v18, v35
    v_add_f32 v18, v18, v36
    v_add_f32 v18, v18, v37
    v_add_f32 v18, v18, v38
    v_add_f32 v18, v18, v39
    v_add_f32 v18, v18, v40
    v_add_f32 v18, v18, v41
    v_add_f32 v18, v18, v42
    v_add_f32 v18, v18, v43
    v_add_f32 v18, v18, v44
    v_add_f32 v18, v18, v45
    v_add_f32 v18, v18, v46
    v_add_f32 v18, v18, v47
    v_mov_b32 v19, v18
    s_nop 1
    v_permlane32_swap_b32 v18, v19
    v_add_f32 v18, v18, v19
    v_cvt_pk_bf16_f32 v18, v18, v18
    v_lshlrev_b32 v18, 16, v18
    s_lshl_b32 s45, s39, 7
    s_mov_b32 exec_hi, 0
    buffer_store_dword v18, v16, s[12:15], s45 offen sc1
    s_mov_b64 exec, -1
L_mod_fin_34:
    s_waitcnt vmcnt(0)
    s_barrier
    s_cmp_lg_u32 s44, 0
    s_cbranch_scc1 L_cnt_35
    v_mov_b32 v30, 1
    v_mov_b32 v31, 0
    s_mov_b64 exec, 1
    buffer_atomic_add v30, v31, s[16:19], 0 offen offset:128 sc1
    s_mov_b64 exec, -1
L_cnt_35:
    s_lshl_b32 s45, s43, 3
    s_add_u32 s45, s45, 16
    s_load_dwordx2 s[6:7], s[0:1], s45
    s_load_dwordx2 s[4:5], s[0:1], 0
    s_waitcnt lgkmcnt(0)
    s_mov_b32 s24, s6
    s_and_b32 s25, s7, 0xffff
    s_mov_b32 s26, 0x800000
    s_mov_b32 s27, 0x00020000
    s_mov_b32 s28, s4
    s_and_b32 s29, s5, 0xffff
    s_mov_b32 s30, 0x400000
    s_mov_b32 s31, 0x00020000
    s_lshl_b32 s46, s41, 8
    s_waitcnt vmcnt(0)
    s_barrier
    v_lshrrev_b32 v20, 4, v1
    s_lshl_b32 s45, s44, 2
    v_add_u32 v21, s45, v20
    s_mov_b32 s45, 8192
    v_mul_lo_u32 v21, v21, s45
    v_lshlrev_b32 v22, 2, v20
    v_and_b32 v23, 15, v1
    v_xor_b32 v22, v22, v23
    v_lshlrev_b32 v22, 4, v22
    v_add_u32 v21, v21, v22
    v_bfe_u32 v22, v1, 2, 2
    v_lshrrev_b32 v23, 5, v1
    v_lshlrev_b32 v23, 3, v23
    v_add_u32 v23, v23, v22
    v_lshlrev_b32 v23, 8, v23
    v_xor_b32 v22, s44, v22
    v_lshlrev_b32 v22, 6, v22
    v_add_u32 v23, v23, v22
    v_and_b32 v22, 1, v1
    v_lshlrev_b32 v22, 5, v22
    v_add_u32 v23, v23, v22
    v_and_b32 v22, 16, v1
    v_add_u32 v23, v23, v22
    v_and_b32 v22, 2, v1
    v_lshlrev_b32 v22, 2, v22
    v_add_u32 v23, v23, v22
    v_add_u32 v24, 65536, v23
    v_add_u32 v25, 131072, v23
    s_lshl_b32 s47, s44, 10
    s_add_u32 s45, s46, 0x0
    s_add_u32 m0, s47, 0
    s_nop 0
    buffer_load_dwordx4 v21, s[24:27], s45 offen lds
    s_add_u32 s45, s46, 0x20000
    s_add_u32 m0, s47, 4096
    s_nop 0
    buffer_load_dwordx4 v21, s[24:27], s45 offen lds
    s_add_u32 s45, s46, 0x40000
    s_add_u32 m0, s47, 8192
    s_nop 0
    buffer_load_dwordx4 v21, s[24:27], s45 offen lds
    s_add_u32 s45, s46, 0x60000
    s_add_u32 m0, s47, 12288
    s_nop 0
    buffer_load_dwordx4 v21, s[24:27], s45 offen lds
    s_add_u32 s45, s46, 0x80000
    s_add_u32 m0, s47, 16384
    s_nop 0
    buffer_load_dwordx4 v21, s[24:27], s45 offen lds
    s_add_u32 s45, s46, 0xa0000
    s_add_u32 m0, s47, 20480
    s_nop 0
    buffer_load_dwordx4 v21, s[24:27], s45 offen lds
    s_add_u32 s45, s46, 0xc0000
    s_add_u32 m0, s47, 24576
    s_nop 0
    buffer_load_dwordx4 v21, s[24:27], s45 offen lds
    s_add_u32 s45, s46, 0xe0000
    s_add_u32 m0, s47, 28672
    s_nop 0
    buffer_load_dwordx4 v21, s[24:27], s45 offen lds
    s_add_u32 s45, s46, 0x100000
    s_add_u32 m0, s47, 32768
    s_nop 0
    buffer_load_dwordx4 v21, s[24:27], s45 offen lds
    s_add_u32 s45, s46, 0x120000
    s_add_u32 m0, s47, 36864
    s_nop 0
    buffer_load_dwordx4 v21, s[24:27], s45 offen lds
    s_add_u32 s45, s46, 0x140000
    s_add_u32 m0, s47, 40960
    s_nop 0
    buffer_load_dwordx4 v21, s[24:27], s45 offen lds
    s_add_u32 s45, s46, 0x160000
    s_add_u32 m0, s47, 45056
    s_nop 0
    buffer_load_dwordx4 v21, s[24:27], s45 offen lds
    s_add_u32 s45, s46, 0x180000
    s_add_u32 m0, s47, 49152
    s_nop 0
    buffer_load_dwordx4 v21, s[24:27], s45 offen lds
    s_add_u32 s45, s46, 0x1a0000
    s_add_u32 m0, s47, 53248
    s_nop 0
    buffer_load_dwordx4 v21, s[24:27], s45 offen lds
    s_add_u32 s45, s46, 0x1c0000
    s_add_u32 m0, s47, 57344
    s_nop 0
    buffer_load_dwordx4 v21, s[24:27], s45 offen lds
    s_add_u32 s45, s46, 0x1e0000
    s_add_u32 m0, s47, 61440
    s_nop 0
    buffer_load_dwordx4 v21, s[24:27], s45 offen lds
    s_add_u32 s45, s46, 0x200000
    s_add_u32 m0, s47, 65536
    s_nop 0
    buffer_load_dwordx4 v21, s[24:27], s45 offen lds
    s_add_u32 s45, s46, 0x220000
    s_add_u32 m0, s47, 69632
    s_nop 0
    buffer_load_dwordx4 v21, s[24:27], s45 offen lds
    s_add_u32 s45, s46, 0x240000
    s_add_u32 m0, s47, 73728
    s_nop 0
    buffer_load_dwordx4 v21, s[24:27], s45 offen lds
    s_add_u32 s45, s46, 0x260000
    s_add_u32 m0, s47, 77824
    s_nop 0
    buffer_load_dwordx4 v21, s[24:27], s45 offen lds
    s_add_u32 s45, s46, 0x280000
    s_add_u32 m0, s47, 81920
    s_nop 0
    buffer_load_dwordx4 v21, s[24:27], s45 offen lds
    s_add_u32 s45, s46, 0x2a0000
    s_add_u32 m0, s47, 86016
    s_nop 0
    buffer_load_dwordx4 v21, s[24:27], s45 offen lds
    s_add_u32 s45, s46, 0x2c0000
    s_add_u32 m0, s47, 90112
    s_nop 0
    buffer_load_dwordx4 v21, s[24:27], s45 offen lds
    s_add_u32 s45, s46, 0x2e0000
    s_add_u32 m0, s47, 94208
    s_nop 0
    buffer_load_dwordx4 v21, s[24:27], s45 offen lds
    s_add_u32 s45, s46, 0x300000
    s_add_u32 m0, s47, 98304
    s_nop 0
    buffer_load_dwordx4 v21, s[24:27], s45 offen lds
    s_add_u32 s45, s46, 0x320000
    s_add_u32 m0, s47, 102400
    s_nop 0
    buffer_load_dwordx4 v21, s[24:27], s45 offen lds
    s_add_u32 s45, s46, 0x340000
    s_add_u32 m0, s47, 106496
    s_nop 0
    buffer_load_dwordx4 v21, s[24:27], s45 offen lds
    s_add_u32 s45, s46, 0x360000
    s_add_u32 m0, s47, 110592
    s_nop 0
    buffer_load_dwordx4 v21, s[24:27], s45 offen lds
    s_add_u32 s45, s46, 0x380000
    s_add_u32 m0, s47, 114688
    s_nop 0
    buffer_load_dwordx4 v21, s[24:27], s45 offen lds
    s_add_u32 s45, s46, 0x3a0000
    s_add_u32 m0, s47, 118784
    s_nop 0
    buffer_load_dwordx4 v21, s[24:27], s45 offen lds
    s_add_u32 s45, s46, 0x3c0000
    s_add_u32 m0, s47, 122880
    s_nop 0
    buffer_load_dwordx4 v21, s[24:27], s45 offen lds
    s_add_u32 s45, s46, 0x3e0000
    s_add_u32 m0, s47, 126976
    s_nop 0
    buffer_load_dwordx4 v21, s[24:27], s45 offen lds
    s_waitcnt vmcnt(28)
    s_barrier
    s_add_u32 s45, s46, 0x400000
    s_add_u32 m0, s47, 131072
    s_nop 0
    buffer_load_dwordx4 v21, s[24:27], s45 offen lds
    s_add_u32 s45, s46, 0x420000
    s_add_u32 m0, s47, 135168
    s_nop 0
    buffer_load_dwordx4 v21, s[24:27], s45 offen lds
    s_add_u32 s45, s46, 0x440000
    s_add_u32 m0, s47, 139264
    s_nop 0
    buffer_load_dwordx4 v21, s[24:27], s45 offen lds
    s_add_u32 s45, s46, 0x460000
    s_add_u32 m0, s47, 143360
    s_nop 0
    buffer_load_dwordx4 v21, s[24:27], s45 offen lds
    ds_read_b64_tr_b16 a[0:1], v23 offset:0
    ds_read_b64_tr_b16 a[2:3], v23 offset:1024
    ds_read_b64_tr_b16 a[4:5], v23 offset:4096
    ds_read_b64_tr_b16 a[6:7], v23 offset:5120
    ds_read_b64_tr_b16 a[8:9], v23 offset:8192
    ds_read_b64_tr_b16 a[10:11], v23 offset:9216
    ds_read_b64_tr_b16 a[12:13], v23 offset:12288
    ds_read_b64_tr_b16 a[14:15], v23 offset:13312
    s_waitcnt lgkmcnt(0)
    s_waitcnt vmcnt(28)
    s_barrier
    s_add_u32 s45, s46, 0x480000
    s_add_u32 m0, s47, 0
    s_nop 0
    buffer_load_dwordx4 v21, s[24:27], s45 offen lds
    s_add_u32 s45, s46, 0x4a0000
    s_add_u32 m0, s47, 4096
    s_nop 0
    buffer_load_dwordx4 v21, s[24:27], s45 offen lds
    s_add_u32 s45, s46, 0x4c0000
    s_add_u32 m0, s47, 8192
    s_nop 0
    buffer_load_dwordx4 v21, s[24:27], s45 offen lds
    s_add_u32 s45, s46, 0x4e0000
    s_add_u32 m0, s47, 12288
    s_nop 0
    buffer_load_dwordx4 v21, s[24:27], s45 offen lds
    ds_read_b64_tr_b16 a[16:17], v23 offset:16384
    ds_read_b64_tr_b16 a[18:19], v23 offset:17408
    ds_read_b64_tr_b16 a[20:21], v23 offset:20480
    ds_read_b64_tr_b16 a[22:23], v23 offset:21504
    ds_read_b64_tr_b16 a[24:25], v23 offset:24576
    ds_read_b64_tr_b16 a[26:27], v23 offset:25600
    ds_read_b64_tr_b16 a[28:29], v23 offset:28672
    ds_read_b64_tr_b16 a[30:31], v23 offset:29696
    s_waitcnt lgkmcnt(0)
    s_waitcnt vmcnt(28)
    s_barrier
    s_add_u32 s45, s46, 0x500000
    s_add_u32 m0, s47, 16384
    s_nop 0
    buffer_load_dwordx4 v21, s[24:27], s45 offen lds
    s_add_u32 s45, s46, 0x520000
    s_add_u32 m0, s47, 20480
    s_nop 0
    buffer_load_dwordx4 v21, s[24:27], s45 offen lds
    s_add_u32 s45, s46, 0x540000
    s_add_u32 m0, s47, 24576
    s_nop 0
    buffer_load_dwordx4 v21, s[24:27], s45 offen lds
    s_add_u32 s45, s46, 0x560000
    s_add_u32 m0, s47, 28672
    s_nop 0
    buffer_load_dwordx4 v21, s[24:27], s45 offen lds
    ds_read_b64_tr_b16 a[32:33], v23 offset:32768
    ds_read_b64_tr_b16 a[34:35], v23 offset:33792
    ds_read_b64_tr_b16 a[36:37], v23 offset:36864
    ds_read_b64_tr_b16 a[38:39], v23 offset:37888
    ds_read_b64_tr_b16 a[40:41], v23 offset:40960
    ds_read_b64_tr_b16 a[42:43], v23 offset:41984
    ds_read_b64_tr_b16 a[44:45], v23 offset:45056
    ds_read_b64_tr_b16 a[46:47], v23 offset:46080
    s_waitcnt lgkmcnt(0)
    s_waitcnt vmcnt(28)
    s_barrier
    s_add_u32 s45, s46, 0x580000
    s_add_u32 m0, s47, 32768
    s_nop 0
    buffer_load_dwordx4 v21, s[24:27], s45 offen lds
    s_add_u32 s45, s46, 0x5a0000
    s_add_u32 m0, s47, 36864
    s_nop 0
    buffer_load_dwordx4 v21, s[24:27], s45 offen lds
    s_add_u32 s45, s46, 0x5c0000
    s_add_u32 m0, s47, 40960
    s_nop 0
    buffer_load_dwordx4 v21, s[24:27], s45 offen lds
    s_add_u32 s45, s46, 0x5e0000
    s_add_u32 m0, s47, 45056
    s_nop 0
    buffer_load_dwordx4 v21, s[24:27], s45 offen lds
    ds_read_b64_tr_b16 a[48:49], v23 offset:49152
    ds_read_b64_tr_b16 a[50:51], v23 offset:50176
    ds_read_b64_tr_b16 a[52:53], v23 offset:53248
    ds_read_b64_tr_b16 a[54:55], v23 offset:54272
    ds_read_b64_tr_b16 a[56:57], v23 offset:57344
    ds_read_b64_tr_b16 a[58:59], v23 offset:58368
    ds_read_b64_tr_b16 a[60:61], v23 offset:61440
    ds_read_b64_tr_b16 a[62:63], v23 offset:62464
    s_waitcnt lgkmcnt(0)
    s_waitcnt vmcnt(28)
    s_barrier
    s_add_u32 s45, s46, 0x600000
    s_add_u32 m0, s47, 49152
    s_nop 0
    buffer_load_dwordx4 v21, s[24:27], s45 offen lds
    s_add_u32 s45, s46, 0x620000
    s_add_u32 m0, s47, 53248
    s_nop 0
    buffer_load_dwordx4 v21, s[24:27], s45 offen lds
    s_add_u32 s45, s46, 0x640000
    s_add_u32 m0, s47, 57344
    s_nop 0
    buffer_load_dwordx4 v21, s[24:27], s45 offen lds
    s_add_u32 s45, s46, 0x660000
    s_add_u32 m0, s47, 61440
    s_nop 0
    buffer_load_dwordx4 v21, s[24:27], s45 offen lds
    ds_read_b64_tr_b16 a[64:65], v24 offset:0
    ds_read_b64_tr_b16 a[66:67], v24 offset:1024
    ds_read_b64_tr_b16 a[68:69], v24 offset:4096
    ds_read_b64_tr_b16 a[70:71], v24 offset:5120
    ds_read_b64_tr_b16 a[72:73], v24 offset:8192
    ds_read_b64_tr_b16 a[74:75], v24 offset:9216
    ds_read_b64_tr_b16 a[76:77], v24 offset:12288
    ds_read_b64_tr_b16 a[78:79], v24 offset:13312
    s_waitcnt lgkmcnt(0)
    s_waitcnt vmcnt(28)
    s_barrier
    s_add_u32 s45, s46, 0x680000
    s_add_u32 m0, s47, 65536
    s_nop 0
    buffer_load_dwordx4 v21, s[24:27], s45 offen lds
    s_add_u32 s45, s46, 0x6a0000
    s_add_u32 m0, s47, 69632
    s_nop 0
    buffer_load_dwordx4 v21, s[24:27], s45 offen lds
    s_add_u32 s45, s46, 0x6c0000
    s_add_u32 m0, s47, 73728
    s_nop 0
    buffer_load_dwordx4 v21, s[24:27], s45 offen lds
    s_add_u32 s45, s46, 0x6e0000
    s_add_u32 m0, s47, 77824
    s_nop 0
    buffer_load_dwordx4 v21, s[24:27], s45 offen lds
    ds_read_b64_tr_b16 a[80:81], v24 offset:16384
    ds_read_b64_tr_b16 a[82:83], v24 offset:17408
    ds_read_b64_tr_b16 a[84:85], v24 offset:20480
    ds_read_b64_tr_b16 a[86:87], v24 offset:21504
    ds_read_b64_tr_b16 a[88:89], v24 offset:24576
    ds_read_b64_tr_b16 a[90:91], v24 offset:25600
    ds_read_b64_tr_b16 a[92:93], v24 offset:28672
    ds_read_b64_tr_b16 a[94:95], v24 offset:29696
    s_waitcnt lgkmcnt(0)
    s_waitcnt vmcnt(28)
    s_barrier
    s_add_u32 s45, s46, 0x700000
    s_add_u32 m0, s47, 81920
    s_nop 0
    buffer_load_dwordx4 v21, s[24:27], s45 offen lds
    s_add_u32 s45, s46, 0x720000
    s_add_u32 m0, s47, 86016
    s_nop 0
    buffer_load_dwordx4 v21, s[24:27], s45 offen lds
    s_add_u32 s45, s46, 0x740000
    s_add_u32 m0, s47, 90112
    s_nop 0
    buffer_load_dwordx4 v21, s[24:27], s45 offen lds
    s_add_u32 s45, s46, 0x760000
    s_add_u32 m0, s47, 94208
    s_nop 0
    buffer_load_dwordx4 v21, s[24:27], s45 offen lds
    ds_read_b64_tr_b16 a[96:97], v24 offset:32768
    ds_read_b64_tr_b16 a[98:99], v24 offset:33792
    ds_read_b64_tr_b16 a[100:101], v24 offset:36864
    ds_read_b64_tr_b16 a[102:103], v24 offset:37888
    ds_read_b64_tr_b16 a[104:105], v24 offset:40960
    ds_read_b64_tr_b16 a[106:107], v24 offset:41984
    ds_read_b64_tr_b16 a[108:109], v24 offset:45056
    ds_read_b64_tr_b16 a[110:111], v24 offset:46080
    s_waitcnt lgkmcnt(0)
    s_waitcnt vmcnt(28)
    s_barrier
    s_add_u32 s45, s46, 0x780000
    s_add_u32 m0, s47, 98304
    s_nop 0
    buffer_load_dwordx4 v21, s[24:27], s45 offen lds
    s_add_u32 s45, s46, 0x7a0000
    s_add_u32 m0, s47, 102400
    s_nop 0
    buffer_load_dwordx4 v21, s[24:27], s45 offen lds
    s_add_u32 s45, s46, 0x7c0000
    s_add_u32 m0, s47, 106496
    s_nop 0
    buffer_load_dwordx4 v21, s[24:27], s45 offen lds
    s_add_u32 s45, s46, 0x7e0000
    s_add_u32 m0, s47, 110592
    s_nop 0
    buffer_load_dwordx4 v21, s[24:27], s45 offen lds
    ds_read_b64_tr_b16 a[112:113], v24 offset:49152
    ds_read_b64_tr_b16 a[114:115], v24 offset:50176
    ds_read_b64_tr_b16 a[116:117], v24 offset:53248
    ds_read_b64_tr_b16 a[118:119], v24 offset:54272
    ds_read_b64_tr_b16 a[120:121], v24 offset:57344
    ds_read_b64_tr_b16 a[122:123], v24 offset:58368
    ds_read_b64_tr_b16 a[124:125], v24 offset:61440
    ds_read_b64_tr_b16 a[126:127], v24 offset:62464
    s_waitcnt lgkmcnt(0)
    s_waitcnt vmcnt(28)
    s_barrier
    ds_read_b64_tr_b16 a[128:129], v25 offset:0
    ds_read_b64_tr_b16 a[130:131], v25 offset:1024
    ds_read_b64_tr_b16 a[132:133], v25 offset:4096
    ds_read_b64_tr_b16 a[134:135], v25 offset:5120
    ds_read_b64_tr_b16 a[136:137], v25 offset:8192
    ds_read_b64_tr_b16 a[138:139], v25 offset:9216
    ds_read_b64_tr_b16 a[140:141], v25 offset:12288
    ds_read_b64_tr_b16 a[142:143], v25 offset:13312
    s_waitcnt lgkmcnt(0)
    s_waitcnt vmcnt(24)
    s_barrier
    ds_read_b64_tr_b16 a[144:145], v23 offset:0
    ds_read_b64_tr_b16 a[146:147], v23 offset:1024
    ds_read_b64_tr_b16 a[148:149], v23 offset:4096
    ds_read_b64_tr_b16 a[150:151], v23 offset:5120
    ds_read_b64_tr_b16 a[152:153], v23 offset:8192
    ds_read_b64_tr_b16 a[154:155], v23 offset:9216
    ds_read_b64_tr_b16 a[156:157], v23 offset:12288
    ds_read_b64_tr_b16 a[158:159], v23 offset:13312
    s_waitcnt lgkmcnt(0)
    s_waitcnt vmcnt(20)
    s_barrier
    ds_read_b64_tr_b16 a[160:161], v23 offset:16384
    ds_read_b64_tr_b16 a[162:163], v23 offset:17408
    ds_read_b64_tr_b16 a[164:165], v23 offset:20480
    ds_read_b64_tr_b16 a[166:167], v23 offset:21504
    ds_read_b64_tr_b16 a[168:169], v23 offset:24576
    ds_read_b64_tr_b16 a[170:171], v23 offset:25600
    ds_read_b64_tr_b16 a[172:173], v23 offset:28672
    ds_read_b64_tr_b16 a[174:175], v23 offset:29696
    s_waitcnt lgkmcnt(0)
    s_waitcnt vmcnt(16)
    s_barrier
    ds_read_b64_tr_b16 a[176:177], v23 offset:32768
    ds_read_b64_tr_b16 a[178:179], v23 offset:33792
    ds_read_b64_tr_b16 a[180:181], v23 offset:36864
    ds_read_b64_tr_b16 a[182:183], v23 offset:37888
    ds_read_b64_tr_b16 a[184:185], v23 offset:40960
    ds_read_b64_tr_b16 a[186:187], v23 offset:41984
    ds_read_b64_tr_b16 a[188:189], v23 offset:45056
    ds_read_b64_tr_b16 a[190:191], v23 offset:46080
    s_waitcnt lgkmcnt(0)
    s_waitcnt vmcnt(12)
    s_barrier
    ds_read_b64_tr_b16 a[192:193], v23 offset:49152
    ds_read_b64_tr_b16 a[194:195], v23 offset:50176
    ds_read_b64_tr_b16 a[196:197], v23 offset:53248
    ds_read_b64_tr_b16 a[198:199], v23 offset:54272
    ds_read_b64_tr_b16 a[200:201], v23 offset:57344
    ds_read_b64_tr_b16 a[202:203], v23 offset:58368
    ds_read_b64_tr_b16 a[204:205], v23 offset:61440
    ds_read_b64_tr_b16 a[206:207], v23 offset:62464
    s_waitcnt lgkmcnt(0)
    s_waitcnt vmcnt(8)
    s_barrier
    ds_read_b64_tr_b16 a[208:209], v24 offset:0
    ds_read_b64_tr_b16 a[210:211], v24 offset:1024
    ds_read_b64_tr_b16 a[212:213], v24 offset:4096
    ds_read_b64_tr_b16 a[214:215], v24 offset:5120
    ds_read_b64_tr_b16 a[216:217], v24 offset:8192
    ds_read_b64_tr_b16 a[218:219], v24 offset:9216
    ds_read_b64_tr_b16 a[220:221], v24 offset:12288
    ds_read_b64_tr_b16 a[222:223], v24 offset:13312
    s_waitcnt lgkmcnt(0)
    s_waitcnt vmcnt(4)
    s_barrier
    ds_read_b64_tr_b16 a[224:225], v24 offset:16384
    ds_read_b64_tr_b16 a[226:227], v24 offset:17408
    ds_read_b64_tr_b16 a[228:229], v24 offset:20480
    ds_read_b64_tr_b16 a[230:231], v24 offset:21504
    ds_read_b64_tr_b16 a[232:233], v24 offset:24576
    ds_read_b64_tr_b16 a[234:235], v24 offset:25600
    ds_read_b64_tr_b16 a[236:237], v24 offset:28672
    ds_read_b64_tr_b16 a[238:239], v24 offset:29696
    s_waitcnt lgkmcnt(0)
    s_waitcnt vmcnt(0)
    s_barrier
    ds_read_b64_tr_b16 a[240:241], v24 offset:32768
    ds_read_b64_tr_b16 a[242:243], v24 offset:33792
    ds_read_b64_tr_b16 a[244:245], v24 offset:36864
    ds_read_b64_tr_b16 a[246:247], v24 offset:37888
    ds_read_b64_tr_b16 a[248:249], v24 offset:40960
    ds_read_b64_tr_b16 a[250:251], v24 offset:41984
    ds_read_b64_tr_b16 a[252:253], v24 offset:45056
    ds_read_b64_tr_b16 a[254:255], v24 offset:46080
    s_waitcnt lgkmcnt(0)
    s_barrier
    s_lshl_b32 s63, s39, 2
    s_add_u32 s63, s63, s44
    s_add_u32 s45, s63, 0
    s_lshl_b32 s45, s45, 11
    buffer_load_dwordx4 v[128:131], v10, s[28:31], s45 offen
    buffer_load_dwordx4 v[132:135], v10, s[28:31], s45 offen offset:1024
    s_add_u32 s45, s63, 768
    s_lshl_b32 s45, s45, 11
    buffer_load_dwordx4 v[136:139], v10, s[28:31], s45 offen
    buffer_load_dwordx4 v[140:143], v10, s[28:31], s45 offen offset:1024
    s_add_u32 s45, s63, 1536
    s_lshl_b32 s45, s45, 11
    buffer_load_dwordx4 v[144:147], v10, s[28:31], s45 offen
    buffer_load_dwordx4 v[148:151], v10, s[28:31], s45 offen offset:1024
    v_mov_b32 v29, 128
    s_mov_b32 s46, 192
    s_mov_b64 exec, 1
    s_mov_b32 s70, 0
L_wp_36:
    buffer_load_dword v31, v29, s[16:19], 0 offen sc1
    s_add_u32 s70, s70, 1
    s_cmp_ge_u32 s70, 0x200000
    s_cbranch_scc1 L_w_done_33
    s_waitcnt vmcnt(0)
    v_cmp_gt_u32 vcc, s46, v31
    s_nop 1
    s_cbranch_vccz L_wp_36_ok
    s_sleep 1
    s_branch L_wp_36
L_wp_36_ok:
    s_mov_b64 exec, -1
    v_lshlrev_b32 v29, 5, v1
    s_mov_b32 s45, 0
    buffer_load_dwordx4 v[96:99], v29, s[12:15], s45 offen offset:0 sc1
    buffer_load_dwordx4 v[100:103], v29, s[12:15], s45 offen offset:16 sc1
    buffer_load_dwordx4 v[104:107], v29, s[12:15], s45 offen offset:2048 sc1
    buffer_load_dwordx4 v[108:111], v29, s[12:15], s45 offen offset:2064 sc1
    s_waitcnt vmcnt(0)
    v_lshlrev_b32 v29, 5, v1
    s_mov_b32 s45, 4096
    buffer_load_dwordx4 v[112:115], v29, s[12:15], s45 offen offset:0 sc1
    buffer_load_dwordx4 v[116:119], v29, s[12:15], s45 offen offset:16 sc1
    buffer_load_dwordx4 v[120:123], v29, s[12:15], s45 offen offset:2048 sc1
    buffer_load_dwordx4 v[124:127], v29, s[12:15], s45 offen offset:2064 sc1
    s_waitcnt vmcnt(0)
    v_add_f32 v112, 1.0, v112
    v_cvt_pk_bf16_f32 v112, v112, v112
    v_lshlrev_b32 v112, 16, v112
    v_add_f32 v113, 1.0, v113
    v_cvt_pk_bf16_f32 v113, v113, v113
    v_lshlrev_b32 v113, 16, v113
    v_add_f32 v114, 1.0, v114
    v_cvt_pk_bf16_f32 v114, v114, v114
    v_lshlrev_b32 v114, 16, v114
    v_add_f32 v115, 1.0, v115
    v_cvt_pk_bf16_f32 v115, v115, v115
    v_lshlrev_b32 v115, 16, v115
    v_add_f32 v116, 1.0, v116
    v_cvt_pk_bf16_f32 v116, v116, v116
    v_lshlrev_b32 v116, 16, v116
    v_add_f32 v117, 1.0, v117
    v_cvt_pk_bf16_f32 v117, v117, v117
    v_lshlrev_b32 v117, 16, v117
    v_add_f32 v118, 1.0, v118
    v_cvt_pk_bf16_f32 v118, v118, v118
    v_lshlrev_b32 v118, 16, v118
    v_add_f32 v119, 1.0, v119
    v_cvt_pk_bf16_f32 v119, v119, v119
    v_lshlrev_b32 v119, 16, v119
    v_add_f32 v120, 1.0, v120
    v_cvt_pk_bf16_f32 v120, v120, v120
    v_lshlrev_b32 v120, 16, v120
    v_add_f32 v121, 1.0, v121
    v_cvt_pk_bf16_f32 v121, v121, v121
    v_lshlrev_b32 v121, 16, v121
    v_add_f32 v122, 1.0, v122
    v_cvt_pk_bf16_f32 v122, v122, v122
    v_lshlrev_b32 v122, 16, v122
    v_add_f32 v123, 1.0, v123
    v_cvt_pk_bf16_f32 v123, v123, v123
    v_lshlrev_b32 v123, 16, v123
    v_add_f32 v124, 1.0, v124
    v_cvt_pk_bf16_f32 v124, v124, v124
    v_lshlrev_b32 v124, 16, v124
    v_add_f32 v125, 1.0, v125
    v_cvt_pk_bf16_f32 v125, v125, v125
    v_lshlrev_b32 v125, 16, v125
    v_add_f32 v126, 1.0, v126
    v_cvt_pk_bf16_f32 v126, v126, v126
    v_lshlrev_b32 v126, 16, v126
    v_add_f32 v127, 1.0, v127
    v_cvt_pk_bf16_f32 v127, v127, v127
    v_lshlrev_b32 v127, 16, v127
    v_lshlrev_b32 v64, 16, v128
    v_and_b32 v65, 0xffff0000, v128
    v_lshlrev_b32 v66, 16, v129
    v_and_b32 v67, 0xffff0000, v129
    v_lshlrev_b32 v68, 16, v130
    v_and_b32 v69, 0xffff0000, v130
    v_lshlrev_b32 v70, 16, v131
    v_and_b32 v71, 0xffff0000, v131
    v_lshlrev_b32 v72, 16, v132
    v_and_b32 v73, 0xffff0000, v132
    v_lshlrev_b32 v74, 16, v133
    v_and_b32 v75, 0xffff0000, v133
    v_lshlrev_b32 v76, 16, v134
    v_and_b32 v77, 0xffff0000, v134
    v_lshlrev_b32 v78, 16, v135
    v_and_b32 v79, 0xffff0000, v135
    v_add_f32 v26, v64, v65
    v_add_f32 v26, v26, v66
    v_add_f32 v26, v26, v67
    v_add_f32 v26, v26, v68
    v_add_f32 v26, v26, v69
    v_add_f32 v26, v26, v70
    v_add_f32 v26, v26, v71
    v_add_f32 v26, v26, v72
    v_add_f32 v26, v26, v73
    v_add_f32 v26, v26, v74
    v_add_f32 v26, v26, v75
    v_add_f32 v26, v26, v76
    v_add_f32 v26, v26, v77
    v_add_f32 v26, v26, v78
    v_add_f32 v26, v26, v79
    s_nop 1
    v_add_f32_dpp v26, v26, v26 row_shr:1 row_mask:0xf bank_mask:0xf bound_ctrl:0
    s_nop 1
    v_add_f32_dpp v26, v26, v26 row_shr:2 row_mask:0xf bank_mask:0xf bound_ctrl:0
    s_nop 1
    v_add_f32_dpp v26, v26, v26 row_shr:4 row_mask:0xf bank_mask:0xf bound_ctrl:0
    s_nop 1
    v_add_f32_dpp v26, v26, v26 row_shr:8 row_mask:0xf bank_mask:0xf bound_ctrl:0
    s_nop 1
    v_add_f32_dpp v26, v26, v26 row_bcast:15 row_mask:0xa bank_mask:0xf
    s_nop 1
    v_add_f32_dpp v26, v26, v26 row_bcast:31 row_mask:0xc bank_mask:0xf
    s_nop 1
    v_readlane_b32 s66, v26, 63
    s_nop 1
    v_mov_b32 v27, s66
    v_mul_f32 v27, 0x3a800000, v27
    v_mov_b32 v26, 0
    v_sub_f32 v28, v64, v27
    v_fmac_f32 v26, v28, v28
    v_sub_f32 v28, v65, v27
    v_fmac_f32 v26, v28, v28
    v_sub_f32 v28, v66, v27
    v_fmac_f32 v26, v28, v28
    v_sub_f32 v28, v67, v27
    v_fmac_f32 v26, v28, v28
    v_sub_f32 v28, v68, v27
    v_fmac_f32 v26, v28, v28
    v_sub_f32 v28, v69, v27
    v_fmac_f32 v26, v28, v28
    v_sub_f32 v28, v70, v27
    v_fmac_f32 v26, v28, v28
    v_sub_f32 v28, v71, v27
    v_fmac_f32 v26, v28, v28
    v_sub_f32 v28, v72, v27
    v_fmac_f32 v26, v28, v28
    v_sub_f32 v28, v73, v27
    v_fmac_f32 v26, v28, v28
    v_sub_f32 v28, v74, v27
    v_fmac_f32 v26, v28, v28
    v_sub_f32 v28, v75, v27
    v_fmac_f32 v26, v28, v28
    v_sub_f32 v28, v76, v27
    v_fmac_f32 v26, v28, v28
    v_sub_f32 v28, v77, v27
    v_fmac_f32 v26, v28, v28
    v_sub_f32 v28, v78, v27
    v_fmac_f32 v26, v28, v28
    v_sub_f32 v28, v79, v27
    v_fmac_f32 v26, v28, v28
    s_nop 1
    v_add_f32_dpp v26, v26, v26 row_shr:1 row_mask:0xf bank_mask:0xf bound_ctrl:0
    s_nop 1
    v_add_f32_dpp v26, v26, v26 row_shr:2 row_mask:0xf bank_mask:0xf bound_ctrl:0
    s_nop 1
    v_add_f32_dpp v26, v26, v26 row_shr:4 row_mask:0xf bank_mask:0xf bound_ctrl:0
    s_nop 1
    v_add_f32_dpp v26, v26, v26 row_shr:8 row_mask:0xf bank_mask:0xf bound_ctrl:0
    s_nop 1
    v_add_f32_dpp v26, v26, v26 row_bcast:15 row_mask:0xa bank_mask:0xf
    s_nop 1
    v_add_f32_dpp v26, v26, v26 row_bcast:31 row_mask:0xc bank_mask:0xf
    s_nop 1
    v_readlane_b32 s66, v26, 63
    s_nop 1
    v_mov_b32 v26, s66
    v_mul_f32 v26, 0x3a800000, v26
    v_cvt_pk_bf16_f32 v26, v26, v26
    v_lshlrev_b32 v26, 16, v26
    v_cvt_pk_bf16_f32 v27, v27, v27
    v_lshlrev_b32 v27, 16, v27
    v_add_f32 v26, 0x3727c5ac, v26
    v_cvt_pk_bf16_f32 v26, v26, v26
    v_lshlrev_b32 v26, 16, v26
    v_sqrt_f32 v26, v26
    s_nop 0
    v_cvt_pk_bf16_f32 v26, v26, v26
    v_lshlrev_b32 v26, 16, v26
    v_rcp_f32 v26, v26
    s_nop 0
    v_sub_f32 v64, v64, v27
    v_cvt_pk_bf16_f32 v64, v64, v64
    v_lshlrev_b32 v64, 16, v64
    v_mul_f32 v64, v64, v26
    v_cvt_pk_bf16_f32 v64, v64, v64
    v_lshlrev_b32 v64, 16, v64
    v_mul_f32 v64, v64, v112
    v_cvt_pk_bf16_f32 v64, v64, v64
    v_lshlrev_b32 v64, 16, v64
    v_add_f32 v64, v64, v96
    v_sub_f32 v65, v65, v27
    v_cvt_pk_bf16_f32 v65, v65, v65
    v_lshlrev_b32 v65, 16, v65
    v_mul_f32 v65, v65, v26
    v_cvt_pk_bf16_f32 v65, v65, v65
    v_lshlrev_b32 v65, 16, v65
    v_mul_f32 v65, v65, v113
    v_cvt_pk_bf16_f32 v65, v65, v65
    v_lshlrev_b32 v65, 16, v65
    v_add_f32 v65, v65, v97
    v_sub_f32 v66, v66, v27
    v_cvt_pk_bf16_f32 v66, v66, v66
    v_lshlrev_b32 v66, 16, v66
    v_mul_f32 v66, v66, v26
    v_cvt_pk_bf16_f32 v66, v66, v66
    v_lshlrev_b32 v66, 16, v66
    v_mul_f32 v66, v66, v114
    v_cvt_pk_bf16_f32 v66, v66, v66
    v_lshlrev_b32 v66, 16, v66
    v_add_f32 v66, v66, v98
    v_sub_f32 v67, v67, v27
    v_cvt_pk_bf16_f32 v67, v67, v67
    v_lshlrev_b32 v67, 16, v67
    v_mul_f32 v67, v67, v26
    v_cvt_pk_bf16_f32 v67, v67, v67
    v_lshlrev_b32 v67, 16, v67
    v_mul_f32 v67, v67, v115
    v_cvt_pk_bf16_f32 v67, v67, v67
    v_lshlrev_b32 v67, 16, v67
    v_add_f32 v67, v67, v99
    v_sub_f32 v68, v68, v27
    v_cvt_pk_bf16_f32 v68, v68, v68
    v_lshlrev_b32 v68, 16, v68
    v_mul_f32 v68, v68, v26
    v_cvt_pk_bf16_f32 v68, v68, v68
    v_lshlrev_b32 v68, 16, v68
    v_mul_f32 v68, v68, v116
    v_cvt_pk_bf16_f32 v68, v68, v68
    v_lshlrev_b32 v68, 16, v68
    v_add_f32 v68, v68, v100
    v_sub_f32 v69, v69, v27
    v_cvt_pk_bf16_f32 v69, v69, v69
    v_lshlrev_b32 v69, 16, v69
    v_mul_f32 v69, v69, v26
    v_cvt_pk_bf16_f32 v69, v69, v69
    v_lshlrev_b32 v69, 16, v69
    v_mul_f32 v69, v69, v117
    v_cvt_pk_bf16_f32 v69, v69, v69
    v_lshlrev_b32 v69, 16, v69
    v_add_f32 v69, v69, v101
    v_sub_f32 v70, v70, v27
    v_cvt_pk_bf16_f32 v70, v70, v70
    v_lshlrev_b32 v70, 16, v70
    v_mul_f32 v70, v70, v26
    v_cvt_pk_bf16_f32 v70, v70, v70
    v_lshlrev_b32 v70, 16, v70
    v_mul_f32 v70, v70, v118
    v_cvt_pk_bf16_f32 v70, v70, v70
    v_lshlrev_b32 v70, 16, v70
    v_add_f32 v70, v70, v102
    v_sub_f32 v71, v71, v27
    v_cvt_pk_bf16_f32 v71, v71, v71
    v_lshlrev_b32 v71, 16, v71
    v_mul_f32 v71, v71, v26
    v_cvt_pk_bf16_f32 v71, v71, v71
    v_lshlrev_b32 v71, 16, v71
    v_mul_f32 v71, v71, v119
    v_cvt_pk_bf16_f32 v71, v71, v71
    v_lshlrev_b32 v71, 16, v71
    v_add_f32 v71, v71, v103
    v_sub_f32 v72, v72, v27
    v_cvt_pk_bf16_f32 v72, v72, v72
    v_lshlrev_b32 v72, 16, v72
    v_mul_f32 v72, v72, v26
    v_cvt_pk_bf16_f32 v72, v72, v72
    v_lshlrev_b32 v72, 16, v72
    v_mul_f32 v72, v72, v120
    v_cvt_pk_bf16_f32 v72, v72, v72
    v_lshlrev_b32 v72, 16, v72
    v_add_f32 v72, v72, v104
    v_sub_f32 v73, v73, v27
    v_cvt_pk_bf16_f32 v73, v73, v73
    v_lshlrev_b32 v73, 16, v73
    v_mul_f32 v73, v73, v26
    v_cvt_pk_bf16_f32 v73, v73, v73
    v_lshlrev_b32 v73, 16, v73
    v_mul_f32 v73, v73, v121
    v_cvt_pk_bf16_f32 v73, v73, v73
    v_lshlrev_b32 v73, 16, v73
    v_add_f32 v73, v73, v105
    v_sub_f32 v74, v74, v27
    v_cvt_pk_bf16_f32 v74, v74, v74
    v_lshlrev_b32 v74, 16, v74
    v_mul_f32 v74, v74, v26
    v_cvt_pk_bf16_f32 v74, v74, v74
    v_lshlrev_b32 v74, 16, v74
    v_mul_f32 v74, v74, v122
    v_cvt_pk_bf16_f32 v74, v74, v74
    v_lshlrev_b32 v74, 16, v74
    v_add_f32 v74, v74, v106
    v_sub_f32 v75, v75, v27
    v_cvt_pk_bf16_f32 v75, v75, v75
    v_lshlrev_b32 v75, 16, v75
    v_mul_f32 v75, v75, v26
    v_cvt_pk_bf16_f32 v75, v75, v75
    v_lshlrev_b32 v75, 16, v75
    v_mul_f32 v75, v75, v123
    v_cvt_pk_bf16_f32 v75, v75, v75
    v_lshlrev_b32 v75, 16, v75
    v_add_f32 v75, v75, v107
    v_sub_f32 v76, v76, v27
    v_cvt_pk_bf16_f32 v76, v76, v76
    v_lshlrev_b32 v76, 16, v76
    v_mul_f32 v76, v76, v26
    v_cvt_pk_bf16_f32 v76, v76, v76
    v_lshlrev_b32 v76, 16, v76
    v_mul_f32 v76, v76, v124
    v_cvt_pk_bf16_f32 v76, v76, v76
    v_lshlrev_b32 v76, 16, v76
    v_add_f32 v76, v76, v108
    v_sub_f32 v77, v77, v27
    v_cvt_pk_bf16_f32 v77, v77, v77
    v_lshlrev_b32 v77, 16, v77
    v_mul_f32 v77, v77, v26
    v_cvt_pk_bf16_f32 v77, v77, v77
    v_lshlrev_b32 v77, 16, v77
    v_mul_f32 v77, v77, v125
    v_cvt_pk_bf16_f32 v77, v77, v77
    v_lshlrev_b32 v77, 16, v77
    v_add_f32 v77, v77, v109
    v_sub_f32 v78, v78, v27
    v_cvt_pk_bf16_f32 v78, v78, v78
    v_lshlrev_b32 v78, 16, v78
    v_mul_f32 v78, v78, v26
    v_cvt_pk_bf16_f32 v78, v78, v78
    v_lshlrev_b32 v78, 16, v78
    v_mul_f32 v78, v78, v126
    v_cvt_pk_bf16_f32 v78, v78, v78
    v_lshlrev_b32 v78, 16, v78
    v_add_f32 v78, v78, v110
    v_sub_f32 v79, v79, v27
    v_cvt_pk_bf16_f32 v79, v79, v79
    v_lshlrev_b32 v79, 16, v79
    v_mul_f32 v79, v79, v26
    v_cvt_pk_bf16_f32 v79, v79, v79
    v_lshlrev_b32 v79, 16, v79
    v_mul_f32 v79, v79, v127
    v_cvt_pk_bf16_f32 v79, v79, v79
    v_lshlrev_b32 v79, 16, v79
    v_add_f32 v79, v79, v111
    v_cvt_pk_bf16_f32 v80, v64, v65
    v_cvt_pk_bf16_f32 v81, v66, v67
    v_cvt_pk_bf16_f32 v82, v68, v69
    v_cvt_pk_bf16_f32 v83, v70, v71
    v_cvt_pk_bf16_f32 v84, v72, v73
    v_cvt_pk_bf16_f32 v85, v74, v75
    v_cvt_pk_bf16_f32 v86, v76, v77
    v_cvt_pk_bf16_f32 v87, v78, v79
    s_lshr_b32 s45, s63, 5
    s_lshl_b32 s45, s45, 16
    s_and_b32 s46, s63, 31
    s_lshl_b32 s46, s46, 8
    s_add_u32 s45, s45, s46
    s_add_u32 s45, s45, 0x400000
    s_add_u32 s46, s45, 32768
    buffer_store_dwordx4 v[80:83], v2, s[12:15], s45 offen sc1
    buffer_store_dwordx4 v[84:87], v2, s[12:15], s46 offen sc1
    s_add_u32 s63, s63, 768
    v_lshlrev_b32 v64, 16, v136
    v_and_b32 v65, 0xffff0000, v136
    v_lshlrev_b32 v66, 16, v137
    v_and_b32 v67, 0xffff0000, v137
    v_lshlrev_b32 v68, 16, v138
    v_and_b32 v69, 0xffff0000, v138
    v_lshlrev_b32 v70, 16, v139
    v_and_b32 v71, 0xffff0000, v139
    v_lshlrev_b32 v72, 16, v140
    v_and_b32 v73, 0xffff0000, v140
    v_lshlrev_b32 v74, 16, v141
    v_and_b32 v75, 0xffff0000, v141
    v_lshlrev_b32 v76, 16, v142
    v_and_b32 v77, 0xffff0000, v142
    v_lshlrev_b32 v78, 16, v143
    v_and_b32 v79, 0xffff0000, v143
    v_add_f32 v26, v64, v65
    v_add_f32 v26, v26, v66
    v_add_f32 v26, v26, v67
    v_add_f32 v26, v26, v68
    v_add_f32 v26, v26, v69
    v_add_f32 v26, v26, v70
    v_add_f32 v26, v26, v71
    v_add_f32 v26, v26, v72
    v_add_f32 v26, v26, v73
    v_add_f32 v26, v26, v74
    v_add_f32 v26, v26, v75
    v_add_f32 v26, v26, v76
    v_add_f32 v26, v26, v77
    v_add_f32 v26, v26, v78
    v_add_f32 v26, v26, v79
    s_nop 1
    v_add_f32_dpp v26, v26, v26 row_shr:1 row_mask:0xf bank_mask:0xf bound_ctrl:0
    s_nop 1
    v_add_f32_dpp v26, v26, v26 row_shr:2 row_mask:0xf bank_mask:0xf bound_ctrl:0
    s_nop 1
    v_add_f32_dpp v26, v26, v26 row_shr:4 row_mask:0xf bank_mask:0xf bound_ctrl:0
    s_nop 1
    v_add_f32_dpp v26, v26, v26 row_shr:8 row_mask:0xf bank_mask:0xf bound_ctrl:0
    s_nop 1
    v_add_f32_dpp v26, v26, v26 row_bcast:15 row_mask:0xa bank_mask:0xf
    s_nop 1
    v_add_f32_dpp v26, v26, v26 row_bcast:31 row_mask:0xc bank_mask:0xf
    s_nop 1
    v_readlane_b32 s66, v26, 63
    s_nop 1
    v_mov_b32 v27, s66
    v_mul_f32 v27, 0x3a800000, v27
    v_mov_b32 v26, 0
    v_sub_f32 v28, v64, v27
    v_fmac_f32 v26, v28, v28
    v_sub_f32 v28, v65, v27
    v_fmac_f32 v26, v28, v28
    v_sub_f32 v28, v66, v27
    v_fmac_f32 v26, v28, v28
    v_sub_f32 v28, v67, v27
    v_fmac_f32 v26, v28, v28
    v_sub_f32 v28, v68, v27
    v_fmac_f32 v26, v28, v28
    v_sub_f32 v28, v69, v27
    v_fmac_f32 v26, v28, v28
    v_sub_f32 v28, v70, v27
    v_fmac_f32 v26, v28, v28
    v_sub_f32 v28, v71, v27
    v_fmac_f32 v26, v28, v28
    v_sub_f32 v28, v72, v27
    v_fmac_f32 v26, v28, v28
    v_sub_f32 v28, v73, v27
    v_fmac_f32 v26, v28, v28
    v_sub_f32 v28, v74, v27
    v_fmac_f32 v26, v28, v28
    v_sub_f32 v28, v75, v27
    v_fmac_f32 v26, v28, v28
    v_sub_f32 v28, v76, v27
    v_fmac_f32 v26, v28, v28
    v_sub_f32 v28, v77, v27
    v_fmac_f32 v26, v28, v28
    v_sub_f32 v28, v78, v27
    v_fmac_f32 v26, v28, v28
    v_sub_f32 v28, v79, v27
    v_fmac_f32 v26, v28, v28
    s_nop 1
    v_add_f32_dpp v26, v26, v26 row_shr:1 row_mask:0xf bank_mask:0xf bound_ctrl:0
    s_nop 1
    v_add_f32_dpp v26, v26, v26 row_shr:2 row_mask:0xf bank_mask:0xf bound_ctrl:0
    s_nop 1
    v_add_f32_dpp v26, v26, v26 row_shr:4 row_mask:0xf bank_mask:0xf bound_ctrl:0
    s_nop 1
    v_add_f32_dpp v26, v26, v26 row_shr:8 row_mask:0xf bank_mask:0xf bound_ctrl:0
    s_nop 1
    v_add_f32_dpp v26, v26, v26 row_bcast:15 row_mask:0xa bank_mask:0xf
    s_nop 1
    v_add_f32_dpp v26, v26, v26 row_bcast:31 row_mask:0xc bank_mask:0xf
    s_nop 1
    v_readlane_b32 s66, v26, 63
    s_nop 1
    v_mov_b32 v26, s66
    v_mul_f32 v26, 0x3a800000, v26
    v_cvt_pk_bf16_f32 v26, v26, v26
    v_lshlrev_b32 v26, 16, v26
    v_cvt_pk_bf16_f32 v27, v27, v27
    v_lshlrev_b32 v27, 16, v27
    v_add_f32 v26, 0x3727c5ac, v26
    v_cvt_pk_bf16_f32 v26, v26, v26
    v_lshlrev_b32 v26, 16, v26
    v_sqrt_f32 v26, v26
    s_nop 0
    v_cvt_pk_bf16_f32 v26, v26, v26
    v_lshlrev_b32 v26, 16, v26
    v_rcp_f32 v26, v26
    s_nop 0
    v_sub_f32 v64, v64, v27
    v_cvt_pk_bf16_f32 v64, v64, v64
    v_lshlrev_b32 v64, 16, v64
    v_mul_f32 v64, v64, v26
    v_cvt_pk_bf16_f32 v64, v64, v64
    v_lshlrev_b32 v64, 16, v64
    v_mul_f32 v64, v64, v112
    v_cvt_pk_bf16_f32 v64, v64, v64
    v_lshlrev_b32 v64, 16, v64
    v_add_f32 v64, v64, v96
    v_sub_f32 v65, v65, v27
    v_cvt_pk_bf16_f32 v65, v65, v65
    v_lshlrev_b32 v65, 16, v65
    v_mul_f32 v65, v65, v26
    v_cvt_pk_bf16_f32 v65, v65, v65
    v_lshlrev_b32 v65, 16, v65
    v_mul_f32 v65, v65, v113
    v_cvt_pk_bf16_f32 v65, v65, v65
    v_lshlrev_b32 v65, 16, v65
    v_add_f32 v65, v65, v97
    v_sub_f32 v66, v66, v27
    v_cvt_pk_bf16_f32 v66, v66, v66
    v_lshlrev_b32 v66, 16, v66
    v_mul_f32 v66, v66, v26
    v_cvt_pk_bf16_f32 v66, v66, v66
    v_lshlrev_b32 v66, 16, v66
    v_mul_f32 v66, v66, v114
    v_cvt_pk_bf16_f32 v66, v66, v66
    v_lshlrev_b32 v66, 16, v66
    v_add_f32 v66, v66, v98
    v_sub_f32 v67, v67, v27
    v_cvt_pk_bf16_f32 v67, v67, v67
    v_lshlrev_b32 v67, 16, v67
    v_mul_f32 v67, v67, v26
    v_cvt_pk_bf16_f32 v67, v67, v67
    v_lshlrev_b32 v67, 16, v67
    v_mul_f32 v67, v67, v115
    v_cvt_pk_bf16_f32 v67, v67, v67
    v_lshlrev_b32 v67, 16, v67
    v_add_f32 v67, v67, v99
    v_sub_f32 v68, v68, v27
    v_cvt_pk_bf16_f32 v68, v68, v68
    v_lshlrev_b32 v68, 16, v68
    v_mul_f32 v68, v68, v26
    v_cvt_pk_bf16_f32 v68, v68, v68
    v_lshlrev_b32 v68, 16, v68
    v_mul_f32 v68, v68, v116
    v_cvt_pk_bf16_f32 v68, v68, v68
    v_lshlrev_b32 v68, 16, v68
    v_add_f32 v68, v68, v100
    v_sub_f32 v69, v69, v27
    v_cvt_pk_bf16_f32 v69, v69, v69
    v_lshlrev_b32 v69, 16, v69
    v_mul_f32 v69, v69, v26
    v_cvt_pk_bf16_f32 v69, v69, v69
    v_lshlrev_b32 v69, 16, v69
    v_mul_f32 v69, v69, v117
    v_cvt_pk_bf16_f32 v69, v69, v69
    v_lshlrev_b32 v69, 16, v69
    v_add_f32 v69, v69, v101
    v_sub_f32 v70, v70, v27
    v_cvt_pk_bf16_f32 v70, v70, v70
    v_lshlrev_b32 v70, 16, v70
    v_mul_f32 v70, v70, v26
    v_cvt_pk_bf16_f32 v70, v70, v70
    v_lshlrev_b32 v70, 16, v70
    v_mul_f32 v70, v70, v118
    v_cvt_pk_bf16_f32 v70, v70, v70
    v_lshlrev_b32 v70, 16, v70
    v_add_f32 v70, v70, v102
    v_sub_f32 v71, v71, v27
    v_cvt_pk_bf16_f32 v71, v71, v71
    v_lshlrev_b32 v71, 16, v71
    v_mul_f32 v71, v71, v26
    v_cvt_pk_bf16_f32 v71, v71, v71
    v_lshlrev_b32 v71, 16, v71
    v_mul_f32 v71, v71, v119
    v_cvt_pk_bf16_f32 v71, v71, v71
    v_lshlrev_b32 v71, 16, v71
    v_add_f32 v71, v71, v103
    v_sub_f32 v72, v72, v27
    v_cvt_pk_bf16_f32 v72, v72, v72
    v_lshlrev_b32 v72, 16, v72
    v_mul_f32 v72, v72, v26
    v_cvt_pk_bf16_f32 v72, v72, v72
    v_lshlrev_b32 v72, 16, v72
    v_mul_f32 v72, v72, v120
    v_cvt_pk_bf16_f32 v72, v72, v72
    v_lshlrev_b32 v72, 16, v72
    v_add_f32 v72, v72, v104
    v_sub_f32 v73, v73, v27
    v_cvt_pk_bf16_f32 v73, v73, v73
    v_lshlrev_b32 v73, 16, v73
    v_mul_f32 v73, v73, v26
    v_cvt_pk_bf16_f32 v73, v73, v73
    v_lshlrev_b32 v73, 16, v73
    v_mul_f32 v73, v73, v121
    v_cvt_pk_bf16_f32 v73, v73, v73
    v_lshlrev_b32 v73, 16, v73
    v_add_f32 v73, v73, v105
    v_sub_f32 v74, v74, v27
    v_cvt_pk_bf16_f32 v74, v74, v74
    v_lshlrev_b32 v74, 16, v74
    v_mul_f32 v74, v74, v26
    v_cvt_pk_bf16_f32 v74, v74, v74
    v_lshlrev_b32 v74, 16, v74
    v_mul_f32 v74, v74, v122
    v_cvt_pk_bf16_f32 v74, v74, v74
    v_lshlrev_b32 v74, 16, v74
    v_add_f32 v74, v74, v106
    v_sub_f32 v75, v75, v27
    v_cvt_pk_bf16_f32 v75, v75, v75
    v_lshlrev_b32 v75, 16, v75
    v_mul_f32 v75, v75, v26
    v_cvt_pk_bf16_f32 v75, v75, v75
    v_lshlrev_b32 v75, 16, v75
    v_mul_f32 v75, v75, v123
    v_cvt_pk_bf16_f32 v75, v75, v75
    v_lshlrev_b32 v75, 16, v75
    v_add_f32 v75, v75, v107
    v_sub_f32 v76, v76, v27
    v_cvt_pk_bf16_f32 v76, v76, v76
    v_lshlrev_b32 v76, 16, v76
    v_mul_f32 v76, v76, v26
    v_cvt_pk_bf16_f32 v76, v76, v76
    v_lshlrev_b32 v76, 16, v76
    v_mul_f32 v76, v76, v124
    v_cvt_pk_bf16_f32 v76, v76, v76
    v_lshlrev_b32 v76, 16, v76
    v_add_f32 v76, v76, v108
    v_sub_f32 v77, v77, v27
    v_cvt_pk_bf16_f32 v77, v77, v77
    v_lshlrev_b32 v77, 16, v77
    v_mul_f32 v77, v77, v26
    v_cvt_pk_bf16_f32 v77, v77, v77
    v_lshlrev_b32 v77, 16, v77
    v_mul_f32 v77, v77, v125
    v_cvt_pk_bf16_f32 v77, v77, v77
    v_lshlrev_b32 v77, 16, v77
    v_add_f32 v77, v77, v109
    v_sub_f32 v78, v78, v27
    v_cvt_pk_bf16_f32 v78, v78, v78
    v_lshlrev_b32 v78, 16, v78
    v_mul_f32 v78, v78, v26
    v_cvt_pk_bf16_f32 v78, v78, v78
    v_lshlrev_b32 v78, 16, v78
    v_mul_f32 v78, v78, v126
    v_cvt_pk_bf16_f32 v78, v78, v78
    v_lshlrev_b32 v78, 16, v78
    v_add_f32 v78, v78, v110
    v_sub_f32 v79, v79, v27
    v_cvt_pk_bf16_f32 v79, v79, v79
    v_lshlrev_b32 v79, 16, v79
    v_mul_f32 v79, v79, v26
    v_cvt_pk_bf16_f32 v79, v79, v79
    v_lshlrev_b32 v79, 16, v79
    v_mul_f32 v79, v79, v127
    v_cvt_pk_bf16_f32 v79, v79, v79
    v_lshlrev_b32 v79, 16, v79
    v_add_f32 v79, v79, v111
    v_cvt_pk_bf16_f32 v80, v64, v65
    v_cvt_pk_bf16_f32 v81, v66, v67
    v_cvt_pk_bf16_f32 v82, v68, v69
    v_cvt_pk_bf16_f32 v83, v70, v71
    v_cvt_pk_bf16_f32 v84, v72, v73
    v_cvt_pk_bf16_f32 v85, v74, v75
    v_cvt_pk_bf16_f32 v86, v76, v77
    v_cvt_pk_bf16_f32 v87, v78, v79
    s_lshr_b32 s45, s63, 5
    s_lshl_b32 s45, s45, 16
    s_and_b32 s46, s63, 31
    s_lshl_b32 s46, s46, 8
    s_add_u32 s45, s45, s46
    s_add_u32 s45, s45, 0x400000
    s_add_u32 s46, s45, 32768
    buffer_store_dwordx4 v[80:83], v2, s[12:15], s45 offen sc1
    buffer_store_dwordx4 v[84:87], v2, s[12:15], s46 offen sc1
    s_add_u32 s63, s63, 768
    s_cmp_ge_u32 s63, 2048
    s_cbranch_scc1 L_ln_done_37
    v_lshlrev_b32 v64, 16, v144
    v_and_b32 v65, 0xffff0000, v144
    v_lshlrev_b32 v66, 16, v145
    v_and_b32 v67, 0xffff0000, v145
    v_lshlrev_b32 v68, 16, v146
    v_and_b32 v69, 0xffff0000, v146
    v_lshlrev_b32 v70, 16, v147
    v_and_b32 v71, 0xffff0000, v147
    v_lshlrev_b32 v72, 16, v148
    v_and_b32 v73, 0xffff0000, v148
    v_lshlrev_b32 v74, 16, v149
    v_and_b32 v75, 0xffff0000, v149
    v_lshlrev_b32 v76, 16, v150
    v_and_b32 v77, 0xffff0000, v150
    v_lshlrev_b32 v78, 16, v151
    v_and_b32 v79, 0xffff0000, v151
    v_add_f32 v26, v64, v65
    v_add_f32 v26, v26, v66
    v_add_f32 v26, v26, v67
    v_add_f32 v26, v26, v68
    v_add_f32 v26, v26, v69
    v_add_f32 v26, v26, v70
    v_add_f32 v26, v26, v71
    v_add_f32 v26, v26, v72
    v_add_f32 v26, v26, v73
    v_add_f32 v26, v26, v74
    v_add_f32 v26, v26, v75
    v_add_f32 v26, v26, v76
    v_add_f32 v26, v26, v77
    v_add_f32 v26, v26, v78
    v_add_f32 v26, v26, v79
    s_nop 1
    v_add_f32_dpp v26, v26, v26 row_shr:1 row_mask:0xf bank_mask:0xf bound_ctrl:0
    s_nop 1
    v_add_f32_dpp v26, v26, v26 row_shr:2 row_mask:0xf bank_mask:0xf bound_ctrl:0
    s_nop 1
    v_add_f32_dpp v26, v26, v26 row_shr:4 row_mask:0xf bank_mask:0xf bound_ctrl:0
    s_nop 1
    v_add_f32_dpp v26, v26, v26 row_shr:8 row_mask:0xf bank_mask:0xf bound_ctrl:0
    s_nop 1
    v_add_f32_dpp v26, v26, v26 row_bcast:15 row_mask:0xa bank_mask:0xf
    s_nop 1
    v_add_f32_dpp v26, v26, v26 row_bcast:31 row_mask:0xc bank_mask:0xf
    s_nop 1
    v_readlane_b32 s66, v26, 63
    s_nop 1
    v_mov_b32 v27, s66
    v_mul_f32 v27, 0x3a800000, v27
    v_mov_b32 v26, 0
    v_sub_f32 v28, v64, v27
    v_fmac_f32 v26, v28, v28
    v_sub_f32 v28, v65, v27
    v_fmac_f32 v26, v28, v28
    v_sub_f32 v28, v66, v27
    v_fmac_f32 v26, v28, v28
    v_sub_f32 v28, v67, v27
    v_fmac_f32 v26, v28, v28
    v_sub_f32 v28, v68, v27
    v_fmac_f32 v26, v28, v28
    v_sub_f32 v28, v69, v27
    v_fmac_f32 v26, v28, v28
    v_sub_f32 v28, v70, v27
    v_fmac_f32 v26, v28, v28
    v_sub_f32 v28, v71, v27
    v_fmac_f32 v26, v28, v28
    v_sub_f32 v28, v72, v27
    v_fmac_f32 v26, v28, v28
    v_sub_f32 v28, v73, v27
    v_fmac_f32 v26, v28, v28
    v_sub_f32 v28, v74, v27
    v_fmac_f32 v26, v28, v28
    v_sub_f32 v28, v75, v27
    v_fmac_f32 v26, v28, v28
    v_sub_f32 v28, v76, v27
    v_fmac_f32 v26, v28, v28
    v_sub_f32 v28, v77, v27
    v_fmac_f32 v26, v28, v28
    v_sub_f32 v28, v78, v27
    v_fmac_f32 v26, v28, v28
    v_sub_f32 v28, v79, v27
    v_fmac_f32 v26, v28, v28
    s_nop 1
    v_add_f32_dpp v26, v26, v26 row_shr:1 row_mask:0xf bank_mask:0xf bound_ctrl:0
    s_nop 1
    v_add_f32_dpp v26, v26, v26 row_shr:2 row_mask:0xf bank_mask:0xf bound_ctrl:0
    s_nop 1
    v_add_f32_dpp v26, v26, v26 row_shr:4 row_mask:0xf bank_mask:0xf bound_ctrl:0
    s_nop 1
    v_add_f32_dpp v26, v26, v26 row_shr:8 row_mask:0xf bank_mask:0xf bound_ctrl:0
    s_nop 1
    v_add_f32_dpp v26, v26, v26 row_bcast:15 row_mask:0xa bank_mask:0xf
    s_nop 1
    v_add_f32_dpp v26, v26, v26 row_bcast:31 row_mask:0xc bank_mask:0xf
    s_nop 1
    v_readlane_b32 s66, v26, 63
    s_nop 1
    v_mov_b32 v26, s66
    v_mul_f32 v26, 0x3a800000, v26
    v_cvt_pk_bf16_f32 v26, v26, v26
    v_lshlrev_b32 v26, 16, v26
    v_cvt_pk_bf16_f32 v27, v27, v27
    v_lshlrev_b32 v27, 16, v27
    v_add_f32 v26, 0x3727c5ac, v26
    v_cvt_pk_bf16_f32 v26, v26, v26
    v_lshlrev_b32 v26, 16, v26
    v_sqrt_f32 v26, v26
    s_nop 0
    v_cvt_pk_bf16_f32 v26, v26, v26
    v_lshlrev_b32 v26, 16, v26
    v_rcp_f32 v26, v26
    s_nop 0
    v_sub_f32 v64, v64, v27
    v_cvt_pk_bf16_f32 v64, v64, v64
    v_lshlrev_b32 v64, 16, v64
    v_mul_f32 v64, v64, v26
    v_cvt_pk_bf16_f32 v64, v64, v64
    v_lshlrev_b32 v64, 16, v64
    v_mul_f32 v64, v64, v112
    v_cvt_pk_bf16_f32 v64, v64, v64
    v_lshlrev_b32 v64, 16, v64
    v_add_f32 v64, v64, v96
    v_sub_f32 v65, v65, v27
    v_cvt_pk_bf16_f32 v65, v65, v65
    v_lshlrev_b32 v65, 16, v65
    v_mul_f32 v65, v65, v26
    v_cvt_pk_bf16_f32 v65, v65, v65
    v_lshlrev_b32 v65, 16, v65
    v_mul_f32 v65, v65, v113
    v_cvt_pk_bf16_f32 v65, v65, v65
    v_lshlrev_b32 v65, 16, v65
    v_add_f32 v65, v65, v97
    v_sub_f32 v66, v66, v27
    v_cvt_pk_bf16_f32 v66, v66, v66
    v_lshlrev_b32 v66, 16, v66
    v_mul_f32 v66, v66, v26
    v_cvt_pk_bf16_f32 v66, v66, v66
    v_lshlrev_b32 v66, 16, v66
    v_mul_f32 v66, v66, v114
    v_cvt_pk_bf16_f32 v66, v66, v66
    v_lshlrev_b32 v66, 16, v66
    v_add_f32 v66, v66, v98
    v_sub_f32 v67, v67, v27
    v_cvt_pk_bf16_f32 v67, v67, v67
    v_lshlrev_b32 v67, 16, v67
    v_mul_f32 v67, v67, v26
    v_cvt_pk_bf16_f32 v67, v67, v67
    v_lshlrev_b32 v67, 16, v67
    v_mul_f32 v67, v67, v115
    v_cvt_pk_bf16_f32 v67, v67, v67
    v_lshlrev_b32 v67, 16, v67
    v_add_f32 v67, v67, v99
    v_sub_f32 v68, v68, v27
    v_cvt_pk_bf16_f32 v68, v68, v68
    v_lshlrev_b32 v68, 16, v68
    v_mul_f32 v68, v68, v26
    v_cvt_pk_bf16_f32 v68, v68, v68
    v_lshlrev_b32 v68, 16, v68
    v_mul_f32 v68, v68, v116
    v_cvt_pk_bf16_f32 v68, v68, v68
    v_lshlrev_b32 v68, 16, v68
    v_add_f32 v68, v68, v100
    v_sub_f32 v69, v69, v27
    v_cvt_pk_bf16_f32 v69, v69, v69
    v_lshlrev_b32 v69, 16, v69
    v_mul_f32 v69, v69, v26
    v_cvt_pk_bf16_f32 v69, v69, v69
    v_lshlrev_b32 v69, 16, v69
    v_mul_f32 v69, v69, v117
    v_cvt_pk_bf16_f32 v69, v69, v69
    v_lshlrev_b32 v69, 16, v69
    v_add_f32 v69, v69, v101
    v_sub_f32 v70, v70, v27
    v_cvt_pk_bf16_f32 v70, v70, v70
    v_lshlrev_b32 v70, 16, v70
    v_mul_f32 v70, v70, v26
    v_cvt_pk_bf16_f32 v70, v70, v70
    v_lshlrev_b32 v70, 16, v70
    v_mul_f32 v70, v70, v118
    v_cvt_pk_bf16_f32 v70, v70, v70
    v_lshlrev_b32 v70, 16, v70
    v_add_f32 v70, v70, v102
    v_sub_f32 v71, v71, v27
    v_cvt_pk_bf16_f32 v71, v71, v71
    v_lshlrev_b32 v71, 16, v71
    v_mul_f32 v71, v71, v26
    v_cvt_pk_bf16_f32 v71, v71, v71
    v_lshlrev_b32 v71, 16, v71
    v_mul_f32 v71, v71, v119
    v_cvt_pk_bf16_f32 v71, v71, v71
    v_lshlrev_b32 v71, 16, v71
    v_add_f32 v71, v71, v103
    v_sub_f32 v72, v72, v27
    v_cvt_pk_bf16_f32 v72, v72, v72
    v_lshlrev_b32 v72, 16, v72
    v_mul_f32 v72, v72, v26
    v_cvt_pk_bf16_f32 v72, v72, v72
    v_lshlrev_b32 v72, 16, v72
    v_mul_f32 v72, v72, v120
    v_cvt_pk_bf16_f32 v72, v72, v72
    v_lshlrev_b32 v72, 16, v72
    v_add_f32 v72, v72, v104
    v_sub_f32 v73, v73, v27
    v_cvt_pk_bf16_f32 v73, v73, v73
    v_lshlrev_b32 v73, 16, v73
    v_mul_f32 v73, v73, v26
    v_cvt_pk_bf16_f32 v73, v73, v73
    v_lshlrev_b32 v73, 16, v73
    v_mul_f32 v73, v73, v121
    v_cvt_pk_bf16_f32 v73, v73, v73
    v_lshlrev_b32 v73, 16, v73
    v_add_f32 v73, v73, v105
    v_sub_f32 v74, v74, v27
    v_cvt_pk_bf16_f32 v74, v74, v74
    v_lshlrev_b32 v74, 16, v74
    v_mul_f32 v74, v74, v26
    v_cvt_pk_bf16_f32 v74, v74, v74
    v_lshlrev_b32 v74, 16, v74
    v_mul_f32 v74, v74, v122
    v_cvt_pk_bf16_f32 v74, v74, v74
    v_lshlrev_b32 v74, 16, v74
    v_add_f32 v74, v74, v106
    v_sub_f32 v75, v75, v27
    v_cvt_pk_bf16_f32 v75, v75, v75
    v_lshlrev_b32 v75, 16, v75
    v_mul_f32 v75, v75, v26
    v_cvt_pk_bf16_f32 v75, v75, v75
    v_lshlrev_b32 v75, 16, v75
    v_mul_f32 v75, v75, v123
    v_cvt_pk_bf16_f32 v75, v75, v75
    v_lshlrev_b32 v75, 16, v75
    v_add_f32 v75, v75, v107
    v_sub_f32 v76, v76, v27
    v_cvt_pk_bf16_f32 v76, v76, v76
    v_lshlrev_b32 v76, 16, v76
    v_mul_f32 v76, v76, v26
    v_cvt_pk_bf16_f32 v76, v76, v76
    v_lshlrev_b32 v76, 16, v76
    v_mul_f32 v76, v76, v124
    v_cvt_pk_bf16_f32 v76, v76, v76
    v_lshlrev_b32 v76, 16, v76
    v_add_f32 v76, v76, v108
    v_sub_f32 v77, v77, v27
    v_cvt_pk_bf16_f32 v77, v77, v77
    v_lshlrev_b32 v77, 16, v77
    v_mul_f32 v77, v77, v26
    v_cvt_pk_bf16_f32 v77, v77, v77
    v_lshlrev_b32 v77, 16, v77
    v_mul_f32 v77, v77, v125
    v_cvt_pk_bf16_f32 v77, v77, v77
    v_lshlrev_b32 v77, 16, v77
    v_add_f32 v77, v77, v109
    v_sub_f32 v78, v78, v27
    v_cvt_pk_bf16_f32 v78, v78, v78
    v_lshlrev_b32 v78, 16, v78
    v_mul_f32 v78, v78, v26
    v_cvt_pk_bf16_f32 v78, v78, v78
    v_lshlrev_b32 v78, 16, v78
    v_mul_f32 v78, v78, v126
    v_cvt_pk_bf16_f32 v78, v78, v78
    v_lshlrev_b32 v78, 16, v78
    v_add_f32 v78, v78, v110
    v_sub_f32 v79, v79, v27
    v_cvt_pk_bf16_f32 v79, v79, v79
    v_lshlrev_b32 v79, 16, v79
    v_mul_f32 v79, v79, v26
    v_cvt_pk_bf16_f32 v79, v79, v79
    v_lshlrev_b32 v79, 16, v79
    v_mul_f32 v79, v79, v127
    v_cvt_pk_bf16_f32 v79, v79, v79
    v_lshlrev_b32 v79, 16, v79
    v_add_f32 v79, v79, v111
    v_cvt_pk_bf16_f32 v80, v64, v65
    v_cvt_pk_bf16_f32 v81, v66, v67
    v_cvt_pk_bf16_f32 v82, v68, v69
    v_cvt_pk_bf16_f32 v83, v70, v71
    v_cvt_pk_bf16_f32 v84, v72, v73
    v_cvt_pk_bf16_f32 v85, v74, v75
    v_cvt_pk_bf16_f32 v86, v76, v77
    v_cvt_pk_bf16_f32 v87, v78, v79
    s_lshr_b32 s45, s63, 5
    s_lshl_b32 s45, s45, 16
    s_and_b32 s46, s63, 31
    s_lshl_b32 s46, s46, 8
    s_add_u32 s45, s45, s46
    s_add_u32 s45, s45, 0x400000
    s_add_u32 s46, s45, 32768
    buffer_store_dwordx4 v[80:83], v2, s[12:15], s45 offen sc1
    buffer_store_dwordx4 v[84:87], v2, s[12:15], s46 offen sc1
    s_add_u32 s63, s63, 768
L_ln_done_37:
    s_waitcnt vmcnt(0)
    s_barrier
    s_cmp_lg_u32 s44, 0
    s_cbranch_scc1 L_cnt_38
    v_mov_b32 v30, 1
    v_mov_b32 v31, 0
    s_mov_b64 exec, 1
    buffer_atomic_add v30, v31, s[16:19], 0 offen offset:192 sc1
    s_mov_b64 exec, -1
L_cnt_38:
    v_mov_b32 v29, 192
    s_mov_b32 s46, 192
    s_mov_b64 exec, 1
    s_mov_b32 s70, 0
L_wp_39:
    buffer_load_dword v31, v29, s[16:19], 0 offen sc1
    s_add_u32 s70, s70, 1
    s_cmp_ge_u32 s70, 0x200000
    s_cbranch_scc1 L_w_done_33
    s_waitcnt vmcnt(0)
    v_cmp_gt_u32 vcc, s46, v31
    s_nop 1
    s_cbranch_vccz L_wp_39_ok
    s_sleep 1
    s_branch L_wp_39
L_wp_39_ok:
    s_mov_b64 exec, -1
    s_mov_b32 s50, s42
    s_mov_b32 s51, 32
    s_mov_b32 s52, 0x400000
    s_lshl_b32 s45, s43, 5
    s_add_u32 s45, s45, s41
    s_lshl_b32 s56, s45, 19
    s_add_u32 s56, s56, 0x2000000
    s_mul_i32 s53, s50, 65536
    s_add_u32 s53, s53, s52
    s_lshl_b32 s45, s44, 11
    s_add_u32 s53, s53, s45
    s_mul_i32 s57, s50, 8192
    s_add_u32 s57, s57, s56
    s_mul_i32 s54, s44, 8320
    s_add_u32 s55, s54, 66560
    s_mov_b32 s58, 0
    v_mov_b32 v13, v4
    s_mov_b32 s59, 66560
    s_add_u32 m0, s54, 0
    s_nop 0
    buffer_load_dwordx4 v2, s[12:15], s53 offen offset:0 sc1 lds
    s_add_u32 m0, s54, 784
    s_nop 0
    buffer_load_dwordx4 v2, s[12:15], s53 offen offset:256 sc1 lds
    s_add_u32 m0, s54, 1568
    s_nop 0
    buffer_load_dwordx4 v2, s[12:15], s53 offen offset:512 sc1 lds
    s_add_u32 m0, s54, 2352
    s_nop 0
    buffer_load_dwordx4 v2, s[12:15], s53 offen offset:768 sc1 lds
    s_add_u32 m0, s54, 3136
    s_nop 0
    buffer_load_dwordx4 v2, s[12:15], s53 offen offset:1024 sc1 lds
    s_add_u32 m0, s54, 3920
    s_nop 0
    buffer_load_dwordx4 v2, s[12:15], s53 offen offset:1280 sc1 lds
    s_add_u32 m0, s54, 4704
    s_nop 0
    buffer_load_dwordx4 v2, s[12:15], s53 offen offset:1536 sc1 lds
    s_add_u32 m0, s54, 5488
    s_nop 0
    buffer_load_dwordx4 v2, s[12:15], s53 offen offset:1792 sc1 lds
    s_add_u32 s45, s53, 32768
    s_add_u32 s46, s54, 33280
    s_add_u32 m0, s46, 0
    s_nop 0
    buffer_load_dwordx4 v2, s[12:15], s45 offen offset:0 sc1 lds
    s_add_u32 m0, s46, 784
    s_nop 0
    buffer_load_dwordx4 v2, s[12:15], s45 offen offset:256 sc1 lds
    s_add_u32 m0, s46, 1568
    s_nop 0
    buffer_load_dwordx4 v2, s[12:15], s45 offen offset:512 sc1 lds
    s_add_u32 m0, s46, 2352
    s_nop 0
    buffer_load_dwordx4 v2, s[12:15], s45 offen offset:768 sc1 lds
    s_add_u32 m0, s46, 3136
    s_nop 0
    buffer_load_dwordx4 v2, s[12:15], s45 offen offset:1024 sc1 lds
    s_add_u32 m0, s46, 3920
    s_nop 0
    buffer_load_dwordx4 v2, s[12:15], s45 offen offset:1280 sc1 lds
    s_add_u32 m0, s46, 4704
    s_nop 0
    buffer_load_dwordx4 v2, s[12:15], s45 offen offset:1536 sc1 lds
    s_add_u32 m0, s46, 5488
    s_nop 0
    buffer_load_dwordx4 v2, s[12:15], s45 offen offset:1792 sc1 lds
    s_add_u32 s45, s53, 131072
    s_cmp_gt_u32 s51, 1
    s_cselect_b32 s45, s45, 0x20000000
    s_add_u32 m0, s55, 0
    s_nop 0
    buffer_load_dwordx4 v2, s[12:15], s45 offen offset:0 sc1 lds
    s_add_u32 m0, s55, 784
    s_nop 0
    buffer_load_dwordx4 v2, s[12:15], s45 offen offset:256 sc1 lds
    s_add_u32 m0, s55, 1568
    s_nop 0
    buffer_load_dwordx4 v2, s[12:15], s45 offen offset:512 sc1 lds
    s_add_u32 m0, s55, 2352
    s_nop 0
    buffer_load_dwordx4 v2, s[12:15], s45 offen offset:768 sc1 lds
    s_add_u32 m0, s55, 3136
    s_nop 0
    buffer_load_dwordx4 v2, s[12:15], s45 offen offset:1024 sc1 lds
    s_add_u32 m0, s55, 3920
    s_nop 0
    buffer_load_dwordx4 v2, s[12:15], s45 offen offset:1280 sc1 lds
    s_add_u32 m0, s55, 4704
    s_nop 0
    buffer_load_dwordx4 v2, s[12:15], s45 offen offset:1536 sc1 lds
    s_add_u32 m0, s55, 5488
    s_nop 0
    buffer_load_dwordx4 v2, s[12:15], s45 offen offset:1792 sc1 lds
L_e_loop_40:
    s_add_u32 s45, s53, 163840
    s_add_u32 s46, s58, 1
    s_cmp_lt_u32 s46, s51
    s_cselect_b32 s48, s45, 0x20000000
    s_add_u32 s49, s55, 33280
    s_waitcnt vmcnt(16)
    s_barrier
    s_cmp_lg_u32 s44, 0
    s_cbranch_scc1 L_e_pr_41
    s_cmp_lt_u32 s58, 2
    s_cbranch_scc1 L_e_pr_41
    s_sub_u32 s45, s58, 1
    v_mov_b32 v30, s45
    v_mov_b32 v31, 0
    s_mov_b64 exec, 1
    buffer_store_dword v30, v31, s[12:15], s61 offen sc1
    s_mov_b64 exec, -1
L_e_pr_41:
    ds_read_b128 v[32:35], v13 offset:0
    ds_read_b128 v[36:39], v13 offset:32
    ds_read_b128 v[40:43], v13 offset:64
    ds_read_b128 v[44:47], v13 offset:96
    ds_read_b128 v[48:51], v13 offset:128
    ds_read_b128 v[52:55], v13 offset:160
    s_waitcnt lgkmcnt(4)
    v_mfma_f32_32x32x16_bf16 v[64:79], a[0:3], v[32:35], 0
    ds_read_b128 v[56:59], v13 offset:192
    v_mfma_f32_32x32x16_bf16 v[64:79], a[4:7], v[36:39], v[64:79]
    ds_read_b128 v[60:63], v13 offset:224
    s_add_u32 m0, s49, 0
    s_nop 0
    buffer_load_dwordx4 v2, s[12:15], s48 offen offset:0 sc1 lds
    s_waitcnt lgkmcnt(4)
    v_mfma_f32_32x32x16_bf16 v[64:79], a[8:11], v[40:43], v[64:79]
    ds_read_b128 v[32:35], v13 offset:256
    v_mfma_f32_32x32x16_bf16 v[64:79], a[12:15], v[44:47], v[64:79]
    ds_read_b128 v[36:39], v13 offset:288
    s_add_u32 m0, s49, 784
    s_nop 0
    buffer_load_dwordx4 v2, s[12:15], s48 offen offset:256 sc1 lds
    s_waitcnt lgkmcnt(4)
    v_mfma_f32_32x32x16_bf16 v[64:79], a[16:19], v[48:51], v[64:79]
    ds_read_b128 v[40:43], v13 offset:320
    v_mfma_f32_32x32x16_bf16 v[64:79], a[20:23], v[52:55], v[64:79]
    ds_read_b128 v[44:47], v13 offset:352
    s_add_u32 m0, s49, 1568
    s_nop 0
    buffer_load_dwordx4 v2, s[12:15], s48 offen offset:512 sc1 lds
    s_waitcnt lgkmcnt(4)
    v_mfma_f32_32x32x16_bf16 v[64:79], a[24:27], v[56:59], v[64:79]
    ds_read_b128 v[48:51], v13 offset:384
    v_mfma_f32_32x32x16_bf16 v[64:79], a[28:31], v[60:63], v[64:79]
    ds_read_b128 v[52:55], v13 offset:416
    s_add_u32 m0, s49, 2352
    s_nop 0
    buffer_load_dwordx4 v2, s[12:15], s48 offen offset:768 sc1 lds
    s_waitcnt lgkmcnt(4)
    v_mfma_f32_32x32x16_bf16 v[64:79], a[32:35], v[32:35], v[64:79]
    ds_read_b128 v[56:59], v13 offset:448
    v_mfma_f32_32x32x16_bf16 v[64:79], a[36:39], v[36:39], v[64:79]
    ds_read_b128 v[60:63], v13 offset:480
    s_add_u32 m0, s49, 3136
    s_nop 0
    buffer_load_dwordx4 v2, s[12:15], s48 offen offset:1024 sc1 lds
    s_waitcnt lgkmcnt(4)
    v_mfma_f32_32x32x16_bf16 v[64:79], a[40:43], v[40:43], v[64:79]
    ds_read_b128 v[32:35], v13 offset:512
    v_mfma_f32_32x32x16_bf16 v[64:79], a[44:47], v[44:47], v[64:79]
    ds_read_b128 v[36:39], v13 offset:544
    s_add_u32 m0, s49, 3920
    s_nop 0
    buffer_load_dwordx4 v2, s[12:15], s48 offen offset:1280 sc1 lds
    s_waitcnt lgkmcnt(4)
    v_mfma_f32_32x32x16_bf16 v[64:79], a[48:51], v[48:51], v[64:79]
    ds_read_b128 v[40:43], v13 offset:576
    v_mfma_f32_32x32x16_bf16 v[64:79], a[52:55], v[52:55], v[64:79]
    ds_read_b128 v[44:47], v13 offset:608
    s_add_u32 m0, s49, 4704
    s_nop 0
    buffer_load_dwordx4 v2, s[12:15], s48 offen offset:1536 sc1 lds
    s_waitcnt lgkmcnt(4)
    v_mfma_f32_32x32x16_bf16 v[64:79], a[56:59], v[56:59], v[64:79]
    ds_read_b128 v[48:51], v13 offset:640
    v_mfma_f32_32x32x16_bf16 v[64:79], a[60:63], v[60:63], v[64:79]
    ds_read_b128 v[52:55], v13 offset:672
    s_add_u32 m0, s49, 5488
    s_nop 0
    buffer_load_dwordx4 v2, s[12:15], s48 offen offset:1792 sc1 lds
    s_waitcnt lgkmcnt(4)
    v_mfma_f32_32x32x16_bf16 v[64:79], a[64:67], v[32:35], v[64:79]
    ds_read_b128 v[56:59], v13 offset:704
    v_mfma_f32_32x32x16_bf16 v[64:79], a[68:71], v[36:39], v[64:79]
    ds_read_b128 v[60:63], v13 offset:736
    s_waitcnt lgkmcnt(4)
    v_mfma_f32_32x32x16_bf16 v[64:79], a[72:75], v[40:43], v[64:79]
    ds_read_b128 v[32:35], v13 offset:768
    v_mfma_f32_32x32x16_bf16 v[64:79], a[76:79], v[44:47], v[64:79]
    ds_read_b128 v[36:39], v13 offset:800
    s_waitcnt lgkmcnt(4)
    v_mfma_f32_32x32x16_bf16 v[64:79], a[80:83], v[48:51], v[64:79]
    ds_read_b128 v[40:43], v13 offset:832
    v_mfma_f32_32x32x16_bf16 v[64:79], a[84:87], v[52:55], v[64:79]
    ds_read_b128 v[44:47], v13 offset:864
    s_waitcnt lgkmcnt(4)
    v_mfma_f32_32x32x16_bf16 v[64:79], a[88:91], v[56:59], v[64:79]
    ds_read_b128 v[48:51], v13 offset:896
    v_mfma_f32_32x32x16_bf16 v[64:79], a[92:95], v[60:63], v[64:79]
    ds_read_b128 v[52:55], v13 offset:928
    s_waitcnt lgkmcnt(4)
    v_mfma_f32_32x32x16_bf16 v[64:79], a[96:99], v[32:35], v[64:79]
    ds_read_b128 v[56:59], v13 offset:960
    v_mfma_f32_32x32x16_bf16 v[64:79], a[100:103], v[36:39], v[64:79]
    ds_read_b128 v[60:63], v13 offset:992
    s_waitcnt lgkmcnt(4)
    v_mfma_f32_32x32x16_bf16 v[64:79], a[104:107], v[40:43], v[64:79]
    v_mfma_f32_32x32x16_bf16 v[64:79], a[108:111], v[44:47], v[64:79]
    s_waitcnt lgkmcnt(2)
    v_mfma_f32_32x32x16_bf16 v[64:79], a[112:115], v[48:51], v[64:79]
    v_mfma_f32_32x32x16_bf16 v[64:79], a[116:119], v[52:55], v[64:79]
    s_waitcnt lgkmcnt(0)
    v_mfma_f32_32x32x16_bf16 v[64:79], a[120:123], v[56:59], v[64:79]
    v_mfma_f32_32x32x16_bf16 v[64:79], a[124:127], v[60:63], v[64:79]
    s_add_u32 s45, s53, 262144
    s_add_u32 s46, s58, 2
    s_cmp_lt_u32 s46, s51
    s_cselect_b32 s48, s45, 0x20000000
    s_mov_b32 s49, s54
    s_waitcnt vmcnt(16)
    s_barrier
    ds_read_b128 v[32:35], v13 offset:33280
    ds_read_b128 v[36:39], v13 offset:33312
    ds_read_b128 v[40:43], v13 offset:33344
    ds_read_b128 v[44:47], v13 offset:33376
    ds_read_b128 v[48:51], v13 offset:33408
    ds_read_b128 v[52:55], v13 offset:33440
    s_waitcnt lgkmcnt(4)
    v_mfma_f32_32x32x16_bf16 v[64:79], a[128:131], v[32:35], v[64:79]
    ds_read_b128 v[56:59], v13 offset:33472
    v_mfma_f32_32x32x16_bf16 v[64:79], a[132:135], v[36:39], v[64:79]
    ds_read_b128 v[60:63], v13 offset:33504
    s_add_u32 m0, s49, 0
    s_nop 0
    buffer_load_dwordx4 v2, s[12:15], s48 offen offset:0 sc1 lds
    s_waitcnt lgkmcnt(4)
    v_mfma_f32_32x32x16_bf16 v[64:79], a[136:139], v[40:43], v[64:79]
    ds_read_b128 v[32:35], v13 offset:33536
    v_mfma_f32_32x32x16_bf16 v[64:79], a[140:143], v[44:47], v[64:79]
    ds_read_b128 v[36:39], v13 offset:33568
    s_add_u32 m0, s49, 784
    s_nop 0
    buffer_load_dwordx4 v2, s[12:15], s48 offen offset:256 sc1 lds
    s_waitcnt lgkmcnt(4)
    v_mfma_f32_32x32x16_bf16 v[64:79], a[144:147], v[48:51], v[64:79]
    ds_read_b128 v[40:43], v13 offset:33600
    v_mfma_f32_32x32x16_bf16 v[64:79], a[148:151], v[52:55], v[64:79]
    ds_read_b128 v[44:47], v13 offset:33632
    s_add_u32 m0, s49, 1568
    s_nop 0
    buffer_load_dwordx4 v2, s[12:15], s48 offen offset:512 sc1 lds
    s_waitcnt lgkmcnt(4)
    v_mfma_f32_32x32x16_bf16 v[64:79], a[152:155], v[56:59], v[64:79]
    ds_read_b128 v[48:51], v13 offset:33664
    v_mfma_f32_32x32x16_bf16 v[64:79], a[156:159], v[60:63], v[64:79]
    ds_read_b128 v[52:55], v13 offset:33696
    s_add_u32 m0, s49, 2352
    s_nop 0
    buffer_load_dwordx4 v2, s[12:15], s48 offen offset:768 sc1 lds
    s_waitcnt lgkmcnt(4)
    v_mfma_f32_32x32x16_bf16 v[64:79], a[160:163], v[32:35], v[64:79]
    ds_read_b128 v[56:59], v13 offset:33728
    v_mfma_f32_32x32x16_bf16 v[64:79], a[164:167], v[36:39], v[64:79]
    ds_read_b128 v[60:63], v13 offset:33760
    s_add_u32 m0, s49, 3136
    s_nop 0
    buffer_load_dwordx4 v2, s[12:15], s48 offen offset:1024 sc1 lds
    s_waitcnt lgkmcnt(4)
    v_mfma_f32_32x32x16_bf16 v[64:79], a[168:171], v[40:43], v[64:79]
    ds_read_b128 v[32:35], v13 offset:33792
    v_mfma_f32_32x32x16_bf16 v[64:79], a[172:175], v[44:47], v[64:79]
    ds_read_b128 v[36:39], v13 offset:33824
    s_add_u32 m0, s49, 3920
    s_nop 0
    buffer_load_dwordx4 v2, s[12:15], s48 offen offset:1280 sc1 lds
    s_waitcnt lgkmcnt(4)
    v_mfma_f32_32x32x16_bf16 v[64:79], a[176:179], v[48:51], v[64:79]
    ds_read_b128 v[40:43], v13 offset:33856
    v_mfma_f32_32x32x16_bf16 v[64:79], a[180:183], v[52:55], v[64:79]
    ds_read_b128 v[44:47], v13 offset:33888
    s_add_u32 m0, s49, 4704
    s_nop 0
    buffer_load_dwordx4 v2, s[12:15], s48 offen offset:1536 sc1 lds
    s_waitcnt lgkmcnt(4)
    v_mfma_f32_32x32x16_bf16 v[64:79], a[184:187], v[56:59], v[64:79]
    ds_read_b128 v[48:51], v13 offset:33920
    v_mfma_f32_32x32x16_bf16 v[64:79], a[188:191], v[60:63], v[64:79]
    ds_read_b128 v[52:55], v13 offset:33952
    s_add_u32 m0, s49, 5488
    s_nop 0
    buffer_load_dwordx4 v2, s[12:15], s48 offen offset:1792 sc1 lds
    s_waitcnt lgkmcnt(4)
    v_mfma_f32_32x32x16_bf16 v[64:79], a[192:195], v[32:35], v[64:79]
    ds_read_b128 v[56:59], v13 offset:33984
    v_mfma_f32_32x32x16_bf16 v[64:79], a[196:199], v[36:39], v[64:79]
    ds_read_b128 v[60:63], v13 offset:34016
    s_waitcnt lgkmcnt(4)
    v_mfma_f32_32x32x16_bf16 v[64:79], a[200:203], v[40:43], v[64:79]
    ds_read_b128 v[32:35], v13 offset:34048
    v_mfma_f32_32x32x16_bf16 v[64:79], a[204:207], v[44:47], v[64:79]
    ds_read_b128 v[36:39], v13 offset:34080
    s_waitcnt lgkmcnt(4)
    v_mfma_f32_32x32x16_bf16 v[64:79], a[208:211], v[48:51], v[64:79]
    ds_read_b128 v[40:43], v13 offset:34112
    v_mfma_f32_32x32x16_bf16 v[64:79], a[212:215], v[52:55], v[64:79]
    ds_read_b128 v[44:47], v13 offset:34144
    s_waitcnt lgkmcnt(4)
    v_mfma_f32_32x32x16_bf16 v[64:79], a[216:219], v[56:59], v[64:79]
    ds_read_b128 v[48:51], v13 offset:34176
    v_mfma_f32_32x32x16_bf16 v[64:79], a[220:223], v[60:63], v[64:79]
    ds_read_b128 v[52:55], v13 offset:34208
    s_waitcnt lgkmcnt(4)
    v_mfma_f32_32x32x16_bf16 v[64:79], a[224:227], v[32:35], v[64:79]
    ds_read_b128 v[56:59], v13 offset:34240
    v_mfma_f32_32x32x16_bf16 v[64:79], a[228:231], v[36:39], v[64:79]
    ds_read_b128 v[60:63], v13 offset:34272
    s_waitcnt lgkmcnt(4)
    v_mfma_f32_32x32x16_bf16 v[64:79], a[232:235], v[40:43], v[64:79]
    v_mfma_f32_32x32x16_bf16 v[64:79], a[236:239], v[44:47], v[64:79]
    s_waitcnt lgkmcnt(2)
    v_mfma_f32_32x32x16_bf16 v[64:79], a[240:243], v[48:51], v[64:79]
    v_mfma_f32_32x32x16_bf16 v[64:79], a[244:247], v[52:55], v[64:79]
    s_waitcnt lgkmcnt(0)
    v_mfma_f32_32x32x16_bf16 v[64:79], a[248:251], v[56:59], v[64:79]
    v_mfma_f32_32x32x16_bf16 v[64:79], a[252:255], v[60:63], v[64:79]
    s_add_u32 s53, s53, 131072
    s_add_u32 s58, s58, 1
    v_add_u32 v13, s59, v13
    s_add_u32 s54, s54, s59
    s_sub_u32 s55, s55, s59
    s_sub_u32 s59, 0, s59
    s_lshl_b32 s45, s44, 11
    s_add_u32 s45, s45, s57
    s_add_u32 s57, s57, 16384
    s_nop 3
    v_cvt_pk_bf16_f32 v64, v64, v65
    v_cvt_pk_bf16_f32 v65, v66, v67
    v_cvt_pk_bf16_f32 v66, v68, v69
    v_cvt_pk_bf16_f32 v67, v70, v71
    v_cvt_pk_bf16_f32 v68, v72, v73
    v_cvt_pk_bf16_f32 v69, v74, v75
    v_cvt_pk_bf16_f32 v70, v76, v77
    v_cvt_pk_bf16_f32 v71, v78, v79
    ds_write_b128 v6, v[64:67]
    ds_write_b128 v6, v[68:71] offset:16
    s_waitcnt lgkmcnt(0)
    s_barrier
    ds_read_b128 v[80:83], v8
    ds_read_b128 v[84:87], v8 offset:1088
    s_waitcnt lgkmcnt(1)
    buffer_store_dwordx4 v[80:83], v10, s[12:15], s45 offen sc1
    s_waitcnt lgkmcnt(0)
    buffer_store_dwordx4 v[84:87], v10, s[12:15], s45 offen offset:1024 sc1
    s_cmp_lt_u32 s58, s51
    s_cbranch_scc1 L_e_loop_40
    s_waitcnt vmcnt(0)
    s_barrier
    s_cmp_lg_u32 s44, 0
    s_cbranch_scc1 L_pub_42
    v_mov_b32 v30, 32
    v_mov_b32 v31, 0
    s_mov_b64 exec, 1
    buffer_store_dword v30, v31, s[12:15], s61 offen sc1
    s_mov_b64 exec, -1
L_pub_42:
    s_mov_b32 s36, 0x11111111
    s_mov_b32 s37, 0xf5511111
    s_andn2_b32 s36, s36, s42
    s_lshr_b32 s38, s41, 3
    s_and_b32 s68, s41, 7
    s_cmp_eq_u32 s43, 1
    s_cbranch_scc1 L_role_b_43
    s_cmp_eq_u32 s43, 2
    s_cbranch_scc1 L_role_c_44
    s_load_dwordx2 s[6:7], s[0:1], 40
    s_waitcnt lgkmcnt(0)
    s_mov_b32 s24, s6
    s_and_b32 s25, s7, 0xffff
    s_mov_b32 s26, 0x800000
    s_mov_b32 s27, 0x00020000
    s_lshl_b32 s46, s38, 21
    s_lshl_b32 s45, s68, 8
    s_add_u32 s46, s46, s45
    s_waitcnt vmcnt(0)
    s_barrier
    v_lshrrev_b32 v20, 4, v1
    s_lshl_b32 s45, s44, 2
    v_add_u32 v21, s45, v20
    s_mov_b32 s45, 2048
    v_mul_lo_u32 v21, v21, s45
    v_lshlrev_b32 v22, 2, v20
    v_and_b32 v23, 15, v1
    v_xor_b32 v22, v22, v23
    v_lshlrev_b32 v22, 4, v22
    v_add_u32 v21, v21, v22
    v_bfe_u32 v22, v1, 2, 2
    v_lshrrev_b32 v23, 5, v1
    v_lshlrev_b32 v23, 3, v23
    v_add_u32 v23, v23, v22
    v_lshlrev_b32 v23, 8, v23
    v_xor_b32 v22, s44, v22
    v_lshlrev_b32 v22, 6, v22
    v_add_u32 v23, v23, v22
    v_and_b32 v22, 1, v1
    v_lshlrev_b32 v22, 5, v22
    v_add_u32 v23, v23, v22
    v_and_b32 v22, 16, v1
    v_add_u32 v23, v23, v22
    v_and_b32 v22, 2, v1
    v_lshlrev_b32 v22, 2, v22
    v_add_u32 v23, v23, v22
    v_add_u32 v24, 65536, v23
    v_add_u32 v25, 131072, v23
    s_lshl_b32 s47, s44, 10
    s_add_u32 s45, s46, 0x0
    s_add_u32 m0, s47, 0
    s_nop 0
    buffer_load_dwordx4 v21, s[24:27], s45 offen lds
    s_add_u32 s45, s46, 0x8000
    s_add_u32 m0, s47, 4096
    s_nop 0
    buffer_load_dwordx4 v21, s[24:27], s45 offen lds
    s_add_u32 s45, s46, 0x10000
    s_add_u32 m0, s47, 8192
    s_nop 0
    buffer_load_dwordx4 v21, s[24:27], s45 offen lds
    s_add_u32 s45, s46, 0x18000
    s_add_u32 m0, s47, 12288
    s_nop 0
    buffer_load_dwordx4 v21, s[24:27], s45 offen lds
    s_add_u32 s45, s46, 0x20000
    s_add_u32 m0, s47, 16384
    s_nop 0
    buffer_load_dwordx4 v21, s[24:27], s45 offen lds
    s_add_u32 s45, s46, 0x28000
    s_add_u32 m0, s47, 20480
    s_nop 0
    buffer_load_dwordx4 v21, s[24:27], s45 offen lds
    s_add_u32 s45, s46, 0x30000
    s_add_u32 m0, s47, 24576
    s_nop 0
    buffer_load_dwordx4 v21, s[24:27], s45 offen lds
    s_add_u32 s45, s46, 0x38000
    s_add_u32 m0, s47, 28672
    s_nop 0
    buffer_load_dwordx4 v21, s[24:27], s45 offen lds
    s_add_u32 s45, s46, 0x40000
    s_add_u32 m0, s47, 32768
    s_nop 0
    buffer_load_dwordx4 v21, s[24:27], s45 offen lds
    s_add_u32 s45, s46, 0x48000
    s_add_u32 m0, s47, 36864
    s_nop 0
    buffer_load_dwordx4 v21, s[24:27], s45 offen lds
    s_add_u32 s45, s46, 0x50000
    s_add_u32 m0, s47, 40960
    s_nop 0
    buffer_load_dwordx4 v21, s[24:27], s45 offen lds
    s_add_u32 s45, s46, 0x58000
    s_add_u32 m0, s47, 45056
    s_nop 0
    buffer_load_dwordx4 v21, s[24:27], s45 offen lds
    s_add_u32 s45, s46, 0x60000
    s_add_u32 m0, s47, 49152
    s_nop 0
    buffer_load_dwordx4 v21, s[24:27], s45 offen lds
    s_add_u32 s45, s46, 0x68000
    s_add_u32 m0, s47, 53248
    s_nop 0
    buffer_load_dwordx4 v21, s[24:27], s45 offen lds
    s_add_u32 s45, s46, 0x70000
    s_add_u32 m0, s47, 57344
    s_nop 0
    buffer_load_dwordx4 v21, s[24:27], s45 offen lds
    s_add_u32 s45, s46, 0x78000
    s_add_u32 m0, s47, 61440
    s_nop 0
    buffer_load_dwordx4 v21, s[24:27], s45 offen lds
    s_add_u32 s45, s46, 0x80000
    s_add_u32 m0, s47, 65536
    s_nop 0
    buffer_load_dwordx4 v21, s[24:27], s45 offen lds
    s_add_u32 s45, s46, 0x88000
    s_add_u32 m0, s47, 69632
    s_nop 0
    buffer_load_dwordx4 v21, s[24:27], s45 offen lds
    s_add_u32 s45, s46, 0x90000
    s_add_u32 m0, s47, 73728
    s_nop 0
    buffer_load_dwordx4 v21, s[24:27], s45 offen lds
    s_add_u32 s45, s46, 0x98000
    s_add_u32 m0, s47, 77824
    s_nop 0
    buffer_load_dwordx4 v21, s[24:27], s45 offen lds
    s_add_u32 s45, s46, 0xa0000
    s_add_u32 m0, s47, 81920
    s_nop 0
    buffer_load_dwordx4 v21, s[24:27], s45 offen lds
    s_add_u32 s45, s46, 0xa8000
    s_add_u32 m0, s47, 86016
    s_nop 0
    buffer_load_dwordx4 v21, s[24:27], s45 offen lds
    s_add_u32 s45, s46, 0xb0000
    s_add_u32 m0, s47, 90112
    s_nop 0
    buffer_load_dwordx4 v21, s[24:27], s45 offen lds
    s_add_u32 s45, s46, 0xb8000
    s_add_u32 m0, s47, 94208
    s_nop 0
    buffer_load_dwordx4 v21, s[24:27], s45 offen lds
    s_add_u32 s45, s46, 0xc0000
    s_add_u32 m0, s47, 98304
    s_nop 0
    buffer_load_dwordx4 v21, s[24:27], s45 offen lds
    s_add_u32 s45, s46, 0xc8000
    s_add_u32 m0, s47, 102400
    s_nop 0
    buffer_load_dwordx4 v21, s[24:27], s45 offen lds
    s_add_u32 s45, s46, 0xd0000
    s_add_u32 m0, s47, 106496
    s_nop 0
    buffer_load_dwordx4 v21, s[24:27], s45 offen lds
    s_add_u32 s45, s46, 0xd8000
    s_add_u32 m0, s47, 110592
    s_nop 0
    buffer_load_dwordx4 v21, s[24:27], s45 offen lds
    s_add_u32 s45, s46, 0xe0000
    s_add_u32 m0, s47, 114688
    s_nop 0
    buffer_load_dwordx4 v21, s[24:27], s45 offen lds
    s_add_u32 s45, s46, 0xe8000
    s_add_u32 m0, s47, 118784
    s_nop 0
    buffer_load_dwordx4 v21, s[24:27], s45 offen lds
    s_add_u32 s45, s46, 0xf0000
    s_add_u32 m0, s47, 122880
    s_nop 0
    buffer_load_dwordx4 v21, s[24:27], s45 offen lds
    s_add_u32 s45, s46, 0xf8000
    s_add_u32 m0, s47, 126976
    s_nop 0
    buffer_load_dwordx4 v21, s[24:27], s45 offen lds
    s_waitcnt vmcnt(28)
    s_barrier
    s_add_u32 s45, s46, 0x100000
    s_add_u32 m0, s47, 131072
    s_nop 0
    buffer_load_dwordx4 v21, s[24:27], s45 offen lds
    s_add_u32 s45, s46, 0x108000
    s_add_u32 m0, s47, 135168
    s_nop 0
    buffer_load_dwordx4 v21, s[24:27], s45 offen lds
    s_add_u32 s45, s46, 0x110000
    s_add_u32 m0, s47, 139264
    s_nop 0
    buffer_load_dwordx4 v21, s[24:27], s45 offen lds
    s_add_u32 s45, s46, 0x118000
    s_add_u32 m0, s47, 143360
    s_nop 0
    buffer_load_dwordx4 v21, s[24:27], s45 offen lds
    ds_read_b64_tr_b16 a[0:1], v23 offset:0
    ds_read_b64_tr_b16 a[2:3], v23 offset:1024
    ds_read_b64_tr_b16 a[4:5], v23 offset:4096
    ds_read_b64_tr_b16 a[6:7], v23 offset:5120
    ds_read_b64_tr_b16 a[8:9], v23 offset:8192
    ds_read_b64_tr_b16 a[10:11], v23 offset:9216
    ds_read_b64_tr_b16 a[12:13], v23 offset:12288
    ds_read_b64_tr_b16 a[14:15], v23 offset:13312
    s_waitcnt lgkmcnt(0)
    s_waitcnt vmcnt(28)
    s_barrier
    s_add_u32 s45, s46, 0x120000
    s_add_u32 m0, s47, 0
    s_nop 0
    buffer_load_dwordx4 v21, s[24:27], s45 offen lds
    s_add_u32 s45, s46, 0x128000
    s_add_u32 m0, s47, 4096
    s_nop 0
    buffer_load_dwordx4 v21, s[24:27], s45 offen lds
    s_add_u32 s45, s46, 0x130000
    s_add_u32 m0, s47, 8192
    s_nop 0
    buffer_load_dwordx4 v21, s[24:27], s45 offen lds
    s_add_u32 s45, s46, 0x138000
    s_add_u32 m0, s47, 12288
    s_nop 0
    buffer_load_dwordx4 v21, s[24:27], s45 offen lds
    ds_read_b64_tr_b16 a[16:17], v23 offset:16384
    ds_read_b64_tr_b16 a[18:19], v23 offset:17408
    ds_read_b64_tr_b16 a[20:21], v23 offset:20480
    ds_read_b64_tr_b16 a[22:23], v23 offset:21504
    ds_read_b64_tr_b16 a[24:25], v23 offset:24576
    ds_read_b64_tr_b16 a[26:27], v23 offset:25600
    ds_read_b64_tr_b16 a[28:29], v23 offset:28672
    ds_read_b64_tr_b16 a[30:31], v23 offset:29696
    s_waitcnt lgkmcnt(0)
    s_waitcnt vmcnt(28)
    s_barrier
    s_add_u32 s45, s46, 0x140000
    s_add_u32 m0, s47, 16384
    s_nop 0
    buffer_load_dwordx4 v21, s[24:27], s45 offen lds
    s_add_u32 s45, s46, 0x148000
    s_add_u32 m0, s47, 20480
    s_nop 0
    buffer_load_dwordx4 v21, s[24:27], s45 offen lds
    s_add_u32 s45, s46, 0x150000
    s_add_u32 m0, s47, 24576
    s_nop 0
    buffer_load_dwordx4 v21, s[24:27], s45 offen lds
    s_add_u32 s45, s46, 0x158000
    s_add_u32 m0, s47, 28672
    s_nop 0
    buffer_load_dwordx4 v21, s[24:27], s45 offen lds
    ds_read_b64_tr_b16 a[32:33], v23 offset:32768
    ds_read_b64_tr_b16 a[34:35], v23 offset:33792
    ds_read_b64_tr_b16 a[36:37], v23 offset:36864
    ds_read_b64_tr_b16 a[38:39], v23 offset:37888
    ds_read_b64_tr_b16 a[40:41], v23 offset:40960
    ds_read_b64_tr_b16 a[42:43], v23 offset:41984
    ds_read_b64_tr_b16 a[44:45], v23 offset:45056
    ds_read_b64_tr_b16 a[46:47], v23 offset:46080
    s_waitcnt lgkmcnt(0)
    s_waitcnt vmcnt(28)
    s_barrier
    s_add_u32 s45, s46, 0x160000
    s_add_u32 m0, s47, 32768
    s_nop 0
    buffer_load_dwordx4 v21, s[24:27], s45 offen lds
    s_add_u32 s45, s46, 0x168000
    s_add_u32 m0, s47, 36864
    s_nop 0
    buffer_load_dwordx4 v21, s[24:27], s45 offen lds
    s_add_u32 s45, s46, 0x170000
    s_add_u32 m0, s47, 40960
    s_nop 0
    buffer_load_dwordx4 v21, s[24:27], s45 offen lds
    s_add_u32 s45, s46, 0x178000
    s_add_u32 m0, s47, 45056
    s_nop 0
    buffer_load_dwordx4 v21, s[24:27], s45 offen lds
    ds_read_b64_tr_b16 a[48:49], v23 offset:49152
    ds_read_b64_tr_b16 a[50:51], v23 offset:50176
    ds_read_b64_tr_b16 a[52:53], v23 offset:53248
    ds_read_b64_tr_b16 a[54:55], v23 offset:54272
    ds_read_b64_tr_b16 a[56:57], v23 offset:57344
    ds_read_b64_tr_b16 a[58:59], v23 offset:58368
    ds_read_b64_tr_b16 a[60:61], v23 offset:61440
    ds_read_b64_tr_b16 a[62:63], v23 offset:62464
    s_waitcnt lgkmcnt(0)
    s_waitcnt vmcnt(28)
    s_barrier
    s_add_u32 s45, s46, 0x180000
    s_add_u32 m0, s47, 49152
    s_nop 0
    buffer_load_dwordx4 v21, s[24:27], s45 offen lds
    s_add_u32 s45, s46, 0x188000
    s_add_u32 m0, s47, 53248
    s_nop 0
    buffer_load_dwordx4 v21, s[24:27], s45 offen lds
    s_add_u32 s45, s46, 0x190000
    s_add_u32 m0, s47, 57344
    s_nop 0
    buffer_load_dwordx4 v21, s[24:27], s45 offen lds
    s_add_u32 s45, s46, 0x198000
    s_add_u32 m0, s47, 61440
    s_nop 0
    buffer_load_dwordx4 v21, s[24:27], s45 offen lds
    ds_read_b64_tr_b16 a[64:65], v24 offset:0
    ds_read_b64_tr_b16 a[66:67], v24 offset:1024
    ds_read_b64_tr_b16 a[68:69], v24 offset:4096
    ds_read_b64_tr_b16 a[70:71], v24 offset:5120
    ds_read_b64_tr_b16 a[72:73], v24 offset:8192
    ds_read_b64_tr_b16 a[74:75], v24 offset:9216
    ds_read_b64_tr_b16 a[76:77], v24 offset:12288
    ds_read_b64_tr_b16 a[78:79], v24 offset:13312
    s_waitcnt lgkmcnt(0)
    s_waitcnt vmcnt(28)
    s_barrier
    s_add_u32 s45, s46, 0x1a0000
    s_add_u32 m0, s47, 65536
    s_nop 0
    buffer_load_dwordx4 v21, s[24:27], s45 offen lds
    s_add_u32 s45, s46, 0x1a8000
    s_add_u32 m0, s47, 69632
    s_nop 0
    buffer_load_dwordx4 v21, s[24:27], s45 offen lds
    s_add_u32 s45, s46, 0x1b0000
    s_add_u32 m0, s47, 73728
    s_nop 0
    buffer_load_dwordx4 v21, s[24:27], s45 offen lds
    s_add_u32 s45, s46, 0x1b8000
    s_add_u32 m0, s47, 77824
    s_nop 0
    buffer_load_dwordx4 v21, s[24:27], s45 offen lds
    ds_read_b64_tr_b16 a[80:81], v24 offset:16384
    ds_read_b64_tr_b16 a[82:83], v24 offset:17408
    ds_read_b64_tr_b16 a[84:85], v24 offset:20480
    ds_read_b64_tr_b16 a[86:87], v24 offset:21504
    ds_read_b64_tr_b16 a[88:89], v24 offset:24576
    ds_read_b64_tr_b16 a[90:91], v24 offset:25600
    ds_read_b64_tr_b16 a[92:93], v24 offset:28672
    ds_read_b64_tr_b16 a[94:95], v24 offset:29696
    s_waitcnt lgkmcnt(0)
    s_waitcnt vmcnt(28)
    s_barrier
    s_add_u32 s45, s46, 0x1c0000
    s_add_u32 m0, s47, 81920
    s_nop 0
    buffer_load_dwordx4 v21, s[24:27], s45 offen lds
    s_add_u32 s45, s46, 0x1c8000
    s_add_u32 m0, s47, 86016
    s_nop 0
    buffer_load_dwordx4 v21, s[24:27], s45 offen lds
    s_add_u32 s45, s46, 0x1d0000
    s_add_u32 m0, s47, 90112
    s_nop 0
    buffer_load_dwordx4 v21, s[24:27], s45 offen lds
    s_add_u32 s45, s46, 0x1d8000
    s_add_u32 m0, s47, 94208
    s_nop 0
    buffer_load_dwordx4 v21, s[24:27], s45 offen lds
    ds_read_b64_tr_b16 a[96:97], v24 offset:32768
    ds_read_b64_tr_b16 a[98:99], v24 offset:33792
    ds_read_b64_tr_b16 a[100:101], v24 offset:36864
    ds_read_b64_tr_b16 a[102:103], v24 offset:37888
    ds_read_b64_tr_b16 a[104:105], v24 offset:40960
    ds_read_b64_tr_b16 a[106:107], v24 offset:41984
    ds_read_b64_tr_b16 a[108:109], v24 offset:45056
    ds_read_b64_tr_b16 a[110:111], v24 offset:46080
    s_waitcnt lgkmcnt(0)
    s_waitcnt vmcnt(28)
    s_barrier
    s_add_u32 s45, s46, 0x1e0000
    s_add_u32 m0, s47, 98304
    s_nop 0
    buffer_load_dwordx4 v21, s[24:27], s45 offen lds
    s_add_u32 s45, s46, 0x1e8000
    s_add_u32 m0, s47, 102400
    s_nop 0
    buffer_load_dwordx4 v21, s[24:27], s45 offen lds
    s_add_u32 s45, s46, 0x1f0000
    s_add_u32 m0, s47, 106496
    s_nop 0
    buffer_load_dwordx4 v21, s[24:27], s45 offen lds
    s_add_u32 s45, s46, 0x1f8000
    s_add_u32 m0, s47, 110592
    s_nop 0
    buffer_load_dwordx4 v21, s[24:27], s45 offen lds
    ds_read_b64_tr_b16 a[112:113], v24 offset:49152
    ds_read_b64_tr_b16 a[114:115], v24 offset:50176
    ds_read_b64_tr_b16 a[116:117], v24 offset:53248
    ds_read_b64_tr_b16 a[118:119], v24 offset:54272
    ds_read_b64_tr_b16 a[120:121], v24 offset:57344
    ds_read_b64_tr_b16 a[122:123], v24 offset:58368
    ds_read_b64_tr_b16 a[124:125], v24 offset:61440
    ds_read_b64_tr_b16 a[126:127], v24 offset:62464
    s_waitcnt lgkmcnt(0)
    s_waitcnt vmcnt(28)
    s_barrier
    ds_read_b64_tr_b16 a[128:129], v25 offset:0
    ds_read_b64_tr_b16 a[130:131], v25 offset:1024
    ds_read_b64_tr_b16 a[132:133], v25 offset:4096
    ds_read_b64_tr_b16 a[134:135], v25 offset:5120
    ds_read_b64_tr_b16 a[136:137], v25 offset:8192
    ds_read_b64_tr_b16 a[138:139], v25 offset:9216
    ds_read_b64_tr_b16 a[140:141], v25 offset:12288
    ds_read_b64_tr_b16 a[142:143], v25 offset:13312
    s_waitcnt lgkmcnt(0)
    s_waitcnt vmcnt(24)
    s_barrier
    ds_read_b64_tr_b16 a[144:145], v23 offset:0
    ds_read_b64_tr_b16 a[146:147], v23 offset:1024
    ds_read_b64_tr_b16 a[148:149], v23 offset:4096
    ds_read_b64_tr_b16 a[150:151], v23 offset:5120
    ds_read_b64_tr_b16 a[152:153], v23 offset:8192
    ds_read_b64_tr_b16 a[154:155], v23 offset:9216
    ds_read_b64_tr_b16 a[156:157], v23 offset:12288
    ds_read_b64_tr_b16 a[158:159], v23 offset:13312
    s_waitcnt lgkmcnt(0)
    s_waitcnt vmcnt(20)
    s_barrier
    ds_read_b64_tr_b16 a[160:161], v23 offset:16384
    ds_read_b64_tr_b16 a[162:163], v23 offset:17408
    ds_read_b64_tr_b16 a[164:165], v23 offset:20480
    ds_read_b64_tr_b16 a[166:167], v23 offset:21504
    ds_read_b64_tr_b16 a[168:169], v23 offset:24576
    ds_read_b64_tr_b16 a[170:171], v23 offset:25600
    ds_read_b64_tr_b16 a[172:173], v23 offset:28672
    ds_read_b64_tr_b16 a[174:175], v23 offset:29696
    s_waitcnt lgkmcnt(0)
    s_waitcnt vmcnt(16)
    s_barrier
    ds_read_b64_tr_b16 a[176:177], v23 offset:32768
    ds_read_b64_tr_b16 a[178:179], v23 offset:33792
    ds_read_b64_tr_b16 a[180:181], v23 offset:36864
    ds_read_b64_tr_b16 a[182:183], v23 offset:37888
    ds_read_b64_tr_b16 a[184:185], v23 offset:40960
    ds_read_b64_tr_b16 a[186:187], v23 offset:41984
    ds_read_b64_tr_b16 a[188:189], v23 offset:45056
    ds_read_b64_tr_b16 a[190:191], v23 offset:46080
    s_waitcnt lgkmcnt(0)
    s_waitcnt vmcnt(12)
    s_barrier
    ds_read_b64_tr_b16 a[192:193], v23 offset:49152
    ds_read_b64_tr_b16 a[194:195], v23 offset:50176
    ds_read_b64_tr_b16 a[196:197], v23 offset:53248
    ds_read_b64_tr_b16 a[198:199], v23 offset:54272
    ds_read_b64_tr_b16 a[200:201], v23 offset:57344
    ds_read_b64_tr_b16 a[202:203], v23 offset:58368
    ds_read_b64_tr_b16 a[204:205], v23 offset:61440
    ds_read_b64_tr_b16 a[206:207], v23 offset:62464
    s_waitcnt lgkmcnt(0)
    s_waitcnt vmcnt(8)
    s_barrier
    ds_read_b64_tr_b16 a[208:209], v24 offset:0
    ds_read_b64_tr_b16 a[210:211], v24 offset:1024
    ds_read_b64_tr_b16 a[212:213], v24 offset:4096
    ds_read_b64_tr_b16 a[214:215], v24 offset:5120
    ds_read_b64_tr_b16 a[216:217], v24 offset:8192
    ds_read_b64_tr_b16 a[218:219], v24 offset:9216
    ds_read_b64_tr_b16 a[220:221], v24 offset:12288
    ds_read_b64_tr_b16 a[222:223], v24 offset:13312
    s_waitcnt lgkmcnt(0)
    s_waitcnt vmcnt(4)
    s_barrier
    ds_read_b64_tr_b16 a[224:225], v24 offset:16384
    ds_read_b64_tr_b16 a[226:227], v24 offset:17408
    ds_read_b64_tr_b16 a[228:229], v24 offset:20480
    ds_read_b64_tr_b16 a[230:231], v24 offset:21504
    ds_read_b64_tr_b16 a[232:233], v24 offset:24576
    ds_read_b64_tr_b16 a[234:235], v24 offset:25600
    ds_read_b64_tr_b16 a[236:237], v24 offset:28672
    ds_read_b64_tr_b16 a[238:239], v24 offset:29696
    s_waitcnt lgkmcnt(0)
    s_waitcnt vmcnt(0)
    s_barrier
    ds_read_b64_tr_b16 a[240:241], v24 offset:32768
    ds_read_b64_tr_b16 a[242:243], v24 offset:33792
    ds_read_b64_tr_b16 a[244:245], v24 offset:36864
    ds_read_b64_tr_b16 a[246:247], v24 offset:37888
    ds_read_b64_tr_b16 a[248:249], v24 offset:40960
    ds_read_b64_tr_b16 a[250:251], v24 offset:41984
    ds_read_b64_tr_b16 a[252:253], v24 offset:45056
    ds_read_b64_tr_b16 a[254:255], v24 offset:46080
    s_waitcnt lgkmcnt(0)
    s_barrier
    s_lshl_b32 s52, s38, 16
    s_add_u32 s52, s52, 0x5000000
    s_lshl_b32 s56, s38, 23
    s_lshl_b32 s45, s68, 9
    s_add_u32 s56, s56, s45
    s_add_u32 s56, s56, 0x8000000
    v_mov_b32 v29, 0
    s_mov_b32 s46, 64
    s_mov_b64 exec, 1
    s_mov_b32 s70, 0
L_wp_45:
    buffer_load_dword v31, v29, s[16:19], 0 offen sc1
    s_add_u32 s70, s70, 1
    s_cmp_ge_u32 s70, 0x200000
    s_cbranch_scc1 L_w_done_33
    s_waitcnt vmcnt(0)
    v_cmp_gt_u32 vcc, s46, v31
    s_nop 1
    s_cbranch_vccz L_wp_45_ok
    s_sleep 2
    s_branch L_wp_45
L_wp_45_ok:
    s_mov_b64 exec, -1
    s_lshl_b32 s45, s41, 7
    s_add_u32 s45, s45, 0x10000
    s_mov_b32 s46, 32
    s_mov_b64 exec, 63
    s_mov_b32 s70, 0
L_wp_46:
    buffer_load_dword v31, v12, s[12:15], s45 offen sc1
    s_add_u32 s70, s70, 1
    s_cmp_ge_u32 s70, 0x200000
    s_cbranch_scc1 L_w_done_33
    s_waitcnt vmcnt(0)
    v_cmp_gt_u32 vcc, s46, v31
    s_nop 1
    s_cbranch_vccz L_wp_46_ok
    s_sleep 2
    s_branch L_wp_46
L_wp_46_ok:
    s_mov_b64 exec, -1
L_a_loop_47:
    s_cmp_eq_u64 s[36:37], 0
    s_cbranch_scc1 L_w_done_33
    s_ff1_i32_b64 s50, s[36:37]
    s_bitset0_b64 s[36:37], s50
    s_ff1_i32_b64 s62, s[36:37]
    s_cmp_eq_u64 s[36:37], 0
    s_cselect_b32 s62, 64, s62
    s_sub_u32 s51, s62, s50
    s_and_b32 s45, s62, 63
    s_bitset0_b64 s[36:37], s45
    s_add_u32 s63, s50, s44
    s_cmp_ge_u32 s44, s51
    s_cbranch_scc1 L_a_skip_48
    s_lshl_b32 s45, s41, 19
    s_lshl_b32 s46, s63, 13
    s_add_u32 s45, s45, s46
    s_add_u32 s45, s45, 0x2000000
    s_add_u32 s48, s45, 16777216
    s_add_u32 s49, s48, 16777216
    v_and_b32 v14, 15, v1
    v_lshlrev_b32 v15, 8, v14
    v_lshrrev_b32 v16, 4, v1
    v_lshlrev_b32 v17, 4, v16
    v_add_u32 v15, v15, v17
    v_add_u32 v17, 4096, v15
    buffer_load_dwordx4 v[128:131], v15, s[12:15], s45 offen offset:0 sc1
    buffer_load_dwordx4 v[132:135], v15, s[12:15], s45 offen offset:64 sc1
    buffer_load_dwordx4 v[136:139], v15, s[12:15], s45 offen offset:128 sc1
    buffer_load_dwordx4 v[140:143], v15, s[12:15], s45 offen offset:192 sc1
    buffer_load_dwordx4 v[144:147], v17, s[12:15], s45 offen offset:0 sc1
    buffer_load_dwordx4 v[148:151], v17, s[12:15], s45 offen offset:64 sc1
    buffer_load_dwordx4 v[152:155], v17, s[12:15], s45 offen offset:128 sc1
    buffer_load_dwordx4 v[156:159], v17, s[12:15], s45 offen offset:192 sc1
    buffer_load_dwordx4 v[160:163], v15, s[12:15], s48 offen offset:0 sc1
    buffer_load_dwordx4 v[164:167], v15, s[12:15], s48 offen offset:64 sc1
    buffer_load_dwordx4 v[168:171], v15, s[12:15], s48 offen offset:128 sc1
    buffer_load_dwordx4 v[172:175], v15, s[12:15], s48 offen offset:192 sc1
    buffer_load_dwordx4 v[176:179], v17, s[12:15], s48 offen offset:0 sc1
    buffer_load_dwordx4 v[180:183], v17, s[12:15], s48 offen offset:64 sc1
    buffer_load_dwordx4 v[184:187], v17, s[12:15], s48 offen offset:128 sc1
    buffer_load_dwordx4 v[188:191], v17, s[12:15], s48 offen offset:192 sc1
    s_add_u32 s46, s49, 4096
    buffer_load_dwordx4 v[208:211], v10, s[12:15], s49 offen offset:0 sc1
    buffer_load_dwordx4 v[212:215], v10, s[12:15], s49 offen offset:1024 sc1
    buffer_load_dwordx4 v[216:219], v10, s[12:15], s49 offen offset:2048 sc1
    buffer_load_dwordx4 v[220:223], v10, s[12:15], s49 offen offset:3072 sc1
    buffer_load_dwordx4 v[224:227], v10, s[12:15], s46 offen offset:0 sc1
    buffer_load_dwordx4 v[228:231], v10, s[12:15], s46 offen offset:1024 sc1
    buffer_load_dwordx4 v[232:235], v10, s[12:15], s46 offen offset:2048 sc1
    buffer_load_dwordx4 v[236:239], v10, s[12:15], s46 offen offset:3072 sc1
    v_mul_u32_u24 v18, 272, v16
    v_lshlrev_b32 v19, 4, v14
    s_mul_i32 s47, s44, 8704
    v_add3_u32 v18, v18, v19, s47
    s_waitcnt vmcnt(0)
    ds_write_b128 v18, v[208:211] offset:0
    ds_write_b128 v18, v[212:215] offset:1088
    ds_write_b128 v18, v[216:219] offset:2176
    ds_write_b128 v18, v[220:223] offset:3264
    ds_write_b128 v18, v[224:227] offset:4352
    ds_write_b128 v18, v[228:231] offset:5440
    ds_write_b128 v18, v[232:235] offset:6528
    ds_write_b128 v18, v[236:239] offset:7616
    v_mfma_f32_16x16x32_bf16 v[32:35], v[160:163], v[128:131], 0
    v_mfma_f32_16x16x32_bf16 v[36:39], v[160:163], v[144:147], 0
    v_mfma_f32_16x16x32_bf16 v[44:47], v[176:179], v[144:147], 0
    v_mfma_f32_16x16x32_bf16 v[32:35], v[164:167], v[132:135], v[32:35]
    v_mfma_f32_16x16x32_bf16 v[36:39], v[164:167], v[148:151], v[36:39]
    v_mfma_f32_16x16x32_bf16 v[44:47], v[180:183], v[148:151], v[44:47]
    v_mfma_f32_16x16x32_bf16 v[32:35], v[168:171], v[136:139], v[32:35]
    v_mfma_f32_16x16x32_bf16 v[36:39], v[168:171], v[152:155], v[36:39]
    v_mfma_f32_16x16x32_bf16 v[44:47], v[184:187], v[152:155], v[44:47]
    v_mfma_f32_16x16x32_bf16 v[32:35], v[172:175], v[140:143], v[32:35]
    v_mfma_f32_16x16x32_bf16 v[36:39], v[172:175], v[156:159], v[36:39]
    v_mfma_f32_16x16x32_bf16 v[44:47], v[188:191], v[156:159], v[44:47]
    v_lshlrev_b32 v19, 2, v16
    v_bfe_u32 v20, v1, 2, 2
    v_add_u32 v20, v19, v20
    v_mul_u32_u24 v20, 272, v20
    v_and_b32 v21, 3, v1
    v_lshlrev_b32 v21, 3, v21
    v_add3_u32 v20, v20, v21, s47
    v_mov_b32 v22, 0xff800000
    s_waitcnt lgkmcnt(0)
    ds_read_b64_tr_b16 v[208:209], v20 offset:0
    ds_read_b64_tr_b16 v[210:211], v20 offset:4352
    ds_read_b64_tr_b16 v[212:213], v20 offset:32
    ds_read_b64_tr_b16 v[214:215], v20 offset:4384
    ds_read_b64_tr_b16 v[216:217], v20 offset:64
    ds_read_b64_tr_b16 v[218:219], v20 offset:4416
    ds_read_b64_tr_b16 v[220:221], v20 offset:96
    ds_read_b64_tr_b16 v[222:223], v20 offset:4448
    ds_read_b64_tr_b16 v[224:225], v20 offset:128
    ds_read_b64_tr_b16 v[226:227], v20 offset:4480
    ds_read_b64_tr_b16 v[228:229], v20 offset:160
    ds_read_b64_tr_b16 v[230:231], v20 offset:4512
    ds_read_b64_tr_b16 v[232:233], v20 offset:192
    ds_read_b64_tr_b16 v[234:235], v20 offset:4544
    ds_read_b64_tr_b16 v[236:237], v20 offset:224
    ds_read_b64_tr_b16 v[238:239], v20 offset:4576
    v_add_u32 v21, 0, v19
    v_cmp_gt_u32 vcc, v21, v14
    s_nop 1
    v_cndmask_b32 v32, v32, v22, vcc
    v_cndmask_b32 v44, v44, v22, vcc
    v_add_u32 v21, 1, v19
    v_cmp_gt_u32 vcc, v21, v14
    s_nop 1
    v_cndmask_b32 v33, v33, v22, vcc
    v_cndmask_b32 v45, v45, v22, vcc
    v_add_u32 v21, 2, v19
    v_cmp_gt_u32 vcc, v21, v14
    s_nop 1
    v_cndmask_b32 v34, v34, v22, vcc
    v_cndmask_b32 v46, v46, v22, vcc
    v_add_u32 v21, 3, v19
    v_cmp_gt_u32 vcc, v21, v14
    s_nop 1
    v_cndmask_b32 v35, v35, v22, vcc
    v_cndmask_b32 v47, v47, v22, vcc
    s_lshl_b32 s45, s41, 7
    s_add_u32 s45, s45, 0x11000
    s_add_u32 s46, s63, 1
    s_mov_b64 exec, 255
    s_mov_b32 s70, 0
L_wp_49:
    buffer_load_dword v31, v12, s[12:15], s45 offen sc1
    s_add_u32 s70, s70, 1
    s_cmp_ge_u32 s70, 0x200000
    s_cbranch_scc1 L_w_done_33
    s_waitcnt vmcnt(0)
    v_cmp_gt_u32 vcc, s46, v31
    s_nop 1
    s_cbranch_vccz L_wp_49_ok
    s_sleep 4
    s_branch L_wp_49
L_wp_49_ok:
    s_mov_b64 exec, -1
    s_lshl_b32 s45, s63, 17
    s_lshl_b32 s46, s41, 12
    s_add_u32 s45, s45, s46
    s_lshr_b32 s46, s45, 1
    s_add_u32 s45, s45, 0x1000000
    s_add_u32 s46, s46, 0x1800000
    v_lshlrev_b32 v21, 3, v1
    buffer_load_dwordx4 v[192:195], v10, s[12:15], s45 offen offset:0 sc1
    buffer_load_dwordx4 v[196:199], v10, s[12:15], s45 offen offset:1024 sc1
    buffer_load_dwordx4 v[200:203], v10, s[12:15], s45 offen offset:2048 sc1
    buffer_load_dwordx4 v[204:207], v10, s[12:15], s45 offen offset:3072 sc1
    buffer_load_dwordx2 v[240:241], v21, s[12:15], s46 offen offset:0 sc1
    buffer_load_dwordx2 v[242:243], v21, s[12:15], s46 offen offset:512 sc1
    buffer_load_dwordx2 v[244:245], v21, s[12:15], s46 offen offset:1024 sc1
    buffer_load_dwordx2 v[246:247], v21, s[12:15], s46 offen offset:1536 sc1
    s_waitcnt vmcnt(4)
    v_mfma_f32_16x16x32_bf16 v[48:51], v[192:195], v[128:131], 0
    v_mfma_f32_16x16x32_bf16 v[52:55], v[192:195], v[144:147], 0
    v_mfma_f32_16x16x32_bf16 v[48:51], v[196:199], v[132:135], v[48:51]
    v_mfma_f32_16x16x32_bf16 v[52:55], v[196:199], v[148:151], v[52:55]
    v_mfma_f32_16x16x32_bf16 v[48:51], v[200:203], v[136:139], v[48:51]
    v_mfma_f32_16x16x32_bf16 v[52:55], v[200:203], v[152:155], v[52:55]
    v_mfma_f32_16x16x32_bf16 v[48:51], v[204:207], v[140:143], v[48:51]
    v_mfma_f32_16x16x32_bf16 v[52:55], v[204:207], v[156:159], v[52:55]
    s_mov_b32 s45, 0x3e0293ee
    s_nop 6
    v_permlane32_swap_b32 v48, v50
    v_permlane32_swap_b32 v49, v51
    v_pk_add_f32 v[48:49], v[48:49], v[50:51]
    v_permlane32_swap_b32 v52, v54
    v_permlane32_swap_b32 v53, v55
    v_pk_add_f32 v[52:53], v[52:53], v[54:55]
    v_max_f32 v22, v32, v33
    v_max3_f32 v22, v22, v34, v35
    v_max3_f32 v22, v22, v48, v49
    v_max_f32 v23, v36, v37
    v_max3_f32 v23, v23, v38, v39
    v_max3_f32 v23, v23, v44, v45
    v_max3_f32 v23, v23, v46, v47
    v_max3_f32 v23, v23, v52, v53
    v_mov_b32 v24, v22
    v_mov_b32 v25, v23
    s_nop 0
    v_permlane32_swap_b32 v22, v24
    v_permlane32_swap_b32 v23, v25
    v_max_f32 v22, v22, v24
    v_max_f32 v23, v23, v25
    v_mov_b32 v24, v22
    v_mov_b32 v25, v23
    s_nop 0
    v_permlane16_swap_b32 v22, v24
    v_permlane16_swap_b32 v23, v25
    v_max_f32 v22, v22, v24
    v_max_f32 v23, v23, v25
    v_mul_f32 v22, s45, v22
    v_mul_f32 v23, s45, v23
    v_fma_f32 v32, v32, s45, -v22
    v_fma_f32 v33, v33, s45, -v22
    v_fma_f32 v34, v34, s45, -v22
    v_fma_f32 v35, v35, s45, -v22
    v_fma_f32 v48, v48, s45, -v22
    v_fma_f32 v49, v49, s45, -v22
    v_exp_f32 v32, v32
    v_exp_f32 v33, v33
    v_exp_f32 v34, v34
    v_exp_f32 v35, v35
    v_exp_f32 v48, v48
    v_exp_f32 v49, v49
    v_fma_f32 v36, v36, s45, -v23
    v_fma_f32 v37, v37, s45, -v23
    v_fma_f32 v38, v38, s45, -v23
    v_fma_f32 v39, v39, s45, -v23
    v_fma_f32 v44, v44, s45, -v23
    v_fma_f32 v45, v45, s45, -v23
    v_fma_f32 v46, v46, s45, -v23
    v_fma_f32 v47, v47, s45, -v23
    v_fma_f32 v52, v52, s45, -v23
    v_fma_f32 v53, v53, s45, -v23
    v_exp_f32 v36, v36
    v_exp_f32 v37, v37
    v_exp_f32 v38, v38
    v_exp_f32 v39, v39
    v_exp_f32 v44, v44
    v_exp_f32 v45, v45
    v_exp_f32 v46, v46
    v_exp_f32 v47, v47
    v_exp_f32 v52, v52
    v_exp_f32 v53, v53
    v_add_f32 v22, v32, v33
    v_add_f32 v22, v22, v34
    v_add_f32 v22, v22, v35
    v_add_f32 v22, v22, v48
    v_add_f32 v22, v22, v49
    v_add_f32 v23, v36, v37
    v_add_f32 v23, v23, v38
    v_add_f32 v23, v23, v39
    v_add_f32 v23, v23, v44
    v_add_f32 v23, v23, v45
    v_add_f32 v23, v23, v46
    v_add_f32 v23, v23, v47
    v_add_f32 v23, v23, v52
    v_add_f32 v23, v23, v53
    v_mov_b32 v24, v22
    v_mov_b32 v25, v23
    s_nop 0
    v_permlane32_swap_b32 v22, v24
    v_permlane32_swap_b32 v23, v25
    v_add_f32 v22, v22, v24
    v_add_f32 v23, v23, v25
    v_mov_b32 v24, v22
    v_mov_b32 v25, v23
    s_nop 0
    v_permlane16_swap_b32 v22, v24
    v_permlane16_swap_b32 v23, v25
    v_add_f32 v22, v22, v24
    v_add_f32 v23, v23, v25
    v_rcp_f32 v22, v22
    v_rcp_f32 v23, v23
    s_nop 0
    v_mul_f32 v32, v32, v22
    v_mul_f32 v33, v33, v22
    v_mul_f32 v34, v34, v22
    v_mul_f32 v35, v35, v22
    v_mul_f32 v48, v48, v22
    v_mul_f32 v49, v49, v22
    v_mul_f32 v36, v36, v23
    v_mul_f32 v37, v37, v23
    v_mul_f32 v38, v38, v23
    v_mul_f32 v39, v39, v23
    v_mul_f32 v44, v44, v23
    v_mul_f32 v45, v45, v23
    v_mul_f32 v46, v46, v23
    v_mul_f32 v47, v47, v23
    v_mul_f32 v52, v52, v23
    v_mul_f32 v53, v53, v23
    v_cvt_pk_bf16_f32 v128, v32, v33
    v_cvt_pk_bf16_f32 v129, v34, v35
    v_mov_b32 v130, 0
    v_mov_b32 v131, 0
    v_cvt_pk_bf16_f32 v132, v48, v49
    v_mov_b32 v133, 0
    v_mov_b32 v134, 0
    v_cvt_pk_bf16_f32 v135, v48, v49
    v_cvt_pk_bf16_f32 v136, v36, v37
    v_cvt_pk_bf16_f32 v137, v38, v39
    v_cvt_pk_bf16_f32 v138, v44, v45
    v_cvt_pk_bf16_f32 v139, v46, v47
    v_cvt_pk_bf16_f32 v140, v52, v53
    v_mov_b32 v141, 0
    v_mov_b32 v142, 0
    v_cvt_pk_bf16_f32 v143, v52, v53
    s_waitcnt vmcnt(0) lgkmcnt(0)
    s_nop 0
    v_mfma_f32_16x16x32_bf16 v[64:67], v[208:211], v[128:131], 0
    v_mfma_f32_16x16x32_bf16 v[68:71], v[212:215], v[128:131], 0
    v_mfma_f32_16x16x32_bf16 v[72:75], v[216:219], v[128:131], 0
    v_mfma_f32_16x16x32_bf16 v[76:79], v[220:223], v[128:131], 0
    v_mfma_f32_16x16x32_bf16 v[80:83], v[224:227], v[128:131], 0
    v_mfma_f32_16x16x32_bf16 v[84:87], v[228:231], v[128:131], 0
    v_mfma_f32_16x16x32_bf16 v[88:91], v[232:235], v[128:131], 0
    v_mfma_f32_16x16x32_bf16 v[92:95], v[236:239], v[128:131], 0
    v_mfma_f32_16x16x16_bf16 v[64:67], v[240:241], v[132:133], v[64:67]
    v_mfma_f32_16x16x16_bf16 v[68:71], v[240:241], v[134:135], v[68:71]
    v_mfma_f32_16x16x16_bf16 v[72:75], v[242:243], v[132:133], v[72:75]
    v_mfma_f32_16x16x16_bf16 v[76:79], v[242:243], v[134:135], v[76:79]
    v_mfma_f32_16x16x16_bf16 v[80:83], v[244:245], v[132:133], v[80:83]
    v_mfma_f32_16x16x16_bf16 v[84:87], v[244:245], v[134:135], v[84:87]
    v_mfma_f32_16x16x16_bf16 v[88:91], v[246:247], v[132:133], v[88:91]
    v_mfma_f32_16x16x16_bf16 v[92:95], v[246:247], v[134:135], v[92:95]
    v_mfma_f32_16x16x32_bf16 v[96:99], v[208:211], v[136:139], 0
    v_mfma_f32_16x16x32_bf16 v[100:103], v[212:215], v[136:139], 0
    v_mfma_f32_16x16x32_bf16 v[104:107], v[216:219], v[136:139], 0
    v_mfma_f32_16x16x32_bf16 v[108:111], v[220:223], v[136:139], 0
    v_mfma_f32_16x16x32_bf16 v[112:115], v[224:227], v[136:139], 0
    v_mfma_f32_16x16x32_bf16 v[116:119], v[228:231], v[136:139], 0
    v_mfma_f32_16x16x32_bf16 v[120:123], v[232:235], v[136:139], 0
    v_mfma_f32_16x16x32_bf16 v[124:127], v[236:239], v[136:139], 0
    v_mfma_f32_16x16x16_bf16 v[96:99], v[240:241], v[140:141], v[96:99]
    v_mfma_f32_16x16x16_bf16 v[100:103], v[240:241], v[142:143], v[100:103]
    v_mfma_f32_16x16x16_bf16 v[104:107], v[242:243], v[140:141], v[104:107]
    v_mfma_f32_16x16x16_bf16 v[108:111], v[242:243], v[142:143], v[108:111]
    v_mfma_f32_16x16x16_bf16 v[112:115], v[244:245], v[140:141], v[112:115]
    v_mfma_f32_16x16x16_bf16 v[116:119], v[244:245], v[142:143], v[116:119]
    v_mfma_f32_16x16x16_bf16 v[120:123], v[246:247], v[140:141], v[120:123]
    v_mfma_f32_16x16x16_bf16 v[124:127], v[246:247], v[142:143], v[124:127]
    v_mul_u32_u24 v19, 272, v14
    v_lshlrev_b32 v20, 3, v16
    v_add3_u32 v19, v19, v20, s47
    s_lshl_b32 s45, s63, 18
    s_lshl_b32 s46, s41, 13
    s_add_u32 s45, s45, s46
    s_add_u32 s45, s45, 0x5000000
    s_add_u32 s46, s45, 4096
    v_cvt_pk_bf16_f32 v64, v64, v65
    v_cvt_pk_bf16_f32 v65, v66, v67
    ds_write_b64 v19, v[64:65] offset:0
    v_cvt_pk_bf16_f32 v68, v68, v69
    v_cvt_pk_bf16_f32 v69, v70, v71
    ds_write_b64 v19, v[68:69] offset:32
    v_cvt_pk_bf16_f32 v72, v72, v73
    v_cvt_pk_bf16_f32 v73, v74, v75
    ds_write_b64 v19, v[72:73] offset:64
    v_cvt_pk_bf16_f32 v76, v76, v77
    v_cvt_pk_bf16_f32 v77, v78, v79
    ds_write_b64 v19, v[76:77] offset:96
    v_cvt_pk_bf16_f32 v80, v80, v81
    v_cvt_pk_bf16_f32 v81, v82, v83
    ds_write_b64 v19, v[80:81] offset:128
    v_cvt_pk_bf16_f32 v84, v84, v85
    v_cvt_pk_bf16_f32 v85, v86, v87
    ds_write_b64 v19, v[84:85] offset:160
    v_cvt_pk_bf16_f32 v88, v88, v89
    v_cvt_pk_bf16_f32 v89, v90, v91
    ds_write_b64 v19, v[88:89] offset:192
    v_cvt_pk_bf16_f32 v92, v92, v93
    v_cvt_pk_bf16_f32 v93, v94, v95
    ds_write_b64 v19, v[92:93] offset:224
    v_cvt_pk_bf16_f32 v96, v96, v97
    v_cvt_pk_bf16_f32 v97, v98, v99
    ds_write_b64 v19, v[96:97] offset:4352
    v_cvt_pk_bf16_f32 v100, v100, v101
    v_cvt_pk_bf16_f32 v101, v102, v103
    ds_write_b64 v19, v[100:101] offset:4384
    v_cvt_pk_bf16_f32 v104, v104, v105
    v_cvt_pk_bf16_f32 v105, v106, v107
    ds_write_b64 v19, v[104:105] offset:4416
    v_cvt_pk_bf16_f32 v108, v108, v109
    v_cvt_pk_bf16_f32 v109, v110, v111
    ds_write_b64 v19, v[108:109] offset:4448
    v_cvt_pk_bf16_f32 v112, v112, v113
    v_cvt_pk_bf16_f32 v113, v114, v115
    ds_write_b64 v19, v[112:113] offset:4480
    v_cvt_pk_bf16_f32 v116, v116, v117
    v_cvt_pk_bf16_f32 v117, v118, v119
    ds_write_b64 v19, v[116:117] offset:4512
    v_cvt_pk_bf16_f32 v120, v120, v121
    v_cvt_pk_bf16_f32 v121, v122, v123
    ds_write_b64 v19, v[120:121] offset:4544
    v_cvt_pk_bf16_f32 v124, v124, v125
    v_cvt_pk_bf16_f32 v125, v126, v127
    ds_write_b64 v19, v[124:125] offset:4576
    s_waitcnt lgkmcnt(0)
    ds_read_b128 v[208:211], v18 offset:0
    ds_read_b128 v[212:215], v18 offset:1088
    ds_read_b128 v[216:219], v18 offset:2176
    ds_read_b128 v[220:223], v18 offset:3264
    ds_read_b128 v[224:227], v18 offset:4352
    ds_read_b128 v[228:231], v18 offset:5440
    ds_read_b128 v[232:235], v18 offset:6528
    ds_read_b128 v[236:239], v18 offset:7616
    s_waitcnt lgkmcnt(7)
    buffer_store_dwordx4 v[208:211], v10, s[12:15], s45 offen offset:0 sc1
    s_waitcnt lgkmcnt(6)
    buffer_store_dwordx4 v[212:215], v10, s[12:15], s45 offen offset:1024 sc1
    s_waitcnt lgkmcnt(5)
    buffer_store_dwordx4 v[216:219], v10, s[12:15], s45 offen offset:2048 sc1
    s_waitcnt lgkmcnt(4)
    buffer_store_dwordx4 v[220:223], v10, s[12:15], s45 offen offset:3072 sc1
    s_waitcnt lgkmcnt(3)
    buffer_store_dwordx4 v[224:227], v10, s[12:15], s46 offen offset:0 sc1
    s_waitcnt lgkmcnt(2)
    buffer_store_dwordx4 v[228:231], v10, s[12:15], s46 offen offset:1024 sc1
    s_waitcnt lgkmcnt(1)
    buffer_store_dwordx4 v[232:235], v10, s[12:15], s46 offen offset:2048 sc1
    s_waitcnt lgkmcnt(0)
    buffer_store_dwordx4 v[236:239], v10, s[12:15], s46 offen offset:3072 sc1
L_a_skip_48:
    s_waitcnt vmcnt(0)
    s_barrier
    s_cmp_lg_u32 s44, 0
    s_cbranch_scc1 L_pub_50
    v_mov_b32 v30, s62
    v_mov_b32 v31, 0
    s_mov_b64 exec, 1
    buffer_store_dword v30, v31, s[12:15], s65 offen sc1
    s_mov_b64 exec, -1
L_pub_50:
    s_lshl_b32 s45, s38, 5
    s_add_u32 s45, s45, s64
    s_mov_b64 exec, 255
    s_mov_b32 s70, 0
L_wp_51:
    buffer_load_dword v31, v12, s[12:15], s45 offen sc1
    s_add_u32 s70, s70, 1
    s_cmp_ge_u32 s70, 0x200000
    s_cbranch_scc1 L_w_done_33
    s_waitcnt vmcnt(0)
    v_cmp_gt_u32 vcc, s62, v31
    s_nop 1
    s_cbranch_vccz L_wp_51_ok
    s_sleep 1
    s_branch L_wp_51
L_wp_51_ok:
    s_mov_b64 exec, -1
    s_mul_i32 s53, s50, 262144
    s_add_u32 s53, s53, s52
    s_lshl_b32 s45, s44, 11
    s_add_u32 s53, s53, s45
    s_mul_i32 s57, s50, 131072
    s_add_u32 s57, s57, s56
    s_mul_i32 s54, s44, 8320
    s_add_u32 s55, s54, 66560
    s_mov_b32 s58, 0
    v_mov_b32 v13, v4
    s_mov_b32 s59, 66560
    s_add_u32 m0, s54, 0
    s_nop 0
    buffer_load_dwordx4 v2, s[12:15], s53 offen offset:0 sc1 lds
    s_add_u32 m0, s54, 784
    s_nop 0
    buffer_load_dwordx4 v2, s[12:15], s53 offen offset:256 sc1 lds
    s_add_u32 m0, s54, 1568
    s_nop 0
    buffer_load_dwordx4 v2, s[12:15], s53 offen offset:512 sc1 lds
    s_add_u32 m0, s54, 2352
    s_nop 0
    buffer_load_dwordx4 v2, s[12:15], s53 offen offset:768 sc1 lds
    s_add_u32 m0, s54, 3136
    s_nop 0
    buffer_load_dwordx4 v2, s[12:15], s53 offen offset:1024 sc1 lds
    s_add_u32 m0, s54, 3920
    s_nop 0
    buffer_load_dwordx4 v2, s[12:15], s53 offen offset:1280 sc1 lds
    s_add_u32 m0, s54, 4704
    s_nop 0
    buffer_load_dwordx4 v2, s[12:15], s53 offen offset:1536 sc1 lds
    s_add_u32 m0, s54, 5488
    s_nop 0
    buffer_load_dwordx4 v2, s[12:15], s53 offen offset:1792 sc1 lds
    s_add_u32 s45, s53, 32768
    s_add_u32 s46, s54, 33280
    s_add_u32 m0, s46, 0
    s_nop 0
    buffer_load_dwordx4 v2, s[12:15], s45 offen offset:0 sc1 lds
    s_add_u32 m0, s46, 784
    s_nop 0
    buffer_load_dwordx4 v2, s[12:15], s45 offen offset:256 sc1 lds
    s_add_u32 m0, s46, 1568
    s_nop 0
    buffer_load_dwordx4 v2, s[12:15], s45 offen offset:512 sc1 lds
    s_add_u32 m0, s46, 2352
    s_nop 0
    buffer_load_dwordx4 v2, s[12:15], s45 offen offset:768 sc1 lds
    s_add_u32 m0, s46, 3136
    s_nop 0
    buffer_load_dwordx4 v2, s[12:15], s45 offen offset:1024 sc1 lds
    s_add_u32 m0, s46, 3920
    s_nop 0
    buffer_load_dwordx4 v2, s[12:15], s45 offen offset:1280 sc1 lds
    s_add_u32 m0, s46, 4704
    s_nop 0
    buffer_load_dwordx4 v2, s[12:15], s45 offen offset:1536 sc1 lds
    s_add_u32 m0, s46, 5488
    s_nop 0
    buffer_load_dwordx4 v2, s[12:15], s45 offen offset:1792 sc1 lds
    s_add_u32 s45, s53, 262144
    s_cmp_gt_u32 s51, 1
    s_cselect_b32 s45, s45, 0x20000000
    s_add_u32 m0, s55, 0
    s_nop 0
    buffer_load_dwordx4 v2, s[12:15], s45 offen offset:0 sc1 lds
    s_add_u32 m0, s55, 784
    s_nop 0
    buffer_load_dwordx4 v2, s[12:15], s45 offen offset:256 sc1 lds
    s_add_u32 m0, s55, 1568
    s_nop 0
    buffer_load_dwordx4 v2, s[12:15], s45 offen offset:512 sc1 lds
    s_add_u32 m0, s55, 2352
    s_nop 0
    buffer_load_dwordx4 v2, s[12:15], s45 offen offset:768 sc1 lds
    s_add_u32 m0, s55, 3136
    s_nop 0
    buffer_load_dwordx4 v2, s[12:15], s45 offen offset:1024 sc1 lds
    s_add_u32 m0, s55, 3920
    s_nop 0
    buffer_load_dwordx4 v2, s[12:15], s45 offen offset:1280 sc1 lds
    s_add_u32 m0, s55, 4704
    s_nop 0
    buffer_load_dwordx4 v2, s[12:15], s45 offen offset:1536 sc1 lds
    s_add_u32 m0, s55, 5488
    s_nop 0
    buffer_load_dwordx4 v2, s[12:15], s45 offen offset:1792 sc1 lds
L_e_loop_52:
    s_add_u32 s45, s53, 294912
    s_add_u32 s46, s58, 1
    s_cmp_lt_u32 s46, s51
    s_cselect_b32 s48, s45, 0x20000000
    s_add_u32 s49, s55, 33280
    s_waitcnt vmcnt(16)
    s_barrier
    ds_read_b128 v[32:35], v13 offset:0
    ds_read_b128 v[36:39], v13 offset:32
    ds_read_b128 v[40:43], v13 offset:64
    ds_read_b128 v[44:47], v13 offset:96
    ds_read_b128 v[48:51], v13 offset:128
    ds_read_b128 v[52:55], v13 offset:160
    s_waitcnt lgkmcnt(4)
    v_mfma_f32_32x32x16_bf16 v[64:79], a[0:3], v[32:35], 0
    ds_read_b128 v[56:59], v13 offset:192
    v_mfma_f32_32x32x16_bf16 v[64:79], a[4:7], v[36:39], v[64:79]
    ds_read_b128 v[60:63], v13 offset:224
    s_add_u32 m0, s49, 0
    s_nop 0
    buffer_load_dwordx4 v2, s[12:15], s48 offen offset:0 sc1 lds
    s_waitcnt lgkmcnt(4)
    v_mfma_f32_32x32x16_bf16 v[64:79], a[8:11], v[40:43], v[64:79]
    ds_read_b128 v[32:35], v13 offset:256
    v_mfma_f32_32x32x16_bf16 v[64:79], a[12:15], v[44:47], v[64:79]
    ds_read_b128 v[36:39], v13 offset:288
    s_add_u32 m0, s49, 784
    s_nop 0
    buffer_load_dwordx4 v2, s[12:15], s48 offen offset:256 sc1 lds
    s_waitcnt lgkmcnt(4)
    v_mfma_f32_32x32x16_bf16 v[64:79], a[16:19], v[48:51], v[64:79]
    ds_read_b128 v[40:43], v13 offset:320
    v_mfma_f32_32x32x16_bf16 v[64:79], a[20:23], v[52:55], v[64:79]
    ds_read_b128 v[44:47], v13 offset:352
    s_add_u32 m0, s49, 1568
    s_nop 0
    buffer_load_dwordx4 v2, s[12:15], s48 offen offset:512 sc1 lds
    s_waitcnt lgkmcnt(4)
    v_mfma_f32_32x32x16_bf16 v[64:79], a[24:27], v[56:59], v[64:79]
    ds_read_b128 v[48:51], v13 offset:384
    v_mfma_f32_32x32x16_bf16 v[64:79], a[28:31], v[60:63], v[64:79]
    ds_read_b128 v[52:55], v13 offset:416
    s_add_u32 m0, s49, 2352
    s_nop 0
    buffer_load_dwordx4 v2, s[12:15], s48 offen offset:768 sc1 lds
    s_waitcnt lgkmcnt(4)
    v_mfma_f32_32x32x16_bf16 v[64:79], a[32:35], v[32:35], v[64:79]
    ds_read_b128 v[56:59], v13 offset:448
    v_mfma_f32_32x32x16_bf16 v[64:79], a[36:39], v[36:39], v[64:79]
    ds_read_b128 v[60:63], v13 offset:480
    s_add_u32 m0, s49, 3136
    s_nop 0
    buffer_load_dwordx4 v2, s[12:15], s48 offen offset:1024 sc1 lds
    s_waitcnt lgkmcnt(4)
    v_mfma_f32_32x32x16_bf16 v[64:79], a[40:43], v[40:43], v[64:79]
    ds_read_b128 v[32:35], v13 offset:512
    v_mfma_f32_32x32x16_bf16 v[64:79], a[44:47], v[44:47], v[64:79]
    ds_read_b128 v[36:39], v13 offset:544
    s_add_u32 m0, s49, 3920
    s_nop 0
    buffer_load_dwordx4 v2, s[12:15], s48 offen offset:1280 sc1 lds
    s_waitcnt lgkmcnt(4)
    v_mfma_f32_32x32x16_bf16 v[64:79], a[48:51], v[48:51], v[64:79]
    ds_read_b128 v[40:43], v13 offset:576
    v_mfma_f32_32x32x16_bf16 v[64:79], a[52:55], v[52:55], v[64:79]
    ds_read_b128 v[44:47], v13 offset:608
    s_add_u32 m0, s49, 4704
    s_nop 0
    buffer_load_dwordx4 v2, s[12:15], s48 offen offset:1536 sc1 lds
    s_waitcnt lgkmcnt(4)
    v_mfma_f32_32x32x16_bf16 v[64:79], a[56:59], v[56:59], v[64:79]
    ds_read_b128 v[48:51], v13 offset:640
    v_mfma_f32_32x32x16_bf16 v[64:79], a[60:63], v[60:63], v[64:79]
    ds_read_b128 v[52:55], v13 offset:672
    s_add_u32 m0, s49, 5488
    s_nop 0
    buffer_load_dwordx4 v2, s[12:15], s48 offen offset:1792 sc1 lds
    s_waitcnt lgkmcnt(4)
    v_mfma_f32_32x32x16_bf16 v[64:79], a[64:67], v[32:35], v[64:79]
    ds_read_b128 v[56:59], v13 offset:704
    v_mfma_f32_32x32x16_bf16 v[64:79], a[68:71], v[36:39], v[64:79]
    ds_read_b128 v[60:63], v13 offset:736
    s_waitcnt lgkmcnt(4)
    v_mfma_f32_32x32x16_bf16 v[64:79], a[72:75], v[40:43], v[64:79]
    ds_read_b128 v[32:35], v13 offset:768
    v_mfma_f32_32x32x16_bf16 v[64:79], a[76:79], v[44:47], v[64:79]
    ds_read_b128 v[36:39], v13 offset:800
    s_waitcnt lgkmcnt(4)
    v_mfma_f32_32x32x16_bf16 v[64:79], a[80:83], v[48:51], v[64:79]
    ds_read_b128 v[40:43], v13 offset:832
    v_mfma_f32_32x32x16_bf16 v[64:79], a[84:87], v[52:55], v[64:79]
    ds_read_b128 v[44:47], v13 offset:864
    s_waitcnt lgkmcnt(4)
    v_mfma_f32_32x32x16_bf16 v[64:79], a[88:91], v[56:59], v[64:79]
    ds_read_b128 v[48:51], v13 offset:896
    v_mfma_f32_32x32x16_bf16 v[64:79], a[92:95], v[60:63], v[64:79]
    ds_read_b128 v[52:55], v13 offset:928
    s_waitcnt lgkmcnt(4)
    v_mfma_f32_32x32x16_bf16 v[64:79], a[96:99], v[32:35], v[64:79]
    ds_read_b128 v[56:59], v13 offset:960
    v_mfma_f32_32x32x16_bf16 v[64:79], a[100:103], v[36:39], v[64:79]
    ds_read_b128 v[60:63], v13 offset:992
    s_waitcnt lgkmcnt(4)
    v_mfma_f32_32x32x16_bf16 v[64:79], a[104:107], v[40:43], v[64:79]
    v_mfma_f32_32x32x16_bf16 v[64:79], a[108:111], v[44:47], v[64:79]
    s_waitcnt lgkmcnt(2)
    v_mfma_f32_32x32x16_bf16 v[64:79], a[112:115], v[48:51], v[64:79]
    v_mfma_f32_32x32x16_bf16 v[64:79], a[116:119], v[52:55], v[64:79]
    s_waitcnt lgkmcnt(0)
    v_mfma_f32_32x32x16_bf16 v[64:79], a[120:123], v[56:59], v[64:79]
    v_mfma_f32_32x32x16_bf16 v[64:79], a[124:127], v[60:63], v[64:79]
    s_add_u32 s45, s53, 524288
    s_add_u32 s46, s58, 2
    s_cmp_lt_u32 s46, s51
    s_cselect_b32 s48, s45, 0x20000000
    s_mov_b32 s49, s54
    s_waitcnt vmcnt(16)
    s_barrier
    ds_read_b128 v[32:35], v13 offset:33280
    ds_read_b128 v[36:39], v13 offset:33312
    ds_read_b128 v[40:43], v13 offset:33344
    ds_read_b128 v[44:47], v13 offset:33376
    ds_read_b128 v[48:51], v13 offset:33408
    ds_read_b128 v[52:55], v13 offset:33440
    s_waitcnt lgkmcnt(4)
    v_mfma_f32_32x32x16_bf16 v[64:79], a[128:131], v[32:35], v[64:79]
    ds_read_b128 v[56:59], v13 offset:33472
    v_mfma_f32_32x32x16_bf16 v[64:79], a[132:135], v[36:39], v[64:79]
    ds_read_b128 v[60:63], v13 offset:33504
    s_add_u32 m0, s49, 0
    s_nop 0
    buffer_load_dwordx4 v2, s[12:15], s48 offen offset:0 sc1 lds
    s_waitcnt lgkmcnt(4)
    v_mfma_f32_32x32x16_bf16 v[64:79], a[136:139], v[40:43], v[64:79]
    ds_read_b128 v[32:35], v13 offset:33536
    v_mfma_f32_32x32x16_bf16 v[64:79], a[140:143], v[44:47], v[64:79]
    ds_read_b128 v[36:39], v13 offset:33568
    s_add_u32 m0, s49, 784
    s_nop 0
    buffer_load_dwordx4 v2, s[12:15], s48 offen offset:256 sc1 lds
    s_waitcnt lgkmcnt(4)
    v_mfma_f32_32x32x16_bf16 v[64:79], a[144:147], v[48:51], v[64:79]
    ds_read_b128 v[40:43], v13 offset:33600
    v_mfma_f32_32x32x16_bf16 v[64:79], a[148:151], v[52:55], v[64:79]
    ds_read_b128 v[44:47], v13 offset:33632
    s_add_u32 m0, s49, 1568
    s_nop 0
    buffer_load_dwordx4 v2, s[12:15], s48 offen offset:512 sc1 lds
    s_waitcnt lgkmcnt(4)
    v_mfma_f32_32x32x16_bf16 v[64:79], a[152:155], v[56:59], v[64:79]
    ds_read_b128 v[48:51], v13 offset:33664
    v_mfma_f32_32x32x16_bf16 v[64:79], a[156:159], v[60:63], v[64:79]
    ds_read_b128 v[52:55], v13 offset:33696
    s_add_u32 m0, s49, 2352
    s_nop 0
    buffer_load_dwordx4 v2, s[12:15], s48 offen offset:768 sc1 lds
    s_waitcnt lgkmcnt(4)
    v_mfma_f32_32x32x16_bf16 v[64:79], a[160:163], v[32:35], v[64:79]
    ds_read_b128 v[56:59], v13 offset:33728
    v_mfma_f32_32x32x16_bf16 v[64:79], a[164:167], v[36:39], v[64:79]
    ds_read_b128 v[60:63], v13 offset:33760
    s_add_u32 m0, s49, 3136
    s_nop 0
    buffer_load_dwordx4 v2, s[12:15], s48 offen offset:1024 sc1 lds
    s_waitcnt lgkmcnt(4)
    v_mfma_f32_32x32x16_bf16 v[64:79], a[168:171], v[40:43], v[64:79]
    ds_read_b128 v[32:35], v13 offset:33792
    v_mfma_f32_32x32x16_bf16 v[64:79], a[172:175], v[44:47], v[64:79]
    ds_read_b128 v[36:39], v13 offset:33824
    s_add_u32 m0, s49, 3920
    s_nop 0
    buffer_load_dwordx4 v2, s[12:15], s48 offen offset:1280 sc1 lds
    s_waitcnt lgkmcnt(4)
    v_mfma_f32_32x32x16_bf16 v[64:79], a[176:179], v[48:51], v[64:79]
    ds_read_b128 v[40:43], v13 offset:33856
    v_mfma_f32_32x32x16_bf16 v[64:79], a[180:183], v[52:55], v[64:79]
    ds_read_b128 v[44:47], v13 offset:33888
    s_add_u32 m0, s49, 4704
    s_nop 0
    buffer_load_dwordx4 v2, s[12:15], s48 offen offset:1536 sc1 lds
    s_waitcnt lgkmcnt(4)
    v_mfma_f32_32x32x16_bf16 v[64:79], a[184:187], v[56:59], v[64:79]
    ds_read_b128 v[48:51], v13 offset:33920
    v_mfma_f32_32x32x16_bf16 v[64:79], a[188:191], v[60:63], v[64:79]
    ds_read_b128 v[52:55], v13 offset:33952
    s_add_u32 m0, s49, 5488
    s_nop 0
    buffer_load_dwordx4 v2, s[12:15], s48 offen offset:1792 sc1 lds
    s_waitcnt lgkmcnt(4)
    v_mfma_f32_32x32x16_bf16 v[64:79], a[192:195], v[32:35], v[64:79]
    ds_read_b128 v[56:59], v13 offset:33984
    v_mfma_f32_32x32x16_bf16 v[64:79], a[196:199], v[36:39], v[64:79]
    ds_read_b128 v[60:63], v13 offset:34016
    s_waitcnt lgkmcnt(4)
    v_mfma_f32_32x32x16_bf16 v[64:79], a[200:203], v[40:43], v[64:79]
    ds_read_b128 v[32:35], v13 offset:34048
    v_mfma_f32_32x32x16_bf16 v[64:79], a[204:207], v[44:47], v[64:79]
    ds_read_b128 v[36:39], v13 offset:34080
    s_waitcnt lgkmcnt(4)
    v_mfma_f32_32x32x16_bf16 v[64:79], a[208:211], v[48:51], v[64:79]
    ds_read_b128 v[40:43], v13 offset:34112
    v_mfma_f32_32x32x16_bf16 v[64:79], a[212:215], v[52:55], v[64:79]
    ds_read_b128 v[44:47], v13 offset:34144
    s_waitcnt lgkmcnt(4)
    v_mfma_f32_32x32x16_bf16 v[64:79], a[216:219], v[56:59], v[64:79]
    ds_read_b128 v[48:51], v13 offset:34176
    v_mfma_f32_32x32x16_bf16 v[64:79], a[220:223], v[60:63], v[64:79]
    ds_read_b128 v[52:55], v13 offset:34208
    s_waitcnt lgkmcnt(4)
    v_mfma_f32_32x32x16_bf16 v[64:79], a[224:227], v[32:35], v[64:79]
    ds_read_b128 v[56:59], v13 offset:34240
    v_mfma_f32_32x32x16_bf16 v[64:79], a[228:231], v[36:39], v[64:79]
    ds_read_b128 v[60:63], v13 offset:34272
    s_waitcnt lgkmcnt(4)
    v_mfma_f32_32x32x16_bf16 v[64:79], a[232:235], v[40:43], v[64:79]
    v_mfma_f32_32x32x16_bf16 v[64:79], a[236:239], v[44:47], v[64:79]
    s_waitcnt lgkmcnt(2)
    v_mfma_f32_32x32x16_bf16 v[64:79], a[240:243], v[48:51], v[64:79]
    v_mfma_f32_32x32x16_bf16 v[64:79], a[244:247], v[52:55], v[64:79]
    s_waitcnt lgkmcnt(0)
    v_mfma_f32_32x32x16_bf16 v[64:79], a[248:251], v[56:59], v[64:79]
    v_mfma_f32_32x32x16_bf16 v[64:79], a[252:255], v[60:63], v[64:79]
    s_add_u32 s53, s53, 262144
    s_add_u32 s58, s58, 1
    v_add_u32 v13, s59, v13
    s_add_u32 s54, s54, s59
    s_sub_u32 s55, s55, s59
    s_sub_u32 s59, 0, s59
    s_lshl_b32 s45, s44, 15
    s_add_u32 s45, s45, s57
    s_add_u32 s57, s57, 131072
    s_nop 3
    ds_write_b128 v7, v[64:67] offset:0
    ds_write_b128 v7, v[68:71] offset:16
    ds_write_b128 v7, v[72:75] offset:32
    ds_write_b128 v7, v[76:79] offset:48
    s_waitcnt lgkmcnt(0)
    s_barrier
    ds_read_b128 v[80:83], v9 offset:0
    ds_read_b128 v[84:87], v9 offset:1056
    ds_read_b128 v[88:91], v9 offset:2112
    ds_read_b128 v[92:95], v9 offset:3168
    s_waitcnt lgkmcnt(3)
    buffer_store_dwordx4 v[80:83], v11, s[12:15], s45 offen sc1
    s_add_u32 s45, s45, 8192
    s_waitcnt lgkmcnt(2)
    buffer_store_dwordx4 v[84:87], v11, s[12:15], s45 offen sc1
    s_add_u32 s45, s45, 8192
    s_waitcnt lgkmcnt(1)
    buffer_store_dwordx4 v[88:91], v11, s[12:15], s45 offen sc1
    s_add_u32 s45, s45, 8192
    s_waitcnt lgkmcnt(0)
    buffer_store_dwordx4 v[92:95], v11, s[12:15], s45 offen sc1
    s_cmp_lt_u32 s58, s51
    s_cbranch_scc1 L_e_loop_52
    s_add_u32 s47, s65, 256
    s_waitcnt vmcnt(0)
    s_barrier
    s_cmp_lg_u32 s44, 0
    s_cbranch_scc1 L_pub_53
    v_mov_b32 v30, s62
    v_mov_b32 v31, 0
    s_mov_b64 exec, 1
    buffer_store_dword v30, v31, s[12:15], s47 offen sc1
    s_mov_b64 exec, -1
L_pub_53:
    s_branch L_a_loop_47
L_role_b_43:
    s_load_dwordx2 s[6:7], s[0:1], 64
    s_load_dwordx2 s[8:9], s[0:1], 72
    s_waitcnt lgkmcnt(0)
    s_mov_b32 s24, s6
    s_and_b32 s25, s7, 0xffff
    s_mov_b32 s26, 0x700000
    s_mov_b32 s27, 0x00020000
    s_mov_b32 s32, s8
    s_and_b32 s33, s9, 0xffff
    s_mov_b32 s34, 0x1c00
    s_mov_b32 s35, 0x00020000
    s_min_u32 s45, s41, 27
    s_lshl_b32 s46, s45, 8
    s_waitcnt vmcnt(0)
    s_barrier
    v_lshrrev_b32 v20, 4, v1
    s_lshl_b32 s45, s44, 2
    v_add_u32 v21, s45, v20
    s_mov_b32 s45, 7168
    v_mul_lo_u32 v21, v21, s45
    v_lshlrev_b32 v22, 2, v20
    v_and_b32 v23, 15, v1
    v_xor_b32 v22, v22, v23
    v_lshlrev_b32 v22, 4, v22
    v_add_u32 v21, v21, v22
    v_bfe_u32 v22, v1, 2, 2
    v_lshrrev_b32 v23, 5, v1
    v_lshlrev_b32 v23, 3, v23
    v_add_u32 v23, v23, v22
    v_lshlrev_b32 v23, 8, v23
    v_xor_b32 v22, s44, v22
    v_lshlrev_b32 v22, 6, v22
    v_add_u32 v23, v23, v22
    v_and_b32 v22, 1, v1
    v_lshlrev_b32 v22, 5, v22
    v_add_u32 v23, v23, v22
    v_and_b32 v22, 16, v1
    v_add_u32 v23, v23, v22
    v_and_b32 v22, 2, v1
    v_lshlrev_b32 v22, 2, v22
    v_add_u32 v23, v23, v22
    v_add_u32 v24, 65536, v23
    v_add_u32 v25, 131072, v23
    s_lshl_b32 s47, s44, 10
    s_add_u32 s45, s46, 0x0
    s_add_u32 m0, s47, 0
    s_nop 0
    buffer_load_dwordx4 v21, s[24:27], s45 offen lds
    s_add_u32 s45, s46, 0x1c000
    s_add_u32 m0, s47, 4096
    s_nop 0
    buffer_load_dwordx4 v21, s[24:27], s45 offen lds
    s_add_u32 s45, s46, 0x38000
    s_add_u32 m0, s47, 8192
    s_nop 0
    buffer_load_dwordx4 v21, s[24:27], s45 offen lds
    s_add_u32 s45, s46, 0x54000
    s_add_u32 m0, s47, 12288
    s_nop 0
    buffer_load_dwordx4 v21, s[24:27], s45 offen lds
    s_add_u32 s45, s46, 0x70000
    s_add_u32 m0, s47, 16384
    s_nop 0
    buffer_load_dwordx4 v21, s[24:27], s45 offen lds
    s_add_u32 s45, s46, 0x8c000
    s_add_u32 m0, s47, 20480
    s_nop 0
    buffer_load_dwordx4 v21, s[24:27], s45 offen lds
    s_add_u32 s45, s46, 0xa8000
    s_add_u32 m0, s47, 24576
    s_nop 0
    buffer_load_dwordx4 v21, s[24:27], s45 offen lds
    s_add_u32 s45, s46, 0xc4000
    s_add_u32 m0, s47, 28672
    s_nop 0
    buffer_load_dwordx4 v21, s[24:27], s45 offen lds
    s_add_u32 s45, s46, 0xe0000
    s_add_u32 m0, s47, 32768
    s_nop 0
    buffer_load_dwordx4 v21, s[24:27], s45 offen lds
    s_add_u32 s45, s46, 0xfc000
    s_add_u32 m0, s47, 36864
    s_nop 0
    buffer_load_dwordx4 v21, s[24:27], s45 offen lds
    s_add_u32 s45, s46, 0x118000
    s_add_u32 m0, s47, 40960
    s_nop 0
    buffer_load_dwordx4 v21, s[24:27], s45 offen lds
    s_add_u32 s45, s46, 0x134000
    s_add_u32 m0, s47, 45056
    s_nop 0
    buffer_load_dwordx4 v21, s[24:27], s45 offen lds
    s_add_u32 s45, s46, 0x150000
    s_add_u32 m0, s47, 49152
    s_nop 0
    buffer_load_dwordx4 v21, s[24:27], s45 offen lds
    s_add_u32 s45, s46, 0x16c000
    s_add_u32 m0, s47, 53248
    s_nop 0
    buffer_load_dwordx4 v21, s[24:27], s45 offen lds
    s_add_u32 s45, s46, 0x188000
    s_add_u32 m0, s47, 57344
    s_nop 0
    buffer_load_dwordx4 v21, s[24:27], s45 offen lds
    s_add_u32 s45, s46, 0x1a4000
    s_add_u32 m0, s47, 61440
    s_nop 0
    buffer_load_dwordx4 v21, s[24:27], s45 offen lds
    s_add_u32 s45, s46, 0x1c0000
    s_add_u32 m0, s47, 65536
    s_nop 0
    buffer_load_dwordx4 v21, s[24:27], s45 offen lds
    s_add_u32 s45, s46, 0x1dc000
    s_add_u32 m0, s47, 69632
    s_nop 0
    buffer_load_dwordx4 v21, s[24:27], s45 offen lds
    s_add_u32 s45, s46, 0x1f8000
    s_add_u32 m0, s47, 73728
    s_nop 0
    buffer_load_dwordx4 v21, s[24:27], s45 offen lds
    s_add_u32 s45, s46, 0x214000
    s_add_u32 m0, s47, 77824
    s_nop 0
    buffer_load_dwordx4 v21, s[24:27], s45 offen lds
    s_add_u32 s45, s46, 0x230000
    s_add_u32 m0, s47, 81920
    s_nop 0
    buffer_load_dwordx4 v21, s[24:27], s45 offen lds
    s_add_u32 s45, s46, 0x24c000
    s_add_u32 m0, s47, 86016
    s_nop 0
    buffer_load_dwordx4 v21, s[24:27], s45 offen lds
    s_add_u32 s45, s46, 0x268000
    s_add_u32 m0, s47, 90112
    s_nop 0
    buffer_load_dwordx4 v21, s[24:27], s45 offen lds
    s_add_u32 s45, s46, 0x284000
    s_add_u32 m0, s47, 94208
    s_nop 0
    buffer_load_dwordx4 v21, s[24:27], s45 offen lds
    s_add_u32 s45, s46, 0x2a0000
    s_add_u32 m0, s47, 98304
    s_nop 0
    buffer_load_dwordx4 v21, s[24:27], s45 offen lds
    s_add_u32 s45, s46, 0x2bc000
    s_add_u32 m0, s47, 102400
    s_nop 0
    buffer_load_dwordx4 v21, s[24:27], s45 offen lds
    s_add_u32 s45, s46, 0x2d8000
    s_add_u32 m0, s47, 106496
    s_nop 0
    buffer_load_dwordx4 v21, s[24:27], s45 offen lds
    s_add_u32 s45, s46, 0x2f4000
    s_add_u32 m0, s47, 110592
    s_nop 0
    buffer_load_dwordx4 v21, s[24:27], s45 offen lds
    s_add_u32 s45, s46, 0x310000
    s_add_u32 m0, s47, 114688
    s_nop 0
    buffer_load_dwordx4 v21, s[24:27], s45 offen lds
    s_add_u32 s45, s46, 0x32c000
    s_add_u32 m0, s47, 118784
    s_nop 0
    buffer_load_dwordx4 v21, s[24:27], s45 offen lds
    s_add_u32 s45, s46, 0x348000
    s_add_u32 m0, s47, 122880
    s_nop 0
    buffer_load_dwordx4 v21, s[24:27], s45 offen lds
    s_add_u32 s45, s46, 0x364000
    s_add_u32 m0, s47, 126976
    s_nop 0
    buffer_load_dwordx4 v21, s[24:27], s45 offen lds
    s_waitcnt vmcnt(28)
    s_barrier
    s_add_u32 s45, s46, 0x380000
    s_add_u32 m0, s47, 131072
    s_nop 0
    buffer_load_dwordx4 v21, s[24:27], s45 offen lds
    s_add_u32 s45, s46, 0x39c000
    s_add_u32 m0, s47, 135168
    s_nop 0
    buffer_load_dwordx4 v21, s[24:27], s45 offen lds
    s_add_u32 s45, s46, 0x3b8000
    s_add_u32 m0, s47, 139264
    s_nop 0
    buffer_load_dwordx4 v21, s[24:27], s45 offen lds
    s_add_u32 s45, s46, 0x3d4000
    s_add_u32 m0, s47, 143360
    s_nop 0
    buffer_load_dwordx4 v21, s[24:27], s45 offen lds
    ds_read_b64_tr_b16 a[0:1], v23 offset:0
    ds_read_b64_tr_b16 a[2:3], v23 offset:1024
    ds_read_b64_tr_b16 a[4:5], v23 offset:4096
    ds_read_b64_tr_b16 a[6:7], v23 offset:5120
    ds_read_b64_tr_b16 a[8:9], v23 offset:8192
    ds_read_b64_tr_b16 a[10:11], v23 offset:9216
    ds_read_b64_tr_b16 a[12:13], v23 offset:12288
    ds_read_b64_tr_b16 a[14:15], v23 offset:13312
    s_waitcnt lgkmcnt(0)
    s_waitcnt vmcnt(28)
    s_barrier
    s_add_u32 s45, s46, 0x3f0000
    s_add_u32 m0, s47, 0
    s_nop 0
    buffer_load_dwordx4 v21, s[24:27], s45 offen lds
    s_add_u32 s45, s46, 0x40c000
    s_add_u32 m0, s47, 4096
    s_nop 0
    buffer_load_dwordx4 v21, s[24:27], s45 offen lds
    s_add_u32 s45, s46, 0x428000
    s_add_u32 m0, s47, 8192
    s_nop 0
    buffer_load_dwordx4 v21, s[24:27], s45 offen lds
    s_add_u32 s45, s46, 0x444000
    s_add_u32 m0, s47, 12288
    s_nop 0
    buffer_load_dwordx4 v21, s[24:27], s45 offen lds
    ds_read_b64_tr_b16 a[16:17], v23 offset:16384
    ds_read_b64_tr_b16 a[18:19], v23 offset:17408
    ds_read_b64_tr_b16 a[20:21], v23 offset:20480
    ds_read_b64_tr_b16 a[22:23], v23 offset:21504
    ds_read_b64_tr_b16 a[24:25], v23 offset:24576
    ds_read_b64_tr_b16 a[26:27], v23 offset:25600
    ds_read_b64_tr_b16 a[28:29], v23 offset:28672
    ds_read_b64_tr_b16 a[30:31], v23 offset:29696
    s_waitcnt lgkmcnt(0)
    s_waitcnt vmcnt(28)
    s_barrier
    s_add_u32 s45, s46, 0x460000
    s_add_u32 m0, s47, 16384
    s_nop 0
    buffer_load_dwordx4 v21, s[24:27], s45 offen lds
    s_add_u32 s45, s46, 0x47c000
    s_add_u32 m0, s47, 20480
    s_nop 0
    buffer_load_dwordx4 v21, s[24:27], s45 offen lds
    s_add_u32 s45, s46, 0x498000
    s_add_u32 m0, s47, 24576
    s_nop 0
    buffer_load_dwordx4 v21, s[24:27], s45 offen lds
    s_add_u32 s45, s46, 0x4b4000
    s_add_u32 m0, s47, 28672
    s_nop 0
    buffer_load_dwordx4 v21, s[24:27], s45 offen lds
    ds_read_b64_tr_b16 a[32:33], v23 offset:32768
    ds_read_b64_tr_b16 a[34:35], v23 offset:33792
    ds_read_b64_tr_b16 a[36:37], v23 offset:36864
    ds_read_b64_tr_b16 a[38:39], v23 offset:37888
    ds_read_b64_tr_b16 a[40:41], v23 offset:40960
    ds_read_b64_tr_b16 a[42:43], v23 offset:41984
    ds_read_b64_tr_b16 a[44:45], v23 offset:45056
    ds_read_b64_tr_b16 a[46:47], v23 offset:46080
    s_waitcnt lgkmcnt(0)
    s_waitcnt vmcnt(28)
    s_barrier
    s_add_u32 s45, s46, 0x4d0000
    s_add_u32 m0, s47, 32768
    s_nop 0
    buffer_load_dwordx4 v21, s[24:27], s45 offen lds
    s_add_u32 s45, s46, 0x4ec000
    s_add_u32 m0, s47, 36864
    s_nop 0
    buffer_load_dwordx4 v21, s[24:27], s45 offen lds
    s_add_u32 s45, s46, 0x508000
    s_add_u32 m0, s47, 40960
    s_nop 0
    buffer_load_dwordx4 v21, s[24:27], s45 offen lds
    s_add_u32 s45, s46, 0x524000
    s_add_u32 m0, s47, 45056
    s_nop 0
    buffer_load_dwordx4 v21, s[24:27], s45 offen lds
    ds_read_b64_tr_b16 a[48:49], v23 offset:49152
    ds_read_b64_tr_b16 a[50:51], v23 offset:50176
    ds_read_b64_tr_b16 a[52:53], v23 offset:53248
    ds_read_b64_tr_b16 a[54:55], v23 offset:54272
    ds_read_b64_tr_b16 a[56:57], v23 offset:57344
    ds_read_b64_tr_b16 a[58:59], v23 offset:58368
    ds_read_b64_tr_b16 a[60:61], v23 offset:61440
    ds_read_b64_tr_b16 a[62:63], v23 offset:62464
    s_waitcnt lgkmcnt(0)
    s_waitcnt vmcnt(28)
    s_barrier
    s_add_u32 s45, s46, 0x540000
    s_add_u32 m0, s47, 49152
    s_nop 0
    buffer_load_dwordx4 v21, s[24:27], s45 offen lds
    s_add_u32 s45, s46, 0x55c000
    s_add_u32 m0, s47, 53248
    s_nop 0
    buffer_load_dwordx4 v21, s[24:27], s45 offen lds
    s_add_u32 s45, s46, 0x578000
    s_add_u32 m0, s47, 57344
    s_nop 0
    buffer_load_dwordx4 v21, s[24:27], s45 offen lds
    s_add_u32 s45, s46, 0x594000
    s_add_u32 m0, s47, 61440
    s_nop 0
    buffer_load_dwordx4 v21, s[24:27], s45 offen lds
    ds_read_b64_tr_b16 a[64:65], v24 offset:0
    ds_read_b64_tr_b16 a[66:67], v24 offset:1024
    ds_read_b64_tr_b16 a[68:69], v24 offset:4096
    ds_read_b64_tr_b16 a[70:71], v24 offset:5120
    ds_read_b64_tr_b16 a[72:73], v24 offset:8192
    ds_read_b64_tr_b16 a[74:75], v24 offset:9216
    ds_read_b64_tr_b16 a[76:77], v24 offset:12288
    ds_read_b64_tr_b16 a[78:79], v24 offset:13312
    s_waitcnt lgkmcnt(0)
    s_waitcnt vmcnt(28)
    s_barrier
    s_add_u32 s45, s46, 0x5b0000
    s_add_u32 m0, s47, 65536
    s_nop 0
    buffer_load_dwordx4 v21, s[24:27], s45 offen lds
    s_add_u32 s45, s46, 0x5cc000
    s_add_u32 m0, s47, 69632
    s_nop 0
    buffer_load_dwordx4 v21, s[24:27], s45 offen lds
    s_add_u32 s45, s46, 0x5e8000
    s_add_u32 m0, s47, 73728
    s_nop 0
    buffer_load_dwordx4 v21, s[24:27], s45 offen lds
    s_add_u32 s45, s46, 0x604000
    s_add_u32 m0, s47, 77824
    s_nop 0
    buffer_load_dwordx4 v21, s[24:27], s45 offen lds
    ds_read_b64_tr_b16 a[80:81], v24 offset:16384
    ds_read_b64_tr_b16 a[82:83], v24 offset:17408
    ds_read_b64_tr_b16 a[84:85], v24 offset:20480
    ds_read_b64_tr_b16 a[86:87], v24 offset:21504
    ds_read_b64_tr_b16 a[88:89], v24 offset:24576
    ds_read_b64_tr_b16 a[90:91], v24 offset:25600
    ds_read_b64_tr_b16 a[92:93], v24 offset:28672
    ds_read_b64_tr_b16 a[94:95], v24 offset:29696
    s_waitcnt lgkmcnt(0)
    s_waitcnt vmcnt(28)
    s_barrier
    s_add_u32 s45, s46, 0x620000
    s_add_u32 m0, s47, 81920
    s_nop 0
    buffer_load_dwordx4 v21, s[24:27], s45 offen lds
    s_add_u32 s45, s46, 0x63c000
    s_add_u32 m0, s47, 86016
    s_nop 0
    buffer_load_dwordx4 v21, s[24:27], s45 offen lds
    s_add_u32 s45, s46, 0x658000
    s_add_u32 m0, s47, 90112
    s_nop 0
    buffer_load_dwordx4 v21, s[24:27], s45 offen lds
    s_add_u32 s45, s46, 0x674000
    s_add_u32 m0, s47, 94208
    s_nop 0
    buffer_load_dwordx4 v21, s[24:27], s45 offen lds
    ds_read_b64_tr_b16 a[96:97], v24 offset:32768
    ds_read_b64_tr_b16 a[98:99], v24 offset:33792
    ds_read_b64_tr_b16 a[100:101], v24 offset:36864
    ds_read_b64_tr_b16 a[102:103], v24 offset:37888
    ds_read_b64_tr_b16 a[104:105], v24 offset:40960
    ds_read_b64_tr_b16 a[106:107], v24 offset:41984
    ds_read_b64_tr_b16 a[108:109], v24 offset:45056
    ds_read_b64_tr_b16 a[110:111], v24 offset:46080
    s_waitcnt lgkmcnt(0)
    s_waitcnt vmcnt(28)
    s_barrier
    s_add_u32 s45, s46, 0x690000
    s_add_u32 m0, s47, 98304
    s_nop 0
    buffer_load_dwordx4 v21, s[24:27], s45 offen lds
    s_add_u32 s45, s46, 0x6ac000
    s_add_u32 m0, s47, 102400
    s_nop 0
    buffer_load_dwordx4 v21, s[24:27], s45 offen lds
    s_add_u32 s45, s46, 0x6c8000
    s_add_u32 m0, s47, 106496
    s_nop 0
    buffer_load_dwordx4 v21, s[24:27], s45 offen lds
    s_add_u32 s45, s46, 0x6e4000
    s_add_u32 m0, s47, 110592
    s_nop 0
    buffer_load_dwordx4 v21, s[24:27], s45 offen lds
    ds_read_b64_tr_b16 a[112:113], v24 offset:49152
    ds_read_b64_tr_b16 a[114:115], v24 offset:50176
    ds_read_b64_tr_b16 a[116:117], v24 offset:53248
    ds_read_b64_tr_b16 a[118:119], v24 offset:54272
    ds_read_b64_tr_b16 a[120:121], v24 offset:57344
    ds_read_b64_tr_b16 a[122:123], v24 offset:58368
    ds_read_b64_tr_b16 a[124:125], v24 offset:61440
    ds_read_b64_tr_b16 a[126:127], v24 offset:62464
    s_waitcnt lgkmcnt(0)
    s_waitcnt vmcnt(28)
    s_barrier
    ds_read_b64_tr_b16 a[128:129], v25 offset:0
    ds_read_b64_tr_b16 a[130:131], v25 offset:1024
    ds_read_b64_tr_b16 a[132:133], v25 offset:4096
    ds_read_b64_tr_b16 a[134:135], v25 offset:5120
    ds_read_b64_tr_b16 a[136:137], v25 offset:8192
    ds_read_b64_tr_b16 a[138:139], v25 offset:9216
    ds_read_b64_tr_b16 a[140:141], v25 offset:12288
    ds_read_b64_tr_b16 a[142:143], v25 offset:13312
    s_waitcnt lgkmcnt(0)
    s_waitcnt vmcnt(24)
    s_barrier
    ds_read_b64_tr_b16 a[144:145], v23 offset:0
    ds_read_b64_tr_b16 a[146:147], v23 offset:1024
    ds_read_b64_tr_b16 a[148:149], v23 offset:4096
    ds_read_b64_tr_b16 a[150:151], v23 offset:5120
    ds_read_b64_tr_b16 a[152:153], v23 offset:8192
    ds_read_b64_tr_b16 a[154:155], v23 offset:9216
    ds_read_b64_tr_b16 a[156:157], v23 offset:12288
    ds_read_b64_tr_b16 a[158:159], v23 offset:13312
    s_waitcnt lgkmcnt(0)
    s_waitcnt vmcnt(20)
    s_barrier
    ds_read_b64_tr_b16 a[160:161], v23 offset:16384
    ds_read_b64_tr_b16 a[162:163], v23 offset:17408
    ds_read_b64_tr_b16 a[164:165], v23 offset:20480
    ds_read_b64_tr_b16 a[166:167], v23 offset:21504
    ds_read_b64_tr_b16 a[168:169], v23 offset:24576
    ds_read_b64_tr_b16 a[170:171], v23 offset:25600
    ds_read_b64_tr_b16 a[172:173], v23 offset:28672
    ds_read_b64_tr_b16 a[174:175], v23 offset:29696
    s_waitcnt lgkmcnt(0)
    s_waitcnt vmcnt(16)
    s_barrier
    ds_read_b64_tr_b16 a[176:177], v23 offset:32768
    ds_read_b64_tr_b16 a[178:179], v23 offset:33792
    ds_read_b64_tr_b16 a[180:181], v23 offset:36864
    ds_read_b64_tr_b16 a[182:183], v23 offset:37888
    ds_read_b64_tr_b16 a[184:185], v23 offset:40960
    ds_read_b64_tr_b16 a[186:187], v23 offset:41984
    ds_read_b64_tr_b16 a[188:189], v23 offset:45056
    ds_read_b64_tr_b16 a[190:191], v23 offset:46080
    s_waitcnt lgkmcnt(0)
    s_waitcnt vmcnt(12)
    s_barrier
    ds_read_b64_tr_b16 a[192:193], v23 offset:49152
    ds_read_b64_tr_b16 a[194:195], v23 offset:50176
    ds_read_b64_tr_b16 a[196:197], v23 offset:53248
    ds_read_b64_tr_b16 a[198:199], v23 offset:54272
    ds_read_b64_tr_b16 a[200:201], v23 offset:57344
    ds_read_b64_tr_b16 a[202:203], v23 offset:58368
    ds_read_b64_tr_b16 a[204:205], v23 offset:61440
    ds_read_b64_tr_b16 a[206:207], v23 offset:62464
    s_waitcnt lgkmcnt(0)
    s_waitcnt vmcnt(8)
    s_barrier
    ds_read_b64_tr_b16 a[208:209], v24 offset:0
    ds_read_b64_tr_b16 a[210:211], v24 offset:1024
    ds_read_b64_tr_b16 a[212:213], v24 offset:4096
    ds_read_b64_tr_b16 a[214:215], v24 offset:5120
    ds_read_b64_tr_b16 a[216:217], v24 offset:8192
    ds_read_b64_tr_b16 a[218:219], v24 offset:9216
    ds_read_b64_tr_b16 a[220:221], v24 offset:12288
    ds_read_b64_tr_b16 a[222:223], v24 offset:13312
    s_waitcnt lgkmcnt(0)
    s_waitcnt vmcnt(4)
    s_barrier
    ds_read_b64_tr_b16 a[224:225], v24 offset:16384
    ds_read_b64_tr_b16 a[226:227], v24 offset:17408
    ds_read_b64_tr_b16 a[228:229], v24 offset:20480
    ds_read_b64_tr_b16 a[230:231], v24 offset:21504
    ds_read_b64_tr_b16 a[232:233], v24 offset:24576
    ds_read_b64_tr_b16 a[234:235], v24 offset:25600
    ds_read_b64_tr_b16 a[236:237], v24 offset:28672
    ds_read_b64_tr_b16 a[238:239], v24 offset:29696
    s_waitcnt lgkmcnt(0)
    s_waitcnt vmcnt(0)
    s_barrier
    ds_read_b64_tr_b16 a[240:241], v24 offset:32768
    ds_read_b64_tr_b16 a[242:243], v24 offset:33792
    ds_read_b64_tr_b16 a[244:245], v24 offset:36864
    ds_read_b64_tr_b16 a[246:247], v24 offset:37888
    ds_read_b64_tr_b16 a[248:249], v24 offset:40960
    ds_read_b64_tr_b16 a[250:251], v24 offset:41984
    ds_read_b64_tr_b16 a[252:253], v24 offset:45056
    ds_read_b64_tr_b16 a[254:255], v24 offset:46080
    s_waitcnt lgkmcnt(0)
    s_barrier
    s_min_u32 s45, s41, 27
    s_lshl_b32 s45, s45, 8
    s_lshl_b32 s46, s44, 6
    s_add_u32 s45, s45, s46
    v_lshrrev_b32 v29, 5, v1
    v_lshlrev_b32 v29, 5, v29
    buffer_load_dwordx4 v[80:83], v29, s[32:35], s45 offen
    buffer_load_dwordx4 v[84:87], v29, s[32:35], s45 offen offset:16
    s_waitcnt vmcnt(0)
    v_lshlrev_b32 v96, 16, v80
    v_and_b32 v97, 0xffff0000, v80
    v_lshlrev_b32 v98, 16, v81
    v_and_b32 v99, 0xffff0000, v81
    v_lshlrev_b32 v100, 16, v82
    v_and_b32 v101, 0xffff0000, v82
    v_lshlrev_b32 v102, 16, v83
    v_and_b32 v103, 0xffff0000, v83
    v_lshlrev_b32 v104, 16, v84
    v_and_b32 v105, 0xffff0000, v84
    v_lshlrev_b32 v106, 16, v85
    v_and_b32 v107, 0xffff0000, v85
    v_lshlrev_b32 v108, 16, v86
    v_and_b32 v109, 0xffff0000, v86
    v_lshlrev_b32 v110, 16, v87
    v_and_b32 v111, 0xffff0000, v87
    v_lshlrev_b32 v29, 5, v1
    s_mov_b32 s45, 8192
    buffer_load_dwordx4 v[112:115], v29, s[12:15], s45 offen offset:0 sc1
    buffer_load_dwordx4 v[116:119], v29, s[12:15], s45 offen offset:16 sc1
    buffer_load_dwordx4 v[120:123], v29, s[12:15], s45 offen offset:2048 sc1
    buffer_load_dwordx4 v[124:127], v29, s[12:15], s45 offen offset:2064 sc1
    s_waitcnt vmcnt(0)
    v_lshlrev_b32 v29, 5, v1
    s_mov_b32 s45, 12288
    buffer_load_dwordx4 v[128:131], v29, s[12:15], s45 offen offset:0 sc1
    buffer_load_dwordx4 v[132:135], v29, s[12:15], s45 offen offset:16 sc1
    buffer_load_dwordx4 v[136:139], v29, s[12:15], s45 offen offset:2048 sc1
    buffer_load_dwordx4 v[140:143], v29, s[12:15], s45 offen offset:2064 sc1
    s_waitcnt vmcnt(0)
    v_lshlrev_b32 v29, 5, v1
    s_mov_b32 s45, 16384
    buffer_load_dwordx4 v[144:147], v29, s[12:15], s45 offen offset:0 sc1
    buffer_load_dwordx4 v[148:151], v29, s[12:15], s45 offen offset:16 sc1
    buffer_load_dwordx4 v[152:155], v29, s[12:15], s45 offen offset:2048 sc1
    buffer_load_dwordx4 v[156:159], v29, s[12:15], s45 offen offset:2064 sc1
    s_waitcnt vmcnt(0)
    v_add_f32 v144, 1.0, v144
    v_cvt_pk_bf16_f32 v144, v144, v144
    v_lshlrev_b32 v144, 16, v144
    v_add_f32 v145, 1.0, v145
    v_cvt_pk_bf16_f32 v145, v145, v145
    v_lshlrev_b32 v145, 16, v145
    v_add_f32 v146, 1.0, v146
    v_cvt_pk_bf16_f32 v146, v146, v146
    v_lshlrev_b32 v146, 16, v146
    v_add_f32 v147, 1.0, v147
    v_cvt_pk_bf16_f32 v147, v147, v147
    v_lshlrev_b32 v147, 16, v147
    v_add_f32 v148, 1.0, v148
    v_cvt_pk_bf16_f32 v148, v148, v148
    v_lshlrev_b32 v148, 16, v148
    v_add_f32 v149, 1.0, v149
    v_cvt_pk_bf16_f32 v149, v149, v149
    v_lshlrev_b32 v149, 16, v149
    v_add_f32 v150, 1.0, v150
    v_cvt_pk_bf16_f32 v150, v150, v150
    v_lshlrev_b32 v150, 16, v150
    v_add_f32 v151, 1.0, v151
    v_cvt_pk_bf16_f32 v151, v151, v151
    v_lshlrev_b32 v151, 16, v151
    v_add_f32 v152, 1.0, v152
    v_cvt_pk_bf16_f32 v152, v152, v152
    v_lshlrev_b32 v152, 16, v152
    v_add_f32 v153, 1.0, v153
    v_cvt_pk_bf16_f32 v153, v153, v153
    v_lshlrev_b32 v153, 16, v153
    v_add_f32 v154, 1.0, v154
    v_cvt_pk_bf16_f32 v154, v154, v154
    v_lshlrev_b32 v154, 16, v154
    v_add_f32 v155, 1.0, v155
    v_cvt_pk_bf16_f32 v155, v155, v155
    v_lshlrev_b32 v155, 16, v155
    v_add_f32 v156, 1.0, v156
    v_cvt_pk_bf16_f32 v156, v156, v156
    v_lshlrev_b32 v156, 16, v156
    v_add_f32 v157, 1.0, v157
    v_cvt_pk_bf16_f32 v157, v157, v157
    v_lshlrev_b32 v157, 16, v157
    v_add_f32 v158, 1.0, v158
    v_cvt_pk_bf16_f32 v158, v158, v158
    v_lshlrev_b32 v158, 16, v158
    v_add_f32 v159, 1.0, v159
    v_cvt_pk_bf16_f32 v159, v159, v159
    v_lshlrev_b32 v159, 16, v159
    s_mov_b32 s52, 0xc00000
    s_lshl_b32 s56, s41, 13
    s_add_u32 s56, s56, 0x6000000
L_b_loop_54:
    s_cmp_eq_u64 s[36:37], 0
    s_cbranch_scc1 L_w_done_33
    s_ff1_i32_b64 s50, s[36:37]
    s_bitset0_b64 s[36:37], s50
    s_ff1_i32_b64 s62, s[36:37]
    s_cmp_eq_u64 s[36:37], 0
    s_cselect_b32 s62, 64, s62
    s_sub_u32 s51, s62, s50
    s_and_b32 s45, s62, 63
    s_bitset0_b64 s[36:37], s45
    s_add_u32 s63, s50, s44
    s_lshl_b32 s63, s63, 5
    s_add_u32 s63, s63, s41
    s_cmp_ge_u32 s44, s51
    s_cbranch_scc1 L_b_skip_55
    s_lshl_b32 s47, s63, 11
    buffer_load_dwordx4 v[208:211], v10, s[28:31], s47 offen
    buffer_load_dwordx4 v[212:215], v10, s[28:31], s47 offen offset:1024
    s_add_u32 s45, s64, 256
    s_mov_b32 exec_hi, 0
    s_mov_b32 s70, 0
L_wp_57:
    buffer_load_dword v31, v12, s[12:15], s45 offen sc1
    s_add_u32 s70, s70, 1
    s_cmp_ge_u32 s70, 0x200000
    s_cbranch_scc1 L_w_done_33
    s_waitcnt vmcnt(0)
    v_cmp_gt_u32 vcc, s62, v31
    s_nop 1
    s_cbranch_vccz L_wp_57_ok
    s_sleep 2
    s_branch L_wp_57
L_wp_57_ok:
    s_mov_b64 exec, -1
    s_lshl_b32 s45, s63, 12
    s_add_u32 s45, s45, 0x8000000
    v_lshlrev_b32 v29, 5, v1
    buffer_load_dwordx4 v[64:67], v29, s[12:15], s45 offen offset:0 sc1
    buffer_load_dwordx4 v[68:71], v29, s[12:15], s45 offen offset:16 sc1
    buffer_load_dwordx4 v[72:75], v29, s[12:15], s45 offen offset:2048 sc1
    buffer_load_dwordx4 v[76:79], v29, s[12:15], s45 offen offset:2064 sc1
    s_add_u32 s45, s45, 0x800000
    buffer_load_dwordx4 v[160:163], v29, s[12:15], s45 offen offset:0 sc1
    buffer_load_dwordx4 v[164:167], v29, s[12:15], s45 offen offset:16 sc1
    buffer_load_dwordx4 v[168:171], v29, s[12:15], s45 offen offset:2048 sc1
    buffer_load_dwordx4 v[172:175], v29, s[12:15], s45 offen offset:2064 sc1
    s_add_u32 s45, s45, 0x800000
    buffer_load_dwordx4 v[176:179], v29, s[12:15], s45 offen offset:0 sc1
    buffer_load_dwordx4 v[180:183], v29, s[12:15], s45 offen offset:16 sc1
    buffer_load_dwordx4 v[184:187], v29, s[12:15], s45 offen offset:2048 sc1
    buffer_load_dwordx4 v[188:191], v29, s[12:15], s45 offen offset:2064 sc1
    s_add_u32 s45, s45, 0x800000
    buffer_load_dwordx4 v[192:195], v29, s[12:15], s45 offen offset:0 sc1
    buffer_load_dwordx4 v[196:199], v29, s[12:15], s45 offen offset:16 sc1
    buffer_load_dwordx4 v[200:203], v29, s[12:15], s45 offen offset:2048 sc1
    buffer_load_dwordx4 v[204:207], v29, s[12:15], s45 offen offset:2064 sc1
    s_waitcnt vmcnt(0)
    v_pk_add_f32 v[64:65], v[64:65], v[160:161]
    v_pk_add_f32 v[176:177], v[176:177], v[192:193]
    v_pk_add_f32 v[66:67], v[66:67], v[162:163]
    v_pk_add_f32 v[178:179], v[178:179], v[194:195]
    v_pk_add_f32 v[68:69], v[68:69], v[164:165]
    v_pk_add_f32 v[180:181], v[180:181], v[196:197]
    v_pk_add_f32 v[70:71], v[70:71], v[166:167]
    v_pk_add_f32 v[182:183], v[182:183], v[198:199]
    v_pk_add_f32 v[72:73], v[72:73], v[168:169]
    v_pk_add_f32 v[184:185], v[184:185], v[200:201]
    v_pk_add_f32 v[74:75], v[74:75], v[170:171]
    v_pk_add_f32 v[186:187], v[186:187], v[202:203]
    v_pk_add_f32 v[76:77], v[76:77], v[172:173]
    v_pk_add_f32 v[188:189], v[188:189], v[204:205]
    v_pk_add_f32 v[78:79], v[78:79], v[174:175]
    v_pk_add_f32 v[190:191], v[190:191], v[206:207]
    v_pk_add_f32 v[64:65], v[64:65], v[176:177]
    v_pk_add_f32 v[66:67], v[66:67], v[178:179]
    v_pk_add_f32 v[68:69], v[68:69], v[180:181]
    v_pk_add_f32 v[70:71], v[70:71], v[182:183]
    v_pk_add_f32 v[72:73], v[72:73], v[184:185]
    v_pk_add_f32 v[74:75], v[74:75], v[186:187]
    v_pk_add_f32 v[76:77], v[76:77], v[188:189]
    v_pk_add_f32 v[78:79], v[78:79], v[190:191]
    v_cvt_pk_bf16_f32 v64, v64, v64
    v_lshlrev_b32 v64, 16, v64
    v_cvt_pk_bf16_f32 v65, v65, v65
    v_lshlrev_b32 v65, 16, v65
    v_cvt_pk_bf16_f32 v66, v66, v66
    v_lshlrev_b32 v66, 16, v66
    v_cvt_pk_bf16_f32 v67, v67, v67
    v_lshlrev_b32 v67, 16, v67
    v_cvt_pk_bf16_f32 v68, v68, v68
    v_lshlrev_b32 v68, 16, v68
    v_cvt_pk_bf16_f32 v69, v69, v69
    v_lshlrev_b32 v69, 16, v69
    v_cvt_pk_bf16_f32 v70, v70, v70
    v_lshlrev_b32 v70, 16, v70
    v_cvt_pk_bf16_f32 v71, v71, v71
    v_lshlrev_b32 v71, 16, v71
    v_cvt_pk_bf16_f32 v72, v72, v72
    v_lshlrev_b32 v72, 16, v72
    v_cvt_pk_bf16_f32 v73, v73, v73
    v_lshlrev_b32 v73, 16, v73
    v_cvt_pk_bf16_f32 v74, v74, v74
    v_lshlrev_b32 v74, 16, v74
    v_cvt_pk_bf16_f32 v75, v75, v75
    v_lshlrev_b32 v75, 16, v75
    v_cvt_pk_bf16_f32 v76, v76, v76
    v_lshlrev_b32 v76, 16, v76
    v_cvt_pk_bf16_f32 v77, v77, v77
    v_lshlrev_b32 v77, 16, v77
    v_cvt_pk_bf16_f32 v78, v78, v78
    v_lshlrev_b32 v78, 16, v78
    v_cvt_pk_bf16_f32 v79, v79, v79
    v_lshlrev_b32 v79, 16, v79
    v_lshlrev_b32 v160, 16, v208
    v_and_b32 v161, 0xffff0000, v208
    v_lshlrev_b32 v162, 16, v209
    v_and_b32 v163, 0xffff0000, v209
    v_lshlrev_b32 v164, 16, v210
    v_and_b32 v165, 0xffff0000, v210
    v_lshlrev_b32 v166, 16, v211
    v_and_b32 v167, 0xffff0000, v211
    v_lshlrev_b32 v168, 16, v212
    v_and_b32 v169, 0xffff0000, v212
    v_lshlrev_b32 v170, 16, v213
    v_and_b32 v171, 0xffff0000, v213
    v_lshlrev_b32 v172, 16, v214
    v_and_b32 v173, 0xffff0000, v214
    v_lshlrev_b32 v174, 16, v215
    v_and_b32 v175, 0xffff0000, v215
    v_mul_f32 v64, v64, v112
    v_cvt_pk_bf16_f32 v64, v64, v64
    v_lshlrev_b32 v64, 16, v64
    v_add_f32 v64, v64, v160
    v_mul_f32 v65, v65, v113
    v_cvt_pk_bf16_f32 v65, v65, v65
    v_lshlrev_b32 v65, 16, v65
    v_add_f32 v65, v65, v161
    v_mul_f32 v66, v66, v114
    v_cvt_pk_bf16_f32 v66, v66, v66
    v_lshlrev_b32 v66, 16, v66
    v_add_f32 v66, v66, v162
    v_mul_f32 v67, v67, v115
    v_cvt_pk_bf16_f32 v67, v67, v67
    v_lshlrev_b32 v67, 16, v67
    v_add_f32 v67, v67, v163
    v_mul_f32 v68, v68, v116
    v_cvt_pk_bf16_f32 v68, v68, v68
    v_lshlrev_b32 v68, 16, v68
    v_add_f32 v68, v68, v164
    v_mul_f32 v69, v69, v117
    v_cvt_pk_bf16_f32 v69, v69, v69
    v_lshlrev_b32 v69, 16, v69
    v_add_f32 v69, v69, v165
    v_mul_f32 v70, v70, v118
    v_cvt_pk_bf16_f32 v70, v70, v70
    v_lshlrev_b32 v70, 16, v70
    v_add_f32 v70, v70, v166
    v_mul_f32 v71, v71, v119
    v_cvt_pk_bf16_f32 v71, v71, v71
    v_lshlrev_b32 v71, 16, v71
    v_add_f32 v71, v71, v167
    v_mul_f32 v72, v72, v120
    v_cvt_pk_bf16_f32 v72, v72, v72
    v_lshlrev_b32 v72, 16, v72
    v_add_f32 v72, v72, v168
    v_mul_f32 v73, v73, v121
    v_cvt_pk_bf16_f32 v73, v73, v73
    v_lshlrev_b32 v73, 16, v73
    v_add_f32 v73, v73, v169
    v_mul_f32 v74, v74, v122
    v_cvt_pk_bf16_f32 v74, v74, v74
    v_lshlrev_b32 v74, 16, v74
    v_add_f32 v74, v74, v170
    v_mul_f32 v75, v75, v123
    v_cvt_pk_bf16_f32 v75, v75, v75
    v_lshlrev_b32 v75, 16, v75
    v_add_f32 v75, v75, v171
    v_mul_f32 v76, v76, v124
    v_cvt_pk_bf16_f32 v76, v76, v76
    v_lshlrev_b32 v76, 16, v76
    v_add_f32 v76, v76, v172
    v_mul_f32 v77, v77, v125
    v_cvt_pk_bf16_f32 v77, v77, v77
    v_lshlrev_b32 v77, 16, v77
    v_add_f32 v77, v77, v173
    v_mul_f32 v78, v78, v126
    v_cvt_pk_bf16_f32 v78, v78, v78
    v_lshlrev_b32 v78, 16, v78
    v_add_f32 v78, v78, v174
    v_mul_f32 v79, v79, v127
    v_cvt_pk_bf16_f32 v79, v79, v79
    v_lshlrev_b32 v79, 16, v79
    v_add_f32 v79, v79, v175
    v_cvt_pk_bf16_f32 v208, v64, v65
    v_cvt_pk_bf16_f32 v209, v66, v67
    v_cvt_pk_bf16_f32 v210, v68, v69
    v_cvt_pk_bf16_f32 v211, v70, v71
    v_cvt_pk_bf16_f32 v212, v72, v73
    v_cvt_pk_bf16_f32 v213, v74, v75
    v_cvt_pk_bf16_f32 v214, v76, v77
    v_cvt_pk_bf16_f32 v215, v78, v79
    s_add_u32 s47, s47, 0x800000
    buffer_store_dwordx4 v[208:211], v10, s[12:15], s47 offen sc1
    buffer_store_dwordx4 v[212:215], v10, s[12:15], s47 offen offset:1024 sc1
    v_lshlrev_b32 v64, 16, v208
    v_and_b32 v65, 0xffff0000, v208
    v_lshlrev_b32 v66, 16, v209
    v_and_b32 v67, 0xffff0000, v209
    v_lshlrev_b32 v68, 16, v210
    v_and_b32 v69, 0xffff0000, v210
    v_lshlrev_b32 v70, 16, v211
    v_and_b32 v71, 0xffff0000, v211
    v_lshlrev_b32 v72, 16, v212
    v_and_b32 v73, 0xffff0000, v212
    v_lshlrev_b32 v74, 16, v213
    v_and_b32 v75, 0xffff0000, v213
    v_lshlrev_b32 v76, 16, v214
    v_and_b32 v77, 0xffff0000, v214
    v_lshlrev_b32 v78, 16, v215
    v_and_b32 v79, 0xffff0000, v215
    v_add_f32 v26, v64, v65
    v_add_f32 v26, v26, v66
    v_add_f32 v26, v26, v67
    v_add_f32 v26, v26, v68
    v_add_f32 v26, v26, v69
    v_add_f32 v26, v26, v70
    v_add_f32 v26, v26, v71
    v_add_f32 v26, v26, v72
    v_add_f32 v26, v26, v73
    v_add_f32 v26, v26, v74
    v_add_f32 v26, v26, v75
    v_add_f32 v26, v26, v76
    v_add_f32 v26, v26, v77
    v_add_f32 v26, v26, v78
    v_add_f32 v26, v26, v79
    s_nop 1
    v_add_f32_dpp v26, v26, v26 row_shr:1 row_mask:0xf bank_mask:0xf bound_ctrl:0
    s_nop 1
    v_add_f32_dpp v26, v26, v26 row_shr:2 row_mask:0xf bank_mask:0xf bound_ctrl:0
    s_nop 1
    v_add_f32_dpp v26, v26, v26 row_shr:4 row_mask:0xf bank_mask:0xf bound_ctrl:0
    s_nop 1
    v_add_f32_dpp v26, v26, v26 row_shr:8 row_mask:0xf bank_mask:0xf bound_ctrl:0
    s_nop 1
    v_add_f32_dpp v26, v26, v26 row_bcast:15 row_mask:0xa bank_mask:0xf
    s_nop 1
    v_add_f32_dpp v26, v26, v26 row_bcast:31 row_mask:0xc bank_mask:0xf
    s_nop 1
    v_readlane_b32 s66, v26, 63
    s_nop 1
    v_mov_b32 v27, s66
    v_mul_f32 v27, 0x3a800000, v27
    v_mov_b32 v26, 0
    v_sub_f32 v28, v64, v27
    v_fmac_f32 v26, v28, v28
    v_sub_f32 v28, v65, v27
    v_fmac_f32 v26, v28, v28
    v_sub_f32 v28, v66, v27
    v_fmac_f32 v26, v28, v28
    v_sub_f32 v28, v67, v27
    v_fmac_f32 v26, v28, v28
    v_sub_f32 v28, v68, v27
    v_fmac_f32 v26, v28, v28
    v_sub_f32 v28, v69, v27
    v_fmac_f32 v26, v28, v28
    v_sub_f32 v28, v70, v27
    v_fmac_f32 v26, v28, v28
    v_sub_f32 v28, v71, v27
    v_fmac_f32 v26, v28, v28
    v_sub_f32 v28, v72, v27
    v_fmac_f32 v26, v28, v28
    v_sub_f32 v28, v73, v27
    v_fmac_f32 v26, v28, v28
    v_sub_f32 v28, v74, v27
    v_fmac_f32 v26, v28, v28
    v_sub_f32 v28, v75, v27
    v_fmac_f32 v26, v28, v28
    v_sub_f32 v28, v76, v27
    v_fmac_f32 v26, v28, v28
    v_sub_f32 v28, v77, v27
    v_fmac_f32 v26, v28, v28
    v_sub_f32 v28, v78, v27
    v_fmac_f32 v26, v28, v28
    v_sub_f32 v28, v79, v27
    v_fmac_f32 v26, v28, v28
    s_nop 1
    v_add_f32_dpp v26, v26, v26 row_shr:1 row_mask:0xf bank_mask:0xf bound_ctrl:0
    s_nop 1
    v_add_f32_dpp v26, v26, v26 row_shr:2 row_mask:0xf bank_mask:0xf bound_ctrl:0
    s_nop 1
    v_add_f32_dpp v26, v26, v26 row_shr:4 row_mask:0xf bank_mask:0xf bound_ctrl:0
    s_nop 1
    v_add_f32_dpp v26, v26, v26 row_shr:8 row_mask:0xf bank_mask:0xf bound_ctrl:0
    s_nop 1
    v_add_f32_dpp v26, v26, v26 row_bcast:15 row_mask:0xa bank_mask:0xf
    s_nop 1
    v_add_f32_dpp v26, v26, v26 row_bcast:31 row_mask:0xc bank_mask:0xf
    s_nop 1
    v_readlane_b32 s66, v26, 63
    s_nop 1
    v_mov_b32 v26, s66
    v_mul_f32 v26, 0x3a800000, v26
    v_cvt_pk_bf16_f32 v26, v26, v26
    v_lshlrev_b32 v26, 16, v26
    v_cvt_pk_bf16_f32 v27, v27, v27
    v_lshlrev_b32 v27, 16, v27
    v_add_f32 v26, 0x3727c5ac, v26
    v_cvt_pk_bf16_f32 v26, v26, v26
    v_lshlrev_b32 v26, 16, v26
    v_sqrt_f32 v26, v26
    s_nop 0
    v_cvt_pk_bf16_f32 v26, v26, v26
    v_lshlrev_b32 v26, 16, v26
    v_rcp_f32 v26, v26
    s_nop 0
    v_sub_f32 v64, v64, v27
    v_cvt_pk_bf16_f32 v64, v64, v64
    v_lshlrev_b32 v64, 16, v64
    v_mul_f32 v64, v64, v26
    v_cvt_pk_bf16_f32 v64, v64, v64
    v_lshlrev_b32 v64, 16, v64
    v_mul_f32 v64, v64, v144
    v_cvt_pk_bf16_f32 v64, v64, v64
    v_lshlrev_b32 v64, 16, v64
    v_add_f32 v64, v64, v128
    v_sub_f32 v65, v65, v27
    v_cvt_pk_bf16_f32 v65, v65, v65
    v_lshlrev_b32 v65, 16, v65
    v_mul_f32 v65, v65, v26
    v_cvt_pk_bf16_f32 v65, v65, v65
    v_lshlrev_b32 v65, 16, v65
    v_mul_f32 v65, v65, v145
    v_cvt_pk_bf16_f32 v65, v65, v65
    v_lshlrev_b32 v65, 16, v65
    v_add_f32 v65, v65, v129
    v_sub_f32 v66, v66, v27
    v_cvt_pk_bf16_f32 v66, v66, v66
    v_lshlrev_b32 v66, 16, v66
    v_mul_f32 v66, v66, v26
    v_cvt_pk_bf16_f32 v66, v66, v66
    v_lshlrev_b32 v66, 16, v66
    v_mul_f32 v66, v66, v146
    v_cvt_pk_bf16_f32 v66, v66, v66
    v_lshlrev_b32 v66, 16, v66
    v_add_f32 v66, v66, v130
    v_sub_f32 v67, v67, v27
    v_cvt_pk_bf16_f32 v67, v67, v67
    v_lshlrev_b32 v67, 16, v67
    v_mul_f32 v67, v67, v26
    v_cvt_pk_bf16_f32 v67, v67, v67
    v_lshlrev_b32 v67, 16, v67
    v_mul_f32 v67, v67, v147
    v_cvt_pk_bf16_f32 v67, v67, v67
    v_lshlrev_b32 v67, 16, v67
    v_add_f32 v67, v67, v131
    v_sub_f32 v68, v68, v27
    v_cvt_pk_bf16_f32 v68, v68, v68
    v_lshlrev_b32 v68, 16, v68
    v_mul_f32 v68, v68, v26
    v_cvt_pk_bf16_f32 v68, v68, v68
    v_lshlrev_b32 v68, 16, v68
    v_mul_f32 v68, v68, v148
    v_cvt_pk_bf16_f32 v68, v68, v68
    v_lshlrev_b32 v68, 16, v68
    v_add_f32 v68, v68, v132
    v_sub_f32 v69, v69, v27
    v_cvt_pk_bf16_f32 v69, v69, v69
    v_lshlrev_b32 v69, 16, v69
    v_mul_f32 v69, v69, v26
    v_cvt_pk_bf16_f32 v69, v69, v69
    v_lshlrev_b32 v69, 16, v69
    v_mul_f32 v69, v69, v149
    v_cvt_pk_bf16_f32 v69, v69, v69
    v_lshlrev_b32 v69, 16, v69
    v_add_f32 v69, v69, v133
    v_sub_f32 v70, v70, v27
    v_cvt_pk_bf16_f32 v70, v70, v70
    v_lshlrev_b32 v70, 16, v70
    v_mul_f32 v70, v70, v26
    v_cvt_pk_bf16_f32 v70, v70, v70
    v_lshlrev_b32 v70, 16, v70
    v_mul_f32 v70, v70, v150
    v_cvt_pk_bf16_f32 v70, v70, v70
    v_lshlrev_b32 v70, 16, v70
    v_add_f32 v70, v70, v134
    v_sub_f32 v71, v71, v27
    v_cvt_pk_bf16_f32 v71, v71, v71
    v_lshlrev_b32 v71, 16, v71
    v_mul_f32 v71, v71, v26
    v_cvt_pk_bf16_f32 v71, v71, v71
    v_lshlrev_b32 v71, 16, v71
    v_mul_f32 v71, v71, v151
    v_cvt_pk_bf16_f32 v71, v71, v71
    v_lshlrev_b32 v71, 16, v71
    v_add_f32 v71, v71, v135
    v_sub_f32 v72, v72, v27
    v_cvt_pk_bf16_f32 v72, v72, v72
    v_lshlrev_b32 v72, 16, v72
    v_mul_f32 v72, v72, v26
    v_cvt_pk_bf16_f32 v72, v72, v72
    v_lshlrev_b32 v72, 16, v72
    v_mul_f32 v72, v72, v152
    v_cvt_pk_bf16_f32 v72, v72, v72
    v_lshlrev_b32 v72, 16, v72
    v_add_f32 v72, v72, v136
    v_sub_f32 v73, v73, v27
    v_cvt_pk_bf16_f32 v73, v73, v73
    v_lshlrev_b32 v73, 16, v73
    v_mul_f32 v73, v73, v26
    v_cvt_pk_bf16_f32 v73, v73, v73
    v_lshlrev_b32 v73, 16, v73
    v_mul_f32 v73, v73, v153
    v_cvt_pk_bf16_f32 v73, v73, v73
    v_lshlrev_b32 v73, 16, v73
    v_add_f32 v73, v73, v137
    v_sub_f32 v74, v74, v27
    v_cvt_pk_bf16_f32 v74, v74, v74
    v_lshlrev_b32 v74, 16, v74
    v_mul_f32 v74, v74, v26
    v_cvt_pk_bf16_f32 v74, v74, v74
    v_lshlrev_b32 v74, 16, v74
    v_mul_f32 v74, v74, v154
    v_cvt_pk_bf16_f32 v74, v74, v74
    v_lshlrev_b32 v74, 16, v74
    v_add_f32 v74, v74, v138
    v_sub_f32 v75, v75, v27
    v_cvt_pk_bf16_f32 v75, v75, v75
    v_lshlrev_b32 v75, 16, v75
    v_mul_f32 v75, v75, v26
    v_cvt_pk_bf16_f32 v75, v75, v75
    v_lshlrev_b32 v75, 16, v75
    v_mul_f32 v75, v75, v155
    v_cvt_pk_bf16_f32 v75, v75, v75
    v_lshlrev_b32 v75, 16, v75
    v_add_f32 v75, v75, v139
    v_sub_f32 v76, v76, v27
    v_cvt_pk_bf16_f32 v76, v76, v76
    v_lshlrev_b32 v76, 16, v76
    v_mul_f32 v76, v76, v26
    v_cvt_pk_bf16_f32 v76, v76, v76
    v_lshlrev_b32 v76, 16, v76
    v_mul_f32 v76, v76, v156
    v_cvt_pk_bf16_f32 v76, v76, v76
    v_lshlrev_b32 v76, 16, v76
    v_add_f32 v76, v76, v140
    v_sub_f32 v77, v77, v27
    v_cvt_pk_bf16_f32 v77, v77, v77
    v_lshlrev_b32 v77, 16, v77
    v_mul_f32 v77, v77, v26
    v_cvt_pk_bf16_f32 v77, v77, v77
    v_lshlrev_b32 v77, 16, v77
    v_mul_f32 v77, v77, v157
    v_cvt_pk_bf16_f32 v77, v77, v77
    v_lshlrev_b32 v77, 16, v77
    v_add_f32 v77, v77, v141
    v_sub_f32 v78, v78, v27
    v_cvt_pk_bf16_f32 v78, v78, v78
    v_lshlrev_b32 v78, 16, v78
    v_mul_f32 v78, v78, v26
    v_cvt_pk_bf16_f32 v78, v78, v78
    v_lshlrev_b32 v78, 16, v78
    v_mul_f32 v78, v78, v158
    v_cvt_pk_bf16_f32 v78, v78, v78
    v_lshlrev_b32 v78, 16, v78
    v_add_f32 v78, v78, v142
    v_sub_f32 v79, v79, v27
    v_cvt_pk_bf16_f32 v79, v79, v79
    v_lshlrev_b32 v79, 16, v79
    v_mul_f32 v79, v79, v26
    v_cvt_pk_bf16_f32 v79, v79, v79
    v_lshlrev_b32 v79, 16, v79
    v_mul_f32 v79, v79, v159
    v_cvt_pk_bf16_f32 v79, v79, v79
    v_lshlrev_b32 v79, 16, v79
    v_add_f32 v79, v79, v143
    v_cvt_pk_bf16_f32 v80, v64, v65
    v_cvt_pk_bf16_f32 v81, v66, v67
    v_cvt_pk_bf16_f32 v82, v68, v69
    v_cvt_pk_bf16_f32 v83, v70, v71
    v_cvt_pk_bf16_f32 v84, v72, v73
    v_cvt_pk_bf16_f32 v85, v74, v75
    v_cvt_pk_bf16_f32 v86, v76, v77
    v_cvt_pk_bf16_f32 v87, v78, v79
    s_lshr_b32 s45, s63, 5
    s_lshl_b32 s45, s45, 16
    s_and_b32 s46, s63, 31
    s_lshl_b32 s46, s46, 8
    s_add_u32 s45, s45, s46
    s_add_u32 s45, s45, 0xc00000
    s_add_u32 s46, s45, 32768
    buffer_store_dwordx4 v[80:83], v2, s[12:15], s45 offen sc1
    buffer_store_dwordx4 v[84:87], v2, s[12:15], s46 offen sc1
L_b_skip_55:
    s_waitcnt vmcnt(0)
    s_barrier
    s_cmp_lg_u32 s44, 0
    s_cbranch_scc1 L_pub_58
    v_mov_b32 v30, s62
    v_mov_b32 v31, 0
    s_mov_b64 exec, 1
    buffer_store_dword v30, v31, s[12:15], s65 offen sc1
    s_mov_b64 exec, -1
L_pub_58:
    s_cmp_ge_u32 s41, 28
    s_cbranch_scc1 L_b_loop_54
    s_add_u32 s45, s64, 512
    s_mov_b32 exec_hi, 0
    s_mov_b32 s70, 0
L_wp_59:
    buffer_load_dword v31, v12, s[12:15], s45 offen sc1
    s_add_u32 s70, s70, 1
    s_cmp_ge_u32 s70, 0x200000
    s_cbranch_scc1 L_w_done_33
    s_waitcnt vmcnt(0)
    v_cmp_gt_u32 vcc, s62, v31
    s_nop 1
    s_cbranch_vccz L_wp_59_ok
    s_sleep 1
    s_branch L_wp_59
L_wp_59_ok:
    s_mov_b64 exec, -1
    s_mul_i32 s53, s50, 65536
    s_add_u32 s53, s53, s52
    s_lshl_b32 s45, s44, 11
    s_add_u32 s53, s53, s45
    s_mul_i32 s57, s50, 229376
    s_add_u32 s57, s57, s56
    s_mul_i32 s54, s44, 8320
    s_add_u32 s55, s54, 66560
    s_mov_b32 s58, 0
    v_mov_b32 v13, v4
    s_mov_b32 s59, 66560
    s_add_u32 m0, s54, 0
    s_nop 0
    buffer_load_dwordx4 v2, s[12:15], s53 offen offset:0 sc1 lds
    s_add_u32 m0, s54, 784
    s_nop 0
    buffer_load_dwordx4 v2, s[12:15], s53 offen offset:256 sc1 lds
    s_add_u32 m0, s54, 1568
    s_nop 0
    buffer_load_dwordx4 v2, s[12:15], s53 offen offset:512 sc1 lds
    s_add_u32 m0, s54, 2352
    s_nop 0
    buffer_load_dwordx4 v2, s[12:15], s53 offen offset:768 sc1 lds
    s_add_u32 m0, s54, 3136
    s_nop 0
    buffer_load_dwordx4 v2, s[12:15], s53 offen offset:1024 sc1 lds
    s_add_u32 m0, s54, 3920
    s_nop 0
    buffer_load_dwordx4 v2, s[12:15], s53 offen offset:1280 sc1 lds
    s_add_u32 m0, s54, 4704
    s_nop 0
    buffer_load_dwordx4 v2, s[12:15], s53 offen offset:1536 sc1 lds
    s_add_u32 m0, s54, 5488
    s_nop 0
    buffer_load_dwordx4 v2, s[12:15], s53 offen offset:1792 sc1 lds
    s_add_u32 s45, s53, 32768
    s_add_u32 s46, s54, 33280
    s_add_u32 m0, s46, 0
    s_nop 0
    buffer_load_dwordx4 v2, s[12:15], s45 offen offset:0 sc1 lds
    s_add_u32 m0, s46, 784
    s_nop 0
    buffer_load_dwordx4 v2, s[12:15], s45 offen offset:256 sc1 lds
    s_add_u32 m0, s46, 1568
    s_nop 0
    buffer_load_dwordx4 v2, s[12:15], s45 offen offset:512 sc1 lds
    s_add_u32 m0, s46, 2352
    s_nop 0
    buffer_load_dwordx4 v2, s[12:15], s45 offen offset:768 sc1 lds
    s_add_u32 m0, s46, 3136
    s_nop 0
    buffer_load_dwordx4 v2, s[12:15], s45 offen offset:1024 sc1 lds
    s_add_u32 m0, s46, 3920
    s_nop 0
    buffer_load_dwordx4 v2, s[12:15], s45 offen offset:1280 sc1 lds
    s_add_u32 m0, s46, 4704
    s_nop 0
    buffer_load_dwordx4 v2, s[12:15], s45 offen offset:1536 sc1 lds
    s_add_u32 m0, s46, 5488
    s_nop 0
    buffer_load_dwordx4 v2, s[12:15], s45 offen offset:1792 sc1 lds
    s_add_u32 s45, s53, 65536
    s_cmp_gt_u32 s51, 1
    s_cselect_b32 s45, s45, 0x20000000
    s_add_u32 m0, s55, 0
    s_nop 0
    buffer_load_dwordx4 v2, s[12:15], s45 offen offset:0 sc1 lds
    s_add_u32 m0, s55, 784
    s_nop 0
    buffer_load_dwordx4 v2, s[12:15], s45 offen offset:256 sc1 lds
    s_add_u32 m0, s55, 1568
    s_nop 0
    buffer_load_dwordx4 v2, s[12:15], s45 offen offset:512 sc1 lds
    s_add_u32 m0, s55, 2352
    s_nop 0
    buffer_load_dwordx4 v2, s[12:15], s45 offen offset:768 sc1 lds
    s_add_u32 m0, s55, 3136
    s_nop 0
    buffer_load_dwordx4 v2, s[12:15], s45 offen offset:1024 sc1 lds
    s_add_u32 m0, s55, 3920
    s_nop 0
    buffer_load_dwordx4 v2, s[12:15], s45 offen offset:1280 sc1 lds
    s_add_u32 m0, s55, 4704
    s_nop 0
    buffer_load_dwordx4 v2, s[12:15], s45 offen offset:1536 sc1 lds
    s_add_u32 m0, s55, 5488
    s_nop 0
    buffer_load_dwordx4 v2, s[12:15], s45 offen offset:1792 sc1 lds
L_e_loop_60:
    s_add_u32 s45, s53, 98304
    s_add_u32 s46, s58, 1
    s_cmp_lt_u32 s46, s51
    s_cselect_b32 s48, s45, 0x20000000
    s_add_u32 s49, s55, 33280
    s_waitcnt vmcnt(16)
    s_barrier
    ds_read_b128 v[32:35], v13 offset:0
    ds_read_b128 v[36:39], v13 offset:32
    ds_read_b128 v[40:43], v13 offset:64
    ds_read_b128 v[44:47], v13 offset:96
    ds_read_b128 v[48:51], v13 offset:128
    ds_read_b128 v[52:55], v13 offset:160
    s_waitcnt lgkmcnt(4)
    v_mfma_f32_32x32x16_bf16 v[64:79], a[0:3], v[32:35], 0
    ds_read_b128 v[56:59], v13 offset:192
    v_mfma_f32_32x32x16_bf16 v[64:79], a[4:7], v[36:39], v[64:79]
    ds_read_b128 v[60:63], v13 offset:224
    s_add_u32 m0, s49, 0
    s_nop 0
    buffer_load_dwordx4 v2, s[12:15], s48 offen offset:0 sc1 lds
    s_waitcnt lgkmcnt(4)
    v_mfma_f32_32x32x16_bf16 v[64:79], a[8:11], v[40:43], v[64:79]
    ds_read_b128 v[32:35], v13 offset:256
    v_mfma_f32_32x32x16_bf16 v[64:79], a[12:15], v[44:47], v[64:79]
    ds_read_b128 v[36:39], v13 offset:288
    s_add_u32 m0, s49, 784
    s_nop 0
    buffer_load_dwordx4 v2, s[12:15], s48 offen offset:256 sc1 lds
    s_waitcnt lgkmcnt(4)
    v_mfma_f32_32x32x16_bf16 v[64:79], a[16:19], v[48:51], v[64:79]
    ds_read_b128 v[40:43], v13 offset:320
    v_mfma_f32_32x32x16_bf16 v[64:79], a[20:23], v[52:55], v[64:79]
    ds_read_b128 v[44:47], v13 offset:352
    s_add_u32 m0, s49, 1568
    s_nop 0
    buffer_load_dwordx4 v2, s[12:15], s48 offen offset:512 sc1 lds
    s_waitcnt lgkmcnt(4)
    v_mfma_f32_32x32x16_bf16 v[64:79], a[24:27], v[56:59], v[64:79]
    ds_read_b128 v[48:51], v13 offset:384
    v_mfma_f32_32x32x16_bf16 v[64:79], a[28:31], v[60:63], v[64:79]
    ds_read_b128 v[52:55], v13 offset:416
    s_add_u32 m0, s49, 2352
    s_nop 0
    buffer_load_dwordx4 v2, s[12:15], s48 offen offset:768 sc1 lds
    s_waitcnt lgkmcnt(4)
    v_mfma_f32_32x32x16_bf16 v[64:79], a[32:35], v[32:35], v[64:79]
    ds_read_b128 v[56:59], v13 offset:448
    v_mfma_f32_32x32x16_bf16 v[64:79], a[36:39], v[36:39], v[64:79]
    ds_read_b128 v[60:63], v13 offset:480
    s_add_u32 m0, s49, 3136
    s_nop 0
    buffer_load_dwordx4 v2, s[12:15], s48 offen offset:1024 sc1 lds
    s_waitcnt lgkmcnt(4)
    v_mfma_f32_32x32x16_bf16 v[64:79], a[40:43], v[40:43], v[64:79]
    ds_read_b128 v[32:35], v13 offset:512
    v_mfma_f32_32x32x16_bf16 v[64:79], a[44:47], v[44:47], v[64:79]
    ds_read_b128 v[36:39], v13 offset:544
    s_add_u32 m0, s49, 3920
    s_nop 0
    buffer_load_dwordx4 v2, s[12:15], s48 offen offset:1280 sc1 lds
    s_waitcnt lgkmcnt(4)
    v_mfma_f32_32x32x16_bf16 v[64:79], a[48:51], v[48:51], v[64:79]
    ds_read_b128 v[40:43], v13 offset:576
    v_mfma_f32_32x32x16_bf16 v[64:79], a[52:55], v[52:55], v[64:79]
    ds_read_b128 v[44:47], v13 offset:608
    s_add_u32 m0, s49, 4704
    s_nop 0
    buffer_load_dwordx4 v2, s[12:15], s48 offen offset:1536 sc1 lds
    s_waitcnt lgkmcnt(4)
    v_mfma_f32_32x32x16_bf16 v[64:79], a[56:59], v[56:59], v[64:79]
    ds_read_b128 v[48:51], v13 offset:640
    v_mfma_f32_32x32x16_bf16 v[64:79], a[60:63], v[60:63], v[64:79]
    ds_read_b128 v[52:55], v13 offset:672
    s_add_u32 m0, s49, 5488
    s_nop 0
    buffer_load_dwordx4 v2, s[12:15], s48 offen offset:1792 sc1 lds
    s_waitcnt lgkmcnt(4)
    v_mfma_f32_32x32x16_bf16 v[64:79], a[64:67], v[32:35], v[64:79]
    ds_read_b128 v[56:59], v13 offset:704
    v_mfma_f32_32x32x16_bf16 v[64:79], a[68:71], v[36:39], v[64:79]
    ds_read_b128 v[60:63], v13 offset:736
    s_waitcnt lgkmcnt(4)
    v_mfma_f32_32x32x16_bf16 v[64:79], a[72:75], v[40:43], v[64:79]
    ds_read_b128 v[32:35], v13 offset:768
    v_mfma_f32_32x32x16_bf16 v[64:79], a[76:79], v[44:47], v[64:79]
    ds_read_b128 v[36:39], v13 offset:800
    s_waitcnt lgkmcnt(4)
    v_mfma_f32_32x32x16_bf16 v[64:79], a[80:83], v[48:51], v[64:79]
    ds_read_b128 v[40:43], v13 offset:832
    v_mfma_f32_32x32x16_bf16 v[64:79], a[84:87], v[52:55], v[64:79]
    ds_read_b128 v[44:47], v13 offset:864
    s_waitcnt lgkmcnt(4)
    v_mfma_f32_32x32x16_bf16 v[64:79], a[88:91], v[56:59], v[64:79]
    ds_read_b128 v[48:51], v13 offset:896
    v_mfma_f32_32x32x16_bf16 v[64:79], a[92:95], v[60:63], v[64:79]
    ds_read_b128 v[52:55], v13 offset:928
    s_waitcnt lgkmcnt(4)
    v_mfma_f32_32x32x16_bf16 v[64:79], a[96:99], v[32:35], v[64:79]
    ds_read_b128 v[56:59], v13 offset:960
    v_mfma_f32_32x32x16_bf16 v[64:79], a[100:103], v[36:39], v[64:79]
    ds_read_b128 v[60:63], v13 offset:992
    s_waitcnt lgkmcnt(4)
    v_mfma_f32_32x32x16_bf16 v[64:79], a[104:107], v[40:43], v[64:79]
    v_mfma_f32_32x32x16_bf16 v[64:79], a[108:111], v[44:47], v[64:79]
    s_waitcnt lgkmcnt(2)
    v_mfma_f32_32x32x16_bf16 v[64:79], a[112:115], v[48:51], v[64:79]
    v_mfma_f32_32x32x16_bf16 v[64:79], a[116:119], v[52:55], v[64:79]
    s_waitcnt lgkmcnt(0)
    v_mfma_f32_32x32x16_bf16 v[64:79], a[120:123], v[56:59], v[64:79]
    v_mfma_f32_32x32x16_bf16 v[64:79], a[124:127], v[60:63], v[64:79]
    s_add_u32 s45, s53, 131072
    s_add_u32 s46, s58, 2
    s_cmp_lt_u32 s46, s51
    s_cselect_b32 s48, s45, 0x20000000
    s_mov_b32 s49, s54
    s_waitcnt vmcnt(16)
    s_barrier
    ds_read_b128 v[32:35], v13 offset:33280
    ds_read_b128 v[36:39], v13 offset:33312
    ds_read_b128 v[40:43], v13 offset:33344
    ds_read_b128 v[44:47], v13 offset:33376
    ds_read_b128 v[48:51], v13 offset:33408
    ds_read_b128 v[52:55], v13 offset:33440
    s_waitcnt lgkmcnt(4)
    v_mfma_f32_32x32x16_bf16 v[64:79], a[128:131], v[32:35], v[64:79]
    ds_read_b128 v[56:59], v13 offset:33472
    v_mfma_f32_32x32x16_bf16 v[64:79], a[132:135], v[36:39], v[64:79]
    ds_read_b128 v[60:63], v13 offset:33504
    s_add_u32 m0, s49, 0
    s_nop 0
    buffer_load_dwordx4 v2, s[12:15], s48 offen offset:0 sc1 lds
    s_waitcnt lgkmcnt(4)
    v_mfma_f32_32x32x16_bf16 v[64:79], a[136:139], v[40:43], v[64:79]
    ds_read_b128 v[32:35], v13 offset:33536
    v_mfma_f32_32x32x16_bf16 v[64:79], a[140:143], v[44:47], v[64:79]
    ds_read_b128 v[36:39], v13 offset:33568
    s_add_u32 m0, s49, 784
    s_nop 0
    buffer_load_dwordx4 v2, s[12:15], s48 offen offset:256 sc1 lds
    s_waitcnt lgkmcnt(4)
    v_mfma_f32_32x32x16_bf16 v[64:79], a[144:147], v[48:51], v[64:79]
    ds_read_b128 v[40:43], v13 offset:33600
    v_mfma_f32_32x32x16_bf16 v[64:79], a[148:151], v[52:55], v[64:79]
    ds_read_b128 v[44:47], v13 offset:33632
    s_add_u32 m0, s49, 1568
    s_nop 0
    buffer_load_dwordx4 v2, s[12:15], s48 offen offset:512 sc1 lds
    s_waitcnt lgkmcnt(4)
    v_mfma_f32_32x32x16_bf16 v[64:79], a[152:155], v[56:59], v[64:79]
    ds_read_b128 v[48:51], v13 offset:33664
    v_mfma_f32_32x32x16_bf16 v[64:79], a[156:159], v[60:63], v[64:79]
    ds_read_b128 v[52:55], v13 offset:33696
    s_add_u32 m0, s49, 2352
    s_nop 0
    buffer_load_dwordx4 v2, s[12:15], s48 offen offset:768 sc1 lds
    s_waitcnt lgkmcnt(4)
    v_mfma_f32_32x32x16_bf16 v[64:79], a[160:163], v[32:35], v[64:79]
    ds_read_b128 v[56:59], v13 offset:33728
    v_mfma_f32_32x32x16_bf16 v[64:79], a[164:167], v[36:39], v[64:79]
    ds_read_b128 v[60:63], v13 offset:33760
    s_add_u32 m0, s49, 3136
    s_nop 0
    buffer_load_dwordx4 v2, s[12:15], s48 offen offset:1024 sc1 lds
    s_waitcnt lgkmcnt(4)
    v_mfma_f32_32x32x16_bf16 v[64:79], a[168:171], v[40:43], v[64:79]
    ds_read_b128 v[32:35], v13 offset:33792
    v_mfma_f32_32x32x16_bf16 v[64:79], a[172:175], v[44:47], v[64:79]
    ds_read_b128 v[36:39], v13 offset:33824
    s_add_u32 m0, s49, 3920
    s_nop 0
    buffer_load_dwordx4 v2, s[12:15], s48 offen offset:1280 sc1 lds
    s_waitcnt lgkmcnt(4)
    v_mfma_f32_32x32x16_bf16 v[64:79], a[176:179], v[48:51], v[64:79]
    ds_read_b128 v[40:43], v13 offset:33856
    v_mfma_f32_32x32x16_bf16 v[64:79], a[180:183], v[52:55], v[64:79]
    ds_read_b128 v[44:47], v13 offset:33888
    s_add_u32 m0, s49, 4704
    s_nop 0
    buffer_load_dwordx4 v2, s[12:15], s48 offen offset:1536 sc1 lds
    s_waitcnt lgkmcnt(4)
    v_mfma_f32_32x32x16_bf16 v[64:79], a[184:187], v[56:59], v[64:79]
    ds_read_b128 v[48:51], v13 offset:33920
    v_mfma_f32_32x32x16_bf16 v[64:79], a[188:191], v[60:63], v[64:79]
    ds_read_b128 v[52:55], v13 offset:33952
    s_add_u32 m0, s49, 5488
    s_nop 0
    buffer_load_dwordx4 v2, s[12:15], s48 offen offset:1792 sc1 lds
    s_waitcnt lgkmcnt(4)
    v_mfma_f32_32x32x16_bf16 v[64:79], a[192:195], v[32:35], v[64:79]
    ds_read_b128 v[56:59], v13 offset:33984
    v_mfma_f32_32x32x16_bf16 v[64:79], a[196:199], v[36:39], v[64:79]
    ds_read_b128 v[60:63], v13 offset:34016
    s_waitcnt lgkmcnt(4)
    v_mfma_f32_32x32x16_bf16 v[64:79], a[200:203], v[40:43], v[64:79]
    ds_read_b128 v[32:35], v13 offset:34048
    v_mfma_f32_32x32x16_bf16 v[64:79], a[204:207], v[44:47], v[64:79]
    ds_read_b128 v[36:39], v13 offset:34080
    s_waitcnt lgkmcnt(4)
    v_mfma_f32_32x32x16_bf16 v[64:79], a[208:211], v[48:51], v[64:79]
    ds_read_b128 v[40:43], v13 offset:34112
    v_mfma_f32_32x32x16_bf16 v[64:79], a[212:215], v[52:55], v[64:79]
    ds_read_b128 v[44:47], v13 offset:34144
    s_waitcnt lgkmcnt(4)
    v_mfma_f32_32x32x16_bf16 v[64:79], a[216:219], v[56:59], v[64:79]
    ds_read_b128 v[48:51], v13 offset:34176
    v_mfma_f32_32x32x16_bf16 v[64:79], a[220:223], v[60:63], v[64:79]
    ds_read_b128 v[52:55], v13 offset:34208
    s_waitcnt lgkmcnt(4)
    v_mfma_f32_32x32x16_bf16 v[64:79], a[224:227], v[32:35], v[64:79]
    ds_read_b128 v[56:59], v13 offset:34240
    v_mfma_f32_32x32x16_bf16 v[64:79], a[228:231], v[36:39], v[64:79]
    ds_read_b128 v[60:63], v13 offset:34272
    s_waitcnt lgkmcnt(4)
    v_mfma_f32_32x32x16_bf16 v[64:79], a[232:235], v[40:43], v[64:79]
    v_mfma_f32_32x32x16_bf16 v[64:79], a[236:239], v[44:47], v[64:79]
    s_waitcnt lgkmcnt(2)
    v_mfma_f32_32x32x16_bf16 v[64:79], a[240:243], v[48:51], v[64:79]
    v_mfma_f32_32x32x16_bf16 v[64:79], a[244:247], v[52:55], v[64:79]
    s_waitcnt lgkmcnt(0)
    v_mfma_f32_32x32x16_bf16 v[64:79], a[248:251], v[56:59], v[64:79]
    v_mfma_f32_32x32x16_bf16 v[64:79], a[252:255], v[60:63], v[64:79]
    s_add_u32 s53, s53, 65536
    s_add_u32 s58, s58, 1
    v_add_u32 v13, s59, v13
    s_add_u32 s54, s54, s59
    s_sub_u32 s55, s55, s59
    s_sub_u32 s59, 0, s59
    s_lshl_b32 s45, s44, 11
    s_add_u32 s45, s45, s57
    s_add_u32 s57, s57, 229376
    s_nop 3
    v_cvt_pk_bf16_f32 v64, v64, v64
    v_lshlrev_b32 v64, 16, v64
    v_add_f32 v64, v64, v96
    v_cvt_pk_bf16_f32 v64, v64, v64
    v_lshlrev_b32 v64, 16, v64
    v_cvt_pk_bf16_f32 v65, v65, v65
    v_lshlrev_b32 v65, 16, v65
    v_add_f32 v65, v65, v97
    v_cvt_pk_bf16_f32 v65, v65, v65
    v_lshlrev_b32 v65, 16, v65
    v_cvt_pk_bf16_f32 v66, v66, v66
    v_lshlrev_b32 v66, 16, v66
    v_add_f32 v66, v66, v98
    v_cvt_pk_bf16_f32 v66, v66, v66
    v_lshlrev_b32 v66, 16, v66
    v_cvt_pk_bf16_f32 v67, v67, v67
    v_lshlrev_b32 v67, 16, v67
    v_add_f32 v67, v67, v99
    v_cvt_pk_bf16_f32 v67, v67, v67
    v_lshlrev_b32 v67, 16, v67
    v_cvt_pk_bf16_f32 v68, v68, v68
    v_lshlrev_b32 v68, 16, v68
    v_add_f32 v68, v68, v100
    v_cvt_pk_bf16_f32 v68, v68, v68
    v_lshlrev_b32 v68, 16, v68
    v_cvt_pk_bf16_f32 v69, v69, v69
    v_lshlrev_b32 v69, 16, v69
    v_add_f32 v69, v69, v101
    v_cvt_pk_bf16_f32 v69, v69, v69
    v_lshlrev_b32 v69, 16, v69
    v_cvt_pk_bf16_f32 v70, v70, v70
    v_lshlrev_b32 v70, 16, v70
    v_add_f32 v70, v70, v102
    v_cvt_pk_bf16_f32 v70, v70, v70
    v_lshlrev_b32 v70, 16, v70
    v_cvt_pk_bf16_f32 v71, v71, v71
    v_lshlrev_b32 v71, 16, v71
    v_add_f32 v71, v71, v103
    v_cvt_pk_bf16_f32 v71, v71, v71
    v_lshlrev_b32 v71, 16, v71
    v_cvt_pk_bf16_f32 v72, v72, v72
    v_lshlrev_b32 v72, 16, v72
    v_add_f32 v72, v72, v104
    v_cvt_pk_bf16_f32 v72, v72, v72
    v_lshlrev_b32 v72, 16, v72
    v_cvt_pk_bf16_f32 v73, v73, v73
    v_lshlrev_b32 v73, 16, v73
    v_add_f32 v73, v73, v105
    v_cvt_pk_bf16_f32 v73, v73, v73
    v_lshlrev_b32 v73, 16, v73
    v_cvt_pk_bf16_f32 v74, v74, v74
    v_lshlrev_b32 v74, 16, v74
    v_add_f32 v74, v74, v106
    v_cvt_pk_bf16_f32 v74, v74, v74
    v_lshlrev_b32 v74, 16, v74
    v_cvt_pk_bf16_f32 v75, v75, v75
    v_lshlrev_b32 v75, 16, v75
    v_add_f32 v75, v75, v107
    v_cvt_pk_bf16_f32 v75, v75, v75
    v_lshlrev_b32 v75, 16, v75
    v_cvt_pk_bf16_f32 v76, v76, v76
    v_lshlrev_b32 v76, 16, v76
    v_add_f32 v76, v76, v108
    v_cvt_pk_bf16_f32 v76, v76, v76
    v_lshlrev_b32 v76, 16, v76
    v_cvt_pk_bf16_f32 v77, v77, v77
    v_lshlrev_b32 v77, 16, v77
    v_add_f32 v77, v77, v109
    v_cvt_pk_bf16_f32 v77, v77, v77
    v_lshlrev_b32 v77, 16, v77
    v_cvt_pk_bf16_f32 v78, v78, v78
    v_lshlrev_b32 v78, 16, v78
    v_add_f32 v78, v78, v110
    v_cvt_pk_bf16_f32 v78, v78, v78
    v_lshlrev_b32 v78, 16, v78
    v_cvt_pk_bf16_f32 v79, v79, v79
    v_lshlrev_b32 v79, 16, v79
    v_add_f32 v79, v79, v111
    v_cvt_pk_bf16_f32 v79, v79, v79
    v_lshlrev_b32 v79, 16, v79
    v_mul_f32 v80, v64, v64
    v_mul_f32 v80, 0x3d372713, v80
    v_add_f32 v80, 1.0, v80
    v_mul_f32 v80, v80, v64
    v_mul_f32 v80, 0xc0135761, v80
    v_mul_f32 v81, v65, v65
    v_mul_f32 v81, 0x3d372713, v81
    v_add_f32 v81, 1.0, v81
    v_mul_f32 v81, v81, v65
    v_mul_f32 v81, 0xc0135761, v81
    v_mul_f32 v82, v66, v66
    v_mul_f32 v82, 0x3d372713, v82
    v_add_f32 v82, 1.0, v82
    v_mul_f32 v82, v82, v66
    v_mul_f32 v82, 0xc0135761, v82
    v_mul_f32 v83, v67, v67
    v_mul_f32 v83, 0x3d372713, v83
    v_add_f32 v83, 1.0, v83
    v_mul_f32 v83, v83, v67
    v_mul_f32 v83, 0xc0135761, v83
    v_mul_f32 v84, v68, v68
    v_mul_f32 v84, 0x3d372713, v84
    v_add_f32 v84, 1.0, v84
    v_mul_f32 v84, v84, v68
    v_mul_f32 v84, 0xc0135761, v84
    v_mul_f32 v85, v69, v69
    v_mul_f32 v85, 0x3d372713, v85
    v_add_f32 v85, 1.0, v85
    v_mul_f32 v85, v85, v69
    v_mul_f32 v85, 0xc0135761, v85
    v_mul_f32 v86, v70, v70
    v_mul_f32 v86, 0x3d372713, v86
    v_add_f32 v86, 1.0, v86
    v_mul_f32 v86, v86, v70
    v_mul_f32 v86, 0xc0135761, v86
    v_mul_f32 v87, v71, v71
    v_mul_f32 v87, 0x3d372713, v87
    v_add_f32 v87, 1.0, v87
    v_mul_f32 v87, v87, v71
    v_mul_f32 v87, 0xc0135761, v87
    v_mul_f32 v88, v72, v72
    v_mul_f32 v88, 0x3d372713, v88
    v_add_f32 v88, 1.0, v88
    v_mul_f32 v88, v88, v72
    v_mul_f32 v88, 0xc0135761, v88
    v_mul_f32 v89, v73, v73
    v_mul_f32 v89, 0x3d372713, v89
    v_add_f32 v89, 1.0, v89
    v_mul_f32 v89, v89, v73
    v_mul_f32 v89, 0xc0135761, v89
    v_mul_f32 v90, v74, v74
    v_mul_f32 v90, 0x3d372713, v90
    v_add_f32 v90, 1.0, v90
    v_mul_f32 v90, v90, v74
    v_mul_f32 v90, 0xc0135761, v90
    v_mul_f32 v91, v75, v75
    v_mul_f32 v91, 0x3d372713, v91
    v_add_f32 v91, 1.0, v91
    v_mul_f32 v91, v91, v75
    v_mul_f32 v91, 0xc0135761, v91
    v_mul_f32 v92, v76, v76
    v_mul_f32 v92, 0x3d372713, v92
    v_add_f32 v92, 1.0, v92
    v_mul_f32 v92, v92, v76
    v_mul_f32 v92, 0xc0135761, v92
    v_mul_f32 v93, v77, v77
    v_mul_f32 v93, 0x3d372713, v93
    v_add_f32 v93, 1.0, v93
    v_mul_f32 v93, v93, v77
    v_mul_f32 v93, 0xc0135761, v93
    v_mul_f32 v94, v78, v78
    v_mul_f32 v94, 0x3d372713, v94
    v_add_f32 v94, 1.0, v94
    v_mul_f32 v94, v94, v78
    v_mul_f32 v94, 0xc0135761, v94
    v_mul_f32 v95, v79, v79
    v_mul_f32 v95, 0x3d372713, v95
    v_add_f32 v95, 1.0, v95
    v_mul_f32 v95, v95, v79
    v_mul_f32 v95, 0xc0135761, v95
    v_exp_f32 v80, v80
    v_exp_f32 v81, v81
    v_exp_f32 v82, v82
    v_exp_f32 v83, v83
    v_exp_f32 v84, v84
    v_exp_f32 v85, v85
    v_exp_f32 v86, v86
    v_exp_f32 v87, v87
    v_exp_f32 v88, v88
    v_exp_f32 v89, v89
    v_exp_f32 v90, v90
    v_exp_f32 v91, v91
    v_exp_f32 v92, v92
    v_exp_f32 v93, v93
    v_exp_f32 v94, v94
    v_exp_f32 v95, v95
    v_add_f32 v80, 1.0, v80
    v_add_f32 v81, 1.0, v81
    v_add_f32 v82, 1.0, v82
    v_add_f32 v83, 1.0, v83
    v_add_f32 v84, 1.0, v84
    v_add_f32 v85, 1.0, v85
    v_add_f32 v86, 1.0, v86
    v_add_f32 v87, 1.0, v87
    v_add_f32 v88, 1.0, v88
    v_add_f32 v89, 1.0, v89
    v_add_f32 v90, 1.0, v90
    v_add_f32 v91, 1.0, v91
    v_add_f32 v92, 1.0, v92
    v_add_f32 v93, 1.0, v93
    v_add_f32 v94, 1.0, v94
    v_add_f32 v95, 1.0, v95
    v_rcp_f32 v80, v80
    v_rcp_f32 v81, v81
    v_rcp_f32 v82, v82
    v_rcp_f32 v83, v83
    v_rcp_f32 v84, v84
    v_rcp_f32 v85, v85
    v_rcp_f32 v86, v86
    v_rcp_f32 v87, v87
    v_rcp_f32 v88, v88
    v_rcp_f32 v89, v89
    v_rcp_f32 v90, v90
    v_rcp_f32 v91, v91
    v_rcp_f32 v92, v92
    v_rcp_f32 v93, v93
    v_rcp_f32 v94, v94
    v_rcp_f32 v95, v95
    v_mul_f32 v64, v64, v80
    v_mul_f32 v65, v65, v81
    v_mul_f32 v66, v66, v82
    v_mul_f32 v67, v67, v83
    v_mul_f32 v68, v68, v84
    v_mul_f32 v69, v69, v85
    v_mul_f32 v70, v70, v86
    v_mul_f32 v71, v71, v87
    v_mul_f32 v72, v72, v88
    v_mul_f32 v73, v73, v89
    v_mul_f32 v74, v74, v90
    v_mul_f32 v75, v75, v91
    v_mul_f32 v76, v76, v92
    v_mul_f32 v77, v77, v93
    v_mul_f32 v78, v78, v94
    v_mul_f32 v79, v79, v95
    v_cvt_pk_bf16_f32 v64, v64, v65
    v_cvt_pk_bf16_f32 v65, v66, v67
    v_cvt_pk_bf16_f32 v66, v68, v69
    v_cvt_pk_bf16_f32 v67, v70, v71
    v_cvt_pk_bf16_f32 v68, v72, v73
    v_cvt_pk_bf16_f32 v69, v74, v75
    v_cvt_pk_bf16_f32 v70, v76, v77
    v_cvt_pk_bf16_f32 v71, v78, v79
    ds_write_b128 v6, v[64:67]
    ds_write_b128 v6, v[68:71] offset:16
    s_waitcnt lgkmcnt(0)
    s_barrier
    ds_read_b128 v[80:83], v8
    ds_read_b128 v[84:87], v8 offset:1088
    s_waitcnt lgkmcnt(1)
    buffer_store_dwordx4 v[80:83], v10, s[12:15], s45 offen sc1
    s_waitcnt lgkmcnt(0)
    buffer_store_dwordx4 v[84:87], v10, s[12:15], s45 offen offset:1024 sc1
    s_cmp_lt_u32 s58, s51
    s_cbranch_scc1 L_e_loop_60
    s_add_u32 s47, s65, 256
    s_waitcnt vmcnt(0)
    s_barrier
    s_cmp_lg_u32 s44, 0
    s_cbranch_scc1 L_pub_61
    v_mov_b32 v30, s62
    v_mov_b32 v31, 0
    s_mov_b64 exec, 1
    buffer_store_dword v30, v31, s[12:15], s47 offen sc1
    s_mov_b64 exec, -1
L_pub_61:
    s_branch L_b_loop_54
L_role_c_44:
    s_load_dwordx2 s[6:7], s[0:1], 80
    s_load_dwordx2 s[8:9], s[0:1], 88
    s_load_dwordx2 s[10:11], s[0:1], 112
    s_waitcnt lgkmcnt(0)
    s_mov_b32 s24, s6
    s_and_b32 s25, s7, 0xffff
    s_mov_b32 s26, 0x700000
    s_mov_b32 s27, 0x00020000
    s_mov_b32 s28, s8
    s_and_b32 s29, s9, 0xffff
    s_mov_b32 s30, 0x800
    s_mov_b32 s31, 0x00020000
    s_mov_b32 s32, s10
    s_and_b32 s33, s11, 0xffff
    s_mov_b32 s34, 0x400000
    s_mov_b32 s35, 0x00020000
    s_mul_i32 s46, s38, 1835008
    s_lshl_b32 s45, s68, 8
    s_add_u32 s46, s46, s45
    s_waitcnt vmcnt(0)
    s_barrier
    v_lshrrev_b32 v20, 4, v1
    s_lshl_b32 s45, s44, 2
    v_add_u32 v21, s45, v20
    s_mov_b32 s45, 2048
    v_mul_lo_u32 v21, v21, s45
    v_lshlrev_b32 v22, 2, v20
    v_and_b32 v23, 15, v1
    v_xor_b32 v22, v22, v23
    v_lshlrev_b32 v22, 4, v22
    v_add_u32 v21, v21, v22
    v_bfe_u32 v22, v1, 2, 2
    v_lshrrev_b32 v23, 5, v1
    v_lshlrev_b32 v23, 3, v23
    v_add_u32 v23, v23, v22
    v_lshlrev_b32 v23, 8, v23
    v_xor_b32 v22, s44, v22
    v_lshlrev_b32 v22, 6, v22
    v_add_u32 v23, v23, v22
    v_and_b32 v22, 1, v1
    v_lshlrev_b32 v22, 5, v22
    v_add_u32 v23, v23, v22
    v_and_b32 v22, 16, v1
    v_add_u32 v23, v23, v22
    v_and_b32 v22, 2, v1
    v_lshlrev_b32 v22, 2, v22
    v_add_u32 v23, v23, v22
    v_add_u32 v24, 65536, v23
    v_add_u32 v25, 131072, v23
    s_lshl_b32 s47, s44, 10
    s_add_u32 s45, s46, 0x0
    s_add_u32 m0, s47, 0
    s_nop 0
    buffer_load_dwordx4 v21, s[24:27], s45 offen lds
    s_add_u32 s45, s46, 0x8000
    s_add_u32 m0, s47, 4096
    s_nop 0
    buffer_load_dwordx4 v21, s[24:27], s45 offen lds
    s_add_u32 s45, s46, 0x10000
    s_add_u32 m0, s47, 8192
    s_nop 0
    buffer_load_dwordx4 v21, s[24:27], s45 offen lds
    s_add_u32 s45, s46, 0x18000
    s_add_u32 m0, s47, 12288
    s_nop 0
    buffer_load_dwordx4 v21, s[24:27], s45 offen lds
    s_add_u32 s45, s46, 0x20000
    s_add_u32 m0, s47, 16384
    s_nop 0
    buffer_load_dwordx4 v21, s[24:27], s45 offen lds
    s_add_u32 s45, s46, 0x28000
    s_add_u32 m0, s47, 20480
    s_nop 0
    buffer_load_dwordx4 v21, s[24:27], s45 offen lds
    s_add_u32 s45, s46, 0x30000
    s_add_u32 m0, s47, 24576
    s_nop 0
    buffer_load_dwordx4 v21, s[24:27], s45 offen lds
    s_add_u32 s45, s46, 0x38000
    s_add_u32 m0, s47, 28672
    s_nop 0
    buffer_load_dwordx4 v21, s[24:27], s45 offen lds
    s_add_u32 s45, s46, 0x40000
    s_add_u32 m0, s47, 32768
    s_nop 0
    buffer_load_dwordx4 v21, s[24:27], s45 offen lds
    s_add_u32 s45, s46, 0x48000
    s_add_u32 m0, s47, 36864
    s_nop 0
    buffer_load_dwordx4 v21, s[24:27], s45 offen lds
    s_add_u32 s45, s46, 0x50000
    s_add_u32 m0, s47, 40960
    s_nop 0
    buffer_load_dwordx4 v21, s[24:27], s45 offen lds
    s_add_u32 s45, s46, 0x58000
    s_add_u32 m0, s47, 45056
    s_nop 0
    buffer_load_dwordx4 v21, s[24:27], s45 offen lds
    s_add_u32 s45, s46, 0x60000
    s_add_u32 m0, s47, 49152
    s_nop 0
    buffer_load_dwordx4 v21, s[24:27], s45 offen lds
    s_add_u32 s45, s46, 0x68000
    s_add_u32 m0, s47, 53248
    s_nop 0
    buffer_load_dwordx4 v21, s[24:27], s45 offen lds
    s_add_u32 s45, s46, 0x70000
    s_add_u32 m0, s47, 57344
    s_nop 0
    buffer_load_dwordx4 v21, s[24:27], s45 offen lds
    s_add_u32 s45, s46, 0x78000
    s_add_u32 m0, s47, 61440
    s_nop 0
    buffer_load_dwordx4 v21, s[24:27], s45 offen lds
    s_add_u32 s45, s46, 0x80000
    s_add_u32 m0, s47, 65536
    s_nop 0
    buffer_load_dwordx4 v21, s[24:27], s45 offen lds
    s_add_u32 s45, s46, 0x88000
    s_add_u32 m0, s47, 69632
    s_nop 0
    buffer_load_dwordx4 v21, s[24:27], s45 offen lds
    s_add_u32 s45, s46, 0x90000
    s_add_u32 m0, s47, 73728
    s_nop 0
    buffer_load_dwordx4 v21, s[24:27], s45 offen lds
    s_add_u32 s45, s46, 0x98000
    s_add_u32 m0, s47, 77824
    s_nop 0
    buffer_load_dwordx4 v21, s[24:27], s45 offen lds
    s_add_u32 s45, s46, 0xa0000
    s_add_u32 m0, s47, 81920
    s_nop 0
    buffer_load_dwordx4 v21, s[24:27], s45 offen lds
    s_add_u32 s45, s46, 0xa8000
    s_add_u32 m0, s47, 86016
    s_nop 0
    buffer_load_dwordx4 v21, s[24:27], s45 offen lds
    s_add_u32 s45, s46, 0xb0000
    s_add_u32 m0, s47, 90112
    s_nop 0
    buffer_load_dwordx4 v21, s[24:27], s45 offen lds
    s_add_u32 s45, s46, 0xb8000
    s_add_u32 m0, s47, 94208
    s_nop 0
    buffer_load_dwordx4 v21, s[24:27], s45 offen lds
    s_add_u32 s45, s46, 0xc0000
    s_add_u32 m0, s47, 98304
    s_nop 0
    buffer_load_dwordx4 v21, s[24:27], s45 offen lds
    s_add_u32 s45, s46, 0xc8000
    s_add_u32 m0, s47, 102400
    s_nop 0
    buffer_load_dwordx4 v21, s[24:27], s45 offen lds
    s_add_u32 s45, s46, 0xd0000
    s_add_u32 m0, s47, 106496
    s_nop 0
    buffer_load_dwordx4 v21, s[24:27], s45 offen lds
    s_add_u32 s45, s46, 0xd8000
    s_add_u32 m0, s47, 110592
    s_nop 0
    buffer_load_dwordx4 v21, s[24:27], s45 offen lds
    s_add_u32 s45, s46, 0xe0000
    s_add_u32 m0, s47, 114688
    s_nop 0
    buffer_load_dwordx4 v21, s[24:27], s45 offen lds
    s_add_u32 s45, s46, 0xe8000
    s_add_u32 m0, s47, 118784
    s_nop 0
    buffer_load_dwordx4 v21, s[24:27], s45 offen lds
    s_add_u32 s45, s46, 0xf0000
    s_add_u32 m0, s47, 122880
    s_nop 0
    buffer_load_dwordx4 v21, s[24:27], s45 offen lds
    s_add_u32 s45, s46, 0xf8000
    s_add_u32 m0, s47, 126976
    s_nop 0
    buffer_load_dwordx4 v21, s[24:27], s45 offen lds
    s_waitcnt vmcnt(28)
    s_barrier
    s_add_u32 s45, s46, 0x100000
    s_add_u32 m0, s47, 131072
    s_nop 0
    buffer_load_dwordx4 v21, s[24:27], s45 offen lds
    s_add_u32 s45, s46, 0x108000
    s_add_u32 m0, s47, 135168
    s_nop 0
    buffer_load_dwordx4 v21, s[24:27], s45 offen lds
    s_add_u32 s45, s46, 0x110000
    s_add_u32 m0, s47, 139264
    s_nop 0
    buffer_load_dwordx4 v21, s[24:27], s45 offen lds
    s_add_u32 s45, s46, 0x118000
    s_add_u32 m0, s47, 143360
    s_nop 0
    buffer_load_dwordx4 v21, s[24:27], s45 offen lds
    ds_read_b64_tr_b16 a[0:1], v23 offset:0
    ds_read_b64_tr_b16 a[2:3], v23 offset:1024
    ds_read_b64_tr_b16 a[4:5], v23 offset:4096
    ds_read_b64_tr_b16 a[6:7], v23 offset:5120
    ds_read_b64_tr_b16 a[8:9], v23 offset:8192
    ds_read_b64_tr_b16 a[10:11], v23 offset:9216
    ds_read_b64_tr_b16 a[12:13], v23 offset:12288
    ds_read_b64_tr_b16 a[14:15], v23 offset:13312
    s_waitcnt lgkmcnt(0)
    s_waitcnt vmcnt(28)
    s_barrier
    s_add_u32 s45, s46, 0x120000
    s_add_u32 m0, s47, 0
    s_nop 0
    buffer_load_dwordx4 v21, s[24:27], s45 offen lds
    s_add_u32 s45, s46, 0x128000
    s_add_u32 m0, s47, 4096
    s_nop 0
    buffer_load_dwordx4 v21, s[24:27], s45 offen lds
    s_add_u32 s45, s46, 0x130000
    s_add_u32 m0, s47, 8192
    s_nop 0
    buffer_load_dwordx4 v21, s[24:27], s45 offen lds
    s_add_u32 s45, s46, 0x138000
    s_add_u32 m0, s47, 12288
    s_nop 0
    buffer_load_dwordx4 v21, s[24:27], s45 offen lds
    ds_read_b64_tr_b16 a[16:17], v23 offset:16384
    ds_read_b64_tr_b16 a[18:19], v23 offset:17408
    ds_read_b64_tr_b16 a[20:21], v23 offset:20480
    ds_read_b64_tr_b16 a[22:23], v23 offset:21504
    ds_read_b64_tr_b16 a[24:25], v23 offset:24576
    ds_read_b64_tr_b16 a[26:27], v23 offset:25600
    ds_read_b64_tr_b16 a[28:29], v23 offset:28672
    ds_read_b64_tr_b16 a[30:31], v23 offset:29696
    s_waitcnt lgkmcnt(0)
    s_waitcnt vmcnt(28)
    s_barrier
    s_add_u32 s45, s46, 0x140000
    s_add_u32 m0, s47, 16384
    s_nop 0
    buffer_load_dwordx4 v21, s[24:27], s45 offen lds
    s_add_u32 s45, s46, 0x148000
    s_add_u32 m0, s47, 20480
    s_nop 0
    buffer_load_dwordx4 v21, s[24:27], s45 offen lds
    s_add_u32 s45, s46, 0x150000
    s_add_u32 m0, s47, 24576
    s_nop 0
    buffer_load_dwordx4 v21, s[24:27], s45 offen lds
    s_add_u32 s45, s46, 0x158000
    s_add_u32 m0, s47, 28672
    s_nop 0
    buffer_load_dwordx4 v21, s[24:27], s45 offen lds
    ds_read_b64_tr_b16 a[32:33], v23 offset:32768
    ds_read_b64_tr_b16 a[34:35], v23 offset:33792
    ds_read_b64_tr_b16 a[36:37], v23 offset:36864
    ds_read_b64_tr_b16 a[38:39], v23 offset:37888
    ds_read_b64_tr_b16 a[40:41], v23 offset:40960
    ds_read_b64_tr_b16 a[42:43], v23 offset:41984
    ds_read_b64_tr_b16 a[44:45], v23 offset:45056
    ds_read_b64_tr_b16 a[46:47], v23 offset:46080
    s_waitcnt lgkmcnt(0)
    s_waitcnt vmcnt(28)
    s_barrier
    s_add_u32 s45, s46, 0x160000
    s_add_u32 m0, s47, 32768
    s_nop 0
    buffer_load_dwordx4 v21, s[24:27], s45 offen lds
    s_add_u32 s45, s46, 0x168000
    s_add_u32 m0, s47, 36864
    s_nop 0
    buffer_load_dwordx4 v21, s[24:27], s45 offen lds
    s_add_u32 s45, s46, 0x170000
    s_add_u32 m0, s47, 40960
    s_nop 0
    buffer_load_dwordx4 v21, s[24:27], s45 offen lds
    s_add_u32 s45, s46, 0x178000
    s_add_u32 m0, s47, 45056
    s_nop 0
    buffer_load_dwordx4 v21, s[24:27], s45 offen lds
    ds_read_b64_tr_b16 a[48:49], v23 offset:49152
    ds_read_b64_tr_b16 a[50:51], v23 offset:50176
    ds_read_b64_tr_b16 a[52:53], v23 offset:53248
    ds_read_b64_tr_b16 a[54:55], v23 offset:54272
    ds_read_b64_tr_b16 a[56:57], v23 offset:57344
    ds_read_b64_tr_b16 a[58:59], v23 offset:58368
    ds_read_b64_tr_b16 a[60:61], v23 offset:61440
    ds_read_b64_tr_b16 a[62:63], v23 offset:62464
    s_waitcnt lgkmcnt(0)
    s_waitcnt vmcnt(28)
    s_barrier
    s_add_u32 s45, s46, 0x180000
    s_add_u32 m0, s47, 49152
    s_nop 0
    buffer_load_dwordx4 v21, s[24:27], s45 offen lds
    s_add_u32 s45, s46, 0x188000
    s_add_u32 m0, s47, 53248
    s_nop 0
    buffer_load_dwordx4 v21, s[24:27], s45 offen lds
    s_add_u32 s45, s46, 0x190000
    s_add_u32 m0, s47, 57344
    s_nop 0
    buffer_load_dwordx4 v21, s[24:27], s45 offen lds
    s_add_u32 s45, s46, 0x198000
    s_add_u32 m0, s47, 61440
    s_nop 0
    buffer_load_dwordx4 v21, s[24:27], s45 offen lds
    ds_read_b64_tr_b16 a[64:65], v24 offset:0
    ds_read_b64_tr_b16 a[66:67], v24 offset:1024
    ds_read_b64_tr_b16 a[68:69], v24 offset:4096
    ds_read_b64_tr_b16 a[70:71], v24 offset:5120
    ds_read_b64_tr_b16 a[72:73], v24 offset:8192
    ds_read_b64_tr_b16 a[74:75], v24 offset:9216
    ds_read_b64_tr_b16 a[76:77], v24 offset:12288
    ds_read_b64_tr_b16 a[78:79], v24 offset:13312
    s_waitcnt lgkmcnt(0)
    s_waitcnt vmcnt(28)
    s_barrier
    s_add_u32 s45, s46, 0x1a0000
    s_add_u32 m0, s47, 65536
    s_nop 0
    buffer_load_dwordx4 v21, s[24:27], s45 offen lds
    s_add_u32 s45, s46, 0x1a8000
    s_add_u32 m0, s47, 69632
    s_nop 0
    buffer_load_dwordx4 v21, s[24:27], s45 offen lds
    s_add_u32 s45, s46, 0x1b0000
    s_add_u32 m0, s47, 73728
    s_nop 0
    buffer_load_dwordx4 v21, s[24:27], s45 offen lds
    s_add_u32 s45, s46, 0x1b8000
    s_add_u32 m0, s47, 77824
    s_nop 0
    buffer_load_dwordx4 v21, s[24:27], s45 offen lds
    ds_read_b64_tr_b16 a[80:81], v24 offset:16384
    ds_read_b64_tr_b16 a[82:83], v24 offset:17408
    ds_read_b64_tr_b16 a[84:85], v24 offset:20480
    ds_read_b64_tr_b16 a[86:87], v24 offset:21504
    ds_read_b64_tr_b16 a[88:89], v24 offset:24576
    ds_read_b64_tr_b16 a[90:91], v24 offset:25600
    ds_read_b64_tr_b16 a[92:93], v24 offset:28672
    ds_read_b64_tr_b16 a[94:95], v24 offset:29696
    s_waitcnt lgkmcnt(0)
    s_waitcnt vmcnt(28)
    s_barrier
    ds_read_b64_tr_b16 a[96:97], v24 offset:32768
    ds_read_b64_tr_b16 a[98:99], v24 offset:33792
    ds_read_b64_tr_b16 a[100:101], v24 offset:36864
    ds_read_b64_tr_b16 a[102:103], v24 offset:37888
    ds_read_b64_tr_b16 a[104:105], v24 offset:40960
    ds_read_b64_tr_b16 a[106:107], v24 offset:41984
    ds_read_b64_tr_b16 a[108:109], v24 offset:45056
    ds_read_b64_tr_b16 a[110:111], v24 offset:46080
    s_waitcnt lgkmcnt(0)
    s_waitcnt vmcnt(24)
    s_barrier
    ds_read_b64_tr_b16 a[112:113], v24 offset:49152
    ds_read_b64_tr_b16 a[114:115], v24 offset:50176
    ds_read_b64_tr_b16 a[116:117], v24 offset:53248
    ds_read_b64_tr_b16 a[118:119], v24 offset:54272
    ds_read_b64_tr_b16 a[120:121], v24 offset:57344
    ds_read_b64_tr_b16 a[122:123], v24 offset:58368
    ds_read_b64_tr_b16 a[124:125], v24 offset:61440
    ds_read_b64_tr_b16 a[126:127], v24 offset:62464
    s_waitcnt lgkmcnt(0)
    s_waitcnt vmcnt(20)
    s_barrier
    ds_read_b64_tr_b16 a[128:129], v25 offset:0
    ds_read_b64_tr_b16 a[130:131], v25 offset:1024
    ds_read_b64_tr_b16 a[132:133], v25 offset:4096
    ds_read_b64_tr_b16 a[134:135], v25 offset:5120
    ds_read_b64_tr_b16 a[136:137], v25 offset:8192
    ds_read_b64_tr_b16 a[138:139], v25 offset:9216
    ds_read_b64_tr_b16 a[140:141], v25 offset:12288
    ds_read_b64_tr_b16 a[142:143], v25 offset:13312
    s_waitcnt lgkmcnt(0)
    s_waitcnt vmcnt(16)
    s_barrier
    ds_read_b64_tr_b16 a[144:145], v23 offset:0
    ds_read_b64_tr_b16 a[146:147], v23 offset:1024
    ds_read_b64_tr_b16 a[148:149], v23 offset:4096
    ds_read_b64_tr_b16 a[150:151], v23 offset:5120
    ds_read_b64_tr_b16 a[152:153], v23 offset:8192
    ds_read_b64_tr_b16 a[154:155], v23 offset:9216
    ds_read_b64_tr_b16 a[156:157], v23 offset:12288
    ds_read_b64_tr_b16 a[158:159], v23 offset:13312
    s_waitcnt lgkmcnt(0)
    s_waitcnt vmcnt(12)
    s_barrier
    ds_read_b64_tr_b16 a[160:161], v23 offset:16384
    ds_read_b64_tr_b16 a[162:163], v23 offset:17408
    ds_read_b64_tr_b16 a[164:165], v23 offset:20480
    ds_read_b64_tr_b16 a[166:167], v23 offset:21504
    ds_read_b64_tr_b16 a[168:169], v23 offset:24576
    ds_read_b64_tr_b16 a[170:171], v23 offset:25600
    ds_read_b64_tr_b16 a[172:173], v23 offset:28672
    ds_read_b64_tr_b16 a[174:175], v23 offset:29696
    s_waitcnt lgkmcnt(0)
    s_waitcnt vmcnt(8)
    s_barrier
    ds_read_b64_tr_b16 a[176:177], v23 offset:32768
    ds_read_b64_tr_b16 a[178:179], v23 offset:33792
    ds_read_b64_tr_b16 a[180:181], v23 offset:36864
    ds_read_b64_tr_b16 a[182:183], v23 offset:37888
    ds_read_b64_tr_b16 a[184:185], v23 offset:40960
    ds_read_b64_tr_b16 a[186:187], v23 offset:41984
    ds_read_b64_tr_b16 a[188:189], v23 offset:45056
    ds_read_b64_tr_b16 a[190:191], v23 offset:46080
    s_waitcnt lgkmcnt(0)
    s_waitcnt vmcnt(4)
    s_barrier
    ds_read_b64_tr_b16 a[192:193], v23 offset:49152
    ds_read_b64_tr_b16 a[194:195], v23 offset:50176
    ds_read_b64_tr_b16 a[196:197], v23 offset:53248
    ds_read_b64_tr_b16 a[198:199], v23 offset:54272
    ds_read_b64_tr_b16 a[200:201], v23 offset:57344
    ds_read_b64_tr_b16 a[202:203], v23 offset:58368
    ds_read_b64_tr_b16 a[204:205], v23 offset:61440
    ds_read_b64_tr_b16 a[206:207], v23 offset:62464
    s_waitcnt lgkmcnt(0)
    s_waitcnt vmcnt(0)
    s_barrier
    ds_read_b64_tr_b16 a[208:209], v24 offset:0
    ds_read_b64_tr_b16 a[210:211], v24 offset:1024
    ds_read_b64_tr_b16 a[212:213], v24 offset:4096
    ds_read_b64_tr_b16 a[214:215], v24 offset:5120
    ds_read_b64_tr_b16 a[216:217], v24 offset:8192
    ds_read_b64_tr_b16 a[218:219], v24 offset:9216
    ds_read_b64_tr_b16 a[220:221], v24 offset:12288
    ds_read_b64_tr_b16 a[222:223], v24 offset:13312
    s_waitcnt lgkmcnt(0)
    s_barrier
    buffer_load_dwordx4 v[80:83], v10, s[28:31], 0 offen
    buffer_load_dwordx4 v[84:87], v10, s[28:31], 0 offen offset:1024
    s_waitcnt vmcnt(0)
    v_lshlrev_b32 v96, 16, v80
    v_and_b32 v97, 0xffff0000, v80
    v_lshlrev_b32 v98, 16, v81
    v_and_b32 v99, 0xffff0000, v81
    v_lshlrev_b32 v100, 16, v82
    v_and_b32 v101, 0xffff0000, v82
    v_lshlrev_b32 v102, 16, v83
    v_and_b32 v103, 0xffff0000, v83
    v_lshlrev_b32 v104, 16, v84
    v_and_b32 v105, 0xffff0000, v84
    v_lshlrev_b32 v106, 16, v85
    v_and_b32 v107, 0xffff0000, v85
    v_lshlrev_b32 v108, 16, v86
    v_and_b32 v109, 0xffff0000, v86
    v_lshlrev_b32 v110, 16, v87
    v_and_b32 v111, 0xffff0000, v87
    v_lshlrev_b32 v29, 5, v1
    s_mov_b32 s45, 20480
    buffer_load_dwordx4 v[112:115], v29, s[12:15], s45 offen offset:0 sc1
    buffer_load_dwordx4 v[116:119], v29, s[12:15], s45 offen offset:16 sc1
    buffer_load_dwordx4 v[120:123], v29, s[12:15], s45 offen offset:2048 sc1
    buffer_load_dwordx4 v[124:127], v29, s[12:15], s45 offen offset:2064 sc1
    s_waitcnt vmcnt(0)
    s_mul_i32 s52, s38, 57344
    s_add_u32 s52, s52, 0x6000000
    s_lshl_b32 s56, s38, 23
    s_lshl_b32 s45, s68, 9
    s_add_u32 s56, s56, s45
    s_add_u32 s56, s56, 0xc000000
L_c_loop_62:
    s_cmp_eq_u64 s[36:37], 0
    s_cbranch_scc1 L_w_done_33
    s_ff1_i32_b64 s50, s[36:37]
    s_bitset0_b64 s[36:37], s50
    s_ff1_i32_b64 s62, s[36:37]
    s_cmp_eq_u64 s[36:37], 0
    s_cselect_b32 s62, 64, s62
    s_sub_u32 s51, s62, s50
    s_and_b32 s45, s62, 63
    s_bitset0_b64 s[36:37], s45
    s_mul_i32 s45, s38, 28
    s_add_u32 s45, s45, s64
    s_add_u32 s45, s45, 768
    s_mov_b64 exec, 127
    s_mov_b32 s70, 0
L_wp_64:
    buffer_load_dword v31, v12, s[12:15], s45 offen sc1
    s_add_u32 s70, s70, 1
    s_cmp_ge_u32 s70, 0x200000
    s_cbranch_scc1 L_w_done_33
    s_waitcnt vmcnt(0)
    v_cmp_gt_u32 vcc, s62, v31
    s_nop 1
    s_cbranch_vccz L_wp_64_ok
    s_sleep 2
    s_branch L_wp_64
L_wp_64_ok:
    s_mov_b64 exec, -1
    s_mul_i32 s53, s50, 229376
    s_add_u32 s53, s53, s52
    s_lshl_b32 s45, s44, 11
    s_add_u32 s53, s53, s45
    s_mul_i32 s57, s50, 131072
    s_add_u32 s57, s57, s56
    s_mul_i32 s54, s44, 8320
    s_add_u32 s55, s54, 66560
    s_mov_b32 s58, 0
    v_mov_b32 v13, v4
    s_mov_b32 s59, 66560
    s_add_u32 m0, s54, 0
    s_nop 0
    buffer_load_dwordx4 v2, s[12:15], s53 offen offset:0 sc1 lds
    s_add_u32 m0, s54, 784
    s_nop 0
    buffer_load_dwordx4 v2, s[12:15], s53 offen offset:256 sc1 lds
    s_add_u32 m0, s54, 1568
    s_nop 0
    buffer_load_dwordx4 v2, s[12:15], s53 offen offset:512 sc1 lds
    s_add_u32 m0, s54, 2352
    s_nop 0
    buffer_load_dwordx4 v2, s[12:15], s53 offen offset:768 sc1 lds
    s_add_u32 m0, s54, 3136
    s_nop 0
    buffer_load_dwordx4 v2, s[12:15], s53 offen offset:1024 sc1 lds
    s_add_u32 m0, s54, 3920
    s_nop 0
    buffer_load_dwordx4 v2, s[12:15], s53 offen offset:1280 sc1 lds
    s_add_u32 m0, s54, 4704
    s_nop 0
    buffer_load_dwordx4 v2, s[12:15], s53 offen offset:1536 sc1 lds
    s_add_u32 m0, s54, 5488
    s_nop 0
    buffer_load_dwordx4 v2, s[12:15], s53 offen offset:1792 sc1 lds
    s_add_u32 s45, s53, 32768
    s_add_u32 s46, s54, 33280
    s_add_u32 m0, s46, 0
    s_mov_b32 exec_hi, 0xffff
    buffer_load_dwordx4 v2, s[12:15], s45 offen offset:0 sc1 lds
    s_mov_b32 exec_hi, -1
    s_add_u32 m0, s46, 784
    s_mov_b32 exec_hi, 0xffff
    buffer_load_dwordx4 v2, s[12:15], s45 offen offset:256 sc1 lds
    s_mov_b32 exec_hi, -1
    s_add_u32 m0, s46, 1568
    s_mov_b32 exec_hi, 0xffff
    buffer_load_dwordx4 v2, s[12:15], s45 offen offset:512 sc1 lds
    s_mov_b32 exec_hi, -1
    s_add_u32 m0, s46, 2352
    s_mov_b32 exec_hi, 0xffff
    buffer_load_dwordx4 v2, s[12:15], s45 offen offset:768 sc1 lds
    s_mov_b32 exec_hi, -1
    s_add_u32 m0, s46, 3136
    s_mov_b32 exec_hi, 0xffff
    buffer_load_dwordx4 v2, s[12:15], s45 offen offset:1024 sc1 lds
    s_mov_b32 exec_hi, -1
    s_add_u32 m0, s46, 3920
    s_mov_b32 exec_hi, 0xffff
    buffer_load_dwordx4 v2, s[12:15], s45 offen offset:1280 sc1 lds
    s_mov_b32 exec_hi, -1
    s_add_u32 m0, s46, 4704
    s_mov_b32 exec_hi, 0xffff
    buffer_load_dwordx4 v2, s[12:15], s45 offen offset:1536 sc1 lds
    s_mov_b32 exec_hi, -1
    s_add_u32 m0, s46, 5488
    s_mov_b32 exec_hi, 0xffff
    buffer_load_dwordx4 v2, s[12:15], s45 offen offset:1792 sc1 lds
    s_mov_b32 exec_hi, -1
    s_add_u32 s45, s53, 229376
    s_cmp_gt_u32 s51, 1
    s_cselect_b32 s45, s45, 0x20000000
    s_add_u32 m0, s55, 0
    s_nop 0
    buffer_load_dwordx4 v2, s[12:15], s45 offen offset:0 sc1 lds
    s_add_u32 m0, s55, 784
    s_nop 0
    buffer_load_dwordx4 v2, s[12:15], s45 offen offset:256 sc1 lds
    s_add_u32 m0, s55, 1568
    s_nop 0
    buffer_load_dwordx4 v2, s[12:15], s45 offen offset:512 sc1 lds
    s_add_u32 m0, s55, 2352
    s_nop 0
    buffer_load_dwordx4 v2, s[12:15], s45 offen offset:768 sc1 lds
    s_add_u32 m0, s55, 3136
    s_nop 0
    buffer_load_dwordx4 v2, s[12:15], s45 offen offset:1024 sc1 lds
    s_add_u32 m0, s55, 3920
    s_nop 0
    buffer_load_dwordx4 v2, s[12:15], s45 offen offset:1280 sc1 lds
    s_add_u32 m0, s55, 4704
    s_nop 0
    buffer_load_dwordx4 v2, s[12:15], s45 offen offset:1536 sc1 lds
    s_add_u32 m0, s55, 5488
    s_nop 0
    buffer_load_dwordx4 v2, s[12:15], s45 offen offset:1792 sc1 lds
L_e_loop_65:
    s_add_u32 s45, s53, 262144
    s_add_u32 s46, s58, 1
    s_cmp_lt_u32 s46, s51
    s_cselect_b32 s48, s45, 0x20000000
    s_add_u32 s49, s55, 33280
    s_waitcnt vmcnt(16)
    s_barrier
    ds_read_b128 v[32:35], v13 offset:0
    ds_read_b128 v[36:39], v13 offset:32
    ds_read_b128 v[40:43], v13 offset:64
    ds_read_b128 v[44:47], v13 offset:96
    ds_read_b128 v[48:51], v13 offset:128
    ds_read_b128 v[52:55], v13 offset:160
    s_waitcnt lgkmcnt(4)
    v_mfma_f32_32x32x16_bf16 v[64:79], a[0:3], v[32:35], 0
    ds_read_b128 v[56:59], v13 offset:192
    v_mfma_f32_32x32x16_bf16 v[64:79], a[4:7], v[36:39], v[64:79]
    ds_read_b128 v[60:63], v13 offset:224
    s_add_u32 m0, s49, 0
    s_mov_b32 exec_hi, 0xffff
    buffer_load_dwordx4 v2, s[12:15], s48 offen offset:0 sc1 lds
    s_mov_b32 exec_hi, -1
    s_waitcnt lgkmcnt(4)
    v_mfma_f32_32x32x16_bf16 v[64:79], a[8:11], v[40:43], v[64:79]
    ds_read_b128 v[32:35], v13 offset:256
    v_mfma_f32_32x32x16_bf16 v[64:79], a[12:15], v[44:47], v[64:79]
    ds_read_b128 v[36:39], v13 offset:288
    s_add_u32 m0, s49, 784
    s_mov_b32 exec_hi, 0xffff
    buffer_load_dwordx4 v2, s[12:15], s48 offen offset:256 sc1 lds
    s_mov_b32 exec_hi, -1
    s_waitcnt lgkmcnt(4)
    v_mfma_f32_32x32x16_bf16 v[64:79], a[16:19], v[48:51], v[64:79]
    ds_read_b128 v[40:43], v13 offset:320
    v_mfma_f32_32x32x16_bf16 v[64:79], a[20:23], v[52:55], v[64:79]
    ds_read_b128 v[44:47], v13 offset:352
    s_add_u32 m0, s49, 1568
    s_mov_b32 exec_hi, 0xffff
    buffer_load_dwordx4 v2, s[12:15], s48 offen offset:512 sc1 lds
    s_mov_b32 exec_hi, -1
    s_waitcnt lgkmcnt(4)
    v_mfma_f32_32x32x16_bf16 v[64:79], a[24:27], v[56:59], v[64:79]
    ds_read_b128 v[48:51], v13 offset:384
    v_mfma_f32_32x32x16_bf16 v[64:79], a[28:31], v[60:63], v[64:79]
    ds_read_b128 v[52:55], v13 offset:416
    s_add_u32 m0, s49, 2352
    s_mov_b32 exec_hi, 0xffff
    buffer_load_dwordx4 v2, s[12:15], s48 offen offset:768 sc1 lds
    s_mov_b32 exec_hi, -1
    s_waitcnt lgkmcnt(4)
    v_mfma_f32_32x32x16_bf16 v[64:79], a[32:35], v[32:35], v[64:79]
    ds_read_b128 v[56:59], v13 offset:448
    v_mfma_f32_32x32x16_bf16 v[64:79], a[36:39], v[36:39], v[64:79]
    ds_read_b128 v[60:63], v13 offset:480
    s_add_u32 m0, s49, 3136
    s_mov_b32 exec_hi, 0xffff
    buffer_load_dwordx4 v2, s[12:15], s48 offen offset:1024 sc1 lds
    s_mov_b32 exec_hi, -1
    s_waitcnt lgkmcnt(4)
    v_mfma_f32_32x32x16_bf16 v[64:79], a[40:43], v[40:43], v[64:79]
    ds_read_b128 v[32:35], v13 offset:512
    v_mfma_f32_32x32x16_bf16 v[64:79], a[44:47], v[44:47], v[64:79]
    ds_read_b128 v[36:39], v13 offset:544
    s_add_u32 m0, s49, 3920
    s_mov_b32 exec_hi, 0xffff
    buffer_load_dwordx4 v2, s[12:15], s48 offen offset:1280 sc1 lds
    s_mov_b32 exec_hi, -1
    s_waitcnt lgkmcnt(4)
    v_mfma_f32_32x32x16_bf16 v[64:79], a[48:51], v[48:51], v[64:79]
    ds_read_b128 v[40:43], v13 offset:576
    v_mfma_f32_32x32x16_bf16 v[64:79], a[52:55], v[52:55], v[64:79]
    ds_read_b128 v[44:47], v13 offset:608
    s_add_u32 m0, s49, 4704
    s_mov_b32 exec_hi, 0xffff
    buffer_load_dwordx4 v2, s[12:15], s48 offen offset:1536 sc1 lds
    s_mov_b32 exec_hi, -1
    s_waitcnt lgkmcnt(4)
    v_mfma_f32_32x32x16_bf16 v[64:79], a[56:59], v[56:59], v[64:79]
    ds_read_b128 v[48:51], v13 offset:640
    v_mfma_f32_32x32x16_bf16 v[64:79], a[60:63], v[60:63], v[64:79]
    ds_read_b128 v[52:55], v13 offset:672
    s_add_u32 m0, s49, 5488
    s_mov_b32 exec_hi, 0xffff
    buffer_load_dwordx4 v2, s[12:15], s48 offen offset:1792 sc1 lds
    s_mov_b32 exec_hi, -1
    s_waitcnt lgkmcnt(4)
    v_mfma_f32_32x32x16_bf16 v[64:79], a[64:67], v[32:35], v[64:79]
    ds_read_b128 v[56:59], v13 offset:704
    v_mfma_f32_32x32x16_bf16 v[64:79], a[68:71], v[36:39], v[64:79]
    ds_read_b128 v[60:63], v13 offset:736
    s_waitcnt lgkmcnt(4)
    v_mfma_f32_32x32x16_bf16 v[64:79], a[72:75], v[40:43], v[64:79]
    ds_read_b128 v[32:35], v13 offset:768
    v_mfma_f32_32x32x16_bf16 v[64:79], a[76:79], v[44:47], v[64:79]
    ds_read_b128 v[36:39], v13 offset:800
    s_waitcnt lgkmcnt(4)
    v_mfma_f32_32x32x16_bf16 v[64:79], a[80:83], v[48:51], v[64:79]
    ds_read_b128 v[40:43], v13 offset:832
    v_mfma_f32_32x32x16_bf16 v[64:79], a[84:87], v[52:55], v[64:79]
    ds_read_b128 v[44:47], v13 offset:864
    s_waitcnt lgkmcnt(4)
    v_mfma_f32_32x32x16_bf16 v[64:79], a[88:91], v[56:59], v[64:79]
    ds_read_b128 v[48:51], v13 offset:896
    v_mfma_f32_32x32x16_bf16 v[64:79], a[92:95], v[60:63], v[64:79]
    ds_read_b128 v[52:55], v13 offset:928
    s_waitcnt lgkmcnt(4)
    v_mfma_f32_32x32x16_bf16 v[64:79], a[96:99], v[32:35], v[64:79]
    ds_read_b128 v[56:59], v13 offset:960
    v_mfma_f32_32x32x16_bf16 v[64:79], a[100:103], v[36:39], v[64:79]
    ds_read_b128 v[60:63], v13 offset:992
    s_waitcnt lgkmcnt(4)
    v_mfma_f32_32x32x16_bf16 v[64:79], a[104:107], v[40:43], v[64:79]
    v_mfma_f32_32x32x16_bf16 v[64:79], a[108:111], v[44:47], v[64:79]
    s_waitcnt lgkmcnt(2)
    v_mfma_f32_32x32x16_bf16 v[64:79], a[112:115], v[48:51], v[64:79]
    v_mfma_f32_32x32x16_bf16 v[64:79], a[116:119], v[52:55], v[64:79]
    s_waitcnt lgkmcnt(0)
    v_mfma_f32_32x32x16_bf16 v[64:79], a[120:123], v[56:59], v[64:79]
    v_mfma_f32_32x32x16_bf16 v[64:79], a[124:127], v[60:63], v[64:79]
    s_add_u32 s45, s53, 458752
    s_add_u32 s46, s58, 2
    s_cmp_lt_u32 s46, s51
    s_cselect_b32 s48, s45, 0x20000000
    s_mov_b32 s49, s54
    s_waitcnt vmcnt(16)
    s_barrier
    ds_read_b128 v[32:35], v13 offset:33280
    ds_read_b128 v[36:39], v13 offset:33312
    ds_read_b128 v[40:43], v13 offset:33344
    ds_read_b128 v[44:47], v13 offset:33376
    ds_read_b128 v[48:51], v13 offset:33408
    ds_read_b128 v[52:55], v13 offset:33440
    s_waitcnt lgkmcnt(4)
    v_mfma_f32_32x32x16_bf16 v[64:79], a[128:131], v[32:35], v[64:79]
    ds_read_b128 v[56:59], v13 offset:33472
    v_mfma_f32_32x32x16_bf16 v[64:79], a[132:135], v[36:39], v[64:79]
    ds_read_b128 v[60:63], v13 offset:33504
    s_add_u32 m0, s49, 0
    s_nop 0
    buffer_load_dwordx4 v2, s[12:15], s48 offen offset:0 sc1 lds
    s_waitcnt lgkmcnt(4)
    v_mfma_f32_32x32x16_bf16 v[64:79], a[136:139], v[40:43], v[64:79]
    ds_read_b128 v[32:35], v13 offset:33536
    v_mfma_f32_32x32x16_bf16 v[64:79], a[140:143], v[44:47], v[64:79]
    ds_read_b128 v[36:39], v13 offset:33568
    s_add_u32 m0, s49, 784
    s_nop 0
    buffer_load_dwordx4 v2, s[12:15], s48 offen offset:256 sc1 lds
    s_waitcnt lgkmcnt(4)
    v_mfma_f32_32x32x16_bf16 v[64:79], a[144:147], v[48:51], v[64:79]
    ds_read_b128 v[40:43], v13 offset:33600
    v_mfma_f32_32x32x16_bf16 v[64:79], a[148:151], v[52:55], v[64:79]
    ds_read_b128 v[44:47], v13 offset:33632
    s_add_u32 m0, s49, 1568
    s_nop 0
    buffer_load_dwordx4 v2, s[12:15], s48 offen offset:512 sc1 lds
    s_waitcnt lgkmcnt(4)
    v_mfma_f32_32x32x16_bf16 v[64:79], a[152:155], v[56:59], v[64:79]
    ds_read_b128 v[48:51], v13 offset:33664
    v_mfma_f32_32x32x16_bf16 v[64:79], a[156:159], v[60:63], v[64:79]
    ds_read_b128 v[52:55], v13 offset:33696
    s_add_u32 m0, s49, 2352
    s_nop 0
    buffer_load_dwordx4 v2, s[12:15], s48 offen offset:768 sc1 lds
    s_waitcnt lgkmcnt(4)
    v_mfma_f32_32x32x16_bf16 v[64:79], a[160:163], v[32:35], v[64:79]
    ds_read_b128 v[56:59], v13 offset:33728
    v_mfma_f32_32x32x16_bf16 v[64:79], a[164:167], v[36:39], v[64:79]
    ds_read_b128 v[60:63], v13 offset:33760
    s_add_u32 m0, s49, 3136
    s_nop 0
    buffer_load_dwordx4 v2, s[12:15], s48 offen offset:1024 sc1 lds
    s_waitcnt lgkmcnt(4)
    v_mfma_f32_32x32x16_bf16 v[64:79], a[168:171], v[40:43], v[64:79]
    ds_read_b128 v[32:35], v13 offset:33792
    v_mfma_f32_32x32x16_bf16 v[64:79], a[172:175], v[44:47], v[64:79]
    ds_read_b128 v[36:39], v13 offset:33824
    s_add_u32 m0, s49, 3920
    s_nop 0
    buffer_load_dwordx4 v2, s[12:15], s48 offen offset:1280 sc1 lds
    s_waitcnt lgkmcnt(4)
    v_mfma_f32_32x32x16_bf16 v[64:79], a[176:179], v[48:51], v[64:79]
    ds_read_b128 v[40:43], v13 offset:33856
    v_mfma_f32_32x32x16_bf16 v[64:79], a[180:183], v[52:55], v[64:79]
    ds_read_b128 v[44:47], v13 offset:33888
    s_add_u32 m0, s49, 4704
    s_nop 0
    buffer_load_dwordx4 v2, s[12:15], s48 offen offset:1536 sc1 lds
    s_waitcnt lgkmcnt(4)
    v_mfma_f32_32x32x16_bf16 v[64:79], a[184:187], v[56:59], v[64:79]
    ds_read_b128 v[48:51], v13 offset:33920
    v_mfma_f32_32x32x16_bf16 v[64:79], a[188:191], v[60:63], v[64:79]
    ds_read_b128 v[52:55], v13 offset:33952
    s_add_u32 m0, s49, 5488
    s_nop 0
    buffer_load_dwordx4 v2, s[12:15], s48 offen offset:1792 sc1 lds
    s_waitcnt lgkmcnt(4)
    v_mfma_f32_32x32x16_bf16 v[64:79], a[192:195], v[32:35], v[64:79]
    ds_read_b128 v[56:59], v13 offset:33984
    v_mfma_f32_32x32x16_bf16 v[64:79], a[196:199], v[36:39], v[64:79]
    ds_read_b128 v[60:63], v13 offset:34016
    s_waitcnt lgkmcnt(4)
    v_mfma_f32_32x32x16_bf16 v[64:79], a[200:203], v[40:43], v[64:79]
    v_mfma_f32_32x32x16_bf16 v[64:79], a[204:207], v[44:47], v[64:79]
    s_waitcnt lgkmcnt(2)
    v_mfma_f32_32x32x16_bf16 v[64:79], a[208:211], v[48:51], v[64:79]
    v_mfma_f32_32x32x16_bf16 v[64:79], a[212:215], v[52:55], v[64:79]
    s_waitcnt lgkmcnt(0)
    v_mfma_f32_32x32x16_bf16 v[64:79], a[216:219], v[56:59], v[64:79]
    v_mfma_f32_32x32x16_bf16 v[64:79], a[220:223], v[60:63], v[64:79]
    s_add_u32 s53, s53, 229376
    s_add_u32 s58, s58, 1
    v_add_u32 v13, s59, v13
    s_add_u32 s54, s54, s59
    s_sub_u32 s55, s55, s59
    s_sub_u32 s59, 0, s59
    s_lshl_b32 s45, s44, 15
    s_add_u32 s45, s45, s57
    s_add_u32 s57, s57, 131072
    s_nop 3
    ds_write_b128 v7, v[64:67] offset:0
    ds_write_b128 v7, v[68:71] offset:16
    ds_write_b128 v7, v[72:75] offset:32
    ds_write_b128 v7, v[76:79] offset:48
    s_waitcnt lgkmcnt(0)
    s_barrier
    ds_read_b128 v[80:83], v9 offset:0
    ds_read_b128 v[84:87], v9 offset:1056
    ds_read_b128 v[88:91], v9 offset:2112
    ds_read_b128 v[92:95], v9 offset:3168
    s_waitcnt lgkmcnt(3)
    buffer_store_dwordx4 v[80:83], v11, s[12:15], s45 offen sc1
    s_add_u32 s45, s45, 8192
    s_waitcnt lgkmcnt(2)
    buffer_store_dwordx4 v[84:87], v11, s[12:15], s45 offen sc1
    s_add_u32 s45, s45, 8192
    s_waitcnt lgkmcnt(1)
    buffer_store_dwordx4 v[88:91], v11, s[12:15], s45 offen sc1
    s_add_u32 s45, s45, 8192
    s_waitcnt lgkmcnt(0)
    buffer_store_dwordx4 v[92:95], v11, s[12:15], s45 offen sc1
    s_cmp_lt_u32 s58, s51
    s_cbranch_scc1 L_e_loop_65
    s_waitcnt vmcnt(0)
    s_barrier
    s_cmp_lg_u32 s44, 0
    s_cbranch_scc1 L_pub_66
    v_mov_b32 v30, s62
    v_mov_b32 v31, 0
    s_mov_b64 exec, 1
    buffer_store_dword v30, v31, s[12:15], s65 offen sc1
    s_mov_b64 exec, -1
L_pub_66:
    s_add_u32 s63, s50, s44
    s_lshl_b32 s63, s63, 5
    s_add_u32 s63, s63, s41
    s_cmp_ge_u32 s44, s51
    s_cbranch_scc1 L_c_loop_62
    s_lshl_b32 s47, s63, 11
    s_add_u32 s46, s47, 0x800000
    buffer_load_dwordx4 v[208:211], v10, s[12:15], s46 offen sc1
    buffer_load_dwordx4 v[212:215], v10, s[12:15], s46 offen offset:1024 sc1
    s_add_u32 s45, s64, 1024
    s_mov_b32 exec_hi, 0
    s_mov_b32 s70, 0
L_wp_67:
    buffer_load_dword v31, v12, s[12:15], s45 offen sc1
    s_add_u32 s70, s70, 1
    s_cmp_ge_u32 s70, 0x200000
    s_cbranch_scc1 L_w_done_33
    s_waitcnt vmcnt(0)
    v_cmp_gt_u32 vcc, s62, v31
    s_nop 1
    s_cbranch_vccz L_wp_67_ok
    s_sleep 1
    s_branch L_wp_67
L_wp_67_ok:
    s_mov_b64 exec, -1
    s_lshl_b32 s45, s63, 12
    s_add_u32 s45, s45, 0xc000000
    v_lshlrev_b32 v29, 5, v1
    buffer_load_dwordx4 v[64:67], v29, s[12:15], s45 offen offset:0 sc1
    buffer_load_dwordx4 v[68:71], v29, s[12:15], s45 offen offset:16 sc1
    buffer_load_dwordx4 v[72:75], v29, s[12:15], s45 offen offset:2048 sc1
    buffer_load_dwordx4 v[76:79], v29, s[12:15], s45 offen offset:2064 sc1
    s_add_u32 s45, s45, 0x800000
    buffer_load_dwordx4 v[160:163], v29, s[12:15], s45 offen offset:0 sc1
    buffer_load_dwordx4 v[164:167], v29, s[12:15], s45 offen offset:16 sc1
    buffer_load_dwordx4 v[168:171], v29, s[12:15], s45 offen offset:2048 sc1
    buffer_load_dwordx4 v[172:175], v29, s[12:15], s45 offen offset:2064 sc1
    s_add_u32 s45, s45, 0x800000
    buffer_load_dwordx4 v[176:179], v29, s[12:15], s45 offen offset:0 sc1
    buffer_load_dwordx4 v[180:183], v29, s[12:15], s45 offen offset:16 sc1
    buffer_load_dwordx4 v[184:187], v29, s[12:15], s45 offen offset:2048 sc1
    buffer_load_dwordx4 v[188:191], v29, s[12:15], s45 offen offset:2064 sc1
    s_add_u32 s45, s45, 0x800000
    buffer_load_dwordx4 v[192:195], v29, s[12:15], s45 offen offset:0 sc1
    buffer_load_dwordx4 v[196:199], v29, s[12:15], s45 offen offset:16 sc1
    buffer_load_dwordx4 v[200:203], v29, s[12:15], s45 offen offset:2048 sc1
    buffer_load_dwordx4 v[204:207], v29, s[12:15], s45 offen offset:2064 sc1
    s_waitcnt vmcnt(0)
    v_pk_add_f32 v[64:65], v[64:65], v[160:161]
    v_pk_add_f32 v[176:177], v[176:177], v[192:193]
    v_pk_add_f32 v[66:67], v[66:67], v[162:163]
    v_pk_add_f32 v[178:179], v[178:179], v[194:195]
    v_pk_add_f32 v[68:69], v[68:69], v[164:165]
    v_pk_add_f32 v[180:181], v[180:181], v[196:197]
    v_pk_add_f32 v[70:71], v[70:71], v[166:167]
    v_pk_add_f32 v[182:183], v[182:183], v[198:199]
    v_pk_add_f32 v[72:73], v[72:73], v[168:169]
    v_pk_add_f32 v[184:185], v[184:185], v[200:201]
    v_pk_add_f32 v[74:75], v[74:75], v[170:171]
    v_pk_add_f32 v[186:187], v[186:187], v[202:203]
    v_pk_add_f32 v[76:77], v[76:77], v[172:173]
    v_pk_add_f32 v[188:189], v[188:189], v[204:205]
    v_pk_add_f32 v[78:79], v[78:79], v[174:175]
    v_pk_add_f32 v[190:191], v[190:191], v[206:207]
    v_pk_add_f32 v[64:65], v[64:65], v[176:177]
    v_pk_add_f32 v[66:67], v[66:67], v[178:179]
    v_pk_add_f32 v[68:69], v[68:69], v[180:181]
    v_pk_add_f32 v[70:71], v[70:71], v[182:183]
    v_pk_add_f32 v[72:73], v[72:73], v[184:185]
    v_pk_add_f32 v[74:75], v[74:75], v[186:187]
    v_pk_add_f32 v[76:77], v[76:77], v[188:189]
    v_pk_add_f32 v[78:79], v[78:79], v[190:191]
    v_cvt_pk_bf16_f32 v64, v64, v64
    v_lshlrev_b32 v64, 16, v64
    v_cvt_pk_bf16_f32 v65, v65, v65
    v_lshlrev_b32 v65, 16, v65
    v_cvt_pk_bf16_f32 v66, v66, v66
    v_lshlrev_b32 v66, 16, v66
    v_cvt_pk_bf16_f32 v67, v67, v67
    v_lshlrev_b32 v67, 16, v67
    v_cvt_pk_bf16_f32 v68, v68, v68
    v_lshlrev_b32 v68, 16, v68
    v_cvt_pk_bf16_f32 v69, v69, v69
    v_lshlrev_b32 v69, 16, v69
    v_cvt_pk_bf16_f32 v70, v70, v70
    v_lshlrev_b32 v70, 16, v70
    v_cvt_pk_bf16_f32 v71, v71, v71
    v_lshlrev_b32 v71, 16, v71
    v_cvt_pk_bf16_f32 v72, v72, v72
    v_lshlrev_b32 v72, 16, v72
    v_cvt_pk_bf16_f32 v73, v73, v73
    v_lshlrev_b32 v73, 16, v73
    v_cvt_pk_bf16_f32 v74, v74, v74
    v_lshlrev_b32 v74, 16, v74
    v_cvt_pk_bf16_f32 v75, v75, v75
    v_lshlrev_b32 v75, 16, v75
    v_cvt_pk_bf16_f32 v76, v76, v76
    v_lshlrev_b32 v76, 16, v76
    v_cvt_pk_bf16_f32 v77, v77, v77
    v_lshlrev_b32 v77, 16, v77
    v_cvt_pk_bf16_f32 v78, v78, v78
    v_lshlrev_b32 v78, 16, v78
    v_cvt_pk_bf16_f32 v79, v79, v79
    v_lshlrev_b32 v79, 16, v79
    v_lshlrev_b32 v160, 16, v208
    v_and_b32 v161, 0xffff0000, v208
    v_lshlrev_b32 v162, 16, v209
    v_and_b32 v163, 0xffff0000, v209
    v_lshlrev_b32 v164, 16, v210
    v_and_b32 v165, 0xffff0000, v210
    v_lshlrev_b32 v166, 16, v211
    v_and_b32 v167, 0xffff0000, v211
    v_lshlrev_b32 v168, 16, v212
    v_and_b32 v169, 0xffff0000, v212
    v_lshlrev_b32 v170, 16, v213
    v_and_b32 v171, 0xffff0000, v213
    v_lshlrev_b32 v172, 16, v214
    v_and_b32 v173, 0xffff0000, v214
    v_lshlrev_b32 v174, 16, v215
    v_and_b32 v175, 0xffff0000, v215
    v_add_f32 v64, v64, v96
    v_cvt_pk_bf16_f32 v64, v64, v64
    v_lshlrev_b32 v64, 16, v64
    v_mul_f32 v64, v64, v112
    v_cvt_pk_bf16_f32 v64, v64, v64
    v_lshlrev_b32 v64, 16, v64
    v_add_f32 v64, v64, v160
    v_add_f32 v65, v65, v97
    v_cvt_pk_bf16_f32 v65, v65, v65
    v_lshlrev_b32 v65, 16, v65
    v_mul_f32 v65, v65, v113
    v_cvt_pk_bf16_f32 v65, v65, v65
    v_lshlrev_b32 v65, 16, v65
    v_add_f32 v65, v65, v161
    v_add_f32 v66, v66, v98
    v_cvt_pk_bf16_f32 v66, v66, v66
    v_lshlrev_b32 v66, 16, v66
    v_mul_f32 v66, v66, v114
    v_cvt_pk_bf16_f32 v66, v66, v66
    v_lshlrev_b32 v66, 16, v66
    v_add_f32 v66, v66, v162
    v_add_f32 v67, v67, v99
    v_cvt_pk_bf16_f32 v67, v67, v67
    v_lshlrev_b32 v67, 16, v67
    v_mul_f32 v67, v67, v115
    v_cvt_pk_bf16_f32 v67, v67, v67
    v_lshlrev_b32 v67, 16, v67
    v_add_f32 v67, v67, v163
    v_add_f32 v68, v68, v100
    v_cvt_pk_bf16_f32 v68, v68, v68
    v_lshlrev_b32 v68, 16, v68
    v_mul_f32 v68, v68, v116
    v_cvt_pk_bf16_f32 v68, v68, v68
    v_lshlrev_b32 v68, 16, v68
    v_add_f32 v68, v68, v164
    v_add_f32 v69, v69, v101
    v_cvt_pk_bf16_f32 v69, v69, v69
    v_lshlrev_b32 v69, 16, v69
    v_mul_f32 v69, v69, v117
    v_cvt_pk_bf16_f32 v69, v69, v69
    v_lshlrev_b32 v69, 16, v69
    v_add_f32 v69, v69, v165
    v_add_f32 v70, v70, v102
    v_cvt_pk_bf16_f32 v70, v70, v70
    v_lshlrev_b32 v70, 16, v70
    v_mul_f32 v70, v70, v118
    v_cvt_pk_bf16_f32 v70, v70, v70
    v_lshlrev_b32 v70, 16, v70
    v_add_f32 v70, v70, v166
    v_add_f32 v71, v71, v103
    v_cvt_pk_bf16_f32 v71, v71, v71
    v_lshlrev_b32 v71, 16, v71
    v_mul_f32 v71, v71, v119
    v_cvt_pk_bf16_f32 v71, v71, v71
    v_lshlrev_b32 v71, 16, v71
    v_add_f32 v71, v71, v167
    v_add_f32 v72, v72, v104
    v_cvt_pk_bf16_f32 v72, v72, v72
    v_lshlrev_b32 v72, 16, v72
    v_mul_f32 v72, v72, v120
    v_cvt_pk_bf16_f32 v72, v72, v72
    v_lshlrev_b32 v72, 16, v72
    v_add_f32 v72, v72, v168
    v_add_f32 v73, v73, v105
    v_cvt_pk_bf16_f32 v73, v73, v73
    v_lshlrev_b32 v73, 16, v73
    v_mul_f32 v73, v73, v121
    v_cvt_pk_bf16_f32 v73, v73, v73
    v_lshlrev_b32 v73, 16, v73
    v_add_f32 v73, v73, v169
    v_add_f32 v74, v74, v106
    v_cvt_pk_bf16_f32 v74, v74, v74
    v_lshlrev_b32 v74, 16, v74
    v_mul_f32 v74, v74, v122
    v_cvt_pk_bf16_f32 v74, v74, v74
    v_lshlrev_b32 v74, 16, v74
    v_add_f32 v74, v74, v170
    v_add_f32 v75, v75, v107
    v_cvt_pk_bf16_f32 v75, v75, v75
    v_lshlrev_b32 v75, 16, v75
    v_mul_f32 v75, v75, v123
    v_cvt_pk_bf16_f32 v75, v75, v75
    v_lshlrev_b32 v75, 16, v75
    v_add_f32 v75, v75, v171
    v_add_f32 v76, v76, v108
    v_cvt_pk_bf16_f32 v76, v76, v76
    v_lshlrev_b32 v76, 16, v76
    v_mul_f32 v76, v76, v124
    v_cvt_pk_bf16_f32 v76, v76, v76
    v_lshlrev_b32 v76, 16, v76
    v_add_f32 v76, v76, v172
    v_add_f32 v77, v77, v109
    v_cvt_pk_bf16_f32 v77, v77, v77
    v_lshlrev_b32 v77, 16, v77
    v_mul_f32 v77, v77, v125
    v_cvt_pk_bf16_f32 v77, v77, v77
    v_lshlrev_b32 v77, 16, v77
    v_add_f32 v77, v77, v173
    v_add_f32 v78, v78, v110
    v_cvt_pk_bf16_f32 v78, v78, v78
    v_lshlrev_b32 v78, 16, v78
    v_mul_f32 v78, v78, v126
    v_cvt_pk_bf16_f32 v78, v78, v78
    v_lshlrev_b32 v78, 16, v78
    v_add_f32 v78, v78, v174
    v_add_f32 v79, v79, v111
    v_cvt_pk_bf16_f32 v79, v79, v79
    v_lshlrev_b32 v79, 16, v79
    v_mul_f32 v79, v79, v127
    v_cvt_pk_bf16_f32 v79, v79, v79
    v_lshlrev_b32 v79, 16, v79
    v_add_f32 v79, v79, v175
    v_cvt_pk_bf16_f32 v208, v64, v65
    v_cvt_pk_bf16_f32 v209, v66, v67
    v_cvt_pk_bf16_f32 v210, v68, v69
    v_cvt_pk_bf16_f32 v211, v70, v71
    v_cvt_pk_bf16_f32 v212, v72, v73
    v_cvt_pk_bf16_f32 v213, v74, v75
    v_cvt_pk_bf16_f32 v214, v76, v77
    v_cvt_pk_bf16_f32 v215, v78, v79
    buffer_store_dwordx4 v[208:211], v10, s[32:35], s47 offen
    buffer_store_dwordx4 v[212:215], v10, s[32:35], s47 offen offset:1024
    s_branch L_c_loop_62
L_w_done_33:
    s_endpgm
.section .rodata,"a"
.p2align 6
.amdhsa_kernel adaLN_cond__memory_aug_recurrent_mem_tr__dense_activation_gelu__prompt_kernel
  .amdhsa_next_free_vgpr 512
  .amdhsa_next_free_sgpr 102
  .amdhsa_accum_offset 256
  .amdhsa_group_segment_fixed_size 0
  .amdhsa_kernarg_size 136
  .amdhsa_user_sgpr_count 2
  .amdhsa_user_sgpr_kernarg_segment_ptr 1
  .amdhsa_system_sgpr_workgroup_id_x 1
.end_amdhsa_kernel
```

```asm
; @launch kernel=adaLN_cond__memory_aug_recurrent_mem_tr__dense_activation_gelu__prompt_kernel grid=(256,1,1) block=(256,1,1) lds=163840
.amdgcn_target "amdgcn-amd-amdhsa--gfx950"
.text
.globl adaLN_cond__memory_aug_recurrent_mem_tr__dense_activation_gelu__prompt_kernel
.p2align 8
.type adaLN_cond__memory_aug_recurrent_mem_tr__dense_activation_gelu__prompt_kernel,@function
adaLN_cond__memory_aug_recurrent_mem_tr__dense_activation_gelu__prompt_kernel:
    s_cmp_lt_u32 s2, 256
    s_cbranch_scc1 L_c_done_1_go
    s_endpgm
L_c_done_1_go:
    s_and_b32 s40, s2, 7
    s_load_dwordx4 s[4:7], s[0:1], 16
    s_load_dwordx4 s[8:11], s[0:1], 32
    s_load_dwordx2 s[20:21], s[0:1], 128
    s_load_dwordx2 s[22:23], s[0:1], 120
    s_load_dwordx2 s[50:51], s[0:1], 8
    s_lshr_b32 s41, s2, 3
    s_and_b32 s42, s41, 15
    v_and_b32 v1, 63, v0
    v_lshrrev_b32 v2, 6, v0
    s_nop 0
    v_readfirstlane_b32 s44, v2
    s_waitcnt lgkmcnt(0)
    s_mov_b32 s24, s4
    s_and_b32 s25, s5, 0xffff
    s_mov_b32 s26, 0x800000
    s_mov_b32 s27, 0x00020000
    s_mov_b32 s28, s6
    s_and_b32 s29, s7, 0xffff
    s_mov_b32 s30, 0x800000
    s_mov_b32 s31, 0x00020000
    s_mov_b32 s32, s8
    s_and_b32 s33, s9, 0xffff
    s_mov_b32 s34, 0x800000
    s_mov_b32 s35, 0x00020000
    s_mov_b32 s36, s10
    s_and_b32 s37, s11, 0xffff
    s_mov_b32 s38, 0x800000
    s_mov_b32 s39, 0x00020000
    s_mov_b32 s12, s20
    s_and_b32 s13, s21, 0xffff
    s_mov_b32 s14, 0x10000000
    s_mov_b32 s15, 0x00020000
    s_mov_b32 s16, s22
    s_and_b32 s17, s23, 0xffff
    s_mov_b32 s18, 0x100
    s_mov_b32 s19, 0x00020000
    s_mov_b32 s52, s50
    s_and_b32 s53, s51, 0xffff
    s_mov_b32 s54, 0x4000
    s_mov_b32 s55, 0x00020000
    v_mov_b32 v41, 0
    s_cmp_lg_u32 s2, 1
    s_cbranch_scc1 L_worker_3_a
    s_getreg_b32 s45, hwreg(HW_REG_XCC_ID)
    s_and_b32 s45, s45, 1
    s_add_u32 s45, s45, 1
    v_mov_b32 v40, s45
    buffer_store_dword v40, v41, s[16:19], 0 offen offset:24 sc1
L_worker_3_a:
    s_cmp_eq_u32 s40, 1
    s_cbranch_scc1 L_worker_3_g0
    s_cmp_lt_u32 s40, 3
    s_cbranch_scc1 L_worker_3_q
    s_sub_u32 s40, s40, 2
    s_branch L_worker_3
L_worker_3_q:
    s_mov_b32 s70, 0
L_worker_3_p:
    buffer_load_dword v40, v41, s[16:19], 0 offen offset:24 sc1
    s_add_u32 s70, s70, 1
    s_cmp_ge_u32 s70, 0x200000
    s_cbranch_scc1 L_c_done_1
    s_waitcnt vmcnt(0)
    v_readfirstlane_b32 s45, v40
    s_nop 3
    s_cmp_eq_u32 s45, 0
    s_cbranch_scc1 L_worker_3_p
    s_and_b32 s45, s45, 2
    s_cmp_lg_u32 s45, s40
    s_mov_b32 s40, 1
    s_cbranch_scc1 L_worker_3_no
    s_mov_b32 s40, 0
    s_branch L_worker_3
L_worker_3_g0:
    s_mov_b32 s40, 0
L_worker_3_no:
    s_lshl_b32 s43, s40, 4
    s_add_u32 s43, s43, s42
    s_lshl_b32 s3, s43, 7
    s_lshr_b32 s45, s41, 4
    s_lshl_b32 s45, s45, 4
    s_add_u32 s3, s3, s45
    s_lshl_b32 s45, s44, 2
    s_add_u32 s3, s3, s45
    s_add_u32 s3, s3, 0x11000
    v_mov_b32 v40, 0
    s_mov_b64 exec, 1
    buffer_store_dword v40, v40, s[12:15], s3 offen sc1
    s_mov_b64 exec, -1
    v_and_b32 v21, 8, v1
    v_cmp_eq_u32 s[56:57], 0, v21
    v_mov_b32 v2, 0xeeee
    v_mov_b32 v3, 0x4444
    v_cndmask_b32 v2, v2, v3, s[56:57]
    v_lshlrev_b32 v68, 4, v1
    s_lshl_b32 s45, s44, 12
    v_add_u32 v3, s45, v68
    v_add_u32 v4, 4096, v3
    v_and_b32 v4, 16383, v4
    v_add_u32 v21, 8192, v3
    v_and_b32 v21, 16383, v21
    v_add_u32 v23, 12288, v3
    v_and_b32 v23, 16383, v23
    s_mul_i32 s45, s44, 24576
    s_add_u32 s45, s45, 65536
    v_add_u32 v5, s45, v68
    v_lshrrev_b32 v63, 4, v1
    s_lshl_b32 s45, s44, 2
    v_add_u32 v64, s45, v63
    s_lshr_b32 s45, s44, 1
    s_lshl_b32 s45, s45, 2
    v_add_u32 v65, s45, v63
    v_bfe_u32 v66, v1, 1, 3
    v_xor_b32 v66, v66, v65
    v_lshlrev_b32 v66, 5, v66
    v_and_b32 v67, 1, v1
    v_lshlrev_b32 v67, 4, v67
    v_add_u32 v66, v66, v67
    v_lshlrev_b32 v64, 13, v64
    v_add_u32 v82, v64, v66
    s_lshl_b32 s47, s43, 8
    s_lshl_b32 s48, s44, 10
    v_bfe_u32 v64, v1, 2, 2
    v_bfe_u32 v65, v1, 4, 1
    v_lshlrev_b32 v65, 2, v65
    v_add_u32 v65, v65, v64
    v_lshlrev_b32 v66, 3, v63
    v_add_u32 v66, v66, v64
    v_lshlrev_b32 v66, 8, v66
    v_and_b32 v67, 3, v1
    v_lshlrev_b32 v67, 3, v67
    v_add_u32 v66, v66, v67
    s_lshl_b32 s45, s44, 1
    v_xor_b32 v65, s45, v65
    v_lshlrev_b32 v65, 5, v65
    v_add_u32 v80, v66, v65
    v_xor_b32 v81, 32, v80
    v_lshrrev_b32 v64, 5, v1
    v_mul_u32_u24 v64, 20480, v64
    v_add_u32 v64, 65536, v64
    v_add_u32 v84, v64, v80
    v_add_u32 v85, v64, v81
    v_add_u32 v86, 49152, v84
    v_add_u32 v87, 49152, v85
    v_mov_b32 v40, -1
    v_mov_b32 v41, -1
    v_mov_b32 v42, -1
    v_mov_b32 v43, -1
    v_mov_b32 v44, 0
    s_mov_b32 s68, 0
    s_cmp_ge_u32 s41, 16
    s_cbranch_scc1 L_c_vo_2
    s_lshl_b32 s45, s42, 11
    s_lshr_b32 s46, s44, 1
    s_lshl_b32 s46, s46, 10
    s_add_u32 s45, s45, s46
    s_and_b32 s46, s44, 1
    s_lshl_b32 s46, s46, 7
    s_add_u32 s45, s45, s46
    v_add_u32 v17, s45, v68
    s_lshl_b32 s62, s40, 17
    s_add_u32 s62, s62, 0x7040000
    s_mov_b64 exec, s[56:57]
    s_add_u32 s63, s62, 0
    buffer_store_dwordx4 v[40:43], v17, s[12:15], s63 offen sc1
    s_add_u32 s63, s62, 32768
    buffer_store_dwordx4 v[40:43], v17, s[12:15], s63 offen sc1
    s_add_u32 s63, s62, 65536
    buffer_store_dwordx4 v[40:43], v17, s[12:15], s63 offen sc1
    s_add_u32 s63, s62, 98304
    buffer_store_dwordx4 v[40:43], v17, s[12:15], s63 offen sc1
    s_mov_b64 exec, -1
    s_lshl_b32 s45, s40, 11
    s_lshl_b32 s46, s42, 2
    s_add_u32 s45, s45, s46
    s_add_u32 s45, s45, 0x7080000
    s_lshl_b32 s46, s44, 9
    s_add_u32 s45, s45, s46
    v_and_b32 v20, 3, v1
    v_lshlrev_b32 v20, 7, v20
    v_add_u32 v20, s45, v20
    buffer_store_dword v44, v20, s[12:15], 0 offen sc1
    s_add_u32 s46, s47, 0x0
    s_add_u32 m0, s48, 73728
    s_nop 0
    buffer_load_dwordx4 v82, s[24:27], s46 offen nt lds
    s_add_u32 s46, s47, 0x20000
    s_add_u32 m0, s48, 98304
    s_nop 0
    buffer_load_dwordx4 v82, s[24:27], s46 offen nt lds
    s_add_u32 s46, s47, 0x40000
    s_add_u32 m0, s48, 122880
    s_nop 0
    buffer_load_dwordx4 v82, s[24:27], s46 offen nt lds
    s_add_u32 s46, s47, 0x60000
    s_add_u32 m0, s48, 147456
    s_nop 0
    buffer_load_dwordx4 v82, s[24:27], s46 offen nt lds
    s_add_u32 s46, s47, 0x80000
    s_add_u32 m0, s48, 77824
    s_nop 0
    buffer_load_dwordx4 v82, s[24:27], s46 offen nt lds
    s_add_u32 s46, s47, 0xa0000
    s_add_u32 m0, s48, 102400
    s_nop 0
    buffer_load_dwordx4 v82, s[24:27], s46 offen nt lds
    s_add_u32 s46, s47, 0xc0000
    s_add_u32 m0, s48, 126976
    s_nop 0
    buffer_load_dwordx4 v82, s[24:27], s46 offen nt lds
    s_add_u32 s46, s47, 0xe0000
    s_add_u32 m0, s48, 151552
    s_nop 0
    buffer_load_dwordx4 v82, s[24:27], s46 offen nt lds
    s_add_u32 s46, s47, 0x100000
    s_add_u32 m0, s48, 81920
    s_nop 0
    buffer_load_dwordx4 v82, s[24:27], s46 offen nt lds
    s_add_u32 s46, s47, 0x120000
    s_add_u32 m0, s48, 106496
    s_nop 0
    buffer_load_dwordx4 v82, s[24:27], s46 offen nt lds
    s_add_u32 s46, s47, 0x140000
    s_add_u32 m0, s48, 131072
    s_nop 0
    buffer_load_dwordx4 v82, s[24:27], s46 offen nt lds
    s_add_u32 s46, s47, 0x160000
    s_add_u32 m0, s48, 155648
    s_nop 0
    buffer_load_dwordx4 v82, s[24:27], s46 offen nt lds
    s_add_u32 s46, s47, 0x180000
    s_add_u32 m0, s48, 86016
    s_nop 0
    buffer_load_dwordx4 v82, s[24:27], s46 offen nt lds
    s_add_u32 s46, s47, 0x1a0000
    s_add_u32 m0, s48, 110592
    s_nop 0
    buffer_load_dwordx4 v82, s[24:27], s46 offen nt lds
    s_add_u32 s46, s47, 0x1c0000
    s_add_u32 m0, s48, 135168
    s_nop 0
    buffer_load_dwordx4 v82, s[24:27], s46 offen nt lds
    s_add_u32 s46, s47, 0x1e0000
    s_add_u32 m0, s48, 159744
    s_nop 0
    buffer_load_dwordx4 v82, s[24:27], s46 offen nt lds
    s_add_u32 s46, s47, 0x200000
    s_add_u32 m0, s48, 0
    s_nop 0
    buffer_load_dwordx4 v82, s[24:27], s46 offen nt lds
    s_add_u32 s46, s47, 0x220000
    s_add_u32 m0, s48, 4096
    s_nop 0
    buffer_load_dwordx4 v82, s[24:27], s46 offen nt lds
    s_add_u32 s46, s47, 0x240000
    s_add_u32 m0, s48, 8192
    s_nop 0
    buffer_load_dwordx4 v82, s[24:27], s46 offen nt lds
    s_add_u32 s46, s47, 0x260000
    s_add_u32 m0, s48, 12288
    s_nop 0
    buffer_load_dwordx4 v82, s[24:27], s46 offen nt lds
    s_add_u32 s46, s47, 0x280000
    s_add_u32 m0, s48, 16384
    s_nop 0
    buffer_load_dwordx4 v82, s[24:27], s46 offen nt lds
    s_add_u32 s46, s47, 0x2a0000
    s_add_u32 m0, s48, 20480
    s_nop 0
    buffer_load_dwordx4 v82, s[24:27], s46 offen nt lds
    s_add_u32 s46, s47, 0x2c0000
    s_add_u32 m0, s48, 24576
    s_nop 0
    buffer_load_dwordx4 v82, s[24:27], s46 offen nt lds
    s_add_u32 s46, s47, 0x2e0000
    s_add_u32 m0, s48, 28672
    s_nop 0
    buffer_load_dwordx4 v82, s[24:27], s46 offen nt lds
    s_add_u32 s46, s47, 0x300000
    s_add_u32 m0, s48, 32768
    s_nop 0
    buffer_load_dwordx4 v82, s[24:27], s46 offen nt lds
    s_add_u32 s46, s47, 0x320000
    s_add_u32 m0, s48, 36864
    s_nop 0
    buffer_load_dwordx4 v82, s[24:27], s46 offen nt lds
    s_add_u32 s46, s47, 0x340000
    s_add_u32 m0, s48, 40960
    s_nop 0
    buffer_load_dwordx4 v82, s[24:27], s46 offen nt lds
    s_add_u32 s46, s47, 0x360000
    s_add_u32 m0, s48, 45056
    s_nop 0
    buffer_load_dwordx4 v82, s[24:27], s46 offen nt lds
    s_add_u32 s46, s47, 0x380000
    s_add_u32 m0, s48, 49152
    s_nop 0
    buffer_load_dwordx4 v82, s[24:27], s46 offen nt lds
    s_add_u32 s46, s47, 0x3a0000
    s_add_u32 m0, s48, 53248
    s_nop 0
    buffer_load_dwordx4 v82, s[24:27], s46 offen nt lds
    s_add_u32 s46, s47, 0x3c0000
    s_add_u32 m0, s48, 57344
    s_nop 0
    buffer_load_dwordx4 v82, s[24:27], s46 offen nt lds
    s_add_u32 s46, s47, 0x3e0000
    s_add_u32 m0, s48, 61440
    s_nop 0
    buffer_load_dwordx4 v82, s[24:27], s46 offen nt lds
    s_waitcnt vmcnt(28)
    s_barrier
    s_cmp_lg_u32 s44, 0
    s_cbranch_scc1 L_lw_4_0
    ds_read_b64_tr_b16 a[0:1], v84 offset:8192
    ds_read_b64_tr_b16 a[2:3], v84 offset:9216
    ds_read_b64_tr_b16 a[4:5], v86 offset:8192
    ds_read_b64_tr_b16 a[6:7], v86 offset:9216
    ds_read_b64_tr_b16 a[8:9], v85 offset:8192
    ds_read_b64_tr_b16 a[10:11], v85 offset:9216
    ds_read_b64_tr_b16 a[12:13], v87 offset:8192
    ds_read_b64_tr_b16 a[14:15], v87 offset:9216
    s_branch L_lw_4
L_lw_4_0:
    s_cmp_lg_u32 s44, 1
    s_cbranch_scc1 L_lw_4_1
    ds_read_b64_tr_b16 v[160:161], v84 offset:8192
    ds_read_b64_tr_b16 v[162:163], v84 offset:9216
    ds_read_b64_tr_b16 v[164:165], v86 offset:8192
    ds_read_b64_tr_b16 v[166:167], v86 offset:9216
    ds_read_b64_tr_b16 v[56:57], v85 offset:8192
    ds_read_b64_tr_b16 v[58:59], v85 offset:9216
    ds_read_b64_tr_b16 v[60:61], v87 offset:8192
    ds_read_b64_tr_b16 v[62:63], v87 offset:9216
    s_waitcnt lgkmcnt(0)
    ds_write_b128 v5, v[56:59] offset:0
    ds_write_b128 v5, v[60:63] offset:1024
    s_branch L_lw_4
L_lw_4_1:
    s_cmp_lg_u32 s44, 2
    s_cbranch_scc1 L_lw_4_2
    ds_read_b64_tr_b16 a[208:209], v84 offset:8192
    ds_read_b64_tr_b16 a[210:211], v84 offset:9216
    ds_read_b64_tr_b16 a[212:213], v86 offset:8192
    ds_read_b64_tr_b16 a[214:215], v86 offset:9216
    ds_read_b64_tr_b16 v[56:57], v85 offset:8192
    ds_read_b64_tr_b16 v[58:59], v85 offset:9216
    ds_read_b64_tr_b16 v[60:61], v87 offset:8192
    ds_read_b64_tr_b16 v[62:63], v87 offset:9216
    s_waitcnt lgkmcnt(0)
    ds_write_b128 v5, v[56:59] offset:2048
    ds_write_b128 v5, v[60:63] offset:3072
    s_branch L_lw_4
L_lw_4_2:
    ds_read_b64_tr_b16 a[104:105], v84 offset:8192
    ds_read_b64_tr_b16 a[106:107], v84 offset:9216
    ds_read_b64_tr_b16 a[108:109], v86 offset:8192
    ds_read_b64_tr_b16 a[110:111], v86 offset:9216
    ds_read_b64_tr_b16 v[56:57], v85 offset:8192
    ds_read_b64_tr_b16 v[58:59], v85 offset:9216
    ds_read_b64_tr_b16 v[60:61], v87 offset:8192
    ds_read_b64_tr_b16 v[62:63], v87 offset:9216
    s_waitcnt lgkmcnt(0)
    ds_write_b128 v5, v[56:59] offset:4096
    ds_write_b128 v5, v[60:63] offset:5120
L_lw_4:
    s_waitcnt lgkmcnt(0)
    s_waitcnt vmcnt(24)
    s_barrier
    s_cmp_lg_u32 s44, 0
    s_cbranch_scc1 L_lw_5_0
    ds_read_b64_tr_b16 a[32:33], v84 offset:12288
    ds_read_b64_tr_b16 a[34:35], v84 offset:13312
    ds_read_b64_tr_b16 a[36:37], v86 offset:12288
    ds_read_b64_tr_b16 a[38:39], v86 offset:13312
    ds_read_b64_tr_b16 a[40:41], v85 offset:12288
    ds_read_b64_tr_b16 a[42:43], v85 offset:13312
    ds_read_b64_tr_b16 a[44:45], v87 offset:12288
    ds_read_b64_tr_b16 a[46:47], v87 offset:13312
    s_branch L_lw_5
L_lw_5_0:
    s_cmp_lg_u32 s44, 1
    s_cbranch_scc1 L_lw_5_1
    ds_read_b64_tr_b16 v[184:185], v84 offset:12288
    ds_read_b64_tr_b16 v[186:187], v84 offset:13312
    ds_read_b64_tr_b16 v[188:189], v86 offset:12288
    ds_read_b64_tr_b16 v[190:191], v86 offset:13312
    ds_read_b64_tr_b16 v[192:193], v85 offset:12288
    ds_read_b64_tr_b16 v[194:195], v85 offset:13312
    ds_read_b64_tr_b16 v[196:197], v87 offset:12288
    ds_read_b64_tr_b16 v[198:199], v87 offset:13312
    s_branch L_lw_5
L_lw_5_1:
    s_cmp_lg_u32 s44, 2
    s_cbranch_scc1 L_lw_5_2
    ds_read_b64_tr_b16 a[232:233], v84 offset:12288
    ds_read_b64_tr_b16 a[234:235], v84 offset:13312
    ds_read_b64_tr_b16 a[236:237], v86 offset:12288
    ds_read_b64_tr_b16 a[238:239], v86 offset:13312
    ds_read_b64_tr_b16 a[240:241], v85 offset:12288
    ds_read_b64_tr_b16 a[242:243], v85 offset:13312
    ds_read_b64_tr_b16 a[244:245], v87 offset:12288
    ds_read_b64_tr_b16 a[246:247], v87 offset:13312
    s_branch L_lw_5
L_lw_5_2:
    ds_read_b64_tr_b16 a[128:129], v84 offset:12288
    ds_read_b64_tr_b16 a[130:131], v84 offset:13312
    ds_read_b64_tr_b16 a[132:133], v86 offset:12288
    ds_read_b64_tr_b16 a[134:135], v86 offset:13312
    ds_read_b64_tr_b16 v[56:57], v85 offset:12288
    ds_read_b64_tr_b16 v[58:59], v85 offset:13312
    ds_read_b64_tr_b16 v[60:61], v87 offset:12288
    ds_read_b64_tr_b16 v[62:63], v87 offset:13312
    s_waitcnt lgkmcnt(0)
    ds_write_b128 v5, v[56:59] offset:6144
    ds_write_b128 v5, v[60:63] offset:7168
L_lw_5:
    s_waitcnt lgkmcnt(0)
    s_waitcnt vmcnt(20)
    s_barrier
    s_cmp_lg_u32 s44, 0
    s_cbranch_scc1 L_lw_6_0
    ds_read_b64_tr_b16 a[64:65], v84 offset:16384
    ds_read_b64_tr_b16 a[66:67], v84 offset:17408
    ds_read_b64_tr_b16 a[68:69], v86 offset:16384
    ds_read_b64_tr_b16 a[70:71], v86 offset:17408
    ds_read_b64_tr_b16 v[56:57], v85 offset:16384
    ds_read_b64_tr_b16 v[58:59], v85 offset:17408
    ds_read_b64_tr_b16 v[60:61], v87 offset:16384
    ds_read_b64_tr_b16 v[62:63], v87 offset:17408
    s_waitcnt lgkmcnt(0)
    ds_write_b128 v5, v[56:59] offset:8192
    ds_write_b128 v5, v[60:63] offset:9216
    s_branch L_lw_6
L_lw_6_0:
    s_cmp_lg_u32 s44, 1
    s_cbranch_scc1 L_lw_6_1
    ds_read_b64_tr_b16 v[208:209], v84 offset:16384
    ds_read_b64_tr_b16 v[210:211], v84 offset:17408
    ds_read_b64_tr_b16 v[212:213], v86 offset:16384
    ds_read_b64_tr_b16 v[214:215], v86 offset:17408
    ds_read_b64_tr_b16 v[56:57], v85 offset:16384
    ds_read_b64_tr_b16 v[58:59], v85 offset:17408
    ds_read_b64_tr_b16 v[60:61], v87 offset:16384
    ds_read_b64_tr_b16 v[62:63], v87 offset:17408
    s_waitcnt lgkmcnt(0)
    ds_write_b128 v5, v[56:59] offset:10240
    ds_write_b128 v5, v[60:63] offset:11264
    s_branch L_lw_6
L_lw_6_1:
    s_cmp_lg_u32 s44, 2
    s_cbranch_scc1 L_lw_6_2
    ds_read_b64_tr_b16 v[104:105], v84 offset:16384
    ds_read_b64_tr_b16 v[106:107], v84 offset:17408
    ds_read_b64_tr_b16 v[108:109], v86 offset:16384
    ds_read_b64_tr_b16 v[110:111], v86 offset:17408
    ds_read_b64_tr_b16 v[56:57], v85 offset:16384
    ds_read_b64_tr_b16 v[58:59], v85 offset:17408
    ds_read_b64_tr_b16 v[60:61], v87 offset:16384
    ds_read_b64_tr_b16 v[62:63], v87 offset:17408
    s_waitcnt lgkmcnt(0)
    ds_write_b128 v5, v[56:59] offset:12288
    ds_write_b128 v5, v[60:63] offset:13312
    s_branch L_lw_6
L_lw_6_2:
    ds_read_b64_tr_b16 a[152:153], v84 offset:16384
    ds_read_b64_tr_b16 a[154:155], v84 offset:17408
    ds_read_b64_tr_b16 a[156:157], v86 offset:16384
    ds_read_b64_tr_b16 a[158:159], v86 offset:17408
    ds_read_b64_tr_b16 v[56:57], v85 offset:16384
    ds_read_b64_tr_b16 v[58:59], v85 offset:17408
    ds_read_b64_tr_b16 v[60:61], v87 offset:16384
    ds_read_b64_tr_b16 v[62:63], v87 offset:17408
    s_waitcnt lgkmcnt(0)
    ds_write_b128 v5, v[56:59] offset:14336
    ds_write_b128 v5, v[60:63] offset:15360
L_lw_6:
    s_waitcnt lgkmcnt(0)
    s_waitcnt vmcnt(16)
    s_barrier
    s_cmp_lg_u32 s44, 0
    s_cbranch_scc1 L_lw_7_0
    ds_read_b64_tr_b16 a[80:81], v84 offset:20480
    ds_read_b64_tr_b16 a[82:83], v84 offset:21504
    ds_read_b64_tr_b16 a[84:85], v86 offset:20480
    ds_read_b64_tr_b16 a[86:87], v86 offset:21504
    ds_read_b64_tr_b16 v[56:57], v85 offset:20480
    ds_read_b64_tr_b16 v[58:59], v85 offset:21504
    ds_read_b64_tr_b16 v[60:61], v87 offset:20480
    ds_read_b64_tr_b16 v[62:63], v87 offset:21504
    s_waitcnt lgkmcnt(0)
    ds_write_b128 v5, v[56:59] offset:16384
    ds_write_b128 v5, v[60:63] offset:17408
    s_branch L_lw_7
L_lw_7_0:
    s_cmp_lg_u32 s44, 1
    s_cbranch_scc1 L_lw_7_1
    ds_read_b64_tr_b16 v[232:233], v84 offset:20480
    ds_read_b64_tr_b16 v[234:235], v84 offset:21504
    ds_read_b64_tr_b16 v[236:237], v86 offset:20480
    ds_read_b64_tr_b16 v[238:239], v86 offset:21504
    ds_read_b64_tr_b16 v[240:241], v85 offset:20480
    ds_read_b64_tr_b16 v[242:243], v85 offset:21504
    ds_read_b64_tr_b16 v[244:245], v87 offset:20480
    ds_read_b64_tr_b16 v[246:247], v87 offset:21504
    s_branch L_lw_7
L_lw_7_1:
    s_cmp_lg_u32 s44, 2
    s_cbranch_scc1 L_lw_7_2
    ds_read_b64_tr_b16 v[128:129], v84 offset:20480
    ds_read_b64_tr_b16 v[130:131], v84 offset:21504
    ds_read_b64_tr_b16 v[132:133], v86 offset:20480
    ds_read_b64_tr_b16 v[134:135], v86 offset:21504
    ds_read_b64_tr_b16 v[136:137], v85 offset:20480
    ds_read_b64_tr_b16 v[138:139], v85 offset:21504
    ds_read_b64_tr_b16 v[140:141], v87 offset:20480
    ds_read_b64_tr_b16 v[142:143], v87 offset:21504
    s_branch L_lw_7
L_lw_7_2:
    ds_read_b64_tr_b16 a[176:177], v84 offset:20480
    ds_read_b64_tr_b16 a[178:179], v84 offset:21504
    ds_read_b64_tr_b16 a[180:181], v86 offset:20480
    ds_read_b64_tr_b16 a[182:183], v86 offset:21504
    ds_read_b64_tr_b16 a[184:185], v85 offset:20480
    ds_read_b64_tr_b16 a[186:187], v85 offset:21504
    ds_read_b64_tr_b16 a[188:189], v87 offset:20480
    ds_read_b64_tr_b16 a[190:191], v87 offset:21504
L_lw_7:
    s_waitcnt lgkmcnt(0)
    s_waitcnt vmcnt(12)
    s_barrier
    s_add_u32 s46, s47, 0x400000
    s_add_u32 m0, s48, 86016
    s_nop 0
    buffer_load_dwordx4 v82, s[24:27], s46 offen nt lds
    s_add_u32 s46, s47, 0x420000
    s_add_u32 m0, s48, 110592
    s_nop 0
    buffer_load_dwordx4 v82, s[24:27], s46 offen nt lds
    s_add_u32 s46, s47, 0x440000
    s_add_u32 m0, s48, 135168
    s_nop 0
    buffer_load_dwordx4 v82, s[24:27], s46 offen nt lds
    s_add_u32 s46, s47, 0x460000
    s_add_u32 m0, s48, 159744
    s_nop 0
    buffer_load_dwordx4 v82, s[24:27], s46 offen nt lds
    s_cmp_lg_u32 s44, 0
    s_cbranch_scc1 L_lw_8_0
    ds_read_b64_tr_b16 a[104:105], v80 offset:0
    ds_read_b64_tr_b16 a[106:107], v80 offset:1024
    ds_read_b64_tr_b16 a[108:109], v80 offset:8192
    ds_read_b64_tr_b16 a[110:111], v80 offset:9216
    ds_read_b64_tr_b16 v[56:57], v81 offset:0
    ds_read_b64_tr_b16 v[58:59], v81 offset:1024
    ds_read_b64_tr_b16 v[60:61], v81 offset:8192
    ds_read_b64_tr_b16 v[62:63], v81 offset:9216
    s_waitcnt lgkmcnt(0)
    ds_write_b128 v5, v[56:59] offset:4096
    ds_write_b128 v5, v[60:63] offset:5120
    s_branch L_lw_8
L_lw_8_0:
    s_cmp_lg_u32 s44, 1
    s_cbranch_scc1 L_lw_8_1
    ds_read_b64_tr_b16 a[0:1], v80 offset:0
    ds_read_b64_tr_b16 a[2:3], v80 offset:1024
    ds_read_b64_tr_b16 a[4:5], v80 offset:8192
    ds_read_b64_tr_b16 a[6:7], v80 offset:9216
    ds_read_b64_tr_b16 a[8:9], v81 offset:0
    ds_read_b64_tr_b16 a[10:11], v81 offset:1024
    ds_read_b64_tr_b16 a[12:13], v81 offset:8192
    ds_read_b64_tr_b16 a[14:15], v81 offset:9216
    s_branch L_lw_8
L_lw_8_1:
    s_cmp_lg_u32 s44, 2
    s_cbranch_scc1 L_lw_8_2
    ds_read_b64_tr_b16 v[160:161], v80 offset:0
    ds_read_b64_tr_b16 v[162:163], v80 offset:1024
    ds_read_b64_tr_b16 v[164:165], v80 offset:8192
    ds_read_b64_tr_b16 v[166:167], v80 offset:9216
    ds_read_b64_tr_b16 v[56:57], v81 offset:0
    ds_read_b64_tr_b16 v[58:59], v81 offset:1024
    ds_read_b64_tr_b16 v[60:61], v81 offset:8192
    ds_read_b64_tr_b16 v[62:63], v81 offset:9216
    s_waitcnt lgkmcnt(0)
    ds_write_b128 v5, v[56:59] offset:0
    ds_write_b128 v5, v[60:63] offset:1024
    s_branch L_lw_8
L_lw_8_2:
    ds_read_b64_tr_b16 a[208:209], v80 offset:0
    ds_read_b64_tr_b16 a[210:211], v80 offset:1024
    ds_read_b64_tr_b16 a[212:213], v80 offset:8192
    ds_read_b64_tr_b16 a[214:215], v80 offset:9216
    ds_read_b64_tr_b16 v[56:57], v81 offset:0
    ds_read_b64_tr_b16 v[58:59], v81 offset:1024
    ds_read_b64_tr_b16 v[60:61], v81 offset:8192
    ds_read_b64_tr_b16 v[62:63], v81 offset:9216
    s_waitcnt lgkmcnt(0)
    ds_write_b128 v5, v[56:59] offset:2048
    ds_write_b128 v5, v[60:63] offset:3072
L_lw_8:
    s_waitcnt lgkmcnt(0)
    s_waitcnt vmcnt(12)
    s_barrier
    s_add_u32 s46, s47, 0x480000
    s_add_u32 m0, s48, 0
    s_nop 0
    buffer_load_dwordx4 v82, s[24:27], s46 offen nt lds
    s_add_u32 s46, s47, 0x4a0000
    s_add_u32 m0, s48, 4096
    s_nop 0
    buffer_load_dwordx4 v82, s[24:27], s46 offen nt lds
    s_add_u32 s46, s47, 0x4c0000
    s_add_u32 m0, s48, 8192
    s_nop 0
    buffer_load_dwordx4 v82, s[24:27], s46 offen nt lds
    s_add_u32 s46, s47, 0x4e0000
    s_add_u32 m0, s48, 12288
    s_nop 0
    buffer_load_dwordx4 v82, s[24:27], s46 offen nt lds
    s_cmp_lg_u32 s44, 0
    s_cbranch_scc1 L_lw_9_0
    ds_read_b64_tr_b16 a[128:129], v80 offset:16384
    ds_read_b64_tr_b16 a[130:131], v80 offset:17408
    ds_read_b64_tr_b16 a[132:133], v80 offset:24576
    ds_read_b64_tr_b16 a[134:135], v80 offset:25600
    ds_read_b64_tr_b16 v[56:57], v81 offset:16384
    ds_read_b64_tr_b16 v[58:59], v81 offset:17408
    ds_read_b64_tr_b16 v[60:61], v81 offset:24576
    ds_read_b64_tr_b16 v[62:63], v81 offset:25600
    s_waitcnt lgkmcnt(0)
    ds_write_b128 v5, v[56:59] offset:6144
    ds_write_b128 v5, v[60:63] offset:7168
    s_branch L_lw_9
L_lw_9_0:
    s_cmp_lg_u32 s44, 1
    s_cbranch_scc1 L_lw_9_1
    ds_read_b64_tr_b16 a[32:33], v80 offset:16384
    ds_read_b64_tr_b16 a[34:35], v80 offset:17408
    ds_read_b64_tr_b16 a[36:37], v80 offset:24576
    ds_read_b64_tr_b16 a[38:39], v80 offset:25600
    ds_read_b64_tr_b16 a[40:41], v81 offset:16384
    ds_read_b64_tr_b16 a[42:43], v81 offset:17408
    ds_read_b64_tr_b16 a[44:45], v81 offset:24576
    ds_read_b64_tr_b16 a[46:47], v81 offset:25600
    s_branch L_lw_9
L_lw_9_1:
    s_cmp_lg_u32 s44, 2
    s_cbranch_scc1 L_lw_9_2
    ds_read_b64_tr_b16 v[184:185], v80 offset:16384
    ds_read_b64_tr_b16 v[186:187], v80 offset:17408
    ds_read_b64_tr_b16 v[188:189], v80 offset:24576
    ds_read_b64_tr_b16 v[190:191], v80 offset:25600
    ds_read_b64_tr_b16 v[192:193], v81 offset:16384
    ds_read_b64_tr_b16 v[194:195], v81 offset:17408
    ds_read_b64_tr_b16 v[196:197], v81 offset:24576
    ds_read_b64_tr_b16 v[198:199], v81 offset:25600
    s_branch L_lw_9
L_lw_9_2:
    ds_read_b64_tr_b16 a[232:233], v80 offset:16384
    ds_read_b64_tr_b16 a[234:235], v80 offset:17408
    ds_read_b64_tr_b16 a[236:237], v80 offset:24576
    ds_read_b64_tr_b16 a[238:239], v80 offset:25600
    ds_read_b64_tr_b16 a[240:241], v81 offset:16384
    ds_read_b64_tr_b16 a[242:243], v81 offset:17408
    ds_read_b64_tr_b16 a[244:245], v81 offset:24576
    ds_read_b64_tr_b16 a[246:247], v81 offset:25600
L_lw_9:
    s_waitcnt lgkmcnt(0)
    s_waitcnt vmcnt(12)
    s_barrier
    s_add_u32 s46, s47, 0x500000
    s_add_u32 m0, s48, 16384
    s_nop 0
    buffer_load_dwordx4 v82, s[24:27], s46 offen nt lds
    s_add_u32 s46, s47, 0x520000
    s_add_u32 m0, s48, 20480
    s_nop 0
    buffer_load_dwordx4 v82, s[24:27], s46 offen nt lds
    s_add_u32 s46, s47, 0x540000
    s_add_u32 m0, s48, 24576
    s_nop 0
    buffer_load_dwordx4 v82, s[24:27], s46 offen nt lds
    s_add_u32 s46, s47, 0x560000
    s_add_u32 m0, s48, 28672
    s_nop 0
    buffer_load_dwordx4 v82, s[24:27], s46 offen nt lds
    s_cmp_lg_u32 s44, 0
    s_cbranch_scc1 L_lw_10_0
    ds_read_b64_tr_b16 a[152:153], v80 offset:32768
    ds_read_b64_tr_b16 a[154:155], v80 offset:33792
    ds_read_b64_tr_b16 a[156:157], v80 offset:40960
    ds_read_b64_tr_b16 a[158:159], v80 offset:41984
    ds_read_b64_tr_b16 v[56:57], v81 offset:32768
    ds_read_b64_tr_b16 v[58:59], v81 offset:33792
    ds_read_b64_tr_b16 v[60:61], v81 offset:40960
    ds_read_b64_tr_b16 v[62:63], v81 offset:41984
    s_waitcnt lgkmcnt(0)
    ds_write_b128 v5, v[56:59] offset:14336
    ds_write_b128 v5, v[60:63] offset:15360
    s_branch L_lw_10
L_lw_10_0:
    s_cmp_lg_u32 s44, 1
    s_cbranch_scc1 L_lw_10_1
    ds_read_b64_tr_b16 a[64:65], v80 offset:32768
    ds_read_b64_tr_b16 a[66:67], v80 offset:33792
    ds_read_b64_tr_b16 a[68:69], v80 offset:40960
    ds_read_b64_tr_b16 a[70:71], v80 offset:41984
    ds_read_b64_tr_b16 v[56:57], v81 offset:32768
    ds_read_b64_tr_b16 v[58:59], v81 offset:33792
    ds_read_b64_tr_b16 v[60:61], v81 offset:40960
    ds_read_b64_tr_b16 v[62:63], v81 offset:41984
    s_waitcnt lgkmcnt(0)
    ds_write_b128 v5, v[56:59] offset:8192
    ds_write_b128 v5, v[60:63] offset:9216
    s_branch L_lw_10
L_lw_10_1:
    s_cmp_lg_u32 s44, 2
    s_cbranch_scc1 L_lw_10_2
    ds_read_b64_tr_b16 v[208:209], v80 offset:32768
    ds_read_b64_tr_b16 v[210:211], v80 offset:33792
    ds_read_b64_tr_b16 v[212:213], v80 offset:40960
    ds_read_b64_tr_b16 v[214:215], v80 offset:41984
    ds_read_b64_tr_b16 v[56:57], v81 offset:32768
    ds_read_b64_tr_b16 v[58:59], v81 offset:33792
    ds_read_b64_tr_b16 v[60:61], v81 offset:40960
    ds_read_b64_tr_b16 v[62:63], v81 offset:41984
    s_waitcnt lgkmcnt(0)
    ds_write_b128 v5, v[56:59] offset:10240
    ds_write_b128 v5, v[60:63] offset:11264
    s_branch L_lw_10
L_lw_10_2:
    ds_read_b64_tr_b16 v[104:105], v80 offset:32768
    ds_read_b64_tr_b16 v[106:107], v80 offset:33792
    ds_read_b64_tr_b16 v[108:109], v80 offset:40960
    ds_read_b64_tr_b16 v[110:111], v80 offset:41984
    ds_read_b64_tr_b16 v[56:57], v81 offset:32768
    ds_read_b64_tr_b16 v[58:59], v81 offset:33792
    ds_read_b64_tr_b16 v[60:61], v81 offset:40960
    ds_read_b64_tr_b16 v[62:63], v81 offset:41984
    s_waitcnt lgkmcnt(0)
    ds_write_b128 v5, v[56:59] offset:12288
    ds_write_b128 v5, v[60:63] offset:13312
L_lw_10:
    s_waitcnt lgkmcnt(0)
    s_waitcnt vmcnt(12)
    s_barrier
    s_add_u32 s46, s47, 0x580000
    s_add_u32 m0, s48, 32768
    s_nop 0
    buffer_load_dwordx4 v82, s[24:27], s46 offen nt lds
    s_add_u32 s46, s47, 0x5a0000
    s_add_u32 m0, s48, 36864
    s_nop 0
    buffer_load_dwordx4 v82, s[24:27], s46 offen nt lds
    s_add_u32 s46, s47, 0x5c0000
    s_add_u32 m0, s48, 40960
    s_nop 0
    buffer_load_dwordx4 v82, s[24:27], s46 offen nt lds
    s_add_u32 s46, s47, 0x5e0000
    s_add_u32 m0, s48, 45056
    s_nop 0
    buffer_load_dwordx4 v82, s[24:27], s46 offen nt lds
    s_cmp_lg_u32 s44, 0
    s_cbranch_scc1 L_lw_11_0
    ds_read_b64_tr_b16 a[176:177], v80 offset:49152
    ds_read_b64_tr_b16 a[178:179], v80 offset:50176
    ds_read_b64_tr_b16 a[180:181], v80 offset:57344
    ds_read_b64_tr_b16 a[182:183], v80 offset:58368
    ds_read_b64_tr_b16 a[184:185], v81 offset:49152
    ds_read_b64_tr_b16 a[186:187], v81 offset:50176
    ds_read_b64_tr_b16 a[188:189], v81 offset:57344
    ds_read_b64_tr_b16 a[190:191], v81 offset:58368
    s_branch L_lw_11
L_lw_11_0:
    s_cmp_lg_u32 s44, 1
    s_cbranch_scc1 L_lw_11_1
    ds_read_b64_tr_b16 a[80:81], v80 offset:49152
    ds_read_b64_tr_b16 a[82:83], v80 offset:50176
    ds_read_b64_tr_b16 a[84:85], v80 offset:57344
    ds_read_b64_tr_b16 a[86:87], v80 offset:58368
    ds_read_b64_tr_b16 v[56:57], v81 offset:49152
    ds_read_b64_tr_b16 v[58:59], v81 offset:50176
    ds_read_b64_tr_b16 v[60:61], v81 offset:57344
    ds_read_b64_tr_b16 v[62:63], v81 offset:58368
    s_waitcnt lgkmcnt(0)
    ds_write_b128 v5, v[56:59] offset:16384
    ds_write_b128 v5, v[60:63] offset:17408
    s_branch L_lw_11
L_lw_11_1:
    s_cmp_lg_u32 s44, 2
    s_cbranch_scc1 L_lw_11_2
    ds_read_b64_tr_b16 v[232:233], v80 offset:49152
    ds_read_b64_tr_b16 v[234:235], v80 offset:50176
    ds_read_b64_tr_b16 v[236:237], v80 offset:57344
    ds_read_b64_tr_b16 v[238:239], v80 offset:58368
    ds_read_b64_tr_b16 v[240:241], v81 offset:49152
    ds_read_b64_tr_b16 v[242:243], v81 offset:50176
    ds_read_b64_tr_b16 v[244:245], v81 offset:57344
    ds_read_b64_tr_b16 v[246:247], v81 offset:58368
    s_branch L_lw_11
L_lw_11_2:
    ds_read_b64_tr_b16 v[128:129], v80 offset:49152
    ds_read_b64_tr_b16 v[130:131], v80 offset:50176
    ds_read_b64_tr_b16 v[132:133], v80 offset:57344
    ds_read_b64_tr_b16 v[134:135], v80 offset:58368
    ds_read_b64_tr_b16 v[136:137], v81 offset:49152
    ds_read_b64_tr_b16 v[138:139], v81 offset:50176
    ds_read_b64_tr_b16 v[140:141], v81 offset:57344
    ds_read_b64_tr_b16 v[142:143], v81 offset:58368
L_lw_11:
    s_waitcnt lgkmcnt(0)
    s_waitcnt vmcnt(12)
    s_barrier
    s_add_u32 s46, s47, 0x600000
    s_add_u32 m0, s48, 49152
    s_nop 0
    buffer_load_dwordx4 v82, s[24:27], s46 offen nt lds
    s_add_u32 s46, s47, 0x620000
    s_add_u32 m0, s48, 53248
    s_nop 0
    buffer_load_dwordx4 v82, s[24:27], s46 offen nt lds
    s_add_u32 s46, s47, 0x640000
    s_add_u32 m0, s48, 57344
    s_nop 0
    buffer_load_dwordx4 v82, s[24:27], s46 offen nt lds
    s_add_u32 s46, s47, 0x660000
    s_add_u32 m0, s48, 61440
    s_nop 0
    buffer_load_dwordx4 v82, s[24:27], s46 offen nt lds
    s_cmp_lg_u32 s44, 0
    s_cbranch_scc1 L_lw_12_0
    ds_read_b64_tr_b16 a[208:209], v84 offset:20480
    ds_read_b64_tr_b16 a[210:211], v84 offset:21504
    ds_read_b64_tr_b16 a[212:213], v86 offset:20480
    ds_read_b64_tr_b16 a[214:215], v86 offset:21504
    ds_read_b64_tr_b16 v[56:57], v85 offset:20480
    ds_read_b64_tr_b16 v[58:59], v85 offset:21504
    ds_read_b64_tr_b16 v[60:61], v87 offset:20480
    ds_read_b64_tr_b16 v[62:63], v87 offset:21504
    s_waitcnt lgkmcnt(0)
    ds_write_b128 v5, v[56:59] offset:2048
    ds_write_b128 v5, v[60:63] offset:3072
    s_branch L_lw_12
L_lw_12_0:
    s_cmp_lg_u32 s44, 1
    s_cbranch_scc1 L_lw_12_1
    ds_read_b64_tr_b16 a[104:105], v84 offset:20480
    ds_read_b64_tr_b16 a[106:107], v84 offset:21504
    ds_read_b64_tr_b16 a[108:109], v86 offset:20480
    ds_read_b64_tr_b16 a[110:111], v86 offset:21504
    ds_read_b64_tr_b16 v[56:57], v85 offset:20480
    ds_read_b64_tr_b16 v[58:59], v85 offset:21504
    ds_read_b64_tr_b16 v[60:61], v87 offset:20480
    ds_read_b64_tr_b16 v[62:63], v87 offset:21504
    s_waitcnt lgkmcnt(0)
    ds_write_b128 v5, v[56:59] offset:4096
    ds_write_b128 v5, v[60:63] offset:5120
    s_branch L_lw_12
L_lw_12_1:
    s_cmp_lg_u32 s44, 2
    s_cbranch_scc1 L_lw_12_2
    ds_read_b64_tr_b16 a[0:1], v84 offset:20480
    ds_read_b64_tr_b16 a[2:3], v84 offset:21504
    ds_read_b64_tr_b16 a[4:5], v86 offset:20480
    ds_read_b64_tr_b16 a[6:7], v86 offset:21504
    ds_read_b64_tr_b16 a[8:9], v85 offset:20480
    ds_read_b64_tr_b16 a[10:11], v85 offset:21504
    ds_read_b64_tr_b16 a[12:13], v87 offset:20480
    ds_read_b64_tr_b16 a[14:15], v87 offset:21504
    s_branch L_lw_12
L_lw_12_2:
    ds_read_b64_tr_b16 v[160:161], v84 offset:20480
    ds_read_b64_tr_b16 v[162:163], v84 offset:21504
    ds_read_b64_tr_b16 v[164:165], v86 offset:20480
    ds_read_b64_tr_b16 v[166:167], v86 offset:21504
    ds_read_b64_tr_b16 v[56:57], v85 offset:20480
    ds_read_b64_tr_b16 v[58:59], v85 offset:21504
    ds_read_b64_tr_b16 v[60:61], v87 offset:20480
    ds_read_b64_tr_b16 v[62:63], v87 offset:21504
    s_waitcnt lgkmcnt(0)
    ds_write_b128 v5, v[56:59] offset:0
    ds_write_b128 v5, v[60:63] offset:1024
L_lw_12:
    s_waitcnt lgkmcnt(0)
    s_waitcnt vmcnt(12)
    s_barrier
    s_add_u32 s46, s47, 0x680000
    s_add_u32 m0, s48, 86016
    s_nop 0
    buffer_load_dwordx4 v82, s[24:27], s46 offen nt lds
    s_add_u32 s46, s47, 0x6a0000
    s_add_u32 m0, s48, 110592
    s_nop 0
    buffer_load_dwordx4 v82, s[24:27], s46 offen nt lds
    s_add_u32 s46, s47, 0x6c0000
    s_add_u32 m0, s48, 135168
    s_nop 0
    buffer_load_dwordx4 v82, s[24:27], s46 offen nt lds
    s_add_u32 s46, s47, 0x6e0000
    s_add_u32 m0, s48, 159744
    s_nop 0
    buffer_load_dwordx4 v82, s[24:27], s46 offen nt lds
    s_cmp_lg_u32 s44, 0
    s_cbranch_scc1 L_lw_13_0
    ds_read_b64_tr_b16 a[232:233], v80 offset:0
    ds_read_b64_tr_b16 a[234:235], v80 offset:1024
    ds_read_b64_tr_b16 a[236:237], v80 offset:8192
    ds_read_b64_tr_b16 a[238:239], v80 offset:9216
    ds_read_b64_tr_b16 a[240:241], v81 offset:0
    ds_read_b64_tr_b16 a[242:243], v81 offset:1024
    ds_read_b64_tr_b16 a[244:245], v81 offset:8192
    ds_read_b64_tr_b16 a[246:247], v81 offset:9216
    s_branch L_lw_13
L_lw_13_0:
    s_cmp_lg_u32 s44, 1
    s_cbranch_scc1 L_lw_13_1
    ds_read_b64_tr_b16 a[128:129], v80 offset:0
    ds_read_b64_tr_b16 a[130:131], v80 offset:1024
    ds_read_b64_tr_b16 a[132:133], v80 offset:8192
    ds_read_b64_tr_b16 a[134:135], v80 offset:9216
    ds_read_b64_tr_b16 v[56:57], v81 offset:0
    ds_read_b64_tr_b16 v[58:59], v81 offset:1024
    ds_read_b64_tr_b16 v[60:61], v81 offset:8192
    ds_read_b64_tr_b16 v[62:63], v81 offset:9216
    s_waitcnt lgkmcnt(0)
    ds_write_b128 v5, v[56:59] offset:6144
    ds_write_b128 v5, v[60:63] offset:7168
    s_branch L_lw_13
L_lw_13_1:
    s_cmp_lg_u32 s44, 2
    s_cbranch_scc1 L_lw_13_2
    ds_read_b64_tr_b16 a[32:33], v80 offset:0
    ds_read_b64_tr_b16 a[34:35], v80 offset:1024
    ds_read_b64_tr_b16 a[36:37], v80 offset:8192
    ds_read_b64_tr_b16 a[38:39], v80 offset:9216
    ds_read_b64_tr_b16 a[40:41], v81 offset:0
    ds_read_b64_tr_b16 a[42:43], v81 offset:1024
    ds_read_b64_tr_b16 a[44:45], v81 offset:8192
    ds_read_b64_tr_b16 a[46:47], v81 offset:9216
    s_branch L_lw_13
L_lw_13_2:
    ds_read_b64_tr_b16 v[184:185], v80 offset:0
    ds_read_b64_tr_b16 v[186:187], v80 offset:1024
    ds_read_b64_tr_b16 v[188:189], v80 offset:8192
    ds_read_b64_tr_b16 v[190:191], v80 offset:9216
    ds_read_b64_tr_b16 v[192:193], v81 offset:0
    ds_read_b64_tr_b16 v[194:195], v81 offset:1024
    ds_read_b64_tr_b16 v[196:197], v81 offset:8192
    ds_read_b64_tr_b16 v[198:199], v81 offset:9216
L_lw_13:
    s_waitcnt lgkmcnt(0)
    s_waitcnt vmcnt(12)
    s_barrier
    s_add_u32 s46, s47, 0x700000
    s_add_u32 m0, s48, 0
    s_nop 0
    buffer_load_dwordx4 v82, s[24:27], s46 offen nt lds
    s_add_u32 s46, s47, 0x720000
    s_add_u32 m0, s48, 4096
    s_nop 0
    buffer_load_dwordx4 v82, s[24:27], s46 offen nt lds
    s_add_u32 s46, s47, 0x740000
    s_add_u32 m0, s48, 8192
    s_nop 0
    buffer_load_dwordx4 v82, s[24:27], s46 offen nt lds
    s_add_u32 s46, s47, 0x760000
    s_add_u32 m0, s48, 12288
    s_nop 0
    buffer_load_dwordx4 v82, s[24:27], s46 offen nt lds
    s_cmp_lg_u32 s44, 0
    s_cbranch_scc1 L_lw_14_0
    ds_read_b64_tr_b16 v[104:105], v80 offset:16384
    ds_read_b64_tr_b16 v[106:107], v80 offset:17408
    ds_read_b64_tr_b16 v[108:109], v80 offset:24576
    ds_read_b64_tr_b16 v[110:111], v80 offset:25600
    ds_read_b64_tr_b16 v[56:57], v81 offset:16384
    ds_read_b64_tr_b16 v[58:59], v81 offset:17408
    ds_read_b64_tr_b16 v[60:61], v81 offset:24576
    ds_read_b64_tr_b16 v[62:63], v81 offset:25600
    s_waitcnt lgkmcnt(0)
    ds_write_b128 v5, v[56:59] offset:12288
    ds_write_b128 v5, v[60:63] offset:13312
    s_branch L_lw_14
L_lw_14_0:
    s_cmp_lg_u32 s44, 1
    s_cbranch_scc1 L_lw_14_1
    ds_read_b64_tr_b16 a[152:153], v80 offset:16384
    ds_read_b64_tr_b16 a[154:155], v80 offset:17408
    ds_read_b64_tr_b16 a[156:157], v80 offset:24576
    ds_read_b64_tr_b16 a[158:159], v80 offset:25600
    ds_read_b64_tr_b16 v[56:57], v81 offset:16384
    ds_read_b64_tr_b16 v[58:59], v81 offset:17408
    ds_read_b64_tr_b16 v[60:61], v81 offset:24576
    ds_read_b64_tr_b16 v[62:63], v81 offset:25600
    s_waitcnt lgkmcnt(0)
    ds_write_b128 v5, v[56:59] offset:14336
    ds_write_b128 v5, v[60:63] offset:15360
    s_branch L_lw_14
L_lw_14_1:
    s_cmp_lg_u32 s44, 2
    s_cbranch_scc1 L_lw_14_2
    ds_read_b64_tr_b16 a[64:65], v80 offset:16384
    ds_read_b64_tr_b16 a[66:67], v80 offset:17408
    ds_read_b64_tr_b16 a[68:69], v80 offset:24576
    ds_read_b64_tr_b16 a[70:71], v80 offset:25600
    ds_read_b64_tr_b16 v[56:57], v81 offset:16384
    ds_read_b64_tr_b16 v[58:59], v81 offset:17408
    ds_read_b64_tr_b16 v[60:61], v81 offset:24576
    ds_read_b64_tr_b16 v[62:63], v81 offset:25600
    s_waitcnt lgkmcnt(0)
    ds_write_b128 v5, v[56:59] offset:8192
    ds_write_b128 v5, v[60:63] offset:9216
    s_branch L_lw_14
L_lw_14_2:
    ds_read_b64_tr_b16 v[208:209], v80 offset:16384
    ds_read_b64_tr_b16 v[210:211], v80 offset:17408
    ds_read_b64_tr_b16 v[212:213], v80 offset:24576
    ds_read_b64_tr_b16 v[214:215], v80 offset:25600
    ds_read_b64_tr_b16 v[56:57], v81 offset:16384
    ds_read_b64_tr_b16 v[58:59], v81 offset:17408
    ds_read_b64_tr_b16 v[60:61], v81 offset:24576
    ds_read_b64_tr_b16 v[62:63], v81 offset:25600
    s_waitcnt lgkmcnt(0)
    ds_write_b128 v5, v[56:59] offset:10240
    ds_write_b128 v5, v[60:63] offset:11264
L_lw_14:
    s_waitcnt lgkmcnt(0)
    s_waitcnt vmcnt(12)
    s_barrier
    s_add_u32 s46, s47, 0x780000
    s_add_u32 m0, s48, 16384
    s_nop 0
    buffer_load_dwordx4 v82, s[24:27], s46 offen nt lds
    s_add_u32 s46, s47, 0x7a0000
    s_add_u32 m0, s48, 20480
    s_nop 0
    buffer_load_dwordx4 v82, s[24:27], s46 offen nt lds
    s_add_u32 s46, s47, 0x7c0000
    s_add_u32 m0, s48, 24576
    s_nop 0
    buffer_load_dwordx4 v82, s[24:27], s46 offen nt lds
    s_add_u32 s46, s47, 0x7e0000
    s_add_u32 m0, s48, 28672
    s_nop 0
    buffer_load_dwordx4 v82, s[24:27], s46 offen nt lds
    s_cmp_lg_u32 s44, 0
    s_cbranch_scc1 L_hs_15
    s_getreg_b32 s45, hwreg(HW_REG_XCC_ID)
    s_and_b32 s45, s45, 15
    s_lshl_b32 s45, 1, s45
    v_mov_b32 v40, s45
    s_lshl_b32 s46, s40, 2
    s_add_u32 s46, s46, 4
    v_mov_b32 v41, 0
    v_mov_b32 v43, s68
    s_mov_b64 exec, 1
    buffer_atomic_or v40, v41, s[16:19], s46 offen sc1
    buffer_atomic_add v43, v41, s[16:19], 0 offen offset:12 sc1
    s_mov_b64 exec, -1
L_hs_15:
    s_cmp_lg_u32 s44, 0
    s_cbranch_scc1 L_lw_16_0
    ds_read_b64_tr_b16 v[128:129], v80 offset:32768
    ds_read_b64_tr_b16 v[130:131], v80 offset:33792
    ds_read_b64_tr_b16 v[132:133], v80 offset:40960
    ds_read_b64_tr_b16 v[134:135], v80 offset:41984
    ds_read_b64_tr_b16 v[136:137], v81 offset:32768
    ds_read_b64_tr_b16 v[138:139], v81 offset:33792
    ds_read_b64_tr_b16 v[140:141], v81 offset:40960
    ds_read_b64_tr_b16 v[142:143], v81 offset:41984
    s_branch L_lw_16
L_lw_16_0:
    s_cmp_lg_u32 s44, 1
    s_cbranch_scc1 L_lw_16_1
    ds_read_b64_tr_b16 a[176:177], v80 offset:32768
    ds_read_b64_tr_b16 a[178:179], v80 offset:33792
    ds_read_b64_tr_b16 a[180:181], v80 offset:40960
    ds_read_b64_tr_b16 a[182:183], v80 offset:41984
    ds_read_b64_tr_b16 a[184:185], v81 offset:32768
    ds_read_b64_tr_b16 a[186:187], v81 offset:33792
    ds_read_b64_tr_b16 a[188:189], v81 offset:40960
    ds_read_b64_tr_b16 a[190:191], v81 offset:41984
    s_branch L_lw_16
L_lw_16_1:
    s_cmp_lg_u32 s44, 2
    s_cbranch_scc1 L_lw_16_2
    ds_read_b64_tr_b16 a[80:81], v80 offset:32768
    ds_read_b64_tr_b16 a[82:83], v80 offset:33792
    ds_read_b64_tr_b16 a[84:85], v80 offset:40960
    ds_read_b64_tr_b16 a[86:87], v80 offset:41984
    ds_read_b64_tr_b16 v[56:57], v81 offset:32768
    ds_read_b64_tr_b16 v[58:59], v81 offset:33792
    ds_read_b64_tr_b16 v[60:61], v81 offset:40960
    ds_read_b64_tr_b16 v[62:63], v81 offset:41984
    s_waitcnt lgkmcnt(0)
    ds_write_b128 v5, v[56:59] offset:16384
    ds_write_b128 v5, v[60:63] offset:17408
    s_branch L_lw_16
L_lw_16_2:
    ds_read_b64_tr_b16 v[232:233], v80 offset:32768
    ds_read_b64_tr_b16 v[234:235], v80 offset:33792
    ds_read_b64_tr_b16 v[236:237], v80 offset:40960
    ds_read_b64_tr_b16 v[238:239], v80 offset:41984
    ds_read_b64_tr_b16 v[240:241], v81 offset:32768
    ds_read_b64_tr_b16 v[242:243], v81 offset:33792
    ds_read_b64_tr_b16 v[244:245], v81 offset:40960
    ds_read_b64_tr_b16 v[246:247], v81 offset:41984
L_lw_16:
    s_waitcnt lgkmcnt(0)
    s_waitcnt vmcnt(12)
    s_barrier
    s_add_u32 s46, s47, 0x0
    s_add_u32 m0, s48, 32768
    s_nop 0
    buffer_load_dwordx4 v82, s[28:31], s46 offen nt lds
    s_add_u32 s46, s47, 0x20000
    s_add_u32 m0, s48, 36864
    s_nop 0
    buffer_load_dwordx4 v82, s[28:31], s46 offen nt lds
    s_add_u32 s46, s47, 0x40000
    s_add_u32 m0, s48, 40960
    s_nop 0
    buffer_load_dwordx4 v82, s[28:31], s46 offen nt lds
    s_add_u32 s46, s47, 0x60000
    s_add_u32 m0, s48, 45056
    s_nop 0
    buffer_load_dwordx4 v82, s[28:31], s46 offen nt lds
    s_cmp_lg_u32 s44, 0
    s_cbranch_scc1 L_lw_17_0
    ds_read_b64_tr_b16 v[160:161], v80 offset:49152
    ds_read_b64_tr_b16 v[162:163], v80 offset:50176
    ds_read_b64_tr_b16 v[164:165], v80 offset:57344
    ds_read_b64_tr_b16 v[166:167], v80 offset:58368
    ds_read_b64_tr_b16 v[56:57], v81 offset:49152
    ds_read_b64_tr_b16 v[58:59], v81 offset:50176
    ds_read_b64_tr_b16 v[60:61], v81 offset:57344
    ds_read_b64_tr_b16 v[62:63], v81 offset:58368
    s_waitcnt lgkmcnt(0)
    ds_write_b128 v5, v[56:59] offset:0
    ds_write_b128 v5, v[60:63] offset:1024
    s_branch L_lw_17
L_lw_17_0:
    s_cmp_lg_u32 s44, 1
    s_cbranch_scc1 L_lw_17_1
    ds_read_b64_tr_b16 a[208:209], v80 offset:49152
    ds_read_b64_tr_b16 a[210:211], v80 offset:50176
    ds_read_b64_tr_b16 a[212:213], v80 offset:57344
    ds_read_b64_tr_b16 a[214:215], v80 offset:58368
    ds_read_b64_tr_b16 v[56:57], v81 offset:49152
    ds_read_b64_tr_b16 v[58:59], v81 offset:50176
    ds_read_b64_tr_b16 v[60:61], v81 offset:57344
    ds_read_b64_tr_b16 v[62:63], v81 offset:58368
    s_waitcnt lgkmcnt(0)
    ds_write_b128 v5, v[56:59] offset:2048
    ds_write_b128 v5, v[60:63] offset:3072
    s_branch L_lw_17
L_lw_17_1:
    s_cmp_lg_u32 s44, 2
    s_cbranch_scc1 L_lw_17_2
    ds_read_b64_tr_b16 a[104:105], v80 offset:49152
    ds_read_b64_tr_b16 a[106:107], v80 offset:50176
    ds_read_b64_tr_b16 a[108:109], v80 offset:57344
    ds_read_b64_tr_b16 a[110:111], v80 offset:58368
    ds_read_b64_tr_b16 v[56:57], v81 offset:49152
    ds_read_b64_tr_b16 v[58:59], v81 offset:50176
    ds_read_b64_tr_b16 v[60:61], v81 offset:57344
    ds_read_b64_tr_b16 v[62:63], v81 offset:58368
    s_waitcnt lgkmcnt(0)
    ds_write_b128 v5, v[56:59] offset:4096
    ds_write_b128 v5, v[60:63] offset:5120
    s_branch L_lw_17
L_lw_17_2:
    ds_read_b64_tr_b16 a[0:1], v80 offset:49152
    ds_read_b64_tr_b16 a[2:3], v80 offset:50176
    ds_read_b64_tr_b16 a[4:5], v80 offset:57344
    ds_read_b64_tr_b16 a[6:7], v80 offset:58368
    ds_read_b64_tr_b16 a[8:9], v81 offset:49152
    ds_read_b64_tr_b16 a[10:11], v81 offset:50176
    ds_read_b64_tr_b16 a[12:13], v81 offset:57344
    ds_read_b64_tr_b16 a[14:15], v81 offset:58368
L_lw_17:
    s_waitcnt lgkmcnt(0)
    s_waitcnt vmcnt(12)
    s_barrier
    s_add_u32 s46, s47, 0x80000
    s_add_u32 m0, s48, 49152
    s_nop 0
    buffer_load_dwordx4 v82, s[28:31], s46 offen nt lds
    s_add_u32 s46, s47, 0xa0000
    s_add_u32 m0, s48, 53248
    s_nop 0
    buffer_load_dwordx4 v82, s[28:31], s46 offen nt lds
    s_add_u32 s46, s47, 0xc0000
    s_add_u32 m0, s48, 57344
    s_nop 0
    buffer_load_dwordx4 v82, s[28:31], s46 offen nt lds
    s_add_u32 s46, s47, 0xe0000
    s_add_u32 m0, s48, 61440
    s_nop 0
    buffer_load_dwordx4 v82, s[28:31], s46 offen nt lds
    s_cmp_lg_u32 s44, 0
    s_cbranch_scc1 L_lw_18_0
    ds_read_b64_tr_b16 v[184:185], v84 offset:20480
    ds_read_b64_tr_b16 v[186:187], v84 offset:21504
    ds_read_b64_tr_b16 v[188:189], v86 offset:20480
    ds_read_b64_tr_b16 v[190:191], v86 offset:21504
    ds_read_b64_tr_b16 v[192:193], v85 offset:20480
    ds_read_b64_tr_b16 v[194:195], v85 offset:21504
    ds_read_b64_tr_b16 v[196:197], v87 offset:20480
    ds_read_b64_tr_b16 v[198:199], v87 offset:21504
    s_branch L_lw_18
L_lw_18_0:
    s_cmp_lg_u32 s44, 1
    s_cbranch_scc1 L_lw_18_1
    ds_read_b64_tr_b16 a[232:233], v84 offset:20480
    ds_read_b64_tr_b16 a[234:235], v84 offset:21504
    ds_read_b64_tr_b16 a[236:237], v86 offset:20480
    ds_read_b64_tr_b16 a[238:239], v86 offset:21504
    ds_read_b64_tr_b16 a[240:241], v85 offset:20480
    ds_read_b64_tr_b16 a[242:243], v85 offset:21504
    ds_read_b64_tr_b16 a[244:245], v87 offset:20480
    ds_read_b64_tr_b16 a[246:247], v87 offset:21504
    s_branch L_lw_18
L_lw_18_1:
    s_cmp_lg_u32 s44, 2
    s_cbranch_scc1 L_lw_18_2
    ds_read_b64_tr_b16 a[128:129], v84 offset:20480
    ds_read_b64_tr_b16 a[130:131], v84 offset:21504
    ds_read_b64_tr_b16 a[132:133], v86 offset:20480
    ds_read_b64_tr_b16 a[134:135], v86 offset:21504
    ds_read_b64_tr_b16 v[56:57], v85 offset:20480
    ds_read_b64_tr_b16 v[58:59], v85 offset:21504
    ds_read_b64_tr_b16 v[60:61], v87 offset:20480
    ds_read_b64_tr_b16 v[62:63], v87 offset:21504
    s_waitcnt lgkmcnt(0)
    ds_write_b128 v5, v[56:59] offset:6144
    ds_write_b128 v5, v[60:63] offset:7168
    s_branch L_lw_18
L_lw_18_2:
    ds_read_b64_tr_b16 a[32:33], v84 offset:20480
    ds_read_b64_tr_b16 a[34:35], v84 offset:21504
    ds_read_b64_tr_b16 a[36:37], v86 offset:20480
    ds_read_b64_tr_b16 a[38:39], v86 offset:21504
    ds_read_b64_tr_b16 a[40:41], v85 offset:20480
    ds_read_b64_tr_b16 a[42:43], v85 offset:21504
    ds_read_b64_tr_b16 a[44:45], v87 offset:20480
    ds_read_b64_tr_b16 a[46:47], v87 offset:21504
L_lw_18:
    s_waitcnt lgkmcnt(0)
    s_waitcnt vmcnt(12)
    s_barrier
    s_cmp_lg_u32 s44, 0
    s_cbranch_scc1 L_lw_19_0
    ds_read_b64_tr_b16 v[208:209], v80 offset:0
    ds_read_b64_tr_b16 v[210:211], v80 offset:1024
    ds_read_b64_tr_b16 v[212:213], v80 offset:8192
    ds_read_b64_tr_b16 v[214:215], v80 offset:9216
    ds_read_b64_tr_b16 v[56:57], v81 offset:0
    ds_read_b64_tr_b16 v[58:59], v81 offset:1024
    ds_read_b64_tr_b16 v[60:61], v81 offset:8192
    ds_read_b64_tr_b16 v[62:63], v81 offset:9216
    s_waitcnt lgkmcnt(0)
    ds_write_b128 v5, v[56:59] offset:10240
    ds_write_b128 v5, v[60:63] offset:11264
    s_branch L_lw_19
L_lw_19_0:
    s_cmp_lg_u32 s44, 1
    s_cbranch_scc1 L_lw_19_1
    ds_read_b64_tr_b16 v[104:105], v80 offset:0
    ds_read_b64_tr_b16 v[106:107], v80 offset:1024
    ds_read_b64_tr_b16 v[108:109], v80 offset:8192
    ds_read_b64_tr_b16 v[110:111], v80 offset:9216
    ds_read_b64_tr_b16 v[56:57], v81 offset:0
    ds_read_b64_tr_b16 v[58:59], v81 offset:1024
    ds_read_b64_tr_b16 v[60:61], v81 offset:8192
    ds_read_b64_tr_b16 v[62:63], v81 offset:9216
    s_waitcnt lgkmcnt(0)
    ds_write_b128 v5, v[56:59] offset:12288
    ds_write_b128 v5, v[60:63] offset:13312
    s_branch L_lw_19
L_lw_19_1:
    s_cmp_lg_u32 s44, 2
    s_cbranch_scc1 L_lw_19_2
    ds_read_b64_tr_b16 a[152:153], v80 offset:0
    ds_read_b64_tr_b16 a[154:155], v80 offset:1024
    ds_read_b64_tr_b16 a[156:157], v80 offset:8192
    ds_read_b64_tr_b16 a[158:159], v80 offset:9216
    ds_read_b64_tr_b16 v[56:57], v81 offset:0
    ds_read_b64_tr_b16 v[58:59], v81 offset:1024
    ds_read_b64_tr_b16 v[60:61], v81 offset:8192
    ds_read_b64_tr_b16 v[62:63], v81 offset:9216
    s_waitcnt lgkmcnt(0)
    ds_write_b128 v5, v[56:59] offset:14336
    ds_write_b128 v5, v[60:63] offset:15360
    s_branch L_lw_19
L_lw_19_2:
    ds_read_b64_tr_b16 a[64:65], v80 offset:0
    ds_read_b64_tr_b16 a[66:67], v80 offset:1024
    ds_read_b64_tr_b16 a[68:69], v80 offset:8192
    ds_read_b64_tr_b16 a[70:71], v80 offset:9216
    ds_read_b64_tr_b16 v[56:57], v81 offset:0
    ds_read_b64_tr_b16 v[58:59], v81 offset:1024
    ds_read_b64_tr_b16 v[60:61], v81 offset:8192
    ds_read_b64_tr_b16 v[62:63], v81 offset:9216
    s_waitcnt lgkmcnt(0)
    ds_write_b128 v5, v[56:59] offset:8192
    ds_write_b128 v5, v[60:63] offset:9216
L_lw_19:
    s_waitcnt lgkmcnt(0)
    s_waitcnt vmcnt(8)
    s_barrier
    s_add_u32 s46, s47, 0x100000
    s_add_u32 m0, s48, 0
    s_nop 0
    buffer_load_dwordx4 v82, s[28:31], s46 offen nt lds
    s_add_u32 s46, s47, 0x120000
    s_add_u32 m0, s48, 4096
    s_nop 0
    buffer_load_dwordx4 v82, s[28:31], s46 offen nt lds
    s_add_u32 s46, s47, 0x140000
    s_add_u32 m0, s48, 8192
    s_nop 0
    buffer_load_dwordx4 v82, s[28:31], s46 offen nt lds
    s_add_u32 s46, s47, 0x160000
    s_add_u32 m0, s48, 12288
    s_nop 0
    buffer_load_dwordx4 v82, s[28:31], s46 offen nt lds
    s_cmp_lg_u32 s44, 0
    s_cbranch_scc1 L_lw_20_0
    ds_read_b64_tr_b16 v[232:233], v80 offset:16384
    ds_read_b64_tr_b16 v[234:235], v80 offset:17408
    ds_read_b64_tr_b16 v[236:237], v80 offset:24576
    ds_read_b64_tr_b16 v[238:239], v80 offset:25600
    ds_read_b64_tr_b16 v[240:241], v81 offset:16384
    ds_read_b64_tr_b16 v[242:243], v81 offset:17408
    ds_read_b64_tr_b16 v[244:245], v81 offset:24576
    ds_read_b64_tr_b16 v[246:247], v81 offset:25600
    s_branch L_lw_20
L_lw_20_0:
    s_cmp_lg_u32 s44, 1
    s_cbranch_scc1 L_lw_20_1
    ds_read_b64_tr_b16 v[128:129], v80 offset:16384
    ds_read_b64_tr_b16 v[130:131], v80 offset:17408
    ds_read_b64_tr_b16 v[132:133], v80 offset:24576
    ds_read_b64_tr_b16 v[134:135], v80 offset:25600
    ds_read_b64_tr_b16 v[136:137], v81 offset:16384
    ds_read_b64_tr_b16 v[138:139], v81 offset:17408
    ds_read_b64_tr_b16 v[140:141], v81 offset:24576
    ds_read_b64_tr_b16 v[142:143], v81 offset:25600
    s_branch L_lw_20
L_lw_20_1:
    s_cmp_lg_u32 s44, 2
    s_cbranch_scc1 L_lw_20_2
    ds_read_b64_tr_b16 a[176:177], v80 offset:16384
    ds_read_b64_tr_b16 a[178:179], v80 offset:17408
    ds_read_b64_tr_b16 a[180:181], v80 offset:24576
    ds_read_b64_tr_b16 a[182:183], v80 offset:25600
    ds_read_b64_tr_b16 a[184:185], v81 offset:16384
    ds_read_b64_tr_b16 a[186:187], v81 offset:17408
    ds_read_b64_tr_b16 a[188:189], v81 offset:24576
    ds_read_b64_tr_b16 a[190:191], v81 offset:25600
    s_branch L_lw_20
L_lw_20_2:
    ds_read_b64_tr_b16 a[80:81], v80 offset:16384
    ds_read_b64_tr_b16 a[82:83], v80 offset:17408
    ds_read_b64_tr_b16 a[84:85], v80 offset:24576
    ds_read_b64_tr_b16 a[86:87], v80 offset:25600
    ds_read_b64_tr_b16 v[56:57], v81 offset:16384
    ds_read_b64_tr_b16 v[58:59], v81 offset:17408
    ds_read_b64_tr_b16 v[60:61], v81 offset:24576
    ds_read_b64_tr_b16 v[62:63], v81 offset:25600
    s_waitcnt lgkmcnt(0)
    ds_write_b128 v5, v[56:59] offset:16384
    ds_write_b128 v5, v[60:63] offset:17408
L_lw_20:
    s_waitcnt lgkmcnt(0)
    s_waitcnt vmcnt(8)
    s_barrier
    s_add_u32 s46, s47, 0x180000
    s_add_u32 m0, s48, 16384
    s_nop 0
    buffer_load_dwordx4 v82, s[28:31], s46 offen nt lds
    s_add_u32 s46, s47, 0x1a0000
    s_add_u32 m0, s48, 20480
    s_nop 0
    buffer_load_dwordx4 v82, s[28:31], s46 offen nt lds
    s_add_u32 s46, s47, 0x1c0000
    s_add_u32 m0, s48, 24576
    s_nop 0
    buffer_load_dwordx4 v82, s[28:31], s46 offen nt lds
    s_add_u32 s46, s47, 0x1e0000
    s_add_u32 m0, s48, 28672
    s_nop 0
    buffer_load_dwordx4 v82, s[28:31], s46 offen nt lds
    s_cmp_lg_u32 s44, 0
    s_cbranch_scc1 L_lw_21_0
    ds_read_b64_tr_b16 a[16:17], v80 offset:32768
    ds_read_b64_tr_b16 a[18:19], v80 offset:33792
    ds_read_b64_tr_b16 a[20:21], v80 offset:40960
    ds_read_b64_tr_b16 a[22:23], v80 offset:41984
    ds_read_b64_tr_b16 a[24:25], v81 offset:32768
    ds_read_b64_tr_b16 a[26:27], v81 offset:33792
    ds_read_b64_tr_b16 a[28:29], v81 offset:40960
    ds_read_b64_tr_b16 a[30:31], v81 offset:41984
    s_branch L_lw_21
L_lw_21_0:
    s_cmp_lg_u32 s44, 1
    s_cbranch_scc1 L_lw_21_1
    ds_read_b64_tr_b16 v[168:169], v80 offset:32768
    ds_read_b64_tr_b16 v[170:171], v80 offset:33792
    ds_read_b64_tr_b16 v[172:173], v80 offset:40960
    ds_read_b64_tr_b16 v[174:175], v80 offset:41984
    ds_read_b64_tr_b16 v[176:177], v81 offset:32768
    ds_read_b64_tr_b16 v[178:179], v81 offset:33792
    ds_read_b64_tr_b16 v[180:181], v81 offset:40960
    ds_read_b64_tr_b16 v[182:183], v81 offset:41984
    s_branch L_lw_21
L_lw_21_1:
    s_cmp_lg_u32 s44, 2
    s_cbranch_scc1 L_lw_21_2
    ds_read_b64_tr_b16 a[216:217], v80 offset:32768
    ds_read_b64_tr_b16 a[218:219], v80 offset:33792
    ds_read_b64_tr_b16 a[220:221], v80 offset:40960
    ds_read_b64_tr_b16 a[222:223], v80 offset:41984
    ds_read_b64_tr_b16 a[224:225], v81 offset:32768
    ds_read_b64_tr_b16 a[226:227], v81 offset:33792
    ds_read_b64_tr_b16 a[228:229], v81 offset:40960
    ds_read_b64_tr_b16 a[230:231], v81 offset:41984
    s_branch L_lw_21
L_lw_21_2:
    ds_read_b64_tr_b16 a[112:113], v80 offset:32768
    ds_read_b64_tr_b16 a[114:115], v80 offset:33792
    ds_read_b64_tr_b16 a[116:117], v80 offset:40960
    ds_read_b64_tr_b16 a[118:119], v80 offset:41984
    ds_read_b64_tr_b16 a[120:121], v81 offset:32768
    ds_read_b64_tr_b16 a[122:123], v81 offset:33792
    ds_read_b64_tr_b16 a[124:125], v81 offset:40960
    ds_read_b64_tr_b16 a[126:127], v81 offset:41984
L_lw_21:
    s_waitcnt lgkmcnt(0)
    s_waitcnt vmcnt(8)
    s_barrier
    s_add_u32 s46, s47, 0x200000
    s_add_u32 m0, s48, 32768
    s_nop 0
    buffer_load_dwordx4 v82, s[28:31], s46 offen nt lds
    s_add_u32 s46, s47, 0x220000
    s_add_u32 m0, s48, 36864
    s_nop 0
    buffer_load_dwordx4 v82, s[28:31], s46 offen nt lds
    s_add_u32 s46, s47, 0x240000
    s_add_u32 m0, s48, 40960
    s_nop 0
    buffer_load_dwordx4 v82, s[28:31], s46 offen nt lds
    s_add_u32 s46, s47, 0x260000
    s_add_u32 m0, s48, 45056
    s_nop 0
    buffer_load_dwordx4 v82, s[28:31], s46 offen nt lds
    s_cmp_lg_u32 s44, 0
    s_cbranch_scc1 L_lw_22_0
    ds_read_b64_tr_b16 a[48:49], v80 offset:49152
    ds_read_b64_tr_b16 a[50:51], v80 offset:50176
    ds_read_b64_tr_b16 a[52:53], v80 offset:57344
    ds_read_b64_tr_b16 a[54:55], v80 offset:58368
    ds_read_b64_tr_b16 a[56:57], v81 offset:49152
    ds_read_b64_tr_b16 a[58:59], v81 offset:50176
    ds_read_b64_tr_b16 a[60:61], v81 offset:57344
    ds_read_b64_tr_b16 a[62:63], v81 offset:58368
    s_branch L_lw_22
L_lw_22_0:
    s_cmp_lg_u32 s44, 1
    s_cbranch_scc1 L_lw_22_1
    ds_read_b64_tr_b16 v[200:201], v80 offset:49152
    ds_read_b64_tr_b16 v[202:203], v80 offset:50176
    ds_read_b64_tr_b16 v[204:205], v80 offset:57344
    ds_read_b64_tr_b16 v[206:207], v80 offset:58368
    ds_read_b64_tr_b16 v[56:57], v81 offset:49152
    ds_read_b64_tr_b16 v[58:59], v81 offset:50176
    ds_read_b64_tr_b16 v[60:61], v81 offset:57344
    ds_read_b64_tr_b16 v[62:63], v81 offset:58368
    s_waitcnt lgkmcnt(0)
    ds_write_b128 v5, v[56:59] offset:18432
    ds_write_b128 v5, v[60:63] offset:19456
    s_branch L_lw_22
L_lw_22_1:
    s_cmp_lg_u32 s44, 2
    s_cbranch_scc1 L_lw_22_2
    ds_read_b64_tr_b16 a[248:249], v80 offset:49152
    ds_read_b64_tr_b16 a[250:251], v80 offset:50176
    ds_read_b64_tr_b16 a[252:253], v80 offset:57344
    ds_read_b64_tr_b16 a[254:255], v80 offset:58368
    ds_read_b64_tr_b16 v[96:97], v81 offset:49152
    ds_read_b64_tr_b16 v[98:99], v81 offset:50176
    ds_read_b64_tr_b16 v[100:101], v81 offset:57344
    ds_read_b64_tr_b16 v[102:103], v81 offset:58368
    s_branch L_lw_22
L_lw_22_2:
    ds_read_b64_tr_b16 a[136:137], v80 offset:49152
    ds_read_b64_tr_b16 a[138:139], v80 offset:50176
    ds_read_b64_tr_b16 a[140:141], v80 offset:57344
    ds_read_b64_tr_b16 a[142:143], v80 offset:58368
    ds_read_b64_tr_b16 a[144:145], v81 offset:49152
    ds_read_b64_tr_b16 a[146:147], v81 offset:50176
    ds_read_b64_tr_b16 a[148:149], v81 offset:57344
    ds_read_b64_tr_b16 a[150:151], v81 offset:58368
L_lw_22:
    s_waitcnt lgkmcnt(0)
    s_waitcnt vmcnt(8)
    s_barrier
    s_add_u32 s46, s47, 0x280000
    s_add_u32 m0, s48, 49152
    s_nop 0
    buffer_load_dwordx4 v82, s[28:31], s46 offen nt lds
    s_add_u32 s46, s47, 0x2a0000
    s_add_u32 m0, s48, 53248
    s_nop 0
    buffer_load_dwordx4 v82, s[28:31], s46 offen nt lds
    s_add_u32 s46, s47, 0x2c0000
    s_add_u32 m0, s48, 57344
    s_nop 0
    buffer_load_dwordx4 v82, s[28:31], s46 offen nt lds
    s_add_u32 s46, s47, 0x2e0000
    s_add_u32 m0, s48, 61440
    s_nop 0
    buffer_load_dwordx4 v82, s[28:31], s46 offen nt lds
    s_cmp_lg_u32 s44, 0
    s_cbranch_scc1 L_lw_23_0
    ds_read_b64_tr_b16 a[72:73], v80 offset:0
    ds_read_b64_tr_b16 a[74:75], v80 offset:1024
    ds_read_b64_tr_b16 a[76:77], v80 offset:8192
    ds_read_b64_tr_b16 a[78:79], v80 offset:9216
    ds_read_b64_tr_b16 v[56:57], v81 offset:0
    ds_read_b64_tr_b16 v[58:59], v81 offset:1024
    ds_read_b64_tr_b16 v[60:61], v81 offset:8192
    ds_read_b64_tr_b16 v[62:63], v81 offset:9216
    s_waitcnt lgkmcnt(0)
    ds_write_b128 v5, v[56:59] offset:20480
    ds_write_b128 v5, v[60:63] offset:21504
    s_branch L_lw_23
L_lw_23_0:
    s_cmp_lg_u32 s44, 1
    s_cbranch_scc1 L_lw_23_1
    ds_read_b64_tr_b16 v[216:217], v80 offset:0
    ds_read_b64_tr_b16 v[218:219], v80 offset:1024
    ds_read_b64_tr_b16 v[220:221], v80 offset:8192
    ds_read_b64_tr_b16 v[222:223], v80 offset:9216
    ds_read_b64_tr_b16 v[224:225], v81 offset:0
    ds_read_b64_tr_b16 v[226:227], v81 offset:1024
    ds_read_b64_tr_b16 v[228:229], v81 offset:8192
    ds_read_b64_tr_b16 v[230:231], v81 offset:9216
    s_branch L_lw_23
L_lw_23_1:
    s_cmp_lg_u32 s44, 2
    s_cbranch_scc1 L_lw_23_2
    ds_read_b64_tr_b16 v[112:113], v80 offset:0
    ds_read_b64_tr_b16 v[114:115], v80 offset:1024
    ds_read_b64_tr_b16 v[116:117], v80 offset:8192
    ds_read_b64_tr_b16 v[118:119], v80 offset:9216
    ds_read_b64_tr_b16 v[120:121], v81 offset:0
    ds_read_b64_tr_b16 v[122:123], v81 offset:1024
    ds_read_b64_tr_b16 v[124:125], v81 offset:8192
    ds_read_b64_tr_b16 v[126:127], v81 offset:9216
    s_branch L_lw_23
L_lw_23_2:
    ds_read_b64_tr_b16 a[160:161], v80 offset:0
    ds_read_b64_tr_b16 a[162:163], v80 offset:1024
    ds_read_b64_tr_b16 a[164:165], v80 offset:8192
    ds_read_b64_tr_b16 a[166:167], v80 offset:9216
    ds_read_b64_tr_b16 a[168:169], v81 offset:0
    ds_read_b64_tr_b16 a[170:171], v81 offset:1024
    ds_read_b64_tr_b16 a[172:173], v81 offset:8192
    ds_read_b64_tr_b16 a[174:175], v81 offset:9216
L_lw_23:
    s_waitcnt lgkmcnt(0)
    s_waitcnt vmcnt(8)
    s_barrier
    s_add_u32 s46, s47, 0x300000
    s_add_u32 m0, s48, 0
    s_nop 0
    buffer_load_dwordx4 v82, s[28:31], s46 offen nt lds
    s_add_u32 s46, s47, 0x320000
    s_add_u32 m0, s48, 4096
    s_nop 0
    buffer_load_dwordx4 v82, s[28:31], s46 offen nt lds
    s_add_u32 s46, s47, 0x340000
    s_add_u32 m0, s48, 8192
    s_nop 0
    buffer_load_dwordx4 v82, s[28:31], s46 offen nt lds
    s_add_u32 s46, s47, 0x360000
    s_add_u32 m0, s48, 12288
    s_nop 0
    buffer_load_dwordx4 v82, s[28:31], s46 offen nt lds
    s_cmp_lg_u32 s44, 0
    s_cbranch_scc1 L_lw_24_0
    ds_read_b64_tr_b16 a[88:89], v80 offset:16384
    ds_read_b64_tr_b16 a[90:91], v80 offset:17408
    ds_read_b64_tr_b16 a[92:93], v80 offset:24576
    ds_read_b64_tr_b16 a[94:95], v80 offset:25600
    ds_read_b64_tr_b16 a[96:97], v81 offset:16384
    ds_read_b64_tr_b16 a[98:99], v81 offset:17408
    ds_read_b64_tr_b16 a[100:101], v81 offset:24576
    ds_read_b64_tr_b16 a[102:103], v81 offset:25600
    s_branch L_lw_24
L_lw_24_0:
    s_cmp_lg_u32 s44, 1
    s_cbranch_scc1 L_lw_24_1
    ds_read_b64_tr_b16 v[248:249], v80 offset:16384
    ds_read_b64_tr_b16 v[250:251], v80 offset:17408
    ds_read_b64_tr_b16 v[252:253], v80 offset:24576
    ds_read_b64_tr_b16 v[254:255], v80 offset:25600
    ds_read_b64_tr_b16 v[56:57], v81 offset:16384
    ds_read_b64_tr_b16 v[58:59], v81 offset:17408
    ds_read_b64_tr_b16 v[60:61], v81 offset:24576
    ds_read_b64_tr_b16 v[62:63], v81 offset:25600
    s_waitcnt lgkmcnt(0)
    ds_write_b128 v5, v[56:59] offset:22528
    ds_write_b128 v5, v[60:63] offset:23552
    s_branch L_lw_24
L_lw_24_1:
    s_cmp_lg_u32 s44, 2
    s_cbranch_scc1 L_lw_24_2
    ds_read_b64_tr_b16 v[144:145], v80 offset:16384
    ds_read_b64_tr_b16 v[146:147], v80 offset:17408
    ds_read_b64_tr_b16 v[148:149], v80 offset:24576
    ds_read_b64_tr_b16 v[150:151], v80 offset:25600
    ds_read_b64_tr_b16 v[152:153], v81 offset:16384
    ds_read_b64_tr_b16 v[154:155], v81 offset:17408
    ds_read_b64_tr_b16 v[156:157], v81 offset:24576
    ds_read_b64_tr_b16 v[158:159], v81 offset:25600
    s_branch L_lw_24
L_lw_24_2:
    ds_read_b64_tr_b16 a[192:193], v80 offset:16384
    ds_read_b64_tr_b16 a[194:195], v80 offset:17408
    ds_read_b64_tr_b16 a[196:197], v80 offset:24576
    ds_read_b64_tr_b16 a[198:199], v80 offset:25600
    ds_read_b64_tr_b16 a[200:201], v81 offset:16384
    ds_read_b64_tr_b16 a[202:203], v81 offset:17408
    ds_read_b64_tr_b16 a[204:205], v81 offset:24576
    ds_read_b64_tr_b16 a[206:207], v81 offset:25600
L_lw_24:
    s_waitcnt lgkmcnt(0)
    s_waitcnt vmcnt(8)
    s_barrier
    s_add_u32 s46, s47, 0x380000
    s_add_u32 m0, s48, 16384
    s_nop 0
    buffer_load_dwordx4 v82, s[28:31], s46 offen nt lds
    s_add_u32 s46, s47, 0x3a0000
    s_add_u32 m0, s48, 20480
    s_nop 0
    buffer_load_dwordx4 v82, s[28:31], s46 offen nt lds
    s_add_u32 s46, s47, 0x3c0000
    s_add_u32 m0, s48, 24576
    s_nop 0
    buffer_load_dwordx4 v82, s[28:31], s46 offen nt lds
    s_add_u32 s46, s47, 0x3e0000
    s_add_u32 m0, s48, 28672
    s_nop 0
    buffer_load_dwordx4 v82, s[28:31], s46 offen nt lds
    s_cmp_lg_u32 s44, 0
    s_cbranch_scc1 L_lw_25_0
    ds_read_b64_tr_b16 a[112:113], v80 offset:32768
    ds_read_b64_tr_b16 a[114:115], v80 offset:33792
    ds_read_b64_tr_b16 a[116:117], v80 offset:40960
    ds_read_b64_tr_b16 a[118:119], v80 offset:41984
    ds_read_b64_tr_b16 a[120:121], v81 offset:32768
    ds_read_b64_tr_b16 a[122:123], v81 offset:33792
    ds_read_b64_tr_b16 a[124:125], v81 offset:40960
    ds_read_b64_tr_b16 a[126:127], v81 offset:41984
    s_branch L_lw_25
L_lw_25_0:
    s_cmp_lg_u32 s44, 1
    s_cbranch_scc1 L_lw_25_1
    ds_read_b64_tr_b16 a[16:17], v80 offset:32768
    ds_read_b64_tr_b16 a[18:19], v80 offset:33792
    ds_read_b64_tr_b16 a[20:21], v80 offset:40960
    ds_read_b64_tr_b16 a[22:23], v80 offset:41984
    ds_read_b64_tr_b16 a[24:25], v81 offset:32768
    ds_read_b64_tr_b16 a[26:27], v81 offset:33792
    ds_read_b64_tr_b16 a[28:29], v81 offset:40960
    ds_read_b64_tr_b16 a[30:31], v81 offset:41984
    s_branch L_lw_25
L_lw_25_1:
    s_cmp_lg_u32 s44, 2
    s_cbranch_scc1 L_lw_25_2
    ds_read_b64_tr_b16 v[168:169], v80 offset:32768
    ds_read_b64_tr_b16 v[170:171], v80 offset:33792
    ds_read_b64_tr_b16 v[172:173], v80 offset:40960
    ds_read_b64_tr_b16 v[174:175], v80 offset:41984
    ds_read_b64_tr_b16 v[176:177], v81 offset:32768
    ds_read_b64_tr_b16 v[178:179], v81 offset:33792
    ds_read_b64_tr_b16 v[180:181], v81 offset:40960
    ds_read_b64_tr_b16 v[182:183], v81 offset:41984
    s_branch L_lw_25
L_lw_25_2:
    ds_read_b64_tr_b16 a[216:217], v80 offset:32768
    ds_read_b64_tr_b16 a[218:219], v80 offset:33792
    ds_read_b64_tr_b16 a[220:221], v80 offset:40960
    ds_read_b64_tr_b16 a[222:223], v80 offset:41984
    ds_read_b64_tr_b16 a[224:225], v81 offset:32768
    ds_read_b64_tr_b16 a[226:227], v81 offset:33792
    ds_read_b64_tr_b16 a[228:229], v81 offset:40960
    ds_read_b64_tr_b16 a[230:231], v81 offset:41984
L_lw_25:
    s_waitcnt lgkmcnt(0)
    s_waitcnt vmcnt(8)
    s_barrier
    s_add_u32 s46, s47, 0x400000
    s_add_u32 m0, s48, 32768
    s_nop 0
    buffer_load_dwordx4 v82, s[28:31], s46 offen nt lds
    s_add_u32 s46, s47, 0x420000
    s_add_u32 m0, s48, 36864
    s_nop 0
    buffer_load_dwordx4 v82, s[28:31], s46 offen nt lds
    s_add_u32 s46, s47, 0x440000
    s_add_u32 m0, s48, 40960
    s_nop 0
    buffer_load_dwordx4 v82, s[28:31], s46 offen nt lds
    s_add_u32 s46, s47, 0x460000
    s_add_u32 m0, s48, 45056
    s_nop 0
    buffer_load_dwordx4 v82, s[28:31], s46 offen nt lds
    s_cmp_lg_u32 s44, 0
    s_cbranch_scc1 L_lw_26_0
    ds_read_b64_tr_b16 a[136:137], v80 offset:49152
    ds_read_b64_tr_b16 a[138:139], v80 offset:50176
    ds_read_b64_tr_b16 a[140:141], v80 offset:57344
    ds_read_b64_tr_b16 a[142:143], v80 offset:58368
    ds_read_b64_tr_b16 a[144:145], v81 offset:49152
    ds_read_b64_tr_b16 a[146:147], v81 offset:50176
    ds_read_b64_tr_b16 a[148:149], v81 offset:57344
    ds_read_b64_tr_b16 a[150:151], v81 offset:58368
    s_branch L_lw_26
L_lw_26_0:
    s_cmp_lg_u32 s44, 1
    s_cbranch_scc1 L_lw_26_1
    ds_read_b64_tr_b16 a[48:49], v80 offset:49152
    ds_read_b64_tr_b16 a[50:51], v80 offset:50176
    ds_read_b64_tr_b16 a[52:53], v80 offset:57344
    ds_read_b64_tr_b16 a[54:55], v80 offset:58368
    ds_read_b64_tr_b16 a[56:57], v81 offset:49152
    ds_read_b64_tr_b16 a[58:59], v81 offset:50176
    ds_read_b64_tr_b16 a[60:61], v81 offset:57344
    ds_read_b64_tr_b16 a[62:63], v81 offset:58368
    s_branch L_lw_26
L_lw_26_1:
    s_cmp_lg_u32 s44, 2
    s_cbranch_scc1 L_lw_26_2
    ds_read_b64_tr_b16 v[200:201], v80 offset:49152
    ds_read_b64_tr_b16 v[202:203], v80 offset:50176
    ds_read_b64_tr_b16 v[204:205], v80 offset:57344
    ds_read_b64_tr_b16 v[206:207], v80 offset:58368
    ds_read_b64_tr_b16 v[56:57], v81 offset:49152
    ds_read_b64_tr_b16 v[58:59], v81 offset:50176
    ds_read_b64_tr_b16 v[60:61], v81 offset:57344
    ds_read_b64_tr_b16 v[62:63], v81 offset:58368
    s_waitcnt lgkmcnt(0)
    ds_write_b128 v5, v[56:59] offset:18432
    ds_write_b128 v5, v[60:63] offset:19456
    s_branch L_lw_26
L_lw_26_2:
    ds_read_b64_tr_b16 a[248:249], v80 offset:49152
    ds_read_b64_tr_b16 a[250:251], v80 offset:50176
    ds_read_b64_tr_b16 a[252:253], v80 offset:57344
    ds_read_b64_tr_b16 a[254:255], v80 offset:58368
    ds_read_b64_tr_b16 v[96:97], v81 offset:49152
    ds_read_b64_tr_b16 v[98:99], v81 offset:50176
    ds_read_b64_tr_b16 v[100:101], v81 offset:57344
    ds_read_b64_tr_b16 v[102:103], v81 offset:58368
L_lw_26:
    s_waitcnt lgkmcnt(0)
    s_waitcnt vmcnt(8)
    s_barrier
    s_add_u32 s46, s47, 0x480000
    s_add_u32 m0, s48, 49152
    s_nop 0
    buffer_load_dwordx4 v82, s[28:31], s46 offen nt lds
    s_add_u32 s46, s47, 0x4a0000
    s_add_u32 m0, s48, 53248
    s_nop 0
    buffer_load_dwordx4 v82, s[28:31], s46 offen nt lds
    s_add_u32 s46, s47, 0x4c0000
    s_add_u32 m0, s48, 57344
    s_nop 0
    buffer_load_dwordx4 v82, s[28:31], s46 offen nt lds
    s_add_u32 s46, s47, 0x4e0000
    s_add_u32 m0, s48, 61440
    s_nop 0
    buffer_load_dwordx4 v82, s[28:31], s46 offen nt lds
    s_cmp_lg_u32 s44, 0
    s_cbranch_scc1 L_lw_27_0
    ds_read_b64_tr_b16 a[160:161], v80 offset:0
    ds_read_b64_tr_b16 a[162:163], v80 offset:1024
    ds_read_b64_tr_b16 a[164:165], v80 offset:8192
    ds_read_b64_tr_b16 a[166:167], v80 offset:9216
    ds_read_b64_tr_b16 a[168:169], v81 offset:0
    ds_read_b64_tr_b16 a[170:171], v81 offset:1024
    ds_read_b64_tr_b16 a[172:173], v81 offset:8192
    ds_read_b64_tr_b16 a[174:175], v81 offset:9216
    s_branch L_lw_27
L_lw_27_0:
    s_cmp_lg_u32 s44, 1
    s_cbranch_scc1 L_lw_27_1
    ds_read_b64_tr_b16 a[72:73], v80 offset:0
    ds_read_b64_tr_b16 a[74:75], v80 offset:1024
    ds_read_b64_tr_b16 a[76:77], v80 offset:8192
    ds_read_b64_tr_b16 a[78:79], v80 offset:9216
    ds_read_b64_tr_b16 v[56:57], v81 offset:0
    ds_read_b64_tr_b16 v[58:59], v81 offset:1024
    ds_read_b64_tr_b16 v[60:61], v81 offset:8192
    ds_read_b64_tr_b16 v[62:63], v81 offset:9216
    s_waitcnt lgkmcnt(0)
    ds_write_b128 v5, v[56:59] offset:20480
    ds_write_b128 v5, v[60:63] offset:21504
    s_branch L_lw_27
L_lw_27_1:
    s_cmp_lg_u32 s44, 2
    s_cbranch_scc1 L_lw_27_2
    ds_read_b64_tr_b16 v[216:217], v80 offset:0
    ds_read_b64_tr_b16 v[218:219], v80 offset:1024
    ds_read_b64_tr_b16 v[220:221], v80 offset:8192
    ds_read_b64_tr_b16 v[222:223], v80 offset:9216
    ds_read_b64_tr_b16 v[224:225], v81 offset:0
    ds_read_b64_tr_b16 v[226:227], v81 offset:1024
    ds_read_b64_tr_b16 v[228:229], v81 offset:8192
    ds_read_b64_tr_b16 v[230:231], v81 offset:9216
    s_branch L_lw_27
L_lw_27_2:
    ds_read_b64_tr_b16 v[112:113], v80 offset:0
    ds_read_b64_tr_b16 v[114:115], v80 offset:1024
    ds_read_b64_tr_b16 v[116:117], v80 offset:8192
    ds_read_b64_tr_b16 v[118:119], v80 offset:9216
    ds_read_b64_tr_b16 v[120:121], v81 offset:0
    ds_read_b64_tr_b16 v[122:123], v81 offset:1024
    ds_read_b64_tr_b16 v[124:125], v81 offset:8192
    ds_read_b64_tr_b16 v[126:127], v81 offset:9216
L_lw_27:
    s_waitcnt lgkmcnt(0)
    s_waitcnt vmcnt(8)
    s_barrier
    s_add_u32 s46, s47, 0x500000
    s_add_u32 m0, s48, 0
    s_nop 0
    buffer_load_dwordx4 v82, s[28:31], s46 offen nt lds
    s_add_u32 s46, s47, 0x520000
    s_add_u32 m0, s48, 4096
    s_nop 0
    buffer_load_dwordx4 v82, s[28:31], s46 offen nt lds
    s_add_u32 s46, s47, 0x540000
    s_add_u32 m0, s48, 8192
    s_nop 0
    buffer_load_dwordx4 v82, s[28:31], s46 offen nt lds
    s_add_u32 s46, s47, 0x560000
    s_add_u32 m0, s48, 12288
    s_nop 0
    buffer_load_dwordx4 v82, s[28:31], s46 offen nt lds
    s_cmp_lg_u32 s44, 0
    s_cbranch_scc1 L_hs_28
    v_mov_b32 v41, 0
    v_mov_b32 v42, 1
    s_mov_b64 exec, 1
    buffer_atomic_add v42, v41, s[16:19], 0 offen sc1
    s_mov_b64 exec, -1
L_hs_28:
    s_cmp_lg_u32 s44, 0
    s_cbranch_scc1 L_lw_29_0
    ds_read_b64_tr_b16 a[192:193], v80 offset:16384
    ds_read_b64_tr_b16 a[194:195], v80 offset:17408
    ds_read_b64_tr_b16 a[196:197], v80 offset:24576
    ds_read_b64_tr_b16 a[198:199], v80 offset:25600
    ds_read_b64_tr_b16 a[200:201], v81 offset:16384
    ds_read_b64_tr_b16 a[202:203], v81 offset:17408
    ds_read_b64_tr_b16 a[204:205], v81 offset:24576
    ds_read_b64_tr_b16 a[206:207], v81 offset:25600
    s_branch L_lw_29
L_lw_29_0:
    s_cmp_lg_u32 s44, 1
    s_cbranch_scc1 L_lw_29_1
    ds_read_b64_tr_b16 a[88:89], v80 offset:16384
    ds_read_b64_tr_b16 a[90:91], v80 offset:17408
    ds_read_b64_tr_b16 a[92:93], v80 offset:24576
    ds_read_b64_tr_b16 a[94:95], v80 offset:25600
    ds_read_b64_tr_b16 a[96:97], v81 offset:16384
    ds_read_b64_tr_b16 a[98:99], v81 offset:17408
    ds_read_b64_tr_b16 a[100:101], v81 offset:24576
    ds_read_b64_tr_b16 a[102:103], v81 offset:25600
    s_branch L_lw_29
L_lw_29_1:
    s_cmp_lg_u32 s44, 2
    s_cbranch_scc1 L_lw_29_2
    ds_read_b64_tr_b16 v[248:249], v80 offset:16384
    ds_read_b64_tr_b16 v[250:251], v80 offset:17408
    ds_read_b64_tr_b16 v[252:253], v80 offset:24576
    ds_read_b64_tr_b16 v[254:255], v80 offset:25600
    ds_read_b64_tr_b16 v[56:57], v81 offset:16384
    ds_read_b64_tr_b16 v[58:59], v81 offset:17408
    ds_read_b64_tr_b16 v[60:61], v81 offset:24576
    ds_read_b64_tr_b16 v[62:63], v81 offset:25600
    s_waitcnt lgkmcnt(0)
    ds_write_b128 v5, v[56:59] offset:22528
    ds_write_b128 v5, v[60:63] offset:23552
    s_branch L_lw_29
L_lw_29_2:
    ds_read_b64_tr_b16 v[144:145], v80 offset:16384
    ds_read_b64_tr_b16 v[146:147], v80 offset:17408
    ds_read_b64_tr_b16 v[148:149], v80 offset:24576
    ds_read_b64_tr_b16 v[150:151], v80 offset:25600
    ds_read_b64_tr_b16 v[152:153], v81 offset:16384
    ds_read_b64_tr_b16 v[154:155], v81 offset:17408
    ds_read_b64_tr_b16 v[156:157], v81 offset:24576
    ds_read_b64_tr_b16 v[158:159], v81 offset:25600
L_lw_29:
    s_waitcnt lgkmcnt(0)
    s_waitcnt vmcnt(8)
    s_barrier
    s_add_u32 s46, s47, 0x580000
    s_add_u32 m0, s48, 16384
    s_nop 0
    buffer_load_dwordx4 v82, s[28:31], s46 offen nt lds
    s_add_u32 s46, s47, 0x5a0000
    s_add_u32 m0, s48, 20480
    s_nop 0
    buffer_load_dwordx4 v82, s[28:31], s46 offen nt lds
    s_add_u32 s46, s47, 0x5c0000
    s_add_u32 m0, s48, 24576
    s_nop 0
    buffer_load_dwordx4 v82, s[28:31], s46 offen nt lds
    s_add_u32 s46, s47, 0x5e0000
    s_add_u32 m0, s48, 28672
    s_nop 0
    buffer_load_dwordx4 v82, s[28:31], s46 offen nt lds
    s_cmp_lg_u32 s44, 0
    s_cbranch_scc1 L_lw_30_0
    ds_read_b64_tr_b16 a[216:217], v80 offset:32768
    ds_read_b64_tr_b16 a[218:219], v80 offset:33792
    ds_read_b64_tr_b16 a[220:221], v80 offset:40960
    ds_read_b64_tr_b16 a[222:223], v80 offset:41984
    ds_read_b64_tr_b16 a[224:225], v81 offset:32768
    ds_read_b64_tr_b16 a[226:227], v81 offset:33792
    ds_read_b64_tr_b16 a[228:229], v81 offset:40960
    ds_read_b64_tr_b16 a[230:231], v81 offset:41984
    s_branch L_lw_30
L_lw_30_0:
    s_cmp_lg_u32 s44, 1
    s_cbranch_scc1 L_lw_30_1
    ds_read_b64_tr_b16 a[112:113], v80 offset:32768
    ds_read_b64_tr_b16 a[114:115], v80 offset:33792
    ds_read_b64_tr_b16 a[116:117], v80 offset:40960
    ds_read_b64_tr_b16 a[118:119], v80 offset:41984
    ds_read_b64_tr_b16 a[120:121], v81 offset:32768
    ds_read_b64_tr_b16 a[122:123], v81 offset:33792
    ds_read_b64_tr_b16 a[124:125], v81 offset:40960
    ds_read_b64_tr_b16 a[126:127], v81 offset:41984
    s_branch L_lw_30
L_lw_30_1:
    s_cmp_lg_u32 s44, 2
    s_cbranch_scc1 L_lw_30_2
    ds_read_b64_tr_b16 a[16:17], v80 offset:32768
    ds_read_b64_tr_b16 a[18:19], v80 offset:33792
    ds_read_b64_tr_b16 a[20:21], v80 offset:40960
    ds_read_b64_tr_b16 a[22:23], v80 offset:41984
    ds_read_b64_tr_b16 a[24:25], v81 offset:32768
    ds_read_b64_tr_b16 a[26:27], v81 offset:33792
    ds_read_b64_tr_b16 a[28:29], v81 offset:40960
    ds_read_b64_tr_b16 a[30:31], v81 offset:41984
    s_branch L_lw_30
L_lw_30_2:
    ds_read_b64_tr_b16 v[168:169], v80 offset:32768
    ds_read_b64_tr_b16 v[170:171], v80 offset:33792
    ds_read_b64_tr_b16 v[172:173], v80 offset:40960
    ds_read_b64_tr_b16 v[174:175], v80 offset:41984
    ds_read_b64_tr_b16 v[176:177], v81 offset:32768
    ds_read_b64_tr_b16 v[178:179], v81 offset:33792
    ds_read_b64_tr_b16 v[180:181], v81 offset:40960
    ds_read_b64_tr_b16 v[182:183], v81 offset:41984
L_lw_30:
    s_waitcnt lgkmcnt(0)
    s_waitcnt vmcnt(8)
    s_barrier
    s_add_u32 s46, s47, 0x600000
    s_add_u32 m0, s48, 32768
    s_nop 0
    buffer_load_dwordx4 v82, s[28:31], s46 offen nt lds
    s_add_u32 s46, s47, 0x620000
    s_add_u32 m0, s48, 36864
    s_nop 0
    buffer_load_dwordx4 v82, s[28:31], s46 offen nt lds
    s_add_u32 s46, s47, 0x640000
    s_add_u32 m0, s48, 40960
    s_nop 0
    buffer_load_dwordx4 v82, s[28:31], s46 offen nt lds
    s_add_u32 s46, s47, 0x660000
    s_add_u32 m0, s48, 45056
    s_nop 0
    buffer_load_dwordx4 v82, s[28:31], s46 offen nt lds
    s_cmp_lg_u32 s44, 0
    s_cbranch_scc1 L_lw_31_0
    ds_read_b64_tr_b16 a[248:249], v80 offset:49152
    ds_read_b64_tr_b16 a[250:251], v80 offset:50176
    ds_read_b64_tr_b16 a[252:253], v80 offset:57344
    ds_read_b64_tr_b16 a[254:255], v80 offset:58368
    ds_read_b64_tr_b16 v[96:97], v81 offset:49152
    ds_read_b64_tr_b16 v[98:99], v81 offset:50176
    ds_read_b64_tr_b16 v[100:101], v81 offset:57344
    ds_read_b64_tr_b16 v[102:103], v81 offset:58368
    s_branch L_lw_31
L_lw_31_0:
    s_cmp_lg_u32 s44, 1
    s_cbranch_scc1 L_lw_31_1
    ds_read_b64_tr_b16 a[136:137], v80 offset:49152
    ds_read_b64_tr_b16 a[138:139], v80 offset:50176
    ds_read_b64_tr_b16 a[140:141], v80 offset:57344
    ds_read_b64_tr_b16 a[142:143], v80 offset:58368
    ds_read_b64_tr_b16 a[144:145], v81 offset:49152
    ds_read_b64_tr_b16 a[146:147], v81 offset:50176
    ds_read_b64_tr_b16 a[148:149], v81 offset:57344
    ds_read_b64_tr_b16 a[150:151], v81 offset:58368
    s_branch L_lw_31
L_lw_31_1:
    s_cmp_lg_u32 s44, 2
    s_cbranch_scc1 L_lw_31_2
    ds_read_b64_tr_b16 a[48:49], v80 offset:49152
    ds_read_b64_tr_b16 a[50:51], v80 offset:50176
    ds_read_b64_tr_b16 a[52:53], v80 offset:57344
    ds_read_b64_tr_b16 a[54:55], v80 offset:58368
    ds_read_b64_tr_b16 a[56:57], v81 offset:49152
    ds_read_b64_tr_b16 a[58:59], v81 offset:50176
    ds_read_b64_tr_b16 a[60:61], v81 offset:57344
    ds_read_b64_tr_b16 a[62:63], v81 offset:58368
    s_branch L_lw_31
L_lw_31_2:
    ds_read_b64_tr_b16 v[200:201], v80 offset:49152
    ds_read_b64_tr_b16 v[202:203], v80 offset:50176
    ds_read_b64_tr_b16 v[204:205], v80 offset:57344
    ds_read_b64_tr_b16 v[206:207], v80 offset:58368
    ds_read_b64_tr_b16 v[56:57], v81 offset:49152
    ds_read_b64_tr_b16 v[58:59], v81 offset:50176
    ds_read_b64_tr_b16 v[60:61], v81 offset:57344
    ds_read_b64_tr_b16 v[62:63], v81 offset:58368
    s_waitcnt lgkmcnt(0)
    ds_write_b128 v5, v[56:59] offset:18432
    ds_write_b128 v5, v[60:63] offset:19456
L_lw_31:
    s_waitcnt lgkmcnt(0)
    s_waitcnt vmcnt(8)
    s_barrier
    s_add_u32 s46, s47, 0x680000
    s_add_u32 m0, s48, 49152
    s_nop 0
    buffer_load_dwordx4 v82, s[28:31], s46 offen nt lds
    s_add_u32 s46, s47, 0x6a0000
    s_add_u32 m0, s48, 53248
    s_nop 0
    buffer_load_dwordx4 v82, s[28:31], s46 offen nt lds
    s_add_u32 s46, s47, 0x6c0000
    s_add_u32 m0, s48, 57344
    s_nop 0
    buffer_load_dwordx4 v82, s[28:31], s46 offen nt lds
    s_add_u32 s46, s47, 0x6e0000
    s_add_u32 m0, s48, 61440
    s_nop 0
    buffer_load_dwordx4 v82, s[28:31], s46 offen nt lds
    s_cmp_lg_u32 s44, 0
    s_cbranch_scc1 L_lw_32_0
    ds_read_b64_tr_b16 v[112:113], v80 offset:0
    ds_read_b64_tr_b16 v[114:115], v80 offset:1024
    ds_read_b64_tr_b16 v[116:117], v80 offset:8192
    ds_read_b64_tr_b16 v[118:119], v80 offset:9216
    ds_read_b64_tr_b16 v[120:121], v81 offset:0
    ds_read_b64_tr_b16 v[122:123], v81 offset:1024
    ds_read_b64_tr_b16 v[124:125], v81 offset:8192
    ds_read_b64_tr_b16 v[126:127], v81 offset:9216
    s_branch L_lw_32
L_lw_32_0:
    s_cmp_lg_u32 s44, 1
    s_cbranch_scc1 L_lw_32_1
    ds_read_b64_tr_b16 a[160:161], v80 offset:0
    ds_read_b64_tr_b16 a[162:163], v80 offset:1024
    ds_read_b64_tr_b16 a[164:165], v80 offset:8192
    ds_read_b64_tr_b16 a[166:167], v80 offset:9216
    ds_read_b64_tr_b16 a[168:169], v81 offset:0
    ds_read_b64_tr_b16 a[170:171], v81 offset:1024
    ds_read_b64_tr_b16 a[172:173], v81 offset:8192
    ds_read_b64_tr_b16 a[174:175], v81 offset:9216
    s_branch L_lw_32
L_lw_32_1:
    s_cmp_lg_u32 s44, 2
    s_cbranch_scc1 L_lw_32_2
    ds_read_b64_tr_b16 a[72:73], v80 offset:0
    ds_read_b64_tr_b16 a[74:75], v80 offset:1024
    ds_read_b64_tr_b16 a[76:77], v80 offset:8192
    ds_read_b64_tr_b16 a[78:79], v80 offset:9216
    ds_read_b64_tr_b16 v[56:57], v81 offset:0
    ds_read_b64_tr_b16 v[58:59], v81 offset:1024
    ds_read_b64_tr_b16 v[60:61], v81 offset:8192
    ds_read_b64_tr_b16 v[62:63], v81 offset:9216
    s_waitcnt lgkmcnt(0)
    ds_write_b128 v5, v[56:59] offset:20480
    ds_write_b128 v5, v[60:63] offset:21504
    s_branch L_lw_32
L_lw_32_2:
    ds_read_b64_tr_b16 v[216:217], v80 offset:0
    ds_read_b64_tr_b16 v[218:219], v80 offset:1024
    ds_read_b64_tr_b16 v[220:221], v80 offset:8192
    ds_read_b64_tr_b16 v[222:223], v80 offset:9216
    ds_read_b64_tr_b16 v[224:225], v81 offset:0
    ds_read_b64_tr_b16 v[226:227], v81 offset:1024
    ds_read_b64_tr_b16 v[228:229], v81 offset:8192
    ds_read_b64_tr_b16 v[230:231], v81 offset:9216
L_lw_32:
    s_waitcnt lgkmcnt(0)
    s_waitcnt vmcnt(8)
    s_barrier
    s_add_u32 s46, s47, 0x700000
    s_add_u32 m0, s48, 0
    s_nop 0
    buffer_load_dwordx4 v82, s[28:31], s46 offen nt lds
    s_add_u32 s46, s47, 0x720000
    s_add_u32 m0, s48, 4096
    s_nop 0
    buffer_load_dwordx4 v82, s[28:31], s46 offen nt lds
    s_add_u32 s46, s47, 0x740000
    s_add_u32 m0, s48, 8192
    s_nop 0
    buffer_load_dwordx4 v82, s[28:31], s46 offen nt lds
    s_add_u32 s46, s47, 0x760000
    s_add_u32 m0, s48, 12288
    s_nop 0
    buffer_load_dwordx4 v82, s[28:31], s46 offen nt lds
    s_cmp_lg_u32 s44, 0
    s_cbranch_scc1 L_lw_33_0
    ds_read_b64_tr_b16 v[144:145], v80 offset:16384
    ds_read_b64_tr_b16 v[146:147], v80 offset:17408
    ds_read_b64_tr_b16 v[148:149], v80 offset:24576
    ds_read_b64_tr_b16 v[150:151], v80 offset:25600
    ds_read_b64_tr_b16 v[152:153], v81 offset:16384
    ds_read_b64_tr_b16 v[154:155], v81 offset:17408
    ds_read_b64_tr_b16 v[156:157], v81 offset:24576
    ds_read_b64_tr_b16 v[158:159], v81 offset:25600
    s_branch L_lw_33
L_lw_33_0:
    s_cmp_lg_u32 s44, 1
    s_cbranch_scc1 L_lw_33_1
    ds_read_b64_tr_b16 a[192:193], v80 offset:16384
    ds_read_b64_tr_b16 a[194:195], v80 offset:17408
    ds_read_b64_tr_b16 a[196:197], v80 offset:24576
    ds_read_b64_tr_b16 a[198:199], v80 offset:25600
    ds_read_b64_tr_b16 a[200:201], v81 offset:16384
    ds_read_b64_tr_b16 a[202:203], v81 offset:17408
    ds_read_b64_tr_b16 a[204:205], v81 offset:24576
    ds_read_b64_tr_b16 a[206:207], v81 offset:25600
    s_branch L_lw_33
L_lw_33_1:
    s_cmp_lg_u32 s44, 2
    s_cbranch_scc1 L_lw_33_2
    ds_read_b64_tr_b16 a[88:89], v80 offset:16384
    ds_read_b64_tr_b16 a[90:91], v80 offset:17408
    ds_read_b64_tr_b16 a[92:93], v80 offset:24576
    ds_read_b64_tr_b16 a[94:95], v80 offset:25600
    ds_read_b64_tr_b16 a[96:97], v81 offset:16384
    ds_read_b64_tr_b16 a[98:99], v81 offset:17408
    ds_read_b64_tr_b16 a[100:101], v81 offset:24576
    ds_read_b64_tr_b16 a[102:103], v81 offset:25600
    s_branch L_lw_33
L_lw_33_2:
    ds_read_b64_tr_b16 v[248:249], v80 offset:16384
    ds_read_b64_tr_b16 v[250:251], v80 offset:17408
    ds_read_b64_tr_b16 v[252:253], v80 offset:24576
    ds_read_b64_tr_b16 v[254:255], v80 offset:25600
    ds_read_b64_tr_b16 v[56:57], v81 offset:16384
    ds_read_b64_tr_b16 v[58:59], v81 offset:17408
    ds_read_b64_tr_b16 v[60:61], v81 offset:24576
    ds_read_b64_tr_b16 v[62:63], v81 offset:25600
    s_waitcnt lgkmcnt(0)
    ds_write_b128 v5, v[56:59] offset:22528
    ds_write_b128 v5, v[60:63] offset:23552
L_lw_33:
    s_waitcnt lgkmcnt(0)
    s_waitcnt vmcnt(8)
    s_barrier
    s_add_u32 s46, s47, 0x780000
    s_add_u32 m0, s48, 16384
    s_nop 0
    buffer_load_dwordx4 v82, s[28:31], s46 offen nt lds
    s_add_u32 s46, s47, 0x7a0000
    s_add_u32 m0, s48, 20480
    s_nop 0
    buffer_load_dwordx4 v82, s[28:31], s46 offen nt lds
    s_add_u32 s46, s47, 0x7c0000
    s_add_u32 m0, s48, 24576
    s_nop 0
    buffer_load_dwordx4 v82, s[28:31], s46 offen nt lds
    s_add_u32 s46, s47, 0x7e0000
    s_add_u32 m0, s48, 28672
    s_nop 0
    buffer_load_dwordx4 v82, s[28:31], s46 offen nt lds
    s_cmp_lg_u32 s44, 0
    s_cbranch_scc1 L_lw_34_0
    ds_read_b64_tr_b16 v[168:169], v80 offset:32768
    ds_read_b64_tr_b16 v[170:171], v80 offset:33792
    ds_read_b64_tr_b16 v[172:173], v80 offset:40960
    ds_read_b64_tr_b16 v[174:175], v80 offset:41984
    ds_read_b64_tr_b16 v[176:177], v81 offset:32768
    ds_read_b64_tr_b16 v[178:179], v81 offset:33792
    ds_read_b64_tr_b16 v[180:181], v81 offset:40960
    ds_read_b64_tr_b16 v[182:183], v81 offset:41984
    s_branch L_lw_34
L_lw_34_0:
    s_cmp_lg_u32 s44, 1
    s_cbranch_scc1 L_lw_34_1
    ds_read_b64_tr_b16 a[216:217], v80 offset:32768
    ds_read_b64_tr_b16 a[218:219], v80 offset:33792
    ds_read_b64_tr_b16 a[220:221], v80 offset:40960
    ds_read_b64_tr_b16 a[222:223], v80 offset:41984
    ds_read_b64_tr_b16 a[224:225], v81 offset:32768
    ds_read_b64_tr_b16 a[226:227], v81 offset:33792
    ds_read_b64_tr_b16 a[228:229], v81 offset:40960
    ds_read_b64_tr_b16 a[230:231], v81 offset:41984
    s_branch L_lw_34
L_lw_34_1:
    s_cmp_lg_u32 s44, 2
    s_cbranch_scc1 L_lw_34_2
    ds_read_b64_tr_b16 a[112:113], v80 offset:32768
    ds_read_b64_tr_b16 a[114:115], v80 offset:33792
    ds_read_b64_tr_b16 a[116:117], v80 offset:40960
    ds_read_b64_tr_b16 a[118:119], v80 offset:41984
    ds_read_b64_tr_b16 a[120:121], v81 offset:32768
    ds_read_b64_tr_b16 a[122:123], v81 offset:33792
    ds_read_b64_tr_b16 a[124:125], v81 offset:40960
    ds_read_b64_tr_b16 a[126:127], v81 offset:41984
    s_branch L_lw_34
L_lw_34_2:
    ds_read_b64_tr_b16 a[16:17], v80 offset:32768
    ds_read_b64_tr_b16 a[18:19], v80 offset:33792
    ds_read_b64_tr_b16 a[20:21], v80 offset:40960
    ds_read_b64_tr_b16 a[22:23], v80 offset:41984
    ds_read_b64_tr_b16 a[24:25], v81 offset:32768
    ds_read_b64_tr_b16 a[26:27], v81 offset:33792
    ds_read_b64_tr_b16 a[28:29], v81 offset:40960
    ds_read_b64_tr_b16 a[30:31], v81 offset:41984
L_lw_34:
    s_waitcnt lgkmcnt(0)
    s_waitcnt vmcnt(8)
    s_barrier
    s_cmp_lg_u32 s44, 0
    s_cbranch_scc1 L_lw_35_0
    ds_read_b64_tr_b16 v[200:201], v80 offset:49152
    ds_read_b64_tr_b16 v[202:203], v80 offset:50176
    ds_read_b64_tr_b16 v[204:205], v80 offset:57344
    ds_read_b64_tr_b16 v[206:207], v80 offset:58368
    ds_read_b64_tr_b16 v[56:57], v81 offset:49152
    ds_read_b64_tr_b16 v[58:59], v81 offset:50176
    ds_read_b64_tr_b16 v[60:61], v81 offset:57344
    ds_read_b64_tr_b16 v[62:63], v81 offset:58368
    s_waitcnt lgkmcnt(0)
    ds_write_b128 v5, v[56:59] offset:18432
    ds_write_b128 v5, v[60:63] offset:19456
    s_branch L_lw_35
L_lw_35_0:
    s_cmp_lg_u32 s44, 1
    s_cbranch_scc1 L_lw_35_1
    ds_read_b64_tr_b16 a[248:249], v80 offset:49152
    ds_read_b64_tr_b16 a[250:251], v80 offset:50176
    ds_read_b64_tr_b16 a[252:253], v80 offset:57344
    ds_read_b64_tr_b16 a[254:255], v80 offset:58368
    ds_read_b64_tr_b16 v[96:97], v81 offset:49152
    ds_read_b64_tr_b16 v[98:99], v81 offset:50176
    ds_read_b64_tr_b16 v[100:101], v81 offset:57344
    ds_read_b64_tr_b16 v[102:103], v81 offset:58368
    s_branch L_lw_35
L_lw_35_1:
    s_cmp_lg_u32 s44, 2
    s_cbranch_scc1 L_lw_35_2
    ds_read_b64_tr_b16 a[136:137], v80 offset:49152
    ds_read_b64_tr_b16 a[138:139], v80 offset:50176
    ds_read_b64_tr_b16 a[140:141], v80 offset:57344
    ds_read_b64_tr_b16 a[142:143], v80 offset:58368
    ds_read_b64_tr_b16 a[144:145], v81 offset:49152
    ds_read_b64_tr_b16 a[146:147], v81 offset:50176
    ds_read_b64_tr_b16 a[148:149], v81 offset:57344
    ds_read_b64_tr_b16 a[150:151], v81 offset:58368
    s_branch L_lw_35
L_lw_35_2:
    ds_read_b64_tr_b16 a[48:49], v80 offset:49152
    ds_read_b64_tr_b16 a[50:51], v80 offset:50176
    ds_read_b64_tr_b16 a[52:53], v80 offset:57344
    ds_read_b64_tr_b16 a[54:55], v80 offset:58368
    ds_read_b64_tr_b16 a[56:57], v81 offset:49152
    ds_read_b64_tr_b16 a[58:59], v81 offset:50176
    ds_read_b64_tr_b16 a[60:61], v81 offset:57344
    ds_read_b64_tr_b16 a[62:63], v81 offset:58368
L_lw_35:
    s_waitcnt lgkmcnt(0)
    s_waitcnt vmcnt(4)
    s_barrier
    s_cmp_lg_u32 s44, 0
    s_cbranch_scc1 L_lw_36_0
    ds_read_b64_tr_b16 v[216:217], v80 offset:0
    ds_read_b64_tr_b16 v[218:219], v80 offset:1024
    ds_read_b64_tr_b16 v[220:221], v80 offset:8192
    ds_read_b64_tr_b16 v[222:223], v80 offset:9216
    ds_read_b64_tr_b16 v[224:225], v81 offset:0
    ds_read_b64_tr_b16 v[226:227], v81 offset:1024
    ds_read_b64_tr_b16 v[228:229], v81 offset:8192
    ds_read_b64_tr_b16 v[230:231], v81 offset:9216
    s_branch L_lw_36
L_lw_36_0:
    s_cmp_lg_u32 s44, 1
    s_cbranch_scc1 L_lw_36_1
    ds_read_b64_tr_b16 v[112:113], v80 offset:0
    ds_read_b64_tr_b16 v[114:115], v80 offset:1024
    ds_read_b64_tr_b16 v[116:117], v80 offset:8192
    ds_read_b64_tr_b16 v[118:119], v80 offset:9216
    ds_read_b64_tr_b16 v[120:121], v81 offset:0
    ds_read_b64_tr_b16 v[122:123], v81 offset:1024
    ds_read_b64_tr_b16 v[124:125], v81 offset:8192
    ds_read_b64_tr_b16 v[126:127], v81 offset:9216
    s_branch L_lw_36
L_lw_36_1:
    s_cmp_lg_u32 s44, 2
    s_cbranch_scc1 L_lw_36_2
    ds_read_b64_tr_b16 a[160:161], v80 offset:0
    ds_read_b64_tr_b16 a[162:163], v80 offset:1024
    ds_read_b64_tr_b16 a[164:165], v80 offset:8192
    ds_read_b64_tr_b16 a[166:167], v80 offset:9216
    ds_read_b64_tr_b16 a[168:169], v81 offset:0
    ds_read_b64_tr_b16 a[170:171], v81 offset:1024
    ds_read_b64_tr_b16 a[172:173], v81 offset:8192
    ds_read_b64_tr_b16 a[174:175], v81 offset:9216
    s_branch L_lw_36
L_lw_36_2:
    ds_read_b64_tr_b16 a[72:73], v80 offset:0
    ds_read_b64_tr_b16 a[74:75], v80 offset:1024
    ds_read_b64_tr_b16 a[76:77], v80 offset:8192
    ds_read_b64_tr_b16 a[78:79], v80 offset:9216
    ds_read_b64_tr_b16 v[56:57], v81 offset:0
    ds_read_b64_tr_b16 v[58:59], v81 offset:1024
    ds_read_b64_tr_b16 v[60:61], v81 offset:8192
    ds_read_b64_tr_b16 v[62:63], v81 offset:9216
    s_waitcnt lgkmcnt(0)
    ds_write_b128 v5, v[56:59] offset:20480
    ds_write_b128 v5, v[60:63] offset:21504
L_lw_36:
    s_waitcnt lgkmcnt(0)
    s_waitcnt vmcnt(0)
    s_barrier
    s_cmp_lg_u32 s44, 0
    s_cbranch_scc1 L_lw_37_0
    ds_read_b64_tr_b16 v[248:249], v80 offset:16384
    ds_read_b64_tr_b16 v[250:251], v80 offset:17408
    ds_read_b64_tr_b16 v[252:253], v80 offset:24576
    ds_read_b64_tr_b16 v[254:255], v80 offset:25600
    ds_read_b64_tr_b16 v[56:57], v81 offset:16384
    ds_read_b64_tr_b16 v[58:59], v81 offset:17408
    ds_read_b64_tr_b16 v[60:61], v81 offset:24576
    ds_read_b64_tr_b16 v[62:63], v81 offset:25600
    s_waitcnt lgkmcnt(0)
    ds_write_b128 v5, v[56:59] offset:22528
    ds_write_b128 v5, v[60:63] offset:23552
    s_branch L_lw_37
L_lw_37_0:
    s_cmp_lg_u32 s44, 1
    s_cbranch_scc1 L_lw_37_1
    ds_read_b64_tr_b16 v[144:145], v80 offset:16384
    ds_read_b64_tr_b16 v[146:147], v80 offset:17408
    ds_read_b64_tr_b16 v[148:149], v80 offset:24576
    ds_read_b64_tr_b16 v[150:151], v80 offset:25600
    ds_read_b64_tr_b16 v[152:153], v81 offset:16384
    ds_read_b64_tr_b16 v[154:155], v81 offset:17408
    ds_read_b64_tr_b16 v[156:157], v81 offset:24576
    ds_read_b64_tr_b16 v[158:159], v81 offset:25600
    s_branch L_lw_37
L_lw_37_1:
    s_cmp_lg_u32 s44, 2
    s_cbranch_scc1 L_lw_37_2
    ds_read_b64_tr_b16 a[192:193], v80 offset:16384
    ds_read_b64_tr_b16 a[194:195], v80 offset:17408
    ds_read_b64_tr_b16 a[196:197], v80 offset:24576
    ds_read_b64_tr_b16 a[198:199], v80 offset:25600
    ds_read_b64_tr_b16 a[200:201], v81 offset:16384
    ds_read_b64_tr_b16 a[202:203], v81 offset:17408
    ds_read_b64_tr_b16 a[204:205], v81 offset:24576
    ds_read_b64_tr_b16 a[206:207], v81 offset:25600
    s_branch L_lw_37
L_lw_37_2:
    ds_read_b64_tr_b16 a[88:89], v80 offset:16384
    ds_read_b64_tr_b16 a[90:91], v80 offset:17408
    ds_read_b64_tr_b16 a[92:93], v80 offset:24576
    ds_read_b64_tr_b16 a[94:95], v80 offset:25600
    ds_read_b64_tr_b16 a[96:97], v81 offset:16384
    ds_read_b64_tr_b16 a[98:99], v81 offset:17408
    ds_read_b64_tr_b16 a[100:101], v81 offset:24576
    ds_read_b64_tr_b16 a[102:103], v81 offset:25600
L_lw_37:
    s_waitcnt lgkmcnt(0)
    s_barrier
    v_and_b32 v63, 15, v1
    v_lshrrev_b32 v64, 4, v1
    v_lshrrev_b32 v65, 5, v1
    v_lshlrev_b32 v65, 4, v65
    v_add_u32 v65, v65, v63
    v_lshlrev_b32 v65, 4, v65
    v_and_b32 v66, 1, v64
    v_lshlrev_b32 v66, 3, v66
    s_lshl_b32 s45, s44, 9
    s_add_u32 s45, s45, 53248
    v_add3_u32 v6, v65, v66, s45
    v_bfe_u32 v65, v1, 2, 2
    v_lshlrev_b32 v66, 3, v64
    v_add_u32 v65, v65, v66
    v_lshlrev_b32 v65, 4, v65
    v_and_b32 v66, 1, v1
    v_lshlrev_b32 v66, 3, v66
    v_add_u32 v65, v65, v66
    v_add_u32 v7, 53248, v65
    v_bfe_u32 v65, v1, 2, 1
    v_lshlrev_b32 v65, 4, v65
    v_bfe_u32 v66, v1, 3, 1
    v_lshlrev_b32 v66, 2, v66
    v_and_b32 v67, 3, v1
    v_add3_u32 v65, v65, v66, v67
    v_lshlrev_b32 v65, 5, v65
    v_lshlrev_b32 v66, 3, v64
    s_lshl_b32 s45, s44, 10
    s_add_u32 s45, s45, 55296
    v_add3_u32 v18, v65, v66, s45
    v_lshlrev_b32 v16, 3, v1
    v_lshrrev_b32 v65, 2, v63
    v_mul_u32_u24 v65, 1088, v65
    v_and_b32 v66, 3, v63
    v_xor_b32 v67, v66, v64
    v_lshlrev_b32 v66, 8, v66
    v_lshlrev_b32 v67, 4, v67
    v_add3_u32 v8, v65, v66, v67
    v_mul_u32_u24 v65, 1056, v64
    v_bfe_u32 v66, v1, 2, 2
    v_xor_b32 v67, s44, v66
    v_lshlrev_b32 v66, 8, v66
    v_lshlrev_b32 v67, 6, v67
    v_add3_u32 v65, v65, v66, v67
    v_and_b32 v66, 3, v1
    v_lshlrev_b32 v66, 3, v66
    v_add_u32 v9, v65, v66
    s_lshl_b32 s45, s44, 2
    v_add_u32 v65, s45, v64
    v_lshlrev_b32 v66, 8, v65
    v_xor_b32 v67, v63, v64
    v_lshlrev_b32 v67, 4, v67
    v_add_u32 v14, v66, v67
    v_lshlrev_b32 v67, 2, v64
    v_xor_b32 v67, v63, v67
    v_lshlrev_b32 v67, 4, v67
    v_add_u32 v15, v66, v67
    s_lshl_b32 s45, s43, 11
    s_lshl_b32 s46, s44, 9
    s_add_u32 s45, s45, s46
    s_add_u32 s51, s45, 0x7020000
    s_lshl_b32 s63, s43, 19
    s_add_u32 s63, s63, 0x3000000
    s_mov_b32 s50, 0
    s_mul_i32 s64, s44, 1088
    s_add_u32 s64, s64, 16384
    s_mul_i32 s65, s44, 1056
    s_add_u32 s65, s65, 25088
    s_lshl_b32 s66, s43, 12
    s_add_u32 s66, s66, 0x1000000
    s_mov_b32 s69, 17408
    s_mov_b32 s52, 0x3e0293ee
    v_and_b32 v19, 3, v1
    v_lshlrev_b32 v19, 10, v19
    s_lshl_b32 s45, s44, 12
    s_add_u32 s45, s45, 1020
    v_add_u32 v19, s45, v19
    v_mov_b32 v29, 64
    s_mov_b32 s46, 192
    s_mov_b64 exec, 1
    s_mov_b32 s70, 0
L_wp_38:
    buffer_load_dword v31, v29, s[16:19], 0 offen sc1
    s_add_u32 s70, s70, 1
    s_cmp_ge_u32 s70, 0x200000
    s_cbranch_scc1 L_c_done_1
    s_waitcnt vmcnt(0)
    v_cmp_gt_u32 vcc, s46, v31
    s_nop 1
    s_cbranch_vccz L_wp_38_ok
    s_sleep 2
    s_branch L_wp_38
L_wp_38_ok:
    s_mov_b64 exec, -1
    s_mov_b32 s47, 0
    s_cmp_lt_u32 s47, s50
    s_cbranch_scc1 L_kv_rdy_39
    s_lshl_b32 s45, s43, 7
    s_add_u32 s45, s45, 0x10014
    v_mov_b32 v0, 0
    s_mov_b32 s70, 0
L_kv_rdy_39_p:
    buffer_load_dwordx2 v[10:11], v0, s[12:15], s45 offen sc1
    s_add_u32 s70, s70, 1
    s_cmp_ge_u32 s70, 0x200000
    s_cbranch_scc1 L_c_done_1
    s_waitcnt vmcnt(0)
    v_min_u32 v10, v10, v11
    s_nop 0
    v_readfirstlane_b32 s50, v10
    s_nop 3
    s_cmp_lt_u32 s47, s50
    s_cbranch_scc1 L_kv_rdy_39
    s_sleep 2
    s_branch L_kv_rdy_39_p
L_kv_rdy_39:
    s_mov_b32 m0, s64
    s_add_u32 s45, s63, 4096
    buffer_load_dwordx4 v14, s[12:15], s63 offen sc1 lds
    s_add_u32 m0, s64, 4352
    s_add_u32 s46, s63, 0x1000000
    buffer_load_dwordx4 v14, s[12:15], s45 offen sc1 lds
    s_mov_b32 m0, s65
    s_add_u32 s45, s45, 0x1000000
    buffer_load_dwordx4 v15, s[12:15], s46 offen sc1 lds
    s_add_u32 m0, s65, 4224
    s_add_u32 s63, s63, 8192
    buffer_load_dwordx4 v15, s[12:15], s45 offen sc1 lds
    s_add_u32 s64, s64, 17408
    s_add_u32 s65, s65, 17408
    s_mov_b32 s70, 0
    v_mov_b32 v41, 0
L_hw_40:
    s_sleep 2
    buffer_load_dword v44, v41, s[16:19], 0 offen sc1
    s_add_u32 s70, s70, 1
    s_cmp_ge_u32 s70, 0x100000
    s_cbranch_scc1 L_c_done_1
    s_waitcnt vmcnt(0)
    v_readfirstlane_b32 s45, v44
    s_cmp_lg_u32 s45, 64
    s_cbranch_scc1 L_hw_40
    buffer_load_dwordx4 v[44:47], v41, s[16:19], 0 offen sc1
    s_waitcnt vmcnt(0)
    v_readfirstlane_b32 s45, v45
    v_readfirstlane_b32 s46, v46
    v_readfirstlane_b32 s68, v47
    s_bcnt1_i32_b32 s45, s45
    s_bcnt1_i32_b32 s46, s46
    s_add_u32 s45, s45, s46
    s_cmp_eq_u32 s45, 2
    s_cselect_b32 s67, 1, 0
    s_cmp_ge_u32 s68, 16
    s_cselect_b32 s68, 8192, 0
    s_mov_b32 s60, 0
    s_lshl_b32 s58, s40, 16
    s_add_u32 s58, s58, 0x7000000
    s_mov_b32 s61, s58
    s_lshl_b32 s59, s40, 17
    s_add_u32 s59, s59, 0x7040000
    s_mov_b32 s62, s59
L_q_loop_41:
    ds_read_b128 v[56:59], v5 offset:8192
    ds_read_b128 v[60:63], v5 offset:9216
    ds_read_b128 v[64:67], v5 offset:20480
    ds_read_b128 v[68:71], v5 offset:21504
    ds_read_b128 v[72:75], v5 offset:16384
    ds_read_b128 v[76:79], v5 offset:17408
    ds_read_b128 v[80:83], v5 offset:4096
    ds_read_b128 v[84:87], v5 offset:5120
    ds_read_b128 v[88:91], v5 offset:6144
    ds_read_b128 v[92:95], v5 offset:7168
    s_cmp_eq_u32 s60, 0
    s_cbranch_scc1 L_q_first_42
    s_sleep 24
    s_mov_b64 exec, 15
    buffer_load_dword v10, v19, s[12:15], s61 offen sc1
    s_nop 15
    buffer_load_dword v11, v19, s[12:15], s61 offen sc1
    s_nop 15
    buffer_load_dword v12, v19, s[12:15], s61 offen sc1
    s_nop 15
    buffer_load_dword v13, v19, s[12:15], s61 offen sc1
    s_mov_b32 s70, 0
L_pp_43:
    s_waitcnt vmcnt(3)
    v_cmp_eq_u32 vcc, -1, v10
    s_add_u32 s70, s70, 1
    s_nop 0
    s_cbranch_vccz L_ppd_44
    buffer_load_dword v10, v19, s[12:15], s61 offen sc1
    s_waitcnt vmcnt(3)
    v_cmp_eq_u32 vcc, -1, v11
    s_add_u32 s70, s70, 1
    s_nop 0
    s_cbranch_vccz L_ppd_44
    buffer_load_dword v11, v19, s[12:15], s61 offen sc1
    s_waitcnt vmcnt(3)
    v_cmp_eq_u32 vcc, -1, v12
    s_add_u32 s70, s70, 1
    s_nop 0
    s_cbranch_vccz L_ppd_44
    buffer_load_dword v12, v19, s[12:15], s61 offen sc1
    s_waitcnt vmcnt(3)
    v_cmp_eq_u32 vcc, -1, v13
    s_add_u32 s70, s70, 1
    s_nop 0
    s_cbranch_vccz L_ppd_44
    buffer_load_dword v13, v19, s[12:15], s61 offen sc1
    s_cmp_lt_u32 s70, 0x400000
    s_cbranch_scc1 L_pp_43
    s_branch L_c_done_1
L_ppd_44:
    s_mov_b64 exec, -1
L_q_first_42:
    s_waitcnt lgkmcnt(0)
    s_mov_b32 s70, 0
L_mg_45:
    buffer_load_dwordx4 v[40:43], v3, s[12:15], s61 offen offset:0 sc1
    s_nop 9
    buffer_load_dwordx4 v[44:47], v3, s[12:15], s61 offen offset:1024 sc1
    s_nop 9
    buffer_load_dwordx4 v[48:51], v3, s[12:15], s61 offen offset:2048 sc1
    s_nop 9
    buffer_load_dwordx4 v[52:55], v3, s[12:15], s61 offen offset:3072 sc1
    s_add_u32 s70, s70, 1
    s_cmp_ge_u32 s70, 0x100000
    s_cbranch_scc1 L_c_done_1
    s_nop 1
    v_mov_b32 v24, 0
    v_mov_b32 v25, 0
    v_mov_b32 v26, 0
    v_mov_b32 v27, 0
    v_mov_b32 v28, 0
    v_mov_b32 v29, 0
    v_mov_b32 v30, 0
    v_mov_b32 v31, 0
    v_mov_b32 v32, 0
    v_mov_b32 v33, 0
    v_mov_b32 v34, 0
    v_mov_b32 v35, 0
    v_mov_b32 v36, 0
    v_mov_b32 v37, 0
    v_mov_b32 v38, 0
    v_mov_b32 v39, 0
    s_waitcnt vmcnt(3)
    ds_write_b128 v3, v[40:43] offset:0
    v_smfmac_f32_16x16x64_bf16 v[24:27], v[40:43], a[0:7], v2
    v_max3_u32 v22, v40, v41, v42
    v_smfmac_f32_16x16x64_bf16 v[28:31], v[40:43], a[8:15], v2
    v_max_u32 v22, v22, v43
    v_smfmac_f32_16x16x64_bf16 v[32:35], v[40:43], a[16:23], v2
    v_smfmac_f32_16x16x64_bf16 v[36:39], v[40:43], a[24:31], v2
    s_waitcnt vmcnt(2)
    ds_write_b128 v3, v[44:47] offset:1024
    v_smfmac_f32_16x16x64_bf16 v[24:27], v[44:47], a[32:39], v2
    v_max3_u32 v22, v22, v44, v45
    v_smfmac_f32_16x16x64_bf16 v[28:31], v[44:47], a[40:47], v2
    v_max3_u32 v22, v22, v46, v47
    v_smfmac_f32_16x16x64_bf16 v[32:35], v[44:47], a[48:55], v2
    v_smfmac_f32_16x16x64_bf16 v[36:39], v[44:47], a[56:63], v2
    s_waitcnt vmcnt(1)
    ds_write_b128 v3, v[48:51] offset:2048
    s_waitcnt vmcnt(0)
    ds_write_b128 v3, v[52:55] offset:3072
    v_max3_u32 v22, v22, v48, v49
    v_max3_u32 v22, v22, v50, v51
    v_max3_u32 v22, v22, v52, v53
    v_max3_u32 v22, v22, v54, v55
    v_cmp_eq_u32 vcc, -1, v22
    s_waitcnt lgkmcnt(0)
    s_nop 0
    s_cbranch_vccnz L_mg_45
    s_barrier
    ds_read_b128 v[40:43], v4 offset:0
    ds_read_b128 v[44:47], v4 offset:1024
    v_smfmac_f32_16x16x64_bf16 v[24:27], v[48:51], a[64:71], v2
    v_smfmac_f32_16x16x64_bf16 v[28:31], v[48:51], v[56:63], v2
    ds_read_b128 v[56:59], v5 offset:14336
    v_smfmac_f32_16x16x64_bf16 v[32:35], v[48:51], a[72:79], v2
    ds_read_b128 v[60:63], v5 offset:15360
    v_smfmac_f32_16x16x64_bf16 v[36:39], v[48:51], v[64:71], v2
    ds_read_b128 v[48:51], v4 offset:2048
    ds_read_b128 v[64:67], v5 offset:2048
    v_smfmac_f32_16x16x64_bf16 v[24:27], v[52:55], a[80:87], v2
    ds_read_b128 v[68:71], v5 offset:3072
    v_smfmac_f32_16x16x64_bf16 v[28:31], v[52:55], v[72:79], v2
    ds_read_b128 v[72:75], v5 offset:12288
    v_smfmac_f32_16x16x64_bf16 v[32:35], v[52:55], a[88:95], v2
    ds_read_b128 v[76:79], v5 offset:13312
    v_smfmac_f32_16x16x64_bf16 v[36:39], v[52:55], a[96:103], v2
    ds_read_b128 v[52:55], v4 offset:3072
    s_waitcnt lgkmcnt(4)
    v_smfmac_f32_16x16x64_bf16 v[24:27], v[40:43], a[104:111], v2
    v_smfmac_f32_16x16x64_bf16 v[28:31], v[40:43], v[80:87], v2
    ds_read_b128 v[80:83], v5 offset:0
    v_smfmac_f32_16x16x64_bf16 v[32:35], v[40:43], a[112:119], v2
    ds_read_b128 v[84:87], v5 offset:1024
    v_smfmac_f32_16x16x64_bf16 v[36:39], v[40:43], a[120:127], v2
    ds_read_b128 v[40:43], v21 offset:0
    v_smfmac_f32_16x16x64_bf16 v[24:27], v[44:47], a[128:135], v2
    v_smfmac_f32_16x16x64_bf16 v[28:31], v[44:47], v[88:95], v2
    ds_read_b128 v[88:91], v5 offset:10240
    v_smfmac_f32_16x16x64_bf16 v[32:35], v[44:47], a[136:143], v2
    ds_read_b128 v[92:95], v5 offset:11264
    v_smfmac_f32_16x16x64_bf16 v[36:39], v[44:47], a[144:151], v2
    ds_read_b128 v[44:47], v21 offset:1024
    v_smfmac_f32_16x16x64_bf16 v[24:27], v[48:51], a[152:159], v2
    v_smfmac_f32_16x16x64_bf16 v[28:31], v[48:51], v[56:63], v2
    ds_read_b128 v[48:51], v21 offset:2048
    ds_read_b128 v[56:59], v5 offset:22528
    s_waitcnt lgkmcnt(4)
    v_smfmac_f32_16x16x64_bf16 v[24:27], v[52:55], a[176:183], v2
    ds_read_b128 v[60:63], v5 offset:23552
    v_smfmac_f32_16x16x64_bf16 v[28:31], v[52:55], a[184:191], v2
    ds_read_b128 v[52:55], v21 offset:3072
    v_smfmac_f32_16x16x64_bf16 v[24:27], v[40:43], a[208:215], v2
    v_smfmac_f32_16x16x64_bf16 v[28:31], v[40:43], v[64:71], v2
    ds_read_b128 v[40:43], v23 offset:0
    ds_read_b128 v[64:67], v5 offset:18432
    s_waitcnt lgkmcnt(4)
    v_smfmac_f32_16x16x64_bf16 v[24:27], v[44:47], a[232:239], v2
    ds_read_b128 v[68:71], v5 offset:19456
    v_smfmac_f32_16x16x64_bf16 v[28:31], v[44:47], a[240:247], v2
    ds_read_b128 v[44:47], v23 offset:1024
    v_smfmac_f32_16x16x64_bf16 v[24:27], v[48:51], v[104:111], v2
    v_smfmac_f32_16x16x64_bf16 v[28:31], v[48:51], v[72:79], v2
    ds_read_b128 v[48:51], v23 offset:2048
    s_waitcnt lgkmcnt(3)
    v_smfmac_f32_16x16x64_bf16 v[24:27], v[52:55], v[128:135], v2
    v_smfmac_f32_16x16x64_bf16 v[28:31], v[52:55], v[136:143], v2
    ds_read_b128 v[52:55], v23 offset:3072
    v_smfmac_f32_16x16x64_bf16 v[24:27], v[40:43], v[160:167], v2
    v_smfmac_f32_16x16x64_bf16 v[28:31], v[40:43], v[80:87], v2
    s_waitcnt lgkmcnt(1)
    v_smfmac_f32_16x16x64_bf16 v[24:27], v[44:47], v[184:191], v2
    v_smfmac_f32_16x16x64_bf16 v[28:31], v[44:47], v[192:199], v2
    v_smfmac_f32_16x16x64_bf16 v[24:27], v[48:51], v[208:215], v2
    v_smfmac_f32_16x16x64_bf16 v[28:31], v[48:51], v[88:95], v2
    s_waitcnt lgkmcnt(0)
    v_smfmac_f32_16x16x64_bf16 v[24:27], v[52:55], v[232:239], v2
    v_smfmac_f32_16x16x64_bf16 v[28:31], v[52:55], v[240:247], v2
    v_smfmac_f32_16x16x64_bf16 v[32:35], v[52:55], v[248:255], v2
    ds_read_b128 v[72:75], v8 offset:16512
    v_smfmac_f32_16x16x64_bf16 v[36:39], v[52:55], v[56:63], v2
    ds_read_b128 v[52:55], v21 offset:3072
    v_smfmac_f32_16x16x64_bf16 v[32:35], v[48:51], v[216:223], v2
    ds_read_b128 v[76:79], v8 offset:20864
    s_nop 1
    v_permlane32_swap_b32 v24, v28
    v_smfmac_f32_16x16x64_bf16 v[36:39], v[48:51], v[224:231], v2
    ds_read_b128 v[48:51], v21 offset:2048
    v_permlane32_swap_b32 v25, v29
    v_smfmac_f32_16x16x64_bf16 v[32:35], v[44:47], v[200:207], v2
    v_permlane32_swap_b32 v26, v30
    v_permlane32_swap_b32 v27, v31
    v_smfmac_f32_16x16x64_bf16 v[36:39], v[44:47], v[64:71], v2
    ds_read_b128 v[44:47], v21 offset:1024
    v_pk_add_f32 v[24:25], v[24:25], v[28:29]
    v_smfmac_f32_16x16x64_bf16 v[32:35], v[40:43], v[168:175], v2
    v_pk_add_f32 v[26:27], v[26:27], v[30:31]
    v_cvt_pk_bf16_f32 v24, v24, v25
    v_smfmac_f32_16x16x64_bf16 v[36:39], v[40:43], v[176:183], v2
    ds_read_b128 v[40:43], v21 offset:0
    v_cvt_pk_bf16_f32 v25, v26, v27
    s_waitcnt lgkmcnt(2)
    v_smfmac_f32_16x16x64_bf16 v[32:35], v[52:55], v[144:151], v2
    ds_write_b64 v6, v[24:25]
    ds_read_b128 v[56:59], v8 offset:16384
    v_smfmac_f32_16x16x64_bf16 v[36:39], v[52:55], v[152:159], v2
    ds_read_b128 v[52:55], v4 offset:3072
    ds_read_b128 v[60:63], v8 offset:20736
    v_smfmac_f32_16x16x64_bf16 v[32:35], v[48:51], v[112:119], v2
    ds_read_b128 v[64:67], v8 offset:16448
    v_smfmac_f32_16x16x64_bf16 v[36:39], v[48:51], v[120:127], v2
    ds_read_b128 v[48:51], v4 offset:2048
    s_waitcnt lgkmcnt(6)
    v_smfmac_f32_16x16x64_bf16 v[32:35], v[44:47], a[248:255], v2
    ds_read_b128 v[68:71], v8 offset:20800
    s_waitcnt lgkmcnt(5)
    s_barrier
    v_smfmac_f32_16x16x64_bf16 v[36:39], v[44:47], v[96:103], v2
    ds_read_b64_tr_b16 v[80:81], v7 offset:0
    ds_read_b64_tr_b16 v[82:83], v7 offset:64
    v_smfmac_f32_16x16x64_bf16 v[32:35], v[40:43], a[216:223], v2
    ds_read_b64_tr_b16 v[84:85], v7 offset:512
    ds_read_b64_tr_b16 v[86:87], v7 offset:576
    v_smfmac_f32_16x16x64_bf16 v[36:39], v[40:43], a[224:231], v2
    ds_read_b64_tr_b16 v[88:89], v7 offset:1024
    ds_read_b64_tr_b16 v[90:91], v7 offset:1088
    s_waitcnt lgkmcnt(7)
    v_smfmac_f32_16x16x64_bf16 v[32:35], v[52:55], a[192:199], v2
    ds_read_b64_tr_b16 v[92:93], v7 offset:1536
    v_smfmac_f32_16x16x64_bf16 v[36:39], v[52:55], a[200:207], v2
    ds_read_b64_tr_b16 v[94:95], v7 offset:1600
    v_smfmac_f32_16x16x64_bf16 v[32:35], v[48:51], a[160:167], v2
    v_smfmac_f32_16x16x64_bf16 v[36:39], v[48:51], a[168:175], v2
    s_waitcnt lgkmcnt(2)
    v_mfma_f32_16x16x32_bf16 v[24:27], v[56:59], v[80:83], 0
    ds_read_b128 v[56:59], v8 offset:16576
    v_mfma_f32_16x16x32_bf16 v[28:31], v[60:63], v[80:83], 0
    ds_read_b128 v[60:63], v8 offset:20928
    v_mfma_f32_16x16x32_bf16 v[24:27], v[64:67], v[84:87], v[24:27]
    s_nop 1
    v_cvt_pk_bf16_f32 v32, v32, v33
    v_cvt_pk_bf16_f32 v33, v34, v35
    v_cvt_pk_bf16_f32 v34, v36, v37
    v_cvt_pk_bf16_f32 v35, v38, v39
    ds_write2_b64 v18, v[32:33], v[34:35] offset1:32
    v_mfma_f32_16x16x32_bf16 v[28:31], v[68:71], v[84:87], v[28:31]
    v_mfma_f32_16x16x32_bf16 v[24:27], v[72:75], v[88:91], v[24:27]
    ds_read_b64_tr_b16 v[64:65], v9 offset:25088
    v_mfma_f32_16x16x32_bf16 v[28:31], v[76:79], v[88:91], v[28:31]
    ds_read_b64_tr_b16 v[66:67], v9 offset:29312
    s_waitcnt lgkmcnt(3)
    v_mfma_f32_16x16x32_bf16 v[24:27], v[56:59], v[92:95], v[24:27]
    ds_read_b64_tr_b16 v[68:69], v9 offset:25120
    v_mfma_f32_16x16x32_bf16 v[28:31], v[60:63], v[92:95], v[28:31]
    ds_read_b64_tr_b16 v[70:71], v9 offset:29344
    s_waitcnt lgkmcnt(4)
    s_barrier
    ds_read_b64_tr_b16 v[40:41], v16 offset:55296
    ds_read_b64_tr_b16 v[42:43], v16 offset:55808
    ds_read_b64_tr_b16 v[44:45], v16 offset:56320
    ds_read_b64_tr_b16 v[46:47], v16 offset:56832
    ds_read_b64_tr_b16 v[48:49], v16 offset:57344
    ds_read_b64_tr_b16 v[50:51], v16 offset:57856
    ds_read_b64_tr_b16 v[52:53], v16 offset:58368
    ds_read_b64_tr_b16 v[54:55], v16 offset:58880
    s_cmp_eq_u32 s60, 63
    s_cbranch_scc1 L_q_last_46
    v_max3_f32 v11, v24, v25, v26
    s_waitcnt lgkmcnt(6)
    v_mfma_f32_16x16x32_bf16 v[36:39], v[40:43], v[80:83], 0
    v_max3_f32 v13, v27, v28, v29
    v_max3_f32 v11, v11, v30, v31
    s_waitcnt lgkmcnt(4)
    v_mfma_f32_16x16x32_bf16 v[36:39], v[44:47], v[84:87], v[36:39]
    v_max_f32 v11, v11, v13
    v_mul_f32 v10, s52, v11
    s_waitcnt lgkmcnt(2)
    v_mfma_f32_16x16x32_bf16 v[36:39], v[48:51], v[88:91], v[36:39]
    v_pk_fma_f32 v[24:25], v[24:25], s[52:53], v[10:11] op_sel_hi:[1,0,0] neg_lo:[0,0,1] neg_hi:[0,0,1]
    v_pk_fma_f32 v[26:27], v[26:27], s[52:53], v[10:11] op_sel_hi:[1,0,0] neg_lo:[0,0,1] neg_hi:[0,0,1]
    s_waitcnt lgkmcnt(0)
    v_mfma_f32_16x16x32_bf16 v[36:39], v[52:55], v[92:95], v[36:39]
    v_pk_fma_f32 v[28:29], v[28:29], s[52:53], v[10:11] op_sel_hi:[1,0,0] neg_lo:[0,0,1] neg_hi:[0,0,1]
    v_pk_fma_f32 v[30:31], v[30:31], s[52:53], v[10:11] op_sel_hi:[1,0,0] neg_lo:[0,0,1] neg_hi:[0,0,1]
    buffer_load_dwordx2 v[0:1], v16, s[12:15], s51 offen sc1
    s_add_u32 s46, s60, 1
    v_mov_b32 v74, s46
    v_mov_b32 v57, 0
    v_mov_b32 v58, 0
    v_exp_f32 v24, v24
    v_exp_f32 v25, v25
    v_permlane32_swap_b32 v36, v38
    v_permlane32_swap_b32 v37, v39
    v_pk_add_f32 v[36:37], v[36:37], v[38:39]
    v_max3_f32 v12, v36, v37, v11
    v_max3_f32 v13, v36, v37, v11
    v_exp_f32 v26, v26
    v_exp_f32 v27, v27
    v_permlane32_swap_b32 v12, v13
    v_max_f32 v22, v12, v13
    v_max_f32 v13, v12, v13
    v_exp_f32 v28, v28
    v_exp_f32 v29, v29
    v_permlane16_swap_b32 v22, v13
    v_max_f32 v12, v22, v13
    v_mul_f32 v12, s52, v12
    v_sub_f32 v10, v10, v12
    v_pk_fma_f32 v[36:37], v[36:37], s[52:53], v[12:13] op_sel_hi:[1,0,0] neg_lo:[0,0,1] neg_hi:[0,0,1]
    v_exp_f32 v10, v10
    v_exp_f32 v30, v30
    v_exp_f32 v31, v31
    v_exp_f32 v36, v36
    v_exp_f32 v37, v37
    v_pk_mul_f32 v[24:25], v[24:25], v[10:11] op_sel_hi:[1,0]
    v_pk_mul_f32 v[26:27], v[26:27], v[10:11] op_sel_hi:[1,0]
    v_pk_mul_f32 v[28:29], v[28:29], v[10:11] op_sel_hi:[1,0]
    v_pk_mul_f32 v[30:31], v[30:31], v[10:11] op_sel_hi:[1,0]
    v_cvt_pk_bf16_f32 v60, v24, v25
    v_cvt_pk_bf16_f32 v61, v26, v27
    v_cvt_pk_bf16_f32 v62, v28, v29
    v_cvt_pk_bf16_f32 v63, v30, v31
    v_cvt_pk_bf16_f32 v56, v36, v37
    v_cvt_pk_bf16_f32 v59, v36, v37
    s_mov_b64 exec, 15
    s_cmp_eq_u32 s67, 1
    s_cbranch_scc0 L_ls_47_s
    buffer_store_dword v74, v20, s[12:15], 0 offen
L_ls_47_d:
    s_mov_b64 exec, -1
    v_mfma_f32_16x16x32_bf16 v[72:75], v[64:67], v[60:63], 0
    v_pk_add_f32 v[24:25], v[24:25], v[26:27]
    v_pk_add_f32 v[28:29], v[28:29], v[30:31]
    v_mfma_f32_16x16x32_bf16 v[76:79], v[68:71], v[60:63], 0
    v_pk_add_f32 v[24:25], v[24:25], v[36:37]
    s_waitcnt vmcnt(1)
L_q_vm_48:
    v_max_u32 v22, v0, v1
    v_cmp_eq_u32 vcc, -1, v22
    v_pk_add_f32 v[10:11], v[24:25], v[28:29]
    v_add_f32 v12, v10, v11
    s_cbranch_vccnz L_q_vm_48_r
    v_add_f32 v13, v10, v11
    v_mfma_f32_16x16x16_bf16 v[72:75], v[0:1], v[56:57], v[72:75]
    v_mfma_f32_16x16x16_bf16 v[76:79], v[0:1], v[58:59], v[76:79]
    v_permlane32_swap_b32 v12, v13
    v_add_f32 v22, v12, v13
    v_add_f32 v13, v12, v13
    s_nop 1
    v_permlane16_swap_b32 v22, v13
    v_add_f32 v12, v22, v13
    v_rcp_f32 v12, v12
    s_mov_b64 exec, s[56:57]
    v_pk_mul_f32 v[72:73], v[72:73], v[12:13] op_sel_hi:[1,0]
    v_pk_mul_f32 v[74:75], v[74:75], v[12:13] op_sel_hi:[1,0]
    v_pk_mul_f32 v[76:77], v[76:77], v[12:13] op_sel_hi:[1,0]
    v_pk_mul_f32 v[78:79], v[78:79], v[12:13] op_sel_hi:[1,0]
    v_cvt_pk_bf16_f32 v72, v72, v73
    v_cvt_pk_bf16_f32 v73, v74, v75
    v_cvt_pk_bf16_f32 v74, v76, v77
    v_cvt_pk_bf16_f32 v75, v78, v79
    v_min_u32 v72, -2, v72
    v_min_u32 v73, -2, v73
    v_min_u32 v74, -2, v74
    v_min_u32 v75, -2, v75
    s_cmp_eq_u32 s67, 1
    s_cbranch_scc0 L_ls_49_s
    buffer_store_dwordx4 v[72:75], v17, s[12:15], s62 offen
L_ls_49_d:
    v_mov_b32 v60, -1
    v_mov_b32 v61, -1
    v_mov_b32 v62, -1
    v_mov_b32 v63, -1
    s_add_u32 s45, s60, 3
    s_and_b32 s45, s45, 3
    s_lshl_b32 s45, s45, 15
    s_add_u32 s45, s45, s59
    s_cmp_eq_u32 s67, 1
    s_cbranch_scc0 L_ls_50_s
    buffer_store_dwordx4 v[60:63], v17, s[12:15], s45 offen
L_ls_50_d:
    s_mov_b64 exec, -1
L_q_last_46:
    s_waitcnt lgkmcnt(0)
    v_lshlrev_b32 v22, 1, v16
    s_cmp_lg_u32 s44, 0
    s_cbranch_scc1 L_q_km_51_0
    buffer_store_dwordx4 v[40:43], v22, s[12:15], s66 offen offset:0 sc1
L_q_km_51_0:
    s_cmp_lg_u32 s44, 1
    s_cbranch_scc1 L_q_km_51_1
    buffer_store_dwordx4 v[44:47], v22, s[12:15], s66 offen offset:1024 sc1
L_q_km_51_1:
    s_cmp_lg_u32 s44, 2
    s_cbranch_scc1 L_q_km_51_2
    buffer_store_dwordx4 v[48:51], v22, s[12:15], s66 offen offset:2048 sc1
L_q_km_51_2:
    s_cmp_lg_u32 s44, 3
    s_cbranch_scc1 L_q_km_51_3
    buffer_store_dwordx4 v[52:55], v22, s[12:15], s66 offen offset:3072 sc1
L_q_km_51_3:
    s_cmp_eq_u32 s60, 63
    s_cbranch_scc1 L_q_fin_52
    v_mov_b32 v22, s60
    v_mov_b32 v0, 0
    s_mov_b64 exec, 1
    buffer_store_dword v22, v0, s[12:15], s3 offen sc1
    s_mov_b64 exec, -1
    s_cmp_eq_u32 s60, 62
    s_cbranch_scc1 L_q_fin_52_n
    s_add_u32 s47, s60, 1
    s_cmp_lt_u32 s47, s50
    s_cbranch_scc1 L_kv_rdy_53
    s_lshl_b32 s45, s43, 7
    s_add_u32 s45, s45, 0x10014
    v_mov_b32 v0, 0
    s_mov_b32 s70, 0
L_kv_rdy_53_p:
    buffer_load_dwordx2 v[10:11], v0, s[12:15], s45 offen sc1
    s_add_u32 s70, s70, 1
    s_cmp_ge_u32 s70, 0x200000
    s_cbranch_scc1 L_c_done_1
    s_waitcnt vmcnt(0)
    v_min_u32 v10, v10, v11
    s_nop 0
    v_readfirstlane_b32 s50, v10
    s_nop 3
    s_cmp_lt_u32 s47, s50
    s_cbranch_scc1 L_kv_rdy_53
    s_sleep 2
    s_branch L_kv_rdy_53_p
L_kv_rdy_53:
    s_mov_b32 m0, s64
    s_add_u32 s45, s63, 4096
    buffer_load_dwordx4 v14, s[12:15], s63 offen sc1 lds
    s_add_u32 m0, s64, 4352
    s_add_u32 s46, s63, 0x1000000
    buffer_load_dwordx4 v14, s[12:15], s45 offen sc1 lds
    s_mov_b32 m0, s65
    s_add_u32 s45, s45, 0x1000000
    buffer_load_dwordx4 v15, s[12:15], s46 offen sc1 lds
    s_add_u32 m0, s65, 4224
    s_add_u32 s63, s63, 8192
    buffer_load_dwordx4 v15, s[12:15], s45 offen sc1 lds
L_q_fin_52_n:
    s_mov_b64 exec, -1
    v_add_u32 v8, s69, v8
    v_add_u32 v9, s69, v9
    s_sub_u32 s64, s64, s69
    s_sub_u32 s65, s65, s69
    s_sub_u32 s69, 0, s69
    s_add_u32 s66, s66, 131072
    s_xor_b32 s51, s51, 65536
    s_add_u32 s60, s60, 1
    s_and_b32 s45, s60, 3
    s_lshl_b32 s46, s45, 14
    s_add_u32 s61, s58, s46
    s_lshl_b32 s46, s45, 15
    s_add_u32 s62, s59, s46
    s_branch L_q_loop_41
L_q_fin_52:
    s_waitcnt vmcnt(0)
    v_mov_b32 v22, 64
    v_mov_b32 v0, 0
    s_mov_b64 exec, 1
    buffer_store_dword v22, v0, s[12:15], s3 offen sc1
    s_mov_b64 exec, -1
    s_endpgm
L_q_vm_48_r:
    buffer_load_dwordx2 v[0:1], v16, s[12:15], s51 offen sc1
    s_add_u32 s70, s70, 1
    s_cmp_lt_u32 s70, 0x100000
    s_waitcnt vmcnt(0)
    s_cbranch_scc1 L_q_vm_48
    s_endpgm
L_ls_47_s:
    buffer_store_dword v74, v20, s[12:15], 0 offen sc1
    s_branch L_ls_47_d
L_ls_49_s:
    buffer_store_dwordx4 v[72:75], v17, s[12:15], s62 offen sc1
    s_branch L_ls_49_d
L_ls_50_s:
    buffer_store_dwordx4 v[60:63], v17, s[12:15], s45 offen sc1
    s_branch L_ls_50_d
L_c_vo_2:
    s_lshl_b32 s45, s43, 11
    s_lshl_b32 s46, s44, 9
    s_add_u32 s45, s45, s46
    v_lshlrev_b32 v10, 3, v1
    v_add_u32 v10, s45, v10
    v_lshlrev_b32 v11, 3, v0
    v_bfe_u32 v69, v1, 4, 1
    v_lshlrev_b32 v69, 2, v69
    v_lshrrev_b32 v63, 5, v1
    v_lshlrev_b32 v63, 1, v63
    v_and_b32 v64, 1, v1
    v_add3_u32 v69, v69, v63, v64
    v_bfe_u32 v63, v1, 1, 1
    v_lshlrev_b32 v63, 3, v63
    v_add_u32 v63, v63, v69
    v_lshlrev_b32 v63, 4, v63
    v_bfe_u32 v64, v1, 2, 2
    v_lshlrev_b32 v64, 2, v64
    s_lshl_b32 s45, s42, 10
    s_lshl_b32 s46, s44, 8
    s_add_u32 s45, s45, s46
    v_add3_u32 v12, v63, v64, s45
    v_and_b32 v64, 1, v1
    v_cmp_eq_u32 vcc, 0, v64
    v_mov_b32 v9, 0x07060302
    v_mov_b32 v63, 0x01000504
    v_cndmask_b32 v9, v9, v63, vcc
    s_lshl_b32 s63, s40, 19
    s_lshl_b32 s45, s42, 15
    s_add_u32 s63, s63, s45
    s_add_u32 s63, s63, 0x7100000
    s_xor_b32 s64, s63, 524288
    s_mov_b32 s45, 0x7020000
    buffer_store_dwordx2 v[40:41], v10, s[12:15], s45 offen sc1
    s_mov_b32 s45, 0x7030000
    buffer_store_dwordx2 v[40:41], v10, s[12:15], s45 offen sc1
    s_add_u32 s45, s63, 0
    buffer_store_dwordx2 v[40:41], v11, s[12:15], s45 offen sc1
    s_add_u32 s45, s63, 4096
    buffer_store_dwordx2 v[40:41], v11, s[12:15], s45 offen sc1
    s_add_u32 s45, s63, 8192
    buffer_store_dwordx2 v[40:41], v11, s[12:15], s45 offen sc1
    s_add_u32 s45, s63, 12288
    buffer_store_dwordx2 v[40:41], v11, s[12:15], s45 offen sc1
    s_add_u32 s45, s63, 16384
    buffer_store_dwordx2 v[40:41], v11, s[12:15], s45 offen sc1
    s_add_u32 s45, s63, 20480
    buffer_store_dwordx2 v[40:41], v11, s[12:15], s45 offen sc1
    s_add_u32 s45, s63, 24576
    buffer_store_dwordx2 v[40:41], v11, s[12:15], s45 offen sc1
    s_add_u32 s45, s63, 28672
    buffer_store_dwordx2 v[40:41], v11, s[12:15], s45 offen sc1
    s_lshl_b32 s61, s40, 16
    s_add_u32 s61, s61, 0x7000000
    s_add_u32 s45, s61, 16384
    buffer_store_dword v40, v12, s[12:15], s45 offen sc1
    s_add_u32 s45, s61, 32768
    buffer_store_dword v40, v12, s[12:15], s45 offen sc1
    s_add_u32 s45, s61, 49152
    buffer_store_dword v40, v12, s[12:15], s45 offen sc1
    v_lshlrev_b32 v63, 11, v69
    v_and_b32 v64, 14, v1
    v_lshlrev_b32 v64, 1, v64
    v_add_u32 v63, v63, v64
    s_lshl_b32 s45, s42, 7
    s_lshl_b32 s46, s44, 5
    s_add_u32 s45, s45, s46
    buffer_load_dword v45, v63, s[52:55], s45 offen
    s_mov_b32 s76, -1
    s_mov_b32 s77, -1
    v_lshrrev_b32 v63, 3, v1
    v_lshlrev_b32 v63, 11, v63
    v_bfe_u32 v64, v1, 1, 2
    v_and_b32 v65, 1, v1
    v_lshlrev_b32 v65, 4, v65
    v_add_u32 v63, v63, v65
    v_xor_b32 v66, 0, v64
    v_lshlrev_b32 v66, 5, v66
    v_add_u32 v70, v63, v66
    v_xor_b32 v66, 1, v64
    v_lshlrev_b32 v66, 5, v66
    v_add_u32 v71, v63, v66
    v_xor_b32 v66, 2, v64
    v_lshlrev_b32 v66, 5, v66
    v_add_u32 v72, v63, v66
    v_xor_b32 v66, 3, v64
    v_lshlrev_b32 v66, 5, v66
    v_add_u32 v73, v63, v66
    v_bfe_u32 v63, v1, 3, 1
    v_lshlrev_b32 v63, 1, v63
    v_bfe_u32 v64, v1, 4, 1
    v_add_u32 v63, v63, v64
    v_lshlrev_b32 v64, 3, v63
    v_lshrrev_b32 v65, 5, v1
    v_lshlrev_b32 v65, 2, v65
    v_add_u32 v64, v64, v65
    v_bfe_u32 v65, v1, 2, 1
    v_add_u32 v64, v64, v65
    v_lshlrev_b32 v64, 7, v64
    v_and_b32 v65, 3, v1
    v_lshlrev_b32 v65, 3, v65
    v_add_u32 v64, v64, v65
    s_lshl_b32 s45, s44, 12
    v_add_u32 v64, s45, v64
    s_add_u32 s45, s44, 1
    s_and_b32 s45, s45, 3
    v_xor_b32 v65, s45, v63
    v_lshlrev_b32 v65, 5, v65
    v_add_u32 v74, v64, v65
    s_mul_i32 s45, s44, 20480
    s_add_u32 s45, s45, 65536
    v_add_u32 v88, s45, v74
    s_add_u32 s45, s44, 2
    s_and_b32 s45, s45, 3
    v_xor_b32 v65, s45, v63
    v_lshlrev_b32 v65, 5, v65
    v_add_u32 v75, v64, v65
    s_mul_i32 s45, s44, 20480
    s_add_u32 s45, s45, 65536
    v_add_u32 v89, s45, v75
    s_add_u32 s45, s44, 3
    s_and_b32 s45, s45, 3
    v_xor_b32 v65, s45, v63
    v_lshlrev_b32 v65, 5, v65
    v_add_u32 v76, v64, v65
    s_mul_i32 s45, s44, 20480
    s_add_u32 s45, s45, 65536
    v_add_u32 v90, s45, v76
    s_add_u32 s45, s44, 4
    s_and_b32 s45, s45, 3
    v_xor_b32 v65, s45, v63
    v_lshlrev_b32 v65, 5, v65
    v_add_u32 v77, v64, v65
    s_mul_i32 s45, s44, 20480
    s_add_u32 s45, s45, 65536
    v_add_u32 v91, s45, v77
    s_mul_i32 s65, s44, 24576
    s_lshl_b32 s49, s40, 22
    s_lshl_b32 s45, s44, 20
    s_add_u32 s49, s49, s45
    s_lshl_b32 s45, s42, 7
    s_add_u32 s49, s49, s45
    s_lshl_b32 s50, s44, 12
    s_mul_i32 s69, s42, 1
    s_add_u32 s51, s69, 0
    s_and_b32 s51, s51, 7
    s_lshl_b32 s51, s51, 17
    s_add_u32 s51, s51, s49
    s_add_u32 s46, s51, 0x0
    s_add_u32 m0, s65, 65536
    s_nop 0
    buffer_load_dwordx4 v70, s[36:39], s46 offen nt lds
    s_add_u32 s46, s51, 0x8000
    s_add_u32 m0, s65, 66560
    s_nop 0
    buffer_load_dwordx4 v71, s[36:39], s46 offen nt lds
    s_add_u32 s46, s51, 0x10000
    s_add_u32 m0, s65, 67584
    s_nop 0
    buffer_load_dwordx4 v72, s[36:39], s46 offen nt lds
    s_add_u32 s46, s51, 0x18000
    s_add_u32 m0, s65, 68608
    s_nop 0
    buffer_load_dwordx4 v73, s[36:39], s46 offen nt lds
    s_add_u32 s51, s69, 0
    s_and_b32 s51, s51, 7
    s_lshl_b32 s51, s51, 17
    s_add_u32 s51, s51, s49
    s_add_u32 s46, s51, 0x4000
    s_add_u32 m0, s65, 69632
    s_nop 0
    buffer_load_dwordx4 v70, s[36:39], s46 offen nt lds
    s_add_u32 s46, s51, 0xc000
    s_add_u32 m0, s65, 70656
    s_nop 0
    buffer_load_dwordx4 v71, s[36:39], s46 offen nt lds
    s_add_u32 s46, s51, 0x14000
    s_add_u32 m0, s65, 71680
    s_nop 0
    buffer_load_dwordx4 v72, s[36:39], s46 offen nt lds
    s_add_u32 s46, s51, 0x1c000
    s_add_u32 m0, s65, 72704
    s_nop 0
    buffer_load_dwordx4 v73, s[36:39], s46 offen nt lds
    s_add_u32 s51, s69, 1
    s_and_b32 s51, s51, 7
    s_lshl_b32 s51, s51, 17
    s_add_u32 s51, s51, s49
    s_add_u32 s46, s51, 0x0
    s_add_u32 m0, s65, 73728
    s_nop 0
    buffer_load_dwordx4 v70, s[36:39], s46 offen nt lds
    s_add_u32 s46, s51, 0x8000
    s_add_u32 m0, s65, 74752
    s_nop 0
    buffer_load_dwordx4 v71, s[36:39], s46 offen nt lds
    s_add_u32 s46, s51, 0x10000
    s_add_u32 m0, s65, 75776
    s_nop 0
    buffer_load_dwordx4 v72, s[36:39], s46 offen nt lds
    s_add_u32 s46, s51, 0x18000
    s_add_u32 m0, s65, 76800
    s_nop 0
    buffer_load_dwordx4 v73, s[36:39], s46 offen nt lds
    s_add_u32 s51, s69, 1
    s_and_b32 s51, s51, 7
    s_lshl_b32 s51, s51, 17
    s_add_u32 s51, s51, s49
    s_add_u32 s46, s51, 0x4000
    s_add_u32 m0, s65, 77824
    s_nop 0
    buffer_load_dwordx4 v70, s[36:39], s46 offen nt lds
    s_add_u32 s46, s51, 0xc000
    s_add_u32 m0, s65, 78848
    s_nop 0
    buffer_load_dwordx4 v71, s[36:39], s46 offen nt lds
    s_add_u32 s46, s51, 0x14000
    s_add_u32 m0, s65, 79872
    s_nop 0
    buffer_load_dwordx4 v72, s[36:39], s46 offen nt lds
    s_add_u32 s46, s51, 0x1c000
    s_add_u32 m0, s65, 80896
    s_nop 0
    buffer_load_dwordx4 v73, s[36:39], s46 offen nt lds
    s_add_u32 s51, s69, 2
    s_and_b32 s51, s51, 7
    s_lshl_b32 s51, s51, 17
    s_add_u32 s51, s51, s49
    s_add_u32 s46, s51, 0x0
    s_add_u32 m0, s65, 81920
    s_nop 0
    buffer_load_dwordx4 v70, s[36:39], s46 offen nt lds
    s_add_u32 s46, s51, 0x8000
    s_add_u32 m0, s65, 82944
    s_nop 0
    buffer_load_dwordx4 v71, s[36:39], s46 offen nt lds
    s_add_u32 s46, s51, 0x10000
    s_add_u32 m0, s65, 83968
    s_nop 0
    buffer_load_dwordx4 v72, s[36:39], s46 offen nt lds
    s_add_u32 s46, s51, 0x18000
    s_add_u32 m0, s65, 84992
    s_nop 0
    buffer_load_dwordx4 v73, s[36:39], s46 offen nt lds
    s_add_u32 s51, s69, 2
    s_and_b32 s51, s51, 7
    s_lshl_b32 s51, s51, 17
    s_add_u32 s51, s51, s49
    s_add_u32 s46, s51, 0x4000
    s_add_u32 m0, s65, 86016
    s_nop 0
    buffer_load_dwordx4 v70, s[36:39], s46 offen nt lds
    s_add_u32 s46, s51, 0xc000
    s_add_u32 m0, s65, 87040
    s_nop 0
    buffer_load_dwordx4 v71, s[36:39], s46 offen nt lds
    s_add_u32 s46, s51, 0x14000
    s_add_u32 m0, s65, 88064
    s_nop 0
    buffer_load_dwordx4 v72, s[36:39], s46 offen nt lds
    s_add_u32 s46, s51, 0x1c000
    s_add_u32 m0, s65, 89088
    s_nop 0
    buffer_load_dwordx4 v73, s[36:39], s46 offen nt lds
    s_add_u32 s51, s69, 3
    s_and_b32 s51, s51, 7
    s_lshl_b32 s51, s51, 17
    s_add_u32 s51, s51, s49
    s_add_u32 s46, s51, 0x0
    s_add_u32 m0, s50, 0
    s_nop 0
    buffer_load_dwordx4 v70, s[36:39], s46 offen nt lds
    s_add_u32 s46, s51, 0x8000
    s_add_u32 m0, s50, 1024
    s_nop 0
    buffer_load_dwordx4 v71, s[36:39], s46 offen nt lds
    s_add_u32 s46, s51, 0x10000
    s_add_u32 m0, s50, 2048
    s_nop 0
    buffer_load_dwordx4 v72, s[36:39], s46 offen nt lds
    s_add_u32 s46, s51, 0x18000
    s_add_u32 m0, s50, 3072
    s_nop 0
    buffer_load_dwordx4 v73, s[36:39], s46 offen nt lds
    s_add_u32 s51, s69, 3
    s_and_b32 s51, s51, 7
    s_lshl_b32 s51, s51, 17
    s_add_u32 s51, s51, s49
    s_add_u32 s46, s51, 0x4000
    s_add_u32 m0, s50, 16384
    s_nop 0
    buffer_load_dwordx4 v70, s[36:39], s46 offen nt lds
    s_add_u32 s46, s51, 0xc000
    s_add_u32 m0, s50, 17408
    s_nop 0
    buffer_load_dwordx4 v71, s[36:39], s46 offen nt lds
    s_add_u32 s46, s51, 0x14000
    s_add_u32 m0, s50, 18432
    s_nop 0
    buffer_load_dwordx4 v72, s[36:39], s46 offen nt lds
    s_add_u32 s46, s51, 0x1c000
    s_add_u32 m0, s50, 19456
    s_nop 0
    buffer_load_dwordx4 v73, s[36:39], s46 offen nt lds
    s_add_u32 s51, s69, 4
    s_and_b32 s51, s51, 7
    s_lshl_b32 s51, s51, 17
    s_add_u32 s51, s51, s49
    s_add_u32 s46, s51, 0x0
    s_add_u32 m0, s50, 32768
    s_nop 0
    buffer_load_dwordx4 v70, s[36:39], s46 offen nt lds
    s_add_u32 s46, s51, 0x8000
    s_add_u32 m0, s50, 33792
    s_nop 0
    buffer_load_dwordx4 v71, s[36:39], s46 offen nt lds
    s_add_u32 s46, s51, 0x10000
    s_add_u32 m0, s50, 34816
    s_nop 0
    buffer_load_dwordx4 v72, s[36:39], s46 offen nt lds
    s_add_u32 s46, s51, 0x18000
    s_add_u32 m0, s50, 35840
    s_nop 0
    buffer_load_dwordx4 v73, s[36:39], s46 offen nt lds
    s_add_u32 s51, s69, 4
    s_and_b32 s51, s51, 7
    s_lshl_b32 s51, s51, 17
    s_add_u32 s51, s51, s49
    s_add_u32 s46, s51, 0x4000
    s_add_u32 m0, s50, 49152
    s_nop 0
    buffer_load_dwordx4 v70, s[36:39], s46 offen nt lds
    s_add_u32 s46, s51, 0xc000
    s_add_u32 m0, s50, 50176
    s_nop 0
    buffer_load_dwordx4 v71, s[36:39], s46 offen nt lds
    s_add_u32 s46, s51, 0x14000
    s_add_u32 m0, s50, 51200
    s_nop 0
    buffer_load_dwordx4 v72, s[36:39], s46 offen nt lds
    s_add_u32 s46, s51, 0x1c000
    s_add_u32 m0, s50, 52224
    s_nop 0
    buffer_load_dwordx4 v73, s[36:39], s46 offen nt lds
    s_waitcnt vmcnt(40)
    v_min_u32 v45, -2, v45
    buffer_store_dword v45, v12, s[12:15], s61 offen sc1
    s_waitcnt vmcnt(36)
    s_barrier
    ds_read_b64_tr_b16 a[160:161], v88 offset:0
    ds_read_b64_tr_b16 a[162:163], v88 offset:256
    ds_read_b64_tr_b16 a[168:169], v89 offset:0
    ds_read_b64_tr_b16 a[170:171], v89 offset:256
    ds_read_b64_tr_b16 a[176:177], v90 offset:0
    ds_read_b64_tr_b16 a[178:179], v90 offset:256
    ds_read_b64_tr_b16 a[184:185], v91 offset:0
    ds_read_b64_tr_b16 a[186:187], v91 offset:256
L_lw_54:
    s_waitcnt lgkmcnt(0)
    s_cmp_lg_u32 s44, 0
    s_cbranch_scc1 L_v_probe_55
    s_add_u32 s45, s63, 0
    s_memtime s[72:73]
    s_waitcnt lgkmcnt(0)
    s_load_dword s78, s[20:21], s45
    s_waitcnt lgkmcnt(0)
    s_memtime s[74:75]
    s_waitcnt lgkmcnt(0)
    s_sub_u32 s45, s74, s72
    s_min_u32 s76, s76, s45
    s_cmp_lt_u32 s77, s76
    s_cselect_b32 s68, 1, 0
L_v_probe_55:
    s_waitcnt vmcnt(32)
    s_barrier
    s_add_u32 s51, s69, 5
    s_and_b32 s51, s51, 7
    s_lshl_b32 s51, s51, 17
    s_add_u32 s51, s51, s49
    s_add_u32 s46, s51, 0x0
    s_add_u32 m0, s65, 65536
    s_nop 0
    buffer_load_dwordx4 v70, s[36:39], s46 offen nt lds
    s_add_u32 s46, s51, 0x8000
    s_add_u32 m0, s65, 66560
    s_nop 0
    buffer_load_dwordx4 v71, s[36:39], s46 offen nt lds
    s_add_u32 s46, s51, 0x10000
    s_add_u32 m0, s65, 67584
    s_nop 0
    buffer_load_dwordx4 v72, s[36:39], s46 offen nt lds
    s_add_u32 s46, s51, 0x18000
    s_add_u32 m0, s65, 68608
    s_nop 0
    buffer_load_dwordx4 v73, s[36:39], s46 offen nt lds
    ds_read_b64_tr_b16 a[164:165], v88 offset:4096
    ds_read_b64_tr_b16 a[166:167], v88 offset:4352
    ds_read_b64_tr_b16 a[172:173], v89 offset:4096
    ds_read_b64_tr_b16 a[174:175], v89 offset:4352
    ds_read_b64_tr_b16 a[180:181], v90 offset:4096
    ds_read_b64_tr_b16 a[182:183], v90 offset:4352
    ds_read_b64_tr_b16 a[188:189], v91 offset:4096
    ds_read_b64_tr_b16 a[190:191], v91 offset:4352
L_lw_56:
    s_waitcnt lgkmcnt(0)
    s_cmp_lg_u32 s44, 0
    s_cbranch_scc1 L_v_probe_57
    s_add_u32 s45, s63, 8192
    s_memtime s[72:73]
    s_waitcnt lgkmcnt(0)
    s_load_dword s78, s[20:21], s45
    s_waitcnt lgkmcnt(0)
    s_memtime s[74:75]
    s_waitcnt lgkmcnt(0)
    s_sub_u32 s45, s74, s72
    s_min_u32 s77, s77, s45
    s_cmp_lt_u32 s77, s76
    s_cselect_b32 s68, 1, 0
L_v_probe_57:
    s_waitcnt vmcnt(32)
    s_barrier
    s_add_u32 s51, s69, 5
    s_and_b32 s51, s51, 7
    s_lshl_b32 s51, s51, 17
    s_add_u32 s51, s51, s49
    s_add_u32 s46, s51, 0x4000
    s_add_u32 m0, s65, 69632
    s_nop 0
    buffer_load_dwordx4 v70, s[36:39], s46 offen nt lds
    s_add_u32 s46, s51, 0xc000
    s_add_u32 m0, s65, 70656
    s_nop 0
    buffer_load_dwordx4 v71, s[36:39], s46 offen nt lds
    s_add_u32 s46, s51, 0x14000
    s_add_u32 m0, s65, 71680
    s_nop 0
    buffer_load_dwordx4 v72, s[36:39], s46 offen nt lds
    s_add_u32 s46, s51, 0x1c000
    s_add_u32 m0, s65, 72704
    s_nop 0
    buffer_load_dwordx4 v73, s[36:39], s46 offen nt lds
    ds_read_b64_tr_b16 a[192:193], v88 offset:8192
    ds_read_b64_tr_b16 a[194:195], v88 offset:8448
    ds_read_b64_tr_b16 a[200:201], v89 offset:8192
    ds_read_b64_tr_b16 a[202:203], v89 offset:8448
    ds_read_b64_tr_b16 a[208:209], v90 offset:8192
    ds_read_b64_tr_b16 a[210:211], v90 offset:8448
    ds_read_b64_tr_b16 a[216:217], v91 offset:8192
    ds_read_b64_tr_b16 a[218:219], v91 offset:8448
L_lw_58:
    s_waitcnt lgkmcnt(0)
    s_cmp_lg_u32 s44, 0
    s_cbranch_scc1 L_v_probe_59
    s_add_u32 s45, s63, 128
    s_memtime s[72:73]
    s_waitcnt lgkmcnt(0)
    s_load_dword s78, s[20:21], s45
    s_waitcnt lgkmcnt(0)
    s_memtime s[74:75]
    s_waitcnt lgkmcnt(0)
    s_sub_u32 s45, s74, s72
    s_min_u32 s76, s76, s45
    s_cmp_lt_u32 s77, s76
    s_cselect_b32 s68, 1, 0
L_v_probe_59:
    s_waitcnt vmcnt(32)
    s_barrier
    s_add_u32 s51, s69, 6
    s_and_b32 s51, s51, 7
    s_lshl_b32 s51, s51, 17
    s_add_u32 s51, s51, s49
    s_add_u32 s46, s51, 0x0
    s_add_u32 m0, s65, 73728
    s_nop 0
    buffer_load_dwordx4 v70, s[36:39], s46 offen nt lds
    s_add_u32 s46, s51, 0x8000
    s_add_u32 m0, s65, 74752
    s_nop 0
    buffer_load_dwordx4 v71, s[36:39], s46 offen nt lds
    s_add_u32 s46, s51, 0x10000
    s_add_u32 m0, s65, 75776
    s_nop 0
    buffer_load_dwordx4 v72, s[36:39], s46 offen nt lds
    s_add_u32 s46, s51, 0x18000
    s_add_u32 m0, s65, 76800
    s_nop 0
    buffer_load_dwordx4 v73, s[36:39], s46 offen nt lds
    ds_read_b64_tr_b16 a[196:197], v88 offset:12288
    ds_read_b64_tr_b16 a[198:199], v88 offset:12544
    ds_read_b64_tr_b16 a[204:205], v89 offset:12288
    ds_read_b64_tr_b16 a[206:207], v89 offset:12544
    ds_read_b64_tr_b16 a[212:213], v90 offset:12288
    ds_read_b64_tr_b16 a[214:215], v90 offset:12544
    ds_read_b64_tr_b16 a[220:221], v91 offset:12288
    ds_read_b64_tr_b16 a[222:223], v91 offset:12544
L_lw_60:
    s_waitcnt lgkmcnt(0)
    s_cmp_lg_u32 s44, 0
    s_cbranch_scc1 L_v_probe_61
    s_add_u32 s45, s63, 8320
    s_memtime s[72:73]
    s_waitcnt lgkmcnt(0)
    s_load_dword s78, s[20:21], s45
    s_waitcnt lgkmcnt(0)
    s_memtime s[74:75]
    s_waitcnt lgkmcnt(0)
    s_sub_u32 s45, s74, s72
    s_min_u32 s77, s77, s45
    s_cmp_lt_u32 s77, s76
    s_cselect_b32 s68, 1, 0
L_v_probe_61:
    s_waitcnt vmcnt(32)
    s_barrier
    s_add_u32 s51, s69, 6
    s_and_b32 s51, s51, 7
    s_lshl_b32 s51, s51, 17
    s_add_u32 s51, s51, s49
    s_add_u32 s46, s51, 0x4000
    s_add_u32 m0, s65, 77824
    s_nop 0
    buffer_load_dwordx4 v70, s[36:39], s46 offen nt lds
    s_add_u32 s46, s51, 0xc000
    s_add_u32 m0, s65, 78848
    s_nop 0
    buffer_load_dwordx4 v71, s[36:39], s46 offen nt lds
    s_add_u32 s46, s51, 0x14000
    s_add_u32 m0, s65, 79872
    s_nop 0
    buffer_load_dwordx4 v72, s[36:39], s46 offen nt lds
    s_add_u32 s46, s51, 0x1c000
    s_add_u32 m0, s65, 80896
    s_nop 0
    buffer_load_dwordx4 v73, s[36:39], s46 offen nt lds
    ds_read_b64_tr_b16 a[224:225], v88 offset:16384
    ds_read_b64_tr_b16 a[226:227], v88 offset:16640
    ds_read_b64_tr_b16 a[232:233], v89 offset:16384
    ds_read_b64_tr_b16 a[234:235], v89 offset:16640
    ds_read_b64_tr_b16 a[240:241], v90 offset:16384
    ds_read_b64_tr_b16 a[242:243], v90 offset:16640
    ds_read_b64_tr_b16 a[248:249], v91 offset:16384
    ds_read_b64_tr_b16 a[250:251], v91 offset:16640
L_lw_62:
    s_waitcnt lgkmcnt(0)
    s_cmp_lg_u32 s44, 0
    s_cbranch_scc1 L_v_probe_63
    s_add_u32 s45, s63, 256
    s_memtime s[72:73]
    s_waitcnt lgkmcnt(0)
    s_load_dword s78, s[20:21], s45
    s_waitcnt lgkmcnt(0)
    s_memtime s[74:75]
    s_waitcnt lgkmcnt(0)
    s_sub_u32 s45, s74, s72
    s_min_u32 s76, s76, s45
    s_cmp_lt_u32 s77, s76
    s_cselect_b32 s68, 1, 0
L_v_probe_63:
    s_waitcnt vmcnt(32)
    s_barrier
    s_add_u32 s51, s69, 7
    s_and_b32 s51, s51, 7
    s_lshl_b32 s51, s51, 17
    s_add_u32 s51, s51, s49
    s_add_u32 s46, s51, 0x0
    s_add_u32 m0, s65, 81920
    s_nop 0
    buffer_load_dwordx4 v70, s[36:39], s46 offen nt lds
    s_add_u32 s46, s51, 0x8000
    s_add_u32 m0, s65, 82944
    s_nop 0
    buffer_load_dwordx4 v71, s[36:39], s46 offen nt lds
    s_add_u32 s46, s51, 0x10000
    s_add_u32 m0, s65, 83968
    s_nop 0
    buffer_load_dwordx4 v72, s[36:39], s46 offen nt lds
    s_add_u32 s46, s51, 0x18000
    s_add_u32 m0, s65, 84992
    s_nop 0
    buffer_load_dwordx4 v73, s[36:39], s46 offen nt lds
    ds_read_b64_tr_b16 a[228:229], v88 offset:20480
    ds_read_b64_tr_b16 a[230:231], v88 offset:20736
    ds_read_b64_tr_b16 a[236:237], v89 offset:20480
    ds_read_b64_tr_b16 a[238:239], v89 offset:20736
    ds_read_b64_tr_b16 a[244:245], v90 offset:20480
    ds_read_b64_tr_b16 a[246:247], v90 offset:20736
    ds_read_b64_tr_b16 a[252:253], v91 offset:20480
    ds_read_b64_tr_b16 a[254:255], v91 offset:20736
L_lw_64:
    s_waitcnt lgkmcnt(0)
    s_cmp_lg_u32 s44, 0
    s_cbranch_scc1 L_v_probe_65
    s_add_u32 s45, s63, 8448
    s_memtime s[72:73]
    s_waitcnt lgkmcnt(0)
    s_load_dword s78, s[20:21], s45
    s_waitcnt lgkmcnt(0)
    s_memtime s[74:75]
    s_waitcnt lgkmcnt(0)
    s_sub_u32 s45, s74, s72
    s_min_u32 s77, s77, s45
    s_cmp_lt_u32 s77, s76
    s_cselect_b32 s68, 1, 0
L_v_probe_65:
    s_waitcnt vmcnt(32)
    s_barrier
    s_add_u32 s51, s69, 7
    s_and_b32 s51, s51, 7
    s_lshl_b32 s51, s51, 17
    s_add_u32 s51, s51, s49
    s_add_u32 s46, s51, 0x4000
    s_add_u32 m0, s65, 86016
    s_nop 0
    buffer_load_dwordx4 v70, s[36:39], s46 offen nt lds
    s_add_u32 s46, s51, 0xc000
    s_add_u32 m0, s65, 87040
    s_nop 0
    buffer_load_dwordx4 v71, s[36:39], s46 offen nt lds
    s_add_u32 s46, s51, 0x14000
    s_add_u32 m0, s65, 88064
    s_nop 0
    buffer_load_dwordx4 v72, s[36:39], s46 offen nt lds
    s_add_u32 s46, s51, 0x1c000
    s_add_u32 m0, s65, 89088
    s_nop 0
    buffer_load_dwordx4 v73, s[36:39], s46 offen nt lds
    ds_read_b64_tr_b16 v[96:97], v74 offset:0
    ds_read_b64_tr_b16 v[98:99], v74 offset:256
    ds_read_b64_tr_b16 v[104:105], v75 offset:0
    ds_read_b64_tr_b16 v[106:107], v75 offset:256
    ds_read_b64_tr_b16 v[112:113], v76 offset:0
    ds_read_b64_tr_b16 v[114:115], v76 offset:256
    ds_read_b64_tr_b16 v[120:121], v77 offset:0
    ds_read_b64_tr_b16 v[122:123], v77 offset:256
L_lw_66:
    s_waitcnt lgkmcnt(0)
    s_cmp_lg_u32 s44, 0
    s_cbranch_scc1 L_v_probe_67
    s_add_u32 s45, s63, 384
    s_memtime s[72:73]
    s_waitcnt lgkmcnt(0)
    s_load_dword s78, s[20:21], s45
    s_waitcnt lgkmcnt(0)
    s_memtime s[74:75]
    s_waitcnt lgkmcnt(0)
    s_sub_u32 s45, s74, s72
    s_min_u32 s76, s76, s45
    s_cmp_lt_u32 s77, s76
    s_cselect_b32 s68, 1, 0
L_v_probe_67:
    s_waitcnt vmcnt(32)
    s_barrier
    s_add_u32 s46, s47, 0x0
    s_add_u32 m0, s48, 0
    s_nop 0
    buffer_load_dwordx4 v82, s[32:35], s46 offen nt lds
    s_add_u32 s46, s47, 0x20000
    s_add_u32 m0, s48, 4096
    s_nop 0
    buffer_load_dwordx4 v82, s[32:35], s46 offen nt lds
    s_add_u32 s46, s47, 0x40000
    s_add_u32 m0, s48, 8192
    s_nop 0
    buffer_load_dwordx4 v82, s[32:35], s46 offen nt lds
    s_add_u32 s46, s47, 0x60000
    s_add_u32 m0, s48, 12288
    s_nop 0
    buffer_load_dwordx4 v82, s[32:35], s46 offen nt lds
    ds_read_b64_tr_b16 v[100:101], v74 offset:16384
    ds_read_b64_tr_b16 v[102:103], v74 offset:16640
    ds_read_b64_tr_b16 v[108:109], v75 offset:16384
    ds_read_b64_tr_b16 v[110:111], v75 offset:16640
    ds_read_b64_tr_b16 v[116:117], v76 offset:16384
    ds_read_b64_tr_b16 v[118:119], v76 offset:16640
    ds_read_b64_tr_b16 v[124:125], v77 offset:16384
    ds_read_b64_tr_b16 v[126:127], v77 offset:16640
L_lw_68:
    s_waitcnt lgkmcnt(0)
    s_cmp_lg_u32 s44, 0
    s_cbranch_scc1 L_v_probe_69
    s_add_u32 s45, s63, 8576
    s_memtime s[72:73]
    s_waitcnt lgkmcnt(0)
    s_load_dword s78, s[20:21], s45
    s_waitcnt lgkmcnt(0)
    s_memtime s[74:75]
    s_waitcnt lgkmcnt(0)
    s_sub_u32 s45, s74, s72
    s_min_u32 s77, s77, s45
    s_cmp_lt_u32 s77, s76
    s_cselect_b32 s68, 1, 0
L_v_probe_69:
    s_waitcnt vmcnt(32)
    s_barrier
    s_add_u32 s46, s47, 0x80000
    s_add_u32 m0, s48, 16384
    s_nop 0
    buffer_load_dwordx4 v82, s[32:35], s46 offen nt lds
    s_add_u32 s46, s47, 0xa0000
    s_add_u32 m0, s48, 20480
    s_nop 0
    buffer_load_dwordx4 v82, s[32:35], s46 offen nt lds
    s_add_u32 s46, s47, 0xc0000
    s_add_u32 m0, s48, 24576
    s_nop 0
    buffer_load_dwordx4 v82, s[32:35], s46 offen nt lds
    s_add_u32 s46, s47, 0xe0000
    s_add_u32 m0, s48, 28672
    s_nop 0
    buffer_load_dwordx4 v82, s[32:35], s46 offen nt lds
    ds_read_b64_tr_b16 v[128:129], v74 offset:32768
    ds_read_b64_tr_b16 v[130:131], v74 offset:33024
    ds_read_b64_tr_b16 v[136:137], v75 offset:32768
    ds_read_b64_tr_b16 v[138:139], v75 offset:33024
    ds_read_b64_tr_b16 v[144:145], v76 offset:32768
    ds_read_b64_tr_b16 v[146:147], v76 offset:33024
    ds_read_b64_tr_b16 v[152:153], v77 offset:32768
    ds_read_b64_tr_b16 v[154:155], v77 offset:33024
L_lw_70:
    s_waitcnt lgkmcnt(0)
    s_cmp_lg_u32 s44, 0
    s_cbranch_scc1 L_v_probe_71
    s_add_u32 s45, s63, 512
    s_memtime s[72:73]
    s_waitcnt lgkmcnt(0)
    s_load_dword s78, s[20:21], s45
    s_waitcnt lgkmcnt(0)
    s_memtime s[74:75]
    s_waitcnt lgkmcnt(0)
    s_sub_u32 s45, s74, s72
    s_min_u32 s76, s76, s45
    s_cmp_lt_u32 s77, s76
    s_cselect_b32 s68, 1, 0
L_v_probe_71:
    s_waitcnt vmcnt(32)
    s_barrier
    s_add_u32 s46, s47, 0x100000
    s_add_u32 m0, s48, 32768
    s_nop 0
    buffer_load_dwordx4 v82, s[32:35], s46 offen nt lds
    s_add_u32 s46, s47, 0x120000
    s_add_u32 m0, s48, 36864
    s_nop 0
    buffer_load_dwordx4 v82, s[32:35], s46 offen nt lds
    s_add_u32 s46, s47, 0x140000
    s_add_u32 m0, s48, 40960
    s_nop 0
    buffer_load_dwordx4 v82, s[32:35], s46 offen nt lds
    s_add_u32 s46, s47, 0x160000
    s_add_u32 m0, s48, 45056
    s_nop 0
    buffer_load_dwordx4 v82, s[32:35], s46 offen nt lds
    ds_read_b64_tr_b16 v[132:133], v74 offset:49152
    ds_read_b64_tr_b16 v[134:135], v74 offset:49408
    ds_read_b64_tr_b16 v[140:141], v75 offset:49152
    ds_read_b64_tr_b16 v[142:143], v75 offset:49408
    ds_read_b64_tr_b16 v[148:149], v76 offset:49152
    ds_read_b64_tr_b16 v[150:151], v76 offset:49408
    ds_read_b64_tr_b16 v[156:157], v77 offset:49152
    ds_read_b64_tr_b16 v[158:159], v77 offset:49408
L_lw_72:
    s_waitcnt lgkmcnt(0)
    s_cmp_lg_u32 s44, 0
    s_cbranch_scc1 L_v_probe_73
    s_add_u32 s45, s63, 8704
    s_memtime s[72:73]
    s_waitcnt lgkmcnt(0)
    s_load_dword s78, s[20:21], s45
    s_waitcnt lgkmcnt(0)
    s_memtime s[74:75]
    s_waitcnt lgkmcnt(0)
    s_sub_u32 s45, s74, s72
    s_min_u32 s77, s77, s45
    s_cmp_lt_u32 s77, s76
    s_cselect_b32 s68, 1, 0
L_v_probe_73:
    s_waitcnt vmcnt(32)
    s_barrier
    s_add_u32 s46, s47, 0x180000
    s_add_u32 m0, s48, 49152
    s_nop 0
    buffer_load_dwordx4 v82, s[32:35], s46 offen nt lds
    s_add_u32 s46, s47, 0x1a0000
    s_add_u32 m0, s48, 53248
    s_nop 0
    buffer_load_dwordx4 v82, s[32:35], s46 offen nt lds
    s_add_u32 s46, s47, 0x1c0000
    s_add_u32 m0, s48, 57344
    s_nop 0
    buffer_load_dwordx4 v82, s[32:35], s46 offen nt lds
    s_add_u32 s46, s47, 0x1e0000
    s_add_u32 m0, s48, 61440
    s_nop 0
    buffer_load_dwordx4 v82, s[32:35], s46 offen nt lds
    ds_read_b64_tr_b16 v[160:161], v88 offset:0
    ds_read_b64_tr_b16 v[162:163], v88 offset:256
    ds_read_b64_tr_b16 v[168:169], v89 offset:0
    ds_read_b64_tr_b16 v[170:171], v89 offset:256
    ds_read_b64_tr_b16 v[176:177], v90 offset:0
    ds_read_b64_tr_b16 v[178:179], v90 offset:256
    ds_read_b64_tr_b16 v[184:185], v91 offset:0
    ds_read_b64_tr_b16 v[186:187], v91 offset:256
L_lw_74:
    s_waitcnt lgkmcnt(0)
    s_waitcnt vmcnt(32)
    s_barrier
    s_cmp_lg_u32 s44, 0
    s_cbranch_scc1 L_hs_75
    s_getreg_b32 s45, hwreg(HW_REG_XCC_ID)
    s_and_b32 s45, s45, 15
    s_lshl_b32 s45, 1, s45
    v_mov_b32 v40, s45
    s_lshl_b32 s46, s40, 2
    s_add_u32 s46, s46, 4
    v_mov_b32 v41, 0
    v_mov_b32 v43, s68
    s_mov_b64 exec, 1
    buffer_atomic_or v40, v41, s[16:19], s46 offen sc1
    buffer_atomic_add v43, v41, s[16:19], 0 offen offset:12 sc1
    s_mov_b64 exec, -1
L_hs_75:
    ds_read_b64_tr_b16 v[164:165], v88 offset:4096
    ds_read_b64_tr_b16 v[166:167], v88 offset:4352
    ds_read_b64_tr_b16 v[172:173], v89 offset:4096
    ds_read_b64_tr_b16 v[174:175], v89 offset:4352
    ds_read_b64_tr_b16 v[180:181], v90 offset:4096
    ds_read_b64_tr_b16 v[182:183], v90 offset:4352
    ds_read_b64_tr_b16 v[188:189], v91 offset:4096
    ds_read_b64_tr_b16 v[190:191], v91 offset:4352
L_lw_76:
    s_waitcnt lgkmcnt(0)
    s_waitcnt vmcnt(28)
    s_barrier
    ds_read_b64_tr_b16 v[192:193], v88 offset:8192
    ds_read_b64_tr_b16 v[194:195], v88 offset:8448
    ds_read_b64_tr_b16 v[200:201], v89 offset:8192
    ds_read_b64_tr_b16 v[202:203], v89 offset:8448
    ds_read_b64_tr_b16 v[208:209], v90 offset:8192
    ds_read_b64_tr_b16 v[210:211], v90 offset:8448
    ds_read_b64_tr_b16 v[216:217], v91 offset:8192
    ds_read_b64_tr_b16 v[218:219], v91 offset:8448
L_lw_77:
    s_waitcnt lgkmcnt(0)
    s_waitcnt vmcnt(24)
    s_barrier
    ds_read_b64_tr_b16 v[196:197], v88 offset:12288
    ds_read_b64_tr_b16 v[198:199], v88 offset:12544
    ds_read_b64_tr_b16 v[204:205], v89 offset:12288
    ds_read_b64_tr_b16 v[206:207], v89 offset:12544
    ds_read_b64_tr_b16 v[212:213], v90 offset:12288
    ds_read_b64_tr_b16 v[214:215], v90 offset:12544
    ds_read_b64_tr_b16 v[220:221], v91 offset:12288
    ds_read_b64_tr_b16 v[222:223], v91 offset:12544
L_lw_78:
    s_waitcnt lgkmcnt(0)
    s_waitcnt vmcnt(20)
    s_barrier
    ds_read_b64_tr_b16 v[224:225], v88 offset:16384
    ds_read_b64_tr_b16 v[226:227], v88 offset:16640
    ds_read_b64_tr_b16 v[232:233], v89 offset:16384
    ds_read_b64_tr_b16 v[234:235], v89 offset:16640
    ds_read_b64_tr_b16 v[240:241], v90 offset:16384
    ds_read_b64_tr_b16 v[242:243], v90 offset:16640
    ds_read_b64_tr_b16 v[248:249], v91 offset:16384
    ds_read_b64_tr_b16 v[250:251], v91 offset:16640
L_lw_79:
    s_waitcnt lgkmcnt(0)
    s_waitcnt vmcnt(16)
    s_barrier
    ds_read_b64_tr_b16 v[228:229], v88 offset:20480
    ds_read_b64_tr_b16 v[230:231], v88 offset:20736
    ds_read_b64_tr_b16 v[236:237], v89 offset:20480
    ds_read_b64_tr_b16 v[238:239], v89 offset:20736
    ds_read_b64_tr_b16 v[244:245], v90 offset:20480
    ds_read_b64_tr_b16 v[246:247], v90 offset:20736
    ds_read_b64_tr_b16 v[252:253], v91 offset:20480
    ds_read_b64_tr_b16 v[254:255], v91 offset:20736
L_lw_80:
    s_waitcnt lgkmcnt(0)
    s_waitcnt vmcnt(12)
    s_barrier
    s_cmp_lg_u32 s44, 0
    s_cbranch_scc1 L_lw_81_0
    ds_read_b64_tr_b16 a[0:1], v80 offset:0
    ds_read_b64_tr_b16 a[2:3], v80 offset:1024
    ds_read_b64_tr_b16 a[4:5], v80 offset:8192
    ds_read_b64_tr_b16 a[6:7], v80 offset:9216
    ds_read_b64_tr_b16 a[8:9], v81 offset:0
    ds_read_b64_tr_b16 a[10:11], v81 offset:1024
    ds_read_b64_tr_b16 a[12:13], v81 offset:8192
    ds_read_b64_tr_b16 a[14:15], v81 offset:9216
    s_branch L_lw_81
L_lw_81_0:
    s_cmp_lg_u32 s44, 1
    s_cbranch_scc1 L_lw_81_1
    ds_read_b64_tr_b16 a[120:121], v80 offset:0
    ds_read_b64_tr_b16 a[122:123], v80 offset:1024
    ds_read_b64_tr_b16 a[124:125], v80 offset:8192
    ds_read_b64_tr_b16 a[126:127], v80 offset:9216
    ds_read_b64_tr_b16 v[56:57], v81 offset:0
    ds_read_b64_tr_b16 v[58:59], v81 offset:1024
    ds_read_b64_tr_b16 v[60:61], v81 offset:8192
    ds_read_b64_tr_b16 v[62:63], v81 offset:9216
    s_waitcnt lgkmcnt(0)
    ds_write_b128 v5, v[56:59] offset:0
    ds_write_b128 v5, v[60:63] offset:1024
    s_branch L_lw_81
L_lw_81_1:
    s_cmp_lg_u32 s44, 2
    s_cbranch_scc1 L_lw_81_2
    ds_read_b64_tr_b16 a[80:81], v80 offset:0
    ds_read_b64_tr_b16 a[82:83], v80 offset:1024
    ds_read_b64_tr_b16 a[84:85], v80 offset:8192
    ds_read_b64_tr_b16 a[86:87], v80 offset:9216
    ds_read_b64_tr_b16 v[56:57], v81 offset:0
    ds_read_b64_tr_b16 v[58:59], v81 offset:1024
    ds_read_b64_tr_b16 v[60:61], v81 offset:8192
    ds_read_b64_tr_b16 v[62:63], v81 offset:9216
    s_waitcnt lgkmcnt(0)
    ds_write_b128 v5, v[56:59] offset:2048
    ds_write_b128 v5, v[60:63] offset:3072
    s_branch L_lw_81
L_lw_81_2:
    ds_read_b64_tr_b16 a[48:49], v80 offset:0
    ds_read_b64_tr_b16 a[50:51], v80 offset:1024
    ds_read_b64_tr_b16 a[52:53], v80 offset:8192
    ds_read_b64_tr_b16 a[54:55], v80 offset:9216
    ds_read_b64_tr_b16 v[56:57], v81 offset:0
    ds_read_b64_tr_b16 v[58:59], v81 offset:1024
    ds_read_b64_tr_b16 v[60:61], v81 offset:8192
    ds_read_b64_tr_b16 v[62:63], v81 offset:9216
    s_waitcnt lgkmcnt(0)
    ds_write_b128 v5, v[56:59] offset:4096
    ds_write_b128 v5, v[60:63] offset:5120
L_lw_81:
    s_waitcnt lgkmcnt(0)
    s_waitcnt vmcnt(8)
    s_barrier
    s_add_u32 s46, s47, 0x200000
    s_add_u32 m0, s48, 0
    s_nop 0
    buffer_load_dwordx4 v82, s[32:35], s46 offen nt lds
    s_add_u32 s46, s47, 0x220000
    s_add_u32 m0, s48, 4096
    s_nop 0
    buffer_load_dwordx4 v82, s[32:35], s46 offen nt lds
    s_add_u32 s46, s47, 0x240000
    s_add_u32 m0, s48, 8192
    s_nop 0
    buffer_load_dwordx4 v82, s[32:35], s46 offen nt lds
    s_add_u32 s46, s47, 0x260000
    s_add_u32 m0, s48, 12288
    s_nop 0
    buffer_load_dwordx4 v82, s[32:35], s46 offen nt lds
    s_cmp_lg_u32 s44, 0
    s_cbranch_scc1 L_lw_82_0
    ds_read_b64_tr_b16 a[16:17], v80 offset:16384
    ds_read_b64_tr_b16 a[18:19], v80 offset:17408
    ds_read_b64_tr_b16 a[20:21], v80 offset:24576
    ds_read_b64_tr_b16 a[22:23], v80 offset:25600
    ds_read_b64_tr_b16 a[24:25], v81 offset:16384
    ds_read_b64_tr_b16 a[26:27], v81 offset:17408
    ds_read_b64_tr_b16 a[28:29], v81 offset:24576
    ds_read_b64_tr_b16 a[30:31], v81 offset:25600
    s_branch L_lw_82
L_lw_82_0:
    s_cmp_lg_u32 s44, 1
    s_cbranch_scc1 L_lw_82_1
    ds_read_b64_tr_b16 a[128:129], v80 offset:16384
    ds_read_b64_tr_b16 a[130:131], v80 offset:17408
    ds_read_b64_tr_b16 a[132:133], v80 offset:24576
    ds_read_b64_tr_b16 a[134:135], v80 offset:25600
    ds_read_b64_tr_b16 a[136:137], v81 offset:16384
    ds_read_b64_tr_b16 a[138:139], v81 offset:17408
    ds_read_b64_tr_b16 a[140:141], v81 offset:24576
    ds_read_b64_tr_b16 a[142:143], v81 offset:25600
    s_branch L_lw_82
L_lw_82_1:
    s_cmp_lg_u32 s44, 2
    s_cbranch_scc1 L_lw_82_2
    ds_read_b64_tr_b16 a[88:89], v80 offset:16384
    ds_read_b64_tr_b16 a[90:91], v80 offset:17408
    ds_read_b64_tr_b16 a[92:93], v80 offset:24576
    ds_read_b64_tr_b16 a[94:95], v80 offset:25600
    ds_read_b64_tr_b16 a[96:97], v81 offset:16384
    ds_read_b64_tr_b16 a[98:99], v81 offset:17408
    ds_read_b64_tr_b16 a[100:101], v81 offset:24576
    ds_read_b64_tr_b16 a[102:103], v81 offset:25600
    s_branch L_lw_82
L_lw_82_2:
    ds_read_b64_tr_b16 a[56:57], v80 offset:16384
    ds_read_b64_tr_b16 a[58:59], v80 offset:17408
    ds_read_b64_tr_b16 a[60:61], v80 offset:24576
    ds_read_b64_tr_b16 a[62:63], v80 offset:25600
    ds_read_b64_tr_b16 v[56:57], v81 offset:16384
    ds_read_b64_tr_b16 v[58:59], v81 offset:17408
    ds_read_b64_tr_b16 v[60:61], v81 offset:24576
    ds_read_b64_tr_b16 v[62:63], v81 offset:25600
    s_waitcnt lgkmcnt(0)
    ds_write_b128 v5, v[56:59] offset:6144
    ds_write_b128 v5, v[60:63] offset:7168
L_lw_82:
    s_waitcnt lgkmcnt(0)
    s_waitcnt vmcnt(8)
    s_barrier
    s_add_u32 s46, s47, 0x280000
    s_add_u32 m0, s48, 16384
    s_nop 0
    buffer_load_dwordx4 v82, s[32:35], s46 offen nt lds
    s_add_u32 s46, s47, 0x2a0000
    s_add_u32 m0, s48, 20480
    s_nop 0
    buffer_load_dwordx4 v82, s[32:35], s46 offen nt lds
    s_add_u32 s46, s47, 0x2c0000
    s_add_u32 m0, s48, 24576
    s_nop 0
    buffer_load_dwordx4 v82, s[32:35], s46 offen nt lds
    s_add_u32 s46, s47, 0x2e0000
    s_add_u32 m0, s48, 28672
    s_nop 0
    buffer_load_dwordx4 v82, s[32:35], s46 offen nt lds
    s_cmp_lg_u32 s44, 0
    s_cbranch_scc1 L_lw_83_0
    ds_read_b64_tr_b16 a[32:33], v80 offset:32768
    ds_read_b64_tr_b16 a[34:35], v80 offset:33792
    ds_read_b64_tr_b16 a[36:37], v80 offset:40960
    ds_read_b64_tr_b16 a[38:39], v80 offset:41984
    ds_read_b64_tr_b16 v[56:57], v81 offset:32768
    ds_read_b64_tr_b16 v[58:59], v81 offset:33792
    ds_read_b64_tr_b16 v[60:61], v81 offset:40960
    ds_read_b64_tr_b16 v[62:63], v81 offset:41984
    s_waitcnt lgkmcnt(0)
    ds_write_b128 v5, v[56:59] offset:8192
    ds_write_b128 v5, v[60:63] offset:9216
    s_branch L_lw_83
L_lw_83_0:
    s_cmp_lg_u32 s44, 1
    s_cbranch_scc1 L_lw_83_1
    ds_read_b64_tr_b16 a[144:145], v80 offset:32768
    ds_read_b64_tr_b16 a[146:147], v80 offset:33792
    ds_read_b64_tr_b16 a[148:149], v80 offset:40960
    ds_read_b64_tr_b16 a[150:151], v80 offset:41984
    ds_read_b64_tr_b16 v[56:57], v81 offset:32768
    ds_read_b64_tr_b16 v[58:59], v81 offset:33792
    ds_read_b64_tr_b16 v[60:61], v81 offset:40960
    ds_read_b64_tr_b16 v[62:63], v81 offset:41984
    s_waitcnt lgkmcnt(0)
    ds_write_b128 v5, v[56:59] offset:10240
    ds_write_b128 v5, v[60:63] offset:11264
    s_branch L_lw_83
L_lw_83_1:
    s_cmp_lg_u32 s44, 2
    s_cbranch_scc1 L_lw_83_2
    ds_read_b64_tr_b16 a[104:105], v80 offset:32768
    ds_read_b64_tr_b16 a[106:107], v80 offset:33792
    ds_read_b64_tr_b16 a[108:109], v80 offset:40960
    ds_read_b64_tr_b16 a[110:111], v80 offset:41984
    ds_read_b64_tr_b16 v[56:57], v81 offset:32768
    ds_read_b64_tr_b16 v[58:59], v81 offset:33792
    ds_read_b64_tr_b16 v[60:61], v81 offset:40960
    ds_read_b64_tr_b16 v[62:63], v81 offset:41984
    s_waitcnt lgkmcnt(0)
    ds_write_b128 v5, v[56:59] offset:12288
    ds_write_b128 v5, v[60:63] offset:13312
    s_branch L_lw_83
L_lw_83_2:
    ds_read_b64_tr_b16 a[64:65], v80 offset:32768
    ds_read_b64_tr_b16 a[66:67], v80 offset:33792
    ds_read_b64_tr_b16 a[68:69], v80 offset:40960
    ds_read_b64_tr_b16 a[70:71], v80 offset:41984
    ds_read_b64_tr_b16 v[56:57], v81 offset:32768
    ds_read_b64_tr_b16 v[58:59], v81 offset:33792
    ds_read_b64_tr_b16 v[60:61], v81 offset:40960
    ds_read_b64_tr_b16 v[62:63], v81 offset:41984
    s_waitcnt lgkmcnt(0)
    ds_write_b128 v5, v[56:59] offset:14336
    ds_write_b128 v5, v[60:63] offset:15360
L_lw_83:
    s_waitcnt lgkmcnt(0)
    s_waitcnt vmcnt(8)
    s_barrier
    s_add_u32 s46, s47, 0x300000
    s_add_u32 m0, s48, 32768
    s_nop 0
    buffer_load_dwordx4 v82, s[32:35], s46 offen nt lds
    s_add_u32 s46, s47, 0x320000
    s_add_u32 m0, s48, 36864
    s_nop 0
    buffer_load_dwordx4 v82, s[32:35], s46 offen nt lds
    s_add_u32 s46, s47, 0x340000
    s_add_u32 m0, s48, 40960
    s_nop 0
    buffer_load_dwordx4 v82, s[32:35], s46 offen nt lds
    s_add_u32 s46, s47, 0x360000
    s_add_u32 m0, s48, 45056
    s_nop 0
    buffer_load_dwordx4 v82, s[32:35], s46 offen nt lds
    s_cmp_lg_u32 s44, 0
    s_cbranch_scc1 L_lw_84_0
    ds_read_b64_tr_b16 a[40:41], v80 offset:49152
    ds_read_b64_tr_b16 a[42:43], v80 offset:50176
    ds_read_b64_tr_b16 a[44:45], v80 offset:57344
    ds_read_b64_tr_b16 a[46:47], v80 offset:58368
    ds_read_b64_tr_b16 v[56:57], v81 offset:49152
    ds_read_b64_tr_b16 v[58:59], v81 offset:50176
    ds_read_b64_tr_b16 v[60:61], v81 offset:57344
    ds_read_b64_tr_b16 v[62:63], v81 offset:58368
    s_waitcnt lgkmcnt(0)
    ds_write_b128 v5, v[56:59] offset:16384
    ds_write_b128 v5, v[60:63] offset:17408
    s_branch L_lw_84
L_lw_84_0:
    s_cmp_lg_u32 s44, 1
    s_cbranch_scc1 L_lw_84_1
    ds_read_b64_tr_b16 a[152:153], v80 offset:49152
    ds_read_b64_tr_b16 a[154:155], v80 offset:50176
    ds_read_b64_tr_b16 a[156:157], v80 offset:57344
    ds_read_b64_tr_b16 a[158:159], v80 offset:58368
    ds_read_b64_tr_b16 v[56:57], v81 offset:49152
    ds_read_b64_tr_b16 v[58:59], v81 offset:50176
    ds_read_b64_tr_b16 v[60:61], v81 offset:57344
    ds_read_b64_tr_b16 v[62:63], v81 offset:58368
    s_waitcnt lgkmcnt(0)
    ds_write_b128 v5, v[56:59] offset:18432
    ds_write_b128 v5, v[60:63] offset:19456
    s_branch L_lw_84
L_lw_84_1:
    s_cmp_lg_u32 s44, 2
    s_cbranch_scc1 L_lw_84_2
    ds_read_b64_tr_b16 a[112:113], v80 offset:49152
    ds_read_b64_tr_b16 a[114:115], v80 offset:50176
    ds_read_b64_tr_b16 a[116:117], v80 offset:57344
    ds_read_b64_tr_b16 a[118:119], v80 offset:58368
    ds_read_b64_tr_b16 v[56:57], v81 offset:49152
    ds_read_b64_tr_b16 v[58:59], v81 offset:50176
    ds_read_b64_tr_b16 v[60:61], v81 offset:57344
    ds_read_b64_tr_b16 v[62:63], v81 offset:58368
    s_waitcnt lgkmcnt(0)
    ds_write_b128 v5, v[56:59] offset:20480
    ds_write_b128 v5, v[60:63] offset:21504
    s_branch L_lw_84
L_lw_84_2:
    ds_read_b64_tr_b16 a[72:73], v80 offset:49152
    ds_read_b64_tr_b16 a[74:75], v80 offset:50176
    ds_read_b64_tr_b16 a[76:77], v80 offset:57344
    ds_read_b64_tr_b16 a[78:79], v80 offset:58368
    ds_read_b64_tr_b16 v[56:57], v81 offset:49152
    ds_read_b64_tr_b16 v[58:59], v81 offset:50176
    ds_read_b64_tr_b16 v[60:61], v81 offset:57344
    ds_read_b64_tr_b16 v[62:63], v81 offset:58368
    s_waitcnt lgkmcnt(0)
    ds_write_b128 v5, v[56:59] offset:22528
    ds_write_b128 v5, v[60:63] offset:23552
L_lw_84:
    s_waitcnt lgkmcnt(0)
    s_waitcnt vmcnt(8)
    s_barrier
    s_add_u32 s46, s47, 0x380000
    s_add_u32 m0, s48, 49152
    s_nop 0
    buffer_load_dwordx4 v82, s[32:35], s46 offen nt lds
    s_add_u32 s46, s47, 0x3a0000
    s_add_u32 m0, s48, 53248
    s_nop 0
    buffer_load_dwordx4 v82, s[32:35], s46 offen nt lds
    s_add_u32 s46, s47, 0x3c0000
    s_add_u32 m0, s48, 57344
    s_nop 0
    buffer_load_dwordx4 v82, s[32:35], s46 offen nt lds
    s_add_u32 s46, s47, 0x3e0000
    s_add_u32 m0, s48, 61440
    s_nop 0
    buffer_load_dwordx4 v82, s[32:35], s46 offen nt lds
    s_cmp_lg_u32 s44, 0
    s_cbranch_scc1 L_lw_85_0
    ds_read_b64_tr_b16 a[48:49], v80 offset:0
    ds_read_b64_tr_b16 a[50:51], v80 offset:1024
    ds_read_b64_tr_b16 a[52:53], v80 offset:8192
    ds_read_b64_tr_b16 a[54:55], v80 offset:9216
    ds_read_b64_tr_b16 v[56:57], v81 offset:0
    ds_read_b64_tr_b16 v[58:59], v81 offset:1024
    ds_read_b64_tr_b16 v[60:61], v81 offset:8192
    ds_read_b64_tr_b16 v[62:63], v81 offset:9216
    s_waitcnt lgkmcnt(0)
    ds_write_b128 v5, v[56:59] offset:4096
    ds_write_b128 v5, v[60:63] offset:5120
    s_branch L_lw_85
L_lw_85_0:
    s_cmp_lg_u32 s44, 1
    s_cbranch_scc1 L_lw_85_1
    ds_read_b64_tr_b16 a[0:1], v80 offset:0
    ds_read_b64_tr_b16 a[2:3], v80 offset:1024
    ds_read_b64_tr_b16 a[4:5], v80 offset:8192
    ds_read_b64_tr_b16 a[6:7], v80 offset:9216
    ds_read_b64_tr_b16 a[8:9], v81 offset:0
    ds_read_b64_tr_b16 a[10:11], v81 offset:1024
    ds_read_b64_tr_b16 a[12:13], v81 offset:8192
    ds_read_b64_tr_b16 a[14:15], v81 offset:9216
    s_branch L_lw_85
L_lw_85_1:
    s_cmp_lg_u32 s44, 2
    s_cbranch_scc1 L_lw_85_2
    ds_read_b64_tr_b16 a[120:121], v80 offset:0
    ds_read_b64_tr_b16 a[122:123], v80 offset:1024
    ds_read_b64_tr_b16 a[124:125], v80 offset:8192
    ds_read_b64_tr_b16 a[126:127], v80 offset:9216
    ds_read_b64_tr_b16 v[56:57], v81 offset:0
    ds_read_b64_tr_b16 v[58:59], v81 offset:1024
    ds_read_b64_tr_b16 v[60:61], v81 offset:8192
    ds_read_b64_tr_b16 v[62:63], v81 offset:9216
    s_waitcnt lgkmcnt(0)
    ds_write_b128 v5, v[56:59] offset:0
    ds_write_b128 v5, v[60:63] offset:1024
    s_branch L_lw_85
L_lw_85_2:
    ds_read_b64_tr_b16 a[80:81], v80 offset:0
    ds_read_b64_tr_b16 a[82:83], v80 offset:1024
    ds_read_b64_tr_b16 a[84:85], v80 offset:8192
    ds_read_b64_tr_b16 a[86:87], v80 offset:9216
    ds_read_b64_tr_b16 v[56:57], v81 offset:0
    ds_read_b64_tr_b16 v[58:59], v81 offset:1024
    ds_read_b64_tr_b16 v[60:61], v81 offset:8192
    ds_read_b64_tr_b16 v[62:63], v81 offset:9216
    s_waitcnt lgkmcnt(0)
    ds_write_b128 v5, v[56:59] offset:2048
    ds_write_b128 v5, v[60:63] offset:3072
L_lw_85:
    s_waitcnt lgkmcnt(0)
    s_waitcnt vmcnt(8)
    s_barrier
    s_add_u32 s46, s47, 0x400000
    s_add_u32 m0, s48, 0
    s_nop 0
    buffer_load_dwordx4 v82, s[32:35], s46 offen nt lds
    s_add_u32 s46, s47, 0x420000
    s_add_u32 m0, s48, 4096
    s_nop 0
    buffer_load_dwordx4 v82, s[32:35], s46 offen nt lds
    s_add_u32 s46, s47, 0x440000
    s_add_u32 m0, s48, 8192
    s_nop 0
    buffer_load_dwordx4 v82, s[32:35], s46 offen nt lds
    s_add_u32 s46, s47, 0x460000
    s_add_u32 m0, s48, 12288
    s_nop 0
    buffer_load_dwordx4 v82, s[32:35], s46 offen nt lds
    s_cmp_lg_u32 s44, 0
    s_cbranch_scc1 L_lw_86_0
    ds_read_b64_tr_b16 a[56:57], v80 offset:16384
    ds_read_b64_tr_b16 a[58:59], v80 offset:17408
    ds_read_b64_tr_b16 a[60:61], v80 offset:24576
    ds_read_b64_tr_b16 a[62:63], v80 offset:25600
    ds_read_b64_tr_b16 v[56:57], v81 offset:16384
    ds_read_b64_tr_b16 v[58:59], v81 offset:17408
    ds_read_b64_tr_b16 v[60:61], v81 offset:24576
    ds_read_b64_tr_b16 v[62:63], v81 offset:25600
    s_waitcnt lgkmcnt(0)
    ds_write_b128 v5, v[56:59] offset:6144
    ds_write_b128 v5, v[60:63] offset:7168
    s_branch L_lw_86
L_lw_86_0:
    s_cmp_lg_u32 s44, 1
    s_cbranch_scc1 L_lw_86_1
    ds_read_b64_tr_b16 a[16:17], v80 offset:16384
    ds_read_b64_tr_b16 a[18:19], v80 offset:17408
    ds_read_b64_tr_b16 a[20:21], v80 offset:24576
    ds_read_b64_tr_b16 a[22:23], v80 offset:25600
    ds_read_b64_tr_b16 a[24:25], v81 offset:16384
    ds_read_b64_tr_b16 a[26:27], v81 offset:17408
    ds_read_b64_tr_b16 a[28:29], v81 offset:24576
    ds_read_b64_tr_b16 a[30:31], v81 offset:25600
    s_branch L_lw_86
L_lw_86_1:
    s_cmp_lg_u32 s44, 2
    s_cbranch_scc1 L_lw_86_2
    ds_read_b64_tr_b16 a[128:129], v80 offset:16384
    ds_read_b64_tr_b16 a[130:131], v80 offset:17408
    ds_read_b64_tr_b16 a[132:133], v80 offset:24576
    ds_read_b64_tr_b16 a[134:135], v80 offset:25600
    ds_read_b64_tr_b16 a[136:137], v81 offset:16384
    ds_read_b64_tr_b16 a[138:139], v81 offset:17408
    ds_read_b64_tr_b16 a[140:141], v81 offset:24576
    ds_read_b64_tr_b16 a[142:143], v81 offset:25600
    s_branch L_lw_86
L_lw_86_2:
    ds_read_b64_tr_b16 a[88:89], v80 offset:16384
    ds_read_b64_tr_b16 a[90:91], v80 offset:17408
    ds_read_b64_tr_b16 a[92:93], v80 offset:24576
    ds_read_b64_tr_b16 a[94:95], v80 offset:25600
    ds_read_b64_tr_b16 a[96:97], v81 offset:16384
    ds_read_b64_tr_b16 a[98:99], v81 offset:17408
    ds_read_b64_tr_b16 a[100:101], v81 offset:24576
    ds_read_b64_tr_b16 a[102:103], v81 offset:25600
L_lw_86:
    s_waitcnt lgkmcnt(0)
    s_waitcnt vmcnt(8)
    s_barrier
    s_add_u32 s46, s47, 0x480000
    s_add_u32 m0, s48, 16384
    s_nop 0
    buffer_load_dwordx4 v82, s[32:35], s46 offen nt lds
    s_add_u32 s46, s47, 0x4a0000
    s_add_u32 m0, s48, 20480
    s_nop 0
    buffer_load_dwordx4 v82, s[32:35], s46 offen nt lds
    s_add_u32 s46, s47, 0x4c0000
    s_add_u32 m0, s48, 24576
    s_nop 0
    buffer_load_dwordx4 v82, s[32:35], s46 offen nt lds
    s_add_u32 s46, s47, 0x4e0000
    s_add_u32 m0, s48, 28672
    s_nop 0
    buffer_load_dwordx4 v82, s[32:35], s46 offen nt lds
    s_cmp_lg_u32 s44, 0
    s_cbranch_scc1 L_lw_87_0
    ds_read_b64_tr_b16 a[64:65], v80 offset:32768
    ds_read_b64_tr_b16 a[66:67], v80 offset:33792
    ds_read_b64_tr_b16 a[68:69], v80 offset:40960
    ds_read_b64_tr_b16 a[70:71], v80 offset:41984
    ds_read_b64_tr_b16 v[56:57], v81 offset:32768
    ds_read_b64_tr_b16 v[58:59], v81 offset:33792
    ds_read_b64_tr_b16 v[60:61], v81 offset:40960
    ds_read_b64_tr_b16 v[62:63], v81 offset:41984
    s_waitcnt lgkmcnt(0)
    ds_write_b128 v5, v[56:59] offset:14336
    ds_write_b128 v5, v[60:63] offset:15360
    s_branch L_lw_87
L_lw_87_0:
    s_cmp_lg_u32 s44, 1
    s_cbranch_scc1 L_lw_87_1
    ds_read_b64_tr_b16 a[32:33], v80 offset:32768
    ds_read_b64_tr_b16 a[34:35], v80 offset:33792
    ds_read_b64_tr_b16 a[36:37], v80 offset:40960
    ds_read_b64_tr_b16 a[38:39], v80 offset:41984
    ds_read_b64_tr_b16 v[56:57], v81 offset:32768
    ds_read_b64_tr_b16 v[58:59], v81 offset:33792
    ds_read_b64_tr_b16 v[60:61], v81 offset:40960
    ds_read_b64_tr_b16 v[62:63], v81 offset:41984
    s_waitcnt lgkmcnt(0)
    ds_write_b128 v5, v[56:59] offset:8192
    ds_write_b128 v5, v[60:63] offset:9216
    s_branch L_lw_87
L_lw_87_1:
    s_cmp_lg_u32 s44, 2
    s_cbranch_scc1 L_lw_87_2
    ds_read_b64_tr_b16 a[144:145], v80 offset:32768
    ds_read_b64_tr_b16 a[146:147], v80 offset:33792
    ds_read_b64_tr_b16 a[148:149], v80 offset:40960
    ds_read_b64_tr_b16 a[150:151], v80 offset:41984
    ds_read_b64_tr_b16 v[56:57], v81 offset:32768
    ds_read_b64_tr_b16 v[58:59], v81 offset:33792
    ds_read_b64_tr_b16 v[60:61], v81 offset:40960
    ds_read_b64_tr_b16 v[62:63], v81 offset:41984
    s_waitcnt lgkmcnt(0)
    ds_write_b128 v5, v[56:59] offset:10240
    ds_write_b128 v5, v[60:63] offset:11264
    s_branch L_lw_87
L_lw_87_2:
    ds_read_b64_tr_b16 a[104:105], v80 offset:32768
    ds_read_b64_tr_b16 a[106:107], v80 offset:33792
    ds_read_b64_tr_b16 a[108:109], v80 offset:40960
    ds_read_b64_tr_b16 a[110:111], v80 offset:41984
    ds_read_b64_tr_b16 v[56:57], v81 offset:32768
    ds_read_b64_tr_b16 v[58:59], v81 offset:33792
    ds_read_b64_tr_b16 v[60:61], v81 offset:40960
    ds_read_b64_tr_b16 v[62:63], v81 offset:41984
    s_waitcnt lgkmcnt(0)
    ds_write_b128 v5, v[56:59] offset:12288
    ds_write_b128 v5, v[60:63] offset:13312
L_lw_87:
    s_waitcnt lgkmcnt(0)
    s_waitcnt vmcnt(8)
    s_barrier
    s_add_u32 s46, s47, 0x500000
    s_add_u32 m0, s48, 32768
    s_nop 0
    buffer_load_dwordx4 v82, s[32:35], s46 offen nt lds
    s_add_u32 s46, s47, 0x520000
    s_add_u32 m0, s48, 36864
    s_nop 0
    buffer_load_dwordx4 v82, s[32:35], s46 offen nt lds
    s_add_u32 s46, s47, 0x540000
    s_add_u32 m0, s48, 40960
    s_nop 0
    buffer_load_dwordx4 v82, s[32:35], s46 offen nt lds
    s_add_u32 s46, s47, 0x560000
    s_add_u32 m0, s48, 45056
    s_nop 0
    buffer_load_dwordx4 v82, s[32:35], s46 offen nt lds
    s_cmp_lg_u32 s44, 0
    s_cbranch_scc1 L_hs_88
    v_mov_b32 v41, 0
    v_mov_b32 v42, 1
    s_mov_b64 exec, 1
    buffer_atomic_add v42, v41, s[16:19], 0 offen sc1
    s_mov_b64 exec, -1
L_hs_88:
    s_cmp_lg_u32 s44, 0
    s_cbranch_scc1 L_lw_89_0
    ds_read_b64_tr_b16 a[72:73], v80 offset:49152
    ds_read_b64_tr_b16 a[74:75], v80 offset:50176
    ds_read_b64_tr_b16 a[76:77], v80 offset:57344
    ds_read_b64_tr_b16 a[78:79], v80 offset:58368
    ds_read_b64_tr_b16 v[56:57], v81 offset:49152
    ds_read_b64_tr_b16 v[58:59], v81 offset:50176
    ds_read_b64_tr_b16 v[60:61], v81 offset:57344
    ds_read_b64_tr_b16 v[62:63], v81 offset:58368
    s_waitcnt lgkmcnt(0)
    ds_write_b128 v5, v[56:59] offset:22528
    ds_write_b128 v5, v[60:63] offset:23552
    s_branch L_lw_89
L_lw_89_0:
    s_cmp_lg_u32 s44, 1
    s_cbranch_scc1 L_lw_89_1
    ds_read_b64_tr_b16 a[40:41], v80 offset:49152
    ds_read_b64_tr_b16 a[42:43], v80 offset:50176
    ds_read_b64_tr_b16 a[44:45], v80 offset:57344
    ds_read_b64_tr_b16 a[46:47], v80 offset:58368
    ds_read_b64_tr_b16 v[56:57], v81 offset:49152
    ds_read_b64_tr_b16 v[58:59], v81 offset:50176
    ds_read_b64_tr_b16 v[60:61], v81 offset:57344
    ds_read_b64_tr_b16 v[62:63], v81 offset:58368
    s_waitcnt lgkmcnt(0)
    ds_write_b128 v5, v[56:59] offset:16384
    ds_write_b128 v5, v[60:63] offset:17408
    s_branch L_lw_89
L_lw_89_1:
    s_cmp_lg_u32 s44, 2
    s_cbranch_scc1 L_lw_89_2
    ds_read_b64_tr_b16 a[152:153], v80 offset:49152
    ds_read_b64_tr_b16 a[154:155], v80 offset:50176
    ds_read_b64_tr_b16 a[156:157], v80 offset:57344
    ds_read_b64_tr_b16 a[158:159], v80 offset:58368
    ds_read_b64_tr_b16 v[56:57], v81 offset:49152
    ds_read_b64_tr_b16 v[58:59], v81 offset:50176
    ds_read_b64_tr_b16 v[60:61], v81 offset:57344
    ds_read_b64_tr_b16 v[62:63], v81 offset:58368
    s_waitcnt lgkmcnt(0)
    ds_write_b128 v5, v[56:59] offset:18432
    ds_write_b128 v5, v[60:63] offset:19456
    s_branch L_lw_89
L_lw_89_2:
    ds_read_b64_tr_b16 a[112:113], v80 offset:49152
    ds_read_b64_tr_b16 a[114:115], v80 offset:50176
    ds_read_b64_tr_b16 a[116:117], v80 offset:57344
    ds_read_b64_tr_b16 a[118:119], v80 offset:58368
    ds_read_b64_tr_b16 v[56:57], v81 offset:49152
    ds_read_b64_tr_b16 v[58:59], v81 offset:50176
    ds_read_b64_tr_b16 v[60:61], v81 offset:57344
    ds_read_b64_tr_b16 v[62:63], v81 offset:58368
    s_waitcnt lgkmcnt(0)
    ds_write_b128 v5, v[56:59] offset:20480
    ds_write_b128 v5, v[60:63] offset:21504
L_lw_89:
    s_waitcnt lgkmcnt(0)
    s_waitcnt vmcnt(8)
    s_barrier
    s_add_u32 s46, s47, 0x580000
    s_add_u32 m0, s48, 49152
    s_nop 0
    buffer_load_dwordx4 v82, s[32:35], s46 offen nt lds
    s_add_u32 s46, s47, 0x5a0000
    s_add_u32 m0, s48, 53248
    s_nop 0
    buffer_load_dwordx4 v82, s[32:35], s46 offen nt lds
    s_add_u32 s46, s47, 0x5c0000
    s_add_u32 m0, s48, 57344
    s_nop 0
    buffer_load_dwordx4 v82, s[32:35], s46 offen nt lds
    s_add_u32 s46, s47, 0x5e0000
    s_add_u32 m0, s48, 61440
    s_nop 0
    buffer_load_dwordx4 v82, s[32:35], s46 offen nt lds
    s_cmp_lg_u32 s44, 0
    s_cbranch_scc1 L_lw_90_0
    ds_read_b64_tr_b16 a[80:81], v80 offset:0
    ds_read_b64_tr_b16 a[82:83], v80 offset:1024
    ds_read_b64_tr_b16 a[84:85], v80 offset:8192
    ds_read_b64_tr_b16 a[86:87], v80 offset:9216
    ds_read_b64_tr_b16 v[56:57], v81 offset:0
    ds_read_b64_tr_b16 v[58:59], v81 offset:1024
    ds_read_b64_tr_b16 v[60:61], v81 offset:8192
    ds_read_b64_tr_b16 v[62:63], v81 offset:9216
    s_waitcnt lgkmcnt(0)
    ds_write_b128 v5, v[56:59] offset:2048
    ds_write_b128 v5, v[60:63] offset:3072
    s_branch L_lw_90
L_lw_90_0:
    s_cmp_lg_u32 s44, 1
    s_cbranch_scc1 L_lw_90_1
    ds_read_b64_tr_b16 a[48:49], v80 offset:0
    ds_read_b64_tr_b16 a[50:51], v80 offset:1024
    ds_read_b64_tr_b16 a[52:53], v80 offset:8192
    ds_read_b64_tr_b16 a[54:55], v80 offset:9216
    ds_read_b64_tr_b16 v[56:57], v81 offset:0
    ds_read_b64_tr_b16 v[58:59], v81 offset:1024
    ds_read_b64_tr_b16 v[60:61], v81 offset:8192
    ds_read_b64_tr_b16 v[62:63], v81 offset:9216
    s_waitcnt lgkmcnt(0)
    ds_write_b128 v5, v[56:59] offset:4096
    ds_write_b128 v5, v[60:63] offset:5120
    s_branch L_lw_90
L_lw_90_1:
    s_cmp_lg_u32 s44, 2
    s_cbranch_scc1 L_lw_90_2
    ds_read_b64_tr_b16 a[0:1], v80 offset:0
    ds_read_b64_tr_b16 a[2:3], v80 offset:1024
    ds_read_b64_tr_b16 a[4:5], v80 offset:8192
    ds_read_b64_tr_b16 a[6:7], v80 offset:9216
    ds_read_b64_tr_b16 a[8:9], v81 offset:0
    ds_read_b64_tr_b16 a[10:11], v81 offset:1024
    ds_read_b64_tr_b16 a[12:13], v81 offset:8192
    ds_read_b64_tr_b16 a[14:15], v81 offset:9216
    s_branch L_lw_90
L_lw_90_2:
    ds_read_b64_tr_b16 a[120:121], v80 offset:0
    ds_read_b64_tr_b16 a[122:123], v80 offset:1024
    ds_read_b64_tr_b16 a[124:125], v80 offset:8192
    ds_read_b64_tr_b16 a[126:127], v80 offset:9216
    ds_read_b64_tr_b16 v[56:57], v81 offset:0
    ds_read_b64_tr_b16 v[58:59], v81 offset:1024
    ds_read_b64_tr_b16 v[60:61], v81 offset:8192
    ds_read_b64_tr_b16 v[62:63], v81 offset:9216
    s_waitcnt lgkmcnt(0)
    ds_write_b128 v5, v[56:59] offset:0
    ds_write_b128 v5, v[60:63] offset:1024
L_lw_90:
    s_waitcnt lgkmcnt(0)
    s_waitcnt vmcnt(8)
    s_barrier
    s_add_u32 s46, s47, 0x600000
    s_add_u32 m0, s48, 0
    s_nop 0
    buffer_load_dwordx4 v82, s[32:35], s46 offen nt lds
    s_add_u32 s46, s47, 0x620000
    s_add_u32 m0, s48, 4096
    s_nop 0
    buffer_load_dwordx4 v82, s[32:35], s46 offen nt lds
    s_add_u32 s46, s47, 0x640000
    s_add_u32 m0, s48, 8192
    s_nop 0
    buffer_load_dwordx4 v82, s[32:35], s46 offen nt lds
    s_add_u32 s46, s47, 0x660000
    s_add_u32 m0, s48, 12288
    s_nop 0
    buffer_load_dwordx4 v82, s[32:35], s46 offen nt lds
    s_cmp_lg_u32 s44, 0
    s_cbranch_scc1 L_lw_91_0
    ds_read_b64_tr_b16 a[88:89], v80 offset:16384
    ds_read_b64_tr_b16 a[90:91], v80 offset:17408
    ds_read_b64_tr_b16 a[92:93], v80 offset:24576
    ds_read_b64_tr_b16 a[94:95], v80 offset:25600
    ds_read_b64_tr_b16 a[96:97], v81 offset:16384
    ds_read_b64_tr_b16 a[98:99], v81 offset:17408
    ds_read_b64_tr_b16 a[100:101], v81 offset:24576
    ds_read_b64_tr_b16 a[102:103], v81 offset:25600
    s_branch L_lw_91
L_lw_91_0:
    s_cmp_lg_u32 s44, 1
    s_cbranch_scc1 L_lw_91_1
    ds_read_b64_tr_b16 a[56:57], v80 offset:16384
    ds_read_b64_tr_b16 a[58:59], v80 offset:17408
    ds_read_b64_tr_b16 a[60:61], v80 offset:24576
    ds_read_b64_tr_b16 a[62:63], v80 offset:25600
    ds_read_b64_tr_b16 v[56:57], v81 offset:16384
    ds_read_b64_tr_b16 v[58:59], v81 offset:17408
    ds_read_b64_tr_b16 v[60:61], v81 offset:24576
    ds_read_b64_tr_b16 v[62:63], v81 offset:25600
    s_waitcnt lgkmcnt(0)
    ds_write_b128 v5, v[56:59] offset:6144
    ds_write_b128 v5, v[60:63] offset:7168
    s_branch L_lw_91
L_lw_91_1:
    s_cmp_lg_u32 s44, 2
    s_cbranch_scc1 L_lw_91_2
    ds_read_b64_tr_b16 a[16:17], v80 offset:16384
    ds_read_b64_tr_b16 a[18:19], v80 offset:17408
    ds_read_b64_tr_b16 a[20:21], v80 offset:24576
    ds_read_b64_tr_b16 a[22:23], v80 offset:25600
    ds_read_b64_tr_b16 a[24:25], v81 offset:16384
    ds_read_b64_tr_b16 a[26:27], v81 offset:17408
    ds_read_b64_tr_b16 a[28:29], v81 offset:24576
    ds_read_b64_tr_b16 a[30:31], v81 offset:25600
    s_branch L_lw_91
L_lw_91_2:
    ds_read_b64_tr_b16 a[128:129], v80 offset:16384
    ds_read_b64_tr_b16 a[130:131], v80 offset:17408
    ds_read_b64_tr_b16 a[132:133], v80 offset:24576
    ds_read_b64_tr_b16 a[134:135], v80 offset:25600
    ds_read_b64_tr_b16 a[136:137], v81 offset:16384
    ds_read_b64_tr_b16 a[138:139], v81 offset:17408
    ds_read_b64_tr_b16 a[140:141], v81 offset:24576
    ds_read_b64_tr_b16 a[142:143], v81 offset:25600
L_lw_91:
    s_waitcnt lgkmcnt(0)
    s_waitcnt vmcnt(8)
    s_barrier
    s_add_u32 s46, s47, 0x680000
    s_add_u32 m0, s48, 16384
    s_nop 0
    buffer_load_dwordx4 v82, s[32:35], s46 offen nt lds
    s_add_u32 s46, s47, 0x6a0000
    s_add_u32 m0, s48, 20480
    s_nop 0
    buffer_load_dwordx4 v82, s[32:35], s46 offen nt lds
    s_add_u32 s46, s47, 0x6c0000
    s_add_u32 m0, s48, 24576
    s_nop 0
    buffer_load_dwordx4 v82, s[32:35], s46 offen nt lds
    s_add_u32 s46, s47, 0x6e0000
    s_add_u32 m0, s48, 28672
    s_nop 0
    buffer_load_dwordx4 v82, s[32:35], s46 offen nt lds
    s_cmp_lg_u32 s44, 0
    s_cbranch_scc1 L_lw_92_0
    ds_read_b64_tr_b16 a[104:105], v80 offset:32768
    ds_read_b64_tr_b16 a[106:107], v80 offset:33792
    ds_read_b64_tr_b16 a[108:109], v80 offset:40960
    ds_read_b64_tr_b16 a[110:111], v80 offset:41984
    ds_read_b64_tr_b16 v[56:57], v81 offset:32768
    ds_read_b64_tr_b16 v[58:59], v81 offset:33792
    ds_read_b64_tr_b16 v[60:61], v81 offset:40960
    ds_read_b64_tr_b16 v[62:63], v81 offset:41984
    s_waitcnt lgkmcnt(0)
    ds_write_b128 v5, v[56:59] offset:12288
    ds_write_b128 v5, v[60:63] offset:13312
    s_branch L_lw_92
L_lw_92_0:
    s_cmp_lg_u32 s44, 1
    s_cbranch_scc1 L_lw_92_1
    ds_read_b64_tr_b16 a[64:65], v80 offset:32768
    ds_read_b64_tr_b16 a[66:67], v80 offset:33792
    ds_read_b64_tr_b16 a[68:69], v80 offset:40960
    ds_read_b64_tr_b16 a[70:71], v80 offset:41984
    ds_read_b64_tr_b16 v[56:57], v81 offset:32768
    ds_read_b64_tr_b16 v[58:59], v81 offset:33792
    ds_read_b64_tr_b16 v[60:61], v81 offset:40960
    ds_read_b64_tr_b16 v[62:63], v81 offset:41984
    s_waitcnt lgkmcnt(0)
    ds_write_b128 v5, v[56:59] offset:14336
    ds_write_b128 v5, v[60:63] offset:15360
    s_branch L_lw_92
L_lw_92_1:
    s_cmp_lg_u32 s44, 2
    s_cbranch_scc1 L_lw_92_2
    ds_read_b64_tr_b16 a[32:33], v80 offset:32768
    ds_read_b64_tr_b16 a[34:35], v80 offset:33792
    ds_read_b64_tr_b16 a[36:37], v80 offset:40960
    ds_read_b64_tr_b16 a[38:39], v80 offset:41984
    ds_read_b64_tr_b16 v[56:57], v81 offset:32768
    ds_read_b64_tr_b16 v[58:59], v81 offset:33792
    ds_read_b64_tr_b16 v[60:61], v81 offset:40960
    ds_read_b64_tr_b16 v[62:63], v81 offset:41984
    s_waitcnt lgkmcnt(0)
    ds_write_b128 v5, v[56:59] offset:8192
    ds_write_b128 v5, v[60:63] offset:9216
    s_branch L_lw_92
L_lw_92_2:
    ds_read_b64_tr_b16 a[144:145], v80 offset:32768
    ds_read_b64_tr_b16 a[146:147], v80 offset:33792
    ds_read_b64_tr_b16 a[148:149], v80 offset:40960
    ds_read_b64_tr_b16 a[150:151], v80 offset:41984
    ds_read_b64_tr_b16 v[56:57], v81 offset:32768
    ds_read_b64_tr_b16 v[58:59], v81 offset:33792
    ds_read_b64_tr_b16 v[60:61], v81 offset:40960
    ds_read_b64_tr_b16 v[62:63], v81 offset:41984
    s_waitcnt lgkmcnt(0)
    ds_write_b128 v5, v[56:59] offset:10240
    ds_write_b128 v5, v[60:63] offset:11264
L_lw_92:
    s_waitcnt lgkmcnt(0)
    s_waitcnt vmcnt(8)
    s_barrier
    s_add_u32 s46, s47, 0x700000
    s_add_u32 m0, s48, 32768
    s_nop 0
    buffer_load_dwordx4 v82, s[32:35], s46 offen nt lds
    s_add_u32 s46, s47, 0x720000
    s_add_u32 m0, s48, 36864
    s_nop 0
    buffer_load_dwordx4 v82, s[32:35], s46 offen nt lds
    s_add_u32 s46, s47, 0x740000
    s_add_u32 m0, s48, 40960
    s_nop 0
    buffer_load_dwordx4 v82, s[32:35], s46 offen nt lds
    s_add_u32 s46, s47, 0x760000
    s_add_u32 m0, s48, 45056
    s_nop 0
    buffer_load_dwordx4 v82, s[32:35], s46 offen nt lds
    s_cmp_lg_u32 s44, 0
    s_cbranch_scc1 L_lw_93_0
    ds_read_b64_tr_b16 a[112:113], v80 offset:49152
    ds_read_b64_tr_b16 a[114:115], v80 offset:50176
    ds_read_b64_tr_b16 a[116:117], v80 offset:57344
    ds_read_b64_tr_b16 a[118:119], v80 offset:58368
    ds_read_b64_tr_b16 v[56:57], v81 offset:49152
    ds_read_b64_tr_b16 v[58:59], v81 offset:50176
    ds_read_b64_tr_b16 v[60:61], v81 offset:57344
    ds_read_b64_tr_b16 v[62:63], v81 offset:58368
    s_waitcnt lgkmcnt(0)
    ds_write_b128 v5, v[56:59] offset:20480
    ds_write_b128 v5, v[60:63] offset:21504
    s_branch L_lw_93
L_lw_93_0:
    s_cmp_lg_u32 s44, 1
    s_cbranch_scc1 L_lw_93_1
    ds_read_b64_tr_b16 a[72:73], v80 offset:49152
    ds_read_b64_tr_b16 a[74:75], v80 offset:50176
    ds_read_b64_tr_b16 a[76:77], v80 offset:57344
    ds_read_b64_tr_b16 a[78:79], v80 offset:58368
    ds_read_b64_tr_b16 v[56:57], v81 offset:49152
    ds_read_b64_tr_b16 v[58:59], v81 offset:50176
    ds_read_b64_tr_b16 v[60:61], v81 offset:57344
    ds_read_b64_tr_b16 v[62:63], v81 offset:58368
    s_waitcnt lgkmcnt(0)
    ds_write_b128 v5, v[56:59] offset:22528
    ds_write_b128 v5, v[60:63] offset:23552
    s_branch L_lw_93
L_lw_93_1:
    s_cmp_lg_u32 s44, 2
    s_cbranch_scc1 L_lw_93_2
    ds_read_b64_tr_b16 a[40:41], v80 offset:49152
    ds_read_b64_tr_b16 a[42:43], v80 offset:50176
    ds_read_b64_tr_b16 a[44:45], v80 offset:57344
    ds_read_b64_tr_b16 a[46:47], v80 offset:58368
    ds_read_b64_tr_b16 v[56:57], v81 offset:49152
    ds_read_b64_tr_b16 v[58:59], v81 offset:50176
    ds_read_b64_tr_b16 v[60:61], v81 offset:57344
    ds_read_b64_tr_b16 v[62:63], v81 offset:58368
    s_waitcnt lgkmcnt(0)
    ds_write_b128 v5, v[56:59] offset:16384
    ds_write_b128 v5, v[60:63] offset:17408
    s_branch L_lw_93
L_lw_93_2:
    ds_read_b64_tr_b16 a[152:153], v80 offset:49152
    ds_read_b64_tr_b16 a[154:155], v80 offset:50176
    ds_read_b64_tr_b16 a[156:157], v80 offset:57344
    ds_read_b64_tr_b16 a[158:159], v80 offset:58368
    ds_read_b64_tr_b16 v[56:57], v81 offset:49152
    ds_read_b64_tr_b16 v[58:59], v81 offset:50176
    ds_read_b64_tr_b16 v[60:61], v81 offset:57344
    ds_read_b64_tr_b16 v[62:63], v81 offset:58368
    s_waitcnt lgkmcnt(0)
    ds_write_b128 v5, v[56:59] offset:18432
    ds_write_b128 v5, v[60:63] offset:19456
L_lw_93:
    s_waitcnt lgkmcnt(0)
    s_waitcnt vmcnt(8)
    s_barrier
    s_add_u32 s46, s47, 0x780000
    s_add_u32 m0, s48, 49152
    s_nop 0
    buffer_load_dwordx4 v82, s[32:35], s46 offen nt lds
    s_add_u32 s46, s47, 0x7a0000
    s_add_u32 m0, s48, 53248
    s_nop 0
    buffer_load_dwordx4 v82, s[32:35], s46 offen nt lds
    s_add_u32 s46, s47, 0x7c0000
    s_add_u32 m0, s48, 57344
    s_nop 0
    buffer_load_dwordx4 v82, s[32:35], s46 offen nt lds
    s_add_u32 s46, s47, 0x7e0000
    s_add_u32 m0, s48, 61440
    s_nop 0
    buffer_load_dwordx4 v82, s[32:35], s46 offen nt lds
    s_cmp_lg_u32 s44, 0
    s_cbranch_scc1 L_lw_94_0
    ds_read_b64_tr_b16 a[120:121], v80 offset:0
    ds_read_b64_tr_b16 a[122:123], v80 offset:1024
    ds_read_b64_tr_b16 a[124:125], v80 offset:8192
    ds_read_b64_tr_b16 a[126:127], v80 offset:9216
    ds_read_b64_tr_b16 v[56:57], v81 offset:0
    ds_read_b64_tr_b16 v[58:59], v81 offset:1024
    ds_read_b64_tr_b16 v[60:61], v81 offset:8192
    ds_read_b64_tr_b16 v[62:63], v81 offset:9216
    s_waitcnt lgkmcnt(0)
    ds_write_b128 v5, v[56:59] offset:0
    ds_write_b128 v5, v[60:63] offset:1024
    s_branch L_lw_94
L_lw_94_0:
    s_cmp_lg_u32 s44, 1
    s_cbranch_scc1 L_lw_94_1
    ds_read_b64_tr_b16 a[80:81], v80 offset:0
    ds_read_b64_tr_b16 a[82:83], v80 offset:1024
    ds_read_b64_tr_b16 a[84:85], v80 offset:8192
    ds_read_b64_tr_b16 a[86:87], v80 offset:9216
    ds_read_b64_tr_b16 v[56:57], v81 offset:0
    ds_read_b64_tr_b16 v[58:59], v81 offset:1024
    ds_read_b64_tr_b16 v[60:61], v81 offset:8192
    ds_read_b64_tr_b16 v[62:63], v81 offset:9216
    s_waitcnt lgkmcnt(0)
    ds_write_b128 v5, v[56:59] offset:2048
    ds_write_b128 v5, v[60:63] offset:3072
    s_branch L_lw_94
L_lw_94_1:
    s_cmp_lg_u32 s44, 2
    s_cbranch_scc1 L_lw_94_2
    ds_read_b64_tr_b16 a[48:49], v80 offset:0
    ds_read_b64_tr_b16 a[50:51], v80 offset:1024
    ds_read_b64_tr_b16 a[52:53], v80 offset:8192
    ds_read_b64_tr_b16 a[54:55], v80 offset:9216
    ds_read_b64_tr_b16 v[56:57], v81 offset:0
    ds_read_b64_tr_b16 v[58:59], v81 offset:1024
    ds_read_b64_tr_b16 v[60:61], v81 offset:8192
    ds_read_b64_tr_b16 v[62:63], v81 offset:9216
    s_waitcnt lgkmcnt(0)
    ds_write_b128 v5, v[56:59] offset:4096
    ds_write_b128 v5, v[60:63] offset:5120
    s_branch L_lw_94
L_lw_94_2:
    ds_read_b64_tr_b16 a[0:1], v80 offset:0
    ds_read_b64_tr_b16 a[2:3], v80 offset:1024
    ds_read_b64_tr_b16 a[4:5], v80 offset:8192
    ds_read_b64_tr_b16 a[6:7], v80 offset:9216
    ds_read_b64_tr_b16 a[8:9], v81 offset:0
    ds_read_b64_tr_b16 a[10:11], v81 offset:1024
    ds_read_b64_tr_b16 a[12:13], v81 offset:8192
    ds_read_b64_tr_b16 a[14:15], v81 offset:9216
L_lw_94:
    s_waitcnt lgkmcnt(0)
    s_waitcnt vmcnt(8)
    s_barrier
    s_cmp_lg_u32 s44, 0
    s_cbranch_scc1 L_lw_95_0
    ds_read_b64_tr_b16 a[128:129], v80 offset:16384
    ds_read_b64_tr_b16 a[130:131], v80 offset:17408
    ds_read_b64_tr_b16 a[132:133], v80 offset:24576
    ds_read_b64_tr_b16 a[134:135], v80 offset:25600
    ds_read_b64_tr_b16 a[136:137], v81 offset:16384
    ds_read_b64_tr_b16 a[138:139], v81 offset:17408
    ds_read_b64_tr_b16 a[140:141], v81 offset:24576
    ds_read_b64_tr_b16 a[142:143], v81 offset:25600
    s_branch L_lw_95
L_lw_95_0:
    s_cmp_lg_u32 s44, 1
    s_cbranch_scc1 L_lw_95_1
    ds_read_b64_tr_b16 a[88:89], v80 offset:16384
    ds_read_b64_tr_b16 a[90:91], v80 offset:17408
    ds_read_b64_tr_b16 a[92:93], v80 offset:24576
    ds_read_b64_tr_b16 a[94:95], v80 offset:25600
    ds_read_b64_tr_b16 a[96:97], v81 offset:16384
    ds_read_b64_tr_b16 a[98:99], v81 offset:17408
    ds_read_b64_tr_b16 a[100:101], v81 offset:24576
    ds_read_b64_tr_b16 a[102:103], v81 offset:25600
    s_branch L_lw_95
L_lw_95_1:
    s_cmp_lg_u32 s44, 2
    s_cbranch_scc1 L_lw_95_2
    ds_read_b64_tr_b16 a[56:57], v80 offset:16384
    ds_read_b64_tr_b16 a[58:59], v80 offset:17408
    ds_read_b64_tr_b16 a[60:61], v80 offset:24576
    ds_read_b64_tr_b16 a[62:63], v80 offset:25600
    ds_read_b64_tr_b16 v[56:57], v81 offset:16384
    ds_read_b64_tr_b16 v[58:59], v81 offset:17408
    ds_read_b64_tr_b16 v[60:61], v81 offset:24576
    ds_read_b64_tr_b16 v[62:63], v81 offset:25600
    s_waitcnt lgkmcnt(0)
    ds_write_b128 v5, v[56:59] offset:6144
    ds_write_b128 v5, v[60:63] offset:7168
    s_branch L_lw_95
L_lw_95_2:
    ds_read_b64_tr_b16 a[16:17], v80 offset:16384
    ds_read_b64_tr_b16 a[18:19], v80 offset:17408
    ds_read_b64_tr_b16 a[20:21], v80 offset:24576
    ds_read_b64_tr_b16 a[22:23], v80 offset:25600
    ds_read_b64_tr_b16 a[24:25], v81 offset:16384
    ds_read_b64_tr_b16 a[26:27], v81 offset:17408
    ds_read_b64_tr_b16 a[28:29], v81 offset:24576
    ds_read_b64_tr_b16 a[30:31], v81 offset:25600
L_lw_95:
    s_waitcnt lgkmcnt(0)
    s_waitcnt vmcnt(4)
    s_barrier
    s_cmp_lg_u32 s44, 0
    s_cbranch_scc1 L_lw_96_0
    ds_read_b64_tr_b16 a[144:145], v80 offset:32768
    ds_read_b64_tr_b16 a[146:147], v80 offset:33792
    ds_read_b64_tr_b16 a[148:149], v80 offset:40960
    ds_read_b64_tr_b16 a[150:151], v80 offset:41984
    ds_read_b64_tr_b16 v[56:57], v81 offset:32768
    ds_read_b64_tr_b16 v[58:59], v81 offset:33792
    ds_read_b64_tr_b16 v[60:61], v81 offset:40960
    ds_read_b64_tr_b16 v[62:63], v81 offset:41984
    s_waitcnt lgkmcnt(0)
    ds_write_b128 v5, v[56:59] offset:10240
    ds_write_b128 v5, v[60:63] offset:11264
    s_branch L_lw_96
L_lw_96_0:
    s_cmp_lg_u32 s44, 1
    s_cbranch_scc1 L_lw_96_1
    ds_read_b64_tr_b16 a[104:105], v80 offset:32768
    ds_read_b64_tr_b16 a[106:107], v80 offset:33792
    ds_read_b64_tr_b16 a[108:109], v80 offset:40960
    ds_read_b64_tr_b16 a[110:111], v80 offset:41984
    ds_read_b64_tr_b16 v[56:57], v81 offset:32768
    ds_read_b64_tr_b16 v[58:59], v81 offset:33792
    ds_read_b64_tr_b16 v[60:61], v81 offset:40960
    ds_read_b64_tr_b16 v[62:63], v81 offset:41984
    s_waitcnt lgkmcnt(0)
    ds_write_b128 v5, v[56:59] offset:12288
    ds_write_b128 v5, v[60:63] offset:13312
    s_branch L_lw_96
L_lw_96_1:
    s_cmp_lg_u32 s44, 2
    s_cbranch_scc1 L_lw_96_2
    ds_read_b64_tr_b16 a[64:65], v80 offset:32768
    ds_read_b64_tr_b16 a[66:67], v80 offset:33792
    ds_read_b64_tr_b16 a[68:69], v80 offset:40960
    ds_read_b64_tr_b16 a[70:71], v80 offset:41984
    ds_read_b64_tr_b16 v[56:57], v81 offset:32768
    ds_read_b64_tr_b16 v[58:59], v81 offset:33792
    ds_read_b64_tr_b16 v[60:61], v81 offset:40960
    ds_read_b64_tr_b16 v[62:63], v81 offset:41984
    s_waitcnt lgkmcnt(0)
    ds_write_b128 v5, v[56:59] offset:14336
    ds_write_b128 v5, v[60:63] offset:15360
    s_branch L_lw_96
L_lw_96_2:
    ds_read_b64_tr_b16 a[32:33], v80 offset:32768
    ds_read_b64_tr_b16 a[34:35], v80 offset:33792
    ds_read_b64_tr_b16 a[36:37], v80 offset:40960
    ds_read_b64_tr_b16 a[38:39], v80 offset:41984
    ds_read_b64_tr_b16 v[56:57], v81 offset:32768
    ds_read_b64_tr_b16 v[58:59], v81 offset:33792
    ds_read_b64_tr_b16 v[60:61], v81 offset:40960
    ds_read_b64_tr_b16 v[62:63], v81 offset:41984
    s_waitcnt lgkmcnt(0)
    ds_write_b128 v5, v[56:59] offset:8192
    ds_write_b128 v5, v[60:63] offset:9216
L_lw_96:
    s_waitcnt lgkmcnt(0)
    s_waitcnt vmcnt(0)
    s_barrier
    s_cmp_lg_u32 s44, 0
    s_cbranch_scc1 L_lw_97_0
    ds_read_b64_tr_b16 a[152:153], v80 offset:49152
    ds_read_b64_tr_b16 a[154:155], v80 offset:50176
    ds_read_b64_tr_b16 a[156:157], v80 offset:57344
    ds_read_b64_tr_b16 a[158:159], v80 offset:58368
    ds_read_b64_tr_b16 v[56:57], v81 offset:49152
    ds_read_b64_tr_b16 v[58:59], v81 offset:50176
    ds_read_b64_tr_b16 v[60:61], v81 offset:57344
    ds_read_b64_tr_b16 v[62:63], v81 offset:58368
    s_waitcnt lgkmcnt(0)
    ds_write_b128 v5, v[56:59] offset:18432
    ds_write_b128 v5, v[60:63] offset:19456
    s_branch L_lw_97
L_lw_97_0:
    s_cmp_lg_u32 s44, 1
    s_cbranch_scc1 L_lw_97_1
    ds_read_b64_tr_b16 a[112:113], v80 offset:49152
    ds_read_b64_tr_b16 a[114:115], v80 offset:50176
    ds_read_b64_tr_b16 a[116:117], v80 offset:57344
    ds_read_b64_tr_b16 a[118:119], v80 offset:58368
    ds_read_b64_tr_b16 v[56:57], v81 offset:49152
    ds_read_b64_tr_b16 v[58:59], v81 offset:50176
    ds_read_b64_tr_b16 v[60:61], v81 offset:57344
    ds_read_b64_tr_b16 v[62:63], v81 offset:58368
    s_waitcnt lgkmcnt(0)
    ds_write_b128 v5, v[56:59] offset:20480
    ds_write_b128 v5, v[60:63] offset:21504
    s_branch L_lw_97
L_lw_97_1:
    s_cmp_lg_u32 s44, 2
    s_cbranch_scc1 L_lw_97_2
    ds_read_b64_tr_b16 a[72:73], v80 offset:49152
    ds_read_b64_tr_b16 a[74:75], v80 offset:50176
    ds_read_b64_tr_b16 a[76:77], v80 offset:57344
    ds_read_b64_tr_b16 a[78:79], v80 offset:58368
    ds_read_b64_tr_b16 v[56:57], v81 offset:49152
    ds_read_b64_tr_b16 v[58:59], v81 offset:50176
    ds_read_b64_tr_b16 v[60:61], v81 offset:57344
    ds_read_b64_tr_b16 v[62:63], v81 offset:58368
    s_waitcnt lgkmcnt(0)
    ds_write_b128 v5, v[56:59] offset:22528
    ds_write_b128 v5, v[60:63] offset:23552
    s_branch L_lw_97
L_lw_97_2:
    ds_read_b64_tr_b16 a[40:41], v80 offset:49152
    ds_read_b64_tr_b16 a[42:43], v80 offset:50176
    ds_read_b64_tr_b16 a[44:45], v80 offset:57344
    ds_read_b64_tr_b16 a[46:47], v80 offset:58368
    ds_read_b64_tr_b16 v[56:57], v81 offset:49152
    ds_read_b64_tr_b16 v[58:59], v81 offset:50176
    ds_read_b64_tr_b16 v[60:61], v81 offset:57344
    ds_read_b64_tr_b16 v[62:63], v81 offset:58368
    s_waitcnt lgkmcnt(0)
    ds_write_b128 v5, v[56:59] offset:16384
    ds_write_b128 v5, v[60:63] offset:17408
L_lw_97:
    s_waitcnt lgkmcnt(0)
    s_barrier
    v_lshlrev_b32 v68, 4, v1
    s_mul_i32 s45, s44, 3072
    s_add_u32 s45, s45, 53248
    v_add_u32 v6, s45, v68
    s_sub_u32 s45, s44, 1
    s_and_b32 s45, s45, 3
    s_mul_i32 s45, s45, 3072
    s_add_u32 s45, s45, 53248
    v_add_u32 v7, s45, v68
    s_sub_u32 s45, s44, 2
    s_and_b32 s45, s45, 3
    s_mul_i32 s45, s45, 3072
    s_add_u32 s45, s45, 54272
    v_add_u32 v8, s45, v68
    s_sub_u32 s45, s44, 3
    s_and_b32 s45, s45, 3
    s_mul_i32 s45, s45, 3072
    s_add_u32 s45, s45, 55296
    v_add_u32 v18, s45, v68
    v_lshlrev_b32 v68, 4, v1
    s_add_u32 s45, s69, 0
    s_and_b32 s45, s45, 7
    s_lshl_b32 s45, s45, 10
    s_lshl_b32 s46, s44, 13
    s_add_u32 s45, s45, s46
    v_add_u32 v80, s45, v68
    s_add_u32 s45, s69, 1
    s_and_b32 s45, s45, 7
    s_lshl_b32 s45, s45, 10
    s_lshl_b32 s46, s44, 13
    s_add_u32 s45, s45, s46
    v_add_u32 v81, s45, v68
    s_add_u32 s45, s69, 2
    s_and_b32 s45, s45, 7
    s_lshl_b32 s45, s45, 10
    s_lshl_b32 s46, s44, 13
    s_add_u32 s45, s45, s46
    v_add_u32 v82, s45, v68
    s_add_u32 s45, s69, 3
    s_and_b32 s45, s45, 7
    s_lshl_b32 s45, s45, 10
    s_lshl_b32 s46, s44, 13
    s_add_u32 s45, s45, s46
    v_add_u32 v83, s45, v68
    s_add_u32 s45, s69, 4
    s_and_b32 s45, s45, 7
    s_lshl_b32 s45, s45, 10
    s_lshl_b32 s46, s44, 13
    s_add_u32 s45, s45, s46
    v_add_u32 v84, s45, v68
    s_add_u32 s45, s69, 5
    s_and_b32 s45, s45, 7
    s_lshl_b32 s45, s45, 10
    s_lshl_b32 s46, s44, 13
    s_add_u32 s45, s45, s46
    v_add_u32 v85, s45, v68
    s_add_u32 s45, s69, 6
    s_and_b32 s45, s45, 7
    s_lshl_b32 s45, s45, 10
    s_lshl_b32 s46, s44, 13
    s_add_u32 s45, s45, s46
    v_add_u32 v86, s45, v68
    s_add_u32 s45, s69, 7
    s_and_b32 s45, s45, 7
    s_lshl_b32 s45, s45, 10
    s_lshl_b32 s46, s44, 13
    s_add_u32 s45, s45, s46
    v_add_u32 v87, s45, v68
    s_lshl_b32 s45, s40, 4
    s_add_u32 s45, s45, s42
    s_lshl_b32 s45, s45, 7
    s_lshl_b32 s46, s44, 4
    s_add_u32 s45, s45, s46
    s_add_u32 s45, s45, 0x7080000
    v_and_b32 v13, 3, v1
    v_lshlrev_b32 v13, 2, v13
    v_add_u32 v13, s45, v13
    s_mov_b32 s66, 0x1800000
    v_mov_b32 v14, -1
    v_mov_b32 v15, -1
    s_mov_b32 s70, 0
    v_mov_b32 v41, 0
L_hw_98:
    s_sleep 2
    buffer_load_dword v44, v41, s[16:19], 0 offen sc1
    s_add_u32 s70, s70, 1
    s_cmp_ge_u32 s70, 0x100000
    s_cbranch_scc1 L_c_done_1
    s_waitcnt vmcnt(0)
    v_readfirstlane_b32 s45, v44
    s_cmp_lg_u32 s45, 64
    s_cbranch_scc1 L_hw_98
    buffer_load_dwordx4 v[44:47], v41, s[16:19], 0 offen sc1
    s_waitcnt vmcnt(0)
    v_readfirstlane_b32 s45, v45
    v_readfirstlane_b32 s46, v46
    v_readfirstlane_b32 s68, v47
    s_bcnt1_i32_b32 s45, s45
    s_bcnt1_i32_b32 s46, s46
    s_add_u32 s45, s45, s46
    s_cmp_eq_u32 s45, 2
    s_cselect_b32 s67, 1, 0
    s_cmp_ge_u32 s68, 16
    s_cselect_b32 s68, 8192, 0
    s_mov_b32 s60, 0
    s_lshl_b32 s58, s40, 16
    s_add_u32 s58, s58, 0x7000000
    s_mov_b32 s61, s58
    s_lshl_b32 s59, s40, 17
    s_add_u32 s59, s59, 0x7040000
    s_mov_b32 s62, s59
    s_add_u32 s63, s63, s68
    s_add_u32 s64, s64, s68
    ds_read_b128 v[56:59], v5 offset:8192
    ds_read_b128 v[60:63], v5 offset:9216
    ds_read_b128 v[64:67], v5 offset:16384
    ds_read_b128 v[68:71], v5 offset:17408
    ds_read_b128 v[72:75], v5 offset:4096
    ds_read_b128 v[76:79], v5 offset:5120
    ds_read_b128 v[88:91], v5 offset:6144
    ds_read_b128 v[92:95], v5 offset:7168
    ds_read_b128 v[32:35], v5 offset:14336
    ds_read_b128 v[36:39], v5 offset:15360
L_v_loop_99:
    s_nop 15
    s_nop 15
    s_waitcnt lgkmcnt(0)
    s_mov_b32 s70, 0
L_mg_100:
    buffer_load_dwordx4 v[40:43], v3, s[12:15], s61 offen offset:0 sc1
    s_nop 9
    buffer_load_dwordx4 v[44:47], v3, s[12:15], s61 offen offset:1024 sc1
    s_nop 9
    buffer_load_dwordx4 v[48:51], v3, s[12:15], s61 offen offset:2048 sc1
    s_nop 9
    buffer_load_dwordx4 v[52:55], v3, s[12:15], s61 offen offset:3072 sc1
    s_add_u32 s70, s70, 1
    s_cmp_ge_u32 s70, 0x100000
    s_cbranch_scc1 L_c_done_1
    s_nop 1
    v_mov_b32 v24, 0
    v_mov_b32 v25, 0
    v_mov_b32 v26, 0
    v_mov_b32 v27, 0
    v_mov_b32 v28, 0
    v_mov_b32 v29, 0
    v_mov_b32 v30, 0
    v_mov_b32 v31, 0
    s_waitcnt vmcnt(3)
    ds_write_b128 v3, v[40:43] offset:0
    v_smfmac_f32_16x16x64_bf16 v[24:27], v[40:43], a[0:7], v2
    v_max3_u32 v22, v40, v41, v42
    v_max_u32 v22, v22, v43
    v_smfmac_f32_16x16x64_bf16 v[28:31], v[40:43], a[8:15], v2
    s_waitcnt vmcnt(2)
    ds_write_b128 v3, v[44:47] offset:1024
    v_smfmac_f32_16x16x64_bf16 v[24:27], v[44:47], a[16:23], v2
    v_max3_u32 v22, v22, v44, v45
    v_max3_u32 v22, v22, v46, v47
    v_smfmac_f32_16x16x64_bf16 v[28:31], v[44:47], a[24:31], v2
    s_waitcnt vmcnt(1)
    ds_write_b128 v3, v[48:51] offset:2048
    s_waitcnt vmcnt(0)
    ds_write_b128 v3, v[52:55] offset:3072
    v_max3_u32 v22, v22, v48, v49
    v_max3_u32 v22, v22, v50, v51
    v_max3_u32 v22, v22, v52, v53
    v_max3_u32 v22, v22, v54, v55
    v_cmp_eq_u32 vcc, -1, v22
    s_waitcnt lgkmcnt(0)
    s_nop 0
    s_cbranch_vccnz L_mg_100
    s_barrier
    ds_read_b128 v[40:43], v4 offset:0
    ds_read_b128 v[44:47], v4 offset:1024
    v_smfmac_f32_16x16x64_bf16 v[24:27], v[48:51], a[32:39], v2
    v_smfmac_f32_16x16x64_bf16 v[28:31], v[48:51], v[56:63], v2
    ds_read_b128 v[48:51], v4 offset:2048
    ds_read_b128 v[56:59], v5 offset:22528
    v_smfmac_f32_16x16x64_bf16 v[24:27], v[52:55], a[40:47], v2
    ds_read_b128 v[60:63], v5 offset:23552
    v_smfmac_f32_16x16x64_bf16 v[28:31], v[52:55], v[64:71], v2
    ds_read_b128 v[52:55], v4 offset:3072
    ds_read_b128 v[64:67], v5 offset:2048
    s_waitcnt lgkmcnt(5)
    v_smfmac_f32_16x16x64_bf16 v[24:27], v[40:43], a[48:55], v2
    ds_read_b128 v[68:71], v5 offset:3072
    v_smfmac_f32_16x16x64_bf16 v[28:31], v[40:43], v[72:79], v2
    ds_read_b128 v[40:43], v21 offset:0
    ds_read_b128 v[72:75], v5 offset:12288
    v_smfmac_f32_16x16x64_bf16 v[24:27], v[44:47], a[56:63], v2
    ds_read_b128 v[76:79], v5 offset:13312
    v_smfmac_f32_16x16x64_bf16 v[28:31], v[44:47], v[88:95], v2
    ds_read_b128 v[44:47], v21 offset:1024
    ds_read_b128 v[88:91], v5 offset:20480
    s_waitcnt lgkmcnt(6)
    v_smfmac_f32_16x16x64_bf16 v[24:27], v[48:51], a[64:71], v2
    ds_read_b128 v[92:95], v5 offset:21504
    v_smfmac_f32_16x16x64_bf16 v[28:31], v[48:51], v[32:39], v2
    ds_read_b128 v[48:51], v21 offset:2048
    ds_read_b128 v[32:35], v5 offset:0
    v_smfmac_f32_16x16x64_bf16 v[24:27], v[52:55], a[72:79], v2
    ds_read_b128 v[36:39], v5 offset:1024
    v_smfmac_f32_16x16x64_bf16 v[28:31], v[52:55], v[56:63], v2
    ds_read_b128 v[52:55], v21 offset:3072
    ds_read_b128 v[56:59], v5 offset:10240
    s_waitcnt lgkmcnt(6)
    v_smfmac_f32_16x16x64_bf16 v[24:27], v[40:43], a[80:87], v2
    ds_read_b128 v[60:63], v5 offset:11264
    v_smfmac_f32_16x16x64_bf16 v[28:31], v[40:43], v[64:71], v2
    ds_read_b128 v[40:43], v23 offset:0
    ds_read_b128 v[64:67], v5 offset:18432
    v_smfmac_f32_16x16x64_bf16 v[24:27], v[44:47], a[88:95], v2
    ds_read_b128 v[68:71], v5 offset:19456
    v_smfmac_f32_16x16x64_bf16 v[28:31], v[44:47], a[96:103], v2
    ds_read_b128 v[44:47], v23 offset:1024
    s_waitcnt lgkmcnt(5)
    v_smfmac_f32_16x16x64_bf16 v[24:27], v[48:51], a[104:111], v2
    v_smfmac_f32_16x16x64_bf16 v[28:31], v[48:51], v[72:79], v2
    ds_read_b128 v[48:51], v23 offset:2048
    v_smfmac_f32_16x16x64_bf16 v[24:27], v[52:55], a[112:119], v2
    v_smfmac_f32_16x16x64_bf16 v[28:31], v[52:55], v[88:95], v2
    ds_read_b128 v[52:55], v23 offset:3072
    s_waitcnt lgkmcnt(2)
    v_smfmac_f32_16x16x64_bf16 v[24:27], v[40:43], a[120:127], v2
    v_smfmac_f32_16x16x64_bf16 v[28:31], v[40:43], v[32:39], v2
    v_smfmac_f32_16x16x64_bf16 v[24:27], v[44:47], a[128:135], v2
    v_smfmac_f32_16x16x64_bf16 v[28:31], v[44:47], a[136:143], v2
    s_waitcnt lgkmcnt(0)
    v_smfmac_f32_16x16x64_bf16 v[24:27], v[48:51], a[144:151], v2
    v_smfmac_f32_16x16x64_bf16 v[28:31], v[48:51], v[56:63], v2
    v_smfmac_f32_16x16x64_bf16 v[24:27], v[52:55], a[152:159], v2
    v_smfmac_f32_16x16x64_bf16 v[28:31], v[52:55], v[64:71], v2
    s_and_b32 s45, s60, 1
    s_lshl_b32 s45, s45, 16
    s_add_u32 s45, s45, 0x7020000
    s_xor_b32 s46, s45, 65536
    s_nop 3
    v_permlane32_swap_b32 v24, v26
    v_permlane32_swap_b32 v25, v27
    v_permlane32_swap_b32 v28, v30
    v_permlane32_swap_b32 v29, v31
    v_pk_add_f32 v[24:25], v[24:25], v[26:27]
    v_pk_add_f32 v[28:29], v[28:29], v[30:31]
    v_cvt_pk_bf16_f32 v16, v24, v25
    v_cvt_pk_bf16_f32 v17, v28, v29
    v_min_u32 v16, -2, v16
    v_min_u32 v17, -2, v17
    s_add_u32 s47, s60, 3
    s_and_b32 s47, s47, 3
    s_lshl_b32 s47, s47, 14
    s_add_u32 s47, s47, s58
    s_cmp_eq_u32 s67, 1
    s_cbranch_scc0 L_ls_101_s
    buffer_store_dwordx2 v[16:17], v10, s[12:15], s45 offen
    buffer_store_dwordx2 v[14:15], v10, s[12:15], s46 offen
    buffer_store_dword v14, v12, s[12:15], s47 offen
L_ls_101_d:
    buffer_store_dwordx2 v[16:17], v10, s[12:15], s66 offen sc1
    s_cmp_eq_u32 s60, 63
    s_cbranch_scc1 L_v_fin_102
    v_mov_b32 v22, s60
    v_mov_b32 v0, 0
    s_mov_b64 exec, 1
    buffer_store_dword v22, v0, s[12:15], s3 offen sc1
    s_mov_b64 exec, -1
    s_and_b32 s65, s60, 1
    s_lshl_b32 s65, s65, 12
    s_and_b32 s45, s60, 2
    s_lshl_b32 s45, s45, 13
    s_add_u32 s65, s65, s45
    s_xor_b32 s45, s65, 16384
    s_add_u32 s45, s45, s63
    buffer_store_dwordx2 v[14:15], v11, s[12:15], s45 offen sc1
    s_add_u32 s48, s63, s65
    s_add_u32 s49, s64, s65
    s_sleep 8
    s_mov_b64 exec, 15
    buffer_load_dword v88, v13, s[12:15], 0 offen sc1
    s_nop 15
    buffer_load_dword v89, v13, s[12:15], 0 offen sc1
    s_nop 15
    buffer_load_dword v90, v13, s[12:15], 0 offen sc1
    s_nop 15
    buffer_load_dword v91, v13, s[12:15], 0 offen sc1
    s_mov_b32 s70, 0
L_pp_103:
    s_waitcnt vmcnt(3)
    v_cmp_ge_u32 vcc, s60, v88
    s_add_u32 s70, s70, 1
    s_nop 0
    s_cbranch_vccz L_ppd_104
    buffer_load_dword v88, v13, s[12:15], 0 offen sc1
    s_waitcnt vmcnt(3)
    v_cmp_ge_u32 vcc, s60, v89
    s_add_u32 s70, s70, 1
    s_nop 0
    s_cbranch_vccz L_ppd_104
    buffer_load_dword v89, v13, s[12:15], 0 offen sc1
    s_waitcnt vmcnt(3)
    v_cmp_ge_u32 vcc, s60, v90
    s_add_u32 s70, s70, 1
    s_nop 0
    s_cbranch_vccz L_ppd_104
    buffer_load_dword v90, v13, s[12:15], 0 offen sc1
    s_waitcnt vmcnt(3)
    v_cmp_ge_u32 vcc, s60, v91
    s_add_u32 s70, s70, 1
    s_nop 0
    s_cbranch_vccz L_ppd_104
    buffer_load_dword v91, v13, s[12:15], 0 offen sc1
    s_cmp_lt_u32 s70, 0x400000
    s_cbranch_scc1 L_pp_103
    s_branch L_c_done_1
L_ppd_104:
    s_mov_b64 exec, -1
    s_nop 15
    s_nop 15
    s_mov_b32 s70, 0
    buffer_load_dwordx4 v[40:43], v80, s[12:15], s62 offen sc1
    v_mov_b32 v24, 0
    v_mov_b32 v25, 0
    v_mov_b32 v26, 0
    v_mov_b32 v27, 0
    s_nop 5
    buffer_load_dwordx4 v[44:47], v81, s[12:15], s62 offen sc1
    v_mov_b32 v28, 0
    v_mov_b32 v29, 0
    v_mov_b32 v30, 0
    v_mov_b32 v31, 0
    s_nop 5
    buffer_load_dwordx4 v[48:51], v82, s[12:15], s62 offen sc1
    v_mov_b32 v32, 0
    v_mov_b32 v33, 0
    v_mov_b32 v34, 0
    v_mov_b32 v35, 0
    s_nop 5
    buffer_load_dwordx4 v[52:55], v83, s[12:15], s62 offen sc1
    v_mov_b32 v36, 0
    v_mov_b32 v37, 0
    v_mov_b32 v38, 0
    v_mov_b32 v39, 0
    s_nop 5
    buffer_load_dwordx4 v[56:59], v84, s[12:15], s62 offen sc1
    s_nop 9
    buffer_load_dwordx4 v[60:63], v85, s[12:15], s62 offen sc1
    s_waitcnt vmcnt(5)
    v_max3_u32 v22, v40, v41, v42
    v_max_u32 v22, v22, v43
    v_cmp_eq_u32 vcc, -1, v22
    s_nop 1
    s_cbranch_vccnz L_v_og_105_r0
L_v_og_105_c0:
    v_smfmac_f32_16x16x64_bf16 v[24:27], v[40:43], a[160:167], v2
    s_waitcnt vmcnt(4)
    v_max3_u32 v22, v44, v45, v46
    v_smfmac_f32_16x16x64_bf16 v[28:31], v[40:43], a[168:175], v2
    v_max_u32 v22, v22, v47
    v_smfmac_f32_16x16x64_bf16 v[32:35], v[40:43], a[176:183], v2
    v_cmp_eq_u32 vcc, -1, v22
    v_smfmac_f32_16x16x64_bf16 v[36:39], v[40:43], a[184:191], v2
    buffer_load_dwordx4 v[64:67], v86, s[12:15], s62 offen sc1
    s_cbranch_vccnz L_v_og_105_r1
L_v_og_105_c1:
    v_smfmac_f32_16x16x64_bf16 v[24:27], v[44:47], a[192:199], v2
    s_waitcnt vmcnt(4)
    v_max3_u32 v22, v48, v49, v50
    v_smfmac_f32_16x16x64_bf16 v[28:31], v[44:47], a[200:207], v2
    v_max_u32 v22, v22, v51
    v_smfmac_f32_16x16x64_bf16 v[32:35], v[44:47], a[208:215], v2
    v_cmp_eq_u32 vcc, -1, v22
    v_smfmac_f32_16x16x64_bf16 v[36:39], v[44:47], a[216:223], v2
    buffer_load_dwordx4 v[68:71], v87, s[12:15], s62 offen sc1
    s_cbranch_vccnz L_v_og_105_r2
L_v_og_105_c2:
    v_smfmac_f32_16x16x64_bf16 v[24:27], v[48:51], a[224:231], v2
    s_waitcnt vmcnt(4)
    v_max3_u32 v22, v52, v53, v54
    v_smfmac_f32_16x16x64_bf16 v[28:31], v[48:51], a[232:239], v2
    v_max_u32 v22, v22, v55
    v_smfmac_f32_16x16x64_bf16 v[32:35], v[48:51], a[240:247], v2
    v_cmp_eq_u32 vcc, -1, v22
    v_smfmac_f32_16x16x64_bf16 v[36:39], v[48:51], a[248:255], v2
    s_nop 0
    s_cbranch_vccnz L_v_og_105_r3
L_v_og_105_c3:
    v_smfmac_f32_16x16x64_bf16 v[24:27], v[52:55], v[96:103], v2
    s_waitcnt vmcnt(3)
    v_max3_u32 v22, v56, v57, v58
    v_smfmac_f32_16x16x64_bf16 v[28:31], v[52:55], v[104:111], v2
    v_max_u32 v22, v22, v59
    v_smfmac_f32_16x16x64_bf16 v[32:35], v[52:55], v[112:119], v2
    v_cmp_eq_u32 vcc, -1, v22
    v_smfmac_f32_16x16x64_bf16 v[36:39], v[52:55], v[120:127], v2
    s_nop 0
    s_cbranch_vccnz L_v_og_105_r4
L_v_og_105_c4:
    v_smfmac_f32_16x16x64_bf16 v[24:27], v[56:59], v[128:135], v2
    s_waitcnt vmcnt(2)
    v_max3_u32 v22, v60, v61, v62
    v_smfmac_f32_16x16x64_bf16 v[28:31], v[56:59], v[136:143], v2
    v_max_u32 v22, v22, v63
    v_smfmac_f32_16x16x64_bf16 v[32:35], v[56:59], v[144:151], v2
    v_cmp_eq_u32 vcc, -1, v22
    v_smfmac_f32_16x16x64_bf16 v[36:39], v[56:59], v[152:159], v2
    s_nop 0
    s_cbranch_vccnz L_v_og_105_r5
L_v_og_105_c5:
    v_smfmac_f32_16x16x64_bf16 v[24:27], v[60:63], v[160:167], v2
    s_waitcnt vmcnt(1)
    v_max3_u32 v22, v64, v65, v66
    v_smfmac_f32_16x16x64_bf16 v[28:31], v[60:63], v[168:175], v2
    v_max_u32 v22, v22, v67
    v_smfmac_f32_16x16x64_bf16 v[32:35], v[60:63], v[176:183], v2
    v_cmp_eq_u32 vcc, -1, v22
    v_smfmac_f32_16x16x64_bf16 v[36:39], v[60:63], v[184:191], v2
    s_nop 0
    s_cbranch_vccnz L_v_og_105_r6
L_v_og_105_c6:
    v_smfmac_f32_16x16x64_bf16 v[24:27], v[64:67], v[192:199], v2
    s_waitcnt vmcnt(0)
    v_max3_u32 v22, v68, v69, v70
    v_smfmac_f32_16x16x64_bf16 v[28:31], v[64:67], v[200:207], v2
    v_max_u32 v22, v22, v71
    v_smfmac_f32_16x16x64_bf16 v[32:35], v[64:67], v[208:215], v2
    v_cmp_eq_u32 vcc, -1, v22
    v_smfmac_f32_16x16x64_bf16 v[36:39], v[64:67], v[216:223], v2
    s_nop 0
    s_cbranch_vccnz L_v_og_105_r7
L_v_og_105_c7:
    v_smfmac_f32_16x16x64_bf16 v[24:27], v[68:71], v[224:231], v2
    v_smfmac_f32_16x16x64_bf16 v[28:31], v[68:71], v[232:239], v2
    v_smfmac_f32_16x16x64_bf16 v[32:35], v[68:71], v[240:247], v2
    v_smfmac_f32_16x16x64_bf16 v[36:39], v[68:71], v[248:255], v2
    s_add_u32 s46, s60, 1
    s_nop 3
    ds_write_b128 v6, v[24:27]
    s_and_b32 s45, s46, 3
    ds_write_b128 v6, v[28:31] offset:1024
    s_mov_b32 s60, s46
    ds_write_b128 v6, v[32:35] offset:2048
    s_lshl_b32 s46, s45, 14
    s_add_u32 s61, s58, s46
    s_lshl_b32 s46, s45, 15
    s_add_u32 s62, s59, s46
    s_waitcnt lgkmcnt(0)
    s_barrier
    ds_read_b128 v[40:43], v7
    ds_read_b128 v[44:47], v8
    ds_read_b128 v[48:51], v18
    s_waitcnt lgkmcnt(2)
    v_pk_add_f32 v[36:37], v[36:37], v[40:41]
    v_pk_add_f32 v[38:39], v[38:39], v[42:43]
    s_waitcnt lgkmcnt(1)
    v_pk_add_f32 v[36:37], v[36:37], v[44:45]
    v_pk_add_f32 v[38:39], v[38:39], v[46:47]
    s_waitcnt lgkmcnt(0)
    v_pk_add_f32 v[36:37], v[36:37], v[48:49]
    v_pk_add_f32 v[38:39], v[38:39], v[50:51]
    s_nop 1
    v_permlane32_swap_b32 v36, v38
    v_permlane32_swap_b32 v37, v39
    v_pk_add_f32 v[24:25], v[36:37], v[38:39]
    v_min_u32 v24, -2, v24
    v_min_u32 v25, -2, v25
    buffer_store_dwordx2 v[24:25], v11, s[12:15], s48 offen sc1
    ds_read_b128 v[56:59], v5 offset:8192
    ds_read_b128 v[60:63], v5 offset:9216
    ds_read_b128 v[64:67], v5 offset:16384
    ds_read_b128 v[68:71], v5 offset:17408
    ds_read_b128 v[72:75], v5 offset:4096
    ds_read_b128 v[76:79], v5 offset:5120
    ds_read_b128 v[88:91], v5 offset:6144
    ds_read_b128 v[92:95], v5 offset:7168
    ds_read_b128 v[32:35], v5 offset:14336
    ds_read_b128 v[36:39], v5 offset:15360
    s_sleep 2
    buffer_load_dwordx2 v[40:41], v11, s[12:15], s49 offen sc1
    s_nop 15
    s_nop 7
    buffer_load_dwordx2 v[42:43], v11, s[12:15], s49 offen sc1
    s_nop 15
    s_nop 7
    buffer_load_dwordx2 v[44:45], v11, s[12:15], s49 offen sc1
    s_mov_b32 s70, 0
L_v_xp_106:
    s_waitcnt vmcnt(2)
    v_max_u32 v22, v40, v41
    v_cmp_eq_u32 vcc, -1, v22
    v_pk_add_f32 v[28:29], v[24:25], v[40:41]
    v_cvt_pk_bf16_f32 v28, v28, v29
    s_cbranch_vccz L_v_xp_106_ok
    buffer_load_dwordx2 v[40:41], v11, s[12:15], s49 offen sc1
    s_waitcnt vmcnt(2)
    v_max_u32 v22, v42, v43
    v_cmp_eq_u32 vcc, -1, v22
    v_pk_add_f32 v[28:29], v[24:25], v[42:43]
    v_cvt_pk_bf16_f32 v28, v28, v29
    s_cbranch_vccz L_v_xp_106_ok
    buffer_load_dwordx2 v[42:43], v11, s[12:15], s49 offen sc1
    s_waitcnt vmcnt(2)
    v_max_u32 v22, v44, v45
    v_cmp_eq_u32 vcc, -1, v22
    v_pk_add_f32 v[28:29], v[24:25], v[44:45]
    v_cvt_pk_bf16_f32 v28, v28, v29
    s_cbranch_vccz L_v_xp_106_ok
    buffer_load_dwordx2 v[44:45], v11, s[12:15], s49 offen sc1
    s_add_u32 s70, s70, 1
    s_cmp_lt_u32 s70, 0x100000
    s_cbranch_scc1 L_v_xp_106
    s_branch L_c_done_1
L_v_xp_106_ok:
    s_add_u32 s66, s66, 65536
    v_mov_b32_dpp v29, v28 quad_perm:[1,0,3,2] row_mask:0xf bank_mask:0xf
    v_perm_b32 v28, v28, v29, v9
    v_min_u32 v28, -2, v28
    s_cmp_eq_u32 s67, 1
    s_cbranch_scc0 L_ls_107_s
    buffer_store_dword v28, v12, s[12:15], s61 offen
L_ls_107_d:
    s_branch L_v_loop_99
L_v_fin_102:
    s_waitcnt vmcnt(0)
    v_mov_b32 v22, 64
    v_mov_b32 v0, 0
    s_mov_b64 exec, 1
    buffer_store_dword v22, v0, s[12:15], s3 offen sc1
    s_mov_b64 exec, -1
L_c_done_1:
    s_endpgm
L_v_og_105_r0:
    buffer_load_dwordx4 v[40:43], v80, s[12:15], s62 offen sc1
    buffer_load_dwordx4 v[44:47], v81, s[12:15], s62 offen sc1
    buffer_load_dwordx4 v[48:51], v82, s[12:15], s62 offen sc1
    buffer_load_dwordx4 v[52:55], v83, s[12:15], s62 offen sc1
    buffer_load_dwordx4 v[56:59], v84, s[12:15], s62 offen sc1
    buffer_load_dwordx4 v[60:63], v85, s[12:15], s62 offen sc1
    s_add_u32 s70, s70, 1
    s_cmp_ge_u32 s70, 0x100000
    s_cbranch_scc1 L_c_done_1
    s_waitcnt vmcnt(5)
    v_max3_u32 v22, v40, v41, v42
    v_max_u32 v22, v22, v43
    v_cmp_eq_u32 vcc, -1, v22
    s_nop 1
    s_cbranch_vccnz L_v_og_105_r0
    s_branch L_v_og_105_c0
L_v_og_105_r1:
    buffer_load_dwordx4 v[44:47], v81, s[12:15], s62 offen sc1
    buffer_load_dwordx4 v[48:51], v82, s[12:15], s62 offen sc1
    buffer_load_dwordx4 v[52:55], v83, s[12:15], s62 offen sc1
    buffer_load_dwordx4 v[56:59], v84, s[12:15], s62 offen sc1
    buffer_load_dwordx4 v[60:63], v85, s[12:15], s62 offen sc1
    buffer_load_dwordx4 v[64:67], v86, s[12:15], s62 offen sc1
    s_add_u32 s70, s70, 1
    s_cmp_ge_u32 s70, 0x100000
    s_cbranch_scc1 L_c_done_1
    s_waitcnt vmcnt(5)
    v_max3_u32 v22, v44, v45, v46
    v_max_u32 v22, v22, v47
    v_cmp_eq_u32 vcc, -1, v22
    s_nop 1
    s_cbranch_vccnz L_v_og_105_r1
    s_branch L_v_og_105_c1
L_v_og_105_r2:
    buffer_load_dwordx4 v[48:51], v82, s[12:15], s62 offen sc1
    buffer_load_dwordx4 v[52:55], v83, s[12:15], s62 offen sc1
    buffer_load_dwordx4 v[56:59], v84, s[12:15], s62 offen sc1
    buffer_load_dwordx4 v[60:63], v85, s[12:15], s62 offen sc1
    buffer_load_dwordx4 v[64:67], v86, s[12:15], s62 offen sc1
    buffer_load_dwordx4 v[68:71], v87, s[12:15], s62 offen sc1
    s_add_u32 s70, s70, 1
    s_cmp_ge_u32 s70, 0x100000
    s_cbranch_scc1 L_c_done_1
    s_waitcnt vmcnt(5)
    v_max3_u32 v22, v48, v49, v50
    v_max_u32 v22, v22, v51
    v_cmp_eq_u32 vcc, -1, v22
    s_nop 1
    s_cbranch_vccnz L_v_og_105_r2
    s_branch L_v_og_105_c2
L_v_og_105_r3:
    buffer_load_dwordx4 v[52:55], v83, s[12:15], s62 offen sc1
    buffer_load_dwordx4 v[56:59], v84, s[12:15], s62 offen sc1
    buffer_load_dwordx4 v[60:63], v85, s[12:15], s62 offen sc1
    buffer_load_dwordx4 v[64:67], v86, s[12:15], s62 offen sc1
    buffer_load_dwordx4 v[68:71], v87, s[12:15], s62 offen sc1
    s_add_u32 s70, s70, 1
    s_cmp_ge_u32 s70, 0x100000
    s_cbranch_scc1 L_c_done_1
    s_waitcnt vmcnt(4)
    v_max3_u32 v22, v52, v53, v54
    v_max_u32 v22, v22, v55
    v_cmp_eq_u32 vcc, -1, v22
    s_nop 1
    s_cbranch_vccnz L_v_og_105_r3
    s_branch L_v_og_105_c3
L_v_og_105_r4:
    buffer_load_dwordx4 v[56:59], v84, s[12:15], s62 offen sc1
    buffer_load_dwordx4 v[60:63], v85, s[12:15], s62 offen sc1
    buffer_load_dwordx4 v[64:67], v86, s[12:15], s62 offen sc1
    buffer_load_dwordx4 v[68:71], v87, s[12:15], s62 offen sc1
    s_add_u32 s70, s70, 1
    s_cmp_ge_u32 s70, 0x100000
    s_cbranch_scc1 L_c_done_1
    s_waitcnt vmcnt(3)
    v_max3_u32 v22, v56, v57, v58
    v_max_u32 v22, v22, v59
    v_cmp_eq_u32 vcc, -1, v22
    s_nop 1
    s_cbranch_vccnz L_v_og_105_r4
    s_branch L_v_og_105_c4
L_v_og_105_r5:
    buffer_load_dwordx4 v[60:63], v85, s[12:15], s62 offen sc1
    buffer_load_dwordx4 v[64:67], v86, s[12:15], s62 offen sc1
    buffer_load_dwordx4 v[68:71], v87, s[12:15], s62 offen sc1
    s_add_u32 s70, s70, 1
    s_cmp_ge_u32 s70, 0x100000
    s_cbranch_scc1 L_c_done_1
    s_waitcnt vmcnt(2)
    v_max3_u32 v22, v60, v61, v62
    v_max_u32 v22, v22, v63
    v_cmp_eq_u32 vcc, -1, v22
    s_nop 1
    s_cbranch_vccnz L_v_og_105_r5
    s_branch L_v_og_105_c5
L_v_og_105_r6:
    buffer_load_dwordx4 v[64:67], v86, s[12:15], s62 offen sc1
    buffer_load_dwordx4 v[68:71], v87, s[12:15], s62 offen sc1
    s_add_u32 s70, s70, 1
    s_cmp_ge_u32 s70, 0x100000
    s_cbranch_scc1 L_c_done_1
    s_waitcnt vmcnt(1)
    v_max3_u32 v22, v64, v65, v66
    v_max_u32 v22, v22, v67
    v_cmp_eq_u32 vcc, -1, v22
    s_nop 1
    s_cbranch_vccnz L_v_og_105_r6
    s_branch L_v_og_105_c6
L_v_og_105_r7:
    buffer_load_dwordx4 v[68:71], v87, s[12:15], s62 offen sc1
    s_add_u32 s70, s70, 1
    s_cmp_ge_u32 s70, 0x100000
    s_cbranch_scc1 L_c_done_1
    s_waitcnt vmcnt(0)
    v_max3_u32 v22, v68, v69, v70
    v_max_u32 v22, v22, v71
    v_cmp_eq_u32 vcc, -1, v22
    s_nop 1
    s_cbranch_vccnz L_v_og_105_r7
    s_branch L_v_og_105_c7
L_ls_101_s:
    buffer_store_dwordx2 v[16:17], v10, s[12:15], s45 offen sc1
    buffer_store_dwordx2 v[14:15], v10, s[12:15], s46 offen sc1
    buffer_store_dword v14, v12, s[12:15], s47 offen sc1
    s_branch L_ls_101_d
L_ls_107_s:
    buffer_store_dword v28, v12, s[12:15], s61 offen sc1
    s_branch L_ls_107_d
L_worker_3:
    s_lshr_b32 s41, s2, 3
    s_cmp_ge_u32 s40, 3
    s_cselect_b32 s42, 1, 0
    s_mul_i32 s45, s42, 3
    s_sub_u32 s43, s40, s45
    s_lshl_b32 s39, s43, 5
    s_add_u32 s39, s39, s41
    s_load_dwordx2 s[4:5], s[0:1], 0
    s_waitcnt lgkmcnt(0)
    s_mov_b32 s28, s4
    s_and_b32 s29, s5, 0xffff
    s_mov_b32 s30, 0x400000
    s_mov_b32 s31, 0x00020000
    v_lshrrev_b32 v2, 4, v1
    v_lshlrev_b32 v2, 13, v2
    v_and_b32 v3, 15, v1
    v_lshlrev_b32 v3, 4, v3
    v_add_u32 v2, v2, v3
    v_and_b32 v3, 31, v1
    v_mul_u32_u24 v4, 1040, v3
    v_lshrrev_b32 v5, 5, v1
    v_lshlrev_b32 v6, 4, v5
    v_add_u32 v4, v4, v6
    v_mul_u32_u24 v6, 272, v3
    v_lshlrev_b32 v7, 5, v5
    s_lshl_b32 s45, s44, 6
    s_add_u32 s45, s45, 133120
    v_add3_u32 v6, v6, v7, s45
    v_mul_u32_u24 v7, 528, v3
    v_lshlrev_b32 v8, 6, v5
    s_lshl_b32 s45, s44, 7
    s_add_u32 s45, s45, 133120
    v_add3_u32 v7, v7, v8, s45
    v_lshrrev_b32 v8, 4, v1
    v_mul_u32_u24 v8, 272, v8
    v_and_b32 v9, 15, v1
    v_lshlrev_b32 v9, 4, v9
    s_mul_i32 s45, s44, 2176
    s_add_u32 s45, s45, 133120
    v_add3_u32 v8, v8, v9, s45
    v_mul_u32_u24 v9, 528, v5
    v_lshlrev_b32 v10, 4, v3
    s_mul_i32 s45, s44, 4224
    s_add_u32 s45, s45, 133120
    v_add3_u32 v9, v9, v10, s45
    v_lshlrev_b32 v11, 12, v5
    v_add_u32 v11, v11, v10
    v_lshlrev_b32 v10, 4, v1
    v_lshlrev_b32 v12, 2, v1
    v_lshlrev_b32 v5, 7, v1
    s_lshl_b32 s61, s41, 7
    s_lshl_b32 s45, s43, 2
    s_add_u32 s61, s61, s45
    s_lshl_b32 s45, s42, 4
    s_add_u32 s61, s61, s45
    s_add_u32 s61, s61, 0x10000
    s_mul_i32 s64, s42, 24576
    s_add_u32 s64, s64, 0x12000
    s_lshl_b32 s45, s41, 7
    s_add_u32 s65, s64, s45
    s_lshl_b32 s45, s43, 13
    s_add_u32 s65, s65, s45
    s_add_u32 s67, s65, 4096
    v_mov_b32 v30, 0
    v_mov_b32 v31, 0
    s_mov_b64 exec, 1
    buffer_store_dword v30, v31, s[12:15], s61 offen sc1
    buffer_store_dword v30, v31, s[12:15], s65 offen sc1
    buffer_store_dword v30, v31, s[12:15], s67 offen sc1
    s_mov_b64 exec, -1
    s_cmp_lg_u32 s42, 0
    s_cbranch_scc1 L_w_kv_109
    s_lshl_b32 s63, s39, 2
    s_add_u32 s63, s63, s44
    s_load_dwordx2 s[4:5], s[0:1], 96
    s_load_dwordx2 s[6:7], s[0:1], 104
    v_and_b32 v14, 7, v0
    v_lshrrev_b32 v15, 3, v0
    s_waitcnt lgkmcnt(0)
    s_mov_b32 s32, s4
    s_and_b32 s33, s5, 0xffff
    s_mov_b32 s34, 0x800
    s_mov_b32 s35, 0x00020000
    s_mov_b32 s24, s6
    s_and_b32 s25, s7, 0xffff
    s_mov_b32 s26, 0xc00000
    s_mov_b32 s27, 0x00020000
    s_and_b32 s47, s39, 1
    s_lshl_b32 s45, s47, 10
    v_lshlrev_b32 v16, 5, v15
    buffer_load_dwordx4 v[104:107], v16, s[32:35], s45 offen
    buffer_load_dwordx4 v[108:111], v16, s[32:35], s45 offen offset:16
    s_mov_b32 s45, 196608
    v_mul_lo_u32 v17, v15, s45
    v_lshlrev_b32 v18, 4, v14
    v_add_u32 v17, v17, v18
    s_lshr_b32 s46, s39, 1
    s_lshl_b32 s46, s46, 7
    s_mul_i32 s45, s47, 6291456
    s_add_u32 s46, s46, s45
    buffer_load_dwordx4 v[32:35], v17, s[24:27], s46 offen nt
    v_add_u32 v17, 12288, v17
    buffer_load_dwordx4 v[36:39], v17, s[24:27], s46 offen nt
    v_add_u32 v17, 12288, v17
    buffer_load_dwordx4 v[40:43], v17, s[24:27], s46 offen nt
    v_add_u32 v17, 12288, v17
    buffer_load_dwordx4 v[44:47], v17, s[24:27], s46 offen nt
    v_add_u32 v17, 12288, v17
    buffer_load_dwordx4 v[48:51], v17, s[24:27], s46 offen nt
    v_add_u32 v17, 12288, v17
    buffer_load_dwordx4 v[52:55], v17, s[24:27], s46 offen nt
    v_add_u32 v17, 12288, v17
    buffer_load_dwordx4 v[56:59], v17, s[24:27], s46 offen nt
    v_add_u32 v17, 12288, v17
    buffer_load_dwordx4 v[60:63], v17, s[24:27], s46 offen nt
    v_add_u32 v17, 12288, v17
    buffer_load_dwordx4 v[64:67], v17, s[24:27], s46 offen nt
    v_add_u32 v17, 12288, v17
    buffer_load_dwordx4 v[68:71], v17, s[24:27], s46 offen nt
    v_add_u32 v17, 12288, v17
    buffer_load_dwordx4 v[72:75], v17, s[24:27], s46 offen nt
    v_add_u32 v17, 12288, v17
    buffer_load_dwordx4 v[76:79], v17, s[24:27], s46 offen nt
    v_add_u32 v17, 12288, v17
    buffer_load_dwordx4 v[80:83], v17, s[24:27], s46 offen nt
    v_add_u32 v17, 12288, v17
    buffer_load_dwordx4 v[84:87], v17, s[24:27], s46 offen nt
    v_add_u32 v17, 12288, v17
    buffer_load_dwordx4 v[88:91], v17, s[24:27], s46 offen nt
    v_add_u32 v17, 12288, v17
    buffer_load_dwordx4 v[92:95], v17, s[24:27], s46 offen nt
    s_add_u32 s45, s63, 0
    s_lshl_b32 s45, s45, 11
    buffer_load_dwordx4 v[128:131], v10, s[28:31], s45 offen nt
    buffer_load_dwordx4 v[132:135], v10, s[28:31], s45 offen offset:1024 nt
    s_add_u32 s45, s63, 384
    s_lshl_b32 s45, s45, 11
    buffer_load_dwordx4 v[136:139], v10, s[28:31], s45 offen nt
    buffer_load_dwordx4 v[140:143], v10, s[28:31], s45 offen offset:1024 nt
    s_add_u32 s45, s63, 768
    s_lshl_b32 s45, s45, 11
    buffer_load_dwordx4 v[144:147], v10, s[28:31], s45 offen nt
    buffer_load_dwordx4 v[148:151], v10, s[28:31], s45 offen offset:1024 nt
    s_add_u32 s45, s63, 1152
    s_lshl_b32 s45, s45, 11
    buffer_load_dwordx4 v[152:155], v10, s[28:31], s45 offen nt
    buffer_load_dwordx4 v[156:159], v10, s[28:31], s45 offen offset:1024 nt
    s_add_u32 s45, s63, 1536
    s_lshl_b32 s45, s45, 11
    buffer_load_dwordx4 v[160:163], v10, s[28:31], s45 offen nt
    buffer_load_dwordx4 v[164:167], v10, s[28:31], s45 offen offset:1024 nt
    s_add_u32 s45, s63, 1920
    s_lshl_b32 s45, s45, 11
    buffer_load_dwordx4 v[168:171], v10, s[28:31], s45 offen nt
    buffer_load_dwordx4 v[172:175], v10, s[28:31], s45 offen offset:1024 nt
    s_waitcnt vmcnt(28)
    v_lshlrev_b32 v112, 16, v104
    v_and_b32 v113, 0xffff0000, v104
    v_lshlrev_b32 v114, 16, v105
    v_and_b32 v115, 0xffff0000, v105
    v_lshlrev_b32 v116, 16, v106
    v_and_b32 v117, 0xffff0000, v106
    v_lshlrev_b32 v118, 16, v107
    v_and_b32 v119, 0xffff0000, v107
    v_lshlrev_b32 v120, 16, v108
    v_and_b32 v121, 0xffff0000, v108
    v_lshlrev_b32 v122, 16, v109
    v_and_b32 v123, 0xffff0000, v109
    v_lshlrev_b32 v124, 16, v110
    v_and_b32 v125, 0xffff0000, v110
    v_lshlrev_b32 v126, 16, v111
    v_and_b32 v127, 0xffff0000, v111
    v_mul_f32 v18, 0xbfb8aa3b, v112
    v_exp_f32 v18, v18
    s_nop 0
    v_add_f32 v18, 1.0, v18
    v_rcp_f32 v18, v18
    s_nop 0
    v_mul_f32 v112, v112, v18
    v_cvt_pk_bf16_f32 v112, v112, v112
    v_lshlrev_b32 v112, 16, v112
    v_mul_f32 v18, 0xbfb8aa3b, v113
    v_exp_f32 v18, v18
    s_nop 0
    v_add_f32 v18, 1.0, v18
    v_rcp_f32 v18, v18
    s_nop 0
    v_mul_f32 v113, v113, v18
    v_cvt_pk_bf16_f32 v113, v113, v113
    v_lshlrev_b32 v113, 16, v113
    v_mul_f32 v18, 0xbfb8aa3b, v114
    v_exp_f32 v18, v18
    s_nop 0
    v_add_f32 v18, 1.0, v18
    v_rcp_f32 v18, v18
    s_nop 0
    v_mul_f32 v114, v114, v18
    v_cvt_pk_bf16_f32 v114, v114, v114
    v_lshlrev_b32 v114, 16, v114
    v_mul_f32 v18, 0xbfb8aa3b, v115
    v_exp_f32 v18, v18
    s_nop 0
    v_add_f32 v18, 1.0, v18
    v_rcp_f32 v18, v18
    s_nop 0
    v_mul_f32 v115, v115, v18
    v_cvt_pk_bf16_f32 v115, v115, v115
    v_lshlrev_b32 v115, 16, v115
    v_mul_f32 v18, 0xbfb8aa3b, v116
    v_exp_f32 v18, v18
    s_nop 0
    v_add_f32 v18, 1.0, v18
    v_rcp_f32 v18, v18
    s_nop 0
    v_mul_f32 v116, v116, v18
    v_cvt_pk_bf16_f32 v116, v116, v116
    v_lshlrev_b32 v116, 16, v116
    v_mul_f32 v18, 0xbfb8aa3b, v117
    v_exp_f32 v18, v18
    s_nop 0
    v_add_f32 v18, 1.0, v18
    v_rcp_f32 v18, v18
    s_nop 0
    v_mul_f32 v117, v117, v18
    v_cvt_pk_bf16_f32 v117, v117, v117
    v_lshlrev_b32 v117, 16, v117
    v_mul_f32 v18, 0xbfb8aa3b, v118
    v_exp_f32 v18, v18
    s_nop 0
    v_add_f32 v18, 1.0, v18
    v_rcp_f32 v18, v18
    s_nop 0
    v_mul_f32 v118, v118, v18
    v_cvt_pk_bf16_f32 v118, v118, v118
    v_lshlrev_b32 v118, 16, v118
    v_mul_f32 v18, 0xbfb8aa3b, v119
    v_exp_f32 v18, v18
    s_nop 0
    v_add_f32 v18, 1.0, v18
    v_rcp_f32 v18, v18
    s_nop 0
    v_mul_f32 v119, v119, v18
    v_cvt_pk_bf16_f32 v119, v119, v119
    v_lshlrev_b32 v119, 16, v119
    v_mul_f32 v18, 0xbfb8aa3b, v120
    v_exp_f32 v18, v18
    s_nop 0
    v_add_f32 v18, 1.0, v18
    v_rcp_f32 v18, v18
    s_nop 0
    v_mul_f32 v120, v120, v18
    v_cvt_pk_bf16_f32 v120, v120, v120
    v_lshlrev_b32 v120, 16, v120
    v_mul_f32 v18, 0xbfb8aa3b, v121
    v_exp_f32 v18, v18
    s_nop 0
    v_add_f32 v18, 1.0, v18
    v_rcp_f32 v18, v18
    s_nop 0
    v_mul_f32 v121, v121, v18
    v_cvt_pk_bf16_f32 v121, v121, v121
    v_lshlrev_b32 v121, 16, v121
    v_mul_f32 v18, 0xbfb8aa3b, v122
    v_exp_f32 v18, v18
    s_nop 0
    v_add_f32 v18, 1.0, v18
    v_rcp_f32 v18, v18
    s_nop 0
    v_mul_f32 v122, v122, v18
    v_cvt_pk_bf16_f32 v122, v122, v122
    v_lshlrev_b32 v122, 16, v122
    v_mul_f32 v18, 0xbfb8aa3b, v123
    v_exp_f32 v18, v18
    s_nop 0
    v_add_f32 v18, 1.0, v18
    v_rcp_f32 v18, v18
    s_nop 0
    v_mul_f32 v123, v123, v18
    v_cvt_pk_bf16_f32 v123, v123, v123
    v_lshlrev_b32 v123, 16, v123
    v_mul_f32 v18, 0xbfb8aa3b, v124
    v_exp_f32 v18, v18
    s_nop 0
    v_add_f32 v18, 1.0, v18
    v_rcp_f32 v18, v18
    s_nop 0
    v_mul_f32 v124, v124, v18
    v_cvt_pk_bf16_f32 v124, v124, v124
    v_lshlrev_b32 v124, 16, v124
    v_mul_f32 v18, 0xbfb8aa3b, v125
    v_exp_f32 v18, v18
    s_nop 0
    v_add_f32 v18, 1.0, v18
    v_rcp_f32 v18, v18
    s_nop 0
    v_mul_f32 v125, v125, v18
    v_cvt_pk_bf16_f32 v125, v125, v125
    v_lshlrev_b32 v125, 16, v125
    v_mul_f32 v18, 0xbfb8aa3b, v126
    v_exp_f32 v18, v18
    s_nop 0
    v_add_f32 v18, 1.0, v18
    v_rcp_f32 v18, v18
    s_nop 0
    v_mul_f32 v126, v126, v18
    v_cvt_pk_bf16_f32 v126, v126, v126
    v_lshlrev_b32 v126, 16, v126
    v_mul_f32 v18, 0xbfb8aa3b, v127
    v_exp_f32 v18, v18
    s_nop 0
    v_add_f32 v18, 1.0, v18
    v_rcp_f32 v18, v18
    s_nop 0
    v_mul_f32 v127, v127, v18
    v_cvt_pk_bf16_f32 v127, v127, v127
    v_lshlrev_b32 v127, 16, v127
    v_mov_b32 v96, 0
    v_mov_b32 v97, 0
    v_mov_b32 v98, 0
    v_mov_b32 v99, 0
    v_mov_b32 v100, 0
    v_mov_b32 v101, 0
    v_mov_b32 v102, 0
    v_mov_b32 v103, 0
    s_waitcnt vmcnt(27)
    v_lshlrev_b32 v18, 16, v32
    v_and_b32 v19, 0xffff0000, v32
    v_fmac_f32 v96, v18, v112
    v_fmac_f32 v97, v19, v112
    v_lshlrev_b32 v18, 16, v33
    v_and_b32 v19, 0xffff0000, v33
    v_fmac_f32 v98, v18, v112
    v_fmac_f32 v99, v19, v112
    v_lshlrev_b32 v18, 16, v34
    v_and_b32 v19, 0xffff0000, v34
    v_fmac_f32 v100, v18, v112
    v_fmac_f32 v101, v19, v112
    v_lshlrev_b32 v18, 16, v35
    v_and_b32 v19, 0xffff0000, v35
    v_fmac_f32 v102, v18, v112
    v_fmac_f32 v103, v19, v112
    s_waitcnt vmcnt(26)
    v_lshlrev_b32 v18, 16, v36
    v_and_b32 v19, 0xffff0000, v36
    v_fmac_f32 v96, v18, v113
    v_fmac_f32 v97, v19, v113
    v_lshlrev_b32 v18, 16, v37
    v_and_b32 v19, 0xffff0000, v37
    v_fmac_f32 v98, v18, v113
    v_fmac_f32 v99, v19, v113
    v_lshlrev_b32 v18, 16, v38
    v_and_b32 v19, 0xffff0000, v38
    v_fmac_f32 v100, v18, v113
    v_fmac_f32 v101, v19, v113
    v_lshlrev_b32 v18, 16, v39
    v_and_b32 v19, 0xffff0000, v39
    v_fmac_f32 v102, v18, v113
    v_fmac_f32 v103, v19, v113
    s_waitcnt vmcnt(25)
    v_lshlrev_b32 v18, 16, v40
    v_and_b32 v19, 0xffff0000, v40
    v_fmac_f32 v96, v18, v114
    v_fmac_f32 v97, v19, v114
    v_lshlrev_b32 v18, 16, v41
    v_and_b32 v19, 0xffff0000, v41
    v_fmac_f32 v98, v18, v114
    v_fmac_f32 v99, v19, v114
    v_lshlrev_b32 v18, 16, v42
    v_and_b32 v19, 0xffff0000, v42
    v_fmac_f32 v100, v18, v114
    v_fmac_f32 v101, v19, v114
    v_lshlrev_b32 v18, 16, v43
    v_and_b32 v19, 0xffff0000, v43
    v_fmac_f32 v102, v18, v114
    v_fmac_f32 v103, v19, v114
    s_waitcnt vmcnt(24)
    v_lshlrev_b32 v18, 16, v44
    v_and_b32 v19, 0xffff0000, v44
    v_fmac_f32 v96, v18, v115
    v_fmac_f32 v97, v19, v115
    v_lshlrev_b32 v18, 16, v45
    v_and_b32 v19, 0xffff0000, v45
    v_fmac_f32 v98, v18, v115
    v_fmac_f32 v99, v19, v115
    v_lshlrev_b32 v18, 16, v46
    v_and_b32 v19, 0xffff0000, v46
    v_fmac_f32 v100, v18, v115
    v_fmac_f32 v101, v19, v115
    v_lshlrev_b32 v18, 16, v47
    v_and_b32 v19, 0xffff0000, v47
    v_fmac_f32 v102, v18, v115
    v_fmac_f32 v103, v19, v115
    s_waitcnt vmcnt(23)
    v_lshlrev_b32 v18, 16, v48
    v_and_b32 v19, 0xffff0000, v48
    v_fmac_f32 v96, v18, v116
    v_fmac_f32 v97, v19, v116
    v_lshlrev_b32 v18, 16, v49
    v_and_b32 v19, 0xffff0000, v49
    v_fmac_f32 v98, v18, v116
    v_fmac_f32 v99, v19, v116
    v_lshlrev_b32 v18, 16, v50
    v_and_b32 v19, 0xffff0000, v50
    v_fmac_f32 v100, v18, v116
    v_fmac_f32 v101, v19, v116
    v_lshlrev_b32 v18, 16, v51
    v_and_b32 v19, 0xffff0000, v51
    v_fmac_f32 v102, v18, v116
    v_fmac_f32 v103, v19, v116
    s_waitcnt vmcnt(22)
    v_lshlrev_b32 v18, 16, v52
    v_and_b32 v19, 0xffff0000, v52
    v_fmac_f32 v96, v18, v117
    v_fmac_f32 v97, v19, v117
    v_lshlrev_b32 v18, 16, v53
    v_and_b32 v19, 0xffff0000, v53
    v_fmac_f32 v98, v18, v117
    v_fmac_f32 v99, v19, v117
    v_lshlrev_b32 v18, 16, v54
    v_and_b32 v19, 0xffff0000, v54
    v_fmac_f32 v100, v18, v117
    v_fmac_f32 v101, v19, v117
    v_lshlrev_b32 v18, 16, v55
    v_and_b32 v19, 0xffff0000, v55
    v_fmac_f32 v102, v18, v117
    v_fmac_f32 v103, v19, v117
    s_waitcnt vmcnt(21)
    v_lshlrev_b32 v18, 16, v56
    v_and_b32 v19, 0xffff0000, v56
    v_fmac_f32 v96, v18, v118
    v_fmac_f32 v97, v19, v118
    v_lshlrev_b32 v18, 16, v57
    v_and_b32 v19, 0xffff0000, v57
    v_fmac_f32 v98, v18, v118
    v_fmac_f32 v99, v19, v118
    v_lshlrev_b32 v18, 16, v58
    v_and_b32 v19, 0xffff0000, v58
    v_fmac_f32 v100, v18, v118
    v_fmac_f32 v101, v19, v118
    v_lshlrev_b32 v18, 16, v59
    v_and_b32 v19, 0xffff0000, v59
    v_fmac_f32 v102, v18, v118
    v_fmac_f32 v103, v19, v118
    s_waitcnt vmcnt(20)
    v_lshlrev_b32 v18, 16, v60
    v_and_b32 v19, 0xffff0000, v60
    v_fmac_f32 v96, v18, v119
    v_fmac_f32 v97, v19, v119
    v_lshlrev_b32 v18, 16, v61
    v_and_b32 v19, 0xffff0000, v61
    v_fmac_f32 v98, v18, v119
    v_fmac_f32 v99, v19, v119
    v_lshlrev_b32 v18, 16, v62
    v_and_b32 v19, 0xffff0000, v62
    v_fmac_f32 v100, v18, v119
    v_fmac_f32 v101, v19, v119
    v_lshlrev_b32 v18, 16, v63
    v_and_b32 v19, 0xffff0000, v63
    v_fmac_f32 v102, v18, v119
    v_fmac_f32 v103, v19, v119
    s_waitcnt vmcnt(19)
    v_lshlrev_b32 v18, 16, v64
    v_and_b32 v19, 0xffff0000, v64
    v_fmac_f32 v96, v18, v120
    v_fmac_f32 v97, v19, v120
    v_lshlrev_b32 v18, 16, v65
    v_and_b32 v19, 0xffff0000, v65
    v_fmac_f32 v98, v18, v120
    v_fmac_f32 v99, v19, v120
    v_lshlrev_b32 v18, 16, v66
    v_and_b32 v19, 0xffff0000, v66
    v_fmac_f32 v100, v18, v120
    v_fmac_f32 v101, v19, v120
    v_lshlrev_b32 v18, 16, v67
    v_and_b32 v19, 0xffff0000, v67
    v_fmac_f32 v102, v18, v120
    v_fmac_f32 v103, v19, v120
    s_waitcnt vmcnt(18)
    v_lshlrev_b32 v18, 16, v68
    v_and_b32 v19, 0xffff0000, v68
    v_fmac_f32 v96, v18, v121
    v_fmac_f32 v97, v19, v121
    v_lshlrev_b32 v18, 16, v69
    v_and_b32 v19, 0xffff0000, v69
    v_fmac_f32 v98, v18, v121
    v_fmac_f32 v99, v19, v121
    v_lshlrev_b32 v18, 16, v70
    v_and_b32 v19, 0xffff0000, v70
    v_fmac_f32 v100, v18, v121
    v_fmac_f32 v101, v19, v121
    v_lshlrev_b32 v18, 16, v71
    v_and_b32 v19, 0xffff0000, v71
    v_fmac_f32 v102, v18, v121
    v_fmac_f32 v103, v19, v121
    s_waitcnt vmcnt(17)
    v_lshlrev_b32 v18, 16, v72
    v_and_b32 v19, 0xffff0000, v72
    v_fmac_f32 v96, v18, v122
    v_fmac_f32 v97, v19, v122
    v_lshlrev_b32 v18, 16, v73
    v_and_b32 v19, 0xffff0000, v73
    v_fmac_f32 v98, v18, v122
    v_fmac_f32 v99, v19, v122
    v_lshlrev_b32 v18, 16, v74
    v_and_b32 v19, 0xffff0000, v74
    v_fmac_f32 v100, v18, v122
    v_fmac_f32 v101, v19, v122
    v_lshlrev_b32 v18, 16, v75
    v_and_b32 v19, 0xffff0000, v75
    v_fmac_f32 v102, v18, v122
    v_fmac_f32 v103, v19, v122
    s_waitcnt vmcnt(16)
    v_lshlrev_b32 v18, 16, v76
    v_and_b32 v19, 0xffff0000, v76
    v_fmac_f32 v96, v18, v123
    v_fmac_f32 v97, v19, v123
    v_lshlrev_b32 v18, 16, v77
    v_and_b32 v19, 0xffff0000, v77
    v_fmac_f32 v98, v18, v123
    v_fmac_f32 v99, v19, v123
    v_lshlrev_b32 v18, 16, v78
    v_and_b32 v19, 0xffff0000, v78
    v_fmac_f32 v100, v18, v123
    v_fmac_f32 v101, v19, v123
    v_lshlrev_b32 v18, 16, v79
    v_and_b32 v19, 0xffff0000, v79
    v_fmac_f32 v102, v18, v123
    v_fmac_f32 v103, v19, v123
    s_waitcnt vmcnt(15)
    v_lshlrev_b32 v18, 16, v80
    v_and_b32 v19, 0xffff0000, v80
    v_fmac_f32 v96, v18, v124
    v_fmac_f32 v97, v19, v124
    v_lshlrev_b32 v18, 16, v81
    v_and_b32 v19, 0xffff0000, v81
    v_fmac_f32 v98, v18, v124
    v_fmac_f32 v99, v19, v124
    v_lshlrev_b32 v18, 16, v82
    v_and_b32 v19, 0xffff0000, v82
    v_fmac_f32 v100, v18, v124
    v_fmac_f32 v101, v19, v124
    v_lshlrev_b32 v18, 16, v83
    v_and_b32 v19, 0xffff0000, v83
    v_fmac_f32 v102, v18, v124
    v_fmac_f32 v103, v19, v124
    s_waitcnt vmcnt(14)
    v_lshlrev_b32 v18, 16, v84
    v_and_b32 v19, 0xffff0000, v84
    v_fmac_f32 v96, v18, v125
    v_fmac_f32 v97, v19, v125
    v_lshlrev_b32 v18, 16, v85
    v_and_b32 v19, 0xffff0000, v85
    v_fmac_f32 v98, v18, v125
    v_fmac_f32 v99, v19, v125
    v_lshlrev_b32 v18, 16, v86
    v_and_b32 v19, 0xffff0000, v86
    v_fmac_f32 v100, v18, v125
    v_fmac_f32 v101, v19, v125
    v_lshlrev_b32 v18, 16, v87
    v_and_b32 v19, 0xffff0000, v87
    v_fmac_f32 v102, v18, v125
    v_fmac_f32 v103, v19, v125
    s_waitcnt vmcnt(13)
    v_lshlrev_b32 v18, 16, v88
    v_and_b32 v19, 0xffff0000, v88
    v_fmac_f32 v96, v18, v126
    v_fmac_f32 v97, v19, v126
    v_lshlrev_b32 v18, 16, v89
    v_and_b32 v19, 0xffff0000, v89
    v_fmac_f32 v98, v18, v126
    v_fmac_f32 v99, v19, v126
    v_lshlrev_b32 v18, 16, v90
    v_and_b32 v19, 0xffff0000, v90
    v_fmac_f32 v100, v18, v126
    v_fmac_f32 v101, v19, v126
    v_lshlrev_b32 v18, 16, v91
    v_and_b32 v19, 0xffff0000, v91
    v_fmac_f32 v102, v18, v126
    v_fmac_f32 v103, v19, v126
    s_waitcnt vmcnt(12)
    v_lshlrev_b32 v18, 16, v92
    v_and_b32 v19, 0xffff0000, v92
    v_fmac_f32 v96, v18, v127
    v_fmac_f32 v97, v19, v127
    v_lshlrev_b32 v18, 16, v93
    v_and_b32 v19, 0xffff0000, v93
    v_fmac_f32 v98, v18, v127
    v_fmac_f32 v99, v19, v127
    v_lshlrev_b32 v18, 16, v94
    v_and_b32 v19, 0xffff0000, v94
    v_fmac_f32 v100, v18, v127
    v_fmac_f32 v101, v19, v127
    v_lshlrev_b32 v18, 16, v95
    v_and_b32 v19, 0xffff0000, v95
    v_fmac_f32 v102, v18, v127
    v_fmac_f32 v103, v19, v127
    v_lshlrev_b32 v16, 5, v0
    ds_write_b128 v16, v[96:99]
    ds_write_b128 v16, v[100:103] offset:16
    s_waitcnt lgkmcnt(0)
    s_barrier
    s_cmp_lg_u32 s44, 0
    s_cbranch_scc1 L_mod_fin_111
    v_mov_b32 v18, 0
    ds_read_b32 v32, v12 offset:0
    ds_read_b32 v33, v12 offset:256
    ds_read_b32 v34, v12 offset:512
    ds_read_b32 v35, v12 offset:768
    ds_read_b32 v36, v12 offset:1024
    ds_read_b32 v37, v12 offset:1280
    ds_read_b32 v38, v12 offset:1536
    ds_read_b32 v39, v12 offset:1792
    ds_read_b32 v40, v12 offset:2048
    ds_read_b32 v41, v12 offset:2304
    ds_read_b32 v42, v12 offset:2560
    ds_read_b32 v43, v12 offset:2816
    ds_read_b32 v44, v12 offset:3072
    ds_read_b32 v45, v12 offset:3328
    ds_read_b32 v46, v12 offset:3584
    ds_read_b32 v47, v12 offset:3840
    s_waitcnt lgkmcnt(0)
    v_add_f32 v18, v18, v32
    v_add_f32 v18, v18, v33
    v_add_f32 v18, v18, v34
    v_add_f32 v18, v18, v35
    v_add_f32 v18, v18, v36
    v_add_f32 v18, v18, v37
    v_add_f32 v18, v18, v38
    v_add_f32 v18, v18, v39
    v_add_f32 v18, v18, v40
    v_add_f32 v18, v18, v41
    v_add_f32 v18, v18, v42
    v_add_f32 v18, v18, v43
    v_add_f32 v18, v18, v44
    v_add_f32 v18, v18, v45
    v_add_f32 v18, v18, v46
    v_add_f32 v18, v18, v47
    ds_read_b32 v32, v12 offset:4096
    ds_read_b32 v33, v12 offset:4352
    ds_read_b32 v34, v12 offset:4608
    ds_read_b32 v35, v12 offset:4864
    ds_read_b32 v36, v12 offset:5120
    ds_read_b32 v37, v12 offset:5376
    ds_read_b32 v38, v12 offset:5632
    ds_read_b32 v39, v12 offset:5888
    ds_read_b32 v40, v12 offset:6144
    ds_read_b32 v41, v12 offset:6400
    ds_read_b32 v42, v12 offset:6656
    ds_read_b32 v43, v12 offset:6912
    ds_read_b32 v44, v12 offset:7168
    ds_read_b32 v45, v12 offset:7424
    ds_read_b32 v46, v12 offset:7680
    ds_read_b32 v47, v12 offset:7936
    s_waitcnt lgkmcnt(0)
    v_add_f32 v18, v18, v32
    v_add_f32 v18, v18, v33
    v_add_f32 v18, v18, v34
    v_add_f32 v18, v18, v35
    v_add_f32 v18, v18, v36
    v_add_f32 v18, v18, v37
    v_add_f32 v18, v18, v38
    v_add_f32 v18, v18, v39
    v_add_f32 v18, v18, v40
    v_add_f32 v18, v18, v41
    v_add_f32 v18, v18, v42
    v_add_f32 v18, v18, v43
    v_add_f32 v18, v18, v44
    v_add_f32 v18, v18, v45
    v_add_f32 v18, v18, v46
    v_add_f32 v18, v18, v47
    s_lshr_b32 s45, s39, 1
    s_lshl_b32 s45, s45, 8
    s_mul_i32 s46, s47, 24576
    s_add_u32 s45, s45, s46
    buffer_store_dword v18, v12, s[12:15], s45 offen sc1
L_mod_fin_111:
    s_waitcnt vmcnt(0)
    s_barrier
    s_cmp_lg_u32 s44, 0
    s_cbranch_scc1 L_cnt_112
    v_mov_b32 v30, 1
    v_mov_b32 v31, 0
    s_mov_b64 exec, 1
    buffer_atomic_add v30, v31, s[16:19], 0 offen offset:128 sc1
    buffer_atomic_add v30, v31, s[16:19], 0 offen offset:64 sc1
    s_mov_b64 exec, -1
L_cnt_112:
    v_lshlrev_b32 v192, 16, v128
    v_and_b32 v193, 0xffff0000, v128
    v_lshlrev_b32 v194, 16, v129
    v_and_b32 v195, 0xffff0000, v129
    v_lshlrev_b32 v196, 16, v130
    v_and_b32 v197, 0xffff0000, v130
    v_lshlrev_b32 v198, 16, v131
    v_and_b32 v199, 0xffff0000, v131
    v_lshlrev_b32 v200, 16, v132
    v_and_b32 v201, 0xffff0000, v132
    v_lshlrev_b32 v202, 16, v133
    v_and_b32 v203, 0xffff0000, v133
    v_lshlrev_b32 v204, 16, v134
    v_and_b32 v205, 0xffff0000, v134
    v_lshlrev_b32 v206, 16, v135
    v_and_b32 v207, 0xffff0000, v135
    v_add_f32 v26, v192, v193
    v_add_f32 v26, v26, v194
    v_add_f32 v26, v26, v195
    v_add_f32 v26, v26, v196
    v_add_f32 v26, v26, v197
    v_add_f32 v26, v26, v198
    v_add_f32 v26, v26, v199
    v_add_f32 v26, v26, v200
    v_add_f32 v26, v26, v201
    v_add_f32 v26, v26, v202
    v_add_f32 v26, v26, v203
    v_add_f32 v26, v26, v204
    v_add_f32 v26, v26, v205
    v_add_f32 v26, v26, v206
    v_add_f32 v26, v26, v207
    s_nop 1
    v_add_f32_dpp v26, v26, v26 row_shr:1 row_mask:0xf bank_mask:0xf bound_ctrl:0
    s_nop 1
    v_add_f32_dpp v26, v26, v26 row_shr:2 row_mask:0xf bank_mask:0xf bound_ctrl:0
    s_nop 1
    v_add_f32_dpp v26, v26, v26 row_shr:4 row_mask:0xf bank_mask:0xf bound_ctrl:0
    s_nop 1
    v_add_f32_dpp v26, v26, v26 row_shr:8 row_mask:0xf bank_mask:0xf bound_ctrl:0
    s_nop 1
    v_add_f32_dpp v26, v26, v26 row_bcast:15 row_mask:0xa bank_mask:0xf
    s_nop 1
    v_add_f32_dpp v26, v26, v26 row_bcast:31 row_mask:0xc bank_mask:0xf
    s_nop 1
    v_readlane_b32 s66, v26, 63
    s_nop 1
    v_mov_b32 v27, s66
    v_mul_f32 v27, 0x3a800000, v27
    v_mov_b32 v26, 0
    v_sub_f32 v28, v192, v27
    v_fmac_f32 v26, v28, v28
    v_sub_f32 v28, v193, v27
    v_fmac_f32 v26, v28, v28
    v_sub_f32 v28, v194, v27
    v_fmac_f32 v26, v28, v28
    v_sub_f32 v28, v195, v27
    v_fmac_f32 v26, v28, v28
    v_sub_f32 v28, v196, v27
    v_fmac_f32 v26, v28, v28
    v_sub_f32 v28, v197, v27
    v_fmac_f32 v26, v28, v28
    v_sub_f32 v28, v198, v27
    v_fmac_f32 v26, v28, v28
    v_sub_f32 v28, v199, v27
    v_fmac_f32 v26, v28, v28
    v_sub_f32 v28, v200, v27
    v_fmac_f32 v26, v28, v28
    v_sub_f32 v28, v201, v27
    v_fmac_f32 v26, v28, v28
    v_sub_f32 v28, v202, v27
    v_fmac_f32 v26, v28, v28
    v_sub_f32 v28, v203, v27
    v_fmac_f32 v26, v28, v28
    v_sub_f32 v28, v204, v27
    v_fmac_f32 v26, v28, v28
    v_sub_f32 v28, v205, v27
    v_fmac_f32 v26, v28, v28
    v_sub_f32 v28, v206, v27
    v_fmac_f32 v26, v28, v28
    v_sub_f32 v28, v207, v27
    v_fmac_f32 v26, v28, v28
    s_nop 1
    v_add_f32_dpp v26, v26, v26 row_shr:1 row_mask:0xf bank_mask:0xf bound_ctrl:0
    s_nop 1
    v_add_f32_dpp v26, v26, v26 row_shr:2 row_mask:0xf bank_mask:0xf bound_ctrl:0
    s_nop 1
    v_add_f32_dpp v26, v26, v26 row_shr:4 row_mask:0xf bank_mask:0xf bound_ctrl:0
    s_nop 1
    v_add_f32_dpp v26, v26, v26 row_shr:8 row_mask:0xf bank_mask:0xf bound_ctrl:0
    s_nop 1
    v_add_f32_dpp v26, v26, v26 row_bcast:15 row_mask:0xa bank_mask:0xf
    s_nop 1
    v_add_f32_dpp v26, v26, v26 row_bcast:31 row_mask:0xc bank_mask:0xf
    s_nop 1
    v_readlane_b32 s66, v26, 63
    s_nop 1
    v_mov_b32 v26, s66
    v_mul_f32 v26, 0x3a800000, v26
    v_cvt_pk_bf16_f32 v26, v26, v26
    v_lshlrev_b32 v26, 16, v26
    v_cvt_pk_bf16_f32 v27, v27, v27
    v_lshlrev_b32 v27, 16, v27
    v_add_f32 v26, 0x3727c5ac, v26
    v_cvt_pk_bf16_f32 v26, v26, v26
    v_lshlrev_b32 v26, 16, v26
    v_sqrt_f32 v26, v26
    s_nop 0
    v_cvt_pk_bf16_f32 v26, v26, v26
    v_lshlrev_b32 v26, 16, v26
    v_rcp_f32 v26, v26
    s_nop 0
    v_sub_f32 v192, v192, v27
    v_cvt_pk_bf16_f32 v192, v192, v192
    v_lshlrev_b32 v192, 16, v192
    v_mul_f32 v192, v192, v26
    v_cvt_pk_bf16_f32 v192, v192, v192
    v_lshlrev_b32 v192, 16, v192
    v_sub_f32 v193, v193, v27
    v_cvt_pk_bf16_f32 v193, v193, v193
    v_lshlrev_b32 v193, 16, v193
    v_mul_f32 v193, v193, v26
    v_cvt_pk_bf16_f32 v193, v193, v193
    v_lshlrev_b32 v193, 16, v193
    v_sub_f32 v194, v194, v27
    v_cvt_pk_bf16_f32 v194, v194, v194
    v_lshlrev_b32 v194, 16, v194
    v_mul_f32 v194, v194, v26
    v_cvt_pk_bf16_f32 v194, v194, v194
    v_lshlrev_b32 v194, 16, v194
    v_sub_f32 v195, v195, v27
    v_cvt_pk_bf16_f32 v195, v195, v195
    v_lshlrev_b32 v195, 16, v195
    v_mul_f32 v195, v195, v26
    v_cvt_pk_bf16_f32 v195, v195, v195
    v_lshlrev_b32 v195, 16, v195
    v_sub_f32 v196, v196, v27
    v_cvt_pk_bf16_f32 v196, v196, v196
    v_lshlrev_b32 v196, 16, v196
    v_mul_f32 v196, v196, v26
    v_cvt_pk_bf16_f32 v196, v196, v196
    v_lshlrev_b32 v196, 16, v196
    v_sub_f32 v197, v197, v27
    v_cvt_pk_bf16_f32 v197, v197, v197
    v_lshlrev_b32 v197, 16, v197
    v_mul_f32 v197, v197, v26
    v_cvt_pk_bf16_f32 v197, v197, v197
    v_lshlrev_b32 v197, 16, v197
    v_sub_f32 v198, v198, v27
    v_cvt_pk_bf16_f32 v198, v198, v198
    v_lshlrev_b32 v198, 16, v198
    v_mul_f32 v198, v198, v26
    v_cvt_pk_bf16_f32 v198, v198, v198
    v_lshlrev_b32 v198, 16, v198
    v_sub_f32 v199, v199, v27
    v_cvt_pk_bf16_f32 v199, v199, v199
    v_lshlrev_b32 v199, 16, v199
    v_mul_f32 v199, v199, v26
    v_cvt_pk_bf16_f32 v199, v199, v199
    v_lshlrev_b32 v199, 16, v199
    v_sub_f32 v200, v200, v27
    v_cvt_pk_bf16_f32 v200, v200, v200
    v_lshlrev_b32 v200, 16, v200
    v_mul_f32 v200, v200, v26
    v_cvt_pk_bf16_f32 v200, v200, v200
    v_lshlrev_b32 v200, 16, v200
    v_sub_f32 v201, v201, v27
    v_cvt_pk_bf16_f32 v201, v201, v201
    v_lshlrev_b32 v201, 16, v201
    v_mul_f32 v201, v201, v26
    v_cvt_pk_bf16_f32 v201, v201, v201
    v_lshlrev_b32 v201, 16, v201
    v_sub_f32 v202, v202, v27
    v_cvt_pk_bf16_f32 v202, v202, v202
    v_lshlrev_b32 v202, 16, v202
    v_mul_f32 v202, v202, v26
    v_cvt_pk_bf16_f32 v202, v202, v202
    v_lshlrev_b32 v202, 16, v202
    v_sub_f32 v203, v203, v27
    v_cvt_pk_bf16_f32 v203, v203, v203
    v_lshlrev_b32 v203, 16, v203
    v_mul_f32 v203, v203, v26
    v_cvt_pk_bf16_f32 v203, v203, v203
    v_lshlrev_b32 v203, 16, v203
    v_sub_f32 v204, v204, v27
    v_cvt_pk_bf16_f32 v204, v204, v204
    v_lshlrev_b32 v204, 16, v204
    v_mul_f32 v204, v204, v26
    v_cvt_pk_bf16_f32 v204, v204, v204
    v_lshlrev_b32 v204, 16, v204
    v_sub_f32 v205, v205, v27
    v_cvt_pk_bf16_f32 v205, v205, v205
    v_lshlrev_b32 v205, 16, v205
    v_mul_f32 v205, v205, v26
    v_cvt_pk_bf16_f32 v205, v205, v205
    v_lshlrev_b32 v205, 16, v205
    v_sub_f32 v206, v206, v27
    v_cvt_pk_bf16_f32 v206, v206, v206
    v_lshlrev_b32 v206, 16, v206
    v_mul_f32 v206, v206, v26
    v_cvt_pk_bf16_f32 v206, v206, v206
    v_lshlrev_b32 v206, 16, v206
    v_sub_f32 v207, v207, v27
    v_cvt_pk_bf16_f32 v207, v207, v207
    v_lshlrev_b32 v207, 16, v207
    v_mul_f32 v207, v207, v26
    v_cvt_pk_bf16_f32 v207, v207, v207
    v_lshlrev_b32 v207, 16, v207
    v_lshlrev_b32 v208, 16, v136
    v_and_b32 v209, 0xffff0000, v136
    v_lshlrev_b32 v210, 16, v137
    v_and_b32 v211, 0xffff0000, v137
    v_lshlrev_b32 v212, 16, v138
    v_and_b32 v213, 0xffff0000, v138
    v_lshlrev_b32 v214, 16, v139
    v_and_b32 v215, 0xffff0000, v139
    v_lshlrev_b32 v216, 16, v140
    v_and_b32 v217, 0xffff0000, v140
    v_lshlrev_b32 v218, 16, v141
    v_and_b32 v219, 0xffff0000, v141
    v_lshlrev_b32 v220, 16, v142
    v_and_b32 v221, 0xffff0000, v142
    v_lshlrev_b32 v222, 16, v143
    v_and_b32 v223, 0xffff0000, v143
    v_add_f32 v26, v208, v209
    v_add_f32 v26, v26, v210
    v_add_f32 v26, v26, v211
    v_add_f32 v26, v26, v212
    v_add_f32 v26, v26, v213
    v_add_f32 v26, v26, v214
    v_add_f32 v26, v26, v215
    v_add_f32 v26, v26, v216
    v_add_f32 v26, v26, v217
    v_add_f32 v26, v26, v218
    v_add_f32 v26, v26, v219
    v_add_f32 v26, v26, v220
    v_add_f32 v26, v26, v221
    v_add_f32 v26, v26, v222
    v_add_f32 v26, v26, v223
    s_nop 1
    v_add_f32_dpp v26, v26, v26 row_shr:1 row_mask:0xf bank_mask:0xf bound_ctrl:0
    s_nop 1
    v_add_f32_dpp v26, v26, v26 row_shr:2 row_mask:0xf bank_mask:0xf bound_ctrl:0
    s_nop 1
    v_add_f32_dpp v26, v26, v26 row_shr:4 row_mask:0xf bank_mask:0xf bound_ctrl:0
    s_nop 1
    v_add_f32_dpp v26, v26, v26 row_shr:8 row_mask:0xf bank_mask:0xf bound_ctrl:0
    s_nop 1
    v_add_f32_dpp v26, v26, v26 row_bcast:15 row_mask:0xa bank_mask:0xf
    s_nop 1
    v_add_f32_dpp v26, v26, v26 row_bcast:31 row_mask:0xc bank_mask:0xf
    s_nop 1
    v_readlane_b32 s66, v26, 63
    s_nop 1
    v_mov_b32 v27, s66
    v_mul_f32 v27, 0x3a800000, v27
    v_mov_b32 v26, 0
    v_sub_f32 v28, v208, v27
    v_fmac_f32 v26, v28, v28
    v_sub_f32 v28, v209, v27
    v_fmac_f32 v26, v28, v28
    v_sub_f32 v28, v210, v27
    v_fmac_f32 v26, v28, v28
    v_sub_f32 v28, v211, v27
    v_fmac_f32 v26, v28, v28
    v_sub_f32 v28, v212, v27
    v_fmac_f32 v26, v28, v28
    v_sub_f32 v28, v213, v27
    v_fmac_f32 v26, v28, v28
    v_sub_f32 v28, v214, v27
    v_fmac_f32 v26, v28, v28
    v_sub_f32 v28, v215, v27
    v_fmac_f32 v26, v28, v28
    v_sub_f32 v28, v216, v27
    v_fmac_f32 v26, v28, v28
    v_sub_f32 v28, v217, v27
    v_fmac_f32 v26, v28, v28
    v_sub_f32 v28, v218, v27
    v_fmac_f32 v26, v28, v28
    v_sub_f32 v28, v219, v27
    v_fmac_f32 v26, v28, v28
    v_sub_f32 v28, v220, v27
    v_fmac_f32 v26, v28, v28
    v_sub_f32 v28, v221, v27
    v_fmac_f32 v26, v28, v28
    v_sub_f32 v28, v222, v27
    v_fmac_f32 v26, v28, v28
    v_sub_f32 v28, v223, v27
    v_fmac_f32 v26, v28, v28
    s_nop 1
    v_add_f32_dpp v26, v26, v26 row_shr:1 row_mask:0xf bank_mask:0xf bound_ctrl:0
    s_nop 1
    v_add_f32_dpp v26, v26, v26 row_shr:2 row_mask:0xf bank_mask:0xf bound_ctrl:0
    s_nop 1
    v_add_f32_dpp v26, v26, v26 row_shr:4 row_mask:0xf bank_mask:0xf bound_ctrl:0
    s_nop 1
    v_add_f32_dpp v26, v26, v26 row_shr:8 row_mask:0xf bank_mask:0xf bound_ctrl:0
    s_nop 1
    v_add_f32_dpp v26, v26, v26 row_bcast:15 row_mask:0xa bank_mask:0xf
    s_nop 1
    v_add_f32_dpp v26, v26, v26 row_bcast:31 row_mask:0xc bank_mask:0xf
    s_nop 1
    v_readlane_b32 s66, v26, 63
    s_nop 1
    v_mov_b32 v26, s66
    v_mul_f32 v26, 0x3a800000, v26
    v_cvt_pk_bf16_f32 v26, v26, v26
    v_lshlrev_b32 v26, 16, v26
    v_cvt_pk_bf16_f32 v27, v27, v27
    v_lshlrev_b32 v27, 16, v27
    v_add_f32 v26, 0x3727c5ac, v26
    v_cvt_pk_bf16_f32 v26, v26, v26
    v_lshlrev_b32 v26, 16, v26
    v_sqrt_f32 v26, v26
    s_nop 0
    v_cvt_pk_bf16_f32 v26, v26, v26
    v_lshlrev_b32 v26, 16, v26
    v_rcp_f32 v26, v26
    s_nop 0
    v_sub_f32 v208, v208, v27
    v_cvt_pk_bf16_f32 v208, v208, v208
    v_lshlrev_b32 v208, 16, v208
    v_mul_f32 v208, v208, v26
    v_cvt_pk_bf16_f32 v208, v208, v208
    v_lshlrev_b32 v208, 16, v208
    v_sub_f32 v209, v209, v27
    v_cvt_pk_bf16_f32 v209, v209, v209
    v_lshlrev_b32 v209, 16, v209
    v_mul_f32 v209, v209, v26
    v_cvt_pk_bf16_f32 v209, v209, v209
    v_lshlrev_b32 v209, 16, v209
    v_sub_f32 v210, v210, v27
    v_cvt_pk_bf16_f32 v210, v210, v210
    v_lshlrev_b32 v210, 16, v210
    v_mul_f32 v210, v210, v26
    v_cvt_pk_bf16_f32 v210, v210, v210
    v_lshlrev_b32 v210, 16, v210
    v_sub_f32 v211, v211, v27
    v_cvt_pk_bf16_f32 v211, v211, v211
    v_lshlrev_b32 v211, 16, v211
    v_mul_f32 v211, v211, v26
    v_cvt_pk_bf16_f32 v211, v211, v211
    v_lshlrev_b32 v211, 16, v211
    v_sub_f32 v212, v212, v27
    v_cvt_pk_bf16_f32 v212, v212, v212
    v_lshlrev_b32 v212, 16, v212
    v_mul_f32 v212, v212, v26
    v_cvt_pk_bf16_f32 v212, v212, v212
    v_lshlrev_b32 v212, 16, v212
    v_sub_f32 v213, v213, v27
    v_cvt_pk_bf16_f32 v213, v213, v213
    v_lshlrev_b32 v213, 16, v213
    v_mul_f32 v213, v213, v26
    v_cvt_pk_bf16_f32 v213, v213, v213
    v_lshlrev_b32 v213, 16, v213
    v_sub_f32 v214, v214, v27
    v_cvt_pk_bf16_f32 v214, v214, v214
    v_lshlrev_b32 v214, 16, v214
    v_mul_f32 v214, v214, v26
    v_cvt_pk_bf16_f32 v214, v214, v214
    v_lshlrev_b32 v214, 16, v214
    v_sub_f32 v215, v215, v27
    v_cvt_pk_bf16_f32 v215, v215, v215
    v_lshlrev_b32 v215, 16, v215
    v_mul_f32 v215, v215, v26
    v_cvt_pk_bf16_f32 v215, v215, v215
    v_lshlrev_b32 v215, 16, v215
    v_sub_f32 v216, v216, v27
    v_cvt_pk_bf16_f32 v216, v216, v216
    v_lshlrev_b32 v216, 16, v216
    v_mul_f32 v216, v216, v26
    v_cvt_pk_bf16_f32 v216, v216, v216
    v_lshlrev_b32 v216, 16, v216
    v_sub_f32 v217, v217, v27
    v_cvt_pk_bf16_f32 v217, v217, v217
    v_lshlrev_b32 v217, 16, v217
    v_mul_f32 v217, v217, v26
    v_cvt_pk_bf16_f32 v217, v217, v217
    v_lshlrev_b32 v217, 16, v217
    v_sub_f32 v218, v218, v27
    v_cvt_pk_bf16_f32 v218, v218, v218
    v_lshlrev_b32 v218, 16, v218
    v_mul_f32 v218, v218, v26
    v_cvt_pk_bf16_f32 v218, v218, v218
    v_lshlrev_b32 v218, 16, v218
    v_sub_f32 v219, v219, v27
    v_cvt_pk_bf16_f32 v219, v219, v219
    v_lshlrev_b32 v219, 16, v219
    v_mul_f32 v219, v219, v26
    v_cvt_pk_bf16_f32 v219, v219, v219
    v_lshlrev_b32 v219, 16, v219
    v_sub_f32 v220, v220, v27
    v_cvt_pk_bf16_f32 v220, v220, v220
    v_lshlrev_b32 v220, 16, v220
    v_mul_f32 v220, v220, v26
    v_cvt_pk_bf16_f32 v220, v220, v220
    v_lshlrev_b32 v220, 16, v220
    v_sub_f32 v221, v221, v27
    v_cvt_pk_bf16_f32 v221, v221, v221
    v_lshlrev_b32 v221, 16, v221
    v_mul_f32 v221, v221, v26
    v_cvt_pk_bf16_f32 v221, v221, v221
    v_lshlrev_b32 v221, 16, v221
    v_sub_f32 v222, v222, v27
    v_cvt_pk_bf16_f32 v222, v222, v222
    v_lshlrev_b32 v222, 16, v222
    v_mul_f32 v222, v222, v26
    v_cvt_pk_bf16_f32 v222, v222, v222
    v_lshlrev_b32 v222, 16, v222
    v_sub_f32 v223, v223, v27
    v_cvt_pk_bf16_f32 v223, v223, v223
    v_lshlrev_b32 v223, 16, v223
    v_mul_f32 v223, v223, v26
    v_cvt_pk_bf16_f32 v223, v223, v223
    v_lshlrev_b32 v223, 16, v223
    s_cmp_lg_u32 s44, 0
    s_cbranch_scc1 L_pd_113
    v_mov_b32 v29, 128
    s_mov_b32 s46, 96
    s_mov_b64 exec, 1
    s_mov_b32 s70, 0
L_wp_114:
    buffer_load_dword v31, v29, s[16:19], 0 offen sc1
    s_add_u32 s70, s70, 1
    s_cmp_ge_u32 s70, 0x200000
    s_cbranch_scc1 L_w_done_108
    s_waitcnt vmcnt(0)
    v_cmp_gt_u32 vcc, s46, v31
    s_nop 1
    s_cbranch_vccz L_wp_114_ok
    s_sleep 1
    s_branch L_wp_114
L_wp_114_ok:
    s_mov_b64 exec, -1
L_pd_113:
    s_barrier
    v_lshlrev_b32 v29, 5, v1
    s_mov_b32 s45, 0
    buffer_load_dwordx4 v[96:99], v29, s[12:15], s45 offen offset:0 sc1
    buffer_load_dwordx4 v[100:103], v29, s[12:15], s45 offen offset:16 sc1
    buffer_load_dwordx4 v[104:107], v29, s[12:15], s45 offen offset:2048 sc1
    buffer_load_dwordx4 v[108:111], v29, s[12:15], s45 offen offset:2064 sc1
    s_mov_b32 s45, 24576
    buffer_load_dwordx4 v[32:35], v29, s[12:15], s45 offen offset:0 sc1
    buffer_load_dwordx4 v[36:39], v29, s[12:15], s45 offen offset:16 sc1
    buffer_load_dwordx4 v[40:43], v29, s[12:15], s45 offen offset:2048 sc1
    buffer_load_dwordx4 v[44:47], v29, s[12:15], s45 offen offset:2064 sc1
    s_mov_b32 s45, 4096
    buffer_load_dwordx4 v[112:115], v29, s[12:15], s45 offen offset:0 sc1
    buffer_load_dwordx4 v[116:119], v29, s[12:15], s45 offen offset:16 sc1
    buffer_load_dwordx4 v[120:123], v29, s[12:15], s45 offen offset:2048 sc1
    buffer_load_dwordx4 v[124:127], v29, s[12:15], s45 offen offset:2064 sc1
    s_mov_b32 s45, 28672
    buffer_load_dwordx4 v[48:51], v29, s[12:15], s45 offen offset:0 sc1
    buffer_load_dwordx4 v[52:55], v29, s[12:15], s45 offen offset:16 sc1
    buffer_load_dwordx4 v[56:59], v29, s[12:15], s45 offen offset:2048 sc1
    buffer_load_dwordx4 v[60:63], v29, s[12:15], s45 offen offset:2064 sc1
    s_waitcnt vmcnt(0)
    v_add_f32 v96, v96, v32
    v_cvt_pk_bf16_f32 v96, v96, v96
    v_lshlrev_b32 v96, 16, v96
    v_add_f32 v97, v97, v33
    v_cvt_pk_bf16_f32 v97, v97, v97
    v_lshlrev_b32 v97, 16, v97
    v_add_f32 v98, v98, v34
    v_cvt_pk_bf16_f32 v98, v98, v98
    v_lshlrev_b32 v98, 16, v98
    v_add_f32 v99, v99, v35
    v_cvt_pk_bf16_f32 v99, v99, v99
    v_lshlrev_b32 v99, 16, v99
    v_add_f32 v100, v100, v36
    v_cvt_pk_bf16_f32 v100, v100, v100
    v_lshlrev_b32 v100, 16, v100
    v_add_f32 v101, v101, v37
    v_cvt_pk_bf16_f32 v101, v101, v101
    v_lshlrev_b32 v101, 16, v101
    v_add_f32 v102, v102, v38
    v_cvt_pk_bf16_f32 v102, v102, v102
    v_lshlrev_b32 v102, 16, v102
    v_add_f32 v103, v103, v39
    v_cvt_pk_bf16_f32 v103, v103, v103
    v_lshlrev_b32 v103, 16, v103
    v_add_f32 v104, v104, v40
    v_cvt_pk_bf16_f32 v104, v104, v104
    v_lshlrev_b32 v104, 16, v104
    v_add_f32 v105, v105, v41
    v_cvt_pk_bf16_f32 v105, v105, v105
    v_lshlrev_b32 v105, 16, v105
    v_add_f32 v106, v106, v42
    v_cvt_pk_bf16_f32 v106, v106, v106
    v_lshlrev_b32 v106, 16, v106
    v_add_f32 v107, v107, v43
    v_cvt_pk_bf16_f32 v107, v107, v107
    v_lshlrev_b32 v107, 16, v107
    v_add_f32 v108, v108, v44
    v_cvt_pk_bf16_f32 v108, v108, v108
    v_lshlrev_b32 v108, 16, v108
    v_add_f32 v109, v109, v45
    v_cvt_pk_bf16_f32 v109, v109, v109
    v_lshlrev_b32 v109, 16, v109
    v_add_f32 v110, v110, v46
    v_cvt_pk_bf16_f32 v110, v110, v110
    v_lshlrev_b32 v110, 16, v110
    v_add_f32 v111, v111, v47
    v_cvt_pk_bf16_f32 v111, v111, v111
    v_lshlrev_b32 v111, 16, v111
    v_add_f32 v112, v112, v48
    v_cvt_pk_bf16_f32 v112, v112, v112
    v_lshlrev_b32 v112, 16, v112
    v_add_f32 v112, 1.0, v112
    v_cvt_pk_bf16_f32 v112, v112, v112
    v_lshlrev_b32 v112, 16, v112
    v_add_f32 v113, v113, v49
    v_cvt_pk_bf16_f32 v113, v113, v113
    v_lshlrev_b32 v113, 16, v113
    v_add_f32 v113, 1.0, v113
    v_cvt_pk_bf16_f32 v113, v113, v113
    v_lshlrev_b32 v113, 16, v113
    v_add_f32 v114, v114, v50
    v_cvt_pk_bf16_f32 v114, v114, v114
    v_lshlrev_b32 v114, 16, v114
    v_add_f32 v114, 1.0, v114
    v_cvt_pk_bf16_f32 v114, v114, v114
    v_lshlrev_b32 v114, 16, v114
    v_add_f32 v115, v115, v51
    v_cvt_pk_bf16_f32 v115, v115, v115
    v_lshlrev_b32 v115, 16, v115
    v_add_f32 v115, 1.0, v115
    v_cvt_pk_bf16_f32 v115, v115, v115
    v_lshlrev_b32 v115, 16, v115
    v_add_f32 v116, v116, v52
    v_cvt_pk_bf16_f32 v116, v116, v116
    v_lshlrev_b32 v116, 16, v116
    v_add_f32 v116, 1.0, v116
    v_cvt_pk_bf16_f32 v116, v116, v116
    v_lshlrev_b32 v116, 16, v116
    v_add_f32 v117, v117, v53
    v_cvt_pk_bf16_f32 v117, v117, v117
    v_lshlrev_b32 v117, 16, v117
    v_add_f32 v117, 1.0, v117
    v_cvt_pk_bf16_f32 v117, v117, v117
    v_lshlrev_b32 v117, 16, v117
    v_add_f32 v118, v118, v54
    v_cvt_pk_bf16_f32 v118, v118, v118
    v_lshlrev_b32 v118, 16, v118
    v_add_f32 v118, 1.0, v118
    v_cvt_pk_bf16_f32 v118, v118, v118
    v_lshlrev_b32 v118, 16, v118
    v_add_f32 v119, v119, v55
    v_cvt_pk_bf16_f32 v119, v119, v119
    v_lshlrev_b32 v119, 16, v119
    v_add_f32 v119, 1.0, v119
    v_cvt_pk_bf16_f32 v119, v119, v119
    v_lshlrev_b32 v119, 16, v119
    v_add_f32 v120, v120, v56
    v_cvt_pk_bf16_f32 v120, v120, v120
    v_lshlrev_b32 v120, 16, v120
    v_add_f32 v120, 1.0, v120
    v_cvt_pk_bf16_f32 v120, v120, v120
    v_lshlrev_b32 v120, 16, v120
    v_add_f32 v121, v121, v57
    v_cvt_pk_bf16_f32 v121, v121, v121
    v_lshlrev_b32 v121, 16, v121
    v_add_f32 v121, 1.0, v121
    v_cvt_pk_bf16_f32 v121, v121, v121
    v_lshlrev_b32 v121, 16, v121
    v_add_f32 v122, v122, v58
    v_cvt_pk_bf16_f32 v122, v122, v122
    v_lshlrev_b32 v122, 16, v122
    v_add_f32 v122, 1.0, v122
    v_cvt_pk_bf16_f32 v122, v122, v122
    v_lshlrev_b32 v122, 16, v122
    v_add_f32 v123, v123, v59
    v_cvt_pk_bf16_f32 v123, v123, v123
    v_lshlrev_b32 v123, 16, v123
    v_add_f32 v123, 1.0, v123
    v_cvt_pk_bf16_f32 v123, v123, v123
    v_lshlrev_b32 v123, 16, v123
    v_add_f32 v124, v124, v60
    v_cvt_pk_bf16_f32 v124, v124, v124
    v_lshlrev_b32 v124, 16, v124
    v_add_f32 v124, 1.0, v124
    v_cvt_pk_bf16_f32 v124, v124, v124
    v_lshlrev_b32 v124, 16, v124
    v_add_f32 v125, v125, v61
    v_cvt_pk_bf16_f32 v125, v125, v125
    v_lshlrev_b32 v125, 16, v125
    v_add_f32 v125, 1.0, v125
    v_cvt_pk_bf16_f32 v125, v125, v125
    v_lshlrev_b32 v125, 16, v125
    v_add_f32 v126, v126, v62
    v_cvt_pk_bf16_f32 v126, v126, v126
    v_lshlrev_b32 v126, 16, v126
    v_add_f32 v126, 1.0, v126
    v_cvt_pk_bf16_f32 v126, v126, v126
    v_lshlrev_b32 v126, 16, v126
    v_add_f32 v127, v127, v63
    v_cvt_pk_bf16_f32 v127, v127, v127
    v_lshlrev_b32 v127, 16, v127
    v_add_f32 v127, 1.0, v127
    v_cvt_pk_bf16_f32 v127, v127, v127
    v_lshlrev_b32 v127, 16, v127
    v_mul_f32 v192, v192, v112
    v_cvt_pk_bf16_f32 v192, v192, v192
    v_lshlrev_b32 v192, 16, v192
    v_add_f32 v192, v192, v96
    v_mul_f32 v193, v193, v113
    v_cvt_pk_bf16_f32 v193, v193, v193
    v_lshlrev_b32 v193, 16, v193
    v_add_f32 v193, v193, v97
    v_mul_f32 v194, v194, v114
    v_cvt_pk_bf16_f32 v194, v194, v194
    v_lshlrev_b32 v194, 16, v194
    v_add_f32 v194, v194, v98
    v_mul_f32 v195, v195, v115
    v_cvt_pk_bf16_f32 v195, v195, v195
    v_lshlrev_b32 v195, 16, v195
    v_add_f32 v195, v195, v99
    v_mul_f32 v196, v196, v116
    v_cvt_pk_bf16_f32 v196, v196, v196
    v_lshlrev_b32 v196, 16, v196
    v_add_f32 v196, v196, v100
    v_mul_f32 v197, v197, v117
    v_cvt_pk_bf16_f32 v197, v197, v197
    v_lshlrev_b32 v197, 16, v197
    v_add_f32 v197, v197, v101
    v_mul_f32 v198, v198, v118
    v_cvt_pk_bf16_f32 v198, v198, v198
    v_lshlrev_b32 v198, 16, v198
    v_add_f32 v198, v198, v102
    v_mul_f32 v199, v199, v119
    v_cvt_pk_bf16_f32 v199, v199, v199
    v_lshlrev_b32 v199, 16, v199
    v_add_f32 v199, v199, v103
    v_mul_f32 v200, v200, v120
    v_cvt_pk_bf16_f32 v200, v200, v200
    v_lshlrev_b32 v200, 16, v200
    v_add_f32 v200, v200, v104
    v_mul_f32 v201, v201, v121
    v_cvt_pk_bf16_f32 v201, v201, v201
    v_lshlrev_b32 v201, 16, v201
    v_add_f32 v201, v201, v105
    v_mul_f32 v202, v202, v122
    v_cvt_pk_bf16_f32 v202, v202, v202
    v_lshlrev_b32 v202, 16, v202
    v_add_f32 v202, v202, v106
    v_mul_f32 v203, v203, v123
    v_cvt_pk_bf16_f32 v203, v203, v203
    v_lshlrev_b32 v203, 16, v203
    v_add_f32 v203, v203, v107
    v_mul_f32 v204, v204, v124
    v_cvt_pk_bf16_f32 v204, v204, v204
    v_lshlrev_b32 v204, 16, v204
    v_add_f32 v204, v204, v108
    v_mul_f32 v205, v205, v125
    v_cvt_pk_bf16_f32 v205, v205, v205
    v_lshlrev_b32 v205, 16, v205
    v_add_f32 v205, v205, v109
    v_mul_f32 v206, v206, v126
    v_cvt_pk_bf16_f32 v206, v206, v206
    v_lshlrev_b32 v206, 16, v206
    v_add_f32 v206, v206, v110
    v_mul_f32 v207, v207, v127
    v_cvt_pk_bf16_f32 v207, v207, v207
    v_lshlrev_b32 v207, 16, v207
    v_add_f32 v207, v207, v111
    v_cvt_pk_bf16_f32 v80, v192, v193
    v_cvt_pk_bf16_f32 v81, v194, v195
    v_cvt_pk_bf16_f32 v82, v196, v197
    v_cvt_pk_bf16_f32 v83, v198, v199
    v_cvt_pk_bf16_f32 v84, v200, v201
    v_cvt_pk_bf16_f32 v85, v202, v203
    v_cvt_pk_bf16_f32 v86, v204, v205
    v_cvt_pk_bf16_f32 v87, v206, v207
    s_lshr_b32 s45, s63, 5
    s_lshl_b32 s45, s45, 16
    s_and_b32 s46, s63, 31
    s_lshl_b32 s46, s46, 8
    s_add_u32 s45, s45, s46
    s_add_u32 s45, s45, 0x400000
    s_add_u32 s46, s45, 32768
    buffer_store_dwordx4 v[80:83], v2, s[12:15], s45 offen sc1
    buffer_store_dwordx4 v[84:87], v2, s[12:15], s46 offen sc1
    s_add_u32 s63, s63, 384
    v_mul_f32 v208, v208, v112
    v_cvt_pk_bf16_f32 v208, v208, v208
    v_lshlrev_b32 v208, 16, v208
    v_add_f32 v208, v208, v96
    v_mul_f32 v209, v209, v113
    v_cvt_pk_bf16_f32 v209, v209, v209
    v_lshlrev_b32 v209, 16, v209
    v_add_f32 v209, v209, v97
    v_mul_f32 v210, v210, v114
    v_cvt_pk_bf16_f32 v210, v210, v210
    v_lshlrev_b32 v210, 16, v210
    v_add_f32 v210, v210, v98
    v_mul_f32 v211, v211, v115
    v_cvt_pk_bf16_f32 v211, v211, v211
    v_lshlrev_b32 v211, 16, v211
    v_add_f32 v211, v211, v99
    v_mul_f32 v212, v212, v116
    v_cvt_pk_bf16_f32 v212, v212, v212
    v_lshlrev_b32 v212, 16, v212
    v_add_f32 v212, v212, v100
    v_mul_f32 v213, v213, v117
    v_cvt_pk_bf16_f32 v213, v213, v213
    v_lshlrev_b32 v213, 16, v213
    v_add_f32 v213, v213, v101
    v_mul_f32 v214, v214, v118
    v_cvt_pk_bf16_f32 v214, v214, v214
    v_lshlrev_b32 v214, 16, v214
    v_add_f32 v214, v214, v102
    v_mul_f32 v215, v215, v119
    v_cvt_pk_bf16_f32 v215, v215, v215
    v_lshlrev_b32 v215, 16, v215
    v_add_f32 v215, v215, v103
    v_mul_f32 v216, v216, v120
    v_cvt_pk_bf16_f32 v216, v216, v216
    v_lshlrev_b32 v216, 16, v216
    v_add_f32 v216, v216, v104
    v_mul_f32 v217, v217, v121
    v_cvt_pk_bf16_f32 v217, v217, v217
    v_lshlrev_b32 v217, 16, v217
    v_add_f32 v217, v217, v105
    v_mul_f32 v218, v218, v122
    v_cvt_pk_bf16_f32 v218, v218, v218
    v_lshlrev_b32 v218, 16, v218
    v_add_f32 v218, v218, v106
    v_mul_f32 v219, v219, v123
    v_cvt_pk_bf16_f32 v219, v219, v219
    v_lshlrev_b32 v219, 16, v219
    v_add_f32 v219, v219, v107
    v_mul_f32 v220, v220, v124
    v_cvt_pk_bf16_f32 v220, v220, v220
    v_lshlrev_b32 v220, 16, v220
    v_add_f32 v220, v220, v108
    v_mul_f32 v221, v221, v125
    v_cvt_pk_bf16_f32 v221, v221, v221
    v_lshlrev_b32 v221, 16, v221
    v_add_f32 v221, v221, v109
    v_mul_f32 v222, v222, v126
    v_cvt_pk_bf16_f32 v222, v222, v222
    v_lshlrev_b32 v222, 16, v222
    v_add_f32 v222, v222, v110
    v_mul_f32 v223, v223, v127
    v_cvt_pk_bf16_f32 v223, v223, v223
    v_lshlrev_b32 v223, 16, v223
    v_add_f32 v223, v223, v111
    v_cvt_pk_bf16_f32 v88, v208, v209
    v_cvt_pk_bf16_f32 v89, v210, v211
    v_cvt_pk_bf16_f32 v90, v212, v213
    v_cvt_pk_bf16_f32 v91, v214, v215
    v_cvt_pk_bf16_f32 v92, v216, v217
    v_cvt_pk_bf16_f32 v93, v218, v219
    v_cvt_pk_bf16_f32 v94, v220, v221
    v_cvt_pk_bf16_f32 v95, v222, v223
    s_lshr_b32 s45, s63, 5
    s_lshl_b32 s45, s45, 16
    s_and_b32 s46, s63, 31
    s_lshl_b32 s46, s46, 8
    s_add_u32 s45, s45, s46
    s_add_u32 s45, s45, 0x400000
    s_add_u32 s46, s45, 32768
    buffer_store_dwordx4 v[88:91], v2, s[12:15], s45 offen sc1
    buffer_store_dwordx4 v[92:95], v2, s[12:15], s46 offen sc1
    s_waitcnt vmcnt(2)
    s_barrier
    s_cmp_lg_u32 s44, 0
    s_cbranch_scc1 L_cnt_116
    v_mov_b32 v30, 1
    v_mov_b32 v31, 0
    s_mov_b64 exec, 1
    buffer_atomic_add v30, v31, s[16:19], 0 offen offset:192 sc1
    s_mov_b64 exec, -1
L_cnt_116:
    s_add_u32 s63, s63, 384
    v_lshlrev_b32 v64, 16, v144
    v_and_b32 v65, 0xffff0000, v144
    v_lshlrev_b32 v66, 16, v145
    v_and_b32 v67, 0xffff0000, v145
    v_lshlrev_b32 v68, 16, v146
    v_and_b32 v69, 0xffff0000, v146
    v_lshlrev_b32 v70, 16, v147
    v_and_b32 v71, 0xffff0000, v147
    v_lshlrev_b32 v72, 16, v148
    v_and_b32 v73, 0xffff0000, v148
    v_lshlrev_b32 v74, 16, v149
    v_and_b32 v75, 0xffff0000, v149
    v_lshlrev_b32 v76, 16, v150
    v_and_b32 v77, 0xffff0000, v150
    v_lshlrev_b32 v78, 16, v151
    v_and_b32 v79, 0xffff0000, v151
    v_add_f32 v26, v64, v65
    v_add_f32 v26, v26, v66
    v_add_f32 v26, v26, v67
    v_add_f32 v26, v26, v68
    v_add_f32 v26, v26, v69
    v_add_f32 v26, v26, v70
    v_add_f32 v26, v26, v71
    v_add_f32 v26, v26, v72
    v_add_f32 v26, v26, v73
    v_add_f32 v26, v26, v74
    v_add_f32 v26, v26, v75
    v_add_f32 v26, v26, v76
    v_add_f32 v26, v26, v77
    v_add_f32 v26, v26, v78
    v_add_f32 v26, v26, v79
    s_nop 1
    v_add_f32_dpp v26, v26, v26 row_shr:1 row_mask:0xf bank_mask:0xf bound_ctrl:0
    s_nop 1
    v_add_f32_dpp v26, v26, v26 row_shr:2 row_mask:0xf bank_mask:0xf bound_ctrl:0
    s_nop 1
    v_add_f32_dpp v26, v26, v26 row_shr:4 row_mask:0xf bank_mask:0xf bound_ctrl:0
    s_nop 1
    v_add_f32_dpp v26, v26, v26 row_shr:8 row_mask:0xf bank_mask:0xf bound_ctrl:0
    s_nop 1
    v_add_f32_dpp v26, v26, v26 row_bcast:15 row_mask:0xa bank_mask:0xf
    s_nop 1
    v_add_f32_dpp v26, v26, v26 row_bcast:31 row_mask:0xc bank_mask:0xf
    s_nop 1
    v_readlane_b32 s66, v26, 63
    s_nop 1
    v_mov_b32 v27, s66
    v_mul_f32 v27, 0x3a800000, v27
    v_mov_b32 v26, 0
    v_sub_f32 v28, v64, v27
    v_fmac_f32 v26, v28, v28
    v_sub_f32 v28, v65, v27
    v_fmac_f32 v26, v28, v28
    v_sub_f32 v28, v66, v27
    v_fmac_f32 v26, v28, v28
    v_sub_f32 v28, v67, v27
    v_fmac_f32 v26, v28, v28
    v_sub_f32 v28, v68, v27
    v_fmac_f32 v26, v28, v28
    v_sub_f32 v28, v69, v27
    v_fmac_f32 v26, v28, v28
    v_sub_f32 v28, v70, v27
    v_fmac_f32 v26, v28, v28
    v_sub_f32 v28, v71, v27
    v_fmac_f32 v26, v28, v28
    v_sub_f32 v28, v72, v27
    v_fmac_f32 v26, v28, v28
    v_sub_f32 v28, v73, v27
    v_fmac_f32 v26, v28, v28
    v_sub_f32 v28, v74, v27
    v_fmac_f32 v26, v28, v28
    v_sub_f32 v28, v75, v27
    v_fmac_f32 v26, v28, v28
    v_sub_f32 v28, v76, v27
    v_fmac_f32 v26, v28, v28
    v_sub_f32 v28, v77, v27
    v_fmac_f32 v26, v28, v28
    v_sub_f32 v28, v78, v27
    v_fmac_f32 v26, v28, v28
    v_sub_f32 v28, v79, v27
    v_fmac_f32 v26, v28, v28
    s_nop 1
    v_add_f32_dpp v26, v26, v26 row_shr:1 row_mask:0xf bank_mask:0xf bound_ctrl:0
    s_nop 1
    v_add_f32_dpp v26, v26, v26 row_shr:2 row_mask:0xf bank_mask:0xf bound_ctrl:0
    s_nop 1
    v_add_f32_dpp v26, v26, v26 row_shr:4 row_mask:0xf bank_mask:0xf bound_ctrl:0
    s_nop 1
    v_add_f32_dpp v26, v26, v26 row_shr:8 row_mask:0xf bank_mask:0xf bound_ctrl:0
    s_nop 1
    v_add_f32_dpp v26, v26, v26 row_bcast:15 row_mask:0xa bank_mask:0xf
    s_nop 1
    v_add_f32_dpp v26, v26, v26 row_bcast:31 row_mask:0xc bank_mask:0xf
    s_nop 1
    v_readlane_b32 s66, v26, 63
    s_nop 1
    v_mov_b32 v26, s66
    v_mul_f32 v26, 0x3a800000, v26
    v_cvt_pk_bf16_f32 v26, v26, v26
    v_lshlrev_b32 v26, 16, v26
    v_cvt_pk_bf16_f32 v27, v27, v27
    v_lshlrev_b32 v27, 16, v27
    v_add_f32 v26, 0x3727c5ac, v26
    v_cvt_pk_bf16_f32 v26, v26, v26
    v_lshlrev_b32 v26, 16, v26
    v_sqrt_f32 v26, v26
    s_nop 0
    v_cvt_pk_bf16_f32 v26, v26, v26
    v_lshlrev_b32 v26, 16, v26
    v_rcp_f32 v26, v26
    s_nop 0
    v_sub_f32 v64, v64, v27
    v_cvt_pk_bf16_f32 v64, v64, v64
    v_lshlrev_b32 v64, 16, v64
    v_mul_f32 v64, v64, v26
    v_cvt_pk_bf16_f32 v64, v64, v64
    v_lshlrev_b32 v64, 16, v64
    v_sub_f32 v65, v65, v27
    v_cvt_pk_bf16_f32 v65, v65, v65
    v_lshlrev_b32 v65, 16, v65
    v_mul_f32 v65, v65, v26
    v_cvt_pk_bf16_f32 v65, v65, v65
    v_lshlrev_b32 v65, 16, v65
    v_sub_f32 v66, v66, v27
    v_cvt_pk_bf16_f32 v66, v66, v66
    v_lshlrev_b32 v66, 16, v66
    v_mul_f32 v66, v66, v26
    v_cvt_pk_bf16_f32 v66, v66, v66
    v_lshlrev_b32 v66, 16, v66
    v_sub_f32 v67, v67, v27
    v_cvt_pk_bf16_f32 v67, v67, v67
    v_lshlrev_b32 v67, 16, v67
    v_mul_f32 v67, v67, v26
    v_cvt_pk_bf16_f32 v67, v67, v67
    v_lshlrev_b32 v67, 16, v67
    v_sub_f32 v68, v68, v27
    v_cvt_pk_bf16_f32 v68, v68, v68
    v_lshlrev_b32 v68, 16, v68
    v_mul_f32 v68, v68, v26
    v_cvt_pk_bf16_f32 v68, v68, v68
    v_lshlrev_b32 v68, 16, v68
    v_sub_f32 v69, v69, v27
    v_cvt_pk_bf16_f32 v69, v69, v69
    v_lshlrev_b32 v69, 16, v69
    v_mul_f32 v69, v69, v26
    v_cvt_pk_bf16_f32 v69, v69, v69
    v_lshlrev_b32 v69, 16, v69
    v_sub_f32 v70, v70, v27
    v_cvt_pk_bf16_f32 v70, v70, v70
    v_lshlrev_b32 v70, 16, v70
    v_mul_f32 v70, v70, v26
    v_cvt_pk_bf16_f32 v70, v70, v70
    v_lshlrev_b32 v70, 16, v70
    v_sub_f32 v71, v71, v27
    v_cvt_pk_bf16_f32 v71, v71, v71
    v_lshlrev_b32 v71, 16, v71
    v_mul_f32 v71, v71, v26
    v_cvt_pk_bf16_f32 v71, v71, v71
    v_lshlrev_b32 v71, 16, v71
    v_sub_f32 v72, v72, v27
    v_cvt_pk_bf16_f32 v72, v72, v72
    v_lshlrev_b32 v72, 16, v72
    v_mul_f32 v72, v72, v26
    v_cvt_pk_bf16_f32 v72, v72, v72
    v_lshlrev_b32 v72, 16, v72
    v_sub_f32 v73, v73, v27
    v_cvt_pk_bf16_f32 v73, v73, v73
    v_lshlrev_b32 v73, 16, v73
    v_mul_f32 v73, v73, v26
    v_cvt_pk_bf16_f32 v73, v73, v73
    v_lshlrev_b32 v73, 16, v73
    v_sub_f32 v74, v74, v27
    v_cvt_pk_bf16_f32 v74, v74, v74
    v_lshlrev_b32 v74, 16, v74
    v_mul_f32 v74, v74, v26
    v_cvt_pk_bf16_f32 v74, v74, v74
    v_lshlrev_b32 v74, 16, v74
    v_sub_f32 v75, v75, v27
    v_cvt_pk_bf16_f32 v75, v75, v75
    v_lshlrev_b32 v75, 16, v75
    v_mul_f32 v75, v75, v26
    v_cvt_pk_bf16_f32 v75, v75, v75
    v_lshlrev_b32 v75, 16, v75
    v_sub_f32 v76, v76, v27
    v_cvt_pk_bf16_f32 v76, v76, v76
    v_lshlrev_b32 v76, 16, v76
    v_mul_f32 v76, v76, v26
    v_cvt_pk_bf16_f32 v76, v76, v76
    v_lshlrev_b32 v76, 16, v76
    v_sub_f32 v77, v77, v27
    v_cvt_pk_bf16_f32 v77, v77, v77
    v_lshlrev_b32 v77, 16, v77
    v_mul_f32 v77, v77, v26
    v_cvt_pk_bf16_f32 v77, v77, v77
    v_lshlrev_b32 v77, 16, v77
    v_sub_f32 v78, v78, v27
    v_cvt_pk_bf16_f32 v78, v78, v78
    v_lshlrev_b32 v78, 16, v78
    v_mul_f32 v78, v78, v26
    v_cvt_pk_bf16_f32 v78, v78, v78
    v_lshlrev_b32 v78, 16, v78
    v_sub_f32 v79, v79, v27
    v_cvt_pk_bf16_f32 v79, v79, v79
    v_lshlrev_b32 v79, 16, v79
    v_mul_f32 v79, v79, v26
    v_cvt_pk_bf16_f32 v79, v79, v79
    v_lshlrev_b32 v79, 16, v79
    v_mul_f32 v64, v64, v112
    v_cvt_pk_bf16_f32 v64, v64, v64
    v_lshlrev_b32 v64, 16, v64
    v_add_f32 v64, v64, v96
    v_mul_f32 v65, v65, v113
    v_cvt_pk_bf16_f32 v65, v65, v65
    v_lshlrev_b32 v65, 16, v65
    v_add_f32 v65, v65, v97
    v_mul_f32 v66, v66, v114
    v_cvt_pk_bf16_f32 v66, v66, v66
    v_lshlrev_b32 v66, 16, v66
    v_add_f32 v66, v66, v98
    v_mul_f32 v67, v67, v115
    v_cvt_pk_bf16_f32 v67, v67, v67
    v_lshlrev_b32 v67, 16, v67
    v_add_f32 v67, v67, v99
    v_mul_f32 v68, v68, v116
    v_cvt_pk_bf16_f32 v68, v68, v68
    v_lshlrev_b32 v68, 16, v68
    v_add_f32 v68, v68, v100
    v_mul_f32 v69, v69, v117
    v_cvt_pk_bf16_f32 v69, v69, v69
    v_lshlrev_b32 v69, 16, v69
    v_add_f32 v69, v69, v101
    v_mul_f32 v70, v70, v118
    v_cvt_pk_bf16_f32 v70, v70, v70
    v_lshlrev_b32 v70, 16, v70
    v_add_f32 v70, v70, v102
    v_mul_f32 v71, v71, v119
    v_cvt_pk_bf16_f32 v71, v71, v71
    v_lshlrev_b32 v71, 16, v71
    v_add_f32 v71, v71, v103
    v_mul_f32 v72, v72, v120
    v_cvt_pk_bf16_f32 v72, v72, v72
    v_lshlrev_b32 v72, 16, v72
    v_add_f32 v72, v72, v104
    v_mul_f32 v73, v73, v121
    v_cvt_pk_bf16_f32 v73, v73, v73
    v_lshlrev_b32 v73, 16, v73
    v_add_f32 v73, v73, v105
    v_mul_f32 v74, v74, v122
    v_cvt_pk_bf16_f32 v74, v74, v74
    v_lshlrev_b32 v74, 16, v74
    v_add_f32 v74, v74, v106
    v_mul_f32 v75, v75, v123
    v_cvt_pk_bf16_f32 v75, v75, v75
    v_lshlrev_b32 v75, 16, v75
    v_add_f32 v75, v75, v107
    v_mul_f32 v76, v76, v124
    v_cvt_pk_bf16_f32 v76, v76, v76
    v_lshlrev_b32 v76, 16, v76
    v_add_f32 v76, v76, v108
    v_mul_f32 v77, v77, v125
    v_cvt_pk_bf16_f32 v77, v77, v77
    v_lshlrev_b32 v77, 16, v77
    v_add_f32 v77, v77, v109
    v_mul_f32 v78, v78, v126
    v_cvt_pk_bf16_f32 v78, v78, v78
    v_lshlrev_b32 v78, 16, v78
    v_add_f32 v78, v78, v110
    v_mul_f32 v79, v79, v127
    v_cvt_pk_bf16_f32 v79, v79, v79
    v_lshlrev_b32 v79, 16, v79
    v_add_f32 v79, v79, v111
    v_cvt_pk_bf16_f32 v80, v64, v65
    v_cvt_pk_bf16_f32 v81, v66, v67
    v_cvt_pk_bf16_f32 v82, v68, v69
    v_cvt_pk_bf16_f32 v83, v70, v71
    v_cvt_pk_bf16_f32 v84, v72, v73
    v_cvt_pk_bf16_f32 v85, v74, v75
    v_cvt_pk_bf16_f32 v86, v76, v77
    v_cvt_pk_bf16_f32 v87, v78, v79
    s_lshr_b32 s45, s63, 5
    s_lshl_b32 s45, s45, 16
    s_and_b32 s46, s63, 31
    s_lshl_b32 s46, s46, 8
    s_add_u32 s45, s45, s46
    s_add_u32 s45, s45, 0x400000
    s_add_u32 s46, s45, 32768
    buffer_store_dwordx4 v[80:83], v2, s[12:15], s45 offen sc1
    buffer_store_dwordx4 v[84:87], v2, s[12:15], s46 offen sc1
    s_add_u32 s63, s63, 384
    v_lshlrev_b32 v64, 16, v152
    v_and_b32 v65, 0xffff0000, v152
    v_lshlrev_b32 v66, 16, v153
    v_and_b32 v67, 0xffff0000, v153
    v_lshlrev_b32 v68, 16, v154
    v_and_b32 v69, 0xffff0000, v154
    v_lshlrev_b32 v70, 16, v155
    v_and_b32 v71, 0xffff0000, v155
    v_lshlrev_b32 v72, 16, v156
    v_and_b32 v73, 0xffff0000, v156
    v_lshlrev_b32 v74, 16, v157
    v_and_b32 v75, 0xffff0000, v157
    v_lshlrev_b32 v76, 16, v158
    v_and_b32 v77, 0xffff0000, v158
    v_lshlrev_b32 v78, 16, v159
    v_and_b32 v79, 0xffff0000, v159
    v_add_f32 v26, v64, v65
    v_add_f32 v26, v26, v66
    v_add_f32 v26, v26, v67
    v_add_f32 v26, v26, v68
    v_add_f32 v26, v26, v69
    v_add_f32 v26, v26, v70
    v_add_f32 v26, v26, v71
    v_add_f32 v26, v26, v72
    v_add_f32 v26, v26, v73
    v_add_f32 v26, v26, v74
    v_add_f32 v26, v26, v75
    v_add_f32 v26, v26, v76
    v_add_f32 v26, v26, v77
    v_add_f32 v26, v26, v78
    v_add_f32 v26, v26, v79
    s_nop 1
    v_add_f32_dpp v26, v26, v26 row_shr:1 row_mask:0xf bank_mask:0xf bound_ctrl:0
    s_nop 1
    v_add_f32_dpp v26, v26, v26 row_shr:2 row_mask:0xf bank_mask:0xf bound_ctrl:0
    s_nop 1
    v_add_f32_dpp v26, v26, v26 row_shr:4 row_mask:0xf bank_mask:0xf bound_ctrl:0
    s_nop 1
    v_add_f32_dpp v26, v26, v26 row_shr:8 row_mask:0xf bank_mask:0xf bound_ctrl:0
    s_nop 1
    v_add_f32_dpp v26, v26, v26 row_bcast:15 row_mask:0xa bank_mask:0xf
    s_nop 1
    v_add_f32_dpp v26, v26, v26 row_bcast:31 row_mask:0xc bank_mask:0xf
    s_nop 1
    v_readlane_b32 s66, v26, 63
    s_nop 1
    v_mov_b32 v27, s66
    v_mul_f32 v27, 0x3a800000, v27
    v_mov_b32 v26, 0
    v_sub_f32 v28, v64, v27
    v_fmac_f32 v26, v28, v28
    v_sub_f32 v28, v65, v27
    v_fmac_f32 v26, v28, v28
    v_sub_f32 v28, v66, v27
    v_fmac_f32 v26, v28, v28
    v_sub_f32 v28, v67, v27
    v_fmac_f32 v26, v28, v28
    v_sub_f32 v28, v68, v27
    v_fmac_f32 v26, v28, v28
    v_sub_f32 v28, v69, v27
    v_fmac_f32 v26, v28, v28
    v_sub_f32 v28, v70, v27
    v_fmac_f32 v26, v28, v28
    v_sub_f32 v28, v71, v27
    v_fmac_f32 v26, v28, v28
    v_sub_f32 v28, v72, v27
    v_fmac_f32 v26, v28, v28
    v_sub_f32 v28, v73, v27
    v_fmac_f32 v26, v28, v28
    v_sub_f32 v28, v74, v27
    v_fmac_f32 v26, v28, v28
    v_sub_f32 v28, v75, v27
    v_fmac_f32 v26, v28, v28
    v_sub_f32 v28, v76, v27
    v_fmac_f32 v26, v28, v28
    v_sub_f32 v28, v77, v27
    v_fmac_f32 v26, v28, v28
    v_sub_f32 v28, v78, v27
    v_fmac_f32 v26, v28, v28
    v_sub_f32 v28, v79, v27
    v_fmac_f32 v26, v28, v28
    s_nop 1
    v_add_f32_dpp v26, v26, v26 row_shr:1 row_mask:0xf bank_mask:0xf bound_ctrl:0
    s_nop 1
    v_add_f32_dpp v26, v26, v26 row_shr:2 row_mask:0xf bank_mask:0xf bound_ctrl:0
    s_nop 1
    v_add_f32_dpp v26, v26, v26 row_shr:4 row_mask:0xf bank_mask:0xf bound_ctrl:0
    s_nop 1
    v_add_f32_dpp v26, v26, v26 row_shr:8 row_mask:0xf bank_mask:0xf bound_ctrl:0
    s_nop 1
    v_add_f32_dpp v26, v26, v26 row_bcast:15 row_mask:0xa bank_mask:0xf
    s_nop 1
    v_add_f32_dpp v26, v26, v26 row_bcast:31 row_mask:0xc bank_mask:0xf
    s_nop 1
    v_readlane_b32 s66, v26, 63
    s_nop 1
    v_mov_b32 v26, s66
    v_mul_f32 v26, 0x3a800000, v26
    v_cvt_pk_bf16_f32 v26, v26, v26
    v_lshlrev_b32 v26, 16, v26
    v_cvt_pk_bf16_f32 v27, v27, v27
    v_lshlrev_b32 v27, 16, v27
    v_add_f32 v26, 0x3727c5ac, v26
    v_cvt_pk_bf16_f32 v26, v26, v26
    v_lshlrev_b32 v26, 16, v26
    v_sqrt_f32 v26, v26
    s_nop 0
    v_cvt_pk_bf16_f32 v26, v26, v26
    v_lshlrev_b32 v26, 16, v26
    v_rcp_f32 v26, v26
    s_nop 0
    v_sub_f32 v64, v64, v27
    v_cvt_pk_bf16_f32 v64, v64, v64
    v_lshlrev_b32 v64, 16, v64
    v_mul_f32 v64, v64, v26
    v_cvt_pk_bf16_f32 v64, v64, v64
    v_lshlrev_b32 v64, 16, v64
    v_sub_f32 v65, v65, v27
    v_cvt_pk_bf16_f32 v65, v65, v65
    v_lshlrev_b32 v65, 16, v65
    v_mul_f32 v65, v65, v26
    v_cvt_pk_bf16_f32 v65, v65, v65
    v_lshlrev_b32 v65, 16, v65
    v_sub_f32 v66, v66, v27
    v_cvt_pk_bf16_f32 v66, v66, v66
    v_lshlrev_b32 v66, 16, v66
    v_mul_f32 v66, v66, v26
    v_cvt_pk_bf16_f32 v66, v66, v66
    v_lshlrev_b32 v66, 16, v66
    v_sub_f32 v67, v67, v27
    v_cvt_pk_bf16_f32 v67, v67, v67
    v_lshlrev_b32 v67, 16, v67
    v_mul_f32 v67, v67, v26
    v_cvt_pk_bf16_f32 v67, v67, v67
    v_lshlrev_b32 v67, 16, v67
    v_sub_f32 v68, v68, v27
    v_cvt_pk_bf16_f32 v68, v68, v68
    v_lshlrev_b32 v68, 16, v68
    v_mul_f32 v68, v68, v26
    v_cvt_pk_bf16_f32 v68, v68, v68
    v_lshlrev_b32 v68, 16, v68
    v_sub_f32 v69, v69, v27
    v_cvt_pk_bf16_f32 v69, v69, v69
    v_lshlrev_b32 v69, 16, v69
    v_mul_f32 v69, v69, v26
    v_cvt_pk_bf16_f32 v69, v69, v69
    v_lshlrev_b32 v69, 16, v69
    v_sub_f32 v70, v70, v27
    v_cvt_pk_bf16_f32 v70, v70, v70
    v_lshlrev_b32 v70, 16, v70
    v_mul_f32 v70, v70, v26
    v_cvt_pk_bf16_f32 v70, v70, v70
    v_lshlrev_b32 v70, 16, v70
    v_sub_f32 v71, v71, v27
    v_cvt_pk_bf16_f32 v71, v71, v71
    v_lshlrev_b32 v71, 16, v71
    v_mul_f32 v71, v71, v26
    v_cvt_pk_bf16_f32 v71, v71, v71
    v_lshlrev_b32 v71, 16, v71
    v_sub_f32 v72, v72, v27
    v_cvt_pk_bf16_f32 v72, v72, v72
    v_lshlrev_b32 v72, 16, v72
    v_mul_f32 v72, v72, v26
    v_cvt_pk_bf16_f32 v72, v72, v72
    v_lshlrev_b32 v72, 16, v72
    v_sub_f32 v73, v73, v27
    v_cvt_pk_bf16_f32 v73, v73, v73
    v_lshlrev_b32 v73, 16, v73
    v_mul_f32 v73, v73, v26
    v_cvt_pk_bf16_f32 v73, v73, v73
    v_lshlrev_b32 v73, 16, v73
    v_sub_f32 v74, v74, v27
    v_cvt_pk_bf16_f32 v74, v74, v74
    v_lshlrev_b32 v74, 16, v74
    v_mul_f32 v74, v74, v26
    v_cvt_pk_bf16_f32 v74, v74, v74
    v_lshlrev_b32 v74, 16, v74
    v_sub_f32 v75, v75, v27
    v_cvt_pk_bf16_f32 v75, v75, v75
    v_lshlrev_b32 v75, 16, v75
    v_mul_f32 v75, v75, v26
    v_cvt_pk_bf16_f32 v75, v75, v75
    v_lshlrev_b32 v75, 16, v75
    v_sub_f32 v76, v76, v27
    v_cvt_pk_bf16_f32 v76, v76, v76
    v_lshlrev_b32 v76, 16, v76
    v_mul_f32 v76, v76, v26
    v_cvt_pk_bf16_f32 v76, v76, v76
    v_lshlrev_b32 v76, 16, v76
    v_sub_f32 v77, v77, v27
    v_cvt_pk_bf16_f32 v77, v77, v77
    v_lshlrev_b32 v77, 16, v77
    v_mul_f32 v77, v77, v26
    v_cvt_pk_bf16_f32 v77, v77, v77
    v_lshlrev_b32 v77, 16, v77
    v_sub_f32 v78, v78, v27
    v_cvt_pk_bf16_f32 v78, v78, v78
    v_lshlrev_b32 v78, 16, v78
    v_mul_f32 v78, v78, v26
    v_cvt_pk_bf16_f32 v78, v78, v78
    v_lshlrev_b32 v78, 16, v78
    v_sub_f32 v79, v79, v27
    v_cvt_pk_bf16_f32 v79, v79, v79
    v_lshlrev_b32 v79, 16, v79
    v_mul_f32 v79, v79, v26
    v_cvt_pk_bf16_f32 v79, v79, v79
    v_lshlrev_b32 v79, 16, v79
    v_mul_f32 v64, v64, v112
    v_cvt_pk_bf16_f32 v64, v64, v64
    v_lshlrev_b32 v64, 16, v64
    v_add_f32 v64, v64, v96
    v_mul_f32 v65, v65, v113
    v_cvt_pk_bf16_f32 v65, v65, v65
    v_lshlrev_b32 v65, 16, v65
    v_add_f32 v65, v65, v97
    v_mul_f32 v66, v66, v114
    v_cvt_pk_bf16_f32 v66, v66, v66
    v_lshlrev_b32 v66, 16, v66
    v_add_f32 v66, v66, v98
    v_mul_f32 v67, v67, v115
    v_cvt_pk_bf16_f32 v67, v67, v67
    v_lshlrev_b32 v67, 16, v67
    v_add_f32 v67, v67, v99
    v_mul_f32 v68, v68, v116
    v_cvt_pk_bf16_f32 v68, v68, v68
    v_lshlrev_b32 v68, 16, v68
    v_add_f32 v68, v68, v100
    v_mul_f32 v69, v69, v117
    v_cvt_pk_bf16_f32 v69, v69, v69
    v_lshlrev_b32 v69, 16, v69
    v_add_f32 v69, v69, v101
    v_mul_f32 v70, v70, v118
    v_cvt_pk_bf16_f32 v70, v70, v70
    v_lshlrev_b32 v70, 16, v70
    v_add_f32 v70, v70, v102
    v_mul_f32 v71, v71, v119
    v_cvt_pk_bf16_f32 v71, v71, v71
    v_lshlrev_b32 v71, 16, v71
    v_add_f32 v71, v71, v103
    v_mul_f32 v72, v72, v120
    v_cvt_pk_bf16_f32 v72, v72, v72
    v_lshlrev_b32 v72, 16, v72
    v_add_f32 v72, v72, v104
    v_mul_f32 v73, v73, v121
    v_cvt_pk_bf16_f32 v73, v73, v73
    v_lshlrev_b32 v73, 16, v73
    v_add_f32 v73, v73, v105
    v_mul_f32 v74, v74, v122
    v_cvt_pk_bf16_f32 v74, v74, v74
    v_lshlrev_b32 v74, 16, v74
    v_add_f32 v74, v74, v106
    v_mul_f32 v75, v75, v123
    v_cvt_pk_bf16_f32 v75, v75, v75
    v_lshlrev_b32 v75, 16, v75
    v_add_f32 v75, v75, v107
    v_mul_f32 v76, v76, v124
    v_cvt_pk_bf16_f32 v76, v76, v76
    v_lshlrev_b32 v76, 16, v76
    v_add_f32 v76, v76, v108
    v_mul_f32 v77, v77, v125
    v_cvt_pk_bf16_f32 v77, v77, v77
    v_lshlrev_b32 v77, 16, v77
    v_add_f32 v77, v77, v109
    v_mul_f32 v78, v78, v126
    v_cvt_pk_bf16_f32 v78, v78, v78
    v_lshlrev_b32 v78, 16, v78
    v_add_f32 v78, v78, v110
    v_mul_f32 v79, v79, v127
    v_cvt_pk_bf16_f32 v79, v79, v79
    v_lshlrev_b32 v79, 16, v79
    v_add_f32 v79, v79, v111
    v_cvt_pk_bf16_f32 v80, v64, v65
    v_cvt_pk_bf16_f32 v81, v66, v67
    v_cvt_pk_bf16_f32 v82, v68, v69
    v_cvt_pk_bf16_f32 v83, v70, v71
    v_cvt_pk_bf16_f32 v84, v72, v73
    v_cvt_pk_bf16_f32 v85, v74, v75
    v_cvt_pk_bf16_f32 v86, v76, v77
    v_cvt_pk_bf16_f32 v87, v78, v79
    s_lshr_b32 s45, s63, 5
    s_lshl_b32 s45, s45, 16
    s_and_b32 s46, s63, 31
    s_lshl_b32 s46, s46, 8
    s_add_u32 s45, s45, s46
    s_add_u32 s45, s45, 0x400000
    s_add_u32 s46, s45, 32768
    buffer_store_dwordx4 v[80:83], v2, s[12:15], s45 offen sc1
    buffer_store_dwordx4 v[84:87], v2, s[12:15], s46 offen sc1
    s_add_u32 s63, s63, 384
    v_lshlrev_b32 v64, 16, v160
    v_and_b32 v65, 0xffff0000, v160
    v_lshlrev_b32 v66, 16, v161
    v_and_b32 v67, 0xffff0000, v161
    v_lshlrev_b32 v68, 16, v162
    v_and_b32 v69, 0xffff0000, v162
    v_lshlrev_b32 v70, 16, v163
    v_and_b32 v71, 0xffff0000, v163
    v_lshlrev_b32 v72, 16, v164
    v_and_b32 v73, 0xffff0000, v164
    v_lshlrev_b32 v74, 16, v165
    v_and_b32 v75, 0xffff0000, v165
    v_lshlrev_b32 v76, 16, v166
    v_and_b32 v77, 0xffff0000, v166
    v_lshlrev_b32 v78, 16, v167
    v_and_b32 v79, 0xffff0000, v167
    v_add_f32 v26, v64, v65
    v_add_f32 v26, v26, v66
    v_add_f32 v26, v26, v67
    v_add_f32 v26, v26, v68
    v_add_f32 v26, v26, v69
    v_add_f32 v26, v26, v70
    v_add_f32 v26, v26, v71
    v_add_f32 v26, v26, v72
    v_add_f32 v26, v26, v73
    v_add_f32 v26, v26, v74
    v_add_f32 v26, v26, v75
    v_add_f32 v26, v26, v76
    v_add_f32 v26, v26, v77
    v_add_f32 v26, v26, v78
    v_add_f32 v26, v26, v79
    s_nop 1
    v_add_f32_dpp v26, v26, v26 row_shr:1 row_mask:0xf bank_mask:0xf bound_ctrl:0
    s_nop 1
    v_add_f32_dpp v26, v26, v26 row_shr:2 row_mask:0xf bank_mask:0xf bound_ctrl:0
    s_nop 1
    v_add_f32_dpp v26, v26, v26 row_shr:4 row_mask:0xf bank_mask:0xf bound_ctrl:0
    s_nop 1
    v_add_f32_dpp v26, v26, v26 row_shr:8 row_mask:0xf bank_mask:0xf bound_ctrl:0
    s_nop 1
    v_add_f32_dpp v26, v26, v26 row_bcast:15 row_mask:0xa bank_mask:0xf
    s_nop 1
    v_add_f32_dpp v26, v26, v26 row_bcast:31 row_mask:0xc bank_mask:0xf
    s_nop 1
    v_readlane_b32 s66, v26, 63
    s_nop 1
    v_mov_b32 v27, s66
    v_mul_f32 v27, 0x3a800000, v27
    v_mov_b32 v26, 0
    v_sub_f32 v28, v64, v27
    v_fmac_f32 v26, v28, v28
    v_sub_f32 v28, v65, v27
    v_fmac_f32 v26, v28, v28
    v_sub_f32 v28, v66, v27
    v_fmac_f32 v26, v28, v28
    v_sub_f32 v28, v67, v27
    v_fmac_f32 v26, v28, v28
    v_sub_f32 v28, v68, v27
    v_fmac_f32 v26, v28, v28
    v_sub_f32 v28, v69, v27
    v_fmac_f32 v26, v28, v28
    v_sub_f32 v28, v70, v27
    v_fmac_f32 v26, v28, v28
    v_sub_f32 v28, v71, v27
    v_fmac_f32 v26, v28, v28
    v_sub_f32 v28, v72, v27
    v_fmac_f32 v26, v28, v28
    v_sub_f32 v28, v73, v27
    v_fmac_f32 v26, v28, v28
    v_sub_f32 v28, v74, v27
    v_fmac_f32 v26, v28, v28
    v_sub_f32 v28, v75, v27
    v_fmac_f32 v26, v28, v28
    v_sub_f32 v28, v76, v27
    v_fmac_f32 v26, v28, v28
    v_sub_f32 v28, v77, v27
    v_fmac_f32 v26, v28, v28
    v_sub_f32 v28, v78, v27
    v_fmac_f32 v26, v28, v28
    v_sub_f32 v28, v79, v27
    v_fmac_f32 v26, v28, v28
    s_nop 1
    v_add_f32_dpp v26, v26, v26 row_shr:1 row_mask:0xf bank_mask:0xf bound_ctrl:0
    s_nop 1
    v_add_f32_dpp v26, v26, v26 row_shr:2 row_mask:0xf bank_mask:0xf bound_ctrl:0
    s_nop 1
    v_add_f32_dpp v26, v26, v26 row_shr:4 row_mask:0xf bank_mask:0xf bound_ctrl:0
    s_nop 1
    v_add_f32_dpp v26, v26, v26 row_shr:8 row_mask:0xf bank_mask:0xf bound_ctrl:0
    s_nop 1
    v_add_f32_dpp v26, v26, v26 row_bcast:15 row_mask:0xa bank_mask:0xf
    s_nop 1
    v_add_f32_dpp v26, v26, v26 row_bcast:31 row_mask:0xc bank_mask:0xf
    s_nop 1
    v_readlane_b32 s66, v26, 63
    s_nop 1
    v_mov_b32 v26, s66
    v_mul_f32 v26, 0x3a800000, v26
    v_cvt_pk_bf16_f32 v26, v26, v26
    v_lshlrev_b32 v26, 16, v26
    v_cvt_pk_bf16_f32 v27, v27, v27
    v_lshlrev_b32 v27, 16, v27
    v_add_f32 v26, 0x3727c5ac, v26
    v_cvt_pk_bf16_f32 v26, v26, v26
    v_lshlrev_b32 v26, 16, v26
    v_sqrt_f32 v26, v26
    s_nop 0
    v_cvt_pk_bf16_f32 v26, v26, v26
    v_lshlrev_b32 v26, 16, v26
    v_rcp_f32 v26, v26
    s_nop 0
    v_sub_f32 v64, v64, v27
    v_cvt_pk_bf16_f32 v64, v64, v64
    v_lshlrev_b32 v64, 16, v64
    v_mul_f32 v64, v64, v26
    v_cvt_pk_bf16_f32 v64, v64, v64
    v_lshlrev_b32 v64, 16, v64
    v_sub_f32 v65, v65, v27
    v_cvt_pk_bf16_f32 v65, v65, v65
    v_lshlrev_b32 v65, 16, v65
    v_mul_f32 v65, v65, v26
    v_cvt_pk_bf16_f32 v65, v65, v65
    v_lshlrev_b32 v65, 16, v65
    v_sub_f32 v66, v66, v27
    v_cvt_pk_bf16_f32 v66, v66, v66
    v_lshlrev_b32 v66, 16, v66
    v_mul_f32 v66, v66, v26
    v_cvt_pk_bf16_f32 v66, v66, v66
    v_lshlrev_b32 v66, 16, v66
    v_sub_f32 v67, v67, v27
    v_cvt_pk_bf16_f32 v67, v67, v67
    v_lshlrev_b32 v67, 16, v67
    v_mul_f32 v67, v67, v26
    v_cvt_pk_bf16_f32 v67, v67, v67
    v_lshlrev_b32 v67, 16, v67
    v_sub_f32 v68, v68, v27
    v_cvt_pk_bf16_f32 v68, v68, v68
    v_lshlrev_b32 v68, 16, v68
    v_mul_f32 v68, v68, v26
    v_cvt_pk_bf16_f32 v68, v68, v68
    v_lshlrev_b32 v68, 16, v68
    v_sub_f32 v69, v69, v27
    v_cvt_pk_bf16_f32 v69, v69, v69
    v_lshlrev_b32 v69, 16, v69
    v_mul_f32 v69, v69, v26
    v_cvt_pk_bf16_f32 v69, v69, v69
    v_lshlrev_b32 v69, 16, v69
    v_sub_f32 v70, v70, v27
    v_cvt_pk_bf16_f32 v70, v70, v70
    v_lshlrev_b32 v70, 16, v70
    v_mul_f32 v70, v70, v26
    v_cvt_pk_bf16_f32 v70, v70, v70
    v_lshlrev_b32 v70, 16, v70
    v_sub_f32 v71, v71, v27
    v_cvt_pk_bf16_f32 v71, v71, v71
    v_lshlrev_b32 v71, 16, v71
    v_mul_f32 v71, v71, v26
    v_cvt_pk_bf16_f32 v71, v71, v71
    v_lshlrev_b32 v71, 16, v71
    v_sub_f32 v72, v72, v27
    v_cvt_pk_bf16_f32 v72, v72, v72
    v_lshlrev_b32 v72, 16, v72
    v_mul_f32 v72, v72, v26
    v_cvt_pk_bf16_f32 v72, v72, v72
    v_lshlrev_b32 v72, 16, v72
    v_sub_f32 v73, v73, v27
    v_cvt_pk_bf16_f32 v73, v73, v73
    v_lshlrev_b32 v73, 16, v73
    v_mul_f32 v73, v73, v26
    v_cvt_pk_bf16_f32 v73, v73, v73
    v_lshlrev_b32 v73, 16, v73
    v_sub_f32 v74, v74, v27
    v_cvt_pk_bf16_f32 v74, v74, v74
    v_lshlrev_b32 v74, 16, v74
    v_mul_f32 v74, v74, v26
    v_cvt_pk_bf16_f32 v74, v74, v74
    v_lshlrev_b32 v74, 16, v74
    v_sub_f32 v75, v75, v27
    v_cvt_pk_bf16_f32 v75, v75, v75
    v_lshlrev_b32 v75, 16, v75
    v_mul_f32 v75, v75, v26
    v_cvt_pk_bf16_f32 v75, v75, v75
    v_lshlrev_b32 v75, 16, v75
    v_sub_f32 v76, v76, v27
    v_cvt_pk_bf16_f32 v76, v76, v76
    v_lshlrev_b32 v76, 16, v76
    v_mul_f32 v76, v76, v26
    v_cvt_pk_bf16_f32 v76, v76, v76
    v_lshlrev_b32 v76, 16, v76
    v_sub_f32 v77, v77, v27
    v_cvt_pk_bf16_f32 v77, v77, v77
    v_lshlrev_b32 v77, 16, v77
    v_mul_f32 v77, v77, v26
    v_cvt_pk_bf16_f32 v77, v77, v77
    v_lshlrev_b32 v77, 16, v77
    v_sub_f32 v78, v78, v27
    v_cvt_pk_bf16_f32 v78, v78, v78
    v_lshlrev_b32 v78, 16, v78
    v_mul_f32 v78, v78, v26
    v_cvt_pk_bf16_f32 v78, v78, v78
    v_lshlrev_b32 v78, 16, v78
    v_sub_f32 v79, v79, v27
    v_cvt_pk_bf16_f32 v79, v79, v79
    v_lshlrev_b32 v79, 16, v79
    v_mul_f32 v79, v79, v26
    v_cvt_pk_bf16_f32 v79, v79, v79
    v_lshlrev_b32 v79, 16, v79
    v_mul_f32 v64, v64, v112
    v_cvt_pk_bf16_f32 v64, v64, v64
    v_lshlrev_b32 v64, 16, v64
    v_add_f32 v64, v64, v96
    v_mul_f32 v65, v65, v113
    v_cvt_pk_bf16_f32 v65, v65, v65
    v_lshlrev_b32 v65, 16, v65
    v_add_f32 v65, v65, v97
    v_mul_f32 v66, v66, v114
    v_cvt_pk_bf16_f32 v66, v66, v66
    v_lshlrev_b32 v66, 16, v66
    v_add_f32 v66, v66, v98
    v_mul_f32 v67, v67, v115
    v_cvt_pk_bf16_f32 v67, v67, v67
    v_lshlrev_b32 v67, 16, v67
    v_add_f32 v67, v67, v99
    v_mul_f32 v68, v68, v116
    v_cvt_pk_bf16_f32 v68, v68, v68
    v_lshlrev_b32 v68, 16, v68
    v_add_f32 v68, v68, v100
    v_mul_f32 v69, v69, v117
    v_cvt_pk_bf16_f32 v69, v69, v69
    v_lshlrev_b32 v69, 16, v69
    v_add_f32 v69, v69, v101
    v_mul_f32 v70, v70, v118
    v_cvt_pk_bf16_f32 v70, v70, v70
    v_lshlrev_b32 v70, 16, v70
    v_add_f32 v70, v70, v102
    v_mul_f32 v71, v71, v119
    v_cvt_pk_bf16_f32 v71, v71, v71
    v_lshlrev_b32 v71, 16, v71
    v_add_f32 v71, v71, v103
    v_mul_f32 v72, v72, v120
    v_cvt_pk_bf16_f32 v72, v72, v72
    v_lshlrev_b32 v72, 16, v72
    v_add_f32 v72, v72, v104
    v_mul_f32 v73, v73, v121
    v_cvt_pk_bf16_f32 v73, v73, v73
    v_lshlrev_b32 v73, 16, v73
    v_add_f32 v73, v73, v105
    v_mul_f32 v74, v74, v122
    v_cvt_pk_bf16_f32 v74, v74, v74
    v_lshlrev_b32 v74, 16, v74
    v_add_f32 v74, v74, v106
    v_mul_f32 v75, v75, v123
    v_cvt_pk_bf16_f32 v75, v75, v75
    v_lshlrev_b32 v75, 16, v75
    v_add_f32 v75, v75, v107
    v_mul_f32 v76, v76, v124
    v_cvt_pk_bf16_f32 v76, v76, v76
    v_lshlrev_b32 v76, 16, v76
    v_add_f32 v76, v76, v108
    v_mul_f32 v77, v77, v125
    v_cvt_pk_bf16_f32 v77, v77, v77
    v_lshlrev_b32 v77, 16, v77
    v_add_f32 v77, v77, v109
    v_mul_f32 v78, v78, v126
    v_cvt_pk_bf16_f32 v78, v78, v78
    v_lshlrev_b32 v78, 16, v78
    v_add_f32 v78, v78, v110
    v_mul_f32 v79, v79, v127
    v_cvt_pk_bf16_f32 v79, v79, v79
    v_lshlrev_b32 v79, 16, v79
    v_add_f32 v79, v79, v111
    v_cvt_pk_bf16_f32 v80, v64, v65
    v_cvt_pk_bf16_f32 v81, v66, v67
    v_cvt_pk_bf16_f32 v82, v68, v69
    v_cvt_pk_bf16_f32 v83, v70, v71
    v_cvt_pk_bf16_f32 v84, v72, v73
    v_cvt_pk_bf16_f32 v85, v74, v75
    v_cvt_pk_bf16_f32 v86, v76, v77
    v_cvt_pk_bf16_f32 v87, v78, v79
    s_lshr_b32 s45, s63, 5
    s_lshl_b32 s45, s45, 16
    s_and_b32 s46, s63, 31
    s_lshl_b32 s46, s46, 8
    s_add_u32 s45, s45, s46
    s_add_u32 s45, s45, 0x400000
    s_add_u32 s46, s45, 32768
    buffer_store_dwordx4 v[80:83], v2, s[12:15], s45 offen sc1
    buffer_store_dwordx4 v[84:87], v2, s[12:15], s46 offen sc1
    s_add_u32 s63, s63, 384
    s_cmp_ge_u32 s63, 2048
    s_cbranch_scc1 L_ln_done_115
    v_lshlrev_b32 v64, 16, v168
    v_and_b32 v65, 0xffff0000, v168
    v_lshlrev_b32 v66, 16, v169
    v_and_b32 v67, 0xffff0000, v169
    v_lshlrev_b32 v68, 16, v170
    v_and_b32 v69, 0xffff0000, v170
    v_lshlrev_b32 v70, 16, v171
    v_and_b32 v71, 0xffff0000, v171
    v_lshlrev_b32 v72, 16, v172
    v_and_b32 v73, 0xffff0000, v172
    v_lshlrev_b32 v74, 16, v173
    v_and_b32 v75, 0xffff0000, v173
    v_lshlrev_b32 v76, 16, v174
    v_and_b32 v77, 0xffff0000, v174
    v_lshlrev_b32 v78, 16, v175
    v_and_b32 v79, 0xffff0000, v175
    v_add_f32 v26, v64, v65
    v_add_f32 v26, v26, v66
    v_add_f32 v26, v26, v67
    v_add_f32 v26, v26, v68
    v_add_f32 v26, v26, v69
    v_add_f32 v26, v26, v70
    v_add_f32 v26, v26, v71
    v_add_f32 v26, v26, v72
    v_add_f32 v26, v26, v73
    v_add_f32 v26, v26, v74
    v_add_f32 v26, v26, v75
    v_add_f32 v26, v26, v76
    v_add_f32 v26, v26, v77
    v_add_f32 v26, v26, v78
    v_add_f32 v26, v26, v79
    s_nop 1
    v_add_f32_dpp v26, v26, v26 row_shr:1 row_mask:0xf bank_mask:0xf bound_ctrl:0
    s_nop 1
    v_add_f32_dpp v26, v26, v26 row_shr:2 row_mask:0xf bank_mask:0xf bound_ctrl:0
    s_nop 1
    v_add_f32_dpp v26, v26, v26 row_shr:4 row_mask:0xf bank_mask:0xf bound_ctrl:0
    s_nop 1
    v_add_f32_dpp v26, v26, v26 row_shr:8 row_mask:0xf bank_mask:0xf bound_ctrl:0
    s_nop 1
    v_add_f32_dpp v26, v26, v26 row_bcast:15 row_mask:0xa bank_mask:0xf
    s_nop 1
    v_add_f32_dpp v26, v26, v26 row_bcast:31 row_mask:0xc bank_mask:0xf
    s_nop 1
    v_readlane_b32 s66, v26, 63
    s_nop 1
    v_mov_b32 v27, s66
    v_mul_f32 v27, 0x3a800000, v27
    v_mov_b32 v26, 0
    v_sub_f32 v28, v64, v27
    v_fmac_f32 v26, v28, v28
    v_sub_f32 v28, v65, v27
    v_fmac_f32 v26, v28, v28
    v_sub_f32 v28, v66, v27
    v_fmac_f32 v26, v28, v28
    v_sub_f32 v28, v67, v27
    v_fmac_f32 v26, v28, v28
    v_sub_f32 v28, v68, v27
    v_fmac_f32 v26, v28, v28
    v_sub_f32 v28, v69, v27
    v_fmac_f32 v26, v28, v28
    v_sub_f32 v28, v70, v27
    v_fmac_f32 v26, v28, v28
    v_sub_f32 v28, v71, v27
    v_fmac_f32 v26, v28, v28
    v_sub_f32 v28, v72, v27
    v_fmac_f32 v26, v28, v28
    v_sub_f32 v28, v73, v27
    v_fmac_f32 v26, v28, v28
    v_sub_f32 v28, v74, v27
    v_fmac_f32 v26, v28, v28
    v_sub_f32 v28, v75, v27
    v_fmac_f32 v26, v28, v28
    v_sub_f32 v28, v76, v27
    v_fmac_f32 v26, v28, v28
    v_sub_f32 v28, v77, v27
    v_fmac_f32 v26, v28, v28
    v_sub_f32 v28, v78, v27
    v_fmac_f32 v26, v28, v28
    v_sub_f32 v28, v79, v27
    v_fmac_f32 v26, v28, v28
    s_nop 1
    v_add_f32_dpp v26, v26, v26 row_shr:1 row_mask:0xf bank_mask:0xf bound_ctrl:0
    s_nop 1
    v_add_f32_dpp v26, v26, v26 row_shr:2 row_mask:0xf bank_mask:0xf bound_ctrl:0
    s_nop 1
    v_add_f32_dpp v26, v26, v26 row_shr:4 row_mask:0xf bank_mask:0xf bound_ctrl:0
    s_nop 1
    v_add_f32_dpp v26, v26, v26 row_shr:8 row_mask:0xf bank_mask:0xf bound_ctrl:0
    s_nop 1
    v_add_f32_dpp v26, v26, v26 row_bcast:15 row_mask:0xa bank_mask:0xf
    s_nop 1
    v_add_f32_dpp v26, v26, v26 row_bcast:31 row_mask:0xc bank_mask:0xf
    s_nop 1
    v_readlane_b32 s66, v26, 63
    s_nop 1
    v_mov_b32 v26, s66
    v_mul_f32 v26, 0x3a800000, v26
    v_cvt_pk_bf16_f32 v26, v26, v26
    v_lshlrev_b32 v26, 16, v26
    v_cvt_pk_bf16_f32 v27, v27, v27
    v_lshlrev_b32 v27, 16, v27
    v_add_f32 v26, 0x3727c5ac, v26
    v_cvt_pk_bf16_f32 v26, v26, v26
    v_lshlrev_b32 v26, 16, v26
    v_sqrt_f32 v26, v26
    s_nop 0
    v_cvt_pk_bf16_f32 v26, v26, v26
    v_lshlrev_b32 v26, 16, v26
    v_rcp_f32 v26, v26
    s_nop 0
    v_sub_f32 v64, v64, v27
    v_cvt_pk_bf16_f32 v64, v64, v64
    v_lshlrev_b32 v64, 16, v64
    v_mul_f32 v64, v64, v26
    v_cvt_pk_bf16_f32 v64, v64, v64
    v_lshlrev_b32 v64, 16, v64
    v_sub_f32 v65, v65, v27
    v_cvt_pk_bf16_f32 v65, v65, v65
    v_lshlrev_b32 v65, 16, v65
    v_mul_f32 v65, v65, v26
    v_cvt_pk_bf16_f32 v65, v65, v65
    v_lshlrev_b32 v65, 16, v65
    v_sub_f32 v66, v66, v27
    v_cvt_pk_bf16_f32 v66, v66, v66
    v_lshlrev_b32 v66, 16, v66
    v_mul_f32 v66, v66, v26
    v_cvt_pk_bf16_f32 v66, v66, v66
    v_lshlrev_b32 v66, 16, v66
    v_sub_f32 v67, v67, v27
    v_cvt_pk_bf16_f32 v67, v67, v67
    v_lshlrev_b32 v67, 16, v67
    v_mul_f32 v67, v67, v26
    v_cvt_pk_bf16_f32 v67, v67, v67
    v_lshlrev_b32 v67, 16, v67
    v_sub_f32 v68, v68, v27
    v_cvt_pk_bf16_f32 v68, v68, v68
    v_lshlrev_b32 v68, 16, v68
    v_mul_f32 v68, v68, v26
    v_cvt_pk_bf16_f32 v68, v68, v68
    v_lshlrev_b32 v68, 16, v68
    v_sub_f32 v69, v69, v27
    v_cvt_pk_bf16_f32 v69, v69, v69
    v_lshlrev_b32 v69, 16, v69
    v_mul_f32 v69, v69, v26
    v_cvt_pk_bf16_f32 v69, v69, v69
    v_lshlrev_b32 v69, 16, v69
    v_sub_f32 v70, v70, v27
    v_cvt_pk_bf16_f32 v70, v70, v70
    v_lshlrev_b32 v70, 16, v70
    v_mul_f32 v70, v70, v26
    v_cvt_pk_bf16_f32 v70, v70, v70
    v_lshlrev_b32 v70, 16, v70
    v_sub_f32 v71, v71, v27
    v_cvt_pk_bf16_f32 v71, v71, v71
    v_lshlrev_b32 v71, 16, v71
    v_mul_f32 v71, v71, v26
    v_cvt_pk_bf16_f32 v71, v71, v71
    v_lshlrev_b32 v71, 16, v71
    v_sub_f32 v72, v72, v27
    v_cvt_pk_bf16_f32 v72, v72, v72
    v_lshlrev_b32 v72, 16, v72
    v_mul_f32 v72, v72, v26
    v_cvt_pk_bf16_f32 v72, v72, v72
    v_lshlrev_b32 v72, 16, v72
    v_sub_f32 v73, v73, v27
    v_cvt_pk_bf16_f32 v73, v73, v73
    v_lshlrev_b32 v73, 16, v73
    v_mul_f32 v73, v73, v26
    v_cvt_pk_bf16_f32 v73, v73, v73
    v_lshlrev_b32 v73, 16, v73
    v_sub_f32 v74, v74, v27
    v_cvt_pk_bf16_f32 v74, v74, v74
    v_lshlrev_b32 v74, 16, v74
    v_mul_f32 v74, v74, v26
    v_cvt_pk_bf16_f32 v74, v74, v74
    v_lshlrev_b32 v74, 16, v74
    v_sub_f32 v75, v75, v27
    v_cvt_pk_bf16_f32 v75, v75, v75
    v_lshlrev_b32 v75, 16, v75
    v_mul_f32 v75, v75, v26
    v_cvt_pk_bf16_f32 v75, v75, v75
    v_lshlrev_b32 v75, 16, v75
    v_sub_f32 v76, v76, v27
    v_cvt_pk_bf16_f32 v76, v76, v76
    v_lshlrev_b32 v76, 16, v76
    v_mul_f32 v76, v76, v26
    v_cvt_pk_bf16_f32 v76, v76, v76
    v_lshlrev_b32 v76, 16, v76
    v_sub_f32 v77, v77, v27
    v_cvt_pk_bf16_f32 v77, v77, v77
    v_lshlrev_b32 v77, 16, v77
    v_mul_f32 v77, v77, v26
    v_cvt_pk_bf16_f32 v77, v77, v77
    v_lshlrev_b32 v77, 16, v77
    v_sub_f32 v78, v78, v27
    v_cvt_pk_bf16_f32 v78, v78, v78
    v_lshlrev_b32 v78, 16, v78
    v_mul_f32 v78, v78, v26
    v_cvt_pk_bf16_f32 v78, v78, v78
    v_lshlrev_b32 v78, 16, v78
    v_sub_f32 v79, v79, v27
    v_cvt_pk_bf16_f32 v79, v79, v79
    v_lshlrev_b32 v79, 16, v79
    v_mul_f32 v79, v79, v26
    v_cvt_pk_bf16_f32 v79, v79, v79
    v_lshlrev_b32 v79, 16, v79
    v_mul_f32 v64, v64, v112
    v_cvt_pk_bf16_f32 v64, v64, v64
    v_lshlrev_b32 v64, 16, v64
    v_add_f32 v64, v64, v96
    v_mul_f32 v65, v65, v113
    v_cvt_pk_bf16_f32 v65, v65, v65
    v_lshlrev_b32 v65, 16, v65
    v_add_f32 v65, v65, v97
    v_mul_f32 v66, v66, v114
    v_cvt_pk_bf16_f32 v66, v66, v66
    v_lshlrev_b32 v66, 16, v66
    v_add_f32 v66, v66, v98
    v_mul_f32 v67, v67, v115
    v_cvt_pk_bf16_f32 v67, v67, v67
    v_lshlrev_b32 v67, 16, v67
    v_add_f32 v67, v67, v99
    v_mul_f32 v68, v68, v116
    v_cvt_pk_bf16_f32 v68, v68, v68
    v_lshlrev_b32 v68, 16, v68
    v_add_f32 v68, v68, v100
    v_mul_f32 v69, v69, v117
    v_cvt_pk_bf16_f32 v69, v69, v69
    v_lshlrev_b32 v69, 16, v69
    v_add_f32 v69, v69, v101
    v_mul_f32 v70, v70, v118
    v_cvt_pk_bf16_f32 v70, v70, v70
    v_lshlrev_b32 v70, 16, v70
    v_add_f32 v70, v70, v102
    v_mul_f32 v71, v71, v119
    v_cvt_pk_bf16_f32 v71, v71, v71
    v_lshlrev_b32 v71, 16, v71
    v_add_f32 v71, v71, v103
    v_mul_f32 v72, v72, v120
    v_cvt_pk_bf16_f32 v72, v72, v72
    v_lshlrev_b32 v72, 16, v72
    v_add_f32 v72, v72, v104
    v_mul_f32 v73, v73, v121
    v_cvt_pk_bf16_f32 v73, v73, v73
    v_lshlrev_b32 v73, 16, v73
    v_add_f32 v73, v73, v105
    v_mul_f32 v74, v74, v122
    v_cvt_pk_bf16_f32 v74, v74, v74
    v_lshlrev_b32 v74, 16, v74
    v_add_f32 v74, v74, v106
    v_mul_f32 v75, v75, v123
    v_cvt_pk_bf16_f32 v75, v75, v75
    v_lshlrev_b32 v75, 16, v75
    v_add_f32 v75, v75, v107
    v_mul_f32 v76, v76, v124
    v_cvt_pk_bf16_f32 v76, v76, v76
    v_lshlrev_b32 v76, 16, v76
    v_add_f32 v76, v76, v108
    v_mul_f32 v77, v77, v125
    v_cvt_pk_bf16_f32 v77, v77, v77
    v_lshlrev_b32 v77, 16, v77
    v_add_f32 v77, v77, v109
    v_mul_f32 v78, v78, v126
    v_cvt_pk_bf16_f32 v78, v78, v78
    v_lshlrev_b32 v78, 16, v78
    v_add_f32 v78, v78, v110
    v_mul_f32 v79, v79, v127
    v_cvt_pk_bf16_f32 v79, v79, v79
    v_lshlrev_b32 v79, 16, v79
    v_add_f32 v79, v79, v111
    v_cvt_pk_bf16_f32 v80, v64, v65
    v_cvt_pk_bf16_f32 v81, v66, v67
    v_cvt_pk_bf16_f32 v82, v68, v69
    v_cvt_pk_bf16_f32 v83, v70, v71
    v_cvt_pk_bf16_f32 v84, v72, v73
    v_cvt_pk_bf16_f32 v85, v74, v75
    v_cvt_pk_bf16_f32 v86, v76, v77
    v_cvt_pk_bf16_f32 v87, v78, v79
    s_lshr_b32 s45, s63, 5
    s_lshl_b32 s45, s45, 16
    s_and_b32 s46, s63, 31
    s_lshl_b32 s46, s46, 8
    s_add_u32 s45, s45, s46
    s_add_u32 s45, s45, 0x400000
    s_add_u32 s46, s45, 32768
    buffer_store_dwordx4 v[80:83], v2, s[12:15], s45 offen sc1
    buffer_store_dwordx4 v[84:87], v2, s[12:15], s46 offen sc1
    s_add_u32 s63, s63, 384
L_ln_done_115:
    s_waitcnt vmcnt(0)
    s_barrier
    s_cmp_lg_u32 s44, 0
    s_cbranch_scc1 L_cnt_117
    v_mov_b32 v30, 1
    v_mov_b32 v31, 0
    s_mov_b64 exec, 1
    buffer_atomic_add v30, v31, s[16:19], 0 offen offset:196 sc1
    s_mov_b64 exec, -1
L_cnt_117:
    s_add_u32 s39, s39, 96
    s_load_dwordx2 s[4:5], s[0:1], 96
    s_load_dwordx2 s[6:7], s[0:1], 104
    v_and_b32 v14, 7, v0
    v_lshrrev_b32 v15, 3, v0
    s_waitcnt lgkmcnt(0)
    s_mov_b32 s32, s4
    s_and_b32 s33, s5, 0xffff
    s_mov_b32 s34, 0x800
    s_mov_b32 s35, 0x00020000
    s_mov_b32 s24, s6
    s_and_b32 s25, s7, 0xffff
    s_mov_b32 s26, 0xc00000
    s_mov_b32 s27, 0x00020000
    s_and_b32 s47, s39, 1
    s_lshl_b32 s45, s47, 10
    v_lshlrev_b32 v16, 5, v15
    buffer_load_dwordx4 v[104:107], v16, s[32:35], s45 offen
    buffer_load_dwordx4 v[108:111], v16, s[32:35], s45 offen offset:16
    s_mov_b32 s45, 196608
    v_mul_lo_u32 v17, v15, s45
    v_lshlrev_b32 v18, 4, v14
    v_add_u32 v17, v17, v18
    s_lshr_b32 s46, s39, 1
    s_lshl_b32 s46, s46, 7
    s_mul_i32 s45, s47, 6291456
    s_add_u32 s46, s46, s45
    buffer_load_dwordx4 v[32:35], v17, s[24:27], s46 offen nt
    v_add_u32 v17, 12288, v17
    buffer_load_dwordx4 v[36:39], v17, s[24:27], s46 offen nt
    v_add_u32 v17, 12288, v17
    buffer_load_dwordx4 v[40:43], v17, s[24:27], s46 offen nt
    v_add_u32 v17, 12288, v17
    buffer_load_dwordx4 v[44:47], v17, s[24:27], s46 offen nt
    v_add_u32 v17, 12288, v17
    buffer_load_dwordx4 v[48:51], v17, s[24:27], s46 offen nt
    v_add_u32 v17, 12288, v17
    buffer_load_dwordx4 v[52:55], v17, s[24:27], s46 offen nt
    v_add_u32 v17, 12288, v17
    buffer_load_dwordx4 v[56:59], v17, s[24:27], s46 offen nt
    v_add_u32 v17, 12288, v17
    buffer_load_dwordx4 v[60:63], v17, s[24:27], s46 offen nt
    v_add_u32 v17, 12288, v17
    buffer_load_dwordx4 v[64:67], v17, s[24:27], s46 offen nt
    v_add_u32 v17, 12288, v17
    buffer_load_dwordx4 v[68:71], v17, s[24:27], s46 offen nt
    v_add_u32 v17, 12288, v17
    buffer_load_dwordx4 v[72:75], v17, s[24:27], s46 offen nt
    v_add_u32 v17, 12288, v17
    buffer_load_dwordx4 v[76:79], v17, s[24:27], s46 offen nt
    v_add_u32 v17, 12288, v17
    buffer_load_dwordx4 v[80:83], v17, s[24:27], s46 offen nt
    v_add_u32 v17, 12288, v17
    buffer_load_dwordx4 v[84:87], v17, s[24:27], s46 offen nt
    v_add_u32 v17, 12288, v17
    buffer_load_dwordx4 v[88:91], v17, s[24:27], s46 offen nt
    v_add_u32 v17, 12288, v17
    buffer_load_dwordx4 v[92:95], v17, s[24:27], s46 offen nt
    s_waitcnt vmcnt(16)
    v_lshlrev_b32 v112, 16, v104
    v_and_b32 v113, 0xffff0000, v104
    v_lshlrev_b32 v114, 16, v105
    v_and_b32 v115, 0xffff0000, v105
    v_lshlrev_b32 v116, 16, v106
    v_and_b32 v117, 0xffff0000, v106
    v_lshlrev_b32 v118, 16, v107
    v_and_b32 v119, 0xffff0000, v107
    v_lshlrev_b32 v120, 16, v108
    v_and_b32 v121, 0xffff0000, v108
    v_lshlrev_b32 v122, 16, v109
    v_and_b32 v123, 0xffff0000, v109
    v_lshlrev_b32 v124, 16, v110
    v_and_b32 v125, 0xffff0000, v110
    v_lshlrev_b32 v126, 16, v111
    v_and_b32 v127, 0xffff0000, v111
    v_mul_f32 v18, 0xbfb8aa3b, v112
    v_exp_f32 v18, v18
    s_nop 0
    v_add_f32 v18, 1.0, v18
    v_rcp_f32 v18, v18
    s_nop 0
    v_mul_f32 v112, v112, v18
    v_cvt_pk_bf16_f32 v112, v112, v112
    v_lshlrev_b32 v112, 16, v112
    v_mul_f32 v18, 0xbfb8aa3b, v113
    v_exp_f32 v18, v18
    s_nop 0
    v_add_f32 v18, 1.0, v18
    v_rcp_f32 v18, v18
    s_nop 0
    v_mul_f32 v113, v113, v18
    v_cvt_pk_bf16_f32 v113, v113, v113
    v_lshlrev_b32 v113, 16, v113
    v_mul_f32 v18, 0xbfb8aa3b, v114
    v_exp_f32 v18, v18
    s_nop 0
    v_add_f32 v18, 1.0, v18
    v_rcp_f32 v18, v18
    s_nop 0
    v_mul_f32 v114, v114, v18
    v_cvt_pk_bf16_f32 v114, v114, v114
    v_lshlrev_b32 v114, 16, v114
    v_mul_f32 v18, 0xbfb8aa3b, v115
    v_exp_f32 v18, v18
    s_nop 0
    v_add_f32 v18, 1.0, v18
    v_rcp_f32 v18, v18
    s_nop 0
    v_mul_f32 v115, v115, v18
    v_cvt_pk_bf16_f32 v115, v115, v115
    v_lshlrev_b32 v115, 16, v115
    v_mul_f32 v18, 0xbfb8aa3b, v116
    v_exp_f32 v18, v18
    s_nop 0
    v_add_f32 v18, 1.0, v18
    v_rcp_f32 v18, v18
    s_nop 0
    v_mul_f32 v116, v116, v18
    v_cvt_pk_bf16_f32 v116, v116, v116
    v_lshlrev_b32 v116, 16, v116
    v_mul_f32 v18, 0xbfb8aa3b, v117
    v_exp_f32 v18, v18
    s_nop 0
    v_add_f32 v18, 1.0, v18
    v_rcp_f32 v18, v18
    s_nop 0
    v_mul_f32 v117, v117, v18
    v_cvt_pk_bf16_f32 v117, v117, v117
    v_lshlrev_b32 v117, 16, v117
    v_mul_f32 v18, 0xbfb8aa3b, v118
    v_exp_f32 v18, v18
    s_nop 0
    v_add_f32 v18, 1.0, v18
    v_rcp_f32 v18, v18
    s_nop 0
    v_mul_f32 v118, v118, v18
    v_cvt_pk_bf16_f32 v118, v118, v118
    v_lshlrev_b32 v118, 16, v118
    v_mul_f32 v18, 0xbfb8aa3b, v119
    v_exp_f32 v18, v18
    s_nop 0
    v_add_f32 v18, 1.0, v18
    v_rcp_f32 v18, v18
    s_nop 0
    v_mul_f32 v119, v119, v18
    v_cvt_pk_bf16_f32 v119, v119, v119
    v_lshlrev_b32 v119, 16, v119
    v_mul_f32 v18, 0xbfb8aa3b, v120
    v_exp_f32 v18, v18
    s_nop 0
    v_add_f32 v18, 1.0, v18
    v_rcp_f32 v18, v18
    s_nop 0
    v_mul_f32 v120, v120, v18
    v_cvt_pk_bf16_f32 v120, v120, v120
    v_lshlrev_b32 v120, 16, v120
    v_mul_f32 v18, 0xbfb8aa3b, v121
    v_exp_f32 v18, v18
    s_nop 0
    v_add_f32 v18, 1.0, v18
    v_rcp_f32 v18, v18
    s_nop 0
    v_mul_f32 v121, v121, v18
    v_cvt_pk_bf16_f32 v121, v121, v121
    v_lshlrev_b32 v121, 16, v121
    v_mul_f32 v18, 0xbfb8aa3b, v122
    v_exp_f32 v18, v18
    s_nop 0
    v_add_f32 v18, 1.0, v18
    v_rcp_f32 v18, v18
    s_nop 0
    v_mul_f32 v122, v122, v18
    v_cvt_pk_bf16_f32 v122, v122, v122
    v_lshlrev_b32 v122, 16, v122
    v_mul_f32 v18, 0xbfb8aa3b, v123
    v_exp_f32 v18, v18
    s_nop 0
    v_add_f32 v18, 1.0, v18
    v_rcp_f32 v18, v18
    s_nop 0
    v_mul_f32 v123, v123, v18
    v_cvt_pk_bf16_f32 v123, v123, v123
    v_lshlrev_b32 v123, 16, v123
    v_mul_f32 v18, 0xbfb8aa3b, v124
    v_exp_f32 v18, v18
    s_nop 0
    v_add_f32 v18, 1.0, v18
    v_rcp_f32 v18, v18
    s_nop 0
    v_mul_f32 v124, v124, v18
    v_cvt_pk_bf16_f32 v124, v124, v124
    v_lshlrev_b32 v124, 16, v124
    v_mul_f32 v18, 0xbfb8aa3b, v125
    v_exp_f32 v18, v18
    s_nop 0
    v_add_f32 v18, 1.0, v18
    v_rcp_f32 v18, v18
    s_nop 0
    v_mul_f32 v125, v125, v18
    v_cvt_pk_bf16_f32 v125, v125, v125
    v_lshlrev_b32 v125, 16, v125
    v_mul_f32 v18, 0xbfb8aa3b, v126
    v_exp_f32 v18, v18
    s_nop 0
    v_add_f32 v18, 1.0, v18
    v_rcp_f32 v18, v18
    s_nop 0
    v_mul_f32 v126, v126, v18
    v_cvt_pk_bf16_f32 v126, v126, v126
    v_lshlrev_b32 v126, 16, v126
    v_mul_f32 v18, 0xbfb8aa3b, v127
    v_exp_f32 v18, v18
    s_nop 0
    v_add_f32 v18, 1.0, v18
    v_rcp_f32 v18, v18
    s_nop 0
    v_mul_f32 v127, v127, v18
    v_cvt_pk_bf16_f32 v127, v127, v127
    v_lshlrev_b32 v127, 16, v127
    v_mov_b32 v96, 0
    v_mov_b32 v97, 0
    v_mov_b32 v98, 0
    v_mov_b32 v99, 0
    v_mov_b32 v100, 0
    v_mov_b32 v101, 0
    v_mov_b32 v102, 0
    v_mov_b32 v103, 0
    s_waitcnt vmcnt(15)
    v_lshlrev_b32 v18, 16, v32
    v_and_b32 v19, 0xffff0000, v32
    v_fmac_f32 v96, v18, v112
    v_fmac_f32 v97, v19, v112
    v_lshlrev_b32 v18, 16, v33
    v_and_b32 v19, 0xffff0000, v33
    v_fmac_f32 v98, v18, v112
    v_fmac_f32 v99, v19, v112
    v_lshlrev_b32 v18, 16, v34
    v_and_b32 v19, 0xffff0000, v34
    v_fmac_f32 v100, v18, v112
    v_fmac_f32 v101, v19, v112
    v_lshlrev_b32 v18, 16, v35
    v_and_b32 v19, 0xffff0000, v35
    v_fmac_f32 v102, v18, v112
    v_fmac_f32 v103, v19, v112
    s_waitcnt vmcnt(14)
    v_lshlrev_b32 v18, 16, v36
    v_and_b32 v19, 0xffff0000, v36
    v_fmac_f32 v96, v18, v113
    v_fmac_f32 v97, v19, v113
    v_lshlrev_b32 v18, 16, v37
    v_and_b32 v19, 0xffff0000, v37
    v_fmac_f32 v98, v18, v113
    v_fmac_f32 v99, v19, v113
    v_lshlrev_b32 v18, 16, v38
    v_and_b32 v19, 0xffff0000, v38
    v_fmac_f32 v100, v18, v113
    v_fmac_f32 v101, v19, v113
    v_lshlrev_b32 v18, 16, v39
    v_and_b32 v19, 0xffff0000, v39
    v_fmac_f32 v102, v18, v113
    v_fmac_f32 v103, v19, v113
    s_waitcnt vmcnt(13)
    v_lshlrev_b32 v18, 16, v40
    v_and_b32 v19, 0xffff0000, v40
    v_fmac_f32 v96, v18, v114
    v_fmac_f32 v97, v19, v114
    v_lshlrev_b32 v18, 16, v41
    v_and_b32 v19, 0xffff0000, v41
    v_fmac_f32 v98, v18, v114
    v_fmac_f32 v99, v19, v114
    v_lshlrev_b32 v18, 16, v42
    v_and_b32 v19, 0xffff0000, v42
    v_fmac_f32 v100, v18, v114
    v_fmac_f32 v101, v19, v114
    v_lshlrev_b32 v18, 16, v43
    v_and_b32 v19, 0xffff0000, v43
    v_fmac_f32 v102, v18, v114
    v_fmac_f32 v103, v19, v114
    s_waitcnt vmcnt(12)
    v_lshlrev_b32 v18, 16, v44
    v_and_b32 v19, 0xffff0000, v44
    v_fmac_f32 v96, v18, v115
    v_fmac_f32 v97, v19, v115
    v_lshlrev_b32 v18, 16, v45
    v_and_b32 v19, 0xffff0000, v45
    v_fmac_f32 v98, v18, v115
    v_fmac_f32 v99, v19, v115
    v_lshlrev_b32 v18, 16, v46
    v_and_b32 v19, 0xffff0000, v46
    v_fmac_f32 v100, v18, v115
    v_fmac_f32 v101, v19, v115
    v_lshlrev_b32 v18, 16, v47
    v_and_b32 v19, 0xffff0000, v47
    v_fmac_f32 v102, v18, v115
    v_fmac_f32 v103, v19, v115
    s_waitcnt vmcnt(11)
    v_lshlrev_b32 v18, 16, v48
    v_and_b32 v19, 0xffff0000, v48
    v_fmac_f32 v96, v18, v116
    v_fmac_f32 v97, v19, v116
    v_lshlrev_b32 v18, 16, v49
    v_and_b32 v19, 0xffff0000, v49
    v_fmac_f32 v98, v18, v116
    v_fmac_f32 v99, v19, v116
    v_lshlrev_b32 v18, 16, v50
    v_and_b32 v19, 0xffff0000, v50
    v_fmac_f32 v100, v18, v116
    v_fmac_f32 v101, v19, v116
    v_lshlrev_b32 v18, 16, v51
    v_and_b32 v19, 0xffff0000, v51
    v_fmac_f32 v102, v18, v116
    v_fmac_f32 v103, v19, v116
    s_waitcnt vmcnt(10)
    v_lshlrev_b32 v18, 16, v52
    v_and_b32 v19, 0xffff0000, v52
    v_fmac_f32 v96, v18, v117
    v_fmac_f32 v97, v19, v117
    v_lshlrev_b32 v18, 16, v53
    v_and_b32 v19, 0xffff0000, v53
    v_fmac_f32 v98, v18, v117
    v_fmac_f32 v99, v19, v117
    v_lshlrev_b32 v18, 16, v54
    v_and_b32 v19, 0xffff0000, v54
    v_fmac_f32 v100, v18, v117
    v_fmac_f32 v101, v19, v117
    v_lshlrev_b32 v18, 16, v55
    v_and_b32 v19, 0xffff0000, v55
    v_fmac_f32 v102, v18, v117
    v_fmac_f32 v103, v19, v117
    s_waitcnt vmcnt(9)
    v_lshlrev_b32 v18, 16, v56
    v_and_b32 v19, 0xffff0000, v56
    v_fmac_f32 v96, v18, v118
    v_fmac_f32 v97, v19, v118
    v_lshlrev_b32 v18, 16, v57
    v_and_b32 v19, 0xffff0000, v57
    v_fmac_f32 v98, v18, v118
    v_fmac_f32 v99, v19, v118
    v_lshlrev_b32 v18, 16, v58
    v_and_b32 v19, 0xffff0000, v58
    v_fmac_f32 v100, v18, v118
    v_fmac_f32 v101, v19, v118
    v_lshlrev_b32 v18, 16, v59
    v_and_b32 v19, 0xffff0000, v59
    v_fmac_f32 v102, v18, v118
    v_fmac_f32 v103, v19, v118
    s_waitcnt vmcnt(8)
    v_lshlrev_b32 v18, 16, v60
    v_and_b32 v19, 0xffff0000, v60
    v_fmac_f32 v96, v18, v119
    v_fmac_f32 v97, v19, v119
    v_lshlrev_b32 v18, 16, v61
    v_and_b32 v19, 0xffff0000, v61
    v_fmac_f32 v98, v18, v119
    v_fmac_f32 v99, v19, v119
    v_lshlrev_b32 v18, 16, v62
    v_and_b32 v19, 0xffff0000, v62
    v_fmac_f32 v100, v18, v119
    v_fmac_f32 v101, v19, v119
    v_lshlrev_b32 v18, 16, v63
    v_and_b32 v19, 0xffff0000, v63
    v_fmac_f32 v102, v18, v119
    v_fmac_f32 v103, v19, v119
    s_waitcnt vmcnt(7)
    v_lshlrev_b32 v18, 16, v64
    v_and_b32 v19, 0xffff0000, v64
    v_fmac_f32 v96, v18, v120
    v_fmac_f32 v97, v19, v120
    v_lshlrev_b32 v18, 16, v65
    v_and_b32 v19, 0xffff0000, v65
    v_fmac_f32 v98, v18, v120
    v_fmac_f32 v99, v19, v120
    v_lshlrev_b32 v18, 16, v66
    v_and_b32 v19, 0xffff0000, v66
    v_fmac_f32 v100, v18, v120
    v_fmac_f32 v101, v19, v120
    v_lshlrev_b32 v18, 16, v67
    v_and_b32 v19, 0xffff0000, v67
    v_fmac_f32 v102, v18, v120
    v_fmac_f32 v103, v19, v120
    s_waitcnt vmcnt(6)
    v_lshlrev_b32 v18, 16, v68
    v_and_b32 v19, 0xffff0000, v68
    v_fmac_f32 v96, v18, v121
    v_fmac_f32 v97, v19, v121
    v_lshlrev_b32 v18, 16, v69
    v_and_b32 v19, 0xffff0000, v69
    v_fmac_f32 v98, v18, v121
    v_fmac_f32 v99, v19, v121
    v_lshlrev_b32 v18, 16, v70
    v_and_b32 v19, 0xffff0000, v70
    v_fmac_f32 v100, v18, v121
    v_fmac_f32 v101, v19, v121
    v_lshlrev_b32 v18, 16, v71
    v_and_b32 v19, 0xffff0000, v71
    v_fmac_f32 v102, v18, v121
    v_fmac_f32 v103, v19, v121
    s_waitcnt vmcnt(5)
    v_lshlrev_b32 v18, 16, v72
    v_and_b32 v19, 0xffff0000, v72
    v_fmac_f32 v96, v18, v122
    v_fmac_f32 v97, v19, v122
    v_lshlrev_b32 v18, 16, v73
    v_and_b32 v19, 0xffff0000, v73
    v_fmac_f32 v98, v18, v122
    v_fmac_f32 v99, v19, v122
    v_lshlrev_b32 v18, 16, v74
    v_and_b32 v19, 0xffff0000, v74
    v_fmac_f32 v100, v18, v122
    v_fmac_f32 v101, v19, v122
    v_lshlrev_b32 v18, 16, v75
    v_and_b32 v19, 0xffff0000, v75
    v_fmac_f32 v102, v18, v122
    v_fmac_f32 v103, v19, v122
    s_waitcnt vmcnt(4)
    v_lshlrev_b32 v18, 16, v76
    v_and_b32 v19, 0xffff0000, v76
    v_fmac_f32 v96, v18, v123
    v_fmac_f32 v97, v19, v123
    v_lshlrev_b32 v18, 16, v77
    v_and_b32 v19, 0xffff0000, v77
    v_fmac_f32 v98, v18, v123
    v_fmac_f32 v99, v19, v123
    v_lshlrev_b32 v18, 16, v78
    v_and_b32 v19, 0xffff0000, v78
    v_fmac_f32 v100, v18, v123
    v_fmac_f32 v101, v19, v123
    v_lshlrev_b32 v18, 16, v79
    v_and_b32 v19, 0xffff0000, v79
    v_fmac_f32 v102, v18, v123
    v_fmac_f32 v103, v19, v123
    s_waitcnt vmcnt(3)
    v_lshlrev_b32 v18, 16, v80
    v_and_b32 v19, 0xffff0000, v80
    v_fmac_f32 v96, v18, v124
    v_fmac_f32 v97, v19, v124
    v_lshlrev_b32 v18, 16, v81
    v_and_b32 v19, 0xffff0000, v81
    v_fmac_f32 v98, v18, v124
    v_fmac_f32 v99, v19, v124
    v_lshlrev_b32 v18, 16, v82
    v_and_b32 v19, 0xffff0000, v82
    v_fmac_f32 v100, v18, v124
    v_fmac_f32 v101, v19, v124
    v_lshlrev_b32 v18, 16, v83
    v_and_b32 v19, 0xffff0000, v83
    v_fmac_f32 v102, v18, v124
    v_fmac_f32 v103, v19, v124
    s_waitcnt vmcnt(2)
    v_lshlrev_b32 v18, 16, v84
    v_and_b32 v19, 0xffff0000, v84
    v_fmac_f32 v96, v18, v125
    v_fmac_f32 v97, v19, v125
    v_lshlrev_b32 v18, 16, v85
    v_and_b32 v19, 0xffff0000, v85
    v_fmac_f32 v98, v18, v125
    v_fmac_f32 v99, v19, v125
    v_lshlrev_b32 v18, 16, v86
    v_and_b32 v19, 0xffff0000, v86
    v_fmac_f32 v100, v18, v125
    v_fmac_f32 v101, v19, v125
    v_lshlrev_b32 v18, 16, v87
    v_and_b32 v19, 0xffff0000, v87
    v_fmac_f32 v102, v18, v125
    v_fmac_f32 v103, v19, v125
    s_waitcnt vmcnt(1)
    v_lshlrev_b32 v18, 16, v88
    v_and_b32 v19, 0xffff0000, v88
    v_fmac_f32 v96, v18, v126
    v_fmac_f32 v97, v19, v126
    v_lshlrev_b32 v18, 16, v89
    v_and_b32 v19, 0xffff0000, v89
    v_fmac_f32 v98, v18, v126
    v_fmac_f32 v99, v19, v126
    v_lshlrev_b32 v18, 16, v90
    v_and_b32 v19, 0xffff0000, v90
    v_fmac_f32 v100, v18, v126
    v_fmac_f32 v101, v19, v126
    v_lshlrev_b32 v18, 16, v91
    v_and_b32 v19, 0xffff0000, v91
    v_fmac_f32 v102, v18, v126
    v_fmac_f32 v103, v19, v126
    s_waitcnt vmcnt(0)
    v_lshlrev_b32 v18, 16, v92
    v_and_b32 v19, 0xffff0000, v92
    v_fmac_f32 v96, v18, v127
    v_fmac_f32 v97, v19, v127
    v_lshlrev_b32 v18, 16, v93
    v_and_b32 v19, 0xffff0000, v93
    v_fmac_f32 v98, v18, v127
    v_fmac_f32 v99, v19, v127
    v_lshlrev_b32 v18, 16, v94
    v_and_b32 v19, 0xffff0000, v94
    v_fmac_f32 v100, v18, v127
    v_fmac_f32 v101, v19, v127
    v_lshlrev_b32 v18, 16, v95
    v_and_b32 v19, 0xffff0000, v95
    v_fmac_f32 v102, v18, v127
    v_fmac_f32 v103, v19, v127
    v_lshlrev_b32 v16, 5, v0
    ds_write_b128 v16, v[96:99]
    ds_write_b128 v16, v[100:103] offset:16
    s_waitcnt lgkmcnt(0)
    s_barrier
    s_cmp_lg_u32 s44, 0
    s_cbranch_scc1 L_mod_fin_118
    v_mov_b32 v18, 0
    ds_read_b32 v32, v12 offset:0
    ds_read_b32 v33, v12 offset:256
    ds_read_b32 v34, v12 offset:512
    ds_read_b32 v35, v12 offset:768
    ds_read_b32 v36, v12 offset:1024
    ds_read_b32 v37, v12 offset:1280
    ds_read_b32 v38, v12 offset:1536
    ds_read_b32 v39, v12 offset:1792
    ds_read_b32 v40, v12 offset:2048
    ds_read_b32 v41, v12 offset:2304
    ds_read_b32 v42, v12 offset:2560
    ds_read_b32 v43, v12 offset:2816
    ds_read_b32 v44, v12 offset:3072
    ds_read_b32 v45, v12 offset:3328
    ds_read_b32 v46, v12 offset:3584
    ds_read_b32 v47, v12 offset:3840
    s_waitcnt lgkmcnt(0)
    v_add_f32 v18, v18, v32
    v_add_f32 v18, v18, v33
    v_add_f32 v18, v18, v34
    v_add_f32 v18, v18, v35
    v_add_f32 v18, v18, v36
    v_add_f32 v18, v18, v37
    v_add_f32 v18, v18, v38
    v_add_f32 v18, v18, v39
    v_add_f32 v18, v18, v40
    v_add_f32 v18, v18, v41
    v_add_f32 v18, v18, v42
    v_add_f32 v18, v18, v43
    v_add_f32 v18, v18, v44
    v_add_f32 v18, v18, v45
    v_add_f32 v18, v18, v46
    v_add_f32 v18, v18, v47
    ds_read_b32 v32, v12 offset:4096
    ds_read_b32 v33, v12 offset:4352
    ds_read_b32 v34, v12 offset:4608
    ds_read_b32 v35, v12 offset:4864
    ds_read_b32 v36, v12 offset:5120
    ds_read_b32 v37, v12 offset:5376
    ds_read_b32 v38, v12 offset:5632
    ds_read_b32 v39, v12 offset:5888
    ds_read_b32 v40, v12 offset:6144
    ds_read_b32 v41, v12 offset:6400
    ds_read_b32 v42, v12 offset:6656
    ds_read_b32 v43, v12 offset:6912
    ds_read_b32 v44, v12 offset:7168
    ds_read_b32 v45, v12 offset:7424
    ds_read_b32 v46, v12 offset:7680
    ds_read_b32 v47, v12 offset:7936
    s_waitcnt lgkmcnt(0)
    v_add_f32 v18, v18, v32
    v_add_f32 v18, v18, v33
    v_add_f32 v18, v18, v34
    v_add_f32 v18, v18, v35
    v_add_f32 v18, v18, v36
    v_add_f32 v18, v18, v37
    v_add_f32 v18, v18, v38
    v_add_f32 v18, v18, v39
    v_add_f32 v18, v18, v40
    v_add_f32 v18, v18, v41
    v_add_f32 v18, v18, v42
    v_add_f32 v18, v18, v43
    v_add_f32 v18, v18, v44
    v_add_f32 v18, v18, v45
    v_add_f32 v18, v18, v46
    v_add_f32 v18, v18, v47
    s_lshr_b32 s45, s39, 1
    s_lshl_b32 s45, s45, 8
    s_mul_i32 s46, s47, 24576
    s_add_u32 s45, s45, s46
    buffer_store_dword v18, v12, s[12:15], s45 offen sc1
L_mod_fin_118:
    s_waitcnt vmcnt(0)
    s_barrier
    s_cmp_lg_u32 s44, 0
    s_cbranch_scc1 L_cnt_119
    v_mov_b32 v30, 1
    v_mov_b32 v31, 0
    s_mov_b64 exec, 1
    buffer_atomic_add v30, v31, s[16:19], 0 offen offset:132 sc1
    s_mov_b64 exec, -1
L_cnt_119:
    s_branch L_w_roles_110
L_w_kv_109:
    s_lshl_b32 s45, s43, 3
    s_add_u32 s45, s45, 16
    s_load_dwordx2 s[6:7], s[0:1], s45
    s_waitcnt lgkmcnt(0)
    s_mov_b32 s24, s6
    s_and_b32 s25, s7, 0xffff
    s_mov_b32 s26, 0x800000
    s_mov_b32 s27, 0x00020000
    s_lshl_b32 s46, s41, 8
    s_barrier
    v_lshrrev_b32 v20, 4, v1
    s_lshl_b32 s45, s44, 2
    v_add_u32 v21, s45, v20
    s_mov_b32 s45, 8192
    v_mul_lo_u32 v21, v21, s45
    v_lshlrev_b32 v22, 2, v20
    v_and_b32 v23, 15, v1
    v_xor_b32 v22, v22, v23
    v_lshlrev_b32 v22, 4, v22
    v_add_u32 v21, v21, v22
    v_bfe_u32 v22, v1, 2, 2
    v_lshrrev_b32 v23, 5, v1
    v_lshlrev_b32 v23, 3, v23
    v_add_u32 v23, v23, v22
    v_lshlrev_b32 v23, 8, v23
    v_xor_b32 v22, s44, v22
    v_lshlrev_b32 v22, 6, v22
    v_add_u32 v23, v23, v22
    v_and_b32 v22, 1, v1
    v_lshlrev_b32 v22, 5, v22
    v_add_u32 v23, v23, v22
    v_and_b32 v22, 16, v1
    v_add_u32 v23, v23, v22
    v_and_b32 v22, 2, v1
    v_lshlrev_b32 v22, 2, v22
    v_add_u32 v23, v23, v22
    v_add_u32 v24, 65536, v23
    v_add_u32 v25, 131072, v23
    s_lshl_b32 s47, s44, 10
    s_add_u32 s45, s46, 0x0
    s_add_u32 m0, s47, 0
    s_nop 0
    buffer_load_dwordx4 v21, s[24:27], s45 offen nt lds
    s_add_u32 s45, s46, 0x20000
    s_add_u32 m0, s47, 4096
    s_nop 0
    buffer_load_dwordx4 v21, s[24:27], s45 offen nt lds
    s_add_u32 s45, s46, 0x40000
    s_add_u32 m0, s47, 8192
    s_nop 0
    buffer_load_dwordx4 v21, s[24:27], s45 offen nt lds
    s_add_u32 s45, s46, 0x60000
    s_add_u32 m0, s47, 12288
    s_nop 0
    buffer_load_dwordx4 v21, s[24:27], s45 offen nt lds
    s_add_u32 s45, s46, 0x80000
    s_add_u32 m0, s47, 16384
    s_nop 0
    buffer_load_dwordx4 v21, s[24:27], s45 offen nt lds
    s_add_u32 s45, s46, 0xa0000
    s_add_u32 m0, s47, 20480
    s_nop 0
    buffer_load_dwordx4 v21, s[24:27], s45 offen nt lds
    s_add_u32 s45, s46, 0xc0000
    s_add_u32 m0, s47, 24576
    s_nop 0
    buffer_load_dwordx4 v21, s[24:27], s45 offen nt lds
    s_add_u32 s45, s46, 0xe0000
    s_add_u32 m0, s47, 28672
    s_nop 0
    buffer_load_dwordx4 v21, s[24:27], s45 offen nt lds
    s_add_u32 s45, s46, 0x100000
    s_add_u32 m0, s47, 32768
    s_nop 0
    buffer_load_dwordx4 v21, s[24:27], s45 offen nt lds
    s_add_u32 s45, s46, 0x120000
    s_add_u32 m0, s47, 36864
    s_nop 0
    buffer_load_dwordx4 v21, s[24:27], s45 offen nt lds
    s_add_u32 s45, s46, 0x140000
    s_add_u32 m0, s47, 40960
    s_nop 0
    buffer_load_dwordx4 v21, s[24:27], s45 offen nt lds
    s_add_u32 s45, s46, 0x160000
    s_add_u32 m0, s47, 45056
    s_nop 0
    buffer_load_dwordx4 v21, s[24:27], s45 offen nt lds
    s_add_u32 s45, s46, 0x180000
    s_add_u32 m0, s47, 49152
    s_nop 0
    buffer_load_dwordx4 v21, s[24:27], s45 offen nt lds
    s_add_u32 s45, s46, 0x1a0000
    s_add_u32 m0, s47, 53248
    s_nop 0
    buffer_load_dwordx4 v21, s[24:27], s45 offen nt lds
    s_add_u32 s45, s46, 0x1c0000
    s_add_u32 m0, s47, 57344
    s_nop 0
    buffer_load_dwordx4 v21, s[24:27], s45 offen nt lds
    s_add_u32 s45, s46, 0x1e0000
    s_add_u32 m0, s47, 61440
    s_nop 0
    buffer_load_dwordx4 v21, s[24:27], s45 offen nt lds
    s_add_u32 s45, s46, 0x200000
    s_add_u32 m0, s47, 65536
    s_nop 0
    buffer_load_dwordx4 v21, s[24:27], s45 offen nt lds
    s_add_u32 s45, s46, 0x220000
    s_add_u32 m0, s47, 69632
    s_nop 0
    buffer_load_dwordx4 v21, s[24:27], s45 offen nt lds
    s_add_u32 s45, s46, 0x240000
    s_add_u32 m0, s47, 73728
    s_nop 0
    buffer_load_dwordx4 v21, s[24:27], s45 offen nt lds
    s_add_u32 s45, s46, 0x260000
    s_add_u32 m0, s47, 77824
    s_nop 0
    buffer_load_dwordx4 v21, s[24:27], s45 offen nt lds
    s_add_u32 s45, s46, 0x280000
    s_add_u32 m0, s47, 81920
    s_nop 0
    buffer_load_dwordx4 v21, s[24:27], s45 offen nt lds
    s_add_u32 s45, s46, 0x2a0000
    s_add_u32 m0, s47, 86016
    s_nop 0
    buffer_load_dwordx4 v21, s[24:27], s45 offen nt lds
    s_add_u32 s45, s46, 0x2c0000
    s_add_u32 m0, s47, 90112
    s_nop 0
    buffer_load_dwordx4 v21, s[24:27], s45 offen nt lds
    s_add_u32 s45, s46, 0x2e0000
    s_add_u32 m0, s47, 94208
    s_nop 0
    buffer_load_dwordx4 v21, s[24:27], s45 offen nt lds
    s_add_u32 s45, s46, 0x300000
    s_add_u32 m0, s47, 98304
    s_nop 0
    buffer_load_dwordx4 v21, s[24:27], s45 offen nt lds
    s_add_u32 s45, s46, 0x320000
    s_add_u32 m0, s47, 102400
    s_nop 0
    buffer_load_dwordx4 v21, s[24:27], s45 offen nt lds
    s_add_u32 s45, s46, 0x340000
    s_add_u32 m0, s47, 106496
    s_nop 0
    buffer_load_dwordx4 v21, s[24:27], s45 offen nt lds
    s_add_u32 s45, s46, 0x360000
    s_add_u32 m0, s47, 110592
    s_nop 0
    buffer_load_dwordx4 v21, s[24:27], s45 offen nt lds
    s_add_u32 s45, s46, 0x380000
    s_add_u32 m0, s47, 114688
    s_nop 0
    buffer_load_dwordx4 v21, s[24:27], s45 offen nt lds
    s_add_u32 s45, s46, 0x3a0000
    s_add_u32 m0, s47, 118784
    s_nop 0
    buffer_load_dwordx4 v21, s[24:27], s45 offen nt lds
    s_add_u32 s45, s46, 0x3c0000
    s_add_u32 m0, s47, 122880
    s_nop 0
    buffer_load_dwordx4 v21, s[24:27], s45 offen nt lds
    s_add_u32 s45, s46, 0x3e0000
    s_add_u32 m0, s47, 126976
    s_nop 0
    buffer_load_dwordx4 v21, s[24:27], s45 offen nt lds
    s_waitcnt vmcnt(28)
    s_barrier
    s_add_u32 s45, s46, 0x400000
    s_add_u32 m0, s47, 131072
    s_nop 0
    buffer_load_dwordx4 v21, s[24:27], s45 offen nt lds
    s_add_u32 s45, s46, 0x420000
    s_add_u32 m0, s47, 135168
    s_nop 0
    buffer_load_dwordx4 v21, s[24:27], s45 offen nt lds
    s_add_u32 s45, s46, 0x440000
    s_add_u32 m0, s47, 139264
    s_nop 0
    buffer_load_dwordx4 v21, s[24:27], s45 offen nt lds
    s_add_u32 s45, s46, 0x460000
    s_add_u32 m0, s47, 143360
    s_nop 0
    buffer_load_dwordx4 v21, s[24:27], s45 offen nt lds
    ds_read_b64_tr_b16 a[0:1], v23 offset:0
    ds_read_b64_tr_b16 a[2:3], v23 offset:1024
    ds_read_b64_tr_b16 a[4:5], v23 offset:4096
    ds_read_b64_tr_b16 a[6:7], v23 offset:5120
    ds_read_b64_tr_b16 a[8:9], v23 offset:8192
    ds_read_b64_tr_b16 a[10:11], v23 offset:9216
    ds_read_b64_tr_b16 a[12:13], v23 offset:12288
    ds_read_b64_tr_b16 a[14:15], v23 offset:13312
    s_waitcnt lgkmcnt(0)
    s_waitcnt vmcnt(28)
    s_barrier
    s_add_u32 s45, s46, 0x480000
    s_add_u32 m0, s47, 0
    s_nop 0
    buffer_load_dwordx4 v21, s[24:27], s45 offen nt lds
    s_add_u32 s45, s46, 0x4a0000
    s_add_u32 m0, s47, 4096
    s_nop 0
    buffer_load_dwordx4 v21, s[24:27], s45 offen nt lds
    s_add_u32 s45, s46, 0x4c0000
    s_add_u32 m0, s47, 8192
    s_nop 0
    buffer_load_dwordx4 v21, s[24:27], s45 offen nt lds
    s_add_u32 s45, s46, 0x4e0000
    s_add_u32 m0, s47, 12288
    s_nop 0
    buffer_load_dwordx4 v21, s[24:27], s45 offen nt lds
    ds_read_b64_tr_b16 a[16:17], v23 offset:16384
    ds_read_b64_tr_b16 a[18:19], v23 offset:17408
    ds_read_b64_tr_b16 a[20:21], v23 offset:20480
    ds_read_b64_tr_b16 a[22:23], v23 offset:21504
    ds_read_b64_tr_b16 a[24:25], v23 offset:24576
    ds_read_b64_tr_b16 a[26:27], v23 offset:25600
    ds_read_b64_tr_b16 a[28:29], v23 offset:28672
    ds_read_b64_tr_b16 a[30:31], v23 offset:29696
    s_waitcnt lgkmcnt(0)
    s_waitcnt vmcnt(28)
    s_barrier
    s_add_u32 s45, s46, 0x500000
    s_add_u32 m0, s47, 16384
    s_nop 0
    buffer_load_dwordx4 v21, s[24:27], s45 offen nt lds
    s_add_u32 s45, s46, 0x520000
    s_add_u32 m0, s47, 20480
    s_nop 0
    buffer_load_dwordx4 v21, s[24:27], s45 offen nt lds
    s_add_u32 s45, s46, 0x540000
    s_add_u32 m0, s47, 24576
    s_nop 0
    buffer_load_dwordx4 v21, s[24:27], s45 offen nt lds
    s_add_u32 s45, s46, 0x560000
    s_add_u32 m0, s47, 28672
    s_nop 0
    buffer_load_dwordx4 v21, s[24:27], s45 offen nt lds
    ds_read_b64_tr_b16 a[32:33], v23 offset:32768
    ds_read_b64_tr_b16 a[34:35], v23 offset:33792
    ds_read_b64_tr_b16 a[36:37], v23 offset:36864
    ds_read_b64_tr_b16 a[38:39], v23 offset:37888
    ds_read_b64_tr_b16 a[40:41], v23 offset:40960
    ds_read_b64_tr_b16 a[42:43], v23 offset:41984
    ds_read_b64_tr_b16 a[44:45], v23 offset:45056
    ds_read_b64_tr_b16 a[46:47], v23 offset:46080
    s_waitcnt lgkmcnt(0)
    s_waitcnt vmcnt(28)
    s_barrier
    s_add_u32 s45, s46, 0x580000
    s_add_u32 m0, s47, 32768
    s_nop 0
    buffer_load_dwordx4 v21, s[24:27], s45 offen nt lds
    s_add_u32 s45, s46, 0x5a0000
    s_add_u32 m0, s47, 36864
    s_nop 0
    buffer_load_dwordx4 v21, s[24:27], s45 offen nt lds
    s_add_u32 s45, s46, 0x5c0000
    s_add_u32 m0, s47, 40960
    s_nop 0
    buffer_load_dwordx4 v21, s[24:27], s45 offen nt lds
    s_add_u32 s45, s46, 0x5e0000
    s_add_u32 m0, s47, 45056
    s_nop 0
    buffer_load_dwordx4 v21, s[24:27], s45 offen nt lds
    ds_read_b64_tr_b16 a[48:49], v23 offset:49152
    ds_read_b64_tr_b16 a[50:51], v23 offset:50176
    ds_read_b64_tr_b16 a[52:53], v23 offset:53248
    ds_read_b64_tr_b16 a[54:55], v23 offset:54272
    ds_read_b64_tr_b16 a[56:57], v23 offset:57344
    ds_read_b64_tr_b16 a[58:59], v23 offset:58368
    ds_read_b64_tr_b16 a[60:61], v23 offset:61440
    ds_read_b64_tr_b16 a[62:63], v23 offset:62464
    s_waitcnt lgkmcnt(0)
    s_waitcnt vmcnt(28)
    s_barrier
    s_add_u32 s45, s46, 0x600000
    s_add_u32 m0, s47, 49152
    s_nop 0
    buffer_load_dwordx4 v21, s[24:27], s45 offen nt lds
    s_add_u32 s45, s46, 0x620000
    s_add_u32 m0, s47, 53248
    s_nop 0
    buffer_load_dwordx4 v21, s[24:27], s45 offen nt lds
    s_add_u32 s45, s46, 0x640000
    s_add_u32 m0, s47, 57344
    s_nop 0
    buffer_load_dwordx4 v21, s[24:27], s45 offen nt lds
    s_add_u32 s45, s46, 0x660000
    s_add_u32 m0, s47, 61440
    s_nop 0
    buffer_load_dwordx4 v21, s[24:27], s45 offen nt lds
    ds_read_b64_tr_b16 a[64:65], v24 offset:0
    ds_read_b64_tr_b16 a[66:67], v24 offset:1024
    ds_read_b64_tr_b16 a[68:69], v24 offset:4096
    ds_read_b64_tr_b16 a[70:71], v24 offset:5120
    ds_read_b64_tr_b16 a[72:73], v24 offset:8192
    ds_read_b64_tr_b16 a[74:75], v24 offset:9216
    ds_read_b64_tr_b16 a[76:77], v24 offset:12288
    ds_read_b64_tr_b16 a[78:79], v24 offset:13312
    s_waitcnt lgkmcnt(0)
    s_waitcnt vmcnt(28)
    s_barrier
    s_add_u32 s45, s46, 0x680000
    s_add_u32 m0, s47, 65536
    s_nop 0
    buffer_load_dwordx4 v21, s[24:27], s45 offen nt lds
    s_add_u32 s45, s46, 0x6a0000
    s_add_u32 m0, s47, 69632
    s_nop 0
    buffer_load_dwordx4 v21, s[24:27], s45 offen nt lds
    s_add_u32 s45, s46, 0x6c0000
    s_add_u32 m0, s47, 73728
    s_nop 0
    buffer_load_dwordx4 v21, s[24:27], s45 offen nt lds
    s_add_u32 s45, s46, 0x6e0000
    s_add_u32 m0, s47, 77824
    s_nop 0
    buffer_load_dwordx4 v21, s[24:27], s45 offen nt lds
    ds_read_b64_tr_b16 a[80:81], v24 offset:16384
    ds_read_b64_tr_b16 a[82:83], v24 offset:17408
    ds_read_b64_tr_b16 a[84:85], v24 offset:20480
    ds_read_b64_tr_b16 a[86:87], v24 offset:21504
    ds_read_b64_tr_b16 a[88:89], v24 offset:24576
    ds_read_b64_tr_b16 a[90:91], v24 offset:25600
    ds_read_b64_tr_b16 a[92:93], v24 offset:28672
    ds_read_b64_tr_b16 a[94:95], v24 offset:29696
    s_waitcnt lgkmcnt(0)
    s_waitcnt vmcnt(28)
    s_barrier
    s_add_u32 s45, s46, 0x700000
    s_add_u32 m0, s47, 81920
    s_nop 0
    buffer_load_dwordx4 v21, s[24:27], s45 offen nt lds
    s_add_u32 s45, s46, 0x720000
    s_add_u32 m0, s47, 86016
    s_nop 0
    buffer_load_dwordx4 v21, s[24:27], s45 offen nt lds
    s_add_u32 s45, s46, 0x740000
    s_add_u32 m0, s47, 90112
    s_nop 0
    buffer_load_dwordx4 v21, s[24:27], s45 offen nt lds
    s_add_u32 s45, s46, 0x760000
    s_add_u32 m0, s47, 94208
    s_nop 0
    buffer_load_dwordx4 v21, s[24:27], s45 offen nt lds
    ds_read_b64_tr_b16 a[96:97], v24 offset:32768
    ds_read_b64_tr_b16 a[98:99], v24 offset:33792
    ds_read_b64_tr_b16 a[100:101], v24 offset:36864
    ds_read_b64_tr_b16 a[102:103], v24 offset:37888
    ds_read_b64_tr_b16 a[104:105], v24 offset:40960
    ds_read_b64_tr_b16 a[106:107], v24 offset:41984
    ds_read_b64_tr_b16 a[108:109], v24 offset:45056
    ds_read_b64_tr_b16 a[110:111], v24 offset:46080
    s_waitcnt lgkmcnt(0)
    s_waitcnt vmcnt(28)
    s_barrier
    s_add_u32 s45, s46, 0x780000
    s_add_u32 m0, s47, 98304
    s_nop 0
    buffer_load_dwordx4 v21, s[24:27], s45 offen nt lds
    s_add_u32 s45, s46, 0x7a0000
    s_add_u32 m0, s47, 102400
    s_nop 0
    buffer_load_dwordx4 v21, s[24:27], s45 offen nt lds
    s_add_u32 s45, s46, 0x7c0000
    s_add_u32 m0, s47, 106496
    s_nop 0
    buffer_load_dwordx4 v21, s[24:27], s45 offen nt lds
    s_add_u32 s45, s46, 0x7e0000
    s_add_u32 m0, s47, 110592
    s_nop 0
    buffer_load_dwordx4 v21, s[24:27], s45 offen nt lds
    ds_read_b64_tr_b16 a[112:113], v24 offset:49152
    ds_read_b64_tr_b16 a[114:115], v24 offset:50176
    ds_read_b64_tr_b16 a[116:117], v24 offset:53248
    ds_read_b64_tr_b16 a[118:119], v24 offset:54272
    ds_read_b64_tr_b16 a[120:121], v24 offset:57344
    ds_read_b64_tr_b16 a[122:123], v24 offset:58368
    ds_read_b64_tr_b16 a[124:125], v24 offset:61440
    ds_read_b64_tr_b16 a[126:127], v24 offset:62464
    s_waitcnt lgkmcnt(0)
    s_waitcnt vmcnt(28)
    s_barrier
    ds_read_b64_tr_b16 a[128:129], v25 offset:0
    ds_read_b64_tr_b16 a[130:131], v25 offset:1024
    ds_read_b64_tr_b16 a[132:133], v25 offset:4096
    ds_read_b64_tr_b16 a[134:135], v25 offset:5120
    ds_read_b64_tr_b16 a[136:137], v25 offset:8192
    ds_read_b64_tr_b16 a[138:139], v25 offset:9216
    ds_read_b64_tr_b16 a[140:141], v25 offset:12288
    ds_read_b64_tr_b16 a[142:143], v25 offset:13312
    s_waitcnt lgkmcnt(0)
    s_waitcnt vmcnt(24)
    s_barrier
    ds_read_b64_tr_b16 a[144:145], v23 offset:0
    ds_read_b64_tr_b16 a[146:147], v23 offset:1024
    ds_read_b64_tr_b16 a[148:149], v23 offset:4096
    ds_read_b64_tr_b16 a[150:151], v23 offset:5120
    ds_read_b64_tr_b16 a[152:153], v23 offset:8192
    ds_read_b64_tr_b16 a[154:155], v23 offset:9216
    ds_read_b64_tr_b16 a[156:157], v23 offset:12288
    ds_read_b64_tr_b16 a[158:159], v23 offset:13312
    s_waitcnt lgkmcnt(0)
    s_waitcnt vmcnt(20)
    s_barrier
    ds_read_b64_tr_b16 a[160:161], v23 offset:16384
    ds_read_b64_tr_b16 a[162:163], v23 offset:17408
    ds_read_b64_tr_b16 a[164:165], v23 offset:20480
    ds_read_b64_tr_b16 a[166:167], v23 offset:21504
    ds_read_b64_tr_b16 a[168:169], v23 offset:24576
    ds_read_b64_tr_b16 a[170:171], v23 offset:25600
    ds_read_b64_tr_b16 a[172:173], v23 offset:28672
    ds_read_b64_tr_b16 a[174:175], v23 offset:29696
    s_waitcnt lgkmcnt(0)
    s_waitcnt vmcnt(16)
    s_barrier
    ds_read_b64_tr_b16 a[176:177], v23 offset:32768
    ds_read_b64_tr_b16 a[178:179], v23 offset:33792
    ds_read_b64_tr_b16 a[180:181], v23 offset:36864
    ds_read_b64_tr_b16 a[182:183], v23 offset:37888
    ds_read_b64_tr_b16 a[184:185], v23 offset:40960
    ds_read_b64_tr_b16 a[186:187], v23 offset:41984
    ds_read_b64_tr_b16 a[188:189], v23 offset:45056
    ds_read_b64_tr_b16 a[190:191], v23 offset:46080
    s_waitcnt lgkmcnt(0)
    s_waitcnt vmcnt(12)
    s_barrier
    ds_read_b64_tr_b16 a[192:193], v23 offset:49152
    ds_read_b64_tr_b16 a[194:195], v23 offset:50176
    ds_read_b64_tr_b16 a[196:197], v23 offset:53248
    ds_read_b64_tr_b16 a[198:199], v23 offset:54272
    ds_read_b64_tr_b16 a[200:201], v23 offset:57344
    ds_read_b64_tr_b16 a[202:203], v23 offset:58368
    ds_read_b64_tr_b16 a[204:205], v23 offset:61440
    ds_read_b64_tr_b16 a[206:207], v23 offset:62464
    s_waitcnt lgkmcnt(0)
    s_waitcnt vmcnt(8)
    s_barrier
    ds_read_b64_tr_b16 a[208:209], v24 offset:0
    ds_read_b64_tr_b16 a[210:211], v24 offset:1024
    ds_read_b64_tr_b16 a[212:213], v24 offset:4096
    ds_read_b64_tr_b16 a[214:215], v24 offset:5120
    ds_read_b64_tr_b16 a[216:217], v24 offset:8192
    ds_read_b64_tr_b16 a[218:219], v24 offset:9216
    ds_read_b64_tr_b16 a[220:221], v24 offset:12288
    ds_read_b64_tr_b16 a[222:223], v24 offset:13312
    s_waitcnt lgkmcnt(0)
    s_waitcnt vmcnt(4)
    s_barrier
    ds_read_b64_tr_b16 a[224:225], v24 offset:16384
    ds_read_b64_tr_b16 a[226:227], v24 offset:17408
    ds_read_b64_tr_b16 a[228:229], v24 offset:20480
    ds_read_b64_tr_b16 a[230:231], v24 offset:21504
    ds_read_b64_tr_b16 a[232:233], v24 offset:24576
    ds_read_b64_tr_b16 a[234:235], v24 offset:25600
    ds_read_b64_tr_b16 a[236:237], v24 offset:28672
    ds_read_b64_tr_b16 a[238:239], v24 offset:29696
    s_waitcnt lgkmcnt(0)
    s_waitcnt vmcnt(0)
    s_barrier
    ds_read_b64_tr_b16 a[240:241], v24 offset:32768
    ds_read_b64_tr_b16 a[242:243], v24 offset:33792
    ds_read_b64_tr_b16 a[244:245], v24 offset:36864
    ds_read_b64_tr_b16 a[246:247], v24 offset:37888
    ds_read_b64_tr_b16 a[248:249], v24 offset:40960
    ds_read_b64_tr_b16 a[250:251], v24 offset:41984
    ds_read_b64_tr_b16 a[252:253], v24 offset:45056
    ds_read_b64_tr_b16 a[254:255], v24 offset:46080
    s_waitcnt lgkmcnt(0)
    s_barrier
    s_waitcnt vmcnt(0)
    s_barrier
    s_cmp_lg_u32 s44, 0
    s_cbranch_scc1 L_cnt_120
    v_mov_b32 v30, 1
    v_mov_b32 v31, 0
    s_mov_b64 exec, 1
    buffer_atomic_add v30, v31, s[16:19], 0 offen offset:64 sc1
    s_mov_b64 exec, -1
L_cnt_120:
    s_mov_b32 s60, 0
    s_mov_b32 s51, 1
    s_mov_b32 s71, 192
    s_mov_b32 s52, 0x400000
    s_lshl_b32 s56, s39, 19
    s_add_u32 s56, s56, 0x2000000
L_w_qkv_121:
    s_cmp_lg_u32 s44, 0
    s_cbranch_scc1 L_pd_122
    v_mov_b32 v29, s71
    s_mov_b32 s46, 96
    s_mov_b64 exec, 1
    s_mov_b32 s70, 0
L_wp_123:
    buffer_load_dword v31, v29, s[16:19], 0 offen sc1
    s_add_u32 s70, s70, 1
    s_cmp_ge_u32 s70, 0x200000
    s_cbranch_scc1 L_w_done_108
    s_waitcnt vmcnt(0)
    v_cmp_gt_u32 vcc, s46, v31
    s_nop 1
    s_cbranch_vccz L_wp_123_ok
    s_sleep 3
    s_branch L_wp_123
L_wp_123_ok:
    s_mov_b64 exec, -1
L_pd_122:
    s_barrier
    s_mov_b32 s50, s60
    s_mul_i32 s53, s50, 65536
    s_add_u32 s53, s53, s52
    s_lshl_b32 s45, s44, 11
    s_add_u32 s53, s53, s45
    s_mul_i32 s57, s50, 8192
    s_add_u32 s57, s57, s56
    s_mul_i32 s54, s44, 8320
    s_add_u32 s55, s54, 66560
    s_mov_b32 s58, 0
    v_mov_b32 v13, v4
    s_mov_b32 s59, 66560
    s_add_u32 m0, s54, 0
    s_nop 0
    buffer_load_dwordx4 v2, s[12:15], s53 offen offset:0 sc1 lds
    s_add_u32 m0, s54, 784
    s_nop 0
    buffer_load_dwordx4 v2, s[12:15], s53 offen offset:256 sc1 lds
    s_add_u32 m0, s54, 1568
    s_nop 0
    buffer_load_dwordx4 v2, s[12:15], s53 offen offset:512 sc1 lds
    s_add_u32 m0, s54, 2352
    s_nop 0
    buffer_load_dwordx4 v2, s[12:15], s53 offen offset:768 sc1 lds
    s_add_u32 m0, s54, 3136
    s_nop 0
    buffer_load_dwordx4 v2, s[12:15], s53 offen offset:1024 sc1 lds
    s_add_u32 m0, s54, 3920
    s_nop 0
    buffer_load_dwordx4 v2, s[12:15], s53 offen offset:1280 sc1 lds
    s_add_u32 m0, s54, 4704
    s_nop 0
    buffer_load_dwordx4 v2, s[12:15], s53 offen offset:1536 sc1 lds
    s_add_u32 m0, s54, 5488
    s_nop 0
    buffer_load_dwordx4 v2, s[12:15], s53 offen offset:1792 sc1 lds
    s_add_u32 s45, s53, 32768
    s_add_u32 s46, s54, 33280
    s_add_u32 m0, s46, 0
    s_nop 0
    buffer_load_dwordx4 v2, s[12:15], s45 offen offset:0 sc1 lds
    s_add_u32 m0, s46, 784
    s_nop 0
    buffer_load_dwordx4 v2, s[12:15], s45 offen offset:256 sc1 lds
    s_add_u32 m0, s46, 1568
    s_nop 0
    buffer_load_dwordx4 v2, s[12:15], s45 offen offset:512 sc1 lds
    s_add_u32 m0, s46, 2352
    s_nop 0
    buffer_load_dwordx4 v2, s[12:15], s45 offen offset:768 sc1 lds
    s_add_u32 m0, s46, 3136
    s_nop 0
    buffer_load_dwordx4 v2, s[12:15], s45 offen offset:1024 sc1 lds
    s_add_u32 m0, s46, 3920
    s_nop 0
    buffer_load_dwordx4 v2, s[12:15], s45 offen offset:1280 sc1 lds
    s_add_u32 m0, s46, 4704
    s_nop 0
    buffer_load_dwordx4 v2, s[12:15], s45 offen offset:1536 sc1 lds
    s_add_u32 m0, s46, 5488
    s_nop 0
    buffer_load_dwordx4 v2, s[12:15], s45 offen offset:1792 sc1 lds
    s_add_u32 s45, s53, 65536
    s_cmp_gt_u32 s51, 1
    s_cselect_b32 s45, s45, 0x20000000
    s_add_u32 m0, s55, 0
    s_nop 0
    buffer_load_dwordx4 v2, s[12:15], s45 offen offset:0 sc1 lds
    s_add_u32 m0, s55, 784
    s_nop 0
    buffer_load_dwordx4 v2, s[12:15], s45 offen offset:256 sc1 lds
    s_add_u32 m0, s55, 1568
    s_nop 0
    buffer_load_dwordx4 v2, s[12:15], s45 offen offset:512 sc1 lds
    s_add_u32 m0, s55, 2352
    s_nop 0
    buffer_load_dwordx4 v2, s[12:15], s45 offen offset:768 sc1 lds
    s_add_u32 m0, s55, 3136
    s_nop 0
    buffer_load_dwordx4 v2, s[12:15], s45 offen offset:1024 sc1 lds
    s_add_u32 m0, s55, 3920
    s_nop 0
    buffer_load_dwordx4 v2, s[12:15], s45 offen offset:1280 sc1 lds
    s_add_u32 m0, s55, 4704
    s_nop 0
    buffer_load_dwordx4 v2, s[12:15], s45 offen offset:1536 sc1 lds
    s_add_u32 m0, s55, 5488
    s_nop 0
    buffer_load_dwordx4 v2, s[12:15], s45 offen offset:1792 sc1 lds
L_e_loop_124:
    s_add_u32 s45, s53, 98304
    s_add_u32 s46, s58, 1
    s_cmp_lt_u32 s46, s51
    s_cselect_b32 s48, s45, 0x20000000
    s_add_u32 s49, s55, 33280
    s_waitcnt vmcnt(16)
    s_barrier
    s_cmp_lg_u32 s44, 0
    s_cbranch_scc1 L_e_pr_125
    s_cmp_lt_u32 s58, 2
    s_cbranch_scc1 L_e_pr_125
    s_add_u32 s45, s58, s60
    s_sub_u32 s45, s45, 1
    v_mov_b32 v30, s45
    v_mov_b32 v31, 0
    s_mov_b64 exec, 1
    buffer_store_dword v30, v31, s[12:15], s61 offen sc1
    s_mov_b64 exec, -1
L_e_pr_125:
    ds_read_b128 v[32:35], v13 offset:0
    ds_read_b128 v[36:39], v13 offset:32
    ds_read_b128 v[40:43], v13 offset:64
    ds_read_b128 v[44:47], v13 offset:96
    ds_read_b128 v[48:51], v13 offset:128
    ds_read_b128 v[52:55], v13 offset:160
    s_waitcnt lgkmcnt(4)
    v_mfma_f32_32x32x16_bf16 v[64:79], a[0:3], v[32:35], 0
    ds_read_b128 v[56:59], v13 offset:192
    v_mfma_f32_32x32x16_bf16 v[64:79], a[4:7], v[36:39], v[64:79]
    ds_read_b128 v[60:63], v13 offset:224
    s_add_u32 m0, s49, 0
    s_nop 0
    buffer_load_dwordx4 v2, s[12:15], s48 offen offset:0 sc1 lds
    s_waitcnt lgkmcnt(4)
    v_mfma_f32_32x32x16_bf16 v[64:79], a[8:11], v[40:43], v[64:79]
    ds_read_b128 v[32:35], v13 offset:256
    v_mfma_f32_32x32x16_bf16 v[64:79], a[12:15], v[44:47], v[64:79]
    ds_read_b128 v[36:39], v13 offset:288
    s_add_u32 m0, s49, 784
    s_nop 0
    buffer_load_dwordx4 v2, s[12:15], s48 offen offset:256 sc1 lds
    s_waitcnt lgkmcnt(4)
    v_mfma_f32_32x32x16_bf16 v[64:79], a[16:19], v[48:51], v[64:79]
    ds_read_b128 v[40:43], v13 offset:320
    v_mfma_f32_32x32x16_bf16 v[64:79], a[20:23], v[52:55], v[64:79]
    ds_read_b128 v[44:47], v13 offset:352
    s_add_u32 m0, s49, 1568
    s_nop 0
    buffer_load_dwordx4 v2, s[12:15], s48 offen offset:512 sc1 lds
    s_waitcnt lgkmcnt(4)
    v_mfma_f32_32x32x16_bf16 v[64:79], a[24:27], v[56:59], v[64:79]
    ds_read_b128 v[48:51], v13 offset:384
    v_mfma_f32_32x32x16_bf16 v[64:79], a[28:31], v[60:63], v[64:79]
    ds_read_b128 v[52:55], v13 offset:416
    s_add_u32 m0, s49, 2352
    s_nop 0
    buffer_load_dwordx4 v2, s[12:15], s48 offen offset:768 sc1 lds
    s_waitcnt lgkmcnt(4)
    v_mfma_f32_32x32x16_bf16 v[64:79], a[32:35], v[32:35], v[64:79]
    ds_read_b128 v[56:59], v13 offset:448
    v_mfma_f32_32x32x16_bf16 v[64:79], a[36:39], v[36:39], v[64:79]
    ds_read_b128 v[60:63], v13 offset:480
    s_add_u32 m0, s49, 3136
    s_nop 0
    buffer_load_dwordx4 v2, s[12:15], s48 offen offset:1024 sc1 lds
    s_waitcnt lgkmcnt(4)
    v_mfma_f32_32x32x16_bf16 v[64:79], a[40:43], v[40:43], v[64:79]
    ds_read_b128 v[32:35], v13 offset:512
    v_mfma_f32_32x32x16_bf16 v[64:79], a[44:47], v[44:47], v[64:79]
    ds_read_b128 v[36:39], v13 offset:544
    s_add_u32 m0, s49, 3920
    s_nop 0
    buffer_load_dwordx4 v2, s[12:15], s48 offen offset:1280 sc1 lds
    s_waitcnt lgkmcnt(4)
    v_mfma_f32_32x32x16_bf16 v[64:79], a[48:51], v[48:51], v[64:79]
    ds_read_b128 v[40:43], v13 offset:576
    v_mfma_f32_32x32x16_bf16 v[64:79], a[52:55], v[52:55], v[64:79]
    ds_read_b128 v[44:47], v13 offset:608
    s_add_u32 m0, s49, 4704
    s_nop 0
    buffer_load_dwordx4 v2, s[12:15], s48 offen offset:1536 sc1 lds
    s_waitcnt lgkmcnt(4)
    v_mfma_f32_32x32x16_bf16 v[64:79], a[56:59], v[56:59], v[64:79]
    ds_read_b128 v[48:51], v13 offset:640
    v_mfma_f32_32x32x16_bf16 v[64:79], a[60:63], v[60:63], v[64:79]
    ds_read_b128 v[52:55], v13 offset:672
    s_add_u32 m0, s49, 5488
    s_nop 0
    buffer_load_dwordx4 v2, s[12:15], s48 offen offset:1792 sc1 lds
    s_waitcnt lgkmcnt(4)
    v_mfma_f32_32x32x16_bf16 v[64:79], a[64:67], v[32:35], v[64:79]
    ds_read_b128 v[56:59], v13 offset:704
    v_mfma_f32_32x32x16_bf16 v[64:79], a[68:71], v[36:39], v[64:79]
    ds_read_b128 v[60:63], v13 offset:736
    s_waitcnt lgkmcnt(4)
    v_mfma_f32_32x32x16_bf16 v[64:79], a[72:75], v[40:43], v[64:79]
    ds_read_b128 v[32:35], v13 offset:768
    v_mfma_f32_32x32x16_bf16 v[64:79], a[76:79], v[44:47], v[64:79]
    ds_read_b128 v[36:39], v13 offset:800
    s_waitcnt lgkmcnt(4)
    v_mfma_f32_32x32x16_bf16 v[64:79], a[80:83], v[48:51], v[64:79]
    ds_read_b128 v[40:43], v13 offset:832
    v_mfma_f32_32x32x16_bf16 v[64:79], a[84:87], v[52:55], v[64:79]
    ds_read_b128 v[44:47], v13 offset:864
    s_waitcnt lgkmcnt(4)
    v_mfma_f32_32x32x16_bf16 v[64:79], a[88:91], v[56:59], v[64:79]
    ds_read_b128 v[48:51], v13 offset:896
    v_mfma_f32_32x32x16_bf16 v[64:79], a[92:95], v[60:63], v[64:79]
    ds_read_b128 v[52:55], v13 offset:928
    s_waitcnt lgkmcnt(4)
    v_mfma_f32_32x32x16_bf16 v[64:79], a[96:99], v[32:35], v[64:79]
    ds_read_b128 v[56:59], v13 offset:960
    v_mfma_f32_32x32x16_bf16 v[64:79], a[100:103], v[36:39], v[64:79]
    ds_read_b128 v[60:63], v13 offset:992
    s_waitcnt lgkmcnt(4)
    v_mfma_f32_32x32x16_bf16 v[64:79], a[104:107], v[40:43], v[64:79]
    v_mfma_f32_32x32x16_bf16 v[64:79], a[108:111], v[44:47], v[64:79]
    s_waitcnt lgkmcnt(2)
    v_mfma_f32_32x32x16_bf16 v[64:79], a[112:115], v[48:51], v[64:79]
    v_mfma_f32_32x32x16_bf16 v[64:79], a[116:119], v[52:55], v[64:79]
    s_waitcnt lgkmcnt(0)
    v_mfma_f32_32x32x16_bf16 v[64:79], a[120:123], v[56:59], v[64:79]
    v_mfma_f32_32x32x16_bf16 v[64:79], a[124:127], v[60:63], v[64:79]
    s_add_u32 s45, s53, 131072
    s_add_u32 s46, s58, 2
    s_cmp_lt_u32 s46, s51
    s_cselect_b32 s48, s45, 0x20000000
    s_mov_b32 s49, s54
    s_waitcnt vmcnt(16)
    s_barrier
    ds_read_b128 v[32:35], v13 offset:33280
    ds_read_b128 v[36:39], v13 offset:33312
    ds_read_b128 v[40:43], v13 offset:33344
    ds_read_b128 v[44:47], v13 offset:33376
    ds_read_b128 v[48:51], v13 offset:33408
    ds_read_b128 v[52:55], v13 offset:33440
    s_waitcnt lgkmcnt(4)
    v_mfma_f32_32x32x16_bf16 v[64:79], a[128:131], v[32:35], v[64:79]
    ds_read_b128 v[56:59], v13 offset:33472
    v_mfma_f32_32x32x16_bf16 v[64:79], a[132:135], v[36:39], v[64:79]
    ds_read_b128 v[60:63], v13 offset:33504
    s_add_u32 m0, s49, 0
    s_nop 0
    buffer_load_dwordx4 v2, s[12:15], s48 offen offset:0 sc1 lds
    s_waitcnt lgkmcnt(4)
    v_mfma_f32_32x32x16_bf16 v[64:79], a[136:139], v[40:43], v[64:79]
    ds_read_b128 v[32:35], v13 offset:33536
    v_mfma_f32_32x32x16_bf16 v[64:79], a[140:143], v[44:47], v[64:79]
    ds_read_b128 v[36:39], v13 offset:33568
    s_add_u32 m0, s49, 784
    s_nop 0
    buffer_load_dwordx4 v2, s[12:15], s48 offen offset:256 sc1 lds
    s_waitcnt lgkmcnt(4)
    v_mfma_f32_32x32x16_bf16 v[64:79], a[144:147], v[48:51], v[64:79]
    ds_read_b128 v[40:43], v13 offset:33600
    v_mfma_f32_32x32x16_bf16 v[64:79], a[148:151], v[52:55], v[64:79]
    ds_read_b128 v[44:47], v13 offset:33632
    s_add_u32 m0, s49, 1568
    s_nop 0
    buffer_load_dwordx4 v2, s[12:15], s48 offen offset:512 sc1 lds
    s_waitcnt lgkmcnt(4)
    v_mfma_f32_32x32x16_bf16 v[64:79], a[152:155], v[56:59], v[64:79]
    ds_read_b128 v[48:51], v13 offset:33664
    v_mfma_f32_32x32x16_bf16 v[64:79], a[156:159], v[60:63], v[64:79]
    ds_read_b128 v[52:55], v13 offset:33696
    s_add_u32 m0, s49, 2352
    s_nop 0
    buffer_load_dwordx4 v2, s[12:15], s48 offen offset:768 sc1 lds
    s_waitcnt lgkmcnt(4)
    v_mfma_f32_32x32x16_bf16 v[64:79], a[160:163], v[32:35], v[64:79]
    ds_read_b128 v[56:59], v13 offset:33728
    v_mfma_f32_32x32x16_bf16 v[64:79], a[164:167], v[36:39], v[64:79]
    ds_read_b128 v[60:63], v13 offset:33760
    s_add_u32 m0, s49, 3136
    s_nop 0
    buffer_load_dwordx4 v2, s[12:15], s48 offen offset:1024 sc1 lds
    s_waitcnt lgkmcnt(4)
    v_mfma_f32_32x32x16_bf16 v[64:79], a[168:171], v[40:43], v[64:79]
    ds_read_b128 v[32:35], v13 offset:33792
    v_mfma_f32_32x32x16_bf16 v[64:79], a[172:175], v[44:47], v[64:79]
    ds_read_b128 v[36:39], v13 offset:33824
    s_add_u32 m0, s49, 3920
    s_nop 0
    buffer_load_dwordx4 v2, s[12:15], s48 offen offset:1280 sc1 lds
    s_waitcnt lgkmcnt(4)
    v_mfma_f32_32x32x16_bf16 v[64:79], a[176:179], v[48:51], v[64:79]
    ds_read_b128 v[40:43], v13 offset:33856
    v_mfma_f32_32x32x16_bf16 v[64:79], a[180:183], v[52:55], v[64:79]
    ds_read_b128 v[44:47], v13 offset:33888
    s_add_u32 m0, s49, 4704
    s_nop 0
    buffer_load_dwordx4 v2, s[12:15], s48 offen offset:1536 sc1 lds
    s_waitcnt lgkmcnt(4)
    v_mfma_f32_32x32x16_bf16 v[64:79], a[184:187], v[56:59], v[64:79]
    ds_read_b128 v[48:51], v13 offset:33920
    v_mfma_f32_32x32x16_bf16 v[64:79], a[188:191], v[60:63], v[64:79]
    ds_read_b128 v[52:55], v13 offset:33952
    s_add_u32 m0, s49, 5488
    s_nop 0
    buffer_load_dwordx4 v2, s[12:15], s48 offen offset:1792 sc1 lds
    s_waitcnt lgkmcnt(4)
    v_mfma_f32_32x32x16_bf16 v[64:79], a[192:195], v[32:35], v[64:79]
    ds_read_b128 v[56:59], v13 offset:33984
    v_mfma_f32_32x32x16_bf16 v[64:79], a[196:199], v[36:39], v[64:79]
    ds_read_b128 v[60:63], v13 offset:34016
    s_waitcnt lgkmcnt(4)
    v_mfma_f32_32x32x16_bf16 v[64:79], a[200:203], v[40:43], v[64:79]
    ds_read_b128 v[32:35], v13 offset:34048
    v_mfma_f32_32x32x16_bf16 v[64:79], a[204:207], v[44:47], v[64:79]
    ds_read_b128 v[36:39], v13 offset:34080
    s_waitcnt lgkmcnt(4)
    v_mfma_f32_32x32x16_bf16 v[64:79], a[208:211], v[48:51], v[64:79]
    ds_read_b128 v[40:43], v13 offset:34112
    v_mfma_f32_32x32x16_bf16 v[64:79], a[212:215], v[52:55], v[64:79]
    ds_read_b128 v[44:47], v13 offset:34144
    s_waitcnt lgkmcnt(4)
    v_mfma_f32_32x32x16_bf16 v[64:79], a[216:219], v[56:59], v[64:79]
    ds_read_b128 v[48:51], v13 offset:34176
    v_mfma_f32_32x32x16_bf16 v[64:79], a[220:223], v[60:63], v[64:79]
    ds_read_b128 v[52:55], v13 offset:34208
    s_waitcnt lgkmcnt(4)
    v_mfma_f32_32x32x16_bf16 v[64:79], a[224:227], v[32:35], v[64:79]
    ds_read_b128 v[56:59], v13 offset:34240
    v_mfma_f32_32x32x16_bf16 v[64:79], a[228:231], v[36:39], v[64:79]
    ds_read_b128 v[60:63], v13 offset:34272
    s_waitcnt lgkmcnt(4)
    v_mfma_f32_32x32x16_bf16 v[64:79], a[232:235], v[40:43], v[64:79]
    v_mfma_f32_32x32x16_bf16 v[64:79], a[236:239], v[44:47], v[64:79]
    s_waitcnt lgkmcnt(2)
    v_mfma_f32_32x32x16_bf16 v[64:79], a[240:243], v[48:51], v[64:79]
    v_mfma_f32_32x32x16_bf16 v[64:79], a[244:247], v[52:55], v[64:79]
    s_waitcnt lgkmcnt(0)
    v_mfma_f32_32x32x16_bf16 v[64:79], a[248:251], v[56:59], v[64:79]
    v_mfma_f32_32x32x16_bf16 v[64:79], a[252:255], v[60:63], v[64:79]
    s_add_u32 s53, s53, 65536
    s_add_u32 s58, s58, 1
    v_add_u32 v13, s59, v13
    s_add_u32 s54, s54, s59
    s_sub_u32 s55, s55, s59
    s_sub_u32 s59, 0, s59
    s_lshl_b32 s45, s44, 11
    s_add_u32 s45, s45, s57
    s_add_u32 s57, s57, 8192
    s_nop 3
    v_cvt_pk_bf16_f32 v64, v64, v65
    v_cvt_pk_bf16_f32 v65, v66, v67
    v_cvt_pk_bf16_f32 v66, v68, v69
    v_cvt_pk_bf16_f32 v67, v70, v71
    v_cvt_pk_bf16_f32 v68, v72, v73
    v_cvt_pk_bf16_f32 v69, v74, v75
    v_cvt_pk_bf16_f32 v70, v76, v77
    v_cvt_pk_bf16_f32 v71, v78, v79
    ds_write_b128 v6, v[64:67]
    ds_write_b128 v6, v[68:71] offset:16
    s_waitcnt lgkmcnt(0)
    s_barrier
    ds_read_b128 v[80:83], v8
    ds_read_b128 v[84:87], v8 offset:1088
    s_waitcnt lgkmcnt(1)
    buffer_store_dwordx4 v[80:83], v10, s[12:15], s45 offen sc1
    s_waitcnt lgkmcnt(0)
    buffer_store_dwordx4 v[84:87], v10, s[12:15], s45 offen offset:1024 sc1
    s_cmp_lt_u32 s58, s51
    s_cbranch_scc1 L_e_loop_124
    s_add_u32 s60, s60, s51
    s_waitcnt vmcnt(0)
    s_barrier
    s_cmp_lg_u32 s44, 0
    s_cbranch_scc1 L_pub_126
    v_mov_b32 v30, s60
    v_mov_b32 v31, 0
    s_mov_b64 exec, 1
    buffer_store_dword v30, v31, s[12:15], s61 offen sc1
    s_mov_b64 exec, -1
L_pub_126:
    s_cmp_eq_u32 s60, 1
    s_cselect_b32 s51, 11, 52
    s_cselect_b32 s71, s71, 196
    s_cmp_lt_u32 s60, 64
    s_cbranch_scc1 L_w_qkv_121
L_w_roles_110:
    s_cmp_lg_u32 s44, 0
    s_cbranch_scc1 L_pd_127
    v_mov_b32 v29, 64
    s_mov_b32 s46, 192
    s_mov_b64 exec, 1
    s_mov_b32 s70, 0
L_wp_128:
    buffer_load_dword v31, v29, s[16:19], 0 offen sc1
    s_add_u32 s70, s70, 1
    s_cmp_ge_u32 s70, 0x200000
    s_cbranch_scc1 L_w_done_108
    s_waitcnt vmcnt(0)
    v_cmp_gt_u32 vcc, s46, v31
    s_nop 1
    s_cbranch_vccz L_wp_128_ok
    s_sleep 3
    s_branch L_wp_128
L_wp_128_ok:
    s_mov_b64 exec, -1
L_pd_127:
    s_barrier
    s_mov_b32 s36, 0x11111111
    s_mov_b32 s37, 0x44101010
    s_cmp_eq_u32 s42, 0
    s_cselect_b32 s36, s36, 0x0
    s_cselect_b32 s37, s37, 0x90810101
    s_mov_b32 s72, 0x88888888
    s_mov_b32 s73, 0xea488888
    s_lshr_b32 s38, s41, 3
    s_and_b32 s68, s41, 7
    s_cmp_eq_u32 s43, 1
    s_cbranch_scc1 L_role_b_129
    s_cmp_eq_u32 s43, 2
    s_cbranch_scc1 L_role_c_130
    s_load_dwordx2 s[6:7], s[0:1], 40
    s_waitcnt lgkmcnt(0)
    s_mov_b32 s24, s6
    s_and_b32 s25, s7, 0xffff
    s_mov_b32 s26, 0x800000
    s_mov_b32 s27, 0x00020000
    s_lshl_b32 s46, s38, 21
    s_lshl_b32 s45, s68, 8
    s_add_u32 s46, s46, s45
    s_waitcnt vmcnt(0)
    s_barrier
    v_lshrrev_b32 v20, 4, v1
    s_lshl_b32 s45, s44, 2
    v_add_u32 v21, s45, v20
    s_mov_b32 s45, 2048
    v_mul_lo_u32 v21, v21, s45
    v_lshlrev_b32 v22, 2, v20
    v_and_b32 v23, 15, v1
    v_xor_b32 v22, v22, v23
    v_lshlrev_b32 v22, 4, v22
    v_add_u32 v21, v21, v22
    v_bfe_u32 v22, v1, 2, 2
    v_lshrrev_b32 v23, 5, v1
    v_lshlrev_b32 v23, 3, v23
    v_add_u32 v23, v23, v22
    v_lshlrev_b32 v23, 8, v23
    v_xor_b32 v22, s44, v22
    v_lshlrev_b32 v22, 6, v22
    v_add_u32 v23, v23, v22
    v_and_b32 v22, 1, v1
    v_lshlrev_b32 v22, 5, v22
    v_add_u32 v23, v23, v22
    v_and_b32 v22, 16, v1
    v_add_u32 v23, v23, v22
    v_and_b32 v22, 2, v1
    v_lshlrev_b32 v22, 2, v22
    v_add_u32 v23, v23, v22
    v_add_u32 v24, 65536, v23
    v_add_u32 v25, 131072, v23
    s_lshl_b32 s47, s44, 10
    s_add_u32 s45, s46, 0x0
    s_add_u32 m0, s47, 0
    s_nop 0
    buffer_load_dwordx4 v21, s[24:27], s45 offen nt lds
    s_add_u32 s45, s46, 0x8000
    s_add_u32 m0, s47, 4096
    s_nop 0
    buffer_load_dwordx4 v21, s[24:27], s45 offen nt lds
    s_add_u32 s45, s46, 0x10000
    s_add_u32 m0, s47, 8192
    s_nop 0
    buffer_load_dwordx4 v21, s[24:27], s45 offen nt lds
    s_add_u32 s45, s46, 0x18000
    s_add_u32 m0, s47, 12288
    s_nop 0
    buffer_load_dwordx4 v21, s[24:27], s45 offen nt lds
    s_add_u32 s45, s46, 0x20000
    s_add_u32 m0, s47, 16384
    s_nop 0
    buffer_load_dwordx4 v21, s[24:27], s45 offen nt lds
    s_add_u32 s45, s46, 0x28000
    s_add_u32 m0, s47, 20480
    s_nop 0
    buffer_load_dwordx4 v21, s[24:27], s45 offen nt lds
    s_add_u32 s45, s46, 0x30000
    s_add_u32 m0, s47, 24576
    s_nop 0
    buffer_load_dwordx4 v21, s[24:27], s45 offen nt lds
    s_add_u32 s45, s46, 0x38000
    s_add_u32 m0, s47, 28672
    s_nop 0
    buffer_load_dwordx4 v21, s[24:27], s45 offen nt lds
    s_add_u32 s45, s46, 0x40000
    s_add_u32 m0, s47, 32768
    s_nop 0
    buffer_load_dwordx4 v21, s[24:27], s45 offen nt lds
    s_add_u32 s45, s46, 0x48000
    s_add_u32 m0, s47, 36864
    s_nop 0
    buffer_load_dwordx4 v21, s[24:27], s45 offen nt lds
    s_add_u32 s45, s46, 0x50000
    s_add_u32 m0, s47, 40960
    s_nop 0
    buffer_load_dwordx4 v21, s[24:27], s45 offen nt lds
    s_add_u32 s45, s46, 0x58000
    s_add_u32 m0, s47, 45056
    s_nop 0
    buffer_load_dwordx4 v21, s[24:27], s45 offen nt lds
    s_add_u32 s45, s46, 0x60000
    s_add_u32 m0, s47, 49152
    s_nop 0
    buffer_load_dwordx4 v21, s[24:27], s45 offen nt lds
    s_add_u32 s45, s46, 0x68000
    s_add_u32 m0, s47, 53248
    s_nop 0
    buffer_load_dwordx4 v21, s[24:27], s45 offen nt lds
    s_add_u32 s45, s46, 0x70000
    s_add_u32 m0, s47, 57344
    s_nop 0
    buffer_load_dwordx4 v21, s[24:27], s45 offen nt lds
    s_add_u32 s45, s46, 0x78000
    s_add_u32 m0, s47, 61440
    s_nop 0
    buffer_load_dwordx4 v21, s[24:27], s45 offen nt lds
    s_add_u32 s45, s46, 0x80000
    s_add_u32 m0, s47, 65536
    s_nop 0
    buffer_load_dwordx4 v21, s[24:27], s45 offen nt lds
    s_add_u32 s45, s46, 0x88000
    s_add_u32 m0, s47, 69632
    s_nop 0
    buffer_load_dwordx4 v21, s[24:27], s45 offen nt lds
    s_add_u32 s45, s46, 0x90000
    s_add_u32 m0, s47, 73728
    s_nop 0
    buffer_load_dwordx4 v21, s[24:27], s45 offen nt lds
    s_add_u32 s45, s46, 0x98000
    s_add_u32 m0, s47, 77824
    s_nop 0
    buffer_load_dwordx4 v21, s[24:27], s45 offen nt lds
    s_add_u32 s45, s46, 0xa0000
    s_add_u32 m0, s47, 81920
    s_nop 0
    buffer_load_dwordx4 v21, s[24:27], s45 offen nt lds
    s_add_u32 s45, s46, 0xa8000
    s_add_u32 m0, s47, 86016
    s_nop 0
    buffer_load_dwordx4 v21, s[24:27], s45 offen nt lds
    s_add_u32 s45, s46, 0xb0000
    s_add_u32 m0, s47, 90112
    s_nop 0
    buffer_load_dwordx4 v21, s[24:27], s45 offen nt lds
    s_add_u32 s45, s46, 0xb8000
    s_add_u32 m0, s47, 94208
    s_nop 0
    buffer_load_dwordx4 v21, s[24:27], s45 offen nt lds
    s_add_u32 s45, s46, 0xc0000
    s_add_u32 m0, s47, 98304
    s_nop 0
    buffer_load_dwordx4 v21, s[24:27], s45 offen nt lds
    s_add_u32 s45, s46, 0xc8000
    s_add_u32 m0, s47, 102400
    s_nop 0
    buffer_load_dwordx4 v21, s[24:27], s45 offen nt lds
    s_add_u32 s45, s46, 0xd0000
    s_add_u32 m0, s47, 106496
    s_nop 0
    buffer_load_dwordx4 v21, s[24:27], s45 offen nt lds
    s_add_u32 s45, s46, 0xd8000
    s_add_u32 m0, s47, 110592
    s_nop 0
    buffer_load_dwordx4 v21, s[24:27], s45 offen nt lds
    s_add_u32 s45, s46, 0xe0000
    s_add_u32 m0, s47, 114688
    s_nop 0
    buffer_load_dwordx4 v21, s[24:27], s45 offen nt lds
    s_add_u32 s45, s46, 0xe8000
    s_add_u32 m0, s47, 118784
    s_nop 0
    buffer_load_dwordx4 v21, s[24:27], s45 offen nt lds
    s_add_u32 s45, s46, 0xf0000
    s_add_u32 m0, s47, 122880
    s_nop 0
    buffer_load_dwordx4 v21, s[24:27], s45 offen nt lds
    s_add_u32 s45, s46, 0xf8000
    s_add_u32 m0, s47, 126976
    s_nop 0
    buffer_load_dwordx4 v21, s[24:27], s45 offen nt lds
    s_waitcnt vmcnt(28)
    s_barrier
    s_add_u32 s45, s46, 0x100000
    s_add_u32 m0, s47, 131072
    s_nop 0
    buffer_load_dwordx4 v21, s[24:27], s45 offen nt lds
    s_add_u32 s45, s46, 0x108000
    s_add_u32 m0, s47, 135168
    s_nop 0
    buffer_load_dwordx4 v21, s[24:27], s45 offen nt lds
    s_add_u32 s45, s46, 0x110000
    s_add_u32 m0, s47, 139264
    s_nop 0
    buffer_load_dwordx4 v21, s[24:27], s45 offen nt lds
    s_add_u32 s45, s46, 0x118000
    s_add_u32 m0, s47, 143360
    s_nop 0
    buffer_load_dwordx4 v21, s[24:27], s45 offen nt lds
    ds_read_b64_tr_b16 a[0:1], v23 offset:0
    ds_read_b64_tr_b16 a[2:3], v23 offset:1024
    ds_read_b64_tr_b16 a[4:5], v23 offset:4096
    ds_read_b64_tr_b16 a[6:7], v23 offset:5120
    ds_read_b64_tr_b16 a[8:9], v23 offset:8192
    ds_read_b64_tr_b16 a[10:11], v23 offset:9216
    ds_read_b64_tr_b16 a[12:13], v23 offset:12288
    ds_read_b64_tr_b16 a[14:15], v23 offset:13312
    s_waitcnt lgkmcnt(0)
    s_waitcnt vmcnt(28)
    s_barrier
    s_add_u32 s45, s46, 0x120000
    s_add_u32 m0, s47, 0
    s_nop 0
    buffer_load_dwordx4 v21, s[24:27], s45 offen nt lds
    s_add_u32 s45, s46, 0x128000
    s_add_u32 m0, s47, 4096
    s_nop 0
    buffer_load_dwordx4 v21, s[24:27], s45 offen nt lds
    s_add_u32 s45, s46, 0x130000
    s_add_u32 m0, s47, 8192
    s_nop 0
    buffer_load_dwordx4 v21, s[24:27], s45 offen nt lds
    s_add_u32 s45, s46, 0x138000
    s_add_u32 m0, s47, 12288
    s_nop 0
    buffer_load_dwordx4 v21, s[24:27], s45 offen nt lds
    ds_read_b64_tr_b16 a[16:17], v23 offset:16384
    ds_read_b64_tr_b16 a[18:19], v23 offset:17408
    ds_read_b64_tr_b16 a[20:21], v23 offset:20480
    ds_read_b64_tr_b16 a[22:23], v23 offset:21504
    ds_read_b64_tr_b16 a[24:25], v23 offset:24576
    ds_read_b64_tr_b16 a[26:27], v23 offset:25600
    ds_read_b64_tr_b16 a[28:29], v23 offset:28672
    ds_read_b64_tr_b16 a[30:31], v23 offset:29696
    s_waitcnt lgkmcnt(0)
    s_waitcnt vmcnt(28)
    s_barrier
    s_add_u32 s45, s46, 0x140000
    s_add_u32 m0, s47, 16384
    s_nop 0
    buffer_load_dwordx4 v21, s[24:27], s45 offen nt lds
    s_add_u32 s45, s46, 0x148000
    s_add_u32 m0, s47, 20480
    s_nop 0
    buffer_load_dwordx4 v21, s[24:27], s45 offen nt lds
    s_add_u32 s45, s46, 0x150000
    s_add_u32 m0, s47, 24576
    s_nop 0
    buffer_load_dwordx4 v21, s[24:27], s45 offen nt lds
    s_add_u32 s45, s46, 0x158000
    s_add_u32 m0, s47, 28672
    s_nop 0
    buffer_load_dwordx4 v21, s[24:27], s45 offen nt lds
    ds_read_b64_tr_b16 a[32:33], v23 offset:32768
    ds_read_b64_tr_b16 a[34:35], v23 offset:33792
    ds_read_b64_tr_b16 a[36:37], v23 offset:36864
    ds_read_b64_tr_b16 a[38:39], v23 offset:37888
    ds_read_b64_tr_b16 a[40:41], v23 offset:40960
    ds_read_b64_tr_b16 a[42:43], v23 offset:41984
    ds_read_b64_tr_b16 a[44:45], v23 offset:45056
    ds_read_b64_tr_b16 a[46:47], v23 offset:46080
    s_waitcnt lgkmcnt(0)
    s_waitcnt vmcnt(28)
    s_barrier
    s_add_u32 s45, s46, 0x160000
    s_add_u32 m0, s47, 32768
    s_nop 0
    buffer_load_dwordx4 v21, s[24:27], s45 offen nt lds
    s_add_u32 s45, s46, 0x168000
    s_add_u32 m0, s47, 36864
    s_nop 0
    buffer_load_dwordx4 v21, s[24:27], s45 offen nt lds
    s_add_u32 s45, s46, 0x170000
    s_add_u32 m0, s47, 40960
    s_nop 0
    buffer_load_dwordx4 v21, s[24:27], s45 offen nt lds
    s_add_u32 s45, s46, 0x178000
    s_add_u32 m0, s47, 45056
    s_nop 0
    buffer_load_dwordx4 v21, s[24:27], s45 offen nt lds
    ds_read_b64_tr_b16 a[48:49], v23 offset:49152
    ds_read_b64_tr_b16 a[50:51], v23 offset:50176
    ds_read_b64_tr_b16 a[52:53], v23 offset:53248
    ds_read_b64_tr_b16 a[54:55], v23 offset:54272
    ds_read_b64_tr_b16 a[56:57], v23 offset:57344
    ds_read_b64_tr_b16 a[58:59], v23 offset:58368
    ds_read_b64_tr_b16 a[60:61], v23 offset:61440
    ds_read_b64_tr_b16 a[62:63], v23 offset:62464
    s_waitcnt lgkmcnt(0)
    s_waitcnt vmcnt(28)
    s_barrier
    s_add_u32 s45, s46, 0x180000
    s_add_u32 m0, s47, 49152
    s_nop 0
    buffer_load_dwordx4 v21, s[24:27], s45 offen nt lds
    s_add_u32 s45, s46, 0x188000
    s_add_u32 m0, s47, 53248
    s_nop 0
    buffer_load_dwordx4 v21, s[24:27], s45 offen nt lds
    s_add_u32 s45, s46, 0x190000
    s_add_u32 m0, s47, 57344
    s_nop 0
    buffer_load_dwordx4 v21, s[24:27], s45 offen nt lds
    s_add_u32 s45, s46, 0x198000
    s_add_u32 m0, s47, 61440
    s_nop 0
    buffer_load_dwordx4 v21, s[24:27], s45 offen nt lds
    ds_read_b64_tr_b16 a[64:65], v24 offset:0
    ds_read_b64_tr_b16 a[66:67], v24 offset:1024
    ds_read_b64_tr_b16 a[68:69], v24 offset:4096
    ds_read_b64_tr_b16 a[70:71], v24 offset:5120
    ds_read_b64_tr_b16 a[72:73], v24 offset:8192
    ds_read_b64_tr_b16 a[74:75], v24 offset:9216
    ds_read_b64_tr_b16 a[76:77], v24 offset:12288
    ds_read_b64_tr_b16 a[78:79], v24 offset:13312
    s_waitcnt lgkmcnt(0)
    s_waitcnt vmcnt(28)
    s_barrier
    s_add_u32 s45, s46, 0x1a0000
    s_add_u32 m0, s47, 65536
    s_nop 0
    buffer_load_dwordx4 v21, s[24:27], s45 offen nt lds
    s_add_u32 s45, s46, 0x1a8000
    s_add_u32 m0, s47, 69632
    s_nop 0
    buffer_load_dwordx4 v21, s[24:27], s45 offen nt lds
    s_add_u32 s45, s46, 0x1b0000
    s_add_u32 m0, s47, 73728
    s_nop 0
    buffer_load_dwordx4 v21, s[24:27], s45 offen nt lds
    s_add_u32 s45, s46, 0x1b8000
    s_add_u32 m0, s47, 77824
    s_nop 0
    buffer_load_dwordx4 v21, s[24:27], s45 offen nt lds
    ds_read_b64_tr_b16 a[80:81], v24 offset:16384
    ds_read_b64_tr_b16 a[82:83], v24 offset:17408
    ds_read_b64_tr_b16 a[84:85], v24 offset:20480
    ds_read_b64_tr_b16 a[86:87], v24 offset:21504
    ds_read_b64_tr_b16 a[88:89], v24 offset:24576
    ds_read_b64_tr_b16 a[90:91], v24 offset:25600
    ds_read_b64_tr_b16 a[92:93], v24 offset:28672
    ds_read_b64_tr_b16 a[94:95], v24 offset:29696
    s_waitcnt lgkmcnt(0)
    s_waitcnt vmcnt(28)
    s_barrier
    s_add_u32 s45, s46, 0x1c0000
    s_add_u32 m0, s47, 81920
    s_nop 0
    buffer_load_dwordx4 v21, s[24:27], s45 offen nt lds
    s_add_u32 s45, s46, 0x1c8000
    s_add_u32 m0, s47, 86016
    s_nop 0
    buffer_load_dwordx4 v21, s[24:27], s45 offen nt lds
    s_add_u32 s45, s46, 0x1d0000
    s_add_u32 m0, s47, 90112
    s_nop 0
    buffer_load_dwordx4 v21, s[24:27], s45 offen nt lds
    s_add_u32 s45, s46, 0x1d8000
    s_add_u32 m0, s47, 94208
    s_nop 0
    buffer_load_dwordx4 v21, s[24:27], s45 offen nt lds
    ds_read_b64_tr_b16 a[96:97], v24 offset:32768
    ds_read_b64_tr_b16 a[98:99], v24 offset:33792
    ds_read_b64_tr_b16 a[100:101], v24 offset:36864
    ds_read_b64_tr_b16 a[102:103], v24 offset:37888
    ds_read_b64_tr_b16 a[104:105], v24 offset:40960
    ds_read_b64_tr_b16 a[106:107], v24 offset:41984
    ds_read_b64_tr_b16 a[108:109], v24 offset:45056
    ds_read_b64_tr_b16 a[110:111], v24 offset:46080
    s_waitcnt lgkmcnt(0)
    s_waitcnt vmcnt(28)
    s_barrier
    s_add_u32 s45, s46, 0x1e0000
    s_add_u32 m0, s47, 98304
    s_nop 0
    buffer_load_dwordx4 v21, s[24:27], s45 offen nt lds
    s_add_u32 s45, s46, 0x1e8000
    s_add_u32 m0, s47, 102400
    s_nop 0
    buffer_load_dwordx4 v21, s[24:27], s45 offen nt lds
    s_add_u32 s45, s46, 0x1f0000
    s_add_u32 m0, s47, 106496
    s_nop 0
    buffer_load_dwordx4 v21, s[24:27], s45 offen nt lds
    s_add_u32 s45, s46, 0x1f8000
    s_add_u32 m0, s47, 110592
    s_nop 0
    buffer_load_dwordx4 v21, s[24:27], s45 offen nt lds
    ds_read_b64_tr_b16 a[112:113], v24 offset:49152
    ds_read_b64_tr_b16 a[114:115], v24 offset:50176
    ds_read_b64_tr_b16 a[116:117], v24 offset:53248
    ds_read_b64_tr_b16 a[118:119], v24 offset:54272
    ds_read_b64_tr_b16 a[120:121], v24 offset:57344
    ds_read_b64_tr_b16 a[122:123], v24 offset:58368
    ds_read_b64_tr_b16 a[124:125], v24 offset:61440
    ds_read_b64_tr_b16 a[126:127], v24 offset:62464
    s_waitcnt lgkmcnt(0)
    s_waitcnt vmcnt(28)
    s_barrier
    ds_read_b64_tr_b16 a[128:129], v25 offset:0
    ds_read_b64_tr_b16 a[130:131], v25 offset:1024
    ds_read_b64_tr_b16 a[132:133], v25 offset:4096
    ds_read_b64_tr_b16 a[134:135], v25 offset:5120
    ds_read_b64_tr_b16 a[136:137], v25 offset:8192
    ds_read_b64_tr_b16 a[138:139], v25 offset:9216
    ds_read_b64_tr_b16 a[140:141], v25 offset:12288
    ds_read_b64_tr_b16 a[142:143], v25 offset:13312
    s_waitcnt lgkmcnt(0)
    s_waitcnt vmcnt(24)
    s_barrier
    ds_read_b64_tr_b16 a[144:145], v23 offset:0
    ds_read_b64_tr_b16 a[146:147], v23 offset:1024
    ds_read_b64_tr_b16 a[148:149], v23 offset:4096
    ds_read_b64_tr_b16 a[150:151], v23 offset:5120
    ds_read_b64_tr_b16 a[152:153], v23 offset:8192
    ds_read_b64_tr_b16 a[154:155], v23 offset:9216
    ds_read_b64_tr_b16 a[156:157], v23 offset:12288
    ds_read_b64_tr_b16 a[158:159], v23 offset:13312
    s_waitcnt lgkmcnt(0)
    s_waitcnt vmcnt(20)
    s_barrier
    ds_read_b64_tr_b16 a[160:161], v23 offset:16384
    ds_read_b64_tr_b16 a[162:163], v23 offset:17408
    ds_read_b64_tr_b16 a[164:165], v23 offset:20480
    ds_read_b64_tr_b16 a[166:167], v23 offset:21504
    ds_read_b64_tr_b16 a[168:169], v23 offset:24576
    ds_read_b64_tr_b16 a[170:171], v23 offset:25600
    ds_read_b64_tr_b16 a[172:173], v23 offset:28672
    ds_read_b64_tr_b16 a[174:175], v23 offset:29696
    s_waitcnt lgkmcnt(0)
    s_waitcnt vmcnt(16)
    s_barrier
    ds_read_b64_tr_b16 a[176:177], v23 offset:32768
    ds_read_b64_tr_b16 a[178:179], v23 offset:33792
    ds_read_b64_tr_b16 a[180:181], v23 offset:36864
    ds_read_b64_tr_b16 a[182:183], v23 offset:37888
    ds_read_b64_tr_b16 a[184:185], v23 offset:40960
    ds_read_b64_tr_b16 a[186:187], v23 offset:41984
    ds_read_b64_tr_b16 a[188:189], v23 offset:45056
    ds_read_b64_tr_b16 a[190:191], v23 offset:46080
    s_waitcnt lgkmcnt(0)
    s_waitcnt vmcnt(12)
    s_barrier
    ds_read_b64_tr_b16 a[192:193], v23 offset:49152
    ds_read_b64_tr_b16 a[194:195], v23 offset:50176
    ds_read_b64_tr_b16 a[196:197], v23 offset:53248
    ds_read_b64_tr_b16 a[198:199], v23 offset:54272
    ds_read_b64_tr_b16 a[200:201], v23 offset:57344
    ds_read_b64_tr_b16 a[202:203], v23 offset:58368
    ds_read_b64_tr_b16 a[204:205], v23 offset:61440
    ds_read_b64_tr_b16 a[206:207], v23 offset:62464
    s_waitcnt lgkmcnt(0)
    s_waitcnt vmcnt(8)
    s_barrier
    ds_read_b64_tr_b16 a[208:209], v24 offset:0
    ds_read_b64_tr_b16 a[210:211], v24 offset:1024
    ds_read_b64_tr_b16 a[212:213], v24 offset:4096
    ds_read_b64_tr_b16 a[214:215], v24 offset:5120
    ds_read_b64_tr_b16 a[216:217], v24 offset:8192
    ds_read_b64_tr_b16 a[218:219], v24 offset:9216
    ds_read_b64_tr_b16 a[220:221], v24 offset:12288
    ds_read_b64_tr_b16 a[222:223], v24 offset:13312
    s_waitcnt lgkmcnt(0)
    s_waitcnt vmcnt(4)
    s_barrier
    ds_read_b64_tr_b16 a[224:225], v24 offset:16384
    ds_read_b64_tr_b16 a[226:227], v24 offset:17408
    ds_read_b64_tr_b16 a[228:229], v24 offset:20480
    ds_read_b64_tr_b16 a[230:231], v24 offset:21504
    ds_read_b64_tr_b16 a[232:233], v24 offset:24576
    ds_read_b64_tr_b16 a[234:235], v24 offset:25600
    ds_read_b64_tr_b16 a[236:237], v24 offset:28672
    ds_read_b64_tr_b16 a[238:239], v24 offset:29696
    s_waitcnt lgkmcnt(0)
    s_waitcnt vmcnt(0)
    s_barrier
    ds_read_b64_tr_b16 a[240:241], v24 offset:32768
    ds_read_b64_tr_b16 a[242:243], v24 offset:33792
    ds_read_b64_tr_b16 a[244:245], v24 offset:36864
    ds_read_b64_tr_b16 a[246:247], v24 offset:37888
    ds_read_b64_tr_b16 a[248:249], v24 offset:40960
    ds_read_b64_tr_b16 a[250:251], v24 offset:41984
    ds_read_b64_tr_b16 a[252:253], v24 offset:45056
    ds_read_b64_tr_b16 a[254:255], v24 offset:46080
    s_waitcnt lgkmcnt(0)
    s_barrier
    s_lshl_b32 s52, s38, 16
    s_add_u32 s52, s52, 0x5000000
    s_lshl_b32 s56, s38, 23
    s_lshl_b32 s45, s68, 9
    s_add_u32 s56, s56, s45
    s_add_u32 s56, s56, 0x8000000
    s_cmp_lg_u32 s44, 0
    s_cbranch_scc1 L_pd_131
    v_mov_b32 v29, 0
    s_mov_b32 s46, 64
    s_mov_b64 exec, 1
    s_mov_b32 s70, 0
L_wp_132:
    buffer_load_dword v31, v29, s[16:19], 0 offen sc1
    s_add_u32 s70, s70, 1
    s_cmp_ge_u32 s70, 0x200000
    s_cbranch_scc1 L_w_done_108
    s_waitcnt vmcnt(0)
    v_cmp_gt_u32 vcc, s46, v31
    s_nop 1
    s_cbranch_vccz L_wp_132_ok
    s_sleep 3
    s_branch L_wp_132
L_wp_132_ok:
    s_mov_b64 exec, -1
L_pd_131:
    s_barrier
L_a_loop_133:
    s_cmp_eq_u64 s[36:37], 0
    s_cbranch_scc1 L_w_done_108
    s_ff1_i32_b64 s50, s[36:37]
    s_bitset0_b64 s[36:37], s50
    s_lshr_b64 s[74:75], s[72:73], s50
    s_ff1_i32_b64 s51, s[74:75]
    s_add_u32 s51, s51, 1
    s_add_u32 s62, s50, s51
    s_add_u32 s63, s50, s44
    s_lshl_b32 s45, s41, 7
    s_add_u32 s45, s45, 0x10010
    s_cmp_lg_u32 s44, 0
    s_cbranch_scc1 L_pw_135
    s_mov_b64 exec, 7
    s_mov_b32 s70, 0
L_wp_136:
    buffer_load_dword v31, v12, s[12:15], s45 offen sc1
    s_add_u32 s70, s70, 1
    s_cmp_ge_u32 s70, 0x200000
    s_cbranch_scc1 L_w_done_108
    s_waitcnt vmcnt(0)
    v_cmp_gt_u32 vcc, s62, v31
    s_nop 1
    s_cbranch_vccz L_wp_136_ok
    s_sleep 2
    s_branch L_wp_136
L_wp_136_ok:
    s_mov_b64 exec, -1
L_pw_135:
    s_barrier
    s_cmp_ge_u32 s44, s51
    s_cbranch_scc1 L_xs1_137
    s_lshl_b32 s45, s41, 19
    s_lshl_b32 s46, s63, 13
    s_add_u32 s45, s45, s46
    s_add_u32 s45, s45, 0x2000000
    s_add_u32 s48, s45, 16777216
    s_add_u32 s49, s48, 16777216
    v_and_b32 v14, 15, v1
    v_lshlrev_b32 v15, 8, v14
    v_lshrrev_b32 v16, 4, v1
    v_lshlrev_b32 v17, 4, v16
    v_add_u32 v15, v15, v17
    v_add_u32 v17, 4096, v15
    buffer_load_dwordx4 v[128:131], v15, s[12:15], s45 offen offset:0 sc1
    buffer_load_dwordx4 v[132:135], v15, s[12:15], s45 offen offset:64 sc1
    buffer_load_dwordx4 v[136:139], v15, s[12:15], s45 offen offset:128 sc1
    buffer_load_dwordx4 v[140:143], v15, s[12:15], s45 offen offset:192 sc1
    buffer_load_dwordx4 v[144:147], v17, s[12:15], s45 offen offset:0 sc1
    buffer_load_dwordx4 v[148:151], v17, s[12:15], s45 offen offset:64 sc1
    buffer_load_dwordx4 v[152:155], v17, s[12:15], s45 offen offset:128 sc1
    buffer_load_dwordx4 v[156:159], v17, s[12:15], s45 offen offset:192 sc1
    buffer_load_dwordx4 v[160:163], v15, s[12:15], s48 offen offset:0 sc1
    buffer_load_dwordx4 v[164:167], v15, s[12:15], s48 offen offset:64 sc1
    buffer_load_dwordx4 v[168:171], v15, s[12:15], s48 offen offset:128 sc1
    buffer_load_dwordx4 v[172:175], v15, s[12:15], s48 offen offset:192 sc1
    buffer_load_dwordx4 v[176:179], v17, s[12:15], s48 offen offset:0 sc1
    buffer_load_dwordx4 v[180:183], v17, s[12:15], s48 offen offset:64 sc1
    buffer_load_dwordx4 v[184:187], v17, s[12:15], s48 offen offset:128 sc1
    buffer_load_dwordx4 v[188:191], v17, s[12:15], s48 offen offset:192 sc1
    s_add_u32 s46, s49, 4096
    buffer_load_dwordx4 v[208:211], v10, s[12:15], s49 offen offset:0 sc1
    buffer_load_dwordx4 v[212:215], v10, s[12:15], s49 offen offset:1024 sc1
    buffer_load_dwordx4 v[216:219], v10, s[12:15], s49 offen offset:2048 sc1
    buffer_load_dwordx4 v[220:223], v10, s[12:15], s49 offen offset:3072 sc1
    buffer_load_dwordx4 v[224:227], v10, s[12:15], s46 offen offset:0 sc1
    buffer_load_dwordx4 v[228:231], v10, s[12:15], s46 offen offset:1024 sc1
    buffer_load_dwordx4 v[232:235], v10, s[12:15], s46 offen offset:2048 sc1
    buffer_load_dwordx4 v[236:239], v10, s[12:15], s46 offen offset:3072 sc1
    v_mul_u32_u24 v18, 272, v16
    v_lshlrev_b32 v19, 4, v14
    s_mul_i32 s47, s44, 8704
    v_add3_u32 v18, v18, v19, s47
    s_waitcnt vmcnt(0)
    ds_write_b128 v18, v[208:211] offset:0
    ds_write_b128 v18, v[212:215] offset:1088
    ds_write_b128 v18, v[216:219] offset:2176
    ds_write_b128 v18, v[220:223] offset:3264
    ds_write_b128 v18, v[224:227] offset:4352
    ds_write_b128 v18, v[228:231] offset:5440
    ds_write_b128 v18, v[232:235] offset:6528
    ds_write_b128 v18, v[236:239] offset:7616
    v_mfma_f32_16x16x32_bf16 v[32:35], v[160:163], v[128:131], 0
    v_mfma_f32_16x16x32_bf16 v[36:39], v[160:163], v[144:147], 0
    v_mfma_f32_16x16x32_bf16 v[44:47], v[176:179], v[144:147], 0
    v_mfma_f32_16x16x32_bf16 v[32:35], v[164:167], v[132:135], v[32:35]
    v_mfma_f32_16x16x32_bf16 v[36:39], v[164:167], v[148:151], v[36:39]
    v_mfma_f32_16x16x32_bf16 v[44:47], v[180:183], v[148:151], v[44:47]
    v_mfma_f32_16x16x32_bf16 v[32:35], v[168:171], v[136:139], v[32:35]
    v_mfma_f32_16x16x32_bf16 v[36:39], v[168:171], v[152:155], v[36:39]
    v_mfma_f32_16x16x32_bf16 v[44:47], v[184:187], v[152:155], v[44:47]
    v_mfma_f32_16x16x32_bf16 v[32:35], v[172:175], v[140:143], v[32:35]
    v_mfma_f32_16x16x32_bf16 v[36:39], v[172:175], v[156:159], v[36:39]
    v_mfma_f32_16x16x32_bf16 v[44:47], v[188:191], v[156:159], v[44:47]
    v_lshlrev_b32 v19, 2, v16
    v_bfe_u32 v20, v1, 2, 2
    v_add_u32 v20, v19, v20
    v_mul_u32_u24 v20, 272, v20
    v_and_b32 v21, 3, v1
    v_lshlrev_b32 v21, 3, v21
    v_add3_u32 v20, v20, v21, s47
    v_mov_b32 v22, 0xff800000
    s_waitcnt lgkmcnt(0)
    ds_read_b64_tr_b16 v[208:209], v20 offset:0
    ds_read_b64_tr_b16 v[210:211], v20 offset:4352
    ds_read_b64_tr_b16 v[212:213], v20 offset:32
    ds_read_b64_tr_b16 v[214:215], v20 offset:4384
    ds_read_b64_tr_b16 v[216:217], v20 offset:64
    ds_read_b64_tr_b16 v[218:219], v20 offset:4416
    ds_read_b64_tr_b16 v[220:221], v20 offset:96
    ds_read_b64_tr_b16 v[222:223], v20 offset:4448
    ds_read_b64_tr_b16 v[224:225], v20 offset:128
    ds_read_b64_tr_b16 v[226:227], v20 offset:4480
    ds_read_b64_tr_b16 v[228:229], v20 offset:160
    ds_read_b64_tr_b16 v[230:231], v20 offset:4512
    ds_read_b64_tr_b16 v[232:233], v20 offset:192
    ds_read_b64_tr_b16 v[234:235], v20 offset:4544
    ds_read_b64_tr_b16 v[236:237], v20 offset:224
    ds_read_b64_tr_b16 v[238:239], v20 offset:4576
    v_add_u32 v21, 0, v19
    v_cmp_gt_u32 vcc, v21, v14
    s_nop 1
    v_cndmask_b32 v32, v32, v22, vcc
    v_cndmask_b32 v44, v44, v22, vcc
    v_add_u32 v21, 1, v19
    v_cmp_gt_u32 vcc, v21, v14
    s_nop 1
    v_cndmask_b32 v33, v33, v22, vcc
    v_cndmask_b32 v45, v45, v22, vcc
    v_add_u32 v21, 2, v19
    v_cmp_gt_u32 vcc, v21, v14
    s_nop 1
    v_cndmask_b32 v34, v34, v22, vcc
    v_cndmask_b32 v46, v46, v22, vcc
    v_add_u32 v21, 3, v19
    v_cmp_gt_u32 vcc, v21, v14
    s_nop 1
    v_cndmask_b32 v35, v35, v22, vcc
    v_cndmask_b32 v47, v47, v22, vcc
L_xs1_137:
    s_lshl_b32 s45, s41, 7
    s_add_u32 s45, s45, 0x11000
    s_cmp_lg_u32 s44, 0
    s_cbranch_scc1 L_pw_139
    s_mov_b64 exec, 255
    s_mov_b32 s70, 0
L_wp_140:
    buffer_load_dword v31, v12, s[12:15], s45 offen sc1
    s_add_u32 s70, s70, 1
    s_cmp_ge_u32 s70, 0x200000
    s_cbranch_scc1 L_w_done_108
    s_waitcnt vmcnt(0)
    v_cmp_gt_u32 vcc, s62, v31
    s_nop 1
    s_cbranch_vccz L_wp_140_ok
    s_sleep 2
    s_branch L_wp_140
L_wp_140_ok:
    s_mov_b64 exec, -1
L_pw_139:
    s_barrier
    s_cmp_ge_u32 s44, s51
    s_cbranch_scc1 L_xs2_138
    s_lshl_b32 s45, s63, 17
    s_lshl_b32 s46, s41, 12
    s_add_u32 s45, s45, s46
    s_lshr_b32 s46, s45, 1
    s_add_u32 s45, s45, 0x1000000
    s_add_u32 s46, s46, 0x1800000
    v_lshlrev_b32 v21, 3, v1
    buffer_load_dwordx4 v[192:195], v10, s[12:15], s45 offen offset:0 sc1
    buffer_load_dwordx4 v[196:199], v10, s[12:15], s45 offen offset:1024 sc1
    buffer_load_dwordx4 v[200:203], v10, s[12:15], s45 offen offset:2048 sc1
    buffer_load_dwordx4 v[204:207], v10, s[12:15], s45 offen offset:3072 sc1
    buffer_load_dwordx2 v[240:241], v21, s[12:15], s46 offen offset:0 sc1
    buffer_load_dwordx2 v[242:243], v21, s[12:15], s46 offen offset:512 sc1
    buffer_load_dwordx2 v[244:245], v21, s[12:15], s46 offen offset:1024 sc1
    buffer_load_dwordx2 v[246:247], v21, s[12:15], s46 offen offset:1536 sc1
    s_waitcnt vmcnt(4)
    v_mfma_f32_16x16x32_bf16 v[48:51], v[192:195], v[128:131], 0
    v_mfma_f32_16x16x32_bf16 v[52:55], v[192:195], v[144:147], 0
    v_mfma_f32_16x16x32_bf16 v[48:51], v[196:199], v[132:135], v[48:51]
    v_mfma_f32_16x16x32_bf16 v[52:55], v[196:199], v[148:151], v[52:55]
    v_mfma_f32_16x16x32_bf16 v[48:51], v[200:203], v[136:139], v[48:51]
    v_mfma_f32_16x16x32_bf16 v[52:55], v[200:203], v[152:155], v[52:55]
    v_mfma_f32_16x16x32_bf16 v[48:51], v[204:207], v[140:143], v[48:51]
    v_mfma_f32_16x16x32_bf16 v[52:55], v[204:207], v[156:159], v[52:55]
    s_mov_b32 s45, 0x3e0293ee
    s_nop 6
    v_permlane32_swap_b32 v48, v50
    v_permlane32_swap_b32 v49, v51
    v_pk_add_f32 v[48:49], v[48:49], v[50:51]
    v_permlane32_swap_b32 v52, v54
    v_permlane32_swap_b32 v53, v55
    v_pk_add_f32 v[52:53], v[52:53], v[54:55]
    v_max_f32 v22, v32, v33
    v_max3_f32 v22, v22, v34, v35
    v_max3_f32 v22, v22, v48, v49
    v_max_f32 v23, v36, v37
    v_max3_f32 v23, v23, v38, v39
    v_max3_f32 v23, v23, v44, v45
    v_max3_f32 v23, v23, v46, v47
    v_max3_f32 v23, v23, v52, v53
    v_mov_b32 v24, v22
    v_mov_b32 v25, v23
    s_nop 0
    v_permlane32_swap_b32 v22, v24
    v_permlane32_swap_b32 v23, v25
    v_max_f32 v22, v22, v24
    v_max_f32 v23, v23, v25
    v_mov_b32 v24, v22
    v_mov_b32 v25, v23
    s_nop 0
    v_permlane16_swap_b32 v22, v24
    v_permlane16_swap_b32 v23, v25
    v_max_f32 v22, v22, v24
    v_max_f32 v23, v23, v25
    v_mul_f32 v22, s45, v22
    v_mul_f32 v23, s45, v23
    v_fma_f32 v32, v32, s45, -v22
    v_fma_f32 v33, v33, s45, -v22
    v_fma_f32 v34, v34, s45, -v22
    v_fma_f32 v35, v35, s45, -v22
    v_fma_f32 v48, v48, s45, -v22
    v_fma_f32 v49, v49, s45, -v22
    v_exp_f32 v32, v32
    v_exp_f32 v33, v33
    v_exp_f32 v34, v34
    v_exp_f32 v35, v35
    v_exp_f32 v48, v48
    v_exp_f32 v49, v49
    v_fma_f32 v36, v36, s45, -v23
    v_fma_f32 v37, v37, s45, -v23
    v_fma_f32 v38, v38, s45, -v23
    v_fma_f32 v39, v39, s45, -v23
    v_fma_f32 v44, v44, s45, -v23
    v_fma_f32 v45, v45, s45, -v23
    v_fma_f32 v46, v46, s45, -v23
    v_fma_f32 v47, v47, s45, -v23
    v_fma_f32 v52, v52, s45, -v23
    v_fma_f32 v53, v53, s45, -v23
    v_exp_f32 v36, v36
    v_exp_f32 v37, v37
    v_exp_f32 v38, v38
    v_exp_f32 v39, v39
    v_exp_f32 v44, v44
    v_exp_f32 v45, v45
    v_exp_f32 v46, v46
    v_exp_f32 v47, v47
    v_exp_f32 v52, v52
    v_exp_f32 v53, v53
    v_add_f32 v22, v32, v33
    v_add_f32 v22, v22, v34
    v_add_f32 v22, v22, v35
    v_add_f32 v22, v22, v48
    v_add_f32 v22, v22, v49
    v_add_f32 v23, v36, v37
    v_add_f32 v23, v23, v38
    v_add_f32 v23, v23, v39
    v_add_f32 v23, v23, v44
    v_add_f32 v23, v23, v45
    v_add_f32 v23, v23, v46
    v_add_f32 v23, v23, v47
    v_add_f32 v23, v23, v52
    v_add_f32 v23, v23, v53
    v_mov_b32 v24, v22
    v_mov_b32 v25, v23
    s_nop 0
    v_permlane32_swap_b32 v22, v24
    v_permlane32_swap_b32 v23, v25
    v_add_f32 v22, v22, v24
    v_add_f32 v23, v23, v25
    v_mov_b32 v24, v22
    v_mov_b32 v25, v23
    s_nop 0
    v_permlane16_swap_b32 v22, v24
    v_permlane16_swap_b32 v23, v25
    v_add_f32 v22, v22, v24
    v_add_f32 v23, v23, v25
    v_rcp_f32 v22, v22
    v_rcp_f32 v23, v23
    s_nop 0
    v_mul_f32 v32, v32, v22
    v_mul_f32 v33, v33, v22
    v_mul_f32 v34, v34, v22
    v_mul_f32 v35, v35, v22
    v_mul_f32 v48, v48, v22
    v_mul_f32 v49, v49, v22
    v_mul_f32 v36, v36, v23
    v_mul_f32 v37, v37, v23
    v_mul_f32 v38, v38, v23
    v_mul_f32 v39, v39, v23
    v_mul_f32 v44, v44, v23
    v_mul_f32 v45, v45, v23
    v_mul_f32 v46, v46, v23
    v_mul_f32 v47, v47, v23
    v_mul_f32 v52, v52, v23
    v_mul_f32 v53, v53, v23
    v_cvt_pk_bf16_f32 v128, v32, v33
    v_cvt_pk_bf16_f32 v129, v34, v35
    v_mov_b32 v130, 0
    v_mov_b32 v131, 0
    v_cvt_pk_bf16_f32 v132, v48, v49
    v_mov_b32 v133, 0
    v_mov_b32 v134, 0
    v_cvt_pk_bf16_f32 v135, v48, v49
    v_cvt_pk_bf16_f32 v136, v36, v37
    v_cvt_pk_bf16_f32 v137, v38, v39
    v_cvt_pk_bf16_f32 v138, v44, v45
    v_cvt_pk_bf16_f32 v139, v46, v47
    v_cvt_pk_bf16_f32 v140, v52, v53
    v_mov_b32 v141, 0
    v_mov_b32 v142, 0
    v_cvt_pk_bf16_f32 v143, v52, v53
    s_waitcnt vmcnt(0) lgkmcnt(0)
    s_nop 0
    v_mfma_f32_16x16x32_bf16 v[64:67], v[208:211], v[128:131], 0
    v_mfma_f32_16x16x32_bf16 v[68:71], v[212:215], v[128:131], 0
    v_mfma_f32_16x16x32_bf16 v[72:75], v[216:219], v[128:131], 0
    v_mfma_f32_16x16x32_bf16 v[76:79], v[220:223], v[128:131], 0
    v_mfma_f32_16x16x32_bf16 v[80:83], v[224:227], v[128:131], 0
    v_mfma_f32_16x16x32_bf16 v[84:87], v[228:231], v[128:131], 0
    v_mfma_f32_16x16x32_bf16 v[88:91], v[232:235], v[128:131], 0
    v_mfma_f32_16x16x32_bf16 v[92:95], v[236:239], v[128:131], 0
    v_mfma_f32_16x16x16_bf16 v[64:67], v[240:241], v[132:133], v[64:67]
    v_mfma_f32_16x16x16_bf16 v[68:71], v[240:241], v[134:135], v[68:71]
    v_mfma_f32_16x16x16_bf16 v[72:75], v[242:243], v[132:133], v[72:75]
    v_mfma_f32_16x16x16_bf16 v[76:79], v[242:243], v[134:135], v[76:79]
    v_mfma_f32_16x16x16_bf16 v[80:83], v[244:245], v[132:133], v[80:83]
    v_mfma_f32_16x16x16_bf16 v[84:87], v[244:245], v[134:135], v[84:87]
    v_mfma_f32_16x16x16_bf16 v[88:91], v[246:247], v[132:133], v[88:91]
    v_mfma_f32_16x16x16_bf16 v[92:95], v[246:247], v[134:135], v[92:95]
    v_mfma_f32_16x16x32_bf16 v[96:99], v[208:211], v[136:139], 0
    v_mfma_f32_16x16x32_bf16 v[100:103], v[212:215], v[136:139], 0
    v_mfma_f32_16x16x32_bf16 v[104:107], v[216:219], v[136:139], 0
    v_mfma_f32_16x16x32_bf16 v[108:111], v[220:223], v[136:139], 0
    v_mfma_f32_16x16x32_bf16 v[112:115], v[224:227], v[136:139], 0
    v_mfma_f32_16x16x32_bf16 v[116:119], v[228:231], v[136:139], 0
    v_mfma_f32_16x16x32_bf16 v[120:123], v[232:235], v[136:139], 0
    v_mfma_f32_16x16x32_bf16 v[124:127], v[236:239], v[136:139], 0
    v_mfma_f32_16x16x16_bf16 v[96:99], v[240:241], v[140:141], v[96:99]
    v_mfma_f32_16x16x16_bf16 v[100:103], v[240:241], v[142:143], v[100:103]
    v_mfma_f32_16x16x16_bf16 v[104:107], v[242:243], v[140:141], v[104:107]
    v_mfma_f32_16x16x16_bf16 v[108:111], v[242:243], v[142:143], v[108:111]
    v_mfma_f32_16x16x16_bf16 v[112:115], v[244:245], v[140:141], v[112:115]
    v_mfma_f32_16x16x16_bf16 v[116:119], v[244:245], v[142:143], v[116:119]
    v_mfma_f32_16x16x16_bf16 v[120:123], v[246:247], v[140:141], v[120:123]
    v_mfma_f32_16x16x16_bf16 v[124:127], v[246:247], v[142:143], v[124:127]
    v_mul_u32_u24 v19, 272, v14
    v_lshlrev_b32 v20, 3, v16
    v_add3_u32 v19, v19, v20, s47
    s_lshl_b32 s45, s63, 18
    s_lshl_b32 s46, s41, 13
    s_add_u32 s45, s45, s46
    s_add_u32 s45, s45, 0x5000000
    s_add_u32 s46, s45, 4096
    v_cvt_pk_bf16_f32 v64, v64, v65
    v_cvt_pk_bf16_f32 v65, v66, v67
    ds_write_b64 v19, v[64:65] offset:0
    v_cvt_pk_bf16_f32 v68, v68, v69
    v_cvt_pk_bf16_f32 v69, v70, v71
    ds_write_b64 v19, v[68:69] offset:32
    v_cvt_pk_bf16_f32 v72, v72, v73
    v_cvt_pk_bf16_f32 v73, v74, v75
    ds_write_b64 v19, v[72:73] offset:64
    v_cvt_pk_bf16_f32 v76, v76, v77
    v_cvt_pk_bf16_f32 v77, v78, v79
    ds_write_b64 v19, v[76:77] offset:96
    v_cvt_pk_bf16_f32 v80, v80, v81
    v_cvt_pk_bf16_f32 v81, v82, v83
    ds_write_b64 v19, v[80:81] offset:128
    v_cvt_pk_bf16_f32 v84, v84, v85
    v_cvt_pk_bf16_f32 v85, v86, v87
    ds_write_b64 v19, v[84:85] offset:160
    v_cvt_pk_bf16_f32 v88, v88, v89
    v_cvt_pk_bf16_f32 v89, v90, v91
    ds_write_b64 v19, v[88:89] offset:192
    v_cvt_pk_bf16_f32 v92, v92, v93
    v_cvt_pk_bf16_f32 v93, v94, v95
    ds_write_b64 v19, v[92:93] offset:224
    v_cvt_pk_bf16_f32 v96, v96, v97
    v_cvt_pk_bf16_f32 v97, v98, v99
    ds_write_b64 v19, v[96:97] offset:4352
    v_cvt_pk_bf16_f32 v100, v100, v101
    v_cvt_pk_bf16_f32 v101, v102, v103
    ds_write_b64 v19, v[100:101] offset:4384
    v_cvt_pk_bf16_f32 v104, v104, v105
    v_cvt_pk_bf16_f32 v105, v106, v107
    ds_write_b64 v19, v[104:105] offset:4416
    v_cvt_pk_bf16_f32 v108, v108, v109
    v_cvt_pk_bf16_f32 v109, v110, v111
    ds_write_b64 v19, v[108:109] offset:4448
    v_cvt_pk_bf16_f32 v112, v112, v113
    v_cvt_pk_bf16_f32 v113, v114, v115
    ds_write_b64 v19, v[112:113] offset:4480
    v_cvt_pk_bf16_f32 v116, v116, v117
    v_cvt_pk_bf16_f32 v117, v118, v119
    ds_write_b64 v19, v[116:117] offset:4512
    v_cvt_pk_bf16_f32 v120, v120, v121
    v_cvt_pk_bf16_f32 v121, v122, v123
    ds_write_b64 v19, v[120:121] offset:4544
    v_cvt_pk_bf16_f32 v124, v124, v125
    v_cvt_pk_bf16_f32 v125, v126, v127
    ds_write_b64 v19, v[124:125] offset:4576
    s_waitcnt lgkmcnt(0)
    ds_read_b128 v[208:211], v18 offset:0
    ds_read_b128 v[212:215], v18 offset:1088
    ds_read_b128 v[216:219], v18 offset:2176
    ds_read_b128 v[220:223], v18 offset:3264
    ds_read_b128 v[224:227], v18 offset:4352
    ds_read_b128 v[228:231], v18 offset:5440
    ds_read_b128 v[232:235], v18 offset:6528
    ds_read_b128 v[236:239], v18 offset:7616
    s_waitcnt lgkmcnt(7)
    buffer_store_dwordx4 v[208:211], v10, s[12:15], s45 offen offset:0 sc1
    s_waitcnt lgkmcnt(6)
    buffer_store_dwordx4 v[212:215], v10, s[12:15], s45 offen offset:1024 sc1
    s_waitcnt lgkmcnt(5)
    buffer_store_dwordx4 v[216:219], v10, s[12:15], s45 offen offset:2048 sc1
    s_waitcnt lgkmcnt(4)
    buffer_store_dwordx4 v[220:223], v10, s[12:15], s45 offen offset:3072 sc1
    s_waitcnt lgkmcnt(3)
    buffer_store_dwordx4 v[224:227], v10, s[12:15], s46 offen offset:0 sc1
    s_waitcnt lgkmcnt(2)
    buffer_store_dwordx4 v[228:231], v10, s[12:15], s46 offen offset:1024 sc1
    s_waitcnt lgkmcnt(1)
    buffer_store_dwordx4 v[232:235], v10, s[12:15], s46 offen offset:2048 sc1
    s_waitcnt lgkmcnt(0)
    buffer_store_dwordx4 v[236:239], v10, s[12:15], s46 offen offset:3072 sc1
L_xs2_138:
    s_waitcnt vmcnt(0)
    s_barrier
    s_cmp_lg_u32 s44, 0
    s_cbranch_scc1 L_pub_141
    v_mov_b32 v30, s62
    v_mov_b32 v31, 0
    s_mov_b64 exec, 1
    buffer_store_dword v30, v31, s[12:15], s65 offen sc1
    s_mov_b64 exec, -1
L_pub_141:
    s_lshl_b32 s45, s38, 10
    s_add_u32 s45, s45, s64
    s_cmp_lg_u32 s44, 0
    s_cbranch_scc1 L_pw_142
    s_mov_b64 exec, 255
    s_mov_b32 s70, 0
L_wp_143:
    buffer_load_dword v31, v5, s[12:15], s45 offen sc1
    s_add_u32 s70, s70, 1
    s_cmp_ge_u32 s70, 0x200000
    s_cbranch_scc1 L_w_done_108
    s_waitcnt vmcnt(0)
    v_cmp_gt_u32 vcc, s62, v31
    s_nop 1
    s_cbranch_vccz L_wp_143_ok
    s_sleep 1
    s_branch L_wp_143
L_wp_143_ok:
    s_mov_b64 exec, -1
L_pw_142:
    s_barrier
    s_mul_i32 s53, s50, 262144
    s_add_u32 s53, s53, s52
    s_lshl_b32 s45, s44, 11
    s_add_u32 s53, s53, s45
    s_mul_i32 s57, s50, 131072
    s_add_u32 s57, s57, s56
    s_mul_i32 s54, s44, 8320
    s_add_u32 s55, s54, 66560
    s_mov_b32 s58, 0
    v_mov_b32 v13, v4
    s_mov_b32 s59, 66560
    s_add_u32 m0, s54, 0
    s_nop 0
    buffer_load_dwordx4 v2, s[12:15], s53 offen offset:0 sc1 lds
    s_add_u32 m0, s54, 784
    s_nop 0
    buffer_load_dwordx4 v2, s[12:15], s53 offen offset:256 sc1 lds
    s_add_u32 m0, s54, 1568
    s_nop 0
    buffer_load_dwordx4 v2, s[12:15], s53 offen offset:512 sc1 lds
    s_add_u32 m0, s54, 2352
    s_nop 0
    buffer_load_dwordx4 v2, s[12:15], s53 offen offset:768 sc1 lds
    s_add_u32 m0, s54, 3136
    s_nop 0
    buffer_load_dwordx4 v2, s[12:15], s53 offen offset:1024 sc1 lds
    s_add_u32 m0, s54, 3920
    s_nop 0
    buffer_load_dwordx4 v2, s[12:15], s53 offen offset:1280 sc1 lds
    s_add_u32 m0, s54, 4704
    s_nop 0
    buffer_load_dwordx4 v2, s[12:15], s53 offen offset:1536 sc1 lds
    s_add_u32 m0, s54, 5488
    s_nop 0
    buffer_load_dwordx4 v2, s[12:15], s53 offen offset:1792 sc1 lds
    s_add_u32 s45, s53, 32768
    s_add_u32 s46, s54, 33280
    s_add_u32 m0, s46, 0
    s_nop 0
    buffer_load_dwordx4 v2, s[12:15], s45 offen offset:0 sc1 lds
    s_add_u32 m0, s46, 784
    s_nop 0
    buffer_load_dwordx4 v2, s[12:15], s45 offen offset:256 sc1 lds
    s_add_u32 m0, s46, 1568
    s_nop 0
    buffer_load_dwordx4 v2, s[12:15], s45 offen offset:512 sc1 lds
    s_add_u32 m0, s46, 2352
    s_nop 0
    buffer_load_dwordx4 v2, s[12:15], s45 offen offset:768 sc1 lds
    s_add_u32 m0, s46, 3136
    s_nop 0
    buffer_load_dwordx4 v2, s[12:15], s45 offen offset:1024 sc1 lds
    s_add_u32 m0, s46, 3920
    s_nop 0
    buffer_load_dwordx4 v2, s[12:15], s45 offen offset:1280 sc1 lds
    s_add_u32 m0, s46, 4704
    s_nop 0
    buffer_load_dwordx4 v2, s[12:15], s45 offen offset:1536 sc1 lds
    s_add_u32 m0, s46, 5488
    s_nop 0
    buffer_load_dwordx4 v2, s[12:15], s45 offen offset:1792 sc1 lds
    s_add_u32 s45, s53, 262144
    s_cmp_gt_u32 s51, 1
    s_cselect_b32 s45, s45, 0x20000000
    s_add_u32 m0, s55, 0
    s_nop 0
    buffer_load_dwordx4 v2, s[12:15], s45 offen offset:0 sc1 lds
    s_add_u32 m0, s55, 784
    s_nop 0
    buffer_load_dwordx4 v2, s[12:15], s45 offen offset:256 sc1 lds
    s_add_u32 m0, s55, 1568
    s_nop 0
    buffer_load_dwordx4 v2, s[12:15], s45 offen offset:512 sc1 lds
    s_add_u32 m0, s55, 2352
    s_nop 0
    buffer_load_dwordx4 v2, s[12:15], s45 offen offset:768 sc1 lds
    s_add_u32 m0, s55, 3136
    s_nop 0
    buffer_load_dwordx4 v2, s[12:15], s45 offen offset:1024 sc1 lds
    s_add_u32 m0, s55, 3920
    s_nop 0
    buffer_load_dwordx4 v2, s[12:15], s45 offen offset:1280 sc1 lds
    s_add_u32 m0, s55, 4704
    s_nop 0
    buffer_load_dwordx4 v2, s[12:15], s45 offen offset:1536 sc1 lds
    s_add_u32 m0, s55, 5488
    s_nop 0
    buffer_load_dwordx4 v2, s[12:15], s45 offen offset:1792 sc1 lds
L_e_loop_144:
    s_add_u32 s45, s53, 294912
    s_add_u32 s46, s58, 1
    s_cmp_lt_u32 s46, s51
    s_cselect_b32 s48, s45, 0x20000000
    s_add_u32 s49, s55, 33280
    s_waitcnt vmcnt(16)
    s_barrier
    ds_read_b128 v[32:35], v13 offset:0
    ds_read_b128 v[36:39], v13 offset:32
    ds_read_b128 v[40:43], v13 offset:64
    ds_read_b128 v[44:47], v13 offset:96
    ds_read_b128 v[48:51], v13 offset:128
    ds_read_b128 v[52:55], v13 offset:160
    s_waitcnt lgkmcnt(4)
    v_mfma_f32_32x32x16_bf16 v[64:79], a[0:3], v[32:35], 0
    ds_read_b128 v[56:59], v13 offset:192
    v_mfma_f32_32x32x16_bf16 v[64:79], a[4:7], v[36:39], v[64:79]
    ds_read_b128 v[60:63], v13 offset:224
    s_add_u32 m0, s49, 0
    s_nop 0
    buffer_load_dwordx4 v2, s[12:15], s48 offen offset:0 sc1 lds
    s_waitcnt lgkmcnt(4)
    v_mfma_f32_32x32x16_bf16 v[64:79], a[8:11], v[40:43], v[64:79]
    ds_read_b128 v[32:35], v13 offset:256
    v_mfma_f32_32x32x16_bf16 v[64:79], a[12:15], v[44:47], v[64:79]
    ds_read_b128 v[36:39], v13 offset:288
    s_add_u32 m0, s49, 784
    s_nop 0
    buffer_load_dwordx4 v2, s[12:15], s48 offen offset:256 sc1 lds
    s_waitcnt lgkmcnt(4)
    v_mfma_f32_32x32x16_bf16 v[64:79], a[16:19], v[48:51], v[64:79]
    ds_read_b128 v[40:43], v13 offset:320
    v_mfma_f32_32x32x16_bf16 v[64:79], a[20:23], v[52:55], v[64:79]
    ds_read_b128 v[44:47], v13 offset:352
    s_add_u32 m0, s49, 1568
    s_nop 0
    buffer_load_dwordx4 v2, s[12:15], s48 offen offset:512 sc1 lds
    s_waitcnt lgkmcnt(4)
    v_mfma_f32_32x32x16_bf16 v[64:79], a[24:27], v[56:59], v[64:79]
    ds_read_b128 v[48:51], v13 offset:384
    v_mfma_f32_32x32x16_bf16 v[64:79], a[28:31], v[60:63], v[64:79]
    ds_read_b128 v[52:55], v13 offset:416
    s_add_u32 m0, s49, 2352
    s_nop 0
    buffer_load_dwordx4 v2, s[12:15], s48 offen offset:768 sc1 lds
    s_waitcnt lgkmcnt(4)
    v_mfma_f32_32x32x16_bf16 v[64:79], a[32:35], v[32:35], v[64:79]
    ds_read_b128 v[56:59], v13 offset:448
    v_mfma_f32_32x32x16_bf16 v[64:79], a[36:39], v[36:39], v[64:79]
    ds_read_b128 v[60:63], v13 offset:480
    s_add_u32 m0, s49, 3136
    s_nop 0
    buffer_load_dwordx4 v2, s[12:15], s48 offen offset:1024 sc1 lds
    s_waitcnt lgkmcnt(4)
    v_mfma_f32_32x32x16_bf16 v[64:79], a[40:43], v[40:43], v[64:79]
    ds_read_b128 v[32:35], v13 offset:512
    v_mfma_f32_32x32x16_bf16 v[64:79], a[44:47], v[44:47], v[64:79]
    ds_read_b128 v[36:39], v13 offset:544
    s_add_u32 m0, s49, 3920
    s_nop 0
    buffer_load_dwordx4 v2, s[12:15], s48 offen offset:1280 sc1 lds
    s_waitcnt lgkmcnt(4)
    v_mfma_f32_32x32x16_bf16 v[64:79], a[48:51], v[48:51], v[64:79]
    ds_read_b128 v[40:43], v13 offset:576
    v_mfma_f32_32x32x16_bf16 v[64:79], a[52:55], v[52:55], v[64:79]
    ds_read_b128 v[44:47], v13 offset:608
    s_add_u32 m0, s49, 4704
    s_nop 0
    buffer_load_dwordx4 v2, s[12:15], s48 offen offset:1536 sc1 lds
    s_waitcnt lgkmcnt(4)
    v_mfma_f32_32x32x16_bf16 v[64:79], a[56:59], v[56:59], v[64:79]
    ds_read_b128 v[48:51], v13 offset:640
    v_mfma_f32_32x32x16_bf16 v[64:79], a[60:63], v[60:63], v[64:79]
    ds_read_b128 v[52:55], v13 offset:672
    s_add_u32 m0, s49, 5488
    s_nop 0
    buffer_load_dwordx4 v2, s[12:15], s48 offen offset:1792 sc1 lds
    s_waitcnt lgkmcnt(4)
    v_mfma_f32_32x32x16_bf16 v[64:79], a[64:67], v[32:35], v[64:79]
    ds_read_b128 v[56:59], v13 offset:704
    v_mfma_f32_32x32x16_bf16 v[64:79], a[68:71], v[36:39], v[64:79]
    ds_read_b128 v[60:63], v13 offset:736
    s_waitcnt lgkmcnt(4)
    v_mfma_f32_32x32x16_bf16 v[64:79], a[72:75], v[40:43], v[64:79]
    ds_read_b128 v[32:35], v13 offset:768
    v_mfma_f32_32x32x16_bf16 v[64:79], a[76:79], v[44:47], v[64:79]
    ds_read_b128 v[36:39], v13 offset:800
    s_waitcnt lgkmcnt(4)
    v_mfma_f32_32x32x16_bf16 v[64:79], a[80:83], v[48:51], v[64:79]
    ds_read_b128 v[40:43], v13 offset:832
    v_mfma_f32_32x32x16_bf16 v[64:79], a[84:87], v[52:55], v[64:79]
    ds_read_b128 v[44:47], v13 offset:864
    s_waitcnt lgkmcnt(4)
    v_mfma_f32_32x32x16_bf16 v[64:79], a[88:91], v[56:59], v[64:79]
    ds_read_b128 v[48:51], v13 offset:896
    v_mfma_f32_32x32x16_bf16 v[64:79], a[92:95], v[60:63], v[64:79]
    ds_read_b128 v[52:55], v13 offset:928
    s_waitcnt lgkmcnt(4)
    v_mfma_f32_32x32x16_bf16 v[64:79], a[96:99], v[32:35], v[64:79]
    ds_read_b128 v[56:59], v13 offset:960
    v_mfma_f32_32x32x16_bf16 v[64:79], a[100:103], v[36:39], v[64:79]
    ds_read_b128 v[60:63], v13 offset:992
    s_waitcnt lgkmcnt(4)
    v_mfma_f32_32x32x16_bf16 v[64:79], a[104:107], v[40:43], v[64:79]
    v_mfma_f32_32x32x16_bf16 v[64:79], a[108:111], v[44:47], v[64:79]
    s_waitcnt lgkmcnt(2)
    v_mfma_f32_32x32x16_bf16 v[64:79], a[112:115], v[48:51], v[64:79]
    v_mfma_f32_32x32x16_bf16 v[64:79], a[116:119], v[52:55], v[64:79]
    s_waitcnt lgkmcnt(0)
    v_mfma_f32_32x32x16_bf16 v[64:79], a[120:123], v[56:59], v[64:79]
    v_mfma_f32_32x32x16_bf16 v[64:79], a[124:127], v[60:63], v[64:79]
    s_add_u32 s45, s53, 524288
    s_add_u32 s46, s58, 2
    s_cmp_lt_u32 s46, s51
    s_cselect_b32 s48, s45, 0x20000000
    s_mov_b32 s49, s54
    s_waitcnt vmcnt(16)
    s_barrier
    ds_read_b128 v[32:35], v13 offset:33280
    ds_read_b128 v[36:39], v13 offset:33312
    ds_read_b128 v[40:43], v13 offset:33344
    ds_read_b128 v[44:47], v13 offset:33376
    ds_read_b128 v[48:51], v13 offset:33408
    ds_read_b128 v[52:55], v13 offset:33440
    s_waitcnt lgkmcnt(4)
    v_mfma_f32_32x32x16_bf16 v[64:79], a[128:131], v[32:35], v[64:79]
    ds_read_b128 v[56:59], v13 offset:33472
    v_mfma_f32_32x32x16_bf16 v[64:79], a[132:135], v[36:39], v[64:79]
    ds_read_b128 v[60:63], v13 offset:33504
    s_add_u32 m0, s49, 0
    s_nop 0
    buffer_load_dwordx4 v2, s[12:15], s48 offen offset:0 sc1 lds
    s_waitcnt lgkmcnt(4)
    v_mfma_f32_32x32x16_bf16 v[64:79], a[136:139], v[40:43], v[64:79]
    ds_read_b128 v[32:35], v13 offset:33536
    v_mfma_f32_32x32x16_bf16 v[64:79], a[140:143], v[44:47], v[64:79]
    ds_read_b128 v[36:39], v13 offset:33568
    s_add_u32 m0, s49, 784
    s_nop 0
    buffer_load_dwordx4 v2, s[12:15], s48 offen offset:256 sc1 lds
    s_waitcnt lgkmcnt(4)
    v_mfma_f32_32x32x16_bf16 v[64:79], a[144:147], v[48:51], v[64:79]
    ds_read_b128 v[40:43], v13 offset:33600
    v_mfma_f32_32x32x16_bf16 v[64:79], a[148:151], v[52:55], v[64:79]
    ds_read_b128 v[44:47], v13 offset:33632
    s_add_u32 m0, s49, 1568
    s_nop 0
    buffer_load_dwordx4 v2, s[12:15], s48 offen offset:512 sc1 lds
    s_waitcnt lgkmcnt(4)
    v_mfma_f32_32x32x16_bf16 v[64:79], a[152:155], v[56:59], v[64:79]
    ds_read_b128 v[48:51], v13 offset:33664
    v_mfma_f32_32x32x16_bf16 v[64:79], a[156:159], v[60:63], v[64:79]
    ds_read_b128 v[52:55], v13 offset:33696
    s_add_u32 m0, s49, 2352
    s_nop 0
    buffer_load_dwordx4 v2, s[12:15], s48 offen offset:768 sc1 lds
    s_waitcnt lgkmcnt(4)
    v_mfma_f32_32x32x16_bf16 v[64:79], a[160:163], v[32:35], v[64:79]
    ds_read_b128 v[56:59], v13 offset:33728
    v_mfma_f32_32x32x16_bf16 v[64:79], a[164:167], v[36:39], v[64:79]
    ds_read_b128 v[60:63], v13 offset:33760
    s_add_u32 m0, s49, 3136
    s_nop 0
    buffer_load_dwordx4 v2, s[12:15], s48 offen offset:1024 sc1 lds
    s_waitcnt lgkmcnt(4)
    v_mfma_f32_32x32x16_bf16 v[64:79], a[168:171], v[40:43], v[64:79]
    ds_read_b128 v[32:35], v13 offset:33792
    v_mfma_f32_32x32x16_bf16 v[64:79], a[172:175], v[44:47], v[64:79]
    ds_read_b128 v[36:39], v13 offset:33824
    s_add_u32 m0, s49, 3920
    s_nop 0
    buffer_load_dwordx4 v2, s[12:15], s48 offen offset:1280 sc1 lds
    s_waitcnt lgkmcnt(4)
    v_mfma_f32_32x32x16_bf16 v[64:79], a[176:179], v[48:51], v[64:79]
    ds_read_b128 v[40:43], v13 offset:33856
    v_mfma_f32_32x32x16_bf16 v[64:79], a[180:183], v[52:55], v[64:79]
    ds_read_b128 v[44:47], v13 offset:33888
    s_add_u32 m0, s49, 4704
    s_nop 0
    buffer_load_dwordx4 v2, s[12:15], s48 offen offset:1536 sc1 lds
    s_waitcnt lgkmcnt(4)
    v_mfma_f32_32x32x16_bf16 v[64:79], a[184:187], v[56:59], v[64:79]
    ds_read_b128 v[48:51], v13 offset:33920
    v_mfma_f32_32x32x16_bf16 v[64:79], a[188:191], v[60:63], v[64:79]
    ds_read_b128 v[52:55], v13 offset:33952
    s_add_u32 m0, s49, 5488
    s_nop 0
    buffer_load_dwordx4 v2, s[12:15], s48 offen offset:1792 sc1 lds
    s_waitcnt lgkmcnt(4)
    v_mfma_f32_32x32x16_bf16 v[64:79], a[192:195], v[32:35], v[64:79]
    ds_read_b128 v[56:59], v13 offset:33984
    v_mfma_f32_32x32x16_bf16 v[64:79], a[196:199], v[36:39], v[64:79]
    ds_read_b128 v[60:63], v13 offset:34016
    s_waitcnt lgkmcnt(4)
    v_mfma_f32_32x32x16_bf16 v[64:79], a[200:203], v[40:43], v[64:79]
    ds_read_b128 v[32:35], v13 offset:34048
    v_mfma_f32_32x32x16_bf16 v[64:79], a[204:207], v[44:47], v[64:79]
    ds_read_b128 v[36:39], v13 offset:34080
    s_waitcnt lgkmcnt(4)
    v_mfma_f32_32x32x16_bf16 v[64:79], a[208:211], v[48:51], v[64:79]
    ds_read_b128 v[40:43], v13 offset:34112
    v_mfma_f32_32x32x16_bf16 v[64:79], a[212:215], v[52:55], v[64:79]
    ds_read_b128 v[44:47], v13 offset:34144
    s_waitcnt lgkmcnt(4)
    v_mfma_f32_32x32x16_bf16 v[64:79], a[216:219], v[56:59], v[64:79]
    ds_read_b128 v[48:51], v13 offset:34176
    v_mfma_f32_32x32x16_bf16 v[64:79], a[220:223], v[60:63], v[64:79]
    ds_read_b128 v[52:55], v13 offset:34208
    s_waitcnt lgkmcnt(4)
    v_mfma_f32_32x32x16_bf16 v[64:79], a[224:227], v[32:35], v[64:79]
    ds_read_b128 v[56:59], v13 offset:34240
    v_mfma_f32_32x32x16_bf16 v[64:79], a[228:231], v[36:39], v[64:79]
    ds_read_b128 v[60:63], v13 offset:34272
    s_waitcnt lgkmcnt(4)
    v_mfma_f32_32x32x16_bf16 v[64:79], a[232:235], v[40:43], v[64:79]
    v_mfma_f32_32x32x16_bf16 v[64:79], a[236:239], v[44:47], v[64:79]
    s_waitcnt lgkmcnt(2)
    v_mfma_f32_32x32x16_bf16 v[64:79], a[240:243], v[48:51], v[64:79]
    v_mfma_f32_32x32x16_bf16 v[64:79], a[244:247], v[52:55], v[64:79]
    s_waitcnt lgkmcnt(0)
    v_mfma_f32_32x32x16_bf16 v[64:79], a[248:251], v[56:59], v[64:79]
    v_mfma_f32_32x32x16_bf16 v[64:79], a[252:255], v[60:63], v[64:79]
    s_add_u32 s53, s53, 262144
    s_add_u32 s58, s58, 1
    v_add_u32 v13, s59, v13
    s_add_u32 s54, s54, s59
    s_sub_u32 s55, s55, s59
    s_sub_u32 s59, 0, s59
    s_lshl_b32 s45, s44, 15
    s_add_u32 s45, s45, s57
    s_add_u32 s57, s57, 131072
    s_nop 3
    ds_write_b128 v7, v[64:67] offset:0
    ds_write_b128 v7, v[68:71] offset:16
    ds_write_b128 v7, v[72:75] offset:32
    ds_write_b128 v7, v[76:79] offset:48
    s_waitcnt lgkmcnt(0)
    s_barrier
    ds_read_b128 v[80:83], v9 offset:0
    ds_read_b128 v[84:87], v9 offset:1056
    ds_read_b128 v[88:91], v9 offset:2112
    ds_read_b128 v[92:95], v9 offset:3168
    s_waitcnt lgkmcnt(3)
    buffer_store_dwordx4 v[80:83], v11, s[12:15], s45 offen sc1
    s_add_u32 s45, s45, 8192
    s_waitcnt lgkmcnt(2)
    buffer_store_dwordx4 v[84:87], v11, s[12:15], s45 offen sc1
    s_add_u32 s45, s45, 8192
    s_waitcnt lgkmcnt(1)
    buffer_store_dwordx4 v[88:91], v11, s[12:15], s45 offen sc1
    s_add_u32 s45, s45, 8192
    s_waitcnt lgkmcnt(0)
    buffer_store_dwordx4 v[92:95], v11, s[12:15], s45 offen sc1
    s_cmp_lt_u32 s58, s51
    s_cbranch_scc1 L_e_loop_144
    s_waitcnt vmcnt(0)
    s_barrier
    s_cmp_lg_u32 s44, 0
    s_cbranch_scc1 L_pub_145
    v_mov_b32 v30, s62
    v_mov_b32 v31, 0
    s_mov_b64 exec, 1
    buffer_store_dword v30, v31, s[12:15], s67 offen sc1
    s_mov_b64 exec, -1
L_pub_145:
    s_branch L_a_loop_133
L_role_b_129:
    s_load_dwordx2 s[6:7], s[0:1], 64
    s_load_dwordx2 s[8:9], s[0:1], 72
    s_waitcnt lgkmcnt(0)
    s_mov_b32 s24, s6
    s_and_b32 s25, s7, 0xffff
    s_mov_b32 s26, 0x700000
    s_mov_b32 s27, 0x00020000
    s_mov_b32 s32, s8
    s_and_b32 s33, s9, 0xffff
    s_mov_b32 s34, 0x1c00
    s_mov_b32 s35, 0x00020000
    s_min_u32 s45, s41, 27
    s_lshl_b32 s46, s45, 8
    s_waitcnt vmcnt(0)
    s_barrier
    v_lshrrev_b32 v20, 4, v1
    s_lshl_b32 s45, s44, 2
    v_add_u32 v21, s45, v20
    s_mov_b32 s45, 7168
    v_mul_lo_u32 v21, v21, s45
    v_lshlrev_b32 v22, 2, v20
    v_and_b32 v23, 15, v1
    v_xor_b32 v22, v22, v23
    v_lshlrev_b32 v22, 4, v22
    v_add_u32 v21, v21, v22
    v_bfe_u32 v22, v1, 2, 2
    v_lshrrev_b32 v23, 5, v1
    v_lshlrev_b32 v23, 3, v23
    v_add_u32 v23, v23, v22
    v_lshlrev_b32 v23, 8, v23
    v_xor_b32 v22, s44, v22
    v_lshlrev_b32 v22, 6, v22
    v_add_u32 v23, v23, v22
    v_and_b32 v22, 1, v1
    v_lshlrev_b32 v22, 5, v22
    v_add_u32 v23, v23, v22
    v_and_b32 v22, 16, v1
    v_add_u32 v23, v23, v22
    v_and_b32 v22, 2, v1
    v_lshlrev_b32 v22, 2, v22
    v_add_u32 v23, v23, v22
    v_add_u32 v24, 65536, v23
    v_add_u32 v25, 131072, v23
    s_lshl_b32 s47, s44, 10
    s_add_u32 s45, s46, 0x0
    s_add_u32 m0, s47, 0
    s_nop 0
    buffer_load_dwordx4 v21, s[24:27], s45 offen nt lds
    s_add_u32 s45, s46, 0x1c000
    s_add_u32 m0, s47, 4096
    s_nop 0
    buffer_load_dwordx4 v21, s[24:27], s45 offen nt lds
    s_add_u32 s45, s46, 0x38000
    s_add_u32 m0, s47, 8192
    s_nop 0
    buffer_load_dwordx4 v21, s[24:27], s45 offen nt lds
    s_add_u32 s45, s46, 0x54000
    s_add_u32 m0, s47, 12288
    s_nop 0
    buffer_load_dwordx4 v21, s[24:27], s45 offen nt lds
    s_add_u32 s45, s46, 0x70000
    s_add_u32 m0, s47, 16384
    s_nop 0
    buffer_load_dwordx4 v21, s[24:27], s45 offen nt lds
    s_add_u32 s45, s46, 0x8c000
    s_add_u32 m0, s47, 20480
    s_nop 0
    buffer_load_dwordx4 v21, s[24:27], s45 offen nt lds
    s_add_u32 s45, s46, 0xa8000
    s_add_u32 m0, s47, 24576
    s_nop 0
    buffer_load_dwordx4 v21, s[24:27], s45 offen nt lds
    s_add_u32 s45, s46, 0xc4000
    s_add_u32 m0, s47, 28672
    s_nop 0
    buffer_load_dwordx4 v21, s[24:27], s45 offen nt lds
    s_add_u32 s45, s46, 0xe0000
    s_add_u32 m0, s47, 32768
    s_nop 0
    buffer_load_dwordx4 v21, s[24:27], s45 offen nt lds
    s_add_u32 s45, s46, 0xfc000
    s_add_u32 m0, s47, 36864
    s_nop 0
    buffer_load_dwordx4 v21, s[24:27], s45 offen nt lds
    s_add_u32 s45, s46, 0x118000
    s_add_u32 m0, s47, 40960
    s_nop 0
    buffer_load_dwordx4 v21, s[24:27], s45 offen nt lds
    s_add_u32 s45, s46, 0x134000
    s_add_u32 m0, s47, 45056
    s_nop 0
    buffer_load_dwordx4 v21, s[24:27], s45 offen nt lds
    s_add_u32 s45, s46, 0x150000
    s_add_u32 m0, s47, 49152
    s_nop 0
    buffer_load_dwordx4 v21, s[24:27], s45 offen nt lds
    s_add_u32 s45, s46, 0x16c000
    s_add_u32 m0, s47, 53248
    s_nop 0
    buffer_load_dwordx4 v21, s[24:27], s45 offen nt lds
    s_add_u32 s45, s46, 0x188000
    s_add_u32 m0, s47, 57344
    s_nop 0
    buffer_load_dwordx4 v21, s[24:27], s45 offen nt lds
    s_add_u32 s45, s46, 0x1a4000
    s_add_u32 m0, s47, 61440
    s_nop 0
    buffer_load_dwordx4 v21, s[24:27], s45 offen nt lds
    s_add_u32 s45, s46, 0x1c0000
    s_add_u32 m0, s47, 65536
    s_nop 0
    buffer_load_dwordx4 v21, s[24:27], s45 offen nt lds
    s_add_u32 s45, s46, 0x1dc000
    s_add_u32 m0, s47, 69632
    s_nop 0
    buffer_load_dwordx4 v21, s[24:27], s45 offen nt lds
    s_add_u32 s45, s46, 0x1f8000
    s_add_u32 m0, s47, 73728
    s_nop 0
    buffer_load_dwordx4 v21, s[24:27], s45 offen nt lds
    s_add_u32 s45, s46, 0x214000
    s_add_u32 m0, s47, 77824
    s_nop 0
    buffer_load_dwordx4 v21, s[24:27], s45 offen nt lds
    s_add_u32 s45, s46, 0x230000
    s_add_u32 m0, s47, 81920
    s_nop 0
    buffer_load_dwordx4 v21, s[24:27], s45 offen nt lds
    s_add_u32 s45, s46, 0x24c000
    s_add_u32 m0, s47, 86016
    s_nop 0
    buffer_load_dwordx4 v21, s[24:27], s45 offen nt lds
    s_add_u32 s45, s46, 0x268000
    s_add_u32 m0, s47, 90112
    s_nop 0
    buffer_load_dwordx4 v21, s[24:27], s45 offen nt lds
    s_add_u32 s45, s46, 0x284000
    s_add_u32 m0, s47, 94208
    s_nop 0
    buffer_load_dwordx4 v21, s[24:27], s45 offen nt lds
    s_add_u32 s45, s46, 0x2a0000
    s_add_u32 m0, s47, 98304
    s_nop 0
    buffer_load_dwordx4 v21, s[24:27], s45 offen nt lds
    s_add_u32 s45, s46, 0x2bc000
    s_add_u32 m0, s47, 102400
    s_nop 0
    buffer_load_dwordx4 v21, s[24:27], s45 offen nt lds
    s_add_u32 s45, s46, 0x2d8000
    s_add_u32 m0, s47, 106496
    s_nop 0
    buffer_load_dwordx4 v21, s[24:27], s45 offen nt lds
    s_add_u32 s45, s46, 0x2f4000
    s_add_u32 m0, s47, 110592
    s_nop 0
    buffer_load_dwordx4 v21, s[24:27], s45 offen nt lds
    s_add_u32 s45, s46, 0x310000
    s_add_u32 m0, s47, 114688
    s_nop 0
    buffer_load_dwordx4 v21, s[24:27], s45 offen nt lds
    s_add_u32 s45, s46, 0x32c000
    s_add_u32 m0, s47, 118784
    s_nop 0
    buffer_load_dwordx4 v21, s[24:27], s45 offen nt lds
    s_add_u32 s45, s46, 0x348000
    s_add_u32 m0, s47, 122880
    s_nop 0
    buffer_load_dwordx4 v21, s[24:27], s45 offen nt lds
    s_add_u32 s45, s46, 0x364000
    s_add_u32 m0, s47, 126976
    s_nop 0
    buffer_load_dwordx4 v21, s[24:27], s45 offen nt lds
    s_waitcnt vmcnt(28)
    s_barrier
    s_add_u32 s45, s46, 0x380000
    s_add_u32 m0, s47, 131072
    s_nop 0
    buffer_load_dwordx4 v21, s[24:27], s45 offen nt lds
    s_add_u32 s45, s46, 0x39c000
    s_add_u32 m0, s47, 135168
    s_nop 0
    buffer_load_dwordx4 v21, s[24:27], s45 offen nt lds
    s_add_u32 s45, s46, 0x3b8000
    s_add_u32 m0, s47, 139264
    s_nop 0
    buffer_load_dwordx4 v21, s[24:27], s45 offen nt lds
    s_add_u32 s45, s46, 0x3d4000
    s_add_u32 m0, s47, 143360
    s_nop 0
    buffer_load_dwordx4 v21, s[24:27], s45 offen nt lds
    ds_read_b64_tr_b16 a[0:1], v23 offset:0
    ds_read_b64_tr_b16 a[2:3], v23 offset:1024
    ds_read_b64_tr_b16 a[4:5], v23 offset:4096
    ds_read_b64_tr_b16 a[6:7], v23 offset:5120
    ds_read_b64_tr_b16 a[8:9], v23 offset:8192
    ds_read_b64_tr_b16 a[10:11], v23 offset:9216
    ds_read_b64_tr_b16 a[12:13], v23 offset:12288
    ds_read_b64_tr_b16 a[14:15], v23 offset:13312
    s_waitcnt lgkmcnt(0)
    s_waitcnt vmcnt(28)
    s_barrier
    s_add_u32 s45, s46, 0x3f0000
    s_add_u32 m0, s47, 0
    s_nop 0
    buffer_load_dwordx4 v21, s[24:27], s45 offen nt lds
    s_add_u32 s45, s46, 0x40c000
    s_add_u32 m0, s47, 4096
    s_nop 0
    buffer_load_dwordx4 v21, s[24:27], s45 offen nt lds
    s_add_u32 s45, s46, 0x428000
    s_add_u32 m0, s47, 8192
    s_nop 0
    buffer_load_dwordx4 v21, s[24:27], s45 offen nt lds
    s_add_u32 s45, s46, 0x444000
    s_add_u32 m0, s47, 12288
    s_nop 0
    buffer_load_dwordx4 v21, s[24:27], s45 offen nt lds
    ds_read_b64_tr_b16 a[16:17], v23 offset:16384
    ds_read_b64_tr_b16 a[18:19], v23 offset:17408
    ds_read_b64_tr_b16 a[20:21], v23 offset:20480
    ds_read_b64_tr_b16 a[22:23], v23 offset:21504
    ds_read_b64_tr_b16 a[24:25], v23 offset:24576
    ds_read_b64_tr_b16 a[26:27], v23 offset:25600
    ds_read_b64_tr_b16 a[28:29], v23 offset:28672
    ds_read_b64_tr_b16 a[30:31], v23 offset:29696
    s_waitcnt lgkmcnt(0)
    s_waitcnt vmcnt(28)
    s_barrier
    s_add_u32 s45, s46, 0x460000
    s_add_u32 m0, s47, 16384
    s_nop 0
    buffer_load_dwordx4 v21, s[24:27], s45 offen nt lds
    s_add_u32 s45, s46, 0x47c000
    s_add_u32 m0, s47, 20480
    s_nop 0
    buffer_load_dwordx4 v21, s[24:27], s45 offen nt lds
    s_add_u32 s45, s46, 0x498000
    s_add_u32 m0, s47, 24576
    s_nop 0
    buffer_load_dwordx4 v21, s[24:27], s45 offen nt lds
    s_add_u32 s45, s46, 0x4b4000
    s_add_u32 m0, s47, 28672
    s_nop 0
    buffer_load_dwordx4 v21, s[24:27], s45 offen nt lds
    ds_read_b64_tr_b16 a[32:33], v23 offset:32768
    ds_read_b64_tr_b16 a[34:35], v23 offset:33792
    ds_read_b64_tr_b16 a[36:37], v23 offset:36864
    ds_read_b64_tr_b16 a[38:39], v23 offset:37888
    ds_read_b64_tr_b16 a[40:41], v23 offset:40960
    ds_read_b64_tr_b16 a[42:43], v23 offset:41984
    ds_read_b64_tr_b16 a[44:45], v23 offset:45056
    ds_read_b64_tr_b16 a[46:47], v23 offset:46080
    s_waitcnt lgkmcnt(0)
    s_waitcnt vmcnt(28)
    s_barrier
    s_add_u32 s45, s46, 0x4d0000
    s_add_u32 m0, s47, 32768
    s_nop 0
    buffer_load_dwordx4 v21, s[24:27], s45 offen nt lds
    s_add_u32 s45, s46, 0x4ec000
    s_add_u32 m0, s47, 36864
    s_nop 0
    buffer_load_dwordx4 v21, s[24:27], s45 offen nt lds
    s_add_u32 s45, s46, 0x508000
    s_add_u32 m0, s47, 40960
    s_nop 0
    buffer_load_dwordx4 v21, s[24:27], s45 offen nt lds
    s_add_u32 s45, s46, 0x524000
    s_add_u32 m0, s47, 45056
    s_nop 0
    buffer_load_dwordx4 v21, s[24:27], s45 offen nt lds
    ds_read_b64_tr_b16 a[48:49], v23 offset:49152
    ds_read_b64_tr_b16 a[50:51], v23 offset:50176
    ds_read_b64_tr_b16 a[52:53], v23 offset:53248
    ds_read_b64_tr_b16 a[54:55], v23 offset:54272
    ds_read_b64_tr_b16 a[56:57], v23 offset:57344
    ds_read_b64_tr_b16 a[58:59], v23 offset:58368
    ds_read_b64_tr_b16 a[60:61], v23 offset:61440
    ds_read_b64_tr_b16 a[62:63], v23 offset:62464
    s_waitcnt lgkmcnt(0)
    s_waitcnt vmcnt(28)
    s_barrier
    s_add_u32 s45, s46, 0x540000
    s_add_u32 m0, s47, 49152
    s_nop 0
    buffer_load_dwordx4 v21, s[24:27], s45 offen nt lds
    s_add_u32 s45, s46, 0x55c000
    s_add_u32 m0, s47, 53248
    s_nop 0
    buffer_load_dwordx4 v21, s[24:27], s45 offen nt lds
    s_add_u32 s45, s46, 0x578000
    s_add_u32 m0, s47, 57344
    s_nop 0
    buffer_load_dwordx4 v21, s[24:27], s45 offen nt lds
    s_add_u32 s45, s46, 0x594000
    s_add_u32 m0, s47, 61440
    s_nop 0
    buffer_load_dwordx4 v21, s[24:27], s45 offen nt lds
    ds_read_b64_tr_b16 a[64:65], v24 offset:0
    ds_read_b64_tr_b16 a[66:67], v24 offset:1024
    ds_read_b64_tr_b16 a[68:69], v24 offset:4096
    ds_read_b64_tr_b16 a[70:71], v24 offset:5120
    ds_read_b64_tr_b16 a[72:73], v24 offset:8192
    ds_read_b64_tr_b16 a[74:75], v24 offset:9216
    ds_read_b64_tr_b16 a[76:77], v24 offset:12288
    ds_read_b64_tr_b16 a[78:79], v24 offset:13312
    s_waitcnt lgkmcnt(0)
    s_waitcnt vmcnt(28)
    s_barrier
    s_add_u32 s45, s46, 0x5b0000
    s_add_u32 m0, s47, 65536
    s_nop 0
    buffer_load_dwordx4 v21, s[24:27], s45 offen nt lds
    s_add_u32 s45, s46, 0x5cc000
    s_add_u32 m0, s47, 69632
    s_nop 0
    buffer_load_dwordx4 v21, s[24:27], s45 offen nt lds
    s_add_u32 s45, s46, 0x5e8000
    s_add_u32 m0, s47, 73728
    s_nop 0
    buffer_load_dwordx4 v21, s[24:27], s45 offen nt lds
    s_add_u32 s45, s46, 0x604000
    s_add_u32 m0, s47, 77824
    s_nop 0
    buffer_load_dwordx4 v21, s[24:27], s45 offen nt lds
    ds_read_b64_tr_b16 a[80:81], v24 offset:16384
    ds_read_b64_tr_b16 a[82:83], v24 offset:17408
    ds_read_b64_tr_b16 a[84:85], v24 offset:20480
    ds_read_b64_tr_b16 a[86:87], v24 offset:21504
    ds_read_b64_tr_b16 a[88:89], v24 offset:24576
    ds_read_b64_tr_b16 a[90:91], v24 offset:25600
    ds_read_b64_tr_b16 a[92:93], v24 offset:28672
    ds_read_b64_tr_b16 a[94:95], v24 offset:29696
    s_waitcnt lgkmcnt(0)
    s_waitcnt vmcnt(28)
    s_barrier
    s_add_u32 s45, s46, 0x620000
    s_add_u32 m0, s47, 81920
    s_nop 0
    buffer_load_dwordx4 v21, s[24:27], s45 offen nt lds
    s_add_u32 s45, s46, 0x63c000
    s_add_u32 m0, s47, 86016
    s_nop 0
    buffer_load_dwordx4 v21, s[24:27], s45 offen nt lds
    s_add_u32 s45, s46, 0x658000
    s_add_u32 m0, s47, 90112
    s_nop 0
    buffer_load_dwordx4 v21, s[24:27], s45 offen nt lds
    s_add_u32 s45, s46, 0x674000
    s_add_u32 m0, s47, 94208
    s_nop 0
    buffer_load_dwordx4 v21, s[24:27], s45 offen nt lds
    ds_read_b64_tr_b16 a[96:97], v24 offset:32768
    ds_read_b64_tr_b16 a[98:99], v24 offset:33792
    ds_read_b64_tr_b16 a[100:101], v24 offset:36864
    ds_read_b64_tr_b16 a[102:103], v24 offset:37888
    ds_read_b64_tr_b16 a[104:105], v24 offset:40960
    ds_read_b64_tr_b16 a[106:107], v24 offset:41984
    ds_read_b64_tr_b16 a[108:109], v24 offset:45056
    ds_read_b64_tr_b16 a[110:111], v24 offset:46080
    s_waitcnt lgkmcnt(0)
    s_waitcnt vmcnt(28)
    s_barrier
    s_add_u32 s45, s46, 0x690000
    s_add_u32 m0, s47, 98304
    s_nop 0
    buffer_load_dwordx4 v21, s[24:27], s45 offen nt lds
    s_add_u32 s45, s46, 0x6ac000
    s_add_u32 m0, s47, 102400
    s_nop 0
    buffer_load_dwordx4 v21, s[24:27], s45 offen nt lds
    s_add_u32 s45, s46, 0x6c8000
    s_add_u32 m0, s47, 106496
    s_nop 0
    buffer_load_dwordx4 v21, s[24:27], s45 offen nt lds
    s_add_u32 s45, s46, 0x6e4000
    s_add_u32 m0, s47, 110592
    s_nop 0
    buffer_load_dwordx4 v21, s[24:27], s45 offen nt lds
    ds_read_b64_tr_b16 a[112:113], v24 offset:49152
    ds_read_b64_tr_b16 a[114:115], v24 offset:50176
    ds_read_b64_tr_b16 a[116:117], v24 offset:53248
    ds_read_b64_tr_b16 a[118:119], v24 offset:54272
    ds_read_b64_tr_b16 a[120:121], v24 offset:57344
    ds_read_b64_tr_b16 a[122:123], v24 offset:58368
    ds_read_b64_tr_b16 a[124:125], v24 offset:61440
    ds_read_b64_tr_b16 a[126:127], v24 offset:62464
    s_waitcnt lgkmcnt(0)
    s_waitcnt vmcnt(28)
    s_barrier
    ds_read_b64_tr_b16 a[128:129], v25 offset:0
    ds_read_b64_tr_b16 a[130:131], v25 offset:1024
    ds_read_b64_tr_b16 a[132:133], v25 offset:4096
    ds_read_b64_tr_b16 a[134:135], v25 offset:5120
    ds_read_b64_tr_b16 a[136:137], v25 offset:8192
    ds_read_b64_tr_b16 a[138:139], v25 offset:9216
    ds_read_b64_tr_b16 a[140:141], v25 offset:12288
    ds_read_b64_tr_b16 a[142:143], v25 offset:13312
    s_waitcnt lgkmcnt(0)
    s_waitcnt vmcnt(24)
    s_barrier
    ds_read_b64_tr_b16 a[144:145], v23 offset:0
    ds_read_b64_tr_b16 a[146:147], v23 offset:1024
    ds_read_b64_tr_b16 a[148:149], v23 offset:4096
    ds_read_b64_tr_b16 a[150:151], v23 offset:5120
    ds_read_b64_tr_b16 a[152:153], v23 offset:8192
    ds_read_b64_tr_b16 a[154:155], v23 offset:9216
    ds_read_b64_tr_b16 a[156:157], v23 offset:12288
    ds_read_b64_tr_b16 a[158:159], v23 offset:13312
    s_waitcnt lgkmcnt(0)
    s_waitcnt vmcnt(20)
    s_barrier
    ds_read_b64_tr_b16 a[160:161], v23 offset:16384
    ds_read_b64_tr_b16 a[162:163], v23 offset:17408
    ds_read_b64_tr_b16 a[164:165], v23 offset:20480
    ds_read_b64_tr_b16 a[166:167], v23 offset:21504
    ds_read_b64_tr_b16 a[168:169], v23 offset:24576
    ds_read_b64_tr_b16 a[170:171], v23 offset:25600
    ds_read_b64_tr_b16 a[172:173], v23 offset:28672
    ds_read_b64_tr_b16 a[174:175], v23 offset:29696
    s_waitcnt lgkmcnt(0)
    s_waitcnt vmcnt(16)
    s_barrier
    ds_read_b64_tr_b16 a[176:177], v23 offset:32768
    ds_read_b64_tr_b16 a[178:179], v23 offset:33792
    ds_read_b64_tr_b16 a[180:181], v23 offset:36864
    ds_read_b64_tr_b16 a[182:183], v23 offset:37888
    ds_read_b64_tr_b16 a[184:185], v23 offset:40960
    ds_read_b64_tr_b16 a[186:187], v23 offset:41984
    ds_read_b64_tr_b16 a[188:189], v23 offset:45056
    ds_read_b64_tr_b16 a[190:191], v23 offset:46080
    s_waitcnt lgkmcnt(0)
    s_waitcnt vmcnt(12)
    s_barrier
    ds_read_b64_tr_b16 a[192:193], v23 offset:49152
    ds_read_b64_tr_b16 a[194:195], v23 offset:50176
    ds_read_b64_tr_b16 a[196:197], v23 offset:53248
    ds_read_b64_tr_b16 a[198:199], v23 offset:54272
    ds_read_b64_tr_b16 a[200:201], v23 offset:57344
    ds_read_b64_tr_b16 a[202:203], v23 offset:58368
    ds_read_b64_tr_b16 a[204:205], v23 offset:61440
    ds_read_b64_tr_b16 a[206:207], v23 offset:62464
    s_waitcnt lgkmcnt(0)
    s_waitcnt vmcnt(8)
    s_barrier
    ds_read_b64_tr_b16 a[208:209], v24 offset:0
    ds_read_b64_tr_b16 a[210:211], v24 offset:1024
    ds_read_b64_tr_b16 a[212:213], v24 offset:4096
    ds_read_b64_tr_b16 a[214:215], v24 offset:5120
    ds_read_b64_tr_b16 a[216:217], v24 offset:8192
    ds_read_b64_tr_b16 a[218:219], v24 offset:9216
    ds_read_b64_tr_b16 a[220:221], v24 offset:12288
    ds_read_b64_tr_b16 a[222:223], v24 offset:13312
    s_waitcnt lgkmcnt(0)
    s_waitcnt vmcnt(4)
    s_barrier
    ds_read_b64_tr_b16 a[224:225], v24 offset:16384
    ds_read_b64_tr_b16 a[226:227], v24 offset:17408
    ds_read_b64_tr_b16 a[228:229], v24 offset:20480
    ds_read_b64_tr_b16 a[230:231], v24 offset:21504
    ds_read_b64_tr_b16 a[232:233], v24 offset:24576
    ds_read_b64_tr_b16 a[234:235], v24 offset:25600
    ds_read_b64_tr_b16 a[236:237], v24 offset:28672
    ds_read_b64_tr_b16 a[238:239], v24 offset:29696
    s_waitcnt lgkmcnt(0)
    s_waitcnt vmcnt(0)
    s_barrier
    ds_read_b64_tr_b16 a[240:241], v24 offset:32768
    ds_read_b64_tr_b16 a[242:243], v24 offset:33792
    ds_read_b64_tr_b16 a[244:245], v24 offset:36864
    ds_read_b64_tr_b16 a[246:247], v24 offset:37888
    ds_read_b64_tr_b16 a[248:249], v24 offset:40960
    ds_read_b64_tr_b16 a[250:251], v24 offset:41984
    ds_read_b64_tr_b16 a[252:253], v24 offset:45056
    ds_read_b64_tr_b16 a[254:255], v24 offset:46080
    s_waitcnt lgkmcnt(0)
    s_barrier
    s_min_u32 s45, s41, 27
    s_lshl_b32 s45, s45, 8
    s_lshl_b32 s46, s44, 6
    s_add_u32 s45, s45, s46
    v_lshrrev_b32 v29, 5, v1
    v_lshlrev_b32 v29, 5, v29
    buffer_load_dwordx4 v[80:83], v29, s[32:35], s45 offen
    buffer_load_dwordx4 v[84:87], v29, s[32:35], s45 offen offset:16
    s_waitcnt vmcnt(0)
    v_lshlrev_b32 v96, 16, v80
    v_and_b32 v97, 0xffff0000, v80
    v_lshlrev_b32 v98, 16, v81
    v_and_b32 v99, 0xffff0000, v81
    v_lshlrev_b32 v100, 16, v82
    v_and_b32 v101, 0xffff0000, v82
    v_lshlrev_b32 v102, 16, v83
    v_and_b32 v103, 0xffff0000, v83
    v_lshlrev_b32 v104, 16, v84
    v_and_b32 v105, 0xffff0000, v84
    v_lshlrev_b32 v106, 16, v85
    v_and_b32 v107, 0xffff0000, v85
    v_lshlrev_b32 v108, 16, v86
    v_and_b32 v109, 0xffff0000, v86
    v_lshlrev_b32 v110, 16, v87
    v_and_b32 v111, 0xffff0000, v87
    s_cmp_lg_u32 s44, 0
    s_cbranch_scc1 L_pd_146
    v_mov_b32 v29, 132
    s_mov_b32 s46, 96
    s_mov_b64 exec, 1
    s_mov_b32 s70, 0
L_wp_147:
    buffer_load_dword v31, v29, s[16:19], 0 offen sc1
    s_add_u32 s70, s70, 1
    s_cmp_ge_u32 s70, 0x200000
    s_cbranch_scc1 L_w_done_108
    s_waitcnt vmcnt(0)
    v_cmp_gt_u32 vcc, s46, v31
    s_nop 1
    s_cbranch_vccz L_wp_147_ok
    s_sleep 3
    s_branch L_wp_147
L_wp_147_ok:
    s_mov_b64 exec, -1
L_pd_146:
    s_barrier
    v_lshlrev_b32 v29, 5, v1
    s_mov_b32 s45, 8192
    buffer_load_dwordx4 v[112:115], v29, s[12:15], s45 offen offset:0 sc1
    buffer_load_dwordx4 v[116:119], v29, s[12:15], s45 offen offset:16 sc1
    buffer_load_dwordx4 v[120:123], v29, s[12:15], s45 offen offset:2048 sc1
    buffer_load_dwordx4 v[124:127], v29, s[12:15], s45 offen offset:2064 sc1
    s_mov_b32 s45, 32768
    buffer_load_dwordx4 v[32:35], v29, s[12:15], s45 offen offset:0 sc1
    buffer_load_dwordx4 v[36:39], v29, s[12:15], s45 offen offset:16 sc1
    buffer_load_dwordx4 v[40:43], v29, s[12:15], s45 offen offset:2048 sc1
    buffer_load_dwordx4 v[44:47], v29, s[12:15], s45 offen offset:2064 sc1
    s_mov_b32 s45, 12288
    buffer_load_dwordx4 v[128:131], v29, s[12:15], s45 offen offset:0 sc1
    buffer_load_dwordx4 v[132:135], v29, s[12:15], s45 offen offset:16 sc1
    buffer_load_dwordx4 v[136:139], v29, s[12:15], s45 offen offset:2048 sc1
    buffer_load_dwordx4 v[140:143], v29, s[12:15], s45 offen offset:2064 sc1
    s_mov_b32 s45, 36864
    buffer_load_dwordx4 v[48:51], v29, s[12:15], s45 offen offset:0 sc1
    buffer_load_dwordx4 v[52:55], v29, s[12:15], s45 offen offset:16 sc1
    buffer_load_dwordx4 v[56:59], v29, s[12:15], s45 offen offset:2048 sc1
    buffer_load_dwordx4 v[60:63], v29, s[12:15], s45 offen offset:2064 sc1
    s_mov_b32 s45, 16384
    buffer_load_dwordx4 v[144:147], v29, s[12:15], s45 offen offset:0 sc1
    buffer_load_dwordx4 v[148:151], v29, s[12:15], s45 offen offset:16 sc1
    buffer_load_dwordx4 v[152:155], v29, s[12:15], s45 offen offset:2048 sc1
    buffer_load_dwordx4 v[156:159], v29, s[12:15], s45 offen offset:2064 sc1
    s_mov_b32 s45, 40960
    buffer_load_dwordx4 v[64:67], v29, s[12:15], s45 offen offset:0 sc1
    buffer_load_dwordx4 v[68:71], v29, s[12:15], s45 offen offset:16 sc1
    buffer_load_dwordx4 v[72:75], v29, s[12:15], s45 offen offset:2048 sc1
    buffer_load_dwordx4 v[76:79], v29, s[12:15], s45 offen offset:2064 sc1
    s_waitcnt vmcnt(0)
    v_add_f32 v112, v112, v32
    v_cvt_pk_bf16_f32 v112, v112, v112
    v_lshlrev_b32 v112, 16, v112
    v_add_f32 v113, v113, v33
    v_cvt_pk_bf16_f32 v113, v113, v113
    v_lshlrev_b32 v113, 16, v113
    v_add_f32 v114, v114, v34
    v_cvt_pk_bf16_f32 v114, v114, v114
    v_lshlrev_b32 v114, 16, v114
    v_add_f32 v115, v115, v35
    v_cvt_pk_bf16_f32 v115, v115, v115
    v_lshlrev_b32 v115, 16, v115
    v_add_f32 v116, v116, v36
    v_cvt_pk_bf16_f32 v116, v116, v116
    v_lshlrev_b32 v116, 16, v116
    v_add_f32 v117, v117, v37
    v_cvt_pk_bf16_f32 v117, v117, v117
    v_lshlrev_b32 v117, 16, v117
    v_add_f32 v118, v118, v38
    v_cvt_pk_bf16_f32 v118, v118, v118
    v_lshlrev_b32 v118, 16, v118
    v_add_f32 v119, v119, v39
    v_cvt_pk_bf16_f32 v119, v119, v119
    v_lshlrev_b32 v119, 16, v119
    v_add_f32 v120, v120, v40
    v_cvt_pk_bf16_f32 v120, v120, v120
    v_lshlrev_b32 v120, 16, v120
    v_add_f32 v121, v121, v41
    v_cvt_pk_bf16_f32 v121, v121, v121
    v_lshlrev_b32 v121, 16, v121
    v_add_f32 v122, v122, v42
    v_cvt_pk_bf16_f32 v122, v122, v122
    v_lshlrev_b32 v122, 16, v122
    v_add_f32 v123, v123, v43
    v_cvt_pk_bf16_f32 v123, v123, v123
    v_lshlrev_b32 v123, 16, v123
    v_add_f32 v124, v124, v44
    v_cvt_pk_bf16_f32 v124, v124, v124
    v_lshlrev_b32 v124, 16, v124
    v_add_f32 v125, v125, v45
    v_cvt_pk_bf16_f32 v125, v125, v125
    v_lshlrev_b32 v125, 16, v125
    v_add_f32 v126, v126, v46
    v_cvt_pk_bf16_f32 v126, v126, v126
    v_lshlrev_b32 v126, 16, v126
    v_add_f32 v127, v127, v47
    v_cvt_pk_bf16_f32 v127, v127, v127
    v_lshlrev_b32 v127, 16, v127
    v_add_f32 v128, v128, v48
    v_cvt_pk_bf16_f32 v128, v128, v128
    v_lshlrev_b32 v128, 16, v128
    v_add_f32 v129, v129, v49
    v_cvt_pk_bf16_f32 v129, v129, v129
    v_lshlrev_b32 v129, 16, v129
    v_add_f32 v130, v130, v50
    v_cvt_pk_bf16_f32 v130, v130, v130
    v_lshlrev_b32 v130, 16, v130
    v_add_f32 v131, v131, v51
    v_cvt_pk_bf16_f32 v131, v131, v131
    v_lshlrev_b32 v131, 16, v131
    v_add_f32 v132, v132, v52
    v_cvt_pk_bf16_f32 v132, v132, v132
    v_lshlrev_b32 v132, 16, v132
    v_add_f32 v133, v133, v53
    v_cvt_pk_bf16_f32 v133, v133, v133
    v_lshlrev_b32 v133, 16, v133
    v_add_f32 v134, v134, v54
    v_cvt_pk_bf16_f32 v134, v134, v134
    v_lshlrev_b32 v134, 16, v134
    v_add_f32 v135, v135, v55
    v_cvt_pk_bf16_f32 v135, v135, v135
    v_lshlrev_b32 v135, 16, v135
    v_add_f32 v136, v136, v56
    v_cvt_pk_bf16_f32 v136, v136, v136
    v_lshlrev_b32 v136, 16, v136
    v_add_f32 v137, v137, v57
    v_cvt_pk_bf16_f32 v137, v137, v137
    v_lshlrev_b32 v137, 16, v137
    v_add_f32 v138, v138, v58
    v_cvt_pk_bf16_f32 v138, v138, v138
    v_lshlrev_b32 v138, 16, v138
    v_add_f32 v139, v139, v59
    v_cvt_pk_bf16_f32 v139, v139, v139
    v_lshlrev_b32 v139, 16, v139
    v_add_f32 v140, v140, v60
    v_cvt_pk_bf16_f32 v140, v140, v140
    v_lshlrev_b32 v140, 16, v140
    v_add_f32 v141, v141, v61
    v_cvt_pk_bf16_f32 v141, v141, v141
    v_lshlrev_b32 v141, 16, v141
    v_add_f32 v142, v142, v62
    v_cvt_pk_bf16_f32 v142, v142, v142
    v_lshlrev_b32 v142, 16, v142
    v_add_f32 v143, v143, v63
    v_cvt_pk_bf16_f32 v143, v143, v143
    v_lshlrev_b32 v143, 16, v143
    v_add_f32 v144, v144, v64
    v_cvt_pk_bf16_f32 v144, v144, v144
    v_lshlrev_b32 v144, 16, v144
    v_add_f32 v144, 1.0, v144
    v_cvt_pk_bf16_f32 v144, v144, v144
    v_lshlrev_b32 v144, 16, v144
    v_add_f32 v145, v145, v65
    v_cvt_pk_bf16_f32 v145, v145, v145
    v_lshlrev_b32 v145, 16, v145
    v_add_f32 v145, 1.0, v145
    v_cvt_pk_bf16_f32 v145, v145, v145
    v_lshlrev_b32 v145, 16, v145
    v_add_f32 v146, v146, v66
    v_cvt_pk_bf16_f32 v146, v146, v146
    v_lshlrev_b32 v146, 16, v146
    v_add_f32 v146, 1.0, v146
    v_cvt_pk_bf16_f32 v146, v146, v146
    v_lshlrev_b32 v146, 16, v146
    v_add_f32 v147, v147, v67
    v_cvt_pk_bf16_f32 v147, v147, v147
    v_lshlrev_b32 v147, 16, v147
    v_add_f32 v147, 1.0, v147
    v_cvt_pk_bf16_f32 v147, v147, v147
    v_lshlrev_b32 v147, 16, v147
    v_add_f32 v148, v148, v68
    v_cvt_pk_bf16_f32 v148, v148, v148
    v_lshlrev_b32 v148, 16, v148
    v_add_f32 v148, 1.0, v148
    v_cvt_pk_bf16_f32 v148, v148, v148
    v_lshlrev_b32 v148, 16, v148
    v_add_f32 v149, v149, v69
    v_cvt_pk_bf16_f32 v149, v149, v149
    v_lshlrev_b32 v149, 16, v149
    v_add_f32 v149, 1.0, v149
    v_cvt_pk_bf16_f32 v149, v149, v149
    v_lshlrev_b32 v149, 16, v149
    v_add_f32 v150, v150, v70
    v_cvt_pk_bf16_f32 v150, v150, v150
    v_lshlrev_b32 v150, 16, v150
    v_add_f32 v150, 1.0, v150
    v_cvt_pk_bf16_f32 v150, v150, v150
    v_lshlrev_b32 v150, 16, v150
    v_add_f32 v151, v151, v71
    v_cvt_pk_bf16_f32 v151, v151, v151
    v_lshlrev_b32 v151, 16, v151
    v_add_f32 v151, 1.0, v151
    v_cvt_pk_bf16_f32 v151, v151, v151
    v_lshlrev_b32 v151, 16, v151
    v_add_f32 v152, v152, v72
    v_cvt_pk_bf16_f32 v152, v152, v152
    v_lshlrev_b32 v152, 16, v152
    v_add_f32 v152, 1.0, v152
    v_cvt_pk_bf16_f32 v152, v152, v152
    v_lshlrev_b32 v152, 16, v152
    v_add_f32 v153, v153, v73
    v_cvt_pk_bf16_f32 v153, v153, v153
    v_lshlrev_b32 v153, 16, v153
    v_add_f32 v153, 1.0, v153
    v_cvt_pk_bf16_f32 v153, v153, v153
    v_lshlrev_b32 v153, 16, v153
    v_add_f32 v154, v154, v74
    v_cvt_pk_bf16_f32 v154, v154, v154
    v_lshlrev_b32 v154, 16, v154
    v_add_f32 v154, 1.0, v154
    v_cvt_pk_bf16_f32 v154, v154, v154
    v_lshlrev_b32 v154, 16, v154
    v_add_f32 v155, v155, v75
    v_cvt_pk_bf16_f32 v155, v155, v155
    v_lshlrev_b32 v155, 16, v155
    v_add_f32 v155, 1.0, v155
    v_cvt_pk_bf16_f32 v155, v155, v155
    v_lshlrev_b32 v155, 16, v155
    v_add_f32 v156, v156, v76
    v_cvt_pk_bf16_f32 v156, v156, v156
    v_lshlrev_b32 v156, 16, v156
    v_add_f32 v156, 1.0, v156
    v_cvt_pk_bf16_f32 v156, v156, v156
    v_lshlrev_b32 v156, 16, v156
    v_add_f32 v157, v157, v77
    v_cvt_pk_bf16_f32 v157, v157, v157
    v_lshlrev_b32 v157, 16, v157
    v_add_f32 v157, 1.0, v157
    v_cvt_pk_bf16_f32 v157, v157, v157
    v_lshlrev_b32 v157, 16, v157
    v_add_f32 v158, v158, v78
    v_cvt_pk_bf16_f32 v158, v158, v158
    v_lshlrev_b32 v158, 16, v158
    v_add_f32 v158, 1.0, v158
    v_cvt_pk_bf16_f32 v158, v158, v158
    v_lshlrev_b32 v158, 16, v158
    v_add_f32 v159, v159, v79
    v_cvt_pk_bf16_f32 v159, v159, v159
    v_lshlrev_b32 v159, 16, v159
    v_add_f32 v159, 1.0, v159
    v_cvt_pk_bf16_f32 v159, v159, v159
    v_lshlrev_b32 v159, 16, v159
    s_mov_b32 s52, 0xc00000
    s_lshl_b32 s56, s41, 13
    s_add_u32 s56, s56, 0x6000000
L_b_loop_148:
    s_cmp_eq_u64 s[36:37], 0
    s_cbranch_scc1 L_w_done_108
    s_ff1_i32_b64 s50, s[36:37]
    s_bitset0_b64 s[36:37], s50
    s_lshr_b64 s[74:75], s[72:73], s50
    s_ff1_i32_b64 s51, s[74:75]
    s_add_u32 s51, s51, 1
    s_add_u32 s62, s50, s51
    s_add_u32 s63, s50, s44
    s_lshl_b32 s63, s63, 5
    s_add_u32 s63, s63, s41
    s_lshl_b32 s47, s63, 11
    buffer_load_dwordx4 v[208:211], v10, s[28:31], s47 offen
    buffer_load_dwordx4 v[212:215], v10, s[28:31], s47 offen offset:1024
    s_add_u32 s45, s64, 4096
    s_cmp_lg_u32 s44, 0
    s_cbranch_scc1 L_pw_151
    s_mov_b32 exec_hi, 0
    s_mov_b32 s70, 0
L_wp_152:
    buffer_load_dword v31, v5, s[12:15], s45 offen sc1
    s_add_u32 s70, s70, 1
    s_cmp_ge_u32 s70, 0x200000
    s_cbranch_scc1 L_w_done_108
    s_waitcnt vmcnt(0)
    v_cmp_gt_u32 vcc, s62, v31
    s_nop 1
    s_cbranch_vccz L_wp_152_ok
    s_sleep 2
    s_branch L_wp_152
L_wp_152_ok:
    s_mov_b64 exec, -1
L_pw_151:
    s_barrier
    s_cmp_ge_u32 s44, s51
    s_cbranch_scc1 L_b_skip_149
    s_lshl_b32 s45, s63, 12
    s_add_u32 s45, s45, 0x8000000
    v_lshlrev_b32 v29, 5, v1
    buffer_load_dwordx4 v[64:67], v29, s[12:15], s45 offen offset:0 sc1
    buffer_load_dwordx4 v[68:71], v29, s[12:15], s45 offen offset:16 sc1
    buffer_load_dwordx4 v[72:75], v29, s[12:15], s45 offen offset:2048 sc1
    buffer_load_dwordx4 v[76:79], v29, s[12:15], s45 offen offset:2064 sc1
    s_add_u32 s45, s45, 0x800000
    buffer_load_dwordx4 v[160:163], v29, s[12:15], s45 offen offset:0 sc1
    buffer_load_dwordx4 v[164:167], v29, s[12:15], s45 offen offset:16 sc1
    buffer_load_dwordx4 v[168:171], v29, s[12:15], s45 offen offset:2048 sc1
    buffer_load_dwordx4 v[172:175], v29, s[12:15], s45 offen offset:2064 sc1
    s_add_u32 s45, s45, 0x800000
    buffer_load_dwordx4 v[176:179], v29, s[12:15], s45 offen offset:0 sc1
    buffer_load_dwordx4 v[180:183], v29, s[12:15], s45 offen offset:16 sc1
    buffer_load_dwordx4 v[184:187], v29, s[12:15], s45 offen offset:2048 sc1
    buffer_load_dwordx4 v[188:191], v29, s[12:15], s45 offen offset:2064 sc1
    s_add_u32 s45, s45, 0x800000
    buffer_load_dwordx4 v[192:195], v29, s[12:15], s45 offen offset:0 sc1
    buffer_load_dwordx4 v[196:199], v29, s[12:15], s45 offen offset:16 sc1
    buffer_load_dwordx4 v[200:203], v29, s[12:15], s45 offen offset:2048 sc1
    buffer_load_dwordx4 v[204:207], v29, s[12:15], s45 offen offset:2064 sc1
    s_waitcnt vmcnt(0)
    v_pk_add_f32 v[64:65], v[64:65], v[160:161]
    v_pk_add_f32 v[176:177], v[176:177], v[192:193]
    v_pk_add_f32 v[66:67], v[66:67], v[162:163]
    v_pk_add_f32 v[178:179], v[178:179], v[194:195]
    v_pk_add_f32 v[68:69], v[68:69], v[164:165]
    v_pk_add_f32 v[180:181], v[180:181], v[196:197]
    v_pk_add_f32 v[70:71], v[70:71], v[166:167]
    v_pk_add_f32 v[182:183], v[182:183], v[198:199]
    v_pk_add_f32 v[72:73], v[72:73], v[168:169]
    v_pk_add_f32 v[184:185], v[184:185], v[200:201]
    v_pk_add_f32 v[74:75], v[74:75], v[170:171]
    v_pk_add_f32 v[186:187], v[186:187], v[202:203]
    v_pk_add_f32 v[76:77], v[76:77], v[172:173]
    v_pk_add_f32 v[188:189], v[188:189], v[204:205]
    v_pk_add_f32 v[78:79], v[78:79], v[174:175]
    v_pk_add_f32 v[190:191], v[190:191], v[206:207]
    v_pk_add_f32 v[64:65], v[64:65], v[176:177]
    v_pk_add_f32 v[66:67], v[66:67], v[178:179]
    v_pk_add_f32 v[68:69], v[68:69], v[180:181]
    v_pk_add_f32 v[70:71], v[70:71], v[182:183]
    v_pk_add_f32 v[72:73], v[72:73], v[184:185]
    v_pk_add_f32 v[74:75], v[74:75], v[186:187]
    v_pk_add_f32 v[76:77], v[76:77], v[188:189]
    v_pk_add_f32 v[78:79], v[78:79], v[190:191]
    v_cvt_pk_bf16_f32 v64, v64, v64
    v_lshlrev_b32 v64, 16, v64
    v_cvt_pk_bf16_f32 v65, v65, v65
    v_lshlrev_b32 v65, 16, v65
    v_cvt_pk_bf16_f32 v66, v66, v66
    v_lshlrev_b32 v66, 16, v66
    v_cvt_pk_bf16_f32 v67, v67, v67
    v_lshlrev_b32 v67, 16, v67
    v_cvt_pk_bf16_f32 v68, v68, v68
    v_lshlrev_b32 v68, 16, v68
    v_cvt_pk_bf16_f32 v69, v69, v69
    v_lshlrev_b32 v69, 16, v69
    v_cvt_pk_bf16_f32 v70, v70, v70
    v_lshlrev_b32 v70, 16, v70
    v_cvt_pk_bf16_f32 v71, v71, v71
    v_lshlrev_b32 v71, 16, v71
    v_cvt_pk_bf16_f32 v72, v72, v72
    v_lshlrev_b32 v72, 16, v72
    v_cvt_pk_bf16_f32 v73, v73, v73
    v_lshlrev_b32 v73, 16, v73
    v_cvt_pk_bf16_f32 v74, v74, v74
    v_lshlrev_b32 v74, 16, v74
    v_cvt_pk_bf16_f32 v75, v75, v75
    v_lshlrev_b32 v75, 16, v75
    v_cvt_pk_bf16_f32 v76, v76, v76
    v_lshlrev_b32 v76, 16, v76
    v_cvt_pk_bf16_f32 v77, v77, v77
    v_lshlrev_b32 v77, 16, v77
    v_cvt_pk_bf16_f32 v78, v78, v78
    v_lshlrev_b32 v78, 16, v78
    v_cvt_pk_bf16_f32 v79, v79, v79
    v_lshlrev_b32 v79, 16, v79
    v_lshlrev_b32 v160, 16, v208
    v_and_b32 v161, 0xffff0000, v208
    v_lshlrev_b32 v162, 16, v209
    v_and_b32 v163, 0xffff0000, v209
    v_lshlrev_b32 v164, 16, v210
    v_and_b32 v165, 0xffff0000, v210
    v_lshlrev_b32 v166, 16, v211
    v_and_b32 v167, 0xffff0000, v211
    v_lshlrev_b32 v168, 16, v212
    v_and_b32 v169, 0xffff0000, v212
    v_lshlrev_b32 v170, 16, v213
    v_and_b32 v171, 0xffff0000, v213
    v_lshlrev_b32 v172, 16, v214
    v_and_b32 v173, 0xffff0000, v214
    v_lshlrev_b32 v174, 16, v215
    v_and_b32 v175, 0xffff0000, v215
    v_mul_f32 v64, v64, v112
    v_cvt_pk_bf16_f32 v64, v64, v64
    v_lshlrev_b32 v64, 16, v64
    v_add_f32 v64, v64, v160
    v_mul_f32 v65, v65, v113
    v_cvt_pk_bf16_f32 v65, v65, v65
    v_lshlrev_b32 v65, 16, v65
    v_add_f32 v65, v65, v161
    v_mul_f32 v66, v66, v114
    v_cvt_pk_bf16_f32 v66, v66, v66
    v_lshlrev_b32 v66, 16, v66
    v_add_f32 v66, v66, v162
    v_mul_f32 v67, v67, v115
    v_cvt_pk_bf16_f32 v67, v67, v67
    v_lshlrev_b32 v67, 16, v67
    v_add_f32 v67, v67, v163
    v_mul_f32 v68, v68, v116
    v_cvt_pk_bf16_f32 v68, v68, v68
    v_lshlrev_b32 v68, 16, v68
    v_add_f32 v68, v68, v164
    v_mul_f32 v69, v69, v117
    v_cvt_pk_bf16_f32 v69, v69, v69
    v_lshlrev_b32 v69, 16, v69
    v_add_f32 v69, v69, v165
    v_mul_f32 v70, v70, v118
    v_cvt_pk_bf16_f32 v70, v70, v70
    v_lshlrev_b32 v70, 16, v70
    v_add_f32 v70, v70, v166
    v_mul_f32 v71, v71, v119
    v_cvt_pk_bf16_f32 v71, v71, v71
    v_lshlrev_b32 v71, 16, v71
    v_add_f32 v71, v71, v167
    v_mul_f32 v72, v72, v120
    v_cvt_pk_bf16_f32 v72, v72, v72
    v_lshlrev_b32 v72, 16, v72
    v_add_f32 v72, v72, v168
    v_mul_f32 v73, v73, v121
    v_cvt_pk_bf16_f32 v73, v73, v73
    v_lshlrev_b32 v73, 16, v73
    v_add_f32 v73, v73, v169
    v_mul_f32 v74, v74, v122
    v_cvt_pk_bf16_f32 v74, v74, v74
    v_lshlrev_b32 v74, 16, v74
    v_add_f32 v74, v74, v170
    v_mul_f32 v75, v75, v123
    v_cvt_pk_bf16_f32 v75, v75, v75
    v_lshlrev_b32 v75, 16, v75
    v_add_f32 v75, v75, v171
    v_mul_f32 v76, v76, v124
    v_cvt_pk_bf16_f32 v76, v76, v76
    v_lshlrev_b32 v76, 16, v76
    v_add_f32 v76, v76, v172
    v_mul_f32 v77, v77, v125
    v_cvt_pk_bf16_f32 v77, v77, v77
    v_lshlrev_b32 v77, 16, v77
    v_add_f32 v77, v77, v173
    v_mul_f32 v78, v78, v126
    v_cvt_pk_bf16_f32 v78, v78, v78
    v_lshlrev_b32 v78, 16, v78
    v_add_f32 v78, v78, v174
    v_mul_f32 v79, v79, v127
    v_cvt_pk_bf16_f32 v79, v79, v79
    v_lshlrev_b32 v79, 16, v79
    v_add_f32 v79, v79, v175
    v_cvt_pk_bf16_f32 v208, v64, v65
    v_cvt_pk_bf16_f32 v209, v66, v67
    v_cvt_pk_bf16_f32 v210, v68, v69
    v_cvt_pk_bf16_f32 v211, v70, v71
    v_cvt_pk_bf16_f32 v212, v72, v73
    v_cvt_pk_bf16_f32 v213, v74, v75
    v_cvt_pk_bf16_f32 v214, v76, v77
    v_cvt_pk_bf16_f32 v215, v78, v79
    s_add_u32 s47, s47, 0x800000
    buffer_store_dwordx4 v[208:211], v10, s[12:15], s47 offen sc1
    buffer_store_dwordx4 v[212:215], v10, s[12:15], s47 offen offset:1024 sc1
    v_lshlrev_b32 v64, 16, v208
    v_and_b32 v65, 0xffff0000, v208
    v_lshlrev_b32 v66, 16, v209
    v_and_b32 v67, 0xffff0000, v209
    v_lshlrev_b32 v68, 16, v210
    v_and_b32 v69, 0xffff0000, v210
    v_lshlrev_b32 v70, 16, v211
    v_and_b32 v71, 0xffff0000, v211
    v_lshlrev_b32 v72, 16, v212
    v_and_b32 v73, 0xffff0000, v212
    v_lshlrev_b32 v74, 16, v213
    v_and_b32 v75, 0xffff0000, v213
    v_lshlrev_b32 v76, 16, v214
    v_and_b32 v77, 0xffff0000, v214
    v_lshlrev_b32 v78, 16, v215
    v_and_b32 v79, 0xffff0000, v215
    v_add_f32 v26, v64, v65
    v_add_f32 v26, v26, v66
    v_add_f32 v26, v26, v67
    v_add_f32 v26, v26, v68
    v_add_f32 v26, v26, v69
    v_add_f32 v26, v26, v70
    v_add_f32 v26, v26, v71
    v_add_f32 v26, v26, v72
    v_add_f32 v26, v26, v73
    v_add_f32 v26, v26, v74
    v_add_f32 v26, v26, v75
    v_add_f32 v26, v26, v76
    v_add_f32 v26, v26, v77
    v_add_f32 v26, v26, v78
    v_add_f32 v26, v26, v79
    s_nop 1
    v_add_f32_dpp v26, v26, v26 row_shr:1 row_mask:0xf bank_mask:0xf bound_ctrl:0
    s_nop 1
    v_add_f32_dpp v26, v26, v26 row_shr:2 row_mask:0xf bank_mask:0xf bound_ctrl:0
    s_nop 1
    v_add_f32_dpp v26, v26, v26 row_shr:4 row_mask:0xf bank_mask:0xf bound_ctrl:0
    s_nop 1
    v_add_f32_dpp v26, v26, v26 row_shr:8 row_mask:0xf bank_mask:0xf bound_ctrl:0
    s_nop 1
    v_add_f32_dpp v26, v26, v26 row_bcast:15 row_mask:0xa bank_mask:0xf
    s_nop 1
    v_add_f32_dpp v26, v26, v26 row_bcast:31 row_mask:0xc bank_mask:0xf
    s_nop 1
    v_readlane_b32 s66, v26, 63
    s_nop 1
    v_mov_b32 v27, s66
    v_mul_f32 v27, 0x3a800000, v27
    v_mov_b32 v26, 0
    v_sub_f32 v28, v64, v27
    v_fmac_f32 v26, v28, v28
    v_sub_f32 v28, v65, v27
    v_fmac_f32 v26, v28, v28
    v_sub_f32 v28, v66, v27
    v_fmac_f32 v26, v28, v28
    v_sub_f32 v28, v67, v27
    v_fmac_f32 v26, v28, v28
    v_sub_f32 v28, v68, v27
    v_fmac_f32 v26, v28, v28
    v_sub_f32 v28, v69, v27
    v_fmac_f32 v26, v28, v28
    v_sub_f32 v28, v70, v27
    v_fmac_f32 v26, v28, v28
    v_sub_f32 v28, v71, v27
    v_fmac_f32 v26, v28, v28
    v_sub_f32 v28, v72, v27
    v_fmac_f32 v26, v28, v28
    v_sub_f32 v28, v73, v27
    v_fmac_f32 v26, v28, v28
    v_sub_f32 v28, v74, v27
    v_fmac_f32 v26, v28, v28
    v_sub_f32 v28, v75, v27
    v_fmac_f32 v26, v28, v28
    v_sub_f32 v28, v76, v27
    v_fmac_f32 v26, v28, v28
    v_sub_f32 v28, v77, v27
    v_fmac_f32 v26, v28, v28
    v_sub_f32 v28, v78, v27
    v_fmac_f32 v26, v28, v28
    v_sub_f32 v28, v79, v27
    v_fmac_f32 v26, v28, v28
    s_nop 1
    v_add_f32_dpp v26, v26, v26 row_shr:1 row_mask:0xf bank_mask:0xf bound_ctrl:0
    s_nop 1
    v_add_f32_dpp v26, v26, v26 row_shr:2 row_mask:0xf bank_mask:0xf bound_ctrl:0
    s_nop 1
    v_add_f32_dpp v26, v26, v26 row_shr:4 row_mask:0xf bank_mask:0xf bound_ctrl:0
    s_nop 1
    v_add_f32_dpp v26, v26, v26 row_shr:8 row_mask:0xf bank_mask:0xf bound_ctrl:0
    s_nop 1
    v_add_f32_dpp v26, v26, v26 row_bcast:15 row_mask:0xa bank_mask:0xf
    s_nop 1
    v_add_f32_dpp v26, v26, v26 row_bcast:31 row_mask:0xc bank_mask:0xf
    s_nop 1
    v_readlane_b32 s66, v26, 63
    s_nop 1
    v_mov_b32 v26, s66
    v_mul_f32 v26, 0x3a800000, v26
    v_cvt_pk_bf16_f32 v26, v26, v26
    v_lshlrev_b32 v26, 16, v26
    v_cvt_pk_bf16_f32 v27, v27, v27
    v_lshlrev_b32 v27, 16, v27
    v_add_f32 v26, 0x3727c5ac, v26
    v_cvt_pk_bf16_f32 v26, v26, v26
    v_lshlrev_b32 v26, 16, v26
    v_sqrt_f32 v26, v26
    s_nop 0
    v_cvt_pk_bf16_f32 v26, v26, v26
    v_lshlrev_b32 v26, 16, v26
    v_rcp_f32 v26, v26
    s_nop 0
    v_sub_f32 v64, v64, v27
    v_cvt_pk_bf16_f32 v64, v64, v64
    v_lshlrev_b32 v64, 16, v64
    v_mul_f32 v64, v64, v26
    v_cvt_pk_bf16_f32 v64, v64, v64
    v_lshlrev_b32 v64, 16, v64
    v_sub_f32 v65, v65, v27
    v_cvt_pk_bf16_f32 v65, v65, v65
    v_lshlrev_b32 v65, 16, v65
    v_mul_f32 v65, v65, v26
    v_cvt_pk_bf16_f32 v65, v65, v65
    v_lshlrev_b32 v65, 16, v65
    v_sub_f32 v66, v66, v27
    v_cvt_pk_bf16_f32 v66, v66, v66
    v_lshlrev_b32 v66, 16, v66
    v_mul_f32 v66, v66, v26
    v_cvt_pk_bf16_f32 v66, v66, v66
    v_lshlrev_b32 v66, 16, v66
    v_sub_f32 v67, v67, v27
    v_cvt_pk_bf16_f32 v67, v67, v67
    v_lshlrev_b32 v67, 16, v67
    v_mul_f32 v67, v67, v26
    v_cvt_pk_bf16_f32 v67, v67, v67
    v_lshlrev_b32 v67, 16, v67
    v_sub_f32 v68, v68, v27
    v_cvt_pk_bf16_f32 v68, v68, v68
    v_lshlrev_b32 v68, 16, v68
    v_mul_f32 v68, v68, v26
    v_cvt_pk_bf16_f32 v68, v68, v68
    v_lshlrev_b32 v68, 16, v68
    v_sub_f32 v69, v69, v27
    v_cvt_pk_bf16_f32 v69, v69, v69
    v_lshlrev_b32 v69, 16, v69
    v_mul_f32 v69, v69, v26
    v_cvt_pk_bf16_f32 v69, v69, v69
    v_lshlrev_b32 v69, 16, v69
    v_sub_f32 v70, v70, v27
    v_cvt_pk_bf16_f32 v70, v70, v70
    v_lshlrev_b32 v70, 16, v70
    v_mul_f32 v70, v70, v26
    v_cvt_pk_bf16_f32 v70, v70, v70
    v_lshlrev_b32 v70, 16, v70
    v_sub_f32 v71, v71, v27
    v_cvt_pk_bf16_f32 v71, v71, v71
    v_lshlrev_b32 v71, 16, v71
    v_mul_f32 v71, v71, v26
    v_cvt_pk_bf16_f32 v71, v71, v71
    v_lshlrev_b32 v71, 16, v71
    v_sub_f32 v72, v72, v27
    v_cvt_pk_bf16_f32 v72, v72, v72
    v_lshlrev_b32 v72, 16, v72
    v_mul_f32 v72, v72, v26
    v_cvt_pk_bf16_f32 v72, v72, v72
    v_lshlrev_b32 v72, 16, v72
    v_sub_f32 v73, v73, v27
    v_cvt_pk_bf16_f32 v73, v73, v73
    v_lshlrev_b32 v73, 16, v73
    v_mul_f32 v73, v73, v26
    v_cvt_pk_bf16_f32 v73, v73, v73
    v_lshlrev_b32 v73, 16, v73
    v_sub_f32 v74, v74, v27
    v_cvt_pk_bf16_f32 v74, v74, v74
    v_lshlrev_b32 v74, 16, v74
    v_mul_f32 v74, v74, v26
    v_cvt_pk_bf16_f32 v74, v74, v74
    v_lshlrev_b32 v74, 16, v74
    v_sub_f32 v75, v75, v27
    v_cvt_pk_bf16_f32 v75, v75, v75
    v_lshlrev_b32 v75, 16, v75
    v_mul_f32 v75, v75, v26
    v_cvt_pk_bf16_f32 v75, v75, v75
    v_lshlrev_b32 v75, 16, v75
    v_sub_f32 v76, v76, v27
    v_cvt_pk_bf16_f32 v76, v76, v76
    v_lshlrev_b32 v76, 16, v76
    v_mul_f32 v76, v76, v26
    v_cvt_pk_bf16_f32 v76, v76, v76
    v_lshlrev_b32 v76, 16, v76
    v_sub_f32 v77, v77, v27
    v_cvt_pk_bf16_f32 v77, v77, v77
    v_lshlrev_b32 v77, 16, v77
    v_mul_f32 v77, v77, v26
    v_cvt_pk_bf16_f32 v77, v77, v77
    v_lshlrev_b32 v77, 16, v77
    v_sub_f32 v78, v78, v27
    v_cvt_pk_bf16_f32 v78, v78, v78
    v_lshlrev_b32 v78, 16, v78
    v_mul_f32 v78, v78, v26
    v_cvt_pk_bf16_f32 v78, v78, v78
    v_lshlrev_b32 v78, 16, v78
    v_sub_f32 v79, v79, v27
    v_cvt_pk_bf16_f32 v79, v79, v79
    v_lshlrev_b32 v79, 16, v79
    v_mul_f32 v79, v79, v26
    v_cvt_pk_bf16_f32 v79, v79, v79
    v_lshlrev_b32 v79, 16, v79
    v_mul_f32 v64, v64, v144
    v_cvt_pk_bf16_f32 v64, v64, v64
    v_lshlrev_b32 v64, 16, v64
    v_add_f32 v64, v64, v128
    v_mul_f32 v65, v65, v145
    v_cvt_pk_bf16_f32 v65, v65, v65
    v_lshlrev_b32 v65, 16, v65
    v_add_f32 v65, v65, v129
    v_mul_f32 v66, v66, v146
    v_cvt_pk_bf16_f32 v66, v66, v66
    v_lshlrev_b32 v66, 16, v66
    v_add_f32 v66, v66, v130
    v_mul_f32 v67, v67, v147
    v_cvt_pk_bf16_f32 v67, v67, v67
    v_lshlrev_b32 v67, 16, v67
    v_add_f32 v67, v67, v131
    v_mul_f32 v68, v68, v148
    v_cvt_pk_bf16_f32 v68, v68, v68
    v_lshlrev_b32 v68, 16, v68
    v_add_f32 v68, v68, v132
    v_mul_f32 v69, v69, v149
    v_cvt_pk_bf16_f32 v69, v69, v69
    v_lshlrev_b32 v69, 16, v69
    v_add_f32 v69, v69, v133
    v_mul_f32 v70, v70, v150
    v_cvt_pk_bf16_f32 v70, v70, v70
    v_lshlrev_b32 v70, 16, v70
    v_add_f32 v70, v70, v134
    v_mul_f32 v71, v71, v151
    v_cvt_pk_bf16_f32 v71, v71, v71
    v_lshlrev_b32 v71, 16, v71
    v_add_f32 v71, v71, v135
    v_mul_f32 v72, v72, v152
    v_cvt_pk_bf16_f32 v72, v72, v72
    v_lshlrev_b32 v72, 16, v72
    v_add_f32 v72, v72, v136
    v_mul_f32 v73, v73, v153
    v_cvt_pk_bf16_f32 v73, v73, v73
    v_lshlrev_b32 v73, 16, v73
    v_add_f32 v73, v73, v137
    v_mul_f32 v74, v74, v154
    v_cvt_pk_bf16_f32 v74, v74, v74
    v_lshlrev_b32 v74, 16, v74
    v_add_f32 v74, v74, v138
    v_mul_f32 v75, v75, v155
    v_cvt_pk_bf16_f32 v75, v75, v75
    v_lshlrev_b32 v75, 16, v75
    v_add_f32 v75, v75, v139
    v_mul_f32 v76, v76, v156
    v_cvt_pk_bf16_f32 v76, v76, v76
    v_lshlrev_b32 v76, 16, v76
    v_add_f32 v76, v76, v140
    v_mul_f32 v77, v77, v157
    v_cvt_pk_bf16_f32 v77, v77, v77
    v_lshlrev_b32 v77, 16, v77
    v_add_f32 v77, v77, v141
    v_mul_f32 v78, v78, v158
    v_cvt_pk_bf16_f32 v78, v78, v78
    v_lshlrev_b32 v78, 16, v78
    v_add_f32 v78, v78, v142
    v_mul_f32 v79, v79, v159
    v_cvt_pk_bf16_f32 v79, v79, v79
    v_lshlrev_b32 v79, 16, v79
    v_add_f32 v79, v79, v143
    v_cvt_pk_bf16_f32 v80, v64, v65
    v_cvt_pk_bf16_f32 v81, v66, v67
    v_cvt_pk_bf16_f32 v82, v68, v69
    v_cvt_pk_bf16_f32 v83, v70, v71
    v_cvt_pk_bf16_f32 v84, v72, v73
    v_cvt_pk_bf16_f32 v85, v74, v75
    v_cvt_pk_bf16_f32 v86, v76, v77
    v_cvt_pk_bf16_f32 v87, v78, v79
    s_lshr_b32 s45, s63, 5
    s_lshl_b32 s45, s45, 16
    s_and_b32 s46, s63, 31
    s_lshl_b32 s46, s46, 8
    s_add_u32 s45, s45, s46
    s_add_u32 s45, s45, 0xc00000
    s_add_u32 s46, s45, 32768
    buffer_store_dwordx4 v[80:83], v2, s[12:15], s45 offen sc1
    buffer_store_dwordx4 v[84:87], v2, s[12:15], s46 offen sc1
L_b_skip_149:
    s_waitcnt vmcnt(0)
    s_barrier
    s_cmp_lg_u32 s44, 0
    s_cbranch_scc1 L_pub_153
    v_mov_b32 v30, s62
    v_mov_b32 v31, 0
    s_mov_b64 exec, 1
    buffer_store_dword v30, v31, s[12:15], s65 offen sc1
    s_mov_b64 exec, -1
L_pub_153:
    s_cmp_ge_u32 s41, 28
    s_cbranch_scc1 L_b_loop_148
    s_add_u32 s45, s64, 8192
    s_cmp_lg_u32 s44, 0
    s_cbranch_scc1 L_pw_154
    s_mov_b32 exec_hi, 0
    s_mov_b32 s70, 0
L_wp_155:
    buffer_load_dword v31, v5, s[12:15], s45 offen sc1
    s_add_u32 s70, s70, 1
    s_cmp_ge_u32 s70, 0x200000
    s_cbranch_scc1 L_w_done_108
    s_waitcnt vmcnt(0)
    v_cmp_gt_u32 vcc, s62, v31
    s_nop 1
    s_cbranch_vccz L_wp_155_ok
    s_sleep 1
    s_branch L_wp_155
L_wp_155_ok:
    s_mov_b64 exec, -1
L_pw_154:
    s_barrier
    s_mul_i32 s53, s50, 65536
    s_add_u32 s53, s53, s52
    s_lshl_b32 s45, s44, 11
    s_add_u32 s53, s53, s45
    s_mul_i32 s57, s50, 229376
    s_add_u32 s57, s57, s56
    s_mul_i32 s54, s44, 8320
    s_add_u32 s55, s54, 66560
    s_mov_b32 s58, 0
    v_mov_b32 v13, v4
    s_mov_b32 s59, 66560
    s_add_u32 m0, s54, 0
    s_nop 0
    buffer_load_dwordx4 v2, s[12:15], s53 offen offset:0 sc1 lds
    s_add_u32 m0, s54, 784
    s_nop 0
    buffer_load_dwordx4 v2, s[12:15], s53 offen offset:256 sc1 lds
    s_add_u32 m0, s54, 1568
    s_nop 0
    buffer_load_dwordx4 v2, s[12:15], s53 offen offset:512 sc1 lds
    s_add_u32 m0, s54, 2352
    s_nop 0
    buffer_load_dwordx4 v2, s[12:15], s53 offen offset:768 sc1 lds
    s_add_u32 m0, s54, 3136
    s_nop 0
    buffer_load_dwordx4 v2, s[12:15], s53 offen offset:1024 sc1 lds
    s_add_u32 m0, s54, 3920
    s_nop 0
    buffer_load_dwordx4 v2, s[12:15], s53 offen offset:1280 sc1 lds
    s_add_u32 m0, s54, 4704
    s_nop 0
    buffer_load_dwordx4 v2, s[12:15], s53 offen offset:1536 sc1 lds
    s_add_u32 m0, s54, 5488
    s_nop 0
    buffer_load_dwordx4 v2, s[12:15], s53 offen offset:1792 sc1 lds
    s_add_u32 s45, s53, 32768
    s_add_u32 s46, s54, 33280
    s_add_u32 m0, s46, 0
    s_nop 0
    buffer_load_dwordx4 v2, s[12:15], s45 offen offset:0 sc1 lds
    s_add_u32 m0, s46, 784
    s_nop 0
    buffer_load_dwordx4 v2, s[12:15], s45 offen offset:256 sc1 lds
    s_add_u32 m0, s46, 1568
    s_nop 0
    buffer_load_dwordx4 v2, s[12:15], s45 offen offset:512 sc1 lds
    s_add_u32 m0, s46, 2352
    s_nop 0
    buffer_load_dwordx4 v2, s[12:15], s45 offen offset:768 sc1 lds
    s_add_u32 m0, s46, 3136
    s_nop 0
    buffer_load_dwordx4 v2, s[12:15], s45 offen offset:1024 sc1 lds
    s_add_u32 m0, s46, 3920
    s_nop 0
    buffer_load_dwordx4 v2, s[12:15], s45 offen offset:1280 sc1 lds
    s_add_u32 m0, s46, 4704
    s_nop 0
    buffer_load_dwordx4 v2, s[12:15], s45 offen offset:1536 sc1 lds
    s_add_u32 m0, s46, 5488
    s_nop 0
    buffer_load_dwordx4 v2, s[12:15], s45 offen offset:1792 sc1 lds
    s_add_u32 s45, s53, 65536
    s_cmp_gt_u32 s51, 1
    s_cselect_b32 s45, s45, 0x20000000
    s_add_u32 m0, s55, 0
    s_nop 0
    buffer_load_dwordx4 v2, s[12:15], s45 offen offset:0 sc1 lds
    s_add_u32 m0, s55, 784
    s_nop 0
    buffer_load_dwordx4 v2, s[12:15], s45 offen offset:256 sc1 lds
    s_add_u32 m0, s55, 1568
    s_nop 0
    buffer_load_dwordx4 v2, s[12:15], s45 offen offset:512 sc1 lds
    s_add_u32 m0, s55, 2352
    s_nop 0
    buffer_load_dwordx4 v2, s[12:15], s45 offen offset:768 sc1 lds
    s_add_u32 m0, s55, 3136
    s_nop 0
    buffer_load_dwordx4 v2, s[12:15], s45 offen offset:1024 sc1 lds
    s_add_u32 m0, s55, 3920
    s_nop 0
    buffer_load_dwordx4 v2, s[12:15], s45 offen offset:1280 sc1 lds
    s_add_u32 m0, s55, 4704
    s_nop 0
    buffer_load_dwordx4 v2, s[12:15], s45 offen offset:1536 sc1 lds
    s_add_u32 m0, s55, 5488
    s_nop 0
    buffer_load_dwordx4 v2, s[12:15], s45 offen offset:1792 sc1 lds
L_e_loop_156:
    s_add_u32 s45, s53, 98304
    s_add_u32 s46, s58, 1
    s_cmp_lt_u32 s46, s51
    s_cselect_b32 s48, s45, 0x20000000
    s_add_u32 s49, s55, 33280
    s_waitcnt vmcnt(16)
    s_barrier
    ds_read_b128 v[32:35], v13 offset:0
    ds_read_b128 v[36:39], v13 offset:32
    ds_read_b128 v[40:43], v13 offset:64
    ds_read_b128 v[44:47], v13 offset:96
    ds_read_b128 v[48:51], v13 offset:128
    ds_read_b128 v[52:55], v13 offset:160
    s_waitcnt lgkmcnt(4)
    v_mfma_f32_32x32x16_bf16 v[64:79], a[0:3], v[32:35], 0
    ds_read_b128 v[56:59], v13 offset:192
    v_mfma_f32_32x32x16_bf16 v[64:79], a[4:7], v[36:39], v[64:79]
    ds_read_b128 v[60:63], v13 offset:224
    s_add_u32 m0, s49, 0
    s_nop 0
    buffer_load_dwordx4 v2, s[12:15], s48 offen offset:0 sc1 lds
    s_waitcnt lgkmcnt(4)
    v_mfma_f32_32x32x16_bf16 v[64:79], a[8:11], v[40:43], v[64:79]
    ds_read_b128 v[32:35], v13 offset:256
    v_mfma_f32_32x32x16_bf16 v[64:79], a[12:15], v[44:47], v[64:79]
    ds_read_b128 v[36:39], v13 offset:288
    s_add_u32 m0, s49, 784
    s_nop 0
    buffer_load_dwordx4 v2, s[12:15], s48 offen offset:256 sc1 lds
    s_waitcnt lgkmcnt(4)
    v_mfma_f32_32x32x16_bf16 v[64:79], a[16:19], v[48:51], v[64:79]
    ds_read_b128 v[40:43], v13 offset:320
    v_mfma_f32_32x32x16_bf16 v[64:79], a[20:23], v[52:55], v[64:79]
    ds_read_b128 v[44:47], v13 offset:352
    s_add_u32 m0, s49, 1568
    s_nop 0
    buffer_load_dwordx4 v2, s[12:15], s48 offen offset:512 sc1 lds
    s_waitcnt lgkmcnt(4)
    v_mfma_f32_32x32x16_bf16 v[64:79], a[24:27], v[56:59], v[64:79]
    ds_read_b128 v[48:51], v13 offset:384
    v_mfma_f32_32x32x16_bf16 v[64:79], a[28:31], v[60:63], v[64:79]
    ds_read_b128 v[52:55], v13 offset:416
    s_add_u32 m0, s49, 2352
    s_nop 0
    buffer_load_dwordx4 v2, s[12:15], s48 offen offset:768 sc1 lds
    s_waitcnt lgkmcnt(4)
    v_mfma_f32_32x32x16_bf16 v[64:79], a[32:35], v[32:35], v[64:79]
    ds_read_b128 v[56:59], v13 offset:448
    v_mfma_f32_32x32x16_bf16 v[64:79], a[36:39], v[36:39], v[64:79]
    ds_read_b128 v[60:63], v13 offset:480
    s_add_u32 m0, s49, 3136
    s_nop 0
    buffer_load_dwordx4 v2, s[12:15], s48 offen offset:1024 sc1 lds
    s_waitcnt lgkmcnt(4)
    v_mfma_f32_32x32x16_bf16 v[64:79], a[40:43], v[40:43], v[64:79]
    ds_read_b128 v[32:35], v13 offset:512
    v_mfma_f32_32x32x16_bf16 v[64:79], a[44:47], v[44:47], v[64:79]
    ds_read_b128 v[36:39], v13 offset:544
    s_add_u32 m0, s49, 3920
    s_nop 0
    buffer_load_dwordx4 v2, s[12:15], s48 offen offset:1280 sc1 lds
    s_waitcnt lgkmcnt(4)
    v_mfma_f32_32x32x16_bf16 v[64:79], a[48:51], v[48:51], v[64:79]
    ds_read_b128 v[40:43], v13 offset:576
    v_mfma_f32_32x32x16_bf16 v[64:79], a[52:55], v[52:55], v[64:79]
    ds_read_b128 v[44:47], v13 offset:608
    s_add_u32 m0, s49, 4704
    s_nop 0
    buffer_load_dwordx4 v2, s[12:15], s48 offen offset:1536 sc1 lds
    s_waitcnt lgkmcnt(4)
    v_mfma_f32_32x32x16_bf16 v[64:79], a[56:59], v[56:59], v[64:79]
    ds_read_b128 v[48:51], v13 offset:640
    v_mfma_f32_32x32x16_bf16 v[64:79], a[60:63], v[60:63], v[64:79]
    ds_read_b128 v[52:55], v13 offset:672
    s_add_u32 m0, s49, 5488
    s_nop 0
    buffer_load_dwordx4 v2, s[12:15], s48 offen offset:1792 sc1 lds
    s_waitcnt lgkmcnt(4)
    v_mfma_f32_32x32x16_bf16 v[64:79], a[64:67], v[32:35], v[64:79]
    ds_read_b128 v[56:59], v13 offset:704
    v_mfma_f32_32x32x16_bf16 v[64:79], a[68:71], v[36:39], v[64:79]
    ds_read_b128 v[60:63], v13 offset:736
    s_waitcnt lgkmcnt(4)
    v_mfma_f32_32x32x16_bf16 v[64:79], a[72:75], v[40:43], v[64:79]
    ds_read_b128 v[32:35], v13 offset:768
    v_mfma_f32_32x32x16_bf16 v[64:79], a[76:79], v[44:47], v[64:79]
    ds_read_b128 v[36:39], v13 offset:800
    s_waitcnt lgkmcnt(4)
    v_mfma_f32_32x32x16_bf16 v[64:79], a[80:83], v[48:51], v[64:79]
    ds_read_b128 v[40:43], v13 offset:832
    v_mfma_f32_32x32x16_bf16 v[64:79], a[84:87], v[52:55], v[64:79]
    ds_read_b128 v[44:47], v13 offset:864
    s_waitcnt lgkmcnt(4)
    v_mfma_f32_32x32x16_bf16 v[64:79], a[88:91], v[56:59], v[64:79]
    ds_read_b128 v[48:51], v13 offset:896
    v_mfma_f32_32x32x16_bf16 v[64:79], a[92:95], v[60:63], v[64:79]
    ds_read_b128 v[52:55], v13 offset:928
    s_waitcnt lgkmcnt(4)
    v_mfma_f32_32x32x16_bf16 v[64:79], a[96:99], v[32:35], v[64:79]
    ds_read_b128 v[56:59], v13 offset:960
    v_mfma_f32_32x32x16_bf16 v[64:79], a[100:103], v[36:39], v[64:79]
    ds_read_b128 v[60:63], v13 offset:992
    s_waitcnt lgkmcnt(4)
    v_mfma_f32_32x32x16_bf16 v[64:79], a[104:107], v[40:43], v[64:79]
    v_mfma_f32_32x32x16_bf16 v[64:79], a[108:111], v[44:47], v[64:79]
    s_waitcnt lgkmcnt(2)
    v_mfma_f32_32x32x16_bf16 v[64:79], a[112:115], v[48:51], v[64:79]
    v_mfma_f32_32x32x16_bf16 v[64:79], a[116:119], v[52:55], v[64:79]
    s_waitcnt lgkmcnt(0)
    v_mfma_f32_32x32x16_bf16 v[64:79], a[120:123], v[56:59], v[64:79]
    v_mfma_f32_32x32x16_bf16 v[64:79], a[124:127], v[60:63], v[64:79]
    s_add_u32 s45, s53, 131072
    s_add_u32 s46, s58, 2
    s_cmp_lt_u32 s46, s51
    s_cselect_b32 s48, s45, 0x20000000
    s_mov_b32 s49, s54
    s_waitcnt vmcnt(16)
    s_barrier
    ds_read_b128 v[32:35], v13 offset:33280
    ds_read_b128 v[36:39], v13 offset:33312
    ds_read_b128 v[40:43], v13 offset:33344
    ds_read_b128 v[44:47], v13 offset:33376
    ds_read_b128 v[48:51], v13 offset:33408
    ds_read_b128 v[52:55], v13 offset:33440
    s_waitcnt lgkmcnt(4)
    v_mfma_f32_32x32x16_bf16 v[64:79], a[128:131], v[32:35], v[64:79]
    ds_read_b128 v[56:59], v13 offset:33472
    v_mfma_f32_32x32x16_bf16 v[64:79], a[132:135], v[36:39], v[64:79]
    ds_read_b128 v[60:63], v13 offset:33504
    s_add_u32 m0, s49, 0
    s_nop 0
    buffer_load_dwordx4 v2, s[12:15], s48 offen offset:0 sc1 lds
    s_waitcnt lgkmcnt(4)
    v_mfma_f32_32x32x16_bf16 v[64:79], a[136:139], v[40:43], v[64:79]
    ds_read_b128 v[32:35], v13 offset:33536
    v_mfma_f32_32x32x16_bf16 v[64:79], a[140:143], v[44:47], v[64:79]
    ds_read_b128 v[36:39], v13 offset:33568
    s_add_u32 m0, s49, 784
    s_nop 0
    buffer_load_dwordx4 v2, s[12:15], s48 offen offset:256 sc1 lds
    s_waitcnt lgkmcnt(4)
    v_mfma_f32_32x32x16_bf16 v[64:79], a[144:147], v[48:51], v[64:79]
    ds_read_b128 v[40:43], v13 offset:33600
    v_mfma_f32_32x32x16_bf16 v[64:79], a[148:151], v[52:55], v[64:79]
    ds_read_b128 v[44:47], v13 offset:33632
    s_add_u32 m0, s49, 1568
    s_nop 0
    buffer_load_dwordx4 v2, s[12:15], s48 offen offset:512 sc1 lds
    s_waitcnt lgkmcnt(4)
    v_mfma_f32_32x32x16_bf16 v[64:79], a[152:155], v[56:59], v[64:79]
    ds_read_b128 v[48:51], v13 offset:33664
    v_mfma_f32_32x32x16_bf16 v[64:79], a[156:159], v[60:63], v[64:79]
    ds_read_b128 v[52:55], v13 offset:33696
    s_add_u32 m0, s49, 2352
    s_nop 0
    buffer_load_dwordx4 v2, s[12:15], s48 offen offset:768 sc1 lds
    s_waitcnt lgkmcnt(4)
    v_mfma_f32_32x32x16_bf16 v[64:79], a[160:163], v[32:35], v[64:79]
    ds_read_b128 v[56:59], v13 offset:33728
    v_mfma_f32_32x32x16_bf16 v[64:79], a[164:167], v[36:39], v[64:79]
    ds_read_b128 v[60:63], v13 offset:33760
    s_add_u32 m0, s49, 3136
    s_nop 0
    buffer_load_dwordx4 v2, s[12:15], s48 offen offset:1024 sc1 lds
    s_waitcnt lgkmcnt(4)
    v_mfma_f32_32x32x16_bf16 v[64:79], a[168:171], v[40:43], v[64:79]
    ds_read_b128 v[32:35], v13 offset:33792
    v_mfma_f32_32x32x16_bf16 v[64:79], a[172:175], v[44:47], v[64:79]
    ds_read_b128 v[36:39], v13 offset:33824
    s_add_u32 m0, s49, 3920
    s_nop 0
    buffer_load_dwordx4 v2, s[12:15], s48 offen offset:1280 sc1 lds
    s_waitcnt lgkmcnt(4)
    v_mfma_f32_32x32x16_bf16 v[64:79], a[176:179], v[48:51], v[64:79]
    ds_read_b128 v[40:43], v13 offset:33856
    v_mfma_f32_32x32x16_bf16 v[64:79], a[180:183], v[52:55], v[64:79]
    ds_read_b128 v[44:47], v13 offset:33888
    s_add_u32 m0, s49, 4704
    s_nop 0
    buffer_load_dwordx4 v2, s[12:15], s48 offen offset:1536 sc1 lds
    s_waitcnt lgkmcnt(4)
    v_mfma_f32_32x32x16_bf16 v[64:79], a[184:187], v[56:59], v[64:79]
    ds_read_b128 v[48:51], v13 offset:33920
    v_mfma_f32_32x32x16_bf16 v[64:79], a[188:191], v[60:63], v[64:79]
    ds_read_b128 v[52:55], v13 offset:33952
    s_add_u32 m0, s49, 5488
    s_nop 0
    buffer_load_dwordx4 v2, s[12:15], s48 offen offset:1792 sc1 lds
    s_waitcnt lgkmcnt(4)
    v_mfma_f32_32x32x16_bf16 v[64:79], a[192:195], v[32:35], v[64:79]
    ds_read_b128 v[56:59], v13 offset:33984
    v_mfma_f32_32x32x16_bf16 v[64:79], a[196:199], v[36:39], v[64:79]
    ds_read_b128 v[60:63], v13 offset:34016
    s_waitcnt lgkmcnt(4)
    v_mfma_f32_32x32x16_bf16 v[64:79], a[200:203], v[40:43], v[64:79]
    ds_read_b128 v[32:35], v13 offset:34048
    v_mfma_f32_32x32x16_bf16 v[64:79], a[204:207], v[44:47], v[64:79]
    ds_read_b128 v[36:39], v13 offset:34080
    s_waitcnt lgkmcnt(4)
    v_mfma_f32_32x32x16_bf16 v[64:79], a[208:211], v[48:51], v[64:79]
    ds_read_b128 v[40:43], v13 offset:34112
    v_mfma_f32_32x32x16_bf16 v[64:79], a[212:215], v[52:55], v[64:79]
    ds_read_b128 v[44:47], v13 offset:34144
    s_waitcnt lgkmcnt(4)
    v_mfma_f32_32x32x16_bf16 v[64:79], a[216:219], v[56:59], v[64:79]
    ds_read_b128 v[48:51], v13 offset:34176
    v_mfma_f32_32x32x16_bf16 v[64:79], a[220:223], v[60:63], v[64:79]
    ds_read_b128 v[52:55], v13 offset:34208
    s_waitcnt lgkmcnt(4)
    v_mfma_f32_32x32x16_bf16 v[64:79], a[224:227], v[32:35], v[64:79]
    ds_read_b128 v[56:59], v13 offset:34240
    v_mfma_f32_32x32x16_bf16 v[64:79], a[228:231], v[36:39], v[64:79]
    ds_read_b128 v[60:63], v13 offset:34272
    s_waitcnt lgkmcnt(4)
    v_mfma_f32_32x32x16_bf16 v[64:79], a[232:235], v[40:43], v[64:79]
    v_mfma_f32_32x32x16_bf16 v[64:79], a[236:239], v[44:47], v[64:79]
    s_waitcnt lgkmcnt(2)
    v_mfma_f32_32x32x16_bf16 v[64:79], a[240:243], v[48:51], v[64:79]
    v_mfma_f32_32x32x16_bf16 v[64:79], a[244:247], v[52:55], v[64:79]
    s_waitcnt lgkmcnt(0)
    v_mfma_f32_32x32x16_bf16 v[64:79], a[248:251], v[56:59], v[64:79]
    v_mfma_f32_32x32x16_bf16 v[64:79], a[252:255], v[60:63], v[64:79]
    s_add_u32 s53, s53, 65536
    s_add_u32 s58, s58, 1
    v_add_u32 v13, s59, v13
    s_add_u32 s54, s54, s59
    s_sub_u32 s55, s55, s59
    s_sub_u32 s59, 0, s59
    s_lshl_b32 s45, s44, 11
    s_add_u32 s45, s45, s57
    s_add_u32 s57, s57, 229376
    s_nop 3
    v_cvt_pk_bf16_f32 v64, v64, v64
    v_lshlrev_b32 v64, 16, v64
    v_add_f32 v64, v64, v96
    v_cvt_pk_bf16_f32 v64, v64, v64
    v_lshlrev_b32 v64, 16, v64
    v_cvt_pk_bf16_f32 v65, v65, v65
    v_lshlrev_b32 v65, 16, v65
    v_add_f32 v65, v65, v97
    v_cvt_pk_bf16_f32 v65, v65, v65
    v_lshlrev_b32 v65, 16, v65
    v_cvt_pk_bf16_f32 v66, v66, v66
    v_lshlrev_b32 v66, 16, v66
    v_add_f32 v66, v66, v98
    v_cvt_pk_bf16_f32 v66, v66, v66
    v_lshlrev_b32 v66, 16, v66
    v_cvt_pk_bf16_f32 v67, v67, v67
    v_lshlrev_b32 v67, 16, v67
    v_add_f32 v67, v67, v99
    v_cvt_pk_bf16_f32 v67, v67, v67
    v_lshlrev_b32 v67, 16, v67
    v_cvt_pk_bf16_f32 v68, v68, v68
    v_lshlrev_b32 v68, 16, v68
    v_add_f32 v68, v68, v100
    v_cvt_pk_bf16_f32 v68, v68, v68
    v_lshlrev_b32 v68, 16, v68
    v_cvt_pk_bf16_f32 v69, v69, v69
    v_lshlrev_b32 v69, 16, v69
    v_add_f32 v69, v69, v101
    v_cvt_pk_bf16_f32 v69, v69, v69
    v_lshlrev_b32 v69, 16, v69
    v_cvt_pk_bf16_f32 v70, v70, v70
    v_lshlrev_b32 v70, 16, v70
    v_add_f32 v70, v70, v102
    v_cvt_pk_bf16_f32 v70, v70, v70
    v_lshlrev_b32 v70, 16, v70
    v_cvt_pk_bf16_f32 v71, v71, v71
    v_lshlrev_b32 v71, 16, v71
    v_add_f32 v71, v71, v103
    v_cvt_pk_bf16_f32 v71, v71, v71
    v_lshlrev_b32 v71, 16, v71
    v_cvt_pk_bf16_f32 v72, v72, v72
    v_lshlrev_b32 v72, 16, v72
    v_add_f32 v72, v72, v104
    v_cvt_pk_bf16_f32 v72, v72, v72
    v_lshlrev_b32 v72, 16, v72
    v_cvt_pk_bf16_f32 v73, v73, v73
    v_lshlrev_b32 v73, 16, v73
    v_add_f32 v73, v73, v105
    v_cvt_pk_bf16_f32 v73, v73, v73
    v_lshlrev_b32 v73, 16, v73
    v_cvt_pk_bf16_f32 v74, v74, v74
    v_lshlrev_b32 v74, 16, v74
    v_add_f32 v74, v74, v106
    v_cvt_pk_bf16_f32 v74, v74, v74
    v_lshlrev_b32 v74, 16, v74
    v_cvt_pk_bf16_f32 v75, v75, v75
    v_lshlrev_b32 v75, 16, v75
    v_add_f32 v75, v75, v107
    v_cvt_pk_bf16_f32 v75, v75, v75
    v_lshlrev_b32 v75, 16, v75
    v_cvt_pk_bf16_f32 v76, v76, v76
    v_lshlrev_b32 v76, 16, v76
    v_add_f32 v76, v76, v108
    v_cvt_pk_bf16_f32 v76, v76, v76
    v_lshlrev_b32 v76, 16, v76
    v_cvt_pk_bf16_f32 v77, v77, v77
    v_lshlrev_b32 v77, 16, v77
    v_add_f32 v77, v77, v109
    v_cvt_pk_bf16_f32 v77, v77, v77
    v_lshlrev_b32 v77, 16, v77
    v_cvt_pk_bf16_f32 v78, v78, v78
    v_lshlrev_b32 v78, 16, v78
    v_add_f32 v78, v78, v110
    v_cvt_pk_bf16_f32 v78, v78, v78
    v_lshlrev_b32 v78, 16, v78
    v_cvt_pk_bf16_f32 v79, v79, v79
    v_lshlrev_b32 v79, 16, v79
    v_add_f32 v79, v79, v111
    v_cvt_pk_bf16_f32 v79, v79, v79
    v_lshlrev_b32 v79, 16, v79
    v_mul_f32 v80, v64, v64
    v_mul_f32 v80, 0x3d372713, v80
    v_add_f32 v80, 1.0, v80
    v_mul_f32 v80, v80, v64
    v_mul_f32 v80, 0xc0135761, v80
    v_mul_f32 v81, v65, v65
    v_mul_f32 v81, 0x3d372713, v81
    v_add_f32 v81, 1.0, v81
    v_mul_f32 v81, v81, v65
    v_mul_f32 v81, 0xc0135761, v81
    v_mul_f32 v82, v66, v66
    v_mul_f32 v82, 0x3d372713, v82
    v_add_f32 v82, 1.0, v82
    v_mul_f32 v82, v82, v66
    v_mul_f32 v82, 0xc0135761, v82
    v_mul_f32 v83, v67, v67
    v_mul_f32 v83, 0x3d372713, v83
    v_add_f32 v83, 1.0, v83
    v_mul_f32 v83, v83, v67
    v_mul_f32 v83, 0xc0135761, v83
    v_mul_f32 v84, v68, v68
    v_mul_f32 v84, 0x3d372713, v84
    v_add_f32 v84, 1.0, v84
    v_mul_f32 v84, v84, v68
    v_mul_f32 v84, 0xc0135761, v84
    v_mul_f32 v85, v69, v69
    v_mul_f32 v85, 0x3d372713, v85
    v_add_f32 v85, 1.0, v85
    v_mul_f32 v85, v85, v69
    v_mul_f32 v85, 0xc0135761, v85
    v_mul_f32 v86, v70, v70
    v_mul_f32 v86, 0x3d372713, v86
    v_add_f32 v86, 1.0, v86
    v_mul_f32 v86, v86, v70
    v_mul_f32 v86, 0xc0135761, v86
    v_mul_f32 v87, v71, v71
    v_mul_f32 v87, 0x3d372713, v87
    v_add_f32 v87, 1.0, v87
    v_mul_f32 v87, v87, v71
    v_mul_f32 v87, 0xc0135761, v87
    v_mul_f32 v88, v72, v72
    v_mul_f32 v88, 0x3d372713, v88
    v_add_f32 v88, 1.0, v88
    v_mul_f32 v88, v88, v72
    v_mul_f32 v88, 0xc0135761, v88
    v_mul_f32 v89, v73, v73
    v_mul_f32 v89, 0x3d372713, v89
    v_add_f32 v89, 1.0, v89
    v_mul_f32 v89, v89, v73
    v_mul_f32 v89, 0xc0135761, v89
    v_mul_f32 v90, v74, v74
    v_mul_f32 v90, 0x3d372713, v90
    v_add_f32 v90, 1.0, v90
    v_mul_f32 v90, v90, v74
    v_mul_f32 v90, 0xc0135761, v90
    v_mul_f32 v91, v75, v75
    v_mul_f32 v91, 0x3d372713, v91
    v_add_f32 v91, 1.0, v91
    v_mul_f32 v91, v91, v75
    v_mul_f32 v91, 0xc0135761, v91
    v_mul_f32 v92, v76, v76
    v_mul_f32 v92, 0x3d372713, v92
    v_add_f32 v92, 1.0, v92
    v_mul_f32 v92, v92, v76
    v_mul_f32 v92, 0xc0135761, v92
    v_mul_f32 v93, v77, v77
    v_mul_f32 v93, 0x3d372713, v93
    v_add_f32 v93, 1.0, v93
    v_mul_f32 v93, v93, v77
    v_mul_f32 v93, 0xc0135761, v93
    v_mul_f32 v94, v78, v78
    v_mul_f32 v94, 0x3d372713, v94
    v_add_f32 v94, 1.0, v94
    v_mul_f32 v94, v94, v78
    v_mul_f32 v94, 0xc0135761, v94
    v_mul_f32 v95, v79, v79
    v_mul_f32 v95, 0x3d372713, v95
    v_add_f32 v95, 1.0, v95
    v_mul_f32 v95, v95, v79
    v_mul_f32 v95, 0xc0135761, v95
    v_exp_f32 v80, v80
    v_exp_f32 v81, v81
    v_exp_f32 v82, v82
    v_exp_f32 v83, v83
    v_exp_f32 v84, v84
    v_exp_f32 v85, v85
    v_exp_f32 v86, v86
    v_exp_f32 v87, v87
    v_exp_f32 v88, v88
    v_exp_f32 v89, v89
    v_exp_f32 v90, v90
    v_exp_f32 v91, v91
    v_exp_f32 v92, v92
    v_exp_f32 v93, v93
    v_exp_f32 v94, v94
    v_exp_f32 v95, v95
    v_add_f32 v80, 1.0, v80
    v_add_f32 v81, 1.0, v81
    v_add_f32 v82, 1.0, v82
    v_add_f32 v83, 1.0, v83
    v_add_f32 v84, 1.0, v84
    v_add_f32 v85, 1.0, v85
    v_add_f32 v86, 1.0, v86
    v_add_f32 v87, 1.0, v87
    v_add_f32 v88, 1.0, v88
    v_add_f32 v89, 1.0, v89
    v_add_f32 v90, 1.0, v90
    v_add_f32 v91, 1.0, v91
    v_add_f32 v92, 1.0, v92
    v_add_f32 v93, 1.0, v93
    v_add_f32 v94, 1.0, v94
    v_add_f32 v95, 1.0, v95
    v_rcp_f32 v80, v80
    v_rcp_f32 v81, v81
    v_rcp_f32 v82, v82
    v_rcp_f32 v83, v83
    v_rcp_f32 v84, v84
    v_rcp_f32 v85, v85
    v_rcp_f32 v86, v86
    v_rcp_f32 v87, v87
    v_rcp_f32 v88, v88
    v_rcp_f32 v89, v89
    v_rcp_f32 v90, v90
    v_rcp_f32 v91, v91
    v_rcp_f32 v92, v92
    v_rcp_f32 v93, v93
    v_rcp_f32 v94, v94
    v_rcp_f32 v95, v95
    v_mul_f32 v64, v64, v80
    v_mul_f32 v65, v65, v81
    v_mul_f32 v66, v66, v82
    v_mul_f32 v67, v67, v83
    v_mul_f32 v68, v68, v84
    v_mul_f32 v69, v69, v85
    v_mul_f32 v70, v70, v86
    v_mul_f32 v71, v71, v87
    v_mul_f32 v72, v72, v88
    v_mul_f32 v73, v73, v89
    v_mul_f32 v74, v74, v90
    v_mul_f32 v75, v75, v91
    v_mul_f32 v76, v76, v92
    v_mul_f32 v77, v77, v93
    v_mul_f32 v78, v78, v94
    v_mul_f32 v79, v79, v95
    v_cvt_pk_bf16_f32 v64, v64, v65
    v_cvt_pk_bf16_f32 v65, v66, v67
    v_cvt_pk_bf16_f32 v66, v68, v69
    v_cvt_pk_bf16_f32 v67, v70, v71
    v_cvt_pk_bf16_f32 v68, v72, v73
    v_cvt_pk_bf16_f32 v69, v74, v75
    v_cvt_pk_bf16_f32 v70, v76, v77
    v_cvt_pk_bf16_f32 v71, v78, v79
    ds_write_b128 v6, v[64:67]
    ds_write_b128 v6, v[68:71] offset:16
    s_waitcnt lgkmcnt(0)
    s_barrier
    ds_read_b128 v[80:83], v8
    ds_read_b128 v[84:87], v8 offset:1088
    s_waitcnt lgkmcnt(1)
    buffer_store_dwordx4 v[80:83], v10, s[12:15], s45 offen sc1
    s_waitcnt lgkmcnt(0)
    buffer_store_dwordx4 v[84:87], v10, s[12:15], s45 offen offset:1024 sc1
    s_cmp_lt_u32 s58, s51
    s_cbranch_scc1 L_e_loop_156
    s_waitcnt vmcnt(0)
    s_barrier
    s_cmp_lg_u32 s44, 0
    s_cbranch_scc1 L_pub_157
    v_mov_b32 v30, s62
    v_mov_b32 v31, 0
    s_mov_b64 exec, 1
    buffer_store_dword v30, v31, s[12:15], s67 offen sc1
    s_mov_b64 exec, -1
L_pub_157:
    s_branch L_b_loop_148
L_role_c_130:
    s_load_dwordx2 s[6:7], s[0:1], 80
    s_load_dwordx2 s[8:9], s[0:1], 88
    s_load_dwordx2 s[10:11], s[0:1], 112
    s_waitcnt lgkmcnt(0)
    s_mov_b32 s24, s6
    s_and_b32 s25, s7, 0xffff
    s_mov_b32 s26, 0x700000
    s_mov_b32 s27, 0x00020000
    s_mov_b32 s28, s8
    s_and_b32 s29, s9, 0xffff
    s_mov_b32 s30, 0x800
    s_mov_b32 s31, 0x00020000
    s_mov_b32 s32, s10
    s_and_b32 s33, s11, 0xffff
    s_mov_b32 s34, 0x400000
    s_mov_b32 s35, 0x00020000
    s_mul_i32 s46, s38, 1835008
    s_lshl_b32 s45, s68, 8
    s_add_u32 s46, s46, s45
    s_waitcnt vmcnt(0)
    s_barrier
    v_lshrrev_b32 v20, 4, v1
    s_lshl_b32 s45, s44, 2
    v_add_u32 v21, s45, v20
    s_mov_b32 s45, 2048
    v_mul_lo_u32 v21, v21, s45
    v_lshlrev_b32 v22, 2, v20
    v_and_b32 v23, 15, v1
    v_xor_b32 v22, v22, v23
    v_lshlrev_b32 v22, 4, v22
    v_add_u32 v21, v21, v22
    v_bfe_u32 v22, v1, 2, 2
    v_lshrrev_b32 v23, 5, v1
    v_lshlrev_b32 v23, 3, v23
    v_add_u32 v23, v23, v22
    v_lshlrev_b32 v23, 8, v23
    v_xor_b32 v22, s44, v22
    v_lshlrev_b32 v22, 6, v22
    v_add_u32 v23, v23, v22
    v_and_b32 v22, 1, v1
    v_lshlrev_b32 v22, 5, v22
    v_add_u32 v23, v23, v22
    v_and_b32 v22, 16, v1
    v_add_u32 v23, v23, v22
    v_and_b32 v22, 2, v1
    v_lshlrev_b32 v22, 2, v22
    v_add_u32 v23, v23, v22
    v_add_u32 v24, 65536, v23
    v_add_u32 v25, 131072, v23
    s_lshl_b32 s47, s44, 10
    s_add_u32 s45, s46, 0x0
    s_add_u32 m0, s47, 0
    s_nop 0
    buffer_load_dwordx4 v21, s[24:27], s45 offen nt lds
    s_add_u32 s45, s46, 0x8000
    s_add_u32 m0, s47, 4096
    s_nop 0
    buffer_load_dwordx4 v21, s[24:27], s45 offen nt lds
    s_add_u32 s45, s46, 0x10000
    s_add_u32 m0, s47, 8192
    s_nop 0
    buffer_load_dwordx4 v21, s[24:27], s45 offen nt lds
    s_add_u32 s45, s46, 0x18000
    s_add_u32 m0, s47, 12288
    s_nop 0
    buffer_load_dwordx4 v21, s[24:27], s45 offen nt lds
    s_add_u32 s45, s46, 0x20000
    s_add_u32 m0, s47, 16384
    s_nop 0
    buffer_load_dwordx4 v21, s[24:27], s45 offen nt lds
    s_add_u32 s45, s46, 0x28000
    s_add_u32 m0, s47, 20480
    s_nop 0
    buffer_load_dwordx4 v21, s[24:27], s45 offen nt lds
    s_add_u32 s45, s46, 0x30000
    s_add_u32 m0, s47, 24576
    s_nop 0
    buffer_load_dwordx4 v21, s[24:27], s45 offen nt lds
    s_add_u32 s45, s46, 0x38000
    s_add_u32 m0, s47, 28672
    s_nop 0
    buffer_load_dwordx4 v21, s[24:27], s45 offen nt lds
    s_add_u32 s45, s46, 0x40000
    s_add_u32 m0, s47, 32768
    s_nop 0
    buffer_load_dwordx4 v21, s[24:27], s45 offen nt lds
    s_add_u32 s45, s46, 0x48000
    s_add_u32 m0, s47, 36864
    s_nop 0
    buffer_load_dwordx4 v21, s[24:27], s45 offen nt lds
    s_add_u32 s45, s46, 0x50000
    s_add_u32 m0, s47, 40960
    s_nop 0
    buffer_load_dwordx4 v21, s[24:27], s45 offen nt lds
    s_add_u32 s45, s46, 0x58000
    s_add_u32 m0, s47, 45056
    s_nop 0
    buffer_load_dwordx4 v21, s[24:27], s45 offen nt lds
    s_add_u32 s45, s46, 0x60000
    s_add_u32 m0, s47, 49152
    s_nop 0
    buffer_load_dwordx4 v21, s[24:27], s45 offen nt lds
    s_add_u32 s45, s46, 0x68000
    s_add_u32 m0, s47, 53248
    s_nop 0
    buffer_load_dwordx4 v21, s[24:27], s45 offen nt lds
    s_add_u32 s45, s46, 0x70000
    s_add_u32 m0, s47, 57344
    s_nop 0
    buffer_load_dwordx4 v21, s[24:27], s45 offen nt lds
    s_add_u32 s45, s46, 0x78000
    s_add_u32 m0, s47, 61440
    s_nop 0
    buffer_load_dwordx4 v21, s[24:27], s45 offen nt lds
    s_add_u32 s45, s46, 0x80000
    s_add_u32 m0, s47, 65536
    s_nop 0
    buffer_load_dwordx4 v21, s[24:27], s45 offen nt lds
    s_add_u32 s45, s46, 0x88000
    s_add_u32 m0, s47, 69632
    s_nop 0
    buffer_load_dwordx4 v21, s[24:27], s45 offen nt lds
    s_add_u32 s45, s46, 0x90000
    s_add_u32 m0, s47, 73728
    s_nop 0
    buffer_load_dwordx4 v21, s[24:27], s45 offen nt lds
    s_add_u32 s45, s46, 0x98000
    s_add_u32 m0, s47, 77824
    s_nop 0
    buffer_load_dwordx4 v21, s[24:27], s45 offen nt lds
    s_add_u32 s45, s46, 0xa0000
    s_add_u32 m0, s47, 81920
    s_nop 0
    buffer_load_dwordx4 v21, s[24:27], s45 offen nt lds
    s_add_u32 s45, s46, 0xa8000
    s_add_u32 m0, s47, 86016
    s_nop 0
    buffer_load_dwordx4 v21, s[24:27], s45 offen nt lds
    s_add_u32 s45, s46, 0xb0000
    s_add_u32 m0, s47, 90112
    s_nop 0
    buffer_load_dwordx4 v21, s[24:27], s45 offen nt lds
    s_add_u32 s45, s46, 0xb8000
    s_add_u32 m0, s47, 94208
    s_nop 0
    buffer_load_dwordx4 v21, s[24:27], s45 offen nt lds
    s_add_u32 s45, s46, 0xc0000
    s_add_u32 m0, s47, 98304
    s_nop 0
    buffer_load_dwordx4 v21, s[24:27], s45 offen nt lds
    s_add_u32 s45, s46, 0xc8000
    s_add_u32 m0, s47, 102400
    s_nop 0
    buffer_load_dwordx4 v21, s[24:27], s45 offen nt lds
    s_add_u32 s45, s46, 0xd0000
    s_add_u32 m0, s47, 106496
    s_nop 0
    buffer_load_dwordx4 v21, s[24:27], s45 offen nt lds
    s_add_u32 s45, s46, 0xd8000
    s_add_u32 m0, s47, 110592
    s_nop 0
    buffer_load_dwordx4 v21, s[24:27], s45 offen nt lds
    s_add_u32 s45, s46, 0xe0000
    s_add_u32 m0, s47, 114688
    s_nop 0
    buffer_load_dwordx4 v21, s[24:27], s45 offen nt lds
    s_add_u32 s45, s46, 0xe8000
    s_add_u32 m0, s47, 118784
    s_nop 0
    buffer_load_dwordx4 v21, s[24:27], s45 offen nt lds
    s_add_u32 s45, s46, 0xf0000
    s_add_u32 m0, s47, 122880
    s_nop 0
    buffer_load_dwordx4 v21, s[24:27], s45 offen nt lds
    s_add_u32 s45, s46, 0xf8000
    s_add_u32 m0, s47, 126976
    s_nop 0
    buffer_load_dwordx4 v21, s[24:27], s45 offen nt lds
    s_waitcnt vmcnt(28)
    s_barrier
    s_add_u32 s45, s46, 0x100000
    s_add_u32 m0, s47, 131072
    s_nop 0
    buffer_load_dwordx4 v21, s[24:27], s45 offen nt lds
    s_add_u32 s45, s46, 0x108000
    s_add_u32 m0, s47, 135168
    s_nop 0
    buffer_load_dwordx4 v21, s[24:27], s45 offen nt lds
    s_add_u32 s45, s46, 0x110000
    s_add_u32 m0, s47, 139264
    s_nop 0
    buffer_load_dwordx4 v21, s[24:27], s45 offen nt lds
    s_add_u32 s45, s46, 0x118000
    s_add_u32 m0, s47, 143360
    s_nop 0
    buffer_load_dwordx4 v21, s[24:27], s45 offen nt lds
    ds_read_b64_tr_b16 a[0:1], v23 offset:0
    ds_read_b64_tr_b16 a[2:3], v23 offset:1024
    ds_read_b64_tr_b16 a[4:5], v23 offset:4096
    ds_read_b64_tr_b16 a[6:7], v23 offset:5120
    ds_read_b64_tr_b16 a[8:9], v23 offset:8192
    ds_read_b64_tr_b16 a[10:11], v23 offset:9216
    ds_read_b64_tr_b16 a[12:13], v23 offset:12288
    ds_read_b64_tr_b16 a[14:15], v23 offset:13312
    s_waitcnt lgkmcnt(0)
    s_waitcnt vmcnt(28)
    s_barrier
    s_add_u32 s45, s46, 0x120000
    s_add_u32 m0, s47, 0
    s_nop 0
    buffer_load_dwordx4 v21, s[24:27], s45 offen nt lds
    s_add_u32 s45, s46, 0x128000
    s_add_u32 m0, s47, 4096
    s_nop 0
    buffer_load_dwordx4 v21, s[24:27], s45 offen nt lds
    s_add_u32 s45, s46, 0x130000
    s_add_u32 m0, s47, 8192
    s_nop 0
    buffer_load_dwordx4 v21, s[24:27], s45 offen nt lds
    s_add_u32 s45, s46, 0x138000
    s_add_u32 m0, s47, 12288
    s_nop 0
    buffer_load_dwordx4 v21, s[24:27], s45 offen nt lds
    ds_read_b64_tr_b16 a[16:17], v23 offset:16384
    ds_read_b64_tr_b16 a[18:19], v23 offset:17408
    ds_read_b64_tr_b16 a[20:21], v23 offset:20480
    ds_read_b64_tr_b16 a[22:23], v23 offset:21504
    ds_read_b64_tr_b16 a[24:25], v23 offset:24576
    ds_read_b64_tr_b16 a[26:27], v23 offset:25600
    ds_read_b64_tr_b16 a[28:29], v23 offset:28672
    ds_read_b64_tr_b16 a[30:31], v23 offset:29696
    s_waitcnt lgkmcnt(0)
    s_waitcnt vmcnt(28)
    s_barrier
    s_add_u32 s45, s46, 0x140000
    s_add_u32 m0, s47, 16384
    s_nop 0
    buffer_load_dwordx4 v21, s[24:27], s45 offen nt lds
    s_add_u32 s45, s46, 0x148000
    s_add_u32 m0, s47, 20480
    s_nop 0
    buffer_load_dwordx4 v21, s[24:27], s45 offen nt lds
    s_add_u32 s45, s46, 0x150000
    s_add_u32 m0, s47, 24576
    s_nop 0
    buffer_load_dwordx4 v21, s[24:27], s45 offen nt lds
    s_add_u32 s45, s46, 0x158000
    s_add_u32 m0, s47, 28672
    s_nop 0
    buffer_load_dwordx4 v21, s[24:27], s45 offen nt lds
    ds_read_b64_tr_b16 a[32:33], v23 offset:32768
    ds_read_b64_tr_b16 a[34:35], v23 offset:33792
    ds_read_b64_tr_b16 a[36:37], v23 offset:36864
    ds_read_b64_tr_b16 a[38:39], v23 offset:37888
    ds_read_b64_tr_b16 a[40:41], v23 offset:40960
    ds_read_b64_tr_b16 a[42:43], v23 offset:41984
    ds_read_b64_tr_b16 a[44:45], v23 offset:45056
    ds_read_b64_tr_b16 a[46:47], v23 offset:46080
    s_waitcnt lgkmcnt(0)
    s_waitcnt vmcnt(28)
    s_barrier
    s_add_u32 s45, s46, 0x160000
    s_add_u32 m0, s47, 32768
    s_nop 0
    buffer_load_dwordx4 v21, s[24:27], s45 offen nt lds
    s_add_u32 s45, s46, 0x168000
    s_add_u32 m0, s47, 36864
    s_nop 0
    buffer_load_dwordx4 v21, s[24:27], s45 offen nt lds
    s_add_u32 s45, s46, 0x170000
    s_add_u32 m0, s47, 40960
    s_nop 0
    buffer_load_dwordx4 v21, s[24:27], s45 offen nt lds
    s_add_u32 s45, s46, 0x178000
    s_add_u32 m0, s47, 45056
    s_nop 0
    buffer_load_dwordx4 v21, s[24:27], s45 offen nt lds
    ds_read_b64_tr_b16 a[48:49], v23 offset:49152
    ds_read_b64_tr_b16 a[50:51], v23 offset:50176
    ds_read_b64_tr_b16 a[52:53], v23 offset:53248
    ds_read_b64_tr_b16 a[54:55], v23 offset:54272
    ds_read_b64_tr_b16 a[56:57], v23 offset:57344
    ds_read_b64_tr_b16 a[58:59], v23 offset:58368
    ds_read_b64_tr_b16 a[60:61], v23 offset:61440
    ds_read_b64_tr_b16 a[62:63], v23 offset:62464
    s_waitcnt lgkmcnt(0)
    s_waitcnt vmcnt(28)
    s_barrier
    s_add_u32 s45, s46, 0x180000
    s_add_u32 m0, s47, 49152
    s_nop 0
    buffer_load_dwordx4 v21, s[24:27], s45 offen nt lds
    s_add_u32 s45, s46, 0x188000
    s_add_u32 m0, s47, 53248
    s_nop 0
    buffer_load_dwordx4 v21, s[24:27], s45 offen nt lds
    s_add_u32 s45, s46, 0x190000
    s_add_u32 m0, s47, 57344
    s_nop 0
    buffer_load_dwordx4 v21, s[24:27], s45 offen nt lds
    s_add_u32 s45, s46, 0x198000
    s_add_u32 m0, s47, 61440
    s_nop 0
    buffer_load_dwordx4 v21, s[24:27], s45 offen nt lds
    ds_read_b64_tr_b16 a[64:65], v24 offset:0
    ds_read_b64_tr_b16 a[66:67], v24 offset:1024
    ds_read_b64_tr_b16 a[68:69], v24 offset:4096
    ds_read_b64_tr_b16 a[70:71], v24 offset:5120
    ds_read_b64_tr_b16 a[72:73], v24 offset:8192
    ds_read_b64_tr_b16 a[74:75], v24 offset:9216
    ds_read_b64_tr_b16 a[76:77], v24 offset:12288
    ds_read_b64_tr_b16 a[78:79], v24 offset:13312
    s_waitcnt lgkmcnt(0)
    s_waitcnt vmcnt(28)
    s_barrier
    s_add_u32 s45, s46, 0x1a0000
    s_add_u32 m0, s47, 65536
    s_nop 0
    buffer_load_dwordx4 v21, s[24:27], s45 offen nt lds
    s_add_u32 s45, s46, 0x1a8000
    s_add_u32 m0, s47, 69632
    s_nop 0
    buffer_load_dwordx4 v21, s[24:27], s45 offen nt lds
    s_add_u32 s45, s46, 0x1b0000
    s_add_u32 m0, s47, 73728
    s_nop 0
    buffer_load_dwordx4 v21, s[24:27], s45 offen nt lds
    s_add_u32 s45, s46, 0x1b8000
    s_add_u32 m0, s47, 77824
    s_nop 0
    buffer_load_dwordx4 v21, s[24:27], s45 offen nt lds
    ds_read_b64_tr_b16 a[80:81], v24 offset:16384
    ds_read_b64_tr_b16 a[82:83], v24 offset:17408
    ds_read_b64_tr_b16 a[84:85], v24 offset:20480
    ds_read_b64_tr_b16 a[86:87], v24 offset:21504
    ds_read_b64_tr_b16 a[88:89], v24 offset:24576
    ds_read_b64_tr_b16 a[90:91], v24 offset:25600
    ds_read_b64_tr_b16 a[92:93], v24 offset:28672
    ds_read_b64_tr_b16 a[94:95], v24 offset:29696
    s_waitcnt lgkmcnt(0)
    s_waitcnt vmcnt(28)
    s_barrier
    ds_read_b64_tr_b16 a[96:97], v24 offset:32768
    ds_read_b64_tr_b16 a[98:99], v24 offset:33792
    ds_read_b64_tr_b16 a[100:101], v24 offset:36864
    ds_read_b64_tr_b16 a[102:103], v24 offset:37888
    ds_read_b64_tr_b16 a[104:105], v24 offset:40960
    ds_read_b64_tr_b16 a[106:107], v24 offset:41984
    ds_read_b64_tr_b16 a[108:109], v24 offset:45056
    ds_read_b64_tr_b16 a[110:111], v24 offset:46080
    s_waitcnt lgkmcnt(0)
    s_waitcnt vmcnt(24)
    s_barrier
    ds_read_b64_tr_b16 a[112:113], v24 offset:49152
    ds_read_b64_tr_b16 a[114:115], v24 offset:50176
    ds_read_b64_tr_b16 a[116:117], v24 offset:53248
    ds_read_b64_tr_b16 a[118:119], v24 offset:54272
    ds_read_b64_tr_b16 a[120:121], v24 offset:57344
    ds_read_b64_tr_b16 a[122:123], v24 offset:58368
    ds_read_b64_tr_b16 a[124:125], v24 offset:61440
    ds_read_b64_tr_b16 a[126:127], v24 offset:62464
    s_waitcnt lgkmcnt(0)
    s_waitcnt vmcnt(20)
    s_barrier
    ds_read_b64_tr_b16 a[128:129], v25 offset:0
    ds_read_b64_tr_b16 a[130:131], v25 offset:1024
    ds_read_b64_tr_b16 a[132:133], v25 offset:4096
    ds_read_b64_tr_b16 a[134:135], v25 offset:5120
    ds_read_b64_tr_b16 a[136:137], v25 offset:8192
    ds_read_b64_tr_b16 a[138:139], v25 offset:9216
    ds_read_b64_tr_b16 a[140:141], v25 offset:12288
    ds_read_b64_tr_b16 a[142:143], v25 offset:13312
    s_waitcnt lgkmcnt(0)
    s_waitcnt vmcnt(16)
    s_barrier
    ds_read_b64_tr_b16 a[144:145], v23 offset:0
    ds_read_b64_tr_b16 a[146:147], v23 offset:1024
    ds_read_b64_tr_b16 a[148:149], v23 offset:4096
    ds_read_b64_tr_b16 a[150:151], v23 offset:5120
    ds_read_b64_tr_b16 a[152:153], v23 offset:8192
    ds_read_b64_tr_b16 a[154:155], v23 offset:9216
    ds_read_b64_tr_b16 a[156:157], v23 offset:12288
    ds_read_b64_tr_b16 a[158:159], v23 offset:13312
    s_waitcnt lgkmcnt(0)
    s_waitcnt vmcnt(12)
    s_barrier
    ds_read_b64_tr_b16 a[160:161], v23 offset:16384
    ds_read_b64_tr_b16 a[162:163], v23 offset:17408
    ds_read_b64_tr_b16 a[164:165], v23 offset:20480
    ds_read_b64_tr_b16 a[166:167], v23 offset:21504
    ds_read_b64_tr_b16 a[168:169], v23 offset:24576
    ds_read_b64_tr_b16 a[170:171], v23 offset:25600
    ds_read_b64_tr_b16 a[172:173], v23 offset:28672
    ds_read_b64_tr_b16 a[174:175], v23 offset:29696
    s_waitcnt lgkmcnt(0)
    s_waitcnt vmcnt(8)
    s_barrier
    ds_read_b64_tr_b16 a[176:177], v23 offset:32768
    ds_read_b64_tr_b16 a[178:179], v23 offset:33792
    ds_read_b64_tr_b16 a[180:181], v23 offset:36864
    ds_read_b64_tr_b16 a[182:183], v23 offset:37888
    ds_read_b64_tr_b16 a[184:185], v23 offset:40960
    ds_read_b64_tr_b16 a[186:187], v23 offset:41984
    ds_read_b64_tr_b16 a[188:189], v23 offset:45056
    ds_read_b64_tr_b16 a[190:191], v23 offset:46080
    s_waitcnt lgkmcnt(0)
    s_waitcnt vmcnt(4)
    s_barrier
    ds_read_b64_tr_b16 a[192:193], v23 offset:49152
    ds_read_b64_tr_b16 a[194:195], v23 offset:50176
    ds_read_b64_tr_b16 a[196:197], v23 offset:53248
    ds_read_b64_tr_b16 a[198:199], v23 offset:54272
    ds_read_b64_tr_b16 a[200:201], v23 offset:57344
    ds_read_b64_tr_b16 a[202:203], v23 offset:58368
    ds_read_b64_tr_b16 a[204:205], v23 offset:61440
    ds_read_b64_tr_b16 a[206:207], v23 offset:62464
    s_waitcnt lgkmcnt(0)
    s_waitcnt vmcnt(0)
    s_barrier
    ds_read_b64_tr_b16 a[208:209], v24 offset:0
    ds_read_b64_tr_b16 a[210:211], v24 offset:1024
    ds_read_b64_tr_b16 a[212:213], v24 offset:4096
    ds_read_b64_tr_b16 a[214:215], v24 offset:5120
    ds_read_b64_tr_b16 a[216:217], v24 offset:8192
    ds_read_b64_tr_b16 a[218:219], v24 offset:9216
    ds_read_b64_tr_b16 a[220:221], v24 offset:12288
    ds_read_b64_tr_b16 a[222:223], v24 offset:13312
    s_waitcnt lgkmcnt(0)
    s_barrier
    buffer_load_dwordx4 v[80:83], v10, s[28:31], 0 offen
    buffer_load_dwordx4 v[84:87], v10, s[28:31], 0 offen offset:1024
    s_waitcnt vmcnt(0)
    v_lshlrev_b32 v96, 16, v80
    v_and_b32 v97, 0xffff0000, v80
    v_lshlrev_b32 v98, 16, v81
    v_and_b32 v99, 0xffff0000, v81
    v_lshlrev_b32 v100, 16, v82
    v_and_b32 v101, 0xffff0000, v82
    v_lshlrev_b32 v102, 16, v83
    v_and_b32 v103, 0xffff0000, v83
    v_lshlrev_b32 v104, 16, v84
    v_and_b32 v105, 0xffff0000, v84
    v_lshlrev_b32 v106, 16, v85
    v_and_b32 v107, 0xffff0000, v85
    v_lshlrev_b32 v108, 16, v86
    v_and_b32 v109, 0xffff0000, v86
    v_lshlrev_b32 v110, 16, v87
    v_and_b32 v111, 0xffff0000, v87
    s_cmp_lg_u32 s44, 0
    s_cbranch_scc1 L_pd_158
    v_mov_b32 v29, 132
    s_mov_b32 s46, 96
    s_mov_b64 exec, 1
    s_mov_b32 s70, 0
L_wp_159:
    buffer_load_dword v31, v29, s[16:19], 0 offen sc1
    s_add_u32 s70, s70, 1
    s_cmp_ge_u32 s70, 0x200000
    s_cbranch_scc1 L_w_done_108
    s_waitcnt vmcnt(0)
    v_cmp_gt_u32 vcc, s46, v31
    s_nop 1
    s_cbranch_vccz L_wp_159_ok
    s_sleep 3
    s_branch L_wp_159
L_wp_159_ok:
    s_mov_b64 exec, -1
L_pd_158:
    s_barrier
    v_lshlrev_b32 v29, 5, v1
    s_mov_b32 s45, 20480
    buffer_load_dwordx4 v[112:115], v29, s[12:15], s45 offen offset:0 sc1
    buffer_load_dwordx4 v[116:119], v29, s[12:15], s45 offen offset:16 sc1
    buffer_load_dwordx4 v[120:123], v29, s[12:15], s45 offen offset:2048 sc1
    buffer_load_dwordx4 v[124:127], v29, s[12:15], s45 offen offset:2064 sc1
    s_mov_b32 s45, 45056
    buffer_load_dwordx4 v[32:35], v29, s[12:15], s45 offen offset:0 sc1
    buffer_load_dwordx4 v[36:39], v29, s[12:15], s45 offen offset:16 sc1
    buffer_load_dwordx4 v[40:43], v29, s[12:15], s45 offen offset:2048 sc1
    buffer_load_dwordx4 v[44:47], v29, s[12:15], s45 offen offset:2064 sc1
    s_waitcnt vmcnt(0)
    v_add_f32 v112, v112, v32
    v_cvt_pk_bf16_f32 v112, v112, v112
    v_lshlrev_b32 v112, 16, v112
    v_add_f32 v113, v113, v33
    v_cvt_pk_bf16_f32 v113, v113, v113
    v_lshlrev_b32 v113, 16, v113
    v_add_f32 v114, v114, v34
    v_cvt_pk_bf16_f32 v114, v114, v114
    v_lshlrev_b32 v114, 16, v114
    v_add_f32 v115, v115, v35
    v_cvt_pk_bf16_f32 v115, v115, v115
    v_lshlrev_b32 v115, 16, v115
    v_add_f32 v116, v116, v36
    v_cvt_pk_bf16_f32 v116, v116, v116
    v_lshlrev_b32 v116, 16, v116
    v_add_f32 v117, v117, v37
    v_cvt_pk_bf16_f32 v117, v117, v117
    v_lshlrev_b32 v117, 16, v117
    v_add_f32 v118, v118, v38
    v_cvt_pk_bf16_f32 v118, v118, v118
    v_lshlrev_b32 v118, 16, v118
    v_add_f32 v119, v119, v39
    v_cvt_pk_bf16_f32 v119, v119, v119
    v_lshlrev_b32 v119, 16, v119
    v_add_f32 v120, v120, v40
    v_cvt_pk_bf16_f32 v120, v120, v120
    v_lshlrev_b32 v120, 16, v120
    v_add_f32 v121, v121, v41
    v_cvt_pk_bf16_f32 v121, v121, v121
    v_lshlrev_b32 v121, 16, v121
    v_add_f32 v122, v122, v42
    v_cvt_pk_bf16_f32 v122, v122, v122
    v_lshlrev_b32 v122, 16, v122
    v_add_f32 v123, v123, v43
    v_cvt_pk_bf16_f32 v123, v123, v123
    v_lshlrev_b32 v123, 16, v123
    v_add_f32 v124, v124, v44
    v_cvt_pk_bf16_f32 v124, v124, v124
    v_lshlrev_b32 v124, 16, v124
    v_add_f32 v125, v125, v45
    v_cvt_pk_bf16_f32 v125, v125, v125
    v_lshlrev_b32 v125, 16, v125
    v_add_f32 v126, v126, v46
    v_cvt_pk_bf16_f32 v126, v126, v126
    v_lshlrev_b32 v126, 16, v126
    v_add_f32 v127, v127, v47
    v_cvt_pk_bf16_f32 v127, v127, v127
    v_lshlrev_b32 v127, 16, v127
    s_mul_i32 s52, s38, 57344
    s_add_u32 s52, s52, 0x6000000
    s_lshl_b32 s56, s38, 23
    s_lshl_b32 s45, s68, 9
    s_add_u32 s56, s56, s45
    s_add_u32 s56, s56, 0xc000000
L_c_loop_160:
    s_cmp_eq_u64 s[36:37], 0
    s_cbranch_scc1 L_w_done_108
    s_ff1_i32_b64 s50, s[36:37]
    s_bitset0_b64 s[36:37], s50
    s_lshr_b64 s[74:75], s[72:73], s50
    s_ff1_i32_b64 s51, s[74:75]
    s_add_u32 s51, s51, 1
    s_add_u32 s62, s50, s51
    s_mul_i32 s45, s38, 896
    s_add_u32 s45, s45, s64
    s_add_u32 s45, s45, 12288
    s_cmp_lg_u32 s44, 0
    s_cbranch_scc1 L_pw_162
    s_mov_b64 exec, 127
    s_mov_b32 s70, 0
L_wp_163:
    buffer_load_dword v31, v5, s[12:15], s45 offen sc1
    s_add_u32 s70, s70, 1
    s_cmp_ge_u32 s70, 0x200000
    s_cbranch_scc1 L_w_done_108
    s_waitcnt vmcnt(0)
    v_cmp_gt_u32 vcc, s62, v31
    s_nop 1
    s_cbranch_vccz L_wp_163_ok
    s_sleep 2
    s_branch L_wp_163
L_wp_163_ok:
    s_mov_b64 exec, -1
L_pw_162:
    s_barrier
    s_mul_i32 s53, s50, 229376
    s_add_u32 s53, s53, s52
    s_lshl_b32 s45, s44, 11
    s_add_u32 s53, s53, s45
    s_mul_i32 s57, s50, 131072
    s_add_u32 s57, s57, s56
    s_mul_i32 s54, s44, 8320
    s_add_u32 s55, s54, 66560
    s_mov_b32 s58, 0
    v_mov_b32 v13, v4
    s_mov_b32 s59, 66560
    s_add_u32 m0, s54, 0
    s_nop 0
    buffer_load_dwordx4 v2, s[12:15], s53 offen offset:0 sc1 lds
    s_add_u32 m0, s54, 784
    s_nop 0
    buffer_load_dwordx4 v2, s[12:15], s53 offen offset:256 sc1 lds
    s_add_u32 m0, s54, 1568
    s_nop 0
    buffer_load_dwordx4 v2, s[12:15], s53 offen offset:512 sc1 lds
    s_add_u32 m0, s54, 2352
    s_nop 0
    buffer_load_dwordx4 v2, s[12:15], s53 offen offset:768 sc1 lds
    s_add_u32 m0, s54, 3136
    s_nop 0
    buffer_load_dwordx4 v2, s[12:15], s53 offen offset:1024 sc1 lds
    s_add_u32 m0, s54, 3920
    s_nop 0
    buffer_load_dwordx4 v2, s[12:15], s53 offen offset:1280 sc1 lds
    s_add_u32 m0, s54, 4704
    s_nop 0
    buffer_load_dwordx4 v2, s[12:15], s53 offen offset:1536 sc1 lds
    s_add_u32 m0, s54, 5488
    s_nop 0
    buffer_load_dwordx4 v2, s[12:15], s53 offen offset:1792 sc1 lds
    s_add_u32 s45, s53, 32768
    s_add_u32 s46, s54, 33280
    s_add_u32 m0, s46, 0
    s_mov_b32 exec_hi, 0xffff
    buffer_load_dwordx4 v2, s[12:15], s45 offen offset:0 sc1 lds
    s_mov_b32 exec_hi, -1
    s_add_u32 m0, s46, 784
    s_mov_b32 exec_hi, 0xffff
    buffer_load_dwordx4 v2, s[12:15], s45 offen offset:256 sc1 lds
    s_mov_b32 exec_hi, -1
    s_add_u32 m0, s46, 1568
    s_mov_b32 exec_hi, 0xffff
    buffer_load_dwordx4 v2, s[12:15], s45 offen offset:512 sc1 lds
    s_mov_b32 exec_hi, -1
    s_add_u32 m0, s46, 2352
    s_mov_b32 exec_hi, 0xffff
    buffer_load_dwordx4 v2, s[12:15], s45 offen offset:768 sc1 lds
    s_mov_b32 exec_hi, -1
    s_add_u32 m0, s46, 3136
    s_mov_b32 exec_hi, 0xffff
    buffer_load_dwordx4 v2, s[12:15], s45 offen offset:1024 sc1 lds
    s_mov_b32 exec_hi, -1
    s_add_u32 m0, s46, 3920
    s_mov_b32 exec_hi, 0xffff
    buffer_load_dwordx4 v2, s[12:15], s45 offen offset:1280 sc1 lds
    s_mov_b32 exec_hi, -1
    s_add_u32 m0, s46, 4704
    s_mov_b32 exec_hi, 0xffff
    buffer_load_dwordx4 v2, s[12:15], s45 offen offset:1536 sc1 lds
    s_mov_b32 exec_hi, -1
    s_add_u32 m0, s46, 5488
    s_mov_b32 exec_hi, 0xffff
    buffer_load_dwordx4 v2, s[12:15], s45 offen offset:1792 sc1 lds
    s_mov_b32 exec_hi, -1
    s_add_u32 s45, s53, 229376
    s_cmp_gt_u32 s51, 1
    s_cselect_b32 s45, s45, 0x20000000
    s_add_u32 m0, s55, 0
    s_nop 0
    buffer_load_dwordx4 v2, s[12:15], s45 offen offset:0 sc1 lds
    s_add_u32 m0, s55, 784
    s_nop 0
    buffer_load_dwordx4 v2, s[12:15], s45 offen offset:256 sc1 lds
    s_add_u32 m0, s55, 1568
    s_nop 0
    buffer_load_dwordx4 v2, s[12:15], s45 offen offset:512 sc1 lds
    s_add_u32 m0, s55, 2352
    s_nop 0
    buffer_load_dwordx4 v2, s[12:15], s45 offen offset:768 sc1 lds
    s_add_u32 m0, s55, 3136
    s_nop 0
    buffer_load_dwordx4 v2, s[12:15], s45 offen offset:1024 sc1 lds
    s_add_u32 m0, s55, 3920
    s_nop 0
    buffer_load_dwordx4 v2, s[12:15], s45 offen offset:1280 sc1 lds
    s_add_u32 m0, s55, 4704
    s_nop 0
    buffer_load_dwordx4 v2, s[12:15], s45 offen offset:1536 sc1 lds
    s_add_u32 m0, s55, 5488
    s_nop 0
    buffer_load_dwordx4 v2, s[12:15], s45 offen offset:1792 sc1 lds
L_e_loop_164:
    s_add_u32 s45, s53, 262144
    s_add_u32 s46, s58, 1
    s_cmp_lt_u32 s46, s51
    s_cselect_b32 s48, s45, 0x20000000
    s_add_u32 s49, s55, 33280
    s_waitcnt vmcnt(16)
    s_barrier
    ds_read_b128 v[32:35], v13 offset:0
    ds_read_b128 v[36:39], v13 offset:32
    ds_read_b128 v[40:43], v13 offset:64
    ds_read_b128 v[44:47], v13 offset:96
    ds_read_b128 v[48:51], v13 offset:128
    ds_read_b128 v[52:55], v13 offset:160
    s_waitcnt lgkmcnt(4)
    v_mfma_f32_32x32x16_bf16 v[64:79], a[0:3], v[32:35], 0
    ds_read_b128 v[56:59], v13 offset:192
    v_mfma_f32_32x32x16_bf16 v[64:79], a[4:7], v[36:39], v[64:79]
    ds_read_b128 v[60:63], v13 offset:224
    s_add_u32 m0, s49, 0
    s_mov_b32 exec_hi, 0xffff
    buffer_load_dwordx4 v2, s[12:15], s48 offen offset:0 sc1 lds
    s_mov_b32 exec_hi, -1
    s_waitcnt lgkmcnt(4)
    v_mfma_f32_32x32x16_bf16 v[64:79], a[8:11], v[40:43], v[64:79]
    ds_read_b128 v[32:35], v13 offset:256
    v_mfma_f32_32x32x16_bf16 v[64:79], a[12:15], v[44:47], v[64:79]
    ds_read_b128 v[36:39], v13 offset:288
    s_add_u32 m0, s49, 784
    s_mov_b32 exec_hi, 0xffff
    buffer_load_dwordx4 v2, s[12:15], s48 offen offset:256 sc1 lds
    s_mov_b32 exec_hi, -1
    s_waitcnt lgkmcnt(4)
    v_mfma_f32_32x32x16_bf16 v[64:79], a[16:19], v[48:51], v[64:79]
    ds_read_b128 v[40:43], v13 offset:320
    v_mfma_f32_32x32x16_bf16 v[64:79], a[20:23], v[52:55], v[64:79]
    ds_read_b128 v[44:47], v13 offset:352
    s_add_u32 m0, s49, 1568
    s_mov_b32 exec_hi, 0xffff
    buffer_load_dwordx4 v2, s[12:15], s48 offen offset:512 sc1 lds
    s_mov_b32 exec_hi, -1
    s_waitcnt lgkmcnt(4)
    v_mfma_f32_32x32x16_bf16 v[64:79], a[24:27], v[56:59], v[64:79]
    ds_read_b128 v[48:51], v13 offset:384
    v_mfma_f32_32x32x16_bf16 v[64:79], a[28:31], v[60:63], v[64:79]
    ds_read_b128 v[52:55], v13 offset:416
    s_add_u32 m0, s49, 2352
    s_mov_b32 exec_hi, 0xffff
    buffer_load_dwordx4 v2, s[12:15], s48 offen offset:768 sc1 lds
    s_mov_b32 exec_hi, -1
    s_waitcnt lgkmcnt(4)
    v_mfma_f32_32x32x16_bf16 v[64:79], a[32:35], v[32:35], v[64:79]
    ds_read_b128 v[56:59], v13 offset:448
    v_mfma_f32_32x32x16_bf16 v[64:79], a[36:39], v[36:39], v[64:79]
    ds_read_b128 v[60:63], v13 offset:480
    s_add_u32 m0, s49, 3136
    s_mov_b32 exec_hi, 0xffff
    buffer_load_dwordx4 v2, s[12:15], s48 offen offset:1024 sc1 lds
    s_mov_b32 exec_hi, -1
    s_waitcnt lgkmcnt(4)
    v_mfma_f32_32x32x16_bf16 v[64:79], a[40:43], v[40:43], v[64:79]
    ds_read_b128 v[32:35], v13 offset:512
    v_mfma_f32_32x32x16_bf16 v[64:79], a[44:47], v[44:47], v[64:79]
    ds_read_b128 v[36:39], v13 offset:544
    s_add_u32 m0, s49, 3920
    s_mov_b32 exec_hi, 0xffff
    buffer_load_dwordx4 v2, s[12:15], s48 offen offset:1280 sc1 lds
    s_mov_b32 exec_hi, -1
    s_waitcnt lgkmcnt(4)
    v_mfma_f32_32x32x16_bf16 v[64:79], a[48:51], v[48:51], v[64:79]
    ds_read_b128 v[40:43], v13 offset:576
    v_mfma_f32_32x32x16_bf16 v[64:79], a[52:55], v[52:55], v[64:79]
    ds_read_b128 v[44:47], v13 offset:608
    s_add_u32 m0, s49, 4704
    s_mov_b32 exec_hi, 0xffff
    buffer_load_dwordx4 v2, s[12:15], s48 offen offset:1536 sc1 lds
    s_mov_b32 exec_hi, -1
    s_waitcnt lgkmcnt(4)
    v_mfma_f32_32x32x16_bf16 v[64:79], a[56:59], v[56:59], v[64:79]
    ds_read_b128 v[48:51], v13 offset:640
    v_mfma_f32_32x32x16_bf16 v[64:79], a[60:63], v[60:63], v[64:79]
    ds_read_b128 v[52:55], v13 offset:672
    s_add_u32 m0, s49, 5488
    s_mov_b32 exec_hi, 0xffff
    buffer_load_dwordx4 v2, s[12:15], s48 offen offset:1792 sc1 lds
    s_mov_b32 exec_hi, -1
    s_waitcnt lgkmcnt(4)
    v_mfma_f32_32x32x16_bf16 v[64:79], a[64:67], v[32:35], v[64:79]
    ds_read_b128 v[56:59], v13 offset:704
    v_mfma_f32_32x32x16_bf16 v[64:79], a[68:71], v[36:39], v[64:79]
    ds_read_b128 v[60:63], v13 offset:736
    s_waitcnt lgkmcnt(4)
    v_mfma_f32_32x32x16_bf16 v[64:79], a[72:75], v[40:43], v[64:79]
    ds_read_b128 v[32:35], v13 offset:768
    v_mfma_f32_32x32x16_bf16 v[64:79], a[76:79], v[44:47], v[64:79]
    ds_read_b128 v[36:39], v13 offset:800
    s_waitcnt lgkmcnt(4)
    v_mfma_f32_32x32x16_bf16 v[64:79], a[80:83], v[48:51], v[64:79]
    ds_read_b128 v[40:43], v13 offset:832
    v_mfma_f32_32x32x16_bf16 v[64:79], a[84:87], v[52:55], v[64:79]
    ds_read_b128 v[44:47], v13 offset:864
    s_waitcnt lgkmcnt(4)
    v_mfma_f32_32x32x16_bf16 v[64:79], a[88:91], v[56:59], v[64:79]
    ds_read_b128 v[48:51], v13 offset:896
    v_mfma_f32_32x32x16_bf16 v[64:79], a[92:95], v[60:63], v[64:79]
    ds_read_b128 v[52:55], v13 offset:928
    s_waitcnt lgkmcnt(4)
    v_mfma_f32_32x32x16_bf16 v[64:79], a[96:99], v[32:35], v[64:79]
    ds_read_b128 v[56:59], v13 offset:960
    v_mfma_f32_32x32x16_bf16 v[64:79], a[100:103], v[36:39], v[64:79]
    ds_read_b128 v[60:63], v13 offset:992
    s_waitcnt lgkmcnt(4)
    v_mfma_f32_32x32x16_bf16 v[64:79], a[104:107], v[40:43], v[64:79]
    v_mfma_f32_32x32x16_bf16 v[64:79], a[108:111], v[44:47], v[64:79]
    s_waitcnt lgkmcnt(2)
    v_mfma_f32_32x32x16_bf16 v[64:79], a[112:115], v[48:51], v[64:79]
    v_mfma_f32_32x32x16_bf16 v[64:79], a[116:119], v[52:55], v[64:79]
    s_waitcnt lgkmcnt(0)
    v_mfma_f32_32x32x16_bf16 v[64:79], a[120:123], v[56:59], v[64:79]
    v_mfma_f32_32x32x16_bf16 v[64:79], a[124:127], v[60:63], v[64:79]
    s_add_u32 s45, s53, 458752
    s_add_u32 s46, s58, 2
    s_cmp_lt_u32 s46, s51
    s_cselect_b32 s48, s45, 0x20000000
    s_mov_b32 s49, s54
    s_waitcnt vmcnt(16)
    s_barrier
    ds_read_b128 v[32:35], v13 offset:33280
    ds_read_b128 v[36:39], v13 offset:33312
    ds_read_b128 v[40:43], v13 offset:33344
    ds_read_b128 v[44:47], v13 offset:33376
    ds_read_b128 v[48:51], v13 offset:33408
    ds_read_b128 v[52:55], v13 offset:33440
    s_waitcnt lgkmcnt(4)
    v_mfma_f32_32x32x16_bf16 v[64:79], a[128:131], v[32:35], v[64:79]
    ds_read_b128 v[56:59], v13 offset:33472
    v_mfma_f32_32x32x16_bf16 v[64:79], a[132:135], v[36:39], v[64:79]
    ds_read_b128 v[60:63], v13 offset:33504
    s_add_u32 m0, s49, 0
    s_nop 0
    buffer_load_dwordx4 v2, s[12:15], s48 offen offset:0 sc1 lds
    s_waitcnt lgkmcnt(4)
    v_mfma_f32_32x32x16_bf16 v[64:79], a[136:139], v[40:43], v[64:79]
    ds_read_b128 v[32:35], v13 offset:33536
    v_mfma_f32_32x32x16_bf16 v[64:79], a[140:143], v[44:47], v[64:79]
    ds_read_b128 v[36:39], v13 offset:33568
    s_add_u32 m0, s49, 784
    s_nop 0
    buffer_load_dwordx4 v2, s[12:15], s48 offen offset:256 sc1 lds
    s_waitcnt lgkmcnt(4)
    v_mfma_f32_32x32x16_bf16 v[64:79], a[144:147], v[48:51], v[64:79]
    ds_read_b128 v[40:43], v13 offset:33600
    v_mfma_f32_32x32x16_bf16 v[64:79], a[148:151], v[52:55], v[64:79]
    ds_read_b128 v[44:47], v13 offset:33632
    s_add_u32 m0, s49, 1568
    s_nop 0
    buffer_load_dwordx4 v2, s[12:15], s48 offen offset:512 sc1 lds
    s_waitcnt lgkmcnt(4)
    v_mfma_f32_32x32x16_bf16 v[64:79], a[152:155], v[56:59], v[64:79]
    ds_read_b128 v[48:51], v13 offset:33664
    v_mfma_f32_32x32x16_bf16 v[64:79], a[156:159], v[60:63], v[64:79]
    ds_read_b128 v[52:55], v13 offset:33696
    s_add_u32 m0, s49, 2352
    s_nop 0
    buffer_load_dwordx4 v2, s[12:15], s48 offen offset:768 sc1 lds
    s_waitcnt lgkmcnt(4)
    v_mfma_f32_32x32x16_bf16 v[64:79], a[160:163], v[32:35], v[64:79]
    ds_read_b128 v[56:59], v13 offset:33728
    v_mfma_f32_32x32x16_bf16 v[64:79], a[164:167], v[36:39], v[64:79]
    ds_read_b128 v[60:63], v13 offset:33760
    s_add_u32 m0, s49, 3136
    s_nop 0
    buffer_load_dwordx4 v2, s[12:15], s48 offen offset:1024 sc1 lds
    s_waitcnt lgkmcnt(4)
    v_mfma_f32_32x32x16_bf16 v[64:79], a[168:171], v[40:43], v[64:79]
    ds_read_b128 v[32:35], v13 offset:33792
    v_mfma_f32_32x32x16_bf16 v[64:79], a[172:175], v[44:47], v[64:79]
    ds_read_b128 v[36:39], v13 offset:33824
    s_add_u32 m0, s49, 3920
    s_nop 0
    buffer_load_dwordx4 v2, s[12:15], s48 offen offset:1280 sc1 lds
    s_waitcnt lgkmcnt(4)
    v_mfma_f32_32x32x16_bf16 v[64:79], a[176:179], v[48:51], v[64:79]
    ds_read_b128 v[40:43], v13 offset:33856
    v_mfma_f32_32x32x16_bf16 v[64:79], a[180:183], v[52:55], v[64:79]
    ds_read_b128 v[44:47], v13 offset:33888
    s_add_u32 m0, s49, 4704
    s_nop 0
    buffer_load_dwordx4 v2, s[12:15], s48 offen offset:1536 sc1 lds
    s_waitcnt lgkmcnt(4)
    v_mfma_f32_32x32x16_bf16 v[64:79], a[184:187], v[56:59], v[64:79]
    ds_read_b128 v[48:51], v13 offset:33920
    v_mfma_f32_32x32x16_bf16 v[64:79], a[188:191], v[60:63], v[64:79]
    ds_read_b128 v[52:55], v13 offset:33952
    s_add_u32 m0, s49, 5488
    s_nop 0
    buffer_load_dwordx4 v2, s[12:15], s48 offen offset:1792 sc1 lds
    s_waitcnt lgkmcnt(4)
    v_mfma_f32_32x32x16_bf16 v[64:79], a[192:195], v[32:35], v[64:79]
    ds_read_b128 v[56:59], v13 offset:33984
    v_mfma_f32_32x32x16_bf16 v[64:79], a[196:199], v[36:39], v[64:79]
    ds_read_b128 v[60:63], v13 offset:34016
    s_waitcnt lgkmcnt(4)
    v_mfma_f32_32x32x16_bf16 v[64:79], a[200:203], v[40:43], v[64:79]
    v_mfma_f32_32x32x16_bf16 v[64:79], a[204:207], v[44:47], v[64:79]
    s_waitcnt lgkmcnt(2)
    v_mfma_f32_32x32x16_bf16 v[64:79], a[208:211], v[48:51], v[64:79]
    v_mfma_f32_32x32x16_bf16 v[64:79], a[212:215], v[52:55], v[64:79]
    s_waitcnt lgkmcnt(0)
    v_mfma_f32_32x32x16_bf16 v[64:79], a[216:219], v[56:59], v[64:79]
    v_mfma_f32_32x32x16_bf16 v[64:79], a[220:223], v[60:63], v[64:79]
    s_add_u32 s53, s53, 229376
    s_add_u32 s58, s58, 1
    v_add_u32 v13, s59, v13
    s_add_u32 s54, s54, s59
    s_sub_u32 s55, s55, s59
    s_sub_u32 s59, 0, s59
    s_lshl_b32 s45, s44, 15
    s_add_u32 s45, s45, s57
    s_add_u32 s57, s57, 131072
    s_nop 3
    ds_write_b128 v7, v[64:67] offset:0
    ds_write_b128 v7, v[68:71] offset:16
    ds_write_b128 v7, v[72:75] offset:32
    ds_write_b128 v7, v[76:79] offset:48
    s_waitcnt lgkmcnt(0)
    s_barrier
    ds_read_b128 v[80:83], v9 offset:0
    ds_read_b128 v[84:87], v9 offset:1056
    ds_read_b128 v[88:91], v9 offset:2112
    ds_read_b128 v[92:95], v9 offset:3168
    s_waitcnt lgkmcnt(3)
    buffer_store_dwordx4 v[80:83], v11, s[12:15], s45 offen sc1
    s_add_u32 s45, s45, 8192
    s_waitcnt lgkmcnt(2)
    buffer_store_dwordx4 v[84:87], v11, s[12:15], s45 offen sc1
    s_add_u32 s45, s45, 8192
    s_waitcnt lgkmcnt(1)
    buffer_store_dwordx4 v[88:91], v11, s[12:15], s45 offen sc1
    s_add_u32 s45, s45, 8192
    s_waitcnt lgkmcnt(0)
    buffer_store_dwordx4 v[92:95], v11, s[12:15], s45 offen sc1
    s_cmp_lt_u32 s58, s51
    s_cbranch_scc1 L_e_loop_164
    s_waitcnt vmcnt(0)
    s_barrier
    s_cmp_lg_u32 s44, 0
    s_cbranch_scc1 L_pub_165
    v_mov_b32 v30, s62
    v_mov_b32 v31, 0
    s_mov_b64 exec, 1
    buffer_store_dword v30, v31, s[12:15], s65 offen sc1
    s_mov_b64 exec, -1
L_pub_165:
    s_add_u32 s63, s50, s44
    s_lshl_b32 s63, s63, 5
    s_add_u32 s63, s63, s41
    s_lshl_b32 s47, s63, 11
    s_add_u32 s46, s47, 0x800000
    s_cmp_lt_u32 s44, s51
    s_cselect_b32 s46, s46, 0x20000000
    buffer_load_dwordx4 v[208:211], v10, s[12:15], s46 offen sc1
    buffer_load_dwordx4 v[212:215], v10, s[12:15], s46 offen offset:1024 sc1
    s_add_u32 s45, s64, 16384
    s_cmp_lg_u32 s44, 0
    s_cbranch_scc1 L_pw_166
    s_mov_b32 exec_hi, 0
    s_mov_b32 s70, 0
L_wp_167:
    buffer_load_dword v31, v5, s[12:15], s45 offen sc1
    s_add_u32 s70, s70, 1
    s_cmp_ge_u32 s70, 0x200000
    s_cbranch_scc1 L_w_done_108
    s_waitcnt vmcnt(0)
    v_cmp_gt_u32 vcc, s62, v31
    s_nop 1
    s_cbranch_vccz L_wp_167_ok
    s_sleep 1
    s_branch L_wp_167
L_wp_167_ok:
    s_mov_b64 exec, -1
L_pw_166:
    s_barrier
    s_cmp_ge_u32 s44, s51
    s_cbranch_scc1 L_c_loop_160
    s_lshl_b32 s45, s63, 12
    s_add_u32 s45, s45, 0xc000000
    v_lshlrev_b32 v29, 5, v1
    buffer_load_dwordx4 v[64:67], v29, s[12:15], s45 offen offset:0 sc1
    buffer_load_dwordx4 v[68:71], v29, s[12:15], s45 offen offset:16 sc1
    buffer_load_dwordx4 v[72:75], v29, s[12:15], s45 offen offset:2048 sc1
    buffer_load_dwordx4 v[76:79], v29, s[12:15], s45 offen offset:2064 sc1
    s_add_u32 s45, s45, 0x800000
    buffer_load_dwordx4 v[160:163], v29, s[12:15], s45 offen offset:0 sc1
    buffer_load_dwordx4 v[164:167], v29, s[12:15], s45 offen offset:16 sc1
    buffer_load_dwordx4 v[168:171], v29, s[12:15], s45 offen offset:2048 sc1
    buffer_load_dwordx4 v[172:175], v29, s[12:15], s45 offen offset:2064 sc1
    s_add_u32 s45, s45, 0x800000
    buffer_load_dwordx4 v[176:179], v29, s[12:15], s45 offen offset:0 sc1
    buffer_load_dwordx4 v[180:183], v29, s[12:15], s45 offen offset:16 sc1
    buffer_load_dwordx4 v[184:187], v29, s[12:15], s45 offen offset:2048 sc1
    buffer_load_dwordx4 v[188:191], v29, s[12:15], s45 offen offset:2064 sc1
    s_add_u32 s45, s45, 0x800000
    buffer_load_dwordx4 v[192:195], v29, s[12:15], s45 offen offset:0 sc1
    buffer_load_dwordx4 v[196:199], v29, s[12:15], s45 offen offset:16 sc1
    buffer_load_dwordx4 v[200:203], v29, s[12:15], s45 offen offset:2048 sc1
    buffer_load_dwordx4 v[204:207], v29, s[12:15], s45 offen offset:2064 sc1
    s_waitcnt vmcnt(0)
    v_pk_add_f32 v[64:65], v[64:65], v[160:161]
    v_pk_add_f32 v[176:177], v[176:177], v[192:193]
    v_pk_add_f32 v[66:67], v[66:67], v[162:163]
    v_pk_add_f32 v[178:179], v[178:179], v[194:195]
    v_pk_add_f32 v[68:69], v[68:69], v[164:165]
    v_pk_add_f32 v[180:181], v[180:181], v[196:197]
    v_pk_add_f32 v[70:71], v[70:71], v[166:167]
    v_pk_add_f32 v[182:183], v[182:183], v[198:199]
    v_pk_add_f32 v[72:73], v[72:73], v[168:169]
    v_pk_add_f32 v[184:185], v[184:185], v[200:201]
    v_pk_add_f32 v[74:75], v[74:75], v[170:171]
    v_pk_add_f32 v[186:187], v[186:187], v[202:203]
    v_pk_add_f32 v[76:77], v[76:77], v[172:173]
    v_pk_add_f32 v[188:189], v[188:189], v[204:205]
    v_pk_add_f32 v[78:79], v[78:79], v[174:175]
    v_pk_add_f32 v[190:191], v[190:191], v[206:207]
    v_pk_add_f32 v[64:65], v[64:65], v[176:177]
    v_pk_add_f32 v[66:67], v[66:67], v[178:179]
    v_pk_add_f32 v[68:69], v[68:69], v[180:181]
    v_pk_add_f32 v[70:71], v[70:71], v[182:183]
    v_pk_add_f32 v[72:73], v[72:73], v[184:185]
    v_pk_add_f32 v[74:75], v[74:75], v[186:187]
    v_pk_add_f32 v[76:77], v[76:77], v[188:189]
    v_pk_add_f32 v[78:79], v[78:79], v[190:191]
    v_cvt_pk_bf16_f32 v64, v64, v64
    v_lshlrev_b32 v64, 16, v64
    v_cvt_pk_bf16_f32 v65, v65, v65
    v_lshlrev_b32 v65, 16, v65
    v_cvt_pk_bf16_f32 v66, v66, v66
    v_lshlrev_b32 v66, 16, v66
    v_cvt_pk_bf16_f32 v67, v67, v67
    v_lshlrev_b32 v67, 16, v67
    v_cvt_pk_bf16_f32 v68, v68, v68
    v_lshlrev_b32 v68, 16, v68
    v_cvt_pk_bf16_f32 v69, v69, v69
    v_lshlrev_b32 v69, 16, v69
    v_cvt_pk_bf16_f32 v70, v70, v70
    v_lshlrev_b32 v70, 16, v70
    v_cvt_pk_bf16_f32 v71, v71, v71
    v_lshlrev_b32 v71, 16, v71
    v_cvt_pk_bf16_f32 v72, v72, v72
    v_lshlrev_b32 v72, 16, v72
    v_cvt_pk_bf16_f32 v73, v73, v73
    v_lshlrev_b32 v73, 16, v73
    v_cvt_pk_bf16_f32 v74, v74, v74
    v_lshlrev_b32 v74, 16, v74
    v_cvt_pk_bf16_f32 v75, v75, v75
    v_lshlrev_b32 v75, 16, v75
    v_cvt_pk_bf16_f32 v76, v76, v76
    v_lshlrev_b32 v76, 16, v76
    v_cvt_pk_bf16_f32 v77, v77, v77
    v_lshlrev_b32 v77, 16, v77
    v_cvt_pk_bf16_f32 v78, v78, v78
    v_lshlrev_b32 v78, 16, v78
    v_cvt_pk_bf16_f32 v79, v79, v79
    v_lshlrev_b32 v79, 16, v79
    v_lshlrev_b32 v160, 16, v208
    v_and_b32 v161, 0xffff0000, v208
    v_lshlrev_b32 v162, 16, v209
    v_and_b32 v163, 0xffff0000, v209
    v_lshlrev_b32 v164, 16, v210
    v_and_b32 v165, 0xffff0000, v210
    v_lshlrev_b32 v166, 16, v211
    v_and_b32 v167, 0xffff0000, v211
    v_lshlrev_b32 v168, 16, v212
    v_and_b32 v169, 0xffff0000, v212
    v_lshlrev_b32 v170, 16, v213
    v_and_b32 v171, 0xffff0000, v213
    v_lshlrev_b32 v172, 16, v214
    v_and_b32 v173, 0xffff0000, v214
    v_lshlrev_b32 v174, 16, v215
    v_and_b32 v175, 0xffff0000, v215
    v_add_f32 v64, v64, v96
    v_cvt_pk_bf16_f32 v64, v64, v64
    v_lshlrev_b32 v64, 16, v64
    v_mul_f32 v64, v64, v112
    v_cvt_pk_bf16_f32 v64, v64, v64
    v_lshlrev_b32 v64, 16, v64
    v_add_f32 v64, v64, v160
    v_add_f32 v65, v65, v97
    v_cvt_pk_bf16_f32 v65, v65, v65
    v_lshlrev_b32 v65, 16, v65
    v_mul_f32 v65, v65, v113
    v_cvt_pk_bf16_f32 v65, v65, v65
    v_lshlrev_b32 v65, 16, v65
    v_add_f32 v65, v65, v161
    v_add_f32 v66, v66, v98
    v_cvt_pk_bf16_f32 v66, v66, v66
    v_lshlrev_b32 v66, 16, v66
    v_mul_f32 v66, v66, v114
    v_cvt_pk_bf16_f32 v66, v66, v66
    v_lshlrev_b32 v66, 16, v66
    v_add_f32 v66, v66, v162
    v_add_f32 v67, v67, v99
    v_cvt_pk_bf16_f32 v67, v67, v67
    v_lshlrev_b32 v67, 16, v67
    v_mul_f32 v67, v67, v115
    v_cvt_pk_bf16_f32 v67, v67, v67
    v_lshlrev_b32 v67, 16, v67
    v_add_f32 v67, v67, v163
    v_add_f32 v68, v68, v100
    v_cvt_pk_bf16_f32 v68, v68, v68
    v_lshlrev_b32 v68, 16, v68
    v_mul_f32 v68, v68, v116
    v_cvt_pk_bf16_f32 v68, v68, v68
    v_lshlrev_b32 v68, 16, v68
    v_add_f32 v68, v68, v164
    v_add_f32 v69, v69, v101
    v_cvt_pk_bf16_f32 v69, v69, v69
    v_lshlrev_b32 v69, 16, v69
    v_mul_f32 v69, v69, v117
    v_cvt_pk_bf16_f32 v69, v69, v69
    v_lshlrev_b32 v69, 16, v69
    v_add_f32 v69, v69, v165
    v_add_f32 v70, v70, v102
    v_cvt_pk_bf16_f32 v70, v70, v70
    v_lshlrev_b32 v70, 16, v70
    v_mul_f32 v70, v70, v118
    v_cvt_pk_bf16_f32 v70, v70, v70
    v_lshlrev_b32 v70, 16, v70
    v_add_f32 v70, v70, v166
    v_add_f32 v71, v71, v103
    v_cvt_pk_bf16_f32 v71, v71, v71
    v_lshlrev_b32 v71, 16, v71
    v_mul_f32 v71, v71, v119
    v_cvt_pk_bf16_f32 v71, v71, v71
    v_lshlrev_b32 v71, 16, v71
    v_add_f32 v71, v71, v167
    v_add_f32 v72, v72, v104
    v_cvt_pk_bf16_f32 v72, v72, v72
    v_lshlrev_b32 v72, 16, v72
    v_mul_f32 v72, v72, v120
    v_cvt_pk_bf16_f32 v72, v72, v72
    v_lshlrev_b32 v72, 16, v72
    v_add_f32 v72, v72, v168
    v_add_f32 v73, v73, v105
    v_cvt_pk_bf16_f32 v73, v73, v73
    v_lshlrev_b32 v73, 16, v73
    v_mul_f32 v73, v73, v121
    v_cvt_pk_bf16_f32 v73, v73, v73
    v_lshlrev_b32 v73, 16, v73
    v_add_f32 v73, v73, v169
    v_add_f32 v74, v74, v106
    v_cvt_pk_bf16_f32 v74, v74, v74
    v_lshlrev_b32 v74, 16, v74
    v_mul_f32 v74, v74, v122
    v_cvt_pk_bf16_f32 v74, v74, v74
    v_lshlrev_b32 v74, 16, v74
    v_add_f32 v74, v74, v170
    v_add_f32 v75, v75, v107
    v_cvt_pk_bf16_f32 v75, v75, v75
    v_lshlrev_b32 v75, 16, v75
    v_mul_f32 v75, v75, v123
    v_cvt_pk_bf16_f32 v75, v75, v75
    v_lshlrev_b32 v75, 16, v75
    v_add_f32 v75, v75, v171
    v_add_f32 v76, v76, v108
    v_cvt_pk_bf16_f32 v76, v76, v76
    v_lshlrev_b32 v76, 16, v76
    v_mul_f32 v76, v76, v124
    v_cvt_pk_bf16_f32 v76, v76, v76
    v_lshlrev_b32 v76, 16, v76
    v_add_f32 v76, v76, v172
    v_add_f32 v77, v77, v109
    v_cvt_pk_bf16_f32 v77, v77, v77
    v_lshlrev_b32 v77, 16, v77
    v_mul_f32 v77, v77, v125
    v_cvt_pk_bf16_f32 v77, v77, v77
    v_lshlrev_b32 v77, 16, v77
    v_add_f32 v77, v77, v173
    v_add_f32 v78, v78, v110
    v_cvt_pk_bf16_f32 v78, v78, v78
    v_lshlrev_b32 v78, 16, v78
    v_mul_f32 v78, v78, v126
    v_cvt_pk_bf16_f32 v78, v78, v78
    v_lshlrev_b32 v78, 16, v78
    v_add_f32 v78, v78, v174
    v_add_f32 v79, v79, v111
    v_cvt_pk_bf16_f32 v79, v79, v79
    v_lshlrev_b32 v79, 16, v79
    v_mul_f32 v79, v79, v127
    v_cvt_pk_bf16_f32 v79, v79, v79
    v_lshlrev_b32 v79, 16, v79
    v_add_f32 v79, v79, v175
    v_cvt_pk_bf16_f32 v208, v64, v65
    v_cvt_pk_bf16_f32 v209, v66, v67
    v_cvt_pk_bf16_f32 v210, v68, v69
    v_cvt_pk_bf16_f32 v211, v70, v71
    v_cvt_pk_bf16_f32 v212, v72, v73
    v_cvt_pk_bf16_f32 v213, v74, v75
    v_cvt_pk_bf16_f32 v214, v76, v77
    v_cvt_pk_bf16_f32 v215, v78, v79
    buffer_store_dwordx4 v[208:211], v10, s[32:35], s47 offen
    buffer_store_dwordx4 v[212:215], v10, s[32:35], s47 offen offset:1024
    s_branch L_c_loop_160
L_w_done_108:
    s_endpgm
.section .rodata,"a"
.p2align 6
.amdhsa_kernel adaLN_cond__memory_aug_recurrent_mem_tr__dense_activation_gelu__prompt_kernel
  .amdhsa_next_free_vgpr 512
  .amdhsa_next_free_sgpr 102
  .amdhsa_accum_offset 256
  .amdhsa_group_segment_fixed_size 0
  .amdhsa_kernarg_size 136
  .amdhsa_user_sgpr_count 2
  .amdhsa_user_sgpr_kernarg_segment_ptr 1
  .amdhsa_system_sgpr_workgroup_id_x 1
.end_amdhsa_kernel
```

```asm
; @launch kernel=adaLN_cond__memory_aug_recurrent_mem_tr__dense_activation_gelu__prompt_kernel grid=(256,1,1) block=(256,1,1) lds=163840
.amdgcn_target "amdgcn-amd-amdhsa--gfx950"
.text
.globl adaLN_cond__memory_aug_recurrent_mem_tr__dense_activation_gelu__prompt_kernel
.p2align 8
.type adaLN_cond__memory_aug_recurrent_mem_tr__dense_activation_gelu__prompt_kernel,@function
adaLN_cond__memory_aug_recurrent_mem_tr__dense_activation_gelu__prompt_kernel:
    s_cmp_lt_u32 s2, 256
    s_cbranch_scc1 L_c_done_1_go
    s_endpgm
L_c_done_1_go:
    s_and_b32 s40, s2, 7
    s_load_dwordx4 s[4:7], s[0:1], 16
    s_load_dwordx4 s[8:11], s[0:1], 32
    s_load_dwordx2 s[20:21], s[0:1], 128
    s_load_dwordx2 s[22:23], s[0:1], 120
    s_load_dwordx2 s[50:51], s[0:1], 8
    s_lshr_b32 s41, s2, 3
    s_and_b32 s42, s41, 15
    v_and_b32 v1, 63, v0
    v_lshrrev_b32 v2, 6, v0
    s_nop 0
    v_readfirstlane_b32 s44, v2
    s_waitcnt lgkmcnt(0)
    s_mov_b32 s24, s4
    s_and_b32 s25, s5, 0xffff
    s_mov_b32 s26, 0x800000
    s_mov_b32 s27, 0x00020000
    s_mov_b32 s28, s6
    s_and_b32 s29, s7, 0xffff
    s_mov_b32 s30, 0x800000
    s_mov_b32 s31, 0x00020000
    s_mov_b32 s32, s8
    s_and_b32 s33, s9, 0xffff
    s_mov_b32 s34, 0x800000
    s_mov_b32 s35, 0x00020000
    s_mov_b32 s36, s10
    s_and_b32 s37, s11, 0xffff
    s_mov_b32 s38, 0x800000
    s_mov_b32 s39, 0x00020000
    s_mov_b32 s12, s20
    s_and_b32 s13, s21, 0xffff
    s_mov_b32 s14, 0x10000000
    s_mov_b32 s15, 0x00020000
    s_mov_b32 s16, s22
    s_and_b32 s17, s23, 0xffff
    s_mov_b32 s18, 0x100
    s_mov_b32 s19, 0x00020000
    s_mov_b32 s52, s50
    s_and_b32 s53, s51, 0xffff
    s_mov_b32 s54, 0x4000
    s_mov_b32 s55, 0x00020000
    v_mov_b32 v41, 0
    s_cmp_lg_u32 s2, 1
    s_cbranch_scc1 L_worker_3_a
    s_getreg_b32 s45, hwreg(HW_REG_XCC_ID)
    s_and_b32 s45, s45, 1
    s_add_u32 s45, s45, 1
    v_mov_b32 v40, s45
    buffer_store_dword v40, v41, s[16:19], 0 offen offset:24 sc1
L_worker_3_a:
    s_cmp_eq_u32 s40, 1
    s_cbranch_scc1 L_worker_3_g0
    s_cmp_lt_u32 s40, 3
    s_cbranch_scc1 L_worker_3_q
    s_sub_u32 s40, s40, 2
    s_branch L_worker_3
L_worker_3_q:
    s_mov_b32 s70, 0
L_worker_3_p:
    buffer_load_dword v40, v41, s[16:19], 0 offen offset:24 sc1
    s_add_u32 s70, s70, 1
    s_cmp_ge_u32 s70, 0x200000
    s_cbranch_scc1 L_c_done_1
    s_waitcnt vmcnt(0)
    v_readfirstlane_b32 s45, v40
    s_nop 3
    s_cmp_eq_u32 s45, 0
    s_cbranch_scc1 L_worker_3_p
    s_and_b32 s45, s45, 2
    s_cmp_lg_u32 s45, s40
    s_mov_b32 s40, 1
    s_cbranch_scc1 L_worker_3_no
    s_mov_b32 s40, 0
    s_branch L_worker_3
L_worker_3_g0:
    s_mov_b32 s40, 0
L_worker_3_no:
    s_lshl_b32 s43, s40, 4
    s_add_u32 s43, s43, s42
    s_lshl_b32 s3, s43, 7
    s_lshr_b32 s45, s41, 4
    s_lshl_b32 s45, s45, 4
    s_add_u32 s3, s3, s45
    s_lshl_b32 s45, s44, 2
    s_add_u32 s3, s3, s45
    s_add_u32 s3, s3, 0x11000
    v_mov_b32 v40, 0
    s_mov_b64 exec, 1
    buffer_store_dword v40, v40, s[12:15], s3 offen sc1
    s_mov_b64 exec, -1
    v_and_b32 v21, 8, v1
    v_cmp_eq_u32 s[56:57], 0, v21
    v_mov_b32 v2, 0xeeee
    v_mov_b32 v3, 0x4444
    v_cndmask_b32 v2, v2, v3, s[56:57]
    v_lshlrev_b32 v68, 4, v1
    s_lshl_b32 s45, s44, 12
    v_add_u32 v3, s45, v68
    v_add_u32 v4, 4096, v3
    v_and_b32 v4, 16383, v4
    v_add_u32 v21, 8192, v3
    v_and_b32 v21, 16383, v21
    v_add_u32 v23, 12288, v3
    v_and_b32 v23, 16383, v23
    s_mul_i32 s45, s44, 24576
    s_add_u32 s45, s45, 65536
    v_add_u32 v5, s45, v68
    v_lshrrev_b32 v63, 4, v1
    s_lshl_b32 s45, s44, 2
    v_add_u32 v64, s45, v63
    s_lshr_b32 s45, s44, 1
    s_lshl_b32 s45, s45, 2
    v_add_u32 v65, s45, v63
    v_bfe_u32 v66, v1, 1, 3
    v_xor_b32 v66, v66, v65
    v_lshlrev_b32 v66, 5, v66
    v_and_b32 v67, 1, v1
    v_lshlrev_b32 v67, 4, v67
    v_add_u32 v66, v66, v67
    v_lshlrev_b32 v64, 13, v64
    v_add_u32 v82, v64, v66
    s_lshl_b32 s47, s43, 8
    s_lshl_b32 s48, s44, 10
    v_bfe_u32 v64, v1, 2, 2
    v_bfe_u32 v65, v1, 4, 1
    v_lshlrev_b32 v65, 2, v65
    v_add_u32 v65, v65, v64
    v_lshlrev_b32 v66, 3, v63
    v_add_u32 v66, v66, v64
    v_lshlrev_b32 v66, 8, v66
    v_and_b32 v67, 3, v1
    v_lshlrev_b32 v67, 3, v67
    v_add_u32 v66, v66, v67
    s_lshl_b32 s45, s44, 1
    v_xor_b32 v65, s45, v65
    v_lshlrev_b32 v65, 5, v65
    v_add_u32 v80, v66, v65
    v_xor_b32 v81, 32, v80
    v_lshrrev_b32 v64, 5, v1
    v_mul_u32_u24 v64, 20480, v64
    v_add_u32 v64, 65536, v64
    v_add_u32 v84, v64, v80
    v_add_u32 v85, v64, v81
    v_add_u32 v86, 49152, v84
    v_add_u32 v87, 49152, v85
    v_mov_b32 v40, -1
    v_mov_b32 v41, -1
    v_mov_b32 v42, -1
    v_mov_b32 v43, -1
    v_mov_b32 v44, 0
    s_mov_b32 s68, 0
    s_cmp_ge_u32 s41, 16
    s_cbranch_scc1 L_c_vo_2
    s_lshl_b32 s45, s42, 11
    s_lshr_b32 s46, s44, 1
    s_lshl_b32 s46, s46, 10
    s_add_u32 s45, s45, s46
    s_and_b32 s46, s44, 1
    s_lshl_b32 s46, s46, 7
    s_add_u32 s45, s45, s46
    v_add_u32 v17, s45, v68
    s_lshl_b32 s62, s40, 17
    s_add_u32 s62, s62, 0x7040000
    s_mov_b64 exec, s[56:57]
    s_add_u32 s63, s62, 0
    buffer_store_dwordx4 v[40:43], v17, s[12:15], s63 offen sc1
    s_add_u32 s63, s62, 32768
    buffer_store_dwordx4 v[40:43], v17, s[12:15], s63 offen sc1
    s_add_u32 s63, s62, 65536
    buffer_store_dwordx4 v[40:43], v17, s[12:15], s63 offen sc1
    s_add_u32 s63, s62, 98304
    buffer_store_dwordx4 v[40:43], v17, s[12:15], s63 offen sc1
    s_mov_b64 exec, -1
    s_lshl_b32 s45, s40, 11
    s_lshl_b32 s46, s42, 2
    s_add_u32 s45, s45, s46
    s_add_u32 s45, s45, 0x7080000
    s_lshl_b32 s46, s44, 9
    s_add_u32 s45, s45, s46
    v_and_b32 v20, 3, v1
    v_lshlrev_b32 v20, 7, v20
    v_add_u32 v20, s45, v20
    buffer_store_dword v44, v20, s[12:15], 0 offen sc1
    s_add_u32 s46, s47, 0x0
    s_add_u32 m0, s48, 73728
    s_nop 0
    buffer_load_dwordx4 v82, s[24:27], s46 offen nt lds
    s_add_u32 s46, s47, 0x20000
    s_add_u32 m0, s48, 98304
    s_nop 0
    buffer_load_dwordx4 v82, s[24:27], s46 offen nt lds
    s_add_u32 s46, s47, 0x40000
    s_add_u32 m0, s48, 122880
    s_nop 0
    buffer_load_dwordx4 v82, s[24:27], s46 offen nt lds
    s_add_u32 s46, s47, 0x60000
    s_add_u32 m0, s48, 147456
    s_nop 0
    buffer_load_dwordx4 v82, s[24:27], s46 offen nt lds
    s_add_u32 s46, s47, 0x80000
    s_add_u32 m0, s48, 77824
    s_nop 0
    buffer_load_dwordx4 v82, s[24:27], s46 offen nt lds
    s_add_u32 s46, s47, 0xa0000
    s_add_u32 m0, s48, 102400
    s_nop 0
    buffer_load_dwordx4 v82, s[24:27], s46 offen nt lds
    s_add_u32 s46, s47, 0xc0000
    s_add_u32 m0, s48, 126976
    s_nop 0
    buffer_load_dwordx4 v82, s[24:27], s46 offen nt lds
    s_add_u32 s46, s47, 0xe0000
    s_add_u32 m0, s48, 151552
    s_nop 0
    buffer_load_dwordx4 v82, s[24:27], s46 offen nt lds
    s_add_u32 s46, s47, 0x100000
    s_add_u32 m0, s48, 81920
    s_nop 0
    buffer_load_dwordx4 v82, s[24:27], s46 offen nt lds
    s_add_u32 s46, s47, 0x120000
    s_add_u32 m0, s48, 106496
    s_nop 0
    buffer_load_dwordx4 v82, s[24:27], s46 offen nt lds
    s_add_u32 s46, s47, 0x140000
    s_add_u32 m0, s48, 131072
    s_nop 0
    buffer_load_dwordx4 v82, s[24:27], s46 offen nt lds
    s_add_u32 s46, s47, 0x160000
    s_add_u32 m0, s48, 155648
    s_nop 0
    buffer_load_dwordx4 v82, s[24:27], s46 offen nt lds
    s_add_u32 s46, s47, 0x180000
    s_add_u32 m0, s48, 86016
    s_nop 0
    buffer_load_dwordx4 v82, s[24:27], s46 offen nt lds
    s_add_u32 s46, s47, 0x1a0000
    s_add_u32 m0, s48, 110592
    s_nop 0
    buffer_load_dwordx4 v82, s[24:27], s46 offen nt lds
    s_add_u32 s46, s47, 0x1c0000
    s_add_u32 m0, s48, 135168
    s_nop 0
    buffer_load_dwordx4 v82, s[24:27], s46 offen nt lds
    s_add_u32 s46, s47, 0x1e0000
    s_add_u32 m0, s48, 159744
    s_nop 0
    buffer_load_dwordx4 v82, s[24:27], s46 offen nt lds
    s_add_u32 s46, s47, 0x200000
    s_add_u32 m0, s48, 0
    s_nop 0
    buffer_load_dwordx4 v82, s[24:27], s46 offen nt lds
    s_add_u32 s46, s47, 0x220000
    s_add_u32 m0, s48, 4096
    s_nop 0
    buffer_load_dwordx4 v82, s[24:27], s46 offen nt lds
    s_add_u32 s46, s47, 0x240000
    s_add_u32 m0, s48, 8192
    s_nop 0
    buffer_load_dwordx4 v82, s[24:27], s46 offen nt lds
    s_add_u32 s46, s47, 0x260000
    s_add_u32 m0, s48, 12288
    s_nop 0
    buffer_load_dwordx4 v82, s[24:27], s46 offen nt lds
    s_add_u32 s46, s47, 0x280000
    s_add_u32 m0, s48, 16384
    s_nop 0
    buffer_load_dwordx4 v82, s[24:27], s46 offen nt lds
    s_add_u32 s46, s47, 0x2a0000
    s_add_u32 m0, s48, 20480
    s_nop 0
    buffer_load_dwordx4 v82, s[24:27], s46 offen nt lds
    s_add_u32 s46, s47, 0x2c0000
    s_add_u32 m0, s48, 24576
    s_nop 0
    buffer_load_dwordx4 v82, s[24:27], s46 offen nt lds
    s_add_u32 s46, s47, 0x2e0000
    s_add_u32 m0, s48, 28672
    s_nop 0
    buffer_load_dwordx4 v82, s[24:27], s46 offen nt lds
    s_add_u32 s46, s47, 0x300000
    s_add_u32 m0, s48, 32768
    s_nop 0
    buffer_load_dwordx4 v82, s[24:27], s46 offen nt lds
    s_add_u32 s46, s47, 0x320000
    s_add_u32 m0, s48, 36864
    s_nop 0
    buffer_load_dwordx4 v82, s[24:27], s46 offen nt lds
    s_add_u32 s46, s47, 0x340000
    s_add_u32 m0, s48, 40960
    s_nop 0
    buffer_load_dwordx4 v82, s[24:27], s46 offen nt lds
    s_add_u32 s46, s47, 0x360000
    s_add_u32 m0, s48, 45056
    s_nop 0
    buffer_load_dwordx4 v82, s[24:27], s46 offen nt lds
    s_add_u32 s46, s47, 0x380000
    s_add_u32 m0, s48, 49152
    s_nop 0
    buffer_load_dwordx4 v82, s[24:27], s46 offen nt lds
    s_add_u32 s46, s47, 0x3a0000
    s_add_u32 m0, s48, 53248
    s_nop 0
    buffer_load_dwordx4 v82, s[24:27], s46 offen nt lds
    s_add_u32 s46, s47, 0x3c0000
    s_add_u32 m0, s48, 57344
    s_nop 0
    buffer_load_dwordx4 v82, s[24:27], s46 offen nt lds
    s_add_u32 s46, s47, 0x3e0000
    s_add_u32 m0, s48, 61440
    s_nop 0
    buffer_load_dwordx4 v82, s[24:27], s46 offen nt lds
    s_waitcnt vmcnt(28)
    s_barrier
    s_cmp_lg_u32 s44, 0
    s_cbranch_scc1 L_lw_4_0
    ds_read_b64_tr_b16 a[0:1], v84 offset:8192
    ds_read_b64_tr_b16 a[2:3], v84 offset:9216
    ds_read_b64_tr_b16 a[4:5], v86 offset:8192
    ds_read_b64_tr_b16 a[6:7], v86 offset:9216
    ds_read_b64_tr_b16 a[8:9], v85 offset:8192
    ds_read_b64_tr_b16 a[10:11], v85 offset:9216
    ds_read_b64_tr_b16 a[12:13], v87 offset:8192
    ds_read_b64_tr_b16 a[14:15], v87 offset:9216
    s_branch L_lw_4
L_lw_4_0:
    s_cmp_lg_u32 s44, 1
    s_cbranch_scc1 L_lw_4_1
    ds_read_b64_tr_b16 v[160:161], v84 offset:8192
    ds_read_b64_tr_b16 v[162:163], v84 offset:9216
    ds_read_b64_tr_b16 v[164:165], v86 offset:8192
    ds_read_b64_tr_b16 v[166:167], v86 offset:9216
    ds_read_b64_tr_b16 v[56:57], v85 offset:8192
    ds_read_b64_tr_b16 v[58:59], v85 offset:9216
    ds_read_b64_tr_b16 v[60:61], v87 offset:8192
    ds_read_b64_tr_b16 v[62:63], v87 offset:9216
    s_waitcnt lgkmcnt(0)
    ds_write_b128 v5, v[56:59] offset:0
    ds_write_b128 v5, v[60:63] offset:1024
    s_branch L_lw_4
L_lw_4_1:
    s_cmp_lg_u32 s44, 2
    s_cbranch_scc1 L_lw_4_2
    ds_read_b64_tr_b16 a[208:209], v84 offset:8192
    ds_read_b64_tr_b16 a[210:211], v84 offset:9216
    ds_read_b64_tr_b16 a[212:213], v86 offset:8192
    ds_read_b64_tr_b16 a[214:215], v86 offset:9216
    ds_read_b64_tr_b16 v[56:57], v85 offset:8192
    ds_read_b64_tr_b16 v[58:59], v85 offset:9216
    ds_read_b64_tr_b16 v[60:61], v87 offset:8192
    ds_read_b64_tr_b16 v[62:63], v87 offset:9216
    s_waitcnt lgkmcnt(0)
    ds_write_b128 v5, v[56:59] offset:2048
    ds_write_b128 v5, v[60:63] offset:3072
    s_branch L_lw_4
L_lw_4_2:
    ds_read_b64_tr_b16 a[104:105], v84 offset:8192
    ds_read_b64_tr_b16 a[106:107], v84 offset:9216
    ds_read_b64_tr_b16 a[108:109], v86 offset:8192
    ds_read_b64_tr_b16 a[110:111], v86 offset:9216
    ds_read_b64_tr_b16 v[56:57], v85 offset:8192
    ds_read_b64_tr_b16 v[58:59], v85 offset:9216
    ds_read_b64_tr_b16 v[60:61], v87 offset:8192
    ds_read_b64_tr_b16 v[62:63], v87 offset:9216
    s_waitcnt lgkmcnt(0)
    ds_write_b128 v5, v[56:59] offset:4096
    ds_write_b128 v5, v[60:63] offset:5120
L_lw_4:
    s_waitcnt lgkmcnt(0)
    s_waitcnt vmcnt(24)
    s_barrier
    s_cmp_lg_u32 s44, 0
    s_cbranch_scc1 L_lw_5_0
    ds_read_b64_tr_b16 a[32:33], v84 offset:12288
    ds_read_b64_tr_b16 a[34:35], v84 offset:13312
    ds_read_b64_tr_b16 a[36:37], v86 offset:12288
    ds_read_b64_tr_b16 a[38:39], v86 offset:13312
    ds_read_b64_tr_b16 a[40:41], v85 offset:12288
    ds_read_b64_tr_b16 a[42:43], v85 offset:13312
    ds_read_b64_tr_b16 a[44:45], v87 offset:12288
    ds_read_b64_tr_b16 a[46:47], v87 offset:13312
    s_branch L_lw_5
L_lw_5_0:
    s_cmp_lg_u32 s44, 1
    s_cbranch_scc1 L_lw_5_1
    ds_read_b64_tr_b16 v[184:185], v84 offset:12288
    ds_read_b64_tr_b16 v[186:187], v84 offset:13312
    ds_read_b64_tr_b16 v[188:189], v86 offset:12288
    ds_read_b64_tr_b16 v[190:191], v86 offset:13312
    ds_read_b64_tr_b16 v[192:193], v85 offset:12288
    ds_read_b64_tr_b16 v[194:195], v85 offset:13312
    ds_read_b64_tr_b16 v[196:197], v87 offset:12288
    ds_read_b64_tr_b16 v[198:199], v87 offset:13312
    s_branch L_lw_5
L_lw_5_1:
    s_cmp_lg_u32 s44, 2
    s_cbranch_scc1 L_lw_5_2
    ds_read_b64_tr_b16 a[232:233], v84 offset:12288
    ds_read_b64_tr_b16 a[234:235], v84 offset:13312
    ds_read_b64_tr_b16 a[236:237], v86 offset:12288
    ds_read_b64_tr_b16 a[238:239], v86 offset:13312
    ds_read_b64_tr_b16 a[240:241], v85 offset:12288
    ds_read_b64_tr_b16 a[242:243], v85 offset:13312
    ds_read_b64_tr_b16 a[244:245], v87 offset:12288
    ds_read_b64_tr_b16 a[246:247], v87 offset:13312
    s_branch L_lw_5
L_lw_5_2:
    ds_read_b64_tr_b16 a[128:129], v84 offset:12288
    ds_read_b64_tr_b16 a[130:131], v84 offset:13312
    ds_read_b64_tr_b16 a[132:133], v86 offset:12288
    ds_read_b64_tr_b16 a[134:135], v86 offset:13312
    ds_read_b64_tr_b16 v[56:57], v85 offset:12288
    ds_read_b64_tr_b16 v[58:59], v85 offset:13312
    ds_read_b64_tr_b16 v[60:61], v87 offset:12288
    ds_read_b64_tr_b16 v[62:63], v87 offset:13312
    s_waitcnt lgkmcnt(0)
    ds_write_b128 v5, v[56:59] offset:6144
    ds_write_b128 v5, v[60:63] offset:7168
L_lw_5:
    s_waitcnt lgkmcnt(0)
    s_waitcnt vmcnt(20)
    s_barrier
    s_cmp_lg_u32 s44, 0
    s_cbranch_scc1 L_lw_6_0
    ds_read_b64_tr_b16 a[64:65], v84 offset:16384
    ds_read_b64_tr_b16 a[66:67], v84 offset:17408
    ds_read_b64_tr_b16 a[68:69], v86 offset:16384
    ds_read_b64_tr_b16 a[70:71], v86 offset:17408
    ds_read_b64_tr_b16 v[56:57], v85 offset:16384
    ds_read_b64_tr_b16 v[58:59], v85 offset:17408
    ds_read_b64_tr_b16 v[60:61], v87 offset:16384
    ds_read_b64_tr_b16 v[62:63], v87 offset:17408
    s_waitcnt lgkmcnt(0)
    ds_write_b128 v5, v[56:59] offset:8192
    ds_write_b128 v5, v[60:63] offset:9216
    s_branch L_lw_6
L_lw_6_0:
    s_cmp_lg_u32 s44, 1
    s_cbranch_scc1 L_lw_6_1
    ds_read_b64_tr_b16 v[208:209], v84 offset:16384
    ds_read_b64_tr_b16 v[210:211], v84 offset:17408
    ds_read_b64_tr_b16 v[212:213], v86 offset:16384
    ds_read_b64_tr_b16 v[214:215], v86 offset:17408
    ds_read_b64_tr_b16 v[56:57], v85 offset:16384
    ds_read_b64_tr_b16 v[58:59], v85 offset:17408
    ds_read_b64_tr_b16 v[60:61], v87 offset:16384
    ds_read_b64_tr_b16 v[62:63], v87 offset:17408
    s_waitcnt lgkmcnt(0)
    ds_write_b128 v5, v[56:59] offset:10240
    ds_write_b128 v5, v[60:63] offset:11264
    s_branch L_lw_6
L_lw_6_1:
    s_cmp_lg_u32 s44, 2
    s_cbranch_scc1 L_lw_6_2
    ds_read_b64_tr_b16 v[104:105], v84 offset:16384
    ds_read_b64_tr_b16 v[106:107], v84 offset:17408
    ds_read_b64_tr_b16 v[108:109], v86 offset:16384
    ds_read_b64_tr_b16 v[110:111], v86 offset:17408
    ds_read_b64_tr_b16 v[56:57], v85 offset:16384
    ds_read_b64_tr_b16 v[58:59], v85 offset:17408
    ds_read_b64_tr_b16 v[60:61], v87 offset:16384
    ds_read_b64_tr_b16 v[62:63], v87 offset:17408
    s_waitcnt lgkmcnt(0)
    ds_write_b128 v5, v[56:59] offset:12288
    ds_write_b128 v5, v[60:63] offset:13312
    s_branch L_lw_6
L_lw_6_2:
    ds_read_b64_tr_b16 a[152:153], v84 offset:16384
    ds_read_b64_tr_b16 a[154:155], v84 offset:17408
    ds_read_b64_tr_b16 a[156:157], v86 offset:16384
    ds_read_b64_tr_b16 a[158:159], v86 offset:17408
    ds_read_b64_tr_b16 v[56:57], v85 offset:16384
    ds_read_b64_tr_b16 v[58:59], v85 offset:17408
    ds_read_b64_tr_b16 v[60:61], v87 offset:16384
    ds_read_b64_tr_b16 v[62:63], v87 offset:17408
    s_waitcnt lgkmcnt(0)
    ds_write_b128 v5, v[56:59] offset:14336
    ds_write_b128 v5, v[60:63] offset:15360
L_lw_6:
    s_waitcnt lgkmcnt(0)
    s_waitcnt vmcnt(16)
    s_barrier
    s_cmp_lg_u32 s44, 0
    s_cbranch_scc1 L_lw_7_0
    ds_read_b64_tr_b16 a[80:81], v84 offset:20480
    ds_read_b64_tr_b16 a[82:83], v84 offset:21504
    ds_read_b64_tr_b16 a[84:85], v86 offset:20480
    ds_read_b64_tr_b16 a[86:87], v86 offset:21504
    ds_read_b64_tr_b16 v[56:57], v85 offset:20480
    ds_read_b64_tr_b16 v[58:59], v85 offset:21504
    ds_read_b64_tr_b16 v[60:61], v87 offset:20480
    ds_read_b64_tr_b16 v[62:63], v87 offset:21504
    s_waitcnt lgkmcnt(0)
    ds_write_b128 v5, v[56:59] offset:16384
    ds_write_b128 v5, v[60:63] offset:17408
    s_branch L_lw_7
L_lw_7_0:
    s_cmp_lg_u32 s44, 1
    s_cbranch_scc1 L_lw_7_1
    ds_read_b64_tr_b16 v[232:233], v84 offset:20480
    ds_read_b64_tr_b16 v[234:235], v84 offset:21504
    ds_read_b64_tr_b16 v[236:237], v86 offset:20480
    ds_read_b64_tr_b16 v[238:239], v86 offset:21504
    ds_read_b64_tr_b16 v[240:241], v85 offset:20480
    ds_read_b64_tr_b16 v[242:243], v85 offset:21504
    ds_read_b64_tr_b16 v[244:245], v87 offset:20480
    ds_read_b64_tr_b16 v[246:247], v87 offset:21504
    s_branch L_lw_7
L_lw_7_1:
    s_cmp_lg_u32 s44, 2
    s_cbranch_scc1 L_lw_7_2
    ds_read_b64_tr_b16 v[128:129], v84 offset:20480
    ds_read_b64_tr_b16 v[130:131], v84 offset:21504
    ds_read_b64_tr_b16 v[132:133], v86 offset:20480
    ds_read_b64_tr_b16 v[134:135], v86 offset:21504
    ds_read_b64_tr_b16 v[136:137], v85 offset:20480
    ds_read_b64_tr_b16 v[138:139], v85 offset:21504
    ds_read_b64_tr_b16 v[140:141], v87 offset:20480
    ds_read_b64_tr_b16 v[142:143], v87 offset:21504
    s_branch L_lw_7
L_lw_7_2:
    ds_read_b64_tr_b16 a[176:177], v84 offset:20480
    ds_read_b64_tr_b16 a[178:179], v84 offset:21504
    ds_read_b64_tr_b16 a[180:181], v86 offset:20480
    ds_read_b64_tr_b16 a[182:183], v86 offset:21504
    ds_read_b64_tr_b16 a[184:185], v85 offset:20480
    ds_read_b64_tr_b16 a[186:187], v85 offset:21504
    ds_read_b64_tr_b16 a[188:189], v87 offset:20480
    ds_read_b64_tr_b16 a[190:191], v87 offset:21504
L_lw_7:
    s_waitcnt lgkmcnt(0)
    s_waitcnt vmcnt(12)
    s_barrier
    s_add_u32 s46, s47, 0x400000
    s_add_u32 m0, s48, 86016
    s_nop 0
    buffer_load_dwordx4 v82, s[24:27], s46 offen nt lds
    s_add_u32 s46, s47, 0x420000
    s_add_u32 m0, s48, 110592
    s_nop 0
    buffer_load_dwordx4 v82, s[24:27], s46 offen nt lds
    s_add_u32 s46, s47, 0x440000
    s_add_u32 m0, s48, 135168
    s_nop 0
    buffer_load_dwordx4 v82, s[24:27], s46 offen nt lds
    s_add_u32 s46, s47, 0x460000
    s_add_u32 m0, s48, 159744
    s_nop 0
    buffer_load_dwordx4 v82, s[24:27], s46 offen nt lds
    s_cmp_lg_u32 s44, 0
    s_cbranch_scc1 L_lw_8_0
    ds_read_b64_tr_b16 a[104:105], v80 offset:0
    ds_read_b64_tr_b16 a[106:107], v80 offset:1024
    ds_read_b64_tr_b16 a[108:109], v80 offset:8192
    ds_read_b64_tr_b16 a[110:111], v80 offset:9216
    ds_read_b64_tr_b16 v[56:57], v81 offset:0
    ds_read_b64_tr_b16 v[58:59], v81 offset:1024
    ds_read_b64_tr_b16 v[60:61], v81 offset:8192
    ds_read_b64_tr_b16 v[62:63], v81 offset:9216
    s_waitcnt lgkmcnt(0)
    ds_write_b128 v5, v[56:59] offset:4096
    ds_write_b128 v5, v[60:63] offset:5120
    s_branch L_lw_8
L_lw_8_0:
    s_cmp_lg_u32 s44, 1
    s_cbranch_scc1 L_lw_8_1
    ds_read_b64_tr_b16 a[0:1], v80 offset:0
    ds_read_b64_tr_b16 a[2:3], v80 offset:1024
    ds_read_b64_tr_b16 a[4:5], v80 offset:8192
    ds_read_b64_tr_b16 a[6:7], v80 offset:9216
    ds_read_b64_tr_b16 a[8:9], v81 offset:0
    ds_read_b64_tr_b16 a[10:11], v81 offset:1024
    ds_read_b64_tr_b16 a[12:13], v81 offset:8192
    ds_read_b64_tr_b16 a[14:15], v81 offset:9216
    s_branch L_lw_8
L_lw_8_1:
    s_cmp_lg_u32 s44, 2
    s_cbranch_scc1 L_lw_8_2
    ds_read_b64_tr_b16 v[160:161], v80 offset:0
    ds_read_b64_tr_b16 v[162:163], v80 offset:1024
    ds_read_b64_tr_b16 v[164:165], v80 offset:8192
    ds_read_b64_tr_b16 v[166:167], v80 offset:9216
    ds_read_b64_tr_b16 v[56:57], v81 offset:0
    ds_read_b64_tr_b16 v[58:59], v81 offset:1024
    ds_read_b64_tr_b16 v[60:61], v81 offset:8192
    ds_read_b64_tr_b16 v[62:63], v81 offset:9216
    s_waitcnt lgkmcnt(0)
    ds_write_b128 v5, v[56:59] offset:0
    ds_write_b128 v5, v[60:63] offset:1024
    s_branch L_lw_8
L_lw_8_2:
    ds_read_b64_tr_b16 a[208:209], v80 offset:0
    ds_read_b64_tr_b16 a[210:211], v80 offset:1024
    ds_read_b64_tr_b16 a[212:213], v80 offset:8192
    ds_read_b64_tr_b16 a[214:215], v80 offset:9216
    ds_read_b64_tr_b16 v[56:57], v81 offset:0
    ds_read_b64_tr_b16 v[58:59], v81 offset:1024
    ds_read_b64_tr_b16 v[60:61], v81 offset:8192
    ds_read_b64_tr_b16 v[62:63], v81 offset:9216
    s_waitcnt lgkmcnt(0)
    ds_write_b128 v5, v[56:59] offset:2048
    ds_write_b128 v5, v[60:63] offset:3072
L_lw_8:
    s_waitcnt lgkmcnt(0)
    s_waitcnt vmcnt(12)
    s_barrier
    s_add_u32 s46, s47, 0x480000
    s_add_u32 m0, s48, 0
    s_nop 0
    buffer_load_dwordx4 v82, s[24:27], s46 offen nt lds
    s_add_u32 s46, s47, 0x4a0000
    s_add_u32 m0, s48, 4096
    s_nop 0
    buffer_load_dwordx4 v82, s[24:27], s46 offen nt lds
    s_add_u32 s46, s47, 0x4c0000
    s_add_u32 m0, s48, 8192
    s_nop 0
    buffer_load_dwordx4 v82, s[24:27], s46 offen nt lds
    s_add_u32 s46, s47, 0x4e0000
    s_add_u32 m0, s48, 12288
    s_nop 0
    buffer_load_dwordx4 v82, s[24:27], s46 offen nt lds
    s_cmp_lg_u32 s44, 0
    s_cbranch_scc1 L_lw_9_0
    ds_read_b64_tr_b16 a[128:129], v80 offset:16384
    ds_read_b64_tr_b16 a[130:131], v80 offset:17408
    ds_read_b64_tr_b16 a[132:133], v80 offset:24576
    ds_read_b64_tr_b16 a[134:135], v80 offset:25600
    ds_read_b64_tr_b16 v[56:57], v81 offset:16384
    ds_read_b64_tr_b16 v[58:59], v81 offset:17408
    ds_read_b64_tr_b16 v[60:61], v81 offset:24576
    ds_read_b64_tr_b16 v[62:63], v81 offset:25600
    s_waitcnt lgkmcnt(0)
    ds_write_b128 v5, v[56:59] offset:6144
    ds_write_b128 v5, v[60:63] offset:7168
    s_branch L_lw_9
L_lw_9_0:
    s_cmp_lg_u32 s44, 1
    s_cbranch_scc1 L_lw_9_1
    ds_read_b64_tr_b16 a[32:33], v80 offset:16384
    ds_read_b64_tr_b16 a[34:35], v80 offset:17408
    ds_read_b64_tr_b16 a[36:37], v80 offset:24576
    ds_read_b64_tr_b16 a[38:39], v80 offset:25600
    ds_read_b64_tr_b16 a[40:41], v81 offset:16384
    ds_read_b64_tr_b16 a[42:43], v81 offset:17408
    ds_read_b64_tr_b16 a[44:45], v81 offset:24576
    ds_read_b64_tr_b16 a[46:47], v81 offset:25600
    s_branch L_lw_9
L_lw_9_1:
    s_cmp_lg_u32 s44, 2
    s_cbranch_scc1 L_lw_9_2
    ds_read_b64_tr_b16 v[184:185], v80 offset:16384
    ds_read_b64_tr_b16 v[186:187], v80 offset:17408
    ds_read_b64_tr_b16 v[188:189], v80 offset:24576
    ds_read_b64_tr_b16 v[190:191], v80 offset:25600
    ds_read_b64_tr_b16 v[192:193], v81 offset:16384
    ds_read_b64_tr_b16 v[194:195], v81 offset:17408
    ds_read_b64_tr_b16 v[196:197], v81 offset:24576
    ds_read_b64_tr_b16 v[198:199], v81 offset:25600
    s_branch L_lw_9
L_lw_9_2:
    ds_read_b64_tr_b16 a[232:233], v80 offset:16384
    ds_read_b64_tr_b16 a[234:235], v80 offset:17408
    ds_read_b64_tr_b16 a[236:237], v80 offset:24576
    ds_read_b64_tr_b16 a[238:239], v80 offset:25600
    ds_read_b64_tr_b16 a[240:241], v81 offset:16384
    ds_read_b64_tr_b16 a[242:243], v81 offset:17408
    ds_read_b64_tr_b16 a[244:245], v81 offset:24576
    ds_read_b64_tr_b16 a[246:247], v81 offset:25600
L_lw_9:
    s_waitcnt lgkmcnt(0)
    s_waitcnt vmcnt(12)
    s_barrier
    s_add_u32 s46, s47, 0x500000
    s_add_u32 m0, s48, 16384
    s_nop 0
    buffer_load_dwordx4 v82, s[24:27], s46 offen nt lds
    s_add_u32 s46, s47, 0x520000
    s_add_u32 m0, s48, 20480
    s_nop 0
    buffer_load_dwordx4 v82, s[24:27], s46 offen nt lds
    s_add_u32 s46, s47, 0x540000
    s_add_u32 m0, s48, 24576
    s_nop 0
    buffer_load_dwordx4 v82, s[24:27], s46 offen nt lds
    s_add_u32 s46, s47, 0x560000
    s_add_u32 m0, s48, 28672
    s_nop 0
    buffer_load_dwordx4 v82, s[24:27], s46 offen nt lds
    s_cmp_lg_u32 s44, 0
    s_cbranch_scc1 L_lw_10_0
    ds_read_b64_tr_b16 a[152:153], v80 offset:32768
    ds_read_b64_tr_b16 a[154:155], v80 offset:33792
    ds_read_b64_tr_b16 a[156:157], v80 offset:40960
    ds_read_b64_tr_b16 a[158:159], v80 offset:41984
    ds_read_b64_tr_b16 v[56:57], v81 offset:32768
    ds_read_b64_tr_b16 v[58:59], v81 offset:33792
    ds_read_b64_tr_b16 v[60:61], v81 offset:40960
    ds_read_b64_tr_b16 v[62:63], v81 offset:41984
    s_waitcnt lgkmcnt(0)
    ds_write_b128 v5, v[56:59] offset:14336
    ds_write_b128 v5, v[60:63] offset:15360
    s_branch L_lw_10
L_lw_10_0:
    s_cmp_lg_u32 s44, 1
    s_cbranch_scc1 L_lw_10_1
    ds_read_b64_tr_b16 a[64:65], v80 offset:32768
    ds_read_b64_tr_b16 a[66:67], v80 offset:33792
    ds_read_b64_tr_b16 a[68:69], v80 offset:40960
    ds_read_b64_tr_b16 a[70:71], v80 offset:41984
    ds_read_b64_tr_b16 v[56:57], v81 offset:32768
    ds_read_b64_tr_b16 v[58:59], v81 offset:33792
    ds_read_b64_tr_b16 v[60:61], v81 offset:40960
    ds_read_b64_tr_b16 v[62:63], v81 offset:41984
    s_waitcnt lgkmcnt(0)
    ds_write_b128 v5, v[56:59] offset:8192
    ds_write_b128 v5, v[60:63] offset:9216
    s_branch L_lw_10
L_lw_10_1:
    s_cmp_lg_u32 s44, 2
    s_cbranch_scc1 L_lw_10_2
    ds_read_b64_tr_b16 v[208:209], v80 offset:32768
    ds_read_b64_tr_b16 v[210:211], v80 offset:33792
    ds_read_b64_tr_b16 v[212:213], v80 offset:40960
    ds_read_b64_tr_b16 v[214:215], v80 offset:41984
    ds_read_b64_tr_b16 v[56:57], v81 offset:32768
    ds_read_b64_tr_b16 v[58:59], v81 offset:33792
    ds_read_b64_tr_b16 v[60:61], v81 offset:40960
    ds_read_b64_tr_b16 v[62:63], v81 offset:41984
    s_waitcnt lgkmcnt(0)
    ds_write_b128 v5, v[56:59] offset:10240
    ds_write_b128 v5, v[60:63] offset:11264
    s_branch L_lw_10
L_lw_10_2:
    ds_read_b64_tr_b16 v[104:105], v80 offset:32768
    ds_read_b64_tr_b16 v[106:107], v80 offset:33792
    ds_read_b64_tr_b16 v[108:109], v80 offset:40960
    ds_read_b64_tr_b16 v[110:111], v80 offset:41984
    ds_read_b64_tr_b16 v[56:57], v81 offset:32768
    ds_read_b64_tr_b16 v[58:59], v81 offset:33792
    ds_read_b64_tr_b16 v[60:61], v81 offset:40960
    ds_read_b64_tr_b16 v[62:63], v81 offset:41984
    s_waitcnt lgkmcnt(0)
    ds_write_b128 v5, v[56:59] offset:12288
    ds_write_b128 v5, v[60:63] offset:13312
L_lw_10:
    s_waitcnt lgkmcnt(0)
    s_waitcnt vmcnt(12)
    s_barrier
    s_add_u32 s46, s47, 0x580000
    s_add_u32 m0, s48, 32768
    s_nop 0
    buffer_load_dwordx4 v82, s[24:27], s46 offen nt lds
    s_add_u32 s46, s47, 0x5a0000
    s_add_u32 m0, s48, 36864
    s_nop 0
    buffer_load_dwordx4 v82, s[24:27], s46 offen nt lds
    s_add_u32 s46, s47, 0x5c0000
    s_add_u32 m0, s48, 40960
    s_nop 0
    buffer_load_dwordx4 v82, s[24:27], s46 offen nt lds
    s_add_u32 s46, s47, 0x5e0000
    s_add_u32 m0, s48, 45056
    s_nop 0
    buffer_load_dwordx4 v82, s[24:27], s46 offen nt lds
    s_cmp_lg_u32 s44, 0
    s_cbranch_scc1 L_lw_11_0
    ds_read_b64_tr_b16 a[176:177], v80 offset:49152
    ds_read_b64_tr_b16 a[178:179], v80 offset:50176
    ds_read_b64_tr_b16 a[180:181], v80 offset:57344
    ds_read_b64_tr_b16 a[182:183], v80 offset:58368
    ds_read_b64_tr_b16 a[184:185], v81 offset:49152
    ds_read_b64_tr_b16 a[186:187], v81 offset:50176
    ds_read_b64_tr_b16 a[188:189], v81 offset:57344
    ds_read_b64_tr_b16 a[190:191], v81 offset:58368
    s_branch L_lw_11
L_lw_11_0:
    s_cmp_lg_u32 s44, 1
    s_cbranch_scc1 L_lw_11_1
    ds_read_b64_tr_b16 a[80:81], v80 offset:49152
    ds_read_b64_tr_b16 a[82:83], v80 offset:50176
    ds_read_b64_tr_b16 a[84:85], v80 offset:57344
    ds_read_b64_tr_b16 a[86:87], v80 offset:58368
    ds_read_b64_tr_b16 v[56:57], v81 offset:49152
    ds_read_b64_tr_b16 v[58:59], v81 offset:50176
    ds_read_b64_tr_b16 v[60:61], v81 offset:57344
    ds_read_b64_tr_b16 v[62:63], v81 offset:58368
    s_waitcnt lgkmcnt(0)
    ds_write_b128 v5, v[56:59] offset:16384
    ds_write_b128 v5, v[60:63] offset:17408
    s_branch L_lw_11
L_lw_11_1:
    s_cmp_lg_u32 s44, 2
    s_cbranch_scc1 L_lw_11_2
    ds_read_b64_tr_b16 v[232:233], v80 offset:49152
    ds_read_b64_tr_b16 v[234:235], v80 offset:50176
    ds_read_b64_tr_b16 v[236:237], v80 offset:57344
    ds_read_b64_tr_b16 v[238:239], v80 offset:58368
    ds_read_b64_tr_b16 v[240:241], v81 offset:49152
    ds_read_b64_tr_b16 v[242:243], v81 offset:50176
    ds_read_b64_tr_b16 v[244:245], v81 offset:57344
    ds_read_b64_tr_b16 v[246:247], v81 offset:58368
    s_branch L_lw_11
L_lw_11_2:
    ds_read_b64_tr_b16 v[128:129], v80 offset:49152
    ds_read_b64_tr_b16 v[130:131], v80 offset:50176
    ds_read_b64_tr_b16 v[132:133], v80 offset:57344
    ds_read_b64_tr_b16 v[134:135], v80 offset:58368
    ds_read_b64_tr_b16 v[136:137], v81 offset:49152
    ds_read_b64_tr_b16 v[138:139], v81 offset:50176
    ds_read_b64_tr_b16 v[140:141], v81 offset:57344
    ds_read_b64_tr_b16 v[142:143], v81 offset:58368
L_lw_11:
    s_waitcnt lgkmcnt(0)
    s_waitcnt vmcnt(12)
    s_barrier
    s_add_u32 s46, s47, 0x600000
    s_add_u32 m0, s48, 49152
    s_nop 0
    buffer_load_dwordx4 v82, s[24:27], s46 offen nt lds
    s_add_u32 s46, s47, 0x620000
    s_add_u32 m0, s48, 53248
    s_nop 0
    buffer_load_dwordx4 v82, s[24:27], s46 offen nt lds
    s_add_u32 s46, s47, 0x640000
    s_add_u32 m0, s48, 57344
    s_nop 0
    buffer_load_dwordx4 v82, s[24:27], s46 offen nt lds
    s_add_u32 s46, s47, 0x660000
    s_add_u32 m0, s48, 61440
    s_nop 0
    buffer_load_dwordx4 v82, s[24:27], s46 offen nt lds
    s_cmp_lg_u32 s44, 0
    s_cbranch_scc1 L_lw_12_0
    ds_read_b64_tr_b16 a[208:209], v84 offset:20480
    ds_read_b64_tr_b16 a[210:211], v84 offset:21504
    ds_read_b64_tr_b16 a[212:213], v86 offset:20480
    ds_read_b64_tr_b16 a[214:215], v86 offset:21504
    ds_read_b64_tr_b16 v[56:57], v85 offset:20480
    ds_read_b64_tr_b16 v[58:59], v85 offset:21504
    ds_read_b64_tr_b16 v[60:61], v87 offset:20480
    ds_read_b64_tr_b16 v[62:63], v87 offset:21504
    s_waitcnt lgkmcnt(0)
    ds_write_b128 v5, v[56:59] offset:2048
    ds_write_b128 v5, v[60:63] offset:3072
    s_branch L_lw_12
L_lw_12_0:
    s_cmp_lg_u32 s44, 1
    s_cbranch_scc1 L_lw_12_1
    ds_read_b64_tr_b16 a[104:105], v84 offset:20480
    ds_read_b64_tr_b16 a[106:107], v84 offset:21504
    ds_read_b64_tr_b16 a[108:109], v86 offset:20480
    ds_read_b64_tr_b16 a[110:111], v86 offset:21504
    ds_read_b64_tr_b16 v[56:57], v85 offset:20480
    ds_read_b64_tr_b16 v[58:59], v85 offset:21504
    ds_read_b64_tr_b16 v[60:61], v87 offset:20480
    ds_read_b64_tr_b16 v[62:63], v87 offset:21504
    s_waitcnt lgkmcnt(0)
    ds_write_b128 v5, v[56:59] offset:4096
    ds_write_b128 v5, v[60:63] offset:5120
    s_branch L_lw_12
L_lw_12_1:
    s_cmp_lg_u32 s44, 2
    s_cbranch_scc1 L_lw_12_2
    ds_read_b64_tr_b16 a[0:1], v84 offset:20480
    ds_read_b64_tr_b16 a[2:3], v84 offset:21504
    ds_read_b64_tr_b16 a[4:5], v86 offset:20480
    ds_read_b64_tr_b16 a[6:7], v86 offset:21504
    ds_read_b64_tr_b16 a[8:9], v85 offset:20480
    ds_read_b64_tr_b16 a[10:11], v85 offset:21504
    ds_read_b64_tr_b16 a[12:13], v87 offset:20480
    ds_read_b64_tr_b16 a[14:15], v87 offset:21504
    s_branch L_lw_12
L_lw_12_2:
    ds_read_b64_tr_b16 v[160:161], v84 offset:20480
    ds_read_b64_tr_b16 v[162:163], v84 offset:21504
    ds_read_b64_tr_b16 v[164:165], v86 offset:20480
    ds_read_b64_tr_b16 v[166:167], v86 offset:21504
    ds_read_b64_tr_b16 v[56:57], v85 offset:20480
    ds_read_b64_tr_b16 v[58:59], v85 offset:21504
    ds_read_b64_tr_b16 v[60:61], v87 offset:20480
    ds_read_b64_tr_b16 v[62:63], v87 offset:21504
    s_waitcnt lgkmcnt(0)
    ds_write_b128 v5, v[56:59] offset:0
    ds_write_b128 v5, v[60:63] offset:1024
L_lw_12:
    s_waitcnt lgkmcnt(0)
    s_waitcnt vmcnt(12)
    s_barrier
    s_add_u32 s46, s47, 0x680000
    s_add_u32 m0, s48, 86016
    s_nop 0
    buffer_load_dwordx4 v82, s[24:27], s46 offen nt lds
    s_add_u32 s46, s47, 0x6a0000
    s_add_u32 m0, s48, 110592
    s_nop 0
    buffer_load_dwordx4 v82, s[24:27], s46 offen nt lds
    s_add_u32 s46, s47, 0x6c0000
    s_add_u32 m0, s48, 135168
    s_nop 0
    buffer_load_dwordx4 v82, s[24:27], s46 offen nt lds
    s_add_u32 s46, s47, 0x6e0000
    s_add_u32 m0, s48, 159744
    s_nop 0
    buffer_load_dwordx4 v82, s[24:27], s46 offen nt lds
    s_cmp_lg_u32 s44, 0
    s_cbranch_scc1 L_lw_13_0
    ds_read_b64_tr_b16 a[232:233], v80 offset:0
    ds_read_b64_tr_b16 a[234:235], v80 offset:1024
    ds_read_b64_tr_b16 a[236:237], v80 offset:8192
    ds_read_b64_tr_b16 a[238:239], v80 offset:9216
    ds_read_b64_tr_b16 a[240:241], v81 offset:0
    ds_read_b64_tr_b16 a[242:243], v81 offset:1024
    ds_read_b64_tr_b16 a[244:245], v81 offset:8192
    ds_read_b64_tr_b16 a[246:247], v81 offset:9216
    s_branch L_lw_13
L_lw_13_0:
    s_cmp_lg_u32 s44, 1
    s_cbranch_scc1 L_lw_13_1
    ds_read_b64_tr_b16 a[128:129], v80 offset:0
    ds_read_b64_tr_b16 a[130:131], v80 offset:1024
    ds_read_b64_tr_b16 a[132:133], v80 offset:8192
    ds_read_b64_tr_b16 a[134:135], v80 offset:9216
    ds_read_b64_tr_b16 v[56:57], v81 offset:0
    ds_read_b64_tr_b16 v[58:59], v81 offset:1024
    ds_read_b64_tr_b16 v[60:61], v81 offset:8192
    ds_read_b64_tr_b16 v[62:63], v81 offset:9216
    s_waitcnt lgkmcnt(0)
    ds_write_b128 v5, v[56:59] offset:6144
    ds_write_b128 v5, v[60:63] offset:7168
    s_branch L_lw_13
L_lw_13_1:
    s_cmp_lg_u32 s44, 2
    s_cbranch_scc1 L_lw_13_2
    ds_read_b64_tr_b16 a[32:33], v80 offset:0
    ds_read_b64_tr_b16 a[34:35], v80 offset:1024
    ds_read_b64_tr_b16 a[36:37], v80 offset:8192
    ds_read_b64_tr_b16 a[38:39], v80 offset:9216
    ds_read_b64_tr_b16 a[40:41], v81 offset:0
    ds_read_b64_tr_b16 a[42:43], v81 offset:1024
    ds_read_b64_tr_b16 a[44:45], v81 offset:8192
    ds_read_b64_tr_b16 a[46:47], v81 offset:9216
    s_branch L_lw_13
L_lw_13_2:
    ds_read_b64_tr_b16 v[184:185], v80 offset:0
    ds_read_b64_tr_b16 v[186:187], v80 offset:1024
    ds_read_b64_tr_b16 v[188:189], v80 offset:8192
    ds_read_b64_tr_b16 v[190:191], v80 offset:9216
    ds_read_b64_tr_b16 v[192:193], v81 offset:0
    ds_read_b64_tr_b16 v[194:195], v81 offset:1024
    ds_read_b64_tr_b16 v[196:197], v81 offset:8192
    ds_read_b64_tr_b16 v[198:199], v81 offset:9216
L_lw_13:
    s_waitcnt lgkmcnt(0)
    s_waitcnt vmcnt(12)
    s_barrier
    s_add_u32 s46, s47, 0x700000
    s_add_u32 m0, s48, 0
    s_nop 0
    buffer_load_dwordx4 v82, s[24:27], s46 offen nt lds
    s_add_u32 s46, s47, 0x720000
    s_add_u32 m0, s48, 4096
    s_nop 0
    buffer_load_dwordx4 v82, s[24:27], s46 offen nt lds
    s_add_u32 s46, s47, 0x740000
    s_add_u32 m0, s48, 8192
    s_nop 0
    buffer_load_dwordx4 v82, s[24:27], s46 offen nt lds
    s_add_u32 s46, s47, 0x760000
    s_add_u32 m0, s48, 12288
    s_nop 0
    buffer_load_dwordx4 v82, s[24:27], s46 offen nt lds
    s_cmp_lg_u32 s44, 0
    s_cbranch_scc1 L_lw_14_0
    ds_read_b64_tr_b16 v[104:105], v80 offset:16384
    ds_read_b64_tr_b16 v[106:107], v80 offset:17408
    ds_read_b64_tr_b16 v[108:109], v80 offset:24576
    ds_read_b64_tr_b16 v[110:111], v80 offset:25600
    ds_read_b64_tr_b16 v[56:57], v81 offset:16384
    ds_read_b64_tr_b16 v[58:59], v81 offset:17408
    ds_read_b64_tr_b16 v[60:61], v81 offset:24576
    ds_read_b64_tr_b16 v[62:63], v81 offset:25600
    s_waitcnt lgkmcnt(0)
    ds_write_b128 v5, v[56:59] offset:12288
    ds_write_b128 v5, v[60:63] offset:13312
    s_branch L_lw_14
L_lw_14_0:
    s_cmp_lg_u32 s44, 1
    s_cbranch_scc1 L_lw_14_1
    ds_read_b64_tr_b16 a[152:153], v80 offset:16384
    ds_read_b64_tr_b16 a[154:155], v80 offset:17408
    ds_read_b64_tr_b16 a[156:157], v80 offset:24576
    ds_read_b64_tr_b16 a[158:159], v80 offset:25600
    ds_read_b64_tr_b16 v[56:57], v81 offset:16384
    ds_read_b64_tr_b16 v[58:59], v81 offset:17408
    ds_read_b64_tr_b16 v[60:61], v81 offset:24576
    ds_read_b64_tr_b16 v[62:63], v81 offset:25600
    s_waitcnt lgkmcnt(0)
    ds_write_b128 v5, v[56:59] offset:14336
    ds_write_b128 v5, v[60:63] offset:15360
    s_branch L_lw_14
L_lw_14_1:
    s_cmp_lg_u32 s44, 2
    s_cbranch_scc1 L_lw_14_2
    ds_read_b64_tr_b16 a[64:65], v80 offset:16384
    ds_read_b64_tr_b16 a[66:67], v80 offset:17408
    ds_read_b64_tr_b16 a[68:69], v80 offset:24576
    ds_read_b64_tr_b16 a[70:71], v80 offset:25600
    ds_read_b64_tr_b16 v[56:57], v81 offset:16384
    ds_read_b64_tr_b16 v[58:59], v81 offset:17408
    ds_read_b64_tr_b16 v[60:61], v81 offset:24576
    ds_read_b64_tr_b16 v[62:63], v81 offset:25600
    s_waitcnt lgkmcnt(0)
    ds_write_b128 v5, v[56:59] offset:8192
    ds_write_b128 v5, v[60:63] offset:9216
    s_branch L_lw_14
L_lw_14_2:
    ds_read_b64_tr_b16 v[208:209], v80 offset:16384
    ds_read_b64_tr_b16 v[210:211], v80 offset:17408
    ds_read_b64_tr_b16 v[212:213], v80 offset:24576
    ds_read_b64_tr_b16 v[214:215], v80 offset:25600
    ds_read_b64_tr_b16 v[56:57], v81 offset:16384
    ds_read_b64_tr_b16 v[58:59], v81 offset:17408
    ds_read_b64_tr_b16 v[60:61], v81 offset:24576
    ds_read_b64_tr_b16 v[62:63], v81 offset:25600
    s_waitcnt lgkmcnt(0)
    ds_write_b128 v5, v[56:59] offset:10240
    ds_write_b128 v5, v[60:63] offset:11264
L_lw_14:
    s_waitcnt lgkmcnt(0)
    s_waitcnt vmcnt(12)
    s_barrier
    s_add_u32 s46, s47, 0x780000
    s_add_u32 m0, s48, 16384
    s_nop 0
    buffer_load_dwordx4 v82, s[24:27], s46 offen nt lds
    s_add_u32 s46, s47, 0x7a0000
    s_add_u32 m0, s48, 20480
    s_nop 0
    buffer_load_dwordx4 v82, s[24:27], s46 offen nt lds
    s_add_u32 s46, s47, 0x7c0000
    s_add_u32 m0, s48, 24576
    s_nop 0
    buffer_load_dwordx4 v82, s[24:27], s46 offen nt lds
    s_add_u32 s46, s47, 0x7e0000
    s_add_u32 m0, s48, 28672
    s_nop 0
    buffer_load_dwordx4 v82, s[24:27], s46 offen nt lds
    s_cmp_lg_u32 s44, 0
    s_cbranch_scc1 L_hs_15
    s_getreg_b32 s45, hwreg(HW_REG_XCC_ID)
    s_and_b32 s45, s45, 15
    s_lshl_b32 s45, 1, s45
    v_mov_b32 v40, s45
    s_lshl_b32 s46, s40, 2
    s_add_u32 s46, s46, 4
    v_mov_b32 v41, 0
    v_mov_b32 v43, s68
    s_mov_b64 exec, 1
    buffer_atomic_or v40, v41, s[16:19], s46 offen sc1
    buffer_atomic_add v43, v41, s[16:19], 0 offen offset:12 sc1
    s_mov_b64 exec, -1
L_hs_15:
    s_cmp_lg_u32 s44, 0
    s_cbranch_scc1 L_lw_16_0
    ds_read_b64_tr_b16 v[128:129], v80 offset:32768
    ds_read_b64_tr_b16 v[130:131], v80 offset:33792
    ds_read_b64_tr_b16 v[132:133], v80 offset:40960
    ds_read_b64_tr_b16 v[134:135], v80 offset:41984
    ds_read_b64_tr_b16 v[136:137], v81 offset:32768
    ds_read_b64_tr_b16 v[138:139], v81 offset:33792
    ds_read_b64_tr_b16 v[140:141], v81 offset:40960
    ds_read_b64_tr_b16 v[142:143], v81 offset:41984
    s_branch L_lw_16
L_lw_16_0:
    s_cmp_lg_u32 s44, 1
    s_cbranch_scc1 L_lw_16_1
    ds_read_b64_tr_b16 a[176:177], v80 offset:32768
    ds_read_b64_tr_b16 a[178:179], v80 offset:33792
    ds_read_b64_tr_b16 a[180:181], v80 offset:40960
    ds_read_b64_tr_b16 a[182:183], v80 offset:41984
    ds_read_b64_tr_b16 a[184:185], v81 offset:32768
    ds_read_b64_tr_b16 a[186:187], v81 offset:33792
    ds_read_b64_tr_b16 a[188:189], v81 offset:40960
    ds_read_b64_tr_b16 a[190:191], v81 offset:41984
    s_branch L_lw_16
L_lw_16_1:
    s_cmp_lg_u32 s44, 2
    s_cbranch_scc1 L_lw_16_2
    ds_read_b64_tr_b16 a[80:81], v80 offset:32768
    ds_read_b64_tr_b16 a[82:83], v80 offset:33792
    ds_read_b64_tr_b16 a[84:85], v80 offset:40960
    ds_read_b64_tr_b16 a[86:87], v80 offset:41984
    ds_read_b64_tr_b16 v[56:57], v81 offset:32768
    ds_read_b64_tr_b16 v[58:59], v81 offset:33792
    ds_read_b64_tr_b16 v[60:61], v81 offset:40960
    ds_read_b64_tr_b16 v[62:63], v81 offset:41984
    s_waitcnt lgkmcnt(0)
    ds_write_b128 v5, v[56:59] offset:16384
    ds_write_b128 v5, v[60:63] offset:17408
    s_branch L_lw_16
L_lw_16_2:
    ds_read_b64_tr_b16 v[232:233], v80 offset:32768
    ds_read_b64_tr_b16 v[234:235], v80 offset:33792
    ds_read_b64_tr_b16 v[236:237], v80 offset:40960
    ds_read_b64_tr_b16 v[238:239], v80 offset:41984
    ds_read_b64_tr_b16 v[240:241], v81 offset:32768
    ds_read_b64_tr_b16 v[242:243], v81 offset:33792
    ds_read_b64_tr_b16 v[244:245], v81 offset:40960
    ds_read_b64_tr_b16 v[246:247], v81 offset:41984
L_lw_16:
    s_waitcnt lgkmcnt(0)
    s_waitcnt vmcnt(12)
    s_barrier
    s_add_u32 s46, s47, 0x0
    s_add_u32 m0, s48, 32768
    s_nop 0
    buffer_load_dwordx4 v82, s[28:31], s46 offen nt lds
    s_add_u32 s46, s47, 0x20000
    s_add_u32 m0, s48, 36864
    s_nop 0
    buffer_load_dwordx4 v82, s[28:31], s46 offen nt lds
    s_add_u32 s46, s47, 0x40000
    s_add_u32 m0, s48, 40960
    s_nop 0
    buffer_load_dwordx4 v82, s[28:31], s46 offen nt lds
    s_add_u32 s46, s47, 0x60000
    s_add_u32 m0, s48, 45056
    s_nop 0
    buffer_load_dwordx4 v82, s[28:31], s46 offen nt lds
    s_cmp_lg_u32 s44, 0
    s_cbranch_scc1 L_lw_17_0
    ds_read_b64_tr_b16 v[160:161], v80 offset:49152
    ds_read_b64_tr_b16 v[162:163], v80 offset:50176
    ds_read_b64_tr_b16 v[164:165], v80 offset:57344
    ds_read_b64_tr_b16 v[166:167], v80 offset:58368
    ds_read_b64_tr_b16 v[56:57], v81 offset:49152
    ds_read_b64_tr_b16 v[58:59], v81 offset:50176
    ds_read_b64_tr_b16 v[60:61], v81 offset:57344
    ds_read_b64_tr_b16 v[62:63], v81 offset:58368
    s_waitcnt lgkmcnt(0)
    ds_write_b128 v5, v[56:59] offset:0
    ds_write_b128 v5, v[60:63] offset:1024
    s_branch L_lw_17
L_lw_17_0:
    s_cmp_lg_u32 s44, 1
    s_cbranch_scc1 L_lw_17_1
    ds_read_b64_tr_b16 a[208:209], v80 offset:49152
    ds_read_b64_tr_b16 a[210:211], v80 offset:50176
    ds_read_b64_tr_b16 a[212:213], v80 offset:57344
    ds_read_b64_tr_b16 a[214:215], v80 offset:58368
    ds_read_b64_tr_b16 v[56:57], v81 offset:49152
    ds_read_b64_tr_b16 v[58:59], v81 offset:50176
    ds_read_b64_tr_b16 v[60:61], v81 offset:57344
    ds_read_b64_tr_b16 v[62:63], v81 offset:58368
    s_waitcnt lgkmcnt(0)
    ds_write_b128 v5, v[56:59] offset:2048
    ds_write_b128 v5, v[60:63] offset:3072
    s_branch L_lw_17
L_lw_17_1:
    s_cmp_lg_u32 s44, 2
    s_cbranch_scc1 L_lw_17_2
    ds_read_b64_tr_b16 a[104:105], v80 offset:49152
    ds_read_b64_tr_b16 a[106:107], v80 offset:50176
    ds_read_b64_tr_b16 a[108:109], v80 offset:57344
    ds_read_b64_tr_b16 a[110:111], v80 offset:58368
    ds_read_b64_tr_b16 v[56:57], v81 offset:49152
    ds_read_b64_tr_b16 v[58:59], v81 offset:50176
    ds_read_b64_tr_b16 v[60:61], v81 offset:57344
    ds_read_b64_tr_b16 v[62:63], v81 offset:58368
    s_waitcnt lgkmcnt(0)
    ds_write_b128 v5, v[56:59] offset:4096
    ds_write_b128 v5, v[60:63] offset:5120
    s_branch L_lw_17
L_lw_17_2:
    ds_read_b64_tr_b16 a[0:1], v80 offset:49152
    ds_read_b64_tr_b16 a[2:3], v80 offset:50176
    ds_read_b64_tr_b16 a[4:5], v80 offset:57344
    ds_read_b64_tr_b16 a[6:7], v80 offset:58368
    ds_read_b64_tr_b16 a[8:9], v81 offset:49152
    ds_read_b64_tr_b16 a[10:11], v81 offset:50176
    ds_read_b64_tr_b16 a[12:13], v81 offset:57344
    ds_read_b64_tr_b16 a[14:15], v81 offset:58368
L_lw_17:
    s_waitcnt lgkmcnt(0)
    s_waitcnt vmcnt(12)
    s_barrier
    s_add_u32 s46, s47, 0x80000
    s_add_u32 m0, s48, 49152
    s_nop 0
    buffer_load_dwordx4 v82, s[28:31], s46 offen nt lds
    s_add_u32 s46, s47, 0xa0000
    s_add_u32 m0, s48, 53248
    s_nop 0
    buffer_load_dwordx4 v82, s[28:31], s46 offen nt lds
    s_add_u32 s46, s47, 0xc0000
    s_add_u32 m0, s48, 57344
    s_nop 0
    buffer_load_dwordx4 v82, s[28:31], s46 offen nt lds
    s_add_u32 s46, s47, 0xe0000
    s_add_u32 m0, s48, 61440
    s_nop 0
    buffer_load_dwordx4 v82, s[28:31], s46 offen nt lds
    s_cmp_lg_u32 s44, 0
    s_cbranch_scc1 L_lw_18_0
    ds_read_b64_tr_b16 v[184:185], v84 offset:20480
    ds_read_b64_tr_b16 v[186:187], v84 offset:21504
    ds_read_b64_tr_b16 v[188:189], v86 offset:20480
    ds_read_b64_tr_b16 v[190:191], v86 offset:21504
    ds_read_b64_tr_b16 v[192:193], v85 offset:20480
    ds_read_b64_tr_b16 v[194:195], v85 offset:21504
    ds_read_b64_tr_b16 v[196:197], v87 offset:20480
    ds_read_b64_tr_b16 v[198:199], v87 offset:21504
    s_branch L_lw_18
L_lw_18_0:
    s_cmp_lg_u32 s44, 1
    s_cbranch_scc1 L_lw_18_1
    ds_read_b64_tr_b16 a[232:233], v84 offset:20480
    ds_read_b64_tr_b16 a[234:235], v84 offset:21504
    ds_read_b64_tr_b16 a[236:237], v86 offset:20480
    ds_read_b64_tr_b16 a[238:239], v86 offset:21504
    ds_read_b64_tr_b16 a[240:241], v85 offset:20480
    ds_read_b64_tr_b16 a[242:243], v85 offset:21504
    ds_read_b64_tr_b16 a[244:245], v87 offset:20480
    ds_read_b64_tr_b16 a[246:247], v87 offset:21504
    s_branch L_lw_18
L_lw_18_1:
    s_cmp_lg_u32 s44, 2
    s_cbranch_scc1 L_lw_18_2
    ds_read_b64_tr_b16 a[128:129], v84 offset:20480
    ds_read_b64_tr_b16 a[130:131], v84 offset:21504
    ds_read_b64_tr_b16 a[132:133], v86 offset:20480
    ds_read_b64_tr_b16 a[134:135], v86 offset:21504
    ds_read_b64_tr_b16 v[56:57], v85 offset:20480
    ds_read_b64_tr_b16 v[58:59], v85 offset:21504
    ds_read_b64_tr_b16 v[60:61], v87 offset:20480
    ds_read_b64_tr_b16 v[62:63], v87 offset:21504
    s_waitcnt lgkmcnt(0)
    ds_write_b128 v5, v[56:59] offset:6144
    ds_write_b128 v5, v[60:63] offset:7168
    s_branch L_lw_18
L_lw_18_2:
    ds_read_b64_tr_b16 a[32:33], v84 offset:20480
    ds_read_b64_tr_b16 a[34:35], v84 offset:21504
    ds_read_b64_tr_b16 a[36:37], v86 offset:20480
    ds_read_b64_tr_b16 a[38:39], v86 offset:21504
    ds_read_b64_tr_b16 a[40:41], v85 offset:20480
    ds_read_b64_tr_b16 a[42:43], v85 offset:21504
    ds_read_b64_tr_b16 a[44:45], v87 offset:20480
    ds_read_b64_tr_b16 a[46:47], v87 offset:21504
L_lw_18:
    s_waitcnt lgkmcnt(0)
    s_waitcnt vmcnt(12)
    s_barrier
    s_cmp_lg_u32 s44, 0
    s_cbranch_scc1 L_lw_19_0
    ds_read_b64_tr_b16 v[208:209], v80 offset:0
    ds_read_b64_tr_b16 v[210:211], v80 offset:1024
    ds_read_b64_tr_b16 v[212:213], v80 offset:8192
    ds_read_b64_tr_b16 v[214:215], v80 offset:9216
    ds_read_b64_tr_b16 v[56:57], v81 offset:0
    ds_read_b64_tr_b16 v[58:59], v81 offset:1024
    ds_read_b64_tr_b16 v[60:61], v81 offset:8192
    ds_read_b64_tr_b16 v[62:63], v81 offset:9216
    s_waitcnt lgkmcnt(0)
    ds_write_b128 v5, v[56:59] offset:10240
    ds_write_b128 v5, v[60:63] offset:11264
    s_branch L_lw_19
L_lw_19_0:
    s_cmp_lg_u32 s44, 1
    s_cbranch_scc1 L_lw_19_1
    ds_read_b64_tr_b16 v[104:105], v80 offset:0
    ds_read_b64_tr_b16 v[106:107], v80 offset:1024
    ds_read_b64_tr_b16 v[108:109], v80 offset:8192
    ds_read_b64_tr_b16 v[110:111], v80 offset:9216
    ds_read_b64_tr_b16 v[56:57], v81 offset:0
    ds_read_b64_tr_b16 v[58:59], v81 offset:1024
    ds_read_b64_tr_b16 v[60:61], v81 offset:8192
    ds_read_b64_tr_b16 v[62:63], v81 offset:9216
    s_waitcnt lgkmcnt(0)
    ds_write_b128 v5, v[56:59] offset:12288
    ds_write_b128 v5, v[60:63] offset:13312
    s_branch L_lw_19
L_lw_19_1:
    s_cmp_lg_u32 s44, 2
    s_cbranch_scc1 L_lw_19_2
    ds_read_b64_tr_b16 a[152:153], v80 offset:0
    ds_read_b64_tr_b16 a[154:155], v80 offset:1024
    ds_read_b64_tr_b16 a[156:157], v80 offset:8192
    ds_read_b64_tr_b16 a[158:159], v80 offset:9216
    ds_read_b64_tr_b16 v[56:57], v81 offset:0
    ds_read_b64_tr_b16 v[58:59], v81 offset:1024
    ds_read_b64_tr_b16 v[60:61], v81 offset:8192
    ds_read_b64_tr_b16 v[62:63], v81 offset:9216
    s_waitcnt lgkmcnt(0)
    ds_write_b128 v5, v[56:59] offset:14336
    ds_write_b128 v5, v[60:63] offset:15360
    s_branch L_lw_19
L_lw_19_2:
    ds_read_b64_tr_b16 a[64:65], v80 offset:0
    ds_read_b64_tr_b16 a[66:67], v80 offset:1024
    ds_read_b64_tr_b16 a[68:69], v80 offset:8192
    ds_read_b64_tr_b16 a[70:71], v80 offset:9216
    ds_read_b64_tr_b16 v[56:57], v81 offset:0
    ds_read_b64_tr_b16 v[58:59], v81 offset:1024
    ds_read_b64_tr_b16 v[60:61], v81 offset:8192
    ds_read_b64_tr_b16 v[62:63], v81 offset:9216
    s_waitcnt lgkmcnt(0)
    ds_write_b128 v5, v[56:59] offset:8192
    ds_write_b128 v5, v[60:63] offset:9216
L_lw_19:
    s_waitcnt lgkmcnt(0)
    s_waitcnt vmcnt(8)
    s_barrier
    s_add_u32 s46, s47, 0x100000
    s_add_u32 m0, s48, 0
    s_nop 0
    buffer_load_dwordx4 v82, s[28:31], s46 offen nt lds
    s_add_u32 s46, s47, 0x120000
    s_add_u32 m0, s48, 4096
    s_nop 0
    buffer_load_dwordx4 v82, s[28:31], s46 offen nt lds
    s_add_u32 s46, s47, 0x140000
    s_add_u32 m0, s48, 8192
    s_nop 0
    buffer_load_dwordx4 v82, s[28:31], s46 offen nt lds
    s_add_u32 s46, s47, 0x160000
    s_add_u32 m0, s48, 12288
    s_nop 0
    buffer_load_dwordx4 v82, s[28:31], s46 offen nt lds
    s_cmp_lg_u32 s44, 0
    s_cbranch_scc1 L_lw_20_0
    ds_read_b64_tr_b16 v[232:233], v80 offset:16384
    ds_read_b64_tr_b16 v[234:235], v80 offset:17408
    ds_read_b64_tr_b16 v[236:237], v80 offset:24576
    ds_read_b64_tr_b16 v[238:239], v80 offset:25600
    ds_read_b64_tr_b16 v[240:241], v81 offset:16384
    ds_read_b64_tr_b16 v[242:243], v81 offset:17408
    ds_read_b64_tr_b16 v[244:245], v81 offset:24576
    ds_read_b64_tr_b16 v[246:247], v81 offset:25600
    s_branch L_lw_20
L_lw_20_0:
    s_cmp_lg_u32 s44, 1
    s_cbranch_scc1 L_lw_20_1
    ds_read_b64_tr_b16 v[128:129], v80 offset:16384
    ds_read_b64_tr_b16 v[130:131], v80 offset:17408
    ds_read_b64_tr_b16 v[132:133], v80 offset:24576
    ds_read_b64_tr_b16 v[134:135], v80 offset:25600
    ds_read_b64_tr_b16 v[136:137], v81 offset:16384
    ds_read_b64_tr_b16 v[138:139], v81 offset:17408
    ds_read_b64_tr_b16 v[140:141], v81 offset:24576
    ds_read_b64_tr_b16 v[142:143], v81 offset:25600
    s_branch L_lw_20
L_lw_20_1:
    s_cmp_lg_u32 s44, 2
    s_cbranch_scc1 L_lw_20_2
    ds_read_b64_tr_b16 a[176:177], v80 offset:16384
    ds_read_b64_tr_b16 a[178:179], v80 offset:17408
    ds_read_b64_tr_b16 a[180:181], v80 offset:24576
    ds_read_b64_tr_b16 a[182:183], v80 offset:25600
    ds_read_b64_tr_b16 a[184:185], v81 offset:16384
    ds_read_b64_tr_b16 a[186:187], v81 offset:17408
    ds_read_b64_tr_b16 a[188:189], v81 offset:24576
    ds_read_b64_tr_b16 a[190:191], v81 offset:25600
    s_branch L_lw_20
L_lw_20_2:
    ds_read_b64_tr_b16 a[80:81], v80 offset:16384
    ds_read_b64_tr_b16 a[82:83], v80 offset:17408
    ds_read_b64_tr_b16 a[84:85], v80 offset:24576
    ds_read_b64_tr_b16 a[86:87], v80 offset:25600
    ds_read_b64_tr_b16 v[56:57], v81 offset:16384
    ds_read_b64_tr_b16 v[58:59], v81 offset:17408
    ds_read_b64_tr_b16 v[60:61], v81 offset:24576
    ds_read_b64_tr_b16 v[62:63], v81 offset:25600
    s_waitcnt lgkmcnt(0)
    ds_write_b128 v5, v[56:59] offset:16384
    ds_write_b128 v5, v[60:63] offset:17408
L_lw_20:
    s_waitcnt lgkmcnt(0)
    s_waitcnt vmcnt(8)
    s_barrier
    s_add_u32 s46, s47, 0x180000
    s_add_u32 m0, s48, 16384
    s_nop 0
    buffer_load_dwordx4 v82, s[28:31], s46 offen nt lds
    s_add_u32 s46, s47, 0x1a0000
    s_add_u32 m0, s48, 20480
    s_nop 0
    buffer_load_dwordx4 v82, s[28:31], s46 offen nt lds
    s_add_u32 s46, s47, 0x1c0000
    s_add_u32 m0, s48, 24576
    s_nop 0
    buffer_load_dwordx4 v82, s[28:31], s46 offen nt lds
    s_add_u32 s46, s47, 0x1e0000
    s_add_u32 m0, s48, 28672
    s_nop 0
    buffer_load_dwordx4 v82, s[28:31], s46 offen nt lds
    s_cmp_lg_u32 s44, 0
    s_cbranch_scc1 L_lw_21_0
    ds_read_b64_tr_b16 a[16:17], v80 offset:32768
    ds_read_b64_tr_b16 a[18:19], v80 offset:33792
    ds_read_b64_tr_b16 a[20:21], v80 offset:40960
    ds_read_b64_tr_b16 a[22:23], v80 offset:41984
    ds_read_b64_tr_b16 a[24:25], v81 offset:32768
    ds_read_b64_tr_b16 a[26:27], v81 offset:33792
    ds_read_b64_tr_b16 a[28:29], v81 offset:40960
    ds_read_b64_tr_b16 a[30:31], v81 offset:41984
    s_branch L_lw_21
L_lw_21_0:
    s_cmp_lg_u32 s44, 1
    s_cbranch_scc1 L_lw_21_1
    ds_read_b64_tr_b16 v[168:169], v80 offset:32768
    ds_read_b64_tr_b16 v[170:171], v80 offset:33792
    ds_read_b64_tr_b16 v[172:173], v80 offset:40960
    ds_read_b64_tr_b16 v[174:175], v80 offset:41984
    ds_read_b64_tr_b16 v[176:177], v81 offset:32768
    ds_read_b64_tr_b16 v[178:179], v81 offset:33792
    ds_read_b64_tr_b16 v[180:181], v81 offset:40960
    ds_read_b64_tr_b16 v[182:183], v81 offset:41984
    s_branch L_lw_21
L_lw_21_1:
    s_cmp_lg_u32 s44, 2
    s_cbranch_scc1 L_lw_21_2
    ds_read_b64_tr_b16 a[216:217], v80 offset:32768
    ds_read_b64_tr_b16 a[218:219], v80 offset:33792
    ds_read_b64_tr_b16 a[220:221], v80 offset:40960
    ds_read_b64_tr_b16 a[222:223], v80 offset:41984
    ds_read_b64_tr_b16 a[224:225], v81 offset:32768
    ds_read_b64_tr_b16 a[226:227], v81 offset:33792
    ds_read_b64_tr_b16 a[228:229], v81 offset:40960
    ds_read_b64_tr_b16 a[230:231], v81 offset:41984
    s_branch L_lw_21
L_lw_21_2:
    ds_read_b64_tr_b16 a[112:113], v80 offset:32768
    ds_read_b64_tr_b16 a[114:115], v80 offset:33792
    ds_read_b64_tr_b16 a[116:117], v80 offset:40960
    ds_read_b64_tr_b16 a[118:119], v80 offset:41984
    ds_read_b64_tr_b16 a[120:121], v81 offset:32768
    ds_read_b64_tr_b16 a[122:123], v81 offset:33792
    ds_read_b64_tr_b16 a[124:125], v81 offset:40960
    ds_read_b64_tr_b16 a[126:127], v81 offset:41984
L_lw_21:
    s_waitcnt lgkmcnt(0)
    s_waitcnt vmcnt(8)
    s_barrier
    s_add_u32 s46, s47, 0x200000
    s_add_u32 m0, s48, 32768
    s_nop 0
    buffer_load_dwordx4 v82, s[28:31], s46 offen nt lds
    s_add_u32 s46, s47, 0x220000
    s_add_u32 m0, s48, 36864
    s_nop 0
    buffer_load_dwordx4 v82, s[28:31], s46 offen nt lds
    s_add_u32 s46, s47, 0x240000
    s_add_u32 m0, s48, 40960
    s_nop 0
    buffer_load_dwordx4 v82, s[28:31], s46 offen nt lds
    s_add_u32 s46, s47, 0x260000
    s_add_u32 m0, s48, 45056
    s_nop 0
    buffer_load_dwordx4 v82, s[28:31], s46 offen nt lds
    s_cmp_lg_u32 s44, 0
    s_cbranch_scc1 L_lw_22_0
    ds_read_b64_tr_b16 a[48:49], v80 offset:49152
    ds_read_b64_tr_b16 a[50:51], v80 offset:50176
    ds_read_b64_tr_b16 a[52:53], v80 offset:57344
    ds_read_b64_tr_b16 a[54:55], v80 offset:58368
    ds_read_b64_tr_b16 a[56:57], v81 offset:49152
    ds_read_b64_tr_b16 a[58:59], v81 offset:50176
    ds_read_b64_tr_b16 a[60:61], v81 offset:57344
    ds_read_b64_tr_b16 a[62:63], v81 offset:58368
    s_branch L_lw_22
L_lw_22_0:
    s_cmp_lg_u32 s44, 1
    s_cbranch_scc1 L_lw_22_1
    ds_read_b64_tr_b16 v[200:201], v80 offset:49152
    ds_read_b64_tr_b16 v[202:203], v80 offset:50176
    ds_read_b64_tr_b16 v[204:205], v80 offset:57344
    ds_read_b64_tr_b16 v[206:207], v80 offset:58368
    ds_read_b64_tr_b16 v[56:57], v81 offset:49152
    ds_read_b64_tr_b16 v[58:59], v81 offset:50176
    ds_read_b64_tr_b16 v[60:61], v81 offset:57344
    ds_read_b64_tr_b16 v[62:63], v81 offset:58368
    s_waitcnt lgkmcnt(0)
    ds_write_b128 v5, v[56:59] offset:18432
    ds_write_b128 v5, v[60:63] offset:19456
    s_branch L_lw_22
L_lw_22_1:
    s_cmp_lg_u32 s44, 2
    s_cbranch_scc1 L_lw_22_2
    ds_read_b64_tr_b16 a[248:249], v80 offset:49152
    ds_read_b64_tr_b16 a[250:251], v80 offset:50176
    ds_read_b64_tr_b16 a[252:253], v80 offset:57344
    ds_read_b64_tr_b16 a[254:255], v80 offset:58368
    ds_read_b64_tr_b16 v[96:97], v81 offset:49152
    ds_read_b64_tr_b16 v[98:99], v81 offset:50176
    ds_read_b64_tr_b16 v[100:101], v81 offset:57344
    ds_read_b64_tr_b16 v[102:103], v81 offset:58368
    s_branch L_lw_22
L_lw_22_2:
    ds_read_b64_tr_b16 a[136:137], v80 offset:49152
    ds_read_b64_tr_b16 a[138:139], v80 offset:50176
    ds_read_b64_tr_b16 a[140:141], v80 offset:57344
    ds_read_b64_tr_b16 a[142:143], v80 offset:58368
    ds_read_b64_tr_b16 a[144:145], v81 offset:49152
    ds_read_b64_tr_b16 a[146:147], v81 offset:50176
    ds_read_b64_tr_b16 a[148:149], v81 offset:57344
    ds_read_b64_tr_b16 a[150:151], v81 offset:58368
L_lw_22:
    s_waitcnt lgkmcnt(0)
    s_waitcnt vmcnt(8)
    s_barrier
    s_add_u32 s46, s47, 0x280000
    s_add_u32 m0, s48, 49152
    s_nop 0
    buffer_load_dwordx4 v82, s[28:31], s46 offen nt lds
    s_add_u32 s46, s47, 0x2a0000
    s_add_u32 m0, s48, 53248
    s_nop 0
    buffer_load_dwordx4 v82, s[28:31], s46 offen nt lds
    s_add_u32 s46, s47, 0x2c0000
    s_add_u32 m0, s48, 57344
    s_nop 0
    buffer_load_dwordx4 v82, s[28:31], s46 offen nt lds
    s_add_u32 s46, s47, 0x2e0000
    s_add_u32 m0, s48, 61440
    s_nop 0
    buffer_load_dwordx4 v82, s[28:31], s46 offen nt lds
    s_cmp_lg_u32 s44, 0
    s_cbranch_scc1 L_lw_23_0
    ds_read_b64_tr_b16 a[72:73], v80 offset:0
    ds_read_b64_tr_b16 a[74:75], v80 offset:1024
    ds_read_b64_tr_b16 a[76:77], v80 offset:8192
    ds_read_b64_tr_b16 a[78:79], v80 offset:9216
    ds_read_b64_tr_b16 v[56:57], v81 offset:0
    ds_read_b64_tr_b16 v[58:59], v81 offset:1024
    ds_read_b64_tr_b16 v[60:61], v81 offset:8192
    ds_read_b64_tr_b16 v[62:63], v81 offset:9216
    s_waitcnt lgkmcnt(0)
    ds_write_b128 v5, v[56:59] offset:20480
    ds_write_b128 v5, v[60:63] offset:21504
    s_branch L_lw_23
L_lw_23_0:
    s_cmp_lg_u32 s44, 1
    s_cbranch_scc1 L_lw_23_1
    ds_read_b64_tr_b16 v[216:217], v80 offset:0
    ds_read_b64_tr_b16 v[218:219], v80 offset:1024
    ds_read_b64_tr_b16 v[220:221], v80 offset:8192
    ds_read_b64_tr_b16 v[222:223], v80 offset:9216
    ds_read_b64_tr_b16 v[224:225], v81 offset:0
    ds_read_b64_tr_b16 v[226:227], v81 offset:1024
    ds_read_b64_tr_b16 v[228:229], v81 offset:8192
    ds_read_b64_tr_b16 v[230:231], v81 offset:9216
    s_branch L_lw_23
L_lw_23_1:
    s_cmp_lg_u32 s44, 2
    s_cbranch_scc1 L_lw_23_2
    ds_read_b64_tr_b16 v[112:113], v80 offset:0
    ds_read_b64_tr_b16 v[114:115], v80 offset:1024
    ds_read_b64_tr_b16 v[116:117], v80 offset:8192
    ds_read_b64_tr_b16 v[118:119], v80 offset:9216
    ds_read_b64_tr_b16 v[120:121], v81 offset:0
    ds_read_b64_tr_b16 v[122:123], v81 offset:1024
    ds_read_b64_tr_b16 v[124:125], v81 offset:8192
    ds_read_b64_tr_b16 v[126:127], v81 offset:9216
    s_branch L_lw_23
L_lw_23_2:
    ds_read_b64_tr_b16 a[160:161], v80 offset:0
    ds_read_b64_tr_b16 a[162:163], v80 offset:1024
    ds_read_b64_tr_b16 a[164:165], v80 offset:8192
    ds_read_b64_tr_b16 a[166:167], v80 offset:9216
    ds_read_b64_tr_b16 a[168:169], v81 offset:0
    ds_read_b64_tr_b16 a[170:171], v81 offset:1024
    ds_read_b64_tr_b16 a[172:173], v81 offset:8192
    ds_read_b64_tr_b16 a[174:175], v81 offset:9216
L_lw_23:
    s_waitcnt lgkmcnt(0)
    s_waitcnt vmcnt(8)
    s_barrier
    s_add_u32 s46, s47, 0x300000
    s_add_u32 m0, s48, 0
    s_nop 0
    buffer_load_dwordx4 v82, s[28:31], s46 offen nt lds
    s_add_u32 s46, s47, 0x320000
    s_add_u32 m0, s48, 4096
    s_nop 0
    buffer_load_dwordx4 v82, s[28:31], s46 offen nt lds
    s_add_u32 s46, s47, 0x340000
    s_add_u32 m0, s48, 8192
    s_nop 0
    buffer_load_dwordx4 v82, s[28:31], s46 offen nt lds
    s_add_u32 s46, s47, 0x360000
    s_add_u32 m0, s48, 12288
    s_nop 0
    buffer_load_dwordx4 v82, s[28:31], s46 offen nt lds
    s_cmp_lg_u32 s44, 0
    s_cbranch_scc1 L_lw_24_0
    ds_read_b64_tr_b16 a[88:89], v80 offset:16384
    ds_read_b64_tr_b16 a[90:91], v80 offset:17408
    ds_read_b64_tr_b16 a[92:93], v80 offset:24576
    ds_read_b64_tr_b16 a[94:95], v80 offset:25600
    ds_read_b64_tr_b16 a[96:97], v81 offset:16384
    ds_read_b64_tr_b16 a[98:99], v81 offset:17408
    ds_read_b64_tr_b16 a[100:101], v81 offset:24576
    ds_read_b64_tr_b16 a[102:103], v81 offset:25600
    s_branch L_lw_24
L_lw_24_0:
    s_cmp_lg_u32 s44, 1
    s_cbranch_scc1 L_lw_24_1
    ds_read_b64_tr_b16 v[248:249], v80 offset:16384
    ds_read_b64_tr_b16 v[250:251], v80 offset:17408
    ds_read_b64_tr_b16 v[252:253], v80 offset:24576
    ds_read_b64_tr_b16 v[254:255], v80 offset:25600
    ds_read_b64_tr_b16 v[56:57], v81 offset:16384
    ds_read_b64_tr_b16 v[58:59], v81 offset:17408
    ds_read_b64_tr_b16 v[60:61], v81 offset:24576
    ds_read_b64_tr_b16 v[62:63], v81 offset:25600
    s_waitcnt lgkmcnt(0)
    ds_write_b128 v5, v[56:59] offset:22528
    ds_write_b128 v5, v[60:63] offset:23552
    s_branch L_lw_24
L_lw_24_1:
    s_cmp_lg_u32 s44, 2
    s_cbranch_scc1 L_lw_24_2
    ds_read_b64_tr_b16 v[144:145], v80 offset:16384
    ds_read_b64_tr_b16 v[146:147], v80 offset:17408
    ds_read_b64_tr_b16 v[148:149], v80 offset:24576
    ds_read_b64_tr_b16 v[150:151], v80 offset:25600
    ds_read_b64_tr_b16 v[152:153], v81 offset:16384
    ds_read_b64_tr_b16 v[154:155], v81 offset:17408
    ds_read_b64_tr_b16 v[156:157], v81 offset:24576
    ds_read_b64_tr_b16 v[158:159], v81 offset:25600
    s_branch L_lw_24
L_lw_24_2:
    ds_read_b64_tr_b16 a[192:193], v80 offset:16384
    ds_read_b64_tr_b16 a[194:195], v80 offset:17408
    ds_read_b64_tr_b16 a[196:197], v80 offset:24576
    ds_read_b64_tr_b16 a[198:199], v80 offset:25600
    ds_read_b64_tr_b16 a[200:201], v81 offset:16384
    ds_read_b64_tr_b16 a[202:203], v81 offset:17408
    ds_read_b64_tr_b16 a[204:205], v81 offset:24576
    ds_read_b64_tr_b16 a[206:207], v81 offset:25600
L_lw_24:
    s_waitcnt lgkmcnt(0)
    s_waitcnt vmcnt(8)
    s_barrier
    s_add_u32 s46, s47, 0x380000
    s_add_u32 m0, s48, 16384
    s_nop 0
    buffer_load_dwordx4 v82, s[28:31], s46 offen nt lds
    s_add_u32 s46, s47, 0x3a0000
    s_add_u32 m0, s48, 20480
    s_nop 0
    buffer_load_dwordx4 v82, s[28:31], s46 offen nt lds
    s_add_u32 s46, s47, 0x3c0000
    s_add_u32 m0, s48, 24576
    s_nop 0
    buffer_load_dwordx4 v82, s[28:31], s46 offen nt lds
    s_add_u32 s46, s47, 0x3e0000
    s_add_u32 m0, s48, 28672
    s_nop 0
    buffer_load_dwordx4 v82, s[28:31], s46 offen nt lds
    s_cmp_lg_u32 s44, 0
    s_cbranch_scc1 L_lw_25_0
    ds_read_b64_tr_b16 a[112:113], v80 offset:32768
    ds_read_b64_tr_b16 a[114:115], v80 offset:33792
    ds_read_b64_tr_b16 a[116:117], v80 offset:40960
    ds_read_b64_tr_b16 a[118:119], v80 offset:41984
    ds_read_b64_tr_b16 a[120:121], v81 offset:32768
    ds_read_b64_tr_b16 a[122:123], v81 offset:33792
    ds_read_b64_tr_b16 a[124:125], v81 offset:40960
    ds_read_b64_tr_b16 a[126:127], v81 offset:41984
    s_branch L_lw_25
L_lw_25_0:
    s_cmp_lg_u32 s44, 1
    s_cbranch_scc1 L_lw_25_1
    ds_read_b64_tr_b16 a[16:17], v80 offset:32768
    ds_read_b64_tr_b16 a[18:19], v80 offset:33792
    ds_read_b64_tr_b16 a[20:21], v80 offset:40960
    ds_read_b64_tr_b16 a[22:23], v80 offset:41984
    ds_read_b64_tr_b16 a[24:25], v81 offset:32768
    ds_read_b64_tr_b16 a[26:27], v81 offset:33792
    ds_read_b64_tr_b16 a[28:29], v81 offset:40960
    ds_read_b64_tr_b16 a[30:31], v81 offset:41984
    s_branch L_lw_25
L_lw_25_1:
    s_cmp_lg_u32 s44, 2
    s_cbranch_scc1 L_lw_25_2
    ds_read_b64_tr_b16 v[168:169], v80 offset:32768
    ds_read_b64_tr_b16 v[170:171], v80 offset:33792
    ds_read_b64_tr_b16 v[172:173], v80 offset:40960
    ds_read_b64_tr_b16 v[174:175], v80 offset:41984
    ds_read_b64_tr_b16 v[176:177], v81 offset:32768
    ds_read_b64_tr_b16 v[178:179], v81 offset:33792
    ds_read_b64_tr_b16 v[180:181], v81 offset:40960
    ds_read_b64_tr_b16 v[182:183], v81 offset:41984
    s_branch L_lw_25
L_lw_25_2:
    ds_read_b64_tr_b16 a[216:217], v80 offset:32768
    ds_read_b64_tr_b16 a[218:219], v80 offset:33792
    ds_read_b64_tr_b16 a[220:221], v80 offset:40960
    ds_read_b64_tr_b16 a[222:223], v80 offset:41984
    ds_read_b64_tr_b16 a[224:225], v81 offset:32768
    ds_read_b64_tr_b16 a[226:227], v81 offset:33792
    ds_read_b64_tr_b16 a[228:229], v81 offset:40960
    ds_read_b64_tr_b16 a[230:231], v81 offset:41984
L_lw_25:
    s_waitcnt lgkmcnt(0)
    s_waitcnt vmcnt(8)
    s_barrier
    s_add_u32 s46, s47, 0x400000
    s_add_u32 m0, s48, 32768
    s_nop 0
    buffer_load_dwordx4 v82, s[28:31], s46 offen nt lds
    s_add_u32 s46, s47, 0x420000
    s_add_u32 m0, s48, 36864
    s_nop 0
    buffer_load_dwordx4 v82, s[28:31], s46 offen nt lds
    s_add_u32 s46, s47, 0x440000
    s_add_u32 m0, s48, 40960
    s_nop 0
    buffer_load_dwordx4 v82, s[28:31], s46 offen nt lds
    s_add_u32 s46, s47, 0x460000
    s_add_u32 m0, s48, 45056
    s_nop 0
    buffer_load_dwordx4 v82, s[28:31], s46 offen nt lds
    s_cmp_lg_u32 s44, 0
    s_cbranch_scc1 L_lw_26_0
    ds_read_b64_tr_b16 a[136:137], v80 offset:49152
    ds_read_b64_tr_b16 a[138:139], v80 offset:50176
    ds_read_b64_tr_b16 a[140:141], v80 offset:57344
    ds_read_b64_tr_b16 a[142:143], v80 offset:58368
    ds_read_b64_tr_b16 a[144:145], v81 offset:49152
    ds_read_b64_tr_b16 a[146:147], v81 offset:50176
    ds_read_b64_tr_b16 a[148:149], v81 offset:57344
    ds_read_b64_tr_b16 a[150:151], v81 offset:58368
    s_branch L_lw_26
L_lw_26_0:
    s_cmp_lg_u32 s44, 1
    s_cbranch_scc1 L_lw_26_1
    ds_read_b64_tr_b16 a[48:49], v80 offset:49152
    ds_read_b64_tr_b16 a[50:51], v80 offset:50176
    ds_read_b64_tr_b16 a[52:53], v80 offset:57344
    ds_read_b64_tr_b16 a[54:55], v80 offset:58368
    ds_read_b64_tr_b16 a[56:57], v81 offset:49152
    ds_read_b64_tr_b16 a[58:59], v81 offset:50176
    ds_read_b64_tr_b16 a[60:61], v81 offset:57344
    ds_read_b64_tr_b16 a[62:63], v81 offset:58368
    s_branch L_lw_26
L_lw_26_1:
    s_cmp_lg_u32 s44, 2
    s_cbranch_scc1 L_lw_26_2
    ds_read_b64_tr_b16 v[200:201], v80 offset:49152
    ds_read_b64_tr_b16 v[202:203], v80 offset:50176
    ds_read_b64_tr_b16 v[204:205], v80 offset:57344
    ds_read_b64_tr_b16 v[206:207], v80 offset:58368
    ds_read_b64_tr_b16 v[56:57], v81 offset:49152
    ds_read_b64_tr_b16 v[58:59], v81 offset:50176
    ds_read_b64_tr_b16 v[60:61], v81 offset:57344
    ds_read_b64_tr_b16 v[62:63], v81 offset:58368
    s_waitcnt lgkmcnt(0)
    ds_write_b128 v5, v[56:59] offset:18432
    ds_write_b128 v5, v[60:63] offset:19456
    s_branch L_lw_26
L_lw_26_2:
    ds_read_b64_tr_b16 a[248:249], v80 offset:49152
    ds_read_b64_tr_b16 a[250:251], v80 offset:50176
    ds_read_b64_tr_b16 a[252:253], v80 offset:57344
    ds_read_b64_tr_b16 a[254:255], v80 offset:58368
    ds_read_b64_tr_b16 v[96:97], v81 offset:49152
    ds_read_b64_tr_b16 v[98:99], v81 offset:50176
    ds_read_b64_tr_b16 v[100:101], v81 offset:57344
    ds_read_b64_tr_b16 v[102:103], v81 offset:58368
L_lw_26:
    s_waitcnt lgkmcnt(0)
    s_waitcnt vmcnt(8)
    s_barrier
    s_add_u32 s46, s47, 0x480000
    s_add_u32 m0, s48, 49152
    s_nop 0
    buffer_load_dwordx4 v82, s[28:31], s46 offen nt lds
    s_add_u32 s46, s47, 0x4a0000
    s_add_u32 m0, s48, 53248
    s_nop 0
    buffer_load_dwordx4 v82, s[28:31], s46 offen nt lds
    s_add_u32 s46, s47, 0x4c0000
    s_add_u32 m0, s48, 57344
    s_nop 0
    buffer_load_dwordx4 v82, s[28:31], s46 offen nt lds
    s_add_u32 s46, s47, 0x4e0000
    s_add_u32 m0, s48, 61440
    s_nop 0
    buffer_load_dwordx4 v82, s[28:31], s46 offen nt lds
    s_cmp_lg_u32 s44, 0
    s_cbranch_scc1 L_lw_27_0
    ds_read_b64_tr_b16 a[160:161], v80 offset:0
    ds_read_b64_tr_b16 a[162:163], v80 offset:1024
    ds_read_b64_tr_b16 a[164:165], v80 offset:8192
    ds_read_b64_tr_b16 a[166:167], v80 offset:9216
    ds_read_b64_tr_b16 a[168:169], v81 offset:0
    ds_read_b64_tr_b16 a[170:171], v81 offset:1024
    ds_read_b64_tr_b16 a[172:173], v81 offset:8192
    ds_read_b64_tr_b16 a[174:175], v81 offset:9216
    s_branch L_lw_27
L_lw_27_0:
    s_cmp_lg_u32 s44, 1
    s_cbranch_scc1 L_lw_27_1
    ds_read_b64_tr_b16 a[72:73], v80 offset:0
    ds_read_b64_tr_b16 a[74:75], v80 offset:1024
    ds_read_b64_tr_b16 a[76:77], v80 offset:8192
    ds_read_b64_tr_b16 a[78:79], v80 offset:9216
    ds_read_b64_tr_b16 v[56:57], v81 offset:0
    ds_read_b64_tr_b16 v[58:59], v81 offset:1024
    ds_read_b64_tr_b16 v[60:61], v81 offset:8192
    ds_read_b64_tr_b16 v[62:63], v81 offset:9216
    s_waitcnt lgkmcnt(0)
    ds_write_b128 v5, v[56:59] offset:20480
    ds_write_b128 v5, v[60:63] offset:21504
    s_branch L_lw_27
L_lw_27_1:
    s_cmp_lg_u32 s44, 2
    s_cbranch_scc1 L_lw_27_2
    ds_read_b64_tr_b16 v[216:217], v80 offset:0
    ds_read_b64_tr_b16 v[218:219], v80 offset:1024
    ds_read_b64_tr_b16 v[220:221], v80 offset:8192
    ds_read_b64_tr_b16 v[222:223], v80 offset:9216
    ds_read_b64_tr_b16 v[224:225], v81 offset:0
    ds_read_b64_tr_b16 v[226:227], v81 offset:1024
    ds_read_b64_tr_b16 v[228:229], v81 offset:8192
    ds_read_b64_tr_b16 v[230:231], v81 offset:9216
    s_branch L_lw_27
L_lw_27_2:
    ds_read_b64_tr_b16 v[112:113], v80 offset:0
    ds_read_b64_tr_b16 v[114:115], v80 offset:1024
    ds_read_b64_tr_b16 v[116:117], v80 offset:8192
    ds_read_b64_tr_b16 v[118:119], v80 offset:9216
    ds_read_b64_tr_b16 v[120:121], v81 offset:0
    ds_read_b64_tr_b16 v[122:123], v81 offset:1024
    ds_read_b64_tr_b16 v[124:125], v81 offset:8192
    ds_read_b64_tr_b16 v[126:127], v81 offset:9216
L_lw_27:
    s_waitcnt lgkmcnt(0)
    s_waitcnt vmcnt(8)
    s_barrier
    s_add_u32 s46, s47, 0x500000
    s_add_u32 m0, s48, 0
    s_nop 0
    buffer_load_dwordx4 v82, s[28:31], s46 offen nt lds
    s_add_u32 s46, s47, 0x520000
    s_add_u32 m0, s48, 4096
    s_nop 0
    buffer_load_dwordx4 v82, s[28:31], s46 offen nt lds
    s_add_u32 s46, s47, 0x540000
    s_add_u32 m0, s48, 8192
    s_nop 0
    buffer_load_dwordx4 v82, s[28:31], s46 offen nt lds
    s_add_u32 s46, s47, 0x560000
    s_add_u32 m0, s48, 12288
    s_nop 0
    buffer_load_dwordx4 v82, s[28:31], s46 offen nt lds
    s_cmp_lg_u32 s44, 0
    s_cbranch_scc1 L_hs_28
    v_mov_b32 v41, 0
    v_mov_b32 v42, 1
    s_mov_b64 exec, 1
    buffer_atomic_add v42, v41, s[16:19], 0 offen sc1
    s_mov_b64 exec, -1
L_hs_28:
    s_cmp_lg_u32 s44, 0
    s_cbranch_scc1 L_lw_29_0
    ds_read_b64_tr_b16 a[192:193], v80 offset:16384
    ds_read_b64_tr_b16 a[194:195], v80 offset:17408
    ds_read_b64_tr_b16 a[196:197], v80 offset:24576
    ds_read_b64_tr_b16 a[198:199], v80 offset:25600
    ds_read_b64_tr_b16 a[200:201], v81 offset:16384
    ds_read_b64_tr_b16 a[202:203], v81 offset:17408
    ds_read_b64_tr_b16 a[204:205], v81 offset:24576
    ds_read_b64_tr_b16 a[206:207], v81 offset:25600
    s_branch L_lw_29
L_lw_29_0:
    s_cmp_lg_u32 s44, 1
    s_cbranch_scc1 L_lw_29_1
    ds_read_b64_tr_b16 a[88:89], v80 offset:16384
    ds_read_b64_tr_b16 a[90:91], v80 offset:17408
    ds_read_b64_tr_b16 a[92:93], v80 offset:24576
    ds_read_b64_tr_b16 a[94:95], v80 offset:25600
    ds_read_b64_tr_b16 a[96:97], v81 offset:16384
    ds_read_b64_tr_b16 a[98:99], v81 offset:17408
    ds_read_b64_tr_b16 a[100:101], v81 offset:24576
    ds_read_b64_tr_b16 a[102:103], v81 offset:25600
    s_branch L_lw_29
L_lw_29_1:
    s_cmp_lg_u32 s44, 2
    s_cbranch_scc1 L_lw_29_2
    ds_read_b64_tr_b16 v[248:249], v80 offset:16384
    ds_read_b64_tr_b16 v[250:251], v80 offset:17408
    ds_read_b64_tr_b16 v[252:253], v80 offset:24576
    ds_read_b64_tr_b16 v[254:255], v80 offset:25600
    ds_read_b64_tr_b16 v[56:57], v81 offset:16384
    ds_read_b64_tr_b16 v[58:59], v81 offset:17408
    ds_read_b64_tr_b16 v[60:61], v81 offset:24576
    ds_read_b64_tr_b16 v[62:63], v81 offset:25600
    s_waitcnt lgkmcnt(0)
    ds_write_b128 v5, v[56:59] offset:22528
    ds_write_b128 v5, v[60:63] offset:23552
    s_branch L_lw_29
L_lw_29_2:
    ds_read_b64_tr_b16 v[144:145], v80 offset:16384
    ds_read_b64_tr_b16 v[146:147], v80 offset:17408
    ds_read_b64_tr_b16 v[148:149], v80 offset:24576
    ds_read_b64_tr_b16 v[150:151], v80 offset:25600
    ds_read_b64_tr_b16 v[152:153], v81 offset:16384
    ds_read_b64_tr_b16 v[154:155], v81 offset:17408
    ds_read_b64_tr_b16 v[156:157], v81 offset:24576
    ds_read_b64_tr_b16 v[158:159], v81 offset:25600
L_lw_29:
    s_waitcnt lgkmcnt(0)
    s_waitcnt vmcnt(8)
    s_barrier
    s_add_u32 s46, s47, 0x580000
    s_add_u32 m0, s48, 16384
    s_nop 0
    buffer_load_dwordx4 v82, s[28:31], s46 offen nt lds
    s_add_u32 s46, s47, 0x5a0000
    s_add_u32 m0, s48, 20480
    s_nop 0
    buffer_load_dwordx4 v82, s[28:31], s46 offen nt lds
    s_add_u32 s46, s47, 0x5c0000
    s_add_u32 m0, s48, 24576
    s_nop 0
    buffer_load_dwordx4 v82, s[28:31], s46 offen nt lds
    s_add_u32 s46, s47, 0x5e0000
    s_add_u32 m0, s48, 28672
    s_nop 0
    buffer_load_dwordx4 v82, s[28:31], s46 offen nt lds
    s_cmp_lg_u32 s44, 0
    s_cbranch_scc1 L_lw_30_0
    ds_read_b64_tr_b16 a[216:217], v80 offset:32768
    ds_read_b64_tr_b16 a[218:219], v80 offset:33792
    ds_read_b64_tr_b16 a[220:221], v80 offset:40960
    ds_read_b64_tr_b16 a[222:223], v80 offset:41984
    ds_read_b64_tr_b16 a[224:225], v81 offset:32768
    ds_read_b64_tr_b16 a[226:227], v81 offset:33792
    ds_read_b64_tr_b16 a[228:229], v81 offset:40960
    ds_read_b64_tr_b16 a[230:231], v81 offset:41984
    s_branch L_lw_30
L_lw_30_0:
    s_cmp_lg_u32 s44, 1
    s_cbranch_scc1 L_lw_30_1
    ds_read_b64_tr_b16 a[112:113], v80 offset:32768
    ds_read_b64_tr_b16 a[114:115], v80 offset:33792
    ds_read_b64_tr_b16 a[116:117], v80 offset:40960
    ds_read_b64_tr_b16 a[118:119], v80 offset:41984
    ds_read_b64_tr_b16 a[120:121], v81 offset:32768
    ds_read_b64_tr_b16 a[122:123], v81 offset:33792
    ds_read_b64_tr_b16 a[124:125], v81 offset:40960
    ds_read_b64_tr_b16 a[126:127], v81 offset:41984
    s_branch L_lw_30
L_lw_30_1:
    s_cmp_lg_u32 s44, 2
    s_cbranch_scc1 L_lw_30_2
    ds_read_b64_tr_b16 a[16:17], v80 offset:32768
    ds_read_b64_tr_b16 a[18:19], v80 offset:33792
    ds_read_b64_tr_b16 a[20:21], v80 offset:40960
    ds_read_b64_tr_b16 a[22:23], v80 offset:41984
    ds_read_b64_tr_b16 a[24:25], v81 offset:32768
    ds_read_b64_tr_b16 a[26:27], v81 offset:33792
    ds_read_b64_tr_b16 a[28:29], v81 offset:40960
    ds_read_b64_tr_b16 a[30:31], v81 offset:41984
    s_branch L_lw_30
L_lw_30_2:
    ds_read_b64_tr_b16 v[168:169], v80 offset:32768
    ds_read_b64_tr_b16 v[170:171], v80 offset:33792
    ds_read_b64_tr_b16 v[172:173], v80 offset:40960
    ds_read_b64_tr_b16 v[174:175], v80 offset:41984
    ds_read_b64_tr_b16 v[176:177], v81 offset:32768
    ds_read_b64_tr_b16 v[178:179], v81 offset:33792
    ds_read_b64_tr_b16 v[180:181], v81 offset:40960
    ds_read_b64_tr_b16 v[182:183], v81 offset:41984
L_lw_30:
    s_waitcnt lgkmcnt(0)
    s_waitcnt vmcnt(8)
    s_barrier
    s_add_u32 s46, s47, 0x600000
    s_add_u32 m0, s48, 32768
    s_nop 0
    buffer_load_dwordx4 v82, s[28:31], s46 offen nt lds
    s_add_u32 s46, s47, 0x620000
    s_add_u32 m0, s48, 36864
    s_nop 0
    buffer_load_dwordx4 v82, s[28:31], s46 offen nt lds
    s_add_u32 s46, s47, 0x640000
    s_add_u32 m0, s48, 40960
    s_nop 0
    buffer_load_dwordx4 v82, s[28:31], s46 offen nt lds
    s_add_u32 s46, s47, 0x660000
    s_add_u32 m0, s48, 45056
    s_nop 0
    buffer_load_dwordx4 v82, s[28:31], s46 offen nt lds
    s_cmp_lg_u32 s44, 0
    s_cbranch_scc1 L_lw_31_0
    ds_read_b64_tr_b16 a[248:249], v80 offset:49152
    ds_read_b64_tr_b16 a[250:251], v80 offset:50176
    ds_read_b64_tr_b16 a[252:253], v80 offset:57344
    ds_read_b64_tr_b16 a[254:255], v80 offset:58368
    ds_read_b64_tr_b16 v[96:97], v81 offset:49152
    ds_read_b64_tr_b16 v[98:99], v81 offset:50176
    ds_read_b64_tr_b16 v[100:101], v81 offset:57344
    ds_read_b64_tr_b16 v[102:103], v81 offset:58368
    s_branch L_lw_31
L_lw_31_0:
    s_cmp_lg_u32 s44, 1
    s_cbranch_scc1 L_lw_31_1
    ds_read_b64_tr_b16 a[136:137], v80 offset:49152
    ds_read_b64_tr_b16 a[138:139], v80 offset:50176
    ds_read_b64_tr_b16 a[140:141], v80 offset:57344
    ds_read_b64_tr_b16 a[142:143], v80 offset:58368
    ds_read_b64_tr_b16 a[144:145], v81 offset:49152
    ds_read_b64_tr_b16 a[146:147], v81 offset:50176
    ds_read_b64_tr_b16 a[148:149], v81 offset:57344
    ds_read_b64_tr_b16 a[150:151], v81 offset:58368
    s_branch L_lw_31
L_lw_31_1:
    s_cmp_lg_u32 s44, 2
    s_cbranch_scc1 L_lw_31_2
    ds_read_b64_tr_b16 a[48:49], v80 offset:49152
    ds_read_b64_tr_b16 a[50:51], v80 offset:50176
    ds_read_b64_tr_b16 a[52:53], v80 offset:57344
    ds_read_b64_tr_b16 a[54:55], v80 offset:58368
    ds_read_b64_tr_b16 a[56:57], v81 offset:49152
    ds_read_b64_tr_b16 a[58:59], v81 offset:50176
    ds_read_b64_tr_b16 a[60:61], v81 offset:57344
    ds_read_b64_tr_b16 a[62:63], v81 offset:58368
    s_branch L_lw_31
L_lw_31_2:
    ds_read_b64_tr_b16 v[200:201], v80 offset:49152
    ds_read_b64_tr_b16 v[202:203], v80 offset:50176
    ds_read_b64_tr_b16 v[204:205], v80 offset:57344
    ds_read_b64_tr_b16 v[206:207], v80 offset:58368
    ds_read_b64_tr_b16 v[56:57], v81 offset:49152
    ds_read_b64_tr_b16 v[58:59], v81 offset:50176
    ds_read_b64_tr_b16 v[60:61], v81 offset:57344
    ds_read_b64_tr_b16 v[62:63], v81 offset:58368
    s_waitcnt lgkmcnt(0)
    ds_write_b128 v5, v[56:59] offset:18432
    ds_write_b128 v5, v[60:63] offset:19456
L_lw_31:
    s_waitcnt lgkmcnt(0)
    s_waitcnt vmcnt(8)
    s_barrier
    s_add_u32 s46, s47, 0x680000
    s_add_u32 m0, s48, 49152
    s_nop 0
    buffer_load_dwordx4 v82, s[28:31], s46 offen nt lds
    s_add_u32 s46, s47, 0x6a0000
    s_add_u32 m0, s48, 53248
    s_nop 0
    buffer_load_dwordx4 v82, s[28:31], s46 offen nt lds
    s_add_u32 s46, s47, 0x6c0000
    s_add_u32 m0, s48, 57344
    s_nop 0
    buffer_load_dwordx4 v82, s[28:31], s46 offen nt lds
    s_add_u32 s46, s47, 0x6e0000
    s_add_u32 m0, s48, 61440
    s_nop 0
    buffer_load_dwordx4 v82, s[28:31], s46 offen nt lds
    s_cmp_lg_u32 s44, 0
    s_cbranch_scc1 L_lw_32_0
    ds_read_b64_tr_b16 v[112:113], v80 offset:0
    ds_read_b64_tr_b16 v[114:115], v80 offset:1024
    ds_read_b64_tr_b16 v[116:117], v80 offset:8192
    ds_read_b64_tr_b16 v[118:119], v80 offset:9216
    ds_read_b64_tr_b16 v[120:121], v81 offset:0
    ds_read_b64_tr_b16 v[122:123], v81 offset:1024
    ds_read_b64_tr_b16 v[124:125], v81 offset:8192
    ds_read_b64_tr_b16 v[126:127], v81 offset:9216
    s_branch L_lw_32
L_lw_32_0:
    s_cmp_lg_u32 s44, 1
    s_cbranch_scc1 L_lw_32_1
    ds_read_b64_tr_b16 a[160:161], v80 offset:0
    ds_read_b64_tr_b16 a[162:163], v80 offset:1024
    ds_read_b64_tr_b16 a[164:165], v80 offset:8192
    ds_read_b64_tr_b16 a[166:167], v80 offset:9216
    ds_read_b64_tr_b16 a[168:169], v81 offset:0
    ds_read_b64_tr_b16 a[170:171], v81 offset:1024
    ds_read_b64_tr_b16 a[172:173], v81 offset:8192
    ds_read_b64_tr_b16 a[174:175], v81 offset:9216
    s_branch L_lw_32
L_lw_32_1:
    s_cmp_lg_u32 s44, 2
    s_cbranch_scc1 L_lw_32_2
    ds_read_b64_tr_b16 a[72:73], v80 offset:0
    ds_read_b64_tr_b16 a[74:75], v80 offset:1024
    ds_read_b64_tr_b16 a[76:77], v80 offset:8192
    ds_read_b64_tr_b16 a[78:79], v80 offset:9216
    ds_read_b64_tr_b16 v[56:57], v81 offset:0
    ds_read_b64_tr_b16 v[58:59], v81 offset:1024
    ds_read_b64_tr_b16 v[60:61], v81 offset:8192
    ds_read_b64_tr_b16 v[62:63], v81 offset:9216
    s_waitcnt lgkmcnt(0)
    ds_write_b128 v5, v[56:59] offset:20480
    ds_write_b128 v5, v[60:63] offset:21504
    s_branch L_lw_32
L_lw_32_2:
    ds_read_b64_tr_b16 v[216:217], v80 offset:0
    ds_read_b64_tr_b16 v[218:219], v80 offset:1024
    ds_read_b64_tr_b16 v[220:221], v80 offset:8192
    ds_read_b64_tr_b16 v[222:223], v80 offset:9216
    ds_read_b64_tr_b16 v[224:225], v81 offset:0
    ds_read_b64_tr_b16 v[226:227], v81 offset:1024
    ds_read_b64_tr_b16 v[228:229], v81 offset:8192
    ds_read_b64_tr_b16 v[230:231], v81 offset:9216
L_lw_32:
    s_waitcnt lgkmcnt(0)
    s_waitcnt vmcnt(8)
    s_barrier
    s_add_u32 s46, s47, 0x700000
    s_add_u32 m0, s48, 0
    s_nop 0
    buffer_load_dwordx4 v82, s[28:31], s46 offen nt lds
    s_add_u32 s46, s47, 0x720000
    s_add_u32 m0, s48, 4096
    s_nop 0
    buffer_load_dwordx4 v82, s[28:31], s46 offen nt lds
    s_add_u32 s46, s47, 0x740000
    s_add_u32 m0, s48, 8192
    s_nop 0
    buffer_load_dwordx4 v82, s[28:31], s46 offen nt lds
    s_add_u32 s46, s47, 0x760000
    s_add_u32 m0, s48, 12288
    s_nop 0
    buffer_load_dwordx4 v82, s[28:31], s46 offen nt lds
    s_cmp_lg_u32 s44, 0
    s_cbranch_scc1 L_lw_33_0
    ds_read_b64_tr_b16 v[144:145], v80 offset:16384
    ds_read_b64_tr_b16 v[146:147], v80 offset:17408
    ds_read_b64_tr_b16 v[148:149], v80 offset:24576
    ds_read_b64_tr_b16 v[150:151], v80 offset:25600
    ds_read_b64_tr_b16 v[152:153], v81 offset:16384
    ds_read_b64_tr_b16 v[154:155], v81 offset:17408
    ds_read_b64_tr_b16 v[156:157], v81 offset:24576
    ds_read_b64_tr_b16 v[158:159], v81 offset:25600
    s_branch L_lw_33
L_lw_33_0:
    s_cmp_lg_u32 s44, 1
    s_cbranch_scc1 L_lw_33_1
    ds_read_b64_tr_b16 a[192:193], v80 offset:16384
    ds_read_b64_tr_b16 a[194:195], v80 offset:17408
    ds_read_b64_tr_b16 a[196:197], v80 offset:24576
    ds_read_b64_tr_b16 a[198:199], v80 offset:25600
    ds_read_b64_tr_b16 a[200:201], v81 offset:16384
    ds_read_b64_tr_b16 a[202:203], v81 offset:17408
    ds_read_b64_tr_b16 a[204:205], v81 offset:24576
    ds_read_b64_tr_b16 a[206:207], v81 offset:25600
    s_branch L_lw_33
L_lw_33_1:
    s_cmp_lg_u32 s44, 2
    s_cbranch_scc1 L_lw_33_2
    ds_read_b64_tr_b16 a[88:89], v80 offset:16384
    ds_read_b64_tr_b16 a[90:91], v80 offset:17408
    ds_read_b64_tr_b16 a[92:93], v80 offset:24576
    ds_read_b64_tr_b16 a[94:95], v80 offset:25600
    ds_read_b64_tr_b16 a[96:97], v81 offset:16384
    ds_read_b64_tr_b16 a[98:99], v81 offset:17408
    ds_read_b64_tr_b16 a[100:101], v81 offset:24576
    ds_read_b64_tr_b16 a[102:103], v81 offset:25600
    s_branch L_lw_33
L_lw_33_2:
    ds_read_b64_tr_b16 v[248:249], v80 offset:16384
    ds_read_b64_tr_b16 v[250:251], v80 offset:17408
    ds_read_b64_tr_b16 v[252:253], v80 offset:24576
    ds_read_b64_tr_b16 v[254:255], v80 offset:25600
    ds_read_b64_tr_b16 v[56:57], v81 offset:16384
    ds_read_b64_tr_b16 v[58:59], v81 offset:17408
    ds_read_b64_tr_b16 v[60:61], v81 offset:24576
    ds_read_b64_tr_b16 v[62:63], v81 offset:25600
    s_waitcnt lgkmcnt(0)
    ds_write_b128 v5, v[56:59] offset:22528
    ds_write_b128 v5, v[60:63] offset:23552
L_lw_33:
    s_waitcnt lgkmcnt(0)
    s_waitcnt vmcnt(8)
    s_barrier
    s_add_u32 s46, s47, 0x780000
    s_add_u32 m0, s48, 16384
    s_nop 0
    buffer_load_dwordx4 v82, s[28:31], s46 offen nt lds
    s_add_u32 s46, s47, 0x7a0000
    s_add_u32 m0, s48, 20480
    s_nop 0
    buffer_load_dwordx4 v82, s[28:31], s46 offen nt lds
    s_add_u32 s46, s47, 0x7c0000
    s_add_u32 m0, s48, 24576
    s_nop 0
    buffer_load_dwordx4 v82, s[28:31], s46 offen nt lds
    s_add_u32 s46, s47, 0x7e0000
    s_add_u32 m0, s48, 28672
    s_nop 0
    buffer_load_dwordx4 v82, s[28:31], s46 offen nt lds
    s_cmp_lg_u32 s44, 0
    s_cbranch_scc1 L_lw_34_0
    ds_read_b64_tr_b16 v[168:169], v80 offset:32768
    ds_read_b64_tr_b16 v[170:171], v80 offset:33792
    ds_read_b64_tr_b16 v[172:173], v80 offset:40960
    ds_read_b64_tr_b16 v[174:175], v80 offset:41984
    ds_read_b64_tr_b16 v[176:177], v81 offset:32768
    ds_read_b64_tr_b16 v[178:179], v81 offset:33792
    ds_read_b64_tr_b16 v[180:181], v81 offset:40960
    ds_read_b64_tr_b16 v[182:183], v81 offset:41984
    s_branch L_lw_34
L_lw_34_0:
    s_cmp_lg_u32 s44, 1
    s_cbranch_scc1 L_lw_34_1
    ds_read_b64_tr_b16 a[216:217], v80 offset:32768
    ds_read_b64_tr_b16 a[218:219], v80 offset:33792
    ds_read_b64_tr_b16 a[220:221], v80 offset:40960
    ds_read_b64_tr_b16 a[222:223], v80 offset:41984
    ds_read_b64_tr_b16 a[224:225], v81 offset:32768
    ds_read_b64_tr_b16 a[226:227], v81 offset:33792
    ds_read_b64_tr_b16 a[228:229], v81 offset:40960
    ds_read_b64_tr_b16 a[230:231], v81 offset:41984
    s_branch L_lw_34
L_lw_34_1:
    s_cmp_lg_u32 s44, 2
    s_cbranch_scc1 L_lw_34_2
    ds_read_b64_tr_b16 a[112:113], v80 offset:32768
    ds_read_b64_tr_b16 a[114:115], v80 offset:33792
    ds_read_b64_tr_b16 a[116:117], v80 offset:40960
    ds_read_b64_tr_b16 a[118:119], v80 offset:41984
    ds_read_b64_tr_b16 a[120:121], v81 offset:32768
    ds_read_b64_tr_b16 a[122:123], v81 offset:33792
    ds_read_b64_tr_b16 a[124:125], v81 offset:40960
    ds_read_b64_tr_b16 a[126:127], v81 offset:41984
    s_branch L_lw_34
L_lw_34_2:
    ds_read_b64_tr_b16 a[16:17], v80 offset:32768
    ds_read_b64_tr_b16 a[18:19], v80 offset:33792
    ds_read_b64_tr_b16 a[20:21], v80 offset:40960
    ds_read_b64_tr_b16 a[22:23], v80 offset:41984
    ds_read_b64_tr_b16 a[24:25], v81 offset:32768
    ds_read_b64_tr_b16 a[26:27], v81 offset:33792
    ds_read_b64_tr_b16 a[28:29], v81 offset:40960
    ds_read_b64_tr_b16 a[30:31], v81 offset:41984
L_lw_34:
    s_waitcnt lgkmcnt(0)
    s_waitcnt vmcnt(8)
    s_barrier
    s_cmp_lg_u32 s44, 0
    s_cbranch_scc1 L_lw_35_0
    ds_read_b64_tr_b16 v[200:201], v80 offset:49152
    ds_read_b64_tr_b16 v[202:203], v80 offset:50176
    ds_read_b64_tr_b16 v[204:205], v80 offset:57344
    ds_read_b64_tr_b16 v[206:207], v80 offset:58368
    ds_read_b64_tr_b16 v[56:57], v81 offset:49152
    ds_read_b64_tr_b16 v[58:59], v81 offset:50176
    ds_read_b64_tr_b16 v[60:61], v81 offset:57344
    ds_read_b64_tr_b16 v[62:63], v81 offset:58368
    s_waitcnt lgkmcnt(0)
    ds_write_b128 v5, v[56:59] offset:18432
    ds_write_b128 v5, v[60:63] offset:19456
    s_branch L_lw_35
L_lw_35_0:
    s_cmp_lg_u32 s44, 1
    s_cbranch_scc1 L_lw_35_1
    ds_read_b64_tr_b16 a[248:249], v80 offset:49152
    ds_read_b64_tr_b16 a[250:251], v80 offset:50176
    ds_read_b64_tr_b16 a[252:253], v80 offset:57344
    ds_read_b64_tr_b16 a[254:255], v80 offset:58368
    ds_read_b64_tr_b16 v[96:97], v81 offset:49152
    ds_read_b64_tr_b16 v[98:99], v81 offset:50176
    ds_read_b64_tr_b16 v[100:101], v81 offset:57344
    ds_read_b64_tr_b16 v[102:103], v81 offset:58368
    s_branch L_lw_35
L_lw_35_1:
    s_cmp_lg_u32 s44, 2
    s_cbranch_scc1 L_lw_35_2
    ds_read_b64_tr_b16 a[136:137], v80 offset:49152
    ds_read_b64_tr_b16 a[138:139], v80 offset:50176
    ds_read_b64_tr_b16 a[140:141], v80 offset:57344
    ds_read_b64_tr_b16 a[142:143], v80 offset:58368
    ds_read_b64_tr_b16 a[144:145], v81 offset:49152
    ds_read_b64_tr_b16 a[146:147], v81 offset:50176
    ds_read_b64_tr_b16 a[148:149], v81 offset:57344
    ds_read_b64_tr_b16 a[150:151], v81 offset:58368
    s_branch L_lw_35
L_lw_35_2:
    ds_read_b64_tr_b16 a[48:49], v80 offset:49152
    ds_read_b64_tr_b16 a[50:51], v80 offset:50176
    ds_read_b64_tr_b16 a[52:53], v80 offset:57344
    ds_read_b64_tr_b16 a[54:55], v80 offset:58368
    ds_read_b64_tr_b16 a[56:57], v81 offset:49152
    ds_read_b64_tr_b16 a[58:59], v81 offset:50176
    ds_read_b64_tr_b16 a[60:61], v81 offset:57344
    ds_read_b64_tr_b16 a[62:63], v81 offset:58368
L_lw_35:
    s_waitcnt lgkmcnt(0)
    s_waitcnt vmcnt(4)
    s_barrier
    s_cmp_lg_u32 s44, 0
    s_cbranch_scc1 L_lw_36_0
    ds_read_b64_tr_b16 v[216:217], v80 offset:0
    ds_read_b64_tr_b16 v[218:219], v80 offset:1024
    ds_read_b64_tr_b16 v[220:221], v80 offset:8192
    ds_read_b64_tr_b16 v[222:223], v80 offset:9216
    ds_read_b64_tr_b16 v[224:225], v81 offset:0
    ds_read_b64_tr_b16 v[226:227], v81 offset:1024
    ds_read_b64_tr_b16 v[228:229], v81 offset:8192
    ds_read_b64_tr_b16 v[230:231], v81 offset:9216
    s_branch L_lw_36
L_lw_36_0:
    s_cmp_lg_u32 s44, 1
    s_cbranch_scc1 L_lw_36_1
    ds_read_b64_tr_b16 v[112:113], v80 offset:0
    ds_read_b64_tr_b16 v[114:115], v80 offset:1024
    ds_read_b64_tr_b16 v[116:117], v80 offset:8192
    ds_read_b64_tr_b16 v[118:119], v80 offset:9216
    ds_read_b64_tr_b16 v[120:121], v81 offset:0
    ds_read_b64_tr_b16 v[122:123], v81 offset:1024
    ds_read_b64_tr_b16 v[124:125], v81 offset:8192
    ds_read_b64_tr_b16 v[126:127], v81 offset:9216
    s_branch L_lw_36
L_lw_36_1:
    s_cmp_lg_u32 s44, 2
    s_cbranch_scc1 L_lw_36_2
    ds_read_b64_tr_b16 a[160:161], v80 offset:0
    ds_read_b64_tr_b16 a[162:163], v80 offset:1024
    ds_read_b64_tr_b16 a[164:165], v80 offset:8192
    ds_read_b64_tr_b16 a[166:167], v80 offset:9216
    ds_read_b64_tr_b16 a[168:169], v81 offset:0
    ds_read_b64_tr_b16 a[170:171], v81 offset:1024
    ds_read_b64_tr_b16 a[172:173], v81 offset:8192
    ds_read_b64_tr_b16 a[174:175], v81 offset:9216
    s_branch L_lw_36
L_lw_36_2:
    ds_read_b64_tr_b16 a[72:73], v80 offset:0
    ds_read_b64_tr_b16 a[74:75], v80 offset:1024
    ds_read_b64_tr_b16 a[76:77], v80 offset:8192
    ds_read_b64_tr_b16 a[78:79], v80 offset:9216
    ds_read_b64_tr_b16 v[56:57], v81 offset:0
    ds_read_b64_tr_b16 v[58:59], v81 offset:1024
    ds_read_b64_tr_b16 v[60:61], v81 offset:8192
    ds_read_b64_tr_b16 v[62:63], v81 offset:9216
    s_waitcnt lgkmcnt(0)
    ds_write_b128 v5, v[56:59] offset:20480
    ds_write_b128 v5, v[60:63] offset:21504
L_lw_36:
    s_waitcnt lgkmcnt(0)
    s_waitcnt vmcnt(0)
    s_barrier
    s_cmp_lg_u32 s44, 0
    s_cbranch_scc1 L_lw_37_0
    ds_read_b64_tr_b16 v[248:249], v80 offset:16384
    ds_read_b64_tr_b16 v[250:251], v80 offset:17408
    ds_read_b64_tr_b16 v[252:253], v80 offset:24576
    ds_read_b64_tr_b16 v[254:255], v80 offset:25600
    ds_read_b64_tr_b16 v[56:57], v81 offset:16384
    ds_read_b64_tr_b16 v[58:59], v81 offset:17408
    ds_read_b64_tr_b16 v[60:61], v81 offset:24576
    ds_read_b64_tr_b16 v[62:63], v81 offset:25600
    s_waitcnt lgkmcnt(0)
    ds_write_b128 v5, v[56:59] offset:22528
    ds_write_b128 v5, v[60:63] offset:23552
    s_branch L_lw_37
L_lw_37_0:
    s_cmp_lg_u32 s44, 1
    s_cbranch_scc1 L_lw_37_1
    ds_read_b64_tr_b16 v[144:145], v80 offset:16384
    ds_read_b64_tr_b16 v[146:147], v80 offset:17408
    ds_read_b64_tr_b16 v[148:149], v80 offset:24576
    ds_read_b64_tr_b16 v[150:151], v80 offset:25600
    ds_read_b64_tr_b16 v[152:153], v81 offset:16384
    ds_read_b64_tr_b16 v[154:155], v81 offset:17408
    ds_read_b64_tr_b16 v[156:157], v81 offset:24576
    ds_read_b64_tr_b16 v[158:159], v81 offset:25600
    s_branch L_lw_37
L_lw_37_1:
    s_cmp_lg_u32 s44, 2
    s_cbranch_scc1 L_lw_37_2
    ds_read_b64_tr_b16 a[192:193], v80 offset:16384
    ds_read_b64_tr_b16 a[194:195], v80 offset:17408
    ds_read_b64_tr_b16 a[196:197], v80 offset:24576
    ds_read_b64_tr_b16 a[198:199], v80 offset:25600
    ds_read_b64_tr_b16 a[200:201], v81 offset:16384
    ds_read_b64_tr_b16 a[202:203], v81 offset:17408
    ds_read_b64_tr_b16 a[204:205], v81 offset:24576
    ds_read_b64_tr_b16 a[206:207], v81 offset:25600
    s_branch L_lw_37
L_lw_37_2:
    ds_read_b64_tr_b16 a[88:89], v80 offset:16384
    ds_read_b64_tr_b16 a[90:91], v80 offset:17408
    ds_read_b64_tr_b16 a[92:93], v80 offset:24576
    ds_read_b64_tr_b16 a[94:95], v80 offset:25600
    ds_read_b64_tr_b16 a[96:97], v81 offset:16384
    ds_read_b64_tr_b16 a[98:99], v81 offset:17408
    ds_read_b64_tr_b16 a[100:101], v81 offset:24576
    ds_read_b64_tr_b16 a[102:103], v81 offset:25600
L_lw_37:
    s_waitcnt lgkmcnt(0)
    s_barrier
    v_and_b32 v63, 15, v1
    v_lshrrev_b32 v64, 4, v1
    v_lshrrev_b32 v65, 5, v1
    v_lshlrev_b32 v65, 4, v65
    v_add_u32 v65, v65, v63
    v_lshlrev_b32 v65, 4, v65
    v_and_b32 v66, 1, v64
    v_lshlrev_b32 v66, 3, v66
    s_lshl_b32 s45, s44, 9
    s_add_u32 s45, s45, 53248
    v_add3_u32 v6, v65, v66, s45
    v_bfe_u32 v65, v1, 2, 2
    v_lshlrev_b32 v66, 3, v64
    v_add_u32 v65, v65, v66
    v_lshlrev_b32 v65, 4, v65
    v_and_b32 v66, 1, v1
    v_lshlrev_b32 v66, 3, v66
    v_add_u32 v65, v65, v66
    v_add_u32 v7, 53248, v65
    v_bfe_u32 v65, v1, 2, 1
    v_lshlrev_b32 v65, 4, v65
    v_bfe_u32 v66, v1, 3, 1
    v_lshlrev_b32 v66, 2, v66
    v_and_b32 v67, 3, v1
    v_add3_u32 v65, v65, v66, v67
    v_lshlrev_b32 v65, 5, v65
    v_lshlrev_b32 v66, 3, v64
    s_lshl_b32 s45, s44, 10
    s_add_u32 s45, s45, 55296
    v_add3_u32 v18, v65, v66, s45
    v_lshlrev_b32 v16, 3, v1
    v_lshlrev_b32 v8, 4, v1
    v_mov_b32 v14, v8
    v_lshrrev_b32 v65, 2, v1
    v_lshlrev_b32 v65, 4, v65
    v_and_b32 v66, 1, v1
    v_lshlrev_b32 v66, 3, v66
    s_lshl_b32 s45, s44, 11
    v_add3_u32 v65, v65, v66, s45
    v_and_b32 v66, 2, v1
    v_lshlrev_b32 v66, 7, v66
    v_add_u32 v9, v65, v66
    s_lshl_b32 s45, s43, 11
    s_lshl_b32 s46, s44, 9
    s_add_u32 s45, s45, s46
    s_add_u32 s51, s45, 0x7020000
    s_lshl_b32 s63, s43, 19
    s_add_u32 s63, s63, 0x3000000
    s_mov_b32 s50, 0
    s_lshl_b32 s64, s44, 11
    s_add_u32 s63, s63, s64
    s_add_u32 s64, s64, 16384
    s_add_u32 s65, s64, 8192
    s_lshl_b32 s66, s43, 12
    s_add_u32 s66, s66, 0x1000000
    s_mov_b32 s69, 16384
    s_mov_b32 s52, 0x3e0293ee
    v_and_b32 v19, 3, v1
    v_lshlrev_b32 v19, 10, v19
    s_lshl_b32 s45, s44, 12
    s_add_u32 s45, s45, 1020
    v_add_u32 v19, s45, v19
    v_mov_b32 v29, 64
    s_mov_b32 s46, 192
    s_mov_b64 exec, 1
    s_mov_b32 s70, 0
L_wp_38:
    buffer_load_dword v31, v29, s[16:19], 0 offen sc1
    s_add_u32 s70, s70, 1
    s_cmp_ge_u32 s70, 0x200000
    s_cbranch_scc1 L_c_done_1
    s_waitcnt vmcnt(0)
    v_cmp_gt_u32 vcc, s46, v31
    s_nop 1
    s_cbranch_vccz L_wp_38_ok
    s_sleep 2
    s_branch L_wp_38
L_wp_38_ok:
    s_mov_b64 exec, -1
    s_mov_b32 s47, 0
    s_cmp_lt_u32 s47, s50
    s_cbranch_scc1 L_kv_rdy_39
    s_lshl_b32 s45, s43, 7
    s_add_u32 s45, s45, 0x10014
    v_mov_b32 v0, 0
    s_mov_b32 s70, 0
L_kv_rdy_39_p:
    buffer_load_dwordx2 v[10:11], v0, s[12:15], s45 offen sc1
    s_add_u32 s70, s70, 1
    s_cmp_ge_u32 s70, 0x200000
    s_cbranch_scc1 L_c_done_1
    s_waitcnt vmcnt(0)
    v_min_u32 v10, v10, v11
    s_nop 0
    v_readfirstlane_b32 s50, v10
    s_nop 3
    s_cmp_lt_u32 s47, s50
    s_cbranch_scc1 L_kv_rdy_39
    s_sleep 2
    s_branch L_kv_rdy_39_p
L_kv_rdy_39:
    s_mov_b32 m0, s64
    s_add_u32 s46, s63, 0x1000000
    buffer_load_dwordx4 v14, s[12:15], s63 offen sc1 lds
    buffer_load_dwordx4 v14, s[12:15], s63 offen offset:1024 sc1 lds
    s_mov_b32 m0, s65
    s_add_u32 s63, s63, 8192
    buffer_load_dwordx4 v14, s[12:15], s46 offen sc1 lds
    buffer_load_dwordx4 v14, s[12:15], s46 offen offset:1024 sc1 lds
    s_add_u32 s64, s64, 16384
    s_add_u32 s65, s65, 16384
    s_mov_b32 s70, 0
    v_mov_b32 v41, 0
L_hw_40:
    s_sleep 2
    buffer_load_dword v44, v41, s[16:19], 0 offen sc1
    s_add_u32 s70, s70, 1
    s_cmp_ge_u32 s70, 0x100000
    s_cbranch_scc1 L_c_done_1
    s_waitcnt vmcnt(0)
    v_readfirstlane_b32 s45, v44
    s_cmp_lg_u32 s45, 64
    s_cbranch_scc1 L_hw_40
    buffer_load_dwordx4 v[44:47], v41, s[16:19], 0 offen sc1
    s_waitcnt vmcnt(0)
    v_readfirstlane_b32 s45, v45
    v_readfirstlane_b32 s46, v46
    v_readfirstlane_b32 s68, v47
    s_bcnt1_i32_b32 s45, s45
    s_bcnt1_i32_b32 s46, s46
    s_add_u32 s45, s45, s46
    s_cmp_eq_u32 s45, 2
    s_cselect_b32 s67, 1, 0
    s_cmp_ge_u32 s68, 16
    s_cselect_b32 s68, 8192, 0
    s_mov_b32 s6, 0x0
    s_mov_b32 s7, 0xd5400000
    s_mov_b32 s60, 0
    s_lshl_b32 s58, s40, 16
    s_add_u32 s58, s58, 0x7000000
    s_mov_b32 s61, s58
    s_lshl_b32 s59, s40, 17
    s_add_u32 s59, s59, 0x7040000
    s_mov_b32 s62, s59
L_q_loop_41:
    ds_read_b128 v[56:59], v5 offset:8192
    ds_read_b128 v[60:63], v5 offset:9216
    ds_read_b128 v[64:67], v5 offset:20480
    ds_read_b128 v[68:71], v5 offset:21504
    ds_read_b128 v[72:75], v5 offset:16384
    ds_read_b128 v[76:79], v5 offset:17408
    ds_read_b128 v[80:83], v5 offset:4096
    ds_read_b128 v[84:87], v5 offset:5120
    ds_read_b128 v[88:91], v5 offset:6144
    ds_read_b128 v[92:95], v5 offset:7168
    s_cmp_eq_u32 s60, 0
    s_cbranch_scc1 L_q_first_42
    s_sleep 16
    s_mov_b64 exec, 15
    buffer_load_dword v10, v19, s[12:15], s61 offen sc1
    s_nop 15
    buffer_load_dword v11, v19, s[12:15], s61 offen sc1
    s_nop 15
    buffer_load_dword v12, v19, s[12:15], s61 offen sc1
    s_nop 15
    buffer_load_dword v13, v19, s[12:15], s61 offen sc1
    s_mov_b32 s70, 0
L_pp_43:
    s_waitcnt vmcnt(3)
    v_cmp_eq_u32 vcc, -1, v10
    s_add_u32 s70, s70, 1
    s_nop 0
    s_cbranch_vccz L_ppd_44
    buffer_load_dword v10, v19, s[12:15], s61 offen sc1
    s_waitcnt vmcnt(3)
    v_cmp_eq_u32 vcc, -1, v11
    s_add_u32 s70, s70, 1
    s_nop 0
    s_cbranch_vccz L_ppd_44
    buffer_load_dword v11, v19, s[12:15], s61 offen sc1
    s_waitcnt vmcnt(3)
    v_cmp_eq_u32 vcc, -1, v12
    s_add_u32 s70, s70, 1
    s_nop 0
    s_cbranch_vccz L_ppd_44
    buffer_load_dword v12, v19, s[12:15], s61 offen sc1
    s_waitcnt vmcnt(3)
    v_cmp_eq_u32 vcc, -1, v13
    s_add_u32 s70, s70, 1
    s_nop 0
    s_cbranch_vccz L_ppd_44
    buffer_load_dword v13, v19, s[12:15], s61 offen sc1
    s_cmp_lt_u32 s70, 0x400000
    s_cbranch_scc1 L_pp_43
    s_branch L_c_done_1
L_ppd_44:
    s_mov_b64 exec, -1
L_q_first_42:
    s_waitcnt lgkmcnt(0)
    s_mov_b32 s70, 0
L_mg_45:
    buffer_load_dwordx4 v[40:43], v3, s[12:15], s61 offen offset:0 sc1
    s_nop 9
    buffer_load_dwordx4 v[44:47], v3, s[12:15], s61 offen offset:1024 sc1
    s_nop 9
    buffer_load_dwordx4 v[48:51], v3, s[12:15], s61 offen offset:2048 sc1
    s_nop 9
    buffer_load_dwordx4 v[52:55], v3, s[12:15], s61 offen offset:3072 sc1
    s_add_u32 s70, s70, 1
    s_cmp_ge_u32 s70, 0x100000
    s_cbranch_scc1 L_c_done_1
    s_nop 1
    v_mov_b32 v24, 0
    v_mov_b32 v25, 0
    v_mov_b32 v26, 0
    v_mov_b32 v27, 0
    v_mov_b32 v28, 0
    v_mov_b32 v29, 0
    v_mov_b32 v30, 0
    v_mov_b32 v31, 0
    v_mov_b32 v32, 0
    v_mov_b32 v33, 0
    v_mov_b32 v34, 0
    v_mov_b32 v35, 0
    v_mov_b32 v36, 0
    v_mov_b32 v37, 0
    v_mov_b32 v38, 0
    v_mov_b32 v39, 0
    s_waitcnt vmcnt(3)
    ds_write_b128 v3, v[40:43] offset:0
    v_smfmac_f32_16x16x64_bf16 v[24:27], v[40:43], a[0:7], v2
    v_max3_u32 v22, v40, v41, v42
    v_smfmac_f32_16x16x64_bf16 v[28:31], v[40:43], a[8:15], v2
    v_max_u32 v22, v22, v43
    v_smfmac_f32_16x16x64_bf16 v[32:35], v[40:43], a[16:23], v2
    v_smfmac_f32_16x16x64_bf16 v[36:39], v[40:43], a[24:31], v2
    s_waitcnt vmcnt(2)
    ds_write_b128 v3, v[44:47] offset:1024
    v_smfmac_f32_16x16x64_bf16 v[24:27], v[44:47], a[32:39], v2
    v_max3_u32 v22, v22, v44, v45
    v_smfmac_f32_16x16x64_bf16 v[28:31], v[44:47], a[40:47], v2
    v_max3_u32 v22, v22, v46, v47
    v_smfmac_f32_16x16x64_bf16 v[32:35], v[44:47], a[48:55], v2
    v_smfmac_f32_16x16x64_bf16 v[36:39], v[44:47], a[56:63], v2
    s_waitcnt vmcnt(1)
    ds_write_b128 v3, v[48:51] offset:2048
    s_waitcnt vmcnt(0)
    ds_write_b128 v3, v[52:55] offset:3072
    v_max3_u32 v22, v22, v48, v49
    v_max3_u32 v22, v22, v50, v51
    v_max3_u32 v22, v22, v52, v53
    v_max3_u32 v22, v22, v54, v55
    v_cmp_eq_u32 vcc, -1, v22
    s_waitcnt lgkmcnt(0)
    s_nop 0
    s_cbranch_vccnz L_mg_45
    s_barrier
    ds_read_b128 v[40:43], v4 offset:0
    ds_read_b128 v[44:47], v4 offset:1024
    v_smfmac_f32_16x16x64_bf16 v[24:27], v[48:51], a[64:71], v2
    v_smfmac_f32_16x16x64_bf16 v[28:31], v[48:51], v[56:63], v2
    ds_read_b128 v[56:59], v5 offset:14336
    v_smfmac_f32_16x16x64_bf16 v[32:35], v[48:51], a[72:79], v2
    ds_read_b128 v[60:63], v5 offset:15360
    v_smfmac_f32_16x16x64_bf16 v[36:39], v[48:51], v[64:71], v2
    ds_read_b128 v[48:51], v4 offset:2048
    ds_read_b128 v[64:67], v5 offset:2048
    v_smfmac_f32_16x16x64_bf16 v[24:27], v[52:55], a[80:87], v2
    ds_read_b128 v[68:71], v5 offset:3072
    v_smfmac_f32_16x16x64_bf16 v[28:31], v[52:55], v[72:79], v2
    ds_read_b128 v[72:75], v5 offset:12288
    v_smfmac_f32_16x16x64_bf16 v[32:35], v[52:55], a[88:95], v2
    ds_read_b128 v[76:79], v5 offset:13312
    v_smfmac_f32_16x16x64_bf16 v[36:39], v[52:55], a[96:103], v2
    ds_read_b128 v[52:55], v4 offset:3072
    s_waitcnt lgkmcnt(4)
    v_smfmac_f32_16x16x64_bf16 v[24:27], v[40:43], a[104:111], v2
    v_smfmac_f32_16x16x64_bf16 v[28:31], v[40:43], v[80:87], v2
    ds_read_b128 v[80:83], v5 offset:0
    v_smfmac_f32_16x16x64_bf16 v[32:35], v[40:43], a[112:119], v2
    ds_read_b128 v[84:87], v5 offset:1024
    v_smfmac_f32_16x16x64_bf16 v[36:39], v[40:43], a[120:127], v2
    ds_read_b128 v[40:43], v21 offset:0
    v_smfmac_f32_16x16x64_bf16 v[24:27], v[44:47], a[128:135], v2
    v_smfmac_f32_16x16x64_bf16 v[28:31], v[44:47], v[88:95], v2
    ds_read_b128 v[88:91], v5 offset:10240
    v_smfmac_f32_16x16x64_bf16 v[32:35], v[44:47], a[136:143], v2
    ds_read_b128 v[92:95], v5 offset:11264
    v_smfmac_f32_16x16x64_bf16 v[36:39], v[44:47], a[144:151], v2
    ds_read_b128 v[44:47], v21 offset:1024
    v_smfmac_f32_16x16x64_bf16 v[24:27], v[48:51], a[152:159], v2
    v_smfmac_f32_16x16x64_bf16 v[28:31], v[48:51], v[56:63], v2
    ds_read_b128 v[48:51], v21 offset:2048
    ds_read_b128 v[56:59], v5 offset:22528
    s_waitcnt lgkmcnt(4)
    v_smfmac_f32_16x16x64_bf16 v[24:27], v[52:55], a[176:183], v2
    ds_read_b128 v[60:63], v5 offset:23552
    v_smfmac_f32_16x16x64_bf16 v[28:31], v[52:55], a[184:191], v2
    ds_read_b128 v[52:55], v21 offset:3072
    v_smfmac_f32_16x16x64_bf16 v[24:27], v[40:43], a[208:215], v2
    v_smfmac_f32_16x16x64_bf16 v[28:31], v[40:43], v[64:71], v2
    ds_read_b128 v[40:43], v23 offset:0
    ds_read_b128 v[64:67], v5 offset:18432
    s_waitcnt lgkmcnt(4)
    v_smfmac_f32_16x16x64_bf16 v[24:27], v[44:47], a[232:239], v2
    ds_read_b128 v[68:71], v5 offset:19456
    v_smfmac_f32_16x16x64_bf16 v[28:31], v[44:47], a[240:247], v2
    ds_read_b128 v[44:47], v23 offset:1024
    v_smfmac_f32_16x16x64_bf16 v[24:27], v[48:51], v[104:111], v2
    v_smfmac_f32_16x16x64_bf16 v[28:31], v[48:51], v[72:79], v2
    ds_read_b128 v[48:51], v23 offset:2048
    s_waitcnt lgkmcnt(3)
    v_smfmac_f32_16x16x64_bf16 v[24:27], v[52:55], v[128:135], v2
    v_smfmac_f32_16x16x64_bf16 v[28:31], v[52:55], v[136:143], v2
    ds_read_b128 v[52:55], v23 offset:3072
    v_smfmac_f32_16x16x64_bf16 v[24:27], v[40:43], v[160:167], v2
    v_smfmac_f32_16x16x64_bf16 v[28:31], v[40:43], v[80:87], v2
    s_waitcnt lgkmcnt(1)
    v_smfmac_f32_16x16x64_bf16 v[24:27], v[44:47], v[184:191], v2
    v_smfmac_f32_16x16x64_bf16 v[28:31], v[44:47], v[192:199], v2
    v_smfmac_f32_16x16x64_bf16 v[24:27], v[48:51], v[208:215], v2
    v_smfmac_f32_16x16x64_bf16 v[28:31], v[48:51], v[88:95], v2
    s_waitcnt lgkmcnt(0)
    v_smfmac_f32_16x16x64_bf16 v[24:27], v[52:55], v[232:239], v2
    v_smfmac_f32_16x16x64_bf16 v[28:31], v[52:55], v[240:247], v2
    v_smfmac_f32_16x16x64_bf16 v[32:35], v[52:55], v[248:255], v2
    ds_read_b128 v[72:75], v8 offset:20480
    v_smfmac_f32_16x16x64_bf16 v[36:39], v[52:55], v[56:63], v2
    ds_read_b128 v[52:55], v21 offset:3072
    v_smfmac_f32_16x16x64_bf16 v[32:35], v[48:51], v[216:223], v2
    ds_read_b128 v[76:79], v8 offset:21504
    s_nop 1
    v_permlane32_swap_b32 v24, v28
    v_smfmac_f32_16x16x64_bf16 v[36:39], v[48:51], v[224:231], v2
    ds_read_b128 v[48:51], v21 offset:2048
    v_permlane32_swap_b32 v25, v29
    v_smfmac_f32_16x16x64_bf16 v[32:35], v[44:47], v[200:207], v2
    v_permlane32_swap_b32 v26, v30
    v_permlane32_swap_b32 v27, v31
    v_smfmac_f32_16x16x64_bf16 v[36:39], v[44:47], v[64:71], v2
    ds_read_b128 v[44:47], v21 offset:1024
    v_pk_add_f32 v[24:25], v[24:25], v[28:29]
    v_smfmac_f32_16x16x64_bf16 v[32:35], v[40:43], v[168:175], v2
    v_pk_add_f32 v[26:27], v[26:27], v[30:31]
    v_cvt_pk_bf16_f32 v24, v24, v25
    v_smfmac_f32_16x16x64_bf16 v[36:39], v[40:43], v[176:183], v2
    ds_read_b128 v[40:43], v21 offset:0
    v_cvt_pk_bf16_f32 v25, v26, v27
    s_waitcnt lgkmcnt(2)
    v_smfmac_f32_16x16x64_bf16 v[32:35], v[52:55], v[144:151], v2
    ds_write_b64 v6, v[24:25]
    ds_read_b128 v[56:59], v8 offset:16384
    v_smfmac_f32_16x16x64_bf16 v[36:39], v[52:55], v[152:159], v2
    ds_read_b128 v[52:55], v4 offset:3072
    ds_read_b128 v[60:63], v8 offset:17408
    v_smfmac_f32_16x16x64_bf16 v[32:35], v[48:51], v[112:119], v2
    ds_read_b128 v[64:67], v8 offset:18432
    v_smfmac_f32_16x16x64_bf16 v[36:39], v[48:51], v[120:127], v2
    ds_read_b128 v[48:51], v4 offset:2048
    s_waitcnt lgkmcnt(6)
    v_smfmac_f32_16x16x64_bf16 v[32:35], v[44:47], a[248:255], v2
    ds_read_b128 v[68:71], v8 offset:19456
    s_waitcnt lgkmcnt(5)
    s_barrier
    v_smfmac_f32_16x16x64_bf16 v[36:39], v[44:47], v[96:103], v2
    ds_read_b64_tr_b16 v[80:81], v7 offset:0
    ds_read_b64_tr_b16 v[82:83], v7 offset:64
    v_smfmac_f32_16x16x64_bf16 v[32:35], v[40:43], a[216:223], v2
    ds_read_b64_tr_b16 v[84:85], v7 offset:512
    ds_read_b64_tr_b16 v[86:87], v7 offset:576
    v_smfmac_f32_16x16x64_bf16 v[36:39], v[40:43], a[224:231], v2
    ds_read_b64_tr_b16 v[88:89], v7 offset:1024
    ds_read_b64_tr_b16 v[90:91], v7 offset:1088
    s_waitcnt lgkmcnt(7)
    v_smfmac_f32_16x16x64_bf16 v[32:35], v[52:55], a[192:199], v2
    ds_read_b64_tr_b16 v[92:93], v7 offset:1536
    v_smfmac_f32_16x16x64_bf16 v[36:39], v[52:55], a[200:207], v2
    ds_read_b64_tr_b16 v[94:95], v7 offset:1600
    v_smfmac_f32_16x16x64_bf16 v[32:35], v[48:51], a[160:167], v2
    v_smfmac_f32_16x16x64_bf16 v[36:39], v[48:51], a[168:175], v2
    s_waitcnt lgkmcnt(2)
    v_mfma_f32_16x16x32_bf16 v[24:27], v[56:59], v[80:83], 0
    ds_read_b128 v[56:59], v8 offset:22528
    v_mfma_f32_16x16x32_bf16 v[28:31], v[60:63], v[80:83], 0
    ds_read_b128 v[60:63], v8 offset:23552
    v_mfma_f32_16x16x32_bf16 v[24:27], v[64:67], v[84:87], v[24:27]
    s_nop 1
    v_cvt_pk_bf16_f32 v32, v32, v33
    v_cvt_pk_bf16_f32 v33, v34, v35
    v_cvt_pk_bf16_f32 v34, v36, v37
    v_cvt_pk_bf16_f32 v35, v38, v39
    ds_write2_b64 v18, v[32:33], v[34:35] offset1:32
    v_mfma_f32_16x16x32_bf16 v[28:31], v[68:71], v[84:87], v[28:31]
    v_mfma_f32_16x16x32_bf16 v[24:27], v[72:75], v[88:91], v[24:27]
    ds_read_b64_tr_b16 v[64:65], v9 offset:24576
    v_mfma_f32_16x16x32_bf16 v[28:31], v[76:79], v[88:91], v[28:31]
    ds_read_b64_tr_b16 v[66:67], v9 offset:25600
    s_waitcnt lgkmcnt(3)
    v_mfma_f32_16x16x32_bf16 v[24:27], v[56:59], v[92:95], v[24:27]
    ds_read_b64_tr_b16 v[68:69], v9 offset:25088
    v_mfma_f32_16x16x32_bf16 v[28:31], v[60:63], v[92:95], v[28:31]
    ds_read_b64_tr_b16 v[70:71], v9 offset:26112
    s_waitcnt lgkmcnt(4)
    s_barrier
    ds_read_b64_tr_b16 v[40:41], v16 offset:55296
    ds_read_b64_tr_b16 v[42:43], v16 offset:55808
    ds_read_b64_tr_b16 v[44:45], v16 offset:56320
    ds_read_b64_tr_b16 v[46:47], v16 offset:56832
    ds_read_b64_tr_b16 v[48:49], v16 offset:57344
    ds_read_b64_tr_b16 v[50:51], v16 offset:57856
    ds_read_b64_tr_b16 v[52:53], v16 offset:58368
    ds_read_b64_tr_b16 v[54:55], v16 offset:58880
    s_cmp_eq_u32 s60, 63
    s_cbranch_scc1 L_q_last_46
    v_max3_f32 v11, v24, v25, v26
    s_waitcnt lgkmcnt(6)
    v_mfma_f32_16x16x32_bf16 v[36:39], v[40:43], v[80:83], 0
    v_max3_f32 v13, v27, v28, v29
    v_max3_f32 v11, v11, v30, v31
    s_waitcnt lgkmcnt(4)
    v_mfma_f32_16x16x32_bf16 v[36:39], v[44:47], v[84:87], v[36:39]
    v_max_f32 v11, v11, v13
    v_mul_f32 v10, s52, v11
    s_waitcnt lgkmcnt(2)
    v_mfma_f32_16x16x32_bf16 v[36:39], v[48:51], v[88:91], v[36:39]
    v_pk_fma_f32 v[24:25], v[24:25], s[52:53], v[10:11] op_sel_hi:[1,0,0] neg_lo:[0,0,1] neg_hi:[0,0,1]
    v_pk_fma_f32 v[26:27], v[26:27], s[52:53], v[10:11] op_sel_hi:[1,0,0] neg_lo:[0,0,1] neg_hi:[0,0,1]
    s_waitcnt lgkmcnt(0)
    v_mfma_f32_16x16x32_bf16 v[36:39], v[52:55], v[92:95], v[36:39]
    v_pk_fma_f32 v[28:29], v[28:29], s[52:53], v[10:11] op_sel_hi:[1,0,0] neg_lo:[0,0,1] neg_hi:[0,0,1]
    v_pk_fma_f32 v[30:31], v[30:31], s[52:53], v[10:11] op_sel_hi:[1,0,0] neg_lo:[0,0,1] neg_hi:[0,0,1]
    buffer_load_dwordx2 v[0:1], v16, s[12:15], s51 offen sc1
    s_add_u32 s46, s60, 1
    v_mov_b32 v74, s46
    v_mov_b32 v57, 0
    v_mov_b32 v58, 0
    v_exp_f32 v24, v24
    v_exp_f32 v25, v25
    v_permlane32_swap_b32 v36, v38
    v_permlane32_swap_b32 v37, v39
    v_pk_add_f32 v[36:37], v[36:37], v[38:39]
    v_max3_f32 v12, v36, v37, v11
    v_max3_f32 v13, v36, v37, v11
    v_exp_f32 v26, v26
    v_exp_f32 v27, v27
    v_permlane32_swap_b32 v12, v13
    v_max_f32 v22, v12, v13
    v_max_f32 v13, v12, v13
    v_exp_f32 v28, v28
    v_exp_f32 v29, v29
    v_permlane16_swap_b32 v22, v13
    v_max_f32 v12, v22, v13
    v_mul_f32 v12, s52, v12
    v_sub_f32 v10, v10, v12
    v_pk_fma_f32 v[36:37], v[36:37], s[52:53], v[12:13] op_sel_hi:[1,0,0] neg_lo:[0,0,1] neg_hi:[0,0,1]
    v_exp_f32 v10, v10
    v_exp_f32 v30, v30
    v_exp_f32 v31, v31
    v_exp_f32 v36, v36
    v_exp_f32 v37, v37
    v_pk_mul_f32 v[24:25], v[24:25], v[10:11] op_sel_hi:[1,0]
    v_pk_mul_f32 v[26:27], v[26:27], v[10:11] op_sel_hi:[1,0]
    v_pk_mul_f32 v[28:29], v[28:29], v[10:11] op_sel_hi:[1,0]
    v_pk_mul_f32 v[30:31], v[30:31], v[10:11] op_sel_hi:[1,0]
    v_cvt_pk_bf16_f32 v60, v24, v25
    v_cvt_pk_bf16_f32 v61, v26, v27
    v_cvt_pk_bf16_f32 v62, v28, v29
    v_cvt_pk_bf16_f32 v63, v30, v31
    v_cvt_pk_bf16_f32 v56, v36, v37
    v_cvt_pk_bf16_f32 v59, v36, v37
    s_mov_b64 exec, 15
    s_cmp_eq_u32 s67, 1
    s_cbranch_scc0 L_ls_47_s
    buffer_store_dword v74, v20, s[12:15], 0 offen
L_ls_47_d:
    s_mov_b64 exec, -1
    v_mfma_f32_16x16x32_bf16 v[72:75], v[64:67], v[60:63], 0
    v_pk_add_f32 v[24:25], v[24:25], v[26:27]
    v_pk_add_f32 v[28:29], v[28:29], v[30:31]
    v_mfma_f32_16x16x32_bf16 v[76:79], v[68:71], v[60:63], 0
    v_pk_add_f32 v[24:25], v[24:25], v[36:37]
    s_waitcnt vmcnt(1)
L_q_vm_48:
    v_max_u32 v22, v0, v1
    v_cmp_eq_u32 vcc, -1, v22
    v_pk_add_f32 v[10:11], v[24:25], v[28:29]
    v_add_f32 v12, v10, v11
    s_cbranch_vccnz L_q_vm_48_r
    v_add_f32 v13, v10, v11
    v_mfma_f32_16x16x16_bf16 v[72:75], v[0:1], v[56:57], v[72:75]
    v_mfma_f32_16x16x16_bf16 v[76:79], v[0:1], v[58:59], v[76:79]
    v_permlane32_swap_b32 v12, v13
    v_add_f32 v22, v12, v13
    v_add_f32 v13, v12, v13
    s_nop 1
    v_permlane16_swap_b32 v22, v13
    v_add_f32 v12, v22, v13
    v_rcp_f32 v12, v12
    s_mov_b64 exec, s[56:57]
    v_pk_mul_f32 v[72:73], v[72:73], v[12:13] op_sel_hi:[1,0]
    v_pk_mul_f32 v[74:75], v[74:75], v[12:13] op_sel_hi:[1,0]
    v_pk_mul_f32 v[76:77], v[76:77], v[12:13] op_sel_hi:[1,0]
    v_pk_mul_f32 v[78:79], v[78:79], v[12:13] op_sel_hi:[1,0]
    v_cvt_pk_bf16_f32 v72, v72, v73
    v_cvt_pk_bf16_f32 v73, v74, v75
    v_cvt_pk_bf16_f32 v74, v76, v77
    v_cvt_pk_bf16_f32 v75, v78, v79
    v_min_u32 v72, -2, v72
    v_min_u32 v73, -2, v73
    v_min_u32 v74, -2, v74
    v_min_u32 v75, -2, v75
    s_cmp_eq_u32 s67, 1
    s_cbranch_scc0 L_ls_49_s
    buffer_store_dwordx4 v[72:75], v17, s[12:15], s62 offen
L_ls_49_d:
    v_mov_b32 v60, -1
    v_mov_b32 v61, -1
    v_mov_b32 v62, -1
    v_mov_b32 v63, -1
    s_add_u32 s45, s60, 3
    s_and_b32 s45, s45, 3
    s_lshl_b32 s45, s45, 15
    s_add_u32 s45, s45, s59
    s_cmp_eq_u32 s67, 1
    s_cbranch_scc0 L_ls_50_s
    buffer_store_dwordx4 v[60:63], v17, s[12:15], s45 offen
L_ls_50_d:
    s_mov_b64 exec, -1
L_q_last_46:
    s_waitcnt lgkmcnt(0)
    v_lshlrev_b32 v22, 1, v16
    s_cmp_lg_u32 s44, 0
    s_cbranch_scc1 L_q_km_51_0
    buffer_store_dwordx4 v[40:43], v22, s[12:15], s66 offen offset:0 sc1
L_q_km_51_0:
    s_cmp_lg_u32 s44, 1
    s_cbranch_scc1 L_q_km_51_1
    buffer_store_dwordx4 v[44:47], v22, s[12:15], s66 offen offset:1024 sc1
L_q_km_51_1:
    s_cmp_lg_u32 s44, 2
    s_cbranch_scc1 L_q_km_51_2
    buffer_store_dwordx4 v[48:51], v22, s[12:15], s66 offen offset:2048 sc1
L_q_km_51_2:
    s_cmp_lg_u32 s44, 3
    s_cbranch_scc1 L_q_km_51_3
    buffer_store_dwordx4 v[52:55], v22, s[12:15], s66 offen offset:3072 sc1
L_q_km_51_3:
    s_cmp_eq_u32 s60, 63
    s_cbranch_scc1 L_q_fin_52
    s_cmp_eq_u32 s60, 62
    s_cbranch_scc1 L_q_fin_52_n
    s_add_u32 s47, s60, 1
    s_cmp_lt_u32 s47, s50
    s_cbranch_scc1 L_kv_rdy_53
    s_lshl_b32 s45, s43, 7
    s_add_u32 s45, s45, 0x10014
    v_mov_b32 v0, 0
    s_mov_b32 s70, 0
L_kv_rdy_53_p:
    buffer_load_dwordx2 v[10:11], v0, s[12:15], s45 offen sc1
    s_add_u32 s70, s70, 1
    s_cmp_ge_u32 s70, 0x200000
    s_cbranch_scc1 L_c_done_1
    s_waitcnt vmcnt(0)
    v_min_u32 v10, v10, v11
    s_nop 0
    v_readfirstlane_b32 s50, v10
    s_nop 3
    s_cmp_lt_u32 s47, s50
    s_cbranch_scc1 L_kv_rdy_53
    s_sleep 2
    s_branch L_kv_rdy_53_p
L_kv_rdy_53:
    s_mov_b32 m0, s64
    s_add_u32 s46, s63, 0x1000000
    buffer_load_dwordx4 v14, s[12:15], s63 offen sc1 lds
    buffer_load_dwordx4 v14, s[12:15], s63 offen offset:1024 sc1 lds
    s_mov_b32 m0, s65
    s_add_u32 s63, s63, 8192
    buffer_load_dwordx4 v14, s[12:15], s46 offen sc1 lds
    buffer_load_dwordx4 v14, s[12:15], s46 offen offset:1024 sc1 lds
L_q_fin_52_n:
    s_add_u32 s47, s60, 1
    s_bitcmp1_b64 s[6:7], s47
    s_cselect_b32 s47, s47, s60
    s_cbranch_scc0 L_q_fin_52_m
    s_waitcnt vmcnt(0)
L_q_fin_52_m:
    v_mov_b32 v22, s47
    v_mov_b32 v0, 0
    s_mov_b64 exec, 1
    buffer_store_dword v22, v0, s[12:15], s3 offen sc1
    s_mov_b64 exec, -1
    s_mov_b64 exec, -1
    v_add_u32 v8, s69, v8
    v_add_u32 v9, s69, v9
    s_sub_u32 s64, s64, s69
    s_sub_u32 s65, s65, s69
    s_sub_u32 s69, 0, s69
    s_add_u32 s66, s66, 131072
    s_xor_b32 s51, s51, 65536
    s_add_u32 s60, s60, 1
    s_and_b32 s45, s60, 3
    s_lshl_b32 s46, s45, 14
    s_add_u32 s61, s58, s46
    s_lshl_b32 s46, s45, 15
    s_add_u32 s62, s59, s46
    s_branch L_q_loop_41
L_q_fin_52:
    s_waitcnt vmcnt(0)
    v_mov_b32 v22, 64
    v_mov_b32 v0, 0
    s_mov_b64 exec, 1
    buffer_store_dword v22, v0, s[12:15], s3 offen sc1
    s_mov_b64 exec, -1
    s_endpgm
L_q_vm_48_r:
    buffer_load_dwordx2 v[0:1], v16, s[12:15], s51 offen sc1
    s_add_u32 s70, s70, 1
    s_cmp_lt_u32 s70, 0x100000
    s_waitcnt vmcnt(0)
    s_cbranch_scc1 L_q_vm_48
    s_endpgm
L_ls_47_s:
    buffer_store_dword v74, v20, s[12:15], 0 offen sc1
    s_branch L_ls_47_d
L_ls_49_s:
    buffer_store_dwordx4 v[72:75], v17, s[12:15], s62 offen sc1
    s_branch L_ls_49_d
L_ls_50_s:
    buffer_store_dwordx4 v[60:63], v17, s[12:15], s45 offen sc1
    s_branch L_ls_50_d
L_c_vo_2:
    s_lshl_b32 s45, s43, 11
    s_lshl_b32 s46, s44, 9
    s_add_u32 s45, s45, s46
    v_lshlrev_b32 v10, 3, v1
    v_add_u32 v10, s45, v10
    v_lshlrev_b32 v11, 3, v0
    v_bfe_u32 v69, v1, 4, 1
    v_lshlrev_b32 v69, 2, v69
    v_lshrrev_b32 v63, 5, v1
    v_lshlrev_b32 v63, 1, v63
    v_and_b32 v64, 1, v1
    v_add3_u32 v69, v69, v63, v64
    v_bfe_u32 v63, v1, 1, 1
    v_lshlrev_b32 v63, 3, v63
    v_add_u32 v63, v63, v69
    v_lshlrev_b32 v63, 4, v63
    v_bfe_u32 v64, v1, 2, 2
    v_lshlrev_b32 v64, 2, v64
    s_lshl_b32 s45, s42, 10
    s_lshl_b32 s46, s44, 8
    s_add_u32 s45, s45, s46
    v_add3_u32 v12, v63, v64, s45
    v_and_b32 v64, 1, v1
    v_cmp_eq_u32 vcc, 0, v64
    v_mov_b32 v9, 0x07060302
    v_mov_b32 v63, 0x01000504
    v_cndmask_b32 v9, v9, v63, vcc
    s_lshl_b32 s63, s40, 19
    s_lshl_b32 s45, s42, 15
    s_add_u32 s63, s63, s45
    s_add_u32 s63, s63, 0x7100000
    s_xor_b32 s64, s63, 524288
    s_mov_b32 s45, 0x7020000
    buffer_store_dwordx2 v[40:41], v10, s[12:15], s45 offen sc1
    s_mov_b32 s45, 0x7030000
    buffer_store_dwordx2 v[40:41], v10, s[12:15], s45 offen sc1
    s_add_u32 s45, s63, 0
    buffer_store_dwordx2 v[40:41], v11, s[12:15], s45 offen sc1
    s_add_u32 s45, s63, 4096
    buffer_store_dwordx2 v[40:41], v11, s[12:15], s45 offen sc1
    s_add_u32 s45, s63, 8192
    buffer_store_dwordx2 v[40:41], v11, s[12:15], s45 offen sc1
    s_add_u32 s45, s63, 12288
    buffer_store_dwordx2 v[40:41], v11, s[12:15], s45 offen sc1
    s_add_u32 s45, s63, 16384
    buffer_store_dwordx2 v[40:41], v11, s[12:15], s45 offen sc1
    s_add_u32 s45, s63, 20480
    buffer_store_dwordx2 v[40:41], v11, s[12:15], s45 offen sc1
    s_add_u32 s45, s63, 24576
    buffer_store_dwordx2 v[40:41], v11, s[12:15], s45 offen sc1
    s_add_u32 s45, s63, 28672
    buffer_store_dwordx2 v[40:41], v11, s[12:15], s45 offen sc1
    s_lshl_b32 s61, s40, 16
    s_add_u32 s61, s61, 0x7000000
    s_add_u32 s45, s61, 16384
    buffer_store_dword v40, v12, s[12:15], s45 offen sc1
    s_add_u32 s45, s61, 32768
    buffer_store_dword v40, v12, s[12:15], s45 offen sc1
    s_add_u32 s45, s61, 49152
    buffer_store_dword v40, v12, s[12:15], s45 offen sc1
    v_lshlrev_b32 v63, 11, v69
    v_and_b32 v64, 14, v1
    v_lshlrev_b32 v64, 1, v64
    v_add_u32 v63, v63, v64
    s_lshl_b32 s45, s42, 7
    s_lshl_b32 s46, s44, 5
    s_add_u32 s45, s45, s46
    buffer_load_dword v45, v63, s[52:55], s45 offen
    s_mov_b32 s76, -1
    s_mov_b32 s77, -1
    v_lshrrev_b32 v63, 3, v1
    v_lshlrev_b32 v63, 11, v63
    v_bfe_u32 v64, v1, 1, 2
    v_and_b32 v65, 1, v1
    v_lshlrev_b32 v65, 4, v65
    v_add_u32 v63, v63, v65
    v_xor_b32 v66, 0, v64
    v_lshlrev_b32 v66, 5, v66
    v_add_u32 v70, v63, v66
    v_xor_b32 v66, 1, v64
    v_lshlrev_b32 v66, 5, v66
    v_add_u32 v71, v63, v66
    v_xor_b32 v66, 2, v64
    v_lshlrev_b32 v66, 5, v66
    v_add_u32 v72, v63, v66
    v_xor_b32 v66, 3, v64
    v_lshlrev_b32 v66, 5, v66
    v_add_u32 v73, v63, v66
    v_bfe_u32 v63, v1, 3, 1
    v_lshlrev_b32 v63, 1, v63
    v_bfe_u32 v64, v1, 4, 1
    v_add_u32 v63, v63, v64
    v_lshlrev_b32 v64, 3, v63
    v_lshrrev_b32 v65, 5, v1
    v_lshlrev_b32 v65, 2, v65
    v_add_u32 v64, v64, v65
    v_bfe_u32 v65, v1, 2, 1
    v_add_u32 v64, v64, v65
    v_lshlrev_b32 v64, 7, v64
    v_and_b32 v65, 3, v1
    v_lshlrev_b32 v65, 3, v65
    v_add_u32 v64, v64, v65
    s_lshl_b32 s45, s44, 12
    v_add_u32 v64, s45, v64
    s_add_u32 s45, s44, 1
    s_and_b32 s45, s45, 3
    v_xor_b32 v65, s45, v63
    v_lshlrev_b32 v65, 5, v65
    v_add_u32 v74, v64, v65
    s_mul_i32 s45, s44, 20480
    s_add_u32 s45, s45, 65536
    v_add_u32 v88, s45, v74
    s_add_u32 s45, s44, 2
    s_and_b32 s45, s45, 3
    v_xor_b32 v65, s45, v63
    v_lshlrev_b32 v65, 5, v65
    v_add_u32 v75, v64, v65
    s_mul_i32 s45, s44, 20480
    s_add_u32 s45, s45, 65536
    v_add_u32 v89, s45, v75
    s_add_u32 s45, s44, 3
    s_and_b32 s45, s45, 3
    v_xor_b32 v65, s45, v63
    v_lshlrev_b32 v65, 5, v65
    v_add_u32 v76, v64, v65
    s_mul_i32 s45, s44, 20480
    s_add_u32 s45, s45, 65536
    v_add_u32 v90, s45, v76
    s_add_u32 s45, s44, 4
    s_and_b32 s45, s45, 3
    v_xor_b32 v65, s45, v63
    v_lshlrev_b32 v65, 5, v65
    v_add_u32 v77, v64, v65
    s_mul_i32 s45, s44, 20480
    s_add_u32 s45, s45, 65536
    v_add_u32 v91, s45, v77
    s_mul_i32 s65, s44, 24576
    s_lshl_b32 s49, s40, 22
    s_lshl_b32 s45, s44, 20
    s_add_u32 s49, s49, s45
    s_lshl_b32 s45, s42, 7
    s_add_u32 s49, s49, s45
    s_lshl_b32 s50, s44, 12
    s_mul_i32 s69, s42, 1
    s_add_u32 s51, s69, 0
    s_and_b32 s51, s51, 7
    s_lshl_b32 s51, s51, 17
    s_add_u32 s51, s51, s49
    s_add_u32 s46, s51, 0x0
    s_add_u32 m0, s65, 65536
    s_nop 0
    buffer_load_dwordx4 v70, s[36:39], s46 offen nt lds
    s_add_u32 s46, s51, 0x8000
    s_add_u32 m0, s65, 66560
    s_nop 0
    buffer_load_dwordx4 v71, s[36:39], s46 offen nt lds
    s_add_u32 s46, s51, 0x10000
    s_add_u32 m0, s65, 67584
    s_nop 0
    buffer_load_dwordx4 v72, s[36:39], s46 offen nt lds
    s_add_u32 s46, s51, 0x18000
    s_add_u32 m0, s65, 68608
    s_nop 0
    buffer_load_dwordx4 v73, s[36:39], s46 offen nt lds
    s_add_u32 s51, s69, 0
    s_and_b32 s51, s51, 7
    s_lshl_b32 s51, s51, 17
    s_add_u32 s51, s51, s49
    s_add_u32 s46, s51, 0x4000
    s_add_u32 m0, s65, 69632
    s_nop 0
    buffer_load_dwordx4 v70, s[36:39], s46 offen nt lds
    s_add_u32 s46, s51, 0xc000
    s_add_u32 m0, s65, 70656
    s_nop 0
    buffer_load_dwordx4 v71, s[36:39], s46 offen nt lds
    s_add_u32 s46, s51, 0x14000
    s_add_u32 m0, s65, 71680
    s_nop 0
    buffer_load_dwordx4 v72, s[36:39], s46 offen nt lds
    s_add_u32 s46, s51, 0x1c000
    s_add_u32 m0, s65, 72704
    s_nop 0
    buffer_load_dwordx4 v73, s[36:39], s46 offen nt lds
    s_add_u32 s51, s69, 1
    s_and_b32 s51, s51, 7
    s_lshl_b32 s51, s51, 17
    s_add_u32 s51, s51, s49
    s_add_u32 s46, s51, 0x0
    s_add_u32 m0, s65, 73728
    s_nop 0
    buffer_load_dwordx4 v70, s[36:39], s46 offen nt lds
    s_add_u32 s46, s51, 0x8000
    s_add_u32 m0, s65, 74752
    s_nop 0
    buffer_load_dwordx4 v71, s[36:39], s46 offen nt lds
    s_add_u32 s46, s51, 0x10000
    s_add_u32 m0, s65, 75776
    s_nop 0
    buffer_load_dwordx4 v72, s[36:39], s46 offen nt lds
    s_add_u32 s46, s51, 0x18000
    s_add_u32 m0, s65, 76800
    s_nop 0
    buffer_load_dwordx4 v73, s[36:39], s46 offen nt lds
    s_add_u32 s51, s69, 1
    s_and_b32 s51, s51, 7
    s_lshl_b32 s51, s51, 17
    s_add_u32 s51, s51, s49
    s_add_u32 s46, s51, 0x4000
    s_add_u32 m0, s65, 77824
    s_nop 0
    buffer_load_dwordx4 v70, s[36:39], s46 offen nt lds
    s_add_u32 s46, s51, 0xc000
    s_add_u32 m0, s65, 78848
    s_nop 0
    buffer_load_dwordx4 v71, s[36:39], s46 offen nt lds
    s_add_u32 s46, s51, 0x14000
    s_add_u32 m0, s65, 79872
    s_nop 0
    buffer_load_dwordx4 v72, s[36:39], s46 offen nt lds
    s_add_u32 s46, s51, 0x1c000
    s_add_u32 m0, s65, 80896
    s_nop 0
    buffer_load_dwordx4 v73, s[36:39], s46 offen nt lds
    s_add_u32 s51, s69, 2
    s_and_b32 s51, s51, 7
    s_lshl_b32 s51, s51, 17
    s_add_u32 s51, s51, s49
    s_add_u32 s46, s51, 0x0
    s_add_u32 m0, s65, 81920
    s_nop 0
    buffer_load_dwordx4 v70, s[36:39], s46 offen nt lds
    s_add_u32 s46, s51, 0x8000
    s_add_u32 m0, s65, 82944
    s_nop 0
    buffer_load_dwordx4 v71, s[36:39], s46 offen nt lds
    s_add_u32 s46, s51, 0x10000
    s_add_u32 m0, s65, 83968
    s_nop 0
    buffer_load_dwordx4 v72, s[36:39], s46 offen nt lds
    s_add_u32 s46, s51, 0x18000
    s_add_u32 m0, s65, 84992
    s_nop 0
    buffer_load_dwordx4 v73, s[36:39], s46 offen nt lds
    s_add_u32 s51, s69, 2
    s_and_b32 s51, s51, 7
    s_lshl_b32 s51, s51, 17
    s_add_u32 s51, s51, s49
    s_add_u32 s46, s51, 0x4000
    s_add_u32 m0, s65, 86016
    s_nop 0
    buffer_load_dwordx4 v70, s[36:39], s46 offen nt lds
    s_add_u32 s46, s51, 0xc000
    s_add_u32 m0, s65, 87040
    s_nop 0
    buffer_load_dwordx4 v71, s[36:39], s46 offen nt lds
    s_add_u32 s46, s51, 0x14000
    s_add_u32 m0, s65, 88064
    s_nop 0
    buffer_load_dwordx4 v72, s[36:39], s46 offen nt lds
    s_add_u32 s46, s51, 0x1c000
    s_add_u32 m0, s65, 89088
    s_nop 0
    buffer_load_dwordx4 v73, s[36:39], s46 offen nt lds
    s_add_u32 s51, s69, 3
    s_and_b32 s51, s51, 7
    s_lshl_b32 s51, s51, 17
    s_add_u32 s51, s51, s49
    s_add_u32 s46, s51, 0x0
    s_add_u32 m0, s50, 0
    s_nop 0
    buffer_load_dwordx4 v70, s[36:39], s46 offen nt lds
    s_add_u32 s46, s51, 0x8000
    s_add_u32 m0, s50, 1024
    s_nop 0
    buffer_load_dwordx4 v71, s[36:39], s46 offen nt lds
    s_add_u32 s46, s51, 0x10000
    s_add_u32 m0, s50, 2048
    s_nop 0
    buffer_load_dwordx4 v72, s[36:39], s46 offen nt lds
    s_add_u32 s46, s51, 0x18000
    s_add_u32 m0, s50, 3072
    s_nop 0
    buffer_load_dwordx4 v73, s[36:39], s46 offen nt lds
    s_add_u32 s51, s69, 3
    s_and_b32 s51, s51, 7
    s_lshl_b32 s51, s51, 17
    s_add_u32 s51, s51, s49
    s_add_u32 s46, s51, 0x4000
    s_add_u32 m0, s50, 16384
    s_nop 0
    buffer_load_dwordx4 v70, s[36:39], s46 offen nt lds
    s_add_u32 s46, s51, 0xc000
    s_add_u32 m0, s50, 17408
    s_nop 0
    buffer_load_dwordx4 v71, s[36:39], s46 offen nt lds
    s_add_u32 s46, s51, 0x14000
    s_add_u32 m0, s50, 18432
    s_nop 0
    buffer_load_dwordx4 v72, s[36:39], s46 offen nt lds
    s_add_u32 s46, s51, 0x1c000
    s_add_u32 m0, s50, 19456
    s_nop 0
    buffer_load_dwordx4 v73, s[36:39], s46 offen nt lds
    s_add_u32 s51, s69, 4
    s_and_b32 s51, s51, 7
    s_lshl_b32 s51, s51, 17
    s_add_u32 s51, s51, s49
    s_add_u32 s46, s51, 0x0
    s_add_u32 m0, s50, 32768
    s_nop 0
    buffer_load_dwordx4 v70, s[36:39], s46 offen nt lds
    s_add_u32 s46, s51, 0x8000
    s_add_u32 m0, s50, 33792
    s_nop 0
    buffer_load_dwordx4 v71, s[36:39], s46 offen nt lds
    s_add_u32 s46, s51, 0x10000
    s_add_u32 m0, s50, 34816
    s_nop 0
    buffer_load_dwordx4 v72, s[36:39], s46 offen nt lds
    s_add_u32 s46, s51, 0x18000
    s_add_u32 m0, s50, 35840
    s_nop 0
    buffer_load_dwordx4 v73, s[36:39], s46 offen nt lds
    s_add_u32 s51, s69, 4
    s_and_b32 s51, s51, 7
    s_lshl_b32 s51, s51, 17
    s_add_u32 s51, s51, s49
    s_add_u32 s46, s51, 0x4000
    s_add_u32 m0, s50, 49152
    s_nop 0
    buffer_load_dwordx4 v70, s[36:39], s46 offen nt lds
    s_add_u32 s46, s51, 0xc000
    s_add_u32 m0, s50, 50176
    s_nop 0
    buffer_load_dwordx4 v71, s[36:39], s46 offen nt lds
    s_add_u32 s46, s51, 0x14000
    s_add_u32 m0, s50, 51200
    s_nop 0
    buffer_load_dwordx4 v72, s[36:39], s46 offen nt lds
    s_add_u32 s46, s51, 0x1c000
    s_add_u32 m0, s50, 52224
    s_nop 0
    buffer_load_dwordx4 v73, s[36:39], s46 offen nt lds
    s_waitcnt vmcnt(40)
    v_min_u32 v45, -2, v45
    buffer_store_dword v45, v12, s[12:15], s61 offen sc1
    s_waitcnt vmcnt(36)
    s_barrier
    ds_read_b64_tr_b16 a[160:161], v88 offset:0
    ds_read_b64_tr_b16 a[162:163], v88 offset:256
    ds_read_b64_tr_b16 a[168:169], v89 offset:0
    ds_read_b64_tr_b16 a[170:171], v89 offset:256
    ds_read_b64_tr_b16 a[176:177], v90 offset:0
    ds_read_b64_tr_b16 a[178:179], v90 offset:256
    ds_read_b64_tr_b16 a[184:185], v91 offset:0
    ds_read_b64_tr_b16 a[186:187], v91 offset:256
L_lw_54:
    s_waitcnt lgkmcnt(0)
    s_cmp_lg_u32 s44, 0
    s_cbranch_scc1 L_v_probe_55
    s_add_u32 s45, s63, 0
    s_memtime s[72:73]
    s_waitcnt lgkmcnt(0)
    s_load_dword s78, s[20:21], s45
    s_waitcnt lgkmcnt(0)
    s_memtime s[74:75]
    s_waitcnt lgkmcnt(0)
    s_sub_u32 s45, s74, s72
    s_min_u32 s76, s76, s45
    s_cmp_lt_u32 s77, s76
    s_cselect_b32 s68, 1, 0
L_v_probe_55:
    s_waitcnt vmcnt(32)
    s_barrier
    s_add_u32 s51, s69, 5
    s_and_b32 s51, s51, 7
    s_lshl_b32 s51, s51, 17
    s_add_u32 s51, s51, s49
    s_add_u32 s46, s51, 0x0
    s_add_u32 m0, s65, 65536
    s_nop 0
    buffer_load_dwordx4 v70, s[36:39], s46 offen nt lds
    s_add_u32 s46, s51, 0x8000
    s_add_u32 m0, s65, 66560
    s_nop 0
    buffer_load_dwordx4 v71, s[36:39], s46 offen nt lds
    s_add_u32 s46, s51, 0x10000
    s_add_u32 m0, s65, 67584
    s_nop 0
    buffer_load_dwordx4 v72, s[36:39], s46 offen nt lds
    s_add_u32 s46, s51, 0x18000
    s_add_u32 m0, s65, 68608
    s_nop 0
    buffer_load_dwordx4 v73, s[36:39], s46 offen nt lds
    ds_read_b64_tr_b16 a[164:165], v88 offset:4096
    ds_read_b64_tr_b16 a[166:167], v88 offset:4352
    ds_read_b64_tr_b16 a[172:173], v89 offset:4096
    ds_read_b64_tr_b16 a[174:175], v89 offset:4352
    ds_read_b64_tr_b16 a[180:181], v90 offset:4096
    ds_read_b64_tr_b16 a[182:183], v90 offset:4352
    ds_read_b64_tr_b16 a[188:189], v91 offset:4096
    ds_read_b64_tr_b16 a[190:191], v91 offset:4352
L_lw_56:
    s_waitcnt lgkmcnt(0)
    s_cmp_lg_u32 s44, 0
    s_cbranch_scc1 L_v_probe_57
    s_add_u32 s45, s63, 8192
    s_memtime s[72:73]
    s_waitcnt lgkmcnt(0)
    s_load_dword s78, s[20:21], s45
    s_waitcnt lgkmcnt(0)
    s_memtime s[74:75]
    s_waitcnt lgkmcnt(0)
    s_sub_u32 s45, s74, s72
    s_min_u32 s77, s77, s45
    s_cmp_lt_u32 s77, s76
    s_cselect_b32 s68, 1, 0
L_v_probe_57:
    s_waitcnt vmcnt(32)
    s_barrier
    s_add_u32 s51, s69, 5
    s_and_b32 s51, s51, 7
    s_lshl_b32 s51, s51, 17
    s_add_u32 s51, s51, s49
    s_add_u32 s46, s51, 0x4000
    s_add_u32 m0, s65, 69632
    s_nop 0
    buffer_load_dwordx4 v70, s[36:39], s46 offen nt lds
    s_add_u32 s46, s51, 0xc000
    s_add_u32 m0, s65, 70656
    s_nop 0
    buffer_load_dwordx4 v71, s[36:39], s46 offen nt lds
    s_add_u32 s46, s51, 0x14000
    s_add_u32 m0, s65, 71680
    s_nop 0
    buffer_load_dwordx4 v72, s[36:39], s46 offen nt lds
    s_add_u32 s46, s51, 0x1c000
    s_add_u32 m0, s65, 72704
    s_nop 0
    buffer_load_dwordx4 v73, s[36:39], s46 offen nt lds
    ds_read_b64_tr_b16 a[192:193], v88 offset:8192
    ds_read_b64_tr_b16 a[194:195], v88 offset:8448
    ds_read_b64_tr_b16 a[200:201], v89 offset:8192
    ds_read_b64_tr_b16 a[202:203], v89 offset:8448
    ds_read_b64_tr_b16 a[208:209], v90 offset:8192
    ds_read_b64_tr_b16 a[210:211], v90 offset:8448
    ds_read_b64_tr_b16 a[216:217], v91 offset:8192
    ds_read_b64_tr_b16 a[218:219], v91 offset:8448
L_lw_58:
    s_waitcnt lgkmcnt(0)
    s_cmp_lg_u32 s44, 0
    s_cbranch_scc1 L_v_probe_59
    s_add_u32 s45, s63, 128
    s_memtime s[72:73]
    s_waitcnt lgkmcnt(0)
    s_load_dword s78, s[20:21], s45
    s_waitcnt lgkmcnt(0)
    s_memtime s[74:75]
    s_waitcnt lgkmcnt(0)
    s_sub_u32 s45, s74, s72
    s_min_u32 s76, s76, s45
    s_cmp_lt_u32 s77, s76
    s_cselect_b32 s68, 1, 0
L_v_probe_59:
    s_waitcnt vmcnt(32)
    s_barrier
    s_add_u32 s51, s69, 6
    s_and_b32 s51, s51, 7
    s_lshl_b32 s51, s51, 17
    s_add_u32 s51, s51, s49
    s_add_u32 s46, s51, 0x0
    s_add_u32 m0, s65, 73728
    s_nop 0
    buffer_load_dwordx4 v70, s[36:39], s46 offen nt lds
    s_add_u32 s46, s51, 0x8000
    s_add_u32 m0, s65, 74752
    s_nop 0
    buffer_load_dwordx4 v71, s[36:39], s46 offen nt lds
    s_add_u32 s46, s51, 0x10000
    s_add_u32 m0, s65, 75776
    s_nop 0
    buffer_load_dwordx4 v72, s[36:39], s46 offen nt lds
    s_add_u32 s46, s51, 0x18000
    s_add_u32 m0, s65, 76800
    s_nop 0
    buffer_load_dwordx4 v73, s[36:39], s46 offen nt lds
    ds_read_b64_tr_b16 a[196:197], v88 offset:12288
    ds_read_b64_tr_b16 a[198:199], v88 offset:12544
    ds_read_b64_tr_b16 a[204:205], v89 offset:12288
    ds_read_b64_tr_b16 a[206:207], v89 offset:12544
    ds_read_b64_tr_b16 a[212:213], v90 offset:12288
    ds_read_b64_tr_b16 a[214:215], v90 offset:12544
    ds_read_b64_tr_b16 a[220:221], v91 offset:12288
    ds_read_b64_tr_b16 a[222:223], v91 offset:12544
L_lw_60:
    s_waitcnt lgkmcnt(0)
    s_cmp_lg_u32 s44, 0
    s_cbranch_scc1 L_v_probe_61
    s_add_u32 s45, s63, 8320
    s_memtime s[72:73]
    s_waitcnt lgkmcnt(0)
    s_load_dword s78, s[20:21], s45
    s_waitcnt lgkmcnt(0)
    s_memtime s[74:75]
    s_waitcnt lgkmcnt(0)
    s_sub_u32 s45, s74, s72
    s_min_u32 s77, s77, s45
    s_cmp_lt_u32 s77, s76
    s_cselect_b32 s68, 1, 0
L_v_probe_61:
    s_waitcnt vmcnt(32)
    s_barrier
    s_add_u32 s51, s69, 6
    s_and_b32 s51, s51, 7
    s_lshl_b32 s51, s51, 17
    s_add_u32 s51, s51, s49
    s_add_u32 s46, s51, 0x4000
    s_add_u32 m0, s65, 77824
    s_nop 0
    buffer_load_dwordx4 v70, s[36:39], s46 offen nt lds
    s_add_u32 s46, s51, 0xc000
    s_add_u32 m0, s65, 78848
    s_nop 0
    buffer_load_dwordx4 v71, s[36:39], s46 offen nt lds
    s_add_u32 s46, s51, 0x14000
    s_add_u32 m0, s65, 79872
    s_nop 0
    buffer_load_dwordx4 v72, s[36:39], s46 offen nt lds
    s_add_u32 s46, s51, 0x1c000
    s_add_u32 m0, s65, 80896
    s_nop 0
    buffer_load_dwordx4 v73, s[36:39], s46 offen nt lds
    ds_read_b64_tr_b16 a[224:225], v88 offset:16384
    ds_read_b64_tr_b16 a[226:227], v88 offset:16640
    ds_read_b64_tr_b16 a[232:233], v89 offset:16384
    ds_read_b64_tr_b16 a[234:235], v89 offset:16640
    ds_read_b64_tr_b16 a[240:241], v90 offset:16384
    ds_read_b64_tr_b16 a[242:243], v90 offset:16640
    ds_read_b64_tr_b16 a[248:249], v91 offset:16384
    ds_read_b64_tr_b16 a[250:251], v91 offset:16640
L_lw_62:
    s_waitcnt lgkmcnt(0)
    s_cmp_lg_u32 s44, 0
    s_cbranch_scc1 L_v_probe_63
    s_add_u32 s45, s63, 256
    s_memtime s[72:73]
    s_waitcnt lgkmcnt(0)
    s_load_dword s78, s[20:21], s45
    s_waitcnt lgkmcnt(0)
    s_memtime s[74:75]
    s_waitcnt lgkmcnt(0)
    s_sub_u32 s45, s74, s72
    s_min_u32 s76, s76, s45
    s_cmp_lt_u32 s77, s76
    s_cselect_b32 s68, 1, 0
L_v_probe_63:
    s_waitcnt vmcnt(32)
    s_barrier
    s_add_u32 s51, s69, 7
    s_and_b32 s51, s51, 7
    s_lshl_b32 s51, s51, 17
    s_add_u32 s51, s51, s49
    s_add_u32 s46, s51, 0x0
    s_add_u32 m0, s65, 81920
    s_nop 0
    buffer_load_dwordx4 v70, s[36:39], s46 offen nt lds
    s_add_u32 s46, s51, 0x8000
    s_add_u32 m0, s65, 82944
    s_nop 0
    buffer_load_dwordx4 v71, s[36:39], s46 offen nt lds
    s_add_u32 s46, s51, 0x10000
    s_add_u32 m0, s65, 83968
    s_nop 0
    buffer_load_dwordx4 v72, s[36:39], s46 offen nt lds
    s_add_u32 s46, s51, 0x18000
    s_add_u32 m0, s65, 84992
    s_nop 0
    buffer_load_dwordx4 v73, s[36:39], s46 offen nt lds
    ds_read_b64_tr_b16 a[228:229], v88 offset:20480
    ds_read_b64_tr_b16 a[230:231], v88 offset:20736
    ds_read_b64_tr_b16 a[236:237], v89 offset:20480
    ds_read_b64_tr_b16 a[238:239], v89 offset:20736
    ds_read_b64_tr_b16 a[244:245], v90 offset:20480
    ds_read_b64_tr_b16 a[246:247], v90 offset:20736
    ds_read_b64_tr_b16 a[252:253], v91 offset:20480
    ds_read_b64_tr_b16 a[254:255], v91 offset:20736
L_lw_64:
    s_waitcnt lgkmcnt(0)
    s_cmp_lg_u32 s44, 0
    s_cbranch_scc1 L_v_probe_65
    s_add_u32 s45, s63, 8448
    s_memtime s[72:73]
    s_waitcnt lgkmcnt(0)
    s_load_dword s78, s[20:21], s45
    s_waitcnt lgkmcnt(0)
    s_memtime s[74:75]
    s_waitcnt lgkmcnt(0)
    s_sub_u32 s45, s74, s72
    s_min_u32 s77, s77, s45
    s_cmp_lt_u32 s77, s76
    s_cselect_b32 s68, 1, 0
L_v_probe_65:
    s_waitcnt vmcnt(32)
    s_barrier
    s_add_u32 s51, s69, 7
    s_and_b32 s51, s51, 7
    s_lshl_b32 s51, s51, 17
    s_add_u32 s51, s51, s49
    s_add_u32 s46, s51, 0x4000
    s_add_u32 m0, s65, 86016
    s_nop 0
    buffer_load_dwordx4 v70, s[36:39], s46 offen nt lds
    s_add_u32 s46, s51, 0xc000
    s_add_u32 m0, s65, 87040
    s_nop 0
    buffer_load_dwordx4 v71, s[36:39], s46 offen nt lds
    s_add_u32 s46, s51, 0x14000
    s_add_u32 m0, s65, 88064
    s_nop 0
    buffer_load_dwordx4 v72, s[36:39], s46 offen nt lds
    s_add_u32 s46, s51, 0x1c000
    s_add_u32 m0, s65, 89088
    s_nop 0
    buffer_load_dwordx4 v73, s[36:39], s46 offen nt lds
    ds_read_b64_tr_b16 v[96:97], v74 offset:0
    ds_read_b64_tr_b16 v[98:99], v74 offset:256
    ds_read_b64_tr_b16 v[104:105], v75 offset:0
    ds_read_b64_tr_b16 v[106:107], v75 offset:256
    ds_read_b64_tr_b16 v[112:113], v76 offset:0
    ds_read_b64_tr_b16 v[114:115], v76 offset:256
    ds_read_b64_tr_b16 v[120:121], v77 offset:0
    ds_read_b64_tr_b16 v[122:123], v77 offset:256
L_lw_66:
    s_waitcnt lgkmcnt(0)
    s_cmp_lg_u32 s44, 0
    s_cbranch_scc1 L_v_probe_67
    s_add_u32 s45, s63, 384
    s_memtime s[72:73]
    s_waitcnt lgkmcnt(0)
    s_load_dword s78, s[20:21], s45
    s_waitcnt lgkmcnt(0)
    s_memtime s[74:75]
    s_waitcnt lgkmcnt(0)
    s_sub_u32 s45, s74, s72
    s_min_u32 s76, s76, s45
    s_cmp_lt_u32 s77, s76
    s_cselect_b32 s68, 1, 0
L_v_probe_67:
    s_waitcnt vmcnt(32)
    s_barrier
    s_add_u32 s46, s47, 0x0
    s_add_u32 m0, s48, 0
    s_nop 0
    buffer_load_dwordx4 v82, s[32:35], s46 offen nt lds
    s_add_u32 s46, s47, 0x20000
    s_add_u32 m0, s48, 4096
    s_nop 0
    buffer_load_dwordx4 v82, s[32:35], s46 offen nt lds
    s_add_u32 s46, s47, 0x40000
    s_add_u32 m0, s48, 8192
    s_nop 0
    buffer_load_dwordx4 v82, s[32:35], s46 offen nt lds
    s_add_u32 s46, s47, 0x60000
    s_add_u32 m0, s48, 12288
    s_nop 0
    buffer_load_dwordx4 v82, s[32:35], s46 offen nt lds
    ds_read_b64_tr_b16 v[100:101], v74 offset:16384
    ds_read_b64_tr_b16 v[102:103], v74 offset:16640
    ds_read_b64_tr_b16 v[108:109], v75 offset:16384
    ds_read_b64_tr_b16 v[110:111], v75 offset:16640
    ds_read_b64_tr_b16 v[116:117], v76 offset:16384
    ds_read_b64_tr_b16 v[118:119], v76 offset:16640
    ds_read_b64_tr_b16 v[124:125], v77 offset:16384
    ds_read_b64_tr_b16 v[126:127], v77 offset:16640
L_lw_68:
    s_waitcnt lgkmcnt(0)
    s_cmp_lg_u32 s44, 0
    s_cbranch_scc1 L_v_probe_69
    s_add_u32 s45, s63, 8576
    s_memtime s[72:73]
    s_waitcnt lgkmcnt(0)
    s_load_dword s78, s[20:21], s45
    s_waitcnt lgkmcnt(0)
    s_memtime s[74:75]
    s_waitcnt lgkmcnt(0)
    s_sub_u32 s45, s74, s72
    s_min_u32 s77, s77, s45
    s_cmp_lt_u32 s77, s76
    s_cselect_b32 s68, 1, 0
L_v_probe_69:
    s_waitcnt vmcnt(32)
    s_barrier
    s_add_u32 s46, s47, 0x80000
    s_add_u32 m0, s48, 16384
    s_nop 0
    buffer_load_dwordx4 v82, s[32:35], s46 offen nt lds
    s_add_u32 s46, s47, 0xa0000
    s_add_u32 m0, s48, 20480
    s_nop 0
    buffer_load_dwordx4 v82, s[32:35], s46 offen nt lds
    s_add_u32 s46, s47, 0xc0000
    s_add_u32 m0, s48, 24576
    s_nop 0
    buffer_load_dwordx4 v82, s[32:35], s46 offen nt lds
    s_add_u32 s46, s47, 0xe0000
    s_add_u32 m0, s48, 28672
    s_nop 0
    buffer_load_dwordx4 v82, s[32:35], s46 offen nt lds
    ds_read_b64_tr_b16 v[128:129], v74 offset:32768
    ds_read_b64_tr_b16 v[130:131], v74 offset:33024
    ds_read_b64_tr_b16 v[136:137], v75 offset:32768
    ds_read_b64_tr_b16 v[138:139], v75 offset:33024
    ds_read_b64_tr_b16 v[144:145], v76 offset:32768
    ds_read_b64_tr_b16 v[146:147], v76 offset:33024
    ds_read_b64_tr_b16 v[152:153], v77 offset:32768
    ds_read_b64_tr_b16 v[154:155], v77 offset:33024
L_lw_70:
    s_waitcnt lgkmcnt(0)
    s_cmp_lg_u32 s44, 0
    s_cbranch_scc1 L_v_probe_71
    s_add_u32 s45, s63, 512
    s_memtime s[72:73]
    s_waitcnt lgkmcnt(0)
    s_load_dword s78, s[20:21], s45
    s_waitcnt lgkmcnt(0)
    s_memtime s[74:75]
    s_waitcnt lgkmcnt(0)
    s_sub_u32 s45, s74, s72
    s_min_u32 s76, s76, s45
    s_cmp_lt_u32 s77, s76
    s_cselect_b32 s68, 1, 0
L_v_probe_71:
    s_waitcnt vmcnt(32)
    s_barrier
    s_add_u32 s46, s47, 0x100000
    s_add_u32 m0, s48, 32768
    s_nop 0
    buffer_load_dwordx4 v82, s[32:35], s46 offen nt lds
    s_add_u32 s46, s47, 0x120000
    s_add_u32 m0, s48, 36864
    s_nop 0
    buffer_load_dwordx4 v82, s[32:35], s46 offen nt lds
    s_add_u32 s46, s47, 0x140000
    s_add_u32 m0, s48, 40960
    s_nop 0
    buffer_load_dwordx4 v82, s[32:35], s46 offen nt lds
    s_add_u32 s46, s47, 0x160000
    s_add_u32 m0, s48, 45056
    s_nop 0
    buffer_load_dwordx4 v82, s[32:35], s46 offen nt lds
    ds_read_b64_tr_b16 v[132:133], v74 offset:49152
    ds_read_b64_tr_b16 v[134:135], v74 offset:49408
    ds_read_b64_tr_b16 v[140:141], v75 offset:49152
    ds_read_b64_tr_b16 v[142:143], v75 offset:49408
    ds_read_b64_tr_b16 v[148:149], v76 offset:49152
    ds_read_b64_tr_b16 v[150:151], v76 offset:49408
    ds_read_b64_tr_b16 v[156:157], v77 offset:49152
    ds_read_b64_tr_b16 v[158:159], v77 offset:49408
L_lw_72:
    s_waitcnt lgkmcnt(0)
    s_cmp_lg_u32 s44, 0
    s_cbranch_scc1 L_v_probe_73
    s_add_u32 s45, s63, 8704
    s_memtime s[72:73]
    s_waitcnt lgkmcnt(0)
    s_load_dword s78, s[20:21], s45
    s_waitcnt lgkmcnt(0)
    s_memtime s[74:75]
    s_waitcnt lgkmcnt(0)
    s_sub_u32 s45, s74, s72
    s_min_u32 s77, s77, s45
    s_cmp_lt_u32 s77, s76
    s_cselect_b32 s68, 1, 0
L_v_probe_73:
    s_waitcnt vmcnt(32)
    s_barrier
    s_add_u32 s46, s47, 0x180000
    s_add_u32 m0, s48, 49152
    s_nop 0
    buffer_load_dwordx4 v82, s[32:35], s46 offen nt lds
    s_add_u32 s46, s47, 0x1a0000
    s_add_u32 m0, s48, 53248
    s_nop 0
    buffer_load_dwordx4 v82, s[32:35], s46 offen nt lds
    s_add_u32 s46, s47, 0x1c0000
    s_add_u32 m0, s48, 57344
    s_nop 0
    buffer_load_dwordx4 v82, s[32:35], s46 offen nt lds
    s_add_u32 s46, s47, 0x1e0000
    s_add_u32 m0, s48, 61440
    s_nop 0
    buffer_load_dwordx4 v82, s[32:35], s46 offen nt lds
    ds_read_b64_tr_b16 v[160:161], v88 offset:0
    ds_read_b64_tr_b16 v[162:163], v88 offset:256
    ds_read_b64_tr_b16 v[168:169], v89 offset:0
    ds_read_b64_tr_b16 v[170:171], v89 offset:256
    ds_read_b64_tr_b16 v[176:177], v90 offset:0
    ds_read_b64_tr_b16 v[178:179], v90 offset:256
    ds_read_b64_tr_b16 v[184:185], v91 offset:0
    ds_read_b64_tr_b16 v[186:187], v91 offset:256
L_lw_74:
    s_waitcnt lgkmcnt(0)
    s_waitcnt vmcnt(32)
    s_barrier
    s_cmp_lg_u32 s44, 0
    s_cbranch_scc1 L_hs_75
    s_getreg_b32 s45, hwreg(HW_REG_XCC_ID)
    s_and_b32 s45, s45, 15
    s_lshl_b32 s45, 1, s45
    v_mov_b32 v40, s45
    s_lshl_b32 s46, s40, 2
    s_add_u32 s46, s46, 4
    v_mov_b32 v41, 0
    v_mov_b32 v43, s68
    s_mov_b64 exec, 1
    buffer_atomic_or v40, v41, s[16:19], s46 offen sc1
    buffer_atomic_add v43, v41, s[16:19], 0 offen offset:12 sc1
    s_mov_b64 exec, -1
L_hs_75:
    ds_read_b64_tr_b16 v[164:165], v88 offset:4096
    ds_read_b64_tr_b16 v[166:167], v88 offset:4352
    ds_read_b64_tr_b16 v[172:173], v89 offset:4096
    ds_read_b64_tr_b16 v[174:175], v89 offset:4352
    ds_read_b64_tr_b16 v[180:181], v90 offset:4096
    ds_read_b64_tr_b16 v[182:183], v90 offset:4352
    ds_read_b64_tr_b16 v[188:189], v91 offset:4096
    ds_read_b64_tr_b16 v[190:191], v91 offset:4352
L_lw_76:
    s_waitcnt lgkmcnt(0)
    s_waitcnt vmcnt(28)
    s_barrier
    ds_read_b64_tr_b16 v[192:193], v88 offset:8192
    ds_read_b64_tr_b16 v[194:195], v88 offset:8448
    ds_read_b64_tr_b16 v[200:201], v89 offset:8192
    ds_read_b64_tr_b16 v[202:203], v89 offset:8448
    ds_read_b64_tr_b16 v[208:209], v90 offset:8192
    ds_read_b64_tr_b16 v[210:211], v90 offset:8448
    ds_read_b64_tr_b16 v[216:217], v91 offset:8192
    ds_read_b64_tr_b16 v[218:219], v91 offset:8448
L_lw_77:
    s_waitcnt lgkmcnt(0)
    s_waitcnt vmcnt(24)
    s_barrier
    ds_read_b64_tr_b16 v[196:197], v88 offset:12288
    ds_read_b64_tr_b16 v[198:199], v88 offset:12544
    ds_read_b64_tr_b16 v[204:205], v89 offset:12288
    ds_read_b64_tr_b16 v[206:207], v89 offset:12544
    ds_read_b64_tr_b16 v[212:213], v90 offset:12288
    ds_read_b64_tr_b16 v[214:215], v90 offset:12544
    ds_read_b64_tr_b16 v[220:221], v91 offset:12288
    ds_read_b64_tr_b16 v[222:223], v91 offset:12544
L_lw_78:
    s_waitcnt lgkmcnt(0)
    s_waitcnt vmcnt(20)
    s_barrier
    ds_read_b64_tr_b16 v[224:225], v88 offset:16384
    ds_read_b64_tr_b16 v[226:227], v88 offset:16640
    ds_read_b64_tr_b16 v[232:233], v89 offset:16384
    ds_read_b64_tr_b16 v[234:235], v89 offset:16640
    ds_read_b64_tr_b16 v[240:241], v90 offset:16384
    ds_read_b64_tr_b16 v[242:243], v90 offset:16640
    ds_read_b64_tr_b16 v[248:249], v91 offset:16384
    ds_read_b64_tr_b16 v[250:251], v91 offset:16640
L_lw_79:
    s_waitcnt lgkmcnt(0)
    s_waitcnt vmcnt(16)
    s_barrier
    ds_read_b64_tr_b16 v[228:229], v88 offset:20480
    ds_read_b64_tr_b16 v[230:231], v88 offset:20736
    ds_read_b64_tr_b16 v[236:237], v89 offset:20480
    ds_read_b64_tr_b16 v[238:239], v89 offset:20736
    ds_read_b64_tr_b16 v[244:245], v90 offset:20480
    ds_read_b64_tr_b16 v[246:247], v90 offset:20736
    ds_read_b64_tr_b16 v[252:253], v91 offset:20480
    ds_read_b64_tr_b16 v[254:255], v91 offset:20736
L_lw_80:
    s_waitcnt lgkmcnt(0)
    s_waitcnt vmcnt(12)
    s_barrier
    s_cmp_lg_u32 s44, 0
    s_cbranch_scc1 L_lw_81_0
    ds_read_b64_tr_b16 a[0:1], v80 offset:0
    ds_read_b64_tr_b16 a[2:3], v80 offset:1024
    ds_read_b64_tr_b16 a[4:5], v80 offset:8192
    ds_read_b64_tr_b16 a[6:7], v80 offset:9216
    ds_read_b64_tr_b16 a[8:9], v81 offset:0
    ds_read_b64_tr_b16 a[10:11], v81 offset:1024
    ds_read_b64_tr_b16 a[12:13], v81 offset:8192
    ds_read_b64_tr_b16 a[14:15], v81 offset:9216
    s_branch L_lw_81
L_lw_81_0:
    s_cmp_lg_u32 s44, 1
    s_cbranch_scc1 L_lw_81_1
    ds_read_b64_tr_b16 a[120:121], v80 offset:0
    ds_read_b64_tr_b16 a[122:123], v80 offset:1024
    ds_read_b64_tr_b16 a[124:125], v80 offset:8192
    ds_read_b64_tr_b16 a[126:127], v80 offset:9216
    ds_read_b64_tr_b16 v[56:57], v81 offset:0
    ds_read_b64_tr_b16 v[58:59], v81 offset:1024
    ds_read_b64_tr_b16 v[60:61], v81 offset:8192
    ds_read_b64_tr_b16 v[62:63], v81 offset:9216
    s_waitcnt lgkmcnt(0)
    ds_write_b128 v5, v[56:59] offset:0
    ds_write_b128 v5, v[60:63] offset:1024
    s_branch L_lw_81
L_lw_81_1:
    s_cmp_lg_u32 s44, 2
    s_cbranch_scc1 L_lw_81_2
    ds_read_b64_tr_b16 a[80:81], v80 offset:0
    ds_read_b64_tr_b16 a[82:83], v80 offset:1024
    ds_read_b64_tr_b16 a[84:85], v80 offset:8192
    ds_read_b64_tr_b16 a[86:87], v80 offset:9216
    ds_read_b64_tr_b16 v[56:57], v81 offset:0
    ds_read_b64_tr_b16 v[58:59], v81 offset:1024
    ds_read_b64_tr_b16 v[60:61], v81 offset:8192
    ds_read_b64_tr_b16 v[62:63], v81 offset:9216
    s_waitcnt lgkmcnt(0)
    ds_write_b128 v5, v[56:59] offset:2048
    ds_write_b128 v5, v[60:63] offset:3072
    s_branch L_lw_81
L_lw_81_2:
    ds_read_b64_tr_b16 a[48:49], v80 offset:0
    ds_read_b64_tr_b16 a[50:51], v80 offset:1024
    ds_read_b64_tr_b16 a[52:53], v80 offset:8192
    ds_read_b64_tr_b16 a[54:55], v80 offset:9216
    ds_read_b64_tr_b16 v[56:57], v81 offset:0
    ds_read_b64_tr_b16 v[58:59], v81 offset:1024
    ds_read_b64_tr_b16 v[60:61], v81 offset:8192
    ds_read_b64_tr_b16 v[62:63], v81 offset:9216
    s_waitcnt lgkmcnt(0)
    ds_write_b128 v5, v[56:59] offset:4096
    ds_write_b128 v5, v[60:63] offset:5120
L_lw_81:
    s_waitcnt lgkmcnt(0)
    s_waitcnt vmcnt(8)
    s_barrier
    s_add_u32 s46, s47, 0x200000
    s_add_u32 m0, s48, 0
    s_nop 0
    buffer_load_dwordx4 v82, s[32:35], s46 offen nt lds
    s_add_u32 s46, s47, 0x220000
    s_add_u32 m0, s48, 4096
    s_nop 0
    buffer_load_dwordx4 v82, s[32:35], s46 offen nt lds
    s_add_u32 s46, s47, 0x240000
    s_add_u32 m0, s48, 8192
    s_nop 0
    buffer_load_dwordx4 v82, s[32:35], s46 offen nt lds
    s_add_u32 s46, s47, 0x260000
    s_add_u32 m0, s48, 12288
    s_nop 0
    buffer_load_dwordx4 v82, s[32:35], s46 offen nt lds
    s_cmp_lg_u32 s44, 0
    s_cbranch_scc1 L_lw_82_0
    ds_read_b64_tr_b16 a[16:17], v80 offset:16384
    ds_read_b64_tr_b16 a[18:19], v80 offset:17408
    ds_read_b64_tr_b16 a[20:21], v80 offset:24576
    ds_read_b64_tr_b16 a[22:23], v80 offset:25600
    ds_read_b64_tr_b16 a[24:25], v81 offset:16384
    ds_read_b64_tr_b16 a[26:27], v81 offset:17408
    ds_read_b64_tr_b16 a[28:29], v81 offset:24576
    ds_read_b64_tr_b16 a[30:31], v81 offset:25600
    s_branch L_lw_82
L_lw_82_0:
    s_cmp_lg_u32 s44, 1
    s_cbranch_scc1 L_lw_82_1
    ds_read_b64_tr_b16 a[128:129], v80 offset:16384
    ds_read_b64_tr_b16 a[130:131], v80 offset:17408
    ds_read_b64_tr_b16 a[132:133], v80 offset:24576
    ds_read_b64_tr_b16 a[134:135], v80 offset:25600
    ds_read_b64_tr_b16 a[136:137], v81 offset:16384
    ds_read_b64_tr_b16 a[138:139], v81 offset:17408
    ds_read_b64_tr_b16 a[140:141], v81 offset:24576
    ds_read_b64_tr_b16 a[142:143], v81 offset:25600
    s_branch L_lw_82
L_lw_82_1:
    s_cmp_lg_u32 s44, 2
    s_cbranch_scc1 L_lw_82_2
    ds_read_b64_tr_b16 a[88:89], v80 offset:16384
    ds_read_b64_tr_b16 a[90:91], v80 offset:17408
    ds_read_b64_tr_b16 a[92:93], v80 offset:24576
    ds_read_b64_tr_b16 a[94:95], v80 offset:25600
    ds_read_b64_tr_b16 a[96:97], v81 offset:16384
    ds_read_b64_tr_b16 a[98:99], v81 offset:17408
    ds_read_b64_tr_b16 a[100:101], v81 offset:24576
    ds_read_b64_tr_b16 a[102:103], v81 offset:25600
    s_branch L_lw_82
L_lw_82_2:
    ds_read_b64_tr_b16 a[56:57], v80 offset:16384
    ds_read_b64_tr_b16 a[58:59], v80 offset:17408
    ds_read_b64_tr_b16 a[60:61], v80 offset:24576
    ds_read_b64_tr_b16 a[62:63], v80 offset:25600
    ds_read_b64_tr_b16 v[56:57], v81 offset:16384
    ds_read_b64_tr_b16 v[58:59], v81 offset:17408
    ds_read_b64_tr_b16 v[60:61], v81 offset:24576
    ds_read_b64_tr_b16 v[62:63], v81 offset:25600
    s_waitcnt lgkmcnt(0)
    ds_write_b128 v5, v[56:59] offset:6144
    ds_write_b128 v5, v[60:63] offset:7168
L_lw_82:
    s_waitcnt lgkmcnt(0)
    s_waitcnt vmcnt(8)
    s_barrier
    s_add_u32 s46, s47, 0x280000
    s_add_u32 m0, s48, 16384
    s_nop 0
    buffer_load_dwordx4 v82, s[32:35], s46 offen nt lds
    s_add_u32 s46, s47, 0x2a0000
    s_add_u32 m0, s48, 20480
    s_nop 0
    buffer_load_dwordx4 v82, s[32:35], s46 offen nt lds
    s_add_u32 s46, s47, 0x2c0000
    s_add_u32 m0, s48, 24576
    s_nop 0
    buffer_load_dwordx4 v82, s[32:35], s46 offen nt lds
    s_add_u32 s46, s47, 0x2e0000
    s_add_u32 m0, s48, 28672
    s_nop 0
    buffer_load_dwordx4 v82, s[32:35], s46 offen nt lds
    s_cmp_lg_u32 s44, 0
    s_cbranch_scc1 L_lw_83_0
    ds_read_b64_tr_b16 a[32:33], v80 offset:32768
    ds_read_b64_tr_b16 a[34:35], v80 offset:33792
    ds_read_b64_tr_b16 a[36:37], v80 offset:40960
    ds_read_b64_tr_b16 a[38:39], v80 offset:41984
    ds_read_b64_tr_b16 v[56:57], v81 offset:32768
    ds_read_b64_tr_b16 v[58:59], v81 offset:33792
    ds_read_b64_tr_b16 v[60:61], v81 offset:40960
    ds_read_b64_tr_b16 v[62:63], v81 offset:41984
    s_waitcnt lgkmcnt(0)
    ds_write_b128 v5, v[56:59] offset:8192
    ds_write_b128 v5, v[60:63] offset:9216
    s_branch L_lw_83
L_lw_83_0:
    s_cmp_lg_u32 s44, 1
    s_cbranch_scc1 L_lw_83_1
    ds_read_b64_tr_b16 a[144:145], v80 offset:32768
    ds_read_b64_tr_b16 a[146:147], v80 offset:33792
    ds_read_b64_tr_b16 a[148:149], v80 offset:40960
    ds_read_b64_tr_b16 a[150:151], v80 offset:41984
    ds_read_b64_tr_b16 v[56:57], v81 offset:32768
    ds_read_b64_tr_b16 v[58:59], v81 offset:33792
    ds_read_b64_tr_b16 v[60:61], v81 offset:40960
    ds_read_b64_tr_b16 v[62:63], v81 offset:41984
    s_waitcnt lgkmcnt(0)
    ds_write_b128 v5, v[56:59] offset:10240
    ds_write_b128 v5, v[60:63] offset:11264
    s_branch L_lw_83
L_lw_83_1:
    s_cmp_lg_u32 s44, 2
    s_cbranch_scc1 L_lw_83_2
    ds_read_b64_tr_b16 a[104:105], v80 offset:32768
    ds_read_b64_tr_b16 a[106:107], v80 offset:33792
    ds_read_b64_tr_b16 a[108:109], v80 offset:40960
    ds_read_b64_tr_b16 a[110:111], v80 offset:41984
    ds_read_b64_tr_b16 v[56:57], v81 offset:32768
    ds_read_b64_tr_b16 v[58:59], v81 offset:33792
    ds_read_b64_tr_b16 v[60:61], v81 offset:40960
    ds_read_b64_tr_b16 v[62:63], v81 offset:41984
    s_waitcnt lgkmcnt(0)
    ds_write_b128 v5, v[56:59] offset:12288
    ds_write_b128 v5, v[60:63] offset:13312
    s_branch L_lw_83
L_lw_83_2:
    ds_read_b64_tr_b16 a[64:65], v80 offset:32768
    ds_read_b64_tr_b16 a[66:67], v80 offset:33792
    ds_read_b64_tr_b16 a[68:69], v80 offset:40960
    ds_read_b64_tr_b16 a[70:71], v80 offset:41984
    ds_read_b64_tr_b16 v[56:57], v81 offset:32768
    ds_read_b64_tr_b16 v[58:59], v81 offset:33792
    ds_read_b64_tr_b16 v[60:61], v81 offset:40960
    ds_read_b64_tr_b16 v[62:63], v81 offset:41984
    s_waitcnt lgkmcnt(0)
    ds_write_b128 v5, v[56:59] offset:14336
    ds_write_b128 v5, v[60:63] offset:15360
L_lw_83:
    s_waitcnt lgkmcnt(0)
    s_waitcnt vmcnt(8)
    s_barrier
    s_add_u32 s46, s47, 0x300000
    s_add_u32 m0, s48, 32768
    s_nop 0
    buffer_load_dwordx4 v82, s[32:35], s46 offen nt lds
    s_add_u32 s46, s47, 0x320000
    s_add_u32 m0, s48, 36864
    s_nop 0
    buffer_load_dwordx4 v82, s[32:35], s46 offen nt lds
    s_add_u32 s46, s47, 0x340000
    s_add_u32 m0, s48, 40960
    s_nop 0
    buffer_load_dwordx4 v82, s[32:35], s46 offen nt lds
    s_add_u32 s46, s47, 0x360000
    s_add_u32 m0, s48, 45056
    s_nop 0
    buffer_load_dwordx4 v82, s[32:35], s46 offen nt lds
    s_cmp_lg_u32 s44, 0
    s_cbranch_scc1 L_lw_84_0
    ds_read_b64_tr_b16 a[40:41], v80 offset:49152
    ds_read_b64_tr_b16 a[42:43], v80 offset:50176
    ds_read_b64_tr_b16 a[44:45], v80 offset:57344
    ds_read_b64_tr_b16 a[46:47], v80 offset:58368
    ds_read_b64_tr_b16 v[56:57], v81 offset:49152
    ds_read_b64_tr_b16 v[58:59], v81 offset:50176
    ds_read_b64_tr_b16 v[60:61], v81 offset:57344
    ds_read_b64_tr_b16 v[62:63], v81 offset:58368
    s_waitcnt lgkmcnt(0)
    ds_write_b128 v5, v[56:59] offset:16384
    ds_write_b128 v5, v[60:63] offset:17408
    s_branch L_lw_84
L_lw_84_0:
    s_cmp_lg_u32 s44, 1
    s_cbranch_scc1 L_lw_84_1
    ds_read_b64_tr_b16 a[152:153], v80 offset:49152
    ds_read_b64_tr_b16 a[154:155], v80 offset:50176
    ds_read_b64_tr_b16 a[156:157], v80 offset:57344
    ds_read_b64_tr_b16 a[158:159], v80 offset:58368
    ds_read_b64_tr_b16 v[56:57], v81 offset:49152
    ds_read_b64_tr_b16 v[58:59], v81 offset:50176
    ds_read_b64_tr_b16 v[60:61], v81 offset:57344
    ds_read_b64_tr_b16 v[62:63], v81 offset:58368
    s_waitcnt lgkmcnt(0)
    ds_write_b128 v5, v[56:59] offset:18432
    ds_write_b128 v5, v[60:63] offset:19456
    s_branch L_lw_84
L_lw_84_1:
    s_cmp_lg_u32 s44, 2
    s_cbranch_scc1 L_lw_84_2
    ds_read_b64_tr_b16 a[112:113], v80 offset:49152
    ds_read_b64_tr_b16 a[114:115], v80 offset:50176
    ds_read_b64_tr_b16 a[116:117], v80 offset:57344
    ds_read_b64_tr_b16 a[118:119], v80 offset:58368
    ds_read_b64_tr_b16 v[56:57], v81 offset:49152
    ds_read_b64_tr_b16 v[58:59], v81 offset:50176
    ds_read_b64_tr_b16 v[60:61], v81 offset:57344
    ds_read_b64_tr_b16 v[62:63], v81 offset:58368
    s_waitcnt lgkmcnt(0)
    ds_write_b128 v5, v[56:59] offset:20480
    ds_write_b128 v5, v[60:63] offset:21504
    s_branch L_lw_84
L_lw_84_2:
    ds_read_b64_tr_b16 a[72:73], v80 offset:49152
    ds_read_b64_tr_b16 a[74:75], v80 offset:50176
    ds_read_b64_tr_b16 a[76:77], v80 offset:57344
    ds_read_b64_tr_b16 a[78:79], v80 offset:58368
    ds_read_b64_tr_b16 v[56:57], v81 offset:49152
    ds_read_b64_tr_b16 v[58:59], v81 offset:50176
    ds_read_b64_tr_b16 v[60:61], v81 offset:57344
    ds_read_b64_tr_b16 v[62:63], v81 offset:58368
    s_waitcnt lgkmcnt(0)
    ds_write_b128 v5, v[56:59] offset:22528
    ds_write_b128 v5, v[60:63] offset:23552
L_lw_84:
    s_waitcnt lgkmcnt(0)
    s_waitcnt vmcnt(8)
    s_barrier
    s_add_u32 s46, s47, 0x380000
    s_add_u32 m0, s48, 49152
    s_nop 0
    buffer_load_dwordx4 v82, s[32:35], s46 offen nt lds
    s_add_u32 s46, s47, 0x3a0000
    s_add_u32 m0, s48, 53248
    s_nop 0
    buffer_load_dwordx4 v82, s[32:35], s46 offen nt lds
    s_add_u32 s46, s47, 0x3c0000
    s_add_u32 m0, s48, 57344
    s_nop 0
    buffer_load_dwordx4 v82, s[32:35], s46 offen nt lds
    s_add_u32 s46, s47, 0x3e0000
    s_add_u32 m0, s48, 61440
    s_nop 0
    buffer_load_dwordx4 v82, s[32:35], s46 offen nt lds
    s_cmp_lg_u32 s44, 0
    s_cbranch_scc1 L_lw_85_0
    ds_read_b64_tr_b16 a[48:49], v80 offset:0
    ds_read_b64_tr_b16 a[50:51], v80 offset:1024
    ds_read_b64_tr_b16 a[52:53], v80 offset:8192
    ds_read_b64_tr_b16 a[54:55], v80 offset:9216
    ds_read_b64_tr_b16 v[56:57], v81 offset:0
    ds_read_b64_tr_b16 v[58:59], v81 offset:1024
    ds_read_b64_tr_b16 v[60:61], v81 offset:8192
    ds_read_b64_tr_b16 v[62:63], v81 offset:9216
    s_waitcnt lgkmcnt(0)
    ds_write_b128 v5, v[56:59] offset:4096
    ds_write_b128 v5, v[60:63] offset:5120
    s_branch L_lw_85
L_lw_85_0:
    s_cmp_lg_u32 s44, 1
    s_cbranch_scc1 L_lw_85_1
    ds_read_b64_tr_b16 a[0:1], v80 offset:0
    ds_read_b64_tr_b16 a[2:3], v80 offset:1024
    ds_read_b64_tr_b16 a[4:5], v80 offset:8192
    ds_read_b64_tr_b16 a[6:7], v80 offset:9216
    ds_read_b64_tr_b16 a[8:9], v81 offset:0
    ds_read_b64_tr_b16 a[10:11], v81 offset:1024
    ds_read_b64_tr_b16 a[12:13], v81 offset:8192
    ds_read_b64_tr_b16 a[14:15], v81 offset:9216
    s_branch L_lw_85
L_lw_85_1:
    s_cmp_lg_u32 s44, 2
    s_cbranch_scc1 L_lw_85_2
    ds_read_b64_tr_b16 a[120:121], v80 offset:0
    ds_read_b64_tr_b16 a[122:123], v80 offset:1024
    ds_read_b64_tr_b16 a[124:125], v80 offset:8192
    ds_read_b64_tr_b16 a[126:127], v80 offset:9216
    ds_read_b64_tr_b16 v[56:57], v81 offset:0
    ds_read_b64_tr_b16 v[58:59], v81 offset:1024
    ds_read_b64_tr_b16 v[60:61], v81 offset:8192
    ds_read_b64_tr_b16 v[62:63], v81 offset:9216
    s_waitcnt lgkmcnt(0)
    ds_write_b128 v5, v[56:59] offset:0
    ds_write_b128 v5, v[60:63] offset:1024
    s_branch L_lw_85
L_lw_85_2:
    ds_read_b64_tr_b16 a[80:81], v80 offset:0
    ds_read_b64_tr_b16 a[82:83], v80 offset:1024
    ds_read_b64_tr_b16 a[84:85], v80 offset:8192
    ds_read_b64_tr_b16 a[86:87], v80 offset:9216
    ds_read_b64_tr_b16 v[56:57], v81 offset:0
    ds_read_b64_tr_b16 v[58:59], v81 offset:1024
    ds_read_b64_tr_b16 v[60:61], v81 offset:8192
    ds_read_b64_tr_b16 v[62:63], v81 offset:9216
    s_waitcnt lgkmcnt(0)
    ds_write_b128 v5, v[56:59] offset:2048
    ds_write_b128 v5, v[60:63] offset:3072
L_lw_85:
    s_waitcnt lgkmcnt(0)
    s_waitcnt vmcnt(8)
    s_barrier
    s_add_u32 s46, s47, 0x400000
    s_add_u32 m0, s48, 0
    s_nop 0
    buffer_load_dwordx4 v82, s[32:35], s46 offen nt lds
    s_add_u32 s46, s47, 0x420000
    s_add_u32 m0, s48, 4096
    s_nop 0
    buffer_load_dwordx4 v82, s[32:35], s46 offen nt lds
    s_add_u32 s46, s47, 0x440000
    s_add_u32 m0, s48, 8192
    s_nop 0
    buffer_load_dwordx4 v82, s[32:35], s46 offen nt lds
    s_add_u32 s46, s47, 0x460000
    s_add_u32 m0, s48, 12288
    s_nop 0
    buffer_load_dwordx4 v82, s[32:35], s46 offen nt lds
    s_cmp_lg_u32 s44, 0
    s_cbranch_scc1 L_lw_86_0
    ds_read_b64_tr_b16 a[56:57], v80 offset:16384
    ds_read_b64_tr_b16 a[58:59], v80 offset:17408
    ds_read_b64_tr_b16 a[60:61], v80 offset:24576
    ds_read_b64_tr_b16 a[62:63], v80 offset:25600
    ds_read_b64_tr_b16 v[56:57], v81 offset:16384
    ds_read_b64_tr_b16 v[58:59], v81 offset:17408
    ds_read_b64_tr_b16 v[60:61], v81 offset:24576
    ds_read_b64_tr_b16 v[62:63], v81 offset:25600
    s_waitcnt lgkmcnt(0)
    ds_write_b128 v5, v[56:59] offset:6144
    ds_write_b128 v5, v[60:63] offset:7168
    s_branch L_lw_86
L_lw_86_0:
    s_cmp_lg_u32 s44, 1
    s_cbranch_scc1 L_lw_86_1
    ds_read_b64_tr_b16 a[16:17], v80 offset:16384
    ds_read_b64_tr_b16 a[18:19], v80 offset:17408
    ds_read_b64_tr_b16 a[20:21], v80 offset:24576
    ds_read_b64_tr_b16 a[22:23], v80 offset:25600
    ds_read_b64_tr_b16 a[24:25], v81 offset:16384
    ds_read_b64_tr_b16 a[26:27], v81 offset:17408
    ds_read_b64_tr_b16 a[28:29], v81 offset:24576
    ds_read_b64_tr_b16 a[30:31], v81 offset:25600
    s_branch L_lw_86
L_lw_86_1:
    s_cmp_lg_u32 s44, 2
    s_cbranch_scc1 L_lw_86_2
    ds_read_b64_tr_b16 a[128:129], v80 offset:16384
    ds_read_b64_tr_b16 a[130:131], v80 offset:17408
    ds_read_b64_tr_b16 a[132:133], v80 offset:24576
    ds_read_b64_tr_b16 a[134:135], v80 offset:25600
    ds_read_b64_tr_b16 a[136:137], v81 offset:16384
    ds_read_b64_tr_b16 a[138:139], v81 offset:17408
    ds_read_b64_tr_b16 a[140:141], v81 offset:24576
    ds_read_b64_tr_b16 a[142:143], v81 offset:25600
    s_branch L_lw_86
L_lw_86_2:
    ds_read_b64_tr_b16 a[88:89], v80 offset:16384
    ds_read_b64_tr_b16 a[90:91], v80 offset:17408
    ds_read_b64_tr_b16 a[92:93], v80 offset:24576
    ds_read_b64_tr_b16 a[94:95], v80 offset:25600
    ds_read_b64_tr_b16 a[96:97], v81 offset:16384
    ds_read_b64_tr_b16 a[98:99], v81 offset:17408
    ds_read_b64_tr_b16 a[100:101], v81 offset:24576
    ds_read_b64_tr_b16 a[102:103], v81 offset:25600
L_lw_86:
    s_waitcnt lgkmcnt(0)
    s_waitcnt vmcnt(8)
    s_barrier
    s_add_u32 s46, s47, 0x480000
    s_add_u32 m0, s48, 16384
    s_nop 0
    buffer_load_dwordx4 v82, s[32:35], s46 offen nt lds
    s_add_u32 s46, s47, 0x4a0000
    s_add_u32 m0, s48, 20480
    s_nop 0
    buffer_load_dwordx4 v82, s[32:35], s46 offen nt lds
    s_add_u32 s46, s47, 0x4c0000
    s_add_u32 m0, s48, 24576
    s_nop 0
    buffer_load_dwordx4 v82, s[32:35], s46 offen nt lds
    s_add_u32 s46, s47, 0x4e0000
    s_add_u32 m0, s48, 28672
    s_nop 0
    buffer_load_dwordx4 v82, s[32:35], s46 offen nt lds
    s_cmp_lg_u32 s44, 0
    s_cbranch_scc1 L_lw_87_0
    ds_read_b64_tr_b16 a[64:65], v80 offset:32768
    ds_read_b64_tr_b16 a[66:67], v80 offset:33792
    ds_read_b64_tr_b16 a[68:69], v80 offset:40960
    ds_read_b64_tr_b16 a[70:71], v80 offset:41984
    ds_read_b64_tr_b16 v[56:57], v81 offset:32768
    ds_read_b64_tr_b16 v[58:59], v81 offset:33792
    ds_read_b64_tr_b16 v[60:61], v81 offset:40960
    ds_read_b64_tr_b16 v[62:63], v81 offset:41984
    s_waitcnt lgkmcnt(0)
    ds_write_b128 v5, v[56:59] offset:14336
    ds_write_b128 v5, v[60:63] offset:15360
    s_branch L_lw_87
L_lw_87_0:
    s_cmp_lg_u32 s44, 1
    s_cbranch_scc1 L_lw_87_1
    ds_read_b64_tr_b16 a[32:33], v80 offset:32768
    ds_read_b64_tr_b16 a[34:35], v80 offset:33792
    ds_read_b64_tr_b16 a[36:37], v80 offset:40960
    ds_read_b64_tr_b16 a[38:39], v80 offset:41984
    ds_read_b64_tr_b16 v[56:57], v81 offset:32768
    ds_read_b64_tr_b16 v[58:59], v81 offset:33792
    ds_read_b64_tr_b16 v[60:61], v81 offset:40960
    ds_read_b64_tr_b16 v[62:63], v81 offset:41984
    s_waitcnt lgkmcnt(0)
    ds_write_b128 v5, v[56:59] offset:8192
    ds_write_b128 v5, v[60:63] offset:9216
    s_branch L_lw_87
L_lw_87_1:
    s_cmp_lg_u32 s44, 2
    s_cbranch_scc1 L_lw_87_2
    ds_read_b64_tr_b16 a[144:145], v80 offset:32768
    ds_read_b64_tr_b16 a[146:147], v80 offset:33792
    ds_read_b64_tr_b16 a[148:149], v80 offset:40960
    ds_read_b64_tr_b16 a[150:151], v80 offset:41984
    ds_read_b64_tr_b16 v[56:57], v81 offset:32768
    ds_read_b64_tr_b16 v[58:59], v81 offset:33792
    ds_read_b64_tr_b16 v[60:61], v81 offset:40960
    ds_read_b64_tr_b16 v[62:63], v81 offset:41984
    s_waitcnt lgkmcnt(0)
    ds_write_b128 v5, v[56:59] offset:10240
    ds_write_b128 v5, v[60:63] offset:11264
    s_branch L_lw_87
L_lw_87_2:
    ds_read_b64_tr_b16 a[104:105], v80 offset:32768
    ds_read_b64_tr_b16 a[106:107], v80 offset:33792
    ds_read_b64_tr_b16 a[108:109], v80 offset:40960
    ds_read_b64_tr_b16 a[110:111], v80 offset:41984
    ds_read_b64_tr_b16 v[56:57], v81 offset:32768
    ds_read_b64_tr_b16 v[58:59], v81 offset:33792
    ds_read_b64_tr_b16 v[60:61], v81 offset:40960
    ds_read_b64_tr_b16 v[62:63], v81 offset:41984
    s_waitcnt lgkmcnt(0)
    ds_write_b128 v5, v[56:59] offset:12288
    ds_write_b128 v5, v[60:63] offset:13312
L_lw_87:
    s_waitcnt lgkmcnt(0)
    s_waitcnt vmcnt(8)
    s_barrier
    s_add_u32 s46, s47, 0x500000
    s_add_u32 m0, s48, 32768
    s_nop 0
    buffer_load_dwordx4 v82, s[32:35], s46 offen nt lds
    s_add_u32 s46, s47, 0x520000
    s_add_u32 m0, s48, 36864
    s_nop 0
    buffer_load_dwordx4 v82, s[32:35], s46 offen nt lds
    s_add_u32 s46, s47, 0x540000
    s_add_u32 m0, s48, 40960
    s_nop 0
    buffer_load_dwordx4 v82, s[32:35], s46 offen nt lds
    s_add_u32 s46, s47, 0x560000
    s_add_u32 m0, s48, 45056
    s_nop 0
    buffer_load_dwordx4 v82, s[32:35], s46 offen nt lds
    s_cmp_lg_u32 s44, 0
    s_cbranch_scc1 L_hs_88
    v_mov_b32 v41, 0
    v_mov_b32 v42, 1
    s_mov_b64 exec, 1
    buffer_atomic_add v42, v41, s[16:19], 0 offen sc1
    s_mov_b64 exec, -1
L_hs_88:
    s_cmp_lg_u32 s44, 0
    s_cbranch_scc1 L_lw_89_0
    ds_read_b64_tr_b16 a[72:73], v80 offset:49152
    ds_read_b64_tr_b16 a[74:75], v80 offset:50176
    ds_read_b64_tr_b16 a[76:77], v80 offset:57344
    ds_read_b64_tr_b16 a[78:79], v80 offset:58368
    ds_read_b64_tr_b16 v[56:57], v81 offset:49152
    ds_read_b64_tr_b16 v[58:59], v81 offset:50176
    ds_read_b64_tr_b16 v[60:61], v81 offset:57344
    ds_read_b64_tr_b16 v[62:63], v81 offset:58368
    s_waitcnt lgkmcnt(0)
    ds_write_b128 v5, v[56:59] offset:22528
    ds_write_b128 v5, v[60:63] offset:23552
    s_branch L_lw_89
L_lw_89_0:
    s_cmp_lg_u32 s44, 1
    s_cbranch_scc1 L_lw_89_1
    ds_read_b64_tr_b16 a[40:41], v80 offset:49152
    ds_read_b64_tr_b16 a[42:43], v80 offset:50176
    ds_read_b64_tr_b16 a[44:45], v80 offset:57344
    ds_read_b64_tr_b16 a[46:47], v80 offset:58368
    ds_read_b64_tr_b16 v[56:57], v81 offset:49152
    ds_read_b64_tr_b16 v[58:59], v81 offset:50176
    ds_read_b64_tr_b16 v[60:61], v81 offset:57344
    ds_read_b64_tr_b16 v[62:63], v81 offset:58368
    s_waitcnt lgkmcnt(0)
    ds_write_b128 v5, v[56:59] offset:16384
    ds_write_b128 v5, v[60:63] offset:17408
    s_branch L_lw_89
L_lw_89_1:
    s_cmp_lg_u32 s44, 2
    s_cbranch_scc1 L_lw_89_2
    ds_read_b64_tr_b16 a[152:153], v80 offset:49152
    ds_read_b64_tr_b16 a[154:155], v80 offset:50176
    ds_read_b64_tr_b16 a[156:157], v80 offset:57344
    ds_read_b64_tr_b16 a[158:159], v80 offset:58368
    ds_read_b64_tr_b16 v[56:57], v81 offset:49152
    ds_read_b64_tr_b16 v[58:59], v81 offset:50176
    ds_read_b64_tr_b16 v[60:61], v81 offset:57344
    ds_read_b64_tr_b16 v[62:63], v81 offset:58368
    s_waitcnt lgkmcnt(0)
    ds_write_b128 v5, v[56:59] offset:18432
    ds_write_b128 v5, v[60:63] offset:19456
    s_branch L_lw_89
L_lw_89_2:
    ds_read_b64_tr_b16 a[112:113], v80 offset:49152
    ds_read_b64_tr_b16 a[114:115], v80 offset:50176
    ds_read_b64_tr_b16 a[116:117], v80 offset:57344
    ds_read_b64_tr_b16 a[118:119], v80 offset:58368
    ds_read_b64_tr_b16 v[56:57], v81 offset:49152
    ds_read_b64_tr_b16 v[58:59], v81 offset:50176
    ds_read_b64_tr_b16 v[60:61], v81 offset:57344
    ds_read_b64_tr_b16 v[62:63], v81 offset:58368
    s_waitcnt lgkmcnt(0)
    ds_write_b128 v5, v[56:59] offset:20480
    ds_write_b128 v5, v[60:63] offset:21504
L_lw_89:
    s_waitcnt lgkmcnt(0)
    s_waitcnt vmcnt(8)
    s_barrier
    s_add_u32 s46, s47, 0x580000
    s_add_u32 m0, s48, 49152
    s_nop 0
    buffer_load_dwordx4 v82, s[32:35], s46 offen nt lds
    s_add_u32 s46, s47, 0x5a0000
    s_add_u32 m0, s48, 53248
    s_nop 0
    buffer_load_dwordx4 v82, s[32:35], s46 offen nt lds
    s_add_u32 s46, s47, 0x5c0000
    s_add_u32 m0, s48, 57344
    s_nop 0
    buffer_load_dwordx4 v82, s[32:35], s46 offen nt lds
    s_add_u32 s46, s47, 0x5e0000
    s_add_u32 m0, s48, 61440
    s_nop 0
    buffer_load_dwordx4 v82, s[32:35], s46 offen nt lds
    s_cmp_lg_u32 s44, 0
    s_cbranch_scc1 L_lw_90_0
    ds_read_b64_tr_b16 a[80:81], v80 offset:0
    ds_read_b64_tr_b16 a[82:83], v80 offset:1024
    ds_read_b64_tr_b16 a[84:85], v80 offset:8192
    ds_read_b64_tr_b16 a[86:87], v80 offset:9216
    ds_read_b64_tr_b16 v[56:57], v81 offset:0
    ds_read_b64_tr_b16 v[58:59], v81 offset:1024
    ds_read_b64_tr_b16 v[60:61], v81 offset:8192
    ds_read_b64_tr_b16 v[62:63], v81 offset:9216
    s_waitcnt lgkmcnt(0)
    ds_write_b128 v5, v[56:59] offset:2048
    ds_write_b128 v5, v[60:63] offset:3072
    s_branch L_lw_90
L_lw_90_0:
    s_cmp_lg_u32 s44, 1
    s_cbranch_scc1 L_lw_90_1
    ds_read_b64_tr_b16 a[48:49], v80 offset:0
    ds_read_b64_tr_b16 a[50:51], v80 offset:1024
    ds_read_b64_tr_b16 a[52:53], v80 offset:8192
    ds_read_b64_tr_b16 a[54:55], v80 offset:9216
    ds_read_b64_tr_b16 v[56:57], v81 offset:0
    ds_read_b64_tr_b16 v[58:59], v81 offset:1024
    ds_read_b64_tr_b16 v[60:61], v81 offset:8192
    ds_read_b64_tr_b16 v[62:63], v81 offset:9216
    s_waitcnt lgkmcnt(0)
    ds_write_b128 v5, v[56:59] offset:4096
    ds_write_b128 v5, v[60:63] offset:5120
    s_branch L_lw_90
L_lw_90_1:
    s_cmp_lg_u32 s44, 2
    s_cbranch_scc1 L_lw_90_2
    ds_read_b64_tr_b16 a[0:1], v80 offset:0
    ds_read_b64_tr_b16 a[2:3], v80 offset:1024
    ds_read_b64_tr_b16 a[4:5], v80 offset:8192
    ds_read_b64_tr_b16 a[6:7], v80 offset:9216
    ds_read_b64_tr_b16 a[8:9], v81 offset:0
    ds_read_b64_tr_b16 a[10:11], v81 offset:1024
    ds_read_b64_tr_b16 a[12:13], v81 offset:8192
    ds_read_b64_tr_b16 a[14:15], v81 offset:9216
    s_branch L_lw_90
L_lw_90_2:
    ds_read_b64_tr_b16 a[120:121], v80 offset:0
    ds_read_b64_tr_b16 a[122:123], v80 offset:1024
    ds_read_b64_tr_b16 a[124:125], v80 offset:8192
    ds_read_b64_tr_b16 a[126:127], v80 offset:9216
    ds_read_b64_tr_b16 v[56:57], v81 offset:0
    ds_read_b64_tr_b16 v[58:59], v81 offset:1024
    ds_read_b64_tr_b16 v[60:61], v81 offset:8192
    ds_read_b64_tr_b16 v[62:63], v81 offset:9216
    s_waitcnt lgkmcnt(0)
    ds_write_b128 v5, v[56:59] offset:0
    ds_write_b128 v5, v[60:63] offset:1024
L_lw_90:
    s_waitcnt lgkmcnt(0)
    s_waitcnt vmcnt(8)
    s_barrier
    s_add_u32 s46, s47, 0x600000
    s_add_u32 m0, s48, 0
    s_nop 0
    buffer_load_dwordx4 v82, s[32:35], s46 offen nt lds
    s_add_u32 s46, s47, 0x620000
    s_add_u32 m0, s48, 4096
    s_nop 0
    buffer_load_dwordx4 v82, s[32:35], s46 offen nt lds
    s_add_u32 s46, s47, 0x640000
    s_add_u32 m0, s48, 8192
    s_nop 0
    buffer_load_dwordx4 v82, s[32:35], s46 offen nt lds
    s_add_u32 s46, s47, 0x660000
    s_add_u32 m0, s48, 12288
    s_nop 0
    buffer_load_dwordx4 v82, s[32:35], s46 offen nt lds
    s_cmp_lg_u32 s44, 0
    s_cbranch_scc1 L_lw_91_0
    ds_read_b64_tr_b16 a[88:89], v80 offset:16384
    ds_read_b64_tr_b16 a[90:91], v80 offset:17408
    ds_read_b64_tr_b16 a[92:93], v80 offset:24576
    ds_read_b64_tr_b16 a[94:95], v80 offset:25600
    ds_read_b64_tr_b16 a[96:97], v81 offset:16384
    ds_read_b64_tr_b16 a[98:99], v81 offset:17408
    ds_read_b64_tr_b16 a[100:101], v81 offset:24576
    ds_read_b64_tr_b16 a[102:103], v81 offset:25600
    s_branch L_lw_91
L_lw_91_0:
    s_cmp_lg_u32 s44, 1
    s_cbranch_scc1 L_lw_91_1
    ds_read_b64_tr_b16 a[56:57], v80 offset:16384
    ds_read_b64_tr_b16 a[58:59], v80 offset:17408
    ds_read_b64_tr_b16 a[60:61], v80 offset:24576
    ds_read_b64_tr_b16 a[62:63], v80 offset:25600
    ds_read_b64_tr_b16 v[56:57], v81 offset:16384
    ds_read_b64_tr_b16 v[58:59], v81 offset:17408
    ds_read_b64_tr_b16 v[60:61], v81 offset:24576
    ds_read_b64_tr_b16 v[62:63], v81 offset:25600
    s_waitcnt lgkmcnt(0)
    ds_write_b128 v5, v[56:59] offset:6144
    ds_write_b128 v5, v[60:63] offset:7168
    s_branch L_lw_91
L_lw_91_1:
    s_cmp_lg_u32 s44, 2
    s_cbranch_scc1 L_lw_91_2
    ds_read_b64_tr_b16 a[16:17], v80 offset:16384
    ds_read_b64_tr_b16 a[18:19], v80 offset:17408
    ds_read_b64_tr_b16 a[20:21], v80 offset:24576
    ds_read_b64_tr_b16 a[22:23], v80 offset:25600
    ds_read_b64_tr_b16 a[24:25], v81 offset:16384
    ds_read_b64_tr_b16 a[26:27], v81 offset:17408
    ds_read_b64_tr_b16 a[28:29], v81 offset:24576
    ds_read_b64_tr_b16 a[30:31], v81 offset:25600
    s_branch L_lw_91
L_lw_91_2:
    ds_read_b64_tr_b16 a[128:129], v80 offset:16384
    ds_read_b64_tr_b16 a[130:131], v80 offset:17408
    ds_read_b64_tr_b16 a[132:133], v80 offset:24576
    ds_read_b64_tr_b16 a[134:135], v80 offset:25600
    ds_read_b64_tr_b16 a[136:137], v81 offset:16384
    ds_read_b64_tr_b16 a[138:139], v81 offset:17408
    ds_read_b64_tr_b16 a[140:141], v81 offset:24576
    ds_read_b64_tr_b16 a[142:143], v81 offset:25600
L_lw_91:
    s_waitcnt lgkmcnt(0)
    s_waitcnt vmcnt(8)
    s_barrier
    s_add_u32 s46, s47, 0x680000
    s_add_u32 m0, s48, 16384
    s_nop 0
    buffer_load_dwordx4 v82, s[32:35], s46 offen nt lds
    s_add_u32 s46, s47, 0x6a0000
    s_add_u32 m0, s48, 20480
    s_nop 0
    buffer_load_dwordx4 v82, s[32:35], s46 offen nt lds
    s_add_u32 s46, s47, 0x6c0000
    s_add_u32 m0, s48, 24576
    s_nop 0
    buffer_load_dwordx4 v82, s[32:35], s46 offen nt lds
    s_add_u32 s46, s47, 0x6e0000
    s_add_u32 m0, s48, 28672
    s_nop 0
    buffer_load_dwordx4 v82, s[32:35], s46 offen nt lds
    s_cmp_lg_u32 s44, 0
    s_cbranch_scc1 L_lw_92_0
    ds_read_b64_tr_b16 a[104:105], v80 offset:32768
    ds_read_b64_tr_b16 a[106:107], v80 offset:33792
    ds_read_b64_tr_b16 a[108:109], v80 offset:40960
    ds_read_b64_tr_b16 a[110:111], v80 offset:41984
    ds_read_b64_tr_b16 v[56:57], v81 offset:32768
    ds_read_b64_tr_b16 v[58:59], v81 offset:33792
    ds_read_b64_tr_b16 v[60:61], v81 offset:40960
    ds_read_b64_tr_b16 v[62:63], v81 offset:41984
    s_waitcnt lgkmcnt(0)
    ds_write_b128 v5, v[56:59] offset:12288
    ds_write_b128 v5, v[60:63] offset:13312
    s_branch L_lw_92
L_lw_92_0:
    s_cmp_lg_u32 s44, 1
    s_cbranch_scc1 L_lw_92_1
    ds_read_b64_tr_b16 a[64:65], v80 offset:32768
    ds_read_b64_tr_b16 a[66:67], v80 offset:33792
    ds_read_b64_tr_b16 a[68:69], v80 offset:40960
    ds_read_b64_tr_b16 a[70:71], v80 offset:41984
    ds_read_b64_tr_b16 v[56:57], v81 offset:32768
    ds_read_b64_tr_b16 v[58:59], v81 offset:33792
    ds_read_b64_tr_b16 v[60:61], v81 offset:40960
    ds_read_b64_tr_b16 v[62:63], v81 offset:41984
    s_waitcnt lgkmcnt(0)
    ds_write_b128 v5, v[56:59] offset:14336
    ds_write_b128 v5, v[60:63] offset:15360
    s_branch L_lw_92
L_lw_92_1:
    s_cmp_lg_u32 s44, 2
    s_cbranch_scc1 L_lw_92_2
    ds_read_b64_tr_b16 a[32:33], v80 offset:32768
    ds_read_b64_tr_b16 a[34:35], v80 offset:33792
    ds_read_b64_tr_b16 a[36:37], v80 offset:40960
    ds_read_b64_tr_b16 a[38:39], v80 offset:41984
    ds_read_b64_tr_b16 v[56:57], v81 offset:32768
    ds_read_b64_tr_b16 v[58:59], v81 offset:33792
    ds_read_b64_tr_b16 v[60:61], v81 offset:40960
    ds_read_b64_tr_b16 v[62:63], v81 offset:41984
    s_waitcnt lgkmcnt(0)
    ds_write_b128 v5, v[56:59] offset:8192
    ds_write_b128 v5, v[60:63] offset:9216
    s_branch L_lw_92
L_lw_92_2:
    ds_read_b64_tr_b16 a[144:145], v80 offset:32768
    ds_read_b64_tr_b16 a[146:147], v80 offset:33792
    ds_read_b64_tr_b16 a[148:149], v80 offset:40960
    ds_read_b64_tr_b16 a[150:151], v80 offset:41984
    ds_read_b64_tr_b16 v[56:57], v81 offset:32768
    ds_read_b64_tr_b16 v[58:59], v81 offset:33792
    ds_read_b64_tr_b16 v[60:61], v81 offset:40960
    ds_read_b64_tr_b16 v[62:63], v81 offset:41984
    s_waitcnt lgkmcnt(0)
    ds_write_b128 v5, v[56:59] offset:10240
    ds_write_b128 v5, v[60:63] offset:11264
L_lw_92:
    s_waitcnt lgkmcnt(0)
    s_waitcnt vmcnt(8)
    s_barrier
    s_add_u32 s46, s47, 0x700000
    s_add_u32 m0, s48, 32768
    s_nop 0
    buffer_load_dwordx4 v82, s[32:35], s46 offen nt lds
    s_add_u32 s46, s47, 0x720000
    s_add_u32 m0, s48, 36864
    s_nop 0
    buffer_load_dwordx4 v82, s[32:35], s46 offen nt lds
    s_add_u32 s46, s47, 0x740000
    s_add_u32 m0, s48, 40960
    s_nop 0
    buffer_load_dwordx4 v82, s[32:35], s46 offen nt lds
    s_add_u32 s46, s47, 0x760000
    s_add_u32 m0, s48, 45056
    s_nop 0
    buffer_load_dwordx4 v82, s[32:35], s46 offen nt lds
    s_cmp_lg_u32 s44, 0
    s_cbranch_scc1 L_lw_93_0
    ds_read_b64_tr_b16 a[112:113], v80 offset:49152
    ds_read_b64_tr_b16 a[114:115], v80 offset:50176
    ds_read_b64_tr_b16 a[116:117], v80 offset:57344
    ds_read_b64_tr_b16 a[118:119], v80 offset:58368
    ds_read_b64_tr_b16 v[56:57], v81 offset:49152
    ds_read_b64_tr_b16 v[58:59], v81 offset:50176
    ds_read_b64_tr_b16 v[60:61], v81 offset:57344
    ds_read_b64_tr_b16 v[62:63], v81 offset:58368
    s_waitcnt lgkmcnt(0)
    ds_write_b128 v5, v[56:59] offset:20480
    ds_write_b128 v5, v[60:63] offset:21504
    s_branch L_lw_93
L_lw_93_0:
    s_cmp_lg_u32 s44, 1
    s_cbranch_scc1 L_lw_93_1
    ds_read_b64_tr_b16 a[72:73], v80 offset:49152
    ds_read_b64_tr_b16 a[74:75], v80 offset:50176
    ds_read_b64_tr_b16 a[76:77], v80 offset:57344
    ds_read_b64_tr_b16 a[78:79], v80 offset:58368
    ds_read_b64_tr_b16 v[56:57], v81 offset:49152
    ds_read_b64_tr_b16 v[58:59], v81 offset:50176
    ds_read_b64_tr_b16 v[60:61], v81 offset:57344
    ds_read_b64_tr_b16 v[62:63], v81 offset:58368
    s_waitcnt lgkmcnt(0)
    ds_write_b128 v5, v[56:59] offset:22528
    ds_write_b128 v5, v[60:63] offset:23552
    s_branch L_lw_93
L_lw_93_1:
    s_cmp_lg_u32 s44, 2
    s_cbranch_scc1 L_lw_93_2
    ds_read_b64_tr_b16 a[40:41], v80 offset:49152
    ds_read_b64_tr_b16 a[42:43], v80 offset:50176
    ds_read_b64_tr_b16 a[44:45], v80 offset:57344
    ds_read_b64_tr_b16 a[46:47], v80 offset:58368
    ds_read_b64_tr_b16 v[56:57], v81 offset:49152
    ds_read_b64_tr_b16 v[58:59], v81 offset:50176
    ds_read_b64_tr_b16 v[60:61], v81 offset:57344
    ds_read_b64_tr_b16 v[62:63], v81 offset:58368
    s_waitcnt lgkmcnt(0)
    ds_write_b128 v5, v[56:59] offset:16384
    ds_write_b128 v5, v[60:63] offset:17408
    s_branch L_lw_93
L_lw_93_2:
    ds_read_b64_tr_b16 a[152:153], v80 offset:49152
    ds_read_b64_tr_b16 a[154:155], v80 offset:50176
    ds_read_b64_tr_b16 a[156:157], v80 offset:57344
    ds_read_b64_tr_b16 a[158:159], v80 offset:58368
    ds_read_b64_tr_b16 v[56:57], v81 offset:49152
    ds_read_b64_tr_b16 v[58:59], v81 offset:50176
    ds_read_b64_tr_b16 v[60:61], v81 offset:57344
    ds_read_b64_tr_b16 v[62:63], v81 offset:58368
    s_waitcnt lgkmcnt(0)
    ds_write_b128 v5, v[56:59] offset:18432
    ds_write_b128 v5, v[60:63] offset:19456
L_lw_93:
    s_waitcnt lgkmcnt(0)
    s_waitcnt vmcnt(8)
    s_barrier
    s_add_u32 s46, s47, 0x780000
    s_add_u32 m0, s48, 49152
    s_nop 0
    buffer_load_dwordx4 v82, s[32:35], s46 offen nt lds
    s_add_u32 s46, s47, 0x7a0000
    s_add_u32 m0, s48, 53248
    s_nop 0
    buffer_load_dwordx4 v82, s[32:35], s46 offen nt lds
    s_add_u32 s46, s47, 0x7c0000
    s_add_u32 m0, s48, 57344
    s_nop 0
    buffer_load_dwordx4 v82, s[32:35], s46 offen nt lds
    s_add_u32 s46, s47, 0x7e0000
    s_add_u32 m0, s48, 61440
    s_nop 0
    buffer_load_dwordx4 v82, s[32:35], s46 offen nt lds
    s_cmp_lg_u32 s44, 0
    s_cbranch_scc1 L_lw_94_0
    ds_read_b64_tr_b16 a[120:121], v80 offset:0
    ds_read_b64_tr_b16 a[122:123], v80 offset:1024
    ds_read_b64_tr_b16 a[124:125], v80 offset:8192
    ds_read_b64_tr_b16 a[126:127], v80 offset:9216
    ds_read_b64_tr_b16 v[56:57], v81 offset:0
    ds_read_b64_tr_b16 v[58:59], v81 offset:1024
    ds_read_b64_tr_b16 v[60:61], v81 offset:8192
    ds_read_b64_tr_b16 v[62:63], v81 offset:9216
    s_waitcnt lgkmcnt(0)
    ds_write_b128 v5, v[56:59] offset:0
    ds_write_b128 v5, v[60:63] offset:1024
    s_branch L_lw_94
L_lw_94_0:
    s_cmp_lg_u32 s44, 1
    s_cbranch_scc1 L_lw_94_1
    ds_read_b64_tr_b16 a[80:81], v80 offset:0
    ds_read_b64_tr_b16 a[82:83], v80 offset:1024
    ds_read_b64_tr_b16 a[84:85], v80 offset:8192
    ds_read_b64_tr_b16 a[86:87], v80 offset:9216
    ds_read_b64_tr_b16 v[56:57], v81 offset:0
    ds_read_b64_tr_b16 v[58:59], v81 offset:1024
    ds_read_b64_tr_b16 v[60:61], v81 offset:8192
    ds_read_b64_tr_b16 v[62:63], v81 offset:9216
    s_waitcnt lgkmcnt(0)
    ds_write_b128 v5, v[56:59] offset:2048
    ds_write_b128 v5, v[60:63] offset:3072
    s_branch L_lw_94
L_lw_94_1:
    s_cmp_lg_u32 s44, 2
    s_cbranch_scc1 L_lw_94_2
    ds_read_b64_tr_b16 a[48:49], v80 offset:0
    ds_read_b64_tr_b16 a[50:51], v80 offset:1024
    ds_read_b64_tr_b16 a[52:53], v80 offset:8192
    ds_read_b64_tr_b16 a[54:55], v80 offset:9216
    ds_read_b64_tr_b16 v[56:57], v81 offset:0
    ds_read_b64_tr_b16 v[58:59], v81 offset:1024
    ds_read_b64_tr_b16 v[60:61], v81 offset:8192
    ds_read_b64_tr_b16 v[62:63], v81 offset:9216
    s_waitcnt lgkmcnt(0)
    ds_write_b128 v5, v[56:59] offset:4096
    ds_write_b128 v5, v[60:63] offset:5120
    s_branch L_lw_94
L_lw_94_2:
    ds_read_b64_tr_b16 a[0:1], v80 offset:0
    ds_read_b64_tr_b16 a[2:3], v80 offset:1024
    ds_read_b64_tr_b16 a[4:5], v80 offset:8192
    ds_read_b64_tr_b16 a[6:7], v80 offset:9216
    ds_read_b64_tr_b16 a[8:9], v81 offset:0
    ds_read_b64_tr_b16 a[10:11], v81 offset:1024
    ds_read_b64_tr_b16 a[12:13], v81 offset:8192
    ds_read_b64_tr_b16 a[14:15], v81 offset:9216
L_lw_94:
    s_waitcnt lgkmcnt(0)
    s_waitcnt vmcnt(8)
    s_barrier
    s_cmp_lg_u32 s44, 0
    s_cbranch_scc1 L_lw_95_0
    ds_read_b64_tr_b16 a[128:129], v80 offset:16384
    ds_read_b64_tr_b16 a[130:131], v80 offset:17408
    ds_read_b64_tr_b16 a[132:133], v80 offset:24576
    ds_read_b64_tr_b16 a[134:135], v80 offset:25600
    ds_read_b64_tr_b16 a[136:137], v81 offset:16384
    ds_read_b64_tr_b16 a[138:139], v81 offset:17408
    ds_read_b64_tr_b16 a[140:141], v81 offset:24576
    ds_read_b64_tr_b16 a[142:143], v81 offset:25600
    s_branch L_lw_95
L_lw_95_0:
    s_cmp_lg_u32 s44, 1
    s_cbranch_scc1 L_lw_95_1
    ds_read_b64_tr_b16 a[88:89], v80 offset:16384
    ds_read_b64_tr_b16 a[90:91], v80 offset:17408
    ds_read_b64_tr_b16 a[92:93], v80 offset:24576
    ds_read_b64_tr_b16 a[94:95], v80 offset:25600
    ds_read_b64_tr_b16 a[96:97], v81 offset:16384
    ds_read_b64_tr_b16 a[98:99], v81 offset:17408
    ds_read_b64_tr_b16 a[100:101], v81 offset:24576
    ds_read_b64_tr_b16 a[102:103], v81 offset:25600
    s_branch L_lw_95
L_lw_95_1:
    s_cmp_lg_u32 s44, 2
    s_cbranch_scc1 L_lw_95_2
    ds_read_b64_tr_b16 a[56:57], v80 offset:16384
    ds_read_b64_tr_b16 a[58:59], v80 offset:17408
    ds_read_b64_tr_b16 a[60:61], v80 offset:24576
    ds_read_b64_tr_b16 a[62:63], v80 offset:25600
    ds_read_b64_tr_b16 v[56:57], v81 offset:16384
    ds_read_b64_tr_b16 v[58:59], v81 offset:17408
    ds_read_b64_tr_b16 v[60:61], v81 offset:24576
    ds_read_b64_tr_b16 v[62:63], v81 offset:25600
    s_waitcnt lgkmcnt(0)
    ds_write_b128 v5, v[56:59] offset:6144
    ds_write_b128 v5, v[60:63] offset:7168
    s_branch L_lw_95
L_lw_95_2:
    ds_read_b64_tr_b16 a[16:17], v80 offset:16384
    ds_read_b64_tr_b16 a[18:19], v80 offset:17408
    ds_read_b64_tr_b16 a[20:21], v80 offset:24576
    ds_read_b64_tr_b16 a[22:23], v80 offset:25600
    ds_read_b64_tr_b16 a[24:25], v81 offset:16384
    ds_read_b64_tr_b16 a[26:27], v81 offset:17408
    ds_read_b64_tr_b16 a[28:29], v81 offset:24576
    ds_read_b64_tr_b16 a[30:31], v81 offset:25600
L_lw_95:
    s_waitcnt lgkmcnt(0)
    s_waitcnt vmcnt(4)
    s_barrier
    s_cmp_lg_u32 s44, 0
    s_cbranch_scc1 L_lw_96_0
    ds_read_b64_tr_b16 a[144:145], v80 offset:32768
    ds_read_b64_tr_b16 a[146:147], v80 offset:33792
    ds_read_b64_tr_b16 a[148:149], v80 offset:40960
    ds_read_b64_tr_b16 a[150:151], v80 offset:41984
    ds_read_b64_tr_b16 v[56:57], v81 offset:32768
    ds_read_b64_tr_b16 v[58:59], v81 offset:33792
    ds_read_b64_tr_b16 v[60:61], v81 offset:40960
    ds_read_b64_tr_b16 v[62:63], v81 offset:41984
    s_waitcnt lgkmcnt(0)
    ds_write_b128 v5, v[56:59] offset:10240
    ds_write_b128 v5, v[60:63] offset:11264
    s_branch L_lw_96
L_lw_96_0:
    s_cmp_lg_u32 s44, 1
    s_cbranch_scc1 L_lw_96_1
    ds_read_b64_tr_b16 a[104:105], v80 offset:32768
    ds_read_b64_tr_b16 a[106:107], v80 offset:33792
    ds_read_b64_tr_b16 a[108:109], v80 offset:40960
    ds_read_b64_tr_b16 a[110:111], v80 offset:41984
    ds_read_b64_tr_b16 v[56:57], v81 offset:32768
    ds_read_b64_tr_b16 v[58:59], v81 offset:33792
    ds_read_b64_tr_b16 v[60:61], v81 offset:40960
    ds_read_b64_tr_b16 v[62:63], v81 offset:41984
    s_waitcnt lgkmcnt(0)
    ds_write_b128 v5, v[56:59] offset:12288
    ds_write_b128 v5, v[60:63] offset:13312
    s_branch L_lw_96
L_lw_96_1:
    s_cmp_lg_u32 s44, 2
    s_cbranch_scc1 L_lw_96_2
    ds_read_b64_tr_b16 a[64:65], v80 offset:32768
    ds_read_b64_tr_b16 a[66:67], v80 offset:33792
    ds_read_b64_tr_b16 a[68:69], v80 offset:40960
    ds_read_b64_tr_b16 a[70:71], v80 offset:41984
    ds_read_b64_tr_b16 v[56:57], v81 offset:32768
    ds_read_b64_tr_b16 v[58:59], v81 offset:33792
    ds_read_b64_tr_b16 v[60:61], v81 offset:40960
    ds_read_b64_tr_b16 v[62:63], v81 offset:41984
    s_waitcnt lgkmcnt(0)
    ds_write_b128 v5, v[56:59] offset:14336
    ds_write_b128 v5, v[60:63] offset:15360
    s_branch L_lw_96
L_lw_96_2:
    ds_read_b64_tr_b16 a[32:33], v80 offset:32768
    ds_read_b64_tr_b16 a[34:35], v80 offset:33792
    ds_read_b64_tr_b16 a[36:37], v80 offset:40960
    ds_read_b64_tr_b16 a[38:39], v80 offset:41984
    ds_read_b64_tr_b16 v[56:57], v81 offset:32768
    ds_read_b64_tr_b16 v[58:59], v81 offset:33792
    ds_read_b64_tr_b16 v[60:61], v81 offset:40960
    ds_read_b64_tr_b16 v[62:63], v81 offset:41984
    s_waitcnt lgkmcnt(0)
    ds_write_b128 v5, v[56:59] offset:8192
    ds_write_b128 v5, v[60:63] offset:9216
L_lw_96:
    s_waitcnt lgkmcnt(0)
    s_waitcnt vmcnt(0)
    s_barrier
    s_cmp_lg_u32 s44, 0
    s_cbranch_scc1 L_lw_97_0
    ds_read_b64_tr_b16 a[152:153], v80 offset:49152
    ds_read_b64_tr_b16 a[154:155], v80 offset:50176
    ds_read_b64_tr_b16 a[156:157], v80 offset:57344
    ds_read_b64_tr_b16 a[158:159], v80 offset:58368
    ds_read_b64_tr_b16 v[56:57], v81 offset:49152
    ds_read_b64_tr_b16 v[58:59], v81 offset:50176
    ds_read_b64_tr_b16 v[60:61], v81 offset:57344
    ds_read_b64_tr_b16 v[62:63], v81 offset:58368
    s_waitcnt lgkmcnt(0)
    ds_write_b128 v5, v[56:59] offset:18432
    ds_write_b128 v5, v[60:63] offset:19456
    s_branch L_lw_97
L_lw_97_0:
    s_cmp_lg_u32 s44, 1
    s_cbranch_scc1 L_lw_97_1
    ds_read_b64_tr_b16 a[112:113], v80 offset:49152
    ds_read_b64_tr_b16 a[114:115], v80 offset:50176
    ds_read_b64_tr_b16 a[116:117], v80 offset:57344
    ds_read_b64_tr_b16 a[118:119], v80 offset:58368
    ds_read_b64_tr_b16 v[56:57], v81 offset:49152
    ds_read_b64_tr_b16 v[58:59], v81 offset:50176
    ds_read_b64_tr_b16 v[60:61], v81 offset:57344
    ds_read_b64_tr_b16 v[62:63], v81 offset:58368
    s_waitcnt lgkmcnt(0)
    ds_write_b128 v5, v[56:59] offset:20480
    ds_write_b128 v5, v[60:63] offset:21504
    s_branch L_lw_97
L_lw_97_1:
    s_cmp_lg_u32 s44, 2
    s_cbranch_scc1 L_lw_97_2
    ds_read_b64_tr_b16 a[72:73], v80 offset:49152
    ds_read_b64_tr_b16 a[74:75], v80 offset:50176
    ds_read_b64_tr_b16 a[76:77], v80 offset:57344
    ds_read_b64_tr_b16 a[78:79], v80 offset:58368
    ds_read_b64_tr_b16 v[56:57], v81 offset:49152
    ds_read_b64_tr_b16 v[58:59], v81 offset:50176
    ds_read_b64_tr_b16 v[60:61], v81 offset:57344
    ds_read_b64_tr_b16 v[62:63], v81 offset:58368
    s_waitcnt lgkmcnt(0)
    ds_write_b128 v5, v[56:59] offset:22528
    ds_write_b128 v5, v[60:63] offset:23552
    s_branch L_lw_97
L_lw_97_2:
    ds_read_b64_tr_b16 a[40:41], v80 offset:49152
    ds_read_b64_tr_b16 a[42:43], v80 offset:50176
    ds_read_b64_tr_b16 a[44:45], v80 offset:57344
    ds_read_b64_tr_b16 a[46:47], v80 offset:58368
    ds_read_b64_tr_b16 v[56:57], v81 offset:49152
    ds_read_b64_tr_b16 v[58:59], v81 offset:50176
    ds_read_b64_tr_b16 v[60:61], v81 offset:57344
    ds_read_b64_tr_b16 v[62:63], v81 offset:58368
    s_waitcnt lgkmcnt(0)
    ds_write_b128 v5, v[56:59] offset:16384
    ds_write_b128 v5, v[60:63] offset:17408
L_lw_97:
    s_waitcnt lgkmcnt(0)
    s_barrier
    v_lshlrev_b32 v68, 4, v1
    s_mul_i32 s45, s44, 3072
    s_add_u32 s45, s45, 53248
    v_add_u32 v6, s45, v68
    s_sub_u32 s45, s44, 1
    s_and_b32 s45, s45, 3
    s_mul_i32 s45, s45, 3072
    s_add_u32 s45, s45, 53248
    v_add_u32 v7, s45, v68
    s_sub_u32 s45, s44, 2
    s_and_b32 s45, s45, 3
    s_mul_i32 s45, s45, 3072
    s_add_u32 s45, s45, 54272
    v_add_u32 v8, s45, v68
    s_sub_u32 s45, s44, 3
    s_and_b32 s45, s45, 3
    s_mul_i32 s45, s45, 3072
    s_add_u32 s45, s45, 55296
    v_add_u32 v18, s45, v68
    v_lshlrev_b32 v68, 4, v1
    s_add_u32 s45, s69, 0
    s_and_b32 s45, s45, 7
    s_lshl_b32 s45, s45, 10
    s_lshl_b32 s46, s44, 13
    s_add_u32 s45, s45, s46
    v_add_u32 v80, s45, v68
    s_add_u32 s45, s69, 1
    s_and_b32 s45, s45, 7
    s_lshl_b32 s45, s45, 10
    s_lshl_b32 s46, s44, 13
    s_add_u32 s45, s45, s46
    v_add_u32 v81, s45, v68
    s_add_u32 s45, s69, 2
    s_and_b32 s45, s45, 7
    s_lshl_b32 s45, s45, 10
    s_lshl_b32 s46, s44, 13
    s_add_u32 s45, s45, s46
    v_add_u32 v82, s45, v68
    s_add_u32 s45, s69, 3
    s_and_b32 s45, s45, 7
    s_lshl_b32 s45, s45, 10
    s_lshl_b32 s46, s44, 13
    s_add_u32 s45, s45, s46
    v_add_u32 v83, s45, v68
    s_add_u32 s45, s69, 4
    s_and_b32 s45, s45, 7
    s_lshl_b32 s45, s45, 10
    s_lshl_b32 s46, s44, 13
    s_add_u32 s45, s45, s46
    v_add_u32 v84, s45, v68
    s_add_u32 s45, s69, 5
    s_and_b32 s45, s45, 7
    s_lshl_b32 s45, s45, 10
    s_lshl_b32 s46, s44, 13
    s_add_u32 s45, s45, s46
    v_add_u32 v85, s45, v68
    s_add_u32 s45, s69, 6
    s_and_b32 s45, s45, 7
    s_lshl_b32 s45, s45, 10
    s_lshl_b32 s46, s44, 13
    s_add_u32 s45, s45, s46
    v_add_u32 v86, s45, v68
    s_add_u32 s45, s69, 7
    s_and_b32 s45, s45, 7
    s_lshl_b32 s45, s45, 10
    s_lshl_b32 s46, s44, 13
    s_add_u32 s45, s45, s46
    v_add_u32 v87, s45, v68
    s_lshl_b32 s45, s40, 4
    s_add_u32 s45, s45, s42
    s_lshl_b32 s45, s45, 7
    s_lshl_b32 s46, s44, 4
    s_add_u32 s45, s45, s46
    s_add_u32 s45, s45, 0x7080000
    v_and_b32 v13, 3, v1
    v_lshlrev_b32 v13, 2, v13
    v_add_u32 v13, s45, v13
    s_mov_b32 s66, 0x1800000
    v_mov_b32 v14, -1
    v_mov_b32 v15, -1
    s_mov_b32 s70, 0
    v_mov_b32 v41, 0
L_hw_98:
    s_sleep 2
    buffer_load_dword v44, v41, s[16:19], 0 offen sc1
    s_add_u32 s70, s70, 1
    s_cmp_ge_u32 s70, 0x100000
    s_cbranch_scc1 L_c_done_1
    s_waitcnt vmcnt(0)
    v_readfirstlane_b32 s45, v44
    s_cmp_lg_u32 s45, 64
    s_cbranch_scc1 L_hw_98
    buffer_load_dwordx4 v[44:47], v41, s[16:19], 0 offen sc1
    s_waitcnt vmcnt(0)
    v_readfirstlane_b32 s45, v45
    v_readfirstlane_b32 s46, v46
    v_readfirstlane_b32 s68, v47
    s_bcnt1_i32_b32 s45, s45
    s_bcnt1_i32_b32 s46, s46
    s_add_u32 s45, s45, s46
    s_cmp_eq_u32 s45, 2
    s_cselect_b32 s67, 1, 0
    s_cmp_ge_u32 s68, 16
    s_cselect_b32 s68, 8192, 0
    s_mov_b32 s6, 0x0
    s_mov_b32 s7, 0xd5400000
    s_mov_b32 s60, 0
    s_lshl_b32 s58, s40, 16
    s_add_u32 s58, s58, 0x7000000
    s_mov_b32 s61, s58
    s_lshl_b32 s59, s40, 17
    s_add_u32 s59, s59, 0x7040000
    s_mov_b32 s62, s59
    s_add_u32 s63, s63, s68
    s_add_u32 s64, s64, s68
    ds_read_b128 v[56:59], v5 offset:8192
    ds_read_b128 v[60:63], v5 offset:9216
    ds_read_b128 v[64:67], v5 offset:16384
    ds_read_b128 v[68:71], v5 offset:17408
    ds_read_b128 v[72:75], v5 offset:4096
    ds_read_b128 v[76:79], v5 offset:5120
    ds_read_b128 v[88:91], v5 offset:6144
    ds_read_b128 v[92:95], v5 offset:7168
    ds_read_b128 v[32:35], v5 offset:14336
    ds_read_b128 v[36:39], v5 offset:15360
L_v_loop_99:
    s_nop 15
    s_nop 15
    s_waitcnt lgkmcnt(0)
    s_mov_b32 s70, 0
L_mg_100:
    buffer_load_dwordx4 v[40:43], v3, s[12:15], s61 offen offset:0 sc1
    s_nop 9
    buffer_load_dwordx4 v[44:47], v3, s[12:15], s61 offen offset:1024 sc1
    s_nop 9
    buffer_load_dwordx4 v[48:51], v3, s[12:15], s61 offen offset:2048 sc1
    s_nop 9
    buffer_load_dwordx4 v[52:55], v3, s[12:15], s61 offen offset:3072 sc1
    s_add_u32 s70, s70, 1
    s_cmp_ge_u32 s70, 0x100000
    s_cbranch_scc1 L_c_done_1
    s_nop 1
    v_mov_b32 v24, 0
    v_mov_b32 v25, 0
    v_mov_b32 v26, 0
    v_mov_b32 v27, 0
    v_mov_b32 v28, 0
    v_mov_b32 v29, 0
    v_mov_b32 v30, 0
    v_mov_b32 v31, 0
    s_waitcnt vmcnt(3)
    ds_write_b128 v3, v[40:43] offset:0
    v_smfmac_f32_16x16x64_bf16 v[24:27], v[40:43], a[0:7], v2
    v_max3_u32 v22, v40, v41, v42
    v_max_u32 v22, v22, v43
    v_smfmac_f32_16x16x64_bf16 v[28:31], v[40:43], a[8:15], v2
    s_waitcnt vmcnt(2)
    ds_write_b128 v3, v[44:47] offset:1024
    v_smfmac_f32_16x16x64_bf16 v[24:27], v[44:47], a[16:23], v2
    v_max3_u32 v22, v22, v44, v45
    v_max3_u32 v22, v22, v46, v47
    v_smfmac_f32_16x16x64_bf16 v[28:31], v[44:47], a[24:31], v2
    s_waitcnt vmcnt(1)
    ds_write_b128 v3, v[48:51] offset:2048
    s_waitcnt vmcnt(0)
    ds_write_b128 v3, v[52:55] offset:3072
    v_max3_u32 v22, v22, v48, v49
    v_max3_u32 v22, v22, v50, v51
    v_max3_u32 v22, v22, v52, v53
    v_max3_u32 v22, v22, v54, v55
    v_cmp_eq_u32 vcc, -1, v22
    s_waitcnt lgkmcnt(0)
    s_nop 0
    s_cbranch_vccnz L_mg_100
    s_barrier
    ds_read_b128 v[40:43], v4 offset:0
    ds_read_b128 v[44:47], v4 offset:1024
    v_smfmac_f32_16x16x64_bf16 v[24:27], v[48:51], a[32:39], v2
    v_smfmac_f32_16x16x64_bf16 v[28:31], v[48:51], v[56:63], v2
    ds_read_b128 v[48:51], v4 offset:2048
    ds_read_b128 v[56:59], v5 offset:22528
    v_smfmac_f32_16x16x64_bf16 v[24:27], v[52:55], a[40:47], v2
    ds_read_b128 v[60:63], v5 offset:23552
    v_smfmac_f32_16x16x64_bf16 v[28:31], v[52:55], v[64:71], v2
    ds_read_b128 v[52:55], v4 offset:3072
    ds_read_b128 v[64:67], v5 offset:2048
    s_waitcnt lgkmcnt(5)
    v_smfmac_f32_16x16x64_bf16 v[24:27], v[40:43], a[48:55], v2
    ds_read_b128 v[68:71], v5 offset:3072
    v_smfmac_f32_16x16x64_bf16 v[28:31], v[40:43], v[72:79], v2
    ds_read_b128 v[40:43], v21 offset:0
    ds_read_b128 v[72:75], v5 offset:12288
    v_smfmac_f32_16x16x64_bf16 v[24:27], v[44:47], a[56:63], v2
    ds_read_b128 v[76:79], v5 offset:13312
    v_smfmac_f32_16x16x64_bf16 v[28:31], v[44:47], v[88:95], v2
    ds_read_b128 v[44:47], v21 offset:1024
    ds_read_b128 v[88:91], v5 offset:20480
    s_waitcnt lgkmcnt(6)
    v_smfmac_f32_16x16x64_bf16 v[24:27], v[48:51], a[64:71], v2
    ds_read_b128 v[92:95], v5 offset:21504
    v_smfmac_f32_16x16x64_bf16 v[28:31], v[48:51], v[32:39], v2
    ds_read_b128 v[48:51], v21 offset:2048
    ds_read_b128 v[32:35], v5 offset:0
    v_smfmac_f32_16x16x64_bf16 v[24:27], v[52:55], a[72:79], v2
    ds_read_b128 v[36:39], v5 offset:1024
    v_smfmac_f32_16x16x64_bf16 v[28:31], v[52:55], v[56:63], v2
    ds_read_b128 v[52:55], v21 offset:3072
    ds_read_b128 v[56:59], v5 offset:10240
    s_waitcnt lgkmcnt(6)
    v_smfmac_f32_16x16x64_bf16 v[24:27], v[40:43], a[80:87], v2
    ds_read_b128 v[60:63], v5 offset:11264
    v_smfmac_f32_16x16x64_bf16 v[28:31], v[40:43], v[64:71], v2
    ds_read_b128 v[40:43], v23 offset:0
    ds_read_b128 v[64:67], v5 offset:18432
    v_smfmac_f32_16x16x64_bf16 v[24:27], v[44:47], a[88:95], v2
    ds_read_b128 v[68:71], v5 offset:19456
    v_smfmac_f32_16x16x64_bf16 v[28:31], v[44:47], a[96:103], v2
    ds_read_b128 v[44:47], v23 offset:1024
    s_waitcnt lgkmcnt(5)
    v_smfmac_f32_16x16x64_bf16 v[24:27], v[48:51], a[104:111], v2
    v_smfmac_f32_16x16x64_bf16 v[28:31], v[48:51], v[72:79], v2
    ds_read_b128 v[48:51], v23 offset:2048
    v_smfmac_f32_16x16x64_bf16 v[24:27], v[52:55], a[112:119], v2
    v_smfmac_f32_16x16x64_bf16 v[28:31], v[52:55], v[88:95], v2
    ds_read_b128 v[52:55], v23 offset:3072
    s_waitcnt lgkmcnt(2)
    v_smfmac_f32_16x16x64_bf16 v[24:27], v[40:43], a[120:127], v2
    v_smfmac_f32_16x16x64_bf16 v[28:31], v[40:43], v[32:39], v2
    v_smfmac_f32_16x16x64_bf16 v[24:27], v[44:47], a[128:135], v2
    v_smfmac_f32_16x16x64_bf16 v[28:31], v[44:47], a[136:143], v2
    s_waitcnt lgkmcnt(0)
    v_smfmac_f32_16x16x64_bf16 v[24:27], v[48:51], a[144:151], v2
    v_smfmac_f32_16x16x64_bf16 v[28:31], v[48:51], v[56:63], v2
    v_smfmac_f32_16x16x64_bf16 v[24:27], v[52:55], a[152:159], v2
    v_smfmac_f32_16x16x64_bf16 v[28:31], v[52:55], v[64:71], v2
    s_and_b32 s45, s60, 1
    s_lshl_b32 s45, s45, 16
    s_add_u32 s45, s45, 0x7020000
    s_xor_b32 s46, s45, 65536
    s_nop 3
    v_permlane32_swap_b32 v24, v26
    v_permlane32_swap_b32 v25, v27
    v_permlane32_swap_b32 v28, v30
    v_permlane32_swap_b32 v29, v31
    v_pk_add_f32 v[24:25], v[24:25], v[26:27]
    v_pk_add_f32 v[28:29], v[28:29], v[30:31]
    v_cvt_pk_bf16_f32 v16, v24, v25
    v_cvt_pk_bf16_f32 v17, v28, v29
    v_min_u32 v16, -2, v16
    v_min_u32 v17, -2, v17
    s_add_u32 s47, s60, 3
    s_and_b32 s47, s47, 3
    s_lshl_b32 s47, s47, 14
    s_add_u32 s47, s47, s58
    s_cmp_eq_u32 s67, 1
    s_cbranch_scc0 L_ls_101_s
    buffer_store_dwordx2 v[16:17], v10, s[12:15], s45 offen
    buffer_store_dwordx2 v[14:15], v10, s[12:15], s46 offen
    buffer_store_dword v14, v12, s[12:15], s47 offen
L_ls_101_d:
    buffer_store_dwordx2 v[16:17], v10, s[12:15], s66 offen sc1
    s_cmp_eq_u32 s60, 63
    s_cbranch_scc1 L_v_fin_102
    v_mov_b32 v22, s60
    v_mov_b32 v0, 0
    s_mov_b64 exec, 1
    buffer_store_dword v22, v0, s[12:15], s3 offen sc1
    s_mov_b64 exec, -1
    s_and_b32 s65, s60, 1
    s_lshl_b32 s65, s65, 12
    s_and_b32 s45, s60, 2
    s_lshl_b32 s45, s45, 13
    s_add_u32 s65, s65, s45
    s_xor_b32 s45, s65, 16384
    s_add_u32 s45, s45, s63
    buffer_store_dwordx2 v[14:15], v11, s[12:15], s45 offen sc1
    s_add_u32 s48, s63, s65
    s_add_u32 s49, s64, s65
    s_sleep 8
    s_mov_b64 exec, 15
    buffer_load_dword v88, v13, s[12:15], 0 offen sc1
    s_nop 15
    buffer_load_dword v89, v13, s[12:15], 0 offen sc1
    s_nop 15
    buffer_load_dword v90, v13, s[12:15], 0 offen sc1
    s_nop 15
    buffer_load_dword v91, v13, s[12:15], 0 offen sc1
    s_mov_b32 s70, 0
L_pp_103:
    s_waitcnt vmcnt(3)
    v_cmp_ge_u32 vcc, s60, v88
    s_add_u32 s70, s70, 1
    s_nop 0
    s_cbranch_vccz L_ppd_104
    buffer_load_dword v88, v13, s[12:15], 0 offen sc1
    s_waitcnt vmcnt(3)
    v_cmp_ge_u32 vcc, s60, v89
    s_add_u32 s70, s70, 1
    s_nop 0
    s_cbranch_vccz L_ppd_104
    buffer_load_dword v89, v13, s[12:15], 0 offen sc1
    s_waitcnt vmcnt(3)
    v_cmp_ge_u32 vcc, s60, v90
    s_add_u32 s70, s70, 1
    s_nop 0
    s_cbranch_vccz L_ppd_104
    buffer_load_dword v90, v13, s[12:15], 0 offen sc1
    s_waitcnt vmcnt(3)
    v_cmp_ge_u32 vcc, s60, v91
    s_add_u32 s70, s70, 1
    s_nop 0
    s_cbranch_vccz L_ppd_104
    buffer_load_dword v91, v13, s[12:15], 0 offen sc1
    s_cmp_lt_u32 s70, 0x400000
    s_cbranch_scc1 L_pp_103
    s_branch L_c_done_1
L_ppd_104:
    s_mov_b64 exec, -1
    s_nop 15
    s_nop 15
    s_mov_b32 s70, 0
    buffer_load_dwordx4 v[40:43], v80, s[12:15], s62 offen sc1
    v_mov_b32 v24, 0
    v_mov_b32 v25, 0
    v_mov_b32 v26, 0
    v_mov_b32 v27, 0
    s_nop 5
    buffer_load_dwordx4 v[44:47], v81, s[12:15], s62 offen sc1
    v_mov_b32 v28, 0
    v_mov_b32 v29, 0
    v_mov_b32 v30, 0
    v_mov_b32 v31, 0
    s_nop 5
    buffer_load_dwordx4 v[48:51], v82, s[12:15], s62 offen sc1
    v_mov_b32 v32, 0
    v_mov_b32 v33, 0
    v_mov_b32 v34, 0
    v_mov_b32 v35, 0
    s_nop 5
    buffer_load_dwordx4 v[52:55], v83, s[12:15], s62 offen sc1
    v_mov_b32 v36, 0
    v_mov_b32 v37, 0
    v_mov_b32 v38, 0
    v_mov_b32 v39, 0
    s_nop 5
    buffer_load_dwordx4 v[56:59], v84, s[12:15], s62 offen sc1
    s_nop 9
    buffer_load_dwordx4 v[60:63], v85, s[12:15], s62 offen sc1
    s_waitcnt vmcnt(5)
    v_max3_u32 v22, v40, v41, v42
    v_max_u32 v22, v22, v43
    v_cmp_eq_u32 vcc, -1, v22
    s_nop 1
    s_cbranch_vccnz L_v_og_105_r0
L_v_og_105_c0:
    v_smfmac_f32_16x16x64_bf16 v[24:27], v[40:43], a[160:167], v2
    s_waitcnt vmcnt(4)
    v_max3_u32 v22, v44, v45, v46
    v_smfmac_f32_16x16x64_bf16 v[28:31], v[40:43], a[168:175], v2
    v_max_u32 v22, v22, v47
    v_smfmac_f32_16x16x64_bf16 v[32:35], v[40:43], a[176:183], v2
    v_cmp_eq_u32 vcc, -1, v22
    v_smfmac_f32_16x16x64_bf16 v[36:39], v[40:43], a[184:191], v2
    buffer_load_dwordx4 v[64:67], v86, s[12:15], s62 offen sc1
    s_cbranch_vccnz L_v_og_105_r1
L_v_og_105_c1:
    v_smfmac_f32_16x16x64_bf16 v[24:27], v[44:47], a[192:199], v2
    s_waitcnt vmcnt(4)
    v_max3_u32 v22, v48, v49, v50
    v_smfmac_f32_16x16x64_bf16 v[28:31], v[44:47], a[200:207], v2
    v_max_u32 v22, v22, v51
    v_smfmac_f32_16x16x64_bf16 v[32:35], v[44:47], a[208:215], v2
    v_cmp_eq_u32 vcc, -1, v22
    v_smfmac_f32_16x16x64_bf16 v[36:39], v[44:47], a[216:223], v2
    buffer_load_dwordx4 v[68:71], v87, s[12:15], s62 offen sc1
    s_cbranch_vccnz L_v_og_105_r2
L_v_og_105_c2:
    v_smfmac_f32_16x16x64_bf16 v[24:27], v[48:51], a[224:231], v2
    s_waitcnt vmcnt(4)
    v_max3_u32 v22, v52, v53, v54
    v_smfmac_f32_16x16x64_bf16 v[28:31], v[48:51], a[232:239], v2
    v_max_u32 v22, v22, v55
    v_smfmac_f32_16x16x64_bf16 v[32:35], v[48:51], a[240:247], v2
    v_cmp_eq_u32 vcc, -1, v22
    v_smfmac_f32_16x16x64_bf16 v[36:39], v[48:51], a[248:255], v2
    s_nop 0
    s_cbranch_vccnz L_v_og_105_r3
L_v_og_105_c3:
    v_smfmac_f32_16x16x64_bf16 v[24:27], v[52:55], v[96:103], v2
    s_waitcnt vmcnt(3)
    v_max3_u32 v22, v56, v57, v58
    v_smfmac_f32_16x16x64_bf16 v[28:31], v[52:55], v[104:111], v2
    v_max_u32 v22, v22, v59
    v_smfmac_f32_16x16x64_bf16 v[32:35], v[52:55], v[112:119], v2
    v_cmp_eq_u32 vcc, -1, v22
    v_smfmac_f32_16x16x64_bf16 v[36:39], v[52:55], v[120:127], v2
    s_nop 0
    s_cbranch_vccnz L_v_og_105_r4
L_v_og_105_c4:
    v_smfmac_f32_16x16x64_bf16 v[24:27], v[56:59], v[128:135], v2
    s_waitcnt vmcnt(2)
    v_max3_u32 v22, v60, v61, v62
    v_smfmac_f32_16x16x64_bf16 v[28:31], v[56:59], v[136:143], v2
    v_max_u32 v22, v22, v63
    v_smfmac_f32_16x16x64_bf16 v[32:35], v[56:59], v[144:151], v2
    v_cmp_eq_u32 vcc, -1, v22
    v_smfmac_f32_16x16x64_bf16 v[36:39], v[56:59], v[152:159], v2
    s_nop 0
    s_cbranch_vccnz L_v_og_105_r5
L_v_og_105_c5:
    v_smfmac_f32_16x16x64_bf16 v[24:27], v[60:63], v[160:167], v2
    s_waitcnt vmcnt(1)
    v_max3_u32 v22, v64, v65, v66
    v_smfmac_f32_16x16x64_bf16 v[28:31], v[60:63], v[168:175], v2
    v_max_u32 v22, v22, v67
    v_smfmac_f32_16x16x64_bf16 v[32:35], v[60:63], v[176:183], v2
    v_cmp_eq_u32 vcc, -1, v22
    v_smfmac_f32_16x16x64_bf16 v[36:39], v[60:63], v[184:191], v2
    s_nop 0
    s_cbranch_vccnz L_v_og_105_r6
L_v_og_105_c6:
    v_smfmac_f32_16x16x64_bf16 v[24:27], v[64:67], v[192:199], v2
    s_waitcnt vmcnt(0)
    v_max3_u32 v22, v68, v69, v70
    v_smfmac_f32_16x16x64_bf16 v[28:31], v[64:67], v[200:207], v2
    v_max_u32 v22, v22, v71
    v_smfmac_f32_16x16x64_bf16 v[32:35], v[64:67], v[208:215], v2
    v_cmp_eq_u32 vcc, -1, v22
    v_smfmac_f32_16x16x64_bf16 v[36:39], v[64:67], v[216:223], v2
    s_nop 0
    s_cbranch_vccnz L_v_og_105_r7
L_v_og_105_c7:
    v_smfmac_f32_16x16x64_bf16 v[24:27], v[68:71], v[224:231], v2
    v_smfmac_f32_16x16x64_bf16 v[28:31], v[68:71], v[232:239], v2
    v_smfmac_f32_16x16x64_bf16 v[32:35], v[68:71], v[240:247], v2
    v_smfmac_f32_16x16x64_bf16 v[36:39], v[68:71], v[248:255], v2
    s_add_u32 s46, s60, 1
    s_nop 3
    ds_write_b128 v6, v[24:27]
    s_and_b32 s45, s46, 3
    ds_write_b128 v6, v[28:31] offset:1024
    s_mov_b32 s60, s46
    ds_write_b128 v6, v[32:35] offset:2048
    s_lshl_b32 s46, s45, 14
    s_add_u32 s61, s58, s46
    s_lshl_b32 s46, s45, 15
    s_add_u32 s62, s59, s46
    s_waitcnt lgkmcnt(0)
    s_barrier
    ds_read_b128 v[40:43], v7
    ds_read_b128 v[44:47], v8
    ds_read_b128 v[48:51], v18
    s_waitcnt lgkmcnt(2)
    v_pk_add_f32 v[36:37], v[36:37], v[40:41]
    v_pk_add_f32 v[38:39], v[38:39], v[42:43]
    s_waitcnt lgkmcnt(1)
    v_pk_add_f32 v[36:37], v[36:37], v[44:45]
    v_pk_add_f32 v[38:39], v[38:39], v[46:47]
    s_waitcnt lgkmcnt(0)
    v_pk_add_f32 v[36:37], v[36:37], v[48:49]
    v_pk_add_f32 v[38:39], v[38:39], v[50:51]
    s_nop 1
    v_permlane32_swap_b32 v36, v38
    v_permlane32_swap_b32 v37, v39
    v_pk_add_f32 v[24:25], v[36:37], v[38:39]
    v_min_u32 v24, -2, v24
    v_min_u32 v25, -2, v25
    buffer_store_dwordx2 v[24:25], v11, s[12:15], s48 offen sc1
    s_bitcmp1_b64 s[6:7], s60
    s_cbranch_scc0 L_v_eag_106
    v_mov_b32 v22, s60
    v_mov_b32 v0, 0
    s_mov_b64 exec, 1
    buffer_store_dword v22, v0, s[12:15], s3 offen sc1
    s_mov_b64 exec, -1
L_v_eag_106:
    ds_read_b128 v[56:59], v5 offset:8192
    ds_read_b128 v[60:63], v5 offset:9216
    ds_read_b128 v[64:67], v5 offset:16384
    ds_read_b128 v[68:71], v5 offset:17408
    ds_read_b128 v[72:75], v5 offset:4096
    ds_read_b128 v[76:79], v5 offset:5120
    ds_read_b128 v[88:91], v5 offset:6144
    ds_read_b128 v[92:95], v5 offset:7168
    ds_read_b128 v[32:35], v5 offset:14336
    ds_read_b128 v[36:39], v5 offset:15360
    s_sleep 2
    buffer_load_dwordx2 v[40:41], v11, s[12:15], s49 offen sc1
    s_nop 15
    s_nop 7
    buffer_load_dwordx2 v[42:43], v11, s[12:15], s49 offen sc1
    s_nop 15
    s_nop 7
    buffer_load_dwordx2 v[44:45], v11, s[12:15], s49 offen sc1
    s_mov_b32 s70, 0
L_v_xp_107:
    s_waitcnt vmcnt(2)
    v_max_u32 v22, v40, v41
    v_cmp_eq_u32 vcc, -1, v22
    v_pk_add_f32 v[28:29], v[24:25], v[40:41]
    v_cvt_pk_bf16_f32 v28, v28, v29
    s_cbranch_vccz L_v_xp_107_ok
    buffer_load_dwordx2 v[40:41], v11, s[12:15], s49 offen sc1
    s_waitcnt vmcnt(2)
    v_max_u32 v22, v42, v43
    v_cmp_eq_u32 vcc, -1, v22
    v_pk_add_f32 v[28:29], v[24:25], v[42:43]
    v_cvt_pk_bf16_f32 v28, v28, v29
    s_cbranch_vccz L_v_xp_107_ok
    buffer_load_dwordx2 v[42:43], v11, s[12:15], s49 offen sc1
    s_waitcnt vmcnt(2)
    v_max_u32 v22, v44, v45
    v_cmp_eq_u32 vcc, -1, v22
    v_pk_add_f32 v[28:29], v[24:25], v[44:45]
    v_cvt_pk_bf16_f32 v28, v28, v29
    s_cbranch_vccz L_v_xp_107_ok
    buffer_load_dwordx2 v[44:45], v11, s[12:15], s49 offen sc1
    s_add_u32 s70, s70, 1
    s_cmp_lt_u32 s70, 0x100000
    s_cbranch_scc1 L_v_xp_107
    s_branch L_c_done_1
L_v_xp_107_ok:
    s_add_u32 s66, s66, 65536
    v_mov_b32_dpp v29, v28 quad_perm:[1,0,3,2] row_mask:0xf bank_mask:0xf
    v_perm_b32 v28, v28, v29, v9
    v_min_u32 v28, -2, v28
    s_cmp_eq_u32 s67, 1
    s_cbranch_scc0 L_ls_108_s
    buffer_store_dword v28, v12, s[12:15], s61 offen
L_ls_108_d:
    s_branch L_v_loop_99
L_v_fin_102:
    s_waitcnt vmcnt(0)
    v_mov_b32 v22, 64
    v_mov_b32 v0, 0
    s_mov_b64 exec, 1
    buffer_store_dword v22, v0, s[12:15], s3 offen sc1
    s_mov_b64 exec, -1
L_c_done_1:
    s_endpgm
L_v_og_105_r0:
    buffer_load_dwordx4 v[40:43], v80, s[12:15], s62 offen sc1
    buffer_load_dwordx4 v[44:47], v81, s[12:15], s62 offen sc1
    buffer_load_dwordx4 v[48:51], v82, s[12:15], s62 offen sc1
    buffer_load_dwordx4 v[52:55], v83, s[12:15], s62 offen sc1
    buffer_load_dwordx4 v[56:59], v84, s[12:15], s62 offen sc1
    buffer_load_dwordx4 v[60:63], v85, s[12:15], s62 offen sc1
    s_add_u32 s70, s70, 1
    s_cmp_ge_u32 s70, 0x100000
    s_cbranch_scc1 L_c_done_1
    s_waitcnt vmcnt(5)
    v_max3_u32 v22, v40, v41, v42
    v_max_u32 v22, v22, v43
    v_cmp_eq_u32 vcc, -1, v22
    s_nop 1
    s_cbranch_vccnz L_v_og_105_r0
    s_branch L_v_og_105_c0
L_v_og_105_r1:
    buffer_load_dwordx4 v[44:47], v81, s[12:15], s62 offen sc1
    buffer_load_dwordx4 v[48:51], v82, s[12:15], s62 offen sc1
    buffer_load_dwordx4 v[52:55], v83, s[12:15], s62 offen sc1
    buffer_load_dwordx4 v[56:59], v84, s[12:15], s62 offen sc1
    buffer_load_dwordx4 v[60:63], v85, s[12:15], s62 offen sc1
    buffer_load_dwordx4 v[64:67], v86, s[12:15], s62 offen sc1
    s_add_u32 s70, s70, 1
    s_cmp_ge_u32 s70, 0x100000
    s_cbranch_scc1 L_c_done_1
    s_waitcnt vmcnt(5)
    v_max3_u32 v22, v44, v45, v46
    v_max_u32 v22, v22, v47
    v_cmp_eq_u32 vcc, -1, v22
    s_nop 1
    s_cbranch_vccnz L_v_og_105_r1
    s_branch L_v_og_105_c1
L_v_og_105_r2:
    buffer_load_dwordx4 v[48:51], v82, s[12:15], s62 offen sc1
    buffer_load_dwordx4 v[52:55], v83, s[12:15], s62 offen sc1
    buffer_load_dwordx4 v[56:59], v84, s[12:15], s62 offen sc1
    buffer_load_dwordx4 v[60:63], v85, s[12:15], s62 offen sc1
    buffer_load_dwordx4 v[64:67], v86, s[12:15], s62 offen sc1
    buffer_load_dwordx4 v[68:71], v87, s[12:15], s62 offen sc1
    s_add_u32 s70, s70, 1
    s_cmp_ge_u32 s70, 0x100000
    s_cbranch_scc1 L_c_done_1
    s_waitcnt vmcnt(5)
    v_max3_u32 v22, v48, v49, v50
    v_max_u32 v22, v22, v51
    v_cmp_eq_u32 vcc, -1, v22
    s_nop 1
    s_cbranch_vccnz L_v_og_105_r2
    s_branch L_v_og_105_c2
L_v_og_105_r3:
    buffer_load_dwordx4 v[52:55], v83, s[12:15], s62 offen sc1
    buffer_load_dwordx4 v[56:59], v84, s[12:15], s62 offen sc1
    buffer_load_dwordx4 v[60:63], v85, s[12:15], s62 offen sc1
    buffer_load_dwordx4 v[64:67], v86, s[12:15], s62 offen sc1
    buffer_load_dwordx4 v[68:71], v87, s[12:15], s62 offen sc1
    s_add_u32 s70, s70, 1
    s_cmp_ge_u32 s70, 0x100000
    s_cbranch_scc1 L_c_done_1
    s_waitcnt vmcnt(4)
    v_max3_u32 v22, v52, v53, v54
    v_max_u32 v22, v22, v55
    v_cmp_eq_u32 vcc, -1, v22
    s_nop 1
    s_cbranch_vccnz L_v_og_105_r3
    s_branch L_v_og_105_c3
L_v_og_105_r4:
    buffer_load_dwordx4 v[56:59], v84, s[12:15], s62 offen sc1
    buffer_load_dwordx4 v[60:63], v85, s[12:15], s62 offen sc1
    buffer_load_dwordx4 v[64:67], v86, s[12:15], s62 offen sc1
    buffer_load_dwordx4 v[68:71], v87, s[12:15], s62 offen sc1
    s_add_u32 s70, s70, 1
    s_cmp_ge_u32 s70, 0x100000
    s_cbranch_scc1 L_c_done_1
    s_waitcnt vmcnt(3)
    v_max3_u32 v22, v56, v57, v58
    v_max_u32 v22, v22, v59
    v_cmp_eq_u32 vcc, -1, v22
    s_nop 1
    s_cbranch_vccnz L_v_og_105_r4
    s_branch L_v_og_105_c4
L_v_og_105_r5:
    buffer_load_dwordx4 v[60:63], v85, s[12:15], s62 offen sc1
    buffer_load_dwordx4 v[64:67], v86, s[12:15], s62 offen sc1
    buffer_load_dwordx4 v[68:71], v87, s[12:15], s62 offen sc1
    s_add_u32 s70, s70, 1
    s_cmp_ge_u32 s70, 0x100000
    s_cbranch_scc1 L_c_done_1
    s_waitcnt vmcnt(2)
    v_max3_u32 v22, v60, v61, v62
    v_max_u32 v22, v22, v63
    v_cmp_eq_u32 vcc, -1, v22
    s_nop 1
    s_cbranch_vccnz L_v_og_105_r5
    s_branch L_v_og_105_c5
L_v_og_105_r6:
    buffer_load_dwordx4 v[64:67], v86, s[12:15], s62 offen sc1
    buffer_load_dwordx4 v[68:71], v87, s[12:15], s62 offen sc1
    s_add_u32 s70, s70, 1
    s_cmp_ge_u32 s70, 0x100000
    s_cbranch_scc1 L_c_done_1
    s_waitcnt vmcnt(1)
    v_max3_u32 v22, v64, v65, v66
    v_max_u32 v22, v22, v67
    v_cmp_eq_u32 vcc, -1, v22
    s_nop 1
    s_cbranch_vccnz L_v_og_105_r6
    s_branch L_v_og_105_c6
L_v_og_105_r7:
    buffer_load_dwordx4 v[68:71], v87, s[12:15], s62 offen sc1
    s_add_u32 s70, s70, 1
    s_cmp_ge_u32 s70, 0x100000
    s_cbranch_scc1 L_c_done_1
    s_waitcnt vmcnt(0)
    v_max3_u32 v22, v68, v69, v70
    v_max_u32 v22, v22, v71
    v_cmp_eq_u32 vcc, -1, v22
    s_nop 1
    s_cbranch_vccnz L_v_og_105_r7
    s_branch L_v_og_105_c7
L_ls_101_s:
    buffer_store_dwordx2 v[16:17], v10, s[12:15], s45 offen sc1
    buffer_store_dwordx2 v[14:15], v10, s[12:15], s46 offen sc1
    buffer_store_dword v14, v12, s[12:15], s47 offen sc1
    s_branch L_ls_101_d
L_ls_108_s:
    buffer_store_dword v28, v12, s[12:15], s61 offen sc1
    s_branch L_ls_108_d
L_worker_3:
    s_lshr_b32 s41, s2, 3
    s_and_b32 s42, s40, 1
    s_lshr_b32 s43, s40, 1
    s_lshl_b32 s39, s43, 5
    s_add_u32 s39, s39, s41
    s_load_dwordx2 s[4:5], s[0:1], 0
    s_waitcnt lgkmcnt(0)
    s_mov_b32 s28, s4
    s_and_b32 s29, s5, 0xffff
    s_mov_b32 s30, 0x400000
    s_mov_b32 s31, 0x00020000
    v_lshrrev_b32 v2, 4, v1
    v_and_b32 v4, 15, v1
    v_lshrrev_b32 v3, 1, v4
    v_xor_b32 v3, v3, v2
    v_lshlrev_b32 v3, 4, v3
    v_lshlrev_b32 v6, 7, v4
    v_add_u32 v3, v3, v6
    v_mul_u32_u24 v7, 144, v4
    v_lshlrev_b32 v6, 4, v2
    s_mul_i32 s45, s44, 4608
    s_add_u32 s45, s45, 131072
    v_add3_u32 v7, v7, v6, s45
    v_lshrrev_b32 v9, 3, v1
    v_mul_u32_u24 v8, 144, v9
    v_and_b32 v6, 7, v1
    v_lshlrev_b32 v6, 4, v6
    v_add3_u32 v8, v8, v6, s45
    v_lshlrev_b32 v11, 12, v9
    v_add_u32 v11, v11, v6
    v_lshlrev_b32 v2, 13, v2
    v_lshlrev_b32 v6, 4, v4
    v_add_u32 v2, v2, v6
    v_lshrrev_b32 v6, 3, v1
    v_lshrrev_b32 v9, 4, v1
    v_and_b32 v4, 7, v1
    v_xor_b32 v9, v9, v4
    v_lshlrev_b32 v9, 4, v9
    v_lshlrev_b32 v6, 8, v6
    v_add_u32 v6, v6, v9
    v_xor_b32 v9, 64, v6
    v_add_u32 v9, 2048, v9
    v_lshlrev_b32 v10, 4, v1
    v_lshlrev_b32 v12, 2, v1
    v_lshlrev_b32 v5, 7, v1
    s_lshl_b32 s61, s41, 7
    s_lshl_b32 s45, s43, 2
    s_add_u32 s61, s61, s45
    s_lshl_b32 s45, s42, 4
    s_add_u32 s61, s61, s45
    s_add_u32 s61, s61, 0x10000
    s_mul_i32 s64, s42, 24576
    s_add_u32 s64, s64, 0x12000
    s_lshl_b32 s45, s41, 7
    s_add_u32 s65, s64, s45
    s_lshl_b32 s45, s43, 13
    s_add_u32 s65, s65, s45
    s_add_u32 s67, s65, 4096
    v_mov_b32 v30, 0
    v_mov_b32 v31, 0
    s_mov_b64 exec, 1
    buffer_store_dword v30, v31, s[12:15], s61 offen sc1
    buffer_store_dword v30, v31, s[12:15], s65 offen sc1
    buffer_store_dword v30, v31, s[12:15], s67 offen sc1
    s_mov_b64 exec, -1
    s_cmp_lg_u32 s42, 0
    s_cbranch_scc1 L_w_kv_110
    s_lshl_b32 s63, s39, 2
    s_add_u32 s63, s63, s44
    s_load_dwordx2 s[4:5], s[0:1], 96
    s_load_dwordx2 s[6:7], s[0:1], 104
    v_and_b32 v14, 7, v0
    v_lshrrev_b32 v15, 3, v0
    s_waitcnt lgkmcnt(0)
    s_mov_b32 s32, s4
    s_and_b32 s33, s5, 0xffff
    s_mov_b32 s34, 0x800
    s_mov_b32 s35, 0x00020000
    s_mov_b32 s24, s6
    s_and_b32 s25, s7, 0xffff
    s_mov_b32 s26, 0xc00000
    s_mov_b32 s27, 0x00020000
    s_and_b32 s47, s39, 1
    s_lshl_b32 s45, s47, 10
    v_lshlrev_b32 v16, 5, v15
    buffer_load_dwordx4 v[104:107], v16, s[32:35], s45 offen
    buffer_load_dwordx4 v[108:111], v16, s[32:35], s45 offen offset:16
    s_mov_b32 s45, 196608
    v_mul_lo_u32 v17, v15, s45
    v_lshlrev_b32 v18, 4, v14
    v_add_u32 v17, v17, v18
    s_lshr_b32 s46, s39, 1
    s_lshl_b32 s46, s46, 7
    s_mul_i32 s45, s47, 6291456
    s_add_u32 s46, s46, s45
    buffer_load_dwordx4 v[32:35], v17, s[24:27], s46 offen nt
    v_add_u32 v17, 12288, v17
    buffer_load_dwordx4 v[36:39], v17, s[24:27], s46 offen nt
    v_add_u32 v17, 12288, v17
    buffer_load_dwordx4 v[40:43], v17, s[24:27], s46 offen nt
    v_add_u32 v17, 12288, v17
    buffer_load_dwordx4 v[44:47], v17, s[24:27], s46 offen nt
    v_add_u32 v17, 12288, v17
    buffer_load_dwordx4 v[48:51], v17, s[24:27], s46 offen nt
    v_add_u32 v17, 12288, v17
    buffer_load_dwordx4 v[52:55], v17, s[24:27], s46 offen nt
    v_add_u32 v17, 12288, v17
    buffer_load_dwordx4 v[56:59], v17, s[24:27], s46 offen nt
    v_add_u32 v17, 12288, v17
    buffer_load_dwordx4 v[60:63], v17, s[24:27], s46 offen nt
    v_add_u32 v17, 12288, v17
    buffer_load_dwordx4 v[64:67], v17, s[24:27], s46 offen nt
    v_add_u32 v17, 12288, v17
    buffer_load_dwordx4 v[68:71], v17, s[24:27], s46 offen nt
    v_add_u32 v17, 12288, v17
    buffer_load_dwordx4 v[72:75], v17, s[24:27], s46 offen nt
    v_add_u32 v17, 12288, v17
    buffer_load_dwordx4 v[76:79], v17, s[24:27], s46 offen nt
    v_add_u32 v17, 12288, v17
    buffer_load_dwordx4 v[80:83], v17, s[24:27], s46 offen nt
    v_add_u32 v17, 12288, v17
    buffer_load_dwordx4 v[84:87], v17, s[24:27], s46 offen nt
    v_add_u32 v17, 12288, v17
    buffer_load_dwordx4 v[88:91], v17, s[24:27], s46 offen nt
    v_add_u32 v17, 12288, v17
    buffer_load_dwordx4 v[92:95], v17, s[24:27], s46 offen nt
    s_add_u32 s45, s63, 0
    s_lshl_b32 s45, s45, 11
    buffer_load_dwordx4 v[128:131], v10, s[28:31], s45 offen nt
    buffer_load_dwordx4 v[132:135], v10, s[28:31], s45 offen offset:1024 nt
    s_add_u32 s45, s63, 384
    s_lshl_b32 s45, s45, 11
    buffer_load_dwordx4 v[136:139], v10, s[28:31], s45 offen nt
    buffer_load_dwordx4 v[140:143], v10, s[28:31], s45 offen offset:1024 nt
    s_add_u32 s45, s63, 768
    s_lshl_b32 s45, s45, 11
    buffer_load_dwordx4 v[144:147], v10, s[28:31], s45 offen nt
    buffer_load_dwordx4 v[148:151], v10, s[28:31], s45 offen offset:1024 nt
    s_add_u32 s45, s63, 1152
    s_lshl_b32 s45, s45, 11
    buffer_load_dwordx4 v[152:155], v10, s[28:31], s45 offen nt
    buffer_load_dwordx4 v[156:159], v10, s[28:31], s45 offen offset:1024 nt
    s_add_u32 s45, s63, 1536
    s_lshl_b32 s45, s45, 11
    buffer_load_dwordx4 v[160:163], v10, s[28:31], s45 offen nt
    buffer_load_dwordx4 v[164:167], v10, s[28:31], s45 offen offset:1024 nt
    s_add_u32 s45, s63, 1920
    s_lshl_b32 s45, s45, 11
    buffer_load_dwordx4 v[168:171], v10, s[28:31], s45 offen nt
    buffer_load_dwordx4 v[172:175], v10, s[28:31], s45 offen offset:1024 nt
    s_waitcnt vmcnt(28)
    v_lshlrev_b32 v112, 16, v104
    v_and_b32 v113, 0xffff0000, v104
    v_lshlrev_b32 v114, 16, v105
    v_and_b32 v115, 0xffff0000, v105
    v_lshlrev_b32 v116, 16, v106
    v_and_b32 v117, 0xffff0000, v106
    v_lshlrev_b32 v118, 16, v107
    v_and_b32 v119, 0xffff0000, v107
    v_lshlrev_b32 v120, 16, v108
    v_and_b32 v121, 0xffff0000, v108
    v_lshlrev_b32 v122, 16, v109
    v_and_b32 v123, 0xffff0000, v109
    v_lshlrev_b32 v124, 16, v110
    v_and_b32 v125, 0xffff0000, v110
    v_lshlrev_b32 v126, 16, v111
    v_and_b32 v127, 0xffff0000, v111
    v_mul_f32 v18, 0xbfb8aa3b, v112
    v_exp_f32 v18, v18
    s_nop 0
    v_add_f32 v18, 1.0, v18
    v_rcp_f32 v18, v18
    s_nop 0
    v_mul_f32 v112, v112, v18
    v_cvt_pk_bf16_f32 v112, v112, v112
    v_lshlrev_b32 v112, 16, v112
    v_mul_f32 v18, 0xbfb8aa3b, v113
    v_exp_f32 v18, v18
    s_nop 0
    v_add_f32 v18, 1.0, v18
    v_rcp_f32 v18, v18
    s_nop 0
    v_mul_f32 v113, v113, v18
    v_cvt_pk_bf16_f32 v113, v113, v113
    v_lshlrev_b32 v113, 16, v113
    v_mul_f32 v18, 0xbfb8aa3b, v114
    v_exp_f32 v18, v18
    s_nop 0
    v_add_f32 v18, 1.0, v18
    v_rcp_f32 v18, v18
    s_nop 0
    v_mul_f32 v114, v114, v18
    v_cvt_pk_bf16_f32 v114, v114, v114
    v_lshlrev_b32 v114, 16, v114
    v_mul_f32 v18, 0xbfb8aa3b, v115
    v_exp_f32 v18, v18
    s_nop 0
    v_add_f32 v18, 1.0, v18
    v_rcp_f32 v18, v18
    s_nop 0
    v_mul_f32 v115, v115, v18
    v_cvt_pk_bf16_f32 v115, v115, v115
    v_lshlrev_b32 v115, 16, v115
    v_mul_f32 v18, 0xbfb8aa3b, v116
    v_exp_f32 v18, v18
    s_nop 0
    v_add_f32 v18, 1.0, v18
    v_rcp_f32 v18, v18
    s_nop 0
    v_mul_f32 v116, v116, v18
    v_cvt_pk_bf16_f32 v116, v116, v116
    v_lshlrev_b32 v116, 16, v116
    v_mul_f32 v18, 0xbfb8aa3b, v117
    v_exp_f32 v18, v18
    s_nop 0
    v_add_f32 v18, 1.0, v18
    v_rcp_f32 v18, v18
    s_nop 0
    v_mul_f32 v117, v117, v18
    v_cvt_pk_bf16_f32 v117, v117, v117
    v_lshlrev_b32 v117, 16, v117
    v_mul_f32 v18, 0xbfb8aa3b, v118
    v_exp_f32 v18, v18
    s_nop 0
    v_add_f32 v18, 1.0, v18
    v_rcp_f32 v18, v18
    s_nop 0
    v_mul_f32 v118, v118, v18
    v_cvt_pk_bf16_f32 v118, v118, v118
    v_lshlrev_b32 v118, 16, v118
    v_mul_f32 v18, 0xbfb8aa3b, v119
    v_exp_f32 v18, v18
    s_nop 0
    v_add_f32 v18, 1.0, v18
    v_rcp_f32 v18, v18
    s_nop 0
    v_mul_f32 v119, v119, v18
    v_cvt_pk_bf16_f32 v119, v119, v119
    v_lshlrev_b32 v119, 16, v119
    v_mul_f32 v18, 0xbfb8aa3b, v120
    v_exp_f32 v18, v18
    s_nop 0
    v_add_f32 v18, 1.0, v18
    v_rcp_f32 v18, v18
    s_nop 0
    v_mul_f32 v120, v120, v18
    v_cvt_pk_bf16_f32 v120, v120, v120
    v_lshlrev_b32 v120, 16, v120
    v_mul_f32 v18, 0xbfb8aa3b, v121
    v_exp_f32 v18, v18
    s_nop 0
    v_add_f32 v18, 1.0, v18
    v_rcp_f32 v18, v18
    s_nop 0
    v_mul_f32 v121, v121, v18
    v_cvt_pk_bf16_f32 v121, v121, v121
    v_lshlrev_b32 v121, 16, v121
    v_mul_f32 v18, 0xbfb8aa3b, v122
    v_exp_f32 v18, v18
    s_nop 0
    v_add_f32 v18, 1.0, v18
    v_rcp_f32 v18, v18
    s_nop 0
    v_mul_f32 v122, v122, v18
    v_cvt_pk_bf16_f32 v122, v122, v122
    v_lshlrev_b32 v122, 16, v122
    v_mul_f32 v18, 0xbfb8aa3b, v123
    v_exp_f32 v18, v18
    s_nop 0
    v_add_f32 v18, 1.0, v18
    v_rcp_f32 v18, v18
    s_nop 0
    v_mul_f32 v123, v123, v18
    v_cvt_pk_bf16_f32 v123, v123, v123
    v_lshlrev_b32 v123, 16, v123
    v_mul_f32 v18, 0xbfb8aa3b, v124
    v_exp_f32 v18, v18
    s_nop 0
    v_add_f32 v18, 1.0, v18
    v_rcp_f32 v18, v18
    s_nop 0
    v_mul_f32 v124, v124, v18
    v_cvt_pk_bf16_f32 v124, v124, v124
    v_lshlrev_b32 v124, 16, v124
    v_mul_f32 v18, 0xbfb8aa3b, v125
    v_exp_f32 v18, v18
    s_nop 0
    v_add_f32 v18, 1.0, v18
    v_rcp_f32 v18, v18
    s_nop 0
    v_mul_f32 v125, v125, v18
    v_cvt_pk_bf16_f32 v125, v125, v125
    v_lshlrev_b32 v125, 16, v125
    v_mul_f32 v18, 0xbfb8aa3b, v126
    v_exp_f32 v18, v18
    s_nop 0
    v_add_f32 v18, 1.0, v18
    v_rcp_f32 v18, v18
    s_nop 0
    v_mul_f32 v126, v126, v18
    v_cvt_pk_bf16_f32 v126, v126, v126
    v_lshlrev_b32 v126, 16, v126
    v_mul_f32 v18, 0xbfb8aa3b, v127
    v_exp_f32 v18, v18
    s_nop 0
    v_add_f32 v18, 1.0, v18
    v_rcp_f32 v18, v18
    s_nop 0
    v_mul_f32 v127, v127, v18
    v_cvt_pk_bf16_f32 v127, v127, v127
    v_lshlrev_b32 v127, 16, v127
    v_mov_b32 v96, 0
    v_mov_b32 v97, 0
    v_mov_b32 v98, 0
    v_mov_b32 v99, 0
    v_mov_b32 v100, 0
    v_mov_b32 v101, 0
    v_mov_b32 v102, 0
    v_mov_b32 v103, 0
    s_waitcnt vmcnt(27)
    v_lshlrev_b32 v18, 16, v32
    v_and_b32 v19, 0xffff0000, v32
    v_fmac_f32 v96, v18, v112
    v_fmac_f32 v97, v19, v112
    v_lshlrev_b32 v18, 16, v33
    v_and_b32 v19, 0xffff0000, v33
    v_fmac_f32 v98, v18, v112
    v_fmac_f32 v99, v19, v112
    v_lshlrev_b32 v18, 16, v34
    v_and_b32 v19, 0xffff0000, v34
    v_fmac_f32 v100, v18, v112
    v_fmac_f32 v101, v19, v112
    v_lshlrev_b32 v18, 16, v35
    v_and_b32 v19, 0xffff0000, v35
    v_fmac_f32 v102, v18, v112
    v_fmac_f32 v103, v19, v112
    s_waitcnt vmcnt(26)
    v_lshlrev_b32 v18, 16, v36
    v_and_b32 v19, 0xffff0000, v36
    v_fmac_f32 v96, v18, v113
    v_fmac_f32 v97, v19, v113
    v_lshlrev_b32 v18, 16, v37
    v_and_b32 v19, 0xffff0000, v37
    v_fmac_f32 v98, v18, v113
    v_fmac_f32 v99, v19, v113
    v_lshlrev_b32 v18, 16, v38
    v_and_b32 v19, 0xffff0000, v38
    v_fmac_f32 v100, v18, v113
    v_fmac_f32 v101, v19, v113
    v_lshlrev_b32 v18, 16, v39
    v_and_b32 v19, 0xffff0000, v39
    v_fmac_f32 v102, v18, v113
    v_fmac_f32 v103, v19, v113
    s_waitcnt vmcnt(25)
    v_lshlrev_b32 v18, 16, v40
    v_and_b32 v19, 0xffff0000, v40
    v_fmac_f32 v96, v18, v114
    v_fmac_f32 v97, v19, v114
    v_lshlrev_b32 v18, 16, v41
    v_and_b32 v19, 0xffff0000, v41
    v_fmac_f32 v98, v18, v114
    v_fmac_f32 v99, v19, v114
    v_lshlrev_b32 v18, 16, v42
    v_and_b32 v19, 0xffff0000, v42
    v_fmac_f32 v100, v18, v114
    v_fmac_f32 v101, v19, v114
    v_lshlrev_b32 v18, 16, v43
    v_and_b32 v19, 0xffff0000, v43
    v_fmac_f32 v102, v18, v114
    v_fmac_f32 v103, v19, v114
    s_waitcnt vmcnt(24)
    v_lshlrev_b32 v18, 16, v44
    v_and_b32 v19, 0xffff0000, v44
    v_fmac_f32 v96, v18, v115
    v_fmac_f32 v97, v19, v115
    v_lshlrev_b32 v18, 16, v45
    v_and_b32 v19, 0xffff0000, v45
    v_fmac_f32 v98, v18, v115
    v_fmac_f32 v99, v19, v115
    v_lshlrev_b32 v18, 16, v46
    v_and_b32 v19, 0xffff0000, v46
    v_fmac_f32 v100, v18, v115
    v_fmac_f32 v101, v19, v115
    v_lshlrev_b32 v18, 16, v47
    v_and_b32 v19, 0xffff0000, v47
    v_fmac_f32 v102, v18, v115
    v_fmac_f32 v103, v19, v115
    s_waitcnt vmcnt(23)
    v_lshlrev_b32 v18, 16, v48
    v_and_b32 v19, 0xffff0000, v48
    v_fmac_f32 v96, v18, v116
    v_fmac_f32 v97, v19, v116
    v_lshlrev_b32 v18, 16, v49
    v_and_b32 v19, 0xffff0000, v49
    v_fmac_f32 v98, v18, v116
    v_fmac_f32 v99, v19, v116
    v_lshlrev_b32 v18, 16, v50
    v_and_b32 v19, 0xffff0000, v50
    v_fmac_f32 v100, v18, v116
    v_fmac_f32 v101, v19, v116
    v_lshlrev_b32 v18, 16, v51
    v_and_b32 v19, 0xffff0000, v51
    v_fmac_f32 v102, v18, v116
    v_fmac_f32 v103, v19, v116
    s_waitcnt vmcnt(22)
    v_lshlrev_b32 v18, 16, v52
    v_and_b32 v19, 0xffff0000, v52
    v_fmac_f32 v96, v18, v117
    v_fmac_f32 v97, v19, v117
    v_lshlrev_b32 v18, 16, v53
    v_and_b32 v19, 0xffff0000, v53
    v_fmac_f32 v98, v18, v117
    v_fmac_f32 v99, v19, v117
    v_lshlrev_b32 v18, 16, v54
    v_and_b32 v19, 0xffff0000, v54
    v_fmac_f32 v100, v18, v117
    v_fmac_f32 v101, v19, v117
    v_lshlrev_b32 v18, 16, v55
    v_and_b32 v19, 0xffff0000, v55
    v_fmac_f32 v102, v18, v117
    v_fmac_f32 v103, v19, v117
    s_waitcnt vmcnt(21)
    v_lshlrev_b32 v18, 16, v56
    v_and_b32 v19, 0xffff0000, v56
    v_fmac_f32 v96, v18, v118
    v_fmac_f32 v97, v19, v118
    v_lshlrev_b32 v18, 16, v57
    v_and_b32 v19, 0xffff0000, v57
    v_fmac_f32 v98, v18, v118
    v_fmac_f32 v99, v19, v118
    v_lshlrev_b32 v18, 16, v58
    v_and_b32 v19, 0xffff0000, v58
    v_fmac_f32 v100, v18, v118
    v_fmac_f32 v101, v19, v118
    v_lshlrev_b32 v18, 16, v59
    v_and_b32 v19, 0xffff0000, v59
    v_fmac_f32 v102, v18, v118
    v_fmac_f32 v103, v19, v118
    s_waitcnt vmcnt(20)
    v_lshlrev_b32 v18, 16, v60
    v_and_b32 v19, 0xffff0000, v60
    v_fmac_f32 v96, v18, v119
    v_fmac_f32 v97, v19, v119
    v_lshlrev_b32 v18, 16, v61
    v_and_b32 v19, 0xffff0000, v61
    v_fmac_f32 v98, v18, v119
    v_fmac_f32 v99, v19, v119
    v_lshlrev_b32 v18, 16, v62
    v_and_b32 v19, 0xffff0000, v62
    v_fmac_f32 v100, v18, v119
    v_fmac_f32 v101, v19, v119
    v_lshlrev_b32 v18, 16, v63
    v_and_b32 v19, 0xffff0000, v63
    v_fmac_f32 v102, v18, v119
    v_fmac_f32 v103, v19, v119
    s_waitcnt vmcnt(19)
    v_lshlrev_b32 v18, 16, v64
    v_and_b32 v19, 0xffff0000, v64
    v_fmac_f32 v96, v18, v120
    v_fmac_f32 v97, v19, v120
    v_lshlrev_b32 v18, 16, v65
    v_and_b32 v19, 0xffff0000, v65
    v_fmac_f32 v98, v18, v120
    v_fmac_f32 v99, v19, v120
    v_lshlrev_b32 v18, 16, v66
    v_and_b32 v19, 0xffff0000, v66
    v_fmac_f32 v100, v18, v120
    v_fmac_f32 v101, v19, v120
    v_lshlrev_b32 v18, 16, v67
    v_and_b32 v19, 0xffff0000, v67
    v_fmac_f32 v102, v18, v120
    v_fmac_f32 v103, v19, v120
    s_waitcnt vmcnt(18)
    v_lshlrev_b32 v18, 16, v68
    v_and_b32 v19, 0xffff0000, v68
    v_fmac_f32 v96, v18, v121
    v_fmac_f32 v97, v19, v121
    v_lshlrev_b32 v18, 16, v69
    v_and_b32 v19, 0xffff0000, v69
    v_fmac_f32 v98, v18, v121
    v_fmac_f32 v99, v19, v121
    v_lshlrev_b32 v18, 16, v70
    v_and_b32 v19, 0xffff0000, v70
    v_fmac_f32 v100, v18, v121
    v_fmac_f32 v101, v19, v121
    v_lshlrev_b32 v18, 16, v71
    v_and_b32 v19, 0xffff0000, v71
    v_fmac_f32 v102, v18, v121
    v_fmac_f32 v103, v19, v121
    s_waitcnt vmcnt(17)
    v_lshlrev_b32 v18, 16, v72
    v_and_b32 v19, 0xffff0000, v72
    v_fmac_f32 v96, v18, v122
    v_fmac_f32 v97, v19, v122
    v_lshlrev_b32 v18, 16, v73
    v_and_b32 v19, 0xffff0000, v73
    v_fmac_f32 v98, v18, v122
    v_fmac_f32 v99, v19, v122
    v_lshlrev_b32 v18, 16, v74
    v_and_b32 v19, 0xffff0000, v74
    v_fmac_f32 v100, v18, v122
    v_fmac_f32 v101, v19, v122
    v_lshlrev_b32 v18, 16, v75
    v_and_b32 v19, 0xffff0000, v75
    v_fmac_f32 v102, v18, v122
    v_fmac_f32 v103, v19, v122
    s_waitcnt vmcnt(16)
    v_lshlrev_b32 v18, 16, v76
    v_and_b32 v19, 0xffff0000, v76
    v_fmac_f32 v96, v18, v123
    v_fmac_f32 v97, v19, v123
    v_lshlrev_b32 v18, 16, v77
    v_and_b32 v19, 0xffff0000, v77
    v_fmac_f32 v98, v18, v123
    v_fmac_f32 v99, v19, v123
    v_lshlrev_b32 v18, 16, v78
    v_and_b32 v19, 0xffff0000, v78
    v_fmac_f32 v100, v18, v123
    v_fmac_f32 v101, v19, v123
    v_lshlrev_b32 v18, 16, v79
    v_and_b32 v19, 0xffff0000, v79
    v_fmac_f32 v102, v18, v123
    v_fmac_f32 v103, v19, v123
    s_waitcnt vmcnt(15)
    v_lshlrev_b32 v18, 16, v80
    v_and_b32 v19, 0xffff0000, v80
    v_fmac_f32 v96, v18, v124
    v_fmac_f32 v97, v19, v124
    v_lshlrev_b32 v18, 16, v81
    v_and_b32 v19, 0xffff0000, v81
    v_fmac_f32 v98, v18, v124
    v_fmac_f32 v99, v19, v124
    v_lshlrev_b32 v18, 16, v82
    v_and_b32 v19, 0xffff0000, v82
    v_fmac_f32 v100, v18, v124
    v_fmac_f32 v101, v19, v124
    v_lshlrev_b32 v18, 16, v83
    v_and_b32 v19, 0xffff0000, v83
    v_fmac_f32 v102, v18, v124
    v_fmac_f32 v103, v19, v124
    s_waitcnt vmcnt(14)
    v_lshlrev_b32 v18, 16, v84
    v_and_b32 v19, 0xffff0000, v84
    v_fmac_f32 v96, v18, v125
    v_fmac_f32 v97, v19, v125
    v_lshlrev_b32 v18, 16, v85
    v_and_b32 v19, 0xffff0000, v85
    v_fmac_f32 v98, v18, v125
    v_fmac_f32 v99, v19, v125
    v_lshlrev_b32 v18, 16, v86
    v_and_b32 v19, 0xffff0000, v86
    v_fmac_f32 v100, v18, v125
    v_fmac_f32 v101, v19, v125
    v_lshlrev_b32 v18, 16, v87
    v_and_b32 v19, 0xffff0000, v87
    v_fmac_f32 v102, v18, v125
    v_fmac_f32 v103, v19, v125
    s_waitcnt vmcnt(13)
    v_lshlrev_b32 v18, 16, v88
    v_and_b32 v19, 0xffff0000, v88
    v_fmac_f32 v96, v18, v126
    v_fmac_f32 v97, v19, v126
    v_lshlrev_b32 v18, 16, v89
    v_and_b32 v19, 0xffff0000, v89
    v_fmac_f32 v98, v18, v126
    v_fmac_f32 v99, v19, v126
    v_lshlrev_b32 v18, 16, v90
    v_and_b32 v19, 0xffff0000, v90
    v_fmac_f32 v100, v18, v126
    v_fmac_f32 v101, v19, v126
    v_lshlrev_b32 v18, 16, v91
    v_and_b32 v19, 0xffff0000, v91
    v_fmac_f32 v102, v18, v126
    v_fmac_f32 v103, v19, v126
    s_waitcnt vmcnt(12)
    v_lshlrev_b32 v18, 16, v92
    v_and_b32 v19, 0xffff0000, v92
    v_fmac_f32 v96, v18, v127
    v_fmac_f32 v97, v19, v127
    v_lshlrev_b32 v18, 16, v93
    v_and_b32 v19, 0xffff0000, v93
    v_fmac_f32 v98, v18, v127
    v_fmac_f32 v99, v19, v127
    v_lshlrev_b32 v18, 16, v94
    v_and_b32 v19, 0xffff0000, v94
    v_fmac_f32 v100, v18, v127
    v_fmac_f32 v101, v19, v127
    v_lshlrev_b32 v18, 16, v95
    v_and_b32 v19, 0xffff0000, v95
    v_fmac_f32 v102, v18, v127
    v_fmac_f32 v103, v19, v127
    v_lshlrev_b32 v16, 5, v0
    ds_write_b128 v16, v[96:99]
    ds_write_b128 v16, v[100:103] offset:16
    s_waitcnt lgkmcnt(0)
    s_barrier
    s_cmp_lg_u32 s44, 0
    s_cbranch_scc1 L_mod_fin_112
    v_mov_b32 v18, 0
    ds_read_b32 v32, v12 offset:0
    ds_read_b32 v33, v12 offset:256
    ds_read_b32 v34, v12 offset:512
    ds_read_b32 v35, v12 offset:768
    ds_read_b32 v36, v12 offset:1024
    ds_read_b32 v37, v12 offset:1280
    ds_read_b32 v38, v12 offset:1536
    ds_read_b32 v39, v12 offset:1792
    ds_read_b32 v40, v12 offset:2048
    ds_read_b32 v41, v12 offset:2304
    ds_read_b32 v42, v12 offset:2560
    ds_read_b32 v43, v12 offset:2816
    ds_read_b32 v44, v12 offset:3072
    ds_read_b32 v45, v12 offset:3328
    ds_read_b32 v46, v12 offset:3584
    ds_read_b32 v47, v12 offset:3840
    s_waitcnt lgkmcnt(0)
    v_add_f32 v18, v18, v32
    v_add_f32 v18, v18, v33
    v_add_f32 v18, v18, v34
    v_add_f32 v18, v18, v35
    v_add_f32 v18, v18, v36
    v_add_f32 v18, v18, v37
    v_add_f32 v18, v18, v38
    v_add_f32 v18, v18, v39
    v_add_f32 v18, v18, v40
    v_add_f32 v18, v18, v41
    v_add_f32 v18, v18, v42
    v_add_f32 v18, v18, v43
    v_add_f32 v18, v18, v44
    v_add_f32 v18, v18, v45
    v_add_f32 v18, v18, v46
    v_add_f32 v18, v18, v47
    ds_read_b32 v32, v12 offset:4096
    ds_read_b32 v33, v12 offset:4352
    ds_read_b32 v34, v12 offset:4608
    ds_read_b32 v35, v12 offset:4864
    ds_read_b32 v36, v12 offset:5120
    ds_read_b32 v37, v12 offset:5376
    ds_read_b32 v38, v12 offset:5632
    ds_read_b32 v39, v12 offset:5888
    ds_read_b32 v40, v12 offset:6144
    ds_read_b32 v41, v12 offset:6400
    ds_read_b32 v42, v12 offset:6656
    ds_read_b32 v43, v12 offset:6912
    ds_read_b32 v44, v12 offset:7168
    ds_read_b32 v45, v12 offset:7424
    ds_read_b32 v46, v12 offset:7680
    ds_read_b32 v47, v12 offset:7936
    s_waitcnt lgkmcnt(0)
    v_add_f32 v18, v18, v32
    v_add_f32 v18, v18, v33
    v_add_f32 v18, v18, v34
    v_add_f32 v18, v18, v35
    v_add_f32 v18, v18, v36
    v_add_f32 v18, v18, v37
    v_add_f32 v18, v18, v38
    v_add_f32 v18, v18, v39
    v_add_f32 v18, v18, v40
    v_add_f32 v18, v18, v41
    v_add_f32 v18, v18, v42
    v_add_f32 v18, v18, v43
    v_add_f32 v18, v18, v44
    v_add_f32 v18, v18, v45
    v_add_f32 v18, v18, v46
    v_add_f32 v18, v18, v47
    s_lshr_b32 s45, s39, 1
    s_lshl_b32 s45, s45, 8
    s_mul_i32 s46, s47, 24576
    s_add_u32 s45, s45, s46
    buffer_store_dword v18, v12, s[12:15], s45 offen sc1
L_mod_fin_112:
    s_waitcnt vmcnt(0)
    s_barrier
    s_cmp_lg_u32 s44, 0
    s_cbranch_scc1 L_cnt_113
    v_mov_b32 v30, 1
    v_mov_b32 v31, 0
    s_mov_b64 exec, 1
    buffer_atomic_add v30, v31, s[16:19], 0 offen offset:128 sc1
    buffer_atomic_add v30, v31, s[16:19], 0 offen offset:64 sc1
    s_mov_b64 exec, -1
L_cnt_113:
    v_lshlrev_b32 v192, 16, v128
    v_and_b32 v193, 0xffff0000, v128
    v_lshlrev_b32 v194, 16, v129
    v_and_b32 v195, 0xffff0000, v129
    v_lshlrev_b32 v196, 16, v130
    v_and_b32 v197, 0xffff0000, v130
    v_lshlrev_b32 v198, 16, v131
    v_and_b32 v199, 0xffff0000, v131
    v_lshlrev_b32 v200, 16, v132
    v_and_b32 v201, 0xffff0000, v132
    v_lshlrev_b32 v202, 16, v133
    v_and_b32 v203, 0xffff0000, v133
    v_lshlrev_b32 v204, 16, v134
    v_and_b32 v205, 0xffff0000, v134
    v_lshlrev_b32 v206, 16, v135
    v_and_b32 v207, 0xffff0000, v135
    v_add_f32 v26, v192, v193
    v_add_f32 v26, v26, v194
    v_add_f32 v26, v26, v195
    v_add_f32 v26, v26, v196
    v_add_f32 v26, v26, v197
    v_add_f32 v26, v26, v198
    v_add_f32 v26, v26, v199
    v_add_f32 v26, v26, v200
    v_add_f32 v26, v26, v201
    v_add_f32 v26, v26, v202
    v_add_f32 v26, v26, v203
    v_add_f32 v26, v26, v204
    v_add_f32 v26, v26, v205
    v_add_f32 v26, v26, v206
    v_add_f32 v26, v26, v207
    s_nop 1
    v_add_f32_dpp v26, v26, v26 row_shr:1 row_mask:0xf bank_mask:0xf bound_ctrl:0
    s_nop 1
    v_add_f32_dpp v26, v26, v26 row_shr:2 row_mask:0xf bank_mask:0xf bound_ctrl:0
    s_nop 1
    v_add_f32_dpp v26, v26, v26 row_shr:4 row_mask:0xf bank_mask:0xf bound_ctrl:0
    s_nop 1
    v_add_f32_dpp v26, v26, v26 row_shr:8 row_mask:0xf bank_mask:0xf bound_ctrl:0
    s_nop 1
    v_add_f32_dpp v26, v26, v26 row_bcast:15 row_mask:0xa bank_mask:0xf
    s_nop 1
    v_add_f32_dpp v26, v26, v26 row_bcast:31 row_mask:0xc bank_mask:0xf
    s_nop 1
    v_readlane_b32 s66, v26, 63
    s_nop 1
    v_mov_b32 v27, s66
    v_mul_f32 v27, 0x3a800000, v27
    v_mov_b32 v26, 0
    v_sub_f32 v28, v192, v27
    v_fmac_f32 v26, v28, v28
    v_sub_f32 v28, v193, v27
    v_fmac_f32 v26, v28, v28
    v_sub_f32 v28, v194, v27
    v_fmac_f32 v26, v28, v28
    v_sub_f32 v28, v195, v27
    v_fmac_f32 v26, v28, v28
    v_sub_f32 v28, v196, v27
    v_fmac_f32 v26, v28, v28
    v_sub_f32 v28, v197, v27
    v_fmac_f32 v26, v28, v28
    v_sub_f32 v28, v198, v27
    v_fmac_f32 v26, v28, v28
    v_sub_f32 v28, v199, v27
    v_fmac_f32 v26, v28, v28
    v_sub_f32 v28, v200, v27
    v_fmac_f32 v26, v28, v28
    v_sub_f32 v28, v201, v27
    v_fmac_f32 v26, v28, v28
    v_sub_f32 v28, v202, v27
    v_fmac_f32 v26, v28, v28
    v_sub_f32 v28, v203, v27
    v_fmac_f32 v26, v28, v28
    v_sub_f32 v28, v204, v27
    v_fmac_f32 v26, v28, v28
    v_sub_f32 v28, v205, v27
    v_fmac_f32 v26, v28, v28
    v_sub_f32 v28, v206, v27
    v_fmac_f32 v26, v28, v28
    v_sub_f32 v28, v207, v27
    v_fmac_f32 v26, v28, v28
    s_nop 1
    v_add_f32_dpp v26, v26, v26 row_shr:1 row_mask:0xf bank_mask:0xf bound_ctrl:0
    s_nop 1
    v_add_f32_dpp v26, v26, v26 row_shr:2 row_mask:0xf bank_mask:0xf bound_ctrl:0
    s_nop 1
    v_add_f32_dpp v26, v26, v26 row_shr:4 row_mask:0xf bank_mask:0xf bound_ctrl:0
    s_nop 1
    v_add_f32_dpp v26, v26, v26 row_shr:8 row_mask:0xf bank_mask:0xf bound_ctrl:0
    s_nop 1
    v_add_f32_dpp v26, v26, v26 row_bcast:15 row_mask:0xa bank_mask:0xf
    s_nop 1
    v_add_f32_dpp v26, v26, v26 row_bcast:31 row_mask:0xc bank_mask:0xf
    s_nop 1
    v_readlane_b32 s66, v26, 63
    s_nop 1
    v_mov_b32 v26, s66
    v_mul_f32 v26, 0x3a800000, v26
    v_cvt_pk_bf16_f32 v26, v26, v26
    v_lshlrev_b32 v26, 16, v26
    v_cvt_pk_bf16_f32 v27, v27, v27
    v_lshlrev_b32 v27, 16, v27
    v_add_f32 v26, 0x3727c5ac, v26
    v_cvt_pk_bf16_f32 v26, v26, v26
    v_lshlrev_b32 v26, 16, v26
    v_sqrt_f32 v26, v26
    s_nop 0
    v_cvt_pk_bf16_f32 v26, v26, v26
    v_lshlrev_b32 v26, 16, v26
    v_rcp_f32 v26, v26
    s_nop 0
    v_sub_f32 v192, v192, v27
    v_cvt_pk_bf16_f32 v192, v192, v192
    v_lshlrev_b32 v192, 16, v192
    v_mul_f32 v192, v192, v26
    v_cvt_pk_bf16_f32 v192, v192, v192
    v_lshlrev_b32 v192, 16, v192
    v_sub_f32 v193, v193, v27
    v_cvt_pk_bf16_f32 v193, v193, v193
    v_lshlrev_b32 v193, 16, v193
    v_mul_f32 v193, v193, v26
    v_cvt_pk_bf16_f32 v193, v193, v193
    v_lshlrev_b32 v193, 16, v193
    v_sub_f32 v194, v194, v27
    v_cvt_pk_bf16_f32 v194, v194, v194
    v_lshlrev_b32 v194, 16, v194
    v_mul_f32 v194, v194, v26
    v_cvt_pk_bf16_f32 v194, v194, v194
    v_lshlrev_b32 v194, 16, v194
    v_sub_f32 v195, v195, v27
    v_cvt_pk_bf16_f32 v195, v195, v195
    v_lshlrev_b32 v195, 16, v195
    v_mul_f32 v195, v195, v26
    v_cvt_pk_bf16_f32 v195, v195, v195
    v_lshlrev_b32 v195, 16, v195
    v_sub_f32 v196, v196, v27
    v_cvt_pk_bf16_f32 v196, v196, v196
    v_lshlrev_b32 v196, 16, v196
    v_mul_f32 v196, v196, v26
    v_cvt_pk_bf16_f32 v196, v196, v196
    v_lshlrev_b32 v196, 16, v196
    v_sub_f32 v197, v197, v27
    v_cvt_pk_bf16_f32 v197, v197, v197
    v_lshlrev_b32 v197, 16, v197
    v_mul_f32 v197, v197, v26
    v_cvt_pk_bf16_f32 v197, v197, v197
    v_lshlrev_b32 v197, 16, v197
    v_sub_f32 v198, v198, v27
    v_cvt_pk_bf16_f32 v198, v198, v198
    v_lshlrev_b32 v198, 16, v198
    v_mul_f32 v198, v198, v26
    v_cvt_pk_bf16_f32 v198, v198, v198
    v_lshlrev_b32 v198, 16, v198
    v_sub_f32 v199, v199, v27
    v_cvt_pk_bf16_f32 v199, v199, v199
    v_lshlrev_b32 v199, 16, v199
    v_mul_f32 v199, v199, v26
    v_cvt_pk_bf16_f32 v199, v199, v199
    v_lshlrev_b32 v199, 16, v199
    v_sub_f32 v200, v200, v27
    v_cvt_pk_bf16_f32 v200, v200, v200
    v_lshlrev_b32 v200, 16, v200
    v_mul_f32 v200, v200, v26
    v_cvt_pk_bf16_f32 v200, v200, v200
    v_lshlrev_b32 v200, 16, v200
    v_sub_f32 v201, v201, v27
    v_cvt_pk_bf16_f32 v201, v201, v201
    v_lshlrev_b32 v201, 16, v201
    v_mul_f32 v201, v201, v26
    v_cvt_pk_bf16_f32 v201, v201, v201
    v_lshlrev_b32 v201, 16, v201
    v_sub_f32 v202, v202, v27
    v_cvt_pk_bf16_f32 v202, v202, v202
    v_lshlrev_b32 v202, 16, v202
    v_mul_f32 v202, v202, v26
    v_cvt_pk_bf16_f32 v202, v202, v202
    v_lshlrev_b32 v202, 16, v202
    v_sub_f32 v203, v203, v27
    v_cvt_pk_bf16_f32 v203, v203, v203
    v_lshlrev_b32 v203, 16, v203
    v_mul_f32 v203, v203, v26
    v_cvt_pk_bf16_f32 v203, v203, v203
    v_lshlrev_b32 v203, 16, v203
    v_sub_f32 v204, v204, v27
    v_cvt_pk_bf16_f32 v204, v204, v204
    v_lshlrev_b32 v204, 16, v204
    v_mul_f32 v204, v204, v26
    v_cvt_pk_bf16_f32 v204, v204, v204
    v_lshlrev_b32 v204, 16, v204
    v_sub_f32 v205, v205, v27
    v_cvt_pk_bf16_f32 v205, v205, v205
    v_lshlrev_b32 v205, 16, v205
    v_mul_f32 v205, v205, v26
    v_cvt_pk_bf16_f32 v205, v205, v205
    v_lshlrev_b32 v205, 16, v205
    v_sub_f32 v206, v206, v27
    v_cvt_pk_bf16_f32 v206, v206, v206
    v_lshlrev_b32 v206, 16, v206
    v_mul_f32 v206, v206, v26
    v_cvt_pk_bf16_f32 v206, v206, v206
    v_lshlrev_b32 v206, 16, v206
    v_sub_f32 v207, v207, v27
    v_cvt_pk_bf16_f32 v207, v207, v207
    v_lshlrev_b32 v207, 16, v207
    v_mul_f32 v207, v207, v26
    v_cvt_pk_bf16_f32 v207, v207, v207
    v_lshlrev_b32 v207, 16, v207
    v_lshlrev_b32 v208, 16, v136
    v_and_b32 v209, 0xffff0000, v136
    v_lshlrev_b32 v210, 16, v137
    v_and_b32 v211, 0xffff0000, v137
    v_lshlrev_b32 v212, 16, v138
    v_and_b32 v213, 0xffff0000, v138
    v_lshlrev_b32 v214, 16, v139
    v_and_b32 v215, 0xffff0000, v139
    v_lshlrev_b32 v216, 16, v140
    v_and_b32 v217, 0xffff0000, v140
    v_lshlrev_b32 v218, 16, v141
    v_and_b32 v219, 0xffff0000, v141
    v_lshlrev_b32 v220, 16, v142
    v_and_b32 v221, 0xffff0000, v142
    v_lshlrev_b32 v222, 16, v143
    v_and_b32 v223, 0xffff0000, v143
    v_add_f32 v26, v208, v209
    v_add_f32 v26, v26, v210
    v_add_f32 v26, v26, v211
    v_add_f32 v26, v26, v212
    v_add_f32 v26, v26, v213
    v_add_f32 v26, v26, v214
    v_add_f32 v26, v26, v215
    v_add_f32 v26, v26, v216
    v_add_f32 v26, v26, v217
    v_add_f32 v26, v26, v218
    v_add_f32 v26, v26, v219
    v_add_f32 v26, v26, v220
    v_add_f32 v26, v26, v221
    v_add_f32 v26, v26, v222
    v_add_f32 v26, v26, v223
    s_nop 1
    v_add_f32_dpp v26, v26, v26 row_shr:1 row_mask:0xf bank_mask:0xf bound_ctrl:0
    s_nop 1
    v_add_f32_dpp v26, v26, v26 row_shr:2 row_mask:0xf bank_mask:0xf bound_ctrl:0
    s_nop 1
    v_add_f32_dpp v26, v26, v26 row_shr:4 row_mask:0xf bank_mask:0xf bound_ctrl:0
    s_nop 1
    v_add_f32_dpp v26, v26, v26 row_shr:8 row_mask:0xf bank_mask:0xf bound_ctrl:0
    s_nop 1
    v_add_f32_dpp v26, v26, v26 row_bcast:15 row_mask:0xa bank_mask:0xf
    s_nop 1
    v_add_f32_dpp v26, v26, v26 row_bcast:31 row_mask:0xc bank_mask:0xf
    s_nop 1
    v_readlane_b32 s66, v26, 63
    s_nop 1
    v_mov_b32 v27, s66
    v_mul_f32 v27, 0x3a800000, v27
    v_mov_b32 v26, 0
    v_sub_f32 v28, v208, v27
    v_fmac_f32 v26, v28, v28
    v_sub_f32 v28, v209, v27
    v_fmac_f32 v26, v28, v28
    v_sub_f32 v28, v210, v27
    v_fmac_f32 v26, v28, v28
    v_sub_f32 v28, v211, v27
    v_fmac_f32 v26, v28, v28
    v_sub_f32 v28, v212, v27
    v_fmac_f32 v26, v28, v28
    v_sub_f32 v28, v213, v27
    v_fmac_f32 v26, v28, v28
    v_sub_f32 v28, v214, v27
    v_fmac_f32 v26, v28, v28
    v_sub_f32 v28, v215, v27
    v_fmac_f32 v26, v28, v28
    v_sub_f32 v28, v216, v27
    v_fmac_f32 v26, v28, v28
    v_sub_f32 v28, v217, v27
    v_fmac_f32 v26, v28, v28
    v_sub_f32 v28, v218, v27
    v_fmac_f32 v26, v28, v28
    v_sub_f32 v28, v219, v27
    v_fmac_f32 v26, v28, v28
    v_sub_f32 v28, v220, v27
    v_fmac_f32 v26, v28, v28
    v_sub_f32 v28, v221, v27
    v_fmac_f32 v26, v28, v28
    v_sub_f32 v28, v222, v27
    v_fmac_f32 v26, v28, v28
    v_sub_f32 v28, v223, v27
    v_fmac_f32 v26, v28, v28
    s_nop 1
    v_add_f32_dpp v26, v26, v26 row_shr:1 row_mask:0xf bank_mask:0xf bound_ctrl:0
    s_nop 1
    v_add_f32_dpp v26, v26, v26 row_shr:2 row_mask:0xf bank_mask:0xf bound_ctrl:0
    s_nop 1
    v_add_f32_dpp v26, v26, v26 row_shr:4 row_mask:0xf bank_mask:0xf bound_ctrl:0
    s_nop 1
    v_add_f32_dpp v26, v26, v26 row_shr:8 row_mask:0xf bank_mask:0xf bound_ctrl:0
    s_nop 1
    v_add_f32_dpp v26, v26, v26 row_bcast:15 row_mask:0xa bank_mask:0xf
    s_nop 1
    v_add_f32_dpp v26, v26, v26 row_bcast:31 row_mask:0xc bank_mask:0xf
    s_nop 1
    v_readlane_b32 s66, v26, 63
    s_nop 1
    v_mov_b32 v26, s66
    v_mul_f32 v26, 0x3a800000, v26
    v_cvt_pk_bf16_f32 v26, v26, v26
    v_lshlrev_b32 v26, 16, v26
    v_cvt_pk_bf16_f32 v27, v27, v27
    v_lshlrev_b32 v27, 16, v27
    v_add_f32 v26, 0x3727c5ac, v26
    v_cvt_pk_bf16_f32 v26, v26, v26
    v_lshlrev_b32 v26, 16, v26
    v_sqrt_f32 v26, v26
    s_nop 0
    v_cvt_pk_bf16_f32 v26, v26, v26
    v_lshlrev_b32 v26, 16, v26
    v_rcp_f32 v26, v26
    s_nop 0
    v_sub_f32 v208, v208, v27
    v_cvt_pk_bf16_f32 v208, v208, v208
    v_lshlrev_b32 v208, 16, v208
    v_mul_f32 v208, v208, v26
    v_cvt_pk_bf16_f32 v208, v208, v208
    v_lshlrev_b32 v208, 16, v208
    v_sub_f32 v209, v209, v27
    v_cvt_pk_bf16_f32 v209, v209, v209
    v_lshlrev_b32 v209, 16, v209
    v_mul_f32 v209, v209, v26
    v_cvt_pk_bf16_f32 v209, v209, v209
    v_lshlrev_b32 v209, 16, v209
    v_sub_f32 v210, v210, v27
    v_cvt_pk_bf16_f32 v210, v210, v210
    v_lshlrev_b32 v210, 16, v210
    v_mul_f32 v210, v210, v26
    v_cvt_pk_bf16_f32 v210, v210, v210
    v_lshlrev_b32 v210, 16, v210
    v_sub_f32 v211, v211, v27
    v_cvt_pk_bf16_f32 v211, v211, v211
    v_lshlrev_b32 v211, 16, v211
    v_mul_f32 v211, v211, v26
    v_cvt_pk_bf16_f32 v211, v211, v211
    v_lshlrev_b32 v211, 16, v211
    v_sub_f32 v212, v212, v27
    v_cvt_pk_bf16_f32 v212, v212, v212
    v_lshlrev_b32 v212, 16, v212
    v_mul_f32 v212, v212, v26
    v_cvt_pk_bf16_f32 v212, v212, v212
    v_lshlrev_b32 v212, 16, v212
    v_sub_f32 v213, v213, v27
    v_cvt_pk_bf16_f32 v213, v213, v213
    v_lshlrev_b32 v213, 16, v213
    v_mul_f32 v213, v213, v26
    v_cvt_pk_bf16_f32 v213, v213, v213
    v_lshlrev_b32 v213, 16, v213
    v_sub_f32 v214, v214, v27
    v_cvt_pk_bf16_f32 v214, v214, v214
    v_lshlrev_b32 v214, 16, v214
    v_mul_f32 v214, v214, v26
    v_cvt_pk_bf16_f32 v214, v214, v214
    v_lshlrev_b32 v214, 16, v214
    v_sub_f32 v215, v215, v27
    v_cvt_pk_bf16_f32 v215, v215, v215
    v_lshlrev_b32 v215, 16, v215
    v_mul_f32 v215, v215, v26
    v_cvt_pk_bf16_f32 v215, v215, v215
    v_lshlrev_b32 v215, 16, v215
    v_sub_f32 v216, v216, v27
    v_cvt_pk_bf16_f32 v216, v216, v216
    v_lshlrev_b32 v216, 16, v216
    v_mul_f32 v216, v216, v26
    v_cvt_pk_bf16_f32 v216, v216, v216
    v_lshlrev_b32 v216, 16, v216
    v_sub_f32 v217, v217, v27
    v_cvt_pk_bf16_f32 v217, v217, v217
    v_lshlrev_b32 v217, 16, v217
    v_mul_f32 v217, v217, v26
    v_cvt_pk_bf16_f32 v217, v217, v217
    v_lshlrev_b32 v217, 16, v217
    v_sub_f32 v218, v218, v27
    v_cvt_pk_bf16_f32 v218, v218, v218
    v_lshlrev_b32 v218, 16, v218
    v_mul_f32 v218, v218, v26
    v_cvt_pk_bf16_f32 v218, v218, v218
    v_lshlrev_b32 v218, 16, v218
    v_sub_f32 v219, v219, v27
    v_cvt_pk_bf16_f32 v219, v219, v219
    v_lshlrev_b32 v219, 16, v219
    v_mul_f32 v219, v219, v26
    v_cvt_pk_bf16_f32 v219, v219, v219
    v_lshlrev_b32 v219, 16, v219
    v_sub_f32 v220, v220, v27
    v_cvt_pk_bf16_f32 v220, v220, v220
    v_lshlrev_b32 v220, 16, v220
    v_mul_f32 v220, v220, v26
    v_cvt_pk_bf16_f32 v220, v220, v220
    v_lshlrev_b32 v220, 16, v220
    v_sub_f32 v221, v221, v27
    v_cvt_pk_bf16_f32 v221, v221, v221
    v_lshlrev_b32 v221, 16, v221
    v_mul_f32 v221, v221, v26
    v_cvt_pk_bf16_f32 v221, v221, v221
    v_lshlrev_b32 v221, 16, v221
    v_sub_f32 v222, v222, v27
    v_cvt_pk_bf16_f32 v222, v222, v222
    v_lshlrev_b32 v222, 16, v222
    v_mul_f32 v222, v222, v26
    v_cvt_pk_bf16_f32 v222, v222, v222
    v_lshlrev_b32 v222, 16, v222
    v_sub_f32 v223, v223, v27
    v_cvt_pk_bf16_f32 v223, v223, v223
    v_lshlrev_b32 v223, 16, v223
    v_mul_f32 v223, v223, v26
    v_cvt_pk_bf16_f32 v223, v223, v223
    v_lshlrev_b32 v223, 16, v223
    s_cmp_lg_u32 s44, 0
    s_cbranch_scc1 L_pd_114
    v_mov_b32 v29, 128
    s_mov_b32 s46, 96
    s_mov_b64 exec, 1
    s_mov_b32 s70, 0
L_wp_115:
    buffer_load_dword v31, v29, s[16:19], 0 offen sc1
    s_add_u32 s70, s70, 1
    s_cmp_ge_u32 s70, 0x200000
    s_cbranch_scc1 L_w_done_109
    s_waitcnt vmcnt(0)
    v_cmp_gt_u32 vcc, s46, v31
    s_nop 1
    s_cbranch_vccz L_wp_115_ok
    s_sleep 1
    s_branch L_wp_115
L_wp_115_ok:
    s_mov_b64 exec, -1
L_pd_114:
    s_barrier
    v_lshlrev_b32 v29, 5, v1
    s_mov_b32 s45, 0
    buffer_load_dwordx4 v[96:99], v29, s[12:15], s45 offen offset:0 sc1
    buffer_load_dwordx4 v[100:103], v29, s[12:15], s45 offen offset:16 sc1
    buffer_load_dwordx4 v[104:107], v29, s[12:15], s45 offen offset:2048 sc1
    buffer_load_dwordx4 v[108:111], v29, s[12:15], s45 offen offset:2064 sc1
    s_mov_b32 s45, 24576
    buffer_load_dwordx4 v[32:35], v29, s[12:15], s45 offen offset:0 sc1
    buffer_load_dwordx4 v[36:39], v29, s[12:15], s45 offen offset:16 sc1
    buffer_load_dwordx4 v[40:43], v29, s[12:15], s45 offen offset:2048 sc1
    buffer_load_dwordx4 v[44:47], v29, s[12:15], s45 offen offset:2064 sc1
    s_mov_b32 s45, 4096
    buffer_load_dwordx4 v[112:115], v29, s[12:15], s45 offen offset:0 sc1
    buffer_load_dwordx4 v[116:119], v29, s[12:15], s45 offen offset:16 sc1
    buffer_load_dwordx4 v[120:123], v29, s[12:15], s45 offen offset:2048 sc1
    buffer_load_dwordx4 v[124:127], v29, s[12:15], s45 offen offset:2064 sc1
    s_mov_b32 s45, 28672
    buffer_load_dwordx4 v[48:51], v29, s[12:15], s45 offen offset:0 sc1
    buffer_load_dwordx4 v[52:55], v29, s[12:15], s45 offen offset:16 sc1
    buffer_load_dwordx4 v[56:59], v29, s[12:15], s45 offen offset:2048 sc1
    buffer_load_dwordx4 v[60:63], v29, s[12:15], s45 offen offset:2064 sc1
    s_waitcnt vmcnt(0)
    v_add_f32 v96, v96, v32
    v_cvt_pk_bf16_f32 v96, v96, v96
    v_lshlrev_b32 v96, 16, v96
    v_add_f32 v97, v97, v33
    v_cvt_pk_bf16_f32 v97, v97, v97
    v_lshlrev_b32 v97, 16, v97
    v_add_f32 v98, v98, v34
    v_cvt_pk_bf16_f32 v98, v98, v98
    v_lshlrev_b32 v98, 16, v98
    v_add_f32 v99, v99, v35
    v_cvt_pk_bf16_f32 v99, v99, v99
    v_lshlrev_b32 v99, 16, v99
    v_add_f32 v100, v100, v36
    v_cvt_pk_bf16_f32 v100, v100, v100
    v_lshlrev_b32 v100, 16, v100
    v_add_f32 v101, v101, v37
    v_cvt_pk_bf16_f32 v101, v101, v101
    v_lshlrev_b32 v101, 16, v101
    v_add_f32 v102, v102, v38
    v_cvt_pk_bf16_f32 v102, v102, v102
    v_lshlrev_b32 v102, 16, v102
    v_add_f32 v103, v103, v39
    v_cvt_pk_bf16_f32 v103, v103, v103
    v_lshlrev_b32 v103, 16, v103
    v_add_f32 v104, v104, v40
    v_cvt_pk_bf16_f32 v104, v104, v104
    v_lshlrev_b32 v104, 16, v104
    v_add_f32 v105, v105, v41
    v_cvt_pk_bf16_f32 v105, v105, v105
    v_lshlrev_b32 v105, 16, v105
    v_add_f32 v106, v106, v42
    v_cvt_pk_bf16_f32 v106, v106, v106
    v_lshlrev_b32 v106, 16, v106
    v_add_f32 v107, v107, v43
    v_cvt_pk_bf16_f32 v107, v107, v107
    v_lshlrev_b32 v107, 16, v107
    v_add_f32 v108, v108, v44
    v_cvt_pk_bf16_f32 v108, v108, v108
    v_lshlrev_b32 v108, 16, v108
    v_add_f32 v109, v109, v45
    v_cvt_pk_bf16_f32 v109, v109, v109
    v_lshlrev_b32 v109, 16, v109
    v_add_f32 v110, v110, v46
    v_cvt_pk_bf16_f32 v110, v110, v110
    v_lshlrev_b32 v110, 16, v110
    v_add_f32 v111, v111, v47
    v_cvt_pk_bf16_f32 v111, v111, v111
    v_lshlrev_b32 v111, 16, v111
    v_add_f32 v112, v112, v48
    v_cvt_pk_bf16_f32 v112, v112, v112
    v_lshlrev_b32 v112, 16, v112
    v_add_f32 v112, 1.0, v112
    v_cvt_pk_bf16_f32 v112, v112, v112
    v_lshlrev_b32 v112, 16, v112
    v_add_f32 v113, v113, v49
    v_cvt_pk_bf16_f32 v113, v113, v113
    v_lshlrev_b32 v113, 16, v113
    v_add_f32 v113, 1.0, v113
    v_cvt_pk_bf16_f32 v113, v113, v113
    v_lshlrev_b32 v113, 16, v113
    v_add_f32 v114, v114, v50
    v_cvt_pk_bf16_f32 v114, v114, v114
    v_lshlrev_b32 v114, 16, v114
    v_add_f32 v114, 1.0, v114
    v_cvt_pk_bf16_f32 v114, v114, v114
    v_lshlrev_b32 v114, 16, v114
    v_add_f32 v115, v115, v51
    v_cvt_pk_bf16_f32 v115, v115, v115
    v_lshlrev_b32 v115, 16, v115
    v_add_f32 v115, 1.0, v115
    v_cvt_pk_bf16_f32 v115, v115, v115
    v_lshlrev_b32 v115, 16, v115
    v_add_f32 v116, v116, v52
    v_cvt_pk_bf16_f32 v116, v116, v116
    v_lshlrev_b32 v116, 16, v116
    v_add_f32 v116, 1.0, v116
    v_cvt_pk_bf16_f32 v116, v116, v116
    v_lshlrev_b32 v116, 16, v116
    v_add_f32 v117, v117, v53
    v_cvt_pk_bf16_f32 v117, v117, v117
    v_lshlrev_b32 v117, 16, v117
    v_add_f32 v117, 1.0, v117
    v_cvt_pk_bf16_f32 v117, v117, v117
    v_lshlrev_b32 v117, 16, v117
    v_add_f32 v118, v118, v54
    v_cvt_pk_bf16_f32 v118, v118, v118
    v_lshlrev_b32 v118, 16, v118
    v_add_f32 v118, 1.0, v118
    v_cvt_pk_bf16_f32 v118, v118, v118
    v_lshlrev_b32 v118, 16, v118
    v_add_f32 v119, v119, v55
    v_cvt_pk_bf16_f32 v119, v119, v119
    v_lshlrev_b32 v119, 16, v119
    v_add_f32 v119, 1.0, v119
    v_cvt_pk_bf16_f32 v119, v119, v119
    v_lshlrev_b32 v119, 16, v119
    v_add_f32 v120, v120, v56
    v_cvt_pk_bf16_f32 v120, v120, v120
    v_lshlrev_b32 v120, 16, v120
    v_add_f32 v120, 1.0, v120
    v_cvt_pk_bf16_f32 v120, v120, v120
    v_lshlrev_b32 v120, 16, v120
    v_add_f32 v121, v121, v57
    v_cvt_pk_bf16_f32 v121, v121, v121
    v_lshlrev_b32 v121, 16, v121
    v_add_f32 v121, 1.0, v121
    v_cvt_pk_bf16_f32 v121, v121, v121
    v_lshlrev_b32 v121, 16, v121
    v_add_f32 v122, v122, v58
    v_cvt_pk_bf16_f32 v122, v122, v122
    v_lshlrev_b32 v122, 16, v122
    v_add_f32 v122, 1.0, v122
    v_cvt_pk_bf16_f32 v122, v122, v122
    v_lshlrev_b32 v122, 16, v122
    v_add_f32 v123, v123, v59
    v_cvt_pk_bf16_f32 v123, v123, v123
    v_lshlrev_b32 v123, 16, v123
    v_add_f32 v123, 1.0, v123
    v_cvt_pk_bf16_f32 v123, v123, v123
    v_lshlrev_b32 v123, 16, v123
    v_add_f32 v124, v124, v60
    v_cvt_pk_bf16_f32 v124, v124, v124
    v_lshlrev_b32 v124, 16, v124
    v_add_f32 v124, 1.0, v124
    v_cvt_pk_bf16_f32 v124, v124, v124
    v_lshlrev_b32 v124, 16, v124
    v_add_f32 v125, v125, v61
    v_cvt_pk_bf16_f32 v125, v125, v125
    v_lshlrev_b32 v125, 16, v125
    v_add_f32 v125, 1.0, v125
    v_cvt_pk_bf16_f32 v125, v125, v125
    v_lshlrev_b32 v125, 16, v125
    v_add_f32 v126, v126, v62
    v_cvt_pk_bf16_f32 v126, v126, v126
    v_lshlrev_b32 v126, 16, v126
    v_add_f32 v126, 1.0, v126
    v_cvt_pk_bf16_f32 v126, v126, v126
    v_lshlrev_b32 v126, 16, v126
    v_add_f32 v127, v127, v63
    v_cvt_pk_bf16_f32 v127, v127, v127
    v_lshlrev_b32 v127, 16, v127
    v_add_f32 v127, 1.0, v127
    v_cvt_pk_bf16_f32 v127, v127, v127
    v_lshlrev_b32 v127, 16, v127
    v_mul_f32 v192, v192, v112
    v_cvt_pk_bf16_f32 v192, v192, v192
    v_lshlrev_b32 v192, 16, v192
    v_add_f32 v192, v192, v96
    v_mul_f32 v193, v193, v113
    v_cvt_pk_bf16_f32 v193, v193, v193
    v_lshlrev_b32 v193, 16, v193
    v_add_f32 v193, v193, v97
    v_mul_f32 v194, v194, v114
    v_cvt_pk_bf16_f32 v194, v194, v194
    v_lshlrev_b32 v194, 16, v194
    v_add_f32 v194, v194, v98
    v_mul_f32 v195, v195, v115
    v_cvt_pk_bf16_f32 v195, v195, v195
    v_lshlrev_b32 v195, 16, v195
    v_add_f32 v195, v195, v99
    v_mul_f32 v196, v196, v116
    v_cvt_pk_bf16_f32 v196, v196, v196
    v_lshlrev_b32 v196, 16, v196
    v_add_f32 v196, v196, v100
    v_mul_f32 v197, v197, v117
    v_cvt_pk_bf16_f32 v197, v197, v197
    v_lshlrev_b32 v197, 16, v197
    v_add_f32 v197, v197, v101
    v_mul_f32 v198, v198, v118
    v_cvt_pk_bf16_f32 v198, v198, v198
    v_lshlrev_b32 v198, 16, v198
    v_add_f32 v198, v198, v102
    v_mul_f32 v199, v199, v119
    v_cvt_pk_bf16_f32 v199, v199, v199
    v_lshlrev_b32 v199, 16, v199
    v_add_f32 v199, v199, v103
    v_mul_f32 v200, v200, v120
    v_cvt_pk_bf16_f32 v200, v200, v200
    v_lshlrev_b32 v200, 16, v200
    v_add_f32 v200, v200, v104
    v_mul_f32 v201, v201, v121
    v_cvt_pk_bf16_f32 v201, v201, v201
    v_lshlrev_b32 v201, 16, v201
    v_add_f32 v201, v201, v105
    v_mul_f32 v202, v202, v122
    v_cvt_pk_bf16_f32 v202, v202, v202
    v_lshlrev_b32 v202, 16, v202
    v_add_f32 v202, v202, v106
    v_mul_f32 v203, v203, v123
    v_cvt_pk_bf16_f32 v203, v203, v203
    v_lshlrev_b32 v203, 16, v203
    v_add_f32 v203, v203, v107
    v_mul_f32 v204, v204, v124
    v_cvt_pk_bf16_f32 v204, v204, v204
    v_lshlrev_b32 v204, 16, v204
    v_add_f32 v204, v204, v108
    v_mul_f32 v205, v205, v125
    v_cvt_pk_bf16_f32 v205, v205, v205
    v_lshlrev_b32 v205, 16, v205
    v_add_f32 v205, v205, v109
    v_mul_f32 v206, v206, v126
    v_cvt_pk_bf16_f32 v206, v206, v206
    v_lshlrev_b32 v206, 16, v206
    v_add_f32 v206, v206, v110
    v_mul_f32 v207, v207, v127
    v_cvt_pk_bf16_f32 v207, v207, v207
    v_lshlrev_b32 v207, 16, v207
    v_add_f32 v207, v207, v111
    v_cvt_pk_bf16_f32 v80, v192, v193
    v_cvt_pk_bf16_f32 v81, v194, v195
    v_cvt_pk_bf16_f32 v82, v196, v197
    v_cvt_pk_bf16_f32 v83, v198, v199
    v_cvt_pk_bf16_f32 v84, v200, v201
    v_cvt_pk_bf16_f32 v85, v202, v203
    v_cvt_pk_bf16_f32 v86, v204, v205
    v_cvt_pk_bf16_f32 v87, v206, v207
    s_lshr_b32 s45, s63, 5
    s_lshl_b32 s45, s45, 16
    s_and_b32 s46, s63, 31
    s_lshl_b32 s46, s46, 8
    s_add_u32 s45, s45, s46
    s_add_u32 s45, s45, 0x400000
    s_add_u32 s46, s45, 32768
    buffer_store_dwordx4 v[80:83], v2, s[12:15], s45 offen sc1
    buffer_store_dwordx4 v[84:87], v2, s[12:15], s46 offen sc1
    s_add_u32 s63, s63, 384
    v_mul_f32 v208, v208, v112
    v_cvt_pk_bf16_f32 v208, v208, v208
    v_lshlrev_b32 v208, 16, v208
    v_add_f32 v208, v208, v96
    v_mul_f32 v209, v209, v113
    v_cvt_pk_bf16_f32 v209, v209, v209
    v_lshlrev_b32 v209, 16, v209
    v_add_f32 v209, v209, v97
    v_mul_f32 v210, v210, v114
    v_cvt_pk_bf16_f32 v210, v210, v210
    v_lshlrev_b32 v210, 16, v210
    v_add_f32 v210, v210, v98
    v_mul_f32 v211, v211, v115
    v_cvt_pk_bf16_f32 v211, v211, v211
    v_lshlrev_b32 v211, 16, v211
    v_add_f32 v211, v211, v99
    v_mul_f32 v212, v212, v116
    v_cvt_pk_bf16_f32 v212, v212, v212
    v_lshlrev_b32 v212, 16, v212
    v_add_f32 v212, v212, v100
    v_mul_f32 v213, v213, v117
    v_cvt_pk_bf16_f32 v213, v213, v213
    v_lshlrev_b32 v213, 16, v213
    v_add_f32 v213, v213, v101
    v_mul_f32 v214, v214, v118
    v_cvt_pk_bf16_f32 v214, v214, v214
    v_lshlrev_b32 v214, 16, v214
    v_add_f32 v214, v214, v102
    v_mul_f32 v215, v215, v119
    v_cvt_pk_bf16_f32 v215, v215, v215
    v_lshlrev_b32 v215, 16, v215
    v_add_f32 v215, v215, v103
    v_mul_f32 v216, v216, v120
    v_cvt_pk_bf16_f32 v216, v216, v216
    v_lshlrev_b32 v216, 16, v216
    v_add_f32 v216, v216, v104
    v_mul_f32 v217, v217, v121
    v_cvt_pk_bf16_f32 v217, v217, v217
    v_lshlrev_b32 v217, 16, v217
    v_add_f32 v217, v217, v105
    v_mul_f32 v218, v218, v122
    v_cvt_pk_bf16_f32 v218, v218, v218
    v_lshlrev_b32 v218, 16, v218
    v_add_f32 v218, v218, v106
    v_mul_f32 v219, v219, v123
    v_cvt_pk_bf16_f32 v219, v219, v219
    v_lshlrev_b32 v219, 16, v219
    v_add_f32 v219, v219, v107
    v_mul_f32 v220, v220, v124
    v_cvt_pk_bf16_f32 v220, v220, v220
    v_lshlrev_b32 v220, 16, v220
    v_add_f32 v220, v220, v108
    v_mul_f32 v221, v221, v125
    v_cvt_pk_bf16_f32 v221, v221, v221
    v_lshlrev_b32 v221, 16, v221
    v_add_f32 v221, v221, v109
    v_mul_f32 v222, v222, v126
    v_cvt_pk_bf16_f32 v222, v222, v222
    v_lshlrev_b32 v222, 16, v222
    v_add_f32 v222, v222, v110
    v_mul_f32 v223, v223, v127
    v_cvt_pk_bf16_f32 v223, v223, v223
    v_lshlrev_b32 v223, 16, v223
    v_add_f32 v223, v223, v111
    v_cvt_pk_bf16_f32 v88, v208, v209
    v_cvt_pk_bf16_f32 v89, v210, v211
    v_cvt_pk_bf16_f32 v90, v212, v213
    v_cvt_pk_bf16_f32 v91, v214, v215
    v_cvt_pk_bf16_f32 v92, v216, v217
    v_cvt_pk_bf16_f32 v93, v218, v219
    v_cvt_pk_bf16_f32 v94, v220, v221
    v_cvt_pk_bf16_f32 v95, v222, v223
    s_lshr_b32 s45, s63, 5
    s_lshl_b32 s45, s45, 16
    s_and_b32 s46, s63, 31
    s_lshl_b32 s46, s46, 8
    s_add_u32 s45, s45, s46
    s_add_u32 s45, s45, 0x400000
    s_add_u32 s46, s45, 32768
    buffer_store_dwordx4 v[88:91], v2, s[12:15], s45 offen sc1
    buffer_store_dwordx4 v[92:95], v2, s[12:15], s46 offen sc1
    s_waitcnt vmcnt(2)
    s_barrier
    s_cmp_lg_u32 s44, 0
    s_cbranch_scc1 L_cnt_117
    v_mov_b32 v30, 1
    v_mov_b32 v31, 0
    s_mov_b64 exec, 1
    buffer_atomic_add v30, v31, s[16:19], 0 offen offset:192 sc1
    s_mov_b64 exec, -1
L_cnt_117:
    s_add_u32 s63, s63, 384
    v_lshlrev_b32 v64, 16, v144
    v_and_b32 v65, 0xffff0000, v144
    v_lshlrev_b32 v66, 16, v145
    v_and_b32 v67, 0xffff0000, v145
    v_lshlrev_b32 v68, 16, v146
    v_and_b32 v69, 0xffff0000, v146
    v_lshlrev_b32 v70, 16, v147
    v_and_b32 v71, 0xffff0000, v147
    v_lshlrev_b32 v72, 16, v148
    v_and_b32 v73, 0xffff0000, v148
    v_lshlrev_b32 v74, 16, v149
    v_and_b32 v75, 0xffff0000, v149
    v_lshlrev_b32 v76, 16, v150
    v_and_b32 v77, 0xffff0000, v150
    v_lshlrev_b32 v78, 16, v151
    v_and_b32 v79, 0xffff0000, v151
    v_add_f32 v26, v64, v65
    v_add_f32 v26, v26, v66
    v_add_f32 v26, v26, v67
    v_add_f32 v26, v26, v68
    v_add_f32 v26, v26, v69
    v_add_f32 v26, v26, v70
    v_add_f32 v26, v26, v71
    v_add_f32 v26, v26, v72
    v_add_f32 v26, v26, v73
    v_add_f32 v26, v26, v74
    v_add_f32 v26, v26, v75
    v_add_f32 v26, v26, v76
    v_add_f32 v26, v26, v77
    v_add_f32 v26, v26, v78
    v_add_f32 v26, v26, v79
    s_nop 1
    v_add_f32_dpp v26, v26, v26 row_shr:1 row_mask:0xf bank_mask:0xf bound_ctrl:0
    s_nop 1
    v_add_f32_dpp v26, v26, v26 row_shr:2 row_mask:0xf bank_mask:0xf bound_ctrl:0
    s_nop 1
    v_add_f32_dpp v26, v26, v26 row_shr:4 row_mask:0xf bank_mask:0xf bound_ctrl:0
    s_nop 1
    v_add_f32_dpp v26, v26, v26 row_shr:8 row_mask:0xf bank_mask:0xf bound_ctrl:0
    s_nop 1
    v_add_f32_dpp v26, v26, v26 row_bcast:15 row_mask:0xa bank_mask:0xf
    s_nop 1
    v_add_f32_dpp v26, v26, v26 row_bcast:31 row_mask:0xc bank_mask:0xf
    s_nop 1
    v_readlane_b32 s66, v26, 63
    s_nop 1
    v_mov_b32 v27, s66
    v_mul_f32 v27, 0x3a800000, v27
    v_mov_b32 v26, 0
    v_sub_f32 v28, v64, v27
    v_fmac_f32 v26, v28, v28
    v_sub_f32 v28, v65, v27
    v_fmac_f32 v26, v28, v28
    v_sub_f32 v28, v66, v27
    v_fmac_f32 v26, v28, v28
    v_sub_f32 v28, v67, v27
    v_fmac_f32 v26, v28, v28
    v_sub_f32 v28, v68, v27
    v_fmac_f32 v26, v28, v28
    v_sub_f32 v28, v69, v27
    v_fmac_f32 v26, v28, v28
    v_sub_f32 v28, v70, v27
    v_fmac_f32 v26, v28, v28
    v_sub_f32 v28, v71, v27
    v_fmac_f32 v26, v28, v28
    v_sub_f32 v28, v72, v27
    v_fmac_f32 v26, v28, v28
    v_sub_f32 v28, v73, v27
    v_fmac_f32 v26, v28, v28
    v_sub_f32 v28, v74, v27
    v_fmac_f32 v26, v28, v28
    v_sub_f32 v28, v75, v27
    v_fmac_f32 v26, v28, v28
    v_sub_f32 v28, v76, v27
    v_fmac_f32 v26, v28, v28
    v_sub_f32 v28, v77, v27
    v_fmac_f32 v26, v28, v28
    v_sub_f32 v28, v78, v27
    v_fmac_f32 v26, v28, v28
    v_sub_f32 v28, v79, v27
    v_fmac_f32 v26, v28, v28
    s_nop 1
    v_add_f32_dpp v26, v26, v26 row_shr:1 row_mask:0xf bank_mask:0xf bound_ctrl:0
    s_nop 1
    v_add_f32_dpp v26, v26, v26 row_shr:2 row_mask:0xf bank_mask:0xf bound_ctrl:0
    s_nop 1
    v_add_f32_dpp v26, v26, v26 row_shr:4 row_mask:0xf bank_mask:0xf bound_ctrl:0
    s_nop 1
    v_add_f32_dpp v26, v26, v26 row_shr:8 row_mask:0xf bank_mask:0xf bound_ctrl:0
    s_nop 1
    v_add_f32_dpp v26, v26, v26 row_bcast:15 row_mask:0xa bank_mask:0xf
    s_nop 1
    v_add_f32_dpp v26, v26, v26 row_bcast:31 row_mask:0xc bank_mask:0xf
    s_nop 1
    v_readlane_b32 s66, v26, 63
    s_nop 1
    v_mov_b32 v26, s66
    v_mul_f32 v26, 0x3a800000, v26
    v_cvt_pk_bf16_f32 v26, v26, v26
    v_lshlrev_b32 v26, 16, v26
    v_cvt_pk_bf16_f32 v27, v27, v27
    v_lshlrev_b32 v27, 16, v27
    v_add_f32 v26, 0x3727c5ac, v26
    v_cvt_pk_bf16_f32 v26, v26, v26
    v_lshlrev_b32 v26, 16, v26
    v_sqrt_f32 v26, v26
    s_nop 0
    v_cvt_pk_bf16_f32 v26, v26, v26
    v_lshlrev_b32 v26, 16, v26
    v_rcp_f32 v26, v26
    s_nop 0
    v_sub_f32 v64, v64, v27
    v_cvt_pk_bf16_f32 v64, v64, v64
    v_lshlrev_b32 v64, 16, v64
    v_mul_f32 v64, v64, v26
    v_cvt_pk_bf16_f32 v64, v64, v64
    v_lshlrev_b32 v64, 16, v64
    v_sub_f32 v65, v65, v27
    v_cvt_pk_bf16_f32 v65, v65, v65
    v_lshlrev_b32 v65, 16, v65
    v_mul_f32 v65, v65, v26
    v_cvt_pk_bf16_f32 v65, v65, v65
    v_lshlrev_b32 v65, 16, v65
    v_sub_f32 v66, v66, v27
    v_cvt_pk_bf16_f32 v66, v66, v66
    v_lshlrev_b32 v66, 16, v66
    v_mul_f32 v66, v66, v26
    v_cvt_pk_bf16_f32 v66, v66, v66
    v_lshlrev_b32 v66, 16, v66
    v_sub_f32 v67, v67, v27
    v_cvt_pk_bf16_f32 v67, v67, v67
    v_lshlrev_b32 v67, 16, v67
    v_mul_f32 v67, v67, v26
    v_cvt_pk_bf16_f32 v67, v67, v67
    v_lshlrev_b32 v67, 16, v67
    v_sub_f32 v68, v68, v27
    v_cvt_pk_bf16_f32 v68, v68, v68
    v_lshlrev_b32 v68, 16, v68
    v_mul_f32 v68, v68, v26
    v_cvt_pk_bf16_f32 v68, v68, v68
    v_lshlrev_b32 v68, 16, v68
    v_sub_f32 v69, v69, v27
    v_cvt_pk_bf16_f32 v69, v69, v69
    v_lshlrev_b32 v69, 16, v69
    v_mul_f32 v69, v69, v26
    v_cvt_pk_bf16_f32 v69, v69, v69
    v_lshlrev_b32 v69, 16, v69
    v_sub_f32 v70, v70, v27
    v_cvt_pk_bf16_f32 v70, v70, v70
    v_lshlrev_b32 v70, 16, v70
    v_mul_f32 v70, v70, v26
    v_cvt_pk_bf16_f32 v70, v70, v70
    v_lshlrev_b32 v70, 16, v70
    v_sub_f32 v71, v71, v27
    v_cvt_pk_bf16_f32 v71, v71, v71
    v_lshlrev_b32 v71, 16, v71
    v_mul_f32 v71, v71, v26
    v_cvt_pk_bf16_f32 v71, v71, v71
    v_lshlrev_b32 v71, 16, v71
    v_sub_f32 v72, v72, v27
    v_cvt_pk_bf16_f32 v72, v72, v72
    v_lshlrev_b32 v72, 16, v72
    v_mul_f32 v72, v72, v26
    v_cvt_pk_bf16_f32 v72, v72, v72
    v_lshlrev_b32 v72, 16, v72
    v_sub_f32 v73, v73, v27
    v_cvt_pk_bf16_f32 v73, v73, v73
    v_lshlrev_b32 v73, 16, v73
    v_mul_f32 v73, v73, v26
    v_cvt_pk_bf16_f32 v73, v73, v73
    v_lshlrev_b32 v73, 16, v73
    v_sub_f32 v74, v74, v27
    v_cvt_pk_bf16_f32 v74, v74, v74
    v_lshlrev_b32 v74, 16, v74
    v_mul_f32 v74, v74, v26
    v_cvt_pk_bf16_f32 v74, v74, v74
    v_lshlrev_b32 v74, 16, v74
    v_sub_f32 v75, v75, v27
    v_cvt_pk_bf16_f32 v75, v75, v75
    v_lshlrev_b32 v75, 16, v75
    v_mul_f32 v75, v75, v26
    v_cvt_pk_bf16_f32 v75, v75, v75
    v_lshlrev_b32 v75, 16, v75
    v_sub_f32 v76, v76, v27
    v_cvt_pk_bf16_f32 v76, v76, v76
    v_lshlrev_b32 v76, 16, v76
    v_mul_f32 v76, v76, v26
    v_cvt_pk_bf16_f32 v76, v76, v76
    v_lshlrev_b32 v76, 16, v76
    v_sub_f32 v77, v77, v27
    v_cvt_pk_bf16_f32 v77, v77, v77
    v_lshlrev_b32 v77, 16, v77
    v_mul_f32 v77, v77, v26
    v_cvt_pk_bf16_f32 v77, v77, v77
    v_lshlrev_b32 v77, 16, v77
    v_sub_f32 v78, v78, v27
    v_cvt_pk_bf16_f32 v78, v78, v78
    v_lshlrev_b32 v78, 16, v78
    v_mul_f32 v78, v78, v26
    v_cvt_pk_bf16_f32 v78, v78, v78
    v_lshlrev_b32 v78, 16, v78
    v_sub_f32 v79, v79, v27
    v_cvt_pk_bf16_f32 v79, v79, v79
    v_lshlrev_b32 v79, 16, v79
    v_mul_f32 v79, v79, v26
    v_cvt_pk_bf16_f32 v79, v79, v79
    v_lshlrev_b32 v79, 16, v79
    v_mul_f32 v64, v64, v112
    v_cvt_pk_bf16_f32 v64, v64, v64
    v_lshlrev_b32 v64, 16, v64
    v_add_f32 v64, v64, v96
    v_mul_f32 v65, v65, v113
    v_cvt_pk_bf16_f32 v65, v65, v65
    v_lshlrev_b32 v65, 16, v65
    v_add_f32 v65, v65, v97
    v_mul_f32 v66, v66, v114
    v_cvt_pk_bf16_f32 v66, v66, v66
    v_lshlrev_b32 v66, 16, v66
    v_add_f32 v66, v66, v98
    v_mul_f32 v67, v67, v115
    v_cvt_pk_bf16_f32 v67, v67, v67
    v_lshlrev_b32 v67, 16, v67
    v_add_f32 v67, v67, v99
    v_mul_f32 v68, v68, v116
    v_cvt_pk_bf16_f32 v68, v68, v68
    v_lshlrev_b32 v68, 16, v68
    v_add_f32 v68, v68, v100
    v_mul_f32 v69, v69, v117
    v_cvt_pk_bf16_f32 v69, v69, v69
    v_lshlrev_b32 v69, 16, v69
    v_add_f32 v69, v69, v101
    v_mul_f32 v70, v70, v118
    v_cvt_pk_bf16_f32 v70, v70, v70
    v_lshlrev_b32 v70, 16, v70
    v_add_f32 v70, v70, v102
    v_mul_f32 v71, v71, v119
    v_cvt_pk_bf16_f32 v71, v71, v71
    v_lshlrev_b32 v71, 16, v71
    v_add_f32 v71, v71, v103
    v_mul_f32 v72, v72, v120
    v_cvt_pk_bf16_f32 v72, v72, v72
    v_lshlrev_b32 v72, 16, v72
    v_add_f32 v72, v72, v104
    v_mul_f32 v73, v73, v121
    v_cvt_pk_bf16_f32 v73, v73, v73
    v_lshlrev_b32 v73, 16, v73
    v_add_f32 v73, v73, v105
    v_mul_f32 v74, v74, v122
    v_cvt_pk_bf16_f32 v74, v74, v74
    v_lshlrev_b32 v74, 16, v74
    v_add_f32 v74, v74, v106
    v_mul_f32 v75, v75, v123
    v_cvt_pk_bf16_f32 v75, v75, v75
    v_lshlrev_b32 v75, 16, v75
    v_add_f32 v75, v75, v107
    v_mul_f32 v76, v76, v124
    v_cvt_pk_bf16_f32 v76, v76, v76
    v_lshlrev_b32 v76, 16, v76
    v_add_f32 v76, v76, v108
    v_mul_f32 v77, v77, v125
    v_cvt_pk_bf16_f32 v77, v77, v77
    v_lshlrev_b32 v77, 16, v77
    v_add_f32 v77, v77, v109
    v_mul_f32 v78, v78, v126
    v_cvt_pk_bf16_f32 v78, v78, v78
    v_lshlrev_b32 v78, 16, v78
    v_add_f32 v78, v78, v110
    v_mul_f32 v79, v79, v127
    v_cvt_pk_bf16_f32 v79, v79, v79
    v_lshlrev_b32 v79, 16, v79
    v_add_f32 v79, v79, v111
    v_cvt_pk_bf16_f32 v80, v64, v65
    v_cvt_pk_bf16_f32 v81, v66, v67
    v_cvt_pk_bf16_f32 v82, v68, v69
    v_cvt_pk_bf16_f32 v83, v70, v71
    v_cvt_pk_bf16_f32 v84, v72, v73
    v_cvt_pk_bf16_f32 v85, v74, v75
    v_cvt_pk_bf16_f32 v86, v76, v77
    v_cvt_pk_bf16_f32 v87, v78, v79
    s_lshr_b32 s45, s63, 5
    s_lshl_b32 s45, s45, 16
    s_and_b32 s46, s63, 31
    s_lshl_b32 s46, s46, 8
    s_add_u32 s45, s45, s46
    s_add_u32 s45, s45, 0x400000
    s_add_u32 s46, s45, 32768
    buffer_store_dwordx4 v[80:83], v2, s[12:15], s45 offen sc1
    buffer_store_dwordx4 v[84:87], v2, s[12:15], s46 offen sc1
    s_add_u32 s63, s63, 384
    v_lshlrev_b32 v64, 16, v152
    v_and_b32 v65, 0xffff0000, v152
    v_lshlrev_b32 v66, 16, v153
    v_and_b32 v67, 0xffff0000, v153
    v_lshlrev_b32 v68, 16, v154
    v_and_b32 v69, 0xffff0000, v154
    v_lshlrev_b32 v70, 16, v155
    v_and_b32 v71, 0xffff0000, v155
    v_lshlrev_b32 v72, 16, v156
    v_and_b32 v73, 0xffff0000, v156
    v_lshlrev_b32 v74, 16, v157
    v_and_b32 v75, 0xffff0000, v157
    v_lshlrev_b32 v76, 16, v158
    v_and_b32 v77, 0xffff0000, v158
    v_lshlrev_b32 v78, 16, v159
    v_and_b32 v79, 0xffff0000, v159
    v_add_f32 v26, v64, v65
    v_add_f32 v26, v26, v66
    v_add_f32 v26, v26, v67
    v_add_f32 v26, v26, v68
    v_add_f32 v26, v26, v69
    v_add_f32 v26, v26, v70
    v_add_f32 v26, v26, v71
    v_add_f32 v26, v26, v72
    v_add_f32 v26, v26, v73
    v_add_f32 v26, v26, v74
    v_add_f32 v26, v26, v75
    v_add_f32 v26, v26, v76
    v_add_f32 v26, v26, v77
    v_add_f32 v26, v26, v78
    v_add_f32 v26, v26, v79
    s_nop 1
    v_add_f32_dpp v26, v26, v26 row_shr:1 row_mask:0xf bank_mask:0xf bound_ctrl:0
    s_nop 1
    v_add_f32_dpp v26, v26, v26 row_shr:2 row_mask:0xf bank_mask:0xf bound_ctrl:0
    s_nop 1
    v_add_f32_dpp v26, v26, v26 row_shr:4 row_mask:0xf bank_mask:0xf bound_ctrl:0
    s_nop 1
    v_add_f32_dpp v26, v26, v26 row_shr:8 row_mask:0xf bank_mask:0xf bound_ctrl:0
    s_nop 1
    v_add_f32_dpp v26, v26, v26 row_bcast:15 row_mask:0xa bank_mask:0xf
    s_nop 1
    v_add_f32_dpp v26, v26, v26 row_bcast:31 row_mask:0xc bank_mask:0xf
    s_nop 1
    v_readlane_b32 s66, v26, 63
    s_nop 1
    v_mov_b32 v27, s66
    v_mul_f32 v27, 0x3a800000, v27
    v_mov_b32 v26, 0
    v_sub_f32 v28, v64, v27
    v_fmac_f32 v26, v28, v28
    v_sub_f32 v28, v65, v27
    v_fmac_f32 v26, v28, v28
    v_sub_f32 v28, v66, v27
    v_fmac_f32 v26, v28, v28
    v_sub_f32 v28, v67, v27
    v_fmac_f32 v26, v28, v28
    v_sub_f32 v28, v68, v27
    v_fmac_f32 v26, v28, v28
    v_sub_f32 v28, v69, v27
    v_fmac_f32 v26, v28, v28
    v_sub_f32 v28, v70, v27
    v_fmac_f32 v26, v28, v28
    v_sub_f32 v28, v71, v27
    v_fmac_f32 v26, v28, v28
    v_sub_f32 v28, v72, v27
    v_fmac_f32 v26, v28, v28
    v_sub_f32 v28, v73, v27
    v_fmac_f32 v26, v28, v28
    v_sub_f32 v28, v74, v27
    v_fmac_f32 v26, v28, v28
    v_sub_f32 v28, v75, v27
    v_fmac_f32 v26, v28, v28
    v_sub_f32 v28, v76, v27
    v_fmac_f32 v26, v28, v28
    v_sub_f32 v28, v77, v27
    v_fmac_f32 v26, v28, v28
    v_sub_f32 v28, v78, v27
    v_fmac_f32 v26, v28, v28
    v_sub_f32 v28, v79, v27
    v_fmac_f32 v26, v28, v28
    s_nop 1
    v_add_f32_dpp v26, v26, v26 row_shr:1 row_mask:0xf bank_mask:0xf bound_ctrl:0
    s_nop 1
    v_add_f32_dpp v26, v26, v26 row_shr:2 row_mask:0xf bank_mask:0xf bound_ctrl:0
    s_nop 1
    v_add_f32_dpp v26, v26, v26 row_shr:4 row_mask:0xf bank_mask:0xf bound_ctrl:0
    s_nop 1
    v_add_f32_dpp v26, v26, v26 row_shr:8 row_mask:0xf bank_mask:0xf bound_ctrl:0
    s_nop 1
    v_add_f32_dpp v26, v26, v26 row_bcast:15 row_mask:0xa bank_mask:0xf
    s_nop 1
    v_add_f32_dpp v26, v26, v26 row_bcast:31 row_mask:0xc bank_mask:0xf
    s_nop 1
    v_readlane_b32 s66, v26, 63
    s_nop 1
    v_mov_b32 v26, s66
    v_mul_f32 v26, 0x3a800000, v26
    v_cvt_pk_bf16_f32 v26, v26, v26
    v_lshlrev_b32 v26, 16, v26
    v_cvt_pk_bf16_f32 v27, v27, v27
    v_lshlrev_b32 v27, 16, v27
    v_add_f32 v26, 0x3727c5ac, v26
    v_cvt_pk_bf16_f32 v26, v26, v26
    v_lshlrev_b32 v26, 16, v26
    v_sqrt_f32 v26, v26
    s_nop 0
    v_cvt_pk_bf16_f32 v26, v26, v26
    v_lshlrev_b32 v26, 16, v26
    v_rcp_f32 v26, v26
    s_nop 0
    v_sub_f32 v64, v64, v27
    v_cvt_pk_bf16_f32 v64, v64, v64
    v_lshlrev_b32 v64, 16, v64
    v_mul_f32 v64, v64, v26
    v_cvt_pk_bf16_f32 v64, v64, v64
    v_lshlrev_b32 v64, 16, v64
    v_sub_f32 v65, v65, v27
    v_cvt_pk_bf16_f32 v65, v65, v65
    v_lshlrev_b32 v65, 16, v65
    v_mul_f32 v65, v65, v26
    v_cvt_pk_bf16_f32 v65, v65, v65
    v_lshlrev_b32 v65, 16, v65
    v_sub_f32 v66, v66, v27
    v_cvt_pk_bf16_f32 v66, v66, v66
    v_lshlrev_b32 v66, 16, v66
    v_mul_f32 v66, v66, v26
    v_cvt_pk_bf16_f32 v66, v66, v66
    v_lshlrev_b32 v66, 16, v66
    v_sub_f32 v67, v67, v27
    v_cvt_pk_bf16_f32 v67, v67, v67
    v_lshlrev_b32 v67, 16, v67
    v_mul_f32 v67, v67, v26
    v_cvt_pk_bf16_f32 v67, v67, v67
    v_lshlrev_b32 v67, 16, v67
    v_sub_f32 v68, v68, v27
    v_cvt_pk_bf16_f32 v68, v68, v68
    v_lshlrev_b32 v68, 16, v68
    v_mul_f32 v68, v68, v26
    v_cvt_pk_bf16_f32 v68, v68, v68
    v_lshlrev_b32 v68, 16, v68
    v_sub_f32 v69, v69, v27
    v_cvt_pk_bf16_f32 v69, v69, v69
    v_lshlrev_b32 v69, 16, v69
    v_mul_f32 v69, v69, v26
    v_cvt_pk_bf16_f32 v69, v69, v69
    v_lshlrev_b32 v69, 16, v69
    v_sub_f32 v70, v70, v27
    v_cvt_pk_bf16_f32 v70, v70, v70
    v_lshlrev_b32 v70, 16, v70
    v_mul_f32 v70, v70, v26
    v_cvt_pk_bf16_f32 v70, v70, v70
    v_lshlrev_b32 v70, 16, v70
    v_sub_f32 v71, v71, v27
    v_cvt_pk_bf16_f32 v71, v71, v71
    v_lshlrev_b32 v71, 16, v71
    v_mul_f32 v71, v71, v26
    v_cvt_pk_bf16_f32 v71, v71, v71
    v_lshlrev_b32 v71, 16, v71
    v_sub_f32 v72, v72, v27
    v_cvt_pk_bf16_f32 v72, v72, v72
    v_lshlrev_b32 v72, 16, v72
    v_mul_f32 v72, v72, v26
    v_cvt_pk_bf16_f32 v72, v72, v72
    v_lshlrev_b32 v72, 16, v72
    v_sub_f32 v73, v73, v27
    v_cvt_pk_bf16_f32 v73, v73, v73
    v_lshlrev_b32 v73, 16, v73
    v_mul_f32 v73, v73, v26
    v_cvt_pk_bf16_f32 v73, v73, v73
    v_lshlrev_b32 v73, 16, v73
    v_sub_f32 v74, v74, v27
    v_cvt_pk_bf16_f32 v74, v74, v74
    v_lshlrev_b32 v74, 16, v74
    v_mul_f32 v74, v74, v26
    v_cvt_pk_bf16_f32 v74, v74, v74
    v_lshlrev_b32 v74, 16, v74
    v_sub_f32 v75, v75, v27
    v_cvt_pk_bf16_f32 v75, v75, v75
    v_lshlrev_b32 v75, 16, v75
    v_mul_f32 v75, v75, v26
    v_cvt_pk_bf16_f32 v75, v75, v75
    v_lshlrev_b32 v75, 16, v75
    v_sub_f32 v76, v76, v27
    v_cvt_pk_bf16_f32 v76, v76, v76
    v_lshlrev_b32 v76, 16, v76
    v_mul_f32 v76, v76, v26
    v_cvt_pk_bf16_f32 v76, v76, v76
    v_lshlrev_b32 v76, 16, v76
    v_sub_f32 v77, v77, v27
    v_cvt_pk_bf16_f32 v77, v77, v77
    v_lshlrev_b32 v77, 16, v77
    v_mul_f32 v77, v77, v26
    v_cvt_pk_bf16_f32 v77, v77, v77
    v_lshlrev_b32 v77, 16, v77
    v_sub_f32 v78, v78, v27
    v_cvt_pk_bf16_f32 v78, v78, v78
    v_lshlrev_b32 v78, 16, v78
    v_mul_f32 v78, v78, v26
    v_cvt_pk_bf16_f32 v78, v78, v78
    v_lshlrev_b32 v78, 16, v78
    v_sub_f32 v79, v79, v27
    v_cvt_pk_bf16_f32 v79, v79, v79
    v_lshlrev_b32 v79, 16, v79
    v_mul_f32 v79, v79, v26
    v_cvt_pk_bf16_f32 v79, v79, v79
    v_lshlrev_b32 v79, 16, v79
    v_mul_f32 v64, v64, v112
    v_cvt_pk_bf16_f32 v64, v64, v64
    v_lshlrev_b32 v64, 16, v64
    v_add_f32 v64, v64, v96
    v_mul_f32 v65, v65, v113
    v_cvt_pk_bf16_f32 v65, v65, v65
    v_lshlrev_b32 v65, 16, v65
    v_add_f32 v65, v65, v97
    v_mul_f32 v66, v66, v114
    v_cvt_pk_bf16_f32 v66, v66, v66
    v_lshlrev_b32 v66, 16, v66
    v_add_f32 v66, v66, v98
    v_mul_f32 v67, v67, v115
    v_cvt_pk_bf16_f32 v67, v67, v67
    v_lshlrev_b32 v67, 16, v67
    v_add_f32 v67, v67, v99
    v_mul_f32 v68, v68, v116
    v_cvt_pk_bf16_f32 v68, v68, v68
    v_lshlrev_b32 v68, 16, v68
    v_add_f32 v68, v68, v100
    v_mul_f32 v69, v69, v117
    v_cvt_pk_bf16_f32 v69, v69, v69
    v_lshlrev_b32 v69, 16, v69
    v_add_f32 v69, v69, v101
    v_mul_f32 v70, v70, v118
    v_cvt_pk_bf16_f32 v70, v70, v70
    v_lshlrev_b32 v70, 16, v70
    v_add_f32 v70, v70, v102
    v_mul_f32 v71, v71, v119
    v_cvt_pk_bf16_f32 v71, v71, v71
    v_lshlrev_b32 v71, 16, v71
    v_add_f32 v71, v71, v103
    v_mul_f32 v72, v72, v120
    v_cvt_pk_bf16_f32 v72, v72, v72
    v_lshlrev_b32 v72, 16, v72
    v_add_f32 v72, v72, v104
    v_mul_f32 v73, v73, v121
    v_cvt_pk_bf16_f32 v73, v73, v73
    v_lshlrev_b32 v73, 16, v73
    v_add_f32 v73, v73, v105
    v_mul_f32 v74, v74, v122
    v_cvt_pk_bf16_f32 v74, v74, v74
    v_lshlrev_b32 v74, 16, v74
    v_add_f32 v74, v74, v106
    v_mul_f32 v75, v75, v123
    v_cvt_pk_bf16_f32 v75, v75, v75
    v_lshlrev_b32 v75, 16, v75
    v_add_f32 v75, v75, v107
    v_mul_f32 v76, v76, v124
    v_cvt_pk_bf16_f32 v76, v76, v76
    v_lshlrev_b32 v76, 16, v76
    v_add_f32 v76, v76, v108
    v_mul_f32 v77, v77, v125
    v_cvt_pk_bf16_f32 v77, v77, v77
    v_lshlrev_b32 v77, 16, v77
    v_add_f32 v77, v77, v109
    v_mul_f32 v78, v78, v126
    v_cvt_pk_bf16_f32 v78, v78, v78
    v_lshlrev_b32 v78, 16, v78
    v_add_f32 v78, v78, v110
    v_mul_f32 v79, v79, v127
    v_cvt_pk_bf16_f32 v79, v79, v79
    v_lshlrev_b32 v79, 16, v79
    v_add_f32 v79, v79, v111
    v_cvt_pk_bf16_f32 v80, v64, v65
    v_cvt_pk_bf16_f32 v81, v66, v67
    v_cvt_pk_bf16_f32 v82, v68, v69
    v_cvt_pk_bf16_f32 v83, v70, v71
    v_cvt_pk_bf16_f32 v84, v72, v73
    v_cvt_pk_bf16_f32 v85, v74, v75
    v_cvt_pk_bf16_f32 v86, v76, v77
    v_cvt_pk_bf16_f32 v87, v78, v79
    s_lshr_b32 s45, s63, 5
    s_lshl_b32 s45, s45, 16
    s_and_b32 s46, s63, 31
    s_lshl_b32 s46, s46, 8
    s_add_u32 s45, s45, s46
    s_add_u32 s45, s45, 0x400000
    s_add_u32 s46, s45, 32768
    buffer_store_dwordx4 v[80:83], v2, s[12:15], s45 offen sc1
    buffer_store_dwordx4 v[84:87], v2, s[12:15], s46 offen sc1
    s_add_u32 s63, s63, 384
    v_lshlrev_b32 v64, 16, v160
    v_and_b32 v65, 0xffff0000, v160
    v_lshlrev_b32 v66, 16, v161
    v_and_b32 v67, 0xffff0000, v161
    v_lshlrev_b32 v68, 16, v162
    v_and_b32 v69, 0xffff0000, v162
    v_lshlrev_b32 v70, 16, v163
    v_and_b32 v71, 0xffff0000, v163
    v_lshlrev_b32 v72, 16, v164
    v_and_b32 v73, 0xffff0000, v164
    v_lshlrev_b32 v74, 16, v165
    v_and_b32 v75, 0xffff0000, v165
    v_lshlrev_b32 v76, 16, v166
    v_and_b32 v77, 0xffff0000, v166
    v_lshlrev_b32 v78, 16, v167
    v_and_b32 v79, 0xffff0000, v167
    v_add_f32 v26, v64, v65
    v_add_f32 v26, v26, v66
    v_add_f32 v26, v26, v67
    v_add_f32 v26, v26, v68
    v_add_f32 v26, v26, v69
    v_add_f32 v26, v26, v70
    v_add_f32 v26, v26, v71
    v_add_f32 v26, v26, v72
    v_add_f32 v26, v26, v73
    v_add_f32 v26, v26, v74
    v_add_f32 v26, v26, v75
    v_add_f32 v26, v26, v76
    v_add_f32 v26, v26, v77
    v_add_f32 v26, v26, v78
    v_add_f32 v26, v26, v79
    s_nop 1
    v_add_f32_dpp v26, v26, v26 row_shr:1 row_mask:0xf bank_mask:0xf bound_ctrl:0
    s_nop 1
    v_add_f32_dpp v26, v26, v26 row_shr:2 row_mask:0xf bank_mask:0xf bound_ctrl:0
    s_nop 1
    v_add_f32_dpp v26, v26, v26 row_shr:4 row_mask:0xf bank_mask:0xf bound_ctrl:0
    s_nop 1
    v_add_f32_dpp v26, v26, v26 row_shr:8 row_mask:0xf bank_mask:0xf bound_ctrl:0
    s_nop 1
    v_add_f32_dpp v26, v26, v26 row_bcast:15 row_mask:0xa bank_mask:0xf
    s_nop 1
    v_add_f32_dpp v26, v26, v26 row_bcast:31 row_mask:0xc bank_mask:0xf
    s_nop 1
    v_readlane_b32 s66, v26, 63
    s_nop 1
    v_mov_b32 v27, s66
    v_mul_f32 v27, 0x3a800000, v27
    v_mov_b32 v26, 0
    v_sub_f32 v28, v64, v27
    v_fmac_f32 v26, v28, v28
    v_sub_f32 v28, v65, v27
    v_fmac_f32 v26, v28, v28
    v_sub_f32 v28, v66, v27
    v_fmac_f32 v26, v28, v28
    v_sub_f32 v28, v67, v27
    v_fmac_f32 v26, v28, v28
    v_sub_f32 v28, v68, v27
    v_fmac_f32 v26, v28, v28
    v_sub_f32 v28, v69, v27
    v_fmac_f32 v26, v28, v28
    v_sub_f32 v28, v70, v27
    v_fmac_f32 v26, v28, v28
    v_sub_f32 v28, v71, v27
    v_fmac_f32 v26, v28, v28
    v_sub_f32 v28, v72, v27
    v_fmac_f32 v26, v28, v28
    v_sub_f32 v28, v73, v27
    v_fmac_f32 v26, v28, v28
    v_sub_f32 v28, v74, v27
    v_fmac_f32 v26, v28, v28
    v_sub_f32 v28, v75, v27
    v_fmac_f32 v26, v28, v28
    v_sub_f32 v28, v76, v27
    v_fmac_f32 v26, v28, v28
    v_sub_f32 v28, v77, v27
    v_fmac_f32 v26, v28, v28
    v_sub_f32 v28, v78, v27
    v_fmac_f32 v26, v28, v28
    v_sub_f32 v28, v79, v27
    v_fmac_f32 v26, v28, v28
    s_nop 1
    v_add_f32_dpp v26, v26, v26 row_shr:1 row_mask:0xf bank_mask:0xf bound_ctrl:0
    s_nop 1
    v_add_f32_dpp v26, v26, v26 row_shr:2 row_mask:0xf bank_mask:0xf bound_ctrl:0
    s_nop 1
    v_add_f32_dpp v26, v26, v26 row_shr:4 row_mask:0xf bank_mask:0xf bound_ctrl:0
    s_nop 1
    v_add_f32_dpp v26, v26, v26 row_shr:8 row_mask:0xf bank_mask:0xf bound_ctrl:0
    s_nop 1
    v_add_f32_dpp v26, v26, v26 row_bcast:15 row_mask:0xa bank_mask:0xf
    s_nop 1
    v_add_f32_dpp v26, v26, v26 row_bcast:31 row_mask:0xc bank_mask:0xf
    s_nop 1
    v_readlane_b32 s66, v26, 63
    s_nop 1
    v_mov_b32 v26, s66
    v_mul_f32 v26, 0x3a800000, v26
    v_cvt_pk_bf16_f32 v26, v26, v26
    v_lshlrev_b32 v26, 16, v26
    v_cvt_pk_bf16_f32 v27, v27, v27
    v_lshlrev_b32 v27, 16, v27
    v_add_f32 v26, 0x3727c5ac, v26
    v_cvt_pk_bf16_f32 v26, v26, v26
    v_lshlrev_b32 v26, 16, v26
    v_sqrt_f32 v26, v26
    s_nop 0
    v_cvt_pk_bf16_f32 v26, v26, v26
    v_lshlrev_b32 v26, 16, v26
    v_rcp_f32 v26, v26
    s_nop 0
    v_sub_f32 v64, v64, v27
    v_cvt_pk_bf16_f32 v64, v64, v64
    v_lshlrev_b32 v64, 16, v64
    v_mul_f32 v64, v64, v26
    v_cvt_pk_bf16_f32 v64, v64, v64
    v_lshlrev_b32 v64, 16, v64
    v_sub_f32 v65, v65, v27
    v_cvt_pk_bf16_f32 v65, v65, v65
    v_lshlrev_b32 v65, 16, v65
    v_mul_f32 v65, v65, v26
    v_cvt_pk_bf16_f32 v65, v65, v65
    v_lshlrev_b32 v65, 16, v65
    v_sub_f32 v66, v66, v27
    v_cvt_pk_bf16_f32 v66, v66, v66
    v_lshlrev_b32 v66, 16, v66
    v_mul_f32 v66, v66, v26
    v_cvt_pk_bf16_f32 v66, v66, v66
    v_lshlrev_b32 v66, 16, v66
    v_sub_f32 v67, v67, v27
    v_cvt_pk_bf16_f32 v67, v67, v67
    v_lshlrev_b32 v67, 16, v67
    v_mul_f32 v67, v67, v26
    v_cvt_pk_bf16_f32 v67, v67, v67
    v_lshlrev_b32 v67, 16, v67
    v_sub_f32 v68, v68, v27
    v_cvt_pk_bf16_f32 v68, v68, v68
    v_lshlrev_b32 v68, 16, v68
    v_mul_f32 v68, v68, v26
    v_cvt_pk_bf16_f32 v68, v68, v68
    v_lshlrev_b32 v68, 16, v68
    v_sub_f32 v69, v69, v27
    v_cvt_pk_bf16_f32 v69, v69, v69
    v_lshlrev_b32 v69, 16, v69
    v_mul_f32 v69, v69, v26
    v_cvt_pk_bf16_f32 v69, v69, v69
    v_lshlrev_b32 v69, 16, v69
    v_sub_f32 v70, v70, v27
    v_cvt_pk_bf16_f32 v70, v70, v70
    v_lshlrev_b32 v70, 16, v70
    v_mul_f32 v70, v70, v26
    v_cvt_pk_bf16_f32 v70, v70, v70
    v_lshlrev_b32 v70, 16, v70
    v_sub_f32 v71, v71, v27
    v_cvt_pk_bf16_f32 v71, v71, v71
    v_lshlrev_b32 v71, 16, v71
    v_mul_f32 v71, v71, v26
    v_cvt_pk_bf16_f32 v71, v71, v71
    v_lshlrev_b32 v71, 16, v71
    v_sub_f32 v72, v72, v27
    v_cvt_pk_bf16_f32 v72, v72, v72
    v_lshlrev_b32 v72, 16, v72
    v_mul_f32 v72, v72, v26
    v_cvt_pk_bf16_f32 v72, v72, v72
    v_lshlrev_b32 v72, 16, v72
    v_sub_f32 v73, v73, v27
    v_cvt_pk_bf16_f32 v73, v73, v73
    v_lshlrev_b32 v73, 16, v73
    v_mul_f32 v73, v73, v26
    v_cvt_pk_bf16_f32 v73, v73, v73
    v_lshlrev_b32 v73, 16, v73
    v_sub_f32 v74, v74, v27
    v_cvt_pk_bf16_f32 v74, v74, v74
    v_lshlrev_b32 v74, 16, v74
    v_mul_f32 v74, v74, v26
    v_cvt_pk_bf16_f32 v74, v74, v74
    v_lshlrev_b32 v74, 16, v74
    v_sub_f32 v75, v75, v27
    v_cvt_pk_bf16_f32 v75, v75, v75
    v_lshlrev_b32 v75, 16, v75
    v_mul_f32 v75, v75, v26
    v_cvt_pk_bf16_f32 v75, v75, v75
    v_lshlrev_b32 v75, 16, v75
    v_sub_f32 v76, v76, v27
    v_cvt_pk_bf16_f32 v76, v76, v76
    v_lshlrev_b32 v76, 16, v76
    v_mul_f32 v76, v76, v26
    v_cvt_pk_bf16_f32 v76, v76, v76
    v_lshlrev_b32 v76, 16, v76
    v_sub_f32 v77, v77, v27
    v_cvt_pk_bf16_f32 v77, v77, v77
    v_lshlrev_b32 v77, 16, v77
    v_mul_f32 v77, v77, v26
    v_cvt_pk_bf16_f32 v77, v77, v77
    v_lshlrev_b32 v77, 16, v77
    v_sub_f32 v78, v78, v27
    v_cvt_pk_bf16_f32 v78, v78, v78
    v_lshlrev_b32 v78, 16, v78
    v_mul_f32 v78, v78, v26
    v_cvt_pk_bf16_f32 v78, v78, v78
    v_lshlrev_b32 v78, 16, v78
    v_sub_f32 v79, v79, v27
    v_cvt_pk_bf16_f32 v79, v79, v79
    v_lshlrev_b32 v79, 16, v79
    v_mul_f32 v79, v79, v26
    v_cvt_pk_bf16_f32 v79, v79, v79
    v_lshlrev_b32 v79, 16, v79
    v_mul_f32 v64, v64, v112
    v_cvt_pk_bf16_f32 v64, v64, v64
    v_lshlrev_b32 v64, 16, v64
    v_add_f32 v64, v64, v96
    v_mul_f32 v65, v65, v113
    v_cvt_pk_bf16_f32 v65, v65, v65
    v_lshlrev_b32 v65, 16, v65
    v_add_f32 v65, v65, v97
    v_mul_f32 v66, v66, v114
    v_cvt_pk_bf16_f32 v66, v66, v66
    v_lshlrev_b32 v66, 16, v66
    v_add_f32 v66, v66, v98
    v_mul_f32 v67, v67, v115
    v_cvt_pk_bf16_f32 v67, v67, v67
    v_lshlrev_b32 v67, 16, v67
    v_add_f32 v67, v67, v99
    v_mul_f32 v68, v68, v116
    v_cvt_pk_bf16_f32 v68, v68, v68
    v_lshlrev_b32 v68, 16, v68
    v_add_f32 v68, v68, v100
    v_mul_f32 v69, v69, v117
    v_cvt_pk_bf16_f32 v69, v69, v69
    v_lshlrev_b32 v69, 16, v69
    v_add_f32 v69, v69, v101
    v_mul_f32 v70, v70, v118
    v_cvt_pk_bf16_f32 v70, v70, v70
    v_lshlrev_b32 v70, 16, v70
    v_add_f32 v70, v70, v102
    v_mul_f32 v71, v71, v119
    v_cvt_pk_bf16_f32 v71, v71, v71
    v_lshlrev_b32 v71, 16, v71
    v_add_f32 v71, v71, v103
    v_mul_f32 v72, v72, v120
    v_cvt_pk_bf16_f32 v72, v72, v72
    v_lshlrev_b32 v72, 16, v72
    v_add_f32 v72, v72, v104
    v_mul_f32 v73, v73, v121
    v_cvt_pk_bf16_f32 v73, v73, v73
    v_lshlrev_b32 v73, 16, v73
    v_add_f32 v73, v73, v105
    v_mul_f32 v74, v74, v122
    v_cvt_pk_bf16_f32 v74, v74, v74
    v_lshlrev_b32 v74, 16, v74
    v_add_f32 v74, v74, v106
    v_mul_f32 v75, v75, v123
    v_cvt_pk_bf16_f32 v75, v75, v75
    v_lshlrev_b32 v75, 16, v75
    v_add_f32 v75, v75, v107
    v_mul_f32 v76, v76, v124
    v_cvt_pk_bf16_f32 v76, v76, v76
    v_lshlrev_b32 v76, 16, v76
    v_add_f32 v76, v76, v108
    v_mul_f32 v77, v77, v125
    v_cvt_pk_bf16_f32 v77, v77, v77
    v_lshlrev_b32 v77, 16, v77
    v_add_f32 v77, v77, v109
    v_mul_f32 v78, v78, v126
    v_cvt_pk_bf16_f32 v78, v78, v78
    v_lshlrev_b32 v78, 16, v78
    v_add_f32 v78, v78, v110
    v_mul_f32 v79, v79, v127
    v_cvt_pk_bf16_f32 v79, v79, v79
    v_lshlrev_b32 v79, 16, v79
    v_add_f32 v79, v79, v111
    v_cvt_pk_bf16_f32 v80, v64, v65
    v_cvt_pk_bf16_f32 v81, v66, v67
    v_cvt_pk_bf16_f32 v82, v68, v69
    v_cvt_pk_bf16_f32 v83, v70, v71
    v_cvt_pk_bf16_f32 v84, v72, v73
    v_cvt_pk_bf16_f32 v85, v74, v75
    v_cvt_pk_bf16_f32 v86, v76, v77
    v_cvt_pk_bf16_f32 v87, v78, v79
    s_lshr_b32 s45, s63, 5
    s_lshl_b32 s45, s45, 16
    s_and_b32 s46, s63, 31
    s_lshl_b32 s46, s46, 8
    s_add_u32 s45, s45, s46
    s_add_u32 s45, s45, 0x400000
    s_add_u32 s46, s45, 32768
    buffer_store_dwordx4 v[80:83], v2, s[12:15], s45 offen sc1
    buffer_store_dwordx4 v[84:87], v2, s[12:15], s46 offen sc1
    s_add_u32 s63, s63, 384
    s_cmp_ge_u32 s63, 2048
    s_cbranch_scc1 L_ln_done_116
    v_lshlrev_b32 v64, 16, v168
    v_and_b32 v65, 0xffff0000, v168
    v_lshlrev_b32 v66, 16, v169
    v_and_b32 v67, 0xffff0000, v169
    v_lshlrev_b32 v68, 16, v170
    v_and_b32 v69, 0xffff0000, v170
    v_lshlrev_b32 v70, 16, v171
    v_and_b32 v71, 0xffff0000, v171
    v_lshlrev_b32 v72, 16, v172
    v_and_b32 v73, 0xffff0000, v172
    v_lshlrev_b32 v74, 16, v173
    v_and_b32 v75, 0xffff0000, v173
    v_lshlrev_b32 v76, 16, v174
    v_and_b32 v77, 0xffff0000, v174
    v_lshlrev_b32 v78, 16, v175
    v_and_b32 v79, 0xffff0000, v175
    v_add_f32 v26, v64, v65
    v_add_f32 v26, v26, v66
    v_add_f32 v26, v26, v67
    v_add_f32 v26, v26, v68
    v_add_f32 v26, v26, v69
    v_add_f32 v26, v26, v70
    v_add_f32 v26, v26, v71
    v_add_f32 v26, v26, v72
    v_add_f32 v26, v26, v73
    v_add_f32 v26, v26, v74
    v_add_f32 v26, v26, v75
    v_add_f32 v26, v26, v76
    v_add_f32 v26, v26, v77
    v_add_f32 v26, v26, v78
    v_add_f32 v26, v26, v79
    s_nop 1
    v_add_f32_dpp v26, v26, v26 row_shr:1 row_mask:0xf bank_mask:0xf bound_ctrl:0
    s_nop 1
    v_add_f32_dpp v26, v26, v26 row_shr:2 row_mask:0xf bank_mask:0xf bound_ctrl:0
    s_nop 1
    v_add_f32_dpp v26, v26, v26 row_shr:4 row_mask:0xf bank_mask:0xf bound_ctrl:0
    s_nop 1
    v_add_f32_dpp v26, v26, v26 row_shr:8 row_mask:0xf bank_mask:0xf bound_ctrl:0
    s_nop 1
    v_add_f32_dpp v26, v26, v26 row_bcast:15 row_mask:0xa bank_mask:0xf
    s_nop 1
    v_add_f32_dpp v26, v26, v26 row_bcast:31 row_mask:0xc bank_mask:0xf
    s_nop 1
    v_readlane_b32 s66, v26, 63
    s_nop 1
    v_mov_b32 v27, s66
    v_mul_f32 v27, 0x3a800000, v27
    v_mov_b32 v26, 0
    v_sub_f32 v28, v64, v27
    v_fmac_f32 v26, v28, v28
    v_sub_f32 v28, v65, v27
    v_fmac_f32 v26, v28, v28
    v_sub_f32 v28, v66, v27
    v_fmac_f32 v26, v28, v28
    v_sub_f32 v28, v67, v27
    v_fmac_f32 v26, v28, v28
    v_sub_f32 v28, v68, v27
    v_fmac_f32 v26, v28, v28
    v_sub_f32 v28, v69, v27
    v_fmac_f32 v26, v28, v28
    v_sub_f32 v28, v70, v27
    v_fmac_f32 v26, v28, v28
    v_sub_f32 v28, v71, v27
    v_fmac_f32 v26, v28, v28
    v_sub_f32 v28, v72, v27
    v_fmac_f32 v26, v28, v28
    v_sub_f32 v28, v73, v27
    v_fmac_f32 v26, v28, v28
    v_sub_f32 v28, v74, v27
    v_fmac_f32 v26, v28, v28
    v_sub_f32 v28, v75, v27
    v_fmac_f32 v26, v28, v28
    v_sub_f32 v28, v76, v27
    v_fmac_f32 v26, v28, v28
    v_sub_f32 v28, v77, v27
    v_fmac_f32 v26, v28, v28
    v_sub_f32 v28, v78, v27
    v_fmac_f32 v26, v28, v28
    v_sub_f32 v28, v79, v27
    v_fmac_f32 v26, v28, v28
    s_nop 1
    v_add_f32_dpp v26, v26, v26 row_shr:1 row_mask:0xf bank_mask:0xf bound_ctrl:0
    s_nop 1
    v_add_f32_dpp v26, v26, v26 row_shr:2 row_mask:0xf bank_mask:0xf bound_ctrl:0
    s_nop 1
    v_add_f32_dpp v26, v26, v26 row_shr:4 row_mask:0xf bank_mask:0xf bound_ctrl:0
    s_nop 1
    v_add_f32_dpp v26, v26, v26 row_shr:8 row_mask:0xf bank_mask:0xf bound_ctrl:0
    s_nop 1
    v_add_f32_dpp v26, v26, v26 row_bcast:15 row_mask:0xa bank_mask:0xf
    s_nop 1
    v_add_f32_dpp v26, v26, v26 row_bcast:31 row_mask:0xc bank_mask:0xf
    s_nop 1
    v_readlane_b32 s66, v26, 63
    s_nop 1
    v_mov_b32 v26, s66
    v_mul_f32 v26, 0x3a800000, v26
    v_cvt_pk_bf16_f32 v26, v26, v26
    v_lshlrev_b32 v26, 16, v26
    v_cvt_pk_bf16_f32 v27, v27, v27
    v_lshlrev_b32 v27, 16, v27
    v_add_f32 v26, 0x3727c5ac, v26
    v_cvt_pk_bf16_f32 v26, v26, v26
    v_lshlrev_b32 v26, 16, v26
    v_sqrt_f32 v26, v26
    s_nop 0
    v_cvt_pk_bf16_f32 v26, v26, v26
    v_lshlrev_b32 v26, 16, v26
    v_rcp_f32 v26, v26
    s_nop 0
    v_sub_f32 v64, v64, v27
    v_cvt_pk_bf16_f32 v64, v64, v64
    v_lshlrev_b32 v64, 16, v64
    v_mul_f32 v64, v64, v26
    v_cvt_pk_bf16_f32 v64, v64, v64
    v_lshlrev_b32 v64, 16, v64
    v_sub_f32 v65, v65, v27
    v_cvt_pk_bf16_f32 v65, v65, v65
    v_lshlrev_b32 v65, 16, v65
    v_mul_f32 v65, v65, v26
    v_cvt_pk_bf16_f32 v65, v65, v65
    v_lshlrev_b32 v65, 16, v65
    v_sub_f32 v66, v66, v27
    v_cvt_pk_bf16_f32 v66, v66, v66
    v_lshlrev_b32 v66, 16, v66
    v_mul_f32 v66, v66, v26
    v_cvt_pk_bf16_f32 v66, v66, v66
    v_lshlrev_b32 v66, 16, v66
    v_sub_f32 v67, v67, v27
    v_cvt_pk_bf16_f32 v67, v67, v67
    v_lshlrev_b32 v67, 16, v67
    v_mul_f32 v67, v67, v26
    v_cvt_pk_bf16_f32 v67, v67, v67
    v_lshlrev_b32 v67, 16, v67
    v_sub_f32 v68, v68, v27
    v_cvt_pk_bf16_f32 v68, v68, v68
    v_lshlrev_b32 v68, 16, v68
    v_mul_f32 v68, v68, v26
    v_cvt_pk_bf16_f32 v68, v68, v68
    v_lshlrev_b32 v68, 16, v68
    v_sub_f32 v69, v69, v27
    v_cvt_pk_bf16_f32 v69, v69, v69
    v_lshlrev_b32 v69, 16, v69
    v_mul_f32 v69, v69, v26
    v_cvt_pk_bf16_f32 v69, v69, v69
    v_lshlrev_b32 v69, 16, v69
    v_sub_f32 v70, v70, v27
    v_cvt_pk_bf16_f32 v70, v70, v70
    v_lshlrev_b32 v70, 16, v70
    v_mul_f32 v70, v70, v26
    v_cvt_pk_bf16_f32 v70, v70, v70
    v_lshlrev_b32 v70, 16, v70
    v_sub_f32 v71, v71, v27
    v_cvt_pk_bf16_f32 v71, v71, v71
    v_lshlrev_b32 v71, 16, v71
    v_mul_f32 v71, v71, v26
    v_cvt_pk_bf16_f32 v71, v71, v71
    v_lshlrev_b32 v71, 16, v71
    v_sub_f32 v72, v72, v27
    v_cvt_pk_bf16_f32 v72, v72, v72
    v_lshlrev_b32 v72, 16, v72
    v_mul_f32 v72, v72, v26
    v_cvt_pk_bf16_f32 v72, v72, v72
    v_lshlrev_b32 v72, 16, v72
    v_sub_f32 v73, v73, v27
    v_cvt_pk_bf16_f32 v73, v73, v73
    v_lshlrev_b32 v73, 16, v73
    v_mul_f32 v73, v73, v26
    v_cvt_pk_bf16_f32 v73, v73, v73
    v_lshlrev_b32 v73, 16, v73
    v_sub_f32 v74, v74, v27
    v_cvt_pk_bf16_f32 v74, v74, v74
    v_lshlrev_b32 v74, 16, v74
    v_mul_f32 v74, v74, v26
    v_cvt_pk_bf16_f32 v74, v74, v74
    v_lshlrev_b32 v74, 16, v74
    v_sub_f32 v75, v75, v27
    v_cvt_pk_bf16_f32 v75, v75, v75
    v_lshlrev_b32 v75, 16, v75
    v_mul_f32 v75, v75, v26
    v_cvt_pk_bf16_f32 v75, v75, v75
    v_lshlrev_b32 v75, 16, v75
    v_sub_f32 v76, v76, v27
    v_cvt_pk_bf16_f32 v76, v76, v76
    v_lshlrev_b32 v76, 16, v76
    v_mul_f32 v76, v76, v26
    v_cvt_pk_bf16_f32 v76, v76, v76
    v_lshlrev_b32 v76, 16, v76
    v_sub_f32 v77, v77, v27
    v_cvt_pk_bf16_f32 v77, v77, v77
    v_lshlrev_b32 v77, 16, v77
    v_mul_f32 v77, v77, v26
    v_cvt_pk_bf16_f32 v77, v77, v77
    v_lshlrev_b32 v77, 16, v77
    v_sub_f32 v78, v78, v27
    v_cvt_pk_bf16_f32 v78, v78, v78
    v_lshlrev_b32 v78, 16, v78
    v_mul_f32 v78, v78, v26
    v_cvt_pk_bf16_f32 v78, v78, v78
    v_lshlrev_b32 v78, 16, v78
    v_sub_f32 v79, v79, v27
    v_cvt_pk_bf16_f32 v79, v79, v79
    v_lshlrev_b32 v79, 16, v79
    v_mul_f32 v79, v79, v26
    v_cvt_pk_bf16_f32 v79, v79, v79
    v_lshlrev_b32 v79, 16, v79
    v_mul_f32 v64, v64, v112
    v_cvt_pk_bf16_f32 v64, v64, v64
    v_lshlrev_b32 v64, 16, v64
    v_add_f32 v64, v64, v96
    v_mul_f32 v65, v65, v113
    v_cvt_pk_bf16_f32 v65, v65, v65
    v_lshlrev_b32 v65, 16, v65
    v_add_f32 v65, v65, v97
    v_mul_f32 v66, v66, v114
    v_cvt_pk_bf16_f32 v66, v66, v66
    v_lshlrev_b32 v66, 16, v66
    v_add_f32 v66, v66, v98
    v_mul_f32 v67, v67, v115
    v_cvt_pk_bf16_f32 v67, v67, v67
    v_lshlrev_b32 v67, 16, v67
    v_add_f32 v67, v67, v99
    v_mul_f32 v68, v68, v116
    v_cvt_pk_bf16_f32 v68, v68, v68
    v_lshlrev_b32 v68, 16, v68
    v_add_f32 v68, v68, v100
    v_mul_f32 v69, v69, v117
    v_cvt_pk_bf16_f32 v69, v69, v69
    v_lshlrev_b32 v69, 16, v69
    v_add_f32 v69, v69, v101
    v_mul_f32 v70, v70, v118
    v_cvt_pk_bf16_f32 v70, v70, v70
    v_lshlrev_b32 v70, 16, v70
    v_add_f32 v70, v70, v102
    v_mul_f32 v71, v71, v119
    v_cvt_pk_bf16_f32 v71, v71, v71
    v_lshlrev_b32 v71, 16, v71
    v_add_f32 v71, v71, v103
    v_mul_f32 v72, v72, v120
    v_cvt_pk_bf16_f32 v72, v72, v72
    v_lshlrev_b32 v72, 16, v72
    v_add_f32 v72, v72, v104
    v_mul_f32 v73, v73, v121
    v_cvt_pk_bf16_f32 v73, v73, v73
    v_lshlrev_b32 v73, 16, v73
    v_add_f32 v73, v73, v105
    v_mul_f32 v74, v74, v122
    v_cvt_pk_bf16_f32 v74, v74, v74
    v_lshlrev_b32 v74, 16, v74
    v_add_f32 v74, v74, v106
    v_mul_f32 v75, v75, v123
    v_cvt_pk_bf16_f32 v75, v75, v75
    v_lshlrev_b32 v75, 16, v75
    v_add_f32 v75, v75, v107
    v_mul_f32 v76, v76, v124
    v_cvt_pk_bf16_f32 v76, v76, v76
    v_lshlrev_b32 v76, 16, v76
    v_add_f32 v76, v76, v108
    v_mul_f32 v77, v77, v125
    v_cvt_pk_bf16_f32 v77, v77, v77
    v_lshlrev_b32 v77, 16, v77
    v_add_f32 v77, v77, v109
    v_mul_f32 v78, v78, v126
    v_cvt_pk_bf16_f32 v78, v78, v78
    v_lshlrev_b32 v78, 16, v78
    v_add_f32 v78, v78, v110
    v_mul_f32 v79, v79, v127
    v_cvt_pk_bf16_f32 v79, v79, v79
    v_lshlrev_b32 v79, 16, v79
    v_add_f32 v79, v79, v111
    v_cvt_pk_bf16_f32 v80, v64, v65
    v_cvt_pk_bf16_f32 v81, v66, v67
    v_cvt_pk_bf16_f32 v82, v68, v69
    v_cvt_pk_bf16_f32 v83, v70, v71
    v_cvt_pk_bf16_f32 v84, v72, v73
    v_cvt_pk_bf16_f32 v85, v74, v75
    v_cvt_pk_bf16_f32 v86, v76, v77
    v_cvt_pk_bf16_f32 v87, v78, v79
    s_lshr_b32 s45, s63, 5
    s_lshl_b32 s45, s45, 16
    s_and_b32 s46, s63, 31
    s_lshl_b32 s46, s46, 8
    s_add_u32 s45, s45, s46
    s_add_u32 s45, s45, 0x400000
    s_add_u32 s46, s45, 32768
    buffer_store_dwordx4 v[80:83], v2, s[12:15], s45 offen sc1
    buffer_store_dwordx4 v[84:87], v2, s[12:15], s46 offen sc1
    s_add_u32 s63, s63, 384
L_ln_done_116:
    s_waitcnt vmcnt(0)
    s_barrier
    s_cmp_lg_u32 s44, 0
    s_cbranch_scc1 L_cnt_118
    v_mov_b32 v30, 1
    v_mov_b32 v31, 0
    s_mov_b64 exec, 1
    buffer_atomic_add v30, v31, s[16:19], 0 offen offset:196 sc1
    s_mov_b64 exec, -1
L_cnt_118:
    s_add_u32 s39, s39, 96
    s_load_dwordx2 s[4:5], s[0:1], 96
    s_load_dwordx2 s[6:7], s[0:1], 104
    v_and_b32 v14, 7, v0
    v_lshrrev_b32 v15, 3, v0
    s_waitcnt lgkmcnt(0)
    s_mov_b32 s32, s4
    s_and_b32 s33, s5, 0xffff
    s_mov_b32 s34, 0x800
    s_mov_b32 s35, 0x00020000
    s_mov_b32 s24, s6
    s_and_b32 s25, s7, 0xffff
    s_mov_b32 s26, 0xc00000
    s_mov_b32 s27, 0x00020000
    s_and_b32 s47, s39, 1
    s_lshl_b32 s45, s47, 10
    v_lshlrev_b32 v16, 5, v15
    buffer_load_dwordx4 v[104:107], v16, s[32:35], s45 offen
    buffer_load_dwordx4 v[108:111], v16, s[32:35], s45 offen offset:16
    s_mov_b32 s45, 196608
    v_mul_lo_u32 v17, v15, s45
    v_lshlrev_b32 v18, 4, v14
    v_add_u32 v17, v17, v18
    s_lshr_b32 s46, s39, 1
    s_lshl_b32 s46, s46, 7
    s_mul_i32 s45, s47, 6291456
    s_add_u32 s46, s46, s45
    buffer_load_dwordx4 v[32:35], v17, s[24:27], s46 offen nt
    v_add_u32 v17, 12288, v17
    buffer_load_dwordx4 v[36:39], v17, s[24:27], s46 offen nt
    v_add_u32 v17, 12288, v17
    buffer_load_dwordx4 v[40:43], v17, s[24:27], s46 offen nt
    v_add_u32 v17, 12288, v17
    buffer_load_dwordx4 v[44:47], v17, s[24:27], s46 offen nt
    v_add_u32 v17, 12288, v17
    buffer_load_dwordx4 v[48:51], v17, s[24:27], s46 offen nt
    v_add_u32 v17, 12288, v17
    buffer_load_dwordx4 v[52:55], v17, s[24:27], s46 offen nt
    v_add_u32 v17, 12288, v17
    buffer_load_dwordx4 v[56:59], v17, s[24:27], s46 offen nt
    v_add_u32 v17, 12288, v17
    buffer_load_dwordx4 v[60:63], v17, s[24:27], s46 offen nt
    v_add_u32 v17, 12288, v17
    buffer_load_dwordx4 v[64:67], v17, s[24:27], s46 offen nt
    v_add_u32 v17, 12288, v17
    buffer_load_dwordx4 v[68:71], v17, s[24:27], s46 offen nt
    v_add_u32 v17, 12288, v17
    buffer_load_dwordx4 v[72:75], v17, s[24:27], s46 offen nt
    v_add_u32 v17, 12288, v17
    buffer_load_dwordx4 v[76:79], v17, s[24:27], s46 offen nt
    v_add_u32 v17, 12288, v17
    buffer_load_dwordx4 v[80:83], v17, s[24:27], s46 offen nt
    v_add_u32 v17, 12288, v17
    buffer_load_dwordx4 v[84:87], v17, s[24:27], s46 offen nt
    v_add_u32 v17, 12288, v17
    buffer_load_dwordx4 v[88:91], v17, s[24:27], s46 offen nt
    v_add_u32 v17, 12288, v17
    buffer_load_dwordx4 v[92:95], v17, s[24:27], s46 offen nt
    s_waitcnt vmcnt(16)
    v_lshlrev_b32 v112, 16, v104
    v_and_b32 v113, 0xffff0000, v104
    v_lshlrev_b32 v114, 16, v105
    v_and_b32 v115, 0xffff0000, v105
    v_lshlrev_b32 v116, 16, v106
    v_and_b32 v117, 0xffff0000, v106
    v_lshlrev_b32 v118, 16, v107
    v_and_b32 v119, 0xffff0000, v107
    v_lshlrev_b32 v120, 16, v108
    v_and_b32 v121, 0xffff0000, v108
    v_lshlrev_b32 v122, 16, v109
    v_and_b32 v123, 0xffff0000, v109
    v_lshlrev_b32 v124, 16, v110
    v_and_b32 v125, 0xffff0000, v110
    v_lshlrev_b32 v126, 16, v111
    v_and_b32 v127, 0xffff0000, v111
    v_mul_f32 v18, 0xbfb8aa3b, v112
    v_exp_f32 v18, v18
    s_nop 0
    v_add_f32 v18, 1.0, v18
    v_rcp_f32 v18, v18
    s_nop 0
    v_mul_f32 v112, v112, v18
    v_cvt_pk_bf16_f32 v112, v112, v112
    v_lshlrev_b32 v112, 16, v112
    v_mul_f32 v18, 0xbfb8aa3b, v113
    v_exp_f32 v18, v18
    s_nop 0
    v_add_f32 v18, 1.0, v18
    v_rcp_f32 v18, v18
    s_nop 0
    v_mul_f32 v113, v113, v18
    v_cvt_pk_bf16_f32 v113, v113, v113
    v_lshlrev_b32 v113, 16, v113
    v_mul_f32 v18, 0xbfb8aa3b, v114
    v_exp_f32 v18, v18
    s_nop 0
    v_add_f32 v18, 1.0, v18
    v_rcp_f32 v18, v18
    s_nop 0
    v_mul_f32 v114, v114, v18
    v_cvt_pk_bf16_f32 v114, v114, v114
    v_lshlrev_b32 v114, 16, v114
    v_mul_f32 v18, 0xbfb8aa3b, v115
    v_exp_f32 v18, v18
    s_nop 0
    v_add_f32 v18, 1.0, v18
    v_rcp_f32 v18, v18
    s_nop 0
    v_mul_f32 v115, v115, v18
    v_cvt_pk_bf16_f32 v115, v115, v115
    v_lshlrev_b32 v115, 16, v115
    v_mul_f32 v18, 0xbfb8aa3b, v116
    v_exp_f32 v18, v18
    s_nop 0
    v_add_f32 v18, 1.0, v18
    v_rcp_f32 v18, v18
    s_nop 0
    v_mul_f32 v116, v116, v18
    v_cvt_pk_bf16_f32 v116, v116, v116
    v_lshlrev_b32 v116, 16, v116
    v_mul_f32 v18, 0xbfb8aa3b, v117
    v_exp_f32 v18, v18
    s_nop 0
    v_add_f32 v18, 1.0, v18
    v_rcp_f32 v18, v18
    s_nop 0
    v_mul_f32 v117, v117, v18
    v_cvt_pk_bf16_f32 v117, v117, v117
    v_lshlrev_b32 v117, 16, v117
    v_mul_f32 v18, 0xbfb8aa3b, v118
    v_exp_f32 v18, v18
    s_nop 0
    v_add_f32 v18, 1.0, v18
    v_rcp_f32 v18, v18
    s_nop 0
    v_mul_f32 v118, v118, v18
    v_cvt_pk_bf16_f32 v118, v118, v118
    v_lshlrev_b32 v118, 16, v118
    v_mul_f32 v18, 0xbfb8aa3b, v119
    v_exp_f32 v18, v18
    s_nop 0
    v_add_f32 v18, 1.0, v18
    v_rcp_f32 v18, v18
    s_nop 0
    v_mul_f32 v119, v119, v18
    v_cvt_pk_bf16_f32 v119, v119, v119
    v_lshlrev_b32 v119, 16, v119
    v_mul_f32 v18, 0xbfb8aa3b, v120
    v_exp_f32 v18, v18
    s_nop 0
    v_add_f32 v18, 1.0, v18
    v_rcp_f32 v18, v18
    s_nop 0
    v_mul_f32 v120, v120, v18
    v_cvt_pk_bf16_f32 v120, v120, v120
    v_lshlrev_b32 v120, 16, v120
    v_mul_f32 v18, 0xbfb8aa3b, v121
    v_exp_f32 v18, v18
    s_nop 0
    v_add_f32 v18, 1.0, v18
    v_rcp_f32 v18, v18
    s_nop 0
    v_mul_f32 v121, v121, v18
    v_cvt_pk_bf16_f32 v121, v121, v121
    v_lshlrev_b32 v121, 16, v121
    v_mul_f32 v18, 0xbfb8aa3b, v122
    v_exp_f32 v18, v18
    s_nop 0
    v_add_f32 v18, 1.0, v18
    v_rcp_f32 v18, v18
    s_nop 0
    v_mul_f32 v122, v122, v18
    v_cvt_pk_bf16_f32 v122, v122, v122
    v_lshlrev_b32 v122, 16, v122
    v_mul_f32 v18, 0xbfb8aa3b, v123
    v_exp_f32 v18, v18
    s_nop 0
    v_add_f32 v18, 1.0, v18
    v_rcp_f32 v18, v18
    s_nop 0
    v_mul_f32 v123, v123, v18
    v_cvt_pk_bf16_f32 v123, v123, v123
    v_lshlrev_b32 v123, 16, v123
    v_mul_f32 v18, 0xbfb8aa3b, v124
    v_exp_f32 v18, v18
    s_nop 0
    v_add_f32 v18, 1.0, v18
    v_rcp_f32 v18, v18
    s_nop 0
    v_mul_f32 v124, v124, v18
    v_cvt_pk_bf16_f32 v124, v124, v124
    v_lshlrev_b32 v124, 16, v124
    v_mul_f32 v18, 0xbfb8aa3b, v125
    v_exp_f32 v18, v18
    s_nop 0
    v_add_f32 v18, 1.0, v18
    v_rcp_f32 v18, v18
    s_nop 0
    v_mul_f32 v125, v125, v18
    v_cvt_pk_bf16_f32 v125, v125, v125
    v_lshlrev_b32 v125, 16, v125
    v_mul_f32 v18, 0xbfb8aa3b, v126
    v_exp_f32 v18, v18
    s_nop 0
    v_add_f32 v18, 1.0, v18
    v_rcp_f32 v18, v18
    s_nop 0
    v_mul_f32 v126, v126, v18
    v_cvt_pk_bf16_f32 v126, v126, v126
    v_lshlrev_b32 v126, 16, v126
    v_mul_f32 v18, 0xbfb8aa3b, v127
    v_exp_f32 v18, v18
    s_nop 0
    v_add_f32 v18, 1.0, v18
    v_rcp_f32 v18, v18
    s_nop 0
    v_mul_f32 v127, v127, v18
    v_cvt_pk_bf16_f32 v127, v127, v127
    v_lshlrev_b32 v127, 16, v127
    v_mov_b32 v96, 0
    v_mov_b32 v97, 0
    v_mov_b32 v98, 0
    v_mov_b32 v99, 0
    v_mov_b32 v100, 0
    v_mov_b32 v101, 0
    v_mov_b32 v102, 0
    v_mov_b32 v103, 0
    s_waitcnt vmcnt(15)
    v_lshlrev_b32 v18, 16, v32
    v_and_b32 v19, 0xffff0000, v32
    v_fmac_f32 v96, v18, v112
    v_fmac_f32 v97, v19, v112
    v_lshlrev_b32 v18, 16, v33
    v_and_b32 v19, 0xffff0000, v33
    v_fmac_f32 v98, v18, v112
    v_fmac_f32 v99, v19, v112
    v_lshlrev_b32 v18, 16, v34
    v_and_b32 v19, 0xffff0000, v34
    v_fmac_f32 v100, v18, v112
    v_fmac_f32 v101, v19, v112
    v_lshlrev_b32 v18, 16, v35
    v_and_b32 v19, 0xffff0000, v35
    v_fmac_f32 v102, v18, v112
    v_fmac_f32 v103, v19, v112
    s_waitcnt vmcnt(14)
    v_lshlrev_b32 v18, 16, v36
    v_and_b32 v19, 0xffff0000, v36
    v_fmac_f32 v96, v18, v113
    v_fmac_f32 v97, v19, v113
    v_lshlrev_b32 v18, 16, v37
    v_and_b32 v19, 0xffff0000, v37
    v_fmac_f32 v98, v18, v113
    v_fmac_f32 v99, v19, v113
    v_lshlrev_b32 v18, 16, v38
    v_and_b32 v19, 0xffff0000, v38
    v_fmac_f32 v100, v18, v113
    v_fmac_f32 v101, v19, v113
    v_lshlrev_b32 v18, 16, v39
    v_and_b32 v19, 0xffff0000, v39
    v_fmac_f32 v102, v18, v113
    v_fmac_f32 v103, v19, v113
    s_waitcnt vmcnt(13)
    v_lshlrev_b32 v18, 16, v40
    v_and_b32 v19, 0xffff0000, v40
    v_fmac_f32 v96, v18, v114
    v_fmac_f32 v97, v19, v114
    v_lshlrev_b32 v18, 16, v41
    v_and_b32 v19, 0xffff0000, v41
    v_fmac_f32 v98, v18, v114
    v_fmac_f32 v99, v19, v114
    v_lshlrev_b32 v18, 16, v42
    v_and_b32 v19, 0xffff0000, v42
    v_fmac_f32 v100, v18, v114
    v_fmac_f32 v101, v19, v114
    v_lshlrev_b32 v18, 16, v43
    v_and_b32 v19, 0xffff0000, v43
    v_fmac_f32 v102, v18, v114
    v_fmac_f32 v103, v19, v114
    s_waitcnt vmcnt(12)
    v_lshlrev_b32 v18, 16, v44
    v_and_b32 v19, 0xffff0000, v44
    v_fmac_f32 v96, v18, v115
    v_fmac_f32 v97, v19, v115
    v_lshlrev_b32 v18, 16, v45
    v_and_b32 v19, 0xffff0000, v45
    v_fmac_f32 v98, v18, v115
    v_fmac_f32 v99, v19, v115
    v_lshlrev_b32 v18, 16, v46
    v_and_b32 v19, 0xffff0000, v46
    v_fmac_f32 v100, v18, v115
    v_fmac_f32 v101, v19, v115
    v_lshlrev_b32 v18, 16, v47
    v_and_b32 v19, 0xffff0000, v47
    v_fmac_f32 v102, v18, v115
    v_fmac_f32 v103, v19, v115
    s_waitcnt vmcnt(11)
    v_lshlrev_b32 v18, 16, v48
    v_and_b32 v19, 0xffff0000, v48
    v_fmac_f32 v96, v18, v116
    v_fmac_f32 v97, v19, v116
    v_lshlrev_b32 v18, 16, v49
    v_and_b32 v19, 0xffff0000, v49
    v_fmac_f32 v98, v18, v116
    v_fmac_f32 v99, v19, v116
    v_lshlrev_b32 v18, 16, v50
    v_and_b32 v19, 0xffff0000, v50
    v_fmac_f32 v100, v18, v116
    v_fmac_f32 v101, v19, v116
    v_lshlrev_b32 v18, 16, v51
    v_and_b32 v19, 0xffff0000, v51
    v_fmac_f32 v102, v18, v116
    v_fmac_f32 v103, v19, v116
    s_waitcnt vmcnt(10)
    v_lshlrev_b32 v18, 16, v52
    v_and_b32 v19, 0xffff0000, v52
    v_fmac_f32 v96, v18, v117
    v_fmac_f32 v97, v19, v117
    v_lshlrev_b32 v18, 16, v53
    v_and_b32 v19, 0xffff0000, v53
    v_fmac_f32 v98, v18, v117
    v_fmac_f32 v99, v19, v117
    v_lshlrev_b32 v18, 16, v54
    v_and_b32 v19, 0xffff0000, v54
    v_fmac_f32 v100, v18, v117
    v_fmac_f32 v101, v19, v117
    v_lshlrev_b32 v18, 16, v55
    v_and_b32 v19, 0xffff0000, v55
    v_fmac_f32 v102, v18, v117
    v_fmac_f32 v103, v19, v117
    s_waitcnt vmcnt(9)
    v_lshlrev_b32 v18, 16, v56
    v_and_b32 v19, 0xffff0000, v56
    v_fmac_f32 v96, v18, v118
    v_fmac_f32 v97, v19, v118
    v_lshlrev_b32 v18, 16, v57
    v_and_b32 v19, 0xffff0000, v57
    v_fmac_f32 v98, v18, v118
    v_fmac_f32 v99, v19, v118
    v_lshlrev_b32 v18, 16, v58
    v_and_b32 v19, 0xffff0000, v58
    v_fmac_f32 v100, v18, v118
    v_fmac_f32 v101, v19, v118
    v_lshlrev_b32 v18, 16, v59
    v_and_b32 v19, 0xffff0000, v59
    v_fmac_f32 v102, v18, v118
    v_fmac_f32 v103, v19, v118
    s_waitcnt vmcnt(8)
    v_lshlrev_b32 v18, 16, v60
    v_and_b32 v19, 0xffff0000, v60
    v_fmac_f32 v96, v18, v119
    v_fmac_f32 v97, v19, v119
    v_lshlrev_b32 v18, 16, v61
    v_and_b32 v19, 0xffff0000, v61
    v_fmac_f32 v98, v18, v119
    v_fmac_f32 v99, v19, v119
    v_lshlrev_b32 v18, 16, v62
    v_and_b32 v19, 0xffff0000, v62
    v_fmac_f32 v100, v18, v119
    v_fmac_f32 v101, v19, v119
    v_lshlrev_b32 v18, 16, v63
    v_and_b32 v19, 0xffff0000, v63
    v_fmac_f32 v102, v18, v119
    v_fmac_f32 v103, v19, v119
    s_waitcnt vmcnt(7)
    v_lshlrev_b32 v18, 16, v64
    v_and_b32 v19, 0xffff0000, v64
    v_fmac_f32 v96, v18, v120
    v_fmac_f32 v97, v19, v120
    v_lshlrev_b32 v18, 16, v65
    v_and_b32 v19, 0xffff0000, v65
    v_fmac_f32 v98, v18, v120
    v_fmac_f32 v99, v19, v120
    v_lshlrev_b32 v18, 16, v66
    v_and_b32 v19, 0xffff0000, v66
    v_fmac_f32 v100, v18, v120
    v_fmac_f32 v101, v19, v120
    v_lshlrev_b32 v18, 16, v67
    v_and_b32 v19, 0xffff0000, v67
    v_fmac_f32 v102, v18, v120
    v_fmac_f32 v103, v19, v120
    s_waitcnt vmcnt(6)
    v_lshlrev_b32 v18, 16, v68
    v_and_b32 v19, 0xffff0000, v68
    v_fmac_f32 v96, v18, v121
    v_fmac_f32 v97, v19, v121
    v_lshlrev_b32 v18, 16, v69
    v_and_b32 v19, 0xffff0000, v69
    v_fmac_f32 v98, v18, v121
    v_fmac_f32 v99, v19, v121
    v_lshlrev_b32 v18, 16, v70
    v_and_b32 v19, 0xffff0000, v70
    v_fmac_f32 v100, v18, v121
    v_fmac_f32 v101, v19, v121
    v_lshlrev_b32 v18, 16, v71
    v_and_b32 v19, 0xffff0000, v71
    v_fmac_f32 v102, v18, v121
    v_fmac_f32 v103, v19, v121
    s_waitcnt vmcnt(5)
    v_lshlrev_b32 v18, 16, v72
    v_and_b32 v19, 0xffff0000, v72
    v_fmac_f32 v96, v18, v122
    v_fmac_f32 v97, v19, v122
    v_lshlrev_b32 v18, 16, v73
    v_and_b32 v19, 0xffff0000, v73
    v_fmac_f32 v98, v18, v122
    v_fmac_f32 v99, v19, v122
    v_lshlrev_b32 v18, 16, v74
    v_and_b32 v19, 0xffff0000, v74
    v_fmac_f32 v100, v18, v122
    v_fmac_f32 v101, v19, v122
    v_lshlrev_b32 v18, 16, v75
    v_and_b32 v19, 0xffff0000, v75
    v_fmac_f32 v102, v18, v122
    v_fmac_f32 v103, v19, v122
    s_waitcnt vmcnt(4)
    v_lshlrev_b32 v18, 16, v76
    v_and_b32 v19, 0xffff0000, v76
    v_fmac_f32 v96, v18, v123
    v_fmac_f32 v97, v19, v123
    v_lshlrev_b32 v18, 16, v77
    v_and_b32 v19, 0xffff0000, v77
    v_fmac_f32 v98, v18, v123
    v_fmac_f32 v99, v19, v123
    v_lshlrev_b32 v18, 16, v78
    v_and_b32 v19, 0xffff0000, v78
    v_fmac_f32 v100, v18, v123
    v_fmac_f32 v101, v19, v123
    v_lshlrev_b32 v18, 16, v79
    v_and_b32 v19, 0xffff0000, v79
    v_fmac_f32 v102, v18, v123
    v_fmac_f32 v103, v19, v123
    s_waitcnt vmcnt(3)
    v_lshlrev_b32 v18, 16, v80
    v_and_b32 v19, 0xffff0000, v80
    v_fmac_f32 v96, v18, v124
    v_fmac_f32 v97, v19, v124
    v_lshlrev_b32 v18, 16, v81
    v_and_b32 v19, 0xffff0000, v81
    v_fmac_f32 v98, v18, v124
    v_fmac_f32 v99, v19, v124
    v_lshlrev_b32 v18, 16, v82
    v_and_b32 v19, 0xffff0000, v82
    v_fmac_f32 v100, v18, v124
    v_fmac_f32 v101, v19, v124
    v_lshlrev_b32 v18, 16, v83
    v_and_b32 v19, 0xffff0000, v83
    v_fmac_f32 v102, v18, v124
    v_fmac_f32 v103, v19, v124
    s_waitcnt vmcnt(2)
    v_lshlrev_b32 v18, 16, v84
    v_and_b32 v19, 0xffff0000, v84
    v_fmac_f32 v96, v18, v125
    v_fmac_f32 v97, v19, v125
    v_lshlrev_b32 v18, 16, v85
    v_and_b32 v19, 0xffff0000, v85
    v_fmac_f32 v98, v18, v125
    v_fmac_f32 v99, v19, v125
    v_lshlrev_b32 v18, 16, v86
    v_and_b32 v19, 0xffff0000, v86
    v_fmac_f32 v100, v18, v125
    v_fmac_f32 v101, v19, v125
    v_lshlrev_b32 v18, 16, v87
    v_and_b32 v19, 0xffff0000, v87
    v_fmac_f32 v102, v18, v125
    v_fmac_f32 v103, v19, v125
    s_waitcnt vmcnt(1)
    v_lshlrev_b32 v18, 16, v88
    v_and_b32 v19, 0xffff0000, v88
    v_fmac_f32 v96, v18, v126
    v_fmac_f32 v97, v19, v126
    v_lshlrev_b32 v18, 16, v89
    v_and_b32 v19, 0xffff0000, v89
    v_fmac_f32 v98, v18, v126
    v_fmac_f32 v99, v19, v126
    v_lshlrev_b32 v18, 16, v90
    v_and_b32 v19, 0xffff0000, v90
    v_fmac_f32 v100, v18, v126
    v_fmac_f32 v101, v19, v126
    v_lshlrev_b32 v18, 16, v91
    v_and_b32 v19, 0xffff0000, v91
    v_fmac_f32 v102, v18, v126
    v_fmac_f32 v103, v19, v126
    s_waitcnt vmcnt(0)
    v_lshlrev_b32 v18, 16, v92
    v_and_b32 v19, 0xffff0000, v92
    v_fmac_f32 v96, v18, v127
    v_fmac_f32 v97, v19, v127
    v_lshlrev_b32 v18, 16, v93
    v_and_b32 v19, 0xffff0000, v93
    v_fmac_f32 v98, v18, v127
    v_fmac_f32 v99, v19, v127
    v_lshlrev_b32 v18, 16, v94
    v_and_b32 v19, 0xffff0000, v94
    v_fmac_f32 v100, v18, v127
    v_fmac_f32 v101, v19, v127
    v_lshlrev_b32 v18, 16, v95
    v_and_b32 v19, 0xffff0000, v95
    v_fmac_f32 v102, v18, v127
    v_fmac_f32 v103, v19, v127
    v_lshlrev_b32 v16, 5, v0
    ds_write_b128 v16, v[96:99]
    ds_write_b128 v16, v[100:103] offset:16
    s_waitcnt lgkmcnt(0)
    s_barrier
    s_cmp_lg_u32 s44, 0
    s_cbranch_scc1 L_mod_fin_119
    v_mov_b32 v18, 0
    ds_read_b32 v32, v12 offset:0
    ds_read_b32 v33, v12 offset:256
    ds_read_b32 v34, v12 offset:512
    ds_read_b32 v35, v12 offset:768
    ds_read_b32 v36, v12 offset:1024
    ds_read_b32 v37, v12 offset:1280
    ds_read_b32 v38, v12 offset:1536
    ds_read_b32 v39, v12 offset:1792
    ds_read_b32 v40, v12 offset:2048
    ds_read_b32 v41, v12 offset:2304
    ds_read_b32 v42, v12 offset:2560
    ds_read_b32 v43, v12 offset:2816
    ds_read_b32 v44, v12 offset:3072
    ds_read_b32 v45, v12 offset:3328
    ds_read_b32 v46, v12 offset:3584
    ds_read_b32 v47, v12 offset:3840
    s_waitcnt lgkmcnt(0)
    v_add_f32 v18, v18, v32
    v_add_f32 v18, v18, v33
    v_add_f32 v18, v18, v34
    v_add_f32 v18, v18, v35
    v_add_f32 v18, v18, v36
    v_add_f32 v18, v18, v37
    v_add_f32 v18, v18, v38
    v_add_f32 v18, v18, v39
    v_add_f32 v18, v18, v40
    v_add_f32 v18, v18, v41
    v_add_f32 v18, v18, v42
    v_add_f32 v18, v18, v43
    v_add_f32 v18, v18, v44
    v_add_f32 v18, v18, v45
    v_add_f32 v18, v18, v46
    v_add_f32 v18, v18, v47
    ds_read_b32 v32, v12 offset:4096
    ds_read_b32 v33, v12 offset:4352
    ds_read_b32 v34, v12 offset:4608
    ds_read_b32 v35, v12 offset:4864
    ds_read_b32 v36, v12 offset:5120
    ds_read_b32 v37, v12 offset:5376
    ds_read_b32 v38, v12 offset:5632
    ds_read_b32 v39, v12 offset:5888
    ds_read_b32 v40, v12 offset:6144
    ds_read_b32 v41, v12 offset:6400
    ds_read_b32 v42, v12 offset:6656
    ds_read_b32 v43, v12 offset:6912
    ds_read_b32 v44, v12 offset:7168
    ds_read_b32 v45, v12 offset:7424
    ds_read_b32 v46, v12 offset:7680
    ds_read_b32 v47, v12 offset:7936
    s_waitcnt lgkmcnt(0)
    v_add_f32 v18, v18, v32
    v_add_f32 v18, v18, v33
    v_add_f32 v18, v18, v34
    v_add_f32 v18, v18, v35
    v_add_f32 v18, v18, v36
    v_add_f32 v18, v18, v37
    v_add_f32 v18, v18, v38
    v_add_f32 v18, v18, v39
    v_add_f32 v18, v18, v40
    v_add_f32 v18, v18, v41
    v_add_f32 v18, v18, v42
    v_add_f32 v18, v18, v43
    v_add_f32 v18, v18, v44
    v_add_f32 v18, v18, v45
    v_add_f32 v18, v18, v46
    v_add_f32 v18, v18, v47
    s_lshr_b32 s45, s39, 1
    s_lshl_b32 s45, s45, 8
    s_mul_i32 s46, s47, 24576
    s_add_u32 s45, s45, s46
    buffer_store_dword v18, v12, s[12:15], s45 offen sc1
L_mod_fin_119:
    s_waitcnt vmcnt(0)
    s_barrier
    s_cmp_lg_u32 s44, 0
    s_cbranch_scc1 L_cnt_120
    v_mov_b32 v30, 1
    v_mov_b32 v31, 0
    s_mov_b64 exec, 1
    buffer_atomic_add v30, v31, s[16:19], 0 offen offset:132 sc1
    s_mov_b64 exec, -1
L_cnt_120:
    s_branch L_w_roles_111
L_w_kv_110:
    s_lshl_b32 s45, s43, 3
    s_add_u32 s45, s45, 16
    s_load_dwordx2 s[6:7], s[0:1], s45
    s_waitcnt lgkmcnt(0)
    s_mov_b32 s24, s6
    s_and_b32 s25, s7, 0xffff
    s_mov_b32 s26, 0x800000
    s_mov_b32 s27, 0x00020000
    s_lshl_b32 s46, s41, 8
    s_barrier
    v_lshrrev_b32 v20, 4, v1
    s_lshl_b32 s45, s44, 2
    v_add_u32 v21, s45, v20
    s_mov_b32 s45, 8192
    v_mul_lo_u32 v21, v21, s45
    v_lshlrev_b32 v22, 2, v20
    v_and_b32 v23, 15, v1
    v_xor_b32 v22, v22, v23
    v_lshlrev_b32 v22, 4, v22
    v_add_u32 v21, v21, v22
    v_bfe_u32 v22, v1, 2, 2
    v_lshlrev_b32 v23, 3, v20
    v_add_u32 v23, v23, v22
    v_lshlrev_b32 v23, 8, v23
    v_xor_b32 v22, s44, v22
    v_lshlrev_b32 v22, 6, v22
    v_add_u32 v23, v23, v22
    v_and_b32 v22, 3, v1
    v_lshlrev_b32 v22, 4, v22
    v_add_u32 v23, v23, v22
    v_add_u32 v24, 65536, v23
    v_add_u32 v25, 131072, v23
    s_lshl_b32 s47, s44, 10
    s_add_u32 s45, s46, 0x0
    s_add_u32 m0, s47, 0
    s_nop 0
    buffer_load_dwordx4 v21, s[24:27], s45 offen nt lds
    s_add_u32 s45, s46, 0x20000
    s_add_u32 m0, s47, 4096
    s_nop 0
    buffer_load_dwordx4 v21, s[24:27], s45 offen nt lds
    s_add_u32 s45, s46, 0x40000
    s_add_u32 m0, s47, 8192
    s_nop 0
    buffer_load_dwordx4 v21, s[24:27], s45 offen nt lds
    s_add_u32 s45, s46, 0x60000
    s_add_u32 m0, s47, 12288
    s_nop 0
    buffer_load_dwordx4 v21, s[24:27], s45 offen nt lds
    s_add_u32 s45, s46, 0x80000
    s_add_u32 m0, s47, 16384
    s_nop 0
    buffer_load_dwordx4 v21, s[24:27], s45 offen nt lds
    s_add_u32 s45, s46, 0xa0000
    s_add_u32 m0, s47, 20480
    s_nop 0
    buffer_load_dwordx4 v21, s[24:27], s45 offen nt lds
    s_add_u32 s45, s46, 0xc0000
    s_add_u32 m0, s47, 24576
    s_nop 0
    buffer_load_dwordx4 v21, s[24:27], s45 offen nt lds
    s_add_u32 s45, s46, 0xe0000
    s_add_u32 m0, s47, 28672
    s_nop 0
    buffer_load_dwordx4 v21, s[24:27], s45 offen nt lds
    s_add_u32 s45, s46, 0x100000
    s_add_u32 m0, s47, 32768
    s_nop 0
    buffer_load_dwordx4 v21, s[24:27], s45 offen nt lds
    s_add_u32 s45, s46, 0x120000
    s_add_u32 m0, s47, 36864
    s_nop 0
    buffer_load_dwordx4 v21, s[24:27], s45 offen nt lds
    s_add_u32 s45, s46, 0x140000
    s_add_u32 m0, s47, 40960
    s_nop 0
    buffer_load_dwordx4 v21, s[24:27], s45 offen nt lds
    s_add_u32 s45, s46, 0x160000
    s_add_u32 m0, s47, 45056
    s_nop 0
    buffer_load_dwordx4 v21, s[24:27], s45 offen nt lds
    s_add_u32 s45, s46, 0x180000
    s_add_u32 m0, s47, 49152
    s_nop 0
    buffer_load_dwordx4 v21, s[24:27], s45 offen nt lds
    s_add_u32 s45, s46, 0x1a0000
    s_add_u32 m0, s47, 53248
    s_nop 0
    buffer_load_dwordx4 v21, s[24:27], s45 offen nt lds
    s_add_u32 s45, s46, 0x1c0000
    s_add_u32 m0, s47, 57344
    s_nop 0
    buffer_load_dwordx4 v21, s[24:27], s45 offen nt lds
    s_add_u32 s45, s46, 0x1e0000
    s_add_u32 m0, s47, 61440
    s_nop 0
    buffer_load_dwordx4 v21, s[24:27], s45 offen nt lds
    s_add_u32 s45, s46, 0x200000
    s_add_u32 m0, s47, 65536
    s_nop 0
    buffer_load_dwordx4 v21, s[24:27], s45 offen nt lds
    s_add_u32 s45, s46, 0x220000
    s_add_u32 m0, s47, 69632
    s_nop 0
    buffer_load_dwordx4 v21, s[24:27], s45 offen nt lds
    s_add_u32 s45, s46, 0x240000
    s_add_u32 m0, s47, 73728
    s_nop 0
    buffer_load_dwordx4 v21, s[24:27], s45 offen nt lds
    s_add_u32 s45, s46, 0x260000
    s_add_u32 m0, s47, 77824
    s_nop 0
    buffer_load_dwordx4 v21, s[24:27], s45 offen nt lds
    s_add_u32 s45, s46, 0x280000
    s_add_u32 m0, s47, 81920
    s_nop 0
    buffer_load_dwordx4 v21, s[24:27], s45 offen nt lds
    s_add_u32 s45, s46, 0x2a0000
    s_add_u32 m0, s47, 86016
    s_nop 0
    buffer_load_dwordx4 v21, s[24:27], s45 offen nt lds
    s_add_u32 s45, s46, 0x2c0000
    s_add_u32 m0, s47, 90112
    s_nop 0
    buffer_load_dwordx4 v21, s[24:27], s45 offen nt lds
    s_add_u32 s45, s46, 0x2e0000
    s_add_u32 m0, s47, 94208
    s_nop 0
    buffer_load_dwordx4 v21, s[24:27], s45 offen nt lds
    s_add_u32 s45, s46, 0x300000
    s_add_u32 m0, s47, 98304
    s_nop 0
    buffer_load_dwordx4 v21, s[24:27], s45 offen nt lds
    s_add_u32 s45, s46, 0x320000
    s_add_u32 m0, s47, 102400
    s_nop 0
    buffer_load_dwordx4 v21, s[24:27], s45 offen nt lds
    s_add_u32 s45, s46, 0x340000
    s_add_u32 m0, s47, 106496
    s_nop 0
    buffer_load_dwordx4 v21, s[24:27], s45 offen nt lds
    s_add_u32 s45, s46, 0x360000
    s_add_u32 m0, s47, 110592
    s_nop 0
    buffer_load_dwordx4 v21, s[24:27], s45 offen nt lds
    s_add_u32 s45, s46, 0x380000
    s_add_u32 m0, s47, 114688
    s_nop 0
    buffer_load_dwordx4 v21, s[24:27], s45 offen nt lds
    s_add_u32 s45, s46, 0x3a0000
    s_add_u32 m0, s47, 118784
    s_nop 0
    buffer_load_dwordx4 v21, s[24:27], s45 offen nt lds
    s_add_u32 s45, s46, 0x3c0000
    s_add_u32 m0, s47, 122880
    s_nop 0
    buffer_load_dwordx4 v21, s[24:27], s45 offen nt lds
    s_add_u32 s45, s46, 0x3e0000
    s_add_u32 m0, s47, 126976
    s_nop 0
    buffer_load_dwordx4 v21, s[24:27], s45 offen nt lds
    s_waitcnt vmcnt(28)
    s_barrier
    s_add_u32 s45, s46, 0x400000
    s_add_u32 m0, s47, 131072
    s_nop 0
    buffer_load_dwordx4 v21, s[24:27], s45 offen nt lds
    s_add_u32 s45, s46, 0x420000
    s_add_u32 m0, s47, 135168
    s_nop 0
    buffer_load_dwordx4 v21, s[24:27], s45 offen nt lds
    s_add_u32 s45, s46, 0x440000
    s_add_u32 m0, s47, 139264
    s_nop 0
    buffer_load_dwordx4 v21, s[24:27], s45 offen nt lds
    s_add_u32 s45, s46, 0x460000
    s_add_u32 m0, s47, 143360
    s_nop 0
    buffer_load_dwordx4 v21, s[24:27], s45 offen nt lds
    ds_read_b64_tr_b16 a[0:1], v23 offset:0
    ds_read_b64_tr_b16 a[2:3], v23 offset:1024
    ds_read_b64_tr_b16 a[4:5], v23 offset:8
    ds_read_b64_tr_b16 a[6:7], v23 offset:1032
    ds_read_b64_tr_b16 a[8:9], v23 offset:8192
    ds_read_b64_tr_b16 a[10:11], v23 offset:9216
    ds_read_b64_tr_b16 a[12:13], v23 offset:8200
    ds_read_b64_tr_b16 a[14:15], v23 offset:9224
    s_waitcnt lgkmcnt(0)
    s_waitcnt vmcnt(28)
    s_barrier
    s_add_u32 s45, s46, 0x480000
    s_add_u32 m0, s47, 0
    s_nop 0
    buffer_load_dwordx4 v21, s[24:27], s45 offen nt lds
    s_add_u32 s45, s46, 0x4a0000
    s_add_u32 m0, s47, 4096
    s_nop 0
    buffer_load_dwordx4 v21, s[24:27], s45 offen nt lds
    s_add_u32 s45, s46, 0x4c0000
    s_add_u32 m0, s47, 8192
    s_nop 0
    buffer_load_dwordx4 v21, s[24:27], s45 offen nt lds
    s_add_u32 s45, s46, 0x4e0000
    s_add_u32 m0, s47, 12288
    s_nop 0
    buffer_load_dwordx4 v21, s[24:27], s45 offen nt lds
    ds_read_b64_tr_b16 a[16:17], v23 offset:16384
    ds_read_b64_tr_b16 a[18:19], v23 offset:17408
    ds_read_b64_tr_b16 a[20:21], v23 offset:16392
    ds_read_b64_tr_b16 a[22:23], v23 offset:17416
    ds_read_b64_tr_b16 a[24:25], v23 offset:24576
    ds_read_b64_tr_b16 a[26:27], v23 offset:25600
    ds_read_b64_tr_b16 a[28:29], v23 offset:24584
    ds_read_b64_tr_b16 a[30:31], v23 offset:25608
    s_waitcnt lgkmcnt(0)
    s_waitcnt vmcnt(28)
    s_barrier
    s_add_u32 s45, s46, 0x500000
    s_add_u32 m0, s47, 16384
    s_nop 0
    buffer_load_dwordx4 v21, s[24:27], s45 offen nt lds
    s_add_u32 s45, s46, 0x520000
    s_add_u32 m0, s47, 20480
    s_nop 0
    buffer_load_dwordx4 v21, s[24:27], s45 offen nt lds
    s_add_u32 s45, s46, 0x540000
    s_add_u32 m0, s47, 24576
    s_nop 0
    buffer_load_dwordx4 v21, s[24:27], s45 offen nt lds
    s_add_u32 s45, s46, 0x560000
    s_add_u32 m0, s47, 28672
    s_nop 0
    buffer_load_dwordx4 v21, s[24:27], s45 offen nt lds
    ds_read_b64_tr_b16 a[32:33], v23 offset:32768
    ds_read_b64_tr_b16 a[34:35], v23 offset:33792
    ds_read_b64_tr_b16 a[36:37], v23 offset:32776
    ds_read_b64_tr_b16 a[38:39], v23 offset:33800
    ds_read_b64_tr_b16 a[40:41], v23 offset:40960
    ds_read_b64_tr_b16 a[42:43], v23 offset:41984
    ds_read_b64_tr_b16 a[44:45], v23 offset:40968
    ds_read_b64_tr_b16 a[46:47], v23 offset:41992
    s_waitcnt lgkmcnt(0)
    s_waitcnt vmcnt(28)
    s_barrier
    s_add_u32 s45, s46, 0x580000
    s_add_u32 m0, s47, 32768
    s_nop 0
    buffer_load_dwordx4 v21, s[24:27], s45 offen nt lds
    s_add_u32 s45, s46, 0x5a0000
    s_add_u32 m0, s47, 36864
    s_nop 0
    buffer_load_dwordx4 v21, s[24:27], s45 offen nt lds
    s_add_u32 s45, s46, 0x5c0000
    s_add_u32 m0, s47, 40960
    s_nop 0
    buffer_load_dwordx4 v21, s[24:27], s45 offen nt lds
    s_add_u32 s45, s46, 0x5e0000
    s_add_u32 m0, s47, 45056
    s_nop 0
    buffer_load_dwordx4 v21, s[24:27], s45 offen nt lds
    ds_read_b64_tr_b16 a[48:49], v23 offset:49152
    ds_read_b64_tr_b16 a[50:51], v23 offset:50176
    ds_read_b64_tr_b16 a[52:53], v23 offset:49160
    ds_read_b64_tr_b16 a[54:55], v23 offset:50184
    ds_read_b64_tr_b16 a[56:57], v23 offset:57344
    ds_read_b64_tr_b16 a[58:59], v23 offset:58368
    ds_read_b64_tr_b16 a[60:61], v23 offset:57352
    ds_read_b64_tr_b16 a[62:63], v23 offset:58376
    s_waitcnt lgkmcnt(0)
    s_waitcnt vmcnt(28)
    s_barrier
    s_add_u32 s45, s46, 0x600000
    s_add_u32 m0, s47, 49152
    s_nop 0
    buffer_load_dwordx4 v21, s[24:27], s45 offen nt lds
    s_add_u32 s45, s46, 0x620000
    s_add_u32 m0, s47, 53248
    s_nop 0
    buffer_load_dwordx4 v21, s[24:27], s45 offen nt lds
    s_add_u32 s45, s46, 0x640000
    s_add_u32 m0, s47, 57344
    s_nop 0
    buffer_load_dwordx4 v21, s[24:27], s45 offen nt lds
    s_add_u32 s45, s46, 0x660000
    s_add_u32 m0, s47, 61440
    s_nop 0
    buffer_load_dwordx4 v21, s[24:27], s45 offen nt lds
    ds_read_b64_tr_b16 a[64:65], v24 offset:0
    ds_read_b64_tr_b16 a[66:67], v24 offset:1024
    ds_read_b64_tr_b16 a[68:69], v24 offset:8
    ds_read_b64_tr_b16 a[70:71], v24 offset:1032
    ds_read_b64_tr_b16 a[72:73], v24 offset:8192
    ds_read_b64_tr_b16 a[74:75], v24 offset:9216
    ds_read_b64_tr_b16 a[76:77], v24 offset:8200
    ds_read_b64_tr_b16 a[78:79], v24 offset:9224
    s_waitcnt lgkmcnt(0)
    s_waitcnt vmcnt(28)
    s_barrier
    s_add_u32 s45, s46, 0x680000
    s_add_u32 m0, s47, 65536
    s_nop 0
    buffer_load_dwordx4 v21, s[24:27], s45 offen nt lds
    s_add_u32 s45, s46, 0x6a0000
    s_add_u32 m0, s47, 69632
    s_nop 0
    buffer_load_dwordx4 v21, s[24:27], s45 offen nt lds
    s_add_u32 s45, s46, 0x6c0000
    s_add_u32 m0, s47, 73728
    s_nop 0
    buffer_load_dwordx4 v21, s[24:27], s45 offen nt lds
    s_add_u32 s45, s46, 0x6e0000
    s_add_u32 m0, s47, 77824
    s_nop 0
    buffer_load_dwordx4 v21, s[24:27], s45 offen nt lds
    ds_read_b64_tr_b16 a[80:81], v24 offset:16384
    ds_read_b64_tr_b16 a[82:83], v24 offset:17408
    ds_read_b64_tr_b16 a[84:85], v24 offset:16392
    ds_read_b64_tr_b16 a[86:87], v24 offset:17416
    ds_read_b64_tr_b16 a[88:89], v24 offset:24576
    ds_read_b64_tr_b16 a[90:91], v24 offset:25600
    ds_read_b64_tr_b16 a[92:93], v24 offset:24584
    ds_read_b64_tr_b16 a[94:95], v24 offset:25608
    s_waitcnt lgkmcnt(0)
    s_waitcnt vmcnt(28)
    s_barrier
    s_add_u32 s45, s46, 0x700000
    s_add_u32 m0, s47, 81920
    s_nop 0
    buffer_load_dwordx4 v21, s[24:27], s45 offen nt lds
    s_add_u32 s45, s46, 0x720000
    s_add_u32 m0, s47, 86016
    s_nop 0
    buffer_load_dwordx4 v21, s[24:27], s45 offen nt lds
    s_add_u32 s45, s46, 0x740000
    s_add_u32 m0, s47, 90112
    s_nop 0
    buffer_load_dwordx4 v21, s[24:27], s45 offen nt lds
    s_add_u32 s45, s46, 0x760000
    s_add_u32 m0, s47, 94208
    s_nop 0
    buffer_load_dwordx4 v21, s[24:27], s45 offen nt lds
    ds_read_b64_tr_b16 a[96:97], v24 offset:32768
    ds_read_b64_tr_b16 a[98:99], v24 offset:33792
    ds_read_b64_tr_b16 a[100:101], v24 offset:32776
    ds_read_b64_tr_b16 a[102:103], v24 offset:33800
    ds_read_b64_tr_b16 a[104:105], v24 offset:40960
    ds_read_b64_tr_b16 a[106:107], v24 offset:41984
    ds_read_b64_tr_b16 a[108:109], v24 offset:40968
    ds_read_b64_tr_b16 a[110:111], v24 offset:41992
    s_waitcnt lgkmcnt(0)
    s_waitcnt vmcnt(28)
    s_barrier
    s_add_u32 s45, s46, 0x780000
    s_add_u32 m0, s47, 98304
    s_nop 0
    buffer_load_dwordx4 v21, s[24:27], s45 offen nt lds
    s_add_u32 s45, s46, 0x7a0000
    s_add_u32 m0, s47, 102400
    s_nop 0
    buffer_load_dwordx4 v21, s[24:27], s45 offen nt lds
    s_add_u32 s45, s46, 0x7c0000
    s_add_u32 m0, s47, 106496
    s_nop 0
    buffer_load_dwordx4 v21, s[24:27], s45 offen nt lds
    s_add_u32 s45, s46, 0x7e0000
    s_add_u32 m0, s47, 110592
    s_nop 0
    buffer_load_dwordx4 v21, s[24:27], s45 offen nt lds
    ds_read_b64_tr_b16 a[112:113], v24 offset:49152
    ds_read_b64_tr_b16 a[114:115], v24 offset:50176
    ds_read_b64_tr_b16 a[116:117], v24 offset:49160
    ds_read_b64_tr_b16 a[118:119], v24 offset:50184
    ds_read_b64_tr_b16 a[120:121], v24 offset:57344
    ds_read_b64_tr_b16 a[122:123], v24 offset:58368
    ds_read_b64_tr_b16 a[124:125], v24 offset:57352
    ds_read_b64_tr_b16 a[126:127], v24 offset:58376
    s_waitcnt lgkmcnt(0)
    s_waitcnt vmcnt(28)
    s_barrier
    ds_read_b64_tr_b16 a[128:129], v25 offset:0
    ds_read_b64_tr_b16 a[130:131], v25 offset:1024
    ds_read_b64_tr_b16 a[132:133], v25 offset:8
    ds_read_b64_tr_b16 a[134:135], v25 offset:1032
    ds_read_b64_tr_b16 a[136:137], v25 offset:8192
    ds_read_b64_tr_b16 a[138:139], v25 offset:9216
    ds_read_b64_tr_b16 a[140:141], v25 offset:8200
    ds_read_b64_tr_b16 a[142:143], v25 offset:9224
    s_waitcnt lgkmcnt(0)
    s_waitcnt vmcnt(24)
    s_barrier
    ds_read_b64_tr_b16 a[144:145], v23 offset:0
    ds_read_b64_tr_b16 a[146:147], v23 offset:1024
    ds_read_b64_tr_b16 a[148:149], v23 offset:8
    ds_read_b64_tr_b16 a[150:151], v23 offset:1032
    ds_read_b64_tr_b16 a[152:153], v23 offset:8192
    ds_read_b64_tr_b16 a[154:155], v23 offset:9216
    ds_read_b64_tr_b16 a[156:157], v23 offset:8200
    ds_read_b64_tr_b16 a[158:159], v23 offset:9224
    s_waitcnt lgkmcnt(0)
    s_waitcnt vmcnt(20)
    s_barrier
    ds_read_b64_tr_b16 a[160:161], v23 offset:16384
    ds_read_b64_tr_b16 a[162:163], v23 offset:17408
    ds_read_b64_tr_b16 a[164:165], v23 offset:16392
    ds_read_b64_tr_b16 a[166:167], v23 offset:17416
    ds_read_b64_tr_b16 a[168:169], v23 offset:24576
    ds_read_b64_tr_b16 a[170:171], v23 offset:25600
    ds_read_b64_tr_b16 a[172:173], v23 offset:24584
    ds_read_b64_tr_b16 a[174:175], v23 offset:25608
    s_waitcnt lgkmcnt(0)
    s_waitcnt vmcnt(16)
    s_barrier
    ds_read_b64_tr_b16 a[176:177], v23 offset:32768
    ds_read_b64_tr_b16 a[178:179], v23 offset:33792
    ds_read_b64_tr_b16 a[180:181], v23 offset:32776
    ds_read_b64_tr_b16 a[182:183], v23 offset:33800
    ds_read_b64_tr_b16 a[184:185], v23 offset:40960
    ds_read_b64_tr_b16 a[186:187], v23 offset:41984
    ds_read_b64_tr_b16 a[188:189], v23 offset:40968
    ds_read_b64_tr_b16 a[190:191], v23 offset:41992
    s_waitcnt lgkmcnt(0)
    s_waitcnt vmcnt(12)
    s_barrier
    ds_read_b64_tr_b16 a[192:193], v23 offset:49152
    ds_read_b64_tr_b16 a[194:195], v23 offset:50176
    ds_read_b64_tr_b16 a[196:197], v23 offset:49160
    ds_read_b64_tr_b16 a[198:199], v23 offset:50184
    ds_read_b64_tr_b16 a[200:201], v23 offset:57344
    ds_read_b64_tr_b16 a[202:203], v23 offset:58368
    ds_read_b64_tr_b16 a[204:205], v23 offset:57352
    ds_read_b64_tr_b16 a[206:207], v23 offset:58376
    s_waitcnt lgkmcnt(0)
    s_waitcnt vmcnt(8)
    s_barrier
    ds_read_b64_tr_b16 a[208:209], v24 offset:0
    ds_read_b64_tr_b16 a[210:211], v24 offset:1024
    ds_read_b64_tr_b16 a[212:213], v24 offset:8
    ds_read_b64_tr_b16 a[214:215], v24 offset:1032
    ds_read_b64_tr_b16 a[216:217], v24 offset:8192
    ds_read_b64_tr_b16 a[218:219], v24 offset:9216
    ds_read_b64_tr_b16 a[220:221], v24 offset:8200
    ds_read_b64_tr_b16 a[222:223], v24 offset:9224
    s_waitcnt lgkmcnt(0)
    s_waitcnt vmcnt(4)
    s_barrier
    ds_read_b64_tr_b16 a[224:225], v24 offset:16384
    ds_read_b64_tr_b16 a[226:227], v24 offset:17408
    ds_read_b64_tr_b16 a[228:229], v24 offset:16392
    ds_read_b64_tr_b16 a[230:231], v24 offset:17416
    ds_read_b64_tr_b16 a[232:233], v24 offset:24576
    ds_read_b64_tr_b16 a[234:235], v24 offset:25600
    ds_read_b64_tr_b16 a[236:237], v24 offset:24584
    ds_read_b64_tr_b16 a[238:239], v24 offset:25608
    s_waitcnt lgkmcnt(0)
    s_waitcnt vmcnt(0)
    s_barrier
    ds_read_b64_tr_b16 a[240:241], v24 offset:32768
    ds_read_b64_tr_b16 a[242:243], v24 offset:33792
    ds_read_b64_tr_b16 a[244:245], v24 offset:32776
    ds_read_b64_tr_b16 a[246:247], v24 offset:33800
    ds_read_b64_tr_b16 a[248:249], v24 offset:40960
    ds_read_b64_tr_b16 a[250:251], v24 offset:41984
    ds_read_b64_tr_b16 a[252:253], v24 offset:40968
    ds_read_b64_tr_b16 a[254:255], v24 offset:41992
    s_waitcnt lgkmcnt(0)
    s_barrier
    s_waitcnt vmcnt(0)
    s_barrier
    s_cmp_lg_u32 s44, 0
    s_cbranch_scc1 L_cnt_121
    v_mov_b32 v30, 1
    v_mov_b32 v31, 0
    s_mov_b64 exec, 1
    buffer_atomic_add v30, v31, s[16:19], 0 offen offset:64 sc1
    s_mov_b64 exec, -1
L_cnt_121:
    s_mov_b32 s60, 0
    s_mov_b32 s51, 1
    s_mov_b32 s71, 192
    s_mov_b32 s52, 0x400000
    s_lshl_b32 s56, s39, 19
    s_add_u32 s56, s56, 0x2000000
L_w_qkv_122:
    s_cmp_lg_u32 s44, 0
    s_cbranch_scc1 L_pd_123
    v_mov_b32 v29, s71
    s_mov_b32 s46, 96
    s_mov_b64 exec, 1
    s_mov_b32 s70, 0
L_wp_124:
    buffer_load_dword v31, v29, s[16:19], 0 offen sc1
    s_add_u32 s70, s70, 1
    s_cmp_ge_u32 s70, 0x200000
    s_cbranch_scc1 L_w_done_109
    s_waitcnt vmcnt(0)
    v_cmp_gt_u32 vcc, s46, v31
    s_nop 1
    s_cbranch_vccz L_wp_124_ok
    s_sleep 3
    s_branch L_wp_124
L_wp_124_ok:
    s_mov_b64 exec, -1
L_pd_123:
    s_barrier
    s_mov_b32 s50, s60
    s_mul_i32 s53, s50, 65536
    s_add_u32 s53, s53, s52
    s_lshl_b32 s54, s44, 13
    s_add_u32 s53, s53, s54
    s_mul_i32 s57, s50, 8192
    s_add_u32 s57, s57, s56
    s_lshl_b32 s45, s44, 11
    s_add_u32 s57, s57, s45
    s_add_u32 s55, s54, 65536
    s_mov_b32 s58, 0
    v_mov_b32 v13, v3
    v_add_u32 v14, 65536, v13
    v_xor_b32 v15, 64, v13
    v_xor_b32 v16, 64, v14
    s_mov_b32 s76, 0x20000000
    s_add_u32 s48, s53, 0
    s_add_u32 s49, s48, 4096
    s_add_u32 m0, s54, 0
    s_nop 0
    buffer_load_dwordx4 v6, s[12:15], s48 offen offset:0 sc1 lds
    s_add_u32 m0, s54, 1024
    s_nop 0
    buffer_load_dwordx4 v9, s[12:15], s48 offen offset:0 sc1 lds
    s_add_u32 m0, s54, 2048
    s_nop 0
    buffer_load_dwordx4 v6, s[12:15], s49 offen offset:0 sc1 lds
    s_add_u32 m0, s54, 3072
    s_nop 0
    buffer_load_dwordx4 v9, s[12:15], s49 offen offset:0 sc1 lds
    s_add_u32 m0, s54, 3968
    s_nop 0
    buffer_load_dwordx4 v6, s[12:15], s48 offen offset:128 sc1 lds
    s_add_u32 m0, s54, 4992
    s_nop 0
    buffer_load_dwordx4 v9, s[12:15], s48 offen offset:128 sc1 lds
    s_add_u32 m0, s54, 6016
    s_nop 0
    buffer_load_dwordx4 v6, s[12:15], s49 offen offset:128 sc1 lds
    s_add_u32 m0, s54, 7040
    s_nop 0
    buffer_load_dwordx4 v9, s[12:15], s49 offen offset:128 sc1 lds
    s_add_u32 s48, s53, 32768
    s_add_u32 s49, s48, 4096
    s_add_u32 s46, s54, 32768
    s_add_u32 m0, s46, 0
    s_nop 0
    buffer_load_dwordx4 v6, s[12:15], s48 offen offset:0 sc1 lds
    s_add_u32 m0, s46, 1024
    s_nop 0
    buffer_load_dwordx4 v9, s[12:15], s48 offen offset:0 sc1 lds
    s_add_u32 m0, s46, 2048
    s_nop 0
    buffer_load_dwordx4 v6, s[12:15], s49 offen offset:0 sc1 lds
    s_add_u32 m0, s46, 3072
    s_nop 0
    buffer_load_dwordx4 v9, s[12:15], s49 offen offset:0 sc1 lds
    s_add_u32 m0, s46, 3968
    s_nop 0
    buffer_load_dwordx4 v6, s[12:15], s48 offen offset:128 sc1 lds
    s_add_u32 m0, s46, 4992
    s_nop 0
    buffer_load_dwordx4 v9, s[12:15], s48 offen offset:128 sc1 lds
    s_add_u32 m0, s46, 6016
    s_nop 0
    buffer_load_dwordx4 v6, s[12:15], s49 offen offset:128 sc1 lds
    s_add_u32 m0, s46, 7040
    s_nop 0
    buffer_load_dwordx4 v9, s[12:15], s49 offen offset:128 sc1 lds
    s_add_u32 s48, s53, 65536
    s_cmp_gt_u32 s51, 1
    s_cselect_b32 s48, s48, 0x20000000
    s_add_u32 s49, s48, 4096
    s_add_u32 m0, s55, 0
    s_nop 0
    buffer_load_dwordx4 v6, s[12:15], s48 offen offset:0 sc1 lds
    s_add_u32 m0, s55, 1024
    s_nop 0
    buffer_load_dwordx4 v9, s[12:15], s48 offen offset:0 sc1 lds
    s_add_u32 m0, s55, 2048
    s_nop 0
    buffer_load_dwordx4 v6, s[12:15], s49 offen offset:0 sc1 lds
    s_add_u32 m0, s55, 3072
    s_nop 0
    buffer_load_dwordx4 v9, s[12:15], s49 offen offset:0 sc1 lds
    s_add_u32 m0, s55, 3968
    s_nop 0
    buffer_load_dwordx4 v6, s[12:15], s48 offen offset:128 sc1 lds
    s_add_u32 m0, s55, 4992
    s_nop 0
    buffer_load_dwordx4 v9, s[12:15], s48 offen offset:128 sc1 lds
    s_add_u32 m0, s55, 6016
    s_nop 0
    buffer_load_dwordx4 v6, s[12:15], s49 offen offset:128 sc1 lds
    s_add_u32 m0, s55, 7040
    s_nop 0
    buffer_load_dwordx4 v9, s[12:15], s49 offen offset:128 sc1 lds
    s_waitcnt vmcnt(16)
    s_barrier
    ds_read_b128 v[32:35], v13 offset:0
    ds_read_b128 v[36:39], v13 offset:2048
    ds_read_b128 v[40:43], v15 offset:0
    ds_read_b128 v[44:47], v15 offset:2048
L_e_loop_125:
    s_add_u32 s48, s53, 98304
    s_add_u32 s46, s58, 1
    s_cmp_lt_u32 s46, s51
    s_cselect_b32 s48, s48, 0x20000000
    s_add_u32 s49, s48, 4096
    s_add_u32 s59, s55, 32768
    s_waitcnt lgkmcnt(2)
    v_mfma_f32_16x16x32_bf16 v[80:83], a[0:3], v[32:35], 0
    ds_read_b128 v[48:51], v13 offset:4096
    ds_read_b128 v[52:55], v13 offset:6144
    v_mfma_f32_16x16x32_bf16 v[84:87], a[4:7], v[32:35], 0
    ds_read_b128 v[56:59], v15 offset:4096
    ds_read_b128 v[60:63], v15 offset:6144
    v_mfma_f32_16x16x32_bf16 v[88:91], a[0:3], v[36:39], 0
    s_add_u32 m0, s59, 0
    s_nop 0
    buffer_load_dwordx4 v6, s[12:15], s48 offen offset:0 sc1 lds
    v_mfma_f32_16x16x32_bf16 v[92:95], a[4:7], v[36:39], 0
    s_waitcnt lgkmcnt(4)
    v_mfma_f32_16x16x32_bf16 v[80:83], a[8:11], v[40:43], v[80:83]
    ds_read_b128 v[32:35], v13 offset:8192
    ds_read_b128 v[36:39], v13 offset:10240
    v_mfma_f32_16x16x32_bf16 v[84:87], a[12:15], v[40:43], v[84:87]
    v_mfma_f32_16x16x32_bf16 v[88:91], a[8:11], v[44:47], v[88:91]
    s_add_u32 m0, s59, 1024
    s_nop 0
    buffer_load_dwordx4 v9, s[12:15], s48 offen offset:0 sc1 lds
    v_mfma_f32_16x16x32_bf16 v[92:95], a[12:15], v[44:47], v[92:95]
    s_waitcnt lgkmcnt(4)
    v_mfma_f32_16x16x32_bf16 v[80:83], a[16:19], v[48:51], v[80:83]
    ds_read_b128 v[40:43], v15 offset:8192
    ds_read_b128 v[44:47], v15 offset:10240
    v_mfma_f32_16x16x32_bf16 v[84:87], a[20:23], v[48:51], v[84:87]
    v_mfma_f32_16x16x32_bf16 v[88:91], a[16:19], v[52:55], v[88:91]
    s_add_u32 m0, s59, 2048
    s_nop 0
    buffer_load_dwordx4 v6, s[12:15], s49 offen offset:0 sc1 lds
    v_mfma_f32_16x16x32_bf16 v[92:95], a[20:23], v[52:55], v[92:95]
    s_waitcnt lgkmcnt(4)
    v_mfma_f32_16x16x32_bf16 v[80:83], a[24:27], v[56:59], v[80:83]
    ds_read_b128 v[48:51], v13 offset:12288
    ds_read_b128 v[52:55], v13 offset:14336
    v_mfma_f32_16x16x32_bf16 v[84:87], a[28:31], v[56:59], v[84:87]
    v_mfma_f32_16x16x32_bf16 v[88:91], a[24:27], v[60:63], v[88:91]
    s_add_u32 m0, s59, 3072
    s_nop 0
    buffer_load_dwordx4 v9, s[12:15], s49 offen offset:0 sc1 lds
    v_mfma_f32_16x16x32_bf16 v[92:95], a[28:31], v[60:63], v[92:95]
    s_waitcnt lgkmcnt(4)
    v_mfma_f32_16x16x32_bf16 v[80:83], a[32:35], v[32:35], v[80:83]
    ds_read_b128 v[56:59], v15 offset:12288
    ds_read_b128 v[60:63], v15 offset:14336
    v_mfma_f32_16x16x32_bf16 v[84:87], a[36:39], v[32:35], v[84:87]
    v_mfma_f32_16x16x32_bf16 v[88:91], a[32:35], v[36:39], v[88:91]
    s_add_u32 m0, s59, 3968
    s_nop 0
    buffer_load_dwordx4 v6, s[12:15], s48 offen offset:128 sc1 lds
    v_mfma_f32_16x16x32_bf16 v[92:95], a[36:39], v[36:39], v[92:95]
    s_waitcnt lgkmcnt(4)
    v_mfma_f32_16x16x32_bf16 v[80:83], a[40:43], v[40:43], v[80:83]
    ds_read_b128 v[32:35], v13 offset:16384
    ds_read_b128 v[36:39], v13 offset:18432
    v_mfma_f32_16x16x32_bf16 v[84:87], a[44:47], v[40:43], v[84:87]
    v_mfma_f32_16x16x32_bf16 v[88:91], a[40:43], v[44:47], v[88:91]
    s_add_u32 m0, s59, 4992
    s_nop 0
    buffer_load_dwordx4 v9, s[12:15], s48 offen offset:128 sc1 lds
    v_mfma_f32_16x16x32_bf16 v[92:95], a[44:47], v[44:47], v[92:95]
    s_waitcnt lgkmcnt(4)
    v_mfma_f32_16x16x32_bf16 v[80:83], a[48:51], v[48:51], v[80:83]
    ds_read_b128 v[40:43], v15 offset:16384
    ds_read_b128 v[44:47], v15 offset:18432
    v_mfma_f32_16x16x32_bf16 v[84:87], a[52:55], v[48:51], v[84:87]
    v_mfma_f32_16x16x32_bf16 v[88:91], a[48:51], v[52:55], v[88:91]
    s_add_u32 m0, s59, 6016
    s_nop 0
    buffer_load_dwordx4 v6, s[12:15], s49 offen offset:128 sc1 lds
    v_mfma_f32_16x16x32_bf16 v[92:95], a[52:55], v[52:55], v[92:95]
    s_waitcnt lgkmcnt(4)
    v_mfma_f32_16x16x32_bf16 v[80:83], a[56:59], v[56:59], v[80:83]
    ds_read_b128 v[48:51], v13 offset:20480
    ds_read_b128 v[52:55], v13 offset:22528
    v_mfma_f32_16x16x32_bf16 v[84:87], a[60:63], v[56:59], v[84:87]
    v_mfma_f32_16x16x32_bf16 v[88:91], a[56:59], v[60:63], v[88:91]
    s_add_u32 m0, s59, 7040
    s_nop 0
    buffer_load_dwordx4 v9, s[12:15], s49 offen offset:128 sc1 lds
    v_mfma_f32_16x16x32_bf16 v[92:95], a[60:63], v[60:63], v[92:95]
    s_waitcnt lgkmcnt(4)
    v_mfma_f32_16x16x32_bf16 v[80:83], a[64:67], v[32:35], v[80:83]
    ds_read_b128 v[56:59], v15 offset:20480
    ds_read_b128 v[60:63], v15 offset:22528
    v_mfma_f32_16x16x32_bf16 v[84:87], a[68:71], v[32:35], v[84:87]
    v_mfma_f32_16x16x32_bf16 v[88:91], a[64:67], v[36:39], v[88:91]
    v_mfma_f32_16x16x32_bf16 v[92:95], a[68:71], v[36:39], v[92:95]
    s_waitcnt lgkmcnt(4)
    v_mfma_f32_16x16x32_bf16 v[80:83], a[72:75], v[40:43], v[80:83]
    ds_read_b128 v[32:35], v13 offset:24576
    ds_read_b128 v[36:39], v13 offset:26624
    v_mfma_f32_16x16x32_bf16 v[84:87], a[76:79], v[40:43], v[84:87]
    v_mfma_f32_16x16x32_bf16 v[88:91], a[72:75], v[44:47], v[88:91]
    v_mfma_f32_16x16x32_bf16 v[92:95], a[76:79], v[44:47], v[92:95]
    s_waitcnt lgkmcnt(4)
    v_mfma_f32_16x16x32_bf16 v[80:83], a[80:83], v[48:51], v[80:83]
    ds_read_b128 v[40:43], v15 offset:24576
    ds_read_b128 v[44:47], v15 offset:26624
    v_mfma_f32_16x16x32_bf16 v[84:87], a[84:87], v[48:51], v[84:87]
    v_mfma_f32_16x16x32_bf16 v[88:91], a[80:83], v[52:55], v[88:91]
    v_mfma_f32_16x16x32_bf16 v[92:95], a[84:87], v[52:55], v[92:95]
    s_waitcnt lgkmcnt(4)
    v_mfma_f32_16x16x32_bf16 v[80:83], a[88:91], v[56:59], v[80:83]
    ds_read_b128 v[48:51], v13 offset:28672
    ds_read_b128 v[52:55], v13 offset:30720
    v_mfma_f32_16x16x32_bf16 v[84:87], a[92:95], v[56:59], v[84:87]
    v_mfma_f32_16x16x32_bf16 v[88:91], a[88:91], v[60:63], v[88:91]
    v_mfma_f32_16x16x32_bf16 v[92:95], a[92:95], v[60:63], v[92:95]
    s_waitcnt lgkmcnt(4)
    v_mfma_f32_16x16x32_bf16 v[80:83], a[96:99], v[32:35], v[80:83]
    ds_read_b128 v[56:59], v15 offset:28672
    ds_read_b128 v[60:63], v15 offset:30720
    v_mfma_f32_16x16x32_bf16 v[84:87], a[100:103], v[32:35], v[84:87]
    v_mfma_f32_16x16x32_bf16 v[88:91], a[96:99], v[36:39], v[88:91]
    v_mfma_f32_16x16x32_bf16 v[92:95], a[100:103], v[36:39], v[92:95]
    s_waitcnt lgkmcnt(4)
    v_mfma_f32_16x16x32_bf16 v[80:83], a[104:107], v[40:43], v[80:83]
    v_mfma_f32_16x16x32_bf16 v[84:87], a[108:111], v[40:43], v[84:87]
    v_mfma_f32_16x16x32_bf16 v[88:91], a[104:107], v[44:47], v[88:91]
    v_mfma_f32_16x16x32_bf16 v[92:95], a[108:111], v[44:47], v[92:95]
    s_waitcnt vmcnt(16) lgkmcnt(0)
    s_barrier
    v_mfma_f32_16x16x32_bf16 v[80:83], a[112:115], v[48:51], v[80:83]
    ds_read_b128 v[32:35], v13 offset:32768
    ds_read_b128 v[36:39], v13 offset:34816
    v_mfma_f32_16x16x32_bf16 v[84:87], a[116:119], v[48:51], v[84:87]
    v_mfma_f32_16x16x32_bf16 v[88:91], a[112:115], v[52:55], v[88:91]
    v_mfma_f32_16x16x32_bf16 v[92:95], a[116:119], v[52:55], v[92:95]
    v_mfma_f32_16x16x32_bf16 v[80:83], a[120:123], v[56:59], v[80:83]
    ds_read_b128 v[40:43], v15 offset:32768
    ds_read_b128 v[44:47], v15 offset:34816
    v_mfma_f32_16x16x32_bf16 v[84:87], a[124:127], v[56:59], v[84:87]
    v_mfma_f32_16x16x32_bf16 v[88:91], a[120:123], v[60:63], v[88:91]
    v_mfma_f32_16x16x32_bf16 v[92:95], a[124:127], v[60:63], v[92:95]
    s_add_u32 s48, s53, 131072
    s_add_u32 s46, s58, 2
    s_cmp_lt_u32 s46, s51
    s_cselect_b32 s48, s48, 0x20000000
    s_add_u32 s49, s48, 4096
    s_mov_b32 s59, s54
    s_waitcnt lgkmcnt(2)
    v_mfma_f32_16x16x32_bf16 v[80:83], a[128:131], v[32:35], v[80:83]
    ds_read_b128 v[48:51], v13 offset:36864
    ds_read_b128 v[52:55], v13 offset:38912
    v_mfma_f32_16x16x32_bf16 v[84:87], a[132:135], v[32:35], v[84:87]
    ds_read_b128 v[56:59], v15 offset:36864
    ds_read_b128 v[60:63], v15 offset:38912
    v_mfma_f32_16x16x32_bf16 v[88:91], a[128:131], v[36:39], v[88:91]
    s_add_u32 m0, s59, 0
    s_nop 0
    buffer_load_dwordx4 v6, s[12:15], s48 offen offset:0 sc1 lds
    v_mfma_f32_16x16x32_bf16 v[92:95], a[132:135], v[36:39], v[92:95]
    s_waitcnt lgkmcnt(4)
    v_mfma_f32_16x16x32_bf16 v[80:83], a[136:139], v[40:43], v[80:83]
    ds_read_b128 v[32:35], v13 offset:40960
    ds_read_b128 v[36:39], v13 offset:43008
    v_mfma_f32_16x16x32_bf16 v[84:87], a[140:143], v[40:43], v[84:87]
    v_mfma_f32_16x16x32_bf16 v[88:91], a[136:139], v[44:47], v[88:91]
    s_add_u32 m0, s59, 1024
    s_nop 0
    buffer_load_dwordx4 v9, s[12:15], s48 offen offset:0 sc1 lds
    v_mfma_f32_16x16x32_bf16 v[92:95], a[140:143], v[44:47], v[92:95]
    s_waitcnt lgkmcnt(4)
    v_mfma_f32_16x16x32_bf16 v[80:83], a[144:147], v[48:51], v[80:83]
    ds_read_b128 v[40:43], v15 offset:40960
    ds_read_b128 v[44:47], v15 offset:43008
    v_mfma_f32_16x16x32_bf16 v[84:87], a[148:151], v[48:51], v[84:87]
    v_mfma_f32_16x16x32_bf16 v[88:91], a[144:147], v[52:55], v[88:91]
    s_add_u32 m0, s59, 2048
    s_nop 0
    buffer_load_dwordx4 v6, s[12:15], s49 offen offset:0 sc1 lds
    v_mfma_f32_16x16x32_bf16 v[92:95], a[148:151], v[52:55], v[92:95]
    s_waitcnt lgkmcnt(4)
    v_mfma_f32_16x16x32_bf16 v[80:83], a[152:155], v[56:59], v[80:83]
    ds_read_b128 v[48:51], v13 offset:45056
    ds_read_b128 v[52:55], v13 offset:47104
    v_mfma_f32_16x16x32_bf16 v[84:87], a[156:159], v[56:59], v[84:87]
    v_mfma_f32_16x16x32_bf16 v[88:91], a[152:155], v[60:63], v[88:91]
    s_add_u32 m0, s59, 3072
    s_nop 0
    buffer_load_dwordx4 v9, s[12:15], s49 offen offset:0 sc1 lds
    v_mfma_f32_16x16x32_bf16 v[92:95], a[156:159], v[60:63], v[92:95]
    s_waitcnt lgkmcnt(4)
    v_mfma_f32_16x16x32_bf16 v[80:83], a[160:163], v[32:35], v[80:83]
    ds_read_b128 v[56:59], v15 offset:45056
    ds_read_b128 v[60:63], v15 offset:47104
    v_mfma_f32_16x16x32_bf16 v[84:87], a[164:167], v[32:35], v[84:87]
    v_mfma_f32_16x16x32_bf16 v[88:91], a[160:163], v[36:39], v[88:91]
    s_add_u32 m0, s59, 3968
    s_nop 0
    buffer_load_dwordx4 v6, s[12:15], s48 offen offset:128 sc1 lds
    v_mfma_f32_16x16x32_bf16 v[92:95], a[164:167], v[36:39], v[92:95]
    s_waitcnt lgkmcnt(4)
    v_mfma_f32_16x16x32_bf16 v[80:83], a[168:171], v[40:43], v[80:83]
    ds_read_b128 v[32:35], v13 offset:49152
    ds_read_b128 v[36:39], v13 offset:51200
    v_mfma_f32_16x16x32_bf16 v[84:87], a[172:175], v[40:43], v[84:87]
    v_mfma_f32_16x16x32_bf16 v[88:91], a[168:171], v[44:47], v[88:91]
    s_add_u32 m0, s59, 4992
    s_nop 0
    buffer_load_dwordx4 v9, s[12:15], s48 offen offset:128 sc1 lds
    v_mfma_f32_16x16x32_bf16 v[92:95], a[172:175], v[44:47], v[92:95]
    s_waitcnt lgkmcnt(4)
    v_mfma_f32_16x16x32_bf16 v[80:83], a[176:179], v[48:51], v[80:83]
    ds_read_b128 v[40:43], v15 offset:49152
    ds_read_b128 v[44:47], v15 offset:51200
    v_mfma_f32_16x16x32_bf16 v[84:87], a[180:183], v[48:51], v[84:87]
    v_mfma_f32_16x16x32_bf16 v[88:91], a[176:179], v[52:55], v[88:91]
    s_add_u32 m0, s59, 6016
    s_nop 0
    buffer_load_dwordx4 v6, s[12:15], s49 offen offset:128 sc1 lds
    v_mfma_f32_16x16x32_bf16 v[92:95], a[180:183], v[52:55], v[92:95]
    s_waitcnt lgkmcnt(4)
    v_mfma_f32_16x16x32_bf16 v[80:83], a[184:187], v[56:59], v[80:83]
    ds_read_b128 v[48:51], v13 offset:53248
    ds_read_b128 v[52:55], v13 offset:55296
    v_mfma_f32_16x16x32_bf16 v[84:87], a[188:191], v[56:59], v[84:87]
    v_mfma_f32_16x16x32_bf16 v[88:91], a[184:187], v[60:63], v[88:91]
    s_add_u32 m0, s59, 7040
    s_nop 0
    buffer_load_dwordx4 v9, s[12:15], s49 offen offset:128 sc1 lds
    v_mfma_f32_16x16x32_bf16 v[92:95], a[188:191], v[60:63], v[92:95]
    s_waitcnt lgkmcnt(4)
    v_mfma_f32_16x16x32_bf16 v[80:83], a[192:195], v[32:35], v[80:83]
    ds_read_b128 v[56:59], v15 offset:53248
    ds_read_b128 v[60:63], v15 offset:55296
    v_mfma_f32_16x16x32_bf16 v[84:87], a[196:199], v[32:35], v[84:87]
    v_mfma_f32_16x16x32_bf16 v[88:91], a[192:195], v[36:39], v[88:91]
    v_mfma_f32_16x16x32_bf16 v[92:95], a[196:199], v[36:39], v[92:95]
    s_waitcnt lgkmcnt(4)
    v_mfma_f32_16x16x32_bf16 v[80:83], a[200:203], v[40:43], v[80:83]
    ds_read_b128 v[32:35], v13 offset:57344
    ds_read_b128 v[36:39], v13 offset:59392
    v_mfma_f32_16x16x32_bf16 v[84:87], a[204:207], v[40:43], v[84:87]
    v_mfma_f32_16x16x32_bf16 v[88:91], a[200:203], v[44:47], v[88:91]
    v_mfma_f32_16x16x32_bf16 v[92:95], a[204:207], v[44:47], v[92:95]
    s_waitcnt lgkmcnt(4)
    v_mfma_f32_16x16x32_bf16 v[80:83], a[208:211], v[48:51], v[80:83]
    ds_read_b128 v[40:43], v15 offset:57344
    ds_read_b128 v[44:47], v15 offset:59392
    v_mfma_f32_16x16x32_bf16 v[84:87], a[212:215], v[48:51], v[84:87]
    v_mfma_f32_16x16x32_bf16 v[88:91], a[208:211], v[52:55], v[88:91]
    v_mfma_f32_16x16x32_bf16 v[92:95], a[212:215], v[52:55], v[92:95]
    s_waitcnt lgkmcnt(4)
    v_mfma_f32_16x16x32_bf16 v[80:83], a[216:219], v[56:59], v[80:83]
    ds_read_b128 v[48:51], v13 offset:61440
    ds_read_b128 v[52:55], v13 offset:63488
    v_mfma_f32_16x16x32_bf16 v[84:87], a[220:223], v[56:59], v[84:87]
    v_mfma_f32_16x16x32_bf16 v[88:91], a[216:219], v[60:63], v[88:91]
    v_mfma_f32_16x16x32_bf16 v[92:95], a[220:223], v[60:63], v[92:95]
    s_waitcnt lgkmcnt(4)
    v_mfma_f32_16x16x32_bf16 v[80:83], a[224:227], v[32:35], v[80:83]
    ds_read_b128 v[56:59], v15 offset:61440
    ds_read_b128 v[60:63], v15 offset:63488
    v_mfma_f32_16x16x32_bf16 v[84:87], a[228:231], v[32:35], v[84:87]
    v_mfma_f32_16x16x32_bf16 v[88:91], a[224:227], v[36:39], v[88:91]
    v_mfma_f32_16x16x32_bf16 v[92:95], a[228:231], v[36:39], v[92:95]
    s_waitcnt lgkmcnt(4)
    v_mfma_f32_16x16x32_bf16 v[80:83], a[232:235], v[40:43], v[80:83]
    v_mfma_f32_16x16x32_bf16 v[84:87], a[236:239], v[40:43], v[84:87]
    v_mfma_f32_16x16x32_bf16 v[88:91], a[232:235], v[44:47], v[88:91]
    v_mfma_f32_16x16x32_bf16 v[92:95], a[236:239], v[44:47], v[92:95]
    s_waitcnt vmcnt(16) lgkmcnt(0)
    s_barrier
    s_cmp_lg_u32 s44, 0
    s_cbranch_scc1 L_e_pr_126
    s_add_u32 s45, s58, s60
    v_mov_b32 v30, s45
    v_mov_b32 v31, 0
    s_mov_b64 exec, 1
    buffer_store_dword v30, v31, s[12:15], s61 offen sc1
    s_mov_b64 exec, -1
L_e_pr_126:
    v_mfma_f32_16x16x32_bf16 v[80:83], a[240:243], v[48:51], v[80:83]
    ds_read_b128 v[32:35], v14 offset:0
    ds_read_b128 v[36:39], v14 offset:2048
    v_mfma_f32_16x16x32_bf16 v[84:87], a[244:247], v[48:51], v[84:87]
    v_mfma_f32_16x16x32_bf16 v[88:91], a[240:243], v[52:55], v[88:91]
    v_mfma_f32_16x16x32_bf16 v[92:95], a[244:247], v[52:55], v[92:95]
    v_mfma_f32_16x16x32_bf16 v[80:83], a[248:251], v[56:59], v[80:83]
    ds_read_b128 v[40:43], v16 offset:0
    ds_read_b128 v[44:47], v16 offset:2048
    v_mfma_f32_16x16x32_bf16 v[84:87], a[252:255], v[56:59], v[84:87]
    v_mfma_f32_16x16x32_bf16 v[88:91], a[248:251], v[60:63], v[88:91]
    v_mfma_f32_16x16x32_bf16 v[92:95], a[252:255], v[60:63], v[92:95]
    s_add_u32 s53, s53, 65536
    s_add_u32 s58, s58, 1
    v_swap_b32 v13, v14
    s_xor_b32 s54, s54, 65536
    s_xor_b32 s55, s55, 65536
    s_mov_b32 s76, s57
    v_swap_b32 v15, v16
    s_add_u32 s57, s57, 8192
    v_cvt_pk_bf16_f32 v216, v80, v81
    v_cvt_pk_bf16_f32 v217, v82, v83
    v_cvt_pk_bf16_f32 v218, v84, v85
    v_cvt_pk_bf16_f32 v219, v86, v87
    v_cvt_pk_bf16_f32 v220, v88, v89
    v_cvt_pk_bf16_f32 v221, v90, v91
    v_cvt_pk_bf16_f32 v222, v92, v93
    v_cvt_pk_bf16_f32 v223, v94, v95
    buffer_store_dwordx4 v[216:219], v10, s[12:15], s76 offen sc1
    buffer_store_dwordx4 v[220:223], v10, s[12:15], s76 offen offset:1024 sc1
    s_cmp_lt_u32 s58, s51
    s_cbranch_scc1 L_e_loop_125
    s_waitcnt lgkmcnt(0)
    s_add_u32 s60, s60, s51
    s_waitcnt vmcnt(0)
    s_barrier
    s_cmp_lg_u32 s44, 0
    s_cbranch_scc1 L_pub_127
    v_mov_b32 v30, s60
    v_mov_b32 v31, 0
    s_mov_b64 exec, 1
    buffer_store_dword v30, v31, s[12:15], s61 offen sc1
    s_mov_b64 exec, -1
L_pub_127:
    s_cmp_eq_u32 s60, 1
    s_cselect_b32 s51, 11, 52
    s_cselect_b32 s71, s71, 196
    s_cmp_lt_u32 s60, 64
    s_cbranch_scc1 L_w_qkv_122
L_w_roles_111:
    s_cmp_lg_u32 s44, 0
    s_cbranch_scc1 L_pd_128
    v_mov_b32 v29, 64
    s_mov_b32 s46, 192
    s_mov_b64 exec, 1
    s_mov_b32 s70, 0
L_wp_129:
    buffer_load_dword v31, v29, s[16:19], 0 offen sc1
    s_add_u32 s70, s70, 1
    s_cmp_ge_u32 s70, 0x200000
    s_cbranch_scc1 L_w_done_109
    s_waitcnt vmcnt(0)
    v_cmp_gt_u32 vcc, s46, v31
    s_nop 1
    s_cbranch_vccz L_wp_129_ok
    s_sleep 3
    s_branch L_wp_129
L_wp_129_ok:
    s_mov_b64 exec, -1
L_pd_128:
    s_barrier
    s_mov_b32 s36, 0x10111111
    s_mov_b32 s37, 0x91081010
    s_cmp_eq_u32 s42, 0
    s_cselect_b32 s36, s36, 0x1000000
    s_cselect_b32 s37, s37, 0x44410101
    s_mov_b32 s72, 0x88888888
    s_mov_b32 s73, 0xeaa48888
    s_lshr_b32 s38, s41, 3
    s_and_b32 s68, s41, 7
    s_cmp_eq_u32 s43, 1
    s_cbranch_scc1 L_role_b_130
    s_cmp_eq_u32 s43, 2
    s_cbranch_scc1 L_role_c_131
    s_load_dwordx2 s[6:7], s[0:1], 40
    s_waitcnt lgkmcnt(0)
    s_mov_b32 s24, s6
    s_and_b32 s25, s7, 0xffff
    s_mov_b32 s26, 0x800000
    s_mov_b32 s27, 0x00020000
    s_lshl_b32 s46, s38, 21
    s_lshl_b32 s45, s68, 8
    s_add_u32 s46, s46, s45
    s_waitcnt vmcnt(0)
    s_barrier
    v_lshrrev_b32 v20, 4, v1
    s_lshl_b32 s45, s44, 2
    v_add_u32 v21, s45, v20
    s_mov_b32 s45, 2048
    v_mul_lo_u32 v21, v21, s45
    v_lshlrev_b32 v22, 2, v20
    v_and_b32 v23, 15, v1
    v_xor_b32 v22, v22, v23
    v_lshlrev_b32 v22, 4, v22
    v_add_u32 v21, v21, v22
    v_bfe_u32 v22, v1, 2, 2
    v_lshlrev_b32 v23, 2, v20
    v_add_u32 v23, v23, v22
    v_lshlrev_b32 v23, 8, v23
    v_xor_b32 v22, s44, v22
    v_lshlrev_b32 v22, 6, v22
    v_add_u32 v23, v23, v22
    v_and_b32 v22, 3, v1
    v_lshlrev_b32 v22, 3, v22
    v_add_u32 v23, v23, v22
    v_add_u32 v24, 65536, v23
    v_add_u32 v25, 131072, v23
    s_lshl_b32 s47, s44, 10
    s_add_u32 s45, s46, 0x0
    s_add_u32 m0, s47, 0
    s_nop 0
    buffer_load_dwordx4 v21, s[24:27], s45 offen nt lds
    s_add_u32 s45, s46, 0x8000
    s_add_u32 m0, s47, 4096
    s_nop 0
    buffer_load_dwordx4 v21, s[24:27], s45 offen nt lds
    s_add_u32 s45, s46, 0x10000
    s_add_u32 m0, s47, 8192
    s_nop 0
    buffer_load_dwordx4 v21, s[24:27], s45 offen nt lds
    s_add_u32 s45, s46, 0x18000
    s_add_u32 m0, s47, 12288
    s_nop 0
    buffer_load_dwordx4 v21, s[24:27], s45 offen nt lds
    s_add_u32 s45, s46, 0x20000
    s_add_u32 m0, s47, 16384
    s_nop 0
    buffer_load_dwordx4 v21, s[24:27], s45 offen nt lds
    s_add_u32 s45, s46, 0x28000
    s_add_u32 m0, s47, 20480
    s_nop 0
    buffer_load_dwordx4 v21, s[24:27], s45 offen nt lds
    s_add_u32 s45, s46, 0x30000
    s_add_u32 m0, s47, 24576
    s_nop 0
    buffer_load_dwordx4 v21, s[24:27], s45 offen nt lds
    s_add_u32 s45, s46, 0x38000
    s_add_u32 m0, s47, 28672
    s_nop 0
    buffer_load_dwordx4 v21, s[24:27], s45 offen nt lds
    s_add_u32 s45, s46, 0x40000
    s_add_u32 m0, s47, 32768
    s_nop 0
    buffer_load_dwordx4 v21, s[24:27], s45 offen nt lds
    s_add_u32 s45, s46, 0x48000
    s_add_u32 m0, s47, 36864
    s_nop 0
    buffer_load_dwordx4 v21, s[24:27], s45 offen nt lds
    s_add_u32 s45, s46, 0x50000
    s_add_u32 m0, s47, 40960
    s_nop 0
    buffer_load_dwordx4 v21, s[24:27], s45 offen nt lds
    s_add_u32 s45, s46, 0x58000
    s_add_u32 m0, s47, 45056
    s_nop 0
    buffer_load_dwordx4 v21, s[24:27], s45 offen nt lds
    s_add_u32 s45, s46, 0x60000
    s_add_u32 m0, s47, 49152
    s_nop 0
    buffer_load_dwordx4 v21, s[24:27], s45 offen nt lds
    s_add_u32 s45, s46, 0x68000
    s_add_u32 m0, s47, 53248
    s_nop 0
    buffer_load_dwordx4 v21, s[24:27], s45 offen nt lds
    s_add_u32 s45, s46, 0x70000
    s_add_u32 m0, s47, 57344
    s_nop 0
    buffer_load_dwordx4 v21, s[24:27], s45 offen nt lds
    s_add_u32 s45, s46, 0x78000
    s_add_u32 m0, s47, 61440
    s_nop 0
    buffer_load_dwordx4 v21, s[24:27], s45 offen nt lds
    s_add_u32 s45, s46, 0x80000
    s_add_u32 m0, s47, 65536
    s_nop 0
    buffer_load_dwordx4 v21, s[24:27], s45 offen nt lds
    s_add_u32 s45, s46, 0x88000
    s_add_u32 m0, s47, 69632
    s_nop 0
    buffer_load_dwordx4 v21, s[24:27], s45 offen nt lds
    s_add_u32 s45, s46, 0x90000
    s_add_u32 m0, s47, 73728
    s_nop 0
    buffer_load_dwordx4 v21, s[24:27], s45 offen nt lds
    s_add_u32 s45, s46, 0x98000
    s_add_u32 m0, s47, 77824
    s_nop 0
    buffer_load_dwordx4 v21, s[24:27], s45 offen nt lds
    s_add_u32 s45, s46, 0xa0000
    s_add_u32 m0, s47, 81920
    s_nop 0
    buffer_load_dwordx4 v21, s[24:27], s45 offen nt lds
    s_add_u32 s45, s46, 0xa8000
    s_add_u32 m0, s47, 86016
    s_nop 0
    buffer_load_dwordx4 v21, s[24:27], s45 offen nt lds
    s_add_u32 s45, s46, 0xb0000
    s_add_u32 m0, s47, 90112
    s_nop 0
    buffer_load_dwordx4 v21, s[24:27], s45 offen nt lds
    s_add_u32 s45, s46, 0xb8000
    s_add_u32 m0, s47, 94208
    s_nop 0
    buffer_load_dwordx4 v21, s[24:27], s45 offen nt lds
    s_add_u32 s45, s46, 0xc0000
    s_add_u32 m0, s47, 98304
    s_nop 0
    buffer_load_dwordx4 v21, s[24:27], s45 offen nt lds
    s_add_u32 s45, s46, 0xc8000
    s_add_u32 m0, s47, 102400
    s_nop 0
    buffer_load_dwordx4 v21, s[24:27], s45 offen nt lds
    s_add_u32 s45, s46, 0xd0000
    s_add_u32 m0, s47, 106496
    s_nop 0
    buffer_load_dwordx4 v21, s[24:27], s45 offen nt lds
    s_add_u32 s45, s46, 0xd8000
    s_add_u32 m0, s47, 110592
    s_nop 0
    buffer_load_dwordx4 v21, s[24:27], s45 offen nt lds
    s_add_u32 s45, s46, 0xe0000
    s_add_u32 m0, s47, 114688
    s_nop 0
    buffer_load_dwordx4 v21, s[24:27], s45 offen nt lds
    s_add_u32 s45, s46, 0xe8000
    s_add_u32 m0, s47, 118784
    s_nop 0
    buffer_load_dwordx4 v21, s[24:27], s45 offen nt lds
    s_add_u32 s45, s46, 0xf0000
    s_add_u32 m0, s47, 122880
    s_nop 0
    buffer_load_dwordx4 v21, s[24:27], s45 offen nt lds
    s_add_u32 s45, s46, 0xf8000
    s_add_u32 m0, s47, 126976
    s_nop 0
    buffer_load_dwordx4 v21, s[24:27], s45 offen nt lds
    s_waitcnt vmcnt(28)
    s_barrier
    s_add_u32 s45, s46, 0x100000
    s_add_u32 m0, s47, 131072
    s_nop 0
    buffer_load_dwordx4 v21, s[24:27], s45 offen nt lds
    s_add_u32 s45, s46, 0x108000
    s_add_u32 m0, s47, 135168
    s_nop 0
    buffer_load_dwordx4 v21, s[24:27], s45 offen nt lds
    s_add_u32 s45, s46, 0x110000
    s_add_u32 m0, s47, 139264
    s_nop 0
    buffer_load_dwordx4 v21, s[24:27], s45 offen nt lds
    s_add_u32 s45, s46, 0x118000
    s_add_u32 m0, s47, 143360
    s_nop 0
    buffer_load_dwordx4 v21, s[24:27], s45 offen nt lds
    ds_read_b64_tr_b16 a[0:1], v23 offset:0
    ds_read_b64_tr_b16 a[2:3], v23 offset:4096
    ds_read_b64_tr_b16 a[4:5], v23 offset:32
    ds_read_b64_tr_b16 a[6:7], v23 offset:4128
    ds_read_b64_tr_b16 a[8:9], v23 offset:8192
    ds_read_b64_tr_b16 a[10:11], v23 offset:12288
    ds_read_b64_tr_b16 a[12:13], v23 offset:8224
    ds_read_b64_tr_b16 a[14:15], v23 offset:12320
    s_waitcnt lgkmcnt(0)
    s_waitcnt vmcnt(28)
    s_barrier
    s_add_u32 s45, s46, 0x120000
    s_add_u32 m0, s47, 0
    s_nop 0
    buffer_load_dwordx4 v21, s[24:27], s45 offen nt lds
    s_add_u32 s45, s46, 0x128000
    s_add_u32 m0, s47, 4096
    s_nop 0
    buffer_load_dwordx4 v21, s[24:27], s45 offen nt lds
    s_add_u32 s45, s46, 0x130000
    s_add_u32 m0, s47, 8192
    s_nop 0
    buffer_load_dwordx4 v21, s[24:27], s45 offen nt lds
    s_add_u32 s45, s46, 0x138000
    s_add_u32 m0, s47, 12288
    s_nop 0
    buffer_load_dwordx4 v21, s[24:27], s45 offen nt lds
    ds_read_b64_tr_b16 a[16:17], v23 offset:16384
    ds_read_b64_tr_b16 a[18:19], v23 offset:20480
    ds_read_b64_tr_b16 a[20:21], v23 offset:16416
    ds_read_b64_tr_b16 a[22:23], v23 offset:20512
    ds_read_b64_tr_b16 a[24:25], v23 offset:24576
    ds_read_b64_tr_b16 a[26:27], v23 offset:28672
    ds_read_b64_tr_b16 a[28:29], v23 offset:24608
    ds_read_b64_tr_b16 a[30:31], v23 offset:28704
    s_waitcnt lgkmcnt(0)
    s_waitcnt vmcnt(28)
    s_barrier
    s_add_u32 s45, s46, 0x140000
    s_add_u32 m0, s47, 16384
    s_nop 0
    buffer_load_dwordx4 v21, s[24:27], s45 offen nt lds
    s_add_u32 s45, s46, 0x148000
    s_add_u32 m0, s47, 20480
    s_nop 0
    buffer_load_dwordx4 v21, s[24:27], s45 offen nt lds
    s_add_u32 s45, s46, 0x150000
    s_add_u32 m0, s47, 24576
    s_nop 0
    buffer_load_dwordx4 v21, s[24:27], s45 offen nt lds
    s_add_u32 s45, s46, 0x158000
    s_add_u32 m0, s47, 28672
    s_nop 0
    buffer_load_dwordx4 v21, s[24:27], s45 offen nt lds
    ds_read_b64_tr_b16 a[32:33], v23 offset:32768
    ds_read_b64_tr_b16 a[34:35], v23 offset:36864
    ds_read_b64_tr_b16 a[36:37], v23 offset:32800
    ds_read_b64_tr_b16 a[38:39], v23 offset:36896
    ds_read_b64_tr_b16 a[40:41], v23 offset:40960
    ds_read_b64_tr_b16 a[42:43], v23 offset:45056
    ds_read_b64_tr_b16 a[44:45], v23 offset:40992
    ds_read_b64_tr_b16 a[46:47], v23 offset:45088
    s_waitcnt lgkmcnt(0)
    s_waitcnt vmcnt(28)
    s_barrier
    s_add_u32 s45, s46, 0x160000
    s_add_u32 m0, s47, 32768
    s_nop 0
    buffer_load_dwordx4 v21, s[24:27], s45 offen nt lds
    s_add_u32 s45, s46, 0x168000
    s_add_u32 m0, s47, 36864
    s_nop 0
    buffer_load_dwordx4 v21, s[24:27], s45 offen nt lds
    s_add_u32 s45, s46, 0x170000
    s_add_u32 m0, s47, 40960
    s_nop 0
    buffer_load_dwordx4 v21, s[24:27], s45 offen nt lds
    s_add_u32 s45, s46, 0x178000
    s_add_u32 m0, s47, 45056
    s_nop 0
    buffer_load_dwordx4 v21, s[24:27], s45 offen nt lds
    ds_read_b64_tr_b16 a[48:49], v23 offset:49152
    ds_read_b64_tr_b16 a[50:51], v23 offset:53248
    ds_read_b64_tr_b16 a[52:53], v23 offset:49184
    ds_read_b64_tr_b16 a[54:55], v23 offset:53280
    ds_read_b64_tr_b16 a[56:57], v23 offset:57344
    ds_read_b64_tr_b16 a[58:59], v23 offset:61440
    ds_read_b64_tr_b16 a[60:61], v23 offset:57376
    ds_read_b64_tr_b16 a[62:63], v23 offset:61472
    s_waitcnt lgkmcnt(0)
    s_waitcnt vmcnt(28)
    s_barrier
    s_add_u32 s45, s46, 0x180000
    s_add_u32 m0, s47, 49152
    s_nop 0
    buffer_load_dwordx4 v21, s[24:27], s45 offen nt lds
    s_add_u32 s45, s46, 0x188000
    s_add_u32 m0, s47, 53248
    s_nop 0
    buffer_load_dwordx4 v21, s[24:27], s45 offen nt lds
    s_add_u32 s45, s46, 0x190000
    s_add_u32 m0, s47, 57344
    s_nop 0
    buffer_load_dwordx4 v21, s[24:27], s45 offen nt lds
    s_add_u32 s45, s46, 0x198000
    s_add_u32 m0, s47, 61440
    s_nop 0
    buffer_load_dwordx4 v21, s[24:27], s45 offen nt lds
    ds_read_b64_tr_b16 a[64:65], v24 offset:0
    ds_read_b64_tr_b16 a[66:67], v24 offset:4096
    ds_read_b64_tr_b16 a[68:69], v24 offset:32
    ds_read_b64_tr_b16 a[70:71], v24 offset:4128
    ds_read_b64_tr_b16 a[72:73], v24 offset:8192
    ds_read_b64_tr_b16 a[74:75], v24 offset:12288
    ds_read_b64_tr_b16 a[76:77], v24 offset:8224
    ds_read_b64_tr_b16 a[78:79], v24 offset:12320
    s_waitcnt lgkmcnt(0)
    s_waitcnt vmcnt(28)
    s_barrier
    s_add_u32 s45, s46, 0x1a0000
    s_add_u32 m0, s47, 65536
    s_nop 0
    buffer_load_dwordx4 v21, s[24:27], s45 offen nt lds
    s_add_u32 s45, s46, 0x1a8000
    s_add_u32 m0, s47, 69632
    s_nop 0
    buffer_load_dwordx4 v21, s[24:27], s45 offen nt lds
    s_add_u32 s45, s46, 0x1b0000
    s_add_u32 m0, s47, 73728
    s_nop 0
    buffer_load_dwordx4 v21, s[24:27], s45 offen nt lds
    s_add_u32 s45, s46, 0x1b8000
    s_add_u32 m0, s47, 77824
    s_nop 0
    buffer_load_dwordx4 v21, s[24:27], s45 offen nt lds
    ds_read_b64_tr_b16 a[80:81], v24 offset:16384
    ds_read_b64_tr_b16 a[82:83], v24 offset:20480
    ds_read_b64_tr_b16 a[84:85], v24 offset:16416
    ds_read_b64_tr_b16 a[86:87], v24 offset:20512
    ds_read_b64_tr_b16 a[88:89], v24 offset:24576
    ds_read_b64_tr_b16 a[90:91], v24 offset:28672
    ds_read_b64_tr_b16 a[92:93], v24 offset:24608
    ds_read_b64_tr_b16 a[94:95], v24 offset:28704
    s_waitcnt lgkmcnt(0)
    s_waitcnt vmcnt(28)
    s_barrier
    s_add_u32 s45, s46, 0x1c0000
    s_add_u32 m0, s47, 81920
    s_nop 0
    buffer_load_dwordx4 v21, s[24:27], s45 offen nt lds
    s_add_u32 s45, s46, 0x1c8000
    s_add_u32 m0, s47, 86016
    s_nop 0
    buffer_load_dwordx4 v21, s[24:27], s45 offen nt lds
    s_add_u32 s45, s46, 0x1d0000
    s_add_u32 m0, s47, 90112
    s_nop 0
    buffer_load_dwordx4 v21, s[24:27], s45 offen nt lds
    s_add_u32 s45, s46, 0x1d8000
    s_add_u32 m0, s47, 94208
    s_nop 0
    buffer_load_dwordx4 v21, s[24:27], s45 offen nt lds
    ds_read_b64_tr_b16 a[96:97], v24 offset:32768
    ds_read_b64_tr_b16 a[98:99], v24 offset:36864
    ds_read_b64_tr_b16 a[100:101], v24 offset:32800
    ds_read_b64_tr_b16 a[102:103], v24 offset:36896
    ds_read_b64_tr_b16 a[104:105], v24 offset:40960
    ds_read_b64_tr_b16 a[106:107], v24 offset:45056
    ds_read_b64_tr_b16 a[108:109], v24 offset:40992
    ds_read_b64_tr_b16 a[110:111], v24 offset:45088
    s_waitcnt lgkmcnt(0)
    s_waitcnt vmcnt(28)
    s_barrier
    s_add_u32 s45, s46, 0x1e0000
    s_add_u32 m0, s47, 98304
    s_nop 0
    buffer_load_dwordx4 v21, s[24:27], s45 offen nt lds
    s_add_u32 s45, s46, 0x1e8000
    s_add_u32 m0, s47, 102400
    s_nop 0
    buffer_load_dwordx4 v21, s[24:27], s45 offen nt lds
    s_add_u32 s45, s46, 0x1f0000
    s_add_u32 m0, s47, 106496
    s_nop 0
    buffer_load_dwordx4 v21, s[24:27], s45 offen nt lds
    s_add_u32 s45, s46, 0x1f8000
    s_add_u32 m0, s47, 110592
    s_nop 0
    buffer_load_dwordx4 v21, s[24:27], s45 offen nt lds
    ds_read_b64_tr_b16 a[112:113], v24 offset:49152
    ds_read_b64_tr_b16 a[114:115], v24 offset:53248
    ds_read_b64_tr_b16 a[116:117], v24 offset:49184
    ds_read_b64_tr_b16 a[118:119], v24 offset:53280
    ds_read_b64_tr_b16 a[120:121], v24 offset:57344
    ds_read_b64_tr_b16 a[122:123], v24 offset:61440
    ds_read_b64_tr_b16 a[124:125], v24 offset:57376
    ds_read_b64_tr_b16 a[126:127], v24 offset:61472
    s_waitcnt lgkmcnt(0)
    s_waitcnt vmcnt(28)
    s_barrier
    ds_read_b64_tr_b16 a[128:129], v25 offset:0
    ds_read_b64_tr_b16 a[130:131], v25 offset:4096
    ds_read_b64_tr_b16 a[132:133], v25 offset:32
    ds_read_b64_tr_b16 a[134:135], v25 offset:4128
    ds_read_b64_tr_b16 a[136:137], v25 offset:8192
    ds_read_b64_tr_b16 a[138:139], v25 offset:12288
    ds_read_b64_tr_b16 a[140:141], v25 offset:8224
    ds_read_b64_tr_b16 a[142:143], v25 offset:12320
    s_waitcnt lgkmcnt(0)
    s_waitcnt vmcnt(24)
    s_barrier
    ds_read_b64_tr_b16 a[144:145], v23 offset:0
    ds_read_b64_tr_b16 a[146:147], v23 offset:4096
    ds_read_b64_tr_b16 a[148:149], v23 offset:32
    ds_read_b64_tr_b16 a[150:151], v23 offset:4128
    ds_read_b64_tr_b16 a[152:153], v23 offset:8192
    ds_read_b64_tr_b16 a[154:155], v23 offset:12288
    ds_read_b64_tr_b16 a[156:157], v23 offset:8224
    ds_read_b64_tr_b16 a[158:159], v23 offset:12320
    s_waitcnt lgkmcnt(0)
    s_waitcnt vmcnt(20)
    s_barrier
    ds_read_b64_tr_b16 a[160:161], v23 offset:16384
    ds_read_b64_tr_b16 a[162:163], v23 offset:20480
    ds_read_b64_tr_b16 a[164:165], v23 offset:16416
    ds_read_b64_tr_b16 a[166:167], v23 offset:20512
    ds_read_b64_tr_b16 a[168:169], v23 offset:24576
    ds_read_b64_tr_b16 a[170:171], v23 offset:28672
    ds_read_b64_tr_b16 a[172:173], v23 offset:24608
    ds_read_b64_tr_b16 a[174:175], v23 offset:28704
    s_waitcnt lgkmcnt(0)
    s_waitcnt vmcnt(16)
    s_barrier
    ds_read_b64_tr_b16 a[176:177], v23 offset:32768
    ds_read_b64_tr_b16 a[178:179], v23 offset:36864
    ds_read_b64_tr_b16 a[180:181], v23 offset:32800
    ds_read_b64_tr_b16 a[182:183], v23 offset:36896
    ds_read_b64_tr_b16 a[184:185], v23 offset:40960
    ds_read_b64_tr_b16 a[186:187], v23 offset:45056
    ds_read_b64_tr_b16 a[188:189], v23 offset:40992
    ds_read_b64_tr_b16 a[190:191], v23 offset:45088
    s_waitcnt lgkmcnt(0)
    s_waitcnt vmcnt(12)
    s_barrier
    ds_read_b64_tr_b16 a[192:193], v23 offset:49152
    ds_read_b64_tr_b16 a[194:195], v23 offset:53248
    ds_read_b64_tr_b16 a[196:197], v23 offset:49184
    ds_read_b64_tr_b16 a[198:199], v23 offset:53280
    ds_read_b64_tr_b16 a[200:201], v23 offset:57344
    ds_read_b64_tr_b16 a[202:203], v23 offset:61440
    ds_read_b64_tr_b16 a[204:205], v23 offset:57376
    ds_read_b64_tr_b16 a[206:207], v23 offset:61472
    s_waitcnt lgkmcnt(0)
    s_waitcnt vmcnt(8)
    s_barrier
    ds_read_b64_tr_b16 a[208:209], v24 offset:0
    ds_read_b64_tr_b16 a[210:211], v24 offset:4096
    ds_read_b64_tr_b16 a[212:213], v24 offset:32
    ds_read_b64_tr_b16 a[214:215], v24 offset:4128
    ds_read_b64_tr_b16 a[216:217], v24 offset:8192
    ds_read_b64_tr_b16 a[218:219], v24 offset:12288
    ds_read_b64_tr_b16 a[220:221], v24 offset:8224
    ds_read_b64_tr_b16 a[222:223], v24 offset:12320
    s_waitcnt lgkmcnt(0)
    s_waitcnt vmcnt(4)
    s_barrier
    ds_read_b64_tr_b16 a[224:225], v24 offset:16384
    ds_read_b64_tr_b16 a[226:227], v24 offset:20480
    ds_read_b64_tr_b16 a[228:229], v24 offset:16416
    ds_read_b64_tr_b16 a[230:231], v24 offset:20512
    ds_read_b64_tr_b16 a[232:233], v24 offset:24576
    ds_read_b64_tr_b16 a[234:235], v24 offset:28672
    ds_read_b64_tr_b16 a[236:237], v24 offset:24608
    ds_read_b64_tr_b16 a[238:239], v24 offset:28704
    s_waitcnt lgkmcnt(0)
    s_waitcnt vmcnt(0)
    s_barrier
    ds_read_b64_tr_b16 a[240:241], v24 offset:32768
    ds_read_b64_tr_b16 a[242:243], v24 offset:36864
    ds_read_b64_tr_b16 a[244:245], v24 offset:32800
    ds_read_b64_tr_b16 a[246:247], v24 offset:36896
    ds_read_b64_tr_b16 a[248:249], v24 offset:40960
    ds_read_b64_tr_b16 a[250:251], v24 offset:45056
    ds_read_b64_tr_b16 a[252:253], v24 offset:40992
    ds_read_b64_tr_b16 a[254:255], v24 offset:45088
    s_waitcnt lgkmcnt(0)
    s_barrier
    s_lshl_b32 s52, s38, 16
    s_add_u32 s52, s52, 0x5000000
    s_lshl_b32 s56, s38, 23
    s_lshl_b32 s45, s68, 9
    s_add_u32 s56, s56, s45
    s_add_u32 s56, s56, 0x8000000
    s_cmp_lg_u32 s44, 0
    s_cbranch_scc1 L_pd_132
    v_mov_b32 v29, 0
    s_mov_b32 s46, 64
    s_mov_b64 exec, 1
    s_mov_b32 s70, 0
L_wp_133:
    buffer_load_dword v31, v29, s[16:19], 0 offen sc1
    s_add_u32 s70, s70, 1
    s_cmp_ge_u32 s70, 0x200000
    s_cbranch_scc1 L_w_done_109
    s_waitcnt vmcnt(0)
    v_cmp_gt_u32 vcc, s46, v31
    s_nop 1
    s_cbranch_vccz L_wp_133_ok
    s_sleep 3
    s_branch L_wp_133
L_wp_133_ok:
    s_mov_b64 exec, -1
L_pd_132:
    s_barrier
L_a_loop_134:
    s_cmp_eq_u64 s[36:37], 0
    s_cbranch_scc1 L_w_done_109
    s_ff1_i32_b64 s50, s[36:37]
    s_bitset0_b64 s[36:37], s50
    s_lshr_b64 s[74:75], s[72:73], s50
    s_ff1_i32_b64 s51, s[74:75]
    s_add_u32 s51, s51, 1
    s_add_u32 s62, s50, s51
    s_add_u32 s63, s50, s44
    s_lshl_b32 s45, s41, 7
    s_add_u32 s45, s45, 0x10010
    s_cmp_lg_u32 s44, 0
    s_cbranch_scc1 L_pw_136
    s_mov_b64 exec, 7
    s_mov_b32 s70, 0
L_wp_137:
    buffer_load_dword v31, v12, s[12:15], s45 offen sc1
    s_add_u32 s70, s70, 1
    s_cmp_ge_u32 s70, 0x200000
    s_cbranch_scc1 L_w_done_109
    s_waitcnt vmcnt(0)
    v_cmp_gt_u32 vcc, s62, v31
    s_nop 1
    s_cbranch_vccz L_wp_137_ok
    s_sleep 2
    s_branch L_wp_137
L_wp_137_ok:
    s_mov_b64 exec, -1
L_pw_136:
    s_barrier
    s_cmp_ge_u32 s44, s51
    s_cbranch_scc1 L_xs1_138
    s_lshl_b32 s45, s41, 19
    s_lshl_b32 s46, s63, 13
    s_add_u32 s45, s45, s46
    s_add_u32 s45, s45, 0x2000000
    s_add_u32 s46, s45, 4096
    s_add_u32 s48, s45, 16777216
    s_add_u32 s49, s48, 4096
    s_add_u32 s76, s48, 16777216
    s_add_u32 s77, s76, 4096
    s_lshl_b32 s47, s44, 13
    s_mov_b32 m0, s47
    v_and_b32 v14, 15, v1
    v_lshrrev_b32 v16, 4, v1
    buffer_load_dwordx4 v10, s[12:15], s76 offen offset:0 sc1 lds
    buffer_load_dwordx4 v10, s[12:15], s76 offen offset:1024 sc1 lds
    buffer_load_dwordx4 v10, s[12:15], s76 offen offset:2048 sc1 lds
    buffer_load_dwordx4 v10, s[12:15], s76 offen offset:3072 sc1 lds
    s_add_u32 m0, s47, 4096
    s_nop 0
    buffer_load_dwordx4 v10, s[12:15], s77 offen offset:0 sc1 lds
    buffer_load_dwordx4 v10, s[12:15], s77 offen offset:1024 sc1 lds
    buffer_load_dwordx4 v10, s[12:15], s77 offen offset:2048 sc1 lds
    buffer_load_dwordx4 v10, s[12:15], s77 offen offset:3072 sc1 lds
    buffer_load_dwordx4 v[128:131], v10, s[12:15], s45 offen offset:0 sc1
    buffer_load_dwordx4 v[160:163], v10, s[12:15], s48 offen offset:0 sc1
    buffer_load_dwordx4 v[144:147], v10, s[12:15], s45 offen offset:1024 sc1
    buffer_load_dwordx4 v[176:179], v10, s[12:15], s48 offen offset:1024 sc1
    buffer_load_dwordx4 v[132:135], v10, s[12:15], s45 offen offset:2048 sc1
    buffer_load_dwordx4 v[164:167], v10, s[12:15], s48 offen offset:2048 sc1
    buffer_load_dwordx4 v[148:151], v10, s[12:15], s45 offen offset:3072 sc1
    buffer_load_dwordx4 v[180:183], v10, s[12:15], s48 offen offset:3072 sc1
    buffer_load_dwordx4 v[136:139], v10, s[12:15], s46 offen offset:0 sc1
    buffer_load_dwordx4 v[168:171], v10, s[12:15], s49 offen offset:0 sc1
    buffer_load_dwordx4 v[152:155], v10, s[12:15], s46 offen offset:1024 sc1
    buffer_load_dwordx4 v[184:187], v10, s[12:15], s49 offen offset:1024 sc1
    buffer_load_dwordx4 v[140:143], v10, s[12:15], s46 offen offset:2048 sc1
    buffer_load_dwordx4 v[172:175], v10, s[12:15], s49 offen offset:2048 sc1
    buffer_load_dwordx4 v[156:159], v10, s[12:15], s46 offen offset:3072 sc1
    buffer_load_dwordx4 v[188:191], v10, s[12:15], s49 offen offset:3072 sc1
    s_waitcnt vmcnt(0)
    v_mfma_f32_16x16x32_bf16 v[32:35], v[160:163], v[128:131], 0
    v_mfma_f32_16x16x32_bf16 v[36:39], v[160:163], v[144:147], 0
    v_mfma_f32_16x16x32_bf16 v[44:47], v[176:179], v[144:147], 0
    v_mfma_f32_16x16x32_bf16 v[32:35], v[164:167], v[132:135], v[32:35]
    v_mfma_f32_16x16x32_bf16 v[36:39], v[164:167], v[148:151], v[36:39]
    v_mfma_f32_16x16x32_bf16 v[44:47], v[180:183], v[148:151], v[44:47]
    v_mfma_f32_16x16x32_bf16 v[32:35], v[168:171], v[136:139], v[32:35]
    v_mfma_f32_16x16x32_bf16 v[36:39], v[168:171], v[152:155], v[36:39]
    v_mfma_f32_16x16x32_bf16 v[44:47], v[184:187], v[152:155], v[44:47]
    v_mfma_f32_16x16x32_bf16 v[32:35], v[172:175], v[140:143], v[32:35]
    v_mfma_f32_16x16x32_bf16 v[36:39], v[172:175], v[156:159], v[36:39]
    v_mfma_f32_16x16x32_bf16 v[44:47], v[188:191], v[156:159], v[44:47]
    v_lshlrev_b32 v19, 2, v16
    v_lshrrev_b32 v20, 2, v1
    v_lshlrev_b32 v20, 4, v20
    v_and_b32 v21, 1, v1
    v_lshlrev_b32 v21, 3, v21
    v_add3_u32 v20, v20, v21, s47
    v_and_b32 v21, 2, v1
    v_lshlrev_b32 v21, 7, v21
    v_add_u32 v20, v20, v21
    v_mov_b32 v22, 0xff800000
    ds_read_b64_tr_b16 v[208:209], v20 offset:0
    ds_read_b64_tr_b16 v[210:211], v20 offset:1024
    ds_read_b64_tr_b16 v[212:213], v20 offset:512
    ds_read_b64_tr_b16 v[214:215], v20 offset:1536
    ds_read_b64_tr_b16 v[216:217], v20 offset:2048
    ds_read_b64_tr_b16 v[218:219], v20 offset:3072
    ds_read_b64_tr_b16 v[220:221], v20 offset:2560
    ds_read_b64_tr_b16 v[222:223], v20 offset:3584
    ds_read_b64_tr_b16 v[224:225], v20 offset:4096
    ds_read_b64_tr_b16 v[226:227], v20 offset:5120
    ds_read_b64_tr_b16 v[228:229], v20 offset:4608
    ds_read_b64_tr_b16 v[230:231], v20 offset:5632
    ds_read_b64_tr_b16 v[232:233], v20 offset:6144
    ds_read_b64_tr_b16 v[234:235], v20 offset:7168
    ds_read_b64_tr_b16 v[236:237], v20 offset:6656
    ds_read_b64_tr_b16 v[238:239], v20 offset:7680
    v_add_u32 v21, 0, v19
    v_cmp_gt_u32 vcc, v21, v14
    s_nop 1
    v_cndmask_b32 v32, v32, v22, vcc
    v_cndmask_b32 v44, v44, v22, vcc
    v_add_u32 v21, 1, v19
    v_cmp_gt_u32 vcc, v21, v14
    s_nop 1
    v_cndmask_b32 v33, v33, v22, vcc
    v_cndmask_b32 v45, v45, v22, vcc
    v_add_u32 v21, 2, v19
    v_cmp_gt_u32 vcc, v21, v14
    s_nop 1
    v_cndmask_b32 v34, v34, v22, vcc
    v_cndmask_b32 v46, v46, v22, vcc
    v_add_u32 v21, 3, v19
    v_cmp_gt_u32 vcc, v21, v14
    s_nop 1
    v_cndmask_b32 v35, v35, v22, vcc
    v_cndmask_b32 v47, v47, v22, vcc
L_xs1_138:
    s_lshl_b32 s45, s41, 7
    s_add_u32 s45, s45, 0x11000
    s_cmp_lg_u32 s44, 0
    s_cbranch_scc1 L_pw_140
    s_mov_b64 exec, 255
    s_mov_b32 s70, 0
L_wp_141:
    buffer_load_dword v31, v12, s[12:15], s45 offen sc1
    s_add_u32 s70, s70, 1
    s_cmp_ge_u32 s70, 0x200000
    s_cbranch_scc1 L_w_done_109
    s_waitcnt vmcnt(0)
    v_cmp_gt_u32 vcc, s62, v31
    s_nop 1
    s_cbranch_vccz L_wp_141_ok
    s_sleep 2
    s_branch L_wp_141
L_wp_141_ok:
    s_mov_b64 exec, -1
L_pw_140:
    s_barrier
    s_cmp_ge_u32 s44, s51
    s_cbranch_scc1 L_xs2_139
    s_lshl_b32 s45, s63, 17
    s_lshl_b32 s46, s41, 12
    s_add_u32 s45, s45, s46
    s_lshr_b32 s46, s45, 1
    s_add_u32 s45, s45, 0x1000000
    s_add_u32 s46, s46, 0x1800000
    v_lshlrev_b32 v21, 3, v1
    buffer_load_dwordx4 v[192:195], v10, s[12:15], s45 offen offset:0 sc1
    buffer_load_dwordx4 v[196:199], v10, s[12:15], s45 offen offset:1024 sc1
    buffer_load_dwordx4 v[200:203], v10, s[12:15], s45 offen offset:2048 sc1
    buffer_load_dwordx4 v[204:207], v10, s[12:15], s45 offen offset:3072 sc1
    buffer_load_dwordx2 v[240:241], v21, s[12:15], s46 offen offset:0 sc1
    buffer_load_dwordx2 v[242:243], v21, s[12:15], s46 offen offset:512 sc1
    buffer_load_dwordx2 v[244:245], v21, s[12:15], s46 offen offset:1024 sc1
    buffer_load_dwordx2 v[246:247], v21, s[12:15], s46 offen offset:1536 sc1
    s_waitcnt vmcnt(4)
    v_mfma_f32_16x16x32_bf16 v[48:51], v[192:195], v[128:131], 0
    v_mfma_f32_16x16x32_bf16 v[52:55], v[192:195], v[144:147], 0
    v_mfma_f32_16x16x32_bf16 v[48:51], v[196:199], v[132:135], v[48:51]
    v_mfma_f32_16x16x32_bf16 v[52:55], v[196:199], v[148:151], v[52:55]
    v_mfma_f32_16x16x32_bf16 v[48:51], v[200:203], v[136:139], v[48:51]
    v_mfma_f32_16x16x32_bf16 v[52:55], v[200:203], v[152:155], v[52:55]
    v_mfma_f32_16x16x32_bf16 v[48:51], v[204:207], v[140:143], v[48:51]
    v_mfma_f32_16x16x32_bf16 v[52:55], v[204:207], v[156:159], v[52:55]
    s_mov_b32 s45, 0x3e0293ee
    s_nop 6
    v_permlane32_swap_b32 v48, v50
    v_permlane32_swap_b32 v49, v51
    v_pk_add_f32 v[48:49], v[48:49], v[50:51]
    v_permlane32_swap_b32 v52, v54
    v_permlane32_swap_b32 v53, v55
    v_pk_add_f32 v[52:53], v[52:53], v[54:55]
    v_max_f32 v22, v32, v33
    v_max3_f32 v22, v22, v34, v35
    v_max3_f32 v22, v22, v48, v49
    v_max_f32 v23, v36, v37
    v_max3_f32 v23, v23, v38, v39
    v_max3_f32 v23, v23, v44, v45
    v_max3_f32 v23, v23, v46, v47
    v_max3_f32 v23, v23, v52, v53
    v_mov_b32 v24, v22
    v_mov_b32 v25, v23
    s_nop 0
    v_permlane32_swap_b32 v22, v24
    v_permlane32_swap_b32 v23, v25
    v_max_f32 v22, v22, v24
    v_max_f32 v23, v23, v25
    v_mov_b32 v24, v22
    v_mov_b32 v25, v23
    s_nop 0
    v_permlane16_swap_b32 v22, v24
    v_permlane16_swap_b32 v23, v25
    v_max_f32 v22, v22, v24
    v_max_f32 v23, v23, v25
    v_mul_f32 v22, s45, v22
    v_mul_f32 v23, s45, v23
    v_fma_f32 v32, v32, s45, -v22
    v_fma_f32 v33, v33, s45, -v22
    v_fma_f32 v34, v34, s45, -v22
    v_fma_f32 v35, v35, s45, -v22
    v_fma_f32 v48, v48, s45, -v22
    v_fma_f32 v49, v49, s45, -v22
    v_exp_f32 v32, v32
    v_exp_f32 v33, v33
    v_exp_f32 v34, v34
    v_exp_f32 v35, v35
    v_exp_f32 v48, v48
    v_exp_f32 v49, v49
    v_fma_f32 v36, v36, s45, -v23
    v_fma_f32 v37, v37, s45, -v23
    v_fma_f32 v38, v38, s45, -v23
    v_fma_f32 v39, v39, s45, -v23
    v_fma_f32 v44, v44, s45, -v23
    v_fma_f32 v45, v45, s45, -v23
    v_fma_f32 v46, v46, s45, -v23
    v_fma_f32 v47, v47, s45, -v23
    v_fma_f32 v52, v52, s45, -v23
    v_fma_f32 v53, v53, s45, -v23
    v_exp_f32 v36, v36
    v_exp_f32 v37, v37
    v_exp_f32 v38, v38
    v_exp_f32 v39, v39
    v_exp_f32 v44, v44
    v_exp_f32 v45, v45
    v_exp_f32 v46, v46
    v_exp_f32 v47, v47
    v_exp_f32 v52, v52
    v_exp_f32 v53, v53
    v_add_f32 v22, v32, v33
    v_add_f32 v22, v22, v34
    v_add_f32 v22, v22, v35
    v_add_f32 v22, v22, v48
    v_add_f32 v22, v22, v49
    v_add_f32 v23, v36, v37
    v_add_f32 v23, v23, v38
    v_add_f32 v23, v23, v39
    v_add_f32 v23, v23, v44
    v_add_f32 v23, v23, v45
    v_add_f32 v23, v23, v46
    v_add_f32 v23, v23, v47
    v_add_f32 v23, v23, v52
    v_add_f32 v23, v23, v53
    v_mov_b32 v24, v22
    v_mov_b32 v25, v23
    s_nop 0
    v_permlane32_swap_b32 v22, v24
    v_permlane32_swap_b32 v23, v25
    v_add_f32 v22, v22, v24
    v_add_f32 v23, v23, v25
    v_mov_b32 v24, v22
    v_mov_b32 v25, v23
    s_nop 0
    v_permlane16_swap_b32 v22, v24
    v_permlane16_swap_b32 v23, v25
    v_add_f32 v22, v22, v24
    v_add_f32 v23, v23, v25
    v_rcp_f32 v22, v22
    v_rcp_f32 v23, v23
    s_nop 0
    v_mul_f32 v32, v32, v22
    v_mul_f32 v33, v33, v22
    v_mul_f32 v34, v34, v22
    v_mul_f32 v35, v35, v22
    v_mul_f32 v48, v48, v22
    v_mul_f32 v49, v49, v22
    v_mul_f32 v36, v36, v23
    v_mul_f32 v37, v37, v23
    v_mul_f32 v38, v38, v23
    v_mul_f32 v39, v39, v23
    v_mul_f32 v44, v44, v23
    v_mul_f32 v45, v45, v23
    v_mul_f32 v46, v46, v23
    v_mul_f32 v47, v47, v23
    v_mul_f32 v52, v52, v23
    v_mul_f32 v53, v53, v23
    v_cvt_pk_bf16_f32 v128, v32, v33
    v_cvt_pk_bf16_f32 v129, v34, v35
    v_mov_b32 v130, 0
    v_mov_b32 v131, 0
    v_cvt_pk_bf16_f32 v132, v48, v49
    v_mov_b32 v133, 0
    v_mov_b32 v134, 0
    v_cvt_pk_bf16_f32 v135, v48, v49
    v_cvt_pk_bf16_f32 v136, v36, v37
    v_cvt_pk_bf16_f32 v137, v38, v39
    v_cvt_pk_bf16_f32 v138, v44, v45
    v_cvt_pk_bf16_f32 v139, v46, v47
    v_cvt_pk_bf16_f32 v140, v52, v53
    v_mov_b32 v141, 0
    v_mov_b32 v142, 0
    v_cvt_pk_bf16_f32 v143, v52, v53
    s_waitcnt vmcnt(0) lgkmcnt(0)
    s_nop 0
    v_mfma_f32_16x16x32_bf16 v[64:67], v[208:211], v[128:131], 0
    v_mfma_f32_16x16x32_bf16 v[68:71], v[212:215], v[128:131], 0
    v_mfma_f32_16x16x32_bf16 v[72:75], v[216:219], v[128:131], 0
    v_mfma_f32_16x16x32_bf16 v[76:79], v[220:223], v[128:131], 0
    v_mfma_f32_16x16x32_bf16 v[80:83], v[224:227], v[128:131], 0
    v_mfma_f32_16x16x32_bf16 v[84:87], v[228:231], v[128:131], 0
    v_mfma_f32_16x16x32_bf16 v[88:91], v[232:235], v[128:131], 0
    v_mfma_f32_16x16x32_bf16 v[92:95], v[236:239], v[128:131], 0
    v_mfma_f32_16x16x16_bf16 v[64:67], v[240:241], v[132:133], v[64:67]
    v_mfma_f32_16x16x16_bf16 v[68:71], v[240:241], v[134:135], v[68:71]
    v_mfma_f32_16x16x16_bf16 v[72:75], v[242:243], v[132:133], v[72:75]
    v_mfma_f32_16x16x16_bf16 v[76:79], v[242:243], v[134:135], v[76:79]
    v_mfma_f32_16x16x16_bf16 v[80:83], v[244:245], v[132:133], v[80:83]
    v_mfma_f32_16x16x16_bf16 v[84:87], v[244:245], v[134:135], v[84:87]
    v_mfma_f32_16x16x16_bf16 v[88:91], v[246:247], v[132:133], v[88:91]
    v_mfma_f32_16x16x16_bf16 v[92:95], v[246:247], v[134:135], v[92:95]
    v_mfma_f32_16x16x32_bf16 v[96:99], v[208:211], v[136:139], 0
    v_mfma_f32_16x16x32_bf16 v[100:103], v[212:215], v[136:139], 0
    v_mfma_f32_16x16x32_bf16 v[104:107], v[216:219], v[136:139], 0
    v_mfma_f32_16x16x32_bf16 v[108:111], v[220:223], v[136:139], 0
    v_mfma_f32_16x16x32_bf16 v[112:115], v[224:227], v[136:139], 0
    v_mfma_f32_16x16x32_bf16 v[116:119], v[228:231], v[136:139], 0
    v_mfma_f32_16x16x32_bf16 v[120:123], v[232:235], v[136:139], 0
    v_mfma_f32_16x16x32_bf16 v[124:127], v[236:239], v[136:139], 0
    v_mfma_f32_16x16x16_bf16 v[96:99], v[240:241], v[140:141], v[96:99]
    v_mfma_f32_16x16x16_bf16 v[100:103], v[240:241], v[142:143], v[100:103]
    v_mfma_f32_16x16x16_bf16 v[104:107], v[242:243], v[140:141], v[104:107]
    v_mfma_f32_16x16x16_bf16 v[108:111], v[242:243], v[142:143], v[108:111]
    v_mfma_f32_16x16x16_bf16 v[112:115], v[244:245], v[140:141], v[112:115]
    v_mfma_f32_16x16x16_bf16 v[116:119], v[244:245], v[142:143], v[116:119]
    v_mfma_f32_16x16x16_bf16 v[120:123], v[246:247], v[140:141], v[120:123]
    v_mfma_f32_16x16x16_bf16 v[124:127], v[246:247], v[142:143], v[124:127]
    s_lshl_b32 s45, s63, 18
    s_lshl_b32 s46, s41, 13
    s_add_u32 s45, s45, s46
    s_add_u32 s45, s45, 0x5000000
    s_add_u32 s46, s45, 4096
    v_cvt_pk_bf16_f32 v64, v64, v65
    v_cvt_pk_bf16_f32 v65, v66, v67
    v_cvt_pk_bf16_f32 v66, v68, v69
    v_cvt_pk_bf16_f32 v67, v70, v71
    buffer_store_dwordx4 v[64:67], v10, s[12:15], s45 offen offset:0 sc1
    v_cvt_pk_bf16_f32 v72, v72, v73
    v_cvt_pk_bf16_f32 v73, v74, v75
    v_cvt_pk_bf16_f32 v74, v76, v77
    v_cvt_pk_bf16_f32 v75, v78, v79
    buffer_store_dwordx4 v[72:75], v10, s[12:15], s45 offen offset:2048 sc1
    v_cvt_pk_bf16_f32 v80, v80, v81
    v_cvt_pk_bf16_f32 v81, v82, v83
    v_cvt_pk_bf16_f32 v82, v84, v85
    v_cvt_pk_bf16_f32 v83, v86, v87
    buffer_store_dwordx4 v[80:83], v10, s[12:15], s46 offen offset:0 sc1
    v_cvt_pk_bf16_f32 v88, v88, v89
    v_cvt_pk_bf16_f32 v89, v90, v91
    v_cvt_pk_bf16_f32 v90, v92, v93
    v_cvt_pk_bf16_f32 v91, v94, v95
    buffer_store_dwordx4 v[88:91], v10, s[12:15], s46 offen offset:2048 sc1
    v_cvt_pk_bf16_f32 v96, v96, v97
    v_cvt_pk_bf16_f32 v97, v98, v99
    v_cvt_pk_bf16_f32 v98, v100, v101
    v_cvt_pk_bf16_f32 v99, v102, v103
    buffer_store_dwordx4 v[96:99], v10, s[12:15], s45 offen offset:1024 sc1
    v_cvt_pk_bf16_f32 v104, v104, v105
    v_cvt_pk_bf16_f32 v105, v106, v107
    v_cvt_pk_bf16_f32 v106, v108, v109
    v_cvt_pk_bf16_f32 v107, v110, v111
    buffer_store_dwordx4 v[104:107], v10, s[12:15], s45 offen offset:3072 sc1
    v_cvt_pk_bf16_f32 v112, v112, v113
    v_cvt_pk_bf16_f32 v113, v114, v115
    v_cvt_pk_bf16_f32 v114, v116, v117
    v_cvt_pk_bf16_f32 v115, v118, v119
    buffer_store_dwordx4 v[112:115], v10, s[12:15], s46 offen offset:1024 sc1
    v_cvt_pk_bf16_f32 v120, v120, v121
    v_cvt_pk_bf16_f32 v121, v122, v123
    v_cvt_pk_bf16_f32 v122, v124, v125
    v_cvt_pk_bf16_f32 v123, v126, v127
    buffer_store_dwordx4 v[120:123], v10, s[12:15], s46 offen offset:3072 sc1
L_xs2_139:
    s_waitcnt vmcnt(0)
    s_barrier
    s_cmp_lg_u32 s44, 0
    s_cbranch_scc1 L_pub_142
    v_mov_b32 v30, s62
    v_mov_b32 v31, 0
    s_mov_b64 exec, 1
    buffer_store_dword v30, v31, s[12:15], s65 offen sc1
    s_mov_b64 exec, -1
L_pub_142:
    s_lshl_b32 s45, s38, 10
    s_add_u32 s45, s45, s64
    s_cmp_lg_u32 s44, 0
    s_cbranch_scc1 L_pw_143
    s_mov_b64 exec, 255
    s_mov_b32 s70, 0
L_wp_144:
    buffer_load_dword v31, v5, s[12:15], s45 offen sc1
    s_add_u32 s70, s70, 1
    s_cmp_ge_u32 s70, 0x200000
    s_cbranch_scc1 L_w_done_109
    s_waitcnt vmcnt(0)
    v_cmp_gt_u32 vcc, s62, v31
    s_nop 1
    s_cbranch_vccz L_wp_144_ok
    s_sleep 1
    s_branch L_wp_144
L_wp_144_ok:
    s_mov_b64 exec, -1
L_pw_143:
    s_barrier
    s_mul_i32 s53, s50, 262144
    s_add_u32 s53, s53, s52
    s_lshl_b32 s54, s44, 13
    s_add_u32 s53, s53, s54
    s_mul_i32 s57, s50, 131072
    s_add_u32 s57, s57, s56
    s_lshl_b32 s45, s44, 7
    s_add_u32 s57, s57, s45
    s_add_u32 s55, s54, 65536
    s_mov_b32 s58, 0
    v_mov_b32 v13, v10
    v_add_u32 v14, 65536, v13
    v_xor_b32 v15, 64, v13
    v_xor_b32 v16, 64, v14
    s_mov_b32 s76, 0x20000000
    s_add_u32 s48, s53, 0
    s_add_u32 s49, s48, 4096
    s_add_u32 m0, s54, 0
    s_nop 0
    buffer_load_dwordx4 v10, s[12:15], s48 offen offset:0 sc1 lds
    buffer_load_dwordx4 v10, s[12:15], s48 offen offset:1024 sc1 lds
    buffer_load_dwordx4 v10, s[12:15], s48 offen offset:2048 sc1 lds
    buffer_load_dwordx4 v10, s[12:15], s48 offen offset:3072 sc1 lds
    s_add_u32 m0, s54, 4096
    s_nop 0
    buffer_load_dwordx4 v10, s[12:15], s49 offen offset:0 sc1 lds
    buffer_load_dwordx4 v10, s[12:15], s49 offen offset:1024 sc1 lds
    buffer_load_dwordx4 v10, s[12:15], s49 offen offset:2048 sc1 lds
    buffer_load_dwordx4 v10, s[12:15], s49 offen offset:3072 sc1 lds
    s_add_u32 s48, s53, 32768
    s_add_u32 s49, s48, 4096
    s_add_u32 s46, s54, 32768
    s_add_u32 m0, s46, 0
    s_nop 0
    buffer_load_dwordx4 v10, s[12:15], s48 offen offset:0 sc1 lds
    buffer_load_dwordx4 v10, s[12:15], s48 offen offset:1024 sc1 lds
    buffer_load_dwordx4 v10, s[12:15], s48 offen offset:2048 sc1 lds
    buffer_load_dwordx4 v10, s[12:15], s48 offen offset:3072 sc1 lds
    s_add_u32 m0, s46, 4096
    s_nop 0
    buffer_load_dwordx4 v10, s[12:15], s49 offen offset:0 sc1 lds
    buffer_load_dwordx4 v10, s[12:15], s49 offen offset:1024 sc1 lds
    buffer_load_dwordx4 v10, s[12:15], s49 offen offset:2048 sc1 lds
    buffer_load_dwordx4 v10, s[12:15], s49 offen offset:3072 sc1 lds
    s_add_u32 s48, s53, 262144
    s_cmp_gt_u32 s51, 1
    s_cselect_b32 s48, s48, 0x20000000
    s_add_u32 s49, s48, 4096
    s_add_u32 m0, s55, 0
    s_nop 0
    buffer_load_dwordx4 v10, s[12:15], s48 offen offset:0 sc1 lds
    buffer_load_dwordx4 v10, s[12:15], s48 offen offset:1024 sc1 lds
    buffer_load_dwordx4 v10, s[12:15], s48 offen offset:2048 sc1 lds
    buffer_load_dwordx4 v10, s[12:15], s48 offen offset:3072 sc1 lds
    s_add_u32 m0, s55, 4096
    s_nop 0
    buffer_load_dwordx4 v10, s[12:15], s49 offen offset:0 sc1 lds
    buffer_load_dwordx4 v10, s[12:15], s49 offen offset:1024 sc1 lds
    buffer_load_dwordx4 v10, s[12:15], s49 offen offset:2048 sc1 lds
    buffer_load_dwordx4 v10, s[12:15], s49 offen offset:3072 sc1 lds
    s_waitcnt vmcnt(16)
    s_barrier
    ds_read_b128 v[32:35], v13 offset:0
    ds_read_b128 v[36:39], v13 offset:1024
    ds_read_b128 v[40:43], v13 offset:2048
    ds_read_b128 v[44:47], v13 offset:3072
L_e_loop_145:
    s_add_u32 s48, s53, 294912
    s_add_u32 s46, s58, 1
    s_cmp_lt_u32 s46, s51
    s_cselect_b32 s48, s48, 0x20000000
    s_add_u32 s49, s48, 4096
    s_add_u32 s59, s55, 32768
    s_waitcnt lgkmcnt(2)
    v_mfma_f32_16x16x32_bf16 v[80:83], a[0:3], v[32:35], 0
    ds_read_b128 v[48:51], v13 offset:4096
    ds_read_b128 v[52:55], v13 offset:5120
    v_mfma_f32_16x16x32_bf16 v[84:87], a[4:7], v[32:35], 0
    ds_read_b128 v[56:59], v13 offset:6144
    ds_read_b128 v[60:63], v13 offset:7168
    v_mfma_f32_16x16x32_bf16 v[88:91], a[0:3], v[36:39], 0
    s_add_u32 m0, s59, 0
    s_nop 0
    buffer_load_dwordx4 v10, s[12:15], s48 offen offset:0 sc1 lds
    v_mfma_f32_16x16x32_bf16 v[92:95], a[4:7], v[36:39], 0
    s_waitcnt lgkmcnt(4)
    v_mfma_f32_16x16x32_bf16 v[80:83], a[8:11], v[40:43], v[80:83]
    ds_read_b128 v[32:35], v13 offset:8192
    ds_read_b128 v[36:39], v13 offset:9216
    v_mfma_f32_16x16x32_bf16 v[84:87], a[12:15], v[40:43], v[84:87]
    v_mfma_f32_16x16x32_bf16 v[88:91], a[8:11], v[44:47], v[88:91]
    buffer_load_dwordx4 v10, s[12:15], s48 offen offset:1024 sc1 lds
    v_mfma_f32_16x16x32_bf16 v[92:95], a[12:15], v[44:47], v[92:95]
    s_waitcnt lgkmcnt(4)
    v_mfma_f32_16x16x32_bf16 v[80:83], a[16:19], v[48:51], v[80:83]
    ds_read_b128 v[40:43], v13 offset:10240
    ds_read_b128 v[44:47], v13 offset:11264
    v_mfma_f32_16x16x32_bf16 v[84:87], a[20:23], v[48:51], v[84:87]
    v_mfma_f32_16x16x32_bf16 v[88:91], a[16:19], v[52:55], v[88:91]
    buffer_load_dwordx4 v10, s[12:15], s48 offen offset:2048 sc1 lds
    v_mfma_f32_16x16x32_bf16 v[92:95], a[20:23], v[52:55], v[92:95]
    s_waitcnt lgkmcnt(4)
    v_mfma_f32_16x16x32_bf16 v[80:83], a[24:27], v[56:59], v[80:83]
    ds_read_b128 v[48:51], v13 offset:12288
    ds_read_b128 v[52:55], v13 offset:13312
    v_mfma_f32_16x16x32_bf16 v[84:87], a[28:31], v[56:59], v[84:87]
    v_mfma_f32_16x16x32_bf16 v[88:91], a[24:27], v[60:63], v[88:91]
    buffer_load_dwordx4 v10, s[12:15], s48 offen offset:3072 sc1 lds
    v_mfma_f32_16x16x32_bf16 v[92:95], a[28:31], v[60:63], v[92:95]
    s_waitcnt lgkmcnt(4)
    v_mfma_f32_16x16x32_bf16 v[80:83], a[32:35], v[32:35], v[80:83]
    ds_read_b128 v[56:59], v13 offset:14336
    ds_read_b128 v[60:63], v13 offset:15360
    v_mfma_f32_16x16x32_bf16 v[84:87], a[36:39], v[32:35], v[84:87]
    v_mfma_f32_16x16x32_bf16 v[88:91], a[32:35], v[36:39], v[88:91]
    s_add_u32 m0, s59, 4096
    s_nop 0
    buffer_load_dwordx4 v10, s[12:15], s49 offen offset:0 sc1 lds
    v_mfma_f32_16x16x32_bf16 v[92:95], a[36:39], v[36:39], v[92:95]
    s_waitcnt lgkmcnt(4)
    v_mfma_f32_16x16x32_bf16 v[80:83], a[40:43], v[40:43], v[80:83]
    ds_read_b128 v[32:35], v13 offset:16384
    ds_read_b128 v[36:39], v13 offset:17408
    v_mfma_f32_16x16x32_bf16 v[84:87], a[44:47], v[40:43], v[84:87]
    v_mfma_f32_16x16x32_bf16 v[88:91], a[40:43], v[44:47], v[88:91]
    buffer_load_dwordx4 v10, s[12:15], s49 offen offset:1024 sc1 lds
    v_mfma_f32_16x16x32_bf16 v[92:95], a[44:47], v[44:47], v[92:95]
    s_waitcnt lgkmcnt(4)
    v_mfma_f32_16x16x32_bf16 v[80:83], a[48:51], v[48:51], v[80:83]
    ds_read_b128 v[40:43], v13 offset:18432
    ds_read_b128 v[44:47], v13 offset:19456
    v_mfma_f32_16x16x32_bf16 v[84:87], a[52:55], v[48:51], v[84:87]
    v_mfma_f32_16x16x32_bf16 v[88:91], a[48:51], v[52:55], v[88:91]
    buffer_load_dwordx4 v10, s[12:15], s49 offen offset:2048 sc1 lds
    v_mfma_f32_16x16x32_bf16 v[92:95], a[52:55], v[52:55], v[92:95]
    s_waitcnt lgkmcnt(4)
    v_mfma_f32_16x16x32_bf16 v[80:83], a[56:59], v[56:59], v[80:83]
    ds_read_b128 v[48:51], v13 offset:20480
    ds_read_b128 v[52:55], v13 offset:21504
    v_mfma_f32_16x16x32_bf16 v[84:87], a[60:63], v[56:59], v[84:87]
    v_mfma_f32_16x16x32_bf16 v[88:91], a[56:59], v[60:63], v[88:91]
    buffer_load_dwordx4 v10, s[12:15], s49 offen offset:3072 sc1 lds
    v_mfma_f32_16x16x32_bf16 v[92:95], a[60:63], v[60:63], v[92:95]
    s_waitcnt lgkmcnt(4)
    v_mfma_f32_16x16x32_bf16 v[80:83], a[64:67], v[32:35], v[80:83]
    ds_read_b128 v[56:59], v13 offset:22528
    ds_read_b128 v[60:63], v13 offset:23552
    v_mfma_f32_16x16x32_bf16 v[84:87], a[68:71], v[32:35], v[84:87]
    v_mfma_f32_16x16x32_bf16 v[88:91], a[64:67], v[36:39], v[88:91]
    v_mfma_f32_16x16x32_bf16 v[92:95], a[68:71], v[36:39], v[92:95]
    s_waitcnt lgkmcnt(4)
    v_mfma_f32_16x16x32_bf16 v[80:83], a[72:75], v[40:43], v[80:83]
    ds_read_b128 v[32:35], v13 offset:24576
    ds_read_b128 v[36:39], v13 offset:25600
    v_mfma_f32_16x16x32_bf16 v[84:87], a[76:79], v[40:43], v[84:87]
    v_mfma_f32_16x16x32_bf16 v[88:91], a[72:75], v[44:47], v[88:91]
    v_mfma_f32_16x16x32_bf16 v[92:95], a[76:79], v[44:47], v[92:95]
    s_waitcnt lgkmcnt(4)
    v_mfma_f32_16x16x32_bf16 v[80:83], a[80:83], v[48:51], v[80:83]
    ds_read_b128 v[40:43], v13 offset:26624
    ds_read_b128 v[44:47], v13 offset:27648
    v_mfma_f32_16x16x32_bf16 v[84:87], a[84:87], v[48:51], v[84:87]
    v_mfma_f32_16x16x32_bf16 v[88:91], a[80:83], v[52:55], v[88:91]
    v_mfma_f32_16x16x32_bf16 v[92:95], a[84:87], v[52:55], v[92:95]
    s_waitcnt lgkmcnt(4)
    v_mfma_f32_16x16x32_bf16 v[80:83], a[88:91], v[56:59], v[80:83]
    ds_read_b128 v[48:51], v13 offset:28672
    ds_read_b128 v[52:55], v13 offset:29696
    v_mfma_f32_16x16x32_bf16 v[84:87], a[92:95], v[56:59], v[84:87]
    v_mfma_f32_16x16x32_bf16 v[88:91], a[88:91], v[60:63], v[88:91]
    v_mfma_f32_16x16x32_bf16 v[92:95], a[92:95], v[60:63], v[92:95]
    s_waitcnt lgkmcnt(4)
    v_mfma_f32_16x16x32_bf16 v[80:83], a[96:99], v[32:35], v[80:83]
    ds_read_b128 v[56:59], v13 offset:30720
    ds_read_b128 v[60:63], v13 offset:31744
    v_mfma_f32_16x16x32_bf16 v[84:87], a[100:103], v[32:35], v[84:87]
    v_mfma_f32_16x16x32_bf16 v[88:91], a[96:99], v[36:39], v[88:91]
    v_mfma_f32_16x16x32_bf16 v[92:95], a[100:103], v[36:39], v[92:95]
    s_waitcnt lgkmcnt(4)
    v_mfma_f32_16x16x32_bf16 v[80:83], a[104:107], v[40:43], v[80:83]
    ds_read_b128 v[216:219], v8 offset:0
    ds_read_b128 v[220:223], v8 offset:1152
    v_mfma_f32_16x16x32_bf16 v[84:87], a[108:111], v[40:43], v[84:87]
    ds_read_b128 v[224:227], v8 offset:2304
    ds_read_b128 v[228:231], v8 offset:3456
    v_mfma_f32_16x16x32_bf16 v[88:91], a[104:107], v[44:47], v[88:91]
    v_mfma_f32_16x16x32_bf16 v[92:95], a[108:111], v[44:47], v[92:95]
    s_waitcnt vmcnt(16) lgkmcnt(0)
    s_barrier
    v_mfma_f32_16x16x32_bf16 v[80:83], a[112:115], v[48:51], v[80:83]
    ds_read_b128 v[32:35], v13 offset:32768
    ds_read_b128 v[36:39], v13 offset:33792
    v_mfma_f32_16x16x32_bf16 v[84:87], a[116:119], v[48:51], v[84:87]
    buffer_store_dwordx4 v[216:219], v11, s[12:15], s76 offen sc1
    v_mfma_f32_16x16x32_bf16 v[88:91], a[112:115], v[52:55], v[88:91]
    s_add_u32 s76, s76, 32768
    v_mfma_f32_16x16x32_bf16 v[92:95], a[116:119], v[52:55], v[92:95]
    buffer_store_dwordx4 v[220:223], v11, s[12:15], s76 offen sc1
    v_mfma_f32_16x16x32_bf16 v[80:83], a[120:123], v[56:59], v[80:83]
    ds_read_b128 v[40:43], v13 offset:34816
    ds_read_b128 v[44:47], v13 offset:35840
    v_mfma_f32_16x16x32_bf16 v[84:87], a[124:127], v[56:59], v[84:87]
    s_add_u32 s76, s76, 32768
    v_mfma_f32_16x16x32_bf16 v[88:91], a[120:123], v[60:63], v[88:91]
    buffer_store_dwordx4 v[224:227], v11, s[12:15], s76 offen sc1
    v_mfma_f32_16x16x32_bf16 v[92:95], a[124:127], v[60:63], v[92:95]
    s_add_u32 s76, s76, 32768
    s_add_u32 s48, s53, 524288
    s_add_u32 s46, s58, 2
    s_cmp_lt_u32 s46, s51
    s_cselect_b32 s48, s48, 0x20000000
    s_add_u32 s49, s48, 4096
    s_mov_b32 s59, s54
    s_waitcnt lgkmcnt(2)
    v_mfma_f32_16x16x32_bf16 v[80:83], a[128:131], v[32:35], v[80:83]
    ds_read_b128 v[48:51], v13 offset:36864
    ds_read_b128 v[52:55], v13 offset:37888
    v_mfma_f32_16x16x32_bf16 v[84:87], a[132:135], v[32:35], v[84:87]
    ds_read_b128 v[56:59], v13 offset:38912
    ds_read_b128 v[60:63], v13 offset:39936
    v_mfma_f32_16x16x32_bf16 v[88:91], a[128:131], v[36:39], v[88:91]
    s_add_u32 m0, s59, 0
    s_nop 0
    buffer_load_dwordx4 v10, s[12:15], s48 offen offset:0 sc1 lds
    v_mfma_f32_16x16x32_bf16 v[92:95], a[132:135], v[36:39], v[92:95]
    buffer_store_dwordx4 v[228:231], v11, s[12:15], s76 offen sc1
    s_waitcnt lgkmcnt(4)
    v_mfma_f32_16x16x32_bf16 v[80:83], a[136:139], v[40:43], v[80:83]
    ds_read_b128 v[32:35], v13 offset:40960
    ds_read_b128 v[36:39], v13 offset:41984
    v_mfma_f32_16x16x32_bf16 v[84:87], a[140:143], v[40:43], v[84:87]
    v_mfma_f32_16x16x32_bf16 v[88:91], a[136:139], v[44:47], v[88:91]
    buffer_load_dwordx4 v10, s[12:15], s48 offen offset:1024 sc1 lds
    v_mfma_f32_16x16x32_bf16 v[92:95], a[140:143], v[44:47], v[92:95]
    s_waitcnt lgkmcnt(4)
    v_mfma_f32_16x16x32_bf16 v[80:83], a[144:147], v[48:51], v[80:83]
    ds_read_b128 v[40:43], v13 offset:43008
    ds_read_b128 v[44:47], v13 offset:44032
    v_mfma_f32_16x16x32_bf16 v[84:87], a[148:151], v[48:51], v[84:87]
    v_mfma_f32_16x16x32_bf16 v[88:91], a[144:147], v[52:55], v[88:91]
    buffer_load_dwordx4 v10, s[12:15], s48 offen offset:2048 sc1 lds
    v_mfma_f32_16x16x32_bf16 v[92:95], a[148:151], v[52:55], v[92:95]
    s_waitcnt lgkmcnt(4)
    v_mfma_f32_16x16x32_bf16 v[80:83], a[152:155], v[56:59], v[80:83]
    ds_read_b128 v[48:51], v13 offset:45056
    ds_read_b128 v[52:55], v13 offset:46080
    v_mfma_f32_16x16x32_bf16 v[84:87], a[156:159], v[56:59], v[84:87]
    v_mfma_f32_16x16x32_bf16 v[88:91], a[152:155], v[60:63], v[88:91]
    buffer_load_dwordx4 v10, s[12:15], s48 offen offset:3072 sc1 lds
    v_mfma_f32_16x16x32_bf16 v[92:95], a[156:159], v[60:63], v[92:95]
    s_waitcnt lgkmcnt(4)
    v_mfma_f32_16x16x32_bf16 v[80:83], a[160:163], v[32:35], v[80:83]
    ds_read_b128 v[56:59], v13 offset:47104
    ds_read_b128 v[60:63], v13 offset:48128
    v_mfma_f32_16x16x32_bf16 v[84:87], a[164:167], v[32:35], v[84:87]
    v_mfma_f32_16x16x32_bf16 v[88:91], a[160:163], v[36:39], v[88:91]
    s_add_u32 m0, s59, 4096
    s_nop 0
    buffer_load_dwordx4 v10, s[12:15], s49 offen offset:0 sc1 lds
    v_mfma_f32_16x16x32_bf16 v[92:95], a[164:167], v[36:39], v[92:95]
    s_waitcnt lgkmcnt(4)
    v_mfma_f32_16x16x32_bf16 v[80:83], a[168:171], v[40:43], v[80:83]
    ds_read_b128 v[32:35], v13 offset:49152
    ds_read_b128 v[36:39], v13 offset:50176
    v_mfma_f32_16x16x32_bf16 v[84:87], a[172:175], v[40:43], v[84:87]
    v_mfma_f32_16x16x32_bf16 v[88:91], a[168:171], v[44:47], v[88:91]
    buffer_load_dwordx4 v10, s[12:15], s49 offen offset:1024 sc1 lds
    v_mfma_f32_16x16x32_bf16 v[92:95], a[172:175], v[44:47], v[92:95]
    s_waitcnt lgkmcnt(4)
    v_mfma_f32_16x16x32_bf16 v[80:83], a[176:179], v[48:51], v[80:83]
    ds_read_b128 v[40:43], v13 offset:51200
    ds_read_b128 v[44:47], v13 offset:52224
    v_mfma_f32_16x16x32_bf16 v[84:87], a[180:183], v[48:51], v[84:87]
    v_mfma_f32_16x16x32_bf16 v[88:91], a[176:179], v[52:55], v[88:91]
    buffer_load_dwordx4 v10, s[12:15], s49 offen offset:2048 sc1 lds
    v_mfma_f32_16x16x32_bf16 v[92:95], a[180:183], v[52:55], v[92:95]
    s_waitcnt lgkmcnt(4)
    v_mfma_f32_16x16x32_bf16 v[80:83], a[184:187], v[56:59], v[80:83]
    ds_read_b128 v[48:51], v13 offset:53248
    ds_read_b128 v[52:55], v13 offset:54272
    v_mfma_f32_16x16x32_bf16 v[84:87], a[188:191], v[56:59], v[84:87]
    v_mfma_f32_16x16x32_bf16 v[88:91], a[184:187], v[60:63], v[88:91]
    buffer_load_dwordx4 v10, s[12:15], s49 offen offset:3072 sc1 lds
    v_mfma_f32_16x16x32_bf16 v[92:95], a[188:191], v[60:63], v[92:95]
    s_waitcnt lgkmcnt(4)
    v_mfma_f32_16x16x32_bf16 v[80:83], a[192:195], v[32:35], v[80:83]
    ds_read_b128 v[56:59], v13 offset:55296
    ds_read_b128 v[60:63], v13 offset:56320
    v_mfma_f32_16x16x32_bf16 v[84:87], a[196:199], v[32:35], v[84:87]
    v_mfma_f32_16x16x32_bf16 v[88:91], a[192:195], v[36:39], v[88:91]
    v_mfma_f32_16x16x32_bf16 v[92:95], a[196:199], v[36:39], v[92:95]
    s_waitcnt lgkmcnt(4)
    v_mfma_f32_16x16x32_bf16 v[80:83], a[200:203], v[40:43], v[80:83]
    ds_read_b128 v[32:35], v13 offset:57344
    ds_read_b128 v[36:39], v13 offset:58368
    v_mfma_f32_16x16x32_bf16 v[84:87], a[204:207], v[40:43], v[84:87]
    v_mfma_f32_16x16x32_bf16 v[88:91], a[200:203], v[44:47], v[88:91]
    v_mfma_f32_16x16x32_bf16 v[92:95], a[204:207], v[44:47], v[92:95]
    s_waitcnt lgkmcnt(4)
    v_mfma_f32_16x16x32_bf16 v[80:83], a[208:211], v[48:51], v[80:83]
    ds_read_b128 v[40:43], v13 offset:59392
    ds_read_b128 v[44:47], v13 offset:60416
    v_mfma_f32_16x16x32_bf16 v[84:87], a[212:215], v[48:51], v[84:87]
    v_mfma_f32_16x16x32_bf16 v[88:91], a[208:211], v[52:55], v[88:91]
    v_mfma_f32_16x16x32_bf16 v[92:95], a[212:215], v[52:55], v[92:95]
    s_waitcnt lgkmcnt(4)
    v_mfma_f32_16x16x32_bf16 v[80:83], a[216:219], v[56:59], v[80:83]
    ds_read_b128 v[48:51], v13 offset:61440
    ds_read_b128 v[52:55], v13 offset:62464
    v_mfma_f32_16x16x32_bf16 v[84:87], a[220:223], v[56:59], v[84:87]
    v_mfma_f32_16x16x32_bf16 v[88:91], a[216:219], v[60:63], v[88:91]
    v_mfma_f32_16x16x32_bf16 v[92:95], a[220:223], v[60:63], v[92:95]
    s_waitcnt lgkmcnt(4)
    v_mfma_f32_16x16x32_bf16 v[80:83], a[224:227], v[32:35], v[80:83]
    ds_read_b128 v[56:59], v13 offset:63488
    ds_read_b128 v[60:63], v13 offset:64512
    v_mfma_f32_16x16x32_bf16 v[84:87], a[228:231], v[32:35], v[84:87]
    v_mfma_f32_16x16x32_bf16 v[88:91], a[224:227], v[36:39], v[88:91]
    v_mfma_f32_16x16x32_bf16 v[92:95], a[228:231], v[36:39], v[92:95]
    s_waitcnt lgkmcnt(4)
    v_mfma_f32_16x16x32_bf16 v[80:83], a[232:235], v[40:43], v[80:83]
    v_mfma_f32_16x16x32_bf16 v[84:87], a[236:239], v[40:43], v[84:87]
    v_mfma_f32_16x16x32_bf16 v[88:91], a[232:235], v[44:47], v[88:91]
    v_mfma_f32_16x16x32_bf16 v[92:95], a[236:239], v[44:47], v[92:95]
    s_waitcnt vmcnt(16) lgkmcnt(0)
    s_barrier
    v_mfma_f32_16x16x32_bf16 v[80:83], a[240:243], v[48:51], v[80:83]
    ds_read_b128 v[32:35], v14 offset:0
    ds_read_b128 v[36:39], v14 offset:1024
    v_mfma_f32_16x16x32_bf16 v[84:87], a[244:247], v[48:51], v[84:87]
    v_mfma_f32_16x16x32_bf16 v[88:91], a[240:243], v[52:55], v[88:91]
    v_mfma_f32_16x16x32_bf16 v[92:95], a[244:247], v[52:55], v[92:95]
    v_mfma_f32_16x16x32_bf16 v[80:83], a[248:251], v[56:59], v[80:83]
    ds_read_b128 v[40:43], v14 offset:2048
    ds_read_b128 v[44:47], v14 offset:3072
    v_mfma_f32_16x16x32_bf16 v[84:87], a[252:255], v[56:59], v[84:87]
    v_mfma_f32_16x16x32_bf16 v[88:91], a[248:251], v[60:63], v[88:91]
    v_mfma_f32_16x16x32_bf16 v[92:95], a[252:255], v[60:63], v[92:95]
    s_add_u32 s53, s53, 262144
    s_add_u32 s58, s58, 1
    v_swap_b32 v13, v14
    s_xor_b32 s54, s54, 65536
    s_xor_b32 s55, s55, 65536
    s_mov_b32 s76, s57
    v_swap_b32 v15, v16
    s_add_u32 s57, s57, 131072
    ds_write_b128 v7, v[80:83] offset:0
    ds_write_b128 v7, v[84:87] offset:64
    ds_write_b128 v7, v[88:91] offset:2304
    ds_write_b128 v7, v[92:95] offset:2368
    s_cmp_lt_u32 s58, s51
    s_cbranch_scc1 L_e_loop_145
    s_waitcnt lgkmcnt(0)
    ds_read_b128 v[216:219], v8 offset:0
    ds_read_b128 v[220:223], v8 offset:1152
    ds_read_b128 v[224:227], v8 offset:2304
    ds_read_b128 v[228:231], v8 offset:3456
    s_waitcnt lgkmcnt(0)
    buffer_store_dwordx4 v[216:219], v11, s[12:15], s76 offen sc1
    s_add_u32 s76, s76, 32768
    buffer_store_dwordx4 v[220:223], v11, s[12:15], s76 offen sc1
    s_add_u32 s76, s76, 32768
    buffer_store_dwordx4 v[224:227], v11, s[12:15], s76 offen sc1
    s_add_u32 s76, s76, 32768
    buffer_store_dwordx4 v[228:231], v11, s[12:15], s76 offen sc1
    s_waitcnt vmcnt(0)
    s_barrier
    s_cmp_lg_u32 s44, 0
    s_cbranch_scc1 L_pub_146
    v_mov_b32 v30, s62
    v_mov_b32 v31, 0
    s_mov_b64 exec, 1
    buffer_store_dword v30, v31, s[12:15], s67 offen sc1
    s_mov_b64 exec, -1
L_pub_146:
    s_branch L_a_loop_134
L_role_b_130:
    s_load_dwordx2 s[6:7], s[0:1], 64
    s_load_dwordx2 s[8:9], s[0:1], 72
    s_waitcnt lgkmcnt(0)
    s_mov_b32 s24, s6
    s_and_b32 s25, s7, 0xffff
    s_mov_b32 s26, 0x700000
    s_mov_b32 s27, 0x00020000
    s_mov_b32 s32, s8
    s_and_b32 s33, s9, 0xffff
    s_mov_b32 s34, 0x1c00
    s_mov_b32 s35, 0x00020000
    s_min_u32 s45, s41, 27
    s_lshl_b32 s46, s45, 8
    s_waitcnt vmcnt(0)
    s_barrier
    v_lshrrev_b32 v20, 4, v1
    s_lshl_b32 s45, s44, 2
    v_add_u32 v21, s45, v20
    s_mov_b32 s45, 7168
    v_mul_lo_u32 v21, v21, s45
    v_lshlrev_b32 v22, 2, v20
    v_and_b32 v23, 15, v1
    v_xor_b32 v22, v22, v23
    v_lshlrev_b32 v22, 4, v22
    v_add_u32 v21, v21, v22
    v_bfe_u32 v22, v1, 2, 2
    v_lshlrev_b32 v23, 3, v20
    v_add_u32 v23, v23, v22
    v_lshlrev_b32 v23, 8, v23
    v_xor_b32 v22, s44, v22
    v_lshlrev_b32 v22, 6, v22
    v_add_u32 v23, v23, v22
    v_and_b32 v22, 3, v1
    v_lshlrev_b32 v22, 4, v22
    v_add_u32 v23, v23, v22
    v_add_u32 v24, 65536, v23
    v_add_u32 v25, 131072, v23
    s_lshl_b32 s47, s44, 10
    s_add_u32 s45, s46, 0x0
    s_add_u32 m0, s47, 0
    s_nop 0
    buffer_load_dwordx4 v21, s[24:27], s45 offen nt lds
    s_add_u32 s45, s46, 0x1c000
    s_add_u32 m0, s47, 4096
    s_nop 0
    buffer_load_dwordx4 v21, s[24:27], s45 offen nt lds
    s_add_u32 s45, s46, 0x38000
    s_add_u32 m0, s47, 8192
    s_nop 0
    buffer_load_dwordx4 v21, s[24:27], s45 offen nt lds
    s_add_u32 s45, s46, 0x54000
    s_add_u32 m0, s47, 12288
    s_nop 0
    buffer_load_dwordx4 v21, s[24:27], s45 offen nt lds
    s_add_u32 s45, s46, 0x70000
    s_add_u32 m0, s47, 16384
    s_nop 0
    buffer_load_dwordx4 v21, s[24:27], s45 offen nt lds
    s_add_u32 s45, s46, 0x8c000
    s_add_u32 m0, s47, 20480
    s_nop 0
    buffer_load_dwordx4 v21, s[24:27], s45 offen nt lds
    s_add_u32 s45, s46, 0xa8000
    s_add_u32 m0, s47, 24576
    s_nop 0
    buffer_load_dwordx4 v21, s[24:27], s45 offen nt lds
    s_add_u32 s45, s46, 0xc4000
    s_add_u32 m0, s47, 28672
    s_nop 0
    buffer_load_dwordx4 v21, s[24:27], s45 offen nt lds
    s_add_u32 s45, s46, 0xe0000
    s_add_u32 m0, s47, 32768
    s_nop 0
    buffer_load_dwordx4 v21, s[24:27], s45 offen nt lds
    s_add_u32 s45, s46, 0xfc000
    s_add_u32 m0, s47, 36864
    s_nop 0
    buffer_load_dwordx4 v21, s[24:27], s45 offen nt lds
    s_add_u32 s45, s46, 0x118000
    s_add_u32 m0, s47, 40960
    s_nop 0
    buffer_load_dwordx4 v21, s[24:27], s45 offen nt lds
    s_add_u32 s45, s46, 0x134000
    s_add_u32 m0, s47, 45056
    s_nop 0
    buffer_load_dwordx4 v21, s[24:27], s45 offen nt lds
    s_add_u32 s45, s46, 0x150000
    s_add_u32 m0, s47, 49152
    s_nop 0
    buffer_load_dwordx4 v21, s[24:27], s45 offen nt lds
    s_add_u32 s45, s46, 0x16c000
    s_add_u32 m0, s47, 53248
    s_nop 0
    buffer_load_dwordx4 v21, s[24:27], s45 offen nt lds
    s_add_u32 s45, s46, 0x188000
    s_add_u32 m0, s47, 57344
    s_nop 0
    buffer_load_dwordx4 v21, s[24:27], s45 offen nt lds
    s_add_u32 s45, s46, 0x1a4000
    s_add_u32 m0, s47, 61440
    s_nop 0
    buffer_load_dwordx4 v21, s[24:27], s45 offen nt lds
    s_add_u32 s45, s46, 0x1c0000
    s_add_u32 m0, s47, 65536
    s_nop 0
    buffer_load_dwordx4 v21, s[24:27], s45 offen nt lds
    s_add_u32 s45, s46, 0x1dc000
    s_add_u32 m0, s47, 69632
    s_nop 0
    buffer_load_dwordx4 v21, s[24:27], s45 offen nt lds
    s_add_u32 s45, s46, 0x1f8000
    s_add_u32 m0, s47, 73728
    s_nop 0
    buffer_load_dwordx4 v21, s[24:27], s45 offen nt lds
    s_add_u32 s45, s46, 0x214000
    s_add_u32 m0, s47, 77824
    s_nop 0
    buffer_load_dwordx4 v21, s[24:27], s45 offen nt lds
    s_add_u32 s45, s46, 0x230000
    s_add_u32 m0, s47, 81920
    s_nop 0
    buffer_load_dwordx4 v21, s[24:27], s45 offen nt lds
    s_add_u32 s45, s46, 0x24c000
    s_add_u32 m0, s47, 86016
    s_nop 0
    buffer_load_dwordx4 v21, s[24:27], s45 offen nt lds
    s_add_u32 s45, s46, 0x268000
    s_add_u32 m0, s47, 90112
    s_nop 0
    buffer_load_dwordx4 v21, s[24:27], s45 offen nt lds
    s_add_u32 s45, s46, 0x284000
    s_add_u32 m0, s47, 94208
    s_nop 0
    buffer_load_dwordx4 v21, s[24:27], s45 offen nt lds
    s_add_u32 s45, s46, 0x2a0000
    s_add_u32 m0, s47, 98304
    s_nop 0
    buffer_load_dwordx4 v21, s[24:27], s45 offen nt lds
    s_add_u32 s45, s46, 0x2bc000
    s_add_u32 m0, s47, 102400
    s_nop 0
    buffer_load_dwordx4 v21, s[24:27], s45 offen nt lds
    s_add_u32 s45, s46, 0x2d8000
    s_add_u32 m0, s47, 106496
    s_nop 0
    buffer_load_dwordx4 v21, s[24:27], s45 offen nt lds
    s_add_u32 s45, s46, 0x2f4000
    s_add_u32 m0, s47, 110592
    s_nop 0
    buffer_load_dwordx4 v21, s[24:27], s45 offen nt lds
    s_add_u32 s45, s46, 0x310000
    s_add_u32 m0, s47, 114688
    s_nop 0
    buffer_load_dwordx4 v21, s[24:27], s45 offen nt lds
    s_add_u32 s45, s46, 0x32c000
    s_add_u32 m0, s47, 118784
    s_nop 0
    buffer_load_dwordx4 v21, s[24:27], s45 offen nt lds
    s_add_u32 s45, s46, 0x348000
    s_add_u32 m0, s47, 122880
    s_nop 0
    buffer_load_dwordx4 v21, s[24:27], s45 offen nt lds
    s_add_u32 s45, s46, 0x364000
    s_add_u32 m0, s47, 126976
    s_nop 0
    buffer_load_dwordx4 v21, s[24:27], s45 offen nt lds
    s_waitcnt vmcnt(28)
    s_barrier
    s_add_u32 s45, s46, 0x380000
    s_add_u32 m0, s47, 131072
    s_nop 0
    buffer_load_dwordx4 v21, s[24:27], s45 offen nt lds
    s_add_u32 s45, s46, 0x39c000
    s_add_u32 m0, s47, 135168
    s_nop 0
    buffer_load_dwordx4 v21, s[24:27], s45 offen nt lds
    s_add_u32 s45, s46, 0x3b8000
    s_add_u32 m0, s47, 139264
    s_nop 0
    buffer_load_dwordx4 v21, s[24:27], s45 offen nt lds
    s_add_u32 s45, s46, 0x3d4000
    s_add_u32 m0, s47, 143360
    s_nop 0
    buffer_load_dwordx4 v21, s[24:27], s45 offen nt lds
    ds_read_b64_tr_b16 a[0:1], v23 offset:0
    ds_read_b64_tr_b16 a[2:3], v23 offset:1024
    ds_read_b64_tr_b16 a[4:5], v23 offset:8
    ds_read_b64_tr_b16 a[6:7], v23 offset:1032
    ds_read_b64_tr_b16 a[8:9], v23 offset:8192
    ds_read_b64_tr_b16 a[10:11], v23 offset:9216
    ds_read_b64_tr_b16 a[12:13], v23 offset:8200
    ds_read_b64_tr_b16 a[14:15], v23 offset:9224
    s_waitcnt lgkmcnt(0)
    s_waitcnt vmcnt(28)
    s_barrier
    s_add_u32 s45, s46, 0x3f0000
    s_add_u32 m0, s47, 0
    s_nop 0
    buffer_load_dwordx4 v21, s[24:27], s45 offen nt lds
    s_add_u32 s45, s46, 0x40c000
    s_add_u32 m0, s47, 4096
    s_nop 0
    buffer_load_dwordx4 v21, s[24:27], s45 offen nt lds
    s_add_u32 s45, s46, 0x428000
    s_add_u32 m0, s47, 8192
    s_nop 0
    buffer_load_dwordx4 v21, s[24:27], s45 offen nt lds
    s_add_u32 s45, s46, 0x444000
    s_add_u32 m0, s47, 12288
    s_nop 0
    buffer_load_dwordx4 v21, s[24:27], s45 offen nt lds
    ds_read_b64_tr_b16 a[16:17], v23 offset:16384
    ds_read_b64_tr_b16 a[18:19], v23 offset:17408
    ds_read_b64_tr_b16 a[20:21], v23 offset:16392
    ds_read_b64_tr_b16 a[22:23], v23 offset:17416
    ds_read_b64_tr_b16 a[24:25], v23 offset:24576
    ds_read_b64_tr_b16 a[26:27], v23 offset:25600
    ds_read_b64_tr_b16 a[28:29], v23 offset:24584
    ds_read_b64_tr_b16 a[30:31], v23 offset:25608
    s_waitcnt lgkmcnt(0)
    s_waitcnt vmcnt(28)
    s_barrier
    s_add_u32 s45, s46, 0x460000
    s_add_u32 m0, s47, 16384
    s_nop 0
    buffer_load_dwordx4 v21, s[24:27], s45 offen nt lds
    s_add_u32 s45, s46, 0x47c000
    s_add_u32 m0, s47, 20480
    s_nop 0
    buffer_load_dwordx4 v21, s[24:27], s45 offen nt lds
    s_add_u32 s45, s46, 0x498000
    s_add_u32 m0, s47, 24576
    s_nop 0
    buffer_load_dwordx4 v21, s[24:27], s45 offen nt lds
    s_add_u32 s45, s46, 0x4b4000
    s_add_u32 m0, s47, 28672
    s_nop 0
    buffer_load_dwordx4 v21, s[24:27], s45 offen nt lds
    ds_read_b64_tr_b16 a[32:33], v23 offset:32768
    ds_read_b64_tr_b16 a[34:35], v23 offset:33792
    ds_read_b64_tr_b16 a[36:37], v23 offset:32776
    ds_read_b64_tr_b16 a[38:39], v23 offset:33800
    ds_read_b64_tr_b16 a[40:41], v23 offset:40960
    ds_read_b64_tr_b16 a[42:43], v23 offset:41984
    ds_read_b64_tr_b16 a[44:45], v23 offset:40968
    ds_read_b64_tr_b16 a[46:47], v23 offset:41992
    s_waitcnt lgkmcnt(0)
    s_waitcnt vmcnt(28)
    s_barrier
    s_add_u32 s45, s46, 0x4d0000
    s_add_u32 m0, s47, 32768
    s_nop 0
    buffer_load_dwordx4 v21, s[24:27], s45 offen nt lds
    s_add_u32 s45, s46, 0x4ec000
    s_add_u32 m0, s47, 36864
    s_nop 0
    buffer_load_dwordx4 v21, s[24:27], s45 offen nt lds
    s_add_u32 s45, s46, 0x508000
    s_add_u32 m0, s47, 40960
    s_nop 0
    buffer_load_dwordx4 v21, s[24:27], s45 offen nt lds
    s_add_u32 s45, s46, 0x524000
    s_add_u32 m0, s47, 45056
    s_nop 0
    buffer_load_dwordx4 v21, s[24:27], s45 offen nt lds
    ds_read_b64_tr_b16 a[48:49], v23 offset:49152
    ds_read_b64_tr_b16 a[50:51], v23 offset:50176
    ds_read_b64_tr_b16 a[52:53], v23 offset:49160
    ds_read_b64_tr_b16 a[54:55], v23 offset:50184
    ds_read_b64_tr_b16 a[56:57], v23 offset:57344
    ds_read_b64_tr_b16 a[58:59], v23 offset:58368
    ds_read_b64_tr_b16 a[60:61], v23 offset:57352
    ds_read_b64_tr_b16 a[62:63], v23 offset:58376
    s_waitcnt lgkmcnt(0)
    s_waitcnt vmcnt(28)
    s_barrier
    s_add_u32 s45, s46, 0x540000
    s_add_u32 m0, s47, 49152
    s_nop 0
    buffer_load_dwordx4 v21, s[24:27], s45 offen nt lds
    s_add_u32 s45, s46, 0x55c000
    s_add_u32 m0, s47, 53248
    s_nop 0
    buffer_load_dwordx4 v21, s[24:27], s45 offen nt lds
    s_add_u32 s45, s46, 0x578000
    s_add_u32 m0, s47, 57344
    s_nop 0
    buffer_load_dwordx4 v21, s[24:27], s45 offen nt lds
    s_add_u32 s45, s46, 0x594000
    s_add_u32 m0, s47, 61440
    s_nop 0
    buffer_load_dwordx4 v21, s[24:27], s45 offen nt lds
    ds_read_b64_tr_b16 a[64:65], v24 offset:0
    ds_read_b64_tr_b16 a[66:67], v24 offset:1024
    ds_read_b64_tr_b16 a[68:69], v24 offset:8
    ds_read_b64_tr_b16 a[70:71], v24 offset:1032
    ds_read_b64_tr_b16 a[72:73], v24 offset:8192
    ds_read_b64_tr_b16 a[74:75], v24 offset:9216
    ds_read_b64_tr_b16 a[76:77], v24 offset:8200
    ds_read_b64_tr_b16 a[78:79], v24 offset:9224
    s_waitcnt lgkmcnt(0)
    s_waitcnt vmcnt(28)
    s_barrier
    s_add_u32 s45, s46, 0x5b0000
    s_add_u32 m0, s47, 65536
    s_nop 0
    buffer_load_dwordx4 v21, s[24:27], s45 offen nt lds
    s_add_u32 s45, s46, 0x5cc000
    s_add_u32 m0, s47, 69632
    s_nop 0
    buffer_load_dwordx4 v21, s[24:27], s45 offen nt lds
    s_add_u32 s45, s46, 0x5e8000
    s_add_u32 m0, s47, 73728
    s_nop 0
    buffer_load_dwordx4 v21, s[24:27], s45 offen nt lds
    s_add_u32 s45, s46, 0x604000
    s_add_u32 m0, s47, 77824
    s_nop 0
    buffer_load_dwordx4 v21, s[24:27], s45 offen nt lds
    ds_read_b64_tr_b16 a[80:81], v24 offset:16384
    ds_read_b64_tr_b16 a[82:83], v24 offset:17408
    ds_read_b64_tr_b16 a[84:85], v24 offset:16392
    ds_read_b64_tr_b16 a[86:87], v24 offset:17416
    ds_read_b64_tr_b16 a[88:89], v24 offset:24576
    ds_read_b64_tr_b16 a[90:91], v24 offset:25600
    ds_read_b64_tr_b16 a[92:93], v24 offset:24584
    ds_read_b64_tr_b16 a[94:95], v24 offset:25608
    s_waitcnt lgkmcnt(0)
    s_waitcnt vmcnt(28)
    s_barrier
    s_add_u32 s45, s46, 0x620000
    s_add_u32 m0, s47, 81920
    s_nop 0
    buffer_load_dwordx4 v21, s[24:27], s45 offen nt lds
    s_add_u32 s45, s46, 0x63c000
    s_add_u32 m0, s47, 86016
    s_nop 0
    buffer_load_dwordx4 v21, s[24:27], s45 offen nt lds
    s_add_u32 s45, s46, 0x658000
    s_add_u32 m0, s47, 90112
    s_nop 0
    buffer_load_dwordx4 v21, s[24:27], s45 offen nt lds
    s_add_u32 s45, s46, 0x674000
    s_add_u32 m0, s47, 94208
    s_nop 0
    buffer_load_dwordx4 v21, s[24:27], s45 offen nt lds
    ds_read_b64_tr_b16 a[96:97], v24 offset:32768
    ds_read_b64_tr_b16 a[98:99], v24 offset:33792
    ds_read_b64_tr_b16 a[100:101], v24 offset:32776
    ds_read_b64_tr_b16 a[102:103], v24 offset:33800
    ds_read_b64_tr_b16 a[104:105], v24 offset:40960
    ds_read_b64_tr_b16 a[106:107], v24 offset:41984
    ds_read_b64_tr_b16 a[108:109], v24 offset:40968
    ds_read_b64_tr_b16 a[110:111], v24 offset:41992
    s_waitcnt lgkmcnt(0)
    s_waitcnt vmcnt(28)
    s_barrier
    s_add_u32 s45, s46, 0x690000
    s_add_u32 m0, s47, 98304
    s_nop 0
    buffer_load_dwordx4 v21, s[24:27], s45 offen nt lds
    s_add_u32 s45, s46, 0x6ac000
    s_add_u32 m0, s47, 102400
    s_nop 0
    buffer_load_dwordx4 v21, s[24:27], s45 offen nt lds
    s_add_u32 s45, s46, 0x6c8000
    s_add_u32 m0, s47, 106496
    s_nop 0
    buffer_load_dwordx4 v21, s[24:27], s45 offen nt lds
    s_add_u32 s45, s46, 0x6e4000
    s_add_u32 m0, s47, 110592
    s_nop 0
    buffer_load_dwordx4 v21, s[24:27], s45 offen nt lds
    ds_read_b64_tr_b16 a[112:113], v24 offset:49152
    ds_read_b64_tr_b16 a[114:115], v24 offset:50176
    ds_read_b64_tr_b16 a[116:117], v24 offset:49160
    ds_read_b64_tr_b16 a[118:119], v24 offset:50184
    ds_read_b64_tr_b16 a[120:121], v24 offset:57344
    ds_read_b64_tr_b16 a[122:123], v24 offset:58368
    ds_read_b64_tr_b16 a[124:125], v24 offset:57352
    ds_read_b64_tr_b16 a[126:127], v24 offset:58376
    s_waitcnt lgkmcnt(0)
    s_waitcnt vmcnt(28)
    s_barrier
    ds_read_b64_tr_b16 a[128:129], v25 offset:0
    ds_read_b64_tr_b16 a[130:131], v25 offset:1024
    ds_read_b64_tr_b16 a[132:133], v25 offset:8
    ds_read_b64_tr_b16 a[134:135], v25 offset:1032
    ds_read_b64_tr_b16 a[136:137], v25 offset:8192
    ds_read_b64_tr_b16 a[138:139], v25 offset:9216
    ds_read_b64_tr_b16 a[140:141], v25 offset:8200
    ds_read_b64_tr_b16 a[142:143], v25 offset:9224
    s_waitcnt lgkmcnt(0)
    s_waitcnt vmcnt(24)
    s_barrier
    ds_read_b64_tr_b16 a[144:145], v23 offset:0
    ds_read_b64_tr_b16 a[146:147], v23 offset:1024
    ds_read_b64_tr_b16 a[148:149], v23 offset:8
    ds_read_b64_tr_b16 a[150:151], v23 offset:1032
    ds_read_b64_tr_b16 a[152:153], v23 offset:8192
    ds_read_b64_tr_b16 a[154:155], v23 offset:9216
    ds_read_b64_tr_b16 a[156:157], v23 offset:8200
    ds_read_b64_tr_b16 a[158:159], v23 offset:9224
    s_waitcnt lgkmcnt(0)
    s_waitcnt vmcnt(20)
    s_barrier
    ds_read_b64_tr_b16 a[160:161], v23 offset:16384
    ds_read_b64_tr_b16 a[162:163], v23 offset:17408
    ds_read_b64_tr_b16 a[164:165], v23 offset:16392
    ds_read_b64_tr_b16 a[166:167], v23 offset:17416
    ds_read_b64_tr_b16 a[168:169], v23 offset:24576
    ds_read_b64_tr_b16 a[170:171], v23 offset:25600
    ds_read_b64_tr_b16 a[172:173], v23 offset:24584
    ds_read_b64_tr_b16 a[174:175], v23 offset:25608
    s_waitcnt lgkmcnt(0)
    s_waitcnt vmcnt(16)
    s_barrier
    ds_read_b64_tr_b16 a[176:177], v23 offset:32768
    ds_read_b64_tr_b16 a[178:179], v23 offset:33792
    ds_read_b64_tr_b16 a[180:181], v23 offset:32776
    ds_read_b64_tr_b16 a[182:183], v23 offset:33800
    ds_read_b64_tr_b16 a[184:185], v23 offset:40960
    ds_read_b64_tr_b16 a[186:187], v23 offset:41984
    ds_read_b64_tr_b16 a[188:189], v23 offset:40968
    ds_read_b64_tr_b16 a[190:191], v23 offset:41992
    s_waitcnt lgkmcnt(0)
    s_waitcnt vmcnt(12)
    s_barrier
    ds_read_b64_tr_b16 a[192:193], v23 offset:49152
    ds_read_b64_tr_b16 a[194:195], v23 offset:50176
    ds_read_b64_tr_b16 a[196:197], v23 offset:49160
    ds_read_b64_tr_b16 a[198:199], v23 offset:50184
    ds_read_b64_tr_b16 a[200:201], v23 offset:57344
    ds_read_b64_tr_b16 a[202:203], v23 offset:58368
    ds_read_b64_tr_b16 a[204:205], v23 offset:57352
    ds_read_b64_tr_b16 a[206:207], v23 offset:58376
    s_waitcnt lgkmcnt(0)
    s_waitcnt vmcnt(8)
    s_barrier
    ds_read_b64_tr_b16 a[208:209], v24 offset:0
    ds_read_b64_tr_b16 a[210:211], v24 offset:1024
    ds_read_b64_tr_b16 a[212:213], v24 offset:8
    ds_read_b64_tr_b16 a[214:215], v24 offset:1032
    ds_read_b64_tr_b16 a[216:217], v24 offset:8192
    ds_read_b64_tr_b16 a[218:219], v24 offset:9216
    ds_read_b64_tr_b16 a[220:221], v24 offset:8200
    ds_read_b64_tr_b16 a[222:223], v24 offset:9224
    s_waitcnt lgkmcnt(0)
    s_waitcnt vmcnt(4)
    s_barrier
    ds_read_b64_tr_b16 a[224:225], v24 offset:16384
    ds_read_b64_tr_b16 a[226:227], v24 offset:17408
    ds_read_b64_tr_b16 a[228:229], v24 offset:16392
    ds_read_b64_tr_b16 a[230:231], v24 offset:17416
    ds_read_b64_tr_b16 a[232:233], v24 offset:24576
    ds_read_b64_tr_b16 a[234:235], v24 offset:25600
    ds_read_b64_tr_b16 a[236:237], v24 offset:24584
    ds_read_b64_tr_b16 a[238:239], v24 offset:25608
    s_waitcnt lgkmcnt(0)
    s_waitcnt vmcnt(0)
    s_barrier
    ds_read_b64_tr_b16 a[240:241], v24 offset:32768
    ds_read_b64_tr_b16 a[242:243], v24 offset:33792
    ds_read_b64_tr_b16 a[244:245], v24 offset:32776
    ds_read_b64_tr_b16 a[246:247], v24 offset:33800
    ds_read_b64_tr_b16 a[248:249], v24 offset:40960
    ds_read_b64_tr_b16 a[250:251], v24 offset:41984
    ds_read_b64_tr_b16 a[252:253], v24 offset:40968
    ds_read_b64_tr_b16 a[254:255], v24 offset:41992
    s_waitcnt lgkmcnt(0)
    s_barrier
    s_min_u32 s45, s41, 27
    s_lshl_b32 s45, s45, 8
    s_lshl_b32 s46, s44, 6
    s_add_u32 s45, s45, s46
    v_lshrrev_b32 v29, 4, v1
    v_lshlrev_b32 v29, 4, v29
    buffer_load_dwordx4 v[80:83], v29, s[32:35], s45 offen
    s_waitcnt vmcnt(0)
    v_lshlrev_b32 v96, 16, v80
    v_and_b32 v97, 0xffff0000, v80
    v_lshlrev_b32 v98, 16, v81
    v_and_b32 v99, 0xffff0000, v81
    v_lshlrev_b32 v100, 16, v82
    v_and_b32 v101, 0xffff0000, v82
    v_lshlrev_b32 v102, 16, v83
    v_and_b32 v103, 0xffff0000, v83
    v_mov_b32 v104, 0xbdd2d3e8
    v_mov_b32 v105, v104
    v_mov_b32 v106, 0xc0135761
    v_mov_b32 v107, v106
    s_cmp_lg_u32 s44, 0
    s_cbranch_scc1 L_pd_147
    v_mov_b32 v29, 132
    s_mov_b32 s46, 96
    s_mov_b64 exec, 1
    s_mov_b32 s70, 0
L_wp_148:
    buffer_load_dword v31, v29, s[16:19], 0 offen sc1
    s_add_u32 s70, s70, 1
    s_cmp_ge_u32 s70, 0x200000
    s_cbranch_scc1 L_w_done_109
    s_waitcnt vmcnt(0)
    v_cmp_gt_u32 vcc, s46, v31
    s_nop 1
    s_cbranch_vccz L_wp_148_ok
    s_sleep 3
    s_branch L_wp_148
L_wp_148_ok:
    s_mov_b64 exec, -1
L_pd_147:
    s_barrier
    v_lshlrev_b32 v29, 5, v1
    s_mov_b32 s45, 8192
    buffer_load_dwordx4 v[112:115], v29, s[12:15], s45 offen offset:0 sc1
    buffer_load_dwordx4 v[116:119], v29, s[12:15], s45 offen offset:16 sc1
    buffer_load_dwordx4 v[120:123], v29, s[12:15], s45 offen offset:2048 sc1
    buffer_load_dwordx4 v[124:127], v29, s[12:15], s45 offen offset:2064 sc1
    s_mov_b32 s45, 32768
    buffer_load_dwordx4 v[32:35], v29, s[12:15], s45 offen offset:0 sc1
    buffer_load_dwordx4 v[36:39], v29, s[12:15], s45 offen offset:16 sc1
    buffer_load_dwordx4 v[40:43], v29, s[12:15], s45 offen offset:2048 sc1
    buffer_load_dwordx4 v[44:47], v29, s[12:15], s45 offen offset:2064 sc1
    s_mov_b32 s45, 12288
    buffer_load_dwordx4 v[128:131], v29, s[12:15], s45 offen offset:0 sc1
    buffer_load_dwordx4 v[132:135], v29, s[12:15], s45 offen offset:16 sc1
    buffer_load_dwordx4 v[136:139], v29, s[12:15], s45 offen offset:2048 sc1
    buffer_load_dwordx4 v[140:143], v29, s[12:15], s45 offen offset:2064 sc1
    s_mov_b32 s45, 36864
    buffer_load_dwordx4 v[48:51], v29, s[12:15], s45 offen offset:0 sc1
    buffer_load_dwordx4 v[52:55], v29, s[12:15], s45 offen offset:16 sc1
    buffer_load_dwordx4 v[56:59], v29, s[12:15], s45 offen offset:2048 sc1
    buffer_load_dwordx4 v[60:63], v29, s[12:15], s45 offen offset:2064 sc1
    s_mov_b32 s45, 16384
    buffer_load_dwordx4 v[144:147], v29, s[12:15], s45 offen offset:0 sc1
    buffer_load_dwordx4 v[148:151], v29, s[12:15], s45 offen offset:16 sc1
    buffer_load_dwordx4 v[152:155], v29, s[12:15], s45 offen offset:2048 sc1
    buffer_load_dwordx4 v[156:159], v29, s[12:15], s45 offen offset:2064 sc1
    s_mov_b32 s45, 40960
    buffer_load_dwordx4 v[64:67], v29, s[12:15], s45 offen offset:0 sc1
    buffer_load_dwordx4 v[68:71], v29, s[12:15], s45 offen offset:16 sc1
    buffer_load_dwordx4 v[72:75], v29, s[12:15], s45 offen offset:2048 sc1
    buffer_load_dwordx4 v[76:79], v29, s[12:15], s45 offen offset:2064 sc1
    s_waitcnt vmcnt(0)
    v_add_f32 v112, v112, v32
    v_cvt_pk_bf16_f32 v112, v112, v112
    v_lshlrev_b32 v112, 16, v112
    v_add_f32 v113, v113, v33
    v_cvt_pk_bf16_f32 v113, v113, v113
    v_lshlrev_b32 v113, 16, v113
    v_add_f32 v114, v114, v34
    v_cvt_pk_bf16_f32 v114, v114, v114
    v_lshlrev_b32 v114, 16, v114
    v_add_f32 v115, v115, v35
    v_cvt_pk_bf16_f32 v115, v115, v115
    v_lshlrev_b32 v115, 16, v115
    v_add_f32 v116, v116, v36
    v_cvt_pk_bf16_f32 v116, v116, v116
    v_lshlrev_b32 v116, 16, v116
    v_add_f32 v117, v117, v37
    v_cvt_pk_bf16_f32 v117, v117, v117
    v_lshlrev_b32 v117, 16, v117
    v_add_f32 v118, v118, v38
    v_cvt_pk_bf16_f32 v118, v118, v118
    v_lshlrev_b32 v118, 16, v118
    v_add_f32 v119, v119, v39
    v_cvt_pk_bf16_f32 v119, v119, v119
    v_lshlrev_b32 v119, 16, v119
    v_add_f32 v120, v120, v40
    v_cvt_pk_bf16_f32 v120, v120, v120
    v_lshlrev_b32 v120, 16, v120
    v_add_f32 v121, v121, v41
    v_cvt_pk_bf16_f32 v121, v121, v121
    v_lshlrev_b32 v121, 16, v121
    v_add_f32 v122, v122, v42
    v_cvt_pk_bf16_f32 v122, v122, v122
    v_lshlrev_b32 v122, 16, v122
    v_add_f32 v123, v123, v43
    v_cvt_pk_bf16_f32 v123, v123, v123
    v_lshlrev_b32 v123, 16, v123
    v_add_f32 v124, v124, v44
    v_cvt_pk_bf16_f32 v124, v124, v124
    v_lshlrev_b32 v124, 16, v124
    v_add_f32 v125, v125, v45
    v_cvt_pk_bf16_f32 v125, v125, v125
    v_lshlrev_b32 v125, 16, v125
    v_add_f32 v126, v126, v46
    v_cvt_pk_bf16_f32 v126, v126, v126
    v_lshlrev_b32 v126, 16, v126
    v_add_f32 v127, v127, v47
    v_cvt_pk_bf16_f32 v127, v127, v127
    v_lshlrev_b32 v127, 16, v127
    v_add_f32 v128, v128, v48
    v_cvt_pk_bf16_f32 v128, v128, v128
    v_lshlrev_b32 v128, 16, v128
    v_add_f32 v129, v129, v49
    v_cvt_pk_bf16_f32 v129, v129, v129
    v_lshlrev_b32 v129, 16, v129
    v_add_f32 v130, v130, v50
    v_cvt_pk_bf16_f32 v130, v130, v130
    v_lshlrev_b32 v130, 16, v130
    v_add_f32 v131, v131, v51
    v_cvt_pk_bf16_f32 v131, v131, v131
    v_lshlrev_b32 v131, 16, v131
    v_add_f32 v132, v132, v52
    v_cvt_pk_bf16_f32 v132, v132, v132
    v_lshlrev_b32 v132, 16, v132
    v_add_f32 v133, v133, v53
    v_cvt_pk_bf16_f32 v133, v133, v133
    v_lshlrev_b32 v133, 16, v133
    v_add_f32 v134, v134, v54
    v_cvt_pk_bf16_f32 v134, v134, v134
    v_lshlrev_b32 v134, 16, v134
    v_add_f32 v135, v135, v55
    v_cvt_pk_bf16_f32 v135, v135, v135
    v_lshlrev_b32 v135, 16, v135
    v_add_f32 v136, v136, v56
    v_cvt_pk_bf16_f32 v136, v136, v136
    v_lshlrev_b32 v136, 16, v136
    v_add_f32 v137, v137, v57
    v_cvt_pk_bf16_f32 v137, v137, v137
    v_lshlrev_b32 v137, 16, v137
    v_add_f32 v138, v138, v58
    v_cvt_pk_bf16_f32 v138, v138, v138
    v_lshlrev_b32 v138, 16, v138
    v_add_f32 v139, v139, v59
    v_cvt_pk_bf16_f32 v139, v139, v139
    v_lshlrev_b32 v139, 16, v139
    v_add_f32 v140, v140, v60
    v_cvt_pk_bf16_f32 v140, v140, v140
    v_lshlrev_b32 v140, 16, v140
    v_add_f32 v141, v141, v61
    v_cvt_pk_bf16_f32 v141, v141, v141
    v_lshlrev_b32 v141, 16, v141
    v_add_f32 v142, v142, v62
    v_cvt_pk_bf16_f32 v142, v142, v142
    v_lshlrev_b32 v142, 16, v142
    v_add_f32 v143, v143, v63
    v_cvt_pk_bf16_f32 v143, v143, v143
    v_lshlrev_b32 v143, 16, v143
    v_add_f32 v144, v144, v64
    v_cvt_pk_bf16_f32 v144, v144, v144
    v_lshlrev_b32 v144, 16, v144
    v_add_f32 v144, 1.0, v144
    v_cvt_pk_bf16_f32 v144, v144, v144
    v_lshlrev_b32 v144, 16, v144
    v_add_f32 v145, v145, v65
    v_cvt_pk_bf16_f32 v145, v145, v145
    v_lshlrev_b32 v145, 16, v145
    v_add_f32 v145, 1.0, v145
    v_cvt_pk_bf16_f32 v145, v145, v145
    v_lshlrev_b32 v145, 16, v145
    v_add_f32 v146, v146, v66
    v_cvt_pk_bf16_f32 v146, v146, v146
    v_lshlrev_b32 v146, 16, v146
    v_add_f32 v146, 1.0, v146
    v_cvt_pk_bf16_f32 v146, v146, v146
    v_lshlrev_b32 v146, 16, v146
    v_add_f32 v147, v147, v67
    v_cvt_pk_bf16_f32 v147, v147, v147
    v_lshlrev_b32 v147, 16, v147
    v_add_f32 v147, 1.0, v147
    v_cvt_pk_bf16_f32 v147, v147, v147
    v_lshlrev_b32 v147, 16, v147
    v_add_f32 v148, v148, v68
    v_cvt_pk_bf16_f32 v148, v148, v148
    v_lshlrev_b32 v148, 16, v148
    v_add_f32 v148, 1.0, v148
    v_cvt_pk_bf16_f32 v148, v148, v148
    v_lshlrev_b32 v148, 16, v148
    v_add_f32 v149, v149, v69
    v_cvt_pk_bf16_f32 v149, v149, v149
    v_lshlrev_b32 v149, 16, v149
    v_add_f32 v149, 1.0, v149
    v_cvt_pk_bf16_f32 v149, v149, v149
    v_lshlrev_b32 v149, 16, v149
    v_add_f32 v150, v150, v70
    v_cvt_pk_bf16_f32 v150, v150, v150
    v_lshlrev_b32 v150, 16, v150
    v_add_f32 v150, 1.0, v150
    v_cvt_pk_bf16_f32 v150, v150, v150
    v_lshlrev_b32 v150, 16, v150
    v_add_f32 v151, v151, v71
    v_cvt_pk_bf16_f32 v151, v151, v151
    v_lshlrev_b32 v151, 16, v151
    v_add_f32 v151, 1.0, v151
    v_cvt_pk_bf16_f32 v151, v151, v151
    v_lshlrev_b32 v151, 16, v151
    v_add_f32 v152, v152, v72
    v_cvt_pk_bf16_f32 v152, v152, v152
    v_lshlrev_b32 v152, 16, v152
    v_add_f32 v152, 1.0, v152
    v_cvt_pk_bf16_f32 v152, v152, v152
    v_lshlrev_b32 v152, 16, v152
    v_add_f32 v153, v153, v73
    v_cvt_pk_bf16_f32 v153, v153, v153
    v_lshlrev_b32 v153, 16, v153
    v_add_f32 v153, 1.0, v153
    v_cvt_pk_bf16_f32 v153, v153, v153
    v_lshlrev_b32 v153, 16, v153
    v_add_f32 v154, v154, v74
    v_cvt_pk_bf16_f32 v154, v154, v154
    v_lshlrev_b32 v154, 16, v154
    v_add_f32 v154, 1.0, v154
    v_cvt_pk_bf16_f32 v154, v154, v154
    v_lshlrev_b32 v154, 16, v154
    v_add_f32 v155, v155, v75
    v_cvt_pk_bf16_f32 v155, v155, v155
    v_lshlrev_b32 v155, 16, v155
    v_add_f32 v155, 1.0, v155
    v_cvt_pk_bf16_f32 v155, v155, v155
    v_lshlrev_b32 v155, 16, v155
    v_add_f32 v156, v156, v76
    v_cvt_pk_bf16_f32 v156, v156, v156
    v_lshlrev_b32 v156, 16, v156
    v_add_f32 v156, 1.0, v156
    v_cvt_pk_bf16_f32 v156, v156, v156
    v_lshlrev_b32 v156, 16, v156
    v_add_f32 v157, v157, v77
    v_cvt_pk_bf16_f32 v157, v157, v157
    v_lshlrev_b32 v157, 16, v157
    v_add_f32 v157, 1.0, v157
    v_cvt_pk_bf16_f32 v157, v157, v157
    v_lshlrev_b32 v157, 16, v157
    v_add_f32 v158, v158, v78
    v_cvt_pk_bf16_f32 v158, v158, v158
    v_lshlrev_b32 v158, 16, v158
    v_add_f32 v158, 1.0, v158
    v_cvt_pk_bf16_f32 v158, v158, v158
    v_lshlrev_b32 v158, 16, v158
    v_add_f32 v159, v159, v79
    v_cvt_pk_bf16_f32 v159, v159, v159
    v_lshlrev_b32 v159, 16, v159
    v_add_f32 v159, 1.0, v159
    v_cvt_pk_bf16_f32 v159, v159, v159
    v_lshlrev_b32 v159, 16, v159
    s_mov_b32 s52, 0xc00000
    s_lshl_b32 s56, s41, 13
    s_add_u32 s56, s56, 0x6000000
L_b_loop_149:
    s_cmp_eq_u64 s[36:37], 0
    s_cbranch_scc1 L_w_done_109
    s_ff1_i32_b64 s50, s[36:37]
    s_bitset0_b64 s[36:37], s50
    s_lshr_b64 s[74:75], s[72:73], s50
    s_ff1_i32_b64 s51, s[74:75]
    s_add_u32 s51, s51, 1
    s_add_u32 s62, s50, s51
    s_add_u32 s63, s50, s44
    s_lshl_b32 s63, s63, 5
    s_add_u32 s63, s63, s41
    s_lshl_b32 s47, s63, 11
    buffer_load_dwordx4 v[208:211], v10, s[28:31], s47 offen
    buffer_load_dwordx4 v[212:215], v10, s[28:31], s47 offen offset:1024
    s_add_u32 s45, s64, 4096
    s_cmp_lg_u32 s44, 0
    s_cbranch_scc1 L_pw_152
    s_mov_b32 exec_hi, 0
    s_mov_b32 s70, 0
L_wp_153:
    buffer_load_dword v31, v5, s[12:15], s45 offen sc1
    s_add_u32 s70, s70, 1
    s_cmp_ge_u32 s70, 0x200000
    s_cbranch_scc1 L_w_done_109
    s_waitcnt vmcnt(0)
    v_cmp_gt_u32 vcc, s62, v31
    s_nop 1
    s_cbranch_vccz L_wp_153_ok
    s_sleep 2
    s_branch L_wp_153
L_wp_153_ok:
    s_mov_b64 exec, -1
L_pw_152:
    s_barrier
    s_cmp_ge_u32 s44, s51
    s_cbranch_scc1 L_b_skip_150
    s_lshl_b32 s45, s63, 12
    s_add_u32 s45, s45, 0x8000000
    v_lshlrev_b32 v29, 5, v1
    buffer_load_dwordx4 v[64:67], v29, s[12:15], s45 offen offset:0 sc1
    buffer_load_dwordx4 v[68:71], v29, s[12:15], s45 offen offset:16 sc1
    buffer_load_dwordx4 v[72:75], v29, s[12:15], s45 offen offset:2048 sc1
    buffer_load_dwordx4 v[76:79], v29, s[12:15], s45 offen offset:2064 sc1
    s_add_u32 s45, s45, 0x800000
    buffer_load_dwordx4 v[160:163], v29, s[12:15], s45 offen offset:0 sc1
    buffer_load_dwordx4 v[164:167], v29, s[12:15], s45 offen offset:16 sc1
    buffer_load_dwordx4 v[168:171], v29, s[12:15], s45 offen offset:2048 sc1
    buffer_load_dwordx4 v[172:175], v29, s[12:15], s45 offen offset:2064 sc1
    s_add_u32 s45, s45, 0x800000
    buffer_load_dwordx4 v[176:179], v29, s[12:15], s45 offen offset:0 sc1
    buffer_load_dwordx4 v[180:183], v29, s[12:15], s45 offen offset:16 sc1
    buffer_load_dwordx4 v[184:187], v29, s[12:15], s45 offen offset:2048 sc1
    buffer_load_dwordx4 v[188:191], v29, s[12:15], s45 offen offset:2064 sc1
    s_add_u32 s45, s45, 0x800000
    buffer_load_dwordx4 v[192:195], v29, s[12:15], s45 offen offset:0 sc1
    buffer_load_dwordx4 v[196:199], v29, s[12:15], s45 offen offset:16 sc1
    buffer_load_dwordx4 v[200:203], v29, s[12:15], s45 offen offset:2048 sc1
    buffer_load_dwordx4 v[204:207], v29, s[12:15], s45 offen offset:2064 sc1
    s_waitcnt vmcnt(0)
    v_pk_add_f32 v[64:65], v[64:65], v[160:161]
    v_pk_add_f32 v[176:177], v[176:177], v[192:193]
    v_pk_add_f32 v[66:67], v[66:67], v[162:163]
    v_pk_add_f32 v[178:179], v[178:179], v[194:195]
    v_pk_add_f32 v[68:69], v[68:69], v[164:165]
    v_pk_add_f32 v[180:181], v[180:181], v[196:197]
    v_pk_add_f32 v[70:71], v[70:71], v[166:167]
    v_pk_add_f32 v[182:183], v[182:183], v[198:199]
    v_pk_add_f32 v[72:73], v[72:73], v[168:169]
    v_pk_add_f32 v[184:185], v[184:185], v[200:201]
    v_pk_add_f32 v[74:75], v[74:75], v[170:171]
    v_pk_add_f32 v[186:187], v[186:187], v[202:203]
    v_pk_add_f32 v[76:77], v[76:77], v[172:173]
    v_pk_add_f32 v[188:189], v[188:189], v[204:205]
    v_pk_add_f32 v[78:79], v[78:79], v[174:175]
    v_pk_add_f32 v[190:191], v[190:191], v[206:207]
    v_pk_add_f32 v[64:65], v[64:65], v[176:177]
    v_pk_add_f32 v[66:67], v[66:67], v[178:179]
    v_pk_add_f32 v[68:69], v[68:69], v[180:181]
    v_pk_add_f32 v[70:71], v[70:71], v[182:183]
    v_pk_add_f32 v[72:73], v[72:73], v[184:185]
    v_pk_add_f32 v[74:75], v[74:75], v[186:187]
    v_pk_add_f32 v[76:77], v[76:77], v[188:189]
    v_pk_add_f32 v[78:79], v[78:79], v[190:191]
    v_cvt_pk_bf16_f32 v64, v64, v64
    v_lshlrev_b32 v64, 16, v64
    v_cvt_pk_bf16_f32 v65, v65, v65
    v_lshlrev_b32 v65, 16, v65
    v_cvt_pk_bf16_f32 v66, v66, v66
    v_lshlrev_b32 v66, 16, v66
    v_cvt_pk_bf16_f32 v67, v67, v67
    v_lshlrev_b32 v67, 16, v67
    v_cvt_pk_bf16_f32 v68, v68, v68
    v_lshlrev_b32 v68, 16, v68
    v_cvt_pk_bf16_f32 v69, v69, v69
    v_lshlrev_b32 v69, 16, v69
    v_cvt_pk_bf16_f32 v70, v70, v70
    v_lshlrev_b32 v70, 16, v70
    v_cvt_pk_bf16_f32 v71, v71, v71
    v_lshlrev_b32 v71, 16, v71
    v_cvt_pk_bf16_f32 v72, v72, v72
    v_lshlrev_b32 v72, 16, v72
    v_cvt_pk_bf16_f32 v73, v73, v73
    v_lshlrev_b32 v73, 16, v73
    v_cvt_pk_bf16_f32 v74, v74, v74
    v_lshlrev_b32 v74, 16, v74
    v_cvt_pk_bf16_f32 v75, v75, v75
    v_lshlrev_b32 v75, 16, v75
    v_cvt_pk_bf16_f32 v76, v76, v76
    v_lshlrev_b32 v76, 16, v76
    v_cvt_pk_bf16_f32 v77, v77, v77
    v_lshlrev_b32 v77, 16, v77
    v_cvt_pk_bf16_f32 v78, v78, v78
    v_lshlrev_b32 v78, 16, v78
    v_cvt_pk_bf16_f32 v79, v79, v79
    v_lshlrev_b32 v79, 16, v79
    v_lshlrev_b32 v160, 16, v208
    v_and_b32 v161, 0xffff0000, v208
    v_lshlrev_b32 v162, 16, v209
    v_and_b32 v163, 0xffff0000, v209
    v_lshlrev_b32 v164, 16, v210
    v_and_b32 v165, 0xffff0000, v210
    v_lshlrev_b32 v166, 16, v211
    v_and_b32 v167, 0xffff0000, v211
    v_lshlrev_b32 v168, 16, v212
    v_and_b32 v169, 0xffff0000, v212
    v_lshlrev_b32 v170, 16, v213
    v_and_b32 v171, 0xffff0000, v213
    v_lshlrev_b32 v172, 16, v214
    v_and_b32 v173, 0xffff0000, v214
    v_lshlrev_b32 v174, 16, v215
    v_and_b32 v175, 0xffff0000, v215
    v_mul_f32 v64, v64, v112
    v_cvt_pk_bf16_f32 v64, v64, v64
    v_lshlrev_b32 v64, 16, v64
    v_add_f32 v64, v64, v160
    v_mul_f32 v65, v65, v113
    v_cvt_pk_bf16_f32 v65, v65, v65
    v_lshlrev_b32 v65, 16, v65
    v_add_f32 v65, v65, v161
    v_mul_f32 v66, v66, v114
    v_cvt_pk_bf16_f32 v66, v66, v66
    v_lshlrev_b32 v66, 16, v66
    v_add_f32 v66, v66, v162
    v_mul_f32 v67, v67, v115
    v_cvt_pk_bf16_f32 v67, v67, v67
    v_lshlrev_b32 v67, 16, v67
    v_add_f32 v67, v67, v163
    v_mul_f32 v68, v68, v116
    v_cvt_pk_bf16_f32 v68, v68, v68
    v_lshlrev_b32 v68, 16, v68
    v_add_f32 v68, v68, v164
    v_mul_f32 v69, v69, v117
    v_cvt_pk_bf16_f32 v69, v69, v69
    v_lshlrev_b32 v69, 16, v69
    v_add_f32 v69, v69, v165
    v_mul_f32 v70, v70, v118
    v_cvt_pk_bf16_f32 v70, v70, v70
    v_lshlrev_b32 v70, 16, v70
    v_add_f32 v70, v70, v166
    v_mul_f32 v71, v71, v119
    v_cvt_pk_bf16_f32 v71, v71, v71
    v_lshlrev_b32 v71, 16, v71
    v_add_f32 v71, v71, v167
    v_mul_f32 v72, v72, v120
    v_cvt_pk_bf16_f32 v72, v72, v72
    v_lshlrev_b32 v72, 16, v72
    v_add_f32 v72, v72, v168
    v_mul_f32 v73, v73, v121
    v_cvt_pk_bf16_f32 v73, v73, v73
    v_lshlrev_b32 v73, 16, v73
    v_add_f32 v73, v73, v169
    v_mul_f32 v74, v74, v122
    v_cvt_pk_bf16_f32 v74, v74, v74
    v_lshlrev_b32 v74, 16, v74
    v_add_f32 v74, v74, v170
    v_mul_f32 v75, v75, v123
    v_cvt_pk_bf16_f32 v75, v75, v75
    v_lshlrev_b32 v75, 16, v75
    v_add_f32 v75, v75, v171
    v_mul_f32 v76, v76, v124
    v_cvt_pk_bf16_f32 v76, v76, v76
    v_lshlrev_b32 v76, 16, v76
    v_add_f32 v76, v76, v172
    v_mul_f32 v77, v77, v125
    v_cvt_pk_bf16_f32 v77, v77, v77
    v_lshlrev_b32 v77, 16, v77
    v_add_f32 v77, v77, v173
    v_mul_f32 v78, v78, v126
    v_cvt_pk_bf16_f32 v78, v78, v78
    v_lshlrev_b32 v78, 16, v78
    v_add_f32 v78, v78, v174
    v_mul_f32 v79, v79, v127
    v_cvt_pk_bf16_f32 v79, v79, v79
    v_lshlrev_b32 v79, 16, v79
    v_add_f32 v79, v79, v175
    v_cvt_pk_bf16_f32 v208, v64, v65
    v_cvt_pk_bf16_f32 v209, v66, v67
    v_cvt_pk_bf16_f32 v210, v68, v69
    v_cvt_pk_bf16_f32 v211, v70, v71
    v_cvt_pk_bf16_f32 v212, v72, v73
    v_cvt_pk_bf16_f32 v213, v74, v75
    v_cvt_pk_bf16_f32 v214, v76, v77
    v_cvt_pk_bf16_f32 v215, v78, v79
    s_add_u32 s47, s47, 0x800000
    buffer_store_dwordx4 v[208:211], v10, s[12:15], s47 offen sc1
    buffer_store_dwordx4 v[212:215], v10, s[12:15], s47 offen offset:1024 sc1
    v_lshlrev_b32 v64, 16, v208
    v_and_b32 v65, 0xffff0000, v208
    v_lshlrev_b32 v66, 16, v209
    v_and_b32 v67, 0xffff0000, v209
    v_lshlrev_b32 v68, 16, v210
    v_and_b32 v69, 0xffff0000, v210
    v_lshlrev_b32 v70, 16, v211
    v_and_b32 v71, 0xffff0000, v211
    v_lshlrev_b32 v72, 16, v212
    v_and_b32 v73, 0xffff0000, v212
    v_lshlrev_b32 v74, 16, v213
    v_and_b32 v75, 0xffff0000, v213
    v_lshlrev_b32 v76, 16, v214
    v_and_b32 v77, 0xffff0000, v214
    v_lshlrev_b32 v78, 16, v215
    v_and_b32 v79, 0xffff0000, v215
    v_add_f32 v26, v64, v65
    v_add_f32 v26, v26, v66
    v_add_f32 v26, v26, v67
    v_add_f32 v26, v26, v68
    v_add_f32 v26, v26, v69
    v_add_f32 v26, v26, v70
    v_add_f32 v26, v26, v71
    v_add_f32 v26, v26, v72
    v_add_f32 v26, v26, v73
    v_add_f32 v26, v26, v74
    v_add_f32 v26, v26, v75
    v_add_f32 v26, v26, v76
    v_add_f32 v26, v26, v77
    v_add_f32 v26, v26, v78
    v_add_f32 v26, v26, v79
    s_nop 1
    v_add_f32_dpp v26, v26, v26 row_shr:1 row_mask:0xf bank_mask:0xf bound_ctrl:0
    s_nop 1
    v_add_f32_dpp v26, v26, v26 row_shr:2 row_mask:0xf bank_mask:0xf bound_ctrl:0
    s_nop 1
    v_add_f32_dpp v26, v26, v26 row_shr:4 row_mask:0xf bank_mask:0xf bound_ctrl:0
    s_nop 1
    v_add_f32_dpp v26, v26, v26 row_shr:8 row_mask:0xf bank_mask:0xf bound_ctrl:0
    s_nop 1
    v_add_f32_dpp v26, v26, v26 row_bcast:15 row_mask:0xa bank_mask:0xf
    s_nop 1
    v_add_f32_dpp v26, v26, v26 row_bcast:31 row_mask:0xc bank_mask:0xf
    s_nop 1
    v_readlane_b32 s66, v26, 63
    s_nop 1
    v_mov_b32 v27, s66
    v_mul_f32 v27, 0x3a800000, v27
    v_mov_b32 v26, 0
    v_sub_f32 v28, v64, v27
    v_fmac_f32 v26, v28, v28
    v_sub_f32 v28, v65, v27
    v_fmac_f32 v26, v28, v28
    v_sub_f32 v28, v66, v27
    v_fmac_f32 v26, v28, v28
    v_sub_f32 v28, v67, v27
    v_fmac_f32 v26, v28, v28
    v_sub_f32 v28, v68, v27
    v_fmac_f32 v26, v28, v28
    v_sub_f32 v28, v69, v27
    v_fmac_f32 v26, v28, v28
    v_sub_f32 v28, v70, v27
    v_fmac_f32 v26, v28, v28
    v_sub_f32 v28, v71, v27
    v_fmac_f32 v26, v28, v28
    v_sub_f32 v28, v72, v27
    v_fmac_f32 v26, v28, v28
    v_sub_f32 v28, v73, v27
    v_fmac_f32 v26, v28, v28
    v_sub_f32 v28, v74, v27
    v_fmac_f32 v26, v28, v28
    v_sub_f32 v28, v75, v27
    v_fmac_f32 v26, v28, v28
    v_sub_f32 v28, v76, v27
    v_fmac_f32 v26, v28, v28
    v_sub_f32 v28, v77, v27
    v_fmac_f32 v26, v28, v28
    v_sub_f32 v28, v78, v27
    v_fmac_f32 v26, v28, v28
    v_sub_f32 v28, v79, v27
    v_fmac_f32 v26, v28, v28
    s_nop 1
    v_add_f32_dpp v26, v26, v26 row_shr:1 row_mask:0xf bank_mask:0xf bound_ctrl:0
    s_nop 1
    v_add_f32_dpp v26, v26, v26 row_shr:2 row_mask:0xf bank_mask:0xf bound_ctrl:0
    s_nop 1
    v_add_f32_dpp v26, v26, v26 row_shr:4 row_mask:0xf bank_mask:0xf bound_ctrl:0
    s_nop 1
    v_add_f32_dpp v26, v26, v26 row_shr:8 row_mask:0xf bank_mask:0xf bound_ctrl:0
    s_nop 1
    v_add_f32_dpp v26, v26, v26 row_bcast:15 row_mask:0xa bank_mask:0xf
    s_nop 1
    v_add_f32_dpp v26, v26, v26 row_bcast:31 row_mask:0xc bank_mask:0xf
    s_nop 1
    v_readlane_b32 s66, v26, 63
    s_nop 1
    v_mov_b32 v26, s66
    v_mul_f32 v26, 0x3a800000, v26
    v_cvt_pk_bf16_f32 v26, v26, v26
    v_lshlrev_b32 v26, 16, v26
    v_cvt_pk_bf16_f32 v27, v27, v27
    v_lshlrev_b32 v27, 16, v27
    v_add_f32 v26, 0x3727c5ac, v26
    v_cvt_pk_bf16_f32 v26, v26, v26
    v_lshlrev_b32 v26, 16, v26
    v_sqrt_f32 v26, v26
    s_nop 0
    v_cvt_pk_bf16_f32 v26, v26, v26
    v_lshlrev_b32 v26, 16, v26
    v_rcp_f32 v26, v26
    s_nop 0
    v_sub_f32 v64, v64, v27
    v_cvt_pk_bf16_f32 v64, v64, v64
    v_lshlrev_b32 v64, 16, v64
    v_mul_f32 v64, v64, v26
    v_cvt_pk_bf16_f32 v64, v64, v64
    v_lshlrev_b32 v64, 16, v64
    v_sub_f32 v65, v65, v27
    v_cvt_pk_bf16_f32 v65, v65, v65
    v_lshlrev_b32 v65, 16, v65
    v_mul_f32 v65, v65, v26
    v_cvt_pk_bf16_f32 v65, v65, v65
    v_lshlrev_b32 v65, 16, v65
    v_sub_f32 v66, v66, v27
    v_cvt_pk_bf16_f32 v66, v66, v66
    v_lshlrev_b32 v66, 16, v66
    v_mul_f32 v66, v66, v26
    v_cvt_pk_bf16_f32 v66, v66, v66
    v_lshlrev_b32 v66, 16, v66
    v_sub_f32 v67, v67, v27
    v_cvt_pk_bf16_f32 v67, v67, v67
    v_lshlrev_b32 v67, 16, v67
    v_mul_f32 v67, v67, v26
    v_cvt_pk_bf16_f32 v67, v67, v67
    v_lshlrev_b32 v67, 16, v67
    v_sub_f32 v68, v68, v27
    v_cvt_pk_bf16_f32 v68, v68, v68
    v_lshlrev_b32 v68, 16, v68
    v_mul_f32 v68, v68, v26
    v_cvt_pk_bf16_f32 v68, v68, v68
    v_lshlrev_b32 v68, 16, v68
    v_sub_f32 v69, v69, v27
    v_cvt_pk_bf16_f32 v69, v69, v69
    v_lshlrev_b32 v69, 16, v69
    v_mul_f32 v69, v69, v26
    v_cvt_pk_bf16_f32 v69, v69, v69
    v_lshlrev_b32 v69, 16, v69
    v_sub_f32 v70, v70, v27
    v_cvt_pk_bf16_f32 v70, v70, v70
    v_lshlrev_b32 v70, 16, v70
    v_mul_f32 v70, v70, v26
    v_cvt_pk_bf16_f32 v70, v70, v70
    v_lshlrev_b32 v70, 16, v70
    v_sub_f32 v71, v71, v27
    v_cvt_pk_bf16_f32 v71, v71, v71
    v_lshlrev_b32 v71, 16, v71
    v_mul_f32 v71, v71, v26
    v_cvt_pk_bf16_f32 v71, v71, v71
    v_lshlrev_b32 v71, 16, v71
    v_sub_f32 v72, v72, v27
    v_cvt_pk_bf16_f32 v72, v72, v72
    v_lshlrev_b32 v72, 16, v72
    v_mul_f32 v72, v72, v26
    v_cvt_pk_bf16_f32 v72, v72, v72
    v_lshlrev_b32 v72, 16, v72
    v_sub_f32 v73, v73, v27
    v_cvt_pk_bf16_f32 v73, v73, v73
    v_lshlrev_b32 v73, 16, v73
    v_mul_f32 v73, v73, v26
    v_cvt_pk_bf16_f32 v73, v73, v73
    v_lshlrev_b32 v73, 16, v73
    v_sub_f32 v74, v74, v27
    v_cvt_pk_bf16_f32 v74, v74, v74
    v_lshlrev_b32 v74, 16, v74
    v_mul_f32 v74, v74, v26
    v_cvt_pk_bf16_f32 v74, v74, v74
    v_lshlrev_b32 v74, 16, v74
    v_sub_f32 v75, v75, v27
    v_cvt_pk_bf16_f32 v75, v75, v75
    v_lshlrev_b32 v75, 16, v75
    v_mul_f32 v75, v75, v26
    v_cvt_pk_bf16_f32 v75, v75, v75
    v_lshlrev_b32 v75, 16, v75
    v_sub_f32 v76, v76, v27
    v_cvt_pk_bf16_f32 v76, v76, v76
    v_lshlrev_b32 v76, 16, v76
    v_mul_f32 v76, v76, v26
    v_cvt_pk_bf16_f32 v76, v76, v76
    v_lshlrev_b32 v76, 16, v76
    v_sub_f32 v77, v77, v27
    v_cvt_pk_bf16_f32 v77, v77, v77
    v_lshlrev_b32 v77, 16, v77
    v_mul_f32 v77, v77, v26
    v_cvt_pk_bf16_f32 v77, v77, v77
    v_lshlrev_b32 v77, 16, v77
    v_sub_f32 v78, v78, v27
    v_cvt_pk_bf16_f32 v78, v78, v78
    v_lshlrev_b32 v78, 16, v78
    v_mul_f32 v78, v78, v26
    v_cvt_pk_bf16_f32 v78, v78, v78
    v_lshlrev_b32 v78, 16, v78
    v_sub_f32 v79, v79, v27
    v_cvt_pk_bf16_f32 v79, v79, v79
    v_lshlrev_b32 v79, 16, v79
    v_mul_f32 v79, v79, v26
    v_cvt_pk_bf16_f32 v79, v79, v79
    v_lshlrev_b32 v79, 16, v79
    v_mul_f32 v64, v64, v144
    v_cvt_pk_bf16_f32 v64, v64, v64
    v_lshlrev_b32 v64, 16, v64
    v_add_f32 v64, v64, v128
    v_mul_f32 v65, v65, v145
    v_cvt_pk_bf16_f32 v65, v65, v65
    v_lshlrev_b32 v65, 16, v65
    v_add_f32 v65, v65, v129
    v_mul_f32 v66, v66, v146
    v_cvt_pk_bf16_f32 v66, v66, v66
    v_lshlrev_b32 v66, 16, v66
    v_add_f32 v66, v66, v130
    v_mul_f32 v67, v67, v147
    v_cvt_pk_bf16_f32 v67, v67, v67
    v_lshlrev_b32 v67, 16, v67
    v_add_f32 v67, v67, v131
    v_mul_f32 v68, v68, v148
    v_cvt_pk_bf16_f32 v68, v68, v68
    v_lshlrev_b32 v68, 16, v68
    v_add_f32 v68, v68, v132
    v_mul_f32 v69, v69, v149
    v_cvt_pk_bf16_f32 v69, v69, v69
    v_lshlrev_b32 v69, 16, v69
    v_add_f32 v69, v69, v133
    v_mul_f32 v70, v70, v150
    v_cvt_pk_bf16_f32 v70, v70, v70
    v_lshlrev_b32 v70, 16, v70
    v_add_f32 v70, v70, v134
    v_mul_f32 v71, v71, v151
    v_cvt_pk_bf16_f32 v71, v71, v71
    v_lshlrev_b32 v71, 16, v71
    v_add_f32 v71, v71, v135
    v_mul_f32 v72, v72, v152
    v_cvt_pk_bf16_f32 v72, v72, v72
    v_lshlrev_b32 v72, 16, v72
    v_add_f32 v72, v72, v136
    v_mul_f32 v73, v73, v153
    v_cvt_pk_bf16_f32 v73, v73, v73
    v_lshlrev_b32 v73, 16, v73
    v_add_f32 v73, v73, v137
    v_mul_f32 v74, v74, v154
    v_cvt_pk_bf16_f32 v74, v74, v74
    v_lshlrev_b32 v74, 16, v74
    v_add_f32 v74, v74, v138
    v_mul_f32 v75, v75, v155
    v_cvt_pk_bf16_f32 v75, v75, v75
    v_lshlrev_b32 v75, 16, v75
    v_add_f32 v75, v75, v139
    v_mul_f32 v76, v76, v156
    v_cvt_pk_bf16_f32 v76, v76, v76
    v_lshlrev_b32 v76, 16, v76
    v_add_f32 v76, v76, v140
    v_mul_f32 v77, v77, v157
    v_cvt_pk_bf16_f32 v77, v77, v77
    v_lshlrev_b32 v77, 16, v77
    v_add_f32 v77, v77, v141
    v_mul_f32 v78, v78, v158
    v_cvt_pk_bf16_f32 v78, v78, v78
    v_lshlrev_b32 v78, 16, v78
    v_add_f32 v78, v78, v142
    v_mul_f32 v79, v79, v159
    v_cvt_pk_bf16_f32 v79, v79, v79
    v_lshlrev_b32 v79, 16, v79
    v_add_f32 v79, v79, v143
    v_cvt_pk_bf16_f32 v80, v64, v65
    v_cvt_pk_bf16_f32 v81, v66, v67
    v_cvt_pk_bf16_f32 v82, v68, v69
    v_cvt_pk_bf16_f32 v83, v70, v71
    v_cvt_pk_bf16_f32 v84, v72, v73
    v_cvt_pk_bf16_f32 v85, v74, v75
    v_cvt_pk_bf16_f32 v86, v76, v77
    v_cvt_pk_bf16_f32 v87, v78, v79
    s_lshr_b32 s45, s63, 5
    s_lshl_b32 s45, s45, 16
    s_and_b32 s46, s63, 31
    s_lshl_b32 s46, s46, 8
    s_add_u32 s45, s45, s46
    s_add_u32 s45, s45, 0xc00000
    s_add_u32 s46, s45, 32768
    buffer_store_dwordx4 v[80:83], v2, s[12:15], s45 offen sc1
    buffer_store_dwordx4 v[84:87], v2, s[12:15], s46 offen sc1
L_b_skip_150:
    s_waitcnt vmcnt(0)
    s_barrier
    s_cmp_lg_u32 s44, 0
    s_cbranch_scc1 L_pub_154
    v_mov_b32 v30, s62
    v_mov_b32 v31, 0
    s_mov_b64 exec, 1
    buffer_store_dword v30, v31, s[12:15], s65 offen sc1
    s_mov_b64 exec, -1
L_pub_154:
    s_cmp_ge_u32 s41, 28
    s_cbranch_scc1 L_b_loop_149
    s_add_u32 s45, s64, 8192
    s_cmp_lg_u32 s44, 0
    s_cbranch_scc1 L_pw_155
    s_mov_b32 exec_hi, 0
    s_mov_b32 s70, 0
L_wp_156:
    buffer_load_dword v31, v5, s[12:15], s45 offen sc1
    s_add_u32 s70, s70, 1
    s_cmp_ge_u32 s70, 0x200000
    s_cbranch_scc1 L_w_done_109
    s_waitcnt vmcnt(0)
    v_cmp_gt_u32 vcc, s62, v31
    s_nop 1
    s_cbranch_vccz L_wp_156_ok
    s_sleep 1
    s_branch L_wp_156
L_wp_156_ok:
    s_mov_b64 exec, -1
L_pw_155:
    s_barrier
    s_mul_i32 s53, s50, 65536
    s_add_u32 s53, s53, s52
    s_lshl_b32 s54, s44, 13
    s_add_u32 s53, s53, s54
    s_mul_i32 s57, s50, 229376
    s_add_u32 s57, s57, s56
    s_lshl_b32 s45, s44, 11
    s_add_u32 s57, s57, s45
    s_add_u32 s55, s54, 65536
    s_mov_b32 s58, 0
    v_mov_b32 v13, v3
    v_add_u32 v14, 65536, v13
    v_xor_b32 v15, 64, v13
    v_xor_b32 v16, 64, v14
    s_mov_b32 s76, 0x20000000
    s_add_u32 s48, s53, 0
    s_add_u32 s49, s48, 4096
    s_add_u32 m0, s54, 0
    s_nop 0
    buffer_load_dwordx4 v6, s[12:15], s48 offen offset:0 sc1 lds
    s_add_u32 m0, s54, 1024
    s_nop 0
    buffer_load_dwordx4 v9, s[12:15], s48 offen offset:0 sc1 lds
    s_add_u32 m0, s54, 2048
    s_nop 0
    buffer_load_dwordx4 v6, s[12:15], s49 offen offset:0 sc1 lds
    s_add_u32 m0, s54, 3072
    s_nop 0
    buffer_load_dwordx4 v9, s[12:15], s49 offen offset:0 sc1 lds
    s_add_u32 m0, s54, 3968
    s_nop 0
    buffer_load_dwordx4 v6, s[12:15], s48 offen offset:128 sc1 lds
    s_add_u32 m0, s54, 4992
    s_nop 0
    buffer_load_dwordx4 v9, s[12:15], s48 offen offset:128 sc1 lds
    s_add_u32 m0, s54, 6016
    s_nop 0
    buffer_load_dwordx4 v6, s[12:15], s49 offen offset:128 sc1 lds
    s_add_u32 m0, s54, 7040
    s_nop 0
    buffer_load_dwordx4 v9, s[12:15], s49 offen offset:128 sc1 lds
    s_add_u32 s48, s53, 32768
    s_add_u32 s49, s48, 4096
    s_add_u32 s46, s54, 32768
    s_add_u32 m0, s46, 0
    s_nop 0
    buffer_load_dwordx4 v6, s[12:15], s48 offen offset:0 sc1 lds
    s_add_u32 m0, s46, 1024
    s_nop 0
    buffer_load_dwordx4 v9, s[12:15], s48 offen offset:0 sc1 lds
    s_add_u32 m0, s46, 2048
    s_nop 0
    buffer_load_dwordx4 v6, s[12:15], s49 offen offset:0 sc1 lds
    s_add_u32 m0, s46, 3072
    s_nop 0
    buffer_load_dwordx4 v9, s[12:15], s49 offen offset:0 sc1 lds
    s_add_u32 m0, s46, 3968
    s_nop 0
    buffer_load_dwordx4 v6, s[12:15], s48 offen offset:128 sc1 lds
    s_add_u32 m0, s46, 4992
    s_nop 0
    buffer_load_dwordx4 v9, s[12:15], s48 offen offset:128 sc1 lds
    s_add_u32 m0, s46, 6016
    s_nop 0
    buffer_load_dwordx4 v6, s[12:15], s49 offen offset:128 sc1 lds
    s_add_u32 m0, s46, 7040
    s_nop 0
    buffer_load_dwordx4 v9, s[12:15], s49 offen offset:128 sc1 lds
    s_add_u32 s48, s53, 65536
    s_cmp_gt_u32 s51, 1
    s_cselect_b32 s48, s48, 0x20000000
    s_add_u32 s49, s48, 4096
    s_add_u32 m0, s55, 0
    s_nop 0
    buffer_load_dwordx4 v6, s[12:15], s48 offen offset:0 sc1 lds
    s_add_u32 m0, s55, 1024
    s_nop 0
    buffer_load_dwordx4 v9, s[12:15], s48 offen offset:0 sc1 lds
    s_add_u32 m0, s55, 2048
    s_nop 0
    buffer_load_dwordx4 v6, s[12:15], s49 offen offset:0 sc1 lds
    s_add_u32 m0, s55, 3072
    s_nop 0
    buffer_load_dwordx4 v9, s[12:15], s49 offen offset:0 sc1 lds
    s_add_u32 m0, s55, 3968
    s_nop 0
    buffer_load_dwordx4 v6, s[12:15], s48 offen offset:128 sc1 lds
    s_add_u32 m0, s55, 4992
    s_nop 0
    buffer_load_dwordx4 v9, s[12:15], s48 offen offset:128 sc1 lds
    s_add_u32 m0, s55, 6016
    s_nop 0
    buffer_load_dwordx4 v6, s[12:15], s49 offen offset:128 sc1 lds
    s_add_u32 m0, s55, 7040
    s_nop 0
    buffer_load_dwordx4 v9, s[12:15], s49 offen offset:128 sc1 lds
    s_waitcnt vmcnt(16)
    s_barrier
    ds_read_b128 v[32:35], v13 offset:0
    ds_read_b128 v[36:39], v13 offset:2048
    ds_read_b128 v[40:43], v15 offset:0
    ds_read_b128 v[44:47], v15 offset:2048
L_e_loop_157:
    s_add_u32 s48, s53, 98304
    s_add_u32 s46, s58, 1
    s_cmp_lt_u32 s46, s51
    s_cselect_b32 s48, s48, 0x20000000
    s_add_u32 s49, s48, 4096
    s_add_u32 s59, s55, 32768
    s_waitcnt lgkmcnt(2)
    v_mfma_f32_16x16x32_bf16 v[80:83], a[0:3], v[32:35], 0
    ds_read_b128 v[48:51], v13 offset:4096
    ds_read_b128 v[52:55], v13 offset:6144
    v_mfma_f32_16x16x32_bf16 v[84:87], a[4:7], v[32:35], 0
    ds_read_b128 v[56:59], v15 offset:4096
    ds_read_b128 v[60:63], v15 offset:6144
    v_mfma_f32_16x16x32_bf16 v[88:91], a[0:3], v[36:39], 0
    s_add_u32 m0, s59, 0
    s_nop 0
    buffer_load_dwordx4 v6, s[12:15], s48 offen offset:0 sc1 lds
    v_mfma_f32_16x16x32_bf16 v[92:95], a[4:7], v[36:39], 0
    v_lshlrev_b32 v224, 16, v216
    v_and_b32 v225, 0xffff0000, v216
    s_waitcnt lgkmcnt(4)
    v_mfma_f32_16x16x32_bf16 v[80:83], a[8:11], v[40:43], v[80:83]
    ds_read_b128 v[32:35], v13 offset:8192
    ds_read_b128 v[36:39], v13 offset:10240
    v_mfma_f32_16x16x32_bf16 v[84:87], a[12:15], v[40:43], v[84:87]
    v_lshlrev_b32 v226, 16, v217
    v_and_b32 v227, 0xffff0000, v217
    v_mfma_f32_16x16x32_bf16 v[88:91], a[8:11], v[44:47], v[88:91]
    s_add_u32 m0, s59, 1024
    s_nop 0
    buffer_load_dwordx4 v9, s[12:15], s48 offen offset:0 sc1 lds
    v_mfma_f32_16x16x32_bf16 v[92:95], a[12:15], v[44:47], v[92:95]
    v_lshlrev_b32 v228, 16, v218
    v_and_b32 v229, 0xffff0000, v218
    s_waitcnt lgkmcnt(4)
    v_mfma_f32_16x16x32_bf16 v[80:83], a[16:19], v[48:51], v[80:83]
    ds_read_b128 v[40:43], v15 offset:8192
    ds_read_b128 v[44:47], v15 offset:10240
    v_mfma_f32_16x16x32_bf16 v[84:87], a[20:23], v[48:51], v[84:87]
    v_lshlrev_b32 v230, 16, v219
    v_and_b32 v231, 0xffff0000, v219
    v_mfma_f32_16x16x32_bf16 v[88:91], a[16:19], v[52:55], v[88:91]
    s_add_u32 m0, s59, 2048
    s_nop 0
    buffer_load_dwordx4 v6, s[12:15], s49 offen offset:0 sc1 lds
    v_mfma_f32_16x16x32_bf16 v[92:95], a[20:23], v[52:55], v[92:95]
    v_lshlrev_b32 v232, 16, v220
    v_and_b32 v233, 0xffff0000, v220
    s_waitcnt lgkmcnt(4)
    v_mfma_f32_16x16x32_bf16 v[80:83], a[24:27], v[56:59], v[80:83]
    ds_read_b128 v[48:51], v13 offset:12288
    ds_read_b128 v[52:55], v13 offset:14336
    v_mfma_f32_16x16x32_bf16 v[84:87], a[28:31], v[56:59], v[84:87]
    v_lshlrev_b32 v234, 16, v221
    v_and_b32 v235, 0xffff0000, v221
    v_mfma_f32_16x16x32_bf16 v[88:91], a[24:27], v[60:63], v[88:91]
    s_add_u32 m0, s59, 3072
    s_nop 0
    buffer_load_dwordx4 v9, s[12:15], s49 offen offset:0 sc1 lds
    v_mfma_f32_16x16x32_bf16 v[92:95], a[28:31], v[60:63], v[92:95]
    v_lshlrev_b32 v236, 16, v222
    v_and_b32 v237, 0xffff0000, v222
    s_waitcnt lgkmcnt(4)
    v_mfma_f32_16x16x32_bf16 v[80:83], a[32:35], v[32:35], v[80:83]
    ds_read_b128 v[56:59], v15 offset:12288
    ds_read_b128 v[60:63], v15 offset:14336
    v_mfma_f32_16x16x32_bf16 v[84:87], a[36:39], v[32:35], v[84:87]
    v_lshlrev_b32 v238, 16, v223
    v_and_b32 v239, 0xffff0000, v223
    v_mfma_f32_16x16x32_bf16 v[88:91], a[32:35], v[36:39], v[88:91]
    s_add_u32 m0, s59, 3968
    s_nop 0
    buffer_load_dwordx4 v6, s[12:15], s48 offen offset:128 sc1 lds
    v_mfma_f32_16x16x32_bf16 v[92:95], a[36:39], v[36:39], v[92:95]
    v_pk_add_f32 v[224:225], v[224:225], v[96:97]
    v_pk_add_f32 v[226:227], v[226:227], v[98:99]
    s_waitcnt lgkmcnt(4)
    v_mfma_f32_16x16x32_bf16 v[80:83], a[40:43], v[40:43], v[80:83]
    ds_read_b128 v[32:35], v13 offset:16384
    ds_read_b128 v[36:39], v13 offset:18432
    v_mfma_f32_16x16x32_bf16 v[84:87], a[44:47], v[40:43], v[84:87]
    v_pk_add_f32 v[228:229], v[228:229], v[100:101]
    v_pk_add_f32 v[230:231], v[230:231], v[102:103]
    v_mfma_f32_16x16x32_bf16 v[88:91], a[40:43], v[44:47], v[88:91]
    s_add_u32 m0, s59, 4992
    s_nop 0
    buffer_load_dwordx4 v9, s[12:15], s48 offen offset:128 sc1 lds
    v_mfma_f32_16x16x32_bf16 v[92:95], a[44:47], v[44:47], v[92:95]
    v_pk_add_f32 v[232:233], v[232:233], v[96:97]
    v_pk_add_f32 v[234:235], v[234:235], v[98:99]
    s_waitcnt lgkmcnt(4)
    v_mfma_f32_16x16x32_bf16 v[80:83], a[48:51], v[48:51], v[80:83]
    ds_read_b128 v[40:43], v15 offset:16384
    ds_read_b128 v[44:47], v15 offset:18432
    v_mfma_f32_16x16x32_bf16 v[84:87], a[52:55], v[48:51], v[84:87]
    v_pk_add_f32 v[236:237], v[236:237], v[100:101]
    v_pk_add_f32 v[238:239], v[238:239], v[102:103]
    v_mfma_f32_16x16x32_bf16 v[88:91], a[48:51], v[52:55], v[88:91]
    s_add_u32 m0, s59, 6016
    s_nop 0
    buffer_load_dwordx4 v6, s[12:15], s49 offen offset:128 sc1 lds
    v_mfma_f32_16x16x32_bf16 v[92:95], a[52:55], v[52:55], v[92:95]
    v_cvt_pk_bf16_f32 v216, v224, v225
    v_cvt_pk_bf16_f32 v217, v226, v227
    s_waitcnt lgkmcnt(4)
    v_mfma_f32_16x16x32_bf16 v[80:83], a[56:59], v[56:59], v[80:83]
    ds_read_b128 v[48:51], v13 offset:20480
    ds_read_b128 v[52:55], v13 offset:22528
    v_mfma_f32_16x16x32_bf16 v[84:87], a[60:63], v[56:59], v[84:87]
    v_cvt_pk_bf16_f32 v218, v228, v229
    v_cvt_pk_bf16_f32 v219, v230, v231
    v_mfma_f32_16x16x32_bf16 v[88:91], a[56:59], v[60:63], v[88:91]
    s_add_u32 m0, s59, 7040
    s_nop 0
    buffer_load_dwordx4 v9, s[12:15], s49 offen offset:128 sc1 lds
    v_mfma_f32_16x16x32_bf16 v[92:95], a[60:63], v[60:63], v[92:95]
    v_cvt_pk_bf16_f32 v220, v232, v233
    v_cvt_pk_bf16_f32 v221, v234, v235
    s_waitcnt lgkmcnt(4)
    v_mfma_f32_16x16x32_bf16 v[80:83], a[64:67], v[32:35], v[80:83]
    ds_read_b128 v[56:59], v15 offset:20480
    ds_read_b128 v[60:63], v15 offset:22528
    v_mfma_f32_16x16x32_bf16 v[84:87], a[68:71], v[32:35], v[84:87]
    v_cvt_pk_bf16_f32 v222, v236, v237
    v_cvt_pk_bf16_f32 v223, v238, v239
    v_mfma_f32_16x16x32_bf16 v[88:91], a[64:67], v[36:39], v[88:91]
    v_lshlrev_b32 v224, 16, v216
    v_and_b32 v225, 0xffff0000, v216
    v_mfma_f32_16x16x32_bf16 v[92:95], a[68:71], v[36:39], v[92:95]
    v_lshlrev_b32 v226, 16, v217
    v_and_b32 v227, 0xffff0000, v217
    s_waitcnt lgkmcnt(4)
    v_mfma_f32_16x16x32_bf16 v[80:83], a[72:75], v[40:43], v[80:83]
    ds_read_b128 v[32:35], v13 offset:24576
    ds_read_b128 v[36:39], v13 offset:26624
    v_mfma_f32_16x16x32_bf16 v[84:87], a[76:79], v[40:43], v[84:87]
    v_lshlrev_b32 v228, 16, v218
    v_and_b32 v229, 0xffff0000, v218
    v_mfma_f32_16x16x32_bf16 v[88:91], a[72:75], v[44:47], v[88:91]
    v_lshlrev_b32 v230, 16, v219
    v_and_b32 v231, 0xffff0000, v219
    v_mfma_f32_16x16x32_bf16 v[92:95], a[76:79], v[44:47], v[92:95]
    v_lshlrev_b32 v232, 16, v220
    v_and_b32 v233, 0xffff0000, v220
    s_waitcnt lgkmcnt(4)
    v_mfma_f32_16x16x32_bf16 v[80:83], a[80:83], v[48:51], v[80:83]
    ds_read_b128 v[40:43], v15 offset:24576
    ds_read_b128 v[44:47], v15 offset:26624
    v_mfma_f32_16x16x32_bf16 v[84:87], a[84:87], v[48:51], v[84:87]
    v_lshlrev_b32 v234, 16, v221
    v_and_b32 v235, 0xffff0000, v221
    v_mfma_f32_16x16x32_bf16 v[88:91], a[80:83], v[52:55], v[88:91]
    v_lshlrev_b32 v236, 16, v222
    v_and_b32 v237, 0xffff0000, v222
    v_mfma_f32_16x16x32_bf16 v[92:95], a[84:87], v[52:55], v[92:95]
    v_lshlrev_b32 v238, 16, v223
    v_and_b32 v239, 0xffff0000, v223
    s_waitcnt lgkmcnt(4)
    v_mfma_f32_16x16x32_bf16 v[80:83], a[88:91], v[56:59], v[80:83]
    ds_read_b128 v[48:51], v13 offset:28672
    ds_read_b128 v[52:55], v13 offset:30720
    v_mfma_f32_16x16x32_bf16 v[84:87], a[92:95], v[56:59], v[84:87]
    v_pk_mul_f32 v[240:241], v[224:225], v[224:225]
    v_pk_mul_f32 v[242:243], v[226:227], v[226:227]
    v_mfma_f32_16x16x32_bf16 v[88:91], a[88:91], v[60:63], v[88:91]
    v_pk_mul_f32 v[244:245], v[228:229], v[228:229]
    v_pk_mul_f32 v[246:247], v[230:231], v[230:231]
    v_mfma_f32_16x16x32_bf16 v[92:95], a[92:95], v[60:63], v[92:95]
    v_pk_mul_f32 v[248:249], v[232:233], v[232:233]
    v_pk_mul_f32 v[250:251], v[234:235], v[234:235]
    s_waitcnt lgkmcnt(4)
    v_mfma_f32_16x16x32_bf16 v[80:83], a[96:99], v[32:35], v[80:83]
    ds_read_b128 v[56:59], v15 offset:28672
    ds_read_b128 v[60:63], v15 offset:30720
    v_mfma_f32_16x16x32_bf16 v[84:87], a[100:103], v[32:35], v[84:87]
    v_pk_mul_f32 v[252:253], v[236:237], v[236:237]
    v_pk_mul_f32 v[254:255], v[238:239], v[238:239]
    v_mfma_f32_16x16x32_bf16 v[88:91], a[96:99], v[36:39], v[88:91]
    v_pk_fma_f32 v[240:241], v[240:241], v[104:105], v[106:107]
    v_pk_fma_f32 v[242:243], v[242:243], v[104:105], v[106:107]
    v_mfma_f32_16x16x32_bf16 v[92:95], a[100:103], v[36:39], v[92:95]
    v_pk_fma_f32 v[244:245], v[244:245], v[104:105], v[106:107]
    v_pk_fma_f32 v[246:247], v[246:247], v[104:105], v[106:107]
    s_waitcnt lgkmcnt(4)
    v_mfma_f32_16x16x32_bf16 v[80:83], a[104:107], v[40:43], v[80:83]
    v_pk_fma_f32 v[248:249], v[248:249], v[104:105], v[106:107]
    v_pk_fma_f32 v[250:251], v[250:251], v[104:105], v[106:107]
    v_mfma_f32_16x16x32_bf16 v[84:87], a[108:111], v[40:43], v[84:87]
    v_pk_fma_f32 v[252:253], v[252:253], v[104:105], v[106:107]
    v_pk_fma_f32 v[254:255], v[254:255], v[104:105], v[106:107]
    v_mfma_f32_16x16x32_bf16 v[88:91], a[104:107], v[44:47], v[88:91]
    v_pk_mul_f32 v[240:241], v[240:241], v[224:225]
    v_pk_mul_f32 v[242:243], v[242:243], v[226:227]
    v_mfma_f32_16x16x32_bf16 v[92:95], a[108:111], v[44:47], v[92:95]
    v_pk_mul_f32 v[244:245], v[244:245], v[228:229]
    v_pk_mul_f32 v[246:247], v[246:247], v[230:231]
    s_waitcnt vmcnt(16) lgkmcnt(0)
    s_barrier
    v_mfma_f32_16x16x32_bf16 v[80:83], a[112:115], v[48:51], v[80:83]
    ds_read_b128 v[32:35], v13 offset:32768
    ds_read_b128 v[36:39], v13 offset:34816
    v_mfma_f32_16x16x32_bf16 v[84:87], a[116:119], v[48:51], v[84:87]
    v_pk_mul_f32 v[248:249], v[248:249], v[232:233]
    v_pk_mul_f32 v[250:251], v[250:251], v[234:235]
    v_mfma_f32_16x16x32_bf16 v[88:91], a[112:115], v[52:55], v[88:91]
    v_pk_mul_f32 v[252:253], v[252:253], v[236:237]
    v_pk_mul_f32 v[254:255], v[254:255], v[238:239]
    v_mfma_f32_16x16x32_bf16 v[92:95], a[116:119], v[52:55], v[92:95]
    v_exp_f32 v240, v240
    v_mfma_f32_16x16x32_bf16 v[80:83], a[120:123], v[56:59], v[80:83]
    ds_read_b128 v[40:43], v15 offset:32768
    ds_read_b128 v[44:47], v15 offset:34816
    v_mfma_f32_16x16x32_bf16 v[84:87], a[124:127], v[56:59], v[84:87]
    v_exp_f32 v241, v241
    v_exp_f32 v242, v242
    v_mfma_f32_16x16x32_bf16 v[88:91], a[120:123], v[60:63], v[88:91]
    v_exp_f32 v243, v243
    v_mfma_f32_16x16x32_bf16 v[92:95], a[124:127], v[60:63], v[92:95]
    v_exp_f32 v244, v244
    s_add_u32 s48, s53, 131072
    s_add_u32 s46, s58, 2
    s_cmp_lt_u32 s46, s51
    s_cselect_b32 s48, s48, 0x20000000
    s_add_u32 s49, s48, 4096
    s_mov_b32 s59, s54
    s_waitcnt lgkmcnt(2)
    v_mfma_f32_16x16x32_bf16 v[80:83], a[128:131], v[32:35], v[80:83]
    ds_read_b128 v[48:51], v13 offset:36864
    ds_read_b128 v[52:55], v13 offset:38912
    v_mfma_f32_16x16x32_bf16 v[84:87], a[132:135], v[32:35], v[84:87]
    ds_read_b128 v[56:59], v15 offset:36864
    ds_read_b128 v[60:63], v15 offset:38912
    v_mfma_f32_16x16x32_bf16 v[88:91], a[128:131], v[36:39], v[88:91]
    s_add_u32 m0, s59, 0
    s_nop 0
    buffer_load_dwordx4 v6, s[12:15], s48 offen offset:0 sc1 lds
    v_mfma_f32_16x16x32_bf16 v[92:95], a[132:135], v[36:39], v[92:95]
    v_exp_f32 v245, v245
    v_exp_f32 v246, v246
    s_waitcnt lgkmcnt(4)
    v_mfma_f32_16x16x32_bf16 v[80:83], a[136:139], v[40:43], v[80:83]
    ds_read_b128 v[32:35], v13 offset:40960
    ds_read_b128 v[36:39], v13 offset:43008
    v_mfma_f32_16x16x32_bf16 v[84:87], a[140:143], v[40:43], v[84:87]
    v_exp_f32 v247, v247
    v_exp_f32 v248, v248
    v_mfma_f32_16x16x32_bf16 v[88:91], a[136:139], v[44:47], v[88:91]
    s_add_u32 m0, s59, 1024
    s_nop 0
    buffer_load_dwordx4 v9, s[12:15], s48 offen offset:0 sc1 lds
    v_mfma_f32_16x16x32_bf16 v[92:95], a[140:143], v[44:47], v[92:95]
    v_exp_f32 v249, v249
    v_exp_f32 v250, v250
    s_waitcnt lgkmcnt(4)
    v_mfma_f32_16x16x32_bf16 v[80:83], a[144:147], v[48:51], v[80:83]
    ds_read_b128 v[40:43], v15 offset:40960
    ds_read_b128 v[44:47], v15 offset:43008
    v_mfma_f32_16x16x32_bf16 v[84:87], a[148:151], v[48:51], v[84:87]
    v_exp_f32 v251, v251
    v_exp_f32 v252, v252
    v_mfma_f32_16x16x32_bf16 v[88:91], a[144:147], v[52:55], v[88:91]
    s_add_u32 m0, s59, 2048
    s_nop 0
    buffer_load_dwordx4 v6, s[12:15], s49 offen offset:0 sc1 lds
    v_mfma_f32_16x16x32_bf16 v[92:95], a[148:151], v[52:55], v[92:95]
    v_exp_f32 v253, v253
    v_exp_f32 v254, v254
    s_waitcnt lgkmcnt(4)
    v_mfma_f32_16x16x32_bf16 v[80:83], a[152:155], v[56:59], v[80:83]
    ds_read_b128 v[48:51], v13 offset:45056
    ds_read_b128 v[52:55], v13 offset:47104
    v_mfma_f32_16x16x32_bf16 v[84:87], a[156:159], v[56:59], v[84:87]
    v_exp_f32 v255, v255
    v_add_f32 v240, 1.0, v240
    v_mfma_f32_16x16x32_bf16 v[88:91], a[152:155], v[60:63], v[88:91]
    s_add_u32 m0, s59, 3072
    s_nop 0
    buffer_load_dwordx4 v9, s[12:15], s49 offen offset:0 sc1 lds
    v_mfma_f32_16x16x32_bf16 v[92:95], a[156:159], v[60:63], v[92:95]
    v_add_f32 v241, 1.0, v241
    v_add_f32 v242, 1.0, v242
    s_waitcnt lgkmcnt(4)
    v_mfma_f32_16x16x32_bf16 v[80:83], a[160:163], v[32:35], v[80:83]
    ds_read_b128 v[56:59], v15 offset:45056
    ds_read_b128 v[60:63], v15 offset:47104
    v_mfma_f32_16x16x32_bf16 v[84:87], a[164:167], v[32:35], v[84:87]
    v_add_f32 v243, 1.0, v243
    v_add_f32 v244, 1.0, v244
    v_mfma_f32_16x16x32_bf16 v[88:91], a[160:163], v[36:39], v[88:91]
    s_add_u32 m0, s59, 3968
    s_nop 0
    buffer_load_dwordx4 v6, s[12:15], s48 offen offset:128 sc1 lds
    v_mfma_f32_16x16x32_bf16 v[92:95], a[164:167], v[36:39], v[92:95]
    v_add_f32 v245, 1.0, v245
    v_add_f32 v246, 1.0, v246
    s_waitcnt lgkmcnt(4)
    v_mfma_f32_16x16x32_bf16 v[80:83], a[168:171], v[40:43], v[80:83]
    ds_read_b128 v[32:35], v13 offset:49152
    ds_read_b128 v[36:39], v13 offset:51200
    v_mfma_f32_16x16x32_bf16 v[84:87], a[172:175], v[40:43], v[84:87]
    v_add_f32 v247, 1.0, v247
    v_add_f32 v248, 1.0, v248
    v_mfma_f32_16x16x32_bf16 v[88:91], a[168:171], v[44:47], v[88:91]
    s_add_u32 m0, s59, 4992
    s_nop 0
    buffer_load_dwordx4 v9, s[12:15], s48 offen offset:128 sc1 lds
    v_mfma_f32_16x16x32_bf16 v[92:95], a[172:175], v[44:47], v[92:95]
    v_add_f32 v249, 1.0, v249
    v_add_f32 v250, 1.0, v250
    s_waitcnt lgkmcnt(4)
    v_mfma_f32_16x16x32_bf16 v[80:83], a[176:179], v[48:51], v[80:83]
    ds_read_b128 v[40:43], v15 offset:49152
    ds_read_b128 v[44:47], v15 offset:51200
    v_mfma_f32_16x16x32_bf16 v[84:87], a[180:183], v[48:51], v[84:87]
    v_add_f32 v251, 1.0, v251
    v_add_f32 v252, 1.0, v252
    v_mfma_f32_16x16x32_bf16 v[88:91], a[176:179], v[52:55], v[88:91]
    s_add_u32 m0, s59, 6016
    s_nop 0
    buffer_load_dwordx4 v6, s[12:15], s49 offen offset:128 sc1 lds
    v_mfma_f32_16x16x32_bf16 v[92:95], a[180:183], v[52:55], v[92:95]
    v_add_f32 v253, 1.0, v253
    v_add_f32 v254, 1.0, v254
    s_waitcnt lgkmcnt(4)
    v_mfma_f32_16x16x32_bf16 v[80:83], a[184:187], v[56:59], v[80:83]
    ds_read_b128 v[48:51], v13 offset:53248
    ds_read_b128 v[52:55], v13 offset:55296
    v_mfma_f32_16x16x32_bf16 v[84:87], a[188:191], v[56:59], v[84:87]
    v_add_f32 v255, 1.0, v255
    v_rcp_f32 v240, v240
    v_mfma_f32_16x16x32_bf16 v[88:91], a[184:187], v[60:63], v[88:91]
    s_add_u32 m0, s59, 7040
    s_nop 0
    buffer_load_dwordx4 v9, s[12:15], s49 offen offset:128 sc1 lds
    v_mfma_f32_16x16x32_bf16 v[92:95], a[188:191], v[60:63], v[92:95]
    v_rcp_f32 v241, v241
    v_rcp_f32 v242, v242
    s_waitcnt lgkmcnt(4)
    v_mfma_f32_16x16x32_bf16 v[80:83], a[192:195], v[32:35], v[80:83]
    ds_read_b128 v[56:59], v15 offset:53248
    ds_read_b128 v[60:63], v15 offset:55296
    v_mfma_f32_16x16x32_bf16 v[84:87], a[196:199], v[32:35], v[84:87]
    v_rcp_f32 v243, v243
    v_rcp_f32 v244, v244
    v_mfma_f32_16x16x32_bf16 v[88:91], a[192:195], v[36:39], v[88:91]
    v_rcp_f32 v245, v245
    v_rcp_f32 v246, v246
    v_mfma_f32_16x16x32_bf16 v[92:95], a[196:199], v[36:39], v[92:95]
    v_rcp_f32 v247, v247
    v_rcp_f32 v248, v248
    s_waitcnt lgkmcnt(4)
    v_mfma_f32_16x16x32_bf16 v[80:83], a[200:203], v[40:43], v[80:83]
    ds_read_b128 v[32:35], v13 offset:57344
    ds_read_b128 v[36:39], v13 offset:59392
    v_mfma_f32_16x16x32_bf16 v[84:87], a[204:207], v[40:43], v[84:87]
    v_rcp_f32 v249, v249
    v_rcp_f32 v250, v250
    v_mfma_f32_16x16x32_bf16 v[88:91], a[200:203], v[44:47], v[88:91]
    v_rcp_f32 v251, v251
    v_mfma_f32_16x16x32_bf16 v[92:95], a[204:207], v[44:47], v[92:95]
    v_rcp_f32 v252, v252
    s_waitcnt lgkmcnt(4)
    v_mfma_f32_16x16x32_bf16 v[80:83], a[208:211], v[48:51], v[80:83]
    ds_read_b128 v[40:43], v15 offset:57344
    ds_read_b128 v[44:47], v15 offset:59392
    v_mfma_f32_16x16x32_bf16 v[84:87], a[212:215], v[48:51], v[84:87]
    v_rcp_f32 v253, v253
    v_rcp_f32 v254, v254
    v_mfma_f32_16x16x32_bf16 v[88:91], a[208:211], v[52:55], v[88:91]
    v_rcp_f32 v255, v255
    v_mfma_f32_16x16x32_bf16 v[92:95], a[212:215], v[52:55], v[92:95]
    v_pk_mul_f32 v[224:225], v[224:225], v[240:241]
    s_waitcnt lgkmcnt(4)
    v_mfma_f32_16x16x32_bf16 v[80:83], a[216:219], v[56:59], v[80:83]
    ds_read_b128 v[48:51], v13 offset:61440
    ds_read_b128 v[52:55], v13 offset:63488
    v_mfma_f32_16x16x32_bf16 v[84:87], a[220:223], v[56:59], v[84:87]
    v_pk_mul_f32 v[226:227], v[226:227], v[242:243]
    v_pk_mul_f32 v[228:229], v[228:229], v[244:245]
    v_mfma_f32_16x16x32_bf16 v[88:91], a[216:219], v[60:63], v[88:91]
    v_pk_mul_f32 v[230:231], v[230:231], v[246:247]
    v_mfma_f32_16x16x32_bf16 v[92:95], a[220:223], v[60:63], v[92:95]
    v_pk_mul_f32 v[232:233], v[232:233], v[248:249]
    s_waitcnt lgkmcnt(4)
    v_mfma_f32_16x16x32_bf16 v[80:83], a[224:227], v[32:35], v[80:83]
    ds_read_b128 v[56:59], v15 offset:61440
    ds_read_b128 v[60:63], v15 offset:63488
    v_mfma_f32_16x16x32_bf16 v[84:87], a[228:231], v[32:35], v[84:87]
    v_pk_mul_f32 v[234:235], v[234:235], v[250:251]
    v_pk_mul_f32 v[236:237], v[236:237], v[252:253]
    v_mfma_f32_16x16x32_bf16 v[88:91], a[224:227], v[36:39], v[88:91]
    v_pk_mul_f32 v[238:239], v[238:239], v[254:255]
    v_mfma_f32_16x16x32_bf16 v[92:95], a[228:231], v[36:39], v[92:95]
    v_cvt_pk_bf16_f32 v240, v224, v225
    s_waitcnt lgkmcnt(4)
    v_mfma_f32_16x16x32_bf16 v[80:83], a[232:235], v[40:43], v[80:83]
    v_cvt_pk_bf16_f32 v241, v226, v227
    v_mfma_f32_16x16x32_bf16 v[84:87], a[236:239], v[40:43], v[84:87]
    v_cvt_pk_bf16_f32 v242, v228, v229
    v_mfma_f32_16x16x32_bf16 v[88:91], a[232:235], v[44:47], v[88:91]
    v_cvt_pk_bf16_f32 v243, v230, v231
    v_mfma_f32_16x16x32_bf16 v[92:95], a[236:239], v[44:47], v[92:95]
    v_cvt_pk_bf16_f32 v244, v232, v233
    s_waitcnt vmcnt(16) lgkmcnt(0)
    s_barrier
    v_mfma_f32_16x16x32_bf16 v[80:83], a[240:243], v[48:51], v[80:83]
    ds_read_b128 v[32:35], v14 offset:0
    ds_read_b128 v[36:39], v14 offset:2048
    v_mfma_f32_16x16x32_bf16 v[84:87], a[244:247], v[48:51], v[84:87]
    v_cvt_pk_bf16_f32 v245, v234, v235
    v_cvt_pk_bf16_f32 v246, v236, v237
    v_mfma_f32_16x16x32_bf16 v[88:91], a[240:243], v[52:55], v[88:91]
    v_cvt_pk_bf16_f32 v247, v238, v239
    v_mfma_f32_16x16x32_bf16 v[92:95], a[244:247], v[52:55], v[92:95]
    buffer_store_dwordx4 v[240:243], v10, s[12:15], s76 offen sc1
    v_mfma_f32_16x16x32_bf16 v[80:83], a[248:251], v[56:59], v[80:83]
    ds_read_b128 v[40:43], v16 offset:0
    ds_read_b128 v[44:47], v16 offset:2048
    v_mfma_f32_16x16x32_bf16 v[84:87], a[252:255], v[56:59], v[84:87]
    buffer_store_dwordx4 v[244:247], v10, s[12:15], s76 offen offset:1024 sc1
    v_mfma_f32_16x16x32_bf16 v[88:91], a[248:251], v[60:63], v[88:91]
    v_mfma_f32_16x16x32_bf16 v[92:95], a[252:255], v[60:63], v[92:95]
    s_add_u32 s53, s53, 65536
    s_add_u32 s58, s58, 1
    v_swap_b32 v13, v14
    s_xor_b32 s54, s54, 65536
    s_xor_b32 s55, s55, 65536
    s_mov_b32 s76, s57
    v_swap_b32 v15, v16
    s_add_u32 s57, s57, 229376
    v_cvt_pk_bf16_f32 v216, v80, v81
    v_cvt_pk_bf16_f32 v217, v82, v83
    v_cvt_pk_bf16_f32 v218, v84, v85
    v_cvt_pk_bf16_f32 v219, v86, v87
    v_cvt_pk_bf16_f32 v220, v88, v89
    v_cvt_pk_bf16_f32 v221, v90, v91
    v_cvt_pk_bf16_f32 v222, v92, v93
    v_cvt_pk_bf16_f32 v223, v94, v95
    s_cmp_lt_u32 s58, s51
    s_cbranch_scc1 L_e_loop_157
    v_lshlrev_b32 v224, 16, v216
    v_and_b32 v225, 0xffff0000, v216
    v_lshlrev_b32 v226, 16, v217
    v_and_b32 v227, 0xffff0000, v217
    v_lshlrev_b32 v228, 16, v218
    v_and_b32 v229, 0xffff0000, v218
    v_lshlrev_b32 v230, 16, v219
    v_and_b32 v231, 0xffff0000, v219
    v_lshlrev_b32 v232, 16, v220
    v_and_b32 v233, 0xffff0000, v220
    v_lshlrev_b32 v234, 16, v221
    v_and_b32 v235, 0xffff0000, v221
    v_lshlrev_b32 v236, 16, v222
    v_and_b32 v237, 0xffff0000, v222
    v_lshlrev_b32 v238, 16, v223
    v_and_b32 v239, 0xffff0000, v223
    v_pk_add_f32 v[224:225], v[224:225], v[96:97]
    v_pk_add_f32 v[226:227], v[226:227], v[98:99]
    v_pk_add_f32 v[228:229], v[228:229], v[100:101]
    v_pk_add_f32 v[230:231], v[230:231], v[102:103]
    v_pk_add_f32 v[232:233], v[232:233], v[96:97]
    v_pk_add_f32 v[234:235], v[234:235], v[98:99]
    v_pk_add_f32 v[236:237], v[236:237], v[100:101]
    v_pk_add_f32 v[238:239], v[238:239], v[102:103]
    v_cvt_pk_bf16_f32 v216, v224, v225
    v_cvt_pk_bf16_f32 v217, v226, v227
    v_cvt_pk_bf16_f32 v218, v228, v229
    v_cvt_pk_bf16_f32 v219, v230, v231
    v_cvt_pk_bf16_f32 v220, v232, v233
    v_cvt_pk_bf16_f32 v221, v234, v235
    v_cvt_pk_bf16_f32 v222, v236, v237
    v_cvt_pk_bf16_f32 v223, v238, v239
    v_lshlrev_b32 v224, 16, v216
    v_and_b32 v225, 0xffff0000, v216
    v_lshlrev_b32 v226, 16, v217
    v_and_b32 v227, 0xffff0000, v217
    v_lshlrev_b32 v228, 16, v218
    v_and_b32 v229, 0xffff0000, v218
    v_lshlrev_b32 v230, 16, v219
    v_and_b32 v231, 0xffff0000, v219
    v_lshlrev_b32 v232, 16, v220
    v_and_b32 v233, 0xffff0000, v220
    v_lshlrev_b32 v234, 16, v221
    v_and_b32 v235, 0xffff0000, v221
    v_lshlrev_b32 v236, 16, v222
    v_and_b32 v237, 0xffff0000, v222
    v_lshlrev_b32 v238, 16, v223
    v_and_b32 v239, 0xffff0000, v223
    v_pk_mul_f32 v[240:241], v[224:225], v[224:225]
    v_pk_mul_f32 v[242:243], v[226:227], v[226:227]
    v_pk_mul_f32 v[244:245], v[228:229], v[228:229]
    v_pk_mul_f32 v[246:247], v[230:231], v[230:231]
    v_pk_mul_f32 v[248:249], v[232:233], v[232:233]
    v_pk_mul_f32 v[250:251], v[234:235], v[234:235]
    v_pk_mul_f32 v[252:253], v[236:237], v[236:237]
    v_pk_mul_f32 v[254:255], v[238:239], v[238:239]
    v_pk_fma_f32 v[240:241], v[240:241], v[104:105], v[106:107]
    v_pk_fma_f32 v[242:243], v[242:243], v[104:105], v[106:107]
    v_pk_fma_f32 v[244:245], v[244:245], v[104:105], v[106:107]
    v_pk_fma_f32 v[246:247], v[246:247], v[104:105], v[106:107]
    v_pk_fma_f32 v[248:249], v[248:249], v[104:105], v[106:107]
    v_pk_fma_f32 v[250:251], v[250:251], v[104:105], v[106:107]
    v_pk_fma_f32 v[252:253], v[252:253], v[104:105], v[106:107]
    v_pk_fma_f32 v[254:255], v[254:255], v[104:105], v[106:107]
    v_pk_mul_f32 v[240:241], v[240:241], v[224:225]
    v_pk_mul_f32 v[242:243], v[242:243], v[226:227]
    v_pk_mul_f32 v[244:245], v[244:245], v[228:229]
    v_pk_mul_f32 v[246:247], v[246:247], v[230:231]
    v_pk_mul_f32 v[248:249], v[248:249], v[232:233]
    v_pk_mul_f32 v[250:251], v[250:251], v[234:235]
    v_pk_mul_f32 v[252:253], v[252:253], v[236:237]
    v_pk_mul_f32 v[254:255], v[254:255], v[238:239]
    v_exp_f32 v240, v240
    v_exp_f32 v241, v241
    v_exp_f32 v242, v242
    v_exp_f32 v243, v243
    v_exp_f32 v244, v244
    v_exp_f32 v245, v245
    v_exp_f32 v246, v246
    v_exp_f32 v247, v247
    v_exp_f32 v248, v248
    v_exp_f32 v249, v249
    v_exp_f32 v250, v250
    v_exp_f32 v251, v251
    v_exp_f32 v252, v252
    v_exp_f32 v253, v253
    v_exp_f32 v254, v254
    v_exp_f32 v255, v255
    v_add_f32 v240, 1.0, v240
    v_add_f32 v241, 1.0, v241
    v_add_f32 v242, 1.0, v242
    v_add_f32 v243, 1.0, v243
    v_add_f32 v244, 1.0, v244
    v_add_f32 v245, 1.0, v245
    v_add_f32 v246, 1.0, v246
    v_add_f32 v247, 1.0, v247
    v_add_f32 v248, 1.0, v248
    v_add_f32 v249, 1.0, v249
    v_add_f32 v250, 1.0, v250
    v_add_f32 v251, 1.0, v251
    v_add_f32 v252, 1.0, v252
    v_add_f32 v253, 1.0, v253
    v_add_f32 v254, 1.0, v254
    v_add_f32 v255, 1.0, v255
    v_rcp_f32 v240, v240
    v_rcp_f32 v241, v241
    v_rcp_f32 v242, v242
    v_rcp_f32 v243, v243
    v_rcp_f32 v244, v244
    v_rcp_f32 v245, v245
    v_rcp_f32 v246, v246
    v_rcp_f32 v247, v247
    v_rcp_f32 v248, v248
    v_rcp_f32 v249, v249
    v_rcp_f32 v250, v250
    v_rcp_f32 v251, v251
    v_rcp_f32 v252, v252
    v_rcp_f32 v253, v253
    v_rcp_f32 v254, v254
    v_rcp_f32 v255, v255
    v_pk_mul_f32 v[224:225], v[224:225], v[240:241]
    v_pk_mul_f32 v[226:227], v[226:227], v[242:243]
    v_pk_mul_f32 v[228:229], v[228:229], v[244:245]
    v_pk_mul_f32 v[230:231], v[230:231], v[246:247]
    v_pk_mul_f32 v[232:233], v[232:233], v[248:249]
    v_pk_mul_f32 v[234:235], v[234:235], v[250:251]
    v_pk_mul_f32 v[236:237], v[236:237], v[252:253]
    v_pk_mul_f32 v[238:239], v[238:239], v[254:255]
    v_cvt_pk_bf16_f32 v240, v224, v225
    v_cvt_pk_bf16_f32 v241, v226, v227
    v_cvt_pk_bf16_f32 v242, v228, v229
    v_cvt_pk_bf16_f32 v243, v230, v231
    v_cvt_pk_bf16_f32 v244, v232, v233
    v_cvt_pk_bf16_f32 v245, v234, v235
    v_cvt_pk_bf16_f32 v246, v236, v237
    v_cvt_pk_bf16_f32 v247, v238, v239
    buffer_store_dwordx4 v[240:243], v10, s[12:15], s76 offen sc1
    buffer_store_dwordx4 v[244:247], v10, s[12:15], s76 offen offset:1024 sc1
    s_waitcnt lgkmcnt(0)
    s_waitcnt vmcnt(0)
    s_barrier
    s_cmp_lg_u32 s44, 0
    s_cbranch_scc1 L_pub_158
    v_mov_b32 v30, s62
    v_mov_b32 v31, 0
    s_mov_b64 exec, 1
    buffer_store_dword v30, v31, s[12:15], s67 offen sc1
    s_mov_b64 exec, -1
L_pub_158:
    s_branch L_b_loop_149
L_role_c_131:
    s_load_dwordx2 s[6:7], s[0:1], 80
    s_load_dwordx2 s[8:9], s[0:1], 88
    s_load_dwordx2 s[10:11], s[0:1], 112
    s_waitcnt lgkmcnt(0)
    s_mov_b32 s24, s6
    s_and_b32 s25, s7, 0xffff
    s_mov_b32 s26, 0x700000
    s_mov_b32 s27, 0x00020000
    s_mov_b32 s28, s8
    s_and_b32 s29, s9, 0xffff
    s_mov_b32 s30, 0x800
    s_mov_b32 s31, 0x00020000
    s_mov_b32 s32, s10
    s_and_b32 s33, s11, 0xffff
    s_mov_b32 s34, 0x400000
    s_mov_b32 s35, 0x00020000
    s_mul_i32 s46, s38, 1835008
    s_lshl_b32 s45, s68, 8
    s_add_u32 s46, s46, s45
    s_waitcnt vmcnt(0)
    s_barrier
    v_lshrrev_b32 v20, 4, v1
    s_lshl_b32 s45, s44, 2
    v_add_u32 v21, s45, v20
    s_mov_b32 s45, 2048
    v_mul_lo_u32 v21, v21, s45
    v_lshlrev_b32 v22, 2, v20
    v_and_b32 v23, 15, v1
    v_xor_b32 v22, v22, v23
    v_lshlrev_b32 v22, 4, v22
    v_add_u32 v21, v21, v22
    v_bfe_u32 v22, v1, 2, 2
    v_lshlrev_b32 v23, 3, v20
    v_add_u32 v23, v23, v22
    v_lshlrev_b32 v23, 8, v23
    v_xor_b32 v22, s44, v22
    v_lshlrev_b32 v22, 6, v22
    v_add_u32 v23, v23, v22
    v_and_b32 v22, 3, v1
    v_lshlrev_b32 v22, 3, v22
    v_add_u32 v23, v23, v22
    v_add_u32 v24, 65536, v23
    v_add_u32 v25, 131072, v23
    s_lshl_b32 s47, s44, 10
    s_add_u32 s45, s46, 0x0
    s_add_u32 m0, s47, 0
    s_nop 0
    buffer_load_dwordx4 v21, s[24:27], s45 offen nt lds
    s_add_u32 s45, s46, 0x8000
    s_add_u32 m0, s47, 4096
    s_nop 0
    buffer_load_dwordx4 v21, s[24:27], s45 offen nt lds
    s_add_u32 s45, s46, 0x10000
    s_add_u32 m0, s47, 8192
    s_nop 0
    buffer_load_dwordx4 v21, s[24:27], s45 offen nt lds
    s_add_u32 s45, s46, 0x18000
    s_add_u32 m0, s47, 12288
    s_nop 0
    buffer_load_dwordx4 v21, s[24:27], s45 offen nt lds
    s_add_u32 s45, s46, 0x20000
    s_add_u32 m0, s47, 16384
    s_nop 0
    buffer_load_dwordx4 v21, s[24:27], s45 offen nt lds
    s_add_u32 s45, s46, 0x28000
    s_add_u32 m0, s47, 20480
    s_nop 0
    buffer_load_dwordx4 v21, s[24:27], s45 offen nt lds
    s_add_u32 s45, s46, 0x30000
    s_add_u32 m0, s47, 24576
    s_nop 0
    buffer_load_dwordx4 v21, s[24:27], s45 offen nt lds
    s_add_u32 s45, s46, 0x38000
    s_add_u32 m0, s47, 28672
    s_nop 0
    buffer_load_dwordx4 v21, s[24:27], s45 offen nt lds
    s_add_u32 s45, s46, 0x40000
    s_add_u32 m0, s47, 32768
    s_nop 0
    buffer_load_dwordx4 v21, s[24:27], s45 offen nt lds
    s_add_u32 s45, s46, 0x48000
    s_add_u32 m0, s47, 36864
    s_nop 0
    buffer_load_dwordx4 v21, s[24:27], s45 offen nt lds
    s_add_u32 s45, s46, 0x50000
    s_add_u32 m0, s47, 40960
    s_nop 0
    buffer_load_dwordx4 v21, s[24:27], s45 offen nt lds
    s_add_u32 s45, s46, 0x58000
    s_add_u32 m0, s47, 45056
    s_nop 0
    buffer_load_dwordx4 v21, s[24:27], s45 offen nt lds
    s_add_u32 s45, s46, 0x60000
    s_add_u32 m0, s47, 49152
    s_nop 0
    buffer_load_dwordx4 v21, s[24:27], s45 offen nt lds
    s_add_u32 s45, s46, 0x68000
    s_add_u32 m0, s47, 53248
    s_nop 0
    buffer_load_dwordx4 v21, s[24:27], s45 offen nt lds
    s_add_u32 s45, s46, 0x70000
    s_add_u32 m0, s47, 57344
    s_nop 0
    buffer_load_dwordx4 v21, s[24:27], s45 offen nt lds
    s_add_u32 s45, s46, 0x78000
    s_add_u32 m0, s47, 61440
    s_nop 0
    buffer_load_dwordx4 v21, s[24:27], s45 offen nt lds
    s_add_u32 s45, s46, 0x80000
    s_add_u32 m0, s47, 65536
    s_nop 0
    buffer_load_dwordx4 v21, s[24:27], s45 offen nt lds
    s_add_u32 s45, s46, 0x88000
    s_add_u32 m0, s47, 69632
    s_nop 0
    buffer_load_dwordx4 v21, s[24:27], s45 offen nt lds
    s_add_u32 s45, s46, 0x90000
    s_add_u32 m0, s47, 73728
    s_nop 0
    buffer_load_dwordx4 v21, s[24:27], s45 offen nt lds
    s_add_u32 s45, s46, 0x98000
    s_add_u32 m0, s47, 77824
    s_nop 0
    buffer_load_dwordx4 v21, s[24:27], s45 offen nt lds
    s_add_u32 s45, s46, 0xa0000
    s_add_u32 m0, s47, 81920
    s_nop 0
    buffer_load_dwordx4 v21, s[24:27], s45 offen nt lds
    s_add_u32 s45, s46, 0xa8000
    s_add_u32 m0, s47, 86016
    s_nop 0
    buffer_load_dwordx4 v21, s[24:27], s45 offen nt lds
    s_add_u32 s45, s46, 0xb0000
    s_add_u32 m0, s47, 90112
    s_nop 0
    buffer_load_dwordx4 v21, s[24:27], s45 offen nt lds
    s_add_u32 s45, s46, 0xb8000
    s_add_u32 m0, s47, 94208
    s_nop 0
    buffer_load_dwordx4 v21, s[24:27], s45 offen nt lds
    s_add_u32 s45, s46, 0xc0000
    s_add_u32 m0, s47, 98304
    s_nop 0
    buffer_load_dwordx4 v21, s[24:27], s45 offen nt lds
    s_add_u32 s45, s46, 0xc8000
    s_add_u32 m0, s47, 102400
    s_nop 0
    buffer_load_dwordx4 v21, s[24:27], s45 offen nt lds
    s_add_u32 s45, s46, 0xd0000
    s_add_u32 m0, s47, 106496
    s_nop 0
    buffer_load_dwordx4 v21, s[24:27], s45 offen nt lds
    s_add_u32 s45, s46, 0xd8000
    s_add_u32 m0, s47, 110592
    s_nop 0
    buffer_load_dwordx4 v21, s[24:27], s45 offen nt lds
    s_add_u32 s45, s46, 0xe0000
    s_add_u32 m0, s47, 114688
    s_nop 0
    buffer_load_dwordx4 v21, s[24:27], s45 offen nt lds
    s_add_u32 s45, s46, 0xe8000
    s_add_u32 m0, s47, 118784
    s_nop 0
    buffer_load_dwordx4 v21, s[24:27], s45 offen nt lds
    s_add_u32 s45, s46, 0xf0000
    s_add_u32 m0, s47, 122880
    s_nop 0
    buffer_load_dwordx4 v21, s[24:27], s45 offen nt lds
    s_add_u32 s45, s46, 0xf8000
    s_add_u32 m0, s47, 126976
    s_nop 0
    buffer_load_dwordx4 v21, s[24:27], s45 offen nt lds
    s_waitcnt vmcnt(28)
    s_barrier
    s_add_u32 s45, s46, 0x100000
    s_add_u32 m0, s47, 131072
    s_nop 0
    buffer_load_dwordx4 v21, s[24:27], s45 offen nt lds
    s_add_u32 s45, s46, 0x108000
    s_add_u32 m0, s47, 135168
    s_nop 0
    buffer_load_dwordx4 v21, s[24:27], s45 offen nt lds
    s_add_u32 s45, s46, 0x110000
    s_add_u32 m0, s47, 139264
    s_nop 0
    buffer_load_dwordx4 v21, s[24:27], s45 offen nt lds
    s_add_u32 s45, s46, 0x118000
    s_add_u32 m0, s47, 143360
    s_nop 0
    buffer_load_dwordx4 v21, s[24:27], s45 offen nt lds
    ds_read_b64_tr_b16 a[0:1], v23 offset:0
    ds_read_b64_tr_b16 a[2:3], v23 offset:1024
    ds_read_b64_tr_b16 a[4:5], v23 offset:32
    ds_read_b64_tr_b16 a[6:7], v23 offset:1056
    ds_read_b64_tr_b16 a[8:9], v23 offset:8192
    ds_read_b64_tr_b16 a[10:11], v23 offset:9216
    ds_read_b64_tr_b16 a[12:13], v23 offset:8224
    ds_read_b64_tr_b16 a[14:15], v23 offset:9248
    s_waitcnt lgkmcnt(0)
    s_waitcnt vmcnt(28)
    s_barrier
    s_add_u32 s45, s46, 0x120000
    s_add_u32 m0, s47, 0
    s_nop 0
    buffer_load_dwordx4 v21, s[24:27], s45 offen nt lds
    s_add_u32 s45, s46, 0x128000
    s_add_u32 m0, s47, 4096
    s_nop 0
    buffer_load_dwordx4 v21, s[24:27], s45 offen nt lds
    s_add_u32 s45, s46, 0x130000
    s_add_u32 m0, s47, 8192
    s_nop 0
    buffer_load_dwordx4 v21, s[24:27], s45 offen nt lds
    s_add_u32 s45, s46, 0x138000
    s_add_u32 m0, s47, 12288
    s_nop 0
    buffer_load_dwordx4 v21, s[24:27], s45 offen nt lds
    ds_read_b64_tr_b16 a[16:17], v23 offset:16384
    ds_read_b64_tr_b16 a[18:19], v23 offset:17408
    ds_read_b64_tr_b16 a[20:21], v23 offset:16416
    ds_read_b64_tr_b16 a[22:23], v23 offset:17440
    ds_read_b64_tr_b16 a[24:25], v23 offset:24576
    ds_read_b64_tr_b16 a[26:27], v23 offset:25600
    ds_read_b64_tr_b16 a[28:29], v23 offset:24608
    ds_read_b64_tr_b16 a[30:31], v23 offset:25632
    s_waitcnt lgkmcnt(0)
    s_waitcnt vmcnt(28)
    s_barrier
    s_add_u32 s45, s46, 0x140000
    s_add_u32 m0, s47, 16384
    s_nop 0
    buffer_load_dwordx4 v21, s[24:27], s45 offen nt lds
    s_add_u32 s45, s46, 0x148000
    s_add_u32 m0, s47, 20480
    s_nop 0
    buffer_load_dwordx4 v21, s[24:27], s45 offen nt lds
    s_add_u32 s45, s46, 0x150000
    s_add_u32 m0, s47, 24576
    s_nop 0
    buffer_load_dwordx4 v21, s[24:27], s45 offen nt lds
    s_add_u32 s45, s46, 0x158000
    s_add_u32 m0, s47, 28672
    s_nop 0
    buffer_load_dwordx4 v21, s[24:27], s45 offen nt lds
    ds_read_b64_tr_b16 a[32:33], v23 offset:32768
    ds_read_b64_tr_b16 a[34:35], v23 offset:33792
    ds_read_b64_tr_b16 a[36:37], v23 offset:32800
    ds_read_b64_tr_b16 a[38:39], v23 offset:33824
    ds_read_b64_tr_b16 a[40:41], v23 offset:40960
    ds_read_b64_tr_b16 a[42:43], v23 offset:41984
    ds_read_b64_tr_b16 a[44:45], v23 offset:40992
    ds_read_b64_tr_b16 a[46:47], v23 offset:42016
    s_waitcnt lgkmcnt(0)
    s_waitcnt vmcnt(28)
    s_barrier
    s_add_u32 s45, s46, 0x160000
    s_add_u32 m0, s47, 32768
    s_nop 0
    buffer_load_dwordx4 v21, s[24:27], s45 offen nt lds
    s_add_u32 s45, s46, 0x168000
    s_add_u32 m0, s47, 36864
    s_nop 0
    buffer_load_dwordx4 v21, s[24:27], s45 offen nt lds
    s_add_u32 s45, s46, 0x170000
    s_add_u32 m0, s47, 40960
    s_nop 0
    buffer_load_dwordx4 v21, s[24:27], s45 offen nt lds
    s_add_u32 s45, s46, 0x178000
    s_add_u32 m0, s47, 45056
    s_nop 0
    buffer_load_dwordx4 v21, s[24:27], s45 offen nt lds
    ds_read_b64_tr_b16 a[48:49], v23 offset:49152
    ds_read_b64_tr_b16 a[50:51], v23 offset:50176
    ds_read_b64_tr_b16 a[52:53], v23 offset:49184
    ds_read_b64_tr_b16 a[54:55], v23 offset:50208
    ds_read_b64_tr_b16 a[56:57], v23 offset:57344
    ds_read_b64_tr_b16 a[58:59], v23 offset:58368
    ds_read_b64_tr_b16 a[60:61], v23 offset:57376
    ds_read_b64_tr_b16 a[62:63], v23 offset:58400
    s_waitcnt lgkmcnt(0)
    s_waitcnt vmcnt(28)
    s_barrier
    s_add_u32 s45, s46, 0x180000
    s_add_u32 m0, s47, 49152
    s_nop 0
    buffer_load_dwordx4 v21, s[24:27], s45 offen nt lds
    s_add_u32 s45, s46, 0x188000
    s_add_u32 m0, s47, 53248
    s_nop 0
    buffer_load_dwordx4 v21, s[24:27], s45 offen nt lds
    s_add_u32 s45, s46, 0x190000
    s_add_u32 m0, s47, 57344
    s_nop 0
    buffer_load_dwordx4 v21, s[24:27], s45 offen nt lds
    s_add_u32 s45, s46, 0x198000
    s_add_u32 m0, s47, 61440
    s_nop 0
    buffer_load_dwordx4 v21, s[24:27], s45 offen nt lds
    ds_read_b64_tr_b16 a[64:65], v24 offset:0
    ds_read_b64_tr_b16 a[66:67], v24 offset:1024
    ds_read_b64_tr_b16 a[68:69], v24 offset:32
    ds_read_b64_tr_b16 a[70:71], v24 offset:1056
    ds_read_b64_tr_b16 a[72:73], v24 offset:8192
    ds_read_b64_tr_b16 a[74:75], v24 offset:9216
    ds_read_b64_tr_b16 a[76:77], v24 offset:8224
    ds_read_b64_tr_b16 a[78:79], v24 offset:9248
    s_waitcnt lgkmcnt(0)
    s_waitcnt vmcnt(28)
    s_barrier
    s_add_u32 s45, s46, 0x1a0000
    s_add_u32 m0, s47, 65536
    s_nop 0
    buffer_load_dwordx4 v21, s[24:27], s45 offen nt lds
    s_add_u32 s45, s46, 0x1a8000
    s_add_u32 m0, s47, 69632
    s_nop 0
    buffer_load_dwordx4 v21, s[24:27], s45 offen nt lds
    s_add_u32 s45, s46, 0x1b0000
    s_add_u32 m0, s47, 73728
    s_nop 0
    buffer_load_dwordx4 v21, s[24:27], s45 offen nt lds
    s_add_u32 s45, s46, 0x1b8000
    s_add_u32 m0, s47, 77824
    s_nop 0
    buffer_load_dwordx4 v21, s[24:27], s45 offen nt lds
    ds_read_b64_tr_b16 a[80:81], v24 offset:16384
    ds_read_b64_tr_b16 a[82:83], v24 offset:17408
    ds_read_b64_tr_b16 a[84:85], v24 offset:16416
    ds_read_b64_tr_b16 a[86:87], v24 offset:17440
    ds_read_b64_tr_b16 a[88:89], v24 offset:24576
    ds_read_b64_tr_b16 a[90:91], v24 offset:25600
    ds_read_b64_tr_b16 a[92:93], v24 offset:24608
    ds_read_b64_tr_b16 a[94:95], v24 offset:25632
    s_waitcnt lgkmcnt(0)
    s_waitcnt vmcnt(28)
    s_barrier
    ds_read_b64_tr_b16 a[96:97], v24 offset:32768
    ds_read_b64_tr_b16 a[98:99], v24 offset:33792
    ds_read_b64_tr_b16 a[100:101], v24 offset:32800
    ds_read_b64_tr_b16 a[102:103], v24 offset:33824
    ds_read_b64_tr_b16 a[104:105], v24 offset:40960
    ds_read_b64_tr_b16 a[106:107], v24 offset:41984
    ds_read_b64_tr_b16 a[108:109], v24 offset:40992
    ds_read_b64_tr_b16 a[110:111], v24 offset:42016
    s_waitcnt lgkmcnt(0)
    s_waitcnt vmcnt(24)
    s_barrier
    ds_read_b64_tr_b16 a[112:113], v24 offset:49152
    ds_read_b64_tr_b16 a[114:115], v24 offset:50176
    ds_read_b64_tr_b16 a[116:117], v24 offset:49184
    ds_read_b64_tr_b16 a[118:119], v24 offset:50208
    ds_read_b64_tr_b16 a[120:121], v24 offset:57344
    ds_read_b64_tr_b16 a[122:123], v24 offset:58368
    ds_read_b64_tr_b16 a[124:125], v24 offset:57376
    ds_read_b64_tr_b16 a[126:127], v24 offset:58400
    s_waitcnt lgkmcnt(0)
    s_waitcnt vmcnt(20)
    s_barrier
    ds_read_b64_tr_b16 a[128:129], v25 offset:0
    ds_read_b64_tr_b16 a[130:131], v25 offset:1024
    ds_read_b64_tr_b16 a[132:133], v25 offset:32
    ds_read_b64_tr_b16 a[134:135], v25 offset:1056
    ds_read_b64_tr_b16 a[136:137], v25 offset:8192
    ds_read_b64_tr_b16 a[138:139], v25 offset:9216
    ds_read_b64_tr_b16 a[140:141], v25 offset:8224
    ds_read_b64_tr_b16 a[142:143], v25 offset:9248
    s_waitcnt lgkmcnt(0)
    s_waitcnt vmcnt(16)
    s_barrier
    ds_read_b64_tr_b16 a[144:145], v23 offset:0
    ds_read_b64_tr_b16 a[146:147], v23 offset:1024
    ds_read_b64_tr_b16 a[148:149], v23 offset:32
    ds_read_b64_tr_b16 a[150:151], v23 offset:1056
    ds_read_b64_tr_b16 a[152:153], v23 offset:8192
    ds_read_b64_tr_b16 a[154:155], v23 offset:9216
    ds_read_b64_tr_b16 a[156:157], v23 offset:8224
    ds_read_b64_tr_b16 a[158:159], v23 offset:9248
    s_waitcnt lgkmcnt(0)
    s_waitcnt vmcnt(12)
    s_barrier
    ds_read_b64_tr_b16 a[160:161], v23 offset:16384
    ds_read_b64_tr_b16 a[162:163], v23 offset:17408
    ds_read_b64_tr_b16 a[164:165], v23 offset:16416
    ds_read_b64_tr_b16 a[166:167], v23 offset:17440
    ds_read_b64_tr_b16 a[168:169], v23 offset:24576
    ds_read_b64_tr_b16 a[170:171], v23 offset:25600
    ds_read_b64_tr_b16 a[172:173], v23 offset:24608
    ds_read_b64_tr_b16 a[174:175], v23 offset:25632
    s_waitcnt lgkmcnt(0)
    s_waitcnt vmcnt(8)
    s_barrier
    ds_read_b64_tr_b16 a[176:177], v23 offset:32768
    ds_read_b64_tr_b16 a[178:179], v23 offset:33792
    ds_read_b64_tr_b16 a[180:181], v23 offset:32800
    ds_read_b64_tr_b16 a[182:183], v23 offset:33824
    ds_read_b64_tr_b16 a[184:185], v23 offset:40960
    ds_read_b64_tr_b16 a[186:187], v23 offset:41984
    ds_read_b64_tr_b16 a[188:189], v23 offset:40992
    ds_read_b64_tr_b16 a[190:191], v23 offset:42016
    s_waitcnt lgkmcnt(0)
    s_waitcnt vmcnt(4)
    s_barrier
    ds_read_b64_tr_b16 a[192:193], v23 offset:49152
    ds_read_b64_tr_b16 a[194:195], v23 offset:50176
    ds_read_b64_tr_b16 a[196:197], v23 offset:49184
    ds_read_b64_tr_b16 a[198:199], v23 offset:50208
    ds_read_b64_tr_b16 a[200:201], v23 offset:57344
    ds_read_b64_tr_b16 a[202:203], v23 offset:58368
    ds_read_b64_tr_b16 a[204:205], v23 offset:57376
    ds_read_b64_tr_b16 a[206:207], v23 offset:58400
    s_waitcnt lgkmcnt(0)
    s_waitcnt vmcnt(0)
    s_barrier
    ds_read_b64_tr_b16 a[208:209], v24 offset:0
    ds_read_b64_tr_b16 a[210:211], v24 offset:1024
    ds_read_b64_tr_b16 a[212:213], v24 offset:32
    ds_read_b64_tr_b16 a[214:215], v24 offset:1056
    ds_read_b64_tr_b16 a[216:217], v24 offset:8192
    ds_read_b64_tr_b16 a[218:219], v24 offset:9216
    ds_read_b64_tr_b16 a[220:221], v24 offset:8224
    ds_read_b64_tr_b16 a[222:223], v24 offset:9248
    s_waitcnt lgkmcnt(0)
    s_barrier
    buffer_load_dwordx4 v[80:83], v10, s[28:31], 0 offen
    buffer_load_dwordx4 v[84:87], v10, s[28:31], 0 offen offset:1024
    s_waitcnt vmcnt(0)
    v_lshlrev_b32 v96, 16, v80
    v_and_b32 v97, 0xffff0000, v80
    v_lshlrev_b32 v98, 16, v81
    v_and_b32 v99, 0xffff0000, v81
    v_lshlrev_b32 v100, 16, v82
    v_and_b32 v101, 0xffff0000, v82
    v_lshlrev_b32 v102, 16, v83
    v_and_b32 v103, 0xffff0000, v83
    v_lshlrev_b32 v104, 16, v84
    v_and_b32 v105, 0xffff0000, v84
    v_lshlrev_b32 v106, 16, v85
    v_and_b32 v107, 0xffff0000, v85
    v_lshlrev_b32 v108, 16, v86
    v_and_b32 v109, 0xffff0000, v86
    v_lshlrev_b32 v110, 16, v87
    v_and_b32 v111, 0xffff0000, v87
    s_cmp_lg_u32 s44, 0
    s_cbranch_scc1 L_pd_159
    v_mov_b32 v29, 132
    s_mov_b32 s46, 96
    s_mov_b64 exec, 1
    s_mov_b32 s70, 0
L_wp_160:
    buffer_load_dword v31, v29, s[16:19], 0 offen sc1
    s_add_u32 s70, s70, 1
    s_cmp_ge_u32 s70, 0x200000
    s_cbranch_scc1 L_w_done_109
    s_waitcnt vmcnt(0)
    v_cmp_gt_u32 vcc, s46, v31
    s_nop 1
    s_cbranch_vccz L_wp_160_ok
    s_sleep 3
    s_branch L_wp_160
L_wp_160_ok:
    s_mov_b64 exec, -1
L_pd_159:
    s_barrier
    v_lshlrev_b32 v29, 5, v1
    s_mov_b32 s45, 20480
    buffer_load_dwordx4 v[112:115], v29, s[12:15], s45 offen offset:0 sc1
    buffer_load_dwordx4 v[116:119], v29, s[12:15], s45 offen offset:16 sc1
    buffer_load_dwordx4 v[120:123], v29, s[12:15], s45 offen offset:2048 sc1
    buffer_load_dwordx4 v[124:127], v29, s[12:15], s45 offen offset:2064 sc1
    s_mov_b32 s45, 45056
    buffer_load_dwordx4 v[32:35], v29, s[12:15], s45 offen offset:0 sc1
    buffer_load_dwordx4 v[36:39], v29, s[12:15], s45 offen offset:16 sc1
    buffer_load_dwordx4 v[40:43], v29, s[12:15], s45 offen offset:2048 sc1
    buffer_load_dwordx4 v[44:47], v29, s[12:15], s45 offen offset:2064 sc1
    s_waitcnt vmcnt(0)
    v_add_f32 v112, v112, v32
    v_cvt_pk_bf16_f32 v112, v112, v112
    v_lshlrev_b32 v112, 16, v112
    v_add_f32 v113, v113, v33
    v_cvt_pk_bf16_f32 v113, v113, v113
    v_lshlrev_b32 v113, 16, v113
    v_add_f32 v114, v114, v34
    v_cvt_pk_bf16_f32 v114, v114, v114
    v_lshlrev_b32 v114, 16, v114
    v_add_f32 v115, v115, v35
    v_cvt_pk_bf16_f32 v115, v115, v115
    v_lshlrev_b32 v115, 16, v115
    v_add_f32 v116, v116, v36
    v_cvt_pk_bf16_f32 v116, v116, v116
    v_lshlrev_b32 v116, 16, v116
    v_add_f32 v117, v117, v37
    v_cvt_pk_bf16_f32 v117, v117, v117
    v_lshlrev_b32 v117, 16, v117
    v_add_f32 v118, v118, v38
    v_cvt_pk_bf16_f32 v118, v118, v118
    v_lshlrev_b32 v118, 16, v118
    v_add_f32 v119, v119, v39
    v_cvt_pk_bf16_f32 v119, v119, v119
    v_lshlrev_b32 v119, 16, v119
    v_add_f32 v120, v120, v40
    v_cvt_pk_bf16_f32 v120, v120, v120
    v_lshlrev_b32 v120, 16, v120
    v_add_f32 v121, v121, v41
    v_cvt_pk_bf16_f32 v121, v121, v121
    v_lshlrev_b32 v121, 16, v121
    v_add_f32 v122, v122, v42
    v_cvt_pk_bf16_f32 v122, v122, v122
    v_lshlrev_b32 v122, 16, v122
    v_add_f32 v123, v123, v43
    v_cvt_pk_bf16_f32 v123, v123, v123
    v_lshlrev_b32 v123, 16, v123
    v_add_f32 v124, v124, v44
    v_cvt_pk_bf16_f32 v124, v124, v124
    v_lshlrev_b32 v124, 16, v124
    v_add_f32 v125, v125, v45
    v_cvt_pk_bf16_f32 v125, v125, v125
    v_lshlrev_b32 v125, 16, v125
    v_add_f32 v126, v126, v46
    v_cvt_pk_bf16_f32 v126, v126, v126
    v_lshlrev_b32 v126, 16, v126
    v_add_f32 v127, v127, v47
    v_cvt_pk_bf16_f32 v127, v127, v127
    v_lshlrev_b32 v127, 16, v127
    s_mul_i32 s52, s38, 57344
    s_add_u32 s52, s52, 0x6000000
    s_lshl_b32 s56, s38, 23
    s_lshl_b32 s45, s68, 9
    s_add_u32 s56, s56, s45
    s_add_u32 s56, s56, 0xc000000
L_c_loop_161:
    s_cmp_eq_u64 s[36:37], 0
    s_cbranch_scc1 L_w_done_109
    s_ff1_i32_b64 s50, s[36:37]
    s_bitset0_b64 s[36:37], s50
    s_lshr_b64 s[74:75], s[72:73], s50
    s_ff1_i32_b64 s51, s[74:75]
    s_add_u32 s51, s51, 1
    s_add_u32 s62, s50, s51
    s_mul_i32 s45, s38, 896
    s_add_u32 s45, s45, s64
    s_add_u32 s45, s45, 12288
    s_cmp_lg_u32 s44, 0
    s_cbranch_scc1 L_pw_163
    s_mov_b64 exec, 127
    s_mov_b32 s70, 0
L_wp_164:
    buffer_load_dword v31, v5, s[12:15], s45 offen sc1
    s_add_u32 s70, s70, 1
    s_cmp_ge_u32 s70, 0x200000
    s_cbranch_scc1 L_w_done_109
    s_waitcnt vmcnt(0)
    v_cmp_gt_u32 vcc, s62, v31
    s_nop 1
    s_cbranch_vccz L_wp_164_ok
    s_sleep 2
    s_branch L_wp_164
L_wp_164_ok:
    s_mov_b64 exec, -1
L_pw_163:
    s_barrier
    s_mul_i32 s53, s50, 229376
    s_add_u32 s53, s53, s52
    s_lshl_b32 s54, s44, 13
    s_add_u32 s53, s53, s54
    s_mul_i32 s57, s50, 131072
    s_add_u32 s57, s57, s56
    s_lshl_b32 s45, s44, 7
    s_add_u32 s57, s57, s45
    s_add_u32 s55, s54, 65536
    s_mov_b32 s58, 0
    v_mov_b32 v13, v10
    v_add_u32 v14, 65536, v13
    v_xor_b32 v15, 64, v13
    v_xor_b32 v16, 64, v14
    s_mov_b32 s76, 0x20000000
    s_add_u32 s48, s53, 0
    s_add_u32 s49, s48, 4096
    s_add_u32 m0, s54, 0
    s_nop 0
    buffer_load_dwordx4 v10, s[12:15], s48 offen offset:0 sc1 lds
    buffer_load_dwordx4 v10, s[12:15], s48 offen offset:1024 sc1 lds
    buffer_load_dwordx4 v10, s[12:15], s48 offen offset:2048 sc1 lds
    buffer_load_dwordx4 v10, s[12:15], s48 offen offset:3072 sc1 lds
    s_add_u32 m0, s54, 4096
    s_nop 0
    buffer_load_dwordx4 v10, s[12:15], s49 offen offset:0 sc1 lds
    buffer_load_dwordx4 v10, s[12:15], s49 offen offset:1024 sc1 lds
    buffer_load_dwordx4 v10, s[12:15], s49 offen offset:2048 sc1 lds
    buffer_load_dwordx4 v10, s[12:15], s49 offen offset:3072 sc1 lds
    s_add_u32 s48, s53, 32768
    s_cmp_lt_u32 s44, 3
    s_cselect_b32 s48, s48, 0x20000000
    s_add_u32 s49, s48, 4096
    s_add_u32 s46, s54, 32768
    s_add_u32 m0, s46, 0
    s_nop 0
    buffer_load_dwordx4 v10, s[12:15], s48 offen offset:0 sc1 lds
    buffer_load_dwordx4 v10, s[12:15], s48 offen offset:1024 sc1 lds
    buffer_load_dwordx4 v10, s[12:15], s48 offen offset:2048 sc1 lds
    buffer_load_dwordx4 v10, s[12:15], s48 offen offset:3072 sc1 lds
    s_add_u32 m0, s46, 4096
    s_nop 0
    buffer_load_dwordx4 v10, s[12:15], s49 offen offset:0 sc1 lds
    buffer_load_dwordx4 v10, s[12:15], s49 offen offset:1024 sc1 lds
    buffer_load_dwordx4 v10, s[12:15], s49 offen offset:2048 sc1 lds
    buffer_load_dwordx4 v10, s[12:15], s49 offen offset:3072 sc1 lds
    s_add_u32 s48, s53, 229376
    s_cmp_gt_u32 s51, 1
    s_cselect_b32 s48, s48, 0x20000000
    s_add_u32 s49, s48, 4096
    s_add_u32 m0, s55, 0
    s_nop 0
    buffer_load_dwordx4 v10, s[12:15], s48 offen offset:0 sc1 lds
    buffer_load_dwordx4 v10, s[12:15], s48 offen offset:1024 sc1 lds
    buffer_load_dwordx4 v10, s[12:15], s48 offen offset:2048 sc1 lds
    buffer_load_dwordx4 v10, s[12:15], s48 offen offset:3072 sc1 lds
    s_add_u32 m0, s55, 4096
    s_nop 0
    buffer_load_dwordx4 v10, s[12:15], s49 offen offset:0 sc1 lds
    buffer_load_dwordx4 v10, s[12:15], s49 offen offset:1024 sc1 lds
    buffer_load_dwordx4 v10, s[12:15], s49 offen offset:2048 sc1 lds
    buffer_load_dwordx4 v10, s[12:15], s49 offen offset:3072 sc1 lds
    s_waitcnt vmcnt(16)
    s_barrier
    ds_read_b128 v[32:35], v13 offset:0
    ds_read_b128 v[36:39], v13 offset:1024
    ds_read_b128 v[40:43], v13 offset:2048
    ds_read_b128 v[44:47], v13 offset:3072
L_e_loop_165:
    s_add_u32 s48, s53, 262144
    s_add_u32 s46, s58, 1
    s_cmp_lt_u32 s46, s51
    s_cselect_b32 s48, s48, 0x20000000
    s_cmp_lt_u32 s44, 3
    s_cselect_b32 s48, s48, 0x20000000
    s_add_u32 s49, s48, 4096
    s_add_u32 s59, s55, 32768
    s_waitcnt lgkmcnt(2)
    v_mfma_f32_16x16x32_bf16 v[80:83], a[0:3], v[32:35], 0
    ds_read_b128 v[48:51], v13 offset:4096
    ds_read_b128 v[52:55], v13 offset:5120
    v_mfma_f32_16x16x32_bf16 v[84:87], a[4:7], v[32:35], 0
    ds_read_b128 v[56:59], v13 offset:6144
    ds_read_b128 v[60:63], v13 offset:7168
    v_mfma_f32_16x16x32_bf16 v[88:91], a[0:3], v[36:39], 0
    s_add_u32 m0, s59, 0
    s_nop 0
    buffer_load_dwordx4 v10, s[12:15], s48 offen offset:0 sc1 lds
    v_mfma_f32_16x16x32_bf16 v[92:95], a[4:7], v[36:39], 0
    s_waitcnt lgkmcnt(4)
    v_mfma_f32_16x16x32_bf16 v[80:83], a[8:11], v[40:43], v[80:83]
    ds_read_b128 v[32:35], v13 offset:8192
    ds_read_b128 v[36:39], v13 offset:9216
    v_mfma_f32_16x16x32_bf16 v[84:87], a[12:15], v[40:43], v[84:87]
    v_mfma_f32_16x16x32_bf16 v[88:91], a[8:11], v[44:47], v[88:91]
    buffer_load_dwordx4 v10, s[12:15], s48 offen offset:1024 sc1 lds
    v_mfma_f32_16x16x32_bf16 v[92:95], a[12:15], v[44:47], v[92:95]
    s_waitcnt lgkmcnt(4)
    v_mfma_f32_16x16x32_bf16 v[80:83], a[16:19], v[48:51], v[80:83]
    ds_read_b128 v[40:43], v13 offset:10240
    ds_read_b128 v[44:47], v13 offset:11264
    v_mfma_f32_16x16x32_bf16 v[84:87], a[20:23], v[48:51], v[84:87]
    v_mfma_f32_16x16x32_bf16 v[88:91], a[16:19], v[52:55], v[88:91]
    buffer_load_dwordx4 v10, s[12:15], s48 offen offset:2048 sc1 lds
    v_mfma_f32_16x16x32_bf16 v[92:95], a[20:23], v[52:55], v[92:95]
    s_waitcnt lgkmcnt(4)
    v_mfma_f32_16x16x32_bf16 v[80:83], a[24:27], v[56:59], v[80:83]
    ds_read_b128 v[48:51], v13 offset:12288
    ds_read_b128 v[52:55], v13 offset:13312
    v_mfma_f32_16x16x32_bf16 v[84:87], a[28:31], v[56:59], v[84:87]
    v_mfma_f32_16x16x32_bf16 v[88:91], a[24:27], v[60:63], v[88:91]
    buffer_load_dwordx4 v10, s[12:15], s48 offen offset:3072 sc1 lds
    v_mfma_f32_16x16x32_bf16 v[92:95], a[28:31], v[60:63], v[92:95]
    s_waitcnt lgkmcnt(4)
    v_mfma_f32_16x16x32_bf16 v[80:83], a[32:35], v[32:35], v[80:83]
    ds_read_b128 v[56:59], v13 offset:14336
    ds_read_b128 v[60:63], v13 offset:15360
    v_mfma_f32_16x16x32_bf16 v[84:87], a[36:39], v[32:35], v[84:87]
    v_mfma_f32_16x16x32_bf16 v[88:91], a[32:35], v[36:39], v[88:91]
    s_add_u32 m0, s59, 4096
    s_nop 0
    buffer_load_dwordx4 v10, s[12:15], s49 offen offset:0 sc1 lds
    v_mfma_f32_16x16x32_bf16 v[92:95], a[36:39], v[36:39], v[92:95]
    s_waitcnt lgkmcnt(4)
    v_mfma_f32_16x16x32_bf16 v[80:83], a[40:43], v[40:43], v[80:83]
    ds_read_b128 v[32:35], v13 offset:16384
    ds_read_b128 v[36:39], v13 offset:17408
    v_mfma_f32_16x16x32_bf16 v[84:87], a[44:47], v[40:43], v[84:87]
    v_mfma_f32_16x16x32_bf16 v[88:91], a[40:43], v[44:47], v[88:91]
    buffer_load_dwordx4 v10, s[12:15], s49 offen offset:1024 sc1 lds
    v_mfma_f32_16x16x32_bf16 v[92:95], a[44:47], v[44:47], v[92:95]
    s_waitcnt lgkmcnt(4)
    v_mfma_f32_16x16x32_bf16 v[80:83], a[48:51], v[48:51], v[80:83]
    ds_read_b128 v[40:43], v13 offset:18432
    ds_read_b128 v[44:47], v13 offset:19456
    v_mfma_f32_16x16x32_bf16 v[84:87], a[52:55], v[48:51], v[84:87]
    v_mfma_f32_16x16x32_bf16 v[88:91], a[48:51], v[52:55], v[88:91]
    buffer_load_dwordx4 v10, s[12:15], s49 offen offset:2048 sc1 lds
    v_mfma_f32_16x16x32_bf16 v[92:95], a[52:55], v[52:55], v[92:95]
    s_waitcnt lgkmcnt(4)
    v_mfma_f32_16x16x32_bf16 v[80:83], a[56:59], v[56:59], v[80:83]
    ds_read_b128 v[48:51], v13 offset:20480
    ds_read_b128 v[52:55], v13 offset:21504
    v_mfma_f32_16x16x32_bf16 v[84:87], a[60:63], v[56:59], v[84:87]
    v_mfma_f32_16x16x32_bf16 v[88:91], a[56:59], v[60:63], v[88:91]
    buffer_load_dwordx4 v10, s[12:15], s49 offen offset:3072 sc1 lds
    v_mfma_f32_16x16x32_bf16 v[92:95], a[60:63], v[60:63], v[92:95]
    s_waitcnt lgkmcnt(4)
    v_mfma_f32_16x16x32_bf16 v[80:83], a[64:67], v[32:35], v[80:83]
    ds_read_b128 v[56:59], v13 offset:22528
    ds_read_b128 v[60:63], v13 offset:23552
    v_mfma_f32_16x16x32_bf16 v[84:87], a[68:71], v[32:35], v[84:87]
    v_mfma_f32_16x16x32_bf16 v[88:91], a[64:67], v[36:39], v[88:91]
    v_mfma_f32_16x16x32_bf16 v[92:95], a[68:71], v[36:39], v[92:95]
    s_waitcnt lgkmcnt(4)
    v_mfma_f32_16x16x32_bf16 v[80:83], a[72:75], v[40:43], v[80:83]
    ds_read_b128 v[32:35], v13 offset:24576
    ds_read_b128 v[36:39], v13 offset:25600
    v_mfma_f32_16x16x32_bf16 v[84:87], a[76:79], v[40:43], v[84:87]
    v_mfma_f32_16x16x32_bf16 v[88:91], a[72:75], v[44:47], v[88:91]
    v_mfma_f32_16x16x32_bf16 v[92:95], a[76:79], v[44:47], v[92:95]
    s_waitcnt lgkmcnt(4)
    v_mfma_f32_16x16x32_bf16 v[80:83], a[80:83], v[48:51], v[80:83]
    ds_read_b128 v[40:43], v13 offset:26624
    ds_read_b128 v[44:47], v13 offset:27648
    v_mfma_f32_16x16x32_bf16 v[84:87], a[84:87], v[48:51], v[84:87]
    v_mfma_f32_16x16x32_bf16 v[88:91], a[80:83], v[52:55], v[88:91]
    v_mfma_f32_16x16x32_bf16 v[92:95], a[84:87], v[52:55], v[92:95]
    s_waitcnt lgkmcnt(4)
    v_mfma_f32_16x16x32_bf16 v[80:83], a[88:91], v[56:59], v[80:83]
    ds_read_b128 v[48:51], v13 offset:28672
    ds_read_b128 v[52:55], v13 offset:29696
    v_mfma_f32_16x16x32_bf16 v[84:87], a[92:95], v[56:59], v[84:87]
    v_mfma_f32_16x16x32_bf16 v[88:91], a[88:91], v[60:63], v[88:91]
    v_mfma_f32_16x16x32_bf16 v[92:95], a[92:95], v[60:63], v[92:95]
    s_waitcnt lgkmcnt(4)
    v_mfma_f32_16x16x32_bf16 v[80:83], a[96:99], v[32:35], v[80:83]
    ds_read_b128 v[56:59], v13 offset:30720
    ds_read_b128 v[60:63], v13 offset:31744
    v_mfma_f32_16x16x32_bf16 v[84:87], a[100:103], v[32:35], v[84:87]
    v_mfma_f32_16x16x32_bf16 v[88:91], a[96:99], v[36:39], v[88:91]
    v_mfma_f32_16x16x32_bf16 v[92:95], a[100:103], v[36:39], v[92:95]
    s_waitcnt lgkmcnt(4)
    v_mfma_f32_16x16x32_bf16 v[80:83], a[104:107], v[40:43], v[80:83]
    ds_read_b128 v[216:219], v8 offset:0
    ds_read_b128 v[220:223], v8 offset:1152
    v_mfma_f32_16x16x32_bf16 v[84:87], a[108:111], v[40:43], v[84:87]
    ds_read_b128 v[224:227], v8 offset:2304
    ds_read_b128 v[228:231], v8 offset:3456
    v_mfma_f32_16x16x32_bf16 v[88:91], a[104:107], v[44:47], v[88:91]
    v_mfma_f32_16x16x32_bf16 v[92:95], a[108:111], v[44:47], v[92:95]
    s_waitcnt vmcnt(16) lgkmcnt(0)
    s_barrier
    v_mfma_f32_16x16x32_bf16 v[80:83], a[112:115], v[48:51], v[80:83]
    ds_read_b128 v[32:35], v13 offset:32768
    ds_read_b128 v[36:39], v13 offset:33792
    v_mfma_f32_16x16x32_bf16 v[84:87], a[116:119], v[48:51], v[84:87]
    buffer_store_dwordx4 v[216:219], v11, s[12:15], s76 offen sc1
    v_mfma_f32_16x16x32_bf16 v[88:91], a[112:115], v[52:55], v[88:91]
    s_add_u32 s76, s76, 32768
    v_mfma_f32_16x16x32_bf16 v[92:95], a[116:119], v[52:55], v[92:95]
    buffer_store_dwordx4 v[220:223], v11, s[12:15], s76 offen sc1
    v_mfma_f32_16x16x32_bf16 v[80:83], a[120:123], v[56:59], v[80:83]
    ds_read_b128 v[40:43], v13 offset:34816
    ds_read_b128 v[44:47], v13 offset:35840
    v_mfma_f32_16x16x32_bf16 v[84:87], a[124:127], v[56:59], v[84:87]
    s_add_u32 s76, s76, 32768
    v_mfma_f32_16x16x32_bf16 v[88:91], a[120:123], v[60:63], v[88:91]
    buffer_store_dwordx4 v[224:227], v11, s[12:15], s76 offen sc1
    v_mfma_f32_16x16x32_bf16 v[92:95], a[124:127], v[60:63], v[92:95]
    s_add_u32 s76, s76, 32768
    s_add_u32 s48, s53, 458752
    s_add_u32 s46, s58, 2
    s_cmp_lt_u32 s46, s51
    s_cselect_b32 s48, s48, 0x20000000
    s_add_u32 s49, s48, 4096
    s_mov_b32 s59, s54
    s_waitcnt lgkmcnt(2)
    v_mfma_f32_16x16x32_bf16 v[80:83], a[128:131], v[32:35], v[80:83]
    ds_read_b128 v[48:51], v13 offset:36864
    ds_read_b128 v[52:55], v13 offset:37888
    v_mfma_f32_16x16x32_bf16 v[84:87], a[132:135], v[32:35], v[84:87]
    ds_read_b128 v[56:59], v13 offset:38912
    ds_read_b128 v[60:63], v13 offset:39936
    v_mfma_f32_16x16x32_bf16 v[88:91], a[128:131], v[36:39], v[88:91]
    s_add_u32 m0, s59, 0
    s_nop 0
    buffer_load_dwordx4 v10, s[12:15], s48 offen offset:0 sc1 lds
    v_mfma_f32_16x16x32_bf16 v[92:95], a[132:135], v[36:39], v[92:95]
    buffer_store_dwordx4 v[228:231], v11, s[12:15], s76 offen sc1
    s_waitcnt lgkmcnt(4)
    v_mfma_f32_16x16x32_bf16 v[80:83], a[136:139], v[40:43], v[80:83]
    ds_read_b128 v[32:35], v13 offset:40960
    ds_read_b128 v[36:39], v13 offset:41984
    v_mfma_f32_16x16x32_bf16 v[84:87], a[140:143], v[40:43], v[84:87]
    v_mfma_f32_16x16x32_bf16 v[88:91], a[136:139], v[44:47], v[88:91]
    buffer_load_dwordx4 v10, s[12:15], s48 offen offset:1024 sc1 lds
    v_mfma_f32_16x16x32_bf16 v[92:95], a[140:143], v[44:47], v[92:95]
    s_waitcnt lgkmcnt(4)
    v_mfma_f32_16x16x32_bf16 v[80:83], a[144:147], v[48:51], v[80:83]
    ds_read_b128 v[40:43], v13 offset:43008
    ds_read_b128 v[44:47], v13 offset:44032
    v_mfma_f32_16x16x32_bf16 v[84:87], a[148:151], v[48:51], v[84:87]
    v_mfma_f32_16x16x32_bf16 v[88:91], a[144:147], v[52:55], v[88:91]
    buffer_load_dwordx4 v10, s[12:15], s48 offen offset:2048 sc1 lds
    v_mfma_f32_16x16x32_bf16 v[92:95], a[148:151], v[52:55], v[92:95]
    s_waitcnt lgkmcnt(4)
    v_mfma_f32_16x16x32_bf16 v[80:83], a[152:155], v[56:59], v[80:83]
    ds_read_b128 v[48:51], v13 offset:45056
    ds_read_b128 v[52:55], v13 offset:46080
    v_mfma_f32_16x16x32_bf16 v[84:87], a[156:159], v[56:59], v[84:87]
    v_mfma_f32_16x16x32_bf16 v[88:91], a[152:155], v[60:63], v[88:91]
    buffer_load_dwordx4 v10, s[12:15], s48 offen offset:3072 sc1 lds
    v_mfma_f32_16x16x32_bf16 v[92:95], a[156:159], v[60:63], v[92:95]
    s_waitcnt lgkmcnt(4)
    v_mfma_f32_16x16x32_bf16 v[80:83], a[160:163], v[32:35], v[80:83]
    ds_read_b128 v[56:59], v13 offset:47104
    ds_read_b128 v[60:63], v13 offset:48128
    v_mfma_f32_16x16x32_bf16 v[84:87], a[164:167], v[32:35], v[84:87]
    v_mfma_f32_16x16x32_bf16 v[88:91], a[160:163], v[36:39], v[88:91]
    s_add_u32 m0, s59, 4096
    s_nop 0
    buffer_load_dwordx4 v10, s[12:15], s49 offen offset:0 sc1 lds
    v_mfma_f32_16x16x32_bf16 v[92:95], a[164:167], v[36:39], v[92:95]
    s_waitcnt lgkmcnt(4)
    v_mfma_f32_16x16x32_bf16 v[80:83], a[168:171], v[40:43], v[80:83]
    ds_read_b128 v[32:35], v13 offset:49152
    ds_read_b128 v[36:39], v13 offset:50176
    v_mfma_f32_16x16x32_bf16 v[84:87], a[172:175], v[40:43], v[84:87]
    v_mfma_f32_16x16x32_bf16 v[88:91], a[168:171], v[44:47], v[88:91]
    buffer_load_dwordx4 v10, s[12:15], s49 offen offset:1024 sc1 lds
    v_mfma_f32_16x16x32_bf16 v[92:95], a[172:175], v[44:47], v[92:95]
    s_waitcnt lgkmcnt(4)
    v_mfma_f32_16x16x32_bf16 v[80:83], a[176:179], v[48:51], v[80:83]
    ds_read_b128 v[40:43], v13 offset:51200
    ds_read_b128 v[44:47], v13 offset:52224
    v_mfma_f32_16x16x32_bf16 v[84:87], a[180:183], v[48:51], v[84:87]
    v_mfma_f32_16x16x32_bf16 v[88:91], a[176:179], v[52:55], v[88:91]
    buffer_load_dwordx4 v10, s[12:15], s49 offen offset:2048 sc1 lds
    v_mfma_f32_16x16x32_bf16 v[92:95], a[180:183], v[52:55], v[92:95]
    s_waitcnt lgkmcnt(4)
    v_mfma_f32_16x16x32_bf16 v[80:83], a[184:187], v[56:59], v[80:83]
    ds_read_b128 v[48:51], v13 offset:53248
    ds_read_b128 v[52:55], v13 offset:54272
    v_mfma_f32_16x16x32_bf16 v[84:87], a[188:191], v[56:59], v[84:87]
    v_mfma_f32_16x16x32_bf16 v[88:91], a[184:187], v[60:63], v[88:91]
    buffer_load_dwordx4 v10, s[12:15], s49 offen offset:3072 sc1 lds
    v_mfma_f32_16x16x32_bf16 v[92:95], a[188:191], v[60:63], v[92:95]
    s_waitcnt lgkmcnt(4)
    v_mfma_f32_16x16x32_bf16 v[80:83], a[192:195], v[32:35], v[80:83]
    ds_read_b128 v[56:59], v13 offset:55296
    ds_read_b128 v[60:63], v13 offset:56320
    v_mfma_f32_16x16x32_bf16 v[84:87], a[196:199], v[32:35], v[84:87]
    v_mfma_f32_16x16x32_bf16 v[88:91], a[192:195], v[36:39], v[88:91]
    v_mfma_f32_16x16x32_bf16 v[92:95], a[196:199], v[36:39], v[92:95]
    s_waitcnt lgkmcnt(4)
    v_mfma_f32_16x16x32_bf16 v[80:83], a[200:203], v[40:43], v[80:83]
    v_mfma_f32_16x16x32_bf16 v[84:87], a[204:207], v[40:43], v[84:87]
    v_mfma_f32_16x16x32_bf16 v[88:91], a[200:203], v[44:47], v[88:91]
    v_mfma_f32_16x16x32_bf16 v[92:95], a[204:207], v[44:47], v[92:95]
    s_waitcnt vmcnt(16) lgkmcnt(0)
    s_barrier
    v_mfma_f32_16x16x32_bf16 v[80:83], a[208:211], v[48:51], v[80:83]
    ds_read_b128 v[32:35], v14 offset:0
    ds_read_b128 v[36:39], v14 offset:1024
    v_mfma_f32_16x16x32_bf16 v[84:87], a[212:215], v[48:51], v[84:87]
    v_mfma_f32_16x16x32_bf16 v[88:91], a[208:211], v[52:55], v[88:91]
    v_mfma_f32_16x16x32_bf16 v[92:95], a[212:215], v[52:55], v[92:95]
    v_mfma_f32_16x16x32_bf16 v[80:83], a[216:219], v[56:59], v[80:83]
    ds_read_b128 v[40:43], v14 offset:2048
    ds_read_b128 v[44:47], v14 offset:3072
    v_mfma_f32_16x16x32_bf16 v[84:87], a[220:223], v[56:59], v[84:87]
    v_mfma_f32_16x16x32_bf16 v[88:91], a[216:219], v[60:63], v[88:91]
    v_mfma_f32_16x16x32_bf16 v[92:95], a[220:223], v[60:63], v[92:95]
    s_add_u32 s53, s53, 229376
    s_add_u32 s58, s58, 1
    v_swap_b32 v13, v14
    s_xor_b32 s54, s54, 65536
    s_xor_b32 s55, s55, 65536
    s_mov_b32 s76, s57
    v_swap_b32 v15, v16
    s_add_u32 s57, s57, 131072
    ds_write_b128 v7, v[80:83] offset:0
    ds_write_b128 v7, v[84:87] offset:64
    ds_write_b128 v7, v[88:91] offset:2304
    ds_write_b128 v7, v[92:95] offset:2368
    s_cmp_lt_u32 s58, s51
    s_cbranch_scc1 L_e_loop_165
    s_waitcnt lgkmcnt(0)
    ds_read_b128 v[216:219], v8 offset:0
    ds_read_b128 v[220:223], v8 offset:1152
    ds_read_b128 v[224:227], v8 offset:2304
    ds_read_b128 v[228:231], v8 offset:3456
    s_waitcnt lgkmcnt(0)
    buffer_store_dwordx4 v[216:219], v11, s[12:15], s76 offen sc1
    s_add_u32 s76, s76, 32768
    buffer_store_dwordx4 v[220:223], v11, s[12:15], s76 offen sc1
    s_add_u32 s76, s76, 32768
    buffer_store_dwordx4 v[224:227], v11, s[12:15], s76 offen sc1
    s_add_u32 s76, s76, 32768
    buffer_store_dwordx4 v[228:231], v11, s[12:15], s76 offen sc1
    s_waitcnt vmcnt(0)
    s_barrier
    s_cmp_lg_u32 s44, 0
    s_cbranch_scc1 L_pub_166
    v_mov_b32 v30, s62
    v_mov_b32 v31, 0
    s_mov_b64 exec, 1
    buffer_store_dword v30, v31, s[12:15], s65 offen sc1
    s_mov_b64 exec, -1
L_pub_166:
    s_add_u32 s63, s50, s44
    s_lshl_b32 s63, s63, 5
    s_add_u32 s63, s63, s41
    s_lshl_b32 s47, s63, 11
    s_add_u32 s46, s47, 0x800000
    s_cmp_lt_u32 s44, s51
    s_cselect_b32 s46, s46, 0x20000000
    buffer_load_dwordx4 v[208:211], v10, s[12:15], s46 offen sc1
    buffer_load_dwordx4 v[212:215], v10, s[12:15], s46 offen offset:1024 sc1
    s_add_u32 s45, s64, 16384
    s_cmp_lg_u32 s44, 0
    s_cbranch_scc1 L_pw_167
    s_mov_b32 exec_hi, 0
    s_mov_b32 s70, 0
L_wp_168:
    buffer_load_dword v31, v5, s[12:15], s45 offen sc1
    s_add_u32 s70, s70, 1
    s_cmp_ge_u32 s70, 0x200000
    s_cbranch_scc1 L_w_done_109
    s_waitcnt vmcnt(0)
    v_cmp_gt_u32 vcc, s62, v31
    s_nop 1
    s_cbranch_vccz L_wp_168_ok
    s_sleep 1
    s_branch L_wp_168
L_wp_168_ok:
    s_mov_b64 exec, -1
L_pw_167:
    s_barrier
    s_cmp_ge_u32 s44, s51
    s_cbranch_scc1 L_c_loop_161
    s_lshl_b32 s45, s63, 12
    s_add_u32 s45, s45, 0xc000000
    v_lshlrev_b32 v29, 5, v1
    buffer_load_dwordx4 v[64:67], v29, s[12:15], s45 offen offset:0 sc1
    buffer_load_dwordx4 v[68:71], v29, s[12:15], s45 offen offset:16 sc1
    buffer_load_dwordx4 v[72:75], v29, s[12:15], s45 offen offset:2048 sc1
    buffer_load_dwordx4 v[76:79], v29, s[12:15], s45 offen offset:2064 sc1
    s_add_u32 s45, s45, 0x800000
    buffer_load_dwordx4 v[160:163], v29, s[12:15], s45 offen offset:0 sc1
    buffer_load_dwordx4 v[164:167], v29, s[12:15], s45 offen offset:16 sc1
    buffer_load_dwordx4 v[168:171], v29, s[12:15], s45 offen offset:2048 sc1
    buffer_load_dwordx4 v[172:175], v29, s[12:15], s45 offen offset:2064 sc1
    s_add_u32 s45, s45, 0x800000
    buffer_load_dwordx4 v[176:179], v29, s[12:15], s45 offen offset:0 sc1
    buffer_load_dwordx4 v[180:183], v29, s[12:15], s45 offen offset:16 sc1
    buffer_load_dwordx4 v[184:187], v29, s[12:15], s45 offen offset:2048 sc1
    buffer_load_dwordx4 v[188:191], v29, s[12:15], s45 offen offset:2064 sc1
    s_add_u32 s45, s45, 0x800000
    buffer_load_dwordx4 v[192:195], v29, s[12:15], s45 offen offset:0 sc1
    buffer_load_dwordx4 v[196:199], v29, s[12:15], s45 offen offset:16 sc1
    buffer_load_dwordx4 v[200:203], v29, s[12:15], s45 offen offset:2048 sc1
    buffer_load_dwordx4 v[204:207], v29, s[12:15], s45 offen offset:2064 sc1
    s_waitcnt vmcnt(0)
    v_pk_add_f32 v[64:65], v[64:65], v[160:161]
    v_pk_add_f32 v[176:177], v[176:177], v[192:193]
    v_pk_add_f32 v[66:67], v[66:67], v[162:163]
    v_pk_add_f32 v[178:179], v[178:179], v[194:195]
    v_pk_add_f32 v[68:69], v[68:69], v[164:165]
    v_pk_add_f32 v[180:181], v[180:181], v[196:197]
    v_pk_add_f32 v[70:71], v[70:71], v[166:167]
    v_pk_add_f32 v[182:183], v[182:183], v[198:199]
    v_pk_add_f32 v[72:73], v[72:73], v[168:169]
    v_pk_add_f32 v[184:185], v[184:185], v[200:201]
    v_pk_add_f32 v[74:75], v[74:75], v[170:171]
    v_pk_add_f32 v[186:187], v[186:187], v[202:203]
    v_pk_add_f32 v[76:77], v[76:77], v[172:173]
    v_pk_add_f32 v[188:189], v[188:189], v[204:205]
    v_pk_add_f32 v[78:79], v[78:79], v[174:175]
    v_pk_add_f32 v[190:191], v[190:191], v[206:207]
    v_pk_add_f32 v[64:65], v[64:65], v[176:177]
    v_pk_add_f32 v[66:67], v[66:67], v[178:179]
    v_pk_add_f32 v[68:69], v[68:69], v[180:181]
    v_pk_add_f32 v[70:71], v[70:71], v[182:183]
    v_pk_add_f32 v[72:73], v[72:73], v[184:185]
    v_pk_add_f32 v[74:75], v[74:75], v[186:187]
    v_pk_add_f32 v[76:77], v[76:77], v[188:189]
    v_pk_add_f32 v[78:79], v[78:79], v[190:191]
    v_cvt_pk_bf16_f32 v64, v64, v64
    v_lshlrev_b32 v64, 16, v64
    v_cvt_pk_bf16_f32 v65, v65, v65
    v_lshlrev_b32 v65, 16, v65
    v_cvt_pk_bf16_f32 v66, v66, v66
    v_lshlrev_b32 v66, 16, v66
    v_cvt_pk_bf16_f32 v67, v67, v67
    v_lshlrev_b32 v67, 16, v67
    v_cvt_pk_bf16_f32 v68, v68, v68
    v_lshlrev_b32 v68, 16, v68
    v_cvt_pk_bf16_f32 v69, v69, v69
    v_lshlrev_b32 v69, 16, v69
    v_cvt_pk_bf16_f32 v70, v70, v70
    v_lshlrev_b32 v70, 16, v70
    v_cvt_pk_bf16_f32 v71, v71, v71
    v_lshlrev_b32 v71, 16, v71
    v_cvt_pk_bf16_f32 v72, v72, v72
    v_lshlrev_b32 v72, 16, v72
    v_cvt_pk_bf16_f32 v73, v73, v73
    v_lshlrev_b32 v73, 16, v73
    v_cvt_pk_bf16_f32 v74, v74, v74
    v_lshlrev_b32 v74, 16, v74
    v_cvt_pk_bf16_f32 v75, v75, v75
    v_lshlrev_b32 v75, 16, v75
    v_cvt_pk_bf16_f32 v76, v76, v76
    v_lshlrev_b32 v76, 16, v76
    v_cvt_pk_bf16_f32 v77, v77, v77
    v_lshlrev_b32 v77, 16, v77
    v_cvt_pk_bf16_f32 v78, v78, v78
    v_lshlrev_b32 v78, 16, v78
    v_cvt_pk_bf16_f32 v79, v79, v79
    v_lshlrev_b32 v79, 16, v79
    v_lshlrev_b32 v160, 16, v208
    v_and_b32 v161, 0xffff0000, v208
    v_lshlrev_b32 v162, 16, v209
    v_and_b32 v163, 0xffff0000, v209
    v_lshlrev_b32 v164, 16, v210
    v_and_b32 v165, 0xffff0000, v210
    v_lshlrev_b32 v166, 16, v211
    v_and_b32 v167, 0xffff0000, v211
    v_lshlrev_b32 v168, 16, v212
    v_and_b32 v169, 0xffff0000, v212
    v_lshlrev_b32 v170, 16, v213
    v_and_b32 v171, 0xffff0000, v213
    v_lshlrev_b32 v172, 16, v214
    v_and_b32 v173, 0xffff0000, v214
    v_lshlrev_b32 v174, 16, v215
    v_and_b32 v175, 0xffff0000, v215
    v_add_f32 v64, v64, v96
    v_cvt_pk_bf16_f32 v64, v64, v64
    v_lshlrev_b32 v64, 16, v64
    v_mul_f32 v64, v64, v112
    v_cvt_pk_bf16_f32 v64, v64, v64
    v_lshlrev_b32 v64, 16, v64
    v_add_f32 v64, v64, v160
    v_add_f32 v65, v65, v97
    v_cvt_pk_bf16_f32 v65, v65, v65
    v_lshlrev_b32 v65, 16, v65
    v_mul_f32 v65, v65, v113
    v_cvt_pk_bf16_f32 v65, v65, v65
    v_lshlrev_b32 v65, 16, v65
    v_add_f32 v65, v65, v161
    v_add_f32 v66, v66, v98
    v_cvt_pk_bf16_f32 v66, v66, v66
    v_lshlrev_b32 v66, 16, v66
    v_mul_f32 v66, v66, v114
    v_cvt_pk_bf16_f32 v66, v66, v66
    v_lshlrev_b32 v66, 16, v66
    v_add_f32 v66, v66, v162
    v_add_f32 v67, v67, v99
    v_cvt_pk_bf16_f32 v67, v67, v67
    v_lshlrev_b32 v67, 16, v67
    v_mul_f32 v67, v67, v115
    v_cvt_pk_bf16_f32 v67, v67, v67
    v_lshlrev_b32 v67, 16, v67
    v_add_f32 v67, v67, v163
    v_add_f32 v68, v68, v100
    v_cvt_pk_bf16_f32 v68, v68, v68
    v_lshlrev_b32 v68, 16, v68
    v_mul_f32 v68, v68, v116
    v_cvt_pk_bf16_f32 v68, v68, v68
    v_lshlrev_b32 v68, 16, v68
    v_add_f32 v68, v68, v164
    v_add_f32 v69, v69, v101
    v_cvt_pk_bf16_f32 v69, v69, v69
    v_lshlrev_b32 v69, 16, v69
    v_mul_f32 v69, v69, v117
    v_cvt_pk_bf16_f32 v69, v69, v69
    v_lshlrev_b32 v69, 16, v69
    v_add_f32 v69, v69, v165
    v_add_f32 v70, v70, v102
    v_cvt_pk_bf16_f32 v70, v70, v70
    v_lshlrev_b32 v70, 16, v70
    v_mul_f32 v70, v70, v118
    v_cvt_pk_bf16_f32 v70, v70, v70
    v_lshlrev_b32 v70, 16, v70
    v_add_f32 v70, v70, v166
    v_add_f32 v71, v71, v103
    v_cvt_pk_bf16_f32 v71, v71, v71
    v_lshlrev_b32 v71, 16, v71
    v_mul_f32 v71, v71, v119
    v_cvt_pk_bf16_f32 v71, v71, v71
    v_lshlrev_b32 v71, 16, v71
    v_add_f32 v71, v71, v167
    v_add_f32 v72, v72, v104
    v_cvt_pk_bf16_f32 v72, v72, v72
    v_lshlrev_b32 v72, 16, v72
    v_mul_f32 v72, v72, v120
    v_cvt_pk_bf16_f32 v72, v72, v72
    v_lshlrev_b32 v72, 16, v72
    v_add_f32 v72, v72, v168
    v_add_f32 v73, v73, v105
    v_cvt_pk_bf16_f32 v73, v73, v73
    v_lshlrev_b32 v73, 16, v73
    v_mul_f32 v73, v73, v121
    v_cvt_pk_bf16_f32 v73, v73, v73
    v_lshlrev_b32 v73, 16, v73
    v_add_f32 v73, v73, v169
    v_add_f32 v74, v74, v106
    v_cvt_pk_bf16_f32 v74, v74, v74
    v_lshlrev_b32 v74, 16, v74
    v_mul_f32 v74, v74, v122
    v_cvt_pk_bf16_f32 v74, v74, v74
    v_lshlrev_b32 v74, 16, v74
    v_add_f32 v74, v74, v170
    v_add_f32 v75, v75, v107
    v_cvt_pk_bf16_f32 v75, v75, v75
    v_lshlrev_b32 v75, 16, v75
    v_mul_f32 v75, v75, v123
    v_cvt_pk_bf16_f32 v75, v75, v75
    v_lshlrev_b32 v75, 16, v75
    v_add_f32 v75, v75, v171
    v_add_f32 v76, v76, v108
    v_cvt_pk_bf16_f32 v76, v76, v76
    v_lshlrev_b32 v76, 16, v76
    v_mul_f32 v76, v76, v124
    v_cvt_pk_bf16_f32 v76, v76, v76
    v_lshlrev_b32 v76, 16, v76
    v_add_f32 v76, v76, v172
    v_add_f32 v77, v77, v109
    v_cvt_pk_bf16_f32 v77, v77, v77
    v_lshlrev_b32 v77, 16, v77
    v_mul_f32 v77, v77, v125
    v_cvt_pk_bf16_f32 v77, v77, v77
    v_lshlrev_b32 v77, 16, v77
    v_add_f32 v77, v77, v173
    v_add_f32 v78, v78, v110
    v_cvt_pk_bf16_f32 v78, v78, v78
    v_lshlrev_b32 v78, 16, v78
    v_mul_f32 v78, v78, v126
    v_cvt_pk_bf16_f32 v78, v78, v78
    v_lshlrev_b32 v78, 16, v78
    v_add_f32 v78, v78, v174
    v_add_f32 v79, v79, v111
    v_cvt_pk_bf16_f32 v79, v79, v79
    v_lshlrev_b32 v79, 16, v79
    v_mul_f32 v79, v79, v127
    v_cvt_pk_bf16_f32 v79, v79, v79
    v_lshlrev_b32 v79, 16, v79
    v_add_f32 v79, v79, v175
    v_cvt_pk_bf16_f32 v208, v64, v65
    v_cvt_pk_bf16_f32 v209, v66, v67
    v_cvt_pk_bf16_f32 v210, v68, v69
    v_cvt_pk_bf16_f32 v211, v70, v71
    v_cvt_pk_bf16_f32 v212, v72, v73
    v_cvt_pk_bf16_f32 v213, v74, v75
    v_cvt_pk_bf16_f32 v214, v76, v77
    v_cvt_pk_bf16_f32 v215, v78, v79
    buffer_store_dwordx4 v[208:211], v10, s[32:35], s47 offen
    buffer_store_dwordx4 v[212:215], v10, s[32:35], s47 offen offset:1024
    s_branch L_c_loop_161
L_w_done_109:
    s_endpgm
.section .rodata,"a"
.p2align 6
.amdhsa_kernel adaLN_cond__memory_aug_recurrent_mem_tr__dense_activation_gelu__prompt_kernel
  .amdhsa_next_free_vgpr 512
  .amdhsa_next_free_sgpr 102
  .amdhsa_accum_offset 256
  .amdhsa_group_segment_fixed_size 0
  .amdhsa_kernarg_size 136
  .amdhsa_user_sgpr_count 2
  .amdhsa_user_sgpr_kernarg_segment_ptr 1
  .amdhsa_system_sgpr_workgroup_id_x 1
.end_amdhsa_kernel
```

```asm
; @launch kernel=adaLN_cond__memory_aug_recurrent_mem_tr__dense_activation_gelu__prompt_kernel grid=(256,1,1) block=(256,1,1) lds=163840
.amdgcn_target "amdgcn-amd-amdhsa--gfx950"
.text
.globl adaLN_cond__memory_aug_recurrent_mem_tr__dense_activation_gelu__prompt_kernel
.p2align 8
.type adaLN_cond__memory_aug_recurrent_mem_tr__dense_activation_gelu__prompt_kernel,@function
adaLN_cond__memory_aug_recurrent_mem_tr__dense_activation_gelu__prompt_kernel:
    s_cmp_lt_u32 s2, 256
    s_cbranch_scc1 L_c_done_1_go
    s_endpgm
L_c_done_1_go:
    s_and_b32 s40, s2, 7
    s_load_dwordx4 s[4:7], s[0:1], 16
    s_load_dwordx4 s[8:11], s[0:1], 32
    s_load_dwordx2 s[20:21], s[0:1], 128
    s_load_dwordx2 s[22:23], s[0:1], 120
    s_load_dwordx2 s[50:51], s[0:1], 8
    s_lshr_b32 s41, s2, 3
    s_and_b32 s42, s41, 15
    v_and_b32 v1, 63, v0
    v_lshrrev_b32 v2, 6, v0
    s_nop 0
    v_readfirstlane_b32 s44, v2
    s_waitcnt lgkmcnt(0)
    s_mov_b32 s24, s4
    s_and_b32 s25, s5, 0xffff
    s_mov_b32 s26, 0x800000
    s_mov_b32 s27, 0x00020000
    s_mov_b32 s28, s6
    s_and_b32 s29, s7, 0xffff
    s_mov_b32 s30, 0x800000
    s_mov_b32 s31, 0x00020000
    s_mov_b32 s32, s8
    s_and_b32 s33, s9, 0xffff
    s_mov_b32 s34, 0x800000
    s_mov_b32 s35, 0x00020000
    s_mov_b32 s36, s10
    s_and_b32 s37, s11, 0xffff
    s_mov_b32 s38, 0x800000
    s_mov_b32 s39, 0x00020000
    s_mov_b32 s12, s20
    s_and_b32 s13, s21, 0xffff
    s_mov_b32 s14, 0x10000000
    s_mov_b32 s15, 0x00020000
    s_mov_b32 s16, s22
    s_and_b32 s17, s23, 0xffff
    s_mov_b32 s18, 0x100
    s_mov_b32 s19, 0x00020000
    s_mov_b32 s52, s50
    s_and_b32 s53, s51, 0xffff
    s_mov_b32 s54, 0x4000
    s_mov_b32 s55, 0x00020000
    v_mov_b32 v41, 0
    s_cmp_lg_u32 s2, 1
    s_cbranch_scc1 L_worker_3_a
    s_getreg_b32 s45, hwreg(HW_REG_XCC_ID)
    s_and_b32 s45, s45, 1
    s_add_u32 s45, s45, 1
    v_mov_b32 v40, s45
    buffer_store_dword v40, v41, s[16:19], 0 offen offset:24 sc1
L_worker_3_a:
    s_cmp_eq_u32 s40, 1
    s_cbranch_scc1 L_worker_3_g0
    s_cmp_lt_u32 s40, 3
    s_cbranch_scc1 L_worker_3_q
    s_sub_u32 s40, s40, 2
    s_branch L_worker_3
L_worker_3_q:
    s_mov_b32 s70, 0
L_worker_3_p:
    buffer_load_dword v40, v41, s[16:19], 0 offen offset:24 sc1
    s_add_u32 s70, s70, 1
    s_cmp_ge_u32 s70, 0x200000
    s_cbranch_scc1 L_c_done_1
    s_waitcnt vmcnt(0)
    v_readfirstlane_b32 s45, v40
    s_nop 3
    s_cmp_eq_u32 s45, 0
    s_cbranch_scc1 L_worker_3_p
    s_and_b32 s45, s45, 2
    s_cmp_lg_u32 s45, s40
    s_mov_b32 s40, 1
    s_cbranch_scc1 L_worker_3_no
    s_mov_b32 s40, 0
    s_branch L_worker_3
L_worker_3_g0:
    s_mov_b32 s40, 0
L_worker_3_no:
    s_lshl_b32 s43, s40, 4
    s_add_u32 s43, s43, s42
    s_lshl_b32 s3, s43, 7
    s_lshr_b32 s45, s41, 4
    s_lshl_b32 s45, s45, 4
    s_add_u32 s3, s3, s45
    s_lshl_b32 s45, s44, 2
    s_add_u32 s3, s3, s45
    s_add_u32 s3, s3, 0x11000
    v_mov_b32 v40, 0
    s_mov_b64 exec, 1
    buffer_store_dword v40, v40, s[12:15], s3 offen sc1
    s_mov_b64 exec, -1
    v_and_b32 v21, 8, v1
    v_cmp_eq_u32 s[56:57], 0, v21
    v_mov_b32 v2, 0xeeee
    v_mov_b32 v3, 0x4444
    v_cndmask_b32 v2, v2, v3, s[56:57]
    v_lshlrev_b32 v68, 4, v1
    s_lshl_b32 s45, s44, 12
    v_add_u32 v3, s45, v68
    v_add_u32 v4, 4096, v3
    v_and_b32 v4, 16383, v4
    v_add_u32 v21, 8192, v3
    v_and_b32 v21, 16383, v21
    v_add_u32 v23, 12288, v3
    v_and_b32 v23, 16383, v23
    s_mul_i32 s45, s44, 24576
    s_add_u32 s45, s45, 65536
    v_add_u32 v5, s45, v68
    v_lshrrev_b32 v63, 4, v1
    s_lshl_b32 s45, s44, 2
    v_add_u32 v64, s45, v63
    s_lshr_b32 s45, s44, 1
    s_lshl_b32 s45, s45, 2
    v_add_u32 v65, s45, v63
    v_bfe_u32 v66, v1, 1, 3
    v_xor_b32 v66, v66, v65
    v_lshlrev_b32 v66, 5, v66
    v_and_b32 v67, 1, v1
    v_lshlrev_b32 v67, 4, v67
    v_add_u32 v66, v66, v67
    v_lshlrev_b32 v64, 13, v64
    v_add_u32 v82, v64, v66
    s_lshl_b32 s47, s43, 8
    s_lshl_b32 s48, s44, 10
    v_bfe_u32 v64, v1, 2, 2
    v_bfe_u32 v65, v1, 4, 1
    v_lshlrev_b32 v65, 2, v65
    v_add_u32 v65, v65, v64
    v_lshlrev_b32 v66, 3, v63
    v_add_u32 v66, v66, v64
    v_lshlrev_b32 v66, 8, v66
    v_and_b32 v67, 3, v1
    v_lshlrev_b32 v67, 3, v67
    v_add_u32 v66, v66, v67
    s_lshl_b32 s45, s44, 1
    v_xor_b32 v65, s45, v65
    v_lshlrev_b32 v65, 5, v65
    v_add_u32 v80, v66, v65
    v_xor_b32 v81, 32, v80
    v_lshrrev_b32 v64, 5, v1
    v_mul_u32_u24 v64, 20480, v64
    v_add_u32 v64, 65536, v64
    v_add_u32 v84, v64, v80
    v_add_u32 v85, v64, v81
    v_add_u32 v86, 49152, v84
    v_add_u32 v87, 49152, v85
    v_mov_b32 v40, -1
    v_mov_b32 v41, -1
    v_mov_b32 v42, -1
    v_mov_b32 v43, -1
    v_mov_b32 v44, 0
    s_mov_b32 s68, 0
    s_cmp_ge_u32 s41, 16
    s_cbranch_scc1 L_c_vo_2
    s_lshl_b32 s45, s42, 11
    s_lshr_b32 s46, s44, 1
    s_lshl_b32 s46, s46, 10
    s_add_u32 s45, s45, s46
    s_and_b32 s46, s44, 1
    s_lshl_b32 s46, s46, 7
    s_add_u32 s45, s45, s46
    v_add_u32 v17, s45, v68
    v_mov_b32 v63, 0x20000000
    v_cndmask_b32 v17, v63, v17, s[56:57]
    s_lshl_b32 s62, s40, 17
    s_add_u32 s62, s62, 0x7040000
    s_add_u32 s63, s62, 0
    buffer_store_dwordx4 v[40:43], v17, s[12:15], s63 offen sc1
    s_add_u32 s63, s62, 32768
    buffer_store_dwordx4 v[40:43], v17, s[12:15], s63 offen sc1
    s_add_u32 s63, s62, 65536
    buffer_store_dwordx4 v[40:43], v17, s[12:15], s63 offen sc1
    s_add_u32 s63, s62, 98304
    buffer_store_dwordx4 v[40:43], v17, s[12:15], s63 offen sc1
    s_mov_b64 exec, -1
    s_lshl_b32 s45, s40, 11
    s_lshl_b32 s46, s42, 2
    s_add_u32 s45, s45, s46
    s_add_u32 s45, s45, 0x7080000
    s_lshl_b32 s46, s44, 9
    s_add_u32 s45, s45, s46
    v_lshlrev_b32 v20, 7, v1
    v_add_u32 v20, s45, v20
    v_cmp_gt_u32 vcc, 4, v1
    s_nop 1
    v_cndmask_b32 v20, v63, v20, vcc
    buffer_store_dword v44, v20, s[12:15], 0 offen sc1
    s_add_u32 s79, s41, 0
    s_and_b32 s79, s79, 3
    s_lshl_b32 s79, s79, 19
    s_add_u32 s79, s79, s47
    s_add_u32 s46, s79, 0x0
    s_add_u32 m0, s48, 73728
    s_nop 0
    buffer_load_dwordx4 v82, s[24:27], s46 offen  lds
    s_add_u32 s46, s79, 0x20000
    s_add_u32 m0, s48, 98304
    s_nop 0
    buffer_load_dwordx4 v82, s[24:27], s46 offen  lds
    s_add_u32 s46, s79, 0x40000
    s_add_u32 m0, s48, 122880
    s_nop 0
    buffer_load_dwordx4 v82, s[24:27], s46 offen  lds
    s_add_u32 s46, s79, 0x60000
    s_add_u32 m0, s48, 147456
    s_nop 0
    buffer_load_dwordx4 v82, s[24:27], s46 offen  lds
    s_add_u32 s79, s41, 1
    s_and_b32 s79, s79, 3
    s_lshl_b32 s79, s79, 19
    s_add_u32 s79, s79, s47
    s_add_u32 s46, s79, 0x0
    s_add_u32 m0, s48, 77824
    s_nop 0
    buffer_load_dwordx4 v82, s[24:27], s46 offen  lds
    s_add_u32 s46, s79, 0x20000
    s_add_u32 m0, s48, 102400
    s_nop 0
    buffer_load_dwordx4 v82, s[24:27], s46 offen  lds
    s_add_u32 s46, s79, 0x40000
    s_add_u32 m0, s48, 126976
    s_nop 0
    buffer_load_dwordx4 v82, s[24:27], s46 offen  lds
    s_add_u32 s46, s79, 0x60000
    s_add_u32 m0, s48, 151552
    s_nop 0
    buffer_load_dwordx4 v82, s[24:27], s46 offen  lds
    s_add_u32 s79, s41, 2
    s_and_b32 s79, s79, 3
    s_lshl_b32 s79, s79, 19
    s_add_u32 s79, s79, s47
    s_add_u32 s46, s79, 0x0
    s_add_u32 m0, s48, 81920
    s_nop 0
    buffer_load_dwordx4 v82, s[24:27], s46 offen  lds
    s_add_u32 s46, s79, 0x20000
    s_add_u32 m0, s48, 106496
    s_nop 0
    buffer_load_dwordx4 v82, s[24:27], s46 offen  lds
    s_add_u32 s46, s79, 0x40000
    s_add_u32 m0, s48, 131072
    s_nop 0
    buffer_load_dwordx4 v82, s[24:27], s46 offen  lds
    s_add_u32 s46, s79, 0x60000
    s_add_u32 m0, s48, 155648
    s_nop 0
    buffer_load_dwordx4 v82, s[24:27], s46 offen  lds
    s_add_u32 s79, s41, 3
    s_and_b32 s79, s79, 3
    s_lshl_b32 s79, s79, 19
    s_add_u32 s79, s79, s47
    s_add_u32 s46, s79, 0x0
    s_add_u32 m0, s48, 86016
    s_nop 0
    buffer_load_dwordx4 v82, s[24:27], s46 offen  lds
    s_add_u32 s46, s79, 0x20000
    s_add_u32 m0, s48, 110592
    s_nop 0
    buffer_load_dwordx4 v82, s[24:27], s46 offen  lds
    s_add_u32 s46, s79, 0x40000
    s_add_u32 m0, s48, 135168
    s_nop 0
    buffer_load_dwordx4 v82, s[24:27], s46 offen  lds
    s_add_u32 s46, s79, 0x60000
    s_add_u32 m0, s48, 159744
    s_nop 0
    buffer_load_dwordx4 v82, s[24:27], s46 offen  lds
    s_add_u32 s79, s41, 4
    s_and_b32 s79, s79, 3
    s_lshl_b32 s79, s79, 19
    s_add_u32 s79, s79, s47
    s_add_u32 s46, s79, 0x200000
    s_add_u32 m0, s48, 0
    s_nop 0
    buffer_load_dwordx4 v82, s[24:27], s46 offen  lds
    s_add_u32 s46, s79, 0x220000
    s_add_u32 m0, s48, 4096
    s_nop 0
    buffer_load_dwordx4 v82, s[24:27], s46 offen  lds
    s_add_u32 s46, s79, 0x240000
    s_add_u32 m0, s48, 8192
    s_nop 0
    buffer_load_dwordx4 v82, s[24:27], s46 offen  lds
    s_add_u32 s46, s79, 0x260000
    s_add_u32 m0, s48, 12288
    s_nop 0
    buffer_load_dwordx4 v82, s[24:27], s46 offen  lds
    s_add_u32 s79, s41, 5
    s_and_b32 s79, s79, 3
    s_lshl_b32 s79, s79, 19
    s_add_u32 s79, s79, s47
    s_add_u32 s46, s79, 0x200000
    s_add_u32 m0, s48, 16384
    s_nop 0
    buffer_load_dwordx4 v82, s[24:27], s46 offen  lds
    s_add_u32 s46, s79, 0x220000
    s_add_u32 m0, s48, 20480
    s_nop 0
    buffer_load_dwordx4 v82, s[24:27], s46 offen  lds
    s_add_u32 s46, s79, 0x240000
    s_add_u32 m0, s48, 24576
    s_nop 0
    buffer_load_dwordx4 v82, s[24:27], s46 offen  lds
    s_add_u32 s46, s79, 0x260000
    s_add_u32 m0, s48, 28672
    s_nop 0
    buffer_load_dwordx4 v82, s[24:27], s46 offen  lds
    s_add_u32 s79, s41, 6
    s_and_b32 s79, s79, 3
    s_lshl_b32 s79, s79, 19
    s_add_u32 s79, s79, s47
    s_add_u32 s46, s79, 0x200000
    s_add_u32 m0, s48, 32768
    s_nop 0
    buffer_load_dwordx4 v82, s[24:27], s46 offen  lds
    s_add_u32 s46, s79, 0x220000
    s_add_u32 m0, s48, 36864
    s_nop 0
    buffer_load_dwordx4 v82, s[24:27], s46 offen  lds
    s_add_u32 s46, s79, 0x240000
    s_add_u32 m0, s48, 40960
    s_nop 0
    buffer_load_dwordx4 v82, s[24:27], s46 offen  lds
    s_add_u32 s46, s79, 0x260000
    s_add_u32 m0, s48, 45056
    s_nop 0
    buffer_load_dwordx4 v82, s[24:27], s46 offen  lds
    s_add_u32 s79, s41, 7
    s_and_b32 s79, s79, 3
    s_lshl_b32 s79, s79, 19
    s_add_u32 s79, s79, s47
    s_add_u32 s46, s79, 0x200000
    s_add_u32 m0, s48, 49152
    s_nop 0
    buffer_load_dwordx4 v82, s[24:27], s46 offen  lds
    s_add_u32 s46, s79, 0x220000
    s_add_u32 m0, s48, 53248
    s_nop 0
    buffer_load_dwordx4 v82, s[24:27], s46 offen  lds
    s_add_u32 s46, s79, 0x240000
    s_add_u32 m0, s48, 57344
    s_nop 0
    buffer_load_dwordx4 v82, s[24:27], s46 offen  lds
    s_add_u32 s46, s79, 0x260000
    s_add_u32 m0, s48, 61440
    s_nop 0
    buffer_load_dwordx4 v82, s[24:27], s46 offen  lds
    s_waitcnt vmcnt(28)
    s_barrier
    s_cmp_lg_u32 s44, 0
    s_cbranch_scc1 L_lw_4_0
    ds_read_b64_tr_b16 a[0:1], v84 offset:8192
    ds_read_b64_tr_b16 a[2:3], v84 offset:9216
    ds_read_b64_tr_b16 a[4:5], v86 offset:8192
    ds_read_b64_tr_b16 a[6:7], v86 offset:9216
    ds_read_b64_tr_b16 a[8:9], v85 offset:8192
    ds_read_b64_tr_b16 a[10:11], v85 offset:9216
    ds_read_b64_tr_b16 a[12:13], v87 offset:8192
    ds_read_b64_tr_b16 a[14:15], v87 offset:9216
    s_branch L_lw_4
L_lw_4_0:
    s_cmp_lg_u32 s44, 1
    s_cbranch_scc1 L_lw_4_1
    ds_read_b64_tr_b16 v[160:161], v84 offset:8192
    ds_read_b64_tr_b16 v[162:163], v84 offset:9216
    ds_read_b64_tr_b16 v[164:165], v86 offset:8192
    ds_read_b64_tr_b16 v[166:167], v86 offset:9216
    ds_read_b64_tr_b16 v[56:57], v85 offset:8192
    ds_read_b64_tr_b16 v[58:59], v85 offset:9216
    ds_read_b64_tr_b16 v[60:61], v87 offset:8192
    ds_read_b64_tr_b16 v[62:63], v87 offset:9216
    s_waitcnt lgkmcnt(0)
    ds_write_b128 v5, v[56:59] offset:0
    ds_write_b128 v5, v[60:63] offset:1024
    s_branch L_lw_4
L_lw_4_1:
    s_cmp_lg_u32 s44, 2
    s_cbranch_scc1 L_lw_4_2
    ds_read_b64_tr_b16 a[208:209], v84 offset:8192
    ds_read_b64_tr_b16 a[210:211], v84 offset:9216
    ds_read_b64_tr_b16 a[212:213], v86 offset:8192
    ds_read_b64_tr_b16 a[214:215], v86 offset:9216
    ds_read_b64_tr_b16 v[56:57], v85 offset:8192
    ds_read_b64_tr_b16 v[58:59], v85 offset:9216
    ds_read_b64_tr_b16 v[60:61], v87 offset:8192
    ds_read_b64_tr_b16 v[62:63], v87 offset:9216
    s_waitcnt lgkmcnt(0)
    ds_write_b128 v5, v[56:59] offset:2048
    ds_write_b128 v5, v[60:63] offset:3072
    s_branch L_lw_4
L_lw_4_2:
    ds_read_b64_tr_b16 a[104:105], v84 offset:8192
    ds_read_b64_tr_b16 a[106:107], v84 offset:9216
    ds_read_b64_tr_b16 a[108:109], v86 offset:8192
    ds_read_b64_tr_b16 a[110:111], v86 offset:9216
    ds_read_b64_tr_b16 v[56:57], v85 offset:8192
    ds_read_b64_tr_b16 v[58:59], v85 offset:9216
    ds_read_b64_tr_b16 v[60:61], v87 offset:8192
    ds_read_b64_tr_b16 v[62:63], v87 offset:9216
    s_waitcnt lgkmcnt(0)
    ds_write_b128 v5, v[56:59] offset:4096
    ds_write_b128 v5, v[60:63] offset:5120
L_lw_4:
    s_waitcnt lgkmcnt(0)
    s_waitcnt vmcnt(24)
    s_barrier
    s_cmp_lg_u32 s44, 0
    s_cbranch_scc1 L_hs_5
    s_getreg_b32 s45, hwreg(HW_REG_XCC_ID)
    s_and_b32 s45, s45, 15
    s_mul_i32 s46, s45, s45
    s_lshl_b32 s46, s46, 9
    s_add_u32 s45, s45, s46
    s_cmp_eq_u32 s40, 0
    s_cselect_b32 s46, s45, 0
    s_cselect_b32 s45, 0, s45
    s_lshl_b32 s68, s68, 24
    s_add_u32 s46, s46, s68
    s_add_u32 s45, s45, 16777216
    v_mov_b32 v40, s46
    v_mov_b32 v41, s45
    v_mov_b32 v42, 0
    s_mov_b64 exec, 1
    buffer_atomic_add_x2 v[40:41], v42, s[16:19], 0 offen sc1
    s_mov_b64 exec, -1
L_hs_5:
    s_cmp_lg_u32 s44, 0
    s_cbranch_scc1 L_lw_6_0
    ds_read_b64_tr_b16 a[32:33], v84 offset:12288
    ds_read_b64_tr_b16 a[34:35], v84 offset:13312
    ds_read_b64_tr_b16 a[36:37], v86 offset:12288
    ds_read_b64_tr_b16 a[38:39], v86 offset:13312
    ds_read_b64_tr_b16 a[40:41], v85 offset:12288
    ds_read_b64_tr_b16 a[42:43], v85 offset:13312
    ds_read_b64_tr_b16 a[44:45], v87 offset:12288
    ds_read_b64_tr_b16 a[46:47], v87 offset:13312
    s_branch L_lw_6
L_lw_6_0:
    s_cmp_lg_u32 s44, 1
    s_cbranch_scc1 L_lw_6_1
    ds_read_b64_tr_b16 v[184:185], v84 offset:12288
    ds_read_b64_tr_b16 v[186:187], v84 offset:13312
    ds_read_b64_tr_b16 v[188:189], v86 offset:12288
    ds_read_b64_tr_b16 v[190:191], v86 offset:13312
    ds_read_b64_tr_b16 v[192:193], v85 offset:12288
    ds_read_b64_tr_b16 v[194:195], v85 offset:13312
    ds_read_b64_tr_b16 v[196:197], v87 offset:12288
    ds_read_b64_tr_b16 v[198:199], v87 offset:13312
    s_branch L_lw_6
L_lw_6_1:
    s_cmp_lg_u32 s44, 2
    s_cbranch_scc1 L_lw_6_2
    ds_read_b64_tr_b16 a[232:233], v84 offset:12288
    ds_read_b64_tr_b16 a[234:235], v84 offset:13312
    ds_read_b64_tr_b16 a[236:237], v86 offset:12288
    ds_read_b64_tr_b16 a[238:239], v86 offset:13312
    ds_read_b64_tr_b16 a[240:241], v85 offset:12288
    ds_read_b64_tr_b16 a[242:243], v85 offset:13312
    ds_read_b64_tr_b16 a[244:245], v87 offset:12288
    ds_read_b64_tr_b16 a[246:247], v87 offset:13312
    s_branch L_lw_6
L_lw_6_2:
    ds_read_b64_tr_b16 a[128:129], v84 offset:12288
    ds_read_b64_tr_b16 a[130:131], v84 offset:13312
    ds_read_b64_tr_b16 a[132:133], v86 offset:12288
    ds_read_b64_tr_b16 a[134:135], v86 offset:13312
    ds_read_b64_tr_b16 v[56:57], v85 offset:12288
    ds_read_b64_tr_b16 v[58:59], v85 offset:13312
    ds_read_b64_tr_b16 v[60:61], v87 offset:12288
    ds_read_b64_tr_b16 v[62:63], v87 offset:13312
    s_waitcnt lgkmcnt(0)
    ds_write_b128 v5, v[56:59] offset:6144
    ds_write_b128 v5, v[60:63] offset:7168
L_lw_6:
    s_waitcnt lgkmcnt(0)
    s_waitcnt vmcnt(20)
    s_barrier
    s_cmp_lg_u32 s44, 0
    s_cbranch_scc1 L_lw_7_0
    ds_read_b64_tr_b16 a[64:65], v84 offset:16384
    ds_read_b64_tr_b16 a[66:67], v84 offset:17408
    ds_read_b64_tr_b16 a[68:69], v86 offset:16384
    ds_read_b64_tr_b16 a[70:71], v86 offset:17408
    ds_read_b64_tr_b16 v[56:57], v85 offset:16384
    ds_read_b64_tr_b16 v[58:59], v85 offset:17408
    ds_read_b64_tr_b16 v[60:61], v87 offset:16384
    ds_read_b64_tr_b16 v[62:63], v87 offset:17408
    s_waitcnt lgkmcnt(0)
    ds_write_b128 v5, v[56:59] offset:8192
    ds_write_b128 v5, v[60:63] offset:9216
    s_branch L_lw_7
L_lw_7_0:
    s_cmp_lg_u32 s44, 1
    s_cbranch_scc1 L_lw_7_1
    ds_read_b64_tr_b16 v[208:209], v84 offset:16384
    ds_read_b64_tr_b16 v[210:211], v84 offset:17408
    ds_read_b64_tr_b16 v[212:213], v86 offset:16384
    ds_read_b64_tr_b16 v[214:215], v86 offset:17408
    ds_read_b64_tr_b16 v[56:57], v85 offset:16384
    ds_read_b64_tr_b16 v[58:59], v85 offset:17408
    ds_read_b64_tr_b16 v[60:61], v87 offset:16384
    ds_read_b64_tr_b16 v[62:63], v87 offset:17408
    s_waitcnt lgkmcnt(0)
    ds_write_b128 v5, v[56:59] offset:10240
    ds_write_b128 v5, v[60:63] offset:11264
    s_branch L_lw_7
L_lw_7_1:
    s_cmp_lg_u32 s44, 2
    s_cbranch_scc1 L_lw_7_2
    ds_read_b64_tr_b16 v[104:105], v84 offset:16384
    ds_read_b64_tr_b16 v[106:107], v84 offset:17408
    ds_read_b64_tr_b16 v[108:109], v86 offset:16384
    ds_read_b64_tr_b16 v[110:111], v86 offset:17408
    ds_read_b64_tr_b16 v[56:57], v85 offset:16384
    ds_read_b64_tr_b16 v[58:59], v85 offset:17408
    ds_read_b64_tr_b16 v[60:61], v87 offset:16384
    ds_read_b64_tr_b16 v[62:63], v87 offset:17408
    s_waitcnt lgkmcnt(0)
    ds_write_b128 v5, v[56:59] offset:12288
    ds_write_b128 v5, v[60:63] offset:13312
    s_branch L_lw_7
L_lw_7_2:
    ds_read_b64_tr_b16 a[152:153], v84 offset:16384
    ds_read_b64_tr_b16 a[154:155], v84 offset:17408
    ds_read_b64_tr_b16 a[156:157], v86 offset:16384
    ds_read_b64_tr_b16 a[158:159], v86 offset:17408
    ds_read_b64_tr_b16 v[56:57], v85 offset:16384
    ds_read_b64_tr_b16 v[58:59], v85 offset:17408
    ds_read_b64_tr_b16 v[60:61], v87 offset:16384
    ds_read_b64_tr_b16 v[62:63], v87 offset:17408
    s_waitcnt lgkmcnt(0)
    ds_write_b128 v5, v[56:59] offset:14336
    ds_write_b128 v5, v[60:63] offset:15360
L_lw_7:
    s_waitcnt lgkmcnt(0)
    s_waitcnt vmcnt(16)
    s_barrier
    s_cmp_lg_u32 s44, 0
    s_cbranch_scc1 L_lw_8_0
    ds_read_b64_tr_b16 a[80:81], v84 offset:20480
    ds_read_b64_tr_b16 a[82:83], v84 offset:21504
    ds_read_b64_tr_b16 a[84:85], v86 offset:20480
    ds_read_b64_tr_b16 a[86:87], v86 offset:21504
    ds_read_b64_tr_b16 v[56:57], v85 offset:20480
    ds_read_b64_tr_b16 v[58:59], v85 offset:21504
    ds_read_b64_tr_b16 v[60:61], v87 offset:20480
    ds_read_b64_tr_b16 v[62:63], v87 offset:21504
    s_waitcnt lgkmcnt(0)
    ds_write_b128 v5, v[56:59] offset:16384
    ds_write_b128 v5, v[60:63] offset:17408
    s_branch L_lw_8
L_lw_8_0:
    s_cmp_lg_u32 s44, 1
    s_cbranch_scc1 L_lw_8_1
    ds_read_b64_tr_b16 v[232:233], v84 offset:20480
    ds_read_b64_tr_b16 v[234:235], v84 offset:21504
    ds_read_b64_tr_b16 v[236:237], v86 offset:20480
    ds_read_b64_tr_b16 v[238:239], v86 offset:21504
    ds_read_b64_tr_b16 v[240:241], v85 offset:20480
    ds_read_b64_tr_b16 v[242:243], v85 offset:21504
    ds_read_b64_tr_b16 v[244:245], v87 offset:20480
    ds_read_b64_tr_b16 v[246:247], v87 offset:21504
    s_branch L_lw_8
L_lw_8_1:
    s_cmp_lg_u32 s44, 2
    s_cbranch_scc1 L_lw_8_2
    ds_read_b64_tr_b16 v[128:129], v84 offset:20480
    ds_read_b64_tr_b16 v[130:131], v84 offset:21504
    ds_read_b64_tr_b16 v[132:133], v86 offset:20480
    ds_read_b64_tr_b16 v[134:135], v86 offset:21504
    ds_read_b64_tr_b16 v[136:137], v85 offset:20480
    ds_read_b64_tr_b16 v[138:139], v85 offset:21504
    ds_read_b64_tr_b16 v[140:141], v87 offset:20480
    ds_read_b64_tr_b16 v[142:143], v87 offset:21504
    s_branch L_lw_8
L_lw_8_2:
    ds_read_b64_tr_b16 a[176:177], v84 offset:20480
    ds_read_b64_tr_b16 a[178:179], v84 offset:21504
    ds_read_b64_tr_b16 a[180:181], v86 offset:20480
    ds_read_b64_tr_b16 a[182:183], v86 offset:21504
    ds_read_b64_tr_b16 a[184:185], v85 offset:20480
    ds_read_b64_tr_b16 a[186:187], v85 offset:21504
    ds_read_b64_tr_b16 a[188:189], v87 offset:20480
    ds_read_b64_tr_b16 a[190:191], v87 offset:21504
L_lw_8:
    s_waitcnt lgkmcnt(0)
    s_waitcnt vmcnt(12)
    s_barrier
    s_add_u32 s79, s41, 8
    s_and_b32 s79, s79, 3
    s_lshl_b32 s79, s79, 19
    s_add_u32 s79, s79, s47
    s_add_u32 s46, s79, 0x400000
    s_add_u32 m0, s48, 86016
    s_nop 0
    buffer_load_dwordx4 v82, s[24:27], s46 offen  lds
    s_add_u32 s46, s79, 0x420000
    s_add_u32 m0, s48, 110592
    s_nop 0
    buffer_load_dwordx4 v82, s[24:27], s46 offen  lds
    s_add_u32 s46, s79, 0x440000
    s_add_u32 m0, s48, 135168
    s_nop 0
    buffer_load_dwordx4 v82, s[24:27], s46 offen  lds
    s_add_u32 s46, s79, 0x460000
    s_add_u32 m0, s48, 159744
    s_nop 0
    buffer_load_dwordx4 v82, s[24:27], s46 offen  lds
    s_cmp_lg_u32 s44, 0
    s_cbranch_scc1 L_lw_9_0
    ds_read_b64_tr_b16 a[104:105], v80 offset:0
    ds_read_b64_tr_b16 a[106:107], v80 offset:1024
    ds_read_b64_tr_b16 a[108:109], v80 offset:8192
    ds_read_b64_tr_b16 a[110:111], v80 offset:9216
    ds_read_b64_tr_b16 v[56:57], v81 offset:0
    ds_read_b64_tr_b16 v[58:59], v81 offset:1024
    ds_read_b64_tr_b16 v[60:61], v81 offset:8192
    ds_read_b64_tr_b16 v[62:63], v81 offset:9216
    s_waitcnt lgkmcnt(0)
    ds_write_b128 v5, v[56:59] offset:4096
    ds_write_b128 v5, v[60:63] offset:5120
    s_branch L_lw_9
L_lw_9_0:
    s_cmp_lg_u32 s44, 1
    s_cbranch_scc1 L_lw_9_1
    ds_read_b64_tr_b16 a[0:1], v80 offset:0
    ds_read_b64_tr_b16 a[2:3], v80 offset:1024
    ds_read_b64_tr_b16 a[4:5], v80 offset:8192
    ds_read_b64_tr_b16 a[6:7], v80 offset:9216
    ds_read_b64_tr_b16 a[8:9], v81 offset:0
    ds_read_b64_tr_b16 a[10:11], v81 offset:1024
    ds_read_b64_tr_b16 a[12:13], v81 offset:8192
    ds_read_b64_tr_b16 a[14:15], v81 offset:9216
    s_branch L_lw_9
L_lw_9_1:
    s_cmp_lg_u32 s44, 2
    s_cbranch_scc1 L_lw_9_2
    ds_read_b64_tr_b16 v[160:161], v80 offset:0
    ds_read_b64_tr_b16 v[162:163], v80 offset:1024
    ds_read_b64_tr_b16 v[164:165], v80 offset:8192
    ds_read_b64_tr_b16 v[166:167], v80 offset:9216
    ds_read_b64_tr_b16 v[56:57], v81 offset:0
    ds_read_b64_tr_b16 v[58:59], v81 offset:1024
    ds_read_b64_tr_b16 v[60:61], v81 offset:8192
    ds_read_b64_tr_b16 v[62:63], v81 offset:9216
    s_waitcnt lgkmcnt(0)
    ds_write_b128 v5, v[56:59] offset:0
    ds_write_b128 v5, v[60:63] offset:1024
    s_branch L_lw_9
L_lw_9_2:
    ds_read_b64_tr_b16 a[208:209], v80 offset:0
    ds_read_b64_tr_b16 a[210:211], v80 offset:1024
    ds_read_b64_tr_b16 a[212:213], v80 offset:8192
    ds_read_b64_tr_b16 a[214:215], v80 offset:9216
    ds_read_b64_tr_b16 v[56:57], v81 offset:0
    ds_read_b64_tr_b16 v[58:59], v81 offset:1024
    ds_read_b64_tr_b16 v[60:61], v81 offset:8192
    ds_read_b64_tr_b16 v[62:63], v81 offset:9216
    s_waitcnt lgkmcnt(0)
    ds_write_b128 v5, v[56:59] offset:2048
    ds_write_b128 v5, v[60:63] offset:3072
L_lw_9:
    s_waitcnt lgkmcnt(0)
    s_waitcnt vmcnt(12)
    s_barrier
    s_add_u32 s79, s41, 9
    s_and_b32 s79, s79, 3
    s_lshl_b32 s79, s79, 19
    s_add_u32 s79, s79, s47
    s_add_u32 s46, s79, 0x400000
    s_add_u32 m0, s48, 0
    s_nop 0
    buffer_load_dwordx4 v82, s[24:27], s46 offen  lds
    s_add_u32 s46, s79, 0x420000
    s_add_u32 m0, s48, 4096
    s_nop 0
    buffer_load_dwordx4 v82, s[24:27], s46 offen  lds
    s_add_u32 s46, s79, 0x440000
    s_add_u32 m0, s48, 8192
    s_nop 0
    buffer_load_dwordx4 v82, s[24:27], s46 offen  lds
    s_add_u32 s46, s79, 0x460000
    s_add_u32 m0, s48, 12288
    s_nop 0
    buffer_load_dwordx4 v82, s[24:27], s46 offen  lds
    s_cmp_lg_u32 s44, 0
    s_cbranch_scc1 L_lw_10_0
    ds_read_b64_tr_b16 a[128:129], v80 offset:16384
    ds_read_b64_tr_b16 a[130:131], v80 offset:17408
    ds_read_b64_tr_b16 a[132:133], v80 offset:24576
    ds_read_b64_tr_b16 a[134:135], v80 offset:25600
    ds_read_b64_tr_b16 v[56:57], v81 offset:16384
    ds_read_b64_tr_b16 v[58:59], v81 offset:17408
    ds_read_b64_tr_b16 v[60:61], v81 offset:24576
    ds_read_b64_tr_b16 v[62:63], v81 offset:25600
    s_waitcnt lgkmcnt(0)
    ds_write_b128 v5, v[56:59] offset:6144
    ds_write_b128 v5, v[60:63] offset:7168
    s_branch L_lw_10
L_lw_10_0:
    s_cmp_lg_u32 s44, 1
    s_cbranch_scc1 L_lw_10_1
    ds_read_b64_tr_b16 a[32:33], v80 offset:16384
    ds_read_b64_tr_b16 a[34:35], v80 offset:17408
    ds_read_b64_tr_b16 a[36:37], v80 offset:24576
    ds_read_b64_tr_b16 a[38:39], v80 offset:25600
    ds_read_b64_tr_b16 a[40:41], v81 offset:16384
    ds_read_b64_tr_b16 a[42:43], v81 offset:17408
    ds_read_b64_tr_b16 a[44:45], v81 offset:24576
    ds_read_b64_tr_b16 a[46:47], v81 offset:25600
    s_branch L_lw_10
L_lw_10_1:
    s_cmp_lg_u32 s44, 2
    s_cbranch_scc1 L_lw_10_2
    ds_read_b64_tr_b16 v[184:185], v80 offset:16384
    ds_read_b64_tr_b16 v[186:187], v80 offset:17408
    ds_read_b64_tr_b16 v[188:189], v80 offset:24576
    ds_read_b64_tr_b16 v[190:191], v80 offset:25600
    ds_read_b64_tr_b16 v[192:193], v81 offset:16384
    ds_read_b64_tr_b16 v[194:195], v81 offset:17408
    ds_read_b64_tr_b16 v[196:197], v81 offset:24576
    ds_read_b64_tr_b16 v[198:199], v81 offset:25600
    s_branch L_lw_10
L_lw_10_2:
    ds_read_b64_tr_b16 a[232:233], v80 offset:16384
    ds_read_b64_tr_b16 a[234:235], v80 offset:17408
    ds_read_b64_tr_b16 a[236:237], v80 offset:24576
    ds_read_b64_tr_b16 a[238:239], v80 offset:25600
    ds_read_b64_tr_b16 a[240:241], v81 offset:16384
    ds_read_b64_tr_b16 a[242:243], v81 offset:17408
    ds_read_b64_tr_b16 a[244:245], v81 offset:24576
    ds_read_b64_tr_b16 a[246:247], v81 offset:25600
L_lw_10:
    s_waitcnt lgkmcnt(0)
    s_waitcnt vmcnt(12)
    s_barrier
    s_add_u32 s79, s41, 10
    s_and_b32 s79, s79, 3
    s_lshl_b32 s79, s79, 19
    s_add_u32 s79, s79, s47
    s_add_u32 s46, s79, 0x400000
    s_add_u32 m0, s48, 16384
    s_nop 0
    buffer_load_dwordx4 v82, s[24:27], s46 offen  lds
    s_add_u32 s46, s79, 0x420000
    s_add_u32 m0, s48, 20480
    s_nop 0
    buffer_load_dwordx4 v82, s[24:27], s46 offen  lds
    s_add_u32 s46, s79, 0x440000
    s_add_u32 m0, s48, 24576
    s_nop 0
    buffer_load_dwordx4 v82, s[24:27], s46 offen  lds
    s_add_u32 s46, s79, 0x460000
    s_add_u32 m0, s48, 28672
    s_nop 0
    buffer_load_dwordx4 v82, s[24:27], s46 offen  lds
    s_cmp_lg_u32 s44, 0
    s_cbranch_scc1 L_lw_11_0
    ds_read_b64_tr_b16 a[152:153], v80 offset:32768
    ds_read_b64_tr_b16 a[154:155], v80 offset:33792
    ds_read_b64_tr_b16 a[156:157], v80 offset:40960
    ds_read_b64_tr_b16 a[158:159], v80 offset:41984
    ds_read_b64_tr_b16 v[56:57], v81 offset:32768
    ds_read_b64_tr_b16 v[58:59], v81 offset:33792
    ds_read_b64_tr_b16 v[60:61], v81 offset:40960
    ds_read_b64_tr_b16 v[62:63], v81 offset:41984
    s_waitcnt lgkmcnt(0)
    ds_write_b128 v5, v[56:59] offset:14336
    ds_write_b128 v5, v[60:63] offset:15360
    s_branch L_lw_11
L_lw_11_0:
    s_cmp_lg_u32 s44, 1
    s_cbranch_scc1 L_lw_11_1
    ds_read_b64_tr_b16 a[64:65], v80 offset:32768
    ds_read_b64_tr_b16 a[66:67], v80 offset:33792
    ds_read_b64_tr_b16 a[68:69], v80 offset:40960
    ds_read_b64_tr_b16 a[70:71], v80 offset:41984
    ds_read_b64_tr_b16 v[56:57], v81 offset:32768
    ds_read_b64_tr_b16 v[58:59], v81 offset:33792
    ds_read_b64_tr_b16 v[60:61], v81 offset:40960
    ds_read_b64_tr_b16 v[62:63], v81 offset:41984
    s_waitcnt lgkmcnt(0)
    ds_write_b128 v5, v[56:59] offset:8192
    ds_write_b128 v5, v[60:63] offset:9216
    s_branch L_lw_11
L_lw_11_1:
    s_cmp_lg_u32 s44, 2
    s_cbranch_scc1 L_lw_11_2
    ds_read_b64_tr_b16 v[208:209], v80 offset:32768
    ds_read_b64_tr_b16 v[210:211], v80 offset:33792
    ds_read_b64_tr_b16 v[212:213], v80 offset:40960
    ds_read_b64_tr_b16 v[214:215], v80 offset:41984
    ds_read_b64_tr_b16 v[56:57], v81 offset:32768
    ds_read_b64_tr_b16 v[58:59], v81 offset:33792
    ds_read_b64_tr_b16 v[60:61], v81 offset:40960
    ds_read_b64_tr_b16 v[62:63], v81 offset:41984
    s_waitcnt lgkmcnt(0)
    ds_write_b128 v5, v[56:59] offset:10240
    ds_write_b128 v5, v[60:63] offset:11264
    s_branch L_lw_11
L_lw_11_2:
    ds_read_b64_tr_b16 v[104:105], v80 offset:32768
    ds_read_b64_tr_b16 v[106:107], v80 offset:33792
    ds_read_b64_tr_b16 v[108:109], v80 offset:40960
    ds_read_b64_tr_b16 v[110:111], v80 offset:41984
    ds_read_b64_tr_b16 v[56:57], v81 offset:32768
    ds_read_b64_tr_b16 v[58:59], v81 offset:33792
    ds_read_b64_tr_b16 v[60:61], v81 offset:40960
    ds_read_b64_tr_b16 v[62:63], v81 offset:41984
    s_waitcnt lgkmcnt(0)
    ds_write_b128 v5, v[56:59] offset:12288
    ds_write_b128 v5, v[60:63] offset:13312
L_lw_11:
    s_waitcnt lgkmcnt(0)
    s_waitcnt vmcnt(12)
    s_barrier
    s_add_u32 s79, s41, 11
    s_and_b32 s79, s79, 3
    s_lshl_b32 s79, s79, 19
    s_add_u32 s79, s79, s47
    s_add_u32 s46, s79, 0x400000
    s_add_u32 m0, s48, 32768
    s_nop 0
    buffer_load_dwordx4 v82, s[24:27], s46 offen  lds
    s_add_u32 s46, s79, 0x420000
    s_add_u32 m0, s48, 36864
    s_nop 0
    buffer_load_dwordx4 v82, s[24:27], s46 offen  lds
    s_add_u32 s46, s79, 0x440000
    s_add_u32 m0, s48, 40960
    s_nop 0
    buffer_load_dwordx4 v82, s[24:27], s46 offen  lds
    s_add_u32 s46, s79, 0x460000
    s_add_u32 m0, s48, 45056
    s_nop 0
    buffer_load_dwordx4 v82, s[24:27], s46 offen  lds
    s_cmp_lg_u32 s44, 0
    s_cbranch_scc1 L_lw_12_0
    ds_read_b64_tr_b16 a[176:177], v80 offset:49152
    ds_read_b64_tr_b16 a[178:179], v80 offset:50176
    ds_read_b64_tr_b16 a[180:181], v80 offset:57344
    ds_read_b64_tr_b16 a[182:183], v80 offset:58368
    ds_read_b64_tr_b16 a[184:185], v81 offset:49152
    ds_read_b64_tr_b16 a[186:187], v81 offset:50176
    ds_read_b64_tr_b16 a[188:189], v81 offset:57344
    ds_read_b64_tr_b16 a[190:191], v81 offset:58368
    s_branch L_lw_12
L_lw_12_0:
    s_cmp_lg_u32 s44, 1
    s_cbranch_scc1 L_lw_12_1
    ds_read_b64_tr_b16 a[80:81], v80 offset:49152
    ds_read_b64_tr_b16 a[82:83], v80 offset:50176
    ds_read_b64_tr_b16 a[84:85], v80 offset:57344
    ds_read_b64_tr_b16 a[86:87], v80 offset:58368
    ds_read_b64_tr_b16 v[56:57], v81 offset:49152
    ds_read_b64_tr_b16 v[58:59], v81 offset:50176
    ds_read_b64_tr_b16 v[60:61], v81 offset:57344
    ds_read_b64_tr_b16 v[62:63], v81 offset:58368
    s_waitcnt lgkmcnt(0)
    ds_write_b128 v5, v[56:59] offset:16384
    ds_write_b128 v5, v[60:63] offset:17408
    s_branch L_lw_12
L_lw_12_1:
    s_cmp_lg_u32 s44, 2
    s_cbranch_scc1 L_lw_12_2
    ds_read_b64_tr_b16 v[232:233], v80 offset:49152
    ds_read_b64_tr_b16 v[234:235], v80 offset:50176
    ds_read_b64_tr_b16 v[236:237], v80 offset:57344
    ds_read_b64_tr_b16 v[238:239], v80 offset:58368
    ds_read_b64_tr_b16 v[240:241], v81 offset:49152
    ds_read_b64_tr_b16 v[242:243], v81 offset:50176
    ds_read_b64_tr_b16 v[244:245], v81 offset:57344
    ds_read_b64_tr_b16 v[246:247], v81 offset:58368
    s_branch L_lw_12
L_lw_12_2:
    ds_read_b64_tr_b16 v[128:129], v80 offset:49152
    ds_read_b64_tr_b16 v[130:131], v80 offset:50176
    ds_read_b64_tr_b16 v[132:133], v80 offset:57344
    ds_read_b64_tr_b16 v[134:135], v80 offset:58368
    ds_read_b64_tr_b16 v[136:137], v81 offset:49152
    ds_read_b64_tr_b16 v[138:139], v81 offset:50176
    ds_read_b64_tr_b16 v[140:141], v81 offset:57344
    ds_read_b64_tr_b16 v[142:143], v81 offset:58368
L_lw_12:
    s_waitcnt lgkmcnt(0)
    s_waitcnt vmcnt(12)
    s_barrier
    s_add_u32 s79, s41, 12
    s_and_b32 s79, s79, 3
    s_lshl_b32 s79, s79, 19
    s_add_u32 s79, s79, s47
    s_add_u32 s46, s79, 0x600000
    s_add_u32 m0, s48, 49152
    s_nop 0
    buffer_load_dwordx4 v82, s[24:27], s46 offen  lds
    s_add_u32 s46, s79, 0x620000
    s_add_u32 m0, s48, 53248
    s_nop 0
    buffer_load_dwordx4 v82, s[24:27], s46 offen  lds
    s_add_u32 s46, s79, 0x640000
    s_add_u32 m0, s48, 57344
    s_nop 0
    buffer_load_dwordx4 v82, s[24:27], s46 offen  lds
    s_add_u32 s46, s79, 0x660000
    s_add_u32 m0, s48, 61440
    s_nop 0
    buffer_load_dwordx4 v82, s[24:27], s46 offen  lds
    s_cmp_lg_u32 s44, 0
    s_cbranch_scc1 L_lw_13_0
    ds_read_b64_tr_b16 a[208:209], v84 offset:20480
    ds_read_b64_tr_b16 a[210:211], v84 offset:21504
    ds_read_b64_tr_b16 a[212:213], v86 offset:20480
    ds_read_b64_tr_b16 a[214:215], v86 offset:21504
    ds_read_b64_tr_b16 v[56:57], v85 offset:20480
    ds_read_b64_tr_b16 v[58:59], v85 offset:21504
    ds_read_b64_tr_b16 v[60:61], v87 offset:20480
    ds_read_b64_tr_b16 v[62:63], v87 offset:21504
    s_waitcnt lgkmcnt(0)
    ds_write_b128 v5, v[56:59] offset:2048
    ds_write_b128 v5, v[60:63] offset:3072
    s_branch L_lw_13
L_lw_13_0:
    s_cmp_lg_u32 s44, 1
    s_cbranch_scc1 L_lw_13_1
    ds_read_b64_tr_b16 a[104:105], v84 offset:20480
    ds_read_b64_tr_b16 a[106:107], v84 offset:21504
    ds_read_b64_tr_b16 a[108:109], v86 offset:20480
    ds_read_b64_tr_b16 a[110:111], v86 offset:21504
    ds_read_b64_tr_b16 v[56:57], v85 offset:20480
    ds_read_b64_tr_b16 v[58:59], v85 offset:21504
    ds_read_b64_tr_b16 v[60:61], v87 offset:20480
    ds_read_b64_tr_b16 v[62:63], v87 offset:21504
    s_waitcnt lgkmcnt(0)
    ds_write_b128 v5, v[56:59] offset:4096
    ds_write_b128 v5, v[60:63] offset:5120
    s_branch L_lw_13
L_lw_13_1:
    s_cmp_lg_u32 s44, 2
    s_cbranch_scc1 L_lw_13_2
    ds_read_b64_tr_b16 a[0:1], v84 offset:20480
    ds_read_b64_tr_b16 a[2:3], v84 offset:21504
    ds_read_b64_tr_b16 a[4:5], v86 offset:20480
    ds_read_b64_tr_b16 a[6:7], v86 offset:21504
    ds_read_b64_tr_b16 a[8:9], v85 offset:20480
    ds_read_b64_tr_b16 a[10:11], v85 offset:21504
    ds_read_b64_tr_b16 a[12:13], v87 offset:20480
    ds_read_b64_tr_b16 a[14:15], v87 offset:21504
    s_branch L_lw_13
L_lw_13_2:
    ds_read_b64_tr_b16 v[160:161], v84 offset:20480
    ds_read_b64_tr_b16 v[162:163], v84 offset:21504
    ds_read_b64_tr_b16 v[164:165], v86 offset:20480
    ds_read_b64_tr_b16 v[166:167], v86 offset:21504
    ds_read_b64_tr_b16 v[56:57], v85 offset:20480
    ds_read_b64_tr_b16 v[58:59], v85 offset:21504
    ds_read_b64_tr_b16 v[60:61], v87 offset:20480
    ds_read_b64_tr_b16 v[62:63], v87 offset:21504
    s_waitcnt lgkmcnt(0)
    ds_write_b128 v5, v[56:59] offset:0
    ds_write_b128 v5, v[60:63] offset:1024
L_lw_13:
    s_waitcnt lgkmcnt(0)
    s_waitcnt vmcnt(12)
    s_barrier
    s_add_u32 s79, s41, 13
    s_and_b32 s79, s79, 3
    s_lshl_b32 s79, s79, 19
    s_add_u32 s79, s79, s47
    s_add_u32 s46, s79, 0x600000
    s_add_u32 m0, s48, 86016
    s_nop 0
    buffer_load_dwordx4 v82, s[24:27], s46 offen  lds
    s_add_u32 s46, s79, 0x620000
    s_add_u32 m0, s48, 110592
    s_nop 0
    buffer_load_dwordx4 v82, s[24:27], s46 offen  lds
    s_add_u32 s46, s79, 0x640000
    s_add_u32 m0, s48, 135168
    s_nop 0
    buffer_load_dwordx4 v82, s[24:27], s46 offen  lds
    s_add_u32 s46, s79, 0x660000
    s_add_u32 m0, s48, 159744
    s_nop 0
    buffer_load_dwordx4 v82, s[24:27], s46 offen  lds
    s_cmp_lg_u32 s44, 0
    s_cbranch_scc1 L_lw_14_0
    ds_read_b64_tr_b16 a[232:233], v80 offset:0
    ds_read_b64_tr_b16 a[234:235], v80 offset:1024
    ds_read_b64_tr_b16 a[236:237], v80 offset:8192
    ds_read_b64_tr_b16 a[238:239], v80 offset:9216
    ds_read_b64_tr_b16 a[240:241], v81 offset:0
    ds_read_b64_tr_b16 a[242:243], v81 offset:1024
    ds_read_b64_tr_b16 a[244:245], v81 offset:8192
    ds_read_b64_tr_b16 a[246:247], v81 offset:9216
    s_branch L_lw_14
L_lw_14_0:
    s_cmp_lg_u32 s44, 1
    s_cbranch_scc1 L_lw_14_1
    ds_read_b64_tr_b16 a[128:129], v80 offset:0
    ds_read_b64_tr_b16 a[130:131], v80 offset:1024
    ds_read_b64_tr_b16 a[132:133], v80 offset:8192
    ds_read_b64_tr_b16 a[134:135], v80 offset:9216
    ds_read_b64_tr_b16 v[56:57], v81 offset:0
    ds_read_b64_tr_b16 v[58:59], v81 offset:1024
    ds_read_b64_tr_b16 v[60:61], v81 offset:8192
    ds_read_b64_tr_b16 v[62:63], v81 offset:9216
    s_waitcnt lgkmcnt(0)
    ds_write_b128 v5, v[56:59] offset:6144
    ds_write_b128 v5, v[60:63] offset:7168
    s_branch L_lw_14
L_lw_14_1:
    s_cmp_lg_u32 s44, 2
    s_cbranch_scc1 L_lw_14_2
    ds_read_b64_tr_b16 a[32:33], v80 offset:0
    ds_read_b64_tr_b16 a[34:35], v80 offset:1024
    ds_read_b64_tr_b16 a[36:37], v80 offset:8192
    ds_read_b64_tr_b16 a[38:39], v80 offset:9216
    ds_read_b64_tr_b16 a[40:41], v81 offset:0
    ds_read_b64_tr_b16 a[42:43], v81 offset:1024
    ds_read_b64_tr_b16 a[44:45], v81 offset:8192
    ds_read_b64_tr_b16 a[46:47], v81 offset:9216
    s_branch L_lw_14
L_lw_14_2:
    ds_read_b64_tr_b16 v[184:185], v80 offset:0
    ds_read_b64_tr_b16 v[186:187], v80 offset:1024
    ds_read_b64_tr_b16 v[188:189], v80 offset:8192
    ds_read_b64_tr_b16 v[190:191], v80 offset:9216
    ds_read_b64_tr_b16 v[192:193], v81 offset:0
    ds_read_b64_tr_b16 v[194:195], v81 offset:1024
    ds_read_b64_tr_b16 v[196:197], v81 offset:8192
    ds_read_b64_tr_b16 v[198:199], v81 offset:9216
L_lw_14:
    s_waitcnt lgkmcnt(0)
    s_waitcnt vmcnt(12)
    s_barrier
    s_add_u32 s79, s41, 14
    s_and_b32 s79, s79, 3
    s_lshl_b32 s79, s79, 19
    s_add_u32 s79, s79, s47
    s_add_u32 s46, s79, 0x600000
    s_add_u32 m0, s48, 0
    s_nop 0
    buffer_load_dwordx4 v82, s[24:27], s46 offen  lds
    s_add_u32 s46, s79, 0x620000
    s_add_u32 m0, s48, 4096
    s_nop 0
    buffer_load_dwordx4 v82, s[24:27], s46 offen  lds
    s_add_u32 s46, s79, 0x640000
    s_add_u32 m0, s48, 8192
    s_nop 0
    buffer_load_dwordx4 v82, s[24:27], s46 offen  lds
    s_add_u32 s46, s79, 0x660000
    s_add_u32 m0, s48, 12288
    s_nop 0
    buffer_load_dwordx4 v82, s[24:27], s46 offen  lds
    s_cmp_lg_u32 s44, 0
    s_cbranch_scc1 L_lw_15_0
    ds_read_b64_tr_b16 v[104:105], v80 offset:16384
    ds_read_b64_tr_b16 v[106:107], v80 offset:17408
    ds_read_b64_tr_b16 v[108:109], v80 offset:24576
    ds_read_b64_tr_b16 v[110:111], v80 offset:25600
    ds_read_b64_tr_b16 v[56:57], v81 offset:16384
    ds_read_b64_tr_b16 v[58:59], v81 offset:17408
    ds_read_b64_tr_b16 v[60:61], v81 offset:24576
    ds_read_b64_tr_b16 v[62:63], v81 offset:25600
    s_waitcnt lgkmcnt(0)
    ds_write_b128 v5, v[56:59] offset:12288
    ds_write_b128 v5, v[60:63] offset:13312
    s_branch L_lw_15
L_lw_15_0:
    s_cmp_lg_u32 s44, 1
    s_cbranch_scc1 L_lw_15_1
    ds_read_b64_tr_b16 a[152:153], v80 offset:16384
    ds_read_b64_tr_b16 a[154:155], v80 offset:17408
    ds_read_b64_tr_b16 a[156:157], v80 offset:24576
    ds_read_b64_tr_b16 a[158:159], v80 offset:25600
    ds_read_b64_tr_b16 v[56:57], v81 offset:16384
    ds_read_b64_tr_b16 v[58:59], v81 offset:17408
    ds_read_b64_tr_b16 v[60:61], v81 offset:24576
    ds_read_b64_tr_b16 v[62:63], v81 offset:25600
    s_waitcnt lgkmcnt(0)
    ds_write_b128 v5, v[56:59] offset:14336
    ds_write_b128 v5, v[60:63] offset:15360
    s_branch L_lw_15
L_lw_15_1:
    s_cmp_lg_u32 s44, 2
    s_cbranch_scc1 L_lw_15_2
    ds_read_b64_tr_b16 a[64:65], v80 offset:16384
    ds_read_b64_tr_b16 a[66:67], v80 offset:17408
    ds_read_b64_tr_b16 a[68:69], v80 offset:24576
    ds_read_b64_tr_b16 a[70:71], v80 offset:25600
    ds_read_b64_tr_b16 v[56:57], v81 offset:16384
    ds_read_b64_tr_b16 v[58:59], v81 offset:17408
    ds_read_b64_tr_b16 v[60:61], v81 offset:24576
    ds_read_b64_tr_b16 v[62:63], v81 offset:25600
    s_waitcnt lgkmcnt(0)
    ds_write_b128 v5, v[56:59] offset:8192
    ds_write_b128 v5, v[60:63] offset:9216
    s_branch L_lw_15
L_lw_15_2:
    ds_read_b64_tr_b16 v[208:209], v80 offset:16384
    ds_read_b64_tr_b16 v[210:211], v80 offset:17408
    ds_read_b64_tr_b16 v[212:213], v80 offset:24576
    ds_read_b64_tr_b16 v[214:215], v80 offset:25600
    ds_read_b64_tr_b16 v[56:57], v81 offset:16384
    ds_read_b64_tr_b16 v[58:59], v81 offset:17408
    ds_read_b64_tr_b16 v[60:61], v81 offset:24576
    ds_read_b64_tr_b16 v[62:63], v81 offset:25600
    s_waitcnt lgkmcnt(0)
    ds_write_b128 v5, v[56:59] offset:10240
    ds_write_b128 v5, v[60:63] offset:11264
L_lw_15:
    s_waitcnt lgkmcnt(0)
    s_waitcnt vmcnt(12)
    s_barrier
    s_add_u32 s79, s41, 15
    s_and_b32 s79, s79, 3
    s_lshl_b32 s79, s79, 19
    s_add_u32 s79, s79, s47
    s_add_u32 s46, s79, 0x600000
    s_add_u32 m0, s48, 16384
    s_nop 0
    buffer_load_dwordx4 v82, s[24:27], s46 offen  lds
    s_add_u32 s46, s79, 0x620000
    s_add_u32 m0, s48, 20480
    s_nop 0
    buffer_load_dwordx4 v82, s[24:27], s46 offen  lds
    s_add_u32 s46, s79, 0x640000
    s_add_u32 m0, s48, 24576
    s_nop 0
    buffer_load_dwordx4 v82, s[24:27], s46 offen  lds
    s_add_u32 s46, s79, 0x660000
    s_add_u32 m0, s48, 28672
    s_nop 0
    buffer_load_dwordx4 v82, s[24:27], s46 offen  lds
    s_cmp_lg_u32 s44, 0
    s_cbranch_scc1 L_lw_16_0
    ds_read_b64_tr_b16 v[128:129], v80 offset:32768
    ds_read_b64_tr_b16 v[130:131], v80 offset:33792
    ds_read_b64_tr_b16 v[132:133], v80 offset:40960
    ds_read_b64_tr_b16 v[134:135], v80 offset:41984
    ds_read_b64_tr_b16 v[136:137], v81 offset:32768
    ds_read_b64_tr_b16 v[138:139], v81 offset:33792
    ds_read_b64_tr_b16 v[140:141], v81 offset:40960
    ds_read_b64_tr_b16 v[142:143], v81 offset:41984
    s_branch L_lw_16
L_lw_16_0:
    s_cmp_lg_u32 s44, 1
    s_cbranch_scc1 L_lw_16_1
    ds_read_b64_tr_b16 a[176:177], v80 offset:32768
    ds_read_b64_tr_b16 a[178:179], v80 offset:33792
    ds_read_b64_tr_b16 a[180:181], v80 offset:40960
    ds_read_b64_tr_b16 a[182:183], v80 offset:41984
    ds_read_b64_tr_b16 a[184:185], v81 offset:32768
    ds_read_b64_tr_b16 a[186:187], v81 offset:33792
    ds_read_b64_tr_b16 a[188:189], v81 offset:40960
    ds_read_b64_tr_b16 a[190:191], v81 offset:41984
    s_branch L_lw_16
L_lw_16_1:
    s_cmp_lg_u32 s44, 2
    s_cbranch_scc1 L_lw_16_2
    ds_read_b64_tr_b16 a[80:81], v80 offset:32768
    ds_read_b64_tr_b16 a[82:83], v80 offset:33792
    ds_read_b64_tr_b16 a[84:85], v80 offset:40960
    ds_read_b64_tr_b16 a[86:87], v80 offset:41984
    ds_read_b64_tr_b16 v[56:57], v81 offset:32768
    ds_read_b64_tr_b16 v[58:59], v81 offset:33792
    ds_read_b64_tr_b16 v[60:61], v81 offset:40960
    ds_read_b64_tr_b16 v[62:63], v81 offset:41984
    s_waitcnt lgkmcnt(0)
    ds_write_b128 v5, v[56:59] offset:16384
    ds_write_b128 v5, v[60:63] offset:17408
    s_branch L_lw_16
L_lw_16_2:
    ds_read_b64_tr_b16 v[232:233], v80 offset:32768
    ds_read_b64_tr_b16 v[234:235], v80 offset:33792
    ds_read_b64_tr_b16 v[236:237], v80 offset:40960
    ds_read_b64_tr_b16 v[238:239], v80 offset:41984
    ds_read_b64_tr_b16 v[240:241], v81 offset:32768
    ds_read_b64_tr_b16 v[242:243], v81 offset:33792
    ds_read_b64_tr_b16 v[244:245], v81 offset:40960
    ds_read_b64_tr_b16 v[246:247], v81 offset:41984
L_lw_16:
    s_waitcnt lgkmcnt(0)
    s_waitcnt vmcnt(12)
    s_barrier
    s_add_u32 s79, s41, 0
    s_and_b32 s79, s79, 3
    s_lshl_b32 s79, s79, 19
    s_add_u32 s79, s79, s47
    s_add_u32 s46, s79, 0x0
    s_add_u32 m0, s48, 32768
    s_nop 0
    buffer_load_dwordx4 v82, s[28:31], s46 offen  lds
    s_add_u32 s46, s79, 0x20000
    s_add_u32 m0, s48, 36864
    s_nop 0
    buffer_load_dwordx4 v82, s[28:31], s46 offen  lds
    s_add_u32 s46, s79, 0x40000
    s_add_u32 m0, s48, 40960
    s_nop 0
    buffer_load_dwordx4 v82, s[28:31], s46 offen  lds
    s_add_u32 s46, s79, 0x60000
    s_add_u32 m0, s48, 45056
    s_nop 0
    buffer_load_dwordx4 v82, s[28:31], s46 offen  lds
    s_cmp_lg_u32 s44, 0
    s_cbranch_scc1 L_lw_17_0
    ds_read_b64_tr_b16 v[160:161], v80 offset:49152
    ds_read_b64_tr_b16 v[162:163], v80 offset:50176
    ds_read_b64_tr_b16 v[164:165], v80 offset:57344
    ds_read_b64_tr_b16 v[166:167], v80 offset:58368
    ds_read_b64_tr_b16 v[56:57], v81 offset:49152
    ds_read_b64_tr_b16 v[58:59], v81 offset:50176
    ds_read_b64_tr_b16 v[60:61], v81 offset:57344
    ds_read_b64_tr_b16 v[62:63], v81 offset:58368
    s_waitcnt lgkmcnt(0)
    ds_write_b128 v5, v[56:59] offset:0
    ds_write_b128 v5, v[60:63] offset:1024
    s_branch L_lw_17
L_lw_17_0:
    s_cmp_lg_u32 s44, 1
    s_cbranch_scc1 L_lw_17_1
    ds_read_b64_tr_b16 a[208:209], v80 offset:49152
    ds_read_b64_tr_b16 a[210:211], v80 offset:50176
    ds_read_b64_tr_b16 a[212:213], v80 offset:57344
    ds_read_b64_tr_b16 a[214:215], v80 offset:58368
    ds_read_b64_tr_b16 v[56:57], v81 offset:49152
    ds_read_b64_tr_b16 v[58:59], v81 offset:50176
    ds_read_b64_tr_b16 v[60:61], v81 offset:57344
    ds_read_b64_tr_b16 v[62:63], v81 offset:58368
    s_waitcnt lgkmcnt(0)
    ds_write_b128 v5, v[56:59] offset:2048
    ds_write_b128 v5, v[60:63] offset:3072
    s_branch L_lw_17
L_lw_17_1:
    s_cmp_lg_u32 s44, 2
    s_cbranch_scc1 L_lw_17_2
    ds_read_b64_tr_b16 a[104:105], v80 offset:49152
    ds_read_b64_tr_b16 a[106:107], v80 offset:50176
    ds_read_b64_tr_b16 a[108:109], v80 offset:57344
    ds_read_b64_tr_b16 a[110:111], v80 offset:58368
    ds_read_b64_tr_b16 v[56:57], v81 offset:49152
    ds_read_b64_tr_b16 v[58:59], v81 offset:50176
    ds_read_b64_tr_b16 v[60:61], v81 offset:57344
    ds_read_b64_tr_b16 v[62:63], v81 offset:58368
    s_waitcnt lgkmcnt(0)
    ds_write_b128 v5, v[56:59] offset:4096
    ds_write_b128 v5, v[60:63] offset:5120
    s_branch L_lw_17
L_lw_17_2:
    ds_read_b64_tr_b16 a[0:1], v80 offset:49152
    ds_read_b64_tr_b16 a[2:3], v80 offset:50176
    ds_read_b64_tr_b16 a[4:5], v80 offset:57344
    ds_read_b64_tr_b16 a[6:7], v80 offset:58368
    ds_read_b64_tr_b16 a[8:9], v81 offset:49152
    ds_read_b64_tr_b16 a[10:11], v81 offset:50176
    ds_read_b64_tr_b16 a[12:13], v81 offset:57344
    ds_read_b64_tr_b16 a[14:15], v81 offset:58368
L_lw_17:
    s_waitcnt lgkmcnt(0)
    s_waitcnt vmcnt(12)
    s_barrier
    s_add_u32 s79, s41, 1
    s_and_b32 s79, s79, 3
    s_lshl_b32 s79, s79, 19
    s_add_u32 s79, s79, s47
    s_add_u32 s46, s79, 0x0
    s_add_u32 m0, s48, 49152
    s_nop 0
    buffer_load_dwordx4 v82, s[28:31], s46 offen  lds
    s_add_u32 s46, s79, 0x20000
    s_add_u32 m0, s48, 53248
    s_nop 0
    buffer_load_dwordx4 v82, s[28:31], s46 offen  lds
    s_add_u32 s46, s79, 0x40000
    s_add_u32 m0, s48, 57344
    s_nop 0
    buffer_load_dwordx4 v82, s[28:31], s46 offen  lds
    s_add_u32 s46, s79, 0x60000
    s_add_u32 m0, s48, 61440
    s_nop 0
    buffer_load_dwordx4 v82, s[28:31], s46 offen  lds
    s_cmp_lg_u32 s44, 0
    s_cbranch_scc1 L_lw_18_0
    ds_read_b64_tr_b16 v[184:185], v84 offset:20480
    ds_read_b64_tr_b16 v[186:187], v84 offset:21504
    ds_read_b64_tr_b16 v[188:189], v86 offset:20480
    ds_read_b64_tr_b16 v[190:191], v86 offset:21504
    ds_read_b64_tr_b16 v[192:193], v85 offset:20480
    ds_read_b64_tr_b16 v[194:195], v85 offset:21504
    ds_read_b64_tr_b16 v[196:197], v87 offset:20480
    ds_read_b64_tr_b16 v[198:199], v87 offset:21504
    s_branch L_lw_18
L_lw_18_0:
    s_cmp_lg_u32 s44, 1
    s_cbranch_scc1 L_lw_18_1
    ds_read_b64_tr_b16 a[232:233], v84 offset:20480
    ds_read_b64_tr_b16 a[234:235], v84 offset:21504
    ds_read_b64_tr_b16 a[236:237], v86 offset:20480
    ds_read_b64_tr_b16 a[238:239], v86 offset:21504
    ds_read_b64_tr_b16 a[240:241], v85 offset:20480
    ds_read_b64_tr_b16 a[242:243], v85 offset:21504
    ds_read_b64_tr_b16 a[244:245], v87 offset:20480
    ds_read_b64_tr_b16 a[246:247], v87 offset:21504
    s_branch L_lw_18
L_lw_18_1:
    s_cmp_lg_u32 s44, 2
    s_cbranch_scc1 L_lw_18_2
    ds_read_b64_tr_b16 a[128:129], v84 offset:20480
    ds_read_b64_tr_b16 a[130:131], v84 offset:21504
    ds_read_b64_tr_b16 a[132:133], v86 offset:20480
    ds_read_b64_tr_b16 a[134:135], v86 offset:21504
    ds_read_b64_tr_b16 v[56:57], v85 offset:20480
    ds_read_b64_tr_b16 v[58:59], v85 offset:21504
    ds_read_b64_tr_b16 v[60:61], v87 offset:20480
    ds_read_b64_tr_b16 v[62:63], v87 offset:21504
    s_waitcnt lgkmcnt(0)
    ds_write_b128 v5, v[56:59] offset:6144
    ds_write_b128 v5, v[60:63] offset:7168
    s_branch L_lw_18
L_lw_18_2:
    ds_read_b64_tr_b16 a[32:33], v84 offset:20480
    ds_read_b64_tr_b16 a[34:35], v84 offset:21504
    ds_read_b64_tr_b16 a[36:37], v86 offset:20480
    ds_read_b64_tr_b16 a[38:39], v86 offset:21504
    ds_read_b64_tr_b16 a[40:41], v85 offset:20480
    ds_read_b64_tr_b16 a[42:43], v85 offset:21504
    ds_read_b64_tr_b16 a[44:45], v87 offset:20480
    ds_read_b64_tr_b16 a[46:47], v87 offset:21504
L_lw_18:
    s_waitcnt lgkmcnt(0)
    s_waitcnt vmcnt(12)
    s_barrier
    s_cmp_lg_u32 s44, 0
    s_cbranch_scc1 L_lw_19_0
    ds_read_b64_tr_b16 v[208:209], v80 offset:0
    ds_read_b64_tr_b16 v[210:211], v80 offset:1024
    ds_read_b64_tr_b16 v[212:213], v80 offset:8192
    ds_read_b64_tr_b16 v[214:215], v80 offset:9216
    ds_read_b64_tr_b16 v[56:57], v81 offset:0
    ds_read_b64_tr_b16 v[58:59], v81 offset:1024
    ds_read_b64_tr_b16 v[60:61], v81 offset:8192
    ds_read_b64_tr_b16 v[62:63], v81 offset:9216
    s_waitcnt lgkmcnt(0)
    ds_write_b128 v5, v[56:59] offset:10240
    ds_write_b128 v5, v[60:63] offset:11264
    s_branch L_lw_19
L_lw_19_0:
    s_cmp_lg_u32 s44, 1
    s_cbranch_scc1 L_lw_19_1
    ds_read_b64_tr_b16 v[104:105], v80 offset:0
    ds_read_b64_tr_b16 v[106:107], v80 offset:1024
    ds_read_b64_tr_b16 v[108:109], v80 offset:8192
    ds_read_b64_tr_b16 v[110:111], v80 offset:9216
    ds_read_b64_tr_b16 v[56:57], v81 offset:0
    ds_read_b64_tr_b16 v[58:59], v81 offset:1024
    ds_read_b64_tr_b16 v[60:61], v81 offset:8192
    ds_read_b64_tr_b16 v[62:63], v81 offset:9216
    s_waitcnt lgkmcnt(0)
    ds_write_b128 v5, v[56:59] offset:12288
    ds_write_b128 v5, v[60:63] offset:13312
    s_branch L_lw_19
L_lw_19_1:
    s_cmp_lg_u32 s44, 2
    s_cbranch_scc1 L_lw_19_2
    ds_read_b64_tr_b16 a[152:153], v80 offset:0
    ds_read_b64_tr_b16 a[154:155], v80 offset:1024
    ds_read_b64_tr_b16 a[156:157], v80 offset:8192
    ds_read_b64_tr_b16 a[158:159], v80 offset:9216
    ds_read_b64_tr_b16 v[56:57], v81 offset:0
    ds_read_b64_tr_b16 v[58:59], v81 offset:1024
    ds_read_b64_tr_b16 v[60:61], v81 offset:8192
    ds_read_b64_tr_b16 v[62:63], v81 offset:9216
    s_waitcnt lgkmcnt(0)
    ds_write_b128 v5, v[56:59] offset:14336
    ds_write_b128 v5, v[60:63] offset:15360
    s_branch L_lw_19
L_lw_19_2:
    ds_read_b64_tr_b16 a[64:65], v80 offset:0
    ds_read_b64_tr_b16 a[66:67], v80 offset:1024
    ds_read_b64_tr_b16 a[68:69], v80 offset:8192
    ds_read_b64_tr_b16 a[70:71], v80 offset:9216
    ds_read_b64_tr_b16 v[56:57], v81 offset:0
    ds_read_b64_tr_b16 v[58:59], v81 offset:1024
    ds_read_b64_tr_b16 v[60:61], v81 offset:8192
    ds_read_b64_tr_b16 v[62:63], v81 offset:9216
    s_waitcnt lgkmcnt(0)
    ds_write_b128 v5, v[56:59] offset:8192
    ds_write_b128 v5, v[60:63] offset:9216
L_lw_19:
    s_waitcnt lgkmcnt(0)
    s_waitcnt vmcnt(8)
    s_barrier
    s_add_u32 s79, s41, 2
    s_and_b32 s79, s79, 3
    s_lshl_b32 s79, s79, 19
    s_add_u32 s79, s79, s47
    s_add_u32 s46, s79, 0x0
    s_add_u32 m0, s48, 0
    s_nop 0
    buffer_load_dwordx4 v82, s[28:31], s46 offen  lds
    s_add_u32 s46, s79, 0x20000
    s_add_u32 m0, s48, 4096
    s_nop 0
    buffer_load_dwordx4 v82, s[28:31], s46 offen  lds
    s_add_u32 s46, s79, 0x40000
    s_add_u32 m0, s48, 8192
    s_nop 0
    buffer_load_dwordx4 v82, s[28:31], s46 offen  lds
    s_add_u32 s46, s79, 0x60000
    s_add_u32 m0, s48, 12288
    s_nop 0
    buffer_load_dwordx4 v82, s[28:31], s46 offen  lds
    s_cmp_lg_u32 s44, 0
    s_cbranch_scc1 L_lw_20_0
    ds_read_b64_tr_b16 v[232:233], v80 offset:16384
    ds_read_b64_tr_b16 v[234:235], v80 offset:17408
    ds_read_b64_tr_b16 v[236:237], v80 offset:24576
    ds_read_b64_tr_b16 v[238:239], v80 offset:25600
    ds_read_b64_tr_b16 v[240:241], v81 offset:16384
    ds_read_b64_tr_b16 v[242:243], v81 offset:17408
    ds_read_b64_tr_b16 v[244:245], v81 offset:24576
    ds_read_b64_tr_b16 v[246:247], v81 offset:25600
    s_branch L_lw_20
L_lw_20_0:
    s_cmp_lg_u32 s44, 1
    s_cbranch_scc1 L_lw_20_1
    ds_read_b64_tr_b16 v[128:129], v80 offset:16384
    ds_read_b64_tr_b16 v[130:131], v80 offset:17408
    ds_read_b64_tr_b16 v[132:133], v80 offset:24576
    ds_read_b64_tr_b16 v[134:135], v80 offset:25600
    ds_read_b64_tr_b16 v[136:137], v81 offset:16384
    ds_read_b64_tr_b16 v[138:139], v81 offset:17408
    ds_read_b64_tr_b16 v[140:141], v81 offset:24576
    ds_read_b64_tr_b16 v[142:143], v81 offset:25600
    s_branch L_lw_20
L_lw_20_1:
    s_cmp_lg_u32 s44, 2
    s_cbranch_scc1 L_lw_20_2
    ds_read_b64_tr_b16 a[176:177], v80 offset:16384
    ds_read_b64_tr_b16 a[178:179], v80 offset:17408
    ds_read_b64_tr_b16 a[180:181], v80 offset:24576
    ds_read_b64_tr_b16 a[182:183], v80 offset:25600
    ds_read_b64_tr_b16 a[184:185], v81 offset:16384
    ds_read_b64_tr_b16 a[186:187], v81 offset:17408
    ds_read_b64_tr_b16 a[188:189], v81 offset:24576
    ds_read_b64_tr_b16 a[190:191], v81 offset:25600
    s_branch L_lw_20
L_lw_20_2:
    ds_read_b64_tr_b16 a[80:81], v80 offset:16384
    ds_read_b64_tr_b16 a[82:83], v80 offset:17408
    ds_read_b64_tr_b16 a[84:85], v80 offset:24576
    ds_read_b64_tr_b16 a[86:87], v80 offset:25600
    ds_read_b64_tr_b16 v[56:57], v81 offset:16384
    ds_read_b64_tr_b16 v[58:59], v81 offset:17408
    ds_read_b64_tr_b16 v[60:61], v81 offset:24576
    ds_read_b64_tr_b16 v[62:63], v81 offset:25600
    s_waitcnt lgkmcnt(0)
    ds_write_b128 v5, v[56:59] offset:16384
    ds_write_b128 v5, v[60:63] offset:17408
L_lw_20:
    s_waitcnt lgkmcnt(0)
    s_waitcnt vmcnt(8)
    s_barrier
    s_add_u32 s79, s41, 3
    s_and_b32 s79, s79, 3
    s_lshl_b32 s79, s79, 19
    s_add_u32 s79, s79, s47
    s_add_u32 s46, s79, 0x0
    s_add_u32 m0, s48, 16384
    s_nop 0
    buffer_load_dwordx4 v82, s[28:31], s46 offen  lds
    s_add_u32 s46, s79, 0x20000
    s_add_u32 m0, s48, 20480
    s_nop 0
    buffer_load_dwordx4 v82, s[28:31], s46 offen  lds
    s_add_u32 s46, s79, 0x40000
    s_add_u32 m0, s48, 24576
    s_nop 0
    buffer_load_dwordx4 v82, s[28:31], s46 offen  lds
    s_add_u32 s46, s79, 0x60000
    s_add_u32 m0, s48, 28672
    s_nop 0
    buffer_load_dwordx4 v82, s[28:31], s46 offen  lds
    s_cmp_lg_u32 s44, 0
    s_cbranch_scc1 L_lw_21_0
    ds_read_b64_tr_b16 a[16:17], v80 offset:32768
    ds_read_b64_tr_b16 a[18:19], v80 offset:33792
    ds_read_b64_tr_b16 a[20:21], v80 offset:40960
    ds_read_b64_tr_b16 a[22:23], v80 offset:41984
    ds_read_b64_tr_b16 a[24:25], v81 offset:32768
    ds_read_b64_tr_b16 a[26:27], v81 offset:33792
    ds_read_b64_tr_b16 a[28:29], v81 offset:40960
    ds_read_b64_tr_b16 a[30:31], v81 offset:41984
    s_branch L_lw_21
L_lw_21_0:
    s_cmp_lg_u32 s44, 1
    s_cbranch_scc1 L_lw_21_1
    ds_read_b64_tr_b16 v[168:169], v80 offset:32768
    ds_read_b64_tr_b16 v[170:171], v80 offset:33792
    ds_read_b64_tr_b16 v[172:173], v80 offset:40960
    ds_read_b64_tr_b16 v[174:175], v80 offset:41984
    ds_read_b64_tr_b16 v[176:177], v81 offset:32768
    ds_read_b64_tr_b16 v[178:179], v81 offset:33792
    ds_read_b64_tr_b16 v[180:181], v81 offset:40960
    ds_read_b64_tr_b16 v[182:183], v81 offset:41984
    s_branch L_lw_21
L_lw_21_1:
    s_cmp_lg_u32 s44, 2
    s_cbranch_scc1 L_lw_21_2
    ds_read_b64_tr_b16 a[216:217], v80 offset:32768
    ds_read_b64_tr_b16 a[218:219], v80 offset:33792
    ds_read_b64_tr_b16 a[220:221], v80 offset:40960
    ds_read_b64_tr_b16 a[222:223], v80 offset:41984
    ds_read_b64_tr_b16 a[224:225], v81 offset:32768
    ds_read_b64_tr_b16 a[226:227], v81 offset:33792
    ds_read_b64_tr_b16 a[228:229], v81 offset:40960
    ds_read_b64_tr_b16 a[230:231], v81 offset:41984
    s_branch L_lw_21
L_lw_21_2:
    ds_read_b64_tr_b16 a[112:113], v80 offset:32768
    ds_read_b64_tr_b16 a[114:115], v80 offset:33792
    ds_read_b64_tr_b16 a[116:117], v80 offset:40960
    ds_read_b64_tr_b16 a[118:119], v80 offset:41984
    ds_read_b64_tr_b16 a[120:121], v81 offset:32768
    ds_read_b64_tr_b16 a[122:123], v81 offset:33792
    ds_read_b64_tr_b16 a[124:125], v81 offset:40960
    ds_read_b64_tr_b16 a[126:127], v81 offset:41984
L_lw_21:
    s_waitcnt lgkmcnt(0)
    s_waitcnt vmcnt(8)
    s_barrier
    s_add_u32 s79, s41, 4
    s_and_b32 s79, s79, 3
    s_lshl_b32 s79, s79, 19
    s_add_u32 s79, s79, s47
    s_add_u32 s46, s79, 0x200000
    s_add_u32 m0, s48, 32768
    s_nop 0
    buffer_load_dwordx4 v82, s[28:31], s46 offen  lds
    s_add_u32 s46, s79, 0x220000
    s_add_u32 m0, s48, 36864
    s_nop 0
    buffer_load_dwordx4 v82, s[28:31], s46 offen  lds
    s_add_u32 s46, s79, 0x240000
    s_add_u32 m0, s48, 40960
    s_nop 0
    buffer_load_dwordx4 v82, s[28:31], s46 offen  lds
    s_add_u32 s46, s79, 0x260000
    s_add_u32 m0, s48, 45056
    s_nop 0
    buffer_load_dwordx4 v82, s[28:31], s46 offen  lds
    s_cmp_lg_u32 s44, 0
    s_cbranch_scc1 L_lw_22_0
    ds_read_b64_tr_b16 a[48:49], v80 offset:49152
    ds_read_b64_tr_b16 a[50:51], v80 offset:50176
    ds_read_b64_tr_b16 a[52:53], v80 offset:57344
    ds_read_b64_tr_b16 a[54:55], v80 offset:58368
    ds_read_b64_tr_b16 a[56:57], v81 offset:49152
    ds_read_b64_tr_b16 a[58:59], v81 offset:50176
    ds_read_b64_tr_b16 a[60:61], v81 offset:57344
    ds_read_b64_tr_b16 a[62:63], v81 offset:58368
    s_branch L_lw_22
L_lw_22_0:
    s_cmp_lg_u32 s44, 1
    s_cbranch_scc1 L_lw_22_1
    ds_read_b64_tr_b16 v[200:201], v80 offset:49152
    ds_read_b64_tr_b16 v[202:203], v80 offset:50176
    ds_read_b64_tr_b16 v[204:205], v80 offset:57344
    ds_read_b64_tr_b16 v[206:207], v80 offset:58368
    ds_read_b64_tr_b16 v[56:57], v81 offset:49152
    ds_read_b64_tr_b16 v[58:59], v81 offset:50176
    ds_read_b64_tr_b16 v[60:61], v81 offset:57344
    ds_read_b64_tr_b16 v[62:63], v81 offset:58368
    s_waitcnt lgkmcnt(0)
    ds_write_b128 v5, v[56:59] offset:18432
    ds_write_b128 v5, v[60:63] offset:19456
    s_branch L_lw_22
L_lw_22_1:
    s_cmp_lg_u32 s44, 2
    s_cbranch_scc1 L_lw_22_2
    ds_read_b64_tr_b16 a[248:249], v80 offset:49152
    ds_read_b64_tr_b16 a[250:251], v80 offset:50176
    ds_read_b64_tr_b16 a[252:253], v80 offset:57344
    ds_read_b64_tr_b16 a[254:255], v80 offset:58368
    ds_read_b64_tr_b16 v[96:97], v81 offset:49152
    ds_read_b64_tr_b16 v[98:99], v81 offset:50176
    ds_read_b64_tr_b16 v[100:101], v81 offset:57344
    ds_read_b64_tr_b16 v[102:103], v81 offset:58368
    s_branch L_lw_22
L_lw_22_2:
    ds_read_b64_tr_b16 a[136:137], v80 offset:49152
    ds_read_b64_tr_b16 a[138:139], v80 offset:50176
    ds_read_b64_tr_b16 a[140:141], v80 offset:57344
    ds_read_b64_tr_b16 a[142:143], v80 offset:58368
    ds_read_b64_tr_b16 a[144:145], v81 offset:49152
    ds_read_b64_tr_b16 a[146:147], v81 offset:50176
    ds_read_b64_tr_b16 a[148:149], v81 offset:57344
    ds_read_b64_tr_b16 a[150:151], v81 offset:58368
L_lw_22:
    s_waitcnt lgkmcnt(0)
    s_waitcnt vmcnt(8)
    s_barrier
    s_add_u32 s79, s41, 5
    s_and_b32 s79, s79, 3
    s_lshl_b32 s79, s79, 19
    s_add_u32 s79, s79, s47
    s_add_u32 s46, s79, 0x200000
    s_add_u32 m0, s48, 49152
    s_nop 0
    buffer_load_dwordx4 v82, s[28:31], s46 offen  lds
    s_add_u32 s46, s79, 0x220000
    s_add_u32 m0, s48, 53248
    s_nop 0
    buffer_load_dwordx4 v82, s[28:31], s46 offen  lds
    s_add_u32 s46, s79, 0x240000
    s_add_u32 m0, s48, 57344
    s_nop 0
    buffer_load_dwordx4 v82, s[28:31], s46 offen  lds
    s_add_u32 s46, s79, 0x260000
    s_add_u32 m0, s48, 61440
    s_nop 0
    buffer_load_dwordx4 v82, s[28:31], s46 offen  lds
    s_cmp_lg_u32 s44, 0
    s_cbranch_scc1 L_lw_23_0
    ds_read_b64_tr_b16 a[72:73], v80 offset:0
    ds_read_b64_tr_b16 a[74:75], v80 offset:1024
    ds_read_b64_tr_b16 a[76:77], v80 offset:8192
    ds_read_b64_tr_b16 a[78:79], v80 offset:9216
    ds_read_b64_tr_b16 v[56:57], v81 offset:0
    ds_read_b64_tr_b16 v[58:59], v81 offset:1024
    ds_read_b64_tr_b16 v[60:61], v81 offset:8192
    ds_read_b64_tr_b16 v[62:63], v81 offset:9216
    s_waitcnt lgkmcnt(0)
    ds_write_b128 v5, v[56:59] offset:20480
    ds_write_b128 v5, v[60:63] offset:21504
    s_branch L_lw_23
L_lw_23_0:
    s_cmp_lg_u32 s44, 1
    s_cbranch_scc1 L_lw_23_1
    ds_read_b64_tr_b16 v[216:217], v80 offset:0
    ds_read_b64_tr_b16 v[218:219], v80 offset:1024
    ds_read_b64_tr_b16 v[220:221], v80 offset:8192
    ds_read_b64_tr_b16 v[222:223], v80 offset:9216
    ds_read_b64_tr_b16 v[224:225], v81 offset:0
    ds_read_b64_tr_b16 v[226:227], v81 offset:1024
    ds_read_b64_tr_b16 v[228:229], v81 offset:8192
    ds_read_b64_tr_b16 v[230:231], v81 offset:9216
    s_branch L_lw_23
L_lw_23_1:
    s_cmp_lg_u32 s44, 2
    s_cbranch_scc1 L_lw_23_2
    ds_read_b64_tr_b16 v[112:113], v80 offset:0
    ds_read_b64_tr_b16 v[114:115], v80 offset:1024
    ds_read_b64_tr_b16 v[116:117], v80 offset:8192
    ds_read_b64_tr_b16 v[118:119], v80 offset:9216
    ds_read_b64_tr_b16 v[120:121], v81 offset:0
    ds_read_b64_tr_b16 v[122:123], v81 offset:1024
    ds_read_b64_tr_b16 v[124:125], v81 offset:8192
    ds_read_b64_tr_b16 v[126:127], v81 offset:9216
    s_branch L_lw_23
L_lw_23_2:
    ds_read_b64_tr_b16 a[160:161], v80 offset:0
    ds_read_b64_tr_b16 a[162:163], v80 offset:1024
    ds_read_b64_tr_b16 a[164:165], v80 offset:8192
    ds_read_b64_tr_b16 a[166:167], v80 offset:9216
    ds_read_b64_tr_b16 a[168:169], v81 offset:0
    ds_read_b64_tr_b16 a[170:171], v81 offset:1024
    ds_read_b64_tr_b16 a[172:173], v81 offset:8192
    ds_read_b64_tr_b16 a[174:175], v81 offset:9216
L_lw_23:
    s_waitcnt lgkmcnt(0)
    s_waitcnt vmcnt(8)
    s_barrier
    s_add_u32 s79, s41, 6
    s_and_b32 s79, s79, 3
    s_lshl_b32 s79, s79, 19
    s_add_u32 s79, s79, s47
    s_add_u32 s46, s79, 0x200000
    s_add_u32 m0, s48, 0
    s_nop 0
    buffer_load_dwordx4 v82, s[28:31], s46 offen  lds
    s_add_u32 s46, s79, 0x220000
    s_add_u32 m0, s48, 4096
    s_nop 0
    buffer_load_dwordx4 v82, s[28:31], s46 offen  lds
    s_add_u32 s46, s79, 0x240000
    s_add_u32 m0, s48, 8192
    s_nop 0
    buffer_load_dwordx4 v82, s[28:31], s46 offen  lds
    s_add_u32 s46, s79, 0x260000
    s_add_u32 m0, s48, 12288
    s_nop 0
    buffer_load_dwordx4 v82, s[28:31], s46 offen  lds
    s_cmp_lg_u32 s44, 0
    s_cbranch_scc1 L_lw_24_0
    ds_read_b64_tr_b16 a[88:89], v80 offset:16384
    ds_read_b64_tr_b16 a[90:91], v80 offset:17408
    ds_read_b64_tr_b16 a[92:93], v80 offset:24576
    ds_read_b64_tr_b16 a[94:95], v80 offset:25600
    ds_read_b64_tr_b16 a[96:97], v81 offset:16384
    ds_read_b64_tr_b16 a[98:99], v81 offset:17408
    ds_read_b64_tr_b16 a[100:101], v81 offset:24576
    ds_read_b64_tr_b16 a[102:103], v81 offset:25600
    s_branch L_lw_24
L_lw_24_0:
    s_cmp_lg_u32 s44, 1
    s_cbranch_scc1 L_lw_24_1
    ds_read_b64_tr_b16 v[248:249], v80 offset:16384
    ds_read_b64_tr_b16 v[250:251], v80 offset:17408
    ds_read_b64_tr_b16 v[252:253], v80 offset:24576
    ds_read_b64_tr_b16 v[254:255], v80 offset:25600
    ds_read_b64_tr_b16 v[56:57], v81 offset:16384
    ds_read_b64_tr_b16 v[58:59], v81 offset:17408
    ds_read_b64_tr_b16 v[60:61], v81 offset:24576
    ds_read_b64_tr_b16 v[62:63], v81 offset:25600
    s_waitcnt lgkmcnt(0)
    ds_write_b128 v5, v[56:59] offset:22528
    ds_write_b128 v5, v[60:63] offset:23552
    s_branch L_lw_24
L_lw_24_1:
    s_cmp_lg_u32 s44, 2
    s_cbranch_scc1 L_lw_24_2
    ds_read_b64_tr_b16 v[144:145], v80 offset:16384
    ds_read_b64_tr_b16 v[146:147], v80 offset:17408
    ds_read_b64_tr_b16 v[148:149], v80 offset:24576
    ds_read_b64_tr_b16 v[150:151], v80 offset:25600
    ds_read_b64_tr_b16 v[152:153], v81 offset:16384
    ds_read_b64_tr_b16 v[154:155], v81 offset:17408
    ds_read_b64_tr_b16 v[156:157], v81 offset:24576
    ds_read_b64_tr_b16 v[158:159], v81 offset:25600
    s_branch L_lw_24
L_lw_24_2:
    ds_read_b64_tr_b16 a[192:193], v80 offset:16384
    ds_read_b64_tr_b16 a[194:195], v80 offset:17408
    ds_read_b64_tr_b16 a[196:197], v80 offset:24576
    ds_read_b64_tr_b16 a[198:199], v80 offset:25600
    ds_read_b64_tr_b16 a[200:201], v81 offset:16384
    ds_read_b64_tr_b16 a[202:203], v81 offset:17408
    ds_read_b64_tr_b16 a[204:205], v81 offset:24576
    ds_read_b64_tr_b16 a[206:207], v81 offset:25600
L_lw_24:
    s_waitcnt lgkmcnt(0)
    s_waitcnt vmcnt(8)
    s_barrier
    s_add_u32 s79, s41, 7
    s_and_b32 s79, s79, 3
    s_lshl_b32 s79, s79, 19
    s_add_u32 s79, s79, s47
    s_add_u32 s46, s79, 0x200000
    s_add_u32 m0, s48, 16384
    s_nop 0
    buffer_load_dwordx4 v82, s[28:31], s46 offen  lds
    s_add_u32 s46, s79, 0x220000
    s_add_u32 m0, s48, 20480
    s_nop 0
    buffer_load_dwordx4 v82, s[28:31], s46 offen  lds
    s_add_u32 s46, s79, 0x240000
    s_add_u32 m0, s48, 24576
    s_nop 0
    buffer_load_dwordx4 v82, s[28:31], s46 offen  lds
    s_add_u32 s46, s79, 0x260000
    s_add_u32 m0, s48, 28672
    s_nop 0
    buffer_load_dwordx4 v82, s[28:31], s46 offen  lds
    s_cmp_lg_u32 s44, 0
    s_cbranch_scc1 L_lw_25_0
    ds_read_b64_tr_b16 a[112:113], v80 offset:32768
    ds_read_b64_tr_b16 a[114:115], v80 offset:33792
    ds_read_b64_tr_b16 a[116:117], v80 offset:40960
    ds_read_b64_tr_b16 a[118:119], v80 offset:41984
    ds_read_b64_tr_b16 a[120:121], v81 offset:32768
    ds_read_b64_tr_b16 a[122:123], v81 offset:33792
    ds_read_b64_tr_b16 a[124:125], v81 offset:40960
    ds_read_b64_tr_b16 a[126:127], v81 offset:41984
    s_branch L_lw_25
L_lw_25_0:
    s_cmp_lg_u32 s44, 1
    s_cbranch_scc1 L_lw_25_1
    ds_read_b64_tr_b16 a[16:17], v80 offset:32768
    ds_read_b64_tr_b16 a[18:19], v80 offset:33792
    ds_read_b64_tr_b16 a[20:21], v80 offset:40960
    ds_read_b64_tr_b16 a[22:23], v80 offset:41984
    ds_read_b64_tr_b16 a[24:25], v81 offset:32768
    ds_read_b64_tr_b16 a[26:27], v81 offset:33792
    ds_read_b64_tr_b16 a[28:29], v81 offset:40960
    ds_read_b64_tr_b16 a[30:31], v81 offset:41984
    s_branch L_lw_25
L_lw_25_1:
    s_cmp_lg_u32 s44, 2
    s_cbranch_scc1 L_lw_25_2
    ds_read_b64_tr_b16 v[168:169], v80 offset:32768
    ds_read_b64_tr_b16 v[170:171], v80 offset:33792
    ds_read_b64_tr_b16 v[172:173], v80 offset:40960
    ds_read_b64_tr_b16 v[174:175], v80 offset:41984
    ds_read_b64_tr_b16 v[176:177], v81 offset:32768
    ds_read_b64_tr_b16 v[178:179], v81 offset:33792
    ds_read_b64_tr_b16 v[180:181], v81 offset:40960
    ds_read_b64_tr_b16 v[182:183], v81 offset:41984
    s_branch L_lw_25
L_lw_25_2:
    ds_read_b64_tr_b16 a[216:217], v80 offset:32768
    ds_read_b64_tr_b16 a[218:219], v80 offset:33792
    ds_read_b64_tr_b16 a[220:221], v80 offset:40960
    ds_read_b64_tr_b16 a[222:223], v80 offset:41984
    ds_read_b64_tr_b16 a[224:225], v81 offset:32768
    ds_read_b64_tr_b16 a[226:227], v81 offset:33792
    ds_read_b64_tr_b16 a[228:229], v81 offset:40960
    ds_read_b64_tr_b16 a[230:231], v81 offset:41984
L_lw_25:
    s_waitcnt lgkmcnt(0)
    s_waitcnt vmcnt(8)
    s_barrier
    s_add_u32 s79, s41, 8
    s_and_b32 s79, s79, 3
    s_lshl_b32 s79, s79, 19
    s_add_u32 s79, s79, s47
    s_add_u32 s46, s79, 0x400000
    s_add_u32 m0, s48, 32768
    s_nop 0
    buffer_load_dwordx4 v82, s[28:31], s46 offen  lds
    s_add_u32 s46, s79, 0x420000
    s_add_u32 m0, s48, 36864
    s_nop 0
    buffer_load_dwordx4 v82, s[28:31], s46 offen  lds
    s_add_u32 s46, s79, 0x440000
    s_add_u32 m0, s48, 40960
    s_nop 0
    buffer_load_dwordx4 v82, s[28:31], s46 offen  lds
    s_add_u32 s46, s79, 0x460000
    s_add_u32 m0, s48, 45056
    s_nop 0
    buffer_load_dwordx4 v82, s[28:31], s46 offen  lds
    s_cmp_lg_u32 s44, 0
    s_cbranch_scc1 L_lw_26_0
    ds_read_b64_tr_b16 a[136:137], v80 offset:49152
    ds_read_b64_tr_b16 a[138:139], v80 offset:50176
    ds_read_b64_tr_b16 a[140:141], v80 offset:57344
    ds_read_b64_tr_b16 a[142:143], v80 offset:58368
    ds_read_b64_tr_b16 a[144:145], v81 offset:49152
    ds_read_b64_tr_b16 a[146:147], v81 offset:50176
    ds_read_b64_tr_b16 a[148:149], v81 offset:57344
    ds_read_b64_tr_b16 a[150:151], v81 offset:58368
    s_branch L_lw_26
L_lw_26_0:
    s_cmp_lg_u32 s44, 1
    s_cbranch_scc1 L_lw_26_1
    ds_read_b64_tr_b16 a[48:49], v80 offset:49152
    ds_read_b64_tr_b16 a[50:51], v80 offset:50176
    ds_read_b64_tr_b16 a[52:53], v80 offset:57344
    ds_read_b64_tr_b16 a[54:55], v80 offset:58368
    ds_read_b64_tr_b16 a[56:57], v81 offset:49152
    ds_read_b64_tr_b16 a[58:59], v81 offset:50176
    ds_read_b64_tr_b16 a[60:61], v81 offset:57344
    ds_read_b64_tr_b16 a[62:63], v81 offset:58368
    s_branch L_lw_26
L_lw_26_1:
    s_cmp_lg_u32 s44, 2
    s_cbranch_scc1 L_lw_26_2
    ds_read_b64_tr_b16 v[200:201], v80 offset:49152
    ds_read_b64_tr_b16 v[202:203], v80 offset:50176
    ds_read_b64_tr_b16 v[204:205], v80 offset:57344
    ds_read_b64_tr_b16 v[206:207], v80 offset:58368
    ds_read_b64_tr_b16 v[56:57], v81 offset:49152
    ds_read_b64_tr_b16 v[58:59], v81 offset:50176
    ds_read_b64_tr_b16 v[60:61], v81 offset:57344
    ds_read_b64_tr_b16 v[62:63], v81 offset:58368
    s_waitcnt lgkmcnt(0)
    ds_write_b128 v5, v[56:59] offset:18432
    ds_write_b128 v5, v[60:63] offset:19456
    s_branch L_lw_26
L_lw_26_2:
    ds_read_b64_tr_b16 a[248:249], v80 offset:49152
    ds_read_b64_tr_b16 a[250:251], v80 offset:50176
    ds_read_b64_tr_b16 a[252:253], v80 offset:57344
    ds_read_b64_tr_b16 a[254:255], v80 offset:58368
    ds_read_b64_tr_b16 v[96:97], v81 offset:49152
    ds_read_b64_tr_b16 v[98:99], v81 offset:50176
    ds_read_b64_tr_b16 v[100:101], v81 offset:57344
    ds_read_b64_tr_b16 v[102:103], v81 offset:58368
L_lw_26:
    s_waitcnt lgkmcnt(0)
    s_waitcnt vmcnt(8)
    s_barrier
    s_add_u32 s79, s41, 9
    s_and_b32 s79, s79, 3
    s_lshl_b32 s79, s79, 19
    s_add_u32 s79, s79, s47
    s_add_u32 s46, s79, 0x400000
    s_add_u32 m0, s48, 49152
    s_nop 0
    buffer_load_dwordx4 v82, s[28:31], s46 offen  lds
    s_add_u32 s46, s79, 0x420000
    s_add_u32 m0, s48, 53248
    s_nop 0
    buffer_load_dwordx4 v82, s[28:31], s46 offen  lds
    s_add_u32 s46, s79, 0x440000
    s_add_u32 m0, s48, 57344
    s_nop 0
    buffer_load_dwordx4 v82, s[28:31], s46 offen  lds
    s_add_u32 s46, s79, 0x460000
    s_add_u32 m0, s48, 61440
    s_nop 0
    buffer_load_dwordx4 v82, s[28:31], s46 offen  lds
    s_cmp_lg_u32 s44, 0
    s_cbranch_scc1 L_lw_27_0
    ds_read_b64_tr_b16 a[160:161], v80 offset:0
    ds_read_b64_tr_b16 a[162:163], v80 offset:1024
    ds_read_b64_tr_b16 a[164:165], v80 offset:8192
    ds_read_b64_tr_b16 a[166:167], v80 offset:9216
    ds_read_b64_tr_b16 a[168:169], v81 offset:0
    ds_read_b64_tr_b16 a[170:171], v81 offset:1024
    ds_read_b64_tr_b16 a[172:173], v81 offset:8192
    ds_read_b64_tr_b16 a[174:175], v81 offset:9216
    s_branch L_lw_27
L_lw_27_0:
    s_cmp_lg_u32 s44, 1
    s_cbranch_scc1 L_lw_27_1
    ds_read_b64_tr_b16 a[72:73], v80 offset:0
    ds_read_b64_tr_b16 a[74:75], v80 offset:1024
    ds_read_b64_tr_b16 a[76:77], v80 offset:8192
    ds_read_b64_tr_b16 a[78:79], v80 offset:9216
    ds_read_b64_tr_b16 v[56:57], v81 offset:0
    ds_read_b64_tr_b16 v[58:59], v81 offset:1024
    ds_read_b64_tr_b16 v[60:61], v81 offset:8192
    ds_read_b64_tr_b16 v[62:63], v81 offset:9216
    s_waitcnt lgkmcnt(0)
    ds_write_b128 v5, v[56:59] offset:20480
    ds_write_b128 v5, v[60:63] offset:21504
    s_branch L_lw_27
L_lw_27_1:
    s_cmp_lg_u32 s44, 2
    s_cbranch_scc1 L_lw_27_2
    ds_read_b64_tr_b16 v[216:217], v80 offset:0
    ds_read_b64_tr_b16 v[218:219], v80 offset:1024
    ds_read_b64_tr_b16 v[220:221], v80 offset:8192
    ds_read_b64_tr_b16 v[222:223], v80 offset:9216
    ds_read_b64_tr_b16 v[224:225], v81 offset:0
    ds_read_b64_tr_b16 v[226:227], v81 offset:1024
    ds_read_b64_tr_b16 v[228:229], v81 offset:8192
    ds_read_b64_tr_b16 v[230:231], v81 offset:9216
    s_branch L_lw_27
L_lw_27_2:
    ds_read_b64_tr_b16 v[112:113], v80 offset:0
    ds_read_b64_tr_b16 v[114:115], v80 offset:1024
    ds_read_b64_tr_b16 v[116:117], v80 offset:8192
    ds_read_b64_tr_b16 v[118:119], v80 offset:9216
    ds_read_b64_tr_b16 v[120:121], v81 offset:0
    ds_read_b64_tr_b16 v[122:123], v81 offset:1024
    ds_read_b64_tr_b16 v[124:125], v81 offset:8192
    ds_read_b64_tr_b16 v[126:127], v81 offset:9216
L_lw_27:
    s_waitcnt lgkmcnt(0)
    s_waitcnt vmcnt(8)
    s_barrier
    s_add_u32 s79, s41, 10
    s_and_b32 s79, s79, 3
    s_lshl_b32 s79, s79, 19
    s_add_u32 s79, s79, s47
    s_add_u32 s46, s79, 0x400000
    s_add_u32 m0, s48, 0
    s_nop 0
    buffer_load_dwordx4 v82, s[28:31], s46 offen  lds
    s_add_u32 s46, s79, 0x420000
    s_add_u32 m0, s48, 4096
    s_nop 0
    buffer_load_dwordx4 v82, s[28:31], s46 offen  lds
    s_add_u32 s46, s79, 0x440000
    s_add_u32 m0, s48, 8192
    s_nop 0
    buffer_load_dwordx4 v82, s[28:31], s46 offen  lds
    s_add_u32 s46, s79, 0x460000
    s_add_u32 m0, s48, 12288
    s_nop 0
    buffer_load_dwordx4 v82, s[28:31], s46 offen  lds
    s_cmp_lg_u32 s44, 0
    s_cbranch_scc1 L_lw_28_0
    ds_read_b64_tr_b16 a[192:193], v80 offset:16384
    ds_read_b64_tr_b16 a[194:195], v80 offset:17408
    ds_read_b64_tr_b16 a[196:197], v80 offset:24576
    ds_read_b64_tr_b16 a[198:199], v80 offset:25600
    ds_read_b64_tr_b16 a[200:201], v81 offset:16384
    ds_read_b64_tr_b16 a[202:203], v81 offset:17408
    ds_read_b64_tr_b16 a[204:205], v81 offset:24576
    ds_read_b64_tr_b16 a[206:207], v81 offset:25600
    s_branch L_lw_28
L_lw_28_0:
    s_cmp_lg_u32 s44, 1
    s_cbranch_scc1 L_lw_28_1
    ds_read_b64_tr_b16 a[88:89], v80 offset:16384
    ds_read_b64_tr_b16 a[90:91], v80 offset:17408
    ds_read_b64_tr_b16 a[92:93], v80 offset:24576
    ds_read_b64_tr_b16 a[94:95], v80 offset:25600
    ds_read_b64_tr_b16 a[96:97], v81 offset:16384
    ds_read_b64_tr_b16 a[98:99], v81 offset:17408
    ds_read_b64_tr_b16 a[100:101], v81 offset:24576
    ds_read_b64_tr_b16 a[102:103], v81 offset:25600
    s_branch L_lw_28
L_lw_28_1:
    s_cmp_lg_u32 s44, 2
    s_cbranch_scc1 L_lw_28_2
    ds_read_b64_tr_b16 v[248:249], v80 offset:16384
    ds_read_b64_tr_b16 v[250:251], v80 offset:17408
    ds_read_b64_tr_b16 v[252:253], v80 offset:24576
    ds_read_b64_tr_b16 v[254:255], v80 offset:25600
    ds_read_b64_tr_b16 v[56:57], v81 offset:16384
    ds_read_b64_tr_b16 v[58:59], v81 offset:17408
    ds_read_b64_tr_b16 v[60:61], v81 offset:24576
    ds_read_b64_tr_b16 v[62:63], v81 offset:25600
    s_waitcnt lgkmcnt(0)
    ds_write_b128 v5, v[56:59] offset:22528
    ds_write_b128 v5, v[60:63] offset:23552
    s_branch L_lw_28
L_lw_28_2:
    ds_read_b64_tr_b16 v[144:145], v80 offset:16384
    ds_read_b64_tr_b16 v[146:147], v80 offset:17408
    ds_read_b64_tr_b16 v[148:149], v80 offset:24576
    ds_read_b64_tr_b16 v[150:151], v80 offset:25600
    ds_read_b64_tr_b16 v[152:153], v81 offset:16384
    ds_read_b64_tr_b16 v[154:155], v81 offset:17408
    ds_read_b64_tr_b16 v[156:157], v81 offset:24576
    ds_read_b64_tr_b16 v[158:159], v81 offset:25600
L_lw_28:
    s_waitcnt lgkmcnt(0)
    s_waitcnt vmcnt(8)
    s_barrier
    s_add_u32 s79, s41, 11
    s_and_b32 s79, s79, 3
    s_lshl_b32 s79, s79, 19
    s_add_u32 s79, s79, s47
    s_add_u32 s46, s79, 0x400000
    s_add_u32 m0, s48, 16384
    s_nop 0
    buffer_load_dwordx4 v82, s[28:31], s46 offen  lds
    s_add_u32 s46, s79, 0x420000
    s_add_u32 m0, s48, 20480
    s_nop 0
    buffer_load_dwordx4 v82, s[28:31], s46 offen  lds
    s_add_u32 s46, s79, 0x440000
    s_add_u32 m0, s48, 24576
    s_nop 0
    buffer_load_dwordx4 v82, s[28:31], s46 offen  lds
    s_add_u32 s46, s79, 0x460000
    s_add_u32 m0, s48, 28672
    s_nop 0
    buffer_load_dwordx4 v82, s[28:31], s46 offen  lds
    s_cmp_lg_u32 s44, 0
    s_cbranch_scc1 L_lw_29_0
    ds_read_b64_tr_b16 a[216:217], v80 offset:32768
    ds_read_b64_tr_b16 a[218:219], v80 offset:33792
    ds_read_b64_tr_b16 a[220:221], v80 offset:40960
    ds_read_b64_tr_b16 a[222:223], v80 offset:41984
    ds_read_b64_tr_b16 a[224:225], v81 offset:32768
    ds_read_b64_tr_b16 a[226:227], v81 offset:33792
    ds_read_b64_tr_b16 a[228:229], v81 offset:40960
    ds_read_b64_tr_b16 a[230:231], v81 offset:41984
    s_branch L_lw_29
L_lw_29_0:
    s_cmp_lg_u32 s44, 1
    s_cbranch_scc1 L_lw_29_1
    ds_read_b64_tr_b16 a[112:113], v80 offset:32768
    ds_read_b64_tr_b16 a[114:115], v80 offset:33792
    ds_read_b64_tr_b16 a[116:117], v80 offset:40960
    ds_read_b64_tr_b16 a[118:119], v80 offset:41984
    ds_read_b64_tr_b16 a[120:121], v81 offset:32768
    ds_read_b64_tr_b16 a[122:123], v81 offset:33792
    ds_read_b64_tr_b16 a[124:125], v81 offset:40960
    ds_read_b64_tr_b16 a[126:127], v81 offset:41984
    s_branch L_lw_29
L_lw_29_1:
    s_cmp_lg_u32 s44, 2
    s_cbranch_scc1 L_lw_29_2
    ds_read_b64_tr_b16 a[16:17], v80 offset:32768
    ds_read_b64_tr_b16 a[18:19], v80 offset:33792
    ds_read_b64_tr_b16 a[20:21], v80 offset:40960
    ds_read_b64_tr_b16 a[22:23], v80 offset:41984
    ds_read_b64_tr_b16 a[24:25], v81 offset:32768
    ds_read_b64_tr_b16 a[26:27], v81 offset:33792
    ds_read_b64_tr_b16 a[28:29], v81 offset:40960
    ds_read_b64_tr_b16 a[30:31], v81 offset:41984
    s_branch L_lw_29
L_lw_29_2:
    ds_read_b64_tr_b16 v[168:169], v80 offset:32768
    ds_read_b64_tr_b16 v[170:171], v80 offset:33792
    ds_read_b64_tr_b16 v[172:173], v80 offset:40960
    ds_read_b64_tr_b16 v[174:175], v80 offset:41984
    ds_read_b64_tr_b16 v[176:177], v81 offset:32768
    ds_read_b64_tr_b16 v[178:179], v81 offset:33792
    ds_read_b64_tr_b16 v[180:181], v81 offset:40960
    ds_read_b64_tr_b16 v[182:183], v81 offset:41984
L_lw_29:
    s_waitcnt lgkmcnt(0)
    s_waitcnt vmcnt(8)
    s_barrier
    s_add_u32 s79, s41, 12
    s_and_b32 s79, s79, 3
    s_lshl_b32 s79, s79, 19
    s_add_u32 s79, s79, s47
    s_add_u32 s46, s79, 0x600000
    s_add_u32 m0, s48, 32768
    s_nop 0
    buffer_load_dwordx4 v82, s[28:31], s46 offen  lds
    s_add_u32 s46, s79, 0x620000
    s_add_u32 m0, s48, 36864
    s_nop 0
    buffer_load_dwordx4 v82, s[28:31], s46 offen  lds
    s_add_u32 s46, s79, 0x640000
    s_add_u32 m0, s48, 40960
    s_nop 0
    buffer_load_dwordx4 v82, s[28:31], s46 offen  lds
    s_add_u32 s46, s79, 0x660000
    s_add_u32 m0, s48, 45056
    s_nop 0
    buffer_load_dwordx4 v82, s[28:31], s46 offen  lds
    s_cmp_lg_u32 s44, 0
    s_cbranch_scc1 L_lw_30_0
    ds_read_b64_tr_b16 a[248:249], v80 offset:49152
    ds_read_b64_tr_b16 a[250:251], v80 offset:50176
    ds_read_b64_tr_b16 a[252:253], v80 offset:57344
    ds_read_b64_tr_b16 a[254:255], v80 offset:58368
    ds_read_b64_tr_b16 v[96:97], v81 offset:49152
    ds_read_b64_tr_b16 v[98:99], v81 offset:50176
    ds_read_b64_tr_b16 v[100:101], v81 offset:57344
    ds_read_b64_tr_b16 v[102:103], v81 offset:58368
    s_branch L_lw_30
L_lw_30_0:
    s_cmp_lg_u32 s44, 1
    s_cbranch_scc1 L_lw_30_1
    ds_read_b64_tr_b16 a[136:137], v80 offset:49152
    ds_read_b64_tr_b16 a[138:139], v80 offset:50176
    ds_read_b64_tr_b16 a[140:141], v80 offset:57344
    ds_read_b64_tr_b16 a[142:143], v80 offset:58368
    ds_read_b64_tr_b16 a[144:145], v81 offset:49152
    ds_read_b64_tr_b16 a[146:147], v81 offset:50176
    ds_read_b64_tr_b16 a[148:149], v81 offset:57344
    ds_read_b64_tr_b16 a[150:151], v81 offset:58368
    s_branch L_lw_30
L_lw_30_1:
    s_cmp_lg_u32 s44, 2
    s_cbranch_scc1 L_lw_30_2
    ds_read_b64_tr_b16 a[48:49], v80 offset:49152
    ds_read_b64_tr_b16 a[50:51], v80 offset:50176
    ds_read_b64_tr_b16 a[52:53], v80 offset:57344
    ds_read_b64_tr_b16 a[54:55], v80 offset:58368
    ds_read_b64_tr_b16 a[56:57], v81 offset:49152
    ds_read_b64_tr_b16 a[58:59], v81 offset:50176
    ds_read_b64_tr_b16 a[60:61], v81 offset:57344
    ds_read_b64_tr_b16 a[62:63], v81 offset:58368
    s_branch L_lw_30
L_lw_30_2:
    ds_read_b64_tr_b16 v[200:201], v80 offset:49152
    ds_read_b64_tr_b16 v[202:203], v80 offset:50176
    ds_read_b64_tr_b16 v[204:205], v80 offset:57344
    ds_read_b64_tr_b16 v[206:207], v80 offset:58368
    ds_read_b64_tr_b16 v[56:57], v81 offset:49152
    ds_read_b64_tr_b16 v[58:59], v81 offset:50176
    ds_read_b64_tr_b16 v[60:61], v81 offset:57344
    ds_read_b64_tr_b16 v[62:63], v81 offset:58368
    s_waitcnt lgkmcnt(0)
    ds_write_b128 v5, v[56:59] offset:18432
    ds_write_b128 v5, v[60:63] offset:19456
L_lw_30:
    s_waitcnt lgkmcnt(0)
    s_waitcnt vmcnt(8)
    s_barrier
    s_add_u32 s79, s41, 13
    s_and_b32 s79, s79, 3
    s_lshl_b32 s79, s79, 19
    s_add_u32 s79, s79, s47
    s_add_u32 s46, s79, 0x600000
    s_add_u32 m0, s48, 49152
    s_nop 0
    buffer_load_dwordx4 v82, s[28:31], s46 offen  lds
    s_add_u32 s46, s79, 0x620000
    s_add_u32 m0, s48, 53248
    s_nop 0
    buffer_load_dwordx4 v82, s[28:31], s46 offen  lds
    s_add_u32 s46, s79, 0x640000
    s_add_u32 m0, s48, 57344
    s_nop 0
    buffer_load_dwordx4 v82, s[28:31], s46 offen  lds
    s_add_u32 s46, s79, 0x660000
    s_add_u32 m0, s48, 61440
    s_nop 0
    buffer_load_dwordx4 v82, s[28:31], s46 offen  lds
    s_cmp_lg_u32 s44, 0
    s_cbranch_scc1 L_lw_31_0
    ds_read_b64_tr_b16 v[112:113], v80 offset:0
    ds_read_b64_tr_b16 v[114:115], v80 offset:1024
    ds_read_b64_tr_b16 v[116:117], v80 offset:8192
    ds_read_b64_tr_b16 v[118:119], v80 offset:9216
    ds_read_b64_tr_b16 v[120:121], v81 offset:0
    ds_read_b64_tr_b16 v[122:123], v81 offset:1024
    ds_read_b64_tr_b16 v[124:125], v81 offset:8192
    ds_read_b64_tr_b16 v[126:127], v81 offset:9216
    s_branch L_lw_31
L_lw_31_0:
    s_cmp_lg_u32 s44, 1
    s_cbranch_scc1 L_lw_31_1
    ds_read_b64_tr_b16 a[160:161], v80 offset:0
    ds_read_b64_tr_b16 a[162:163], v80 offset:1024
    ds_read_b64_tr_b16 a[164:165], v80 offset:8192
    ds_read_b64_tr_b16 a[166:167], v80 offset:9216
    ds_read_b64_tr_b16 a[168:169], v81 offset:0
    ds_read_b64_tr_b16 a[170:171], v81 offset:1024
    ds_read_b64_tr_b16 a[172:173], v81 offset:8192
    ds_read_b64_tr_b16 a[174:175], v81 offset:9216
    s_branch L_lw_31
L_lw_31_1:
    s_cmp_lg_u32 s44, 2
    s_cbranch_scc1 L_lw_31_2
    ds_read_b64_tr_b16 a[72:73], v80 offset:0
    ds_read_b64_tr_b16 a[74:75], v80 offset:1024
    ds_read_b64_tr_b16 a[76:77], v80 offset:8192
    ds_read_b64_tr_b16 a[78:79], v80 offset:9216
    ds_read_b64_tr_b16 v[56:57], v81 offset:0
    ds_read_b64_tr_b16 v[58:59], v81 offset:1024
    ds_read_b64_tr_b16 v[60:61], v81 offset:8192
    ds_read_b64_tr_b16 v[62:63], v81 offset:9216
    s_waitcnt lgkmcnt(0)
    ds_write_b128 v5, v[56:59] offset:20480
    ds_write_b128 v5, v[60:63] offset:21504
    s_branch L_lw_31
L_lw_31_2:
    ds_read_b64_tr_b16 v[216:217], v80 offset:0
    ds_read_b64_tr_b16 v[218:219], v80 offset:1024
    ds_read_b64_tr_b16 v[220:221], v80 offset:8192
    ds_read_b64_tr_b16 v[222:223], v80 offset:9216
    ds_read_b64_tr_b16 v[224:225], v81 offset:0
    ds_read_b64_tr_b16 v[226:227], v81 offset:1024
    ds_read_b64_tr_b16 v[228:229], v81 offset:8192
    ds_read_b64_tr_b16 v[230:231], v81 offset:9216
L_lw_31:
    s_waitcnt lgkmcnt(0)
    s_waitcnt vmcnt(8)
    s_barrier
    s_add_u32 s79, s41, 14
    s_and_b32 s79, s79, 3
    s_lshl_b32 s79, s79, 19
    s_add_u32 s79, s79, s47
    s_add_u32 s46, s79, 0x600000
    s_add_u32 m0, s48, 0
    s_nop 0
    buffer_load_dwordx4 v82, s[28:31], s46 offen  lds
    s_add_u32 s46, s79, 0x620000
    s_add_u32 m0, s48, 4096
    s_nop 0
    buffer_load_dwordx4 v82, s[28:31], s46 offen  lds
    s_add_u32 s46, s79, 0x640000
    s_add_u32 m0, s48, 8192
    s_nop 0
    buffer_load_dwordx4 v82, s[28:31], s46 offen  lds
    s_add_u32 s46, s79, 0x660000
    s_add_u32 m0, s48, 12288
    s_nop 0
    buffer_load_dwordx4 v82, s[28:31], s46 offen  lds
    s_cmp_lg_u32 s44, 0
    s_cbranch_scc1 L_lw_32_0
    ds_read_b64_tr_b16 v[144:145], v80 offset:16384
    ds_read_b64_tr_b16 v[146:147], v80 offset:17408
    ds_read_b64_tr_b16 v[148:149], v80 offset:24576
    ds_read_b64_tr_b16 v[150:151], v80 offset:25600
    ds_read_b64_tr_b16 v[152:153], v81 offset:16384
    ds_read_b64_tr_b16 v[154:155], v81 offset:17408
    ds_read_b64_tr_b16 v[156:157], v81 offset:24576
    ds_read_b64_tr_b16 v[158:159], v81 offset:25600
    s_branch L_lw_32
L_lw_32_0:
    s_cmp_lg_u32 s44, 1
    s_cbranch_scc1 L_lw_32_1
    ds_read_b64_tr_b16 a[192:193], v80 offset:16384
    ds_read_b64_tr_b16 a[194:195], v80 offset:17408
    ds_read_b64_tr_b16 a[196:197], v80 offset:24576
    ds_read_b64_tr_b16 a[198:199], v80 offset:25600
    ds_read_b64_tr_b16 a[200:201], v81 offset:16384
    ds_read_b64_tr_b16 a[202:203], v81 offset:17408
    ds_read_b64_tr_b16 a[204:205], v81 offset:24576
    ds_read_b64_tr_b16 a[206:207], v81 offset:25600
    s_branch L_lw_32
L_lw_32_1:
    s_cmp_lg_u32 s44, 2
    s_cbranch_scc1 L_lw_32_2
    ds_read_b64_tr_b16 a[88:89], v80 offset:16384
    ds_read_b64_tr_b16 a[90:91], v80 offset:17408
    ds_read_b64_tr_b16 a[92:93], v80 offset:24576
    ds_read_b64_tr_b16 a[94:95], v80 offset:25600
    ds_read_b64_tr_b16 a[96:97], v81 offset:16384
    ds_read_b64_tr_b16 a[98:99], v81 offset:17408
    ds_read_b64_tr_b16 a[100:101], v81 offset:24576
    ds_read_b64_tr_b16 a[102:103], v81 offset:25600
    s_branch L_lw_32
L_lw_32_2:
    ds_read_b64_tr_b16 v[248:249], v80 offset:16384
    ds_read_b64_tr_b16 v[250:251], v80 offset:17408
    ds_read_b64_tr_b16 v[252:253], v80 offset:24576
    ds_read_b64_tr_b16 v[254:255], v80 offset:25600
    ds_read_b64_tr_b16 v[56:57], v81 offset:16384
    ds_read_b64_tr_b16 v[58:59], v81 offset:17408
    ds_read_b64_tr_b16 v[60:61], v81 offset:24576
    ds_read_b64_tr_b16 v[62:63], v81 offset:25600
    s_waitcnt lgkmcnt(0)
    ds_write_b128 v5, v[56:59] offset:22528
    ds_write_b128 v5, v[60:63] offset:23552
L_lw_32:
    s_waitcnt lgkmcnt(0)
    s_waitcnt vmcnt(8)
    s_barrier
    s_add_u32 s79, s41, 15
    s_and_b32 s79, s79, 3
    s_lshl_b32 s79, s79, 19
    s_add_u32 s79, s79, s47
    s_add_u32 s46, s79, 0x600000
    s_add_u32 m0, s48, 16384
    s_nop 0
    buffer_load_dwordx4 v82, s[28:31], s46 offen  lds
    s_add_u32 s46, s79, 0x620000
    s_add_u32 m0, s48, 20480
    s_nop 0
    buffer_load_dwordx4 v82, s[28:31], s46 offen  lds
    s_add_u32 s46, s79, 0x640000
    s_add_u32 m0, s48, 24576
    s_nop 0
    buffer_load_dwordx4 v82, s[28:31], s46 offen  lds
    s_add_u32 s46, s79, 0x660000
    s_add_u32 m0, s48, 28672
    s_nop 0
    buffer_load_dwordx4 v82, s[28:31], s46 offen  lds
    s_cmp_lg_u32 s44, 0
    s_cbranch_scc1 L_lw_33_0
    ds_read_b64_tr_b16 v[168:169], v80 offset:32768
    ds_read_b64_tr_b16 v[170:171], v80 offset:33792
    ds_read_b64_tr_b16 v[172:173], v80 offset:40960
    ds_read_b64_tr_b16 v[174:175], v80 offset:41984
    ds_read_b64_tr_b16 v[176:177], v81 offset:32768
    ds_read_b64_tr_b16 v[178:179], v81 offset:33792
    ds_read_b64_tr_b16 v[180:181], v81 offset:40960
    ds_read_b64_tr_b16 v[182:183], v81 offset:41984
    s_branch L_lw_33
L_lw_33_0:
    s_cmp_lg_u32 s44, 1
    s_cbranch_scc1 L_lw_33_1
    ds_read_b64_tr_b16 a[216:217], v80 offset:32768
    ds_read_b64_tr_b16 a[218:219], v80 offset:33792
    ds_read_b64_tr_b16 a[220:221], v80 offset:40960
    ds_read_b64_tr_b16 a[222:223], v80 offset:41984
    ds_read_b64_tr_b16 a[224:225], v81 offset:32768
    ds_read_b64_tr_b16 a[226:227], v81 offset:33792
    ds_read_b64_tr_b16 a[228:229], v81 offset:40960
    ds_read_b64_tr_b16 a[230:231], v81 offset:41984
    s_branch L_lw_33
L_lw_33_1:
    s_cmp_lg_u32 s44, 2
    s_cbranch_scc1 L_lw_33_2
    ds_read_b64_tr_b16 a[112:113], v80 offset:32768
    ds_read_b64_tr_b16 a[114:115], v80 offset:33792
    ds_read_b64_tr_b16 a[116:117], v80 offset:40960
    ds_read_b64_tr_b16 a[118:119], v80 offset:41984
    ds_read_b64_tr_b16 a[120:121], v81 offset:32768
    ds_read_b64_tr_b16 a[122:123], v81 offset:33792
    ds_read_b64_tr_b16 a[124:125], v81 offset:40960
    ds_read_b64_tr_b16 a[126:127], v81 offset:41984
    s_branch L_lw_33
L_lw_33_2:
    ds_read_b64_tr_b16 a[16:17], v80 offset:32768
    ds_read_b64_tr_b16 a[18:19], v80 offset:33792
    ds_read_b64_tr_b16 a[20:21], v80 offset:40960
    ds_read_b64_tr_b16 a[22:23], v80 offset:41984
    ds_read_b64_tr_b16 a[24:25], v81 offset:32768
    ds_read_b64_tr_b16 a[26:27], v81 offset:33792
    ds_read_b64_tr_b16 a[28:29], v81 offset:40960
    ds_read_b64_tr_b16 a[30:31], v81 offset:41984
L_lw_33:
    s_waitcnt lgkmcnt(0)
    s_waitcnt vmcnt(8)
    s_barrier
    s_cmp_lg_u32 s44, 0
    s_cbranch_scc1 L_lw_34_0
    ds_read_b64_tr_b16 v[200:201], v80 offset:49152
    ds_read_b64_tr_b16 v[202:203], v80 offset:50176
    ds_read_b64_tr_b16 v[204:205], v80 offset:57344
    ds_read_b64_tr_b16 v[206:207], v80 offset:58368
    ds_read_b64_tr_b16 v[56:57], v81 offset:49152
    ds_read_b64_tr_b16 v[58:59], v81 offset:50176
    ds_read_b64_tr_b16 v[60:61], v81 offset:57344
    ds_read_b64_tr_b16 v[62:63], v81 offset:58368
    s_waitcnt lgkmcnt(0)
    ds_write_b128 v5, v[56:59] offset:18432
    ds_write_b128 v5, v[60:63] offset:19456
    s_branch L_lw_34
L_lw_34_0:
    s_cmp_lg_u32 s44, 1
    s_cbranch_scc1 L_lw_34_1
    ds_read_b64_tr_b16 a[248:249], v80 offset:49152
    ds_read_b64_tr_b16 a[250:251], v80 offset:50176
    ds_read_b64_tr_b16 a[252:253], v80 offset:57344
    ds_read_b64_tr_b16 a[254:255], v80 offset:58368
    ds_read_b64_tr_b16 v[96:97], v81 offset:49152
    ds_read_b64_tr_b16 v[98:99], v81 offset:50176
    ds_read_b64_tr_b16 v[100:101], v81 offset:57344
    ds_read_b64_tr_b16 v[102:103], v81 offset:58368
    s_branch L_lw_34
L_lw_34_1:
    s_cmp_lg_u32 s44, 2
    s_cbranch_scc1 L_lw_34_2
    ds_read_b64_tr_b16 a[136:137], v80 offset:49152
    ds_read_b64_tr_b16 a[138:139], v80 offset:50176
    ds_read_b64_tr_b16 a[140:141], v80 offset:57344
    ds_read_b64_tr_b16 a[142:143], v80 offset:58368
    ds_read_b64_tr_b16 a[144:145], v81 offset:49152
    ds_read_b64_tr_b16 a[146:147], v81 offset:50176
    ds_read_b64_tr_b16 a[148:149], v81 offset:57344
    ds_read_b64_tr_b16 a[150:151], v81 offset:58368
    s_branch L_lw_34
L_lw_34_2:
    ds_read_b64_tr_b16 a[48:49], v80 offset:49152
    ds_read_b64_tr_b16 a[50:51], v80 offset:50176
    ds_read_b64_tr_b16 a[52:53], v80 offset:57344
    ds_read_b64_tr_b16 a[54:55], v80 offset:58368
    ds_read_b64_tr_b16 a[56:57], v81 offset:49152
    ds_read_b64_tr_b16 a[58:59], v81 offset:50176
    ds_read_b64_tr_b16 a[60:61], v81 offset:57344
    ds_read_b64_tr_b16 a[62:63], v81 offset:58368
L_lw_34:
    s_waitcnt lgkmcnt(0)
    s_waitcnt vmcnt(4)
    s_barrier
    s_cmp_lg_u32 s44, 0
    s_cbranch_scc1 L_lw_35_0
    ds_read_b64_tr_b16 v[216:217], v80 offset:0
    ds_read_b64_tr_b16 v[218:219], v80 offset:1024
    ds_read_b64_tr_b16 v[220:221], v80 offset:8192
    ds_read_b64_tr_b16 v[222:223], v80 offset:9216
    ds_read_b64_tr_b16 v[224:225], v81 offset:0
    ds_read_b64_tr_b16 v[226:227], v81 offset:1024
    ds_read_b64_tr_b16 v[228:229], v81 offset:8192
    ds_read_b64_tr_b16 v[230:231], v81 offset:9216
    s_branch L_lw_35
L_lw_35_0:
    s_cmp_lg_u32 s44, 1
    s_cbranch_scc1 L_lw_35_1
    ds_read_b64_tr_b16 v[112:113], v80 offset:0
    ds_read_b64_tr_b16 v[114:115], v80 offset:1024
    ds_read_b64_tr_b16 v[116:117], v80 offset:8192
    ds_read_b64_tr_b16 v[118:119], v80 offset:9216
    ds_read_b64_tr_b16 v[120:121], v81 offset:0
    ds_read_b64_tr_b16 v[122:123], v81 offset:1024
    ds_read_b64_tr_b16 v[124:125], v81 offset:8192
    ds_read_b64_tr_b16 v[126:127], v81 offset:9216
    s_branch L_lw_35
L_lw_35_1:
    s_cmp_lg_u32 s44, 2
    s_cbranch_scc1 L_lw_35_2
    ds_read_b64_tr_b16 a[160:161], v80 offset:0
    ds_read_b64_tr_b16 a[162:163], v80 offset:1024
    ds_read_b64_tr_b16 a[164:165], v80 offset:8192
    ds_read_b64_tr_b16 a[166:167], v80 offset:9216
    ds_read_b64_tr_b16 a[168:169], v81 offset:0
    ds_read_b64_tr_b16 a[170:171], v81 offset:1024
    ds_read_b64_tr_b16 a[172:173], v81 offset:8192
    ds_read_b64_tr_b16 a[174:175], v81 offset:9216
    s_branch L_lw_35
L_lw_35_2:
    ds_read_b64_tr_b16 a[72:73], v80 offset:0
    ds_read_b64_tr_b16 a[74:75], v80 offset:1024
    ds_read_b64_tr_b16 a[76:77], v80 offset:8192
    ds_read_b64_tr_b16 a[78:79], v80 offset:9216
    ds_read_b64_tr_b16 v[56:57], v81 offset:0
    ds_read_b64_tr_b16 v[58:59], v81 offset:1024
    ds_read_b64_tr_b16 v[60:61], v81 offset:8192
    ds_read_b64_tr_b16 v[62:63], v81 offset:9216
    s_waitcnt lgkmcnt(0)
    ds_write_b128 v5, v[56:59] offset:20480
    ds_write_b128 v5, v[60:63] offset:21504
L_lw_35:
    s_waitcnt lgkmcnt(0)
    s_waitcnt vmcnt(0)
    s_barrier
    s_cmp_lg_u32 s44, 0
    s_cbranch_scc1 L_lw_36_0
    ds_read_b64_tr_b16 v[248:249], v80 offset:16384
    ds_read_b64_tr_b16 v[250:251], v80 offset:17408
    ds_read_b64_tr_b16 v[252:253], v80 offset:24576
    ds_read_b64_tr_b16 v[254:255], v80 offset:25600
    ds_read_b64_tr_b16 v[56:57], v81 offset:16384
    ds_read_b64_tr_b16 v[58:59], v81 offset:17408
    ds_read_b64_tr_b16 v[60:61], v81 offset:24576
    ds_read_b64_tr_b16 v[62:63], v81 offset:25600
    s_waitcnt lgkmcnt(0)
    ds_write_b128 v5, v[56:59] offset:22528
    ds_write_b128 v5, v[60:63] offset:23552
    s_branch L_lw_36
L_lw_36_0:
    s_cmp_lg_u32 s44, 1
    s_cbranch_scc1 L_lw_36_1
    ds_read_b64_tr_b16 v[144:145], v80 offset:16384
    ds_read_b64_tr_b16 v[146:147], v80 offset:17408
    ds_read_b64_tr_b16 v[148:149], v80 offset:24576
    ds_read_b64_tr_b16 v[150:151], v80 offset:25600
    ds_read_b64_tr_b16 v[152:153], v81 offset:16384
    ds_read_b64_tr_b16 v[154:155], v81 offset:17408
    ds_read_b64_tr_b16 v[156:157], v81 offset:24576
    ds_read_b64_tr_b16 v[158:159], v81 offset:25600
    s_branch L_lw_36
L_lw_36_1:
    s_cmp_lg_u32 s44, 2
    s_cbranch_scc1 L_lw_36_2
    ds_read_b64_tr_b16 a[192:193], v80 offset:16384
    ds_read_b64_tr_b16 a[194:195], v80 offset:17408
    ds_read_b64_tr_b16 a[196:197], v80 offset:24576
    ds_read_b64_tr_b16 a[198:199], v80 offset:25600
    ds_read_b64_tr_b16 a[200:201], v81 offset:16384
    ds_read_b64_tr_b16 a[202:203], v81 offset:17408
    ds_read_b64_tr_b16 a[204:205], v81 offset:24576
    ds_read_b64_tr_b16 a[206:207], v81 offset:25600
    s_branch L_lw_36
L_lw_36_2:
    ds_read_b64_tr_b16 a[88:89], v80 offset:16384
    ds_read_b64_tr_b16 a[90:91], v80 offset:17408
    ds_read_b64_tr_b16 a[92:93], v80 offset:24576
    ds_read_b64_tr_b16 a[94:95], v80 offset:25600
    ds_read_b64_tr_b16 a[96:97], v81 offset:16384
    ds_read_b64_tr_b16 a[98:99], v81 offset:17408
    ds_read_b64_tr_b16 a[100:101], v81 offset:24576
    ds_read_b64_tr_b16 a[102:103], v81 offset:25600
L_lw_36:
    s_waitcnt lgkmcnt(0)
    s_barrier
    v_and_b32 v63, 15, v1
    v_lshrrev_b32 v64, 4, v1
    v_lshrrev_b32 v65, 5, v1
    v_lshlrev_b32 v65, 4, v65
    v_add_u32 v65, v65, v63
    v_lshlrev_b32 v65, 4, v65
    v_and_b32 v66, 1, v64
    v_lshlrev_b32 v66, 3, v66
    s_lshl_b32 s45, s44, 9
    s_add_u32 s45, s45, 53248
    v_add3_u32 v6, v65, v66, s45
    v_bfe_u32 v65, v1, 2, 2
    v_lshlrev_b32 v66, 3, v64
    v_add_u32 v65, v65, v66
    v_lshlrev_b32 v65, 4, v65
    v_and_b32 v66, 1, v1
    v_lshlrev_b32 v66, 3, v66
    v_add_u32 v65, v65, v66
    v_add_u32 v7, 53248, v65
    v_bfe_u32 v65, v1, 2, 1
    v_lshlrev_b32 v65, 4, v65
    v_bfe_u32 v66, v1, 3, 1
    v_lshlrev_b32 v66, 2, v66
    v_and_b32 v67, 3, v1
    v_add3_u32 v65, v65, v66, v67
    v_lshlrev_b32 v65, 5, v65
    v_lshlrev_b32 v66, 3, v64
    s_lshl_b32 s45, s44, 10
    s_add_u32 s45, s45, 55296
    v_add3_u32 v18, v65, v66, s45
    v_lshlrev_b32 v16, 3, v1
    v_lshlrev_b32 v8, 4, v1
    v_mov_b32 v14, v8
    v_lshrrev_b32 v65, 2, v1
    v_lshlrev_b32 v65, 4, v65
    v_and_b32 v66, 1, v1
    v_lshlrev_b32 v66, 3, v66
    s_lshl_b32 s45, s44, 11
    v_add3_u32 v65, v65, v66, s45
    v_and_b32 v66, 2, v1
    v_lshlrev_b32 v66, 7, v66
    v_add_u32 v9, v65, v66
    s_lshl_b32 s45, s43, 11
    s_lshl_b32 s46, s44, 9
    s_add_u32 s45, s45, s46
    s_add_u32 s51, s45, 0x7020000
    s_lshl_b32 s63, s43, 19
    s_add_u32 s63, s63, 0x3000000
    s_mov_b32 s50, 0
    s_lshl_b32 s64, s44, 11
    s_add_u32 s63, s63, s64
    s_add_u32 s64, s64, 16384
    s_add_u32 s65, s64, 8192
    s_lshl_b32 s66, s43, 12
    s_add_u32 s66, s66, 0x1000000
    s_mov_b32 s69, 16384
    s_mov_b32 s52, 0x3e0293ee
    v_and_b32 v19, 3, v1
    v_lshlrev_b32 v19, 10, v19
    s_lshl_b32 s45, s44, 12
    s_add_u32 s45, s45, 1020
    v_add_u32 v19, s45, v19
    v_mov_b32 v29, 128
    s_mov_b32 s46, 96
    s_mov_b64 exec, 1
    s_mov_b32 s70, 0
L_wp_37:
    buffer_load_dword v31, v29, s[16:19], 0 offen sc1
    s_add_u32 s70, s70, 1
    s_cmp_ge_u32 s70, 0x200000
    s_cbranch_scc1 L_c_done_1
    s_waitcnt vmcnt(0)
    v_cmp_gt_u32 vcc, s46, v31
    s_nop 1
    s_cbranch_vccz L_wp_37_ok
    s_sleep 2
    s_branch L_wp_37
L_wp_37_ok:
    s_mov_b64 exec, -1
    s_mov_b32 s47, 0
    s_cmp_lt_u32 s47, s50
    s_cbranch_scc1 L_kv_rdy_38
    s_lshl_b32 s45, s43, 7
    s_add_u32 s45, s45, 0x10014
    v_mov_b32 v0, 0
    s_mov_b32 s70, 0
L_kv_rdy_38_p:
    buffer_load_dwordx2 v[10:11], v0, s[12:15], s45 offen sc1
    s_add_u32 s70, s70, 1
    s_cmp_ge_u32 s70, 0x200000
    s_cbranch_scc1 L_c_done_1
    s_waitcnt vmcnt(0)
    v_min_u32 v10, v10, v11
    s_nop 0
    v_readfirstlane_b32 s50, v10
    s_nop 3
    s_cmp_lt_u32 s47, s50
    s_cbranch_scc1 L_kv_rdy_38
    s_sleep 2
    s_branch L_kv_rdy_38_p
L_kv_rdy_38:
    s_mov_b32 m0, s64
    s_add_u32 s46, s63, 0x1000000
    buffer_load_dwordx4 v14, s[12:15], s63 offen sc1 lds
    buffer_load_dwordx4 v14, s[12:15], s63 offen offset:1024 sc1 lds
    s_mov_b32 m0, s65
    s_add_u32 s63, s63, 8192
    buffer_load_dwordx4 v14, s[12:15], s46 offen sc1 lds
    buffer_load_dwordx4 v14, s[12:15], s46 offen offset:1024 sc1 lds
    s_add_u32 s64, s64, 16384
    s_add_u32 s65, s65, 16384
    s_mov_b32 s70, 0
    v_mov_b32 v41, 0
L_hw_39:
    buffer_load_dwordx2 v[44:45], v41, s[16:19], 0 offen sc1
    s_add_u32 s70, s70, 1
    s_cmp_ge_u32 s70, 0x100000
    s_cbranch_scc1 L_c_done_1
    s_waitcnt vmcnt(0)
    v_readfirstlane_b32 s45, v44
    v_readfirstlane_b32 s46, v45
    s_nop 3
    s_lshr_b32 s47, s46, 24
    s_cmp_lg_u32 s47, 64
    s_cbranch_scc1 L_hw_39
    s_lshr_b32 s68, s45, 24
    s_and_b32 s47, s45, 511
    s_mul_i32 s47, s47, s47
    s_bfe_u32 s45, s45, 0xf0009
    s_lshl_b32 s45, s45, 5
    s_sub_u32 s45, s45, s47
    s_and_b32 s47, s46, 511
    s_mul_i32 s47, s47, s47
    s_bfe_u32 s46, s46, 0xf0009
    s_lshl_b32 s46, s46, 5
    s_sub_u32 s46, s46, s47
    s_or_b32 s45, s45, s46
    s_cmp_eq_u32 s45, 0
    s_cselect_b32 s67, 1, 0
    s_mov_b32 s24, s12
    s_mov_b32 s25, s13
    s_mov_b32 s28, s12
    s_mov_b32 s29, s13
    s_cmp_eq_u32 s67, 1
    s_cselect_b32 s26, s14, 0
    s_cselect_b32 s30, 0, s14
    s_cmp_ge_u32 s68, 16
    s_cselect_b32 s68, 8192, 0
    s_mov_b32 s6, 0x0
    s_mov_b32 s7, 0xd5400000
    s_mov_b32 s60, 0
    s_lshl_b32 s58, s40, 16
    s_add_u32 s58, s58, 0x7000000
    s_mov_b32 s61, s58
    s_lshl_b32 s59, s40, 17
    s_add_u32 s59, s59, 0x7040000
    s_mov_b32 s62, s59
    s_add_u32 s32, s41, 0
    s_and_b32 s32, s32, 3
    s_lshl_b32 s32, s32, 10
    s_add_u32 s33, s41, 1
    s_and_b32 s33, s33, 3
    s_lshl_b32 s33, s33, 10
    s_add_u32 s34, s41, 2
    s_and_b32 s34, s34, 3
    s_lshl_b32 s34, s34, 10
    s_add_u32 s35, s41, 3
    s_and_b32 s35, s35, 3
    s_lshl_b32 s35, s35, 10
L_q_loop_40:
    ds_read_b128 v[56:59], v5 offset:8192
    ds_read_b128 v[60:63], v5 offset:9216
    ds_read_b128 v[64:67], v5 offset:20480
    ds_read_b128 v[68:71], v5 offset:21504
    ds_read_b128 v[72:75], v5 offset:16384
    ds_read_b128 v[76:79], v5 offset:17408
    ds_read_b128 v[80:83], v5 offset:4096
    ds_read_b128 v[84:87], v5 offset:5120
    ds_read_b128 v[88:91], v5 offset:6144
    ds_read_b128 v[92:95], v5 offset:7168
    s_add_u32 s46, s60, 1
    v_mov_b32 v15, s46
    v_mov_b32 v0, -1
    s_add_u32 s8, s61, s32
    s_add_u32 s9, s61, s33
    s_add_u32 s10, s61, s34
    s_add_u32 s11, s61, s35
    s_cmp_eq_u32 s60, 0
    s_cbranch_scc1 L_q_first_41
    s_sleep 16
    s_mov_b64 exec, 15
    buffer_load_dword v10, v19, s[12:15], s61 offen sc1
    s_nop 15
    buffer_load_dword v11, v19, s[12:15], s61 offen sc1
    s_nop 15
    buffer_load_dword v12, v19, s[12:15], s61 offen sc1
    s_nop 15
    buffer_load_dword v13, v19, s[12:15], s61 offen sc1
    s_mov_b32 s70, 0
L_pp_42:
    s_waitcnt vmcnt(3)
    v_cmp_eq_u32 vcc, -1, v10
    s_add_u32 s70, s70, 1
    s_nop 0
    s_cbranch_vccz L_ppd_43
    buffer_load_dword v10, v19, s[12:15], s61 offen sc1
    s_waitcnt vmcnt(3)
    v_cmp_eq_u32 vcc, -1, v11
    s_add_u32 s70, s70, 1
    s_nop 0
    s_cbranch_vccz L_ppd_43
    buffer_load_dword v11, v19, s[12:15], s61 offen sc1
    s_waitcnt vmcnt(3)
    v_cmp_eq_u32 vcc, -1, v12
    s_add_u32 s70, s70, 1
    s_nop 0
    s_cbranch_vccz L_ppd_43
    buffer_load_dword v12, v19, s[12:15], s61 offen sc1
    s_waitcnt vmcnt(3)
    v_cmp_eq_u32 vcc, -1, v13
    s_add_u32 s70, s70, 1
    s_nop 0
    s_cbranch_vccz L_ppd_43
    buffer_load_dword v13, v19, s[12:15], s61 offen sc1
    s_cmp_lt_u32 s70, 0x400000
    s_cbranch_scc1 L_pp_42
    s_branch L_c_done_1
L_ppd_43:
    s_mov_b64 exec, -1
L_q_first_41:
    s_waitcnt lgkmcnt(0)
    buffer_load_dwordx4 v[40:43], v3, s[12:15], s8 offen sc1
    v_mov_b32 v24, 0
    v_mov_b32 v25, 0
    v_mov_b32 v26, 0
    v_mov_b32 v27, 0
    v_mov_b32 v28, 0
    buffer_load_dwordx4 v[44:47], v3, s[12:15], s9 offen sc1
    v_mov_b32 v29, 0
    v_mov_b32 v30, 0
    v_mov_b32 v31, 0
    v_mov_b32 v32, 0
    v_mov_b32 v33, 0
    buffer_load_dwordx4 v[48:51], v3, s[12:15], s10 offen sc1
    v_mov_b32 v34, 0
    v_mov_b32 v35, 0
    v_mov_b32 v36, 0
    v_mov_b32 v37, 0
    v_mov_b32 v38, 0
    buffer_load_dwordx4 v[52:55], v3, s[12:15], s11 offen sc1
    s_mov_b32 s70, 0
    v_mov_b32 v39, 0
    s_waitcnt vmcnt(3)
    v_max3_u32 v22, v40, v41, v42
    ds_write_b128 v3, v[40:43] offset:0
    v_max_u32 v22, v22, v43
    v_cmp_eq_u32 vcc, -1, v22
    s_nop 0
    s_nop 0
    s_cbranch_vccnz L_mg_44_r0
L_mg_44_c0:
    v_smfmac_f32_16x16x64_bf16 v[24:27], v[40:43], a[0:7], v2
    s_waitcnt vmcnt(2)
    v_max3_u32 v22, v44, v45, v46
    v_smfmac_f32_16x16x64_bf16 v[28:31], v[40:43], a[8:15], v2
    ds_write_b128 v3, v[44:47] offset:1024
    v_max_u32 v22, v22, v47
    v_smfmac_f32_16x16x64_bf16 v[32:35], v[40:43], a[16:23], v2
    v_cmp_eq_u32 vcc, -1, v22
    v_smfmac_f32_16x16x64_bf16 v[36:39], v[40:43], a[24:31], v2
    s_nop 0
    s_cbranch_vccnz L_mg_44_r1
L_mg_44_c1:
    v_smfmac_f32_16x16x64_bf16 v[24:27], v[44:47], a[32:39], v2
    s_waitcnt vmcnt(1)
    v_max3_u32 v22, v48, v49, v50
    v_smfmac_f32_16x16x64_bf16 v[28:31], v[44:47], a[40:47], v2
    ds_write_b128 v3, v[48:51] offset:2048
    v_max_u32 v22, v22, v51
    v_smfmac_f32_16x16x64_bf16 v[32:35], v[44:47], a[48:55], v2
    v_cmp_eq_u32 vcc, -1, v22
    v_smfmac_f32_16x16x64_bf16 v[36:39], v[44:47], a[56:63], v2
    s_nop 0
    s_cbranch_vccnz L_mg_44_r2
L_mg_44_c2:
    s_waitcnt vmcnt(0)
    v_max3_u32 v22, v52, v53, v54
    ds_write_b128 v3, v[52:55] offset:3072
    v_max_u32 v22, v22, v55
    v_cmp_eq_u32 vcc, -1, v22
    s_waitcnt lgkmcnt(0)
    s_nop 0
    s_cbranch_vccnz L_mg_44_r3
L_mg_44_c3:
    s_barrier
    ds_read_b128 v[40:43], v4 offset:0
    ds_read_b128 v[44:47], v4 offset:1024
    v_smfmac_f32_16x16x64_bf16 v[24:27], v[48:51], a[64:71], v2
    v_smfmac_f32_16x16x64_bf16 v[28:31], v[48:51], v[56:63], v2
    ds_read_b128 v[56:59], v5 offset:14336
    v_smfmac_f32_16x16x64_bf16 v[32:35], v[48:51], a[72:79], v2
    ds_read_b128 v[60:63], v5 offset:15360
    v_smfmac_f32_16x16x64_bf16 v[36:39], v[48:51], v[64:71], v2
    ds_read_b128 v[48:51], v4 offset:2048
    v_smfmac_f32_16x16x64_bf16 v[24:27], v[52:55], a[80:87], v2
    ds_read_b128 v[64:67], v5 offset:2048
    v_smfmac_f32_16x16x64_bf16 v[28:31], v[52:55], v[72:79], v2
    ds_read_b128 v[68:71], v5 offset:3072
    v_smfmac_f32_16x16x64_bf16 v[32:35], v[52:55], a[88:95], v2
    ds_read_b128 v[72:75], v5 offset:12288
    v_smfmac_f32_16x16x64_bf16 v[36:39], v[52:55], a[96:103], v2
    ds_read_b128 v[52:55], v4 offset:3072
    s_waitcnt lgkmcnt(4)
    v_smfmac_f32_16x16x64_bf16 v[24:27], v[40:43], a[104:111], v2
    ds_read_b128 v[76:79], v5 offset:13312
    v_smfmac_f32_16x16x64_bf16 v[28:31], v[40:43], v[80:87], v2
    ds_read_b128 v[80:83], v5 offset:0
    v_smfmac_f32_16x16x64_bf16 v[32:35], v[40:43], a[112:119], v2
    ds_read_b128 v[84:87], v5 offset:1024
    v_smfmac_f32_16x16x64_bf16 v[36:39], v[40:43], a[120:127], v2
    ds_read_b128 v[40:43], v21 offset:0
    v_smfmac_f32_16x16x64_bf16 v[24:27], v[44:47], a[128:135], v2
    v_smfmac_f32_16x16x64_bf16 v[28:31], v[44:47], v[88:95], v2
    ds_read_b128 v[88:91], v5 offset:10240
    v_smfmac_f32_16x16x64_bf16 v[32:35], v[44:47], a[136:143], v2
    ds_read_b128 v[92:95], v5 offset:11264
    v_smfmac_f32_16x16x64_bf16 v[36:39], v[44:47], a[144:151], v2
    ds_read_b128 v[44:47], v21 offset:1024
    v_smfmac_f32_16x16x64_bf16 v[24:27], v[48:51], a[152:159], v2
    v_smfmac_f32_16x16x64_bf16 v[28:31], v[48:51], v[56:63], v2
    ds_read_b128 v[48:51], v21 offset:2048
    s_waitcnt lgkmcnt(3)
    v_smfmac_f32_16x16x64_bf16 v[24:27], v[52:55], a[176:183], v2
    ds_read_b128 v[56:59], v5 offset:22528
    v_smfmac_f32_16x16x64_bf16 v[28:31], v[52:55], a[184:191], v2
    ds_read_b128 v[52:55], v21 offset:3072
    v_smfmac_f32_16x16x64_bf16 v[24:27], v[40:43], a[208:215], v2
    ds_read_b128 v[60:63], v5 offset:23552
    v_smfmac_f32_16x16x64_bf16 v[28:31], v[40:43], v[64:71], v2
    ds_read_b128 v[40:43], v23 offset:0
    s_waitcnt lgkmcnt(4)
    v_smfmac_f32_16x16x64_bf16 v[24:27], v[44:47], a[232:239], v2
    ds_read_b128 v[64:67], v5 offset:18432
    v_smfmac_f32_16x16x64_bf16 v[28:31], v[44:47], a[240:247], v2
    ds_read_b128 v[44:47], v23 offset:1024
    v_smfmac_f32_16x16x64_bf16 v[24:27], v[48:51], v[104:111], v2
    ds_read_b128 v[68:71], v5 offset:19456
    v_smfmac_f32_16x16x64_bf16 v[28:31], v[48:51], v[72:79], v2
    ds_read_b128 v[48:51], v23 offset:2048
    s_waitcnt lgkmcnt(4)
    v_smfmac_f32_16x16x64_bf16 v[24:27], v[52:55], v[128:135], v2
    v_smfmac_f32_16x16x64_bf16 v[28:31], v[52:55], v[136:143], v2
    ds_read_b128 v[52:55], v23 offset:3072
    v_smfmac_f32_16x16x64_bf16 v[24:27], v[40:43], v[160:167], v2
    v_smfmac_f32_16x16x64_bf16 v[28:31], v[40:43], v[80:87], v2
    s_waitcnt lgkmcnt(1)
    v_smfmac_f32_16x16x64_bf16 v[24:27], v[44:47], v[184:191], v2
    v_smfmac_f32_16x16x64_bf16 v[28:31], v[44:47], v[192:199], v2
    v_smfmac_f32_16x16x64_bf16 v[24:27], v[48:51], v[208:215], v2
    v_smfmac_f32_16x16x64_bf16 v[28:31], v[48:51], v[88:95], v2
    s_waitcnt lgkmcnt(0)
    v_smfmac_f32_16x16x64_bf16 v[24:27], v[52:55], v[232:239], v2
    v_smfmac_f32_16x16x64_bf16 v[28:31], v[52:55], v[240:247], v2
    v_smfmac_f32_16x16x64_bf16 v[32:35], v[52:55], v[248:255], v2
    ds_read_b128 v[72:75], v8 offset:20480
    v_smfmac_f32_16x16x64_bf16 v[36:39], v[52:55], v[56:63], v2
    ds_read_b128 v[52:55], v21 offset:3072
    v_smfmac_f32_16x16x64_bf16 v[32:35], v[48:51], v[216:223], v2
    ds_read_b128 v[76:79], v8 offset:21504
    s_nop 1
    v_permlane32_swap_b32 v24, v28
    v_smfmac_f32_16x16x64_bf16 v[36:39], v[48:51], v[224:231], v2
    ds_read_b128 v[48:51], v21 offset:2048
    v_permlane32_swap_b32 v25, v29
    v_smfmac_f32_16x16x64_bf16 v[32:35], v[44:47], v[200:207], v2
    v_permlane32_swap_b32 v26, v30
    v_permlane32_swap_b32 v27, v31
    v_smfmac_f32_16x16x64_bf16 v[36:39], v[44:47], v[64:71], v2
    ds_read_b128 v[44:47], v21 offset:1024
    v_add_f32 v24, v24, v28
    v_smfmac_f32_16x16x64_bf16 v[32:35], v[40:43], v[168:175], v2
    v_add_f32 v25, v25, v29
    v_add_f32 v26, v26, v30
    v_smfmac_f32_16x16x64_bf16 v[36:39], v[40:43], v[176:183], v2
    ds_read_b128 v[40:43], v21 offset:0
    v_add_f32 v27, v27, v31
    s_waitcnt lgkmcnt(2)
    v_smfmac_f32_16x16x64_bf16 v[32:35], v[52:55], v[144:151], v2
    v_cvt_pk_bf16_f32 v24, v24, v25
    v_cvt_pk_bf16_f32 v25, v26, v27
    v_smfmac_f32_16x16x64_bf16 v[36:39], v[52:55], v[152:159], v2
    ds_read_b128 v[52:55], v4 offset:3072
    ds_write_b64 v6, v[24:25]
    v_smfmac_f32_16x16x64_bf16 v[32:35], v[48:51], v[112:119], v2
    ds_read_b128 v[56:59], v8 offset:16384
    ds_read_b128 v[60:63], v8 offset:17408
    v_smfmac_f32_16x16x64_bf16 v[36:39], v[48:51], v[120:127], v2
    ds_read_b128 v[48:51], v4 offset:2048
    s_waitcnt lgkmcnt(5)
    v_smfmac_f32_16x16x64_bf16 v[32:35], v[44:47], a[248:255], v2
    ds_read_b128 v[64:67], v8 offset:18432
    ds_read_b128 v[68:71], v8 offset:19456
    v_smfmac_f32_16x16x64_bf16 v[36:39], v[44:47], v[96:103], v2
    s_waitcnt lgkmcnt(5)
    s_barrier
    ds_read_b64_tr_b16 v[80:81], v7 offset:0
    v_smfmac_f32_16x16x64_bf16 v[32:35], v[40:43], a[216:223], v2
    ds_read_b64_tr_b16 v[82:83], v7 offset:64
    ds_read_b64_tr_b16 v[84:85], v7 offset:512
    v_smfmac_f32_16x16x64_bf16 v[36:39], v[40:43], a[224:231], v2
    ds_read_b64_tr_b16 v[86:87], v7 offset:576
    ds_read_b64_tr_b16 v[88:89], v7 offset:1024
    v_smfmac_f32_16x16x64_bf16 v[32:35], v[52:55], a[192:199], v2
    ds_read_b64_tr_b16 v[90:91], v7 offset:1088
    v_smfmac_f32_16x16x64_bf16 v[36:39], v[52:55], a[200:207], v2
    ds_read_b64_tr_b16 v[92:93], v7 offset:1536
    s_waitcnt lgkmcnt(6)
    v_smfmac_f32_16x16x64_bf16 v[32:35], v[48:51], a[160:167], v2
    ds_read_b64_tr_b16 v[94:95], v7 offset:1600
    v_smfmac_f32_16x16x64_bf16 v[36:39], v[48:51], a[168:175], v2
    s_waitcnt lgkmcnt(3)
    v_mfma_f32_16x16x32_bf16 v[24:27], v[56:59], v[80:83], 0
    ds_read_b128 v[56:59], v8 offset:22528
    v_mfma_f32_16x16x32_bf16 v[28:31], v[60:63], v[80:83], 0
    ds_read_b128 v[60:63], v8 offset:23552
    v_mfma_f32_16x16x32_bf16 v[24:27], v[64:67], v[84:87], v[24:27]
    s_nop 1
    v_cvt_pk_bf16_f32 v32, v32, v33
    v_cvt_pk_bf16_f32 v33, v34, v35
    v_cvt_pk_bf16_f32 v34, v36, v37
    v_cvt_pk_bf16_f32 v35, v38, v39
    ds_write2_b64 v18, v[32:33], v[34:35] offset1:32
    v_mfma_f32_16x16x32_bf16 v[28:31], v[68:71], v[84:87], v[28:31]
    s_waitcnt lgkmcnt(3)
    v_mfma_f32_16x16x32_bf16 v[24:27], v[72:75], v[88:91], v[24:27]
    ds_read_b64_tr_b16 v[64:65], v9 offset:24576
    v_mfma_f32_16x16x32_bf16 v[28:31], v[76:79], v[88:91], v[28:31]
    ds_read_b64_tr_b16 v[66:67], v9 offset:25600
    s_waitcnt lgkmcnt(3)
    v_mfma_f32_16x16x32_bf16 v[24:27], v[56:59], v[92:95], v[24:27]
    ds_read_b64_tr_b16 v[68:69], v9 offset:25088
    v_mfma_f32_16x16x32_bf16 v[28:31], v[60:63], v[92:95], v[28:31]
    ds_read_b64_tr_b16 v[70:71], v9 offset:26112
    v_mov_b32 v57, 0
    v_mov_b32 v58, 0
    s_waitcnt lgkmcnt(4)
    s_barrier
    ds_read_b64_tr_b16 v[40:41], v16 offset:55296
    ds_read_b64_tr_b16 v[42:43], v16 offset:55808
    ds_read_b64_tr_b16 v[44:45], v16 offset:56320
    ds_read_b64_tr_b16 v[46:47], v16 offset:56832
    ds_read_b64_tr_b16 v[48:49], v16 offset:57344
    ds_read_b64_tr_b16 v[50:51], v16 offset:57856
    ds_read_b64_tr_b16 v[52:53], v16 offset:58368
    ds_read_b64_tr_b16 v[54:55], v16 offset:58880
    s_cmp_eq_u32 s60, 63
    s_cbranch_scc1 L_q_last_45
    v_max3_f32 v11, v24, v25, v26
    v_max3_f32 v13, v27, v28, v29
    s_waitcnt lgkmcnt(4)
    v_mfma_f32_16x16x32_bf16 v[36:39], v[40:43], v[80:83], 0
    v_max3_f32 v11, v11, v30, v31
    v_max_f32 v11, v11, v13
    v_mfma_f32_16x16x32_bf16 v[36:39], v[44:47], v[84:87], v[36:39]
    v_mul_f32 v10, s52, v11
    s_waitcnt lgkmcnt(0)
    v_mfma_f32_16x16x32_bf16 v[36:39], v[48:51], v[88:91], v[36:39]
    v_fma_f32 v24, v24, s52, -v10
    v_fma_f32 v25, v25, s52, -v10
    v_mfma_f32_16x16x32_bf16 v[36:39], v[52:55], v[92:95], v[36:39]
    v_fma_f32 v26, v26, s52, -v10
    v_fma_f32 v27, v27, s52, -v10
    v_fma_f32 v28, v28, s52, -v10
    v_fma_f32 v29, v29, s52, -v10
    v_fma_f32 v30, v30, s52, -v10
    v_fma_f32 v31, v31, s52, -v10
    v_exp_f32 v24, v24
    v_exp_f32 v25, v25
    v_permlane32_swap_b32 v36, v38
    v_permlane32_swap_b32 v37, v39
    v_pk_add_f32 v[36:37], v[36:37], v[38:39]
    v_max3_f32 v12, v36, v37, v11
    v_max3_f32 v13, v36, v37, v11
    v_exp_f32 v26, v26
    v_exp_f32 v27, v27
    buffer_load_dwordx2 v[0:1], v16, s[12:15], s51 offen sc1
    v_permlane32_swap_b32 v12, v13
    v_max_f32 v22, v12, v13
    v_max_f32 v13, v12, v13
    v_exp_f32 v28, v28
    v_exp_f32 v29, v29
    v_permlane16_swap_b32 v22, v13
    v_max_f32 v12, v22, v13
    v_mul_f32 v12, s52, v12
    v_sub_f32 v10, v10, v12
    v_pk_fma_f32 v[36:37], v[36:37], s[52:53], v[12:13] op_sel_hi:[1,0,0] neg_lo:[0,0,1] neg_hi:[0,0,1]
    v_exp_f32 v10, v10
    v_exp_f32 v30, v30
    v_exp_f32 v31, v31
    v_exp_f32 v36, v36
    v_exp_f32 v37, v37
    v_pk_mul_f32 v[24:25], v[24:25], v[10:11] op_sel_hi:[1,0]
    v_pk_mul_f32 v[26:27], v[26:27], v[10:11] op_sel_hi:[1,0]
    v_pk_mul_f32 v[28:29], v[28:29], v[10:11] op_sel_hi:[1,0]
    v_pk_mul_f32 v[30:31], v[30:31], v[10:11] op_sel_hi:[1,0]
    v_cvt_pk_bf16_f32 v60, v24, v25
    v_cvt_pk_bf16_f32 v61, v26, v27
    v_cvt_pk_bf16_f32 v62, v28, v29
    v_cvt_pk_bf16_f32 v63, v30, v31
    v_cvt_pk_bf16_f32 v56, v36, v37
    v_cvt_pk_bf16_f32 v59, v36, v37
    buffer_store_dword v15, v20, s[24:27], 0 offen
    v_mfma_f32_16x16x32_bf16 v[72:75], v[64:67], v[60:63], 0
    v_add_f32 v10, v24, v25
    v_add_f32 v11, v26, v27
    v_mfma_f32_16x16x32_bf16 v[76:79], v[68:71], v[60:63], 0
    v_add_f32 v10, v10, v28
    s_waitcnt vmcnt(1)
L_q_vm_46:
    v_max_u32 v22, v0, v1
    v_cmp_eq_u32 vcc, -1, v22
    v_add_f32 v12, v11, v29
    v_add_f32 v13, v10, v30
    s_cbranch_vccnz L_q_vm_46_r
    v_mfma_f32_16x16x16_bf16 v[72:75], v[0:1], v[56:57], v[72:75]
    v_add_f32 v11, v12, v31
    v_add_f32 v10, v13, v36
    v_mfma_f32_16x16x16_bf16 v[76:79], v[0:1], v[58:59], v[76:79]
    v_add_f32 v11, v11, v37
    v_add_f32 v12, v10, v11
    v_add_f32 v13, v10, v11
    s_nop 1
    v_permlane32_swap_b32 v12, v13
    v_add_f32 v22, v12, v13
    v_add_f32 v13, v12, v13
    s_nop 1
    v_permlane16_swap_b32 v22, v13
    v_add_f32 v12, v22, v13
    v_rcp_f32 v12, v12
    s_nop 0
    v_pk_mul_f32 v[72:73], v[72:73], v[12:13] op_sel_hi:[1,0]
    v_pk_mul_f32 v[74:75], v[74:75], v[12:13] op_sel_hi:[1,0]
    v_pk_mul_f32 v[76:77], v[76:77], v[12:13] op_sel_hi:[1,0]
    v_pk_mul_f32 v[78:79], v[78:79], v[12:13] op_sel_hi:[1,0]
    v_cvt_pk_bf16_f32 v72, v72, v73
    v_cvt_pk_bf16_f32 v73, v74, v75
    v_cvt_pk_bf16_f32 v74, v76, v77
    v_cvt_pk_bf16_f32 v75, v78, v79
    buffer_store_dwordx4 v[72:75], v17, s[24:27], s62 offen
    buffer_store_dwordx4 v[72:75], v17, s[28:31], s62 offen sc1
    buffer_store_dword v15, v20, s[28:31], 0 offen sc1
    v_mov_b32 v60, -1
    v_mov_b32 v61, -1
    v_mov_b32 v62, -1
    v_mov_b32 v63, -1
    s_add_u32 s45, s60, 3
    s_and_b32 s45, s45, 3
    s_lshl_b32 s45, s45, 15
    s_add_u32 s45, s45, s59
    buffer_store_dwordx4 v[60:63], v17, s[24:27], s45 offen
    buffer_store_dwordx4 v[60:63], v17, s[28:31], s45 offen sc1
L_q_last_45:
    s_waitcnt lgkmcnt(0)
    v_lshlrev_b32 v22, 1, v16
    s_cmp_lg_u32 s44, 0
    s_cbranch_scc1 L_q_km_47_0
    buffer_store_dwordx4 v[40:43], v22, s[12:15], s66 offen offset:0 sc1
L_q_km_47_0:
    s_cmp_lg_u32 s44, 1
    s_cbranch_scc1 L_q_km_47_1
    buffer_store_dwordx4 v[44:47], v22, s[12:15], s66 offen offset:1024 sc1
L_q_km_47_1:
    s_cmp_lg_u32 s44, 2
    s_cbranch_scc1 L_q_km_47_2
    buffer_store_dwordx4 v[48:51], v22, s[12:15], s66 offen offset:2048 sc1
L_q_km_47_2:
    s_cmp_lg_u32 s44, 3
    s_cbranch_scc1 L_q_km_47_3
    buffer_store_dwordx4 v[52:55], v22, s[12:15], s66 offen offset:3072 sc1
L_q_km_47_3:
    s_cmp_eq_u32 s60, 63
    s_cbranch_scc1 L_q_fin_48
    s_cmp_eq_u32 s60, 62
    s_cbranch_scc1 L_q_fin_48_n
    s_add_u32 s47, s60, 1
    s_cmp_lt_u32 s47, s50
    s_cbranch_scc1 L_kv_rdy_49
    s_lshl_b32 s45, s43, 7
    s_add_u32 s45, s45, 0x10014
    v_mov_b32 v0, 0
    s_mov_b32 s70, 0
L_kv_rdy_49_p:
    buffer_load_dwordx2 v[10:11], v0, s[12:15], s45 offen sc1
    s_add_u32 s70, s70, 1
    s_cmp_ge_u32 s70, 0x200000
    s_cbranch_scc1 L_c_done_1
    s_waitcnt vmcnt(0)
    v_min_u32 v10, v10, v11
    s_nop 0
    v_readfirstlane_b32 s50, v10
    s_nop 3
    s_cmp_lt_u32 s47, s50
    s_cbranch_scc1 L_kv_rdy_49
    s_sleep 2
    s_branch L_kv_rdy_49_p
L_kv_rdy_49:
    s_mov_b32 m0, s64
    s_add_u32 s46, s63, 0x1000000
    buffer_load_dwordx4 v14, s[12:15], s63 offen sc1 lds
    buffer_load_dwordx4 v14, s[12:15], s63 offen offset:1024 sc1 lds
    s_mov_b32 m0, s65
    s_add_u32 s63, s63, 8192
    buffer_load_dwordx4 v14, s[12:15], s46 offen sc1 lds
    buffer_load_dwordx4 v14, s[12:15], s46 offen offset:1024 sc1 lds
L_q_fin_48_n:
    s_add_u32 s47, s60, 1
    s_bitcmp1_b64 s[6:7], s47
    s_cselect_b32 s47, s47, s60
    s_cbranch_scc0 L_q_fin_48_m
    s_waitcnt vmcnt(0)
L_q_fin_48_m:
    v_mov_b32 v22, s47
    v_mov_b32 v0, 0
    s_mov_b64 exec, 1
    buffer_store_dword v22, v0, s[12:15], s3 offen sc1
    s_mov_b64 exec, -1
    s_mov_b64 exec, -1
    v_add_u32 v8, s69, v8
    v_add_u32 v9, s69, v9
    s_sub_u32 s64, s64, s69
    s_sub_u32 s65, s65, s69
    s_sub_u32 s69, 0, s69
    s_add_u32 s66, s66, 131072
    s_xor_b32 s51, s51, 65536
    s_add_u32 s60, s60, 1
    s_and_b32 s45, s60, 3
    s_lshl_b32 s46, s45, 14
    s_add_u32 s61, s58, s46
    s_lshl_b32 s46, s45, 15
    s_add_u32 s62, s59, s46
    s_branch L_q_loop_40
L_q_fin_48:
    s_waitcnt vmcnt(0)
    v_mov_b32 v22, 64
    v_mov_b32 v0, 0
    s_mov_b64 exec, 1
    buffer_store_dword v22, v0, s[12:15], s3 offen sc1
    s_mov_b64 exec, -1
    s_endpgm
L_q_vm_46_r:
    buffer_load_dwordx2 v[0:1], v16, s[12:15], s51 offen sc1
    s_add_u32 s70, s70, 1
    s_cmp_lt_u32 s70, 0x100000
    s_waitcnt vmcnt(0)
    s_cbranch_scc1 L_q_vm_46
    s_endpgm
L_mg_44_r0:
    buffer_load_dwordx4 v[40:43], v3, s[12:15], s8 offen sc1
    buffer_load_dwordx4 v[44:47], v3, s[12:15], s9 offen sc1
    buffer_load_dwordx4 v[48:51], v3, s[12:15], s10 offen sc1
    buffer_load_dwordx4 v[52:55], v3, s[12:15], s11 offen sc1
    s_add_u32 s70, s70, 1
    s_cmp_ge_u32 s70, 0x100000
    s_cbranch_scc1 L_c_done_1
    s_waitcnt vmcnt(3)
    ds_write_b128 v3, v[40:43] offset:0
    v_max3_u32 v22, v40, v41, v42
    v_max_u32 v22, v22, v43
    v_cmp_eq_u32 vcc, -1, v22
    s_waitcnt lgkmcnt(0)
    s_nop 0
    s_cbranch_vccnz L_mg_44_r0
    s_branch L_mg_44_c0
L_mg_44_r1:
    buffer_load_dwordx4 v[44:47], v3, s[12:15], s9 offen sc1
    buffer_load_dwordx4 v[48:51], v3, s[12:15], s10 offen sc1
    buffer_load_dwordx4 v[52:55], v3, s[12:15], s11 offen sc1
    s_add_u32 s70, s70, 1
    s_cmp_ge_u32 s70, 0x100000
    s_cbranch_scc1 L_c_done_1
    s_waitcnt vmcnt(2)
    ds_write_b128 v3, v[44:47] offset:1024
    v_max3_u32 v22, v44, v45, v46
    v_max_u32 v22, v22, v47
    v_cmp_eq_u32 vcc, -1, v22
    s_waitcnt lgkmcnt(0)
    s_nop 0
    s_cbranch_vccnz L_mg_44_r1
    s_branch L_mg_44_c1
L_mg_44_r2:
    buffer_load_dwordx4 v[48:51], v3, s[12:15], s10 offen sc1
    buffer_load_dwordx4 v[52:55], v3, s[12:15], s11 offen sc1
    s_add_u32 s70, s70, 1
    s_cmp_ge_u32 s70, 0x100000
    s_cbranch_scc1 L_c_done_1
    s_waitcnt vmcnt(1)
    ds_write_b128 v3, v[48:51] offset:2048
    v_max3_u32 v22, v48, v49, v50
    v_max_u32 v22, v22, v51
    v_cmp_eq_u32 vcc, -1, v22
    s_waitcnt lgkmcnt(0)
    s_nop 0
    s_cbranch_vccnz L_mg_44_r2
    s_branch L_mg_44_c2
L_mg_44_r3:
    buffer_load_dwordx4 v[52:55], v3, s[12:15], s11 offen sc1
    s_add_u32 s70, s70, 1
    s_cmp_ge_u32 s70, 0x100000
    s_cbranch_scc1 L_c_done_1
    s_waitcnt vmcnt(0)
    ds_write_b128 v3, v[52:55] offset:3072
    v_max3_u32 v22, v52, v53, v54
    v_max_u32 v22, v22, v55
    v_cmp_eq_u32 vcc, -1, v22
    s_waitcnt lgkmcnt(0)
    s_nop 0
    s_cbranch_vccnz L_mg_44_r3
    s_branch L_mg_44_c3
L_c_vo_2:
    s_lshl_b32 s45, s43, 11
    s_lshl_b32 s46, s44, 9
    s_add_u32 s45, s45, s46
    v_lshlrev_b32 v10, 3, v1
    v_add_u32 v10, s45, v10
    v_lshlrev_b32 v11, 3, v0
    v_bfe_u32 v69, v1, 4, 1
    v_lshlrev_b32 v69, 2, v69
    v_lshrrev_b32 v63, 5, v1
    v_lshlrev_b32 v63, 1, v63
    v_and_b32 v64, 1, v1
    v_add3_u32 v69, v69, v63, v64
    v_bfe_u32 v63, v1, 1, 1
    v_lshlrev_b32 v63, 3, v63
    v_add_u32 v63, v63, v69
    v_lshlrev_b32 v63, 4, v63
    v_bfe_u32 v64, v1, 2, 2
    v_lshlrev_b32 v64, 2, v64
    s_lshl_b32 s45, s42, 10
    s_lshl_b32 s46, s44, 8
    s_add_u32 s45, s45, s46
    v_add3_u32 v12, v63, v64, s45
    v_and_b32 v64, 1, v1
    v_cmp_eq_u32 vcc, 0, v64
    v_mov_b32 v9, 0x07060302
    v_mov_b32 v63, 0x01000504
    v_cndmask_b32 v9, v9, v63, vcc
    s_lshl_b32 s63, s40, 19
    s_lshl_b32 s45, s42, 15
    s_add_u32 s63, s63, s45
    s_add_u32 s63, s63, 0x7100000
    s_xor_b32 s64, s63, 524288
    s_lshl_b32 s45, s40, 12
    s_lshl_b32 s46, s44, 9
    s_add_u32 s45, s45, s46
    s_lshl_b32 s46, s42, 2
    s_add_u32 s45, s45, s46
    s_add_u32 s45, s45, 0x7082000
    v_lshlrev_b32 v20, 7, v1
    v_add_u32 v20, s45, v20
    v_mov_b32 v63, 0x20000000
    v_cmp_gt_u32 vcc, 4, v1
    s_nop 1
    v_cndmask_b32 v20, v63, v20, vcc
    buffer_store_dword v44, v20, s[12:15], 0 offen sc1
    s_mov_b32 s45, 0x7020000
    buffer_store_dwordx2 v[40:41], v10, s[12:15], s45 offen sc1
    s_mov_b32 s45, 0x7030000
    buffer_store_dwordx2 v[40:41], v10, s[12:15], s45 offen sc1
    s_add_u32 s45, s63, 0
    buffer_store_dwordx2 v[40:41], v11, s[12:15], s45 offen sc1
    s_add_u32 s45, s63, 4096
    buffer_store_dwordx2 v[40:41], v11, s[12:15], s45 offen sc1
    s_add_u32 s45, s63, 8192
    buffer_store_dwordx2 v[40:41], v11, s[12:15], s45 offen sc1
    s_add_u32 s45, s63, 12288
    buffer_store_dwordx2 v[40:41], v11, s[12:15], s45 offen sc1
    s_add_u32 s45, s63, 16384
    buffer_store_dwordx2 v[40:41], v11, s[12:15], s45 offen sc1
    s_add_u32 s45, s63, 20480
    buffer_store_dwordx2 v[40:41], v11, s[12:15], s45 offen sc1
    s_add_u32 s45, s63, 24576
    buffer_store_dwordx2 v[40:41], v11, s[12:15], s45 offen sc1
    s_add_u32 s45, s63, 28672
    buffer_store_dwordx2 v[40:41], v11, s[12:15], s45 offen sc1
    s_lshl_b32 s61, s40, 16
    s_add_u32 s61, s61, 0x7000000
    s_add_u32 s45, s61, 16384
    buffer_store_dword v40, v12, s[12:15], s45 offen sc1
    s_add_u32 s45, s61, 32768
    buffer_store_dword v40, v12, s[12:15], s45 offen sc1
    s_add_u32 s45, s61, 49152
    buffer_store_dword v40, v12, s[12:15], s45 offen sc1
    v_lshlrev_b32 v63, 11, v69
    v_and_b32 v64, 14, v1
    v_lshlrev_b32 v64, 1, v64
    v_add_u32 v63, v63, v64
    s_lshl_b32 s45, s42, 7
    s_lshl_b32 s46, s44, 5
    s_add_u32 s45, s45, s46
    buffer_load_dword v45, v63, s[52:55], s45 offen
    s_mov_b32 s76, -1
    s_mov_b32 s77, -1
    v_lshrrev_b32 v63, 3, v1
    v_lshlrev_b32 v63, 11, v63
    v_bfe_u32 v64, v1, 1, 2
    v_and_b32 v65, 1, v1
    v_lshlrev_b32 v65, 4, v65
    v_add_u32 v63, v63, v65
    v_xor_b32 v66, 0, v64
    v_lshlrev_b32 v66, 5, v66
    v_add_u32 v70, v63, v66
    v_xor_b32 v66, 1, v64
    v_lshlrev_b32 v66, 5, v66
    v_add_u32 v71, v63, v66
    v_xor_b32 v66, 2, v64
    v_lshlrev_b32 v66, 5, v66
    v_add_u32 v72, v63, v66
    v_xor_b32 v66, 3, v64
    v_lshlrev_b32 v66, 5, v66
    v_add_u32 v73, v63, v66
    v_bfe_u32 v63, v1, 3, 1
    v_lshlrev_b32 v63, 1, v63
    v_bfe_u32 v64, v1, 4, 1
    v_add_u32 v63, v63, v64
    v_lshlrev_b32 v64, 3, v63
    v_lshrrev_b32 v65, 5, v1
    v_lshlrev_b32 v65, 2, v65
    v_add_u32 v64, v64, v65
    v_bfe_u32 v65, v1, 2, 1
    v_add_u32 v64, v64, v65
    v_lshlrev_b32 v64, 7, v64
    v_and_b32 v65, 3, v1
    v_lshlrev_b32 v65, 3, v65
    v_add_u32 v64, v64, v65
    s_lshl_b32 s45, s44, 12
    v_add_u32 v64, s45, v64
    s_add_u32 s45, s44, 1
    s_and_b32 s45, s45, 3
    v_xor_b32 v65, s45, v63
    v_lshlrev_b32 v65, 5, v65
    v_add_u32 v74, v64, v65
    s_mul_i32 s45, s44, 20480
    s_add_u32 s45, s45, 65536
    v_add_u32 v88, s45, v74
    s_add_u32 s45, s44, 2
    s_and_b32 s45, s45, 3
    v_xor_b32 v65, s45, v63
    v_lshlrev_b32 v65, 5, v65
    v_add_u32 v75, v64, v65
    s_mul_i32 s45, s44, 20480
    s_add_u32 s45, s45, 65536
    v_add_u32 v89, s45, v75
    s_add_u32 s45, s44, 3
    s_and_b32 s45, s45, 3
    v_xor_b32 v65, s45, v63
    v_lshlrev_b32 v65, 5, v65
    v_add_u32 v76, v64, v65
    s_mul_i32 s45, s44, 20480
    s_add_u32 s45, s45, 65536
    v_add_u32 v90, s45, v76
    s_add_u32 s45, s44, 4
    s_and_b32 s45, s45, 3
    v_xor_b32 v65, s45, v63
    v_lshlrev_b32 v65, 5, v65
    v_add_u32 v77, v64, v65
    s_mul_i32 s45, s44, 20480
    s_add_u32 s45, s45, 65536
    v_add_u32 v91, s45, v77
    s_mul_i32 s65, s44, 24576
    s_lshl_b32 s49, s40, 22
    s_lshl_b32 s45, s44, 20
    s_add_u32 s49, s49, s45
    s_lshl_b32 s45, s42, 7
    s_add_u32 s49, s49, s45
    s_lshl_b32 s50, s44, 12
    s_mul_i32 s69, s42, 1
    s_add_u32 s51, s69, 0
    s_and_b32 s51, s51, 7
    s_lshl_b32 s51, s51, 17
    s_add_u32 s51, s51, s49
    s_add_u32 s46, s51, 0x0
    s_add_u32 m0, s65, 65536
    s_nop 0
    buffer_load_dwordx4 v70, s[36:39], s46 offen  lds
    s_add_u32 s46, s51, 0x8000
    s_add_u32 m0, s65, 66560
    s_nop 0
    buffer_load_dwordx4 v71, s[36:39], s46 offen  lds
    s_add_u32 s46, s51, 0x10000
    s_add_u32 m0, s65, 67584
    s_nop 0
    buffer_load_dwordx4 v72, s[36:39], s46 offen  lds
    s_add_u32 s46, s51, 0x18000
    s_add_u32 m0, s65, 68608
    s_nop 0
    buffer_load_dwordx4 v73, s[36:39], s46 offen  lds
    s_add_u32 s51, s69, 0
    s_and_b32 s51, s51, 7
    s_lshl_b32 s51, s51, 17
    s_add_u32 s51, s51, s49
    s_add_u32 s46, s51, 0x4000
    s_add_u32 m0, s65, 69632
    s_nop 0
    buffer_load_dwordx4 v70, s[36:39], s46 offen  lds
    s_add_u32 s46, s51, 0xc000
    s_add_u32 m0, s65, 70656
    s_nop 0
    buffer_load_dwordx4 v71, s[36:39], s46 offen  lds
    s_add_u32 s46, s51, 0x14000
    s_add_u32 m0, s65, 71680
    s_nop 0
    buffer_load_dwordx4 v72, s[36:39], s46 offen  lds
    s_add_u32 s46, s51, 0x1c000
    s_add_u32 m0, s65, 72704
    s_nop 0
    buffer_load_dwordx4 v73, s[36:39], s46 offen  lds
    s_add_u32 s51, s69, 1
    s_and_b32 s51, s51, 7
    s_lshl_b32 s51, s51, 17
    s_add_u32 s51, s51, s49
    s_add_u32 s46, s51, 0x0
    s_add_u32 m0, s65, 73728
    s_nop 0
    buffer_load_dwordx4 v70, s[36:39], s46 offen  lds
    s_add_u32 s46, s51, 0x8000
    s_add_u32 m0, s65, 74752
    s_nop 0
    buffer_load_dwordx4 v71, s[36:39], s46 offen  lds
    s_add_u32 s46, s51, 0x10000
    s_add_u32 m0, s65, 75776
    s_nop 0
    buffer_load_dwordx4 v72, s[36:39], s46 offen  lds
    s_add_u32 s46, s51, 0x18000
    s_add_u32 m0, s65, 76800
    s_nop 0
    buffer_load_dwordx4 v73, s[36:39], s46 offen  lds
    s_add_u32 s51, s69, 1
    s_and_b32 s51, s51, 7
    s_lshl_b32 s51, s51, 17
    s_add_u32 s51, s51, s49
    s_add_u32 s46, s51, 0x4000
    s_add_u32 m0, s65, 77824
    s_nop 0
    buffer_load_dwordx4 v70, s[36:39], s46 offen  lds
    s_add_u32 s46, s51, 0xc000
    s_add_u32 m0, s65, 78848
    s_nop 0
    buffer_load_dwordx4 v71, s[36:39], s46 offen  lds
    s_add_u32 s46, s51, 0x14000
    s_add_u32 m0, s65, 79872
    s_nop 0
    buffer_load_dwordx4 v72, s[36:39], s46 offen  lds
    s_add_u32 s46, s51, 0x1c000
    s_add_u32 m0, s65, 80896
    s_nop 0
    buffer_load_dwordx4 v73, s[36:39], s46 offen  lds
    s_add_u32 s51, s69, 2
    s_and_b32 s51, s51, 7
    s_lshl_b32 s51, s51, 17
    s_add_u32 s51, s51, s49
    s_add_u32 s46, s51, 0x0
    s_add_u32 m0, s65, 81920
    s_nop 0
    buffer_load_dwordx4 v70, s[36:39], s46 offen  lds
    s_add_u32 s46, s51, 0x8000
    s_add_u32 m0, s65, 82944
    s_nop 0
    buffer_load_dwordx4 v71, s[36:39], s46 offen  lds
    s_add_u32 s46, s51, 0x10000
    s_add_u32 m0, s65, 83968
    s_nop 0
    buffer_load_dwordx4 v72, s[36:39], s46 offen  lds
    s_add_u32 s46, s51, 0x18000
    s_add_u32 m0, s65, 84992
    s_nop 0
    buffer_load_dwordx4 v73, s[36:39], s46 offen  lds
    s_add_u32 s51, s69, 2
    s_and_b32 s51, s51, 7
    s_lshl_b32 s51, s51, 17
    s_add_u32 s51, s51, s49
    s_add_u32 s46, s51, 0x4000
    s_add_u32 m0, s65, 86016
    s_nop 0
    buffer_load_dwordx4 v70, s[36:39], s46 offen  lds
    s_add_u32 s46, s51, 0xc000
    s_add_u32 m0, s65, 87040
    s_nop 0
    buffer_load_dwordx4 v71, s[36:39], s46 offen  lds
    s_add_u32 s46, s51, 0x14000
    s_add_u32 m0, s65, 88064
    s_nop 0
    buffer_load_dwordx4 v72, s[36:39], s46 offen  lds
    s_add_u32 s46, s51, 0x1c000
    s_add_u32 m0, s65, 89088
    s_nop 0
    buffer_load_dwordx4 v73, s[36:39], s46 offen  lds
    s_add_u32 s51, s69, 3
    s_and_b32 s51, s51, 7
    s_lshl_b32 s51, s51, 17
    s_add_u32 s51, s51, s49
    s_add_u32 s46, s51, 0x0
    s_add_u32 m0, s50, 0
    s_nop 0
    buffer_load_dwordx4 v70, s[36:39], s46 offen  lds
    s_add_u32 s46, s51, 0x8000
    s_add_u32 m0, s50, 1024
    s_nop 0
    buffer_load_dwordx4 v71, s[36:39], s46 offen  lds
    s_add_u32 s46, s51, 0x10000
    s_add_u32 m0, s50, 2048
    s_nop 0
    buffer_load_dwordx4 v72, s[36:39], s46 offen  lds
    s_add_u32 s46, s51, 0x18000
    s_add_u32 m0, s50, 3072
    s_nop 0
    buffer_load_dwordx4 v73, s[36:39], s46 offen  lds
    s_add_u32 s51, s69, 3
    s_and_b32 s51, s51, 7
    s_lshl_b32 s51, s51, 17
    s_add_u32 s51, s51, s49
    s_add_u32 s46, s51, 0x4000
    s_add_u32 m0, s50, 16384
    s_nop 0
    buffer_load_dwordx4 v70, s[36:39], s46 offen  lds
    s_add_u32 s46, s51, 0xc000
    s_add_u32 m0, s50, 17408
    s_nop 0
    buffer_load_dwordx4 v71, s[36:39], s46 offen  lds
    s_add_u32 s46, s51, 0x14000
    s_add_u32 m0, s50, 18432
    s_nop 0
    buffer_load_dwordx4 v72, s[36:39], s46 offen  lds
    s_add_u32 s46, s51, 0x1c000
    s_add_u32 m0, s50, 19456
    s_nop 0
    buffer_load_dwordx4 v73, s[36:39], s46 offen  lds
    s_add_u32 s51, s69, 4
    s_and_b32 s51, s51, 7
    s_lshl_b32 s51, s51, 17
    s_add_u32 s51, s51, s49
    s_add_u32 s46, s51, 0x0
    s_add_u32 m0, s50, 32768
    s_nop 0
    buffer_load_dwordx4 v70, s[36:39], s46 offen  lds
    s_add_u32 s46, s51, 0x8000
    s_add_u32 m0, s50, 33792
    s_nop 0
    buffer_load_dwordx4 v71, s[36:39], s46 offen  lds
    s_add_u32 s46, s51, 0x10000
    s_add_u32 m0, s50, 34816
    s_nop 0
    buffer_load_dwordx4 v72, s[36:39], s46 offen  lds
    s_add_u32 s46, s51, 0x18000
    s_add_u32 m0, s50, 35840
    s_nop 0
    buffer_load_dwordx4 v73, s[36:39], s46 offen  lds
    s_add_u32 s51, s69, 4
    s_and_b32 s51, s51, 7
    s_lshl_b32 s51, s51, 17
    s_add_u32 s51, s51, s49
    s_add_u32 s46, s51, 0x4000
    s_add_u32 m0, s50, 49152
    s_nop 0
    buffer_load_dwordx4 v70, s[36:39], s46 offen  lds
    s_add_u32 s46, s51, 0xc000
    s_add_u32 m0, s50, 50176
    s_nop 0
    buffer_load_dwordx4 v71, s[36:39], s46 offen  lds
    s_add_u32 s46, s51, 0x14000
    s_add_u32 m0, s50, 51200
    s_nop 0
    buffer_load_dwordx4 v72, s[36:39], s46 offen  lds
    s_add_u32 s46, s51, 0x1c000
    s_add_u32 m0, s50, 52224
    s_nop 0
    buffer_load_dwordx4 v73, s[36:39], s46 offen  lds
    s_waitcnt vmcnt(40)
    v_min_u32 v45, -2, v45
    buffer_store_dword v45, v12, s[12:15], s61 offen sc1
    s_waitcnt vmcnt(36)
    s_barrier
    ds_read_b64_tr_b16 a[160:161], v88 offset:0
    ds_read_b64_tr_b16 a[162:163], v88 offset:256
    ds_read_b64_tr_b16 a[168:169], v89 offset:0
    ds_read_b64_tr_b16 a[170:171], v89 offset:256
    ds_read_b64_tr_b16 a[176:177], v90 offset:0
    ds_read_b64_tr_b16 a[178:179], v90 offset:256
    ds_read_b64_tr_b16 a[184:185], v91 offset:0
    ds_read_b64_tr_b16 a[186:187], v91 offset:256
L_lw_50:
    s_waitcnt lgkmcnt(0)
    s_cmp_lg_u32 s44, 0
    s_cbranch_scc1 L_v_probe_51
    s_add_u32 s45, s63, 0
    s_memtime s[72:73]
    s_waitcnt lgkmcnt(0)
    s_load_dword s78, s[20:21], s45
    s_waitcnt lgkmcnt(0)
    s_memtime s[74:75]
    s_waitcnt lgkmcnt(0)
    s_sub_u32 s45, s74, s72
    s_min_u32 s76, s76, s45
    s_cmp_lt_u32 s77, s76
    s_cselect_b32 s68, 1, 0
L_v_probe_51:
    s_waitcnt vmcnt(32)
    s_barrier
    s_add_u32 s51, s69, 5
    s_and_b32 s51, s51, 7
    s_lshl_b32 s51, s51, 17
    s_add_u32 s51, s51, s49
    s_add_u32 s46, s51, 0x0
    s_add_u32 m0, s65, 65536
    s_nop 0
    buffer_load_dwordx4 v70, s[36:39], s46 offen  lds
    s_add_u32 s46, s51, 0x8000
    s_add_u32 m0, s65, 66560
    s_nop 0
    buffer_load_dwordx4 v71, s[36:39], s46 offen  lds
    s_add_u32 s46, s51, 0x10000
    s_add_u32 m0, s65, 67584
    s_nop 0
    buffer_load_dwordx4 v72, s[36:39], s46 offen  lds
    s_add_u32 s46, s51, 0x18000
    s_add_u32 m0, s65, 68608
    s_nop 0
    buffer_load_dwordx4 v73, s[36:39], s46 offen  lds
    ds_read_b64_tr_b16 a[164:165], v88 offset:4096
    ds_read_b64_tr_b16 a[166:167], v88 offset:4352
    ds_read_b64_tr_b16 a[172:173], v89 offset:4096
    ds_read_b64_tr_b16 a[174:175], v89 offset:4352
    ds_read_b64_tr_b16 a[180:181], v90 offset:4096
    ds_read_b64_tr_b16 a[182:183], v90 offset:4352
    ds_read_b64_tr_b16 a[188:189], v91 offset:4096
    ds_read_b64_tr_b16 a[190:191], v91 offset:4352
L_lw_52:
    s_waitcnt lgkmcnt(0)
    s_cmp_lg_u32 s44, 0
    s_cbranch_scc1 L_v_probe_53
    s_add_u32 s45, s63, 8192
    s_memtime s[72:73]
    s_waitcnt lgkmcnt(0)
    s_load_dword s78, s[20:21], s45
    s_waitcnt lgkmcnt(0)
    s_memtime s[74:75]
    s_waitcnt lgkmcnt(0)
    s_sub_u32 s45, s74, s72
    s_min_u32 s77, s77, s45
    s_cmp_lt_u32 s77, s76
    s_cselect_b32 s68, 1, 0
L_v_probe_53:
    s_waitcnt vmcnt(32)
    s_barrier
    s_add_u32 s51, s69, 5
    s_and_b32 s51, s51, 7
    s_lshl_b32 s51, s51, 17
    s_add_u32 s51, s51, s49
    s_add_u32 s46, s51, 0x4000
    s_add_u32 m0, s65, 69632
    s_nop 0
    buffer_load_dwordx4 v70, s[36:39], s46 offen  lds
    s_add_u32 s46, s51, 0xc000
    s_add_u32 m0, s65, 70656
    s_nop 0
    buffer_load_dwordx4 v71, s[36:39], s46 offen  lds
    s_add_u32 s46, s51, 0x14000
    s_add_u32 m0, s65, 71680
    s_nop 0
    buffer_load_dwordx4 v72, s[36:39], s46 offen  lds
    s_add_u32 s46, s51, 0x1c000
    s_add_u32 m0, s65, 72704
    s_nop 0
    buffer_load_dwordx4 v73, s[36:39], s46 offen  lds
    ds_read_b64_tr_b16 a[192:193], v88 offset:8192
    ds_read_b64_tr_b16 a[194:195], v88 offset:8448
    ds_read_b64_tr_b16 a[200:201], v89 offset:8192
    ds_read_b64_tr_b16 a[202:203], v89 offset:8448
    ds_read_b64_tr_b16 a[208:209], v90 offset:8192
    ds_read_b64_tr_b16 a[210:211], v90 offset:8448
    ds_read_b64_tr_b16 a[216:217], v91 offset:8192
    ds_read_b64_tr_b16 a[218:219], v91 offset:8448
L_lw_54:
    s_waitcnt lgkmcnt(0)
    s_cmp_lg_u32 s44, 0
    s_cbranch_scc1 L_v_probe_55
    s_add_u32 s45, s63, 128
    s_memtime s[72:73]
    s_waitcnt lgkmcnt(0)
    s_load_dword s78, s[20:21], s45
    s_waitcnt lgkmcnt(0)
    s_memtime s[74:75]
    s_waitcnt lgkmcnt(0)
    s_sub_u32 s45, s74, s72
    s_min_u32 s76, s76, s45
    s_cmp_lt_u32 s77, s76
    s_cselect_b32 s68, 1, 0
L_v_probe_55:
    s_waitcnt vmcnt(32)
    s_barrier
    s_add_u32 s51, s69, 6
    s_and_b32 s51, s51, 7
    s_lshl_b32 s51, s51, 17
    s_add_u32 s51, s51, s49
    s_add_u32 s46, s51, 0x0
    s_add_u32 m0, s65, 73728
    s_nop 0
    buffer_load_dwordx4 v70, s[36:39], s46 offen  lds
    s_add_u32 s46, s51, 0x8000
    s_add_u32 m0, s65, 74752
    s_nop 0
    buffer_load_dwordx4 v71, s[36:39], s46 offen  lds
    s_add_u32 s46, s51, 0x10000
    s_add_u32 m0, s65, 75776
    s_nop 0
    buffer_load_dwordx4 v72, s[36:39], s46 offen  lds
    s_add_u32 s46, s51, 0x18000
    s_add_u32 m0, s65, 76800
    s_nop 0
    buffer_load_dwordx4 v73, s[36:39], s46 offen  lds
    ds_read_b64_tr_b16 a[196:197], v88 offset:12288
    ds_read_b64_tr_b16 a[198:199], v88 offset:12544
    ds_read_b64_tr_b16 a[204:205], v89 offset:12288
    ds_read_b64_tr_b16 a[206:207], v89 offset:12544
    ds_read_b64_tr_b16 a[212:213], v90 offset:12288
    ds_read_b64_tr_b16 a[214:215], v90 offset:12544
    ds_read_b64_tr_b16 a[220:221], v91 offset:12288
    ds_read_b64_tr_b16 a[222:223], v91 offset:12544
L_lw_56:
    s_waitcnt lgkmcnt(0)
    s_cmp_lg_u32 s44, 0
    s_cbranch_scc1 L_v_probe_57
    s_add_u32 s45, s63, 8320
    s_memtime s[72:73]
    s_waitcnt lgkmcnt(0)
    s_load_dword s78, s[20:21], s45
    s_waitcnt lgkmcnt(0)
    s_memtime s[74:75]
    s_waitcnt lgkmcnt(0)
    s_sub_u32 s45, s74, s72
    s_min_u32 s77, s77, s45
    s_cmp_lt_u32 s77, s76
    s_cselect_b32 s68, 1, 0
L_v_probe_57:
    s_waitcnt vmcnt(32)
    s_barrier
    s_add_u32 s51, s69, 6
    s_and_b32 s51, s51, 7
    s_lshl_b32 s51, s51, 17
    s_add_u32 s51, s51, s49
    s_add_u32 s46, s51, 0x4000
    s_add_u32 m0, s65, 77824
    s_nop 0
    buffer_load_dwordx4 v70, s[36:39], s46 offen  lds
    s_add_u32 s46, s51, 0xc000
    s_add_u32 m0, s65, 78848
    s_nop 0
    buffer_load_dwordx4 v71, s[36:39], s46 offen  lds
    s_add_u32 s46, s51, 0x14000
    s_add_u32 m0, s65, 79872
    s_nop 0
    buffer_load_dwordx4 v72, s[36:39], s46 offen  lds
    s_add_u32 s46, s51, 0x1c000
    s_add_u32 m0, s65, 80896
    s_nop 0
    buffer_load_dwordx4 v73, s[36:39], s46 offen  lds
    ds_read_b64_tr_b16 a[224:225], v88 offset:16384
    ds_read_b64_tr_b16 a[226:227], v88 offset:16640
    ds_read_b64_tr_b16 a[232:233], v89 offset:16384
    ds_read_b64_tr_b16 a[234:235], v89 offset:16640
    ds_read_b64_tr_b16 a[240:241], v90 offset:16384
    ds_read_b64_tr_b16 a[242:243], v90 offset:16640
    ds_read_b64_tr_b16 a[248:249], v91 offset:16384
    ds_read_b64_tr_b16 a[250:251], v91 offset:16640
L_lw_58:
    s_waitcnt lgkmcnt(0)
    s_cmp_lg_u32 s44, 0
    s_cbranch_scc1 L_v_probe_59
    s_add_u32 s45, s63, 256
    s_memtime s[72:73]
    s_waitcnt lgkmcnt(0)
    s_load_dword s78, s[20:21], s45
    s_waitcnt lgkmcnt(0)
    s_memtime s[74:75]
    s_waitcnt lgkmcnt(0)
    s_sub_u32 s45, s74, s72
    s_min_u32 s76, s76, s45
    s_cmp_lt_u32 s77, s76
    s_cselect_b32 s68, 1, 0
L_v_probe_59:
    s_waitcnt vmcnt(32)
    s_barrier
    s_add_u32 s51, s69, 7
    s_and_b32 s51, s51, 7
    s_lshl_b32 s51, s51, 17
    s_add_u32 s51, s51, s49
    s_add_u32 s46, s51, 0x0
    s_add_u32 m0, s65, 81920
    s_nop 0
    buffer_load_dwordx4 v70, s[36:39], s46 offen  lds
    s_add_u32 s46, s51, 0x8000
    s_add_u32 m0, s65, 82944
    s_nop 0
    buffer_load_dwordx4 v71, s[36:39], s46 offen  lds
    s_add_u32 s46, s51, 0x10000
    s_add_u32 m0, s65, 83968
    s_nop 0
    buffer_load_dwordx4 v72, s[36:39], s46 offen  lds
    s_add_u32 s46, s51, 0x18000
    s_add_u32 m0, s65, 84992
    s_nop 0
    buffer_load_dwordx4 v73, s[36:39], s46 offen  lds
    ds_read_b64_tr_b16 a[228:229], v88 offset:20480
    ds_read_b64_tr_b16 a[230:231], v88 offset:20736
    ds_read_b64_tr_b16 a[236:237], v89 offset:20480
    ds_read_b64_tr_b16 a[238:239], v89 offset:20736
    ds_read_b64_tr_b16 a[244:245], v90 offset:20480
    ds_read_b64_tr_b16 a[246:247], v90 offset:20736
    ds_read_b64_tr_b16 a[252:253], v91 offset:20480
    ds_read_b64_tr_b16 a[254:255], v91 offset:20736
L_lw_60:
    s_waitcnt lgkmcnt(0)
    s_cmp_lg_u32 s44, 0
    s_cbranch_scc1 L_v_probe_61
    s_add_u32 s45, s63, 8448
    s_memtime s[72:73]
    s_waitcnt lgkmcnt(0)
    s_load_dword s78, s[20:21], s45
    s_waitcnt lgkmcnt(0)
    s_memtime s[74:75]
    s_waitcnt lgkmcnt(0)
    s_sub_u32 s45, s74, s72
    s_min_u32 s77, s77, s45
    s_cmp_lt_u32 s77, s76
    s_cselect_b32 s68, 1, 0
L_v_probe_61:
    s_waitcnt vmcnt(32)
    s_barrier
    s_add_u32 s51, s69, 7
    s_and_b32 s51, s51, 7
    s_lshl_b32 s51, s51, 17
    s_add_u32 s51, s51, s49
    s_add_u32 s46, s51, 0x4000
    s_add_u32 m0, s65, 86016
    s_nop 0
    buffer_load_dwordx4 v70, s[36:39], s46 offen  lds
    s_add_u32 s46, s51, 0xc000
    s_add_u32 m0, s65, 87040
    s_nop 0
    buffer_load_dwordx4 v71, s[36:39], s46 offen  lds
    s_add_u32 s46, s51, 0x14000
    s_add_u32 m0, s65, 88064
    s_nop 0
    buffer_load_dwordx4 v72, s[36:39], s46 offen  lds
    s_add_u32 s46, s51, 0x1c000
    s_add_u32 m0, s65, 89088
    s_nop 0
    buffer_load_dwordx4 v73, s[36:39], s46 offen  lds
    ds_read_b64_tr_b16 v[96:97], v74 offset:0
    ds_read_b64_tr_b16 v[98:99], v74 offset:256
    ds_read_b64_tr_b16 v[104:105], v75 offset:0
    ds_read_b64_tr_b16 v[106:107], v75 offset:256
    ds_read_b64_tr_b16 v[112:113], v76 offset:0
    ds_read_b64_tr_b16 v[114:115], v76 offset:256
    ds_read_b64_tr_b16 v[120:121], v77 offset:0
    ds_read_b64_tr_b16 v[122:123], v77 offset:256
L_lw_62:
    s_waitcnt lgkmcnt(0)
    s_cmp_lg_u32 s44, 0
    s_cbranch_scc1 L_v_probe_63
    s_add_u32 s45, s63, 384
    s_memtime s[72:73]
    s_waitcnt lgkmcnt(0)
    s_load_dword s78, s[20:21], s45
    s_waitcnt lgkmcnt(0)
    s_memtime s[74:75]
    s_waitcnt lgkmcnt(0)
    s_sub_u32 s45, s74, s72
    s_min_u32 s76, s76, s45
    s_cmp_lt_u32 s77, s76
    s_cselect_b32 s68, 1, 0
L_v_probe_63:
    s_waitcnt vmcnt(32)
    s_barrier
    s_add_u32 s79, s41, 0
    s_and_b32 s79, s79, 3
    s_lshl_b32 s79, s79, 19
    s_add_u32 s79, s79, s47
    s_add_u32 s46, s79, 0x0
    s_add_u32 m0, s48, 0
    s_nop 0
    buffer_load_dwordx4 v82, s[32:35], s46 offen  lds
    s_add_u32 s46, s79, 0x20000
    s_add_u32 m0, s48, 4096
    s_nop 0
    buffer_load_dwordx4 v82, s[32:35], s46 offen  lds
    s_add_u32 s46, s79, 0x40000
    s_add_u32 m0, s48, 8192
    s_nop 0
    buffer_load_dwordx4 v82, s[32:35], s46 offen  lds
    s_add_u32 s46, s79, 0x60000
    s_add_u32 m0, s48, 12288
    s_nop 0
    buffer_load_dwordx4 v82, s[32:35], s46 offen  lds
    ds_read_b64_tr_b16 v[100:101], v74 offset:16384
    ds_read_b64_tr_b16 v[102:103], v74 offset:16640
    ds_read_b64_tr_b16 v[108:109], v75 offset:16384
    ds_read_b64_tr_b16 v[110:111], v75 offset:16640
    ds_read_b64_tr_b16 v[116:117], v76 offset:16384
    ds_read_b64_tr_b16 v[118:119], v76 offset:16640
    ds_read_b64_tr_b16 v[124:125], v77 offset:16384
    ds_read_b64_tr_b16 v[126:127], v77 offset:16640
L_lw_64:
    s_waitcnt lgkmcnt(0)
    s_cmp_lg_u32 s44, 0
    s_cbranch_scc1 L_v_probe_65
    s_add_u32 s45, s63, 8576
    s_memtime s[72:73]
    s_waitcnt lgkmcnt(0)
    s_load_dword s78, s[20:21], s45
    s_waitcnt lgkmcnt(0)
    s_memtime s[74:75]
    s_waitcnt lgkmcnt(0)
    s_sub_u32 s45, s74, s72
    s_min_u32 s77, s77, s45
    s_cmp_lt_u32 s77, s76
    s_cselect_b32 s68, 1, 0
L_v_probe_65:
    s_waitcnt vmcnt(32)
    s_barrier
    s_add_u32 s79, s41, 1
    s_and_b32 s79, s79, 3
    s_lshl_b32 s79, s79, 19
    s_add_u32 s79, s79, s47
    s_add_u32 s46, s79, 0x0
    s_add_u32 m0, s48, 16384
    s_nop 0
    buffer_load_dwordx4 v82, s[32:35], s46 offen  lds
    s_add_u32 s46, s79, 0x20000
    s_add_u32 m0, s48, 20480
    s_nop 0
    buffer_load_dwordx4 v82, s[32:35], s46 offen  lds
    s_add_u32 s46, s79, 0x40000
    s_add_u32 m0, s48, 24576
    s_nop 0
    buffer_load_dwordx4 v82, s[32:35], s46 offen  lds
    s_add_u32 s46, s79, 0x60000
    s_add_u32 m0, s48, 28672
    s_nop 0
    buffer_load_dwordx4 v82, s[32:35], s46 offen  lds
    ds_read_b64_tr_b16 v[128:129], v74 offset:32768
    ds_read_b64_tr_b16 v[130:131], v74 offset:33024
    ds_read_b64_tr_b16 v[136:137], v75 offset:32768
    ds_read_b64_tr_b16 v[138:139], v75 offset:33024
    ds_read_b64_tr_b16 v[144:145], v76 offset:32768
    ds_read_b64_tr_b16 v[146:147], v76 offset:33024
    ds_read_b64_tr_b16 v[152:153], v77 offset:32768
    ds_read_b64_tr_b16 v[154:155], v77 offset:33024
L_lw_66:
    s_waitcnt lgkmcnt(0)
    s_cmp_lg_u32 s44, 0
    s_cbranch_scc1 L_v_probe_67
    s_add_u32 s45, s63, 512
    s_memtime s[72:73]
    s_waitcnt lgkmcnt(0)
    s_load_dword s78, s[20:21], s45
    s_waitcnt lgkmcnt(0)
    s_memtime s[74:75]
    s_waitcnt lgkmcnt(0)
    s_sub_u32 s45, s74, s72
    s_min_u32 s76, s76, s45
    s_cmp_lt_u32 s77, s76
    s_cselect_b32 s68, 1, 0
L_v_probe_67:
    s_waitcnt vmcnt(32)
    s_barrier
    s_add_u32 s79, s41, 2
    s_and_b32 s79, s79, 3
    s_lshl_b32 s79, s79, 19
    s_add_u32 s79, s79, s47
    s_add_u32 s46, s79, 0x0
    s_add_u32 m0, s48, 32768
    s_nop 0
    buffer_load_dwordx4 v82, s[32:35], s46 offen  lds
    s_add_u32 s46, s79, 0x20000
    s_add_u32 m0, s48, 36864
    s_nop 0
    buffer_load_dwordx4 v82, s[32:35], s46 offen  lds
    s_add_u32 s46, s79, 0x40000
    s_add_u32 m0, s48, 40960
    s_nop 0
    buffer_load_dwordx4 v82, s[32:35], s46 offen  lds
    s_add_u32 s46, s79, 0x60000
    s_add_u32 m0, s48, 45056
    s_nop 0
    buffer_load_dwordx4 v82, s[32:35], s46 offen  lds
    ds_read_b64_tr_b16 v[132:133], v74 offset:49152
    ds_read_b64_tr_b16 v[134:135], v74 offset:49408
    ds_read_b64_tr_b16 v[140:141], v75 offset:49152
    ds_read_b64_tr_b16 v[142:143], v75 offset:49408
    ds_read_b64_tr_b16 v[148:149], v76 offset:49152
    ds_read_b64_tr_b16 v[150:151], v76 offset:49408
    ds_read_b64_tr_b16 v[156:157], v77 offset:49152
    ds_read_b64_tr_b16 v[158:159], v77 offset:49408
L_lw_68:
    s_waitcnt lgkmcnt(0)
    s_cmp_lg_u32 s44, 0
    s_cbranch_scc1 L_v_probe_69
    s_add_u32 s45, s63, 8704
    s_memtime s[72:73]
    s_waitcnt lgkmcnt(0)
    s_load_dword s78, s[20:21], s45
    s_waitcnt lgkmcnt(0)
    s_memtime s[74:75]
    s_waitcnt lgkmcnt(0)
    s_sub_u32 s45, s74, s72
    s_min_u32 s77, s77, s45
    s_cmp_lt_u32 s77, s76
    s_cselect_b32 s68, 1, 0
L_v_probe_69:
    s_waitcnt vmcnt(32)
    s_barrier
    s_add_u32 s79, s41, 3
    s_and_b32 s79, s79, 3
    s_lshl_b32 s79, s79, 19
    s_add_u32 s79, s79, s47
    s_add_u32 s46, s79, 0x0
    s_add_u32 m0, s48, 49152
    s_nop 0
    buffer_load_dwordx4 v82, s[32:35], s46 offen  lds
    s_add_u32 s46, s79, 0x20000
    s_add_u32 m0, s48, 53248
    s_nop 0
    buffer_load_dwordx4 v82, s[32:35], s46 offen  lds
    s_add_u32 s46, s79, 0x40000
    s_add_u32 m0, s48, 57344
    s_nop 0
    buffer_load_dwordx4 v82, s[32:35], s46 offen  lds
    s_add_u32 s46, s79, 0x60000
    s_add_u32 m0, s48, 61440
    s_nop 0
    buffer_load_dwordx4 v82, s[32:35], s46 offen  lds
    ds_read_b64_tr_b16 v[160:161], v88 offset:0
    ds_read_b64_tr_b16 v[162:163], v88 offset:256
    ds_read_b64_tr_b16 v[168:169], v89 offset:0
    ds_read_b64_tr_b16 v[170:171], v89 offset:256
    ds_read_b64_tr_b16 v[176:177], v90 offset:0
    ds_read_b64_tr_b16 v[178:179], v90 offset:256
    ds_read_b64_tr_b16 v[184:185], v91 offset:0
    ds_read_b64_tr_b16 v[186:187], v91 offset:256
L_lw_70:
    s_waitcnt lgkmcnt(0)
    s_waitcnt vmcnt(32)
    s_barrier
    s_cmp_lg_u32 s44, 0
    s_cbranch_scc1 L_hs_71
    s_getreg_b32 s45, hwreg(HW_REG_XCC_ID)
    s_and_b32 s45, s45, 15
    s_mul_i32 s46, s45, s45
    s_lshl_b32 s46, s46, 9
    s_add_u32 s45, s45, s46
    s_cmp_eq_u32 s40, 0
    s_cselect_b32 s46, s45, 0
    s_cselect_b32 s45, 0, s45
    s_lshl_b32 s68, s68, 24
    s_add_u32 s46, s46, s68
    s_add_u32 s45, s45, 16777216
    v_mov_b32 v40, s46
    v_mov_b32 v41, s45
    v_mov_b32 v42, 0
    s_mov_b64 exec, 1
    buffer_atomic_add_x2 v[40:41], v42, s[16:19], 0 offen sc1
    s_mov_b64 exec, -1
L_hs_71:
    ds_read_b64_tr_b16 v[164:165], v88 offset:4096
    ds_read_b64_tr_b16 v[166:167], v88 offset:4352
    ds_read_b64_tr_b16 v[172:173], v89 offset:4096
    ds_read_b64_tr_b16 v[174:175], v89 offset:4352
    ds_read_b64_tr_b16 v[180:181], v90 offset:4096
    ds_read_b64_tr_b16 v[182:183], v90 offset:4352
    ds_read_b64_tr_b16 v[188:189], v91 offset:4096
    ds_read_b64_tr_b16 v[190:191], v91 offset:4352
L_lw_72:
    s_waitcnt lgkmcnt(0)
    s_waitcnt vmcnt(28)
    s_barrier
    ds_read_b64_tr_b16 v[192:193], v88 offset:8192
    ds_read_b64_tr_b16 v[194:195], v88 offset:8448
    ds_read_b64_tr_b16 v[200:201], v89 offset:8192
    ds_read_b64_tr_b16 v[202:203], v89 offset:8448
    ds_read_b64_tr_b16 v[208:209], v90 offset:8192
    ds_read_b64_tr_b16 v[210:211], v90 offset:8448
    ds_read_b64_tr_b16 v[216:217], v91 offset:8192
    ds_read_b64_tr_b16 v[218:219], v91 offset:8448
L_lw_73:
    s_waitcnt lgkmcnt(0)
    s_waitcnt vmcnt(24)
    s_barrier
    ds_read_b64_tr_b16 v[196:197], v88 offset:12288
    ds_read_b64_tr_b16 v[198:199], v88 offset:12544
    ds_read_b64_tr_b16 v[204:205], v89 offset:12288
    ds_read_b64_tr_b16 v[206:207], v89 offset:12544
    ds_read_b64_tr_b16 v[212:213], v90 offset:12288
    ds_read_b64_tr_b16 v[214:215], v90 offset:12544
    ds_read_b64_tr_b16 v[220:221], v91 offset:12288
    ds_read_b64_tr_b16 v[222:223], v91 offset:12544
L_lw_74:
    s_waitcnt lgkmcnt(0)
    s_waitcnt vmcnt(20)
    s_barrier
    ds_read_b64_tr_b16 v[224:225], v88 offset:16384
    ds_read_b64_tr_b16 v[226:227], v88 offset:16640
    ds_read_b64_tr_b16 v[232:233], v89 offset:16384
    ds_read_b64_tr_b16 v[234:235], v89 offset:16640
    ds_read_b64_tr_b16 v[240:241], v90 offset:16384
    ds_read_b64_tr_b16 v[242:243], v90 offset:16640
    ds_read_b64_tr_b16 v[248:249], v91 offset:16384
    ds_read_b64_tr_b16 v[250:251], v91 offset:16640
L_lw_75:
    s_waitcnt lgkmcnt(0)
    s_waitcnt vmcnt(16)
    s_barrier
    ds_read_b64_tr_b16 v[228:229], v88 offset:20480
    ds_read_b64_tr_b16 v[230:231], v88 offset:20736
    ds_read_b64_tr_b16 v[236:237], v89 offset:20480
    ds_read_b64_tr_b16 v[238:239], v89 offset:20736
    ds_read_b64_tr_b16 v[244:245], v90 offset:20480
    ds_read_b64_tr_b16 v[246:247], v90 offset:20736
    ds_read_b64_tr_b16 v[252:253], v91 offset:20480
    ds_read_b64_tr_b16 v[254:255], v91 offset:20736
L_lw_76:
    s_waitcnt lgkmcnt(0)
    s_waitcnt vmcnt(12)
    s_barrier
    s_cmp_lg_u32 s44, 0
    s_cbranch_scc1 L_lw_77_0
    ds_read_b64_tr_b16 a[0:1], v80 offset:0
    ds_read_b64_tr_b16 a[2:3], v80 offset:1024
    ds_read_b64_tr_b16 a[4:5], v80 offset:8192
    ds_read_b64_tr_b16 a[6:7], v80 offset:9216
    ds_read_b64_tr_b16 a[8:9], v81 offset:0
    ds_read_b64_tr_b16 a[10:11], v81 offset:1024
    ds_read_b64_tr_b16 a[12:13], v81 offset:8192
    ds_read_b64_tr_b16 a[14:15], v81 offset:9216
    s_branch L_lw_77
L_lw_77_0:
    s_cmp_lg_u32 s44, 1
    s_cbranch_scc1 L_lw_77_1
    ds_read_b64_tr_b16 a[120:121], v80 offset:0
    ds_read_b64_tr_b16 a[122:123], v80 offset:1024
    ds_read_b64_tr_b16 a[124:125], v80 offset:8192
    ds_read_b64_tr_b16 a[126:127], v80 offset:9216
    ds_read_b64_tr_b16 v[56:57], v81 offset:0
    ds_read_b64_tr_b16 v[58:59], v81 offset:1024
    ds_read_b64_tr_b16 v[60:61], v81 offset:8192
    ds_read_b64_tr_b16 v[62:63], v81 offset:9216
    s_waitcnt lgkmcnt(0)
    ds_write_b128 v5, v[56:59] offset:0
    ds_write_b128 v5, v[60:63] offset:1024
    s_branch L_lw_77
L_lw_77_1:
    s_cmp_lg_u32 s44, 2
    s_cbranch_scc1 L_lw_77_2
    ds_read_b64_tr_b16 a[80:81], v80 offset:0
    ds_read_b64_tr_b16 a[82:83], v80 offset:1024
    ds_read_b64_tr_b16 a[84:85], v80 offset:8192
    ds_read_b64_tr_b16 a[86:87], v80 offset:9216
    ds_read_b64_tr_b16 v[56:57], v81 offset:0
    ds_read_b64_tr_b16 v[58:59], v81 offset:1024
    ds_read_b64_tr_b16 v[60:61], v81 offset:8192
    ds_read_b64_tr_b16 v[62:63], v81 offset:9216
    s_waitcnt lgkmcnt(0)
    ds_write_b128 v5, v[56:59] offset:2048
    ds_write_b128 v5, v[60:63] offset:3072
    s_branch L_lw_77
L_lw_77_2:
    ds_read_b64_tr_b16 a[48:49], v80 offset:0
    ds_read_b64_tr_b16 a[50:51], v80 offset:1024
    ds_read_b64_tr_b16 a[52:53], v80 offset:8192
    ds_read_b64_tr_b16 a[54:55], v80 offset:9216
    ds_read_b64_tr_b16 v[56:57], v81 offset:0
    ds_read_b64_tr_b16 v[58:59], v81 offset:1024
    ds_read_b64_tr_b16 v[60:61], v81 offset:8192
    ds_read_b64_tr_b16 v[62:63], v81 offset:9216
    s_waitcnt lgkmcnt(0)
    ds_write_b128 v5, v[56:59] offset:4096
    ds_write_b128 v5, v[60:63] offset:5120
L_lw_77:
    s_waitcnt lgkmcnt(0)
    s_waitcnt vmcnt(8)
    s_barrier
    s_add_u32 s79, s41, 4
    s_and_b32 s79, s79, 3
    s_lshl_b32 s79, s79, 19
    s_add_u32 s79, s79, s47
    s_add_u32 s46, s79, 0x200000
    s_add_u32 m0, s48, 0
    s_nop 0
    buffer_load_dwordx4 v82, s[32:35], s46 offen  lds
    s_add_u32 s46, s79, 0x220000
    s_add_u32 m0, s48, 4096
    s_nop 0
    buffer_load_dwordx4 v82, s[32:35], s46 offen  lds
    s_add_u32 s46, s79, 0x240000
    s_add_u32 m0, s48, 8192
    s_nop 0
    buffer_load_dwordx4 v82, s[32:35], s46 offen  lds
    s_add_u32 s46, s79, 0x260000
    s_add_u32 m0, s48, 12288
    s_nop 0
    buffer_load_dwordx4 v82, s[32:35], s46 offen  lds
    s_cmp_lg_u32 s44, 0
    s_cbranch_scc1 L_lw_78_0
    ds_read_b64_tr_b16 a[16:17], v80 offset:16384
    ds_read_b64_tr_b16 a[18:19], v80 offset:17408
    ds_read_b64_tr_b16 a[20:21], v80 offset:24576
    ds_read_b64_tr_b16 a[22:23], v80 offset:25600
    ds_read_b64_tr_b16 a[24:25], v81 offset:16384
    ds_read_b64_tr_b16 a[26:27], v81 offset:17408
    ds_read_b64_tr_b16 a[28:29], v81 offset:24576
    ds_read_b64_tr_b16 a[30:31], v81 offset:25600
    s_branch L_lw_78
L_lw_78_0:
    s_cmp_lg_u32 s44, 1
    s_cbranch_scc1 L_lw_78_1
    ds_read_b64_tr_b16 a[128:129], v80 offset:16384
    ds_read_b64_tr_b16 a[130:131], v80 offset:17408
    ds_read_b64_tr_b16 a[132:133], v80 offset:24576
    ds_read_b64_tr_b16 a[134:135], v80 offset:25600
    ds_read_b64_tr_b16 a[136:137], v81 offset:16384
    ds_read_b64_tr_b16 a[138:139], v81 offset:17408
    ds_read_b64_tr_b16 a[140:141], v81 offset:24576
    ds_read_b64_tr_b16 a[142:143], v81 offset:25600
    s_branch L_lw_78
L_lw_78_1:
    s_cmp_lg_u32 s44, 2
    s_cbranch_scc1 L_lw_78_2
    ds_read_b64_tr_b16 a[88:89], v80 offset:16384
    ds_read_b64_tr_b16 a[90:91], v80 offset:17408
    ds_read_b64_tr_b16 a[92:93], v80 offset:24576
    ds_read_b64_tr_b16 a[94:95], v80 offset:25600
    ds_read_b64_tr_b16 a[96:97], v81 offset:16384
    ds_read_b64_tr_b16 a[98:99], v81 offset:17408
    ds_read_b64_tr_b16 a[100:101], v81 offset:24576
    ds_read_b64_tr_b16 a[102:103], v81 offset:25600
    s_branch L_lw_78
L_lw_78_2:
    ds_read_b64_tr_b16 a[56:57], v80 offset:16384
    ds_read_b64_tr_b16 a[58:59], v80 offset:17408
    ds_read_b64_tr_b16 a[60:61], v80 offset:24576
    ds_read_b64_tr_b16 a[62:63], v80 offset:25600
    ds_read_b64_tr_b16 v[56:57], v81 offset:16384
    ds_read_b64_tr_b16 v[58:59], v81 offset:17408
    ds_read_b64_tr_b16 v[60:61], v81 offset:24576
    ds_read_b64_tr_b16 v[62:63], v81 offset:25600
    s_waitcnt lgkmcnt(0)
    ds_write_b128 v5, v[56:59] offset:6144
    ds_write_b128 v5, v[60:63] offset:7168
L_lw_78:
    s_waitcnt lgkmcnt(0)
    s_waitcnt vmcnt(8)
    s_barrier
    s_add_u32 s79, s41, 5
    s_and_b32 s79, s79, 3
    s_lshl_b32 s79, s79, 19
    s_add_u32 s79, s79, s47
    s_add_u32 s46, s79, 0x200000
    s_add_u32 m0, s48, 16384
    s_nop 0
    buffer_load_dwordx4 v82, s[32:35], s46 offen  lds
    s_add_u32 s46, s79, 0x220000
    s_add_u32 m0, s48, 20480
    s_nop 0
    buffer_load_dwordx4 v82, s[32:35], s46 offen  lds
    s_add_u32 s46, s79, 0x240000
    s_add_u32 m0, s48, 24576
    s_nop 0
    buffer_load_dwordx4 v82, s[32:35], s46 offen  lds
    s_add_u32 s46, s79, 0x260000
    s_add_u32 m0, s48, 28672
    s_nop 0
    buffer_load_dwordx4 v82, s[32:35], s46 offen  lds
    s_cmp_lg_u32 s44, 0
    s_cbranch_scc1 L_lw_79_0
    ds_read_b64_tr_b16 a[32:33], v80 offset:32768
    ds_read_b64_tr_b16 a[34:35], v80 offset:33792
    ds_read_b64_tr_b16 a[36:37], v80 offset:40960
    ds_read_b64_tr_b16 a[38:39], v80 offset:41984
    ds_read_b64_tr_b16 v[56:57], v81 offset:32768
    ds_read_b64_tr_b16 v[58:59], v81 offset:33792
    ds_read_b64_tr_b16 v[60:61], v81 offset:40960
    ds_read_b64_tr_b16 v[62:63], v81 offset:41984
    s_waitcnt lgkmcnt(0)
    ds_write_b128 v5, v[56:59] offset:8192
    ds_write_b128 v5, v[60:63] offset:9216
    s_branch L_lw_79
L_lw_79_0:
    s_cmp_lg_u32 s44, 1
    s_cbranch_scc1 L_lw_79_1
    ds_read_b64_tr_b16 a[144:145], v80 offset:32768
    ds_read_b64_tr_b16 a[146:147], v80 offset:33792
    ds_read_b64_tr_b16 a[148:149], v80 offset:40960
    ds_read_b64_tr_b16 a[150:151], v80 offset:41984
    ds_read_b64_tr_b16 v[56:57], v81 offset:32768
    ds_read_b64_tr_b16 v[58:59], v81 offset:33792
    ds_read_b64_tr_b16 v[60:61], v81 offset:40960
    ds_read_b64_tr_b16 v[62:63], v81 offset:41984
    s_waitcnt lgkmcnt(0)
    ds_write_b128 v5, v[56:59] offset:10240
    ds_write_b128 v5, v[60:63] offset:11264
    s_branch L_lw_79
L_lw_79_1:
    s_cmp_lg_u32 s44, 2
    s_cbranch_scc1 L_lw_79_2
    ds_read_b64_tr_b16 a[104:105], v80 offset:32768
    ds_read_b64_tr_b16 a[106:107], v80 offset:33792
    ds_read_b64_tr_b16 a[108:109], v80 offset:40960
    ds_read_b64_tr_b16 a[110:111], v80 offset:41984
    ds_read_b64_tr_b16 v[56:57], v81 offset:32768
    ds_read_b64_tr_b16 v[58:59], v81 offset:33792
    ds_read_b64_tr_b16 v[60:61], v81 offset:40960
    ds_read_b64_tr_b16 v[62:63], v81 offset:41984
    s_waitcnt lgkmcnt(0)
    ds_write_b128 v5, v[56:59] offset:12288
    ds_write_b128 v5, v[60:63] offset:13312
    s_branch L_lw_79
L_lw_79_2:
    ds_read_b64_tr_b16 a[64:65], v80 offset:32768
    ds_read_b64_tr_b16 a[66:67], v80 offset:33792
    ds_read_b64_tr_b16 a[68:69], v80 offset:40960
    ds_read_b64_tr_b16 a[70:71], v80 offset:41984
    ds_read_b64_tr_b16 v[56:57], v81 offset:32768
    ds_read_b64_tr_b16 v[58:59], v81 offset:33792
    ds_read_b64_tr_b16 v[60:61], v81 offset:40960
    ds_read_b64_tr_b16 v[62:63], v81 offset:41984
    s_waitcnt lgkmcnt(0)
    ds_write_b128 v5, v[56:59] offset:14336
    ds_write_b128 v5, v[60:63] offset:15360
L_lw_79:
    s_waitcnt lgkmcnt(0)
    s_waitcnt vmcnt(8)
    s_barrier
    s_add_u32 s79, s41, 6
    s_and_b32 s79, s79, 3
    s_lshl_b32 s79, s79, 19
    s_add_u32 s79, s79, s47
    s_add_u32 s46, s79, 0x200000
    s_add_u32 m0, s48, 32768
    s_nop 0
    buffer_load_dwordx4 v82, s[32:35], s46 offen  lds
    s_add_u32 s46, s79, 0x220000
    s_add_u32 m0, s48, 36864
    s_nop 0
    buffer_load_dwordx4 v82, s[32:35], s46 offen  lds
    s_add_u32 s46, s79, 0x240000
    s_add_u32 m0, s48, 40960
    s_nop 0
    buffer_load_dwordx4 v82, s[32:35], s46 offen  lds
    s_add_u32 s46, s79, 0x260000
    s_add_u32 m0, s48, 45056
    s_nop 0
    buffer_load_dwordx4 v82, s[32:35], s46 offen  lds
    s_cmp_lg_u32 s44, 0
    s_cbranch_scc1 L_lw_80_0
    ds_read_b64_tr_b16 a[40:41], v80 offset:49152
    ds_read_b64_tr_b16 a[42:43], v80 offset:50176
    ds_read_b64_tr_b16 a[44:45], v80 offset:57344
    ds_read_b64_tr_b16 a[46:47], v80 offset:58368
    ds_read_b64_tr_b16 v[56:57], v81 offset:49152
    ds_read_b64_tr_b16 v[58:59], v81 offset:50176
    ds_read_b64_tr_b16 v[60:61], v81 offset:57344
    ds_read_b64_tr_b16 v[62:63], v81 offset:58368
    s_waitcnt lgkmcnt(0)
    ds_write_b128 v5, v[56:59] offset:16384
    ds_write_b128 v5, v[60:63] offset:17408
    s_branch L_lw_80
L_lw_80_0:
    s_cmp_lg_u32 s44, 1
    s_cbranch_scc1 L_lw_80_1
    ds_read_b64_tr_b16 a[152:153], v80 offset:49152
    ds_read_b64_tr_b16 a[154:155], v80 offset:50176
    ds_read_b64_tr_b16 a[156:157], v80 offset:57344
    ds_read_b64_tr_b16 a[158:159], v80 offset:58368
    ds_read_b64_tr_b16 v[56:57], v81 offset:49152
    ds_read_b64_tr_b16 v[58:59], v81 offset:50176
    ds_read_b64_tr_b16 v[60:61], v81 offset:57344
    ds_read_b64_tr_b16 v[62:63], v81 offset:58368
    s_waitcnt lgkmcnt(0)
    ds_write_b128 v5, v[56:59] offset:18432
    ds_write_b128 v5, v[60:63] offset:19456
    s_branch L_lw_80
L_lw_80_1:
    s_cmp_lg_u32 s44, 2
    s_cbranch_scc1 L_lw_80_2
    ds_read_b64_tr_b16 a[112:113], v80 offset:49152
    ds_read_b64_tr_b16 a[114:115], v80 offset:50176
    ds_read_b64_tr_b16 a[116:117], v80 offset:57344
    ds_read_b64_tr_b16 a[118:119], v80 offset:58368
    ds_read_b64_tr_b16 v[56:57], v81 offset:49152
    ds_read_b64_tr_b16 v[58:59], v81 offset:50176
    ds_read_b64_tr_b16 v[60:61], v81 offset:57344
    ds_read_b64_tr_b16 v[62:63], v81 offset:58368
    s_waitcnt lgkmcnt(0)
    ds_write_b128 v5, v[56:59] offset:20480
    ds_write_b128 v5, v[60:63] offset:21504
    s_branch L_lw_80
L_lw_80_2:
    ds_read_b64_tr_b16 a[72:73], v80 offset:49152
    ds_read_b64_tr_b16 a[74:75], v80 offset:50176
    ds_read_b64_tr_b16 a[76:77], v80 offset:57344
    ds_read_b64_tr_b16 a[78:79], v80 offset:58368
    ds_read_b64_tr_b16 v[56:57], v81 offset:49152
    ds_read_b64_tr_b16 v[58:59], v81 offset:50176
    ds_read_b64_tr_b16 v[60:61], v81 offset:57344
    ds_read_b64_tr_b16 v[62:63], v81 offset:58368
    s_waitcnt lgkmcnt(0)
    ds_write_b128 v5, v[56:59] offset:22528
    ds_write_b128 v5, v[60:63] offset:23552
L_lw_80:
    s_waitcnt lgkmcnt(0)
    s_waitcnt vmcnt(8)
    s_barrier
    s_add_u32 s79, s41, 7
    s_and_b32 s79, s79, 3
    s_lshl_b32 s79, s79, 19
    s_add_u32 s79, s79, s47
    s_add_u32 s46, s79, 0x200000
    s_add_u32 m0, s48, 49152
    s_nop 0
    buffer_load_dwordx4 v82, s[32:35], s46 offen  lds
    s_add_u32 s46, s79, 0x220000
    s_add_u32 m0, s48, 53248
    s_nop 0
    buffer_load_dwordx4 v82, s[32:35], s46 offen  lds
    s_add_u32 s46, s79, 0x240000
    s_add_u32 m0, s48, 57344
    s_nop 0
    buffer_load_dwordx4 v82, s[32:35], s46 offen  lds
    s_add_u32 s46, s79, 0x260000
    s_add_u32 m0, s48, 61440
    s_nop 0
    buffer_load_dwordx4 v82, s[32:35], s46 offen  lds
    s_cmp_lg_u32 s44, 0
    s_cbranch_scc1 L_lw_81_0
    ds_read_b64_tr_b16 a[48:49], v80 offset:0
    ds_read_b64_tr_b16 a[50:51], v80 offset:1024
    ds_read_b64_tr_b16 a[52:53], v80 offset:8192
    ds_read_b64_tr_b16 a[54:55], v80 offset:9216
    ds_read_b64_tr_b16 v[56:57], v81 offset:0
    ds_read_b64_tr_b16 v[58:59], v81 offset:1024
    ds_read_b64_tr_b16 v[60:61], v81 offset:8192
    ds_read_b64_tr_b16 v[62:63], v81 offset:9216
    s_waitcnt lgkmcnt(0)
    ds_write_b128 v5, v[56:59] offset:4096
    ds_write_b128 v5, v[60:63] offset:5120
    s_branch L_lw_81
L_lw_81_0:
    s_cmp_lg_u32 s44, 1
    s_cbranch_scc1 L_lw_81_1
    ds_read_b64_tr_b16 a[0:1], v80 offset:0
    ds_read_b64_tr_b16 a[2:3], v80 offset:1024
    ds_read_b64_tr_b16 a[4:5], v80 offset:8192
    ds_read_b64_tr_b16 a[6:7], v80 offset:9216
    ds_read_b64_tr_b16 a[8:9], v81 offset:0
    ds_read_b64_tr_b16 a[10:11], v81 offset:1024
    ds_read_b64_tr_b16 a[12:13], v81 offset:8192
    ds_read_b64_tr_b16 a[14:15], v81 offset:9216
    s_branch L_lw_81
L_lw_81_1:
    s_cmp_lg_u32 s44, 2
    s_cbranch_scc1 L_lw_81_2
    ds_read_b64_tr_b16 a[120:121], v80 offset:0
    ds_read_b64_tr_b16 a[122:123], v80 offset:1024
    ds_read_b64_tr_b16 a[124:125], v80 offset:8192
    ds_read_b64_tr_b16 a[126:127], v80 offset:9216
    ds_read_b64_tr_b16 v[56:57], v81 offset:0
    ds_read_b64_tr_b16 v[58:59], v81 offset:1024
    ds_read_b64_tr_b16 v[60:61], v81 offset:8192
    ds_read_b64_tr_b16 v[62:63], v81 offset:9216
    s_waitcnt lgkmcnt(0)
    ds_write_b128 v5, v[56:59] offset:0
    ds_write_b128 v5, v[60:63] offset:1024
    s_branch L_lw_81
L_lw_81_2:
    ds_read_b64_tr_b16 a[80:81], v80 offset:0
    ds_read_b64_tr_b16 a[82:83], v80 offset:1024
    ds_read_b64_tr_b16 a[84:85], v80 offset:8192
    ds_read_b64_tr_b16 a[86:87], v80 offset:9216
    ds_read_b64_tr_b16 v[56:57], v81 offset:0
    ds_read_b64_tr_b16 v[58:59], v81 offset:1024
    ds_read_b64_tr_b16 v[60:61], v81 offset:8192
    ds_read_b64_tr_b16 v[62:63], v81 offset:9216
    s_waitcnt lgkmcnt(0)
    ds_write_b128 v5, v[56:59] offset:2048
    ds_write_b128 v5, v[60:63] offset:3072
L_lw_81:
    s_waitcnt lgkmcnt(0)
    s_waitcnt vmcnt(8)
    s_barrier
    s_add_u32 s79, s41, 8
    s_and_b32 s79, s79, 3
    s_lshl_b32 s79, s79, 19
    s_add_u32 s79, s79, s47
    s_add_u32 s46, s79, 0x400000
    s_add_u32 m0, s48, 0
    s_nop 0
    buffer_load_dwordx4 v82, s[32:35], s46 offen  lds
    s_add_u32 s46, s79, 0x420000
    s_add_u32 m0, s48, 4096
    s_nop 0
    buffer_load_dwordx4 v82, s[32:35], s46 offen  lds
    s_add_u32 s46, s79, 0x440000
    s_add_u32 m0, s48, 8192
    s_nop 0
    buffer_load_dwordx4 v82, s[32:35], s46 offen  lds
    s_add_u32 s46, s79, 0x460000
    s_add_u32 m0, s48, 12288
    s_nop 0
    buffer_load_dwordx4 v82, s[32:35], s46 offen  lds
    s_cmp_lg_u32 s44, 0
    s_cbranch_scc1 L_lw_82_0
    ds_read_b64_tr_b16 a[56:57], v80 offset:16384
    ds_read_b64_tr_b16 a[58:59], v80 offset:17408
    ds_read_b64_tr_b16 a[60:61], v80 offset:24576
    ds_read_b64_tr_b16 a[62:63], v80 offset:25600
    ds_read_b64_tr_b16 v[56:57], v81 offset:16384
    ds_read_b64_tr_b16 v[58:59], v81 offset:17408
    ds_read_b64_tr_b16 v[60:61], v81 offset:24576
    ds_read_b64_tr_b16 v[62:63], v81 offset:25600
    s_waitcnt lgkmcnt(0)
    ds_write_b128 v5, v[56:59] offset:6144
    ds_write_b128 v5, v[60:63] offset:7168
    s_branch L_lw_82
L_lw_82_0:
    s_cmp_lg_u32 s44, 1
    s_cbranch_scc1 L_lw_82_1
    ds_read_b64_tr_b16 a[16:17], v80 offset:16384
    ds_read_b64_tr_b16 a[18:19], v80 offset:17408
    ds_read_b64_tr_b16 a[20:21], v80 offset:24576
    ds_read_b64_tr_b16 a[22:23], v80 offset:25600
    ds_read_b64_tr_b16 a[24:25], v81 offset:16384
    ds_read_b64_tr_b16 a[26:27], v81 offset:17408
    ds_read_b64_tr_b16 a[28:29], v81 offset:24576
    ds_read_b64_tr_b16 a[30:31], v81 offset:25600
    s_branch L_lw_82
L_lw_82_1:
    s_cmp_lg_u32 s44, 2
    s_cbranch_scc1 L_lw_82_2
    ds_read_b64_tr_b16 a[128:129], v80 offset:16384
    ds_read_b64_tr_b16 a[130:131], v80 offset:17408
    ds_read_b64_tr_b16 a[132:133], v80 offset:24576
    ds_read_b64_tr_b16 a[134:135], v80 offset:25600
    ds_read_b64_tr_b16 a[136:137], v81 offset:16384
    ds_read_b64_tr_b16 a[138:139], v81 offset:17408
    ds_read_b64_tr_b16 a[140:141], v81 offset:24576
    ds_read_b64_tr_b16 a[142:143], v81 offset:25600
    s_branch L_lw_82
L_lw_82_2:
    ds_read_b64_tr_b16 a[88:89], v80 offset:16384
    ds_read_b64_tr_b16 a[90:91], v80 offset:17408
    ds_read_b64_tr_b16 a[92:93], v80 offset:24576
    ds_read_b64_tr_b16 a[94:95], v80 offset:25600
    ds_read_b64_tr_b16 a[96:97], v81 offset:16384
    ds_read_b64_tr_b16 a[98:99], v81 offset:17408
    ds_read_b64_tr_b16 a[100:101], v81 offset:24576
    ds_read_b64_tr_b16 a[102:103], v81 offset:25600
L_lw_82:
    s_waitcnt lgkmcnt(0)
    s_waitcnt vmcnt(8)
    s_barrier
    s_add_u32 s79, s41, 9
    s_and_b32 s79, s79, 3
    s_lshl_b32 s79, s79, 19
    s_add_u32 s79, s79, s47
    s_add_u32 s46, s79, 0x400000
    s_add_u32 m0, s48, 16384
    s_nop 0
    buffer_load_dwordx4 v82, s[32:35], s46 offen  lds
    s_add_u32 s46, s79, 0x420000
    s_add_u32 m0, s48, 20480
    s_nop 0
    buffer_load_dwordx4 v82, s[32:35], s46 offen  lds
    s_add_u32 s46, s79, 0x440000
    s_add_u32 m0, s48, 24576
    s_nop 0
    buffer_load_dwordx4 v82, s[32:35], s46 offen  lds
    s_add_u32 s46, s79, 0x460000
    s_add_u32 m0, s48, 28672
    s_nop 0
    buffer_load_dwordx4 v82, s[32:35], s46 offen  lds
    s_cmp_lg_u32 s44, 0
    s_cbranch_scc1 L_lw_83_0
    ds_read_b64_tr_b16 a[64:65], v80 offset:32768
    ds_read_b64_tr_b16 a[66:67], v80 offset:33792
    ds_read_b64_tr_b16 a[68:69], v80 offset:40960
    ds_read_b64_tr_b16 a[70:71], v80 offset:41984
    ds_read_b64_tr_b16 v[56:57], v81 offset:32768
    ds_read_b64_tr_b16 v[58:59], v81 offset:33792
    ds_read_b64_tr_b16 v[60:61], v81 offset:40960
    ds_read_b64_tr_b16 v[62:63], v81 offset:41984
    s_waitcnt lgkmcnt(0)
    ds_write_b128 v5, v[56:59] offset:14336
    ds_write_b128 v5, v[60:63] offset:15360
    s_branch L_lw_83
L_lw_83_0:
    s_cmp_lg_u32 s44, 1
    s_cbranch_scc1 L_lw_83_1
    ds_read_b64_tr_b16 a[32:33], v80 offset:32768
    ds_read_b64_tr_b16 a[34:35], v80 offset:33792
    ds_read_b64_tr_b16 a[36:37], v80 offset:40960
    ds_read_b64_tr_b16 a[38:39], v80 offset:41984
    ds_read_b64_tr_b16 v[56:57], v81 offset:32768
    ds_read_b64_tr_b16 v[58:59], v81 offset:33792
    ds_read_b64_tr_b16 v[60:61], v81 offset:40960
    ds_read_b64_tr_b16 v[62:63], v81 offset:41984
    s_waitcnt lgkmcnt(0)
    ds_write_b128 v5, v[56:59] offset:8192
    ds_write_b128 v5, v[60:63] offset:9216
    s_branch L_lw_83
L_lw_83_1:
    s_cmp_lg_u32 s44, 2
    s_cbranch_scc1 L_lw_83_2
    ds_read_b64_tr_b16 a[144:145], v80 offset:32768
    ds_read_b64_tr_b16 a[146:147], v80 offset:33792
    ds_read_b64_tr_b16 a[148:149], v80 offset:40960
    ds_read_b64_tr_b16 a[150:151], v80 offset:41984
    ds_read_b64_tr_b16 v[56:57], v81 offset:32768
    ds_read_b64_tr_b16 v[58:59], v81 offset:33792
    ds_read_b64_tr_b16 v[60:61], v81 offset:40960
    ds_read_b64_tr_b16 v[62:63], v81 offset:41984
    s_waitcnt lgkmcnt(0)
    ds_write_b128 v5, v[56:59] offset:10240
    ds_write_b128 v5, v[60:63] offset:11264
    s_branch L_lw_83
L_lw_83_2:
    ds_read_b64_tr_b16 a[104:105], v80 offset:32768
    ds_read_b64_tr_b16 a[106:107], v80 offset:33792
    ds_read_b64_tr_b16 a[108:109], v80 offset:40960
    ds_read_b64_tr_b16 a[110:111], v80 offset:41984
    ds_read_b64_tr_b16 v[56:57], v81 offset:32768
    ds_read_b64_tr_b16 v[58:59], v81 offset:33792
    ds_read_b64_tr_b16 v[60:61], v81 offset:40960
    ds_read_b64_tr_b16 v[62:63], v81 offset:41984
    s_waitcnt lgkmcnt(0)
    ds_write_b128 v5, v[56:59] offset:12288
    ds_write_b128 v5, v[60:63] offset:13312
L_lw_83:
    s_waitcnt lgkmcnt(0)
    s_waitcnt vmcnt(8)
    s_barrier
    s_add_u32 s79, s41, 10
    s_and_b32 s79, s79, 3
    s_lshl_b32 s79, s79, 19
    s_add_u32 s79, s79, s47
    s_add_u32 s46, s79, 0x400000
    s_add_u32 m0, s48, 32768
    s_nop 0
    buffer_load_dwordx4 v82, s[32:35], s46 offen  lds
    s_add_u32 s46, s79, 0x420000
    s_add_u32 m0, s48, 36864
    s_nop 0
    buffer_load_dwordx4 v82, s[32:35], s46 offen  lds
    s_add_u32 s46, s79, 0x440000
    s_add_u32 m0, s48, 40960
    s_nop 0
    buffer_load_dwordx4 v82, s[32:35], s46 offen  lds
    s_add_u32 s46, s79, 0x460000
    s_add_u32 m0, s48, 45056
    s_nop 0
    buffer_load_dwordx4 v82, s[32:35], s46 offen  lds
    s_cmp_lg_u32 s44, 0
    s_cbranch_scc1 L_lw_84_0
    ds_read_b64_tr_b16 a[72:73], v80 offset:49152
    ds_read_b64_tr_b16 a[74:75], v80 offset:50176
    ds_read_b64_tr_b16 a[76:77], v80 offset:57344
    ds_read_b64_tr_b16 a[78:79], v80 offset:58368
    ds_read_b64_tr_b16 v[56:57], v81 offset:49152
    ds_read_b64_tr_b16 v[58:59], v81 offset:50176
    ds_read_b64_tr_b16 v[60:61], v81 offset:57344
    ds_read_b64_tr_b16 v[62:63], v81 offset:58368
    s_waitcnt lgkmcnt(0)
    ds_write_b128 v5, v[56:59] offset:22528
    ds_write_b128 v5, v[60:63] offset:23552
    s_branch L_lw_84
L_lw_84_0:
    s_cmp_lg_u32 s44, 1
    s_cbranch_scc1 L_lw_84_1
    ds_read_b64_tr_b16 a[40:41], v80 offset:49152
    ds_read_b64_tr_b16 a[42:43], v80 offset:50176
    ds_read_b64_tr_b16 a[44:45], v80 offset:57344
    ds_read_b64_tr_b16 a[46:47], v80 offset:58368
    ds_read_b64_tr_b16 v[56:57], v81 offset:49152
    ds_read_b64_tr_b16 v[58:59], v81 offset:50176
    ds_read_b64_tr_b16 v[60:61], v81 offset:57344
    ds_read_b64_tr_b16 v[62:63], v81 offset:58368
    s_waitcnt lgkmcnt(0)
    ds_write_b128 v5, v[56:59] offset:16384
    ds_write_b128 v5, v[60:63] offset:17408
    s_branch L_lw_84
L_lw_84_1:
    s_cmp_lg_u32 s44, 2
    s_cbranch_scc1 L_lw_84_2
    ds_read_b64_tr_b16 a[152:153], v80 offset:49152
    ds_read_b64_tr_b16 a[154:155], v80 offset:50176
    ds_read_b64_tr_b16 a[156:157], v80 offset:57344
    ds_read_b64_tr_b16 a[158:159], v80 offset:58368
    ds_read_b64_tr_b16 v[56:57], v81 offset:49152
    ds_read_b64_tr_b16 v[58:59], v81 offset:50176
    ds_read_b64_tr_b16 v[60:61], v81 offset:57344
    ds_read_b64_tr_b16 v[62:63], v81 offset:58368
    s_waitcnt lgkmcnt(0)
    ds_write_b128 v5, v[56:59] offset:18432
    ds_write_b128 v5, v[60:63] offset:19456
    s_branch L_lw_84
L_lw_84_2:
    ds_read_b64_tr_b16 a[112:113], v80 offset:49152
    ds_read_b64_tr_b16 a[114:115], v80 offset:50176
    ds_read_b64_tr_b16 a[116:117], v80 offset:57344
    ds_read_b64_tr_b16 a[118:119], v80 offset:58368
    ds_read_b64_tr_b16 v[56:57], v81 offset:49152
    ds_read_b64_tr_b16 v[58:59], v81 offset:50176
    ds_read_b64_tr_b16 v[60:61], v81 offset:57344
    ds_read_b64_tr_b16 v[62:63], v81 offset:58368
    s_waitcnt lgkmcnt(0)
    ds_write_b128 v5, v[56:59] offset:20480
    ds_write_b128 v5, v[60:63] offset:21504
L_lw_84:
    s_waitcnt lgkmcnt(0)
    s_waitcnt vmcnt(8)
    s_barrier
    s_add_u32 s79, s41, 11
    s_and_b32 s79, s79, 3
    s_lshl_b32 s79, s79, 19
    s_add_u32 s79, s79, s47
    s_add_u32 s46, s79, 0x400000
    s_add_u32 m0, s48, 49152
    s_nop 0
    buffer_load_dwordx4 v82, s[32:35], s46 offen  lds
    s_add_u32 s46, s79, 0x420000
    s_add_u32 m0, s48, 53248
    s_nop 0
    buffer_load_dwordx4 v82, s[32:35], s46 offen  lds
    s_add_u32 s46, s79, 0x440000
    s_add_u32 m0, s48, 57344
    s_nop 0
    buffer_load_dwordx4 v82, s[32:35], s46 offen  lds
    s_add_u32 s46, s79, 0x460000
    s_add_u32 m0, s48, 61440
    s_nop 0
    buffer_load_dwordx4 v82, s[32:35], s46 offen  lds
    s_cmp_lg_u32 s44, 0
    s_cbranch_scc1 L_lw_85_0
    ds_read_b64_tr_b16 a[80:81], v80 offset:0
    ds_read_b64_tr_b16 a[82:83], v80 offset:1024
    ds_read_b64_tr_b16 a[84:85], v80 offset:8192
    ds_read_b64_tr_b16 a[86:87], v80 offset:9216
    ds_read_b64_tr_b16 v[56:57], v81 offset:0
    ds_read_b64_tr_b16 v[58:59], v81 offset:1024
    ds_read_b64_tr_b16 v[60:61], v81 offset:8192
    ds_read_b64_tr_b16 v[62:63], v81 offset:9216
    s_waitcnt lgkmcnt(0)
    ds_write_b128 v5, v[56:59] offset:2048
    ds_write_b128 v5, v[60:63] offset:3072
    s_branch L_lw_85
L_lw_85_0:
    s_cmp_lg_u32 s44, 1
    s_cbranch_scc1 L_lw_85_1
    ds_read_b64_tr_b16 a[48:49], v80 offset:0
    ds_read_b64_tr_b16 a[50:51], v80 offset:1024
    ds_read_b64_tr_b16 a[52:53], v80 offset:8192
    ds_read_b64_tr_b16 a[54:55], v80 offset:9216
    ds_read_b64_tr_b16 v[56:57], v81 offset:0
    ds_read_b64_tr_b16 v[58:59], v81 offset:1024
    ds_read_b64_tr_b16 v[60:61], v81 offset:8192
    ds_read_b64_tr_b16 v[62:63], v81 offset:9216
    s_waitcnt lgkmcnt(0)
    ds_write_b128 v5, v[56:59] offset:4096
    ds_write_b128 v5, v[60:63] offset:5120
    s_branch L_lw_85
L_lw_85_1:
    s_cmp_lg_u32 s44, 2
    s_cbranch_scc1 L_lw_85_2
    ds_read_b64_tr_b16 a[0:1], v80 offset:0
    ds_read_b64_tr_b16 a[2:3], v80 offset:1024
    ds_read_b64_tr_b16 a[4:5], v80 offset:8192
    ds_read_b64_tr_b16 a[6:7], v80 offset:9216
    ds_read_b64_tr_b16 a[8:9], v81 offset:0
    ds_read_b64_tr_b16 a[10:11], v81 offset:1024
    ds_read_b64_tr_b16 a[12:13], v81 offset:8192
    ds_read_b64_tr_b16 a[14:15], v81 offset:9216
    s_branch L_lw_85
L_lw_85_2:
    ds_read_b64_tr_b16 a[120:121], v80 offset:0
    ds_read_b64_tr_b16 a[122:123], v80 offset:1024
    ds_read_b64_tr_b16 a[124:125], v80 offset:8192
    ds_read_b64_tr_b16 a[126:127], v80 offset:9216
    ds_read_b64_tr_b16 v[56:57], v81 offset:0
    ds_read_b64_tr_b16 v[58:59], v81 offset:1024
    ds_read_b64_tr_b16 v[60:61], v81 offset:8192
    ds_read_b64_tr_b16 v[62:63], v81 offset:9216
    s_waitcnt lgkmcnt(0)
    ds_write_b128 v5, v[56:59] offset:0
    ds_write_b128 v5, v[60:63] offset:1024
L_lw_85:
    s_waitcnt lgkmcnt(0)
    s_waitcnt vmcnt(8)
    s_barrier
    s_add_u32 s79, s41, 12
    s_and_b32 s79, s79, 3
    s_lshl_b32 s79, s79, 19
    s_add_u32 s79, s79, s47
    s_add_u32 s46, s79, 0x600000
    s_add_u32 m0, s48, 0
    s_nop 0
    buffer_load_dwordx4 v82, s[32:35], s46 offen  lds
    s_add_u32 s46, s79, 0x620000
    s_add_u32 m0, s48, 4096
    s_nop 0
    buffer_load_dwordx4 v82, s[32:35], s46 offen  lds
    s_add_u32 s46, s79, 0x640000
    s_add_u32 m0, s48, 8192
    s_nop 0
    buffer_load_dwordx4 v82, s[32:35], s46 offen  lds
    s_add_u32 s46, s79, 0x660000
    s_add_u32 m0, s48, 12288
    s_nop 0
    buffer_load_dwordx4 v82, s[32:35], s46 offen  lds
    s_cmp_lg_u32 s44, 0
    s_cbranch_scc1 L_lw_86_0
    ds_read_b64_tr_b16 a[88:89], v80 offset:16384
    ds_read_b64_tr_b16 a[90:91], v80 offset:17408
    ds_read_b64_tr_b16 a[92:93], v80 offset:24576
    ds_read_b64_tr_b16 a[94:95], v80 offset:25600
    ds_read_b64_tr_b16 a[96:97], v81 offset:16384
    ds_read_b64_tr_b16 a[98:99], v81 offset:17408
    ds_read_b64_tr_b16 a[100:101], v81 offset:24576
    ds_read_b64_tr_b16 a[102:103], v81 offset:25600
    s_branch L_lw_86
L_lw_86_0:
    s_cmp_lg_u32 s44, 1
    s_cbranch_scc1 L_lw_86_1
    ds_read_b64_tr_b16 a[56:57], v80 offset:16384
    ds_read_b64_tr_b16 a[58:59], v80 offset:17408
    ds_read_b64_tr_b16 a[60:61], v80 offset:24576
    ds_read_b64_tr_b16 a[62:63], v80 offset:25600
    ds_read_b64_tr_b16 v[56:57], v81 offset:16384
    ds_read_b64_tr_b16 v[58:59], v81 offset:17408
    ds_read_b64_tr_b16 v[60:61], v81 offset:24576
    ds_read_b64_tr_b16 v[62:63], v81 offset:25600
    s_waitcnt lgkmcnt(0)
    ds_write_b128 v5, v[56:59] offset:6144
    ds_write_b128 v5, v[60:63] offset:7168
    s_branch L_lw_86
L_lw_86_1:
    s_cmp_lg_u32 s44, 2
    s_cbranch_scc1 L_lw_86_2
    ds_read_b64_tr_b16 a[16:17], v80 offset:16384
    ds_read_b64_tr_b16 a[18:19], v80 offset:17408
    ds_read_b64_tr_b16 a[20:21], v80 offset:24576
    ds_read_b64_tr_b16 a[22:23], v80 offset:25600
    ds_read_b64_tr_b16 a[24:25], v81 offset:16384
    ds_read_b64_tr_b16 a[26:27], v81 offset:17408
    ds_read_b64_tr_b16 a[28:29], v81 offset:24576
    ds_read_b64_tr_b16 a[30:31], v81 offset:25600
    s_branch L_lw_86
L_lw_86_2:
    ds_read_b64_tr_b16 a[128:129], v80 offset:16384
    ds_read_b64_tr_b16 a[130:131], v80 offset:17408
    ds_read_b64_tr_b16 a[132:133], v80 offset:24576
    ds_read_b64_tr_b16 a[134:135], v80 offset:25600
    ds_read_b64_tr_b16 a[136:137], v81 offset:16384
    ds_read_b64_tr_b16 a[138:139], v81 offset:17408
    ds_read_b64_tr_b16 a[140:141], v81 offset:24576
    ds_read_b64_tr_b16 a[142:143], v81 offset:25600
L_lw_86:
    s_waitcnt lgkmcnt(0)
    s_waitcnt vmcnt(8)
    s_barrier
    s_add_u32 s79, s41, 13
    s_and_b32 s79, s79, 3
    s_lshl_b32 s79, s79, 19
    s_add_u32 s79, s79, s47
    s_add_u32 s46, s79, 0x600000
    s_add_u32 m0, s48, 16384
    s_nop 0
    buffer_load_dwordx4 v82, s[32:35], s46 offen  lds
    s_add_u32 s46, s79, 0x620000
    s_add_u32 m0, s48, 20480
    s_nop 0
    buffer_load_dwordx4 v82, s[32:35], s46 offen  lds
    s_add_u32 s46, s79, 0x640000
    s_add_u32 m0, s48, 24576
    s_nop 0
    buffer_load_dwordx4 v82, s[32:35], s46 offen  lds
    s_add_u32 s46, s79, 0x660000
    s_add_u32 m0, s48, 28672
    s_nop 0
    buffer_load_dwordx4 v82, s[32:35], s46 offen  lds
    s_cmp_lg_u32 s44, 0
    s_cbranch_scc1 L_lw_87_0
    ds_read_b64_tr_b16 a[104:105], v80 offset:32768
    ds_read_b64_tr_b16 a[106:107], v80 offset:33792
    ds_read_b64_tr_b16 a[108:109], v80 offset:40960
    ds_read_b64_tr_b16 a[110:111], v80 offset:41984
    ds_read_b64_tr_b16 v[56:57], v81 offset:32768
    ds_read_b64_tr_b16 v[58:59], v81 offset:33792
    ds_read_b64_tr_b16 v[60:61], v81 offset:40960
    ds_read_b64_tr_b16 v[62:63], v81 offset:41984
    s_waitcnt lgkmcnt(0)
    ds_write_b128 v5, v[56:59] offset:12288
    ds_write_b128 v5, v[60:63] offset:13312
    s_branch L_lw_87
L_lw_87_0:
    s_cmp_lg_u32 s44, 1
    s_cbranch_scc1 L_lw_87_1
    ds_read_b64_tr_b16 a[64:65], v80 offset:32768
    ds_read_b64_tr_b16 a[66:67], v80 offset:33792
    ds_read_b64_tr_b16 a[68:69], v80 offset:40960
    ds_read_b64_tr_b16 a[70:71], v80 offset:41984
    ds_read_b64_tr_b16 v[56:57], v81 offset:32768
    ds_read_b64_tr_b16 v[58:59], v81 offset:33792
    ds_read_b64_tr_b16 v[60:61], v81 offset:40960
    ds_read_b64_tr_b16 v[62:63], v81 offset:41984
    s_waitcnt lgkmcnt(0)
    ds_write_b128 v5, v[56:59] offset:14336
    ds_write_b128 v5, v[60:63] offset:15360
    s_branch L_lw_87
L_lw_87_1:
    s_cmp_lg_u32 s44, 2
    s_cbranch_scc1 L_lw_87_2
    ds_read_b64_tr_b16 a[32:33], v80 offset:32768
    ds_read_b64_tr_b16 a[34:35], v80 offset:33792
    ds_read_b64_tr_b16 a[36:37], v80 offset:40960
    ds_read_b64_tr_b16 a[38:39], v80 offset:41984
    ds_read_b64_tr_b16 v[56:57], v81 offset:32768
    ds_read_b64_tr_b16 v[58:59], v81 offset:33792
    ds_read_b64_tr_b16 v[60:61], v81 offset:40960
    ds_read_b64_tr_b16 v[62:63], v81 offset:41984
    s_waitcnt lgkmcnt(0)
    ds_write_b128 v5, v[56:59] offset:8192
    ds_write_b128 v5, v[60:63] offset:9216
    s_branch L_lw_87
L_lw_87_2:
    ds_read_b64_tr_b16 a[144:145], v80 offset:32768
    ds_read_b64_tr_b16 a[146:147], v80 offset:33792
    ds_read_b64_tr_b16 a[148:149], v80 offset:40960
    ds_read_b64_tr_b16 a[150:151], v80 offset:41984
    ds_read_b64_tr_b16 v[56:57], v81 offset:32768
    ds_read_b64_tr_b16 v[58:59], v81 offset:33792
    ds_read_b64_tr_b16 v[60:61], v81 offset:40960
    ds_read_b64_tr_b16 v[62:63], v81 offset:41984
    s_waitcnt lgkmcnt(0)
    ds_write_b128 v5, v[56:59] offset:10240
    ds_write_b128 v5, v[60:63] offset:11264
L_lw_87:
    s_waitcnt lgkmcnt(0)
    s_waitcnt vmcnt(8)
    s_barrier
    s_add_u32 s79, s41, 14
    s_and_b32 s79, s79, 3
    s_lshl_b32 s79, s79, 19
    s_add_u32 s79, s79, s47
    s_add_u32 s46, s79, 0x600000
    s_add_u32 m0, s48, 32768
    s_nop 0
    buffer_load_dwordx4 v82, s[32:35], s46 offen  lds
    s_add_u32 s46, s79, 0x620000
    s_add_u32 m0, s48, 36864
    s_nop 0
    buffer_load_dwordx4 v82, s[32:35], s46 offen  lds
    s_add_u32 s46, s79, 0x640000
    s_add_u32 m0, s48, 40960
    s_nop 0
    buffer_load_dwordx4 v82, s[32:35], s46 offen  lds
    s_add_u32 s46, s79, 0x660000
    s_add_u32 m0, s48, 45056
    s_nop 0
    buffer_load_dwordx4 v82, s[32:35], s46 offen  lds
    s_cmp_lg_u32 s44, 0
    s_cbranch_scc1 L_lw_88_0
    ds_read_b64_tr_b16 a[112:113], v80 offset:49152
    ds_read_b64_tr_b16 a[114:115], v80 offset:50176
    ds_read_b64_tr_b16 a[116:117], v80 offset:57344
    ds_read_b64_tr_b16 a[118:119], v80 offset:58368
    ds_read_b64_tr_b16 v[56:57], v81 offset:49152
    ds_read_b64_tr_b16 v[58:59], v81 offset:50176
    ds_read_b64_tr_b16 v[60:61], v81 offset:57344
    ds_read_b64_tr_b16 v[62:63], v81 offset:58368
    s_waitcnt lgkmcnt(0)
    ds_write_b128 v5, v[56:59] offset:20480
    ds_write_b128 v5, v[60:63] offset:21504
    s_branch L_lw_88
L_lw_88_0:
    s_cmp_lg_u32 s44, 1
    s_cbranch_scc1 L_lw_88_1
    ds_read_b64_tr_b16 a[72:73], v80 offset:49152
    ds_read_b64_tr_b16 a[74:75], v80 offset:50176
    ds_read_b64_tr_b16 a[76:77], v80 offset:57344
    ds_read_b64_tr_b16 a[78:79], v80 offset:58368
    ds_read_b64_tr_b16 v[56:57], v81 offset:49152
    ds_read_b64_tr_b16 v[58:59], v81 offset:50176
    ds_read_b64_tr_b16 v[60:61], v81 offset:57344
    ds_read_b64_tr_b16 v[62:63], v81 offset:58368
    s_waitcnt lgkmcnt(0)
    ds_write_b128 v5, v[56:59] offset:22528
    ds_write_b128 v5, v[60:63] offset:23552
    s_branch L_lw_88
L_lw_88_1:
    s_cmp_lg_u32 s44, 2
    s_cbranch_scc1 L_lw_88_2
    ds_read_b64_tr_b16 a[40:41], v80 offset:49152
    ds_read_b64_tr_b16 a[42:43], v80 offset:50176
    ds_read_b64_tr_b16 a[44:45], v80 offset:57344
    ds_read_b64_tr_b16 a[46:47], v80 offset:58368
    ds_read_b64_tr_b16 v[56:57], v81 offset:49152
    ds_read_b64_tr_b16 v[58:59], v81 offset:50176
    ds_read_b64_tr_b16 v[60:61], v81 offset:57344
    ds_read_b64_tr_b16 v[62:63], v81 offset:58368
    s_waitcnt lgkmcnt(0)
    ds_write_b128 v5, v[56:59] offset:16384
    ds_write_b128 v5, v[60:63] offset:17408
    s_branch L_lw_88
L_lw_88_2:
    ds_read_b64_tr_b16 a[152:153], v80 offset:49152
    ds_read_b64_tr_b16 a[154:155], v80 offset:50176
    ds_read_b64_tr_b16 a[156:157], v80 offset:57344
    ds_read_b64_tr_b16 a[158:159], v80 offset:58368
    ds_read_b64_tr_b16 v[56:57], v81 offset:49152
    ds_read_b64_tr_b16 v[58:59], v81 offset:50176
    ds_read_b64_tr_b16 v[60:61], v81 offset:57344
    ds_read_b64_tr_b16 v[62:63], v81 offset:58368
    s_waitcnt lgkmcnt(0)
    ds_write_b128 v5, v[56:59] offset:18432
    ds_write_b128 v5, v[60:63] offset:19456
L_lw_88:
    s_waitcnt lgkmcnt(0)
    s_waitcnt vmcnt(8)
    s_barrier
    s_add_u32 s79, s41, 15
    s_and_b32 s79, s79, 3
    s_lshl_b32 s79, s79, 19
    s_add_u32 s79, s79, s47
    s_add_u32 s46, s79, 0x600000
    s_add_u32 m0, s48, 49152
    s_nop 0
    buffer_load_dwordx4 v82, s[32:35], s46 offen  lds
    s_add_u32 s46, s79, 0x620000
    s_add_u32 m0, s48, 53248
    s_nop 0
    buffer_load_dwordx4 v82, s[32:35], s46 offen  lds
    s_add_u32 s46, s79, 0x640000
    s_add_u32 m0, s48, 57344
    s_nop 0
    buffer_load_dwordx4 v82, s[32:35], s46 offen  lds
    s_add_u32 s46, s79, 0x660000
    s_add_u32 m0, s48, 61440
    s_nop 0
    buffer_load_dwordx4 v82, s[32:35], s46 offen  lds
    s_cmp_lg_u32 s44, 0
    s_cbranch_scc1 L_lw_89_0
    ds_read_b64_tr_b16 a[120:121], v80 offset:0
    ds_read_b64_tr_b16 a[122:123], v80 offset:1024
    ds_read_b64_tr_b16 a[124:125], v80 offset:8192
    ds_read_b64_tr_b16 a[126:127], v80 offset:9216
    ds_read_b64_tr_b16 v[56:57], v81 offset:0
    ds_read_b64_tr_b16 v[58:59], v81 offset:1024
    ds_read_b64_tr_b16 v[60:61], v81 offset:8192
    ds_read_b64_tr_b16 v[62:63], v81 offset:9216
    s_waitcnt lgkmcnt(0)
    ds_write_b128 v5, v[56:59] offset:0
    ds_write_b128 v5, v[60:63] offset:1024
    s_branch L_lw_89
L_lw_89_0:
    s_cmp_lg_u32 s44, 1
    s_cbranch_scc1 L_lw_89_1
    ds_read_b64_tr_b16 a[80:81], v80 offset:0
    ds_read_b64_tr_b16 a[82:83], v80 offset:1024
    ds_read_b64_tr_b16 a[84:85], v80 offset:8192
    ds_read_b64_tr_b16 a[86:87], v80 offset:9216
    ds_read_b64_tr_b16 v[56:57], v81 offset:0
    ds_read_b64_tr_b16 v[58:59], v81 offset:1024
    ds_read_b64_tr_b16 v[60:61], v81 offset:8192
    ds_read_b64_tr_b16 v[62:63], v81 offset:9216
    s_waitcnt lgkmcnt(0)
    ds_write_b128 v5, v[56:59] offset:2048
    ds_write_b128 v5, v[60:63] offset:3072
    s_branch L_lw_89
L_lw_89_1:
    s_cmp_lg_u32 s44, 2
    s_cbranch_scc1 L_lw_89_2
    ds_read_b64_tr_b16 a[48:49], v80 offset:0
    ds_read_b64_tr_b16 a[50:51], v80 offset:1024
    ds_read_b64_tr_b16 a[52:53], v80 offset:8192
    ds_read_b64_tr_b16 a[54:55], v80 offset:9216
    ds_read_b64_tr_b16 v[56:57], v81 offset:0
    ds_read_b64_tr_b16 v[58:59], v81 offset:1024
    ds_read_b64_tr_b16 v[60:61], v81 offset:8192
    ds_read_b64_tr_b16 v[62:63], v81 offset:9216
    s_waitcnt lgkmcnt(0)
    ds_write_b128 v5, v[56:59] offset:4096
    ds_write_b128 v5, v[60:63] offset:5120
    s_branch L_lw_89
L_lw_89_2:
    ds_read_b64_tr_b16 a[0:1], v80 offset:0
    ds_read_b64_tr_b16 a[2:3], v80 offset:1024
    ds_read_b64_tr_b16 a[4:5], v80 offset:8192
    ds_read_b64_tr_b16 a[6:7], v80 offset:9216
    ds_read_b64_tr_b16 a[8:9], v81 offset:0
    ds_read_b64_tr_b16 a[10:11], v81 offset:1024
    ds_read_b64_tr_b16 a[12:13], v81 offset:8192
    ds_read_b64_tr_b16 a[14:15], v81 offset:9216
L_lw_89:
    s_waitcnt lgkmcnt(0)
    s_waitcnt vmcnt(8)
    s_barrier
    s_cmp_lg_u32 s44, 0
    s_cbranch_scc1 L_lw_90_0
    ds_read_b64_tr_b16 a[128:129], v80 offset:16384
    ds_read_b64_tr_b16 a[130:131], v80 offset:17408
    ds_read_b64_tr_b16 a[132:133], v80 offset:24576
    ds_read_b64_tr_b16 a[134:135], v80 offset:25600
    ds_read_b64_tr_b16 a[136:137], v81 offset:16384
    ds_read_b64_tr_b16 a[138:139], v81 offset:17408
    ds_read_b64_tr_b16 a[140:141], v81 offset:24576
    ds_read_b64_tr_b16 a[142:143], v81 offset:25600
    s_branch L_lw_90
L_lw_90_0:
    s_cmp_lg_u32 s44, 1
    s_cbranch_scc1 L_lw_90_1
    ds_read_b64_tr_b16 a[88:89], v80 offset:16384
    ds_read_b64_tr_b16 a[90:91], v80 offset:17408
    ds_read_b64_tr_b16 a[92:93], v80 offset:24576
    ds_read_b64_tr_b16 a[94:95], v80 offset:25600
    ds_read_b64_tr_b16 a[96:97], v81 offset:16384
    ds_read_b64_tr_b16 a[98:99], v81 offset:17408
    ds_read_b64_tr_b16 a[100:101], v81 offset:24576
    ds_read_b64_tr_b16 a[102:103], v81 offset:25600
    s_branch L_lw_90
L_lw_90_1:
    s_cmp_lg_u32 s44, 2
    s_cbranch_scc1 L_lw_90_2
    ds_read_b64_tr_b16 a[56:57], v80 offset:16384
    ds_read_b64_tr_b16 a[58:59], v80 offset:17408
    ds_read_b64_tr_b16 a[60:61], v80 offset:24576
    ds_read_b64_tr_b16 a[62:63], v80 offset:25600
    ds_read_b64_tr_b16 v[56:57], v81 offset:16384
    ds_read_b64_tr_b16 v[58:59], v81 offset:17408
    ds_read_b64_tr_b16 v[60:61], v81 offset:24576
    ds_read_b64_tr_b16 v[62:63], v81 offset:25600
    s_waitcnt lgkmcnt(0)
    ds_write_b128 v5, v[56:59] offset:6144
    ds_write_b128 v5, v[60:63] offset:7168
    s_branch L_lw_90
L_lw_90_2:
    ds_read_b64_tr_b16 a[16:17], v80 offset:16384
    ds_read_b64_tr_b16 a[18:19], v80 offset:17408
    ds_read_b64_tr_b16 a[20:21], v80 offset:24576
    ds_read_b64_tr_b16 a[22:23], v80 offset:25600
    ds_read_b64_tr_b16 a[24:25], v81 offset:16384
    ds_read_b64_tr_b16 a[26:27], v81 offset:17408
    ds_read_b64_tr_b16 a[28:29], v81 offset:24576
    ds_read_b64_tr_b16 a[30:31], v81 offset:25600
L_lw_90:
    s_waitcnt lgkmcnt(0)
    s_waitcnt vmcnt(4)
    s_barrier
    s_cmp_lg_u32 s44, 0
    s_cbranch_scc1 L_lw_91_0
    ds_read_b64_tr_b16 a[144:145], v80 offset:32768
    ds_read_b64_tr_b16 a[146:147], v80 offset:33792
    ds_read_b64_tr_b16 a[148:149], v80 offset:40960
    ds_read_b64_tr_b16 a[150:151], v80 offset:41984
    ds_read_b64_tr_b16 v[56:57], v81 offset:32768
    ds_read_b64_tr_b16 v[58:59], v81 offset:33792
    ds_read_b64_tr_b16 v[60:61], v81 offset:40960
    ds_read_b64_tr_b16 v[62:63], v81 offset:41984
    s_waitcnt lgkmcnt(0)
    ds_write_b128 v5, v[56:59] offset:10240
    ds_write_b128 v5, v[60:63] offset:11264
    s_branch L_lw_91
L_lw_91_0:
    s_cmp_lg_u32 s44, 1
    s_cbranch_scc1 L_lw_91_1
    ds_read_b64_tr_b16 a[104:105], v80 offset:32768
    ds_read_b64_tr_b16 a[106:107], v80 offset:33792
    ds_read_b64_tr_b16 a[108:109], v80 offset:40960
    ds_read_b64_tr_b16 a[110:111], v80 offset:41984
    ds_read_b64_tr_b16 v[56:57], v81 offset:32768
    ds_read_b64_tr_b16 v[58:59], v81 offset:33792
    ds_read_b64_tr_b16 v[60:61], v81 offset:40960
    ds_read_b64_tr_b16 v[62:63], v81 offset:41984
    s_waitcnt lgkmcnt(0)
    ds_write_b128 v5, v[56:59] offset:12288
    ds_write_b128 v5, v[60:63] offset:13312
    s_branch L_lw_91
L_lw_91_1:
    s_cmp_lg_u32 s44, 2
    s_cbranch_scc1 L_lw_91_2
    ds_read_b64_tr_b16 a[64:65], v80 offset:32768
    ds_read_b64_tr_b16 a[66:67], v80 offset:33792
    ds_read_b64_tr_b16 a[68:69], v80 offset:40960
    ds_read_b64_tr_b16 a[70:71], v80 offset:41984
    ds_read_b64_tr_b16 v[56:57], v81 offset:32768
    ds_read_b64_tr_b16 v[58:59], v81 offset:33792
    ds_read_b64_tr_b16 v[60:61], v81 offset:40960
    ds_read_b64_tr_b16 v[62:63], v81 offset:41984
    s_waitcnt lgkmcnt(0)
    ds_write_b128 v5, v[56:59] offset:14336
    ds_write_b128 v5, v[60:63] offset:15360
    s_branch L_lw_91
L_lw_91_2:
    ds_read_b64_tr_b16 a[32:33], v80 offset:32768
    ds_read_b64_tr_b16 a[34:35], v80 offset:33792
    ds_read_b64_tr_b16 a[36:37], v80 offset:40960
    ds_read_b64_tr_b16 a[38:39], v80 offset:41984
    ds_read_b64_tr_b16 v[56:57], v81 offset:32768
    ds_read_b64_tr_b16 v[58:59], v81 offset:33792
    ds_read_b64_tr_b16 v[60:61], v81 offset:40960
    ds_read_b64_tr_b16 v[62:63], v81 offset:41984
    s_waitcnt lgkmcnt(0)
    ds_write_b128 v5, v[56:59] offset:8192
    ds_write_b128 v5, v[60:63] offset:9216
L_lw_91:
    s_waitcnt lgkmcnt(0)
    s_waitcnt vmcnt(0)
    s_barrier
    s_cmp_lg_u32 s44, 0
    s_cbranch_scc1 L_lw_92_0
    ds_read_b64_tr_b16 a[152:153], v80 offset:49152
    ds_read_b64_tr_b16 a[154:155], v80 offset:50176
    ds_read_b64_tr_b16 a[156:157], v80 offset:57344
    ds_read_b64_tr_b16 a[158:159], v80 offset:58368
    ds_read_b64_tr_b16 v[56:57], v81 offset:49152
    ds_read_b64_tr_b16 v[58:59], v81 offset:50176
    ds_read_b64_tr_b16 v[60:61], v81 offset:57344
    ds_read_b64_tr_b16 v[62:63], v81 offset:58368
    s_waitcnt lgkmcnt(0)
    ds_write_b128 v5, v[56:59] offset:18432
    ds_write_b128 v5, v[60:63] offset:19456
    s_branch L_lw_92
L_lw_92_0:
    s_cmp_lg_u32 s44, 1
    s_cbranch_scc1 L_lw_92_1
    ds_read_b64_tr_b16 a[112:113], v80 offset:49152
    ds_read_b64_tr_b16 a[114:115], v80 offset:50176
    ds_read_b64_tr_b16 a[116:117], v80 offset:57344
    ds_read_b64_tr_b16 a[118:119], v80 offset:58368
    ds_read_b64_tr_b16 v[56:57], v81 offset:49152
    ds_read_b64_tr_b16 v[58:59], v81 offset:50176
    ds_read_b64_tr_b16 v[60:61], v81 offset:57344
    ds_read_b64_tr_b16 v[62:63], v81 offset:58368
    s_waitcnt lgkmcnt(0)
    ds_write_b128 v5, v[56:59] offset:20480
    ds_write_b128 v5, v[60:63] offset:21504
    s_branch L_lw_92
L_lw_92_1:
    s_cmp_lg_u32 s44, 2
    s_cbranch_scc1 L_lw_92_2
    ds_read_b64_tr_b16 a[72:73], v80 offset:49152
    ds_read_b64_tr_b16 a[74:75], v80 offset:50176
    ds_read_b64_tr_b16 a[76:77], v80 offset:57344
    ds_read_b64_tr_b16 a[78:79], v80 offset:58368
    ds_read_b64_tr_b16 v[56:57], v81 offset:49152
    ds_read_b64_tr_b16 v[58:59], v81 offset:50176
    ds_read_b64_tr_b16 v[60:61], v81 offset:57344
    ds_read_b64_tr_b16 v[62:63], v81 offset:58368
    s_waitcnt lgkmcnt(0)
    ds_write_b128 v5, v[56:59] offset:22528
    ds_write_b128 v5, v[60:63] offset:23552
    s_branch L_lw_92
L_lw_92_2:
    ds_read_b64_tr_b16 a[40:41], v80 offset:49152
    ds_read_b64_tr_b16 a[42:43], v80 offset:50176
    ds_read_b64_tr_b16 a[44:45], v80 offset:57344
    ds_read_b64_tr_b16 a[46:47], v80 offset:58368
    ds_read_b64_tr_b16 v[56:57], v81 offset:49152
    ds_read_b64_tr_b16 v[58:59], v81 offset:50176
    ds_read_b64_tr_b16 v[60:61], v81 offset:57344
    ds_read_b64_tr_b16 v[62:63], v81 offset:58368
    s_waitcnt lgkmcnt(0)
    ds_write_b128 v5, v[56:59] offset:16384
    ds_write_b128 v5, v[60:63] offset:17408
L_lw_92:
    s_waitcnt lgkmcnt(0)
    s_barrier
    v_lshlrev_b32 v68, 4, v1
    s_mul_i32 s45, s44, 3072
    s_add_u32 s45, s45, 53248
    v_add_u32 v6, s45, v68
    s_sub_u32 s45, s44, 1
    s_and_b32 s45, s45, 3
    s_mul_i32 s45, s45, 3072
    s_add_u32 s45, s45, 53248
    v_add_u32 v7, s45, v68
    s_sub_u32 s45, s44, 2
    s_and_b32 s45, s45, 3
    s_mul_i32 s45, s45, 3072
    s_add_u32 s45, s45, 54272
    v_add_u32 v8, s45, v68
    s_sub_u32 s45, s44, 3
    s_and_b32 s45, s45, 3
    s_mul_i32 s45, s45, 3072
    s_add_u32 s45, s45, 55296
    v_add_u32 v18, s45, v68
    v_lshlrev_b32 v68, 4, v1
    s_add_u32 s45, s69, 0
    s_and_b32 s45, s45, 7
    s_lshl_b32 s45, s45, 10
    s_lshl_b32 s46, s44, 13
    s_add_u32 s45, s45, s46
    v_add_u32 v80, s45, v68
    s_add_u32 s45, s69, 1
    s_and_b32 s45, s45, 7
    s_lshl_b32 s45, s45, 10
    s_lshl_b32 s46, s44, 13
    s_add_u32 s45, s45, s46
    v_add_u32 v81, s45, v68
    s_add_u32 s45, s69, 2
    s_and_b32 s45, s45, 7
    s_lshl_b32 s45, s45, 10
    s_lshl_b32 s46, s44, 13
    s_add_u32 s45, s45, s46
    v_add_u32 v82, s45, v68
    s_add_u32 s45, s69, 3
    s_and_b32 s45, s45, 7
    s_lshl_b32 s45, s45, 10
    s_lshl_b32 s46, s44, 13
    s_add_u32 s45, s45, s46
    v_add_u32 v83, s45, v68
    s_add_u32 s45, s69, 4
    s_and_b32 s45, s45, 7
    s_lshl_b32 s45, s45, 10
    s_lshl_b32 s46, s44, 13
    s_add_u32 s45, s45, s46
    v_add_u32 v84, s45, v68
    s_add_u32 s45, s69, 5
    s_and_b32 s45, s45, 7
    s_lshl_b32 s45, s45, 10
    s_lshl_b32 s46, s44, 13
    s_add_u32 s45, s45, s46
    v_add_u32 v85, s45, v68
    s_add_u32 s45, s69, 6
    s_and_b32 s45, s45, 7
    s_lshl_b32 s45, s45, 10
    s_lshl_b32 s46, s44, 13
    s_add_u32 s45, s45, s46
    v_add_u32 v86, s45, v68
    s_add_u32 s45, s69, 7
    s_and_b32 s45, s45, 7
    s_lshl_b32 s45, s45, 10
    s_lshl_b32 s46, s44, 13
    s_add_u32 s45, s45, s46
    v_add_u32 v87, s45, v68
    s_lshl_b32 s45, s40, 4
    s_add_u32 s45, s45, s42
    s_lshl_b32 s45, s45, 7
    s_lshl_b32 s46, s44, 4
    s_add_u32 s45, s45, s46
    s_add_u32 s45, s45, 0x7080000
    v_and_b32 v13, 3, v1
    v_lshlrev_b32 v13, 2, v13
    v_add_u32 v13, s45, v13
    s_mov_b32 s66, 0x1800000
    v_mov_b32 v14, -1
    v_mov_b32 v15, -1
    s_mov_b32 s70, 0
    v_mov_b32 v41, 0
L_hw_93:
    buffer_load_dwordx2 v[44:45], v41, s[16:19], 0 offen sc1
    s_add_u32 s70, s70, 1
    s_cmp_ge_u32 s70, 0x100000
    s_cbranch_scc1 L_c_done_1
    s_waitcnt vmcnt(0)
    v_readfirstlane_b32 s45, v44
    v_readfirstlane_b32 s46, v45
    s_nop 3
    s_lshr_b32 s47, s46, 24
    s_cmp_lg_u32 s47, 64
    s_cbranch_scc1 L_hw_93
    s_lshr_b32 s68, s45, 24
    s_and_b32 s47, s45, 511
    s_mul_i32 s47, s47, s47
    s_bfe_u32 s45, s45, 0xf0009
    s_lshl_b32 s45, s45, 5
    s_sub_u32 s45, s45, s47
    s_and_b32 s47, s46, 511
    s_mul_i32 s47, s47, s47
    s_bfe_u32 s46, s46, 0xf0009
    s_lshl_b32 s46, s46, 5
    s_sub_u32 s46, s46, s47
    s_or_b32 s45, s45, s46
    s_cmp_eq_u32 s45, 0
    s_cselect_b32 s67, 1, 0
    s_mov_b32 s24, s12
    s_mov_b32 s25, s13
    s_mov_b32 s28, s12
    s_mov_b32 s29, s13
    s_cmp_eq_u32 s67, 1
    s_cselect_b32 s26, s14, 0
    s_cselect_b32 s30, 0, s14
    s_cmp_ge_u32 s68, 16
    s_cselect_b32 s68, 8192, 0
    s_mov_b32 s6, 0x0
    s_mov_b32 s7, 0xd5400000
    s_mov_b32 s60, 0
    s_lshl_b32 s58, s40, 16
    s_add_u32 s58, s58, 0x7000000
    s_mov_b32 s61, s58
    s_lshl_b32 s59, s40, 17
    s_add_u32 s59, s59, 0x7040000
    s_mov_b32 s62, s59
    s_add_u32 s32, s41, 0
    s_and_b32 s32, s32, 3
    s_lshl_b32 s32, s32, 10
    s_add_u32 s33, s41, 1
    s_and_b32 s33, s33, 3
    s_lshl_b32 s33, s33, 10
    s_add_u32 s34, s41, 2
    s_and_b32 s34, s34, 3
    s_lshl_b32 s34, s34, 10
    s_add_u32 s35, s41, 3
    s_and_b32 s35, s35, 3
    s_lshl_b32 s35, s35, 10
    s_add_u32 s63, s63, s68
    s_add_u32 s64, s64, s68
    ds_read_b128 v[56:59], v5 offset:8192
    ds_read_b128 v[60:63], v5 offset:9216
    ds_read_b128 v[64:67], v5 offset:16384
    ds_read_b128 v[68:71], v5 offset:17408
    ds_read_b128 v[72:75], v5 offset:4096
    ds_read_b128 v[76:79], v5 offset:5120
    ds_read_b128 v[88:91], v5 offset:6144
    ds_read_b128 v[92:95], v5 offset:7168
    ds_read_b128 v[32:35], v5 offset:14336
    ds_read_b128 v[36:39], v5 offset:15360
L_v_loop_94:
    s_add_u32 s8, s61, s32
    s_add_u32 s9, s61, s33
    s_add_u32 s10, s61, s34
    s_add_u32 s11, s61, s35
    s_nop 15
    s_nop 15
    s_waitcnt lgkmcnt(0)
    buffer_load_dwordx4 v[40:43], v3, s[12:15], s8 offen sc1
    v_mov_b32 v24, 0
    v_mov_b32 v25, 0
    v_mov_b32 v26, 0
    v_mov_b32 v27, 0
    v_mov_b32 v28, 0
    buffer_load_dwordx4 v[44:47], v3, s[12:15], s9 offen sc1
    v_mov_b32 v29, 0
    v_mov_b32 v30, 0
    v_mov_b32 v31, 0
    s_nop 1
    buffer_load_dwordx4 v[48:51], v3, s[12:15], s10 offen sc1
    s_nop 4
    buffer_load_dwordx4 v[52:55], v3, s[12:15], s11 offen sc1
    s_mov_b32 s70, 0
    s_waitcnt vmcnt(3)
    v_max3_u32 v22, v40, v41, v42
    ds_write_b128 v3, v[40:43] offset:0
    v_max_u32 v22, v22, v43
    v_cmp_eq_u32 vcc, -1, v22
    s_nop 0
    s_nop 0
    s_cbranch_vccnz L_mg_95_r0
L_mg_95_c0:
    v_smfmac_f32_16x16x64_bf16 v[24:27], v[40:43], a[0:7], v2
    s_waitcnt vmcnt(2)
    v_max3_u32 v22, v44, v45, v46
    ds_write_b128 v3, v[44:47] offset:1024
    v_max_u32 v22, v22, v47
    v_cmp_eq_u32 vcc, -1, v22
    v_smfmac_f32_16x16x64_bf16 v[28:31], v[40:43], a[8:15], v2
    s_nop 0
    s_cbranch_vccnz L_mg_95_r1
L_mg_95_c1:
    v_smfmac_f32_16x16x64_bf16 v[24:27], v[44:47], a[16:23], v2
    s_waitcnt vmcnt(1)
    v_max3_u32 v22, v48, v49, v50
    ds_write_b128 v3, v[48:51] offset:2048
    v_max_u32 v22, v22, v51
    v_cmp_eq_u32 vcc, -1, v22
    v_smfmac_f32_16x16x64_bf16 v[28:31], v[44:47], a[24:31], v2
    s_nop 0
    s_cbranch_vccnz L_mg_95_r2
L_mg_95_c2:
    s_waitcnt vmcnt(0)
    v_max3_u32 v22, v52, v53, v54
    ds_write_b128 v3, v[52:55] offset:3072
    v_max_u32 v22, v22, v55
    v_cmp_eq_u32 vcc, -1, v22
    s_waitcnt lgkmcnt(0)
    s_nop 0
    s_cbranch_vccnz L_mg_95_r3
L_mg_95_c3:
    s_barrier
    ds_read_b128 v[40:43], v4 offset:0
    ds_read_b128 v[44:47], v4 offset:1024
    v_smfmac_f32_16x16x64_bf16 v[24:27], v[48:51], a[32:39], v2
    v_smfmac_f32_16x16x64_bf16 v[28:31], v[48:51], v[56:63], v2
    ds_read_b128 v[48:51], v4 offset:2048
    v_smfmac_f32_16x16x64_bf16 v[24:27], v[52:55], a[40:47], v2
    ds_read_b128 v[56:59], v5 offset:22528
    v_smfmac_f32_16x16x64_bf16 v[28:31], v[52:55], v[64:71], v2
    ds_read_b128 v[52:55], v4 offset:3072
    ds_read_b128 v[60:63], v5 offset:23552
    s_waitcnt lgkmcnt(4)
    v_smfmac_f32_16x16x64_bf16 v[24:27], v[40:43], a[48:55], v2
    ds_read_b128 v[64:67], v5 offset:2048
    v_smfmac_f32_16x16x64_bf16 v[28:31], v[40:43], v[72:79], v2
    ds_read_b128 v[40:43], v21 offset:0
    ds_read_b128 v[68:71], v5 offset:3072
    v_smfmac_f32_16x16x64_bf16 v[24:27], v[44:47], a[56:63], v2
    ds_read_b128 v[72:75], v5 offset:12288
    v_smfmac_f32_16x16x64_bf16 v[28:31], v[44:47], v[88:95], v2
    ds_read_b128 v[44:47], v21 offset:1024
    ds_read_b128 v[76:79], v5 offset:13312
    s_waitcnt lgkmcnt(6)
    v_smfmac_f32_16x16x64_bf16 v[24:27], v[48:51], a[64:71], v2
    ds_read_b128 v[88:91], v5 offset:20480
    v_smfmac_f32_16x16x64_bf16 v[28:31], v[48:51], v[32:39], v2
    ds_read_b128 v[48:51], v21 offset:2048
    ds_read_b128 v[92:95], v5 offset:21504
    v_smfmac_f32_16x16x64_bf16 v[24:27], v[52:55], a[72:79], v2
    ds_read_b128 v[32:35], v5 offset:0
    v_smfmac_f32_16x16x64_bf16 v[28:31], v[52:55], v[56:63], v2
    ds_read_b128 v[52:55], v21 offset:3072
    ds_read_b128 v[36:39], v5 offset:1024
    s_waitcnt lgkmcnt(6)
    v_smfmac_f32_16x16x64_bf16 v[24:27], v[40:43], a[80:87], v2
    ds_read_b128 v[56:59], v5 offset:10240
    v_smfmac_f32_16x16x64_bf16 v[28:31], v[40:43], v[64:71], v2
    ds_read_b128 v[40:43], v23 offset:0
    ds_read_b128 v[60:63], v5 offset:11264
    v_smfmac_f32_16x16x64_bf16 v[24:27], v[44:47], a[88:95], v2
    ds_read_b128 v[64:67], v5 offset:18432
    v_smfmac_f32_16x16x64_bf16 v[28:31], v[44:47], a[96:103], v2
    ds_read_b128 v[44:47], v23 offset:1024
    s_waitcnt lgkmcnt(5)
    v_smfmac_f32_16x16x64_bf16 v[24:27], v[48:51], a[104:111], v2
    ds_read_b128 v[68:71], v5 offset:19456
    v_smfmac_f32_16x16x64_bf16 v[28:31], v[48:51], v[72:79], v2
    ds_read_b128 v[48:51], v23 offset:2048
    v_smfmac_f32_16x16x64_bf16 v[24:27], v[52:55], a[112:119], v2
    v_smfmac_f32_16x16x64_bf16 v[28:31], v[52:55], v[88:95], v2
    ds_read_b128 v[52:55], v23 offset:3072
    s_waitcnt lgkmcnt(3)
    v_smfmac_f32_16x16x64_bf16 v[24:27], v[40:43], a[120:127], v2
    v_smfmac_f32_16x16x64_bf16 v[28:31], v[40:43], v[32:39], v2
    v_smfmac_f32_16x16x64_bf16 v[24:27], v[44:47], a[128:135], v2
    v_smfmac_f32_16x16x64_bf16 v[28:31], v[44:47], a[136:143], v2
    s_waitcnt lgkmcnt(0)
    v_smfmac_f32_16x16x64_bf16 v[24:27], v[48:51], a[144:151], v2
    v_smfmac_f32_16x16x64_bf16 v[28:31], v[48:51], v[56:63], v2
    v_smfmac_f32_16x16x64_bf16 v[24:27], v[52:55], a[152:159], v2
    v_smfmac_f32_16x16x64_bf16 v[28:31], v[52:55], v[64:71], v2
    s_and_b32 s45, s60, 1
    s_lshl_b32 s45, s45, 16
    s_add_u32 s45, s45, 0x7020000
    s_xor_b32 s46, s45, 65536
    s_nop 3
    v_permlane32_swap_b32 v24, v26
    v_permlane32_swap_b32 v25, v27
    v_permlane32_swap_b32 v28, v30
    v_permlane32_swap_b32 v29, v31
    v_pk_add_f32 v[24:25], v[24:25], v[26:27]
    v_pk_add_f32 v[28:29], v[28:29], v[30:31]
    v_cvt_pk_bf16_f32 v16, v24, v25
    v_cvt_pk_bf16_f32 v17, v28, v29
    s_add_u32 s47, s60, 3
    s_and_b32 s47, s47, 3
    s_lshl_b32 s47, s47, 14
    s_add_u32 s47, s47, s58
    buffer_store_dwordx2 v[16:17], v10, s[24:27], s45 offen
    buffer_store_dwordx2 v[14:15], v10, s[24:27], s46 offen
    buffer_store_dword v14, v12, s[24:27], s47 offen
    buffer_store_dwordx2 v[16:17], v10, s[28:31], s45 offen sc1
    buffer_store_dwordx2 v[14:15], v10, s[28:31], s46 offen sc1
    buffer_store_dword v14, v12, s[28:31], s47 offen sc1
    buffer_store_dwordx2 v[16:17], v10, s[12:15], s66 offen sc1
    s_cmp_eq_u32 s60, 63
    s_cbranch_scc1 L_v_fin_96
    v_mov_b32 v22, s60
    v_mov_b32 v0, 0
    s_mov_b64 exec, 1
    buffer_store_dword v22, v0, s[12:15], s3 offen sc1
    s_mov_b64 exec, -1
    s_and_b32 s65, s60, 1
    s_lshl_b32 s65, s65, 12
    s_and_b32 s45, s60, 2
    s_lshl_b32 s45, s45, 13
    s_add_u32 s65, s65, s45
    s_xor_b32 s45, s65, 16384
    s_add_u32 s45, s45, s63
    buffer_store_dwordx2 v[14:15], v11, s[12:15], s45 offen sc1
    s_add_u32 s48, s63, s65
    s_add_u32 s49, s64, s65
    s_sleep 12
    s_mov_b64 exec, 15
    buffer_load_dword v88, v13, s[12:15], 0 offen sc1
    s_nop 15
    buffer_load_dword v89, v13, s[12:15], 0 offen sc1
    s_nop 15
    buffer_load_dword v90, v13, s[12:15], 0 offen sc1
    s_nop 15
    buffer_load_dword v91, v13, s[12:15], 0 offen sc1
    s_mov_b32 s70, 0
L_pp_97:
    s_waitcnt vmcnt(3)
    v_cmp_ge_u32 vcc, s60, v88
    s_add_u32 s70, s70, 1
    s_nop 0
    s_cbranch_vccz L_ppd_98
    buffer_load_dword v88, v13, s[12:15], 0 offen sc1
    s_waitcnt vmcnt(3)
    v_cmp_ge_u32 vcc, s60, v89
    s_add_u32 s70, s70, 1
    s_nop 0
    s_cbranch_vccz L_ppd_98
    buffer_load_dword v89, v13, s[12:15], 0 offen sc1
    s_waitcnt vmcnt(3)
    v_cmp_ge_u32 vcc, s60, v90
    s_add_u32 s70, s70, 1
    s_nop 0
    s_cbranch_vccz L_ppd_98
    buffer_load_dword v90, v13, s[12:15], 0 offen sc1
    s_waitcnt vmcnt(3)
    v_cmp_ge_u32 vcc, s60, v91
    s_add_u32 s70, s70, 1
    s_nop 0
    s_cbranch_vccz L_ppd_98
    buffer_load_dword v91, v13, s[12:15], 0 offen sc1
    s_cmp_lt_u32 s70, 0x400000
    s_cbranch_scc1 L_pp_97
    s_branch L_c_done_1
L_ppd_98:
    s_mov_b64 exec, -1
    s_nop 15
    s_nop 11
    s_mov_b32 s70, 0
    buffer_load_dwordx4 v[40:43], v80, s[12:15], s62 offen sc1
    v_mov_b32 v24, 0
    v_mov_b32 v25, 0
    v_mov_b32 v26, 0
    v_mov_b32 v27, 0
    s_nop 3
    buffer_load_dwordx4 v[44:47], v81, s[12:15], s62 offen sc1
    v_mov_b32 v28, 0
    v_mov_b32 v29, 0
    v_mov_b32 v30, 0
    v_mov_b32 v31, 0
    s_nop 3
    buffer_load_dwordx4 v[48:51], v82, s[12:15], s62 offen sc1
    v_mov_b32 v32, 0
    v_mov_b32 v33, 0
    v_mov_b32 v34, 0
    v_mov_b32 v35, 0
    s_nop 3
    buffer_load_dwordx4 v[52:55], v83, s[12:15], s62 offen sc1
    v_mov_b32 v36, 0
    v_mov_b32 v37, 0
    v_mov_b32 v38, 0
    v_mov_b32 v39, 0
    s_nop 3
    buffer_load_dwordx4 v[56:59], v84, s[12:15], s62 offen sc1
    s_nop 7
    buffer_load_dwordx4 v[60:63], v85, s[12:15], s62 offen sc1
    s_waitcnt vmcnt(5)
    v_cmp_eq_u32 vcc, -1, v43
    s_nop 1
    s_cbranch_vccnz L_v_og_99_r0
L_v_og_99_c0:
    v_smfmac_f32_16x16x64_bf16 v[24:27], v[40:43], a[160:167], v2
    s_waitcnt vmcnt(4)
    v_smfmac_f32_16x16x64_bf16 v[28:31], v[40:43], a[168:175], v2
    v_cmp_eq_u32 vcc, -1, v47
    v_smfmac_f32_16x16x64_bf16 v[32:35], v[40:43], a[176:183], v2
    buffer_load_dwordx4 v[64:67], v86, s[12:15], s62 offen sc1
    v_smfmac_f32_16x16x64_bf16 v[36:39], v[40:43], a[184:191], v2
    s_cbranch_vccnz L_v_og_99_r1
L_v_og_99_c1:
    v_smfmac_f32_16x16x64_bf16 v[24:27], v[44:47], a[192:199], v2
    s_waitcnt vmcnt(4)
    v_smfmac_f32_16x16x64_bf16 v[28:31], v[44:47], a[200:207], v2
    v_cmp_eq_u32 vcc, -1, v51
    v_smfmac_f32_16x16x64_bf16 v[32:35], v[44:47], a[208:215], v2
    buffer_load_dwordx4 v[68:71], v87, s[12:15], s62 offen sc1
    v_smfmac_f32_16x16x64_bf16 v[36:39], v[44:47], a[216:223], v2
    s_cbranch_vccnz L_v_og_99_r2
L_v_og_99_c2:
    v_smfmac_f32_16x16x64_bf16 v[24:27], v[48:51], a[224:231], v2
    s_waitcnt vmcnt(4)
    v_smfmac_f32_16x16x64_bf16 v[28:31], v[48:51], a[232:239], v2
    v_cmp_eq_u32 vcc, -1, v55
    v_smfmac_f32_16x16x64_bf16 v[32:35], v[48:51], a[240:247], v2
    v_smfmac_f32_16x16x64_bf16 v[36:39], v[48:51], a[248:255], v2
    s_cbranch_vccnz L_v_og_99_r3
L_v_og_99_c3:
    v_smfmac_f32_16x16x64_bf16 v[24:27], v[52:55], v[96:103], v2
    s_waitcnt vmcnt(3)
    v_cmp_eq_u32 vcc, -1, v59
    v_smfmac_f32_16x16x64_bf16 v[28:31], v[52:55], v[104:111], v2
    v_smfmac_f32_16x16x64_bf16 v[32:35], v[52:55], v[112:119], v2
    s_cbranch_vccnz L_v_og_99_r4
L_v_og_99_c4:
    v_smfmac_f32_16x16x64_bf16 v[24:27], v[56:59], v[128:135], v2
    s_waitcnt vmcnt(2)
    v_cmp_eq_u32 vcc, -1, v63
    v_smfmac_f32_16x16x64_bf16 v[28:31], v[56:59], v[136:143], v2
    v_smfmac_f32_16x16x64_bf16 v[32:35], v[56:59], v[144:151], v2
    s_cbranch_vccnz L_v_og_99_r5
L_v_og_99_c5:
    v_smfmac_f32_16x16x64_bf16 v[24:27], v[60:63], v[160:167], v2
    s_waitcnt vmcnt(1)
    v_cmp_eq_u32 vcc, -1, v67
    v_smfmac_f32_16x16x64_bf16 v[28:31], v[60:63], v[168:175], v2
    v_smfmac_f32_16x16x64_bf16 v[32:35], v[60:63], v[176:183], v2
    s_cbranch_vccnz L_v_og_99_r6
L_v_og_99_c6:
    v_smfmac_f32_16x16x64_bf16 v[24:27], v[64:67], v[192:199], v2
    s_waitcnt vmcnt(0)
    v_cmp_eq_u32 vcc, -1, v71
    v_smfmac_f32_16x16x64_bf16 v[28:31], v[64:67], v[200:207], v2
    v_smfmac_f32_16x16x64_bf16 v[32:35], v[64:67], v[208:215], v2
    s_cbranch_vccnz L_v_og_99_r7
L_v_og_99_c7:
    v_smfmac_f32_16x16x64_bf16 v[24:27], v[68:71], v[224:231], v2
    v_smfmac_f32_16x16x64_bf16 v[28:31], v[68:71], v[232:239], v2
    v_smfmac_f32_16x16x64_bf16 v[32:35], v[68:71], v[240:247], v2
    v_smfmac_f32_16x16x64_bf16 v[36:39], v[52:55], v[120:127], v2
    s_add_u32 s46, s60, 1
    v_smfmac_f32_16x16x64_bf16 v[36:39], v[56:59], v[152:159], v2
    s_and_b32 s45, s46, 3
    v_smfmac_f32_16x16x64_bf16 v[36:39], v[60:63], v[184:191], v2
    s_mov_b32 s60, s46
    ds_write_b128 v6, v[24:27] offset:0
    v_smfmac_f32_16x16x64_bf16 v[36:39], v[64:67], v[216:223], v2
    ds_write_b128 v6, v[28:31] offset:1024
    v_smfmac_f32_16x16x64_bf16 v[36:39], v[68:71], v[248:255], v2
    ds_write_b128 v6, v[32:35] offset:2048
    s_lshl_b32 s46, s45, 14
    s_add_u32 s61, s58, s46
    s_lshl_b32 s46, s45, 15
    s_add_u32 s62, s59, s46
    s_waitcnt lgkmcnt(0)
    s_barrier
    ds_read_b128 v[40:43], v7
    ds_read_b128 v[44:47], v8
    ds_read_b128 v[48:51], v18
    s_waitcnt lgkmcnt(2)
    v_pk_add_f32 v[36:37], v[36:37], v[40:41]
    v_pk_add_f32 v[38:39], v[38:39], v[42:43]
    s_waitcnt lgkmcnt(1)
    v_pk_add_f32 v[36:37], v[36:37], v[44:45]
    v_pk_add_f32 v[38:39], v[38:39], v[46:47]
    s_waitcnt lgkmcnt(0)
    v_pk_add_f32 v[36:37], v[36:37], v[48:49]
    v_pk_add_f32 v[38:39], v[38:39], v[50:51]
    s_nop 1
    v_permlane32_swap_b32 v36, v38
    v_permlane32_swap_b32 v37, v39
    v_pk_add_f32 v[24:25], v[36:37], v[38:39]
    buffer_store_dwordx2 v[24:25], v11, s[12:15], s48 offen sc1
    s_bitcmp1_b64 s[6:7], s60
    s_cbranch_scc0 L_v_eag_100
    v_mov_b32 v22, s60
    v_mov_b32 v0, 0
    s_mov_b64 exec, 1
    buffer_store_dword v22, v0, s[12:15], s3 offen sc1
    s_mov_b64 exec, -1
L_v_eag_100:
    ds_read_b128 v[56:59], v5 offset:8192
    ds_read_b128 v[60:63], v5 offset:9216
    ds_read_b128 v[64:67], v5 offset:16384
    ds_read_b128 v[68:71], v5 offset:17408
    ds_read_b128 v[72:75], v5 offset:4096
    ds_read_b128 v[76:79], v5 offset:5120
    ds_read_b128 v[88:91], v5 offset:6144
    ds_read_b128 v[92:95], v5 offset:7168
    ds_read_b128 v[32:35], v5 offset:14336
    ds_read_b128 v[36:39], v5 offset:15360
    s_sleep 2
    buffer_load_dwordx2 v[40:41], v11, s[12:15], s49 offen sc1
    s_nop 15
    s_nop 7
    buffer_load_dwordx2 v[42:43], v11, s[12:15], s49 offen sc1
    s_nop 15
    s_nop 7
    buffer_load_dwordx2 v[44:45], v11, s[12:15], s49 offen sc1
    s_mov_b32 s70, 0
L_v_xp_101:
    s_waitcnt vmcnt(2)
    v_max_u32 v22, v40, v41
    v_cmp_eq_u32 vcc, -1, v22
    v_pk_add_f32 v[28:29], v[24:25], v[40:41]
    v_cvt_pk_bf16_f32 v28, v28, v29
    s_cbranch_vccz L_v_xp_101_ok
    buffer_load_dwordx2 v[40:41], v11, s[12:15], s49 offen sc1
    s_waitcnt vmcnt(2)
    v_max_u32 v22, v42, v43
    v_cmp_eq_u32 vcc, -1, v22
    v_pk_add_f32 v[28:29], v[24:25], v[42:43]
    v_cvt_pk_bf16_f32 v28, v28, v29
    s_cbranch_vccz L_v_xp_101_ok
    buffer_load_dwordx2 v[42:43], v11, s[12:15], s49 offen sc1
    s_waitcnt vmcnt(2)
    v_max_u32 v22, v44, v45
    v_cmp_eq_u32 vcc, -1, v22
    v_pk_add_f32 v[28:29], v[24:25], v[44:45]
    v_cvt_pk_bf16_f32 v28, v28, v29
    s_cbranch_vccz L_v_xp_101_ok
    buffer_load_dwordx2 v[44:45], v11, s[12:15], s49 offen sc1
    s_add_u32 s70, s70, 1
    s_cmp_lt_u32 s70, 0x100000
    s_cbranch_scc1 L_v_xp_101
    s_branch L_c_done_1
L_v_xp_101_ok:
    s_add_u32 s66, s66, 65536
    v_mov_b32_dpp v29, v28 quad_perm:[1,0,3,2] row_mask:0xf bank_mask:0xf
    v_perm_b32 v28, v28, v29, v9
    buffer_store_dword v28, v12, s[24:27], s61 offen
    buffer_store_dword v28, v12, s[28:31], s61 offen sc1
    s_branch L_v_loop_94
L_v_fin_96:
    s_waitcnt vmcnt(0)
    v_mov_b32 v22, 64
    v_mov_b32 v0, 0
    s_mov_b64 exec, 1
    buffer_store_dword v22, v0, s[12:15], s3 offen sc1
    s_mov_b64 exec, -1
L_c_done_1:
    s_endpgm
L_v_og_99_r0:
    buffer_load_dwordx4 v[40:43], v80, s[12:15], s62 offen sc1
    buffer_load_dwordx4 v[44:47], v81, s[12:15], s62 offen sc1
    buffer_load_dwordx4 v[48:51], v82, s[12:15], s62 offen sc1
    buffer_load_dwordx4 v[52:55], v83, s[12:15], s62 offen sc1
    buffer_load_dwordx4 v[56:59], v84, s[12:15], s62 offen sc1
    buffer_load_dwordx4 v[60:63], v85, s[12:15], s62 offen sc1
    s_add_u32 s70, s70, 1
    s_cmp_ge_u32 s70, 0x100000
    s_cbranch_scc1 L_c_done_1
    s_waitcnt vmcnt(5)
    v_cmp_eq_u32 vcc, -1, v43
    s_nop 1
    s_cbranch_vccnz L_v_og_99_r0
    s_branch L_v_og_99_c0
L_v_og_99_r1:
    buffer_load_dwordx4 v[44:47], v81, s[12:15], s62 offen sc1
    buffer_load_dwordx4 v[48:51], v82, s[12:15], s62 offen sc1
    buffer_load_dwordx4 v[52:55], v83, s[12:15], s62 offen sc1
    buffer_load_dwordx4 v[56:59], v84, s[12:15], s62 offen sc1
    buffer_load_dwordx4 v[60:63], v85, s[12:15], s62 offen sc1
    buffer_load_dwordx4 v[64:67], v86, s[12:15], s62 offen sc1
    s_add_u32 s70, s70, 1
    s_cmp_ge_u32 s70, 0x100000
    s_cbranch_scc1 L_c_done_1
    s_waitcnt vmcnt(5)
    v_cmp_eq_u32 vcc, -1, v47
    s_nop 1
    s_cbranch_vccnz L_v_og_99_r1
    s_branch L_v_og_99_c1
L_v_og_99_r2:
    buffer_load_dwordx4 v[48:51], v82, s[12:15], s62 offen sc1
    buffer_load_dwordx4 v[52:55], v83, s[12:15], s62 offen sc1
    buffer_load_dwordx4 v[56:59], v84, s[12:15], s62 offen sc1
    buffer_load_dwordx4 v[60:63], v85, s[12:15], s62 offen sc1
    buffer_load_dwordx4 v[64:67], v86, s[12:15], s62 offen sc1
    buffer_load_dwordx4 v[68:71], v87, s[12:15], s62 offen sc1
    s_add_u32 s70, s70, 1
    s_cmp_ge_u32 s70, 0x100000
    s_cbranch_scc1 L_c_done_1
    s_waitcnt vmcnt(5)
    v_cmp_eq_u32 vcc, -1, v51
    s_nop 1
    s_cbranch_vccnz L_v_og_99_r2
    s_branch L_v_og_99_c2
L_v_og_99_r3:
    buffer_load_dwordx4 v[52:55], v83, s[12:15], s62 offen sc1
    buffer_load_dwordx4 v[56:59], v84, s[12:15], s62 offen sc1
    buffer_load_dwordx4 v[60:63], v85, s[12:15], s62 offen sc1
    buffer_load_dwordx4 v[64:67], v86, s[12:15], s62 offen sc1
    buffer_load_dwordx4 v[68:71], v87, s[12:15], s62 offen sc1
    s_add_u32 s70, s70, 1
    s_cmp_ge_u32 s70, 0x100000
    s_cbranch_scc1 L_c_done_1
    s_waitcnt vmcnt(4)
    v_cmp_eq_u32 vcc, -1, v55
    s_nop 1
    s_cbranch_vccnz L_v_og_99_r3
    s_branch L_v_og_99_c3
L_v_og_99_r4:
    buffer_load_dwordx4 v[56:59], v84, s[12:15], s62 offen sc1
    buffer_load_dwordx4 v[60:63], v85, s[12:15], s62 offen sc1
    buffer_load_dwordx4 v[64:67], v86, s[12:15], s62 offen sc1
    buffer_load_dwordx4 v[68:71], v87, s[12:15], s62 offen sc1
    s_add_u32 s70, s70, 1
    s_cmp_ge_u32 s70, 0x100000
    s_cbranch_scc1 L_c_done_1
    s_waitcnt vmcnt(3)
    v_cmp_eq_u32 vcc, -1, v59
    s_nop 1
    s_cbranch_vccnz L_v_og_99_r4
    s_branch L_v_og_99_c4
L_v_og_99_r5:
    buffer_load_dwordx4 v[60:63], v85, s[12:15], s62 offen sc1
    buffer_load_dwordx4 v[64:67], v86, s[12:15], s62 offen sc1
    buffer_load_dwordx4 v[68:71], v87, s[12:15], s62 offen sc1
    s_add_u32 s70, s70, 1
    s_cmp_ge_u32 s70, 0x100000
    s_cbranch_scc1 L_c_done_1
    s_waitcnt vmcnt(2)
    v_cmp_eq_u32 vcc, -1, v63
    s_nop 1
    s_cbranch_vccnz L_v_og_99_r5
    s_branch L_v_og_99_c5
L_v_og_99_r6:
    buffer_load_dwordx4 v[64:67], v86, s[12:15], s62 offen sc1
    buffer_load_dwordx4 v[68:71], v87, s[12:15], s62 offen sc1
    s_add_u32 s70, s70, 1
    s_cmp_ge_u32 s70, 0x100000
    s_cbranch_scc1 L_c_done_1
    s_waitcnt vmcnt(1)
    v_cmp_eq_u32 vcc, -1, v67
    s_nop 1
    s_cbranch_vccnz L_v_og_99_r6
    s_branch L_v_og_99_c6
L_v_og_99_r7:
    buffer_load_dwordx4 v[68:71], v87, s[12:15], s62 offen sc1
    s_add_u32 s70, s70, 1
    s_cmp_ge_u32 s70, 0x100000
    s_cbranch_scc1 L_c_done_1
    s_waitcnt vmcnt(0)
    v_cmp_eq_u32 vcc, -1, v71
    s_nop 1
    s_cbranch_vccnz L_v_og_99_r7
    s_branch L_v_og_99_c7
L_mg_95_r0:
    buffer_load_dwordx4 v[40:43], v3, s[12:15], s8 offen sc1
    buffer_load_dwordx4 v[44:47], v3, s[12:15], s9 offen sc1
    buffer_load_dwordx4 v[48:51], v3, s[12:15], s10 offen sc1
    buffer_load_dwordx4 v[52:55], v3, s[12:15], s11 offen sc1
    s_add_u32 s70, s70, 1
    s_cmp_ge_u32 s70, 0x100000
    s_cbranch_scc1 L_c_done_1
    s_waitcnt vmcnt(3)
    ds_write_b128 v3, v[40:43] offset:0
    v_max3_u32 v22, v40, v41, v42
    v_max_u32 v22, v22, v43
    v_cmp_eq_u32 vcc, -1, v22
    s_waitcnt lgkmcnt(0)
    s_nop 0
    s_cbranch_vccnz L_mg_95_r0
    s_branch L_mg_95_c0
L_mg_95_r1:
    buffer_load_dwordx4 v[44:47], v3, s[12:15], s9 offen sc1
    buffer_load_dwordx4 v[48:51], v3, s[12:15], s10 offen sc1
    buffer_load_dwordx4 v[52:55], v3, s[12:15], s11 offen sc1
    s_add_u32 s70, s70, 1
    s_cmp_ge_u32 s70, 0x100000
    s_cbranch_scc1 L_c_done_1
    s_waitcnt vmcnt(2)
    ds_write_b128 v3, v[44:47] offset:1024
    v_max3_u32 v22, v44, v45, v46
    v_max_u32 v22, v22, v47
    v_cmp_eq_u32 vcc, -1, v22
    s_waitcnt lgkmcnt(0)
    s_nop 0
    s_cbranch_vccnz L_mg_95_r1
    s_branch L_mg_95_c1
L_mg_95_r2:
    buffer_load_dwordx4 v[48:51], v3, s[12:15], s10 offen sc1
    buffer_load_dwordx4 v[52:55], v3, s[12:15], s11 offen sc1
    s_add_u32 s70, s70, 1
    s_cmp_ge_u32 s70, 0x100000
    s_cbranch_scc1 L_c_done_1
    s_waitcnt vmcnt(1)
    ds_write_b128 v3, v[48:51] offset:2048
    v_max3_u32 v22, v48, v49, v50
    v_max_u32 v22, v22, v51
    v_cmp_eq_u32 vcc, -1, v22
    s_waitcnt lgkmcnt(0)
    s_nop 0
    s_cbranch_vccnz L_mg_95_r2
    s_branch L_mg_95_c2
L_mg_95_r3:
    buffer_load_dwordx4 v[52:55], v3, s[12:15], s11 offen sc1
    s_add_u32 s70, s70, 1
    s_cmp_ge_u32 s70, 0x100000
    s_cbranch_scc1 L_c_done_1
    s_waitcnt vmcnt(0)
    ds_write_b128 v3, v[52:55] offset:3072
    v_max3_u32 v22, v52, v53, v54
    v_max_u32 v22, v22, v55
    v_cmp_eq_u32 vcc, -1, v22
    s_waitcnt lgkmcnt(0)
    s_nop 0
    s_cbranch_vccnz L_mg_95_r3
    s_branch L_mg_95_c3
L_worker_3:
    s_lshr_b32 s41, s2, 3
    s_and_b32 s42, s40, 1
    s_lshr_b32 s43, s40, 1
    s_lshl_b32 s39, s43, 5
    s_add_u32 s39, s39, s41
    s_load_dwordx2 s[4:5], s[0:1], 0
    s_waitcnt lgkmcnt(0)
    s_mov_b32 s28, s4
    s_and_b32 s29, s5, 0xffff
    s_mov_b32 s30, 0x400000
    s_mov_b32 s31, 0x00020000
    v_lshrrev_b32 v2, 4, v1
    v_and_b32 v4, 15, v1
    v_lshrrev_b32 v3, 1, v4
    v_xor_b32 v3, v3, v2
    v_lshlrev_b32 v3, 4, v3
    v_lshlrev_b32 v6, 7, v4
    v_add_u32 v3, v3, v6
    v_mul_u32_u24 v7, 144, v4
    v_lshlrev_b32 v6, 4, v2
    s_mul_i32 s45, s44, 4608
    s_add_u32 s45, s45, 131072
    v_add3_u32 v7, v7, v6, s45
    v_lshrrev_b32 v9, 3, v1
    v_mul_u32_u24 v8, 144, v9
    v_and_b32 v6, 7, v1
    v_lshlrev_b32 v6, 4, v6
    v_add3_u32 v8, v8, v6, s45
    v_lshlrev_b32 v11, 12, v9
    v_add_u32 v11, v11, v6
    v_lshlrev_b32 v2, 13, v2
    v_lshlrev_b32 v6, 4, v4
    v_add_u32 v2, v2, v6
    v_lshrrev_b32 v6, 3, v1
    v_lshrrev_b32 v9, 4, v1
    v_and_b32 v4, 7, v1
    v_xor_b32 v9, v9, v4
    v_lshlrev_b32 v9, 4, v9
    v_lshlrev_b32 v6, 8, v6
    v_add_u32 v6, v6, v9
    v_xor_b32 v9, 64, v6
    v_add_u32 v9, 2048, v9
    v_lshlrev_b32 v10, 4, v1
    v_lshlrev_b32 v12, 2, v1
    v_lshlrev_b32 v5, 7, v1
    s_lshl_b32 s61, s41, 7
    s_lshl_b32 s45, s43, 2
    s_add_u32 s61, s61, s45
    s_add_u32 s61, s61, 0x10010
    s_mul_i32 s64, s42, 24576
    s_add_u32 s64, s64, 0x12000
    s_lshl_b32 s45, s41, 7
    s_add_u32 s65, s64, s45
    s_lshl_b32 s45, s43, 13
    s_add_u32 s65, s65, s45
    s_add_u32 s67, s65, 4096
    s_cmp_lg_u32 s42, 0
    s_cbranch_scc1 L_w_kv_103
    v_mov_b32 v30, 0
    v_mov_b32 v31, 0
    v_mov_b32 v29, 24576
    s_mov_b64 exec, 1
    buffer_store_dword v30, v31, s[12:15], s61 offen sc1
    buffer_store_dword v30, v31, s[12:15], s65 offen sc1
    buffer_store_dword v30, v31, s[12:15], s67 offen sc1
    buffer_store_dword v30, v29, s[12:15], s65 offen sc1
    buffer_store_dword v30, v29, s[12:15], s67 offen sc1
    s_mov_b64 exec, -1
    s_lshl_b32 s63, s39, 2
    s_add_u32 s63, s63, s44
    s_load_dwordx2 s[4:5], s[0:1], 96
    s_load_dwordx2 s[6:7], s[0:1], 104
    v_and_b32 v14, 7, v0
    v_lshrrev_b32 v15, 3, v0
    s_waitcnt lgkmcnt(0)
    s_mov_b32 s32, s4
    s_and_b32 s33, s5, 0xffff
    s_mov_b32 s34, 0x800
    s_mov_b32 s35, 0x00020000
    s_mov_b32 s24, s6
    s_and_b32 s25, s7, 0xffff
    s_mov_b32 s26, 0xc00000
    s_mov_b32 s27, 0x00020000
    s_and_b32 s47, s39, 1
    s_lshl_b32 s45, s47, 10
    v_lshlrev_b32 v16, 5, v15
    buffer_load_dwordx4 v[104:107], v16, s[32:35], s45 offen
    buffer_load_dwordx4 v[108:111], v16, s[32:35], s45 offen offset:16
    s_mov_b32 s45, 196608
    v_mul_lo_u32 v17, v15, s45
    v_lshlrev_b32 v18, 4, v14
    v_add_u32 v17, v17, v18
    s_lshr_b32 s46, s39, 1
    s_lshl_b32 s46, s46, 7
    s_mul_i32 s45, s47, 6291456
    s_add_u32 s46, s46, s45
    buffer_load_dwordx4 v[32:35], v17, s[24:27], s46 offen
    v_add_u32 v17, 12288, v17
    buffer_load_dwordx4 v[36:39], v17, s[24:27], s46 offen
    v_add_u32 v17, 12288, v17
    buffer_load_dwordx4 v[40:43], v17, s[24:27], s46 offen
    v_add_u32 v17, 12288, v17
    buffer_load_dwordx4 v[44:47], v17, s[24:27], s46 offen
    v_add_u32 v17, 12288, v17
    buffer_load_dwordx4 v[48:51], v17, s[24:27], s46 offen
    v_add_u32 v17, 12288, v17
    buffer_load_dwordx4 v[52:55], v17, s[24:27], s46 offen
    v_add_u32 v17, 12288, v17
    buffer_load_dwordx4 v[56:59], v17, s[24:27], s46 offen
    v_add_u32 v17, 12288, v17
    buffer_load_dwordx4 v[60:63], v17, s[24:27], s46 offen
    v_add_u32 v17, 12288, v17
    buffer_load_dwordx4 v[64:67], v17, s[24:27], s46 offen
    v_add_u32 v17, 12288, v17
    buffer_load_dwordx4 v[68:71], v17, s[24:27], s46 offen
    v_add_u32 v17, 12288, v17
    buffer_load_dwordx4 v[72:75], v17, s[24:27], s46 offen
    v_add_u32 v17, 12288, v17
    buffer_load_dwordx4 v[76:79], v17, s[24:27], s46 offen
    v_add_u32 v17, 12288, v17
    buffer_load_dwordx4 v[80:83], v17, s[24:27], s46 offen
    v_add_u32 v17, 12288, v17
    buffer_load_dwordx4 v[84:87], v17, s[24:27], s46 offen
    v_add_u32 v17, 12288, v17
    buffer_load_dwordx4 v[88:91], v17, s[24:27], s46 offen
    v_add_u32 v17, 12288, v17
    buffer_load_dwordx4 v[92:95], v17, s[24:27], s46 offen
    s_add_u32 s45, s63, 0
    s_lshl_b32 s45, s45, 11
    buffer_load_dwordx4 v[128:131], v10, s[28:31], s45 offen
    buffer_load_dwordx4 v[132:135], v10, s[28:31], s45 offen offset:1024
    s_add_u32 s45, s63, 384
    s_lshl_b32 s45, s45, 11
    buffer_load_dwordx4 v[136:139], v10, s[28:31], s45 offen
    buffer_load_dwordx4 v[140:143], v10, s[28:31], s45 offen offset:1024
    s_add_u32 s45, s63, 768
    s_lshl_b32 s45, s45, 11
    buffer_load_dwordx4 v[144:147], v10, s[28:31], s45 offen
    buffer_load_dwordx4 v[148:151], v10, s[28:31], s45 offen offset:1024
    s_add_u32 s45, s63, 1152
    s_lshl_b32 s45, s45, 11
    buffer_load_dwordx4 v[152:155], v10, s[28:31], s45 offen
    buffer_load_dwordx4 v[156:159], v10, s[28:31], s45 offen offset:1024
    s_add_u32 s45, s63, 1536
    s_lshl_b32 s45, s45, 11
    buffer_load_dwordx4 v[160:163], v10, s[28:31], s45 offen
    buffer_load_dwordx4 v[164:167], v10, s[28:31], s45 offen offset:1024
    s_add_u32 s45, s63, 1920
    s_lshl_b32 s45, s45, 11
    buffer_load_dwordx4 v[168:171], v10, s[28:31], s45 offen
    buffer_load_dwordx4 v[172:175], v10, s[28:31], s45 offen offset:1024
    s_waitcnt vmcnt(28)
    v_lshlrev_b32 v112, 16, v104
    v_and_b32 v113, 0xffff0000, v104
    v_lshlrev_b32 v114, 16, v105
    v_and_b32 v115, 0xffff0000, v105
    v_lshlrev_b32 v116, 16, v106
    v_and_b32 v117, 0xffff0000, v106
    v_lshlrev_b32 v118, 16, v107
    v_and_b32 v119, 0xffff0000, v107
    v_lshlrev_b32 v120, 16, v108
    v_and_b32 v121, 0xffff0000, v108
    v_lshlrev_b32 v122, 16, v109
    v_and_b32 v123, 0xffff0000, v109
    v_lshlrev_b32 v124, 16, v110
    v_and_b32 v125, 0xffff0000, v110
    v_lshlrev_b32 v126, 16, v111
    v_and_b32 v127, 0xffff0000, v111
    v_mul_f32 v18, 0xbfb8aa3b, v112
    v_exp_f32 v18, v18
    s_nop 0
    v_add_f32 v18, 1.0, v18
    v_rcp_f32 v18, v18
    s_nop 0
    v_mul_f32 v112, v112, v18
    v_cvt_pk_bf16_f32 v112, v112, v112
    v_lshlrev_b32 v112, 16, v112
    v_mul_f32 v18, 0xbfb8aa3b, v113
    v_exp_f32 v18, v18
    s_nop 0
    v_add_f32 v18, 1.0, v18
    v_rcp_f32 v18, v18
    s_nop 0
    v_mul_f32 v113, v113, v18
    v_cvt_pk_bf16_f32 v113, v113, v113
    v_lshlrev_b32 v113, 16, v113
    v_mul_f32 v18, 0xbfb8aa3b, v114
    v_exp_f32 v18, v18
    s_nop 0
    v_add_f32 v18, 1.0, v18
    v_rcp_f32 v18, v18
    s_nop 0
    v_mul_f32 v114, v114, v18
    v_cvt_pk_bf16_f32 v114, v114, v114
    v_lshlrev_b32 v114, 16, v114
    v_mul_f32 v18, 0xbfb8aa3b, v115
    v_exp_f32 v18, v18
    s_nop 0
    v_add_f32 v18, 1.0, v18
    v_rcp_f32 v18, v18
    s_nop 0
    v_mul_f32 v115, v115, v18
    v_cvt_pk_bf16_f32 v115, v115, v115
    v_lshlrev_b32 v115, 16, v115
    v_mul_f32 v18, 0xbfb8aa3b, v116
    v_exp_f32 v18, v18
    s_nop 0
    v_add_f32 v18, 1.0, v18
    v_rcp_f32 v18, v18
    s_nop 0
    v_mul_f32 v116, v116, v18
    v_cvt_pk_bf16_f32 v116, v116, v116
    v_lshlrev_b32 v116, 16, v116
    v_mul_f32 v18, 0xbfb8aa3b, v117
    v_exp_f32 v18, v18
    s_nop 0
    v_add_f32 v18, 1.0, v18
    v_rcp_f32 v18, v18
    s_nop 0
    v_mul_f32 v117, v117, v18
    v_cvt_pk_bf16_f32 v117, v117, v117
    v_lshlrev_b32 v117, 16, v117
    v_mul_f32 v18, 0xbfb8aa3b, v118
    v_exp_f32 v18, v18
    s_nop 0
    v_add_f32 v18, 1.0, v18
    v_rcp_f32 v18, v18
    s_nop 0
    v_mul_f32 v118, v118, v18
    v_cvt_pk_bf16_f32 v118, v118, v118
    v_lshlrev_b32 v118, 16, v118
    v_mul_f32 v18, 0xbfb8aa3b, v119
    v_exp_f32 v18, v18
    s_nop 0
    v_add_f32 v18, 1.0, v18
    v_rcp_f32 v18, v18
    s_nop 0
    v_mul_f32 v119, v119, v18
    v_cvt_pk_bf16_f32 v119, v119, v119
    v_lshlrev_b32 v119, 16, v119
    v_mul_f32 v18, 0xbfb8aa3b, v120
    v_exp_f32 v18, v18
    s_nop 0
    v_add_f32 v18, 1.0, v18
    v_rcp_f32 v18, v18
    s_nop 0
    v_mul_f32 v120, v120, v18
    v_cvt_pk_bf16_f32 v120, v120, v120
    v_lshlrev_b32 v120, 16, v120
    v_mul_f32 v18, 0xbfb8aa3b, v121
    v_exp_f32 v18, v18
    s_nop 0
    v_add_f32 v18, 1.0, v18
    v_rcp_f32 v18, v18
    s_nop 0
    v_mul_f32 v121, v121, v18
    v_cvt_pk_bf16_f32 v121, v121, v121
    v_lshlrev_b32 v121, 16, v121
    v_mul_f32 v18, 0xbfb8aa3b, v122
    v_exp_f32 v18, v18
    s_nop 0
    v_add_f32 v18, 1.0, v18
    v_rcp_f32 v18, v18
    s_nop 0
    v_mul_f32 v122, v122, v18
    v_cvt_pk_bf16_f32 v122, v122, v122
    v_lshlrev_b32 v122, 16, v122
    v_mul_f32 v18, 0xbfb8aa3b, v123
    v_exp_f32 v18, v18
    s_nop 0
    v_add_f32 v18, 1.0, v18
    v_rcp_f32 v18, v18
    s_nop 0
    v_mul_f32 v123, v123, v18
    v_cvt_pk_bf16_f32 v123, v123, v123
    v_lshlrev_b32 v123, 16, v123
    v_mul_f32 v18, 0xbfb8aa3b, v124
    v_exp_f32 v18, v18
    s_nop 0
    v_add_f32 v18, 1.0, v18
    v_rcp_f32 v18, v18
    s_nop 0
    v_mul_f32 v124, v124, v18
    v_cvt_pk_bf16_f32 v124, v124, v124
    v_lshlrev_b32 v124, 16, v124
    v_mul_f32 v18, 0xbfb8aa3b, v125
    v_exp_f32 v18, v18
    s_nop 0
    v_add_f32 v18, 1.0, v18
    v_rcp_f32 v18, v18
    s_nop 0
    v_mul_f32 v125, v125, v18
    v_cvt_pk_bf16_f32 v125, v125, v125
    v_lshlrev_b32 v125, 16, v125
    v_mul_f32 v18, 0xbfb8aa3b, v126
    v_exp_f32 v18, v18
    s_nop 0
    v_add_f32 v18, 1.0, v18
    v_rcp_f32 v18, v18
    s_nop 0
    v_mul_f32 v126, v126, v18
    v_cvt_pk_bf16_f32 v126, v126, v126
    v_lshlrev_b32 v126, 16, v126
    v_mul_f32 v18, 0xbfb8aa3b, v127
    v_exp_f32 v18, v18
    s_nop 0
    v_add_f32 v18, 1.0, v18
    v_rcp_f32 v18, v18
    s_nop 0
    v_mul_f32 v127, v127, v18
    v_cvt_pk_bf16_f32 v127, v127, v127
    v_lshlrev_b32 v127, 16, v127
    v_mov_b32 v96, 0
    v_mov_b32 v97, 0
    v_mov_b32 v98, 0
    v_mov_b32 v99, 0
    v_mov_b32 v100, 0
    v_mov_b32 v101, 0
    v_mov_b32 v102, 0
    v_mov_b32 v103, 0
    s_waitcnt vmcnt(27)
    v_lshlrev_b32 v18, 16, v32
    v_and_b32 v19, 0xffff0000, v32
    v_fmac_f32 v96, v18, v112
    v_fmac_f32 v97, v19, v112
    v_lshlrev_b32 v18, 16, v33
    v_and_b32 v19, 0xffff0000, v33
    v_fmac_f32 v98, v18, v112
    v_fmac_f32 v99, v19, v112
    v_lshlrev_b32 v18, 16, v34
    v_and_b32 v19, 0xffff0000, v34
    v_fmac_f32 v100, v18, v112
    v_fmac_f32 v101, v19, v112
    v_lshlrev_b32 v18, 16, v35
    v_and_b32 v19, 0xffff0000, v35
    v_fmac_f32 v102, v18, v112
    v_fmac_f32 v103, v19, v112
    s_waitcnt vmcnt(26)
    v_lshlrev_b32 v18, 16, v36
    v_and_b32 v19, 0xffff0000, v36
    v_fmac_f32 v96, v18, v113
    v_fmac_f32 v97, v19, v113
    v_lshlrev_b32 v18, 16, v37
    v_and_b32 v19, 0xffff0000, v37
    v_fmac_f32 v98, v18, v113
    v_fmac_f32 v99, v19, v113
    v_lshlrev_b32 v18, 16, v38
    v_and_b32 v19, 0xffff0000, v38
    v_fmac_f32 v100, v18, v113
    v_fmac_f32 v101, v19, v113
    v_lshlrev_b32 v18, 16, v39
    v_and_b32 v19, 0xffff0000, v39
    v_fmac_f32 v102, v18, v113
    v_fmac_f32 v103, v19, v113
    s_waitcnt vmcnt(25)
    v_lshlrev_b32 v18, 16, v40
    v_and_b32 v19, 0xffff0000, v40
    v_fmac_f32 v96, v18, v114
    v_fmac_f32 v97, v19, v114
    v_lshlrev_b32 v18, 16, v41
    v_and_b32 v19, 0xffff0000, v41
    v_fmac_f32 v98, v18, v114
    v_fmac_f32 v99, v19, v114
    v_lshlrev_b32 v18, 16, v42
    v_and_b32 v19, 0xffff0000, v42
    v_fmac_f32 v100, v18, v114
    v_fmac_f32 v101, v19, v114
    v_lshlrev_b32 v18, 16, v43
    v_and_b32 v19, 0xffff0000, v43
    v_fmac_f32 v102, v18, v114
    v_fmac_f32 v103, v19, v114
    s_waitcnt vmcnt(24)
    v_lshlrev_b32 v18, 16, v44
    v_and_b32 v19, 0xffff0000, v44
    v_fmac_f32 v96, v18, v115
    v_fmac_f32 v97, v19, v115
    v_lshlrev_b32 v18, 16, v45
    v_and_b32 v19, 0xffff0000, v45
    v_fmac_f32 v98, v18, v115
    v_fmac_f32 v99, v19, v115
    v_lshlrev_b32 v18, 16, v46
    v_and_b32 v19, 0xffff0000, v46
    v_fmac_f32 v100, v18, v115
    v_fmac_f32 v101, v19, v115
    v_lshlrev_b32 v18, 16, v47
    v_and_b32 v19, 0xffff0000, v47
    v_fmac_f32 v102, v18, v115
    v_fmac_f32 v103, v19, v115
    s_waitcnt vmcnt(23)
    v_lshlrev_b32 v18, 16, v48
    v_and_b32 v19, 0xffff0000, v48
    v_fmac_f32 v96, v18, v116
    v_fmac_f32 v97, v19, v116
    v_lshlrev_b32 v18, 16, v49
    v_and_b32 v19, 0xffff0000, v49
    v_fmac_f32 v98, v18, v116
    v_fmac_f32 v99, v19, v116
    v_lshlrev_b32 v18, 16, v50
    v_and_b32 v19, 0xffff0000, v50
    v_fmac_f32 v100, v18, v116
    v_fmac_f32 v101, v19, v116
    v_lshlrev_b32 v18, 16, v51
    v_and_b32 v19, 0xffff0000, v51
    v_fmac_f32 v102, v18, v116
    v_fmac_f32 v103, v19, v116
    s_waitcnt vmcnt(22)
    v_lshlrev_b32 v18, 16, v52
    v_and_b32 v19, 0xffff0000, v52
    v_fmac_f32 v96, v18, v117
    v_fmac_f32 v97, v19, v117
    v_lshlrev_b32 v18, 16, v53
    v_and_b32 v19, 0xffff0000, v53
    v_fmac_f32 v98, v18, v117
    v_fmac_f32 v99, v19, v117
    v_lshlrev_b32 v18, 16, v54
    v_and_b32 v19, 0xffff0000, v54
    v_fmac_f32 v100, v18, v117
    v_fmac_f32 v101, v19, v117
    v_lshlrev_b32 v18, 16, v55
    v_and_b32 v19, 0xffff0000, v55
    v_fmac_f32 v102, v18, v117
    v_fmac_f32 v103, v19, v117
    s_waitcnt vmcnt(21)
    v_lshlrev_b32 v18, 16, v56
    v_and_b32 v19, 0xffff0000, v56
    v_fmac_f32 v96, v18, v118
    v_fmac_f32 v97, v19, v118
    v_lshlrev_b32 v18, 16, v57
    v_and_b32 v19, 0xffff0000, v57
    v_fmac_f32 v98, v18, v118
    v_fmac_f32 v99, v19, v118
    v_lshlrev_b32 v18, 16, v58
    v_and_b32 v19, 0xffff0000, v58
    v_fmac_f32 v100, v18, v118
    v_fmac_f32 v101, v19, v118
    v_lshlrev_b32 v18, 16, v59
    v_and_b32 v19, 0xffff0000, v59
    v_fmac_f32 v102, v18, v118
    v_fmac_f32 v103, v19, v118
    s_waitcnt vmcnt(20)
    v_lshlrev_b32 v18, 16, v60
    v_and_b32 v19, 0xffff0000, v60
    v_fmac_f32 v96, v18, v119
    v_fmac_f32 v97, v19, v119
    v_lshlrev_b32 v18, 16, v61
    v_and_b32 v19, 0xffff0000, v61
    v_fmac_f32 v98, v18, v119
    v_fmac_f32 v99, v19, v119
    v_lshlrev_b32 v18, 16, v62
    v_and_b32 v19, 0xffff0000, v62
    v_fmac_f32 v100, v18, v119
    v_fmac_f32 v101, v19, v119
    v_lshlrev_b32 v18, 16, v63
    v_and_b32 v19, 0xffff0000, v63
    v_fmac_f32 v102, v18, v119
    v_fmac_f32 v103, v19, v119
    s_waitcnt vmcnt(19)
    v_lshlrev_b32 v18, 16, v64
    v_and_b32 v19, 0xffff0000, v64
    v_fmac_f32 v96, v18, v120
    v_fmac_f32 v97, v19, v120
    v_lshlrev_b32 v18, 16, v65
    v_and_b32 v19, 0xffff0000, v65
    v_fmac_f32 v98, v18, v120
    v_fmac_f32 v99, v19, v120
    v_lshlrev_b32 v18, 16, v66
    v_and_b32 v19, 0xffff0000, v66
    v_fmac_f32 v100, v18, v120
    v_fmac_f32 v101, v19, v120
    v_lshlrev_b32 v18, 16, v67
    v_and_b32 v19, 0xffff0000, v67
    v_fmac_f32 v102, v18, v120
    v_fmac_f32 v103, v19, v120
    s_waitcnt vmcnt(18)
    v_lshlrev_b32 v18, 16, v68
    v_and_b32 v19, 0xffff0000, v68
    v_fmac_f32 v96, v18, v121
    v_fmac_f32 v97, v19, v121
    v_lshlrev_b32 v18, 16, v69
    v_and_b32 v19, 0xffff0000, v69
    v_fmac_f32 v98, v18, v121
    v_fmac_f32 v99, v19, v121
    v_lshlrev_b32 v18, 16, v70
    v_and_b32 v19, 0xffff0000, v70
    v_fmac_f32 v100, v18, v121
    v_fmac_f32 v101, v19, v121
    v_lshlrev_b32 v18, 16, v71
    v_and_b32 v19, 0xffff0000, v71
    v_fmac_f32 v102, v18, v121
    v_fmac_f32 v103, v19, v121
    s_waitcnt vmcnt(17)
    v_lshlrev_b32 v18, 16, v72
    v_and_b32 v19, 0xffff0000, v72
    v_fmac_f32 v96, v18, v122
    v_fmac_f32 v97, v19, v122
    v_lshlrev_b32 v18, 16, v73
    v_and_b32 v19, 0xffff0000, v73
    v_fmac_f32 v98, v18, v122
    v_fmac_f32 v99, v19, v122
    v_lshlrev_b32 v18, 16, v74
    v_and_b32 v19, 0xffff0000, v74
    v_fmac_f32 v100, v18, v122
    v_fmac_f32 v101, v19, v122
    v_lshlrev_b32 v18, 16, v75
    v_and_b32 v19, 0xffff0000, v75
    v_fmac_f32 v102, v18, v122
    v_fmac_f32 v103, v19, v122
    s_waitcnt vmcnt(16)
    v_lshlrev_b32 v18, 16, v76
    v_and_b32 v19, 0xffff0000, v76
    v_fmac_f32 v96, v18, v123
    v_fmac_f32 v97, v19, v123
    v_lshlrev_b32 v18, 16, v77
    v_and_b32 v19, 0xffff0000, v77
    v_fmac_f32 v98, v18, v123
    v_fmac_f32 v99, v19, v123
    v_lshlrev_b32 v18, 16, v78
    v_and_b32 v19, 0xffff0000, v78
    v_fmac_f32 v100, v18, v123
    v_fmac_f32 v101, v19, v123
    v_lshlrev_b32 v18, 16, v79
    v_and_b32 v19, 0xffff0000, v79
    v_fmac_f32 v102, v18, v123
    v_fmac_f32 v103, v19, v123
    s_waitcnt vmcnt(15)
    v_lshlrev_b32 v18, 16, v80
    v_and_b32 v19, 0xffff0000, v80
    v_fmac_f32 v96, v18, v124
    v_fmac_f32 v97, v19, v124
    v_lshlrev_b32 v18, 16, v81
    v_and_b32 v19, 0xffff0000, v81
    v_fmac_f32 v98, v18, v124
    v_fmac_f32 v99, v19, v124
    v_lshlrev_b32 v18, 16, v82
    v_and_b32 v19, 0xffff0000, v82
    v_fmac_f32 v100, v18, v124
    v_fmac_f32 v101, v19, v124
    v_lshlrev_b32 v18, 16, v83
    v_and_b32 v19, 0xffff0000, v83
    v_fmac_f32 v102, v18, v124
    v_fmac_f32 v103, v19, v124
    s_waitcnt vmcnt(14)
    v_lshlrev_b32 v18, 16, v84
    v_and_b32 v19, 0xffff0000, v84
    v_fmac_f32 v96, v18, v125
    v_fmac_f32 v97, v19, v125
    v_lshlrev_b32 v18, 16, v85
    v_and_b32 v19, 0xffff0000, v85
    v_fmac_f32 v98, v18, v125
    v_fmac_f32 v99, v19, v125
    v_lshlrev_b32 v18, 16, v86
    v_and_b32 v19, 0xffff0000, v86
    v_fmac_f32 v100, v18, v125
    v_fmac_f32 v101, v19, v125
    v_lshlrev_b32 v18, 16, v87
    v_and_b32 v19, 0xffff0000, v87
    v_fmac_f32 v102, v18, v125
    v_fmac_f32 v103, v19, v125
    s_waitcnt vmcnt(13)
    v_lshlrev_b32 v18, 16, v88
    v_and_b32 v19, 0xffff0000, v88
    v_fmac_f32 v96, v18, v126
    v_fmac_f32 v97, v19, v126
    v_lshlrev_b32 v18, 16, v89
    v_and_b32 v19, 0xffff0000, v89
    v_fmac_f32 v98, v18, v126
    v_fmac_f32 v99, v19, v126
    v_lshlrev_b32 v18, 16, v90
    v_and_b32 v19, 0xffff0000, v90
    v_fmac_f32 v100, v18, v126
    v_fmac_f32 v101, v19, v126
    v_lshlrev_b32 v18, 16, v91
    v_and_b32 v19, 0xffff0000, v91
    v_fmac_f32 v102, v18, v126
    v_fmac_f32 v103, v19, v126
    s_waitcnt vmcnt(12)
    v_lshlrev_b32 v18, 16, v92
    v_and_b32 v19, 0xffff0000, v92
    v_fmac_f32 v96, v18, v127
    v_fmac_f32 v97, v19, v127
    v_lshlrev_b32 v18, 16, v93
    v_and_b32 v19, 0xffff0000, v93
    v_fmac_f32 v98, v18, v127
    v_fmac_f32 v99, v19, v127
    v_lshlrev_b32 v18, 16, v94
    v_and_b32 v19, 0xffff0000, v94
    v_fmac_f32 v100, v18, v127
    v_fmac_f32 v101, v19, v127
    v_lshlrev_b32 v18, 16, v95
    v_and_b32 v19, 0xffff0000, v95
    v_fmac_f32 v102, v18, v127
    v_fmac_f32 v103, v19, v127
    v_lshlrev_b32 v16, 5, v0
    ds_write_b128 v16, v[96:99]
    ds_write_b128 v16, v[100:103] offset:16
    s_waitcnt lgkmcnt(0)
    s_barrier
    s_cmp_lg_u32 s44, 0
    s_cbranch_scc1 L_mod_fin_105
    v_mov_b32 v18, 0
    ds_read_b32 v32, v12 offset:0
    ds_read_b32 v33, v12 offset:256
    ds_read_b32 v34, v12 offset:512
    ds_read_b32 v35, v12 offset:768
    ds_read_b32 v36, v12 offset:1024
    ds_read_b32 v37, v12 offset:1280
    ds_read_b32 v38, v12 offset:1536
    ds_read_b32 v39, v12 offset:1792
    ds_read_b32 v40, v12 offset:2048
    ds_read_b32 v41, v12 offset:2304
    ds_read_b32 v42, v12 offset:2560
    ds_read_b32 v43, v12 offset:2816
    ds_read_b32 v44, v12 offset:3072
    ds_read_b32 v45, v12 offset:3328
    ds_read_b32 v46, v12 offset:3584
    ds_read_b32 v47, v12 offset:3840
    s_waitcnt lgkmcnt(0)
    v_add_f32 v18, v18, v32
    v_add_f32 v18, v18, v33
    v_add_f32 v18, v18, v34
    v_add_f32 v18, v18, v35
    v_add_f32 v18, v18, v36
    v_add_f32 v18, v18, v37
    v_add_f32 v18, v18, v38
    v_add_f32 v18, v18, v39
    v_add_f32 v18, v18, v40
    v_add_f32 v18, v18, v41
    v_add_f32 v18, v18, v42
    v_add_f32 v18, v18, v43
    v_add_f32 v18, v18, v44
    v_add_f32 v18, v18, v45
    v_add_f32 v18, v18, v46
    v_add_f32 v18, v18, v47
    ds_read_b32 v32, v12 offset:4096
    ds_read_b32 v33, v12 offset:4352
    ds_read_b32 v34, v12 offset:4608
    ds_read_b32 v35, v12 offset:4864
    ds_read_b32 v36, v12 offset:5120
    ds_read_b32 v37, v12 offset:5376
    ds_read_b32 v38, v12 offset:5632
    ds_read_b32 v39, v12 offset:5888
    ds_read_b32 v40, v12 offset:6144
    ds_read_b32 v41, v12 offset:6400
    ds_read_b32 v42, v12 offset:6656
    ds_read_b32 v43, v12 offset:6912
    ds_read_b32 v44, v12 offset:7168
    ds_read_b32 v45, v12 offset:7424
    ds_read_b32 v46, v12 offset:7680
    ds_read_b32 v47, v12 offset:7936
    s_waitcnt lgkmcnt(0)
    v_add_f32 v18, v18, v32
    v_add_f32 v18, v18, v33
    v_add_f32 v18, v18, v34
    v_add_f32 v18, v18, v35
    v_add_f32 v18, v18, v36
    v_add_f32 v18, v18, v37
    v_add_f32 v18, v18, v38
    v_add_f32 v18, v18, v39
    v_add_f32 v18, v18, v40
    v_add_f32 v18, v18, v41
    v_add_f32 v18, v18, v42
    v_add_f32 v18, v18, v43
    v_add_f32 v18, v18, v44
    v_add_f32 v18, v18, v45
    v_add_f32 v18, v18, v46
    v_add_f32 v18, v18, v47
    s_lshr_b32 s45, s39, 1
    s_lshl_b32 s45, s45, 8
    s_mul_i32 s46, s47, 24576
    s_add_u32 s45, s45, s46
    buffer_store_dword v18, v12, s[12:15], s45 offen sc1
L_mod_fin_105:
    s_waitcnt vmcnt(0)
    s_barrier
    s_cmp_lg_u32 s44, 0
    s_cbranch_scc1 L_cnt_106
    v_mov_b32 v30, 1
    v_mov_b32 v31, 0
    s_mov_b64 exec, 1
    buffer_atomic_add v30, v31, s[16:19], 0 offen offset:128 sc1
    s_mov_b64 exec, -1
L_cnt_106:
    v_lshlrev_b32 v192, 16, v128
    v_and_b32 v193, 0xffff0000, v128
    v_lshlrev_b32 v194, 16, v129
    v_and_b32 v195, 0xffff0000, v129
    v_lshlrev_b32 v196, 16, v130
    v_and_b32 v197, 0xffff0000, v130
    v_lshlrev_b32 v198, 16, v131
    v_and_b32 v199, 0xffff0000, v131
    v_lshlrev_b32 v200, 16, v132
    v_and_b32 v201, 0xffff0000, v132
    v_lshlrev_b32 v202, 16, v133
    v_and_b32 v203, 0xffff0000, v133
    v_lshlrev_b32 v204, 16, v134
    v_and_b32 v205, 0xffff0000, v134
    v_lshlrev_b32 v206, 16, v135
    v_and_b32 v207, 0xffff0000, v135
    v_add_f32 v26, v192, v193
    v_add_f32 v26, v26, v194
    v_add_f32 v26, v26, v195
    v_add_f32 v26, v26, v196
    v_add_f32 v26, v26, v197
    v_add_f32 v26, v26, v198
    v_add_f32 v26, v26, v199
    v_add_f32 v26, v26, v200
    v_add_f32 v26, v26, v201
    v_add_f32 v26, v26, v202
    v_add_f32 v26, v26, v203
    v_add_f32 v26, v26, v204
    v_add_f32 v26, v26, v205
    v_add_f32 v26, v26, v206
    v_add_f32 v26, v26, v207
    s_nop 1
    v_add_f32_dpp v26, v26, v26 row_shr:1 row_mask:0xf bank_mask:0xf bound_ctrl:0
    s_nop 1
    v_add_f32_dpp v26, v26, v26 row_shr:2 row_mask:0xf bank_mask:0xf bound_ctrl:0
    s_nop 1
    v_add_f32_dpp v26, v26, v26 row_shr:4 row_mask:0xf bank_mask:0xf bound_ctrl:0
    s_nop 1
    v_add_f32_dpp v26, v26, v26 row_shr:8 row_mask:0xf bank_mask:0xf bound_ctrl:0
    s_nop 1
    v_add_f32_dpp v26, v26, v26 row_bcast:15 row_mask:0xa bank_mask:0xf
    s_nop 1
    v_add_f32_dpp v26, v26, v26 row_bcast:31 row_mask:0xc bank_mask:0xf
    s_nop 1
    v_readlane_b32 s66, v26, 63
    s_nop 1
    v_mov_b32 v27, s66
    v_mul_f32 v27, 0x3a800000, v27
    v_mov_b32 v26, 0
    v_sub_f32 v28, v192, v27
    v_fmac_f32 v26, v28, v28
    v_sub_f32 v28, v193, v27
    v_fmac_f32 v26, v28, v28
    v_sub_f32 v28, v194, v27
    v_fmac_f32 v26, v28, v28
    v_sub_f32 v28, v195, v27
    v_fmac_f32 v26, v28, v28
    v_sub_f32 v28, v196, v27
    v_fmac_f32 v26, v28, v28
    v_sub_f32 v28, v197, v27
    v_fmac_f32 v26, v28, v28
    v_sub_f32 v28, v198, v27
    v_fmac_f32 v26, v28, v28
    v_sub_f32 v28, v199, v27
    v_fmac_f32 v26, v28, v28
    v_sub_f32 v28, v200, v27
    v_fmac_f32 v26, v28, v28
    v_sub_f32 v28, v201, v27
    v_fmac_f32 v26, v28, v28
    v_sub_f32 v28, v202, v27
    v_fmac_f32 v26, v28, v28
    v_sub_f32 v28, v203, v27
    v_fmac_f32 v26, v28, v28
    v_sub_f32 v28, v204, v27
    v_fmac_f32 v26, v28, v28
    v_sub_f32 v28, v205, v27
    v_fmac_f32 v26, v28, v28
    v_sub_f32 v28, v206, v27
    v_fmac_f32 v26, v28, v28
    v_sub_f32 v28, v207, v27
    v_fmac_f32 v26, v28, v28
    s_nop 1
    v_add_f32_dpp v26, v26, v26 row_shr:1 row_mask:0xf bank_mask:0xf bound_ctrl:0
    s_nop 1
    v_add_f32_dpp v26, v26, v26 row_shr:2 row_mask:0xf bank_mask:0xf bound_ctrl:0
    s_nop 1
    v_add_f32_dpp v26, v26, v26 row_shr:4 row_mask:0xf bank_mask:0xf bound_ctrl:0
    s_nop 1
    v_add_f32_dpp v26, v26, v26 row_shr:8 row_mask:0xf bank_mask:0xf bound_ctrl:0
    s_nop 1
    v_add_f32_dpp v26, v26, v26 row_bcast:15 row_mask:0xa bank_mask:0xf
    s_nop 1
    v_add_f32_dpp v26, v26, v26 row_bcast:31 row_mask:0xc bank_mask:0xf
    s_nop 1
    v_readlane_b32 s66, v26, 63
    s_nop 1
    v_mov_b32 v26, s66
    v_mul_f32 v26, 0x3a800000, v26
    v_cvt_pk_bf16_f32 v26, v26, v26
    v_lshlrev_b32 v26, 16, v26
    v_cvt_pk_bf16_f32 v27, v27, v27
    v_lshlrev_b32 v27, 16, v27
    v_add_f32 v26, 0x3727c5ac, v26
    v_cvt_pk_bf16_f32 v26, v26, v26
    v_lshlrev_b32 v26, 16, v26
    v_sqrt_f32 v26, v26
    s_nop 0
    v_cvt_pk_bf16_f32 v26, v26, v26
    v_lshlrev_b32 v26, 16, v26
    v_rcp_f32 v26, v26
    s_nop 0
    v_sub_f32 v192, v192, v27
    v_cvt_pk_bf16_f32 v192, v192, v192
    v_lshlrev_b32 v192, 16, v192
    v_mul_f32 v192, v192, v26
    v_cvt_pk_bf16_f32 v192, v192, v192
    v_lshlrev_b32 v192, 16, v192
    v_sub_f32 v193, v193, v27
    v_cvt_pk_bf16_f32 v193, v193, v193
    v_lshlrev_b32 v193, 16, v193
    v_mul_f32 v193, v193, v26
    v_cvt_pk_bf16_f32 v193, v193, v193
    v_lshlrev_b32 v193, 16, v193
    v_sub_f32 v194, v194, v27
    v_cvt_pk_bf16_f32 v194, v194, v194
    v_lshlrev_b32 v194, 16, v194
    v_mul_f32 v194, v194, v26
    v_cvt_pk_bf16_f32 v194, v194, v194
    v_lshlrev_b32 v194, 16, v194
    v_sub_f32 v195, v195, v27
    v_cvt_pk_bf16_f32 v195, v195, v195
    v_lshlrev_b32 v195, 16, v195
    v_mul_f32 v195, v195, v26
    v_cvt_pk_bf16_f32 v195, v195, v195
    v_lshlrev_b32 v195, 16, v195
    v_sub_f32 v196, v196, v27
    v_cvt_pk_bf16_f32 v196, v196, v196
    v_lshlrev_b32 v196, 16, v196
    v_mul_f32 v196, v196, v26
    v_cvt_pk_bf16_f32 v196, v196, v196
    v_lshlrev_b32 v196, 16, v196
    v_sub_f32 v197, v197, v27
    v_cvt_pk_bf16_f32 v197, v197, v197
    v_lshlrev_b32 v197, 16, v197
    v_mul_f32 v197, v197, v26
    v_cvt_pk_bf16_f32 v197, v197, v197
    v_lshlrev_b32 v197, 16, v197
    v_sub_f32 v198, v198, v27
    v_cvt_pk_bf16_f32 v198, v198, v198
    v_lshlrev_b32 v198, 16, v198
    v_mul_f32 v198, v198, v26
    v_cvt_pk_bf16_f32 v198, v198, v198
    v_lshlrev_b32 v198, 16, v198
    v_sub_f32 v199, v199, v27
    v_cvt_pk_bf16_f32 v199, v199, v199
    v_lshlrev_b32 v199, 16, v199
    v_mul_f32 v199, v199, v26
    v_cvt_pk_bf16_f32 v199, v199, v199
    v_lshlrev_b32 v199, 16, v199
    v_sub_f32 v200, v200, v27
    v_cvt_pk_bf16_f32 v200, v200, v200
    v_lshlrev_b32 v200, 16, v200
    v_mul_f32 v200, v200, v26
    v_cvt_pk_bf16_f32 v200, v200, v200
    v_lshlrev_b32 v200, 16, v200
    v_sub_f32 v201, v201, v27
    v_cvt_pk_bf16_f32 v201, v201, v201
    v_lshlrev_b32 v201, 16, v201
    v_mul_f32 v201, v201, v26
    v_cvt_pk_bf16_f32 v201, v201, v201
    v_lshlrev_b32 v201, 16, v201
    v_sub_f32 v202, v202, v27
    v_cvt_pk_bf16_f32 v202, v202, v202
    v_lshlrev_b32 v202, 16, v202
    v_mul_f32 v202, v202, v26
    v_cvt_pk_bf16_f32 v202, v202, v202
    v_lshlrev_b32 v202, 16, v202
    v_sub_f32 v203, v203, v27
    v_cvt_pk_bf16_f32 v203, v203, v203
    v_lshlrev_b32 v203, 16, v203
    v_mul_f32 v203, v203, v26
    v_cvt_pk_bf16_f32 v203, v203, v203
    v_lshlrev_b32 v203, 16, v203
    v_sub_f32 v204, v204, v27
    v_cvt_pk_bf16_f32 v204, v204, v204
    v_lshlrev_b32 v204, 16, v204
    v_mul_f32 v204, v204, v26
    v_cvt_pk_bf16_f32 v204, v204, v204
    v_lshlrev_b32 v204, 16, v204
    v_sub_f32 v205, v205, v27
    v_cvt_pk_bf16_f32 v205, v205, v205
    v_lshlrev_b32 v205, 16, v205
    v_mul_f32 v205, v205, v26
    v_cvt_pk_bf16_f32 v205, v205, v205
    v_lshlrev_b32 v205, 16, v205
    v_sub_f32 v206, v206, v27
    v_cvt_pk_bf16_f32 v206, v206, v206
    v_lshlrev_b32 v206, 16, v206
    v_mul_f32 v206, v206, v26
    v_cvt_pk_bf16_f32 v206, v206, v206
    v_lshlrev_b32 v206, 16, v206
    v_sub_f32 v207, v207, v27
    v_cvt_pk_bf16_f32 v207, v207, v207
    v_lshlrev_b32 v207, 16, v207
    v_mul_f32 v207, v207, v26
    v_cvt_pk_bf16_f32 v207, v207, v207
    v_lshlrev_b32 v207, 16, v207
    v_lshlrev_b32 v208, 16, v136
    v_and_b32 v209, 0xffff0000, v136
    v_lshlrev_b32 v210, 16, v137
    v_and_b32 v211, 0xffff0000, v137
    v_lshlrev_b32 v212, 16, v138
    v_and_b32 v213, 0xffff0000, v138
    v_lshlrev_b32 v214, 16, v139
    v_and_b32 v215, 0xffff0000, v139
    v_lshlrev_b32 v216, 16, v140
    v_and_b32 v217, 0xffff0000, v140
    v_lshlrev_b32 v218, 16, v141
    v_and_b32 v219, 0xffff0000, v141
    v_lshlrev_b32 v220, 16, v142
    v_and_b32 v221, 0xffff0000, v142
    v_lshlrev_b32 v222, 16, v143
    v_and_b32 v223, 0xffff0000, v143
    v_add_f32 v26, v208, v209
    v_add_f32 v26, v26, v210
    v_add_f32 v26, v26, v211
    v_add_f32 v26, v26, v212
    v_add_f32 v26, v26, v213
    v_add_f32 v26, v26, v214
    v_add_f32 v26, v26, v215
    v_add_f32 v26, v26, v216
    v_add_f32 v26, v26, v217
    v_add_f32 v26, v26, v218
    v_add_f32 v26, v26, v219
    v_add_f32 v26, v26, v220
    v_add_f32 v26, v26, v221
    v_add_f32 v26, v26, v222
    v_add_f32 v26, v26, v223
    s_nop 1
    v_add_f32_dpp v26, v26, v26 row_shr:1 row_mask:0xf bank_mask:0xf bound_ctrl:0
    s_nop 1
    v_add_f32_dpp v26, v26, v26 row_shr:2 row_mask:0xf bank_mask:0xf bound_ctrl:0
    s_nop 1
    v_add_f32_dpp v26, v26, v26 row_shr:4 row_mask:0xf bank_mask:0xf bound_ctrl:0
    s_nop 1
    v_add_f32_dpp v26, v26, v26 row_shr:8 row_mask:0xf bank_mask:0xf bound_ctrl:0
    s_nop 1
    v_add_f32_dpp v26, v26, v26 row_bcast:15 row_mask:0xa bank_mask:0xf
    s_nop 1
    v_add_f32_dpp v26, v26, v26 row_bcast:31 row_mask:0xc bank_mask:0xf
    s_nop 1
    v_readlane_b32 s66, v26, 63
    s_nop 1
    v_mov_b32 v27, s66
    v_mul_f32 v27, 0x3a800000, v27
    v_mov_b32 v26, 0
    v_sub_f32 v28, v208, v27
    v_fmac_f32 v26, v28, v28
    v_sub_f32 v28, v209, v27
    v_fmac_f32 v26, v28, v28
    v_sub_f32 v28, v210, v27
    v_fmac_f32 v26, v28, v28
    v_sub_f32 v28, v211, v27
    v_fmac_f32 v26, v28, v28
    v_sub_f32 v28, v212, v27
    v_fmac_f32 v26, v28, v28
    v_sub_f32 v28, v213, v27
    v_fmac_f32 v26, v28, v28
    v_sub_f32 v28, v214, v27
    v_fmac_f32 v26, v28, v28
    v_sub_f32 v28, v215, v27
    v_fmac_f32 v26, v28, v28
    v_sub_f32 v28, v216, v27
    v_fmac_f32 v26, v28, v28
    v_sub_f32 v28, v217, v27
    v_fmac_f32 v26, v28, v28
    v_sub_f32 v28, v218, v27
    v_fmac_f32 v26, v28, v28
    v_sub_f32 v28, v219, v27
    v_fmac_f32 v26, v28, v28
    v_sub_f32 v28, v220, v27
    v_fmac_f32 v26, v28, v28
    v_sub_f32 v28, v221, v27
    v_fmac_f32 v26, v28, v28
    v_sub_f32 v28, v222, v27
    v_fmac_f32 v26, v28, v28
    v_sub_f32 v28, v223, v27
    v_fmac_f32 v26, v28, v28
    s_nop 1
    v_add_f32_dpp v26, v26, v26 row_shr:1 row_mask:0xf bank_mask:0xf bound_ctrl:0
    s_nop 1
    v_add_f32_dpp v26, v26, v26 row_shr:2 row_mask:0xf bank_mask:0xf bound_ctrl:0
    s_nop 1
    v_add_f32_dpp v26, v26, v26 row_shr:4 row_mask:0xf bank_mask:0xf bound_ctrl:0
    s_nop 1
    v_add_f32_dpp v26, v26, v26 row_shr:8 row_mask:0xf bank_mask:0xf bound_ctrl:0
    s_nop 1
    v_add_f32_dpp v26, v26, v26 row_bcast:15 row_mask:0xa bank_mask:0xf
    s_nop 1
    v_add_f32_dpp v26, v26, v26 row_bcast:31 row_mask:0xc bank_mask:0xf
    s_nop 1
    v_readlane_b32 s66, v26, 63
    s_nop 1
    v_mov_b32 v26, s66
    v_mul_f32 v26, 0x3a800000, v26
    v_cvt_pk_bf16_f32 v26, v26, v26
    v_lshlrev_b32 v26, 16, v26
    v_cvt_pk_bf16_f32 v27, v27, v27
    v_lshlrev_b32 v27, 16, v27
    v_add_f32 v26, 0x3727c5ac, v26
    v_cvt_pk_bf16_f32 v26, v26, v26
    v_lshlrev_b32 v26, 16, v26
    v_sqrt_f32 v26, v26
    s_nop 0
    v_cvt_pk_bf16_f32 v26, v26, v26
    v_lshlrev_b32 v26, 16, v26
    v_rcp_f32 v26, v26
    s_nop 0
    v_sub_f32 v208, v208, v27
    v_cvt_pk_bf16_f32 v208, v208, v208
    v_lshlrev_b32 v208, 16, v208
    v_mul_f32 v208, v208, v26
    v_cvt_pk_bf16_f32 v208, v208, v208
    v_lshlrev_b32 v208, 16, v208
    v_sub_f32 v209, v209, v27
    v_cvt_pk_bf16_f32 v209, v209, v209
    v_lshlrev_b32 v209, 16, v209
    v_mul_f32 v209, v209, v26
    v_cvt_pk_bf16_f32 v209, v209, v209
    v_lshlrev_b32 v209, 16, v209
    v_sub_f32 v210, v210, v27
    v_cvt_pk_bf16_f32 v210, v210, v210
    v_lshlrev_b32 v210, 16, v210
    v_mul_f32 v210, v210, v26
    v_cvt_pk_bf16_f32 v210, v210, v210
    v_lshlrev_b32 v210, 16, v210
    v_sub_f32 v211, v211, v27
    v_cvt_pk_bf16_f32 v211, v211, v211
    v_lshlrev_b32 v211, 16, v211
    v_mul_f32 v211, v211, v26
    v_cvt_pk_bf16_f32 v211, v211, v211
    v_lshlrev_b32 v211, 16, v211
    v_sub_f32 v212, v212, v27
    v_cvt_pk_bf16_f32 v212, v212, v212
    v_lshlrev_b32 v212, 16, v212
    v_mul_f32 v212, v212, v26
    v_cvt_pk_bf16_f32 v212, v212, v212
    v_lshlrev_b32 v212, 16, v212
    v_sub_f32 v213, v213, v27
    v_cvt_pk_bf16_f32 v213, v213, v213
    v_lshlrev_b32 v213, 16, v213
    v_mul_f32 v213, v213, v26
    v_cvt_pk_bf16_f32 v213, v213, v213
    v_lshlrev_b32 v213, 16, v213
    v_sub_f32 v214, v214, v27
    v_cvt_pk_bf16_f32 v214, v214, v214
    v_lshlrev_b32 v214, 16, v214
    v_mul_f32 v214, v214, v26
    v_cvt_pk_bf16_f32 v214, v214, v214
    v_lshlrev_b32 v214, 16, v214
    v_sub_f32 v215, v215, v27
    v_cvt_pk_bf16_f32 v215, v215, v215
    v_lshlrev_b32 v215, 16, v215
    v_mul_f32 v215, v215, v26
    v_cvt_pk_bf16_f32 v215, v215, v215
    v_lshlrev_b32 v215, 16, v215
    v_sub_f32 v216, v216, v27
    v_cvt_pk_bf16_f32 v216, v216, v216
    v_lshlrev_b32 v216, 16, v216
    v_mul_f32 v216, v216, v26
    v_cvt_pk_bf16_f32 v216, v216, v216
    v_lshlrev_b32 v216, 16, v216
    v_sub_f32 v217, v217, v27
    v_cvt_pk_bf16_f32 v217, v217, v217
    v_lshlrev_b32 v217, 16, v217
    v_mul_f32 v217, v217, v26
    v_cvt_pk_bf16_f32 v217, v217, v217
    v_lshlrev_b32 v217, 16, v217
    v_sub_f32 v218, v218, v27
    v_cvt_pk_bf16_f32 v218, v218, v218
    v_lshlrev_b32 v218, 16, v218
    v_mul_f32 v218, v218, v26
    v_cvt_pk_bf16_f32 v218, v218, v218
    v_lshlrev_b32 v218, 16, v218
    v_sub_f32 v219, v219, v27
    v_cvt_pk_bf16_f32 v219, v219, v219
    v_lshlrev_b32 v219, 16, v219
    v_mul_f32 v219, v219, v26
    v_cvt_pk_bf16_f32 v219, v219, v219
    v_lshlrev_b32 v219, 16, v219
    v_sub_f32 v220, v220, v27
    v_cvt_pk_bf16_f32 v220, v220, v220
    v_lshlrev_b32 v220, 16, v220
    v_mul_f32 v220, v220, v26
    v_cvt_pk_bf16_f32 v220, v220, v220
    v_lshlrev_b32 v220, 16, v220
    v_sub_f32 v221, v221, v27
    v_cvt_pk_bf16_f32 v221, v221, v221
    v_lshlrev_b32 v221, 16, v221
    v_mul_f32 v221, v221, v26
    v_cvt_pk_bf16_f32 v221, v221, v221
    v_lshlrev_b32 v221, 16, v221
    v_sub_f32 v222, v222, v27
    v_cvt_pk_bf16_f32 v222, v222, v222
    v_lshlrev_b32 v222, 16, v222
    v_mul_f32 v222, v222, v26
    v_cvt_pk_bf16_f32 v222, v222, v222
    v_lshlrev_b32 v222, 16, v222
    v_sub_f32 v223, v223, v27
    v_cvt_pk_bf16_f32 v223, v223, v223
    v_lshlrev_b32 v223, 16, v223
    v_mul_f32 v223, v223, v26
    v_cvt_pk_bf16_f32 v223, v223, v223
    v_lshlrev_b32 v223, 16, v223
    s_cmp_lg_u32 s44, 0
    s_cbranch_scc1 L_pd_107
    v_mov_b32 v29, 128
    s_mov_b32 s46, 96
    s_mov_b64 exec, 1
    s_mov_b32 s70, 0
L_wp_108:
    buffer_load_dword v31, v29, s[16:19], 0 offen sc1
    s_add_u32 s70, s70, 1
    s_cmp_ge_u32 s70, 0x200000
    s_cbranch_scc1 L_w_done_102
    s_waitcnt vmcnt(0)
    v_cmp_gt_u32 vcc, s46, v31
    s_nop 1
    s_cbranch_vccz L_wp_108_ok
    s_sleep 1
    s_branch L_wp_108
L_wp_108_ok:
    s_mov_b64 exec, -1
L_pd_107:
    s_barrier
    v_lshlrev_b32 v29, 5, v1
    s_mov_b32 s45, 0
    buffer_load_dwordx4 v[96:99], v29, s[12:15], s45 offen offset:0 sc1
    buffer_load_dwordx4 v[100:103], v29, s[12:15], s45 offen offset:16 sc1
    buffer_load_dwordx4 v[104:107], v29, s[12:15], s45 offen offset:2048 sc1
    buffer_load_dwordx4 v[108:111], v29, s[12:15], s45 offen offset:2064 sc1
    s_mov_b32 s45, 24576
    buffer_load_dwordx4 v[32:35], v29, s[12:15], s45 offen offset:0 sc1
    buffer_load_dwordx4 v[36:39], v29, s[12:15], s45 offen offset:16 sc1
    buffer_load_dwordx4 v[40:43], v29, s[12:15], s45 offen offset:2048 sc1
    buffer_load_dwordx4 v[44:47], v29, s[12:15], s45 offen offset:2064 sc1
    s_mov_b32 s45, 4096
    buffer_load_dwordx4 v[112:115], v29, s[12:15], s45 offen offset:0 sc1
    buffer_load_dwordx4 v[116:119], v29, s[12:15], s45 offen offset:16 sc1
    buffer_load_dwordx4 v[120:123], v29, s[12:15], s45 offen offset:2048 sc1
    buffer_load_dwordx4 v[124:127], v29, s[12:15], s45 offen offset:2064 sc1
    s_mov_b32 s45, 28672
    buffer_load_dwordx4 v[48:51], v29, s[12:15], s45 offen offset:0 sc1
    buffer_load_dwordx4 v[52:55], v29, s[12:15], s45 offen offset:16 sc1
    buffer_load_dwordx4 v[56:59], v29, s[12:15], s45 offen offset:2048 sc1
    buffer_load_dwordx4 v[60:63], v29, s[12:15], s45 offen offset:2064 sc1
    s_waitcnt vmcnt(0)
    v_add_f32 v96, v96, v32
    v_cvt_pk_bf16_f32 v96, v96, v96
    v_lshlrev_b32 v96, 16, v96
    v_add_f32 v97, v97, v33
    v_cvt_pk_bf16_f32 v97, v97, v97
    v_lshlrev_b32 v97, 16, v97
    v_add_f32 v98, v98, v34
    v_cvt_pk_bf16_f32 v98, v98, v98
    v_lshlrev_b32 v98, 16, v98
    v_add_f32 v99, v99, v35
    v_cvt_pk_bf16_f32 v99, v99, v99
    v_lshlrev_b32 v99, 16, v99
    v_add_f32 v100, v100, v36
    v_cvt_pk_bf16_f32 v100, v100, v100
    v_lshlrev_b32 v100, 16, v100
    v_add_f32 v101, v101, v37
    v_cvt_pk_bf16_f32 v101, v101, v101
    v_lshlrev_b32 v101, 16, v101
    v_add_f32 v102, v102, v38
    v_cvt_pk_bf16_f32 v102, v102, v102
    v_lshlrev_b32 v102, 16, v102
    v_add_f32 v103, v103, v39
    v_cvt_pk_bf16_f32 v103, v103, v103
    v_lshlrev_b32 v103, 16, v103
    v_add_f32 v104, v104, v40
    v_cvt_pk_bf16_f32 v104, v104, v104
    v_lshlrev_b32 v104, 16, v104
    v_add_f32 v105, v105, v41
    v_cvt_pk_bf16_f32 v105, v105, v105
    v_lshlrev_b32 v105, 16, v105
    v_add_f32 v106, v106, v42
    v_cvt_pk_bf16_f32 v106, v106, v106
    v_lshlrev_b32 v106, 16, v106
    v_add_f32 v107, v107, v43
    v_cvt_pk_bf16_f32 v107, v107, v107
    v_lshlrev_b32 v107, 16, v107
    v_add_f32 v108, v108, v44
    v_cvt_pk_bf16_f32 v108, v108, v108
    v_lshlrev_b32 v108, 16, v108
    v_add_f32 v109, v109, v45
    v_cvt_pk_bf16_f32 v109, v109, v109
    v_lshlrev_b32 v109, 16, v109
    v_add_f32 v110, v110, v46
    v_cvt_pk_bf16_f32 v110, v110, v110
    v_lshlrev_b32 v110, 16, v110
    v_add_f32 v111, v111, v47
    v_cvt_pk_bf16_f32 v111, v111, v111
    v_lshlrev_b32 v111, 16, v111
    v_add_f32 v112, v112, v48
    v_cvt_pk_bf16_f32 v112, v112, v112
    v_lshlrev_b32 v112, 16, v112
    v_add_f32 v112, 1.0, v112
    v_cvt_pk_bf16_f32 v112, v112, v112
    v_lshlrev_b32 v112, 16, v112
    v_add_f32 v113, v113, v49
    v_cvt_pk_bf16_f32 v113, v113, v113
    v_lshlrev_b32 v113, 16, v113
    v_add_f32 v113, 1.0, v113
    v_cvt_pk_bf16_f32 v113, v113, v113
    v_lshlrev_b32 v113, 16, v113
    v_add_f32 v114, v114, v50
    v_cvt_pk_bf16_f32 v114, v114, v114
    v_lshlrev_b32 v114, 16, v114
    v_add_f32 v114, 1.0, v114
    v_cvt_pk_bf16_f32 v114, v114, v114
    v_lshlrev_b32 v114, 16, v114
    v_add_f32 v115, v115, v51
    v_cvt_pk_bf16_f32 v115, v115, v115
    v_lshlrev_b32 v115, 16, v115
    v_add_f32 v115, 1.0, v115
    v_cvt_pk_bf16_f32 v115, v115, v115
    v_lshlrev_b32 v115, 16, v115
    v_add_f32 v116, v116, v52
    v_cvt_pk_bf16_f32 v116, v116, v116
    v_lshlrev_b32 v116, 16, v116
    v_add_f32 v116, 1.0, v116
    v_cvt_pk_bf16_f32 v116, v116, v116
    v_lshlrev_b32 v116, 16, v116
    v_add_f32 v117, v117, v53
    v_cvt_pk_bf16_f32 v117, v117, v117
    v_lshlrev_b32 v117, 16, v117
    v_add_f32 v117, 1.0, v117
    v_cvt_pk_bf16_f32 v117, v117, v117
    v_lshlrev_b32 v117, 16, v117
    v_add_f32 v118, v118, v54
    v_cvt_pk_bf16_f32 v118, v118, v118
    v_lshlrev_b32 v118, 16, v118
    v_add_f32 v118, 1.0, v118
    v_cvt_pk_bf16_f32 v118, v118, v118
    v_lshlrev_b32 v118, 16, v118
    v_add_f32 v119, v119, v55
    v_cvt_pk_bf16_f32 v119, v119, v119
    v_lshlrev_b32 v119, 16, v119
    v_add_f32 v119, 1.0, v119
    v_cvt_pk_bf16_f32 v119, v119, v119
    v_lshlrev_b32 v119, 16, v119
    v_add_f32 v120, v120, v56
    v_cvt_pk_bf16_f32 v120, v120, v120
    v_lshlrev_b32 v120, 16, v120
    v_add_f32 v120, 1.0, v120
    v_cvt_pk_bf16_f32 v120, v120, v120
    v_lshlrev_b32 v120, 16, v120
    v_add_f32 v121, v121, v57
    v_cvt_pk_bf16_f32 v121, v121, v121
    v_lshlrev_b32 v121, 16, v121
    v_add_f32 v121, 1.0, v121
    v_cvt_pk_bf16_f32 v121, v121, v121
    v_lshlrev_b32 v121, 16, v121
    v_add_f32 v122, v122, v58
    v_cvt_pk_bf16_f32 v122, v122, v122
    v_lshlrev_b32 v122, 16, v122
    v_add_f32 v122, 1.0, v122
    v_cvt_pk_bf16_f32 v122, v122, v122
    v_lshlrev_b32 v122, 16, v122
    v_add_f32 v123, v123, v59
    v_cvt_pk_bf16_f32 v123, v123, v123
    v_lshlrev_b32 v123, 16, v123
    v_add_f32 v123, 1.0, v123
    v_cvt_pk_bf16_f32 v123, v123, v123
    v_lshlrev_b32 v123, 16, v123
    v_add_f32 v124, v124, v60
    v_cvt_pk_bf16_f32 v124, v124, v124
    v_lshlrev_b32 v124, 16, v124
    v_add_f32 v124, 1.0, v124
    v_cvt_pk_bf16_f32 v124, v124, v124
    v_lshlrev_b32 v124, 16, v124
    v_add_f32 v125, v125, v61
    v_cvt_pk_bf16_f32 v125, v125, v125
    v_lshlrev_b32 v125, 16, v125
    v_add_f32 v125, 1.0, v125
    v_cvt_pk_bf16_f32 v125, v125, v125
    v_lshlrev_b32 v125, 16, v125
    v_add_f32 v126, v126, v62
    v_cvt_pk_bf16_f32 v126, v126, v126
    v_lshlrev_b32 v126, 16, v126
    v_add_f32 v126, 1.0, v126
    v_cvt_pk_bf16_f32 v126, v126, v126
    v_lshlrev_b32 v126, 16, v126
    v_add_f32 v127, v127, v63
    v_cvt_pk_bf16_f32 v127, v127, v127
    v_lshlrev_b32 v127, 16, v127
    v_add_f32 v127, 1.0, v127
    v_cvt_pk_bf16_f32 v127, v127, v127
    v_lshlrev_b32 v127, 16, v127
    v_mul_f32 v192, v192, v112
    v_cvt_pk_bf16_f32 v192, v192, v192
    v_lshlrev_b32 v192, 16, v192
    v_add_f32 v192, v192, v96
    v_mul_f32 v193, v193, v113
    v_cvt_pk_bf16_f32 v193, v193, v193
    v_lshlrev_b32 v193, 16, v193
    v_add_f32 v193, v193, v97
    v_mul_f32 v194, v194, v114
    v_cvt_pk_bf16_f32 v194, v194, v194
    v_lshlrev_b32 v194, 16, v194
    v_add_f32 v194, v194, v98
    v_mul_f32 v195, v195, v115
    v_cvt_pk_bf16_f32 v195, v195, v195
    v_lshlrev_b32 v195, 16, v195
    v_add_f32 v195, v195, v99
    v_mul_f32 v196, v196, v116
    v_cvt_pk_bf16_f32 v196, v196, v196
    v_lshlrev_b32 v196, 16, v196
    v_add_f32 v196, v196, v100
    v_mul_f32 v197, v197, v117
    v_cvt_pk_bf16_f32 v197, v197, v197
    v_lshlrev_b32 v197, 16, v197
    v_add_f32 v197, v197, v101
    v_mul_f32 v198, v198, v118
    v_cvt_pk_bf16_f32 v198, v198, v198
    v_lshlrev_b32 v198, 16, v198
    v_add_f32 v198, v198, v102
    v_mul_f32 v199, v199, v119
    v_cvt_pk_bf16_f32 v199, v199, v199
    v_lshlrev_b32 v199, 16, v199
    v_add_f32 v199, v199, v103
    v_mul_f32 v200, v200, v120
    v_cvt_pk_bf16_f32 v200, v200, v200
    v_lshlrev_b32 v200, 16, v200
    v_add_f32 v200, v200, v104
    v_mul_f32 v201, v201, v121
    v_cvt_pk_bf16_f32 v201, v201, v201
    v_lshlrev_b32 v201, 16, v201
    v_add_f32 v201, v201, v105
    v_mul_f32 v202, v202, v122
    v_cvt_pk_bf16_f32 v202, v202, v202
    v_lshlrev_b32 v202, 16, v202
    v_add_f32 v202, v202, v106
    v_mul_f32 v203, v203, v123
    v_cvt_pk_bf16_f32 v203, v203, v203
    v_lshlrev_b32 v203, 16, v203
    v_add_f32 v203, v203, v107
    v_mul_f32 v204, v204, v124
    v_cvt_pk_bf16_f32 v204, v204, v204
    v_lshlrev_b32 v204, 16, v204
    v_add_f32 v204, v204, v108
    v_mul_f32 v205, v205, v125
    v_cvt_pk_bf16_f32 v205, v205, v205
    v_lshlrev_b32 v205, 16, v205
    v_add_f32 v205, v205, v109
    v_mul_f32 v206, v206, v126
    v_cvt_pk_bf16_f32 v206, v206, v206
    v_lshlrev_b32 v206, 16, v206
    v_add_f32 v206, v206, v110
    v_mul_f32 v207, v207, v127
    v_cvt_pk_bf16_f32 v207, v207, v207
    v_lshlrev_b32 v207, 16, v207
    v_add_f32 v207, v207, v111
    v_cvt_pk_bf16_f32 v80, v192, v193
    v_cvt_pk_bf16_f32 v81, v194, v195
    v_cvt_pk_bf16_f32 v82, v196, v197
    v_cvt_pk_bf16_f32 v83, v198, v199
    v_cvt_pk_bf16_f32 v84, v200, v201
    v_cvt_pk_bf16_f32 v85, v202, v203
    v_cvt_pk_bf16_f32 v86, v204, v205
    v_cvt_pk_bf16_f32 v87, v206, v207
    s_lshr_b32 s45, s63, 5
    s_lshl_b32 s45, s45, 16
    s_and_b32 s46, s63, 31
    s_lshl_b32 s46, s46, 8
    s_add_u32 s45, s45, s46
    s_add_u32 s45, s45, 0x400000
    s_add_u32 s46, s45, 32768
    buffer_store_dwordx4 v[80:83], v2, s[12:15], s45 offen sc1
    buffer_store_dwordx4 v[84:87], v2, s[12:15], s46 offen sc1
    s_add_u32 s63, s63, 384
    v_mul_f32 v208, v208, v112
    v_cvt_pk_bf16_f32 v208, v208, v208
    v_lshlrev_b32 v208, 16, v208
    v_add_f32 v208, v208, v96
    v_mul_f32 v209, v209, v113
    v_cvt_pk_bf16_f32 v209, v209, v209
    v_lshlrev_b32 v209, 16, v209
    v_add_f32 v209, v209, v97
    v_mul_f32 v210, v210, v114
    v_cvt_pk_bf16_f32 v210, v210, v210
    v_lshlrev_b32 v210, 16, v210
    v_add_f32 v210, v210, v98
    v_mul_f32 v211, v211, v115
    v_cvt_pk_bf16_f32 v211, v211, v211
    v_lshlrev_b32 v211, 16, v211
    v_add_f32 v211, v211, v99
    v_mul_f32 v212, v212, v116
    v_cvt_pk_bf16_f32 v212, v212, v212
    v_lshlrev_b32 v212, 16, v212
    v_add_f32 v212, v212, v100
    v_mul_f32 v213, v213, v117
    v_cvt_pk_bf16_f32 v213, v213, v213
    v_lshlrev_b32 v213, 16, v213
    v_add_f32 v213, v213, v101
    v_mul_f32 v214, v214, v118
    v_cvt_pk_bf16_f32 v214, v214, v214
    v_lshlrev_b32 v214, 16, v214
    v_add_f32 v214, v214, v102
    v_mul_f32 v215, v215, v119
    v_cvt_pk_bf16_f32 v215, v215, v215
    v_lshlrev_b32 v215, 16, v215
    v_add_f32 v215, v215, v103
    v_mul_f32 v216, v216, v120
    v_cvt_pk_bf16_f32 v216, v216, v216
    v_lshlrev_b32 v216, 16, v216
    v_add_f32 v216, v216, v104
    v_mul_f32 v217, v217, v121
    v_cvt_pk_bf16_f32 v217, v217, v217
    v_lshlrev_b32 v217, 16, v217
    v_add_f32 v217, v217, v105
    v_mul_f32 v218, v218, v122
    v_cvt_pk_bf16_f32 v218, v218, v218
    v_lshlrev_b32 v218, 16, v218
    v_add_f32 v218, v218, v106
    v_mul_f32 v219, v219, v123
    v_cvt_pk_bf16_f32 v219, v219, v219
    v_lshlrev_b32 v219, 16, v219
    v_add_f32 v219, v219, v107
    v_mul_f32 v220, v220, v124
    v_cvt_pk_bf16_f32 v220, v220, v220
    v_lshlrev_b32 v220, 16, v220
    v_add_f32 v220, v220, v108
    v_mul_f32 v221, v221, v125
    v_cvt_pk_bf16_f32 v221, v221, v221
    v_lshlrev_b32 v221, 16, v221
    v_add_f32 v221, v221, v109
    v_mul_f32 v222, v222, v126
    v_cvt_pk_bf16_f32 v222, v222, v222
    v_lshlrev_b32 v222, 16, v222
    v_add_f32 v222, v222, v110
    v_mul_f32 v223, v223, v127
    v_cvt_pk_bf16_f32 v223, v223, v223
    v_lshlrev_b32 v223, 16, v223
    v_add_f32 v223, v223, v111
    v_cvt_pk_bf16_f32 v88, v208, v209
    v_cvt_pk_bf16_f32 v89, v210, v211
    v_cvt_pk_bf16_f32 v90, v212, v213
    v_cvt_pk_bf16_f32 v91, v214, v215
    v_cvt_pk_bf16_f32 v92, v216, v217
    v_cvt_pk_bf16_f32 v93, v218, v219
    v_cvt_pk_bf16_f32 v94, v220, v221
    v_cvt_pk_bf16_f32 v95, v222, v223
    s_lshr_b32 s45, s63, 5
    s_lshl_b32 s45, s45, 16
    s_and_b32 s46, s63, 31
    s_lshl_b32 s46, s46, 8
    s_add_u32 s45, s45, s46
    s_add_u32 s45, s45, 0x400000
    s_add_u32 s46, s45, 32768
    buffer_store_dwordx4 v[88:91], v2, s[12:15], s45 offen sc1
    buffer_store_dwordx4 v[92:95], v2, s[12:15], s46 offen sc1
    s_waitcnt vmcnt(2)
    s_barrier
    s_cmp_lg_u32 s44, 0
    s_cbranch_scc1 L_cnt_110
    v_mov_b32 v30, 1
    v_mov_b32 v31, 0
    s_mov_b64 exec, 1
    buffer_atomic_add v30, v31, s[16:19], 0 offen offset:64 sc1
    s_mov_b64 exec, -1
L_cnt_110:
    s_add_u32 s63, s63, 384
    v_lshlrev_b32 v64, 16, v144
    v_and_b32 v65, 0xffff0000, v144
    v_lshlrev_b32 v66, 16, v145
    v_and_b32 v67, 0xffff0000, v145
    v_lshlrev_b32 v68, 16, v146
    v_and_b32 v69, 0xffff0000, v146
    v_lshlrev_b32 v70, 16, v147
    v_and_b32 v71, 0xffff0000, v147
    v_lshlrev_b32 v72, 16, v148
    v_and_b32 v73, 0xffff0000, v148
    v_lshlrev_b32 v74, 16, v149
    v_and_b32 v75, 0xffff0000, v149
    v_lshlrev_b32 v76, 16, v150
    v_and_b32 v77, 0xffff0000, v150
    v_lshlrev_b32 v78, 16, v151
    v_and_b32 v79, 0xffff0000, v151
    v_add_f32 v26, v64, v65
    v_add_f32 v26, v26, v66
    v_add_f32 v26, v26, v67
    v_add_f32 v26, v26, v68
    v_add_f32 v26, v26, v69
    v_add_f32 v26, v26, v70
    v_add_f32 v26, v26, v71
    v_add_f32 v26, v26, v72
    v_add_f32 v26, v26, v73
    v_add_f32 v26, v26, v74
    v_add_f32 v26, v26, v75
    v_add_f32 v26, v26, v76
    v_add_f32 v26, v26, v77
    v_add_f32 v26, v26, v78
    v_add_f32 v26, v26, v79
    s_nop 1
    v_add_f32_dpp v26, v26, v26 row_shr:1 row_mask:0xf bank_mask:0xf bound_ctrl:0
    s_nop 1
    v_add_f32_dpp v26, v26, v26 row_shr:2 row_mask:0xf bank_mask:0xf bound_ctrl:0
    s_nop 1
    v_add_f32_dpp v26, v26, v26 row_shr:4 row_mask:0xf bank_mask:0xf bound_ctrl:0
    s_nop 1
    v_add_f32_dpp v26, v26, v26 row_shr:8 row_mask:0xf bank_mask:0xf bound_ctrl:0
    s_nop 1
    v_add_f32_dpp v26, v26, v26 row_bcast:15 row_mask:0xa bank_mask:0xf
    s_nop 1
    v_add_f32_dpp v26, v26, v26 row_bcast:31 row_mask:0xc bank_mask:0xf
    s_nop 1
    v_readlane_b32 s66, v26, 63
    s_nop 1
    v_mov_b32 v27, s66
    v_mul_f32 v27, 0x3a800000, v27
    v_mov_b32 v26, 0
    v_sub_f32 v28, v64, v27
    v_fmac_f32 v26, v28, v28
    v_sub_f32 v28, v65, v27
    v_fmac_f32 v26, v28, v28
    v_sub_f32 v28, v66, v27
    v_fmac_f32 v26, v28, v28
    v_sub_f32 v28, v67, v27
    v_fmac_f32 v26, v28, v28
    v_sub_f32 v28, v68, v27
    v_fmac_f32 v26, v28, v28
    v_sub_f32 v28, v69, v27
    v_fmac_f32 v26, v28, v28
    v_sub_f32 v28, v70, v27
    v_fmac_f32 v26, v28, v28
    v_sub_f32 v28, v71, v27
    v_fmac_f32 v26, v28, v28
    v_sub_f32 v28, v72, v27
    v_fmac_f32 v26, v28, v28
    v_sub_f32 v28, v73, v27
    v_fmac_f32 v26, v28, v28
    v_sub_f32 v28, v74, v27
    v_fmac_f32 v26, v28, v28
    v_sub_f32 v28, v75, v27
    v_fmac_f32 v26, v28, v28
    v_sub_f32 v28, v76, v27
    v_fmac_f32 v26, v28, v28
    v_sub_f32 v28, v77, v27
    v_fmac_f32 v26, v28, v28
    v_sub_f32 v28, v78, v27
    v_fmac_f32 v26, v28, v28
    v_sub_f32 v28, v79, v27
    v_fmac_f32 v26, v28, v28
    s_nop 1
    v_add_f32_dpp v26, v26, v26 row_shr:1 row_mask:0xf bank_mask:0xf bound_ctrl:0
    s_nop 1
    v_add_f32_dpp v26, v26, v26 row_shr:2 row_mask:0xf bank_mask:0xf bound_ctrl:0
    s_nop 1
    v_add_f32_dpp v26, v26, v26 row_shr:4 row_mask:0xf bank_mask:0xf bound_ctrl:0
    s_nop 1
    v_add_f32_dpp v26, v26, v26 row_shr:8 row_mask:0xf bank_mask:0xf bound_ctrl:0
    s_nop 1
    v_add_f32_dpp v26, v26, v26 row_bcast:15 row_mask:0xa bank_mask:0xf
    s_nop 1
    v_add_f32_dpp v26, v26, v26 row_bcast:31 row_mask:0xc bank_mask:0xf
    s_nop 1
    v_readlane_b32 s66, v26, 63
    s_nop 1
    v_mov_b32 v26, s66
    v_mul_f32 v26, 0x3a800000, v26
    v_cvt_pk_bf16_f32 v26, v26, v26
    v_lshlrev_b32 v26, 16, v26
    v_cvt_pk_bf16_f32 v27, v27, v27
    v_lshlrev_b32 v27, 16, v27
    v_add_f32 v26, 0x3727c5ac, v26
    v_cvt_pk_bf16_f32 v26, v26, v26
    v_lshlrev_b32 v26, 16, v26
    v_sqrt_f32 v26, v26
    s_nop 0
    v_cvt_pk_bf16_f32 v26, v26, v26
    v_lshlrev_b32 v26, 16, v26
    v_rcp_f32 v26, v26
    s_nop 0
    v_sub_f32 v64, v64, v27
    v_cvt_pk_bf16_f32 v64, v64, v64
    v_lshlrev_b32 v64, 16, v64
    v_mul_f32 v64, v64, v26
    v_cvt_pk_bf16_f32 v64, v64, v64
    v_lshlrev_b32 v64, 16, v64
    v_sub_f32 v65, v65, v27
    v_cvt_pk_bf16_f32 v65, v65, v65
    v_lshlrev_b32 v65, 16, v65
    v_mul_f32 v65, v65, v26
    v_cvt_pk_bf16_f32 v65, v65, v65
    v_lshlrev_b32 v65, 16, v65
    v_sub_f32 v66, v66, v27
    v_cvt_pk_bf16_f32 v66, v66, v66
    v_lshlrev_b32 v66, 16, v66
    v_mul_f32 v66, v66, v26
    v_cvt_pk_bf16_f32 v66, v66, v66
    v_lshlrev_b32 v66, 16, v66
    v_sub_f32 v67, v67, v27
    v_cvt_pk_bf16_f32 v67, v67, v67
    v_lshlrev_b32 v67, 16, v67
    v_mul_f32 v67, v67, v26
    v_cvt_pk_bf16_f32 v67, v67, v67
    v_lshlrev_b32 v67, 16, v67
    v_sub_f32 v68, v68, v27
    v_cvt_pk_bf16_f32 v68, v68, v68
    v_lshlrev_b32 v68, 16, v68
    v_mul_f32 v68, v68, v26
    v_cvt_pk_bf16_f32 v68, v68, v68
    v_lshlrev_b32 v68, 16, v68
    v_sub_f32 v69, v69, v27
    v_cvt_pk_bf16_f32 v69, v69, v69
    v_lshlrev_b32 v69, 16, v69
    v_mul_f32 v69, v69, v26
    v_cvt_pk_bf16_f32 v69, v69, v69
    v_lshlrev_b32 v69, 16, v69
    v_sub_f32 v70, v70, v27
    v_cvt_pk_bf16_f32 v70, v70, v70
    v_lshlrev_b32 v70, 16, v70
    v_mul_f32 v70, v70, v26
    v_cvt_pk_bf16_f32 v70, v70, v70
    v_lshlrev_b32 v70, 16, v70
    v_sub_f32 v71, v71, v27
    v_cvt_pk_bf16_f32 v71, v71, v71
    v_lshlrev_b32 v71, 16, v71
    v_mul_f32 v71, v71, v26
    v_cvt_pk_bf16_f32 v71, v71, v71
    v_lshlrev_b32 v71, 16, v71
    v_sub_f32 v72, v72, v27
    v_cvt_pk_bf16_f32 v72, v72, v72
    v_lshlrev_b32 v72, 16, v72
    v_mul_f32 v72, v72, v26
    v_cvt_pk_bf16_f32 v72, v72, v72
    v_lshlrev_b32 v72, 16, v72
    v_sub_f32 v73, v73, v27
    v_cvt_pk_bf16_f32 v73, v73, v73
    v_lshlrev_b32 v73, 16, v73
    v_mul_f32 v73, v73, v26
    v_cvt_pk_bf16_f32 v73, v73, v73
    v_lshlrev_b32 v73, 16, v73
    v_sub_f32 v74, v74, v27
    v_cvt_pk_bf16_f32 v74, v74, v74
    v_lshlrev_b32 v74, 16, v74
    v_mul_f32 v74, v74, v26
    v_cvt_pk_bf16_f32 v74, v74, v74
    v_lshlrev_b32 v74, 16, v74
    v_sub_f32 v75, v75, v27
    v_cvt_pk_bf16_f32 v75, v75, v75
    v_lshlrev_b32 v75, 16, v75
    v_mul_f32 v75, v75, v26
    v_cvt_pk_bf16_f32 v75, v75, v75
    v_lshlrev_b32 v75, 16, v75
    v_sub_f32 v76, v76, v27
    v_cvt_pk_bf16_f32 v76, v76, v76
    v_lshlrev_b32 v76, 16, v76
    v_mul_f32 v76, v76, v26
    v_cvt_pk_bf16_f32 v76, v76, v76
    v_lshlrev_b32 v76, 16, v76
    v_sub_f32 v77, v77, v27
    v_cvt_pk_bf16_f32 v77, v77, v77
    v_lshlrev_b32 v77, 16, v77
    v_mul_f32 v77, v77, v26
    v_cvt_pk_bf16_f32 v77, v77, v77
    v_lshlrev_b32 v77, 16, v77
    v_sub_f32 v78, v78, v27
    v_cvt_pk_bf16_f32 v78, v78, v78
    v_lshlrev_b32 v78, 16, v78
    v_mul_f32 v78, v78, v26
    v_cvt_pk_bf16_f32 v78, v78, v78
    v_lshlrev_b32 v78, 16, v78
    v_sub_f32 v79, v79, v27
    v_cvt_pk_bf16_f32 v79, v79, v79
    v_lshlrev_b32 v79, 16, v79
    v_mul_f32 v79, v79, v26
    v_cvt_pk_bf16_f32 v79, v79, v79
    v_lshlrev_b32 v79, 16, v79
    v_mul_f32 v64, v64, v112
    v_cvt_pk_bf16_f32 v64, v64, v64
    v_lshlrev_b32 v64, 16, v64
    v_add_f32 v64, v64, v96
    v_mul_f32 v65, v65, v113
    v_cvt_pk_bf16_f32 v65, v65, v65
    v_lshlrev_b32 v65, 16, v65
    v_add_f32 v65, v65, v97
    v_mul_f32 v66, v66, v114
    v_cvt_pk_bf16_f32 v66, v66, v66
    v_lshlrev_b32 v66, 16, v66
    v_add_f32 v66, v66, v98
    v_mul_f32 v67, v67, v115
    v_cvt_pk_bf16_f32 v67, v67, v67
    v_lshlrev_b32 v67, 16, v67
    v_add_f32 v67, v67, v99
    v_mul_f32 v68, v68, v116
    v_cvt_pk_bf16_f32 v68, v68, v68
    v_lshlrev_b32 v68, 16, v68
    v_add_f32 v68, v68, v100
    v_mul_f32 v69, v69, v117
    v_cvt_pk_bf16_f32 v69, v69, v69
    v_lshlrev_b32 v69, 16, v69
    v_add_f32 v69, v69, v101
    v_mul_f32 v70, v70, v118
    v_cvt_pk_bf16_f32 v70, v70, v70
    v_lshlrev_b32 v70, 16, v70
    v_add_f32 v70, v70, v102
    v_mul_f32 v71, v71, v119
    v_cvt_pk_bf16_f32 v71, v71, v71
    v_lshlrev_b32 v71, 16, v71
    v_add_f32 v71, v71, v103
    v_mul_f32 v72, v72, v120
    v_cvt_pk_bf16_f32 v72, v72, v72
    v_lshlrev_b32 v72, 16, v72
    v_add_f32 v72, v72, v104
    v_mul_f32 v73, v73, v121
    v_cvt_pk_bf16_f32 v73, v73, v73
    v_lshlrev_b32 v73, 16, v73
    v_add_f32 v73, v73, v105
    v_mul_f32 v74, v74, v122
    v_cvt_pk_bf16_f32 v74, v74, v74
    v_lshlrev_b32 v74, 16, v74
    v_add_f32 v74, v74, v106
    v_mul_f32 v75, v75, v123
    v_cvt_pk_bf16_f32 v75, v75, v75
    v_lshlrev_b32 v75, 16, v75
    v_add_f32 v75, v75, v107
    v_mul_f32 v76, v76, v124
    v_cvt_pk_bf16_f32 v76, v76, v76
    v_lshlrev_b32 v76, 16, v76
    v_add_f32 v76, v76, v108
    v_mul_f32 v77, v77, v125
    v_cvt_pk_bf16_f32 v77, v77, v77
    v_lshlrev_b32 v77, 16, v77
    v_add_f32 v77, v77, v109
    v_mul_f32 v78, v78, v126
    v_cvt_pk_bf16_f32 v78, v78, v78
    v_lshlrev_b32 v78, 16, v78
    v_add_f32 v78, v78, v110
    v_mul_f32 v79, v79, v127
    v_cvt_pk_bf16_f32 v79, v79, v79
    v_lshlrev_b32 v79, 16, v79
    v_add_f32 v79, v79, v111
    v_cvt_pk_bf16_f32 v80, v64, v65
    v_cvt_pk_bf16_f32 v81, v66, v67
    v_cvt_pk_bf16_f32 v82, v68, v69
    v_cvt_pk_bf16_f32 v83, v70, v71
    v_cvt_pk_bf16_f32 v84, v72, v73
    v_cvt_pk_bf16_f32 v85, v74, v75
    v_cvt_pk_bf16_f32 v86, v76, v77
    v_cvt_pk_bf16_f32 v87, v78, v79
    s_lshr_b32 s45, s63, 5
    s_lshl_b32 s45, s45, 16
    s_and_b32 s46, s63, 31
    s_lshl_b32 s46, s46, 8
    s_add_u32 s45, s45, s46
    s_add_u32 s45, s45, 0x400000
    s_add_u32 s46, s45, 32768
    buffer_store_dwordx4 v[80:83], v2, s[12:15], s45 offen sc1
    buffer_store_dwordx4 v[84:87], v2, s[12:15], s46 offen sc1
    s_add_u32 s63, s63, 384
    v_lshlrev_b32 v64, 16, v152
    v_and_b32 v65, 0xffff0000, v152
    v_lshlrev_b32 v66, 16, v153
    v_and_b32 v67, 0xffff0000, v153
    v_lshlrev_b32 v68, 16, v154
    v_and_b32 v69, 0xffff0000, v154
    v_lshlrev_b32 v70, 16, v155
    v_and_b32 v71, 0xffff0000, v155
    v_lshlrev_b32 v72, 16, v156
    v_and_b32 v73, 0xffff0000, v156
    v_lshlrev_b32 v74, 16, v157
    v_and_b32 v75, 0xffff0000, v157
    v_lshlrev_b32 v76, 16, v158
    v_and_b32 v77, 0xffff0000, v158
    v_lshlrev_b32 v78, 16, v159
    v_and_b32 v79, 0xffff0000, v159
    v_add_f32 v26, v64, v65
    v_add_f32 v26, v26, v66
    v_add_f32 v26, v26, v67
    v_add_f32 v26, v26, v68
    v_add_f32 v26, v26, v69
    v_add_f32 v26, v26, v70
    v_add_f32 v26, v26, v71
    v_add_f32 v26, v26, v72
    v_add_f32 v26, v26, v73
    v_add_f32 v26, v26, v74
    v_add_f32 v26, v26, v75
    v_add_f32 v26, v26, v76
    v_add_f32 v26, v26, v77
    v_add_f32 v26, v26, v78
    v_add_f32 v26, v26, v79
    s_nop 1
    v_add_f32_dpp v26, v26, v26 row_shr:1 row_mask:0xf bank_mask:0xf bound_ctrl:0
    s_nop 1
    v_add_f32_dpp v26, v26, v26 row_shr:2 row_mask:0xf bank_mask:0xf bound_ctrl:0
    s_nop 1
    v_add_f32_dpp v26, v26, v26 row_shr:4 row_mask:0xf bank_mask:0xf bound_ctrl:0
    s_nop 1
    v_add_f32_dpp v26, v26, v26 row_shr:8 row_mask:0xf bank_mask:0xf bound_ctrl:0
    s_nop 1
    v_add_f32_dpp v26, v26, v26 row_bcast:15 row_mask:0xa bank_mask:0xf
    s_nop 1
    v_add_f32_dpp v26, v26, v26 row_bcast:31 row_mask:0xc bank_mask:0xf
    s_nop 1
    v_readlane_b32 s66, v26, 63
    s_nop 1
    v_mov_b32 v27, s66
    v_mul_f32 v27, 0x3a800000, v27
    v_mov_b32 v26, 0
    v_sub_f32 v28, v64, v27
    v_fmac_f32 v26, v28, v28
    v_sub_f32 v28, v65, v27
    v_fmac_f32 v26, v28, v28
    v_sub_f32 v28, v66, v27
    v_fmac_f32 v26, v28, v28
    v_sub_f32 v28, v67, v27
    v_fmac_f32 v26, v28, v28
    v_sub_f32 v28, v68, v27
    v_fmac_f32 v26, v28, v28
    v_sub_f32 v28, v69, v27
    v_fmac_f32 v26, v28, v28
    v_sub_f32 v28, v70, v27
    v_fmac_f32 v26, v28, v28
    v_sub_f32 v28, v71, v27
    v_fmac_f32 v26, v28, v28
    v_sub_f32 v28, v72, v27
    v_fmac_f32 v26, v28, v28
    v_sub_f32 v28, v73, v27
    v_fmac_f32 v26, v28, v28
    v_sub_f32 v28, v74, v27
    v_fmac_f32 v26, v28, v28
    v_sub_f32 v28, v75, v27
    v_fmac_f32 v26, v28, v28
    v_sub_f32 v28, v76, v27
    v_fmac_f32 v26, v28, v28
    v_sub_f32 v28, v77, v27
    v_fmac_f32 v26, v28, v28
    v_sub_f32 v28, v78, v27
    v_fmac_f32 v26, v28, v28
    v_sub_f32 v28, v79, v27
    v_fmac_f32 v26, v28, v28
    s_nop 1
    v_add_f32_dpp v26, v26, v26 row_shr:1 row_mask:0xf bank_mask:0xf bound_ctrl:0
    s_nop 1
    v_add_f32_dpp v26, v26, v26 row_shr:2 row_mask:0xf bank_mask:0xf bound_ctrl:0
    s_nop 1
    v_add_f32_dpp v26, v26, v26 row_shr:4 row_mask:0xf bank_mask:0xf bound_ctrl:0
    s_nop 1
    v_add_f32_dpp v26, v26, v26 row_shr:8 row_mask:0xf bank_mask:0xf bound_ctrl:0
    s_nop 1
    v_add_f32_dpp v26, v26, v26 row_bcast:15 row_mask:0xa bank_mask:0xf
    s_nop 1
    v_add_f32_dpp v26, v26, v26 row_bcast:31 row_mask:0xc bank_mask:0xf
    s_nop 1
    v_readlane_b32 s66, v26, 63
    s_nop 1
    v_mov_b32 v26, s66
    v_mul_f32 v26, 0x3a800000, v26
    v_cvt_pk_bf16_f32 v26, v26, v26
    v_lshlrev_b32 v26, 16, v26
    v_cvt_pk_bf16_f32 v27, v27, v27
    v_lshlrev_b32 v27, 16, v27
    v_add_f32 v26, 0x3727c5ac, v26
    v_cvt_pk_bf16_f32 v26, v26, v26
    v_lshlrev_b32 v26, 16, v26
    v_sqrt_f32 v26, v26
    s_nop 0
    v_cvt_pk_bf16_f32 v26, v26, v26
    v_lshlrev_b32 v26, 16, v26
    v_rcp_f32 v26, v26
    s_nop 0
    v_sub_f32 v64, v64, v27
    v_cvt_pk_bf16_f32 v64, v64, v64
    v_lshlrev_b32 v64, 16, v64
    v_mul_f32 v64, v64, v26
    v_cvt_pk_bf16_f32 v64, v64, v64
    v_lshlrev_b32 v64, 16, v64
    v_sub_f32 v65, v65, v27
    v_cvt_pk_bf16_f32 v65, v65, v65
    v_lshlrev_b32 v65, 16, v65
    v_mul_f32 v65, v65, v26
    v_cvt_pk_bf16_f32 v65, v65, v65
    v_lshlrev_b32 v65, 16, v65
    v_sub_f32 v66, v66, v27
    v_cvt_pk_bf16_f32 v66, v66, v66
    v_lshlrev_b32 v66, 16, v66
    v_mul_f32 v66, v66, v26
    v_cvt_pk_bf16_f32 v66, v66, v66
    v_lshlrev_b32 v66, 16, v66
    v_sub_f32 v67, v67, v27
    v_cvt_pk_bf16_f32 v67, v67, v67
    v_lshlrev_b32 v67, 16, v67
    v_mul_f32 v67, v67, v26
    v_cvt_pk_bf16_f32 v67, v67, v67
    v_lshlrev_b32 v67, 16, v67
    v_sub_f32 v68, v68, v27
    v_cvt_pk_bf16_f32 v68, v68, v68
    v_lshlrev_b32 v68, 16, v68
    v_mul_f32 v68, v68, v26
    v_cvt_pk_bf16_f32 v68, v68, v68
    v_lshlrev_b32 v68, 16, v68
    v_sub_f32 v69, v69, v27
    v_cvt_pk_bf16_f32 v69, v69, v69
    v_lshlrev_b32 v69, 16, v69
    v_mul_f32 v69, v69, v26
    v_cvt_pk_bf16_f32 v69, v69, v69
    v_lshlrev_b32 v69, 16, v69
    v_sub_f32 v70, v70, v27
    v_cvt_pk_bf16_f32 v70, v70, v70
    v_lshlrev_b32 v70, 16, v70
    v_mul_f32 v70, v70, v26
    v_cvt_pk_bf16_f32 v70, v70, v70
    v_lshlrev_b32 v70, 16, v70
    v_sub_f32 v71, v71, v27
    v_cvt_pk_bf16_f32 v71, v71, v71
    v_lshlrev_b32 v71, 16, v71
    v_mul_f32 v71, v71, v26
    v_cvt_pk_bf16_f32 v71, v71, v71
    v_lshlrev_b32 v71, 16, v71
    v_sub_f32 v72, v72, v27
    v_cvt_pk_bf16_f32 v72, v72, v72
    v_lshlrev_b32 v72, 16, v72
    v_mul_f32 v72, v72, v26
    v_cvt_pk_bf16_f32 v72, v72, v72
    v_lshlrev_b32 v72, 16, v72
    v_sub_f32 v73, v73, v27
    v_cvt_pk_bf16_f32 v73, v73, v73
    v_lshlrev_b32 v73, 16, v73
    v_mul_f32 v73, v73, v26
    v_cvt_pk_bf16_f32 v73, v73, v73
    v_lshlrev_b32 v73, 16, v73
    v_sub_f32 v74, v74, v27
    v_cvt_pk_bf16_f32 v74, v74, v74
    v_lshlrev_b32 v74, 16, v74
    v_mul_f32 v74, v74, v26
    v_cvt_pk_bf16_f32 v74, v74, v74
    v_lshlrev_b32 v74, 16, v74
    v_sub_f32 v75, v75, v27
    v_cvt_pk_bf16_f32 v75, v75, v75
    v_lshlrev_b32 v75, 16, v75
    v_mul_f32 v75, v75, v26
    v_cvt_pk_bf16_f32 v75, v75, v75
    v_lshlrev_b32 v75, 16, v75
    v_sub_f32 v76, v76, v27
    v_cvt_pk_bf16_f32 v76, v76, v76
    v_lshlrev_b32 v76, 16, v76
    v_mul_f32 v76, v76, v26
    v_cvt_pk_bf16_f32 v76, v76, v76
    v_lshlrev_b32 v76, 16, v76
    v_sub_f32 v77, v77, v27
    v_cvt_pk_bf16_f32 v77, v77, v77
    v_lshlrev_b32 v77, 16, v77
    v_mul_f32 v77, v77, v26
    v_cvt_pk_bf16_f32 v77, v77, v77
    v_lshlrev_b32 v77, 16, v77
    v_sub_f32 v78, v78, v27
    v_cvt_pk_bf16_f32 v78, v78, v78
    v_lshlrev_b32 v78, 16, v78
    v_mul_f32 v78, v78, v26
    v_cvt_pk_bf16_f32 v78, v78, v78
    v_lshlrev_b32 v78, 16, v78
    v_sub_f32 v79, v79, v27
    v_cvt_pk_bf16_f32 v79, v79, v79
    v_lshlrev_b32 v79, 16, v79
    v_mul_f32 v79, v79, v26
    v_cvt_pk_bf16_f32 v79, v79, v79
    v_lshlrev_b32 v79, 16, v79
    v_mul_f32 v64, v64, v112
    v_cvt_pk_bf16_f32 v64, v64, v64
    v_lshlrev_b32 v64, 16, v64
    v_add_f32 v64, v64, v96
    v_mul_f32 v65, v65, v113
    v_cvt_pk_bf16_f32 v65, v65, v65
    v_lshlrev_b32 v65, 16, v65
    v_add_f32 v65, v65, v97
    v_mul_f32 v66, v66, v114
    v_cvt_pk_bf16_f32 v66, v66, v66
    v_lshlrev_b32 v66, 16, v66
    v_add_f32 v66, v66, v98
    v_mul_f32 v67, v67, v115
    v_cvt_pk_bf16_f32 v67, v67, v67
    v_lshlrev_b32 v67, 16, v67
    v_add_f32 v67, v67, v99
    v_mul_f32 v68, v68, v116
    v_cvt_pk_bf16_f32 v68, v68, v68
    v_lshlrev_b32 v68, 16, v68
    v_add_f32 v68, v68, v100
    v_mul_f32 v69, v69, v117
    v_cvt_pk_bf16_f32 v69, v69, v69
    v_lshlrev_b32 v69, 16, v69
    v_add_f32 v69, v69, v101
    v_mul_f32 v70, v70, v118
    v_cvt_pk_bf16_f32 v70, v70, v70
    v_lshlrev_b32 v70, 16, v70
    v_add_f32 v70, v70, v102
    v_mul_f32 v71, v71, v119
    v_cvt_pk_bf16_f32 v71, v71, v71
    v_lshlrev_b32 v71, 16, v71
    v_add_f32 v71, v71, v103
    v_mul_f32 v72, v72, v120
    v_cvt_pk_bf16_f32 v72, v72, v72
    v_lshlrev_b32 v72, 16, v72
    v_add_f32 v72, v72, v104
    v_mul_f32 v73, v73, v121
    v_cvt_pk_bf16_f32 v73, v73, v73
    v_lshlrev_b32 v73, 16, v73
    v_add_f32 v73, v73, v105
    v_mul_f32 v74, v74, v122
    v_cvt_pk_bf16_f32 v74, v74, v74
    v_lshlrev_b32 v74, 16, v74
    v_add_f32 v74, v74, v106
    v_mul_f32 v75, v75, v123
    v_cvt_pk_bf16_f32 v75, v75, v75
    v_lshlrev_b32 v75, 16, v75
    v_add_f32 v75, v75, v107
    v_mul_f32 v76, v76, v124
    v_cvt_pk_bf16_f32 v76, v76, v76
    v_lshlrev_b32 v76, 16, v76
    v_add_f32 v76, v76, v108
    v_mul_f32 v77, v77, v125
    v_cvt_pk_bf16_f32 v77, v77, v77
    v_lshlrev_b32 v77, 16, v77
    v_add_f32 v77, v77, v109
    v_mul_f32 v78, v78, v126
    v_cvt_pk_bf16_f32 v78, v78, v78
    v_lshlrev_b32 v78, 16, v78
    v_add_f32 v78, v78, v110
    v_mul_f32 v79, v79, v127
    v_cvt_pk_bf16_f32 v79, v79, v79
    v_lshlrev_b32 v79, 16, v79
    v_add_f32 v79, v79, v111
    v_cvt_pk_bf16_f32 v80, v64, v65
    v_cvt_pk_bf16_f32 v81, v66, v67
    v_cvt_pk_bf16_f32 v82, v68, v69
    v_cvt_pk_bf16_f32 v83, v70, v71
    v_cvt_pk_bf16_f32 v84, v72, v73
    v_cvt_pk_bf16_f32 v85, v74, v75
    v_cvt_pk_bf16_f32 v86, v76, v77
    v_cvt_pk_bf16_f32 v87, v78, v79
    s_lshr_b32 s45, s63, 5
    s_lshl_b32 s45, s45, 16
    s_and_b32 s46, s63, 31
    s_lshl_b32 s46, s46, 8
    s_add_u32 s45, s45, s46
    s_add_u32 s45, s45, 0x400000
    s_add_u32 s46, s45, 32768
    buffer_store_dwordx4 v[80:83], v2, s[12:15], s45 offen sc1
    buffer_store_dwordx4 v[84:87], v2, s[12:15], s46 offen sc1
    s_add_u32 s63, s63, 384
    v_lshlrev_b32 v64, 16, v160
    v_and_b32 v65, 0xffff0000, v160
    v_lshlrev_b32 v66, 16, v161
    v_and_b32 v67, 0xffff0000, v161
    v_lshlrev_b32 v68, 16, v162
    v_and_b32 v69, 0xffff0000, v162
    v_lshlrev_b32 v70, 16, v163
    v_and_b32 v71, 0xffff0000, v163
    v_lshlrev_b32 v72, 16, v164
    v_and_b32 v73, 0xffff0000, v164
    v_lshlrev_b32 v74, 16, v165
    v_and_b32 v75, 0xffff0000, v165
    v_lshlrev_b32 v76, 16, v166
    v_and_b32 v77, 0xffff0000, v166
    v_lshlrev_b32 v78, 16, v167
    v_and_b32 v79, 0xffff0000, v167
    v_add_f32 v26, v64, v65
    v_add_f32 v26, v26, v66
    v_add_f32 v26, v26, v67
    v_add_f32 v26, v26, v68
    v_add_f32 v26, v26, v69
    v_add_f32 v26, v26, v70
    v_add_f32 v26, v26, v71
    v_add_f32 v26, v26, v72
    v_add_f32 v26, v26, v73
    v_add_f32 v26, v26, v74
    v_add_f32 v26, v26, v75
    v_add_f32 v26, v26, v76
    v_add_f32 v26, v26, v77
    v_add_f32 v26, v26, v78
    v_add_f32 v26, v26, v79
    s_nop 1
    v_add_f32_dpp v26, v26, v26 row_shr:1 row_mask:0xf bank_mask:0xf bound_ctrl:0
    s_nop 1
    v_add_f32_dpp v26, v26, v26 row_shr:2 row_mask:0xf bank_mask:0xf bound_ctrl:0
    s_nop 1
    v_add_f32_dpp v26, v26, v26 row_shr:4 row_mask:0xf bank_mask:0xf bound_ctrl:0
    s_nop 1
    v_add_f32_dpp v26, v26, v26 row_shr:8 row_mask:0xf bank_mask:0xf bound_ctrl:0
    s_nop 1
    v_add_f32_dpp v26, v26, v26 row_bcast:15 row_mask:0xa bank_mask:0xf
    s_nop 1
    v_add_f32_dpp v26, v26, v26 row_bcast:31 row_mask:0xc bank_mask:0xf
    s_nop 1
    v_readlane_b32 s66, v26, 63
    s_nop 1
    v_mov_b32 v27, s66
    v_mul_f32 v27, 0x3a800000, v27
    v_mov_b32 v26, 0
    v_sub_f32 v28, v64, v27
    v_fmac_f32 v26, v28, v28
    v_sub_f32 v28, v65, v27
    v_fmac_f32 v26, v28, v28
    v_sub_f32 v28, v66, v27
    v_fmac_f32 v26, v28, v28
    v_sub_f32 v28, v67, v27
    v_fmac_f32 v26, v28, v28
    v_sub_f32 v28, v68, v27
    v_fmac_f32 v26, v28, v28
    v_sub_f32 v28, v69, v27
    v_fmac_f32 v26, v28, v28
    v_sub_f32 v28, v70, v27
    v_fmac_f32 v26, v28, v28
    v_sub_f32 v28, v71, v27
    v_fmac_f32 v26, v28, v28
    v_sub_f32 v28, v72, v27
    v_fmac_f32 v26, v28, v28
    v_sub_f32 v28, v73, v27
    v_fmac_f32 v26, v28, v28
    v_sub_f32 v28, v74, v27
    v_fmac_f32 v26, v28, v28
    v_sub_f32 v28, v75, v27
    v_fmac_f32 v26, v28, v28
    v_sub_f32 v28, v76, v27
    v_fmac_f32 v26, v28, v28
    v_sub_f32 v28, v77, v27
    v_fmac_f32 v26, v28, v28
    v_sub_f32 v28, v78, v27
    v_fmac_f32 v26, v28, v28
    v_sub_f32 v28, v79, v27
    v_fmac_f32 v26, v28, v28
    s_nop 1
    v_add_f32_dpp v26, v26, v26 row_shr:1 row_mask:0xf bank_mask:0xf bound_ctrl:0
    s_nop 1
    v_add_f32_dpp v26, v26, v26 row_shr:2 row_mask:0xf bank_mask:0xf bound_ctrl:0
    s_nop 1
    v_add_f32_dpp v26, v26, v26 row_shr:4 row_mask:0xf bank_mask:0xf bound_ctrl:0
    s_nop 1
    v_add_f32_dpp v26, v26, v26 row_shr:8 row_mask:0xf bank_mask:0xf bound_ctrl:0
    s_nop 1
    v_add_f32_dpp v26, v26, v26 row_bcast:15 row_mask:0xa bank_mask:0xf
    s_nop 1
    v_add_f32_dpp v26, v26, v26 row_bcast:31 row_mask:0xc bank_mask:0xf
    s_nop 1
    v_readlane_b32 s66, v26, 63
    s_nop 1
    v_mov_b32 v26, s66
    v_mul_f32 v26, 0x3a800000, v26
    v_cvt_pk_bf16_f32 v26, v26, v26
    v_lshlrev_b32 v26, 16, v26
    v_cvt_pk_bf16_f32 v27, v27, v27
    v_lshlrev_b32 v27, 16, v27
    v_add_f32 v26, 0x3727c5ac, v26
    v_cvt_pk_bf16_f32 v26, v26, v26
    v_lshlrev_b32 v26, 16, v26
    v_sqrt_f32 v26, v26
    s_nop 0
    v_cvt_pk_bf16_f32 v26, v26, v26
    v_lshlrev_b32 v26, 16, v26
    v_rcp_f32 v26, v26
    s_nop 0
    v_sub_f32 v64, v64, v27
    v_cvt_pk_bf16_f32 v64, v64, v64
    v_lshlrev_b32 v64, 16, v64
    v_mul_f32 v64, v64, v26
    v_cvt_pk_bf16_f32 v64, v64, v64
    v_lshlrev_b32 v64, 16, v64
    v_sub_f32 v65, v65, v27
    v_cvt_pk_bf16_f32 v65, v65, v65
    v_lshlrev_b32 v65, 16, v65
    v_mul_f32 v65, v65, v26
    v_cvt_pk_bf16_f32 v65, v65, v65
    v_lshlrev_b32 v65, 16, v65
    v_sub_f32 v66, v66, v27
    v_cvt_pk_bf16_f32 v66, v66, v66
    v_lshlrev_b32 v66, 16, v66
    v_mul_f32 v66, v66, v26
    v_cvt_pk_bf16_f32 v66, v66, v66
    v_lshlrev_b32 v66, 16, v66
    v_sub_f32 v67, v67, v27
    v_cvt_pk_bf16_f32 v67, v67, v67
    v_lshlrev_b32 v67, 16, v67
    v_mul_f32 v67, v67, v26
    v_cvt_pk_bf16_f32 v67, v67, v67
    v_lshlrev_b32 v67, 16, v67
    v_sub_f32 v68, v68, v27
    v_cvt_pk_bf16_f32 v68, v68, v68
    v_lshlrev_b32 v68, 16, v68
    v_mul_f32 v68, v68, v26
    v_cvt_pk_bf16_f32 v68, v68, v68
    v_lshlrev_b32 v68, 16, v68
    v_sub_f32 v69, v69, v27
    v_cvt_pk_bf16_f32 v69, v69, v69
    v_lshlrev_b32 v69, 16, v69
    v_mul_f32 v69, v69, v26
    v_cvt_pk_bf16_f32 v69, v69, v69
    v_lshlrev_b32 v69, 16, v69
    v_sub_f32 v70, v70, v27
    v_cvt_pk_bf16_f32 v70, v70, v70
    v_lshlrev_b32 v70, 16, v70
    v_mul_f32 v70, v70, v26
    v_cvt_pk_bf16_f32 v70, v70, v70
    v_lshlrev_b32 v70, 16, v70
    v_sub_f32 v71, v71, v27
    v_cvt_pk_bf16_f32 v71, v71, v71
    v_lshlrev_b32 v71, 16, v71
    v_mul_f32 v71, v71, v26
    v_cvt_pk_bf16_f32 v71, v71, v71
    v_lshlrev_b32 v71, 16, v71
    v_sub_f32 v72, v72, v27
    v_cvt_pk_bf16_f32 v72, v72, v72
    v_lshlrev_b32 v72, 16, v72
    v_mul_f32 v72, v72, v26
    v_cvt_pk_bf16_f32 v72, v72, v72
    v_lshlrev_b32 v72, 16, v72
    v_sub_f32 v73, v73, v27
    v_cvt_pk_bf16_f32 v73, v73, v73
    v_lshlrev_b32 v73, 16, v73
    v_mul_f32 v73, v73, v26
    v_cvt_pk_bf16_f32 v73, v73, v73
    v_lshlrev_b32 v73, 16, v73
    v_sub_f32 v74, v74, v27
    v_cvt_pk_bf16_f32 v74, v74, v74
    v_lshlrev_b32 v74, 16, v74
    v_mul_f32 v74, v74, v26
    v_cvt_pk_bf16_f32 v74, v74, v74
    v_lshlrev_b32 v74, 16, v74
    v_sub_f32 v75, v75, v27
    v_cvt_pk_bf16_f32 v75, v75, v75
    v_lshlrev_b32 v75, 16, v75
    v_mul_f32 v75, v75, v26
    v_cvt_pk_bf16_f32 v75, v75, v75
    v_lshlrev_b32 v75, 16, v75
    v_sub_f32 v76, v76, v27
    v_cvt_pk_bf16_f32 v76, v76, v76
    v_lshlrev_b32 v76, 16, v76
    v_mul_f32 v76, v76, v26
    v_cvt_pk_bf16_f32 v76, v76, v76
    v_lshlrev_b32 v76, 16, v76
    v_sub_f32 v77, v77, v27
    v_cvt_pk_bf16_f32 v77, v77, v77
    v_lshlrev_b32 v77, 16, v77
    v_mul_f32 v77, v77, v26
    v_cvt_pk_bf16_f32 v77, v77, v77
    v_lshlrev_b32 v77, 16, v77
    v_sub_f32 v78, v78, v27
    v_cvt_pk_bf16_f32 v78, v78, v78
    v_lshlrev_b32 v78, 16, v78
    v_mul_f32 v78, v78, v26
    v_cvt_pk_bf16_f32 v78, v78, v78
    v_lshlrev_b32 v78, 16, v78
    v_sub_f32 v79, v79, v27
    v_cvt_pk_bf16_f32 v79, v79, v79
    v_lshlrev_b32 v79, 16, v79
    v_mul_f32 v79, v79, v26
    v_cvt_pk_bf16_f32 v79, v79, v79
    v_lshlrev_b32 v79, 16, v79
    v_mul_f32 v64, v64, v112
    v_cvt_pk_bf16_f32 v64, v64, v64
    v_lshlrev_b32 v64, 16, v64
    v_add_f32 v64, v64, v96
    v_mul_f32 v65, v65, v113
    v_cvt_pk_bf16_f32 v65, v65, v65
    v_lshlrev_b32 v65, 16, v65
    v_add_f32 v65, v65, v97
    v_mul_f32 v66, v66, v114
    v_cvt_pk_bf16_f32 v66, v66, v66
    v_lshlrev_b32 v66, 16, v66
    v_add_f32 v66, v66, v98
    v_mul_f32 v67, v67, v115
    v_cvt_pk_bf16_f32 v67, v67, v67
    v_lshlrev_b32 v67, 16, v67
    v_add_f32 v67, v67, v99
    v_mul_f32 v68, v68, v116
    v_cvt_pk_bf16_f32 v68, v68, v68
    v_lshlrev_b32 v68, 16, v68
    v_add_f32 v68, v68, v100
    v_mul_f32 v69, v69, v117
    v_cvt_pk_bf16_f32 v69, v69, v69
    v_lshlrev_b32 v69, 16, v69
    v_add_f32 v69, v69, v101
    v_mul_f32 v70, v70, v118
    v_cvt_pk_bf16_f32 v70, v70, v70
    v_lshlrev_b32 v70, 16, v70
    v_add_f32 v70, v70, v102
    v_mul_f32 v71, v71, v119
    v_cvt_pk_bf16_f32 v71, v71, v71
    v_lshlrev_b32 v71, 16, v71
    v_add_f32 v71, v71, v103
    v_mul_f32 v72, v72, v120
    v_cvt_pk_bf16_f32 v72, v72, v72
    v_lshlrev_b32 v72, 16, v72
    v_add_f32 v72, v72, v104
    v_mul_f32 v73, v73, v121
    v_cvt_pk_bf16_f32 v73, v73, v73
    v_lshlrev_b32 v73, 16, v73
    v_add_f32 v73, v73, v105
    v_mul_f32 v74, v74, v122
    v_cvt_pk_bf16_f32 v74, v74, v74
    v_lshlrev_b32 v74, 16, v74
    v_add_f32 v74, v74, v106
    v_mul_f32 v75, v75, v123
    v_cvt_pk_bf16_f32 v75, v75, v75
    v_lshlrev_b32 v75, 16, v75
    v_add_f32 v75, v75, v107
    v_mul_f32 v76, v76, v124
    v_cvt_pk_bf16_f32 v76, v76, v76
    v_lshlrev_b32 v76, 16, v76
    v_add_f32 v76, v76, v108
    v_mul_f32 v77, v77, v125
    v_cvt_pk_bf16_f32 v77, v77, v77
    v_lshlrev_b32 v77, 16, v77
    v_add_f32 v77, v77, v109
    v_mul_f32 v78, v78, v126
    v_cvt_pk_bf16_f32 v78, v78, v78
    v_lshlrev_b32 v78, 16, v78
    v_add_f32 v78, v78, v110
    v_mul_f32 v79, v79, v127
    v_cvt_pk_bf16_f32 v79, v79, v79
    v_lshlrev_b32 v79, 16, v79
    v_add_f32 v79, v79, v111
    v_cvt_pk_bf16_f32 v80, v64, v65
    v_cvt_pk_bf16_f32 v81, v66, v67
    v_cvt_pk_bf16_f32 v82, v68, v69
    v_cvt_pk_bf16_f32 v83, v70, v71
    v_cvt_pk_bf16_f32 v84, v72, v73
    v_cvt_pk_bf16_f32 v85, v74, v75
    v_cvt_pk_bf16_f32 v86, v76, v77
    v_cvt_pk_bf16_f32 v87, v78, v79
    s_lshr_b32 s45, s63, 5
    s_lshl_b32 s45, s45, 16
    s_and_b32 s46, s63, 31
    s_lshl_b32 s46, s46, 8
    s_add_u32 s45, s45, s46
    s_add_u32 s45, s45, 0x400000
    s_add_u32 s46, s45, 32768
    buffer_store_dwordx4 v[80:83], v2, s[12:15], s45 offen sc1
    buffer_store_dwordx4 v[84:87], v2, s[12:15], s46 offen sc1
    s_add_u32 s63, s63, 384
    s_cmp_ge_u32 s63, 2048
    s_cbranch_scc1 L_ln_done_109
    v_lshlrev_b32 v64, 16, v168
    v_and_b32 v65, 0xffff0000, v168
    v_lshlrev_b32 v66, 16, v169
    v_and_b32 v67, 0xffff0000, v169
    v_lshlrev_b32 v68, 16, v170
    v_and_b32 v69, 0xffff0000, v170
    v_lshlrev_b32 v70, 16, v171
    v_and_b32 v71, 0xffff0000, v171
    v_lshlrev_b32 v72, 16, v172
    v_and_b32 v73, 0xffff0000, v172
    v_lshlrev_b32 v74, 16, v173
    v_and_b32 v75, 0xffff0000, v173
    v_lshlrev_b32 v76, 16, v174
    v_and_b32 v77, 0xffff0000, v174
    v_lshlrev_b32 v78, 16, v175
    v_and_b32 v79, 0xffff0000, v175
    v_add_f32 v26, v64, v65
    v_add_f32 v26, v26, v66
    v_add_f32 v26, v26, v67
    v_add_f32 v26, v26, v68
    v_add_f32 v26, v26, v69
    v_add_f32 v26, v26, v70
    v_add_f32 v26, v26, v71
    v_add_f32 v26, v26, v72
    v_add_f32 v26, v26, v73
    v_add_f32 v26, v26, v74
    v_add_f32 v26, v26, v75
    v_add_f32 v26, v26, v76
    v_add_f32 v26, v26, v77
    v_add_f32 v26, v26, v78
    v_add_f32 v26, v26, v79
    s_nop 1
    v_add_f32_dpp v26, v26, v26 row_shr:1 row_mask:0xf bank_mask:0xf bound_ctrl:0
    s_nop 1
    v_add_f32_dpp v26, v26, v26 row_shr:2 row_mask:0xf bank_mask:0xf bound_ctrl:0
    s_nop 1
    v_add_f32_dpp v26, v26, v26 row_shr:4 row_mask:0xf bank_mask:0xf bound_ctrl:0
    s_nop 1
    v_add_f32_dpp v26, v26, v26 row_shr:8 row_mask:0xf bank_mask:0xf bound_ctrl:0
    s_nop 1
    v_add_f32_dpp v26, v26, v26 row_bcast:15 row_mask:0xa bank_mask:0xf
    s_nop 1
    v_add_f32_dpp v26, v26, v26 row_bcast:31 row_mask:0xc bank_mask:0xf
    s_nop 1
    v_readlane_b32 s66, v26, 63
    s_nop 1
    v_mov_b32 v27, s66
    v_mul_f32 v27, 0x3a800000, v27
    v_mov_b32 v26, 0
    v_sub_f32 v28, v64, v27
    v_fmac_f32 v26, v28, v28
    v_sub_f32 v28, v65, v27
    v_fmac_f32 v26, v28, v28
    v_sub_f32 v28, v66, v27
    v_fmac_f32 v26, v28, v28
    v_sub_f32 v28, v67, v27
    v_fmac_f32 v26, v28, v28
    v_sub_f32 v28, v68, v27
    v_fmac_f32 v26, v28, v28
    v_sub_f32 v28, v69, v27
    v_fmac_f32 v26, v28, v28
    v_sub_f32 v28, v70, v27
    v_fmac_f32 v26, v28, v28
    v_sub_f32 v28, v71, v27
    v_fmac_f32 v26, v28, v28
    v_sub_f32 v28, v72, v27
    v_fmac_f32 v26, v28, v28
    v_sub_f32 v28, v73, v27
    v_fmac_f32 v26, v28, v28
    v_sub_f32 v28, v74, v27
    v_fmac_f32 v26, v28, v28
    v_sub_f32 v28, v75, v27
    v_fmac_f32 v26, v28, v28
    v_sub_f32 v28, v76, v27
    v_fmac_f32 v26, v28, v28
    v_sub_f32 v28, v77, v27
    v_fmac_f32 v26, v28, v28
    v_sub_f32 v28, v78, v27
    v_fmac_f32 v26, v28, v28
    v_sub_f32 v28, v79, v27
    v_fmac_f32 v26, v28, v28
    s_nop 1
    v_add_f32_dpp v26, v26, v26 row_shr:1 row_mask:0xf bank_mask:0xf bound_ctrl:0
    s_nop 1
    v_add_f32_dpp v26, v26, v26 row_shr:2 row_mask:0xf bank_mask:0xf bound_ctrl:0
    s_nop 1
    v_add_f32_dpp v26, v26, v26 row_shr:4 row_mask:0xf bank_mask:0xf bound_ctrl:0
    s_nop 1
    v_add_f32_dpp v26, v26, v26 row_shr:8 row_mask:0xf bank_mask:0xf bound_ctrl:0
    s_nop 1
    v_add_f32_dpp v26, v26, v26 row_bcast:15 row_mask:0xa bank_mask:0xf
    s_nop 1
    v_add_f32_dpp v26, v26, v26 row_bcast:31 row_mask:0xc bank_mask:0xf
    s_nop 1
    v_readlane_b32 s66, v26, 63
    s_nop 1
    v_mov_b32 v26, s66
    v_mul_f32 v26, 0x3a800000, v26
    v_cvt_pk_bf16_f32 v26, v26, v26
    v_lshlrev_b32 v26, 16, v26
    v_cvt_pk_bf16_f32 v27, v27, v27
    v_lshlrev_b32 v27, 16, v27
    v_add_f32 v26, 0x3727c5ac, v26
    v_cvt_pk_bf16_f32 v26, v26, v26
    v_lshlrev_b32 v26, 16, v26
    v_sqrt_f32 v26, v26
    s_nop 0
    v_cvt_pk_bf16_f32 v26, v26, v26
    v_lshlrev_b32 v26, 16, v26
    v_rcp_f32 v26, v26
    s_nop 0
    v_sub_f32 v64, v64, v27
    v_cvt_pk_bf16_f32 v64, v64, v64
    v_lshlrev_b32 v64, 16, v64
    v_mul_f32 v64, v64, v26
    v_cvt_pk_bf16_f32 v64, v64, v64
    v_lshlrev_b32 v64, 16, v64
    v_sub_f32 v65, v65, v27
    v_cvt_pk_bf16_f32 v65, v65, v65
    v_lshlrev_b32 v65, 16, v65
    v_mul_f32 v65, v65, v26
    v_cvt_pk_bf16_f32 v65, v65, v65
    v_lshlrev_b32 v65, 16, v65
    v_sub_f32 v66, v66, v27
    v_cvt_pk_bf16_f32 v66, v66, v66
    v_lshlrev_b32 v66, 16, v66
    v_mul_f32 v66, v66, v26
    v_cvt_pk_bf16_f32 v66, v66, v66
    v_lshlrev_b32 v66, 16, v66
    v_sub_f32 v67, v67, v27
    v_cvt_pk_bf16_f32 v67, v67, v67
    v_lshlrev_b32 v67, 16, v67
    v_mul_f32 v67, v67, v26
    v_cvt_pk_bf16_f32 v67, v67, v67
    v_lshlrev_b32 v67, 16, v67
    v_sub_f32 v68, v68, v27
    v_cvt_pk_bf16_f32 v68, v68, v68
    v_lshlrev_b32 v68, 16, v68
    v_mul_f32 v68, v68, v26
    v_cvt_pk_bf16_f32 v68, v68, v68
    v_lshlrev_b32 v68, 16, v68
    v_sub_f32 v69, v69, v27
    v_cvt_pk_bf16_f32 v69, v69, v69
    v_lshlrev_b32 v69, 16, v69
    v_mul_f32 v69, v69, v26
    v_cvt_pk_bf16_f32 v69, v69, v69
    v_lshlrev_b32 v69, 16, v69
    v_sub_f32 v70, v70, v27
    v_cvt_pk_bf16_f32 v70, v70, v70
    v_lshlrev_b32 v70, 16, v70
    v_mul_f32 v70, v70, v26
    v_cvt_pk_bf16_f32 v70, v70, v70
    v_lshlrev_b32 v70, 16, v70
    v_sub_f32 v71, v71, v27
    v_cvt_pk_bf16_f32 v71, v71, v71
    v_lshlrev_b32 v71, 16, v71
    v_mul_f32 v71, v71, v26
    v_cvt_pk_bf16_f32 v71, v71, v71
    v_lshlrev_b32 v71, 16, v71
    v_sub_f32 v72, v72, v27
    v_cvt_pk_bf16_f32 v72, v72, v72
    v_lshlrev_b32 v72, 16, v72
    v_mul_f32 v72, v72, v26
    v_cvt_pk_bf16_f32 v72, v72, v72
    v_lshlrev_b32 v72, 16, v72
    v_sub_f32 v73, v73, v27
    v_cvt_pk_bf16_f32 v73, v73, v73
    v_lshlrev_b32 v73, 16, v73
    v_mul_f32 v73, v73, v26
    v_cvt_pk_bf16_f32 v73, v73, v73
    v_lshlrev_b32 v73, 16, v73
    v_sub_f32 v74, v74, v27
    v_cvt_pk_bf16_f32 v74, v74, v74
    v_lshlrev_b32 v74, 16, v74
    v_mul_f32 v74, v74, v26
    v_cvt_pk_bf16_f32 v74, v74, v74
    v_lshlrev_b32 v74, 16, v74
    v_sub_f32 v75, v75, v27
    v_cvt_pk_bf16_f32 v75, v75, v75
    v_lshlrev_b32 v75, 16, v75
    v_mul_f32 v75, v75, v26
    v_cvt_pk_bf16_f32 v75, v75, v75
    v_lshlrev_b32 v75, 16, v75
    v_sub_f32 v76, v76, v27
    v_cvt_pk_bf16_f32 v76, v76, v76
    v_lshlrev_b32 v76, 16, v76
    v_mul_f32 v76, v76, v26
    v_cvt_pk_bf16_f32 v76, v76, v76
    v_lshlrev_b32 v76, 16, v76
    v_sub_f32 v77, v77, v27
    v_cvt_pk_bf16_f32 v77, v77, v77
    v_lshlrev_b32 v77, 16, v77
    v_mul_f32 v77, v77, v26
    v_cvt_pk_bf16_f32 v77, v77, v77
    v_lshlrev_b32 v77, 16, v77
    v_sub_f32 v78, v78, v27
    v_cvt_pk_bf16_f32 v78, v78, v78
    v_lshlrev_b32 v78, 16, v78
    v_mul_f32 v78, v78, v26
    v_cvt_pk_bf16_f32 v78, v78, v78
    v_lshlrev_b32 v78, 16, v78
    v_sub_f32 v79, v79, v27
    v_cvt_pk_bf16_f32 v79, v79, v79
    v_lshlrev_b32 v79, 16, v79
    v_mul_f32 v79, v79, v26
    v_cvt_pk_bf16_f32 v79, v79, v79
    v_lshlrev_b32 v79, 16, v79
    v_mul_f32 v64, v64, v112
    v_cvt_pk_bf16_f32 v64, v64, v64
    v_lshlrev_b32 v64, 16, v64
    v_add_f32 v64, v64, v96
    v_mul_f32 v65, v65, v113
    v_cvt_pk_bf16_f32 v65, v65, v65
    v_lshlrev_b32 v65, 16, v65
    v_add_f32 v65, v65, v97
    v_mul_f32 v66, v66, v114
    v_cvt_pk_bf16_f32 v66, v66, v66
    v_lshlrev_b32 v66, 16, v66
    v_add_f32 v66, v66, v98
    v_mul_f32 v67, v67, v115
    v_cvt_pk_bf16_f32 v67, v67, v67
    v_lshlrev_b32 v67, 16, v67
    v_add_f32 v67, v67, v99
    v_mul_f32 v68, v68, v116
    v_cvt_pk_bf16_f32 v68, v68, v68
    v_lshlrev_b32 v68, 16, v68
    v_add_f32 v68, v68, v100
    v_mul_f32 v69, v69, v117
    v_cvt_pk_bf16_f32 v69, v69, v69
    v_lshlrev_b32 v69, 16, v69
    v_add_f32 v69, v69, v101
    v_mul_f32 v70, v70, v118
    v_cvt_pk_bf16_f32 v70, v70, v70
    v_lshlrev_b32 v70, 16, v70
    v_add_f32 v70, v70, v102
    v_mul_f32 v71, v71, v119
    v_cvt_pk_bf16_f32 v71, v71, v71
    v_lshlrev_b32 v71, 16, v71
    v_add_f32 v71, v71, v103
    v_mul_f32 v72, v72, v120
    v_cvt_pk_bf16_f32 v72, v72, v72
    v_lshlrev_b32 v72, 16, v72
    v_add_f32 v72, v72, v104
    v_mul_f32 v73, v73, v121
    v_cvt_pk_bf16_f32 v73, v73, v73
    v_lshlrev_b32 v73, 16, v73
    v_add_f32 v73, v73, v105
    v_mul_f32 v74, v74, v122
    v_cvt_pk_bf16_f32 v74, v74, v74
    v_lshlrev_b32 v74, 16, v74
    v_add_f32 v74, v74, v106
    v_mul_f32 v75, v75, v123
    v_cvt_pk_bf16_f32 v75, v75, v75
    v_lshlrev_b32 v75, 16, v75
    v_add_f32 v75, v75, v107
    v_mul_f32 v76, v76, v124
    v_cvt_pk_bf16_f32 v76, v76, v76
    v_lshlrev_b32 v76, 16, v76
    v_add_f32 v76, v76, v108
    v_mul_f32 v77, v77, v125
    v_cvt_pk_bf16_f32 v77, v77, v77
    v_lshlrev_b32 v77, 16, v77
    v_add_f32 v77, v77, v109
    v_mul_f32 v78, v78, v126
    v_cvt_pk_bf16_f32 v78, v78, v78
    v_lshlrev_b32 v78, 16, v78
    v_add_f32 v78, v78, v110
    v_mul_f32 v79, v79, v127
    v_cvt_pk_bf16_f32 v79, v79, v79
    v_lshlrev_b32 v79, 16, v79
    v_add_f32 v79, v79, v111
    v_cvt_pk_bf16_f32 v80, v64, v65
    v_cvt_pk_bf16_f32 v81, v66, v67
    v_cvt_pk_bf16_f32 v82, v68, v69
    v_cvt_pk_bf16_f32 v83, v70, v71
    v_cvt_pk_bf16_f32 v84, v72, v73
    v_cvt_pk_bf16_f32 v85, v74, v75
    v_cvt_pk_bf16_f32 v86, v76, v77
    v_cvt_pk_bf16_f32 v87, v78, v79
    s_lshr_b32 s45, s63, 5
    s_lshl_b32 s45, s45, 16
    s_and_b32 s46, s63, 31
    s_lshl_b32 s46, s46, 8
    s_add_u32 s45, s45, s46
    s_add_u32 s45, s45, 0x400000
    s_add_u32 s46, s45, 32768
    buffer_store_dwordx4 v[80:83], v2, s[12:15], s45 offen sc1
    buffer_store_dwordx4 v[84:87], v2, s[12:15], s46 offen sc1
    s_add_u32 s63, s63, 384
L_ln_done_109:
    s_waitcnt vmcnt(0)
    s_barrier
    s_cmp_lg_u32 s44, 0
    s_cbranch_scc1 L_cnt_111
    v_mov_b32 v30, 1
    v_mov_b32 v31, 0
    s_mov_b64 exec, 1
    buffer_atomic_add v30, v31, s[16:19], 0 offen offset:196 sc1
    s_mov_b64 exec, -1
L_cnt_111:
    s_add_u32 s39, s39, 96
    s_load_dwordx2 s[4:5], s[0:1], 96
    s_load_dwordx2 s[6:7], s[0:1], 104
    v_and_b32 v14, 7, v0
    v_lshrrev_b32 v15, 3, v0
    s_waitcnt lgkmcnt(0)
    s_mov_b32 s32, s4
    s_and_b32 s33, s5, 0xffff
    s_mov_b32 s34, 0x800
    s_mov_b32 s35, 0x00020000
    s_mov_b32 s24, s6
    s_and_b32 s25, s7, 0xffff
    s_mov_b32 s26, 0xc00000
    s_mov_b32 s27, 0x00020000
    s_and_b32 s47, s39, 1
    s_lshl_b32 s45, s47, 10
    v_lshlrev_b32 v16, 5, v15
    buffer_load_dwordx4 v[104:107], v16, s[32:35], s45 offen
    buffer_load_dwordx4 v[108:111], v16, s[32:35], s45 offen offset:16
    s_mov_b32 s45, 196608
    v_mul_lo_u32 v17, v15, s45
    v_lshlrev_b32 v18, 4, v14
    v_add_u32 v17, v17, v18
    s_lshr_b32 s46, s39, 1
    s_lshl_b32 s46, s46, 7
    s_mul_i32 s45, s47, 6291456
    s_add_u32 s46, s46, s45
    buffer_load_dwordx4 v[32:35], v17, s[24:27], s46 offen
    v_add_u32 v17, 12288, v17
    buffer_load_dwordx4 v[36:39], v17, s[24:27], s46 offen
    v_add_u32 v17, 12288, v17
    buffer_load_dwordx4 v[40:43], v17, s[24:27], s46 offen
    v_add_u32 v17, 12288, v17
    buffer_load_dwordx4 v[44:47], v17, s[24:27], s46 offen
    v_add_u32 v17, 12288, v17
    buffer_load_dwordx4 v[48:51], v17, s[24:27], s46 offen
    v_add_u32 v17, 12288, v17
    buffer_load_dwordx4 v[52:55], v17, s[24:27], s46 offen
    v_add_u32 v17, 12288, v17
    buffer_load_dwordx4 v[56:59], v17, s[24:27], s46 offen
    v_add_u32 v17, 12288, v17
    buffer_load_dwordx4 v[60:63], v17, s[24:27], s46 offen
    v_add_u32 v17, 12288, v17
    buffer_load_dwordx4 v[64:67], v17, s[24:27], s46 offen
    v_add_u32 v17, 12288, v17
    buffer_load_dwordx4 v[68:71], v17, s[24:27], s46 offen
    v_add_u32 v17, 12288, v17
    buffer_load_dwordx4 v[72:75], v17, s[24:27], s46 offen
    v_add_u32 v17, 12288, v17
    buffer_load_dwordx4 v[76:79], v17, s[24:27], s46 offen
    v_add_u32 v17, 12288, v17
    buffer_load_dwordx4 v[80:83], v17, s[24:27], s46 offen
    v_add_u32 v17, 12288, v17
    buffer_load_dwordx4 v[84:87], v17, s[24:27], s46 offen
    v_add_u32 v17, 12288, v17
    buffer_load_dwordx4 v[88:91], v17, s[24:27], s46 offen
    v_add_u32 v17, 12288, v17
    buffer_load_dwordx4 v[92:95], v17, s[24:27], s46 offen
    s_waitcnt vmcnt(16)
    v_lshlrev_b32 v112, 16, v104
    v_and_b32 v113, 0xffff0000, v104
    v_lshlrev_b32 v114, 16, v105
    v_and_b32 v115, 0xffff0000, v105
    v_lshlrev_b32 v116, 16, v106
    v_and_b32 v117, 0xffff0000, v106
    v_lshlrev_b32 v118, 16, v107
    v_and_b32 v119, 0xffff0000, v107
    v_lshlrev_b32 v120, 16, v108
    v_and_b32 v121, 0xffff0000, v108
    v_lshlrev_b32 v122, 16, v109
    v_and_b32 v123, 0xffff0000, v109
    v_lshlrev_b32 v124, 16, v110
    v_and_b32 v125, 0xffff0000, v110
    v_lshlrev_b32 v126, 16, v111
    v_and_b32 v127, 0xffff0000, v111
    v_mul_f32 v18, 0xbfb8aa3b, v112
    v_exp_f32 v18, v18
    s_nop 0
    v_add_f32 v18, 1.0, v18
    v_rcp_f32 v18, v18
    s_nop 0
    v_mul_f32 v112, v112, v18
    v_cvt_pk_bf16_f32 v112, v112, v112
    v_lshlrev_b32 v112, 16, v112
    v_mul_f32 v18, 0xbfb8aa3b, v113
    v_exp_f32 v18, v18
    s_nop 0
    v_add_f32 v18, 1.0, v18
    v_rcp_f32 v18, v18
    s_nop 0
    v_mul_f32 v113, v113, v18
    v_cvt_pk_bf16_f32 v113, v113, v113
    v_lshlrev_b32 v113, 16, v113
    v_mul_f32 v18, 0xbfb8aa3b, v114
    v_exp_f32 v18, v18
    s_nop 0
    v_add_f32 v18, 1.0, v18
    v_rcp_f32 v18, v18
    s_nop 0
    v_mul_f32 v114, v114, v18
    v_cvt_pk_bf16_f32 v114, v114, v114
    v_lshlrev_b32 v114, 16, v114
    v_mul_f32 v18, 0xbfb8aa3b, v115
    v_exp_f32 v18, v18
    s_nop 0
    v_add_f32 v18, 1.0, v18
    v_rcp_f32 v18, v18
    s_nop 0
    v_mul_f32 v115, v115, v18
    v_cvt_pk_bf16_f32 v115, v115, v115
    v_lshlrev_b32 v115, 16, v115
    v_mul_f32 v18, 0xbfb8aa3b, v116
    v_exp_f32 v18, v18
    s_nop 0
    v_add_f32 v18, 1.0, v18
    v_rcp_f32 v18, v18
    s_nop 0
    v_mul_f32 v116, v116, v18
    v_cvt_pk_bf16_f32 v116, v116, v116
    v_lshlrev_b32 v116, 16, v116
    v_mul_f32 v18, 0xbfb8aa3b, v117
    v_exp_f32 v18, v18
    s_nop 0
    v_add_f32 v18, 1.0, v18
    v_rcp_f32 v18, v18
    s_nop 0
    v_mul_f32 v117, v117, v18
    v_cvt_pk_bf16_f32 v117, v117, v117
    v_lshlrev_b32 v117, 16, v117
    v_mul_f32 v18, 0xbfb8aa3b, v118
    v_exp_f32 v18, v18
    s_nop 0
    v_add_f32 v18, 1.0, v18
    v_rcp_f32 v18, v18
    s_nop 0
    v_mul_f32 v118, v118, v18
    v_cvt_pk_bf16_f32 v118, v118, v118
    v_lshlrev_b32 v118, 16, v118
    v_mul_f32 v18, 0xbfb8aa3b, v119
    v_exp_f32 v18, v18
    s_nop 0
    v_add_f32 v18, 1.0, v18
    v_rcp_f32 v18, v18
    s_nop 0
    v_mul_f32 v119, v119, v18
    v_cvt_pk_bf16_f32 v119, v119, v119
    v_lshlrev_b32 v119, 16, v119
    v_mul_f32 v18, 0xbfb8aa3b, v120
    v_exp_f32 v18, v18
    s_nop 0
    v_add_f32 v18, 1.0, v18
    v_rcp_f32 v18, v18
    s_nop 0
    v_mul_f32 v120, v120, v18
    v_cvt_pk_bf16_f32 v120, v120, v120
    v_lshlrev_b32 v120, 16, v120
    v_mul_f32 v18, 0xbfb8aa3b, v121
    v_exp_f32 v18, v18
    s_nop 0
    v_add_f32 v18, 1.0, v18
    v_rcp_f32 v18, v18
    s_nop 0
    v_mul_f32 v121, v121, v18
    v_cvt_pk_bf16_f32 v121, v121, v121
    v_lshlrev_b32 v121, 16, v121
    v_mul_f32 v18, 0xbfb8aa3b, v122
    v_exp_f32 v18, v18
    s_nop 0
    v_add_f32 v18, 1.0, v18
    v_rcp_f32 v18, v18
    s_nop 0
    v_mul_f32 v122, v122, v18
    v_cvt_pk_bf16_f32 v122, v122, v122
    v_lshlrev_b32 v122, 16, v122
    v_mul_f32 v18, 0xbfb8aa3b, v123
    v_exp_f32 v18, v18
    s_nop 0
    v_add_f32 v18, 1.0, v18
    v_rcp_f32 v18, v18
    s_nop 0
    v_mul_f32 v123, v123, v18
    v_cvt_pk_bf16_f32 v123, v123, v123
    v_lshlrev_b32 v123, 16, v123
    v_mul_f32 v18, 0xbfb8aa3b, v124
    v_exp_f32 v18, v18
    s_nop 0
    v_add_f32 v18, 1.0, v18
    v_rcp_f32 v18, v18
    s_nop 0
    v_mul_f32 v124, v124, v18
    v_cvt_pk_bf16_f32 v124, v124, v124
    v_lshlrev_b32 v124, 16, v124
    v_mul_f32 v18, 0xbfb8aa3b, v125
    v_exp_f32 v18, v18
    s_nop 0
    v_add_f32 v18, 1.0, v18
    v_rcp_f32 v18, v18
    s_nop 0
    v_mul_f32 v125, v125, v18
    v_cvt_pk_bf16_f32 v125, v125, v125
    v_lshlrev_b32 v125, 16, v125
    v_mul_f32 v18, 0xbfb8aa3b, v126
    v_exp_f32 v18, v18
    s_nop 0
    v_add_f32 v18, 1.0, v18
    v_rcp_f32 v18, v18
    s_nop 0
    v_mul_f32 v126, v126, v18
    v_cvt_pk_bf16_f32 v126, v126, v126
    v_lshlrev_b32 v126, 16, v126
    v_mul_f32 v18, 0xbfb8aa3b, v127
    v_exp_f32 v18, v18
    s_nop 0
    v_add_f32 v18, 1.0, v18
    v_rcp_f32 v18, v18
    s_nop 0
    v_mul_f32 v127, v127, v18
    v_cvt_pk_bf16_f32 v127, v127, v127
    v_lshlrev_b32 v127, 16, v127
    v_mov_b32 v96, 0
    v_mov_b32 v97, 0
    v_mov_b32 v98, 0
    v_mov_b32 v99, 0
    v_mov_b32 v100, 0
    v_mov_b32 v101, 0
    v_mov_b32 v102, 0
    v_mov_b32 v103, 0
    s_waitcnt vmcnt(15)
    v_lshlrev_b32 v18, 16, v32
    v_and_b32 v19, 0xffff0000, v32
    v_fmac_f32 v96, v18, v112
    v_fmac_f32 v97, v19, v112
    v_lshlrev_b32 v18, 16, v33
    v_and_b32 v19, 0xffff0000, v33
    v_fmac_f32 v98, v18, v112
    v_fmac_f32 v99, v19, v112
    v_lshlrev_b32 v18, 16, v34
    v_and_b32 v19, 0xffff0000, v34
    v_fmac_f32 v100, v18, v112
    v_fmac_f32 v101, v19, v112
    v_lshlrev_b32 v18, 16, v35
    v_and_b32 v19, 0xffff0000, v35
    v_fmac_f32 v102, v18, v112
    v_fmac_f32 v103, v19, v112
    s_waitcnt vmcnt(14)
    v_lshlrev_b32 v18, 16, v36
    v_and_b32 v19, 0xffff0000, v36
    v_fmac_f32 v96, v18, v113
    v_fmac_f32 v97, v19, v113
    v_lshlrev_b32 v18, 16, v37
    v_and_b32 v19, 0xffff0000, v37
    v_fmac_f32 v98, v18, v113
    v_fmac_f32 v99, v19, v113
    v_lshlrev_b32 v18, 16, v38
    v_and_b32 v19, 0xffff0000, v38
    v_fmac_f32 v100, v18, v113
    v_fmac_f32 v101, v19, v113
    v_lshlrev_b32 v18, 16, v39
    v_and_b32 v19, 0xffff0000, v39
    v_fmac_f32 v102, v18, v113
    v_fmac_f32 v103, v19, v113
    s_waitcnt vmcnt(13)
    v_lshlrev_b32 v18, 16, v40
    v_and_b32 v19, 0xffff0000, v40
    v_fmac_f32 v96, v18, v114
    v_fmac_f32 v97, v19, v114
    v_lshlrev_b32 v18, 16, v41
    v_and_b32 v19, 0xffff0000, v41
    v_fmac_f32 v98, v18, v114
    v_fmac_f32 v99, v19, v114
    v_lshlrev_b32 v18, 16, v42
    v_and_b32 v19, 0xffff0000, v42
    v_fmac_f32 v100, v18, v114
    v_fmac_f32 v101, v19, v114
    v_lshlrev_b32 v18, 16, v43
    v_and_b32 v19, 0xffff0000, v43
    v_fmac_f32 v102, v18, v114
    v_fmac_f32 v103, v19, v114
    s_waitcnt vmcnt(12)
    v_lshlrev_b32 v18, 16, v44
    v_and_b32 v19, 0xffff0000, v44
    v_fmac_f32 v96, v18, v115
    v_fmac_f32 v97, v19, v115
    v_lshlrev_b32 v18, 16, v45
    v_and_b32 v19, 0xffff0000, v45
    v_fmac_f32 v98, v18, v115
    v_fmac_f32 v99, v19, v115
    v_lshlrev_b32 v18, 16, v46
    v_and_b32 v19, 0xffff0000, v46
    v_fmac_f32 v100, v18, v115
    v_fmac_f32 v101, v19, v115
    v_lshlrev_b32 v18, 16, v47
    v_and_b32 v19, 0xffff0000, v47
    v_fmac_f32 v102, v18, v115
    v_fmac_f32 v103, v19, v115
    s_waitcnt vmcnt(11)
    v_lshlrev_b32 v18, 16, v48
    v_and_b32 v19, 0xffff0000, v48
    v_fmac_f32 v96, v18, v116
    v_fmac_f32 v97, v19, v116
    v_lshlrev_b32 v18, 16, v49
    v_and_b32 v19, 0xffff0000, v49
    v_fmac_f32 v98, v18, v116
    v_fmac_f32 v99, v19, v116
    v_lshlrev_b32 v18, 16, v50
    v_and_b32 v19, 0xffff0000, v50
    v_fmac_f32 v100, v18, v116
    v_fmac_f32 v101, v19, v116
    v_lshlrev_b32 v18, 16, v51
    v_and_b32 v19, 0xffff0000, v51
    v_fmac_f32 v102, v18, v116
    v_fmac_f32 v103, v19, v116
    s_waitcnt vmcnt(10)
    v_lshlrev_b32 v18, 16, v52
    v_and_b32 v19, 0xffff0000, v52
    v_fmac_f32 v96, v18, v117
    v_fmac_f32 v97, v19, v117
    v_lshlrev_b32 v18, 16, v53
    v_and_b32 v19, 0xffff0000, v53
    v_fmac_f32 v98, v18, v117
    v_fmac_f32 v99, v19, v117
    v_lshlrev_b32 v18, 16, v54
    v_and_b32 v19, 0xffff0000, v54
    v_fmac_f32 v100, v18, v117
    v_fmac_f32 v101, v19, v117
    v_lshlrev_b32 v18, 16, v55
    v_and_b32 v19, 0xffff0000, v55
    v_fmac_f32 v102, v18, v117
    v_fmac_f32 v103, v19, v117
    s_waitcnt vmcnt(9)
    v_lshlrev_b32 v18, 16, v56
    v_and_b32 v19, 0xffff0000, v56
    v_fmac_f32 v96, v18, v118
    v_fmac_f32 v97, v19, v118
    v_lshlrev_b32 v18, 16, v57
    v_and_b32 v19, 0xffff0000, v57
    v_fmac_f32 v98, v18, v118
    v_fmac_f32 v99, v19, v118
    v_lshlrev_b32 v18, 16, v58
    v_and_b32 v19, 0xffff0000, v58
    v_fmac_f32 v100, v18, v118
    v_fmac_f32 v101, v19, v118
    v_lshlrev_b32 v18, 16, v59
    v_and_b32 v19, 0xffff0000, v59
    v_fmac_f32 v102, v18, v118
    v_fmac_f32 v103, v19, v118
    s_waitcnt vmcnt(8)
    v_lshlrev_b32 v18, 16, v60
    v_and_b32 v19, 0xffff0000, v60
    v_fmac_f32 v96, v18, v119
    v_fmac_f32 v97, v19, v119
    v_lshlrev_b32 v18, 16, v61
    v_and_b32 v19, 0xffff0000, v61
    v_fmac_f32 v98, v18, v119
    v_fmac_f32 v99, v19, v119
    v_lshlrev_b32 v18, 16, v62
    v_and_b32 v19, 0xffff0000, v62
    v_fmac_f32 v100, v18, v119
    v_fmac_f32 v101, v19, v119
    v_lshlrev_b32 v18, 16, v63
    v_and_b32 v19, 0xffff0000, v63
    v_fmac_f32 v102, v18, v119
    v_fmac_f32 v103, v19, v119
    s_waitcnt vmcnt(7)
    v_lshlrev_b32 v18, 16, v64
    v_and_b32 v19, 0xffff0000, v64
    v_fmac_f32 v96, v18, v120
    v_fmac_f32 v97, v19, v120
    v_lshlrev_b32 v18, 16, v65
    v_and_b32 v19, 0xffff0000, v65
    v_fmac_f32 v98, v18, v120
    v_fmac_f32 v99, v19, v120
    v_lshlrev_b32 v18, 16, v66
    v_and_b32 v19, 0xffff0000, v66
    v_fmac_f32 v100, v18, v120
    v_fmac_f32 v101, v19, v120
    v_lshlrev_b32 v18, 16, v67
    v_and_b32 v19, 0xffff0000, v67
    v_fmac_f32 v102, v18, v120
    v_fmac_f32 v103, v19, v120
    s_waitcnt vmcnt(6)
    v_lshlrev_b32 v18, 16, v68
    v_and_b32 v19, 0xffff0000, v68
    v_fmac_f32 v96, v18, v121
    v_fmac_f32 v97, v19, v121
    v_lshlrev_b32 v18, 16, v69
    v_and_b32 v19, 0xffff0000, v69
    v_fmac_f32 v98, v18, v121
    v_fmac_f32 v99, v19, v121
    v_lshlrev_b32 v18, 16, v70
    v_and_b32 v19, 0xffff0000, v70
    v_fmac_f32 v100, v18, v121
    v_fmac_f32 v101, v19, v121
    v_lshlrev_b32 v18, 16, v71
    v_and_b32 v19, 0xffff0000, v71
    v_fmac_f32 v102, v18, v121
    v_fmac_f32 v103, v19, v121
    s_waitcnt vmcnt(5)
    v_lshlrev_b32 v18, 16, v72
    v_and_b32 v19, 0xffff0000, v72
    v_fmac_f32 v96, v18, v122
    v_fmac_f32 v97, v19, v122
    v_lshlrev_b32 v18, 16, v73
    v_and_b32 v19, 0xffff0000, v73
    v_fmac_f32 v98, v18, v122
    v_fmac_f32 v99, v19, v122
    v_lshlrev_b32 v18, 16, v74
    v_and_b32 v19, 0xffff0000, v74
    v_fmac_f32 v100, v18, v122
    v_fmac_f32 v101, v19, v122
    v_lshlrev_b32 v18, 16, v75
    v_and_b32 v19, 0xffff0000, v75
    v_fmac_f32 v102, v18, v122
    v_fmac_f32 v103, v19, v122
    s_waitcnt vmcnt(4)
    v_lshlrev_b32 v18, 16, v76
    v_and_b32 v19, 0xffff0000, v76
    v_fmac_f32 v96, v18, v123
    v_fmac_f32 v97, v19, v123
    v_lshlrev_b32 v18, 16, v77
    v_and_b32 v19, 0xffff0000, v77
    v_fmac_f32 v98, v18, v123
    v_fmac_f32 v99, v19, v123
    v_lshlrev_b32 v18, 16, v78
    v_and_b32 v19, 0xffff0000, v78
    v_fmac_f32 v100, v18, v123
    v_fmac_f32 v101, v19, v123
    v_lshlrev_b32 v18, 16, v79
    v_and_b32 v19, 0xffff0000, v79
    v_fmac_f32 v102, v18, v123
    v_fmac_f32 v103, v19, v123
    s_waitcnt vmcnt(3)
    v_lshlrev_b32 v18, 16, v80
    v_and_b32 v19, 0xffff0000, v80
    v_fmac_f32 v96, v18, v124
    v_fmac_f32 v97, v19, v124
    v_lshlrev_b32 v18, 16, v81
    v_and_b32 v19, 0xffff0000, v81
    v_fmac_f32 v98, v18, v124
    v_fmac_f32 v99, v19, v124
    v_lshlrev_b32 v18, 16, v82
    v_and_b32 v19, 0xffff0000, v82
    v_fmac_f32 v100, v18, v124
    v_fmac_f32 v101, v19, v124
    v_lshlrev_b32 v18, 16, v83
    v_and_b32 v19, 0xffff0000, v83
    v_fmac_f32 v102, v18, v124
    v_fmac_f32 v103, v19, v124
    s_waitcnt vmcnt(2)
    v_lshlrev_b32 v18, 16, v84
    v_and_b32 v19, 0xffff0000, v84
    v_fmac_f32 v96, v18, v125
    v_fmac_f32 v97, v19, v125
    v_lshlrev_b32 v18, 16, v85
    v_and_b32 v19, 0xffff0000, v85
    v_fmac_f32 v98, v18, v125
    v_fmac_f32 v99, v19, v125
    v_lshlrev_b32 v18, 16, v86
    v_and_b32 v19, 0xffff0000, v86
    v_fmac_f32 v100, v18, v125
    v_fmac_f32 v101, v19, v125
    v_lshlrev_b32 v18, 16, v87
    v_and_b32 v19, 0xffff0000, v87
    v_fmac_f32 v102, v18, v125
    v_fmac_f32 v103, v19, v125
    s_waitcnt vmcnt(1)
    v_lshlrev_b32 v18, 16, v88
    v_and_b32 v19, 0xffff0000, v88
    v_fmac_f32 v96, v18, v126
    v_fmac_f32 v97, v19, v126
    v_lshlrev_b32 v18, 16, v89
    v_and_b32 v19, 0xffff0000, v89
    v_fmac_f32 v98, v18, v126
    v_fmac_f32 v99, v19, v126
    v_lshlrev_b32 v18, 16, v90
    v_and_b32 v19, 0xffff0000, v90
    v_fmac_f32 v100, v18, v126
    v_fmac_f32 v101, v19, v126
    v_lshlrev_b32 v18, 16, v91
    v_and_b32 v19, 0xffff0000, v91
    v_fmac_f32 v102, v18, v126
    v_fmac_f32 v103, v19, v126
    s_waitcnt vmcnt(0)
    v_lshlrev_b32 v18, 16, v92
    v_and_b32 v19, 0xffff0000, v92
    v_fmac_f32 v96, v18, v127
    v_fmac_f32 v97, v19, v127
    v_lshlrev_b32 v18, 16, v93
    v_and_b32 v19, 0xffff0000, v93
    v_fmac_f32 v98, v18, v127
    v_fmac_f32 v99, v19, v127
    v_lshlrev_b32 v18, 16, v94
    v_and_b32 v19, 0xffff0000, v94
    v_fmac_f32 v100, v18, v127
    v_fmac_f32 v101, v19, v127
    v_lshlrev_b32 v18, 16, v95
    v_and_b32 v19, 0xffff0000, v95
    v_fmac_f32 v102, v18, v127
    v_fmac_f32 v103, v19, v127
    v_lshlrev_b32 v16, 5, v0
    ds_write_b128 v16, v[96:99]
    ds_write_b128 v16, v[100:103] offset:16
    s_waitcnt lgkmcnt(0)
    s_barrier
    s_cmp_lg_u32 s44, 0
    s_cbranch_scc1 L_mod_fin_112
    v_mov_b32 v18, 0
    ds_read_b32 v32, v12 offset:0
    ds_read_b32 v33, v12 offset:256
    ds_read_b32 v34, v12 offset:512
    ds_read_b32 v35, v12 offset:768
    ds_read_b32 v36, v12 offset:1024
    ds_read_b32 v37, v12 offset:1280
    ds_read_b32 v38, v12 offset:1536
    ds_read_b32 v39, v12 offset:1792
    ds_read_b32 v40, v12 offset:2048
    ds_read_b32 v41, v12 offset:2304
    ds_read_b32 v42, v12 offset:2560
    ds_read_b32 v43, v12 offset:2816
    ds_read_b32 v44, v12 offset:3072
    ds_read_b32 v45, v12 offset:3328
    ds_read_b32 v46, v12 offset:3584
    ds_read_b32 v47, v12 offset:3840
    s_waitcnt lgkmcnt(0)
    v_add_f32 v18, v18, v32
    v_add_f32 v18, v18, v33
    v_add_f32 v18, v18, v34
    v_add_f32 v18, v18, v35
    v_add_f32 v18, v18, v36
    v_add_f32 v18, v18, v37
    v_add_f32 v18, v18, v38
    v_add_f32 v18, v18, v39
    v_add_f32 v18, v18, v40
    v_add_f32 v18, v18, v41
    v_add_f32 v18, v18, v42
    v_add_f32 v18, v18, v43
    v_add_f32 v18, v18, v44
    v_add_f32 v18, v18, v45
    v_add_f32 v18, v18, v46
    v_add_f32 v18, v18, v47
    ds_read_b32 v32, v12 offset:4096
    ds_read_b32 v33, v12 offset:4352
    ds_read_b32 v34, v12 offset:4608
    ds_read_b32 v35, v12 offset:4864
    ds_read_b32 v36, v12 offset:5120
    ds_read_b32 v37, v12 offset:5376
    ds_read_b32 v38, v12 offset:5632
    ds_read_b32 v39, v12 offset:5888
    ds_read_b32 v40, v12 offset:6144
    ds_read_b32 v41, v12 offset:6400
    ds_read_b32 v42, v12 offset:6656
    ds_read_b32 v43, v12 offset:6912
    ds_read_b32 v44, v12 offset:7168
    ds_read_b32 v45, v12 offset:7424
    ds_read_b32 v46, v12 offset:7680
    ds_read_b32 v47, v12 offset:7936
    s_waitcnt lgkmcnt(0)
    v_add_f32 v18, v18, v32
    v_add_f32 v18, v18, v33
    v_add_f32 v18, v18, v34
    v_add_f32 v18, v18, v35
    v_add_f32 v18, v18, v36
    v_add_f32 v18, v18, v37
    v_add_f32 v18, v18, v38
    v_add_f32 v18, v18, v39
    v_add_f32 v18, v18, v40
    v_add_f32 v18, v18, v41
    v_add_f32 v18, v18, v42
    v_add_f32 v18, v18, v43
    v_add_f32 v18, v18, v44
    v_add_f32 v18, v18, v45
    v_add_f32 v18, v18, v46
    v_add_f32 v18, v18, v47
    s_lshr_b32 s45, s39, 1
    s_lshl_b32 s45, s45, 8
    s_mul_i32 s46, s47, 24576
    s_add_u32 s45, s45, s46
    buffer_store_dword v18, v12, s[12:15], s45 offen sc1
L_mod_fin_112:
    s_waitcnt vmcnt(0)
    s_barrier
    s_cmp_lg_u32 s44, 0
    s_cbranch_scc1 L_cnt_113
    v_mov_b32 v30, 1
    v_mov_b32 v31, 0
    s_mov_b64 exec, 1
    buffer_atomic_add v30, v31, s[16:19], 0 offen offset:132 sc1
    s_mov_b64 exec, -1
L_cnt_113:
    s_branch L_w_roles_104
L_w_kv_103:
    s_lshl_b32 s45, s43, 3
    s_add_u32 s45, s45, 16
    s_load_dwordx2 s[6:7], s[0:1], s45
    s_waitcnt lgkmcnt(0)
    s_mov_b32 s24, s6
    s_and_b32 s25, s7, 0xffff
    s_mov_b32 s26, 0x800000
    s_mov_b32 s27, 0x00020000
    s_lshl_b32 s46, s41, 8
    s_barrier
    v_lshrrev_b32 v20, 4, v1
    s_lshl_b32 s45, s44, 2
    v_add_u32 v21, s45, v20
    s_mov_b32 s45, 8192
    v_mul_lo_u32 v21, v21, s45
    v_lshlrev_b32 v22, 2, v20
    v_and_b32 v23, 15, v1
    v_xor_b32 v22, v22, v23
    v_lshlrev_b32 v22, 4, v22
    v_add_u32 v21, v21, v22
    v_bfe_u32 v22, v1, 2, 2
    v_lshlrev_b32 v23, 3, v20
    v_add_u32 v23, v23, v22
    v_lshlrev_b32 v23, 8, v23
    v_xor_b32 v22, s44, v22
    v_lshlrev_b32 v22, 6, v22
    v_add_u32 v23, v23, v22
    v_and_b32 v22, 3, v1
    v_lshlrev_b32 v22, 4, v22
    v_add_u32 v23, v23, v22
    v_add_u32 v24, 65536, v23
    v_add_u32 v25, 131072, v23
    s_lshl_b32 s47, s44, 10
    s_add_u32 s45, s46, 0x0
    s_add_u32 m0, s47, 0
    s_nop 0
    buffer_load_dwordx4 v21, s[24:27], s45 offen  lds
    s_add_u32 s45, s46, 0x20000
    s_add_u32 m0, s47, 4096
    s_nop 0
    buffer_load_dwordx4 v21, s[24:27], s45 offen  lds
    s_add_u32 s45, s46, 0x40000
    s_add_u32 m0, s47, 8192
    s_nop 0
    buffer_load_dwordx4 v21, s[24:27], s45 offen  lds
    s_add_u32 s45, s46, 0x60000
    s_add_u32 m0, s47, 12288
    s_nop 0
    buffer_load_dwordx4 v21, s[24:27], s45 offen  lds
    s_add_u32 s45, s46, 0x80000
    s_add_u32 m0, s47, 16384
    s_nop 0
    buffer_load_dwordx4 v21, s[24:27], s45 offen  lds
    s_add_u32 s45, s46, 0xa0000
    s_add_u32 m0, s47, 20480
    s_nop 0
    buffer_load_dwordx4 v21, s[24:27], s45 offen  lds
    s_add_u32 s45, s46, 0xc0000
    s_add_u32 m0, s47, 24576
    s_nop 0
    buffer_load_dwordx4 v21, s[24:27], s45 offen  lds
    s_add_u32 s45, s46, 0xe0000
    s_add_u32 m0, s47, 28672
    s_nop 0
    buffer_load_dwordx4 v21, s[24:27], s45 offen  lds
    s_add_u32 s45, s46, 0x100000
    s_add_u32 m0, s47, 32768
    s_nop 0
    buffer_load_dwordx4 v21, s[24:27], s45 offen  lds
    s_add_u32 s45, s46, 0x120000
    s_add_u32 m0, s47, 36864
    s_nop 0
    buffer_load_dwordx4 v21, s[24:27], s45 offen  lds
    s_add_u32 s45, s46, 0x140000
    s_add_u32 m0, s47, 40960
    s_nop 0
    buffer_load_dwordx4 v21, s[24:27], s45 offen  lds
    s_add_u32 s45, s46, 0x160000
    s_add_u32 m0, s47, 45056
    s_nop 0
    buffer_load_dwordx4 v21, s[24:27], s45 offen  lds
    s_add_u32 s45, s46, 0x180000
    s_add_u32 m0, s47, 49152
    s_nop 0
    buffer_load_dwordx4 v21, s[24:27], s45 offen  lds
    s_add_u32 s45, s46, 0x1a0000
    s_add_u32 m0, s47, 53248
    s_nop 0
    buffer_load_dwordx4 v21, s[24:27], s45 offen  lds
    s_add_u32 s45, s46, 0x1c0000
    s_add_u32 m0, s47, 57344
    s_nop 0
    buffer_load_dwordx4 v21, s[24:27], s45 offen  lds
    s_add_u32 s45, s46, 0x1e0000
    s_add_u32 m0, s47, 61440
    s_nop 0
    buffer_load_dwordx4 v21, s[24:27], s45 offen  lds
    s_add_u32 s45, s46, 0x200000
    s_add_u32 m0, s47, 65536
    s_nop 0
    buffer_load_dwordx4 v21, s[24:27], s45 offen  lds
    s_add_u32 s45, s46, 0x220000
    s_add_u32 m0, s47, 69632
    s_nop 0
    buffer_load_dwordx4 v21, s[24:27], s45 offen  lds
    s_add_u32 s45, s46, 0x240000
    s_add_u32 m0, s47, 73728
    s_nop 0
    buffer_load_dwordx4 v21, s[24:27], s45 offen  lds
    s_add_u32 s45, s46, 0x260000
    s_add_u32 m0, s47, 77824
    s_nop 0
    buffer_load_dwordx4 v21, s[24:27], s45 offen  lds
    s_add_u32 s45, s46, 0x280000
    s_add_u32 m0, s47, 81920
    s_nop 0
    buffer_load_dwordx4 v21, s[24:27], s45 offen  lds
    s_add_u32 s45, s46, 0x2a0000
    s_add_u32 m0, s47, 86016
    s_nop 0
    buffer_load_dwordx4 v21, s[24:27], s45 offen  lds
    s_add_u32 s45, s46, 0x2c0000
    s_add_u32 m0, s47, 90112
    s_nop 0
    buffer_load_dwordx4 v21, s[24:27], s45 offen  lds
    s_add_u32 s45, s46, 0x2e0000
    s_add_u32 m0, s47, 94208
    s_nop 0
    buffer_load_dwordx4 v21, s[24:27], s45 offen  lds
    s_add_u32 s45, s46, 0x300000
    s_add_u32 m0, s47, 98304
    s_nop 0
    buffer_load_dwordx4 v21, s[24:27], s45 offen  lds
    s_add_u32 s45, s46, 0x320000
    s_add_u32 m0, s47, 102400
    s_nop 0
    buffer_load_dwordx4 v21, s[24:27], s45 offen  lds
    s_add_u32 s45, s46, 0x340000
    s_add_u32 m0, s47, 106496
    s_nop 0
    buffer_load_dwordx4 v21, s[24:27], s45 offen  lds
    s_add_u32 s45, s46, 0x360000
    s_add_u32 m0, s47, 110592
    s_nop 0
    buffer_load_dwordx4 v21, s[24:27], s45 offen  lds
    s_add_u32 s45, s46, 0x380000
    s_add_u32 m0, s47, 114688
    s_nop 0
    buffer_load_dwordx4 v21, s[24:27], s45 offen  lds
    s_add_u32 s45, s46, 0x3a0000
    s_add_u32 m0, s47, 118784
    s_nop 0
    buffer_load_dwordx4 v21, s[24:27], s45 offen  lds
    s_add_u32 s45, s46, 0x3c0000
    s_add_u32 m0, s47, 122880
    s_nop 0
    buffer_load_dwordx4 v21, s[24:27], s45 offen  lds
    s_add_u32 s45, s46, 0x3e0000
    s_add_u32 m0, s47, 126976
    s_nop 0
    buffer_load_dwordx4 v21, s[24:27], s45 offen  lds
    s_waitcnt vmcnt(28)
    s_barrier
    s_add_u32 s45, s46, 0x400000
    s_add_u32 m0, s47, 131072
    s_nop 0
    buffer_load_dwordx4 v21, s[24:27], s45 offen  lds
    s_add_u32 s45, s46, 0x420000
    s_add_u32 m0, s47, 135168
    s_nop 0
    buffer_load_dwordx4 v21, s[24:27], s45 offen  lds
    s_add_u32 s45, s46, 0x440000
    s_add_u32 m0, s47, 139264
    s_nop 0
    buffer_load_dwordx4 v21, s[24:27], s45 offen  lds
    s_add_u32 s45, s46, 0x460000
    s_add_u32 m0, s47, 143360
    s_nop 0
    buffer_load_dwordx4 v21, s[24:27], s45 offen  lds
    ds_read_b64_tr_b16 a[0:1], v23 offset:0
    ds_read_b64_tr_b16 a[2:3], v23 offset:1024
    ds_read_b64_tr_b16 a[4:5], v23 offset:8
    ds_read_b64_tr_b16 a[6:7], v23 offset:1032
    ds_read_b64_tr_b16 a[8:9], v23 offset:8192
    ds_read_b64_tr_b16 a[10:11], v23 offset:9216
    ds_read_b64_tr_b16 a[12:13], v23 offset:8200
    ds_read_b64_tr_b16 a[14:15], v23 offset:9224
    s_waitcnt lgkmcnt(0)
    s_waitcnt vmcnt(28)
    s_barrier
    s_add_u32 s45, s46, 0x480000
    s_add_u32 m0, s47, 0
    s_nop 0
    buffer_load_dwordx4 v21, s[24:27], s45 offen  lds
    s_add_u32 s45, s46, 0x4a0000
    s_add_u32 m0, s47, 4096
    s_nop 0
    buffer_load_dwordx4 v21, s[24:27], s45 offen  lds
    s_add_u32 s45, s46, 0x4c0000
    s_add_u32 m0, s47, 8192
    s_nop 0
    buffer_load_dwordx4 v21, s[24:27], s45 offen  lds
    s_add_u32 s45, s46, 0x4e0000
    s_add_u32 m0, s47, 12288
    s_nop 0
    buffer_load_dwordx4 v21, s[24:27], s45 offen  lds
    ds_read_b64_tr_b16 a[16:17], v23 offset:16384
    ds_read_b64_tr_b16 a[18:19], v23 offset:17408
    ds_read_b64_tr_b16 a[20:21], v23 offset:16392
    ds_read_b64_tr_b16 a[22:23], v23 offset:17416
    ds_read_b64_tr_b16 a[24:25], v23 offset:24576
    ds_read_b64_tr_b16 a[26:27], v23 offset:25600
    ds_read_b64_tr_b16 a[28:29], v23 offset:24584
    ds_read_b64_tr_b16 a[30:31], v23 offset:25608
    s_waitcnt lgkmcnt(0)
    s_waitcnt vmcnt(28)
    s_barrier
    s_add_u32 s45, s46, 0x500000
    s_add_u32 m0, s47, 16384
    s_nop 0
    buffer_load_dwordx4 v21, s[24:27], s45 offen  lds
    s_add_u32 s45, s46, 0x520000
    s_add_u32 m0, s47, 20480
    s_nop 0
    buffer_load_dwordx4 v21, s[24:27], s45 offen  lds
    s_add_u32 s45, s46, 0x540000
    s_add_u32 m0, s47, 24576
    s_nop 0
    buffer_load_dwordx4 v21, s[24:27], s45 offen  lds
    s_add_u32 s45, s46, 0x560000
    s_add_u32 m0, s47, 28672
    s_nop 0
    buffer_load_dwordx4 v21, s[24:27], s45 offen  lds
    ds_read_b64_tr_b16 a[32:33], v23 offset:32768
    ds_read_b64_tr_b16 a[34:35], v23 offset:33792
    ds_read_b64_tr_b16 a[36:37], v23 offset:32776
    ds_read_b64_tr_b16 a[38:39], v23 offset:33800
    ds_read_b64_tr_b16 a[40:41], v23 offset:40960
    ds_read_b64_tr_b16 a[42:43], v23 offset:41984
    ds_read_b64_tr_b16 a[44:45], v23 offset:40968
    ds_read_b64_tr_b16 a[46:47], v23 offset:41992
    s_waitcnt lgkmcnt(0)
    s_waitcnt vmcnt(28)
    s_barrier
    s_add_u32 s45, s46, 0x580000
    s_add_u32 m0, s47, 32768
    s_nop 0
    buffer_load_dwordx4 v21, s[24:27], s45 offen  lds
    s_add_u32 s45, s46, 0x5a0000
    s_add_u32 m0, s47, 36864
    s_nop 0
    buffer_load_dwordx4 v21, s[24:27], s45 offen  lds
    s_add_u32 s45, s46, 0x5c0000
    s_add_u32 m0, s47, 40960
    s_nop 0
    buffer_load_dwordx4 v21, s[24:27], s45 offen  lds
    s_add_u32 s45, s46, 0x5e0000
    s_add_u32 m0, s47, 45056
    s_nop 0
    buffer_load_dwordx4 v21, s[24:27], s45 offen  lds
    ds_read_b64_tr_b16 a[48:49], v23 offset:49152
    ds_read_b64_tr_b16 a[50:51], v23 offset:50176
    ds_read_b64_tr_b16 a[52:53], v23 offset:49160
    ds_read_b64_tr_b16 a[54:55], v23 offset:50184
    ds_read_b64_tr_b16 a[56:57], v23 offset:57344
    ds_read_b64_tr_b16 a[58:59], v23 offset:58368
    ds_read_b64_tr_b16 a[60:61], v23 offset:57352
    ds_read_b64_tr_b16 a[62:63], v23 offset:58376
    s_waitcnt lgkmcnt(0)
    s_waitcnt vmcnt(28)
    s_barrier
    s_add_u32 s45, s46, 0x600000
    s_add_u32 m0, s47, 49152
    s_nop 0
    buffer_load_dwordx4 v21, s[24:27], s45 offen  lds
    s_add_u32 s45, s46, 0x620000
    s_add_u32 m0, s47, 53248
    s_nop 0
    buffer_load_dwordx4 v21, s[24:27], s45 offen  lds
    s_add_u32 s45, s46, 0x640000
    s_add_u32 m0, s47, 57344
    s_nop 0
    buffer_load_dwordx4 v21, s[24:27], s45 offen  lds
    s_add_u32 s45, s46, 0x660000
    s_add_u32 m0, s47, 61440
    s_nop 0
    buffer_load_dwordx4 v21, s[24:27], s45 offen  lds
    ds_read_b64_tr_b16 a[64:65], v24 offset:0
    ds_read_b64_tr_b16 a[66:67], v24 offset:1024
    ds_read_b64_tr_b16 a[68:69], v24 offset:8
    ds_read_b64_tr_b16 a[70:71], v24 offset:1032
    ds_read_b64_tr_b16 a[72:73], v24 offset:8192
    ds_read_b64_tr_b16 a[74:75], v24 offset:9216
    ds_read_b64_tr_b16 a[76:77], v24 offset:8200
    ds_read_b64_tr_b16 a[78:79], v24 offset:9224
    s_waitcnt lgkmcnt(0)
    s_waitcnt vmcnt(28)
    s_barrier
    s_add_u32 s45, s46, 0x680000
    s_add_u32 m0, s47, 65536
    s_nop 0
    buffer_load_dwordx4 v21, s[24:27], s45 offen  lds
    s_add_u32 s45, s46, 0x6a0000
    s_add_u32 m0, s47, 69632
    s_nop 0
    buffer_load_dwordx4 v21, s[24:27], s45 offen  lds
    s_add_u32 s45, s46, 0x6c0000
    s_add_u32 m0, s47, 73728
    s_nop 0
    buffer_load_dwordx4 v21, s[24:27], s45 offen  lds
    s_add_u32 s45, s46, 0x6e0000
    s_add_u32 m0, s47, 77824
    s_nop 0
    buffer_load_dwordx4 v21, s[24:27], s45 offen  lds
    ds_read_b64_tr_b16 a[80:81], v24 offset:16384
    ds_read_b64_tr_b16 a[82:83], v24 offset:17408
    ds_read_b64_tr_b16 a[84:85], v24 offset:16392
    ds_read_b64_tr_b16 a[86:87], v24 offset:17416
    ds_read_b64_tr_b16 a[88:89], v24 offset:24576
    ds_read_b64_tr_b16 a[90:91], v24 offset:25600
    ds_read_b64_tr_b16 a[92:93], v24 offset:24584
    ds_read_b64_tr_b16 a[94:95], v24 offset:25608
    s_waitcnt lgkmcnt(0)
    s_waitcnt vmcnt(28)
    s_barrier
    s_add_u32 s45, s46, 0x700000
    s_add_u32 m0, s47, 81920
    s_nop 0
    buffer_load_dwordx4 v21, s[24:27], s45 offen  lds
    s_add_u32 s45, s46, 0x720000
    s_add_u32 m0, s47, 86016
    s_nop 0
    buffer_load_dwordx4 v21, s[24:27], s45 offen  lds
    s_add_u32 s45, s46, 0x740000
    s_add_u32 m0, s47, 90112
    s_nop 0
    buffer_load_dwordx4 v21, s[24:27], s45 offen  lds
    s_add_u32 s45, s46, 0x760000
    s_add_u32 m0, s47, 94208
    s_nop 0
    buffer_load_dwordx4 v21, s[24:27], s45 offen  lds
    ds_read_b64_tr_b16 a[96:97], v24 offset:32768
    ds_read_b64_tr_b16 a[98:99], v24 offset:33792
    ds_read_b64_tr_b16 a[100:101], v24 offset:32776
    ds_read_b64_tr_b16 a[102:103], v24 offset:33800
    ds_read_b64_tr_b16 a[104:105], v24 offset:40960
    ds_read_b64_tr_b16 a[106:107], v24 offset:41984
    ds_read_b64_tr_b16 a[108:109], v24 offset:40968
    ds_read_b64_tr_b16 a[110:111], v24 offset:41992
    s_waitcnt lgkmcnt(0)
    s_waitcnt vmcnt(28)
    s_barrier
    s_add_u32 s45, s46, 0x780000
    s_add_u32 m0, s47, 98304
    s_nop 0
    buffer_load_dwordx4 v21, s[24:27], s45 offen  lds
    s_add_u32 s45, s46, 0x7a0000
    s_add_u32 m0, s47, 102400
    s_nop 0
    buffer_load_dwordx4 v21, s[24:27], s45 offen  lds
    s_add_u32 s45, s46, 0x7c0000
    s_add_u32 m0, s47, 106496
    s_nop 0
    buffer_load_dwordx4 v21, s[24:27], s45 offen  lds
    s_add_u32 s45, s46, 0x7e0000
    s_add_u32 m0, s47, 110592
    s_nop 0
    buffer_load_dwordx4 v21, s[24:27], s45 offen  lds
    ds_read_b64_tr_b16 a[112:113], v24 offset:49152
    ds_read_b64_tr_b16 a[114:115], v24 offset:50176
    ds_read_b64_tr_b16 a[116:117], v24 offset:49160
    ds_read_b64_tr_b16 a[118:119], v24 offset:50184
    ds_read_b64_tr_b16 a[120:121], v24 offset:57344
    ds_read_b64_tr_b16 a[122:123], v24 offset:58368
    ds_read_b64_tr_b16 a[124:125], v24 offset:57352
    ds_read_b64_tr_b16 a[126:127], v24 offset:58376
    s_waitcnt lgkmcnt(0)
    s_waitcnt vmcnt(28)
    s_barrier
    ds_read_b64_tr_b16 a[128:129], v25 offset:0
    ds_read_b64_tr_b16 a[130:131], v25 offset:1024
    ds_read_b64_tr_b16 a[132:133], v25 offset:8
    ds_read_b64_tr_b16 a[134:135], v25 offset:1032
    ds_read_b64_tr_b16 a[136:137], v25 offset:8192
    ds_read_b64_tr_b16 a[138:139], v25 offset:9216
    ds_read_b64_tr_b16 a[140:141], v25 offset:8200
    ds_read_b64_tr_b16 a[142:143], v25 offset:9224
    s_waitcnt lgkmcnt(0)
    s_waitcnt vmcnt(24)
    s_barrier
    ds_read_b64_tr_b16 a[144:145], v23 offset:0
    ds_read_b64_tr_b16 a[146:147], v23 offset:1024
    ds_read_b64_tr_b16 a[148:149], v23 offset:8
    ds_read_b64_tr_b16 a[150:151], v23 offset:1032
    ds_read_b64_tr_b16 a[152:153], v23 offset:8192
    ds_read_b64_tr_b16 a[154:155], v23 offset:9216
    ds_read_b64_tr_b16 a[156:157], v23 offset:8200
    ds_read_b64_tr_b16 a[158:159], v23 offset:9224
    s_waitcnt lgkmcnt(0)
    s_waitcnt vmcnt(20)
    s_barrier
    ds_read_b64_tr_b16 a[160:161], v23 offset:16384
    ds_read_b64_tr_b16 a[162:163], v23 offset:17408
    ds_read_b64_tr_b16 a[164:165], v23 offset:16392
    ds_read_b64_tr_b16 a[166:167], v23 offset:17416
    ds_read_b64_tr_b16 a[168:169], v23 offset:24576
    ds_read_b64_tr_b16 a[170:171], v23 offset:25600
    ds_read_b64_tr_b16 a[172:173], v23 offset:24584
    ds_read_b64_tr_b16 a[174:175], v23 offset:25608
    s_waitcnt lgkmcnt(0)
    s_waitcnt vmcnt(16)
    s_barrier
    ds_read_b64_tr_b16 a[176:177], v23 offset:32768
    ds_read_b64_tr_b16 a[178:179], v23 offset:33792
    ds_read_b64_tr_b16 a[180:181], v23 offset:32776
    ds_read_b64_tr_b16 a[182:183], v23 offset:33800
    ds_read_b64_tr_b16 a[184:185], v23 offset:40960
    ds_read_b64_tr_b16 a[186:187], v23 offset:41984
    ds_read_b64_tr_b16 a[188:189], v23 offset:40968
    ds_read_b64_tr_b16 a[190:191], v23 offset:41992
    s_waitcnt lgkmcnt(0)
    s_waitcnt vmcnt(12)
    s_barrier
    ds_read_b64_tr_b16 a[192:193], v23 offset:49152
    ds_read_b64_tr_b16 a[194:195], v23 offset:50176
    ds_read_b64_tr_b16 a[196:197], v23 offset:49160
    ds_read_b64_tr_b16 a[198:199], v23 offset:50184
    ds_read_b64_tr_b16 a[200:201], v23 offset:57344
    ds_read_b64_tr_b16 a[202:203], v23 offset:58368
    ds_read_b64_tr_b16 a[204:205], v23 offset:57352
    ds_read_b64_tr_b16 a[206:207], v23 offset:58376
    s_waitcnt lgkmcnt(0)
    s_waitcnt vmcnt(8)
    s_barrier
    ds_read_b64_tr_b16 a[208:209], v24 offset:0
    ds_read_b64_tr_b16 a[210:211], v24 offset:1024
    ds_read_b64_tr_b16 a[212:213], v24 offset:8
    ds_read_b64_tr_b16 a[214:215], v24 offset:1032
    ds_read_b64_tr_b16 a[216:217], v24 offset:8192
    ds_read_b64_tr_b16 a[218:219], v24 offset:9216
    ds_read_b64_tr_b16 a[220:221], v24 offset:8200
    ds_read_b64_tr_b16 a[222:223], v24 offset:9224
    s_waitcnt lgkmcnt(0)
    s_waitcnt vmcnt(4)
    s_barrier
    ds_read_b64_tr_b16 a[224:225], v24 offset:16384
    ds_read_b64_tr_b16 a[226:227], v24 offset:17408
    ds_read_b64_tr_b16 a[228:229], v24 offset:16392
    ds_read_b64_tr_b16 a[230:231], v24 offset:17416
    ds_read_b64_tr_b16 a[232:233], v24 offset:24576
    ds_read_b64_tr_b16 a[234:235], v24 offset:25600
    ds_read_b64_tr_b16 a[236:237], v24 offset:24584
    ds_read_b64_tr_b16 a[238:239], v24 offset:25608
    s_waitcnt lgkmcnt(0)
    s_waitcnt vmcnt(0)
    s_barrier
    ds_read_b64_tr_b16 a[240:241], v24 offset:32768
    ds_read_b64_tr_b16 a[242:243], v24 offset:33792
    ds_read_b64_tr_b16 a[244:245], v24 offset:32776
    ds_read_b64_tr_b16 a[246:247], v24 offset:33800
    ds_read_b64_tr_b16 a[248:249], v24 offset:40960
    ds_read_b64_tr_b16 a[250:251], v24 offset:41984
    ds_read_b64_tr_b16 a[252:253], v24 offset:40968
    ds_read_b64_tr_b16 a[254:255], v24 offset:41992
    s_waitcnt lgkmcnt(0)
    s_barrier
    s_mov_b32 s60, 0
    s_mov_b32 s51, 1
    s_mov_b32 s71, 64
    s_mov_b32 s52, 0x400000
    s_lshl_b32 s56, s39, 19
    s_add_u32 s56, s56, 0x2000000
L_w_qkv_114:
    s_cmp_lg_u32 s44, 0
    s_cbranch_scc1 L_pd_115
    v_mov_b32 v29, s71
    s_mov_b32 s46, 96
    s_mov_b64 exec, 1
    s_mov_b32 s70, 0
L_wp_116:
    buffer_load_dword v31, v29, s[16:19], 0 offen sc1
    s_add_u32 s70, s70, 1
    s_cmp_ge_u32 s70, 0x200000
    s_cbranch_scc1 L_w_done_102
    s_waitcnt vmcnt(0)
    v_cmp_gt_u32 vcc, s46, v31
    s_nop 1
    s_cbranch_vccz L_wp_116_ok
    s_sleep 3
    s_branch L_wp_116
L_wp_116_ok:
    s_mov_b64 exec, -1
L_pd_115:
    s_barrier
    s_mov_b32 s50, s60
    s_mul_i32 s53, s50, 65536
    s_add_u32 s53, s53, s52
    s_lshl_b32 s54, s44, 13
    s_add_u32 s53, s53, s54
    s_mul_i32 s57, s50, 8192
    s_add_u32 s57, s57, s56
    s_lshl_b32 s45, s44, 11
    s_add_u32 s57, s57, s45
    s_add_u32 s55, s54, 65536
    s_mov_b32 s58, 0
    v_mov_b32 v13, v3
    v_add_u32 v14, 65536, v13
    v_xor_b32 v15, 64, v13
    v_xor_b32 v16, 64, v14
    s_mov_b32 s76, 0x20000000
    s_add_u32 s48, s53, 0
    s_add_u32 s49, s48, 4096
    s_add_u32 m0, s54, 0
    s_nop 0
    buffer_load_dwordx4 v6, s[12:15], s48 offen offset:0 sc1 lds
    s_add_u32 m0, s54, 1024
    s_nop 0
    buffer_load_dwordx4 v9, s[12:15], s48 offen offset:0 sc1 lds
    s_add_u32 m0, s54, 2048
    s_nop 0
    buffer_load_dwordx4 v6, s[12:15], s49 offen offset:0 sc1 lds
    s_add_u32 m0, s54, 3072
    s_nop 0
    buffer_load_dwordx4 v9, s[12:15], s49 offen offset:0 sc1 lds
    s_add_u32 m0, s54, 3968
    s_nop 0
    buffer_load_dwordx4 v6, s[12:15], s48 offen offset:128 sc1 lds
    s_add_u32 m0, s54, 4992
    s_nop 0
    buffer_load_dwordx4 v9, s[12:15], s48 offen offset:128 sc1 lds
    s_add_u32 m0, s54, 6016
    s_nop 0
    buffer_load_dwordx4 v6, s[12:15], s49 offen offset:128 sc1 lds
    s_add_u32 m0, s54, 7040
    s_nop 0
    buffer_load_dwordx4 v9, s[12:15], s49 offen offset:128 sc1 lds
    s_add_u32 s48, s53, 32768
    s_add_u32 s49, s48, 4096
    s_add_u32 s46, s54, 32768
    s_add_u32 m0, s46, 0
    s_nop 0
    buffer_load_dwordx4 v6, s[12:15], s48 offen offset:0 sc1 lds
    s_add_u32 m0, s46, 1024
    s_nop 0
    buffer_load_dwordx4 v9, s[12:15], s48 offen offset:0 sc1 lds
    s_add_u32 m0, s46, 2048
    s_nop 0
    buffer_load_dwordx4 v6, s[12:15], s49 offen offset:0 sc1 lds
    s_add_u32 m0, s46, 3072
    s_nop 0
    buffer_load_dwordx4 v9, s[12:15], s49 offen offset:0 sc1 lds
    s_add_u32 m0, s46, 3968
    s_nop 0
    buffer_load_dwordx4 v6, s[12:15], s48 offen offset:128 sc1 lds
    s_add_u32 m0, s46, 4992
    s_nop 0
    buffer_load_dwordx4 v9, s[12:15], s48 offen offset:128 sc1 lds
    s_add_u32 m0, s46, 6016
    s_nop 0
    buffer_load_dwordx4 v6, s[12:15], s49 offen offset:128 sc1 lds
    s_add_u32 m0, s46, 7040
    s_nop 0
    buffer_load_dwordx4 v9, s[12:15], s49 offen offset:128 sc1 lds
    s_add_u32 s48, s53, 65536
    s_cmp_gt_u32 s51, 1
    s_cselect_b32 s48, s48, 0x20000000
    s_add_u32 s49, s48, 4096
    s_add_u32 m0, s55, 0
    s_nop 0
    buffer_load_dwordx4 v6, s[12:15], s48 offen offset:0 sc1 lds
    s_add_u32 m0, s55, 1024
    s_nop 0
    buffer_load_dwordx4 v9, s[12:15], s48 offen offset:0 sc1 lds
    s_add_u32 m0, s55, 2048
    s_nop 0
    buffer_load_dwordx4 v6, s[12:15], s49 offen offset:0 sc1 lds
    s_add_u32 m0, s55, 3072
    s_nop 0
    buffer_load_dwordx4 v9, s[12:15], s49 offen offset:0 sc1 lds
    s_add_u32 m0, s55, 3968
    s_nop 0
    buffer_load_dwordx4 v6, s[12:15], s48 offen offset:128 sc1 lds
    s_add_u32 m0, s55, 4992
    s_nop 0
    buffer_load_dwordx4 v9, s[12:15], s48 offen offset:128 sc1 lds
    s_add_u32 m0, s55, 6016
    s_nop 0
    buffer_load_dwordx4 v6, s[12:15], s49 offen offset:128 sc1 lds
    s_add_u32 m0, s55, 7040
    s_nop 0
    buffer_load_dwordx4 v9, s[12:15], s49 offen offset:128 sc1 lds
    s_waitcnt vmcnt(16)
    s_barrier
    ds_read_b128 v[32:35], v13 offset:0
    ds_read_b128 v[36:39], v13 offset:2048
    ds_read_b128 v[40:43], v15 offset:0
    ds_read_b128 v[44:47], v15 offset:2048
L_e_loop_117:
    s_add_u32 s48, s53, 98304
    s_add_u32 s46, s58, 1
    s_cmp_lt_u32 s46, s51
    s_cselect_b32 s48, s48, 0x20000000
    s_add_u32 s49, s48, 4096
    s_add_u32 s59, s55, 32768
    s_waitcnt lgkmcnt(2)
    v_mfma_f32_16x16x32_bf16 v[80:83], a[0:3], v[32:35], 0
    ds_read_b128 v[48:51], v13 offset:4096
    ds_read_b128 v[52:55], v13 offset:6144
    v_mfma_f32_16x16x32_bf16 v[84:87], a[4:7], v[32:35], 0
    ds_read_b128 v[56:59], v15 offset:4096
    ds_read_b128 v[60:63], v15 offset:6144
    v_mfma_f32_16x16x32_bf16 v[88:91], a[0:3], v[36:39], 0
    s_add_u32 m0, s59, 0
    s_nop 0
    buffer_load_dwordx4 v6, s[12:15], s48 offen offset:0 sc1 lds
    v_mfma_f32_16x16x32_bf16 v[92:95], a[4:7], v[36:39], 0
    s_waitcnt lgkmcnt(4)
    v_mfma_f32_16x16x32_bf16 v[80:83], a[8:11], v[40:43], v[80:83]
    ds_read_b128 v[32:35], v13 offset:8192
    ds_read_b128 v[36:39], v13 offset:10240
    v_mfma_f32_16x16x32_bf16 v[84:87], a[12:15], v[40:43], v[84:87]
    v_mfma_f32_16x16x32_bf16 v[88:91], a[8:11], v[44:47], v[88:91]
    s_add_u32 m0, s59, 1024
    s_nop 0
    buffer_load_dwordx4 v9, s[12:15], s48 offen offset:0 sc1 lds
    v_mfma_f32_16x16x32_bf16 v[92:95], a[12:15], v[44:47], v[92:95]
    s_waitcnt lgkmcnt(4)
    v_mfma_f32_16x16x32_bf16 v[80:83], a[16:19], v[48:51], v[80:83]
    ds_read_b128 v[40:43], v15 offset:8192
    ds_read_b128 v[44:47], v15 offset:10240
    v_mfma_f32_16x16x32_bf16 v[84:87], a[20:23], v[48:51], v[84:87]
    v_mfma_f32_16x16x32_bf16 v[88:91], a[16:19], v[52:55], v[88:91]
    s_add_u32 m0, s59, 2048
    s_nop 0
    buffer_load_dwordx4 v6, s[12:15], s49 offen offset:0 sc1 lds
    v_mfma_f32_16x16x32_bf16 v[92:95], a[20:23], v[52:55], v[92:95]
    s_waitcnt lgkmcnt(4)
    v_mfma_f32_16x16x32_bf16 v[80:83], a[24:27], v[56:59], v[80:83]
    ds_read_b128 v[48:51], v13 offset:12288
    ds_read_b128 v[52:55], v13 offset:14336
    v_mfma_f32_16x16x32_bf16 v[84:87], a[28:31], v[56:59], v[84:87]
    v_mfma_f32_16x16x32_bf16 v[88:91], a[24:27], v[60:63], v[88:91]
    s_add_u32 m0, s59, 3072
    s_nop 0
    buffer_load_dwordx4 v9, s[12:15], s49 offen offset:0 sc1 lds
    v_mfma_f32_16x16x32_bf16 v[92:95], a[28:31], v[60:63], v[92:95]
    s_waitcnt lgkmcnt(4)
    v_mfma_f32_16x16x32_bf16 v[80:83], a[32:35], v[32:35], v[80:83]
    ds_read_b128 v[56:59], v15 offset:12288
    ds_read_b128 v[60:63], v15 offset:14336
    v_mfma_f32_16x16x32_bf16 v[84:87], a[36:39], v[32:35], v[84:87]
    v_mfma_f32_16x16x32_bf16 v[88:91], a[32:35], v[36:39], v[88:91]
    s_add_u32 m0, s59, 3968
    s_nop 0
    buffer_load_dwordx4 v6, s[12:15], s48 offen offset:128 sc1 lds
    v_mfma_f32_16x16x32_bf16 v[92:95], a[36:39], v[36:39], v[92:95]
    s_waitcnt lgkmcnt(4)
    v_mfma_f32_16x16x32_bf16 v[80:83], a[40:43], v[40:43], v[80:83]
    ds_read_b128 v[32:35], v13 offset:16384
    ds_read_b128 v[36:39], v13 offset:18432
    v_mfma_f32_16x16x32_bf16 v[84:87], a[44:47], v[40:43], v[84:87]
    v_mfma_f32_16x16x32_bf16 v[88:91], a[40:43], v[44:47], v[88:91]
    s_add_u32 m0, s59, 4992
    s_nop 0
    buffer_load_dwordx4 v9, s[12:15], s48 offen offset:128 sc1 lds
    v_mfma_f32_16x16x32_bf16 v[92:95], a[44:47], v[44:47], v[92:95]
    s_waitcnt lgkmcnt(4)
    v_mfma_f32_16x16x32_bf16 v[80:83], a[48:51], v[48:51], v[80:83]
    ds_read_b128 v[40:43], v15 offset:16384
    ds_read_b128 v[44:47], v15 offset:18432
    v_mfma_f32_16x16x32_bf16 v[84:87], a[52:55], v[48:51], v[84:87]
    v_mfma_f32_16x16x32_bf16 v[88:91], a[48:51], v[52:55], v[88:91]
    s_add_u32 m0, s59, 6016
    s_nop 0
    buffer_load_dwordx4 v6, s[12:15], s49 offen offset:128 sc1 lds
    v_mfma_f32_16x16x32_bf16 v[92:95], a[52:55], v[52:55], v[92:95]
    s_waitcnt lgkmcnt(4)
    v_mfma_f32_16x16x32_bf16 v[80:83], a[56:59], v[56:59], v[80:83]
    ds_read_b128 v[48:51], v13 offset:20480
    ds_read_b128 v[52:55], v13 offset:22528
    v_mfma_f32_16x16x32_bf16 v[84:87], a[60:63], v[56:59], v[84:87]
    v_mfma_f32_16x16x32_bf16 v[88:91], a[56:59], v[60:63], v[88:91]
    s_add_u32 m0, s59, 7040
    s_nop 0
    buffer_load_dwordx4 v9, s[12:15], s49 offen offset:128 sc1 lds
    v_mfma_f32_16x16x32_bf16 v[92:95], a[60:63], v[60:63], v[92:95]
    s_waitcnt lgkmcnt(4)
    v_mfma_f32_16x16x32_bf16 v[80:83], a[64:67], v[32:35], v[80:83]
    ds_read_b128 v[56:59], v15 offset:20480
    ds_read_b128 v[60:63], v15 offset:22528
    v_mfma_f32_16x16x32_bf16 v[84:87], a[68:71], v[32:35], v[84:87]
    v_mfma_f32_16x16x32_bf16 v[88:91], a[64:67], v[36:39], v[88:91]
    v_mfma_f32_16x16x32_bf16 v[92:95], a[68:71], v[36:39], v[92:95]
    s_waitcnt lgkmcnt(4)
    v_mfma_f32_16x16x32_bf16 v[80:83], a[72:75], v[40:43], v[80:83]
    ds_read_b128 v[32:35], v13 offset:24576
    ds_read_b128 v[36:39], v13 offset:26624
    v_mfma_f32_16x16x32_bf16 v[84:87], a[76:79], v[40:43], v[84:87]
    v_mfma_f32_16x16x32_bf16 v[88:91], a[72:75], v[44:47], v[88:91]
    v_mfma_f32_16x16x32_bf16 v[92:95], a[76:79], v[44:47], v[92:95]
    s_waitcnt lgkmcnt(4)
    v_mfma_f32_16x16x32_bf16 v[80:83], a[80:83], v[48:51], v[80:83]
    ds_read_b128 v[40:43], v15 offset:24576
    ds_read_b128 v[44:47], v15 offset:26624
    v_mfma_f32_16x16x32_bf16 v[84:87], a[84:87], v[48:51], v[84:87]
    v_mfma_f32_16x16x32_bf16 v[88:91], a[80:83], v[52:55], v[88:91]
    v_mfma_f32_16x16x32_bf16 v[92:95], a[84:87], v[52:55], v[92:95]
    s_waitcnt lgkmcnt(4)
    v_mfma_f32_16x16x32_bf16 v[80:83], a[88:91], v[56:59], v[80:83]
    ds_read_b128 v[48:51], v13 offset:28672
    ds_read_b128 v[52:55], v13 offset:30720
    v_mfma_f32_16x16x32_bf16 v[84:87], a[92:95], v[56:59], v[84:87]
    v_mfma_f32_16x16x32_bf16 v[88:91], a[88:91], v[60:63], v[88:91]
    v_mfma_f32_16x16x32_bf16 v[92:95], a[92:95], v[60:63], v[92:95]
    s_waitcnt lgkmcnt(4)
    v_mfma_f32_16x16x32_bf16 v[80:83], a[96:99], v[32:35], v[80:83]
    ds_read_b128 v[56:59], v15 offset:28672
    ds_read_b128 v[60:63], v15 offset:30720
    v_mfma_f32_16x16x32_bf16 v[84:87], a[100:103], v[32:35], v[84:87]
    v_mfma_f32_16x16x32_bf16 v[88:91], a[96:99], v[36:39], v[88:91]
    v_mfma_f32_16x16x32_bf16 v[92:95], a[100:103], v[36:39], v[92:95]
    s_waitcnt lgkmcnt(4)
    v_mfma_f32_16x16x32_bf16 v[80:83], a[104:107], v[40:43], v[80:83]
    v_mfma_f32_16x16x32_bf16 v[84:87], a[108:111], v[40:43], v[84:87]
    v_mfma_f32_16x16x32_bf16 v[88:91], a[104:107], v[44:47], v[88:91]
    v_mfma_f32_16x16x32_bf16 v[92:95], a[108:111], v[44:47], v[92:95]
    s_waitcnt vmcnt(16) lgkmcnt(0)
    s_barrier
    v_mfma_f32_16x16x32_bf16 v[80:83], a[112:115], v[48:51], v[80:83]
    ds_read_b128 v[32:35], v13 offset:32768
    ds_read_b128 v[36:39], v13 offset:34816
    v_mfma_f32_16x16x32_bf16 v[84:87], a[116:119], v[48:51], v[84:87]
    v_mfma_f32_16x16x32_bf16 v[88:91], a[112:115], v[52:55], v[88:91]
    v_mfma_f32_16x16x32_bf16 v[92:95], a[116:119], v[52:55], v[92:95]
    v_mfma_f32_16x16x32_bf16 v[80:83], a[120:123], v[56:59], v[80:83]
    ds_read_b128 v[40:43], v15 offset:32768
    ds_read_b128 v[44:47], v15 offset:34816
    v_mfma_f32_16x16x32_bf16 v[84:87], a[124:127], v[56:59], v[84:87]
    v_mfma_f32_16x16x32_bf16 v[88:91], a[120:123], v[60:63], v[88:91]
    v_mfma_f32_16x16x32_bf16 v[92:95], a[124:127], v[60:63], v[92:95]
    s_add_u32 s48, s53, 131072
    s_add_u32 s46, s58, 2
    s_cmp_lt_u32 s46, s51
    s_cselect_b32 s48, s48, 0x20000000
    s_add_u32 s49, s48, 4096
    s_mov_b32 s59, s54
    s_waitcnt lgkmcnt(2)
    v_mfma_f32_16x16x32_bf16 v[80:83], a[128:131], v[32:35], v[80:83]
    ds_read_b128 v[48:51], v13 offset:36864
    ds_read_b128 v[52:55], v13 offset:38912
    v_mfma_f32_16x16x32_bf16 v[84:87], a[132:135], v[32:35], v[84:87]
    ds_read_b128 v[56:59], v15 offset:36864
    ds_read_b128 v[60:63], v15 offset:38912
    v_mfma_f32_16x16x32_bf16 v[88:91], a[128:131], v[36:39], v[88:91]
    s_add_u32 m0, s59, 0
    s_nop 0
    buffer_load_dwordx4 v6, s[12:15], s48 offen offset:0 sc1 lds
    v_mfma_f32_16x16x32_bf16 v[92:95], a[132:135], v[36:39], v[92:95]
    s_waitcnt lgkmcnt(4)
    v_mfma_f32_16x16x32_bf16 v[80:83], a[136:139], v[40:43], v[80:83]
    ds_read_b128 v[32:35], v13 offset:40960
    ds_read_b128 v[36:39], v13 offset:43008
    v_mfma_f32_16x16x32_bf16 v[84:87], a[140:143], v[40:43], v[84:87]
    v_mfma_f32_16x16x32_bf16 v[88:91], a[136:139], v[44:47], v[88:91]
    s_add_u32 m0, s59, 1024
    s_nop 0
    buffer_load_dwordx4 v9, s[12:15], s48 offen offset:0 sc1 lds
    v_mfma_f32_16x16x32_bf16 v[92:95], a[140:143], v[44:47], v[92:95]
    s_waitcnt lgkmcnt(4)
    v_mfma_f32_16x16x32_bf16 v[80:83], a[144:147], v[48:51], v[80:83]
    ds_read_b128 v[40:43], v15 offset:40960
    ds_read_b128 v[44:47], v15 offset:43008
    v_mfma_f32_16x16x32_bf16 v[84:87], a[148:151], v[48:51], v[84:87]
    v_mfma_f32_16x16x32_bf16 v[88:91], a[144:147], v[52:55], v[88:91]
    s_add_u32 m0, s59, 2048
    s_nop 0
    buffer_load_dwordx4 v6, s[12:15], s49 offen offset:0 sc1 lds
    v_mfma_f32_16x16x32_bf16 v[92:95], a[148:151], v[52:55], v[92:95]
    s_waitcnt lgkmcnt(4)
    v_mfma_f32_16x16x32_bf16 v[80:83], a[152:155], v[56:59], v[80:83]
    ds_read_b128 v[48:51], v13 offset:45056
    ds_read_b128 v[52:55], v13 offset:47104
    v_mfma_f32_16x16x32_bf16 v[84:87], a[156:159], v[56:59], v[84:87]
    v_mfma_f32_16x16x32_bf16 v[88:91], a[152:155], v[60:63], v[88:91]
    s_add_u32 m0, s59, 3072
    s_nop 0
    buffer_load_dwordx4 v9, s[12:15], s49 offen offset:0 sc1 lds
    v_mfma_f32_16x16x32_bf16 v[92:95], a[156:159], v[60:63], v[92:95]
    s_waitcnt lgkmcnt(4)
    v_mfma_f32_16x16x32_bf16 v[80:83], a[160:163], v[32:35], v[80:83]
    ds_read_b128 v[56:59], v15 offset:45056
    ds_read_b128 v[60:63], v15 offset:47104
    v_mfma_f32_16x16x32_bf16 v[84:87], a[164:167], v[32:35], v[84:87]
    v_mfma_f32_16x16x32_bf16 v[88:91], a[160:163], v[36:39], v[88:91]
    s_add_u32 m0, s59, 3968
    s_nop 0
    buffer_load_dwordx4 v6, s[12:15], s48 offen offset:128 sc1 lds
    v_mfma_f32_16x16x32_bf16 v[92:95], a[164:167], v[36:39], v[92:95]
    s_waitcnt lgkmcnt(4)
    v_mfma_f32_16x16x32_bf16 v[80:83], a[168:171], v[40:43], v[80:83]
    ds_read_b128 v[32:35], v13 offset:49152
    ds_read_b128 v[36:39], v13 offset:51200
    v_mfma_f32_16x16x32_bf16 v[84:87], a[172:175], v[40:43], v[84:87]
    v_mfma_f32_16x16x32_bf16 v[88:91], a[168:171], v[44:47], v[88:91]
    s_add_u32 m0, s59, 4992
    s_nop 0
    buffer_load_dwordx4 v9, s[12:15], s48 offen offset:128 sc1 lds
    v_mfma_f32_16x16x32_bf16 v[92:95], a[172:175], v[44:47], v[92:95]
    s_waitcnt lgkmcnt(4)
    v_mfma_f32_16x16x32_bf16 v[80:83], a[176:179], v[48:51], v[80:83]
    ds_read_b128 v[40:43], v15 offset:49152
    ds_read_b128 v[44:47], v15 offset:51200
    v_mfma_f32_16x16x32_bf16 v[84:87], a[180:183], v[48:51], v[84:87]
    v_mfma_f32_16x16x32_bf16 v[88:91], a[176:179], v[52:55], v[88:91]
    s_add_u32 m0, s59, 6016
    s_nop 0
    buffer_load_dwordx4 v6, s[12:15], s49 offen offset:128 sc1 lds
    v_mfma_f32_16x16x32_bf16 v[92:95], a[180:183], v[52:55], v[92:95]
    s_waitcnt lgkmcnt(4)
    v_mfma_f32_16x16x32_bf16 v[80:83], a[184:187], v[56:59], v[80:83]
    ds_read_b128 v[48:51], v13 offset:53248
    ds_read_b128 v[52:55], v13 offset:55296
    v_mfma_f32_16x16x32_bf16 v[84:87], a[188:191], v[56:59], v[84:87]
    v_mfma_f32_16x16x32_bf16 v[88:91], a[184:187], v[60:63], v[88:91]
    s_add_u32 m0, s59, 7040
    s_nop 0
    buffer_load_dwordx4 v9, s[12:15], s49 offen offset:128 sc1 lds
    v_mfma_f32_16x16x32_bf16 v[92:95], a[188:191], v[60:63], v[92:95]
    s_waitcnt lgkmcnt(4)
    v_mfma_f32_16x16x32_bf16 v[80:83], a[192:195], v[32:35], v[80:83]
    ds_read_b128 v[56:59], v15 offset:53248
    ds_read_b128 v[60:63], v15 offset:55296
    v_mfma_f32_16x16x32_bf16 v[84:87], a[196:199], v[32:35], v[84:87]
    v_mfma_f32_16x16x32_bf16 v[88:91], a[192:195], v[36:39], v[88:91]
    v_mfma_f32_16x16x32_bf16 v[92:95], a[196:199], v[36:39], v[92:95]
    s_waitcnt lgkmcnt(4)
    v_mfma_f32_16x16x32_bf16 v[80:83], a[200:203], v[40:43], v[80:83]
    ds_read_b128 v[32:35], v13 offset:57344
    ds_read_b128 v[36:39], v13 offset:59392
    v_mfma_f32_16x16x32_bf16 v[84:87], a[204:207], v[40:43], v[84:87]
    v_mfma_f32_16x16x32_bf16 v[88:91], a[200:203], v[44:47], v[88:91]
    v_mfma_f32_16x16x32_bf16 v[92:95], a[204:207], v[44:47], v[92:95]
    s_waitcnt lgkmcnt(4)
    v_mfma_f32_16x16x32_bf16 v[80:83], a[208:211], v[48:51], v[80:83]
    ds_read_b128 v[40:43], v15 offset:57344
    ds_read_b128 v[44:47], v15 offset:59392
    v_mfma_f32_16x16x32_bf16 v[84:87], a[212:215], v[48:51], v[84:87]
    v_mfma_f32_16x16x32_bf16 v[88:91], a[208:211], v[52:55], v[88:91]
    v_mfma_f32_16x16x32_bf16 v[92:95], a[212:215], v[52:55], v[92:95]
    s_waitcnt lgkmcnt(4)
    v_mfma_f32_16x16x32_bf16 v[80:83], a[216:219], v[56:59], v[80:83]
    ds_read_b128 v[48:51], v13 offset:61440
    ds_read_b128 v[52:55], v13 offset:63488
    v_mfma_f32_16x16x32_bf16 v[84:87], a[220:223], v[56:59], v[84:87]
    v_mfma_f32_16x16x32_bf16 v[88:91], a[216:219], v[60:63], v[88:91]
    v_mfma_f32_16x16x32_bf16 v[92:95], a[220:223], v[60:63], v[92:95]
    s_waitcnt lgkmcnt(4)
    v_mfma_f32_16x16x32_bf16 v[80:83], a[224:227], v[32:35], v[80:83]
    ds_read_b128 v[56:59], v15 offset:61440
    ds_read_b128 v[60:63], v15 offset:63488
    v_mfma_f32_16x16x32_bf16 v[84:87], a[228:231], v[32:35], v[84:87]
    v_mfma_f32_16x16x32_bf16 v[88:91], a[224:227], v[36:39], v[88:91]
    v_mfma_f32_16x16x32_bf16 v[92:95], a[228:231], v[36:39], v[92:95]
    s_waitcnt lgkmcnt(4)
    v_mfma_f32_16x16x32_bf16 v[80:83], a[232:235], v[40:43], v[80:83]
    v_mfma_f32_16x16x32_bf16 v[84:87], a[236:239], v[40:43], v[84:87]
    v_mfma_f32_16x16x32_bf16 v[88:91], a[232:235], v[44:47], v[88:91]
    v_mfma_f32_16x16x32_bf16 v[92:95], a[236:239], v[44:47], v[92:95]
    s_waitcnt vmcnt(16) lgkmcnt(0)
    s_barrier
    s_cmp_lg_u32 s44, 0
    s_cbranch_scc1 L_e_pr_118
    s_add_u32 s45, s58, s60
    v_mov_b32 v30, s45
    v_mov_b32 v31, 0
    s_mov_b64 exec, 1
    buffer_store_dword v30, v31, s[12:15], s61 offen sc1
    s_mov_b64 exec, -1
L_e_pr_118:
    v_mfma_f32_16x16x32_bf16 v[80:83], a[240:243], v[48:51], v[80:83]
    ds_read_b128 v[32:35], v14 offset:0
    ds_read_b128 v[36:39], v14 offset:2048
    v_mfma_f32_16x16x32_bf16 v[84:87], a[244:247], v[48:51], v[84:87]
    v_mfma_f32_16x16x32_bf16 v[88:91], a[240:243], v[52:55], v[88:91]
    v_mfma_f32_16x16x32_bf16 v[92:95], a[244:247], v[52:55], v[92:95]
    v_mfma_f32_16x16x32_bf16 v[80:83], a[248:251], v[56:59], v[80:83]
    ds_read_b128 v[40:43], v16 offset:0
    ds_read_b128 v[44:47], v16 offset:2048
    v_mfma_f32_16x16x32_bf16 v[84:87], a[252:255], v[56:59], v[84:87]
    v_mfma_f32_16x16x32_bf16 v[88:91], a[248:251], v[60:63], v[88:91]
    v_mfma_f32_16x16x32_bf16 v[92:95], a[252:255], v[60:63], v[92:95]
    s_add_u32 s53, s53, 65536
    s_add_u32 s58, s58, 1
    v_swap_b32 v13, v14
    s_xor_b32 s54, s54, 65536
    s_xor_b32 s55, s55, 65536
    s_mov_b32 s76, s57
    v_swap_b32 v15, v16
    s_add_u32 s57, s57, 8192
    v_cvt_pk_bf16_f32 v216, v80, v81
    v_cvt_pk_bf16_f32 v217, v82, v83
    v_cvt_pk_bf16_f32 v218, v84, v85
    v_cvt_pk_bf16_f32 v219, v86, v87
    v_cvt_pk_bf16_f32 v220, v88, v89
    v_cvt_pk_bf16_f32 v221, v90, v91
    v_cvt_pk_bf16_f32 v222, v92, v93
    v_cvt_pk_bf16_f32 v223, v94, v95
    buffer_store_dwordx4 v[216:219], v10, s[12:15], s76 offen sc1
    buffer_store_dwordx4 v[220:223], v10, s[12:15], s76 offen offset:1024 sc1
    s_cmp_lt_u32 s58, s51
    s_cbranch_scc1 L_e_loop_117
    s_waitcnt lgkmcnt(0)
    s_add_u32 s60, s60, s51
    s_waitcnt vmcnt(0)
    s_barrier
    s_cmp_lg_u32 s44, 0
    s_cbranch_scc1 L_pub_119
    v_mov_b32 v30, s60
    v_mov_b32 v31, 0
    s_mov_b64 exec, 1
    buffer_store_dword v30, v31, s[12:15], s61 offen sc1
    s_mov_b64 exec, -1
L_pub_119:
    s_cmp_eq_u32 s60, 1
    s_cselect_b32 s51, 11, 52
    s_cselect_b32 s71, s71, 196
    s_cmp_lt_u32 s60, 64
    s_cbranch_scc1 L_w_qkv_114
L_w_roles_104:
    s_mov_b32 s36, 0x10111111
    s_mov_b32 s37, 0x91081010
    s_cmp_eq_u32 s42, 0
    s_cselect_b32 s36, s36, 0x1000000
    s_cselect_b32 s37, s37, 0x44410101
    s_mov_b32 s72, 0x88888888
    s_mov_b32 s73, 0xeaa48888
    s_lshr_b32 s38, s41, 3
    s_and_b32 s68, s41, 7
    s_cmp_eq_u32 s43, 1
    s_cbranch_scc1 L_role_b_120
    s_cmp_eq_u32 s43, 2
    s_cbranch_scc1 L_role_c_121
    s_load_dwordx2 s[6:7], s[0:1], 40
    s_waitcnt lgkmcnt(0)
    s_mov_b32 s24, s6
    s_and_b32 s25, s7, 0xffff
    s_mov_b32 s26, 0x800000
    s_mov_b32 s27, 0x00020000
    s_lshl_b32 s46, s38, 21
    s_lshl_b32 s45, s68, 8
    s_add_u32 s46, s46, s45
    s_waitcnt vmcnt(0)
    s_barrier
    v_lshrrev_b32 v20, 4, v1
    s_lshl_b32 s45, s44, 2
    v_add_u32 v21, s45, v20
    s_mov_b32 s45, 2048
    v_mul_lo_u32 v21, v21, s45
    v_lshlrev_b32 v22, 2, v20
    v_and_b32 v23, 15, v1
    v_xor_b32 v22, v22, v23
    v_lshlrev_b32 v22, 4, v22
    v_add_u32 v21, v21, v22
    v_bfe_u32 v22, v1, 2, 2
    v_lshlrev_b32 v23, 2, v20
    v_add_u32 v23, v23, v22
    v_lshlrev_b32 v23, 8, v23
    v_xor_b32 v22, s44, v22
    v_lshlrev_b32 v22, 6, v22
    v_add_u32 v23, v23, v22
    v_and_b32 v22, 3, v1
    v_lshlrev_b32 v22, 3, v22
    v_add_u32 v23, v23, v22
    v_add_u32 v24, 65536, v23
    v_add_u32 v25, 131072, v23
    s_lshl_b32 s47, s44, 10
    s_add_u32 s45, s46, 0x0
    s_add_u32 m0, s47, 0
    s_nop 0
    buffer_load_dwordx4 v21, s[24:27], s45 offen  lds
    s_add_u32 s45, s46, 0x8000
    s_add_u32 m0, s47, 4096
    s_nop 0
    buffer_load_dwordx4 v21, s[24:27], s45 offen  lds
    s_add_u32 s45, s46, 0x10000
    s_add_u32 m0, s47, 8192
    s_nop 0
    buffer_load_dwordx4 v21, s[24:27], s45 offen  lds
    s_add_u32 s45, s46, 0x18000
    s_add_u32 m0, s47, 12288
    s_nop 0
    buffer_load_dwordx4 v21, s[24:27], s45 offen  lds
    s_add_u32 s45, s46, 0x20000
    s_add_u32 m0, s47, 16384
    s_nop 0
    buffer_load_dwordx4 v21, s[24:27], s45 offen  lds
    s_add_u32 s45, s46, 0x28000
    s_add_u32 m0, s47, 20480
    s_nop 0
    buffer_load_dwordx4 v21, s[24:27], s45 offen  lds
    s_add_u32 s45, s46, 0x30000
    s_add_u32 m0, s47, 24576
    s_nop 0
    buffer_load_dwordx4 v21, s[24:27], s45 offen  lds
    s_add_u32 s45, s46, 0x38000
    s_add_u32 m0, s47, 28672
    s_nop 0
    buffer_load_dwordx4 v21, s[24:27], s45 offen  lds
    s_add_u32 s45, s46, 0x40000
    s_add_u32 m0, s47, 32768
    s_nop 0
    buffer_load_dwordx4 v21, s[24:27], s45 offen  lds
    s_add_u32 s45, s46, 0x48000
    s_add_u32 m0, s47, 36864
    s_nop 0
    buffer_load_dwordx4 v21, s[24:27], s45 offen  lds
    s_add_u32 s45, s46, 0x50000
    s_add_u32 m0, s47, 40960
    s_nop 0
    buffer_load_dwordx4 v21, s[24:27], s45 offen  lds
    s_add_u32 s45, s46, 0x58000
    s_add_u32 m0, s47, 45056
    s_nop 0
    buffer_load_dwordx4 v21, s[24:27], s45 offen  lds
    s_add_u32 s45, s46, 0x60000
    s_add_u32 m0, s47, 49152
    s_nop 0
    buffer_load_dwordx4 v21, s[24:27], s45 offen  lds
    s_add_u32 s45, s46, 0x68000
    s_add_u32 m0, s47, 53248
    s_nop 0
    buffer_load_dwordx4 v21, s[24:27], s45 offen  lds
    s_add_u32 s45, s46, 0x70000
    s_add_u32 m0, s47, 57344
    s_nop 0
    buffer_load_dwordx4 v21, s[24:27], s45 offen  lds
    s_add_u32 s45, s46, 0x78000
    s_add_u32 m0, s47, 61440
    s_nop 0
    buffer_load_dwordx4 v21, s[24:27], s45 offen  lds
    s_add_u32 s45, s46, 0x80000
    s_add_u32 m0, s47, 65536
    s_nop 0
    buffer_load_dwordx4 v21, s[24:27], s45 offen  lds
    s_add_u32 s45, s46, 0x88000
    s_add_u32 m0, s47, 69632
    s_nop 0
    buffer_load_dwordx4 v21, s[24:27], s45 offen  lds
    s_add_u32 s45, s46, 0x90000
    s_add_u32 m0, s47, 73728
    s_nop 0
    buffer_load_dwordx4 v21, s[24:27], s45 offen  lds
    s_add_u32 s45, s46, 0x98000
    s_add_u32 m0, s47, 77824
    s_nop 0
    buffer_load_dwordx4 v21, s[24:27], s45 offen  lds
    s_add_u32 s45, s46, 0xa0000
    s_add_u32 m0, s47, 81920
    s_nop 0
    buffer_load_dwordx4 v21, s[24:27], s45 offen  lds
    s_add_u32 s45, s46, 0xa8000
    s_add_u32 m0, s47, 86016
    s_nop 0
    buffer_load_dwordx4 v21, s[24:27], s45 offen  lds
    s_add_u32 s45, s46, 0xb0000
    s_add_u32 m0, s47, 90112
    s_nop 0
    buffer_load_dwordx4 v21, s[24:27], s45 offen  lds
    s_add_u32 s45, s46, 0xb8000
    s_add_u32 m0, s47, 94208
    s_nop 0
    buffer_load_dwordx4 v21, s[24:27], s45 offen  lds
    s_add_u32 s45, s46, 0xc0000
    s_add_u32 m0, s47, 98304
    s_nop 0
    buffer_load_dwordx4 v21, s[24:27], s45 offen  lds
    s_add_u32 s45, s46, 0xc8000
    s_add_u32 m0, s47, 102400
    s_nop 0
    buffer_load_dwordx4 v21, s[24:27], s45 offen  lds
    s_add_u32 s45, s46, 0xd0000
    s_add_u32 m0, s47, 106496
    s_nop 0
    buffer_load_dwordx4 v21, s[24:27], s45 offen  lds
    s_add_u32 s45, s46, 0xd8000
    s_add_u32 m0, s47, 110592
    s_nop 0
    buffer_load_dwordx4 v21, s[24:27], s45 offen  lds
    s_add_u32 s45, s46, 0xe0000
    s_add_u32 m0, s47, 114688
    s_nop 0
    buffer_load_dwordx4 v21, s[24:27], s45 offen  lds
    s_add_u32 s45, s46, 0xe8000
    s_add_u32 m0, s47, 118784
    s_nop 0
    buffer_load_dwordx4 v21, s[24:27], s45 offen  lds
    s_add_u32 s45, s46, 0xf0000
    s_add_u32 m0, s47, 122880
    s_nop 0
    buffer_load_dwordx4 v21, s[24:27], s45 offen  lds
    s_add_u32 s45, s46, 0xf8000
    s_add_u32 m0, s47, 126976
    s_nop 0
    buffer_load_dwordx4 v21, s[24:27], s45 offen  lds
    s_waitcnt vmcnt(28)
    s_barrier
    s_add_u32 s45, s46, 0x100000
    s_add_u32 m0, s47, 131072
    s_nop 0
    buffer_load_dwordx4 v21, s[24:27], s45 offen  lds
    s_add_u32 s45, s46, 0x108000
    s_add_u32 m0, s47, 135168
    s_nop 0
    buffer_load_dwordx4 v21, s[24:27], s45 offen  lds
    s_add_u32 s45, s46, 0x110000
    s_add_u32 m0, s47, 139264
    s_nop 0
    buffer_load_dwordx4 v21, s[24:27], s45 offen  lds
    s_add_u32 s45, s46, 0x118000
    s_add_u32 m0, s47, 143360
    s_nop 0
    buffer_load_dwordx4 v21, s[24:27], s45 offen  lds
    ds_read_b64_tr_b16 a[0:1], v23 offset:0
    ds_read_b64_tr_b16 a[2:3], v23 offset:4096
    ds_read_b64_tr_b16 a[4:5], v23 offset:32
    ds_read_b64_tr_b16 a[6:7], v23 offset:4128
    ds_read_b64_tr_b16 a[8:9], v23 offset:8192
    ds_read_b64_tr_b16 a[10:11], v23 offset:12288
    ds_read_b64_tr_b16 a[12:13], v23 offset:8224
    ds_read_b64_tr_b16 a[14:15], v23 offset:12320
    s_waitcnt lgkmcnt(0)
    s_waitcnt vmcnt(28)
    s_barrier
    s_add_u32 s45, s46, 0x120000
    s_add_u32 m0, s47, 0
    s_nop 0
    buffer_load_dwordx4 v21, s[24:27], s45 offen  lds
    s_add_u32 s45, s46, 0x128000
    s_add_u32 m0, s47, 4096
    s_nop 0
    buffer_load_dwordx4 v21, s[24:27], s45 offen  lds
    s_add_u32 s45, s46, 0x130000
    s_add_u32 m0, s47, 8192
    s_nop 0
    buffer_load_dwordx4 v21, s[24:27], s45 offen  lds
    s_add_u32 s45, s46, 0x138000
    s_add_u32 m0, s47, 12288
    s_nop 0
    buffer_load_dwordx4 v21, s[24:27], s45 offen  lds
    ds_read_b64_tr_b16 a[16:17], v23 offset:16384
    ds_read_b64_tr_b16 a[18:19], v23 offset:20480
    ds_read_b64_tr_b16 a[20:21], v23 offset:16416
    ds_read_b64_tr_b16 a[22:23], v23 offset:20512
    ds_read_b64_tr_b16 a[24:25], v23 offset:24576
    ds_read_b64_tr_b16 a[26:27], v23 offset:28672
    ds_read_b64_tr_b16 a[28:29], v23 offset:24608
    ds_read_b64_tr_b16 a[30:31], v23 offset:28704
    s_waitcnt lgkmcnt(0)
    s_waitcnt vmcnt(28)
    s_barrier
    s_add_u32 s45, s46, 0x140000
    s_add_u32 m0, s47, 16384
    s_nop 0
    buffer_load_dwordx4 v21, s[24:27], s45 offen  lds
    s_add_u32 s45, s46, 0x148000
    s_add_u32 m0, s47, 20480
    s_nop 0
    buffer_load_dwordx4 v21, s[24:27], s45 offen  lds
    s_add_u32 s45, s46, 0x150000
    s_add_u32 m0, s47, 24576
    s_nop 0
    buffer_load_dwordx4 v21, s[24:27], s45 offen  lds
    s_add_u32 s45, s46, 0x158000
    s_add_u32 m0, s47, 28672
    s_nop 0
    buffer_load_dwordx4 v21, s[24:27], s45 offen  lds
    ds_read_b64_tr_b16 a[32:33], v23 offset:32768
    ds_read_b64_tr_b16 a[34:35], v23 offset:36864
    ds_read_b64_tr_b16 a[36:37], v23 offset:32800
    ds_read_b64_tr_b16 a[38:39], v23 offset:36896
    ds_read_b64_tr_b16 a[40:41], v23 offset:40960
    ds_read_b64_tr_b16 a[42:43], v23 offset:45056
    ds_read_b64_tr_b16 a[44:45], v23 offset:40992
    ds_read_b64_tr_b16 a[46:47], v23 offset:45088
    s_waitcnt lgkmcnt(0)
    s_waitcnt vmcnt(28)
    s_barrier
    s_add_u32 s45, s46, 0x160000
    s_add_u32 m0, s47, 32768
    s_nop 0
    buffer_load_dwordx4 v21, s[24:27], s45 offen  lds
    s_add_u32 s45, s46, 0x168000
    s_add_u32 m0, s47, 36864
    s_nop 0
    buffer_load_dwordx4 v21, s[24:27], s45 offen  lds
    s_add_u32 s45, s46, 0x170000
    s_add_u32 m0, s47, 40960
    s_nop 0
    buffer_load_dwordx4 v21, s[24:27], s45 offen  lds
    s_add_u32 s45, s46, 0x178000
    s_add_u32 m0, s47, 45056
    s_nop 0
    buffer_load_dwordx4 v21, s[24:27], s45 offen  lds
    ds_read_b64_tr_b16 a[48:49], v23 offset:49152
    ds_read_b64_tr_b16 a[50:51], v23 offset:53248
    ds_read_b64_tr_b16 a[52:53], v23 offset:49184
    ds_read_b64_tr_b16 a[54:55], v23 offset:53280
    ds_read_b64_tr_b16 a[56:57], v23 offset:57344
    ds_read_b64_tr_b16 a[58:59], v23 offset:61440
    ds_read_b64_tr_b16 a[60:61], v23 offset:57376
    ds_read_b64_tr_b16 a[62:63], v23 offset:61472
    s_waitcnt lgkmcnt(0)
    s_waitcnt vmcnt(28)
    s_barrier
    s_add_u32 s45, s46, 0x180000
    s_add_u32 m0, s47, 49152
    s_nop 0
    buffer_load_dwordx4 v21, s[24:27], s45 offen  lds
    s_add_u32 s45, s46, 0x188000
    s_add_u32 m0, s47, 53248
    s_nop 0
    buffer_load_dwordx4 v21, s[24:27], s45 offen  lds
    s_add_u32 s45, s46, 0x190000
    s_add_u32 m0, s47, 57344
    s_nop 0
    buffer_load_dwordx4 v21, s[24:27], s45 offen  lds
    s_add_u32 s45, s46, 0x198000
    s_add_u32 m0, s47, 61440
    s_nop 0
    buffer_load_dwordx4 v21, s[24:27], s45 offen  lds
    ds_read_b64_tr_b16 a[64:65], v24 offset:0
    ds_read_b64_tr_b16 a[66:67], v24 offset:4096
    ds_read_b64_tr_b16 a[68:69], v24 offset:32
    ds_read_b64_tr_b16 a[70:71], v24 offset:4128
    ds_read_b64_tr_b16 a[72:73], v24 offset:8192
    ds_read_b64_tr_b16 a[74:75], v24 offset:12288
    ds_read_b64_tr_b16 a[76:77], v24 offset:8224
    ds_read_b64_tr_b16 a[78:79], v24 offset:12320
    s_waitcnt lgkmcnt(0)
    s_waitcnt vmcnt(28)
    s_barrier
    s_add_u32 s45, s46, 0x1a0000
    s_add_u32 m0, s47, 65536
    s_nop 0
    buffer_load_dwordx4 v21, s[24:27], s45 offen  lds
    s_add_u32 s45, s46, 0x1a8000
    s_add_u32 m0, s47, 69632
    s_nop 0
    buffer_load_dwordx4 v21, s[24:27], s45 offen  lds
    s_add_u32 s45, s46, 0x1b0000
    s_add_u32 m0, s47, 73728
    s_nop 0
    buffer_load_dwordx4 v21, s[24:27], s45 offen  lds
    s_add_u32 s45, s46, 0x1b8000
    s_add_u32 m0, s47, 77824
    s_nop 0
    buffer_load_dwordx4 v21, s[24:27], s45 offen  lds
    ds_read_b64_tr_b16 a[80:81], v24 offset:16384
    ds_read_b64_tr_b16 a[82:83], v24 offset:20480
    ds_read_b64_tr_b16 a[84:85], v24 offset:16416
    ds_read_b64_tr_b16 a[86:87], v24 offset:20512
    ds_read_b64_tr_b16 a[88:89], v24 offset:24576
    ds_read_b64_tr_b16 a[90:91], v24 offset:28672
    ds_read_b64_tr_b16 a[92:93], v24 offset:24608
    ds_read_b64_tr_b16 a[94:95], v24 offset:28704
    s_waitcnt lgkmcnt(0)
    s_waitcnt vmcnt(28)
    s_barrier
    s_add_u32 s45, s46, 0x1c0000
    s_add_u32 m0, s47, 81920
    s_nop 0
    buffer_load_dwordx4 v21, s[24:27], s45 offen  lds
    s_add_u32 s45, s46, 0x1c8000
    s_add_u32 m0, s47, 86016
    s_nop 0
    buffer_load_dwordx4 v21, s[24:27], s45 offen  lds
    s_add_u32 s45, s46, 0x1d0000
    s_add_u32 m0, s47, 90112
    s_nop 0
    buffer_load_dwordx4 v21, s[24:27], s45 offen  lds
    s_add_u32 s45, s46, 0x1d8000
    s_add_u32 m0, s47, 94208
    s_nop 0
    buffer_load_dwordx4 v21, s[24:27], s45 offen  lds
    ds_read_b64_tr_b16 a[96:97], v24 offset:32768
    ds_read_b64_tr_b16 a[98:99], v24 offset:36864
    ds_read_b64_tr_b16 a[100:101], v24 offset:32800
    ds_read_b64_tr_b16 a[102:103], v24 offset:36896
    ds_read_b64_tr_b16 a[104:105], v24 offset:40960
    ds_read_b64_tr_b16 a[106:107], v24 offset:45056
    ds_read_b64_tr_b16 a[108:109], v24 offset:40992
    ds_read_b64_tr_b16 a[110:111], v24 offset:45088
    s_waitcnt lgkmcnt(0)
    s_waitcnt vmcnt(28)
    s_barrier
    s_add_u32 s45, s46, 0x1e0000
    s_add_u32 m0, s47, 98304
    s_nop 0
    buffer_load_dwordx4 v21, s[24:27], s45 offen  lds
    s_add_u32 s45, s46, 0x1e8000
    s_add_u32 m0, s47, 102400
    s_nop 0
    buffer_load_dwordx4 v21, s[24:27], s45 offen  lds
    s_add_u32 s45, s46, 0x1f0000
    s_add_u32 m0, s47, 106496
    s_nop 0
    buffer_load_dwordx4 v21, s[24:27], s45 offen  lds
    s_add_u32 s45, s46, 0x1f8000
    s_add_u32 m0, s47, 110592
    s_nop 0
    buffer_load_dwordx4 v21, s[24:27], s45 offen  lds
    ds_read_b64_tr_b16 a[112:113], v24 offset:49152
    ds_read_b64_tr_b16 a[114:115], v24 offset:53248
    ds_read_b64_tr_b16 a[116:117], v24 offset:49184
    ds_read_b64_tr_b16 a[118:119], v24 offset:53280
    ds_read_b64_tr_b16 a[120:121], v24 offset:57344
    ds_read_b64_tr_b16 a[122:123], v24 offset:61440
    ds_read_b64_tr_b16 a[124:125], v24 offset:57376
    ds_read_b64_tr_b16 a[126:127], v24 offset:61472
    s_waitcnt lgkmcnt(0)
    s_waitcnt vmcnt(28)
    s_barrier
    ds_read_b64_tr_b16 a[128:129], v25 offset:0
    ds_read_b64_tr_b16 a[130:131], v25 offset:4096
    ds_read_b64_tr_b16 a[132:133], v25 offset:32
    ds_read_b64_tr_b16 a[134:135], v25 offset:4128
    ds_read_b64_tr_b16 a[136:137], v25 offset:8192
    ds_read_b64_tr_b16 a[138:139], v25 offset:12288
    ds_read_b64_tr_b16 a[140:141], v25 offset:8224
    ds_read_b64_tr_b16 a[142:143], v25 offset:12320
    s_waitcnt lgkmcnt(0)
    s_waitcnt vmcnt(24)
    s_barrier
    ds_read_b64_tr_b16 a[144:145], v23 offset:0
    ds_read_b64_tr_b16 a[146:147], v23 offset:4096
    ds_read_b64_tr_b16 a[148:149], v23 offset:32
    ds_read_b64_tr_b16 a[150:151], v23 offset:4128
    ds_read_b64_tr_b16 a[152:153], v23 offset:8192
    ds_read_b64_tr_b16 a[154:155], v23 offset:12288
    ds_read_b64_tr_b16 a[156:157], v23 offset:8224
    ds_read_b64_tr_b16 a[158:159], v23 offset:12320
    s_waitcnt lgkmcnt(0)
    s_waitcnt vmcnt(20)
    s_barrier
    ds_read_b64_tr_b16 a[160:161], v23 offset:16384
    ds_read_b64_tr_b16 a[162:163], v23 offset:20480
    ds_read_b64_tr_b16 a[164:165], v23 offset:16416
    ds_read_b64_tr_b16 a[166:167], v23 offset:20512
    ds_read_b64_tr_b16 a[168:169], v23 offset:24576
    ds_read_b64_tr_b16 a[170:171], v23 offset:28672
    ds_read_b64_tr_b16 a[172:173], v23 offset:24608
    ds_read_b64_tr_b16 a[174:175], v23 offset:28704
    s_waitcnt lgkmcnt(0)
    s_waitcnt vmcnt(16)
    s_barrier
    ds_read_b64_tr_b16 a[176:177], v23 offset:32768
    ds_read_b64_tr_b16 a[178:179], v23 offset:36864
    ds_read_b64_tr_b16 a[180:181], v23 offset:32800
    ds_read_b64_tr_b16 a[182:183], v23 offset:36896
    ds_read_b64_tr_b16 a[184:185], v23 offset:40960
    ds_read_b64_tr_b16 a[186:187], v23 offset:45056
    ds_read_b64_tr_b16 a[188:189], v23 offset:40992
    ds_read_b64_tr_b16 a[190:191], v23 offset:45088
    s_waitcnt lgkmcnt(0)
    s_waitcnt vmcnt(12)
    s_barrier
    ds_read_b64_tr_b16 a[192:193], v23 offset:49152
    ds_read_b64_tr_b16 a[194:195], v23 offset:53248
    ds_read_b64_tr_b16 a[196:197], v23 offset:49184
    ds_read_b64_tr_b16 a[198:199], v23 offset:53280
    ds_read_b64_tr_b16 a[200:201], v23 offset:57344
    ds_read_b64_tr_b16 a[202:203], v23 offset:61440
    ds_read_b64_tr_b16 a[204:205], v23 offset:57376
    ds_read_b64_tr_b16 a[206:207], v23 offset:61472
    s_waitcnt lgkmcnt(0)
    s_waitcnt vmcnt(8)
    s_barrier
    ds_read_b64_tr_b16 a[208:209], v24 offset:0
    ds_read_b64_tr_b16 a[210:211], v24 offset:4096
    ds_read_b64_tr_b16 a[212:213], v24 offset:32
    ds_read_b64_tr_b16 a[214:215], v24 offset:4128
    ds_read_b64_tr_b16 a[216:217], v24 offset:8192
    ds_read_b64_tr_b16 a[218:219], v24 offset:12288
    ds_read_b64_tr_b16 a[220:221], v24 offset:8224
    ds_read_b64_tr_b16 a[222:223], v24 offset:12320
    s_waitcnt lgkmcnt(0)
    s_waitcnt vmcnt(4)
    s_barrier
    ds_read_b64_tr_b16 a[224:225], v24 offset:16384
    ds_read_b64_tr_b16 a[226:227], v24 offset:20480
    ds_read_b64_tr_b16 a[228:229], v24 offset:16416
    ds_read_b64_tr_b16 a[230:231], v24 offset:20512
    ds_read_b64_tr_b16 a[232:233], v24 offset:24576
    ds_read_b64_tr_b16 a[234:235], v24 offset:28672
    ds_read_b64_tr_b16 a[236:237], v24 offset:24608
    ds_read_b64_tr_b16 a[238:239], v24 offset:28704
    s_waitcnt lgkmcnt(0)
    s_waitcnt vmcnt(0)
    s_barrier
    ds_read_b64_tr_b16 a[240:241], v24 offset:32768
    ds_read_b64_tr_b16 a[242:243], v24 offset:36864
    ds_read_b64_tr_b16 a[244:245], v24 offset:32800
    ds_read_b64_tr_b16 a[246:247], v24 offset:36896
    ds_read_b64_tr_b16 a[248:249], v24 offset:40960
    ds_read_b64_tr_b16 a[250:251], v24 offset:45056
    ds_read_b64_tr_b16 a[252:253], v24 offset:40992
    ds_read_b64_tr_b16 a[254:255], v24 offset:45088
    s_waitcnt lgkmcnt(0)
    s_barrier
    s_lshl_b32 s52, s38, 16
    s_add_u32 s52, s52, 0x5000000
    s_lshl_b32 s56, s38, 23
    s_lshl_b32 s45, s68, 9
    s_add_u32 s56, s56, s45
    s_add_u32 s56, s56, 0x8000000
    s_cmp_lg_u32 s44, 0
    s_cbranch_scc1 L_pd_122
    v_mov_b32 v29, 4
    s_mov_b32 s46, 1073741824
    s_mov_b64 exec, 1
    s_mov_b32 s70, 0
L_wp_123:
    buffer_load_dword v31, v29, s[16:19], 0 offen sc1
    s_add_u32 s70, s70, 1
    s_cmp_ge_u32 s70, 0x200000
    s_cbranch_scc1 L_w_done_102
    s_waitcnt vmcnt(0)
    v_cmp_gt_u32 vcc, s46, v31
    s_nop 1
    s_cbranch_vccz L_wp_123_ok
    s_sleep 3
    s_branch L_wp_123
L_wp_123_ok:
    s_mov_b64 exec, -1
L_pd_122:
    s_barrier
L_a_loop_124:
    s_cmp_eq_u64 s[36:37], 0
    s_cbranch_scc1 L_w_done_102
    s_ff1_i32_b64 s50, s[36:37]
    s_bitset0_b64 s[36:37], s50
    s_lshr_b64 s[74:75], s[72:73], s50
    s_ff1_i32_b64 s51, s[74:75]
    s_add_u32 s51, s51, 1
    s_add_u32 s62, s50, s51
    s_add_u32 s63, s50, s44
    s_lshl_b32 s45, s41, 7
    s_add_u32 s45, s45, 0x10010
    s_cmp_lg_u32 s44, 0
    s_cbranch_scc1 L_pw_126
    s_mov_b64 exec, 7
    s_mov_b32 s70, 0
L_wp_127:
    buffer_load_dword v31, v12, s[12:15], s45 offen sc1
    s_add_u32 s70, s70, 1
    s_cmp_ge_u32 s70, 0x200000
    s_cbranch_scc1 L_w_done_102
    s_waitcnt vmcnt(0)
    v_cmp_gt_u32 vcc, s62, v31
    s_nop 1
    s_cbranch_vccz L_wp_127_ok
    s_sleep 2
    s_branch L_wp_127
L_wp_127_ok:
    s_mov_b64 exec, -1
L_pw_126:
    s_barrier
    s_cmp_ge_u32 s44, s51
    s_cbranch_scc1 L_xs1_128
    s_lshl_b32 s45, s41, 19
    s_lshl_b32 s46, s63, 13
    s_add_u32 s45, s45, s46
    s_add_u32 s45, s45, 0x2000000
    s_add_u32 s46, s45, 4096
    s_add_u32 s48, s45, 16777216
    s_add_u32 s49, s48, 4096
    s_add_u32 s76, s48, 16777216
    s_add_u32 s77, s76, 4096
    s_lshl_b32 s47, s44, 13
    s_mov_b32 m0, s47
    v_and_b32 v14, 15, v1
    v_lshrrev_b32 v16, 4, v1
    buffer_load_dwordx4 v10, s[12:15], s76 offen offset:0 sc1 lds
    buffer_load_dwordx4 v10, s[12:15], s76 offen offset:1024 sc1 lds
    buffer_load_dwordx4 v10, s[12:15], s76 offen offset:2048 sc1 lds
    buffer_load_dwordx4 v10, s[12:15], s76 offen offset:3072 sc1 lds
    s_add_u32 m0, s47, 4096
    s_nop 0
    buffer_load_dwordx4 v10, s[12:15], s77 offen offset:0 sc1 lds
    buffer_load_dwordx4 v10, s[12:15], s77 offen offset:1024 sc1 lds
    buffer_load_dwordx4 v10, s[12:15], s77 offen offset:2048 sc1 lds
    buffer_load_dwordx4 v10, s[12:15], s77 offen offset:3072 sc1 lds
    buffer_load_dwordx4 v[128:131], v10, s[12:15], s45 offen offset:0 sc1
    buffer_load_dwordx4 v[160:163], v10, s[12:15], s48 offen offset:0 sc1
    buffer_load_dwordx4 v[144:147], v10, s[12:15], s45 offen offset:1024 sc1
    buffer_load_dwordx4 v[176:179], v10, s[12:15], s48 offen offset:1024 sc1
    buffer_load_dwordx4 v[132:135], v10, s[12:15], s45 offen offset:2048 sc1
    buffer_load_dwordx4 v[164:167], v10, s[12:15], s48 offen offset:2048 sc1
    buffer_load_dwordx4 v[148:151], v10, s[12:15], s45 offen offset:3072 sc1
    buffer_load_dwordx4 v[180:183], v10, s[12:15], s48 offen offset:3072 sc1
    buffer_load_dwordx4 v[136:139], v10, s[12:15], s46 offen offset:0 sc1
    buffer_load_dwordx4 v[168:171], v10, s[12:15], s49 offen offset:0 sc1
    buffer_load_dwordx4 v[152:155], v10, s[12:15], s46 offen offset:1024 sc1
    buffer_load_dwordx4 v[184:187], v10, s[12:15], s49 offen offset:1024 sc1
    buffer_load_dwordx4 v[140:143], v10, s[12:15], s46 offen offset:2048 sc1
    buffer_load_dwordx4 v[172:175], v10, s[12:15], s49 offen offset:2048 sc1
    buffer_load_dwordx4 v[156:159], v10, s[12:15], s46 offen offset:3072 sc1
    buffer_load_dwordx4 v[188:191], v10, s[12:15], s49 offen offset:3072 sc1
    s_waitcnt vmcnt(0)
    v_mfma_f32_16x16x32_bf16 v[32:35], v[160:163], v[128:131], 0
    v_mfma_f32_16x16x32_bf16 v[36:39], v[160:163], v[144:147], 0
    v_mfma_f32_16x16x32_bf16 v[44:47], v[176:179], v[144:147], 0
    v_mfma_f32_16x16x32_bf16 v[32:35], v[164:167], v[132:135], v[32:35]
    v_mfma_f32_16x16x32_bf16 v[36:39], v[164:167], v[148:151], v[36:39]
    v_mfma_f32_16x16x32_bf16 v[44:47], v[180:183], v[148:151], v[44:47]
    v_mfma_f32_16x16x32_bf16 v[32:35], v[168:171], v[136:139], v[32:35]
    v_mfma_f32_16x16x32_bf16 v[36:39], v[168:171], v[152:155], v[36:39]
    v_mfma_f32_16x16x32_bf16 v[44:47], v[184:187], v[152:155], v[44:47]
    v_mfma_f32_16x16x32_bf16 v[32:35], v[172:175], v[140:143], v[32:35]
    v_mfma_f32_16x16x32_bf16 v[36:39], v[172:175], v[156:159], v[36:39]
    v_mfma_f32_16x16x32_bf16 v[44:47], v[188:191], v[156:159], v[44:47]
    v_lshlrev_b32 v19, 2, v16
    v_lshrrev_b32 v20, 2, v1
    v_lshlrev_b32 v20, 4, v20
    v_and_b32 v21, 1, v1
    v_lshlrev_b32 v21, 3, v21
    v_add3_u32 v20, v20, v21, s47
    v_and_b32 v21, 2, v1
    v_lshlrev_b32 v21, 7, v21
    v_add_u32 v20, v20, v21
    v_mov_b32 v22, 0xff800000
    ds_read_b64_tr_b16 v[208:209], v20 offset:0
    ds_read_b64_tr_b16 v[210:211], v20 offset:1024
    ds_read_b64_tr_b16 v[212:213], v20 offset:512
    ds_read_b64_tr_b16 v[214:215], v20 offset:1536
    ds_read_b64_tr_b16 v[216:217], v20 offset:2048
    ds_read_b64_tr_b16 v[218:219], v20 offset:3072
    ds_read_b64_tr_b16 v[220:221], v20 offset:2560
    ds_read_b64_tr_b16 v[222:223], v20 offset:3584
    ds_read_b64_tr_b16 v[224:225], v20 offset:4096
    ds_read_b64_tr_b16 v[226:227], v20 offset:5120
    ds_read_b64_tr_b16 v[228:229], v20 offset:4608
    ds_read_b64_tr_b16 v[230:231], v20 offset:5632
    ds_read_b64_tr_b16 v[232:233], v20 offset:6144
    ds_read_b64_tr_b16 v[234:235], v20 offset:7168
    ds_read_b64_tr_b16 v[236:237], v20 offset:6656
    ds_read_b64_tr_b16 v[238:239], v20 offset:7680
    v_add_u32 v21, 0, v19
    v_cmp_gt_u32 vcc, v21, v14
    s_nop 1
    v_cndmask_b32 v32, v32, v22, vcc
    v_cndmask_b32 v44, v44, v22, vcc
    v_add_u32 v21, 1, v19
    v_cmp_gt_u32 vcc, v21, v14
    s_nop 1
    v_cndmask_b32 v33, v33, v22, vcc
    v_cndmask_b32 v45, v45, v22, vcc
    v_add_u32 v21, 2, v19
    v_cmp_gt_u32 vcc, v21, v14
    s_nop 1
    v_cndmask_b32 v34, v34, v22, vcc
    v_cndmask_b32 v46, v46, v22, vcc
    v_add_u32 v21, 3, v19
    v_cmp_gt_u32 vcc, v21, v14
    s_nop 1
    v_cndmask_b32 v35, v35, v22, vcc
    v_cndmask_b32 v47, v47, v22, vcc
L_xs1_128:
    s_lshl_b32 s45, s41, 7
    s_add_u32 s45, s45, 0x11000
    s_cmp_lg_u32 s44, 0
    s_cbranch_scc1 L_pw_130
    s_mov_b64 exec, 255
    s_mov_b32 s70, 0
L_wp_131:
    buffer_load_dword v31, v12, s[12:15], s45 offen sc1
    s_add_u32 s70, s70, 1
    s_cmp_ge_u32 s70, 0x200000
    s_cbranch_scc1 L_w_done_102
    s_waitcnt vmcnt(0)
    v_cmp_gt_u32 vcc, s62, v31
    s_nop 1
    s_cbranch_vccz L_wp_131_ok
    s_sleep 2
    s_branch L_wp_131
L_wp_131_ok:
    s_mov_b64 exec, -1
L_pw_130:
    s_barrier
    s_cmp_ge_u32 s44, s51
    s_cbranch_scc1 L_xs2_129
    s_lshl_b32 s45, s63, 17
    s_lshl_b32 s46, s41, 12
    s_add_u32 s45, s45, s46
    s_lshr_b32 s46, s45, 1
    s_add_u32 s45, s45, 0x1000000
    s_add_u32 s46, s46, 0x1800000
    v_lshlrev_b32 v21, 3, v1
    buffer_load_dwordx4 v[192:195], v10, s[12:15], s45 offen offset:0 sc1
    buffer_load_dwordx4 v[196:199], v10, s[12:15], s45 offen offset:1024 sc1
    buffer_load_dwordx4 v[200:203], v10, s[12:15], s45 offen offset:2048 sc1
    buffer_load_dwordx4 v[204:207], v10, s[12:15], s45 offen offset:3072 sc1
    buffer_load_dwordx2 v[240:241], v21, s[12:15], s46 offen offset:0 sc1
    buffer_load_dwordx2 v[242:243], v21, s[12:15], s46 offen offset:512 sc1
    buffer_load_dwordx2 v[244:245], v21, s[12:15], s46 offen offset:1024 sc1
    buffer_load_dwordx2 v[246:247], v21, s[12:15], s46 offen offset:1536 sc1
    s_waitcnt vmcnt(4)
    v_mfma_f32_16x16x32_bf16 v[48:51], v[192:195], v[128:131], 0
    v_mfma_f32_16x16x32_bf16 v[52:55], v[192:195], v[144:147], 0
    v_mfma_f32_16x16x32_bf16 v[48:51], v[196:199], v[132:135], v[48:51]
    v_mfma_f32_16x16x32_bf16 v[52:55], v[196:199], v[148:151], v[52:55]
    v_mfma_f32_16x16x32_bf16 v[48:51], v[200:203], v[136:139], v[48:51]
    v_mfma_f32_16x16x32_bf16 v[52:55], v[200:203], v[152:155], v[52:55]
    v_mfma_f32_16x16x32_bf16 v[48:51], v[204:207], v[140:143], v[48:51]
    v_mfma_f32_16x16x32_bf16 v[52:55], v[204:207], v[156:159], v[52:55]
    s_mov_b32 s45, 0x3e0293ee
    s_nop 6
    v_permlane32_swap_b32 v48, v50
    v_permlane32_swap_b32 v49, v51
    v_pk_add_f32 v[48:49], v[48:49], v[50:51]
    v_permlane32_swap_b32 v52, v54
    v_permlane32_swap_b32 v53, v55
    v_pk_add_f32 v[52:53], v[52:53], v[54:55]
    v_max_f32 v22, v32, v33
    v_max3_f32 v22, v22, v34, v35
    v_max3_f32 v22, v22, v48, v49
    v_max_f32 v23, v36, v37
    v_max3_f32 v23, v23, v38, v39
    v_max3_f32 v23, v23, v44, v45
    v_max3_f32 v23, v23, v46, v47
    v_max3_f32 v23, v23, v52, v53
    v_mov_b32 v24, v22
    v_mov_b32 v25, v23
    s_nop 0
    v_permlane32_swap_b32 v22, v24
    v_permlane32_swap_b32 v23, v25
    v_max_f32 v22, v22, v24
    v_max_f32 v23, v23, v25
    v_mov_b32 v24, v22
    v_mov_b32 v25, v23
    s_nop 0
    v_permlane16_swap_b32 v22, v24
    v_permlane16_swap_b32 v23, v25
    v_max_f32 v22, v22, v24
    v_max_f32 v23, v23, v25
    v_mul_f32 v22, s45, v22
    v_mul_f32 v23, s45, v23
    v_fma_f32 v32, v32, s45, -v22
    v_fma_f32 v33, v33, s45, -v22
    v_fma_f32 v34, v34, s45, -v22
    v_fma_f32 v35, v35, s45, -v22
    v_fma_f32 v48, v48, s45, -v22
    v_fma_f32 v49, v49, s45, -v22
    v_exp_f32 v32, v32
    v_exp_f32 v33, v33
    v_exp_f32 v34, v34
    v_exp_f32 v35, v35
    v_exp_f32 v48, v48
    v_exp_f32 v49, v49
    v_fma_f32 v36, v36, s45, -v23
    v_fma_f32 v37, v37, s45, -v23
    v_fma_f32 v38, v38, s45, -v23
    v_fma_f32 v39, v39, s45, -v23
    v_fma_f32 v44, v44, s45, -v23
    v_fma_f32 v45, v45, s45, -v23
    v_fma_f32 v46, v46, s45, -v23
    v_fma_f32 v47, v47, s45, -v23
    v_fma_f32 v52, v52, s45, -v23
    v_fma_f32 v53, v53, s45, -v23
    v_exp_f32 v36, v36
    v_exp_f32 v37, v37
    v_exp_f32 v38, v38
    v_exp_f32 v39, v39
    v_exp_f32 v44, v44
    v_exp_f32 v45, v45
    v_exp_f32 v46, v46
    v_exp_f32 v47, v47
    v_exp_f32 v52, v52
    v_exp_f32 v53, v53
    v_add_f32 v22, v32, v33
    v_add_f32 v22, v22, v34
    v_add_f32 v22, v22, v35
    v_add_f32 v22, v22, v48
    v_add_f32 v22, v22, v49
    v_add_f32 v23, v36, v37
    v_add_f32 v23, v23, v38
    v_add_f32 v23, v23, v39
    v_add_f32 v23, v23, v44
    v_add_f32 v23, v23, v45
    v_add_f32 v23, v23, v46
    v_add_f32 v23, v23, v47
    v_add_f32 v23, v23, v52
    v_add_f32 v23, v23, v53
    v_mov_b32 v24, v22
    v_mov_b32 v25, v23
    s_nop 0
    v_permlane32_swap_b32 v22, v24
    v_permlane32_swap_b32 v23, v25
    v_add_f32 v22, v22, v24
    v_add_f32 v23, v23, v25
    v_mov_b32 v24, v22
    v_mov_b32 v25, v23
    s_nop 0
    v_permlane16_swap_b32 v22, v24
    v_permlane16_swap_b32 v23, v25
    v_add_f32 v22, v22, v24
    v_add_f32 v23, v23, v25
    v_rcp_f32 v22, v22
    v_rcp_f32 v23, v23
    s_nop 0
    v_mul_f32 v32, v32, v22
    v_mul_f32 v33, v33, v22
    v_mul_f32 v34, v34, v22
    v_mul_f32 v35, v35, v22
    v_mul_f32 v48, v48, v22
    v_mul_f32 v49, v49, v22
    v_mul_f32 v36, v36, v23
    v_mul_f32 v37, v37, v23
    v_mul_f32 v38, v38, v23
    v_mul_f32 v39, v39, v23
    v_mul_f32 v44, v44, v23
    v_mul_f32 v45, v45, v23
    v_mul_f32 v46, v46, v23
    v_mul_f32 v47, v47, v23
    v_mul_f32 v52, v52, v23
    v_mul_f32 v53, v53, v23
    v_cvt_pk_bf16_f32 v128, v32, v33
    v_cvt_pk_bf16_f32 v129, v34, v35
    v_mov_b32 v130, 0
    v_mov_b32 v131, 0
    v_cvt_pk_bf16_f32 v132, v48, v49
    v_mov_b32 v133, 0
    v_mov_b32 v134, 0
    v_cvt_pk_bf16_f32 v135, v48, v49
    v_cvt_pk_bf16_f32 v136, v36, v37
    v_cvt_pk_bf16_f32 v137, v38, v39
    v_cvt_pk_bf16_f32 v138, v44, v45
    v_cvt_pk_bf16_f32 v139, v46, v47
    v_cvt_pk_bf16_f32 v140, v52, v53
    v_mov_b32 v141, 0
    v_mov_b32 v142, 0
    v_cvt_pk_bf16_f32 v143, v52, v53
    s_waitcnt vmcnt(0) lgkmcnt(0)
    s_nop 0
    v_mfma_f32_16x16x32_bf16 v[64:67], v[208:211], v[128:131], 0
    v_mfma_f32_16x16x32_bf16 v[68:71], v[212:215], v[128:131], 0
    v_mfma_f32_16x16x32_bf16 v[72:75], v[216:219], v[128:131], 0
    v_mfma_f32_16x16x32_bf16 v[76:79], v[220:223], v[128:131], 0
    v_mfma_f32_16x16x32_bf16 v[80:83], v[224:227], v[128:131], 0
    v_mfma_f32_16x16x32_bf16 v[84:87], v[228:231], v[128:131], 0
    v_mfma_f32_16x16x32_bf16 v[88:91], v[232:235], v[128:131], 0
    v_mfma_f32_16x16x32_bf16 v[92:95], v[236:239], v[128:131], 0
    v_mfma_f32_16x16x16_bf16 v[64:67], v[240:241], v[132:133], v[64:67]
    v_mfma_f32_16x16x16_bf16 v[68:71], v[240:241], v[134:135], v[68:71]
    v_mfma_f32_16x16x16_bf16 v[72:75], v[242:243], v[132:133], v[72:75]
    v_mfma_f32_16x16x16_bf16 v[76:79], v[242:243], v[134:135], v[76:79]
    v_mfma_f32_16x16x16_bf16 v[80:83], v[244:245], v[132:133], v[80:83]
    v_mfma_f32_16x16x16_bf16 v[84:87], v[244:245], v[134:135], v[84:87]
    v_mfma_f32_16x16x16_bf16 v[88:91], v[246:247], v[132:133], v[88:91]
    v_mfma_f32_16x16x16_bf16 v[92:95], v[246:247], v[134:135], v[92:95]
    v_mfma_f32_16x16x32_bf16 v[96:99], v[208:211], v[136:139], 0
    v_mfma_f32_16x16x32_bf16 v[100:103], v[212:215], v[136:139], 0
    v_mfma_f32_16x16x32_bf16 v[104:107], v[216:219], v[136:139], 0
    v_mfma_f32_16x16x32_bf16 v[108:111], v[220:223], v[136:139], 0
    v_mfma_f32_16x16x32_bf16 v[112:115], v[224:227], v[136:139], 0
    v_mfma_f32_16x16x32_bf16 v[116:119], v[228:231], v[136:139], 0
    v_mfma_f32_16x16x32_bf16 v[120:123], v[232:235], v[136:139], 0
    v_mfma_f32_16x16x32_bf16 v[124:127], v[236:239], v[136:139], 0
    v_mfma_f32_16x16x16_bf16 v[96:99], v[240:241], v[140:141], v[96:99]
    v_mfma_f32_16x16x16_bf16 v[100:103], v[240:241], v[142:143], v[100:103]
    v_mfma_f32_16x16x16_bf16 v[104:107], v[242:243], v[140:141], v[104:107]
    v_mfma_f32_16x16x16_bf16 v[108:111], v[242:243], v[142:143], v[108:111]
    v_mfma_f32_16x16x16_bf16 v[112:115], v[244:245], v[140:141], v[112:115]
    v_mfma_f32_16x16x16_bf16 v[116:119], v[244:245], v[142:143], v[116:119]
    v_mfma_f32_16x16x16_bf16 v[120:123], v[246:247], v[140:141], v[120:123]
    v_mfma_f32_16x16x16_bf16 v[124:127], v[246:247], v[142:143], v[124:127]
    s_lshl_b32 s45, s63, 18
    s_lshl_b32 s46, s41, 13
    s_add_u32 s45, s45, s46
    s_add_u32 s45, s45, 0x5000000
    s_add_u32 s46, s45, 4096
    v_cvt_pk_bf16_f32 v64, v64, v65
    v_cvt_pk_bf16_f32 v65, v66, v67
    v_cvt_pk_bf16_f32 v66, v68, v69
    v_cvt_pk_bf16_f32 v67, v70, v71
    buffer_store_dwordx4 v[64:67], v10, s[12:15], s45 offen offset:0 sc1
    v_cvt_pk_bf16_f32 v72, v72, v73
    v_cvt_pk_bf16_f32 v73, v74, v75
    v_cvt_pk_bf16_f32 v74, v76, v77
    v_cvt_pk_bf16_f32 v75, v78, v79
    buffer_store_dwordx4 v[72:75], v10, s[12:15], s45 offen offset:2048 sc1
    v_cvt_pk_bf16_f32 v80, v80, v81
    v_cvt_pk_bf16_f32 v81, v82, v83
    v_cvt_pk_bf16_f32 v82, v84, v85
    v_cvt_pk_bf16_f32 v83, v86, v87
    buffer_store_dwordx4 v[80:83], v10, s[12:15], s46 offen offset:0 sc1
    v_cvt_pk_bf16_f32 v88, v88, v89
    v_cvt_pk_bf16_f32 v89, v90, v91
    v_cvt_pk_bf16_f32 v90, v92, v93
    v_cvt_pk_bf16_f32 v91, v94, v95
    buffer_store_dwordx4 v[88:91], v10, s[12:15], s46 offen offset:2048 sc1
    v_cvt_pk_bf16_f32 v96, v96, v97
    v_cvt_pk_bf16_f32 v97, v98, v99
    v_cvt_pk_bf16_f32 v98, v100, v101
    v_cvt_pk_bf16_f32 v99, v102, v103
    buffer_store_dwordx4 v[96:99], v10, s[12:15], s45 offen offset:1024 sc1
    v_cvt_pk_bf16_f32 v104, v104, v105
    v_cvt_pk_bf16_f32 v105, v106, v107
    v_cvt_pk_bf16_f32 v106, v108, v109
    v_cvt_pk_bf16_f32 v107, v110, v111
    buffer_store_dwordx4 v[104:107], v10, s[12:15], s45 offen offset:3072 sc1
    v_cvt_pk_bf16_f32 v112, v112, v113
    v_cvt_pk_bf16_f32 v113, v114, v115
    v_cvt_pk_bf16_f32 v114, v116, v117
    v_cvt_pk_bf16_f32 v115, v118, v119
    buffer_store_dwordx4 v[112:115], v10, s[12:15], s46 offen offset:1024 sc1
    v_cvt_pk_bf16_f32 v120, v120, v121
    v_cvt_pk_bf16_f32 v121, v122, v123
    v_cvt_pk_bf16_f32 v122, v124, v125
    v_cvt_pk_bf16_f32 v123, v126, v127
    buffer_store_dwordx4 v[120:123], v10, s[12:15], s46 offen offset:3072 sc1
L_xs2_129:
    s_waitcnt vmcnt(0)
    s_barrier
    s_cmp_lg_u32 s44, 0
    s_cbranch_scc1 L_pub_132
    v_mov_b32 v30, s62
    v_mov_b32 v31, 0
    s_mov_b64 exec, 1
    buffer_store_dword v30, v31, s[12:15], s65 offen sc1
    s_mov_b64 exec, -1
L_pub_132:
    s_lshl_b32 s45, s38, 10
    s_add_u32 s45, s45, s64
    s_cmp_lg_u32 s44, 0
    s_cbranch_scc1 L_pw_133
    s_mov_b64 exec, 255
    s_mov_b32 s70, 0
L_wp_134:
    buffer_load_dword v31, v5, s[12:15], s45 offen sc1
    s_add_u32 s70, s70, 1
    s_cmp_ge_u32 s70, 0x200000
    s_cbranch_scc1 L_w_done_102
    s_waitcnt vmcnt(0)
    v_cmp_gt_u32 vcc, s62, v31
    s_nop 1
    s_cbranch_vccz L_wp_134_ok
    s_sleep 1
    s_branch L_wp_134
L_wp_134_ok:
    s_mov_b64 exec, -1
L_pw_133:
    s_barrier
    s_mul_i32 s53, s50, 262144
    s_add_u32 s53, s53, s52
    s_lshl_b32 s54, s44, 13
    s_add_u32 s53, s53, s54
    s_mul_i32 s57, s50, 131072
    s_add_u32 s57, s57, s56
    s_lshl_b32 s45, s44, 7
    s_add_u32 s57, s57, s45
    s_add_u32 s55, s54, 65536
    s_mov_b32 s58, 0
    v_mov_b32 v13, v10
    v_add_u32 v14, 65536, v13
    v_xor_b32 v15, 64, v13
    v_xor_b32 v16, 64, v14
    s_mov_b32 s76, 0x20000000
    s_add_u32 s48, s53, 0
    s_add_u32 s49, s48, 4096
    s_add_u32 m0, s54, 0
    s_nop 0
    buffer_load_dwordx4 v10, s[12:15], s48 offen offset:0 sc1 lds
    buffer_load_dwordx4 v10, s[12:15], s48 offen offset:1024 sc1 lds
    buffer_load_dwordx4 v10, s[12:15], s48 offen offset:2048 sc1 lds
    buffer_load_dwordx4 v10, s[12:15], s48 offen offset:3072 sc1 lds
    s_add_u32 m0, s54, 4096
    s_nop 0
    buffer_load_dwordx4 v10, s[12:15], s49 offen offset:0 sc1 lds
    buffer_load_dwordx4 v10, s[12:15], s49 offen offset:1024 sc1 lds
    buffer_load_dwordx4 v10, s[12:15], s49 offen offset:2048 sc1 lds
    buffer_load_dwordx4 v10, s[12:15], s49 offen offset:3072 sc1 lds
    s_add_u32 s48, s53, 32768
    s_add_u32 s49, s48, 4096
    s_add_u32 s46, s54, 32768
    s_add_u32 m0, s46, 0
    s_nop 0
    buffer_load_dwordx4 v10, s[12:15], s48 offen offset:0 sc1 lds
    buffer_load_dwordx4 v10, s[12:15], s48 offen offset:1024 sc1 lds
    buffer_load_dwordx4 v10, s[12:15], s48 offen offset:2048 sc1 lds
    buffer_load_dwordx4 v10, s[12:15], s48 offen offset:3072 sc1 lds
    s_add_u32 m0, s46, 4096
    s_nop 0
    buffer_load_dwordx4 v10, s[12:15], s49 offen offset:0 sc1 lds
    buffer_load_dwordx4 v10, s[12:15], s49 offen offset:1024 sc1 lds
    buffer_load_dwordx4 v10, s[12:15], s49 offen offset:2048 sc1 lds
    buffer_load_dwordx4 v10, s[12:15], s49 offen offset:3072 sc1 lds
    s_add_u32 s48, s53, 262144
    s_cmp_gt_u32 s51, 1
    s_cselect_b32 s48, s48, 0x20000000
    s_add_u32 s49, s48, 4096
    s_add_u32 m0, s55, 0
    s_nop 0
    buffer_load_dwordx4 v10, s[12:15], s48 offen offset:0 sc1 lds
    buffer_load_dwordx4 v10, s[12:15], s48 offen offset:1024 sc1 lds
    buffer_load_dwordx4 v10, s[12:15], s48 offen offset:2048 sc1 lds
    buffer_load_dwordx4 v10, s[12:15], s48 offen offset:3072 sc1 lds
    s_add_u32 m0, s55, 4096
    s_nop 0
    buffer_load_dwordx4 v10, s[12:15], s49 offen offset:0 sc1 lds
    buffer_load_dwordx4 v10, s[12:15], s49 offen offset:1024 sc1 lds
    buffer_load_dwordx4 v10, s[12:15], s49 offen offset:2048 sc1 lds
    buffer_load_dwordx4 v10, s[12:15], s49 offen offset:3072 sc1 lds
    s_waitcnt vmcnt(16)
    s_barrier
    ds_read_b128 v[32:35], v13 offset:0
    ds_read_b128 v[36:39], v13 offset:1024
    ds_read_b128 v[40:43], v13 offset:2048
    ds_read_b128 v[44:47], v13 offset:3072
L_e_loop_135:
    s_add_u32 s48, s53, 294912
    s_add_u32 s46, s58, 1
    s_cmp_lt_u32 s46, s51
    s_cselect_b32 s48, s48, 0x20000000
    s_add_u32 s49, s48, 4096
    s_add_u32 s59, s55, 32768
    s_waitcnt lgkmcnt(2)
    v_mfma_f32_16x16x32_bf16 v[80:83], a[0:3], v[32:35], 0
    ds_read_b128 v[48:51], v13 offset:4096
    ds_read_b128 v[52:55], v13 offset:5120
    v_mfma_f32_16x16x32_bf16 v[84:87], a[4:7], v[32:35], 0
    ds_read_b128 v[56:59], v13 offset:6144
    ds_read_b128 v[60:63], v13 offset:7168
    v_mfma_f32_16x16x32_bf16 v[88:91], a[0:3], v[36:39], 0
    s_add_u32 m0, s59, 0
    s_nop 0
    buffer_load_dwordx4 v10, s[12:15], s48 offen offset:0 sc1 lds
    v_mfma_f32_16x16x32_bf16 v[92:95], a[4:7], v[36:39], 0
    s_waitcnt lgkmcnt(4)
    v_mfma_f32_16x16x32_bf16 v[80:83], a[8:11], v[40:43], v[80:83]
    ds_read_b128 v[32:35], v13 offset:8192
    ds_read_b128 v[36:39], v13 offset:9216
    v_mfma_f32_16x16x32_bf16 v[84:87], a[12:15], v[40:43], v[84:87]
    v_mfma_f32_16x16x32_bf16 v[88:91], a[8:11], v[44:47], v[88:91]
    buffer_load_dwordx4 v10, s[12:15], s48 offen offset:1024 sc1 lds
    v_mfma_f32_16x16x32_bf16 v[92:95], a[12:15], v[44:47], v[92:95]
    s_waitcnt lgkmcnt(4)
    v_mfma_f32_16x16x32_bf16 v[80:83], a[16:19], v[48:51], v[80:83]
    ds_read_b128 v[40:43], v13 offset:10240
    ds_read_b128 v[44:47], v13 offset:11264
    v_mfma_f32_16x16x32_bf16 v[84:87], a[20:23], v[48:51], v[84:87]
    v_mfma_f32_16x16x32_bf16 v[88:91], a[16:19], v[52:55], v[88:91]
    buffer_load_dwordx4 v10, s[12:15], s48 offen offset:2048 sc1 lds
    v_mfma_f32_16x16x32_bf16 v[92:95], a[20:23], v[52:55], v[92:95]
    s_waitcnt lgkmcnt(4)
    v_mfma_f32_16x16x32_bf16 v[80:83], a[24:27], v[56:59], v[80:83]
    ds_read_b128 v[48:51], v13 offset:12288
    ds_read_b128 v[52:55], v13 offset:13312
    v_mfma_f32_16x16x32_bf16 v[84:87], a[28:31], v[56:59], v[84:87]
    v_mfma_f32_16x16x32_bf16 v[88:91], a[24:27], v[60:63], v[88:91]
    buffer_load_dwordx4 v10, s[12:15], s48 offen offset:3072 sc1 lds
    v_mfma_f32_16x16x32_bf16 v[92:95], a[28:31], v[60:63], v[92:95]
    s_waitcnt lgkmcnt(4)
    v_mfma_f32_16x16x32_bf16 v[80:83], a[32:35], v[32:35], v[80:83]
    ds_read_b128 v[56:59], v13 offset:14336
    ds_read_b128 v[60:63], v13 offset:15360
    v_mfma_f32_16x16x32_bf16 v[84:87], a[36:39], v[32:35], v[84:87]
    v_mfma_f32_16x16x32_bf16 v[88:91], a[32:35], v[36:39], v[88:91]
    s_add_u32 m0, s59, 4096
    s_nop 0
    buffer_load_dwordx4 v10, s[12:15], s49 offen offset:0 sc1 lds
    v_mfma_f32_16x16x32_bf16 v[92:95], a[36:39], v[36:39], v[92:95]
    s_waitcnt lgkmcnt(4)
    v_mfma_f32_16x16x32_bf16 v[80:83], a[40:43], v[40:43], v[80:83]
    ds_read_b128 v[32:35], v13 offset:16384
    ds_read_b128 v[36:39], v13 offset:17408
    v_mfma_f32_16x16x32_bf16 v[84:87], a[44:47], v[40:43], v[84:87]
    v_mfma_f32_16x16x32_bf16 v[88:91], a[40:43], v[44:47], v[88:91]
    buffer_load_dwordx4 v10, s[12:15], s49 offen offset:1024 sc1 lds
    v_mfma_f32_16x16x32_bf16 v[92:95], a[44:47], v[44:47], v[92:95]
    s_waitcnt lgkmcnt(4)
    v_mfma_f32_16x16x32_bf16 v[80:83], a[48:51], v[48:51], v[80:83]
    ds_read_b128 v[40:43], v13 offset:18432
    ds_read_b128 v[44:47], v13 offset:19456
    v_mfma_f32_16x16x32_bf16 v[84:87], a[52:55], v[48:51], v[84:87]
    v_mfma_f32_16x16x32_bf16 v[88:91], a[48:51], v[52:55], v[88:91]
    buffer_load_dwordx4 v10, s[12:15], s49 offen offset:2048 sc1 lds
    v_mfma_f32_16x16x32_bf16 v[92:95], a[52:55], v[52:55], v[92:95]
    s_waitcnt lgkmcnt(4)
    v_mfma_f32_16x16x32_bf16 v[80:83], a[56:59], v[56:59], v[80:83]
    ds_read_b128 v[48:51], v13 offset:20480
    ds_read_b128 v[52:55], v13 offset:21504
    v_mfma_f32_16x16x32_bf16 v[84:87], a[60:63], v[56:59], v[84:87]
    v_mfma_f32_16x16x32_bf16 v[88:91], a[56:59], v[60:63], v[88:91]
    buffer_load_dwordx4 v10, s[12:15], s49 offen offset:3072 sc1 lds
    v_mfma_f32_16x16x32_bf16 v[92:95], a[60:63], v[60:63], v[92:95]
    s_waitcnt lgkmcnt(4)
    v_mfma_f32_16x16x32_bf16 v[80:83], a[64:67], v[32:35], v[80:83]
    ds_read_b128 v[56:59], v13 offset:22528
    ds_read_b128 v[60:63], v13 offset:23552
    v_mfma_f32_16x16x32_bf16 v[84:87], a[68:71], v[32:35], v[84:87]
    v_mfma_f32_16x16x32_bf16 v[88:91], a[64:67], v[36:39], v[88:91]
    v_mfma_f32_16x16x32_bf16 v[92:95], a[68:71], v[36:39], v[92:95]
    s_waitcnt lgkmcnt(4)
    v_mfma_f32_16x16x32_bf16 v[80:83], a[72:75], v[40:43], v[80:83]
    ds_read_b128 v[32:35], v13 offset:24576
    ds_read_b128 v[36:39], v13 offset:25600
    v_mfma_f32_16x16x32_bf16 v[84:87], a[76:79], v[40:43], v[84:87]
    v_mfma_f32_16x16x32_bf16 v[88:91], a[72:75], v[44:47], v[88:91]
    v_mfma_f32_16x16x32_bf16 v[92:95], a[76:79], v[44:47], v[92:95]
    s_waitcnt lgkmcnt(4)
    v_mfma_f32_16x16x32_bf16 v[80:83], a[80:83], v[48:51], v[80:83]
    ds_read_b128 v[40:43], v13 offset:26624
    ds_read_b128 v[44:47], v13 offset:27648
    v_mfma_f32_16x16x32_bf16 v[84:87], a[84:87], v[48:51], v[84:87]
    v_mfma_f32_16x16x32_bf16 v[88:91], a[80:83], v[52:55], v[88:91]
    v_mfma_f32_16x16x32_bf16 v[92:95], a[84:87], v[52:55], v[92:95]
    s_waitcnt lgkmcnt(4)
    v_mfma_f32_16x16x32_bf16 v[80:83], a[88:91], v[56:59], v[80:83]
    ds_read_b128 v[48:51], v13 offset:28672
    ds_read_b128 v[52:55], v13 offset:29696
    v_mfma_f32_16x16x32_bf16 v[84:87], a[92:95], v[56:59], v[84:87]
    v_mfma_f32_16x16x32_bf16 v[88:91], a[88:91], v[60:63], v[88:91]
    v_mfma_f32_16x16x32_bf16 v[92:95], a[92:95], v[60:63], v[92:95]
    s_waitcnt lgkmcnt(4)
    v_mfma_f32_16x16x32_bf16 v[80:83], a[96:99], v[32:35], v[80:83]
    ds_read_b128 v[56:59], v13 offset:30720
    ds_read_b128 v[60:63], v13 offset:31744
    v_mfma_f32_16x16x32_bf16 v[84:87], a[100:103], v[32:35], v[84:87]
    v_mfma_f32_16x16x32_bf16 v[88:91], a[96:99], v[36:39], v[88:91]
    v_mfma_f32_16x16x32_bf16 v[92:95], a[100:103], v[36:39], v[92:95]
    s_waitcnt lgkmcnt(4)
    v_mfma_f32_16x16x32_bf16 v[80:83], a[104:107], v[40:43], v[80:83]
    ds_read_b128 v[216:219], v8 offset:0
    ds_read_b128 v[220:223], v8 offset:1152
    v_mfma_f32_16x16x32_bf16 v[84:87], a[108:111], v[40:43], v[84:87]
    ds_read_b128 v[224:227], v8 offset:2304
    ds_read_b128 v[228:231], v8 offset:3456
    v_mfma_f32_16x16x32_bf16 v[88:91], a[104:107], v[44:47], v[88:91]
    v_mfma_f32_16x16x32_bf16 v[92:95], a[108:111], v[44:47], v[92:95]
    s_waitcnt vmcnt(16) lgkmcnt(0)
    s_barrier
    v_mfma_f32_16x16x32_bf16 v[80:83], a[112:115], v[48:51], v[80:83]
    ds_read_b128 v[32:35], v13 offset:32768
    ds_read_b128 v[36:39], v13 offset:33792
    v_mfma_f32_16x16x32_bf16 v[84:87], a[116:119], v[48:51], v[84:87]
    buffer_store_dwordx4 v[216:219], v11, s[12:15], s76 offen sc1
    v_mfma_f32_16x16x32_bf16 v[88:91], a[112:115], v[52:55], v[88:91]
    s_add_u32 s76, s76, 32768
    v_mfma_f32_16x16x32_bf16 v[92:95], a[116:119], v[52:55], v[92:95]
    buffer_store_dwordx4 v[220:223], v11, s[12:15], s76 offen sc1
    v_mfma_f32_16x16x32_bf16 v[80:83], a[120:123], v[56:59], v[80:83]
    ds_read_b128 v[40:43], v13 offset:34816
    ds_read_b128 v[44:47], v13 offset:35840
    v_mfma_f32_16x16x32_bf16 v[84:87], a[124:127], v[56:59], v[84:87]
    s_add_u32 s76, s76, 32768
    v_mfma_f32_16x16x32_bf16 v[88:91], a[120:123], v[60:63], v[88:91]
    buffer_store_dwordx4 v[224:227], v11, s[12:15], s76 offen sc1
    v_mfma_f32_16x16x32_bf16 v[92:95], a[124:127], v[60:63], v[92:95]
    s_add_u32 s76, s76, 32768
    s_add_u32 s48, s53, 524288
    s_add_u32 s46, s58, 2
    s_cmp_lt_u32 s46, s51
    s_cselect_b32 s48, s48, 0x20000000
    s_add_u32 s49, s48, 4096
    s_mov_b32 s59, s54
    s_waitcnt lgkmcnt(2)
    v_mfma_f32_16x16x32_bf16 v[80:83], a[128:131], v[32:35], v[80:83]
    ds_read_b128 v[48:51], v13 offset:36864
    ds_read_b128 v[52:55], v13 offset:37888
    v_mfma_f32_16x16x32_bf16 v[84:87], a[132:135], v[32:35], v[84:87]
    ds_read_b128 v[56:59], v13 offset:38912
    ds_read_b128 v[60:63], v13 offset:39936
    v_mfma_f32_16x16x32_bf16 v[88:91], a[128:131], v[36:39], v[88:91]
    s_add_u32 m0, s59, 0
    s_nop 0
    buffer_load_dwordx4 v10, s[12:15], s48 offen offset:0 sc1 lds
    v_mfma_f32_16x16x32_bf16 v[92:95], a[132:135], v[36:39], v[92:95]
    buffer_store_dwordx4 v[228:231], v11, s[12:15], s76 offen sc1
    s_waitcnt lgkmcnt(4)
    v_mfma_f32_16x16x32_bf16 v[80:83], a[136:139], v[40:43], v[80:83]
    ds_read_b128 v[32:35], v13 offset:40960
    ds_read_b128 v[36:39], v13 offset:41984
    v_mfma_f32_16x16x32_bf16 v[84:87], a[140:143], v[40:43], v[84:87]
    v_mfma_f32_16x16x32_bf16 v[88:91], a[136:139], v[44:47], v[88:91]
    buffer_load_dwordx4 v10, s[12:15], s48 offen offset:1024 sc1 lds
    v_mfma_f32_16x16x32_bf16 v[92:95], a[140:143], v[44:47], v[92:95]
    s_waitcnt lgkmcnt(4)
    v_mfma_f32_16x16x32_bf16 v[80:83], a[144:147], v[48:51], v[80:83]
    ds_read_b128 v[40:43], v13 offset:43008
    ds_read_b128 v[44:47], v13 offset:44032
    v_mfma_f32_16x16x32_bf16 v[84:87], a[148:151], v[48:51], v[84:87]
    v_mfma_f32_16x16x32_bf16 v[88:91], a[144:147], v[52:55], v[88:91]
    buffer_load_dwordx4 v10, s[12:15], s48 offen offset:2048 sc1 lds
    v_mfma_f32_16x16x32_bf16 v[92:95], a[148:151], v[52:55], v[92:95]
    s_waitcnt lgkmcnt(4)
    v_mfma_f32_16x16x32_bf16 v[80:83], a[152:155], v[56:59], v[80:83]
    ds_read_b128 v[48:51], v13 offset:45056
    ds_read_b128 v[52:55], v13 offset:46080
    v_mfma_f32_16x16x32_bf16 v[84:87], a[156:159], v[56:59], v[84:87]
    v_mfma_f32_16x16x32_bf16 v[88:91], a[152:155], v[60:63], v[88:91]
    buffer_load_dwordx4 v10, s[12:15], s48 offen offset:3072 sc1 lds
    v_mfma_f32_16x16x32_bf16 v[92:95], a[156:159], v[60:63], v[92:95]
    s_waitcnt lgkmcnt(4)
    v_mfma_f32_16x16x32_bf16 v[80:83], a[160:163], v[32:35], v[80:83]
    ds_read_b128 v[56:59], v13 offset:47104
    ds_read_b128 v[60:63], v13 offset:48128
    v_mfma_f32_16x16x32_bf16 v[84:87], a[164:167], v[32:35], v[84:87]
    v_mfma_f32_16x16x32_bf16 v[88:91], a[160:163], v[36:39], v[88:91]
    s_add_u32 m0, s59, 4096
    s_nop 0
    buffer_load_dwordx4 v10, s[12:15], s49 offen offset:0 sc1 lds
    v_mfma_f32_16x16x32_bf16 v[92:95], a[164:167], v[36:39], v[92:95]
    s_waitcnt lgkmcnt(4)
    v_mfma_f32_16x16x32_bf16 v[80:83], a[168:171], v[40:43], v[80:83]
    ds_read_b128 v[32:35], v13 offset:49152
    ds_read_b128 v[36:39], v13 offset:50176
    v_mfma_f32_16x16x32_bf16 v[84:87], a[172:175], v[40:43], v[84:87]
    v_mfma_f32_16x16x32_bf16 v[88:91], a[168:171], v[44:47], v[88:91]
    buffer_load_dwordx4 v10, s[12:15], s49 offen offset:1024 sc1 lds
    v_mfma_f32_16x16x32_bf16 v[92:95], a[172:175], v[44:47], v[92:95]
    s_waitcnt lgkmcnt(4)
    v_mfma_f32_16x16x32_bf16 v[80:83], a[176:179], v[48:51], v[80:83]
    ds_read_b128 v[40:43], v13 offset:51200
    ds_read_b128 v[44:47], v13 offset:52224
    v_mfma_f32_16x16x32_bf16 v[84:87], a[180:183], v[48:51], v[84:87]
    v_mfma_f32_16x16x32_bf16 v[88:91], a[176:179], v[52:55], v[88:91]
    buffer_load_dwordx4 v10, s[12:15], s49 offen offset:2048 sc1 lds
    v_mfma_f32_16x16x32_bf16 v[92:95], a[180:183], v[52:55], v[92:95]
    s_waitcnt lgkmcnt(4)
    v_mfma_f32_16x16x32_bf16 v[80:83], a[184:187], v[56:59], v[80:83]
    ds_read_b128 v[48:51], v13 offset:53248
    ds_read_b128 v[52:55], v13 offset:54272
    v_mfma_f32_16x16x32_bf16 v[84:87], a[188:191], v[56:59], v[84:87]
    v_mfma_f32_16x16x32_bf16 v[88:91], a[184:187], v[60:63], v[88:91]
    buffer_load_dwordx4 v10, s[12:15], s49 offen offset:3072 sc1 lds
    v_mfma_f32_16x16x32_bf16 v[92:95], a[188:191], v[60:63], v[92:95]
    s_waitcnt lgkmcnt(4)
    v_mfma_f32_16x16x32_bf16 v[80:83], a[192:195], v[32:35], v[80:83]
    ds_read_b128 v[56:59], v13 offset:55296
    ds_read_b128 v[60:63], v13 offset:56320
    v_mfma_f32_16x16x32_bf16 v[84:87], a[196:199], v[32:35], v[84:87]
    v_mfma_f32_16x16x32_bf16 v[88:91], a[192:195], v[36:39], v[88:91]
    v_mfma_f32_16x16x32_bf16 v[92:95], a[196:199], v[36:39], v[92:95]
    s_waitcnt lgkmcnt(4)
    v_mfma_f32_16x16x32_bf16 v[80:83], a[200:203], v[40:43], v[80:83]
    ds_read_b128 v[32:35], v13 offset:57344
    ds_read_b128 v[36:39], v13 offset:58368
    v_mfma_f32_16x16x32_bf16 v[84:87], a[204:207], v[40:43], v[84:87]
    v_mfma_f32_16x16x32_bf16 v[88:91], a[200:203], v[44:47], v[88:91]
    v_mfma_f32_16x16x32_bf16 v[92:95], a[204:207], v[44:47], v[92:95]
    s_waitcnt lgkmcnt(4)
    v_mfma_f32_16x16x32_bf16 v[80:83], a[208:211], v[48:51], v[80:83]
    ds_read_b128 v[40:43], v13 offset:59392
    ds_read_b128 v[44:47], v13 offset:60416
    v_mfma_f32_16x16x32_bf16 v[84:87], a[212:215], v[48:51], v[84:87]
    v_mfma_f32_16x16x32_bf16 v[88:91], a[208:211], v[52:55], v[88:91]
    v_mfma_f32_16x16x32_bf16 v[92:95], a[212:215], v[52:55], v[92:95]
    s_waitcnt lgkmcnt(4)
    v_mfma_f32_16x16x32_bf16 v[80:83], a[216:219], v[56:59], v[80:83]
    ds_read_b128 v[48:51], v13 offset:61440
    ds_read_b128 v[52:55], v13 offset:62464
    v_mfma_f32_16x16x32_bf16 v[84:87], a[220:223], v[56:59], v[84:87]
    v_mfma_f32_16x16x32_bf16 v[88:91], a[216:219], v[60:63], v[88:91]
    v_mfma_f32_16x16x32_bf16 v[92:95], a[220:223], v[60:63], v[92:95]
    s_waitcnt lgkmcnt(4)
    v_mfma_f32_16x16x32_bf16 v[80:83], a[224:227], v[32:35], v[80:83]
    ds_read_b128 v[56:59], v13 offset:63488
    ds_read_b128 v[60:63], v13 offset:64512
    v_mfma_f32_16x16x32_bf16 v[84:87], a[228:231], v[32:35], v[84:87]
    v_mfma_f32_16x16x32_bf16 v[88:91], a[224:227], v[36:39], v[88:91]
    v_mfma_f32_16x16x32_bf16 v[92:95], a[228:231], v[36:39], v[92:95]
    s_waitcnt lgkmcnt(4)
    v_mfma_f32_16x16x32_bf16 v[80:83], a[232:235], v[40:43], v[80:83]
    v_mfma_f32_16x16x32_bf16 v[84:87], a[236:239], v[40:43], v[84:87]
    v_mfma_f32_16x16x32_bf16 v[88:91], a[232:235], v[44:47], v[88:91]
    v_mfma_f32_16x16x32_bf16 v[92:95], a[236:239], v[44:47], v[92:95]
    s_waitcnt vmcnt(16) lgkmcnt(0)
    s_barrier
    v_mfma_f32_16x16x32_bf16 v[80:83], a[240:243], v[48:51], v[80:83]
    ds_read_b128 v[32:35], v14 offset:0
    ds_read_b128 v[36:39], v14 offset:1024
    v_mfma_f32_16x16x32_bf16 v[84:87], a[244:247], v[48:51], v[84:87]
    v_mfma_f32_16x16x32_bf16 v[88:91], a[240:243], v[52:55], v[88:91]
    v_mfma_f32_16x16x32_bf16 v[92:95], a[244:247], v[52:55], v[92:95]
    v_mfma_f32_16x16x32_bf16 v[80:83], a[248:251], v[56:59], v[80:83]
    ds_read_b128 v[40:43], v14 offset:2048
    ds_read_b128 v[44:47], v14 offset:3072
    v_mfma_f32_16x16x32_bf16 v[84:87], a[252:255], v[56:59], v[84:87]
    v_mfma_f32_16x16x32_bf16 v[88:91], a[248:251], v[60:63], v[88:91]
    v_mfma_f32_16x16x32_bf16 v[92:95], a[252:255], v[60:63], v[92:95]
    s_add_u32 s53, s53, 262144
    s_add_u32 s58, s58, 1
    v_swap_b32 v13, v14
    s_xor_b32 s54, s54, 65536
    s_xor_b32 s55, s55, 65536
    s_mov_b32 s76, s57
    v_swap_b32 v15, v16
    s_add_u32 s57, s57, 131072
    ds_write_b128 v7, v[80:83] offset:0
    ds_write_b128 v7, v[84:87] offset:64
    ds_write_b128 v7, v[88:91] offset:2304
    ds_write_b128 v7, v[92:95] offset:2368
    s_cmp_lt_u32 s58, s51
    s_cbranch_scc1 L_e_loop_135
    s_waitcnt lgkmcnt(0)
    ds_read_b128 v[216:219], v8 offset:0
    ds_read_b128 v[220:223], v8 offset:1152
    ds_read_b128 v[224:227], v8 offset:2304
    ds_read_b128 v[228:231], v8 offset:3456
    s_waitcnt lgkmcnt(0)
    buffer_store_dwordx4 v[216:219], v11, s[12:15], s76 offen sc1
    s_add_u32 s76, s76, 32768
    buffer_store_dwordx4 v[220:223], v11, s[12:15], s76 offen sc1
    s_add_u32 s76, s76, 32768
    buffer_store_dwordx4 v[224:227], v11, s[12:15], s76 offen sc1
    s_add_u32 s76, s76, 32768
    buffer_store_dwordx4 v[228:231], v11, s[12:15], s76 offen sc1
    s_waitcnt vmcnt(0)
    s_barrier
    s_cmp_lg_u32 s44, 0
    s_cbranch_scc1 L_pub_136
    v_mov_b32 v30, s62
    v_mov_b32 v31, 0
    s_mov_b64 exec, 1
    buffer_store_dword v30, v31, s[12:15], s67 offen sc1
    s_mov_b64 exec, -1
L_pub_136:
    s_branch L_a_loop_124
L_role_b_120:
    s_load_dwordx2 s[6:7], s[0:1], 64
    s_load_dwordx2 s[8:9], s[0:1], 72
    s_waitcnt lgkmcnt(0)
    s_mov_b32 s24, s6
    s_and_b32 s25, s7, 0xffff
    s_mov_b32 s26, 0x700000
    s_mov_b32 s27, 0x00020000
    s_mov_b32 s32, s8
    s_and_b32 s33, s9, 0xffff
    s_mov_b32 s34, 0x1c00
    s_mov_b32 s35, 0x00020000
    s_min_u32 s45, s41, 27
    s_lshl_b32 s46, s45, 8
    s_waitcnt vmcnt(0)
    s_barrier
    v_lshrrev_b32 v20, 4, v1
    s_lshl_b32 s45, s44, 2
    v_add_u32 v21, s45, v20
    s_mov_b32 s45, 7168
    v_mul_lo_u32 v21, v21, s45
    v_lshlrev_b32 v22, 2, v20
    v_and_b32 v23, 15, v1
    v_xor_b32 v22, v22, v23
    v_lshlrev_b32 v22, 4, v22
    v_add_u32 v21, v21, v22
    v_bfe_u32 v22, v1, 2, 2
    v_lshlrev_b32 v23, 3, v20
    v_add_u32 v23, v23, v22
    v_lshlrev_b32 v23, 8, v23
    v_xor_b32 v22, s44, v22
    v_lshlrev_b32 v22, 6, v22
    v_add_u32 v23, v23, v22
    v_and_b32 v22, 3, v1
    v_lshlrev_b32 v22, 4, v22
    v_add_u32 v23, v23, v22
    v_add_u32 v24, 65536, v23
    v_add_u32 v25, 131072, v23
    s_lshl_b32 s47, s44, 10
    s_add_u32 s45, s46, 0x0
    s_add_u32 m0, s47, 0
    s_nop 0
    buffer_load_dwordx4 v21, s[24:27], s45 offen  lds
    s_add_u32 s45, s46, 0x1c000
    s_add_u32 m0, s47, 4096
    s_nop 0
    buffer_load_dwordx4 v21, s[24:27], s45 offen  lds
    s_add_u32 s45, s46, 0x38000
    s_add_u32 m0, s47, 8192
    s_nop 0
    buffer_load_dwordx4 v21, s[24:27], s45 offen  lds
    s_add_u32 s45, s46, 0x54000
    s_add_u32 m0, s47, 12288
    s_nop 0
    buffer_load_dwordx4 v21, s[24:27], s45 offen  lds
    s_add_u32 s45, s46, 0x70000
    s_add_u32 m0, s47, 16384
    s_nop 0
    buffer_load_dwordx4 v21, s[24:27], s45 offen  lds
    s_add_u32 s45, s46, 0x8c000
    s_add_u32 m0, s47, 20480
    s_nop 0
    buffer_load_dwordx4 v21, s[24:27], s45 offen  lds
    s_add_u32 s45, s46, 0xa8000
    s_add_u32 m0, s47, 24576
    s_nop 0
    buffer_load_dwordx4 v21, s[24:27], s45 offen  lds
    s_add_u32 s45, s46, 0xc4000
    s_add_u32 m0, s47, 28672
    s_nop 0
    buffer_load_dwordx4 v21, s[24:27], s45 offen  lds
    s_add_u32 s45, s46, 0xe0000
    s_add_u32 m0, s47, 32768
    s_nop 0
    buffer_load_dwordx4 v21, s[24:27], s45 offen  lds
    s_add_u32 s45, s46, 0xfc000
    s_add_u32 m0, s47, 36864
    s_nop 0
    buffer_load_dwordx4 v21, s[24:27], s45 offen  lds
    s_add_u32 s45, s46, 0x118000
    s_add_u32 m0, s47, 40960
    s_nop 0
    buffer_load_dwordx4 v21, s[24:27], s45 offen  lds
    s_add_u32 s45, s46, 0x134000
    s_add_u32 m0, s47, 45056
    s_nop 0
    buffer_load_dwordx4 v21, s[24:27], s45 offen  lds
    s_add_u32 s45, s46, 0x150000
    s_add_u32 m0, s47, 49152
    s_nop 0
    buffer_load_dwordx4 v21, s[24:27], s45 offen  lds
    s_add_u32 s45, s46, 0x16c000
    s_add_u32 m0, s47, 53248
    s_nop 0
    buffer_load_dwordx4 v21, s[24:27], s45 offen  lds
    s_add_u32 s45, s46, 0x188000
    s_add_u32 m0, s47, 57344
    s_nop 0
    buffer_load_dwordx4 v21, s[24:27], s45 offen  lds
    s_add_u32 s45, s46, 0x1a4000
    s_add_u32 m0, s47, 61440
    s_nop 0
    buffer_load_dwordx4 v21, s[24:27], s45 offen  lds
    s_add_u32 s45, s46, 0x1c0000
    s_add_u32 m0, s47, 65536
    s_nop 0
    buffer_load_dwordx4 v21, s[24:27], s45 offen  lds
    s_add_u32 s45, s46, 0x1dc000
    s_add_u32 m0, s47, 69632
    s_nop 0
    buffer_load_dwordx4 v21, s[24:27], s45 offen  lds
    s_add_u32 s45, s46, 0x1f8000
    s_add_u32 m0, s47, 73728
    s_nop 0
    buffer_load_dwordx4 v21, s[24:27], s45 offen  lds
    s_add_u32 s45, s46, 0x214000
    s_add_u32 m0, s47, 77824
    s_nop 0
    buffer_load_dwordx4 v21, s[24:27], s45 offen  lds
    s_add_u32 s45, s46, 0x230000
    s_add_u32 m0, s47, 81920
    s_nop 0
    buffer_load_dwordx4 v21, s[24:27], s45 offen  lds
    s_add_u32 s45, s46, 0x24c000
    s_add_u32 m0, s47, 86016
    s_nop 0
    buffer_load_dwordx4 v21, s[24:27], s45 offen  lds
    s_add_u32 s45, s46, 0x268000
    s_add_u32 m0, s47, 90112
    s_nop 0
    buffer_load_dwordx4 v21, s[24:27], s45 offen  lds
    s_add_u32 s45, s46, 0x284000
    s_add_u32 m0, s47, 94208
    s_nop 0
    buffer_load_dwordx4 v21, s[24:27], s45 offen  lds
    s_add_u32 s45, s46, 0x2a0000
    s_add_u32 m0, s47, 98304
    s_nop 0
    buffer_load_dwordx4 v21, s[24:27], s45 offen  lds
    s_add_u32 s45, s46, 0x2bc000
    s_add_u32 m0, s47, 102400
    s_nop 0
    buffer_load_dwordx4 v21, s[24:27], s45 offen  lds
    s_add_u32 s45, s46, 0x2d8000
    s_add_u32 m0, s47, 106496
    s_nop 0
    buffer_load_dwordx4 v21, s[24:27], s45 offen  lds
    s_add_u32 s45, s46, 0x2f4000
    s_add_u32 m0, s47, 110592
    s_nop 0
    buffer_load_dwordx4 v21, s[24:27], s45 offen  lds
    s_add_u32 s45, s46, 0x310000
    s_add_u32 m0, s47, 114688
    s_nop 0
    buffer_load_dwordx4 v21, s[24:27], s45 offen  lds
    s_add_u32 s45, s46, 0x32c000
    s_add_u32 m0, s47, 118784
    s_nop 0
    buffer_load_dwordx4 v21, s[24:27], s45 offen  lds
    s_add_u32 s45, s46, 0x348000
    s_add_u32 m0, s47, 122880
    s_nop 0
    buffer_load_dwordx4 v21, s[24:27], s45 offen  lds
    s_add_u32 s45, s46, 0x364000
    s_add_u32 m0, s47, 126976
    s_nop 0
    buffer_load_dwordx4 v21, s[24:27], s45 offen  lds
    s_waitcnt vmcnt(28)
    s_barrier
    s_add_u32 s45, s46, 0x380000
    s_add_u32 m0, s47, 131072
    s_nop 0
    buffer_load_dwordx4 v21, s[24:27], s45 offen  lds
    s_add_u32 s45, s46, 0x39c000
    s_add_u32 m0, s47, 135168
    s_nop 0
    buffer_load_dwordx4 v21, s[24:27], s45 offen  lds
    s_add_u32 s45, s46, 0x3b8000
    s_add_u32 m0, s47, 139264
    s_nop 0
    buffer_load_dwordx4 v21, s[24:27], s45 offen  lds
    s_add_u32 s45, s46, 0x3d4000
    s_add_u32 m0, s47, 143360
    s_nop 0
    buffer_load_dwordx4 v21, s[24:27], s45 offen  lds
    ds_read_b64_tr_b16 a[0:1], v23 offset:0
    ds_read_b64_tr_b16 a[2:3], v23 offset:1024
    ds_read_b64_tr_b16 a[4:5], v23 offset:8
    ds_read_b64_tr_b16 a[6:7], v23 offset:1032
    ds_read_b64_tr_b16 a[8:9], v23 offset:8192
    ds_read_b64_tr_b16 a[10:11], v23 offset:9216
    ds_read_b64_tr_b16 a[12:13], v23 offset:8200
    ds_read_b64_tr_b16 a[14:15], v23 offset:9224
    s_waitcnt lgkmcnt(0)
    s_waitcnt vmcnt(28)
    s_barrier
    s_add_u32 s45, s46, 0x3f0000
    s_add_u32 m0, s47, 0
    s_nop 0
    buffer_load_dwordx4 v21, s[24:27], s45 offen  lds
    s_add_u32 s45, s46, 0x40c000
    s_add_u32 m0, s47, 4096
    s_nop 0
    buffer_load_dwordx4 v21, s[24:27], s45 offen  lds
    s_add_u32 s45, s46, 0x428000
    s_add_u32 m0, s47, 8192
    s_nop 0
    buffer_load_dwordx4 v21, s[24:27], s45 offen  lds
    s_add_u32 s45, s46, 0x444000
    s_add_u32 m0, s47, 12288
    s_nop 0
    buffer_load_dwordx4 v21, s[24:27], s45 offen  lds
    ds_read_b64_tr_b16 a[16:17], v23 offset:16384
    ds_read_b64_tr_b16 a[18:19], v23 offset:17408
    ds_read_b64_tr_b16 a[20:21], v23 offset:16392
    ds_read_b64_tr_b16 a[22:23], v23 offset:17416
    ds_read_b64_tr_b16 a[24:25], v23 offset:24576
    ds_read_b64_tr_b16 a[26:27], v23 offset:25600
    ds_read_b64_tr_b16 a[28:29], v23 offset:24584
    ds_read_b64_tr_b16 a[30:31], v23 offset:25608
    s_waitcnt lgkmcnt(0)
    s_waitcnt vmcnt(28)
    s_barrier
    s_add_u32 s45, s46, 0x460000
    s_add_u32 m0, s47, 16384
    s_nop 0
    buffer_load_dwordx4 v21, s[24:27], s45 offen  lds
    s_add_u32 s45, s46, 0x47c000
    s_add_u32 m0, s47, 20480
    s_nop 0
    buffer_load_dwordx4 v21, s[24:27], s45 offen  lds
    s_add_u32 s45, s46, 0x498000
    s_add_u32 m0, s47, 24576
    s_nop 0
    buffer_load_dwordx4 v21, s[24:27], s45 offen  lds
    s_add_u32 s45, s46, 0x4b4000
    s_add_u32 m0, s47, 28672
    s_nop 0
    buffer_load_dwordx4 v21, s[24:27], s45 offen  lds
    ds_read_b64_tr_b16 a[32:33], v23 offset:32768
    ds_read_b64_tr_b16 a[34:35], v23 offset:33792
    ds_read_b64_tr_b16 a[36:37], v23 offset:32776
    ds_read_b64_tr_b16 a[38:39], v23 offset:33800
    ds_read_b64_tr_b16 a[40:41], v23 offset:40960
    ds_read_b64_tr_b16 a[42:43], v23 offset:41984
    ds_read_b64_tr_b16 a[44:45], v23 offset:40968
    ds_read_b64_tr_b16 a[46:47], v23 offset:41992
    s_waitcnt lgkmcnt(0)
    s_waitcnt vmcnt(28)
    s_barrier
    s_add_u32 s45, s46, 0x4d0000
    s_add_u32 m0, s47, 32768
    s_nop 0
    buffer_load_dwordx4 v21, s[24:27], s45 offen  lds
    s_add_u32 s45, s46, 0x4ec000
    s_add_u32 m0, s47, 36864
    s_nop 0
    buffer_load_dwordx4 v21, s[24:27], s45 offen  lds
    s_add_u32 s45, s46, 0x508000
    s_add_u32 m0, s47, 40960
    s_nop 0
    buffer_load_dwordx4 v21, s[24:27], s45 offen  lds
    s_add_u32 s45, s46, 0x524000
    s_add_u32 m0, s47, 45056
    s_nop 0
    buffer_load_dwordx4 v21, s[24:27], s45 offen  lds
    ds_read_b64_tr_b16 a[48:49], v23 offset:49152
    ds_read_b64_tr_b16 a[50:51], v23 offset:50176
    ds_read_b64_tr_b16 a[52:53], v23 offset:49160
    ds_read_b64_tr_b16 a[54:55], v23 offset:50184
    ds_read_b64_tr_b16 a[56:57], v23 offset:57344
    ds_read_b64_tr_b16 a[58:59], v23 offset:58368
    ds_read_b64_tr_b16 a[60:61], v23 offset:57352
    ds_read_b64_tr_b16 a[62:63], v23 offset:58376
    s_waitcnt lgkmcnt(0)
    s_waitcnt vmcnt(28)
    s_barrier
    s_add_u32 s45, s46, 0x540000
    s_add_u32 m0, s47, 49152
    s_nop 0
    buffer_load_dwordx4 v21, s[24:27], s45 offen  lds
    s_add_u32 s45, s46, 0x55c000
    s_add_u32 m0, s47, 53248
    s_nop 0
    buffer_load_dwordx4 v21, s[24:27], s45 offen  lds
    s_add_u32 s45, s46, 0x578000
    s_add_u32 m0, s47, 57344
    s_nop 0
    buffer_load_dwordx4 v21, s[24:27], s45 offen  lds
    s_add_u32 s45, s46, 0x594000
    s_add_u32 m0, s47, 61440
    s_nop 0
    buffer_load_dwordx4 v21, s[24:27], s45 offen  lds
    ds_read_b64_tr_b16 a[64:65], v24 offset:0
    ds_read_b64_tr_b16 a[66:67], v24 offset:1024
    ds_read_b64_tr_b16 a[68:69], v24 offset:8
    ds_read_b64_tr_b16 a[70:71], v24 offset:1032
    ds_read_b64_tr_b16 a[72:73], v24 offset:8192
    ds_read_b64_tr_b16 a[74:75], v24 offset:9216
    ds_read_b64_tr_b16 a[76:77], v24 offset:8200
    ds_read_b64_tr_b16 a[78:79], v24 offset:9224
    s_waitcnt lgkmcnt(0)
    s_waitcnt vmcnt(28)
    s_barrier
    s_add_u32 s45, s46, 0x5b0000
    s_add_u32 m0, s47, 65536
    s_nop 0
    buffer_load_dwordx4 v21, s[24:27], s45 offen  lds
    s_add_u32 s45, s46, 0x5cc000
    s_add_u32 m0, s47, 69632
    s_nop 0
    buffer_load_dwordx4 v21, s[24:27], s45 offen  lds
    s_add_u32 s45, s46, 0x5e8000
    s_add_u32 m0, s47, 73728
    s_nop 0
    buffer_load_dwordx4 v21, s[24:27], s45 offen  lds
    s_add_u32 s45, s46, 0x604000
    s_add_u32 m0, s47, 77824
    s_nop 0
    buffer_load_dwordx4 v21, s[24:27], s45 offen  lds
    ds_read_b64_tr_b16 a[80:81], v24 offset:16384
    ds_read_b64_tr_b16 a[82:83], v24 offset:17408
    ds_read_b64_tr_b16 a[84:85], v24 offset:16392
    ds_read_b64_tr_b16 a[86:87], v24 offset:17416
    ds_read_b64_tr_b16 a[88:89], v24 offset:24576
    ds_read_b64_tr_b16 a[90:91], v24 offset:25600
    ds_read_b64_tr_b16 a[92:93], v24 offset:24584
    ds_read_b64_tr_b16 a[94:95], v24 offset:25608
    s_waitcnt lgkmcnt(0)
    s_waitcnt vmcnt(28)
    s_barrier
    s_add_u32 s45, s46, 0x620000
    s_add_u32 m0, s47, 81920
    s_nop 0
    buffer_load_dwordx4 v21, s[24:27], s45 offen  lds
    s_add_u32 s45, s46, 0x63c000
    s_add_u32 m0, s47, 86016
    s_nop 0
    buffer_load_dwordx4 v21, s[24:27], s45 offen  lds
    s_add_u32 s45, s46, 0x658000
    s_add_u32 m0, s47, 90112
    s_nop 0
    buffer_load_dwordx4 v21, s[24:27], s45 offen  lds
    s_add_u32 s45, s46, 0x674000
    s_add_u32 m0, s47, 94208
    s_nop 0
    buffer_load_dwordx4 v21, s[24:27], s45 offen  lds
    ds_read_b64_tr_b16 a[96:97], v24 offset:32768
    ds_read_b64_tr_b16 a[98:99], v24 offset:33792
    ds_read_b64_tr_b16 a[100:101], v24 offset:32776
    ds_read_b64_tr_b16 a[102:103], v24 offset:33800
    ds_read_b64_tr_b16 a[104:105], v24 offset:40960
    ds_read_b64_tr_b16 a[106:107], v24 offset:41984
    ds_read_b64_tr_b16 a[108:109], v24 offset:40968
    ds_read_b64_tr_b16 a[110:111], v24 offset:41992
    s_waitcnt lgkmcnt(0)
    s_waitcnt vmcnt(28)
    s_barrier
    s_add_u32 s45, s46, 0x690000
    s_add_u32 m0, s47, 98304
    s_nop 0
    buffer_load_dwordx4 v21, s[24:27], s45 offen  lds
    s_add_u32 s45, s46, 0x6ac000
    s_add_u32 m0, s47, 102400
    s_nop 0
    buffer_load_dwordx4 v21, s[24:27], s45 offen  lds
    s_add_u32 s45, s46, 0x6c8000
    s_add_u32 m0, s47, 106496
    s_nop 0
    buffer_load_dwordx4 v21, s[24:27], s45 offen  lds
    s_add_u32 s45, s46, 0x6e4000
    s_add_u32 m0, s47, 110592
    s_nop 0
    buffer_load_dwordx4 v21, s[24:27], s45 offen  lds
    ds_read_b64_tr_b16 a[112:113], v24 offset:49152
    ds_read_b64_tr_b16 a[114:115], v24 offset:50176
    ds_read_b64_tr_b16 a[116:117], v24 offset:49160
    ds_read_b64_tr_b16 a[118:119], v24 offset:50184
    ds_read_b64_tr_b16 a[120:121], v24 offset:57344
    ds_read_b64_tr_b16 a[122:123], v24 offset:58368
    ds_read_b64_tr_b16 a[124:125], v24 offset:57352
    ds_read_b64_tr_b16 a[126:127], v24 offset:58376
    s_waitcnt lgkmcnt(0)
    s_waitcnt vmcnt(28)
    s_barrier
    ds_read_b64_tr_b16 a[128:129], v25 offset:0
    ds_read_b64_tr_b16 a[130:131], v25 offset:1024
    ds_read_b64_tr_b16 a[132:133], v25 offset:8
    ds_read_b64_tr_b16 a[134:135], v25 offset:1032
    ds_read_b64_tr_b16 a[136:137], v25 offset:8192
    ds_read_b64_tr_b16 a[138:139], v25 offset:9216
    ds_read_b64_tr_b16 a[140:141], v25 offset:8200
    ds_read_b64_tr_b16 a[142:143], v25 offset:9224
    s_waitcnt lgkmcnt(0)
    s_waitcnt vmcnt(24)
    s_barrier
    ds_read_b64_tr_b16 a[144:145], v23 offset:0
    ds_read_b64_tr_b16 a[146:147], v23 offset:1024
    ds_read_b64_tr_b16 a[148:149], v23 offset:8
    ds_read_b64_tr_b16 a[150:151], v23 offset:1032
    ds_read_b64_tr_b16 a[152:153], v23 offset:8192
    ds_read_b64_tr_b16 a[154:155], v23 offset:9216
    ds_read_b64_tr_b16 a[156:157], v23 offset:8200
    ds_read_b64_tr_b16 a[158:159], v23 offset:9224
    s_waitcnt lgkmcnt(0)
    s_waitcnt vmcnt(20)
    s_barrier
    ds_read_b64_tr_b16 a[160:161], v23 offset:16384
    ds_read_b64_tr_b16 a[162:163], v23 offset:17408
    ds_read_b64_tr_b16 a[164:165], v23 offset:16392
    ds_read_b64_tr_b16 a[166:167], v23 offset:17416
    ds_read_b64_tr_b16 a[168:169], v23 offset:24576
    ds_read_b64_tr_b16 a[170:171], v23 offset:25600
    ds_read_b64_tr_b16 a[172:173], v23 offset:24584
    ds_read_b64_tr_b16 a[174:175], v23 offset:25608
    s_waitcnt lgkmcnt(0)
    s_waitcnt vmcnt(16)
    s_barrier
    ds_read_b64_tr_b16 a[176:177], v23 offset:32768
    ds_read_b64_tr_b16 a[178:179], v23 offset:33792
    ds_read_b64_tr_b16 a[180:181], v23 offset:32776
    ds_read_b64_tr_b16 a[182:183], v23 offset:33800
    ds_read_b64_tr_b16 a[184:185], v23 offset:40960
    ds_read_b64_tr_b16 a[186:187], v23 offset:41984
    ds_read_b64_tr_b16 a[188:189], v23 offset:40968
    ds_read_b64_tr_b16 a[190:191], v23 offset:41992
    s_waitcnt lgkmcnt(0)
    s_waitcnt vmcnt(12)
    s_barrier
    ds_read_b64_tr_b16 a[192:193], v23 offset:49152
    ds_read_b64_tr_b16 a[194:195], v23 offset:50176
    ds_read_b64_tr_b16 a[196:197], v23 offset:49160
    ds_read_b64_tr_b16 a[198:199], v23 offset:50184
    ds_read_b64_tr_b16 a[200:201], v23 offset:57344
    ds_read_b64_tr_b16 a[202:203], v23 offset:58368
    ds_read_b64_tr_b16 a[204:205], v23 offset:57352
    ds_read_b64_tr_b16 a[206:207], v23 offset:58376
    s_waitcnt lgkmcnt(0)
    s_waitcnt vmcnt(8)
    s_barrier
    ds_read_b64_tr_b16 a[208:209], v24 offset:0
    ds_read_b64_tr_b16 a[210:211], v24 offset:1024
    ds_read_b64_tr_b16 a[212:213], v24 offset:8
    ds_read_b64_tr_b16 a[214:215], v24 offset:1032
    ds_read_b64_tr_b16 a[216:217], v24 offset:8192
    ds_read_b64_tr_b16 a[218:219], v24 offset:9216
    ds_read_b64_tr_b16 a[220:221], v24 offset:8200
    ds_read_b64_tr_b16 a[222:223], v24 offset:9224
    s_waitcnt lgkmcnt(0)
    s_waitcnt vmcnt(4)
    s_barrier
    ds_read_b64_tr_b16 a[224:225], v24 offset:16384
    ds_read_b64_tr_b16 a[226:227], v24 offset:17408
    ds_read_b64_tr_b16 a[228:229], v24 offset:16392
    ds_read_b64_tr_b16 a[230:231], v24 offset:17416
    ds_read_b64_tr_b16 a[232:233], v24 offset:24576
    ds_read_b64_tr_b16 a[234:235], v24 offset:25600
    ds_read_b64_tr_b16 a[236:237], v24 offset:24584
    ds_read_b64_tr_b16 a[238:239], v24 offset:25608
    s_waitcnt lgkmcnt(0)
    s_waitcnt vmcnt(0)
    s_barrier
    ds_read_b64_tr_b16 a[240:241], v24 offset:32768
    ds_read_b64_tr_b16 a[242:243], v24 offset:33792
    ds_read_b64_tr_b16 a[244:245], v24 offset:32776
    ds_read_b64_tr_b16 a[246:247], v24 offset:33800
    ds_read_b64_tr_b16 a[248:249], v24 offset:40960
    ds_read_b64_tr_b16 a[250:251], v24 offset:41984
    ds_read_b64_tr_b16 a[252:253], v24 offset:40968
    ds_read_b64_tr_b16 a[254:255], v24 offset:41992
    s_waitcnt lgkmcnt(0)
    s_barrier
    s_min_u32 s45, s41, 27
    s_lshl_b32 s45, s45, 8
    s_lshl_b32 s46, s44, 6
    s_add_u32 s45, s45, s46
    v_lshrrev_b32 v29, 4, v1
    v_lshlrev_b32 v29, 4, v29
    buffer_load_dwordx4 v[80:83], v29, s[32:35], s45 offen
    s_waitcnt vmcnt(0)
    v_lshlrev_b32 v96, 16, v80
    v_and_b32 v97, 0xffff0000, v80
    v_lshlrev_b32 v98, 16, v81
    v_and_b32 v99, 0xffff0000, v81
    v_lshlrev_b32 v100, 16, v82
    v_and_b32 v101, 0xffff0000, v82
    v_lshlrev_b32 v102, 16, v83
    v_and_b32 v103, 0xffff0000, v83
    v_mov_b32 v104, 0xbdd2d3e8
    v_mov_b32 v105, v104
    v_mov_b32 v106, 0xc0135761
    v_mov_b32 v107, v106
    s_cmp_lg_u32 s44, 0
    s_cbranch_scc1 L_pd_137
    v_mov_b32 v29, 132
    s_mov_b32 s46, 96
    s_mov_b64 exec, 1
    s_mov_b32 s70, 0
L_wp_138:
    buffer_load_dword v31, v29, s[16:19], 0 offen sc1
    s_add_u32 s70, s70, 1
    s_cmp_ge_u32 s70, 0x200000
    s_cbranch_scc1 L_w_done_102
    s_waitcnt vmcnt(0)
    v_cmp_gt_u32 vcc, s46, v31
    s_nop 1
    s_cbranch_vccz L_wp_138_ok
    s_sleep 3
    s_branch L_wp_138
L_wp_138_ok:
    s_mov_b64 exec, -1
L_pd_137:
    s_barrier
    v_lshlrev_b32 v29, 5, v1
    s_mov_b32 s45, 8192
    buffer_load_dwordx4 v[112:115], v29, s[12:15], s45 offen offset:0 sc1
    buffer_load_dwordx4 v[116:119], v29, s[12:15], s45 offen offset:16 sc1
    buffer_load_dwordx4 v[120:123], v29, s[12:15], s45 offen offset:2048 sc1
    buffer_load_dwordx4 v[124:127], v29, s[12:15], s45 offen offset:2064 sc1
    s_mov_b32 s45, 32768
    buffer_load_dwordx4 v[32:35], v29, s[12:15], s45 offen offset:0 sc1
    buffer_load_dwordx4 v[36:39], v29, s[12:15], s45 offen offset:16 sc1
    buffer_load_dwordx4 v[40:43], v29, s[12:15], s45 offen offset:2048 sc1
    buffer_load_dwordx4 v[44:47], v29, s[12:15], s45 offen offset:2064 sc1
    s_mov_b32 s45, 12288
    buffer_load_dwordx4 v[128:131], v29, s[12:15], s45 offen offset:0 sc1
    buffer_load_dwordx4 v[132:135], v29, s[12:15], s45 offen offset:16 sc1
    buffer_load_dwordx4 v[136:139], v29, s[12:15], s45 offen offset:2048 sc1
    buffer_load_dwordx4 v[140:143], v29, s[12:15], s45 offen offset:2064 sc1
    s_mov_b32 s45, 36864
    buffer_load_dwordx4 v[48:51], v29, s[12:15], s45 offen offset:0 sc1
    buffer_load_dwordx4 v[52:55], v29, s[12:15], s45 offen offset:16 sc1
    buffer_load_dwordx4 v[56:59], v29, s[12:15], s45 offen offset:2048 sc1
    buffer_load_dwordx4 v[60:63], v29, s[12:15], s45 offen offset:2064 sc1
    s_mov_b32 s45, 16384
    buffer_load_dwordx4 v[144:147], v29, s[12:15], s45 offen offset:0 sc1
    buffer_load_dwordx4 v[148:151], v29, s[12:15], s45 offen offset:16 sc1
    buffer_load_dwordx4 v[152:155], v29, s[12:15], s45 offen offset:2048 sc1
    buffer_load_dwordx4 v[156:159], v29, s[12:15], s45 offen offset:2064 sc1
    s_mov_b32 s45, 40960
    buffer_load_dwordx4 v[64:67], v29, s[12:15], s45 offen offset:0 sc1
    buffer_load_dwordx4 v[68:71], v29, s[12:15], s45 offen offset:16 sc1
    buffer_load_dwordx4 v[72:75], v29, s[12:15], s45 offen offset:2048 sc1
    buffer_load_dwordx4 v[76:79], v29, s[12:15], s45 offen offset:2064 sc1
    s_waitcnt vmcnt(0)
    v_add_f32 v112, v112, v32
    v_cvt_pk_bf16_f32 v112, v112, v112
    v_lshlrev_b32 v112, 16, v112
    v_add_f32 v113, v113, v33
    v_cvt_pk_bf16_f32 v113, v113, v113
    v_lshlrev_b32 v113, 16, v113
    v_add_f32 v114, v114, v34
    v_cvt_pk_bf16_f32 v114, v114, v114
    v_lshlrev_b32 v114, 16, v114
    v_add_f32 v115, v115, v35
    v_cvt_pk_bf16_f32 v115, v115, v115
    v_lshlrev_b32 v115, 16, v115
    v_add_f32 v116, v116, v36
    v_cvt_pk_bf16_f32 v116, v116, v116
    v_lshlrev_b32 v116, 16, v116
    v_add_f32 v117, v117, v37
    v_cvt_pk_bf16_f32 v117, v117, v117
    v_lshlrev_b32 v117, 16, v117
    v_add_f32 v118, v118, v38
    v_cvt_pk_bf16_f32 v118, v118, v118
    v_lshlrev_b32 v118, 16, v118
    v_add_f32 v119, v119, v39
    v_cvt_pk_bf16_f32 v119, v119, v119
    v_lshlrev_b32 v119, 16, v119
    v_add_f32 v120, v120, v40
    v_cvt_pk_bf16_f32 v120, v120, v120
    v_lshlrev_b32 v120, 16, v120
    v_add_f32 v121, v121, v41
    v_cvt_pk_bf16_f32 v121, v121, v121
    v_lshlrev_b32 v121, 16, v121
    v_add_f32 v122, v122, v42
    v_cvt_pk_bf16_f32 v122, v122, v122
    v_lshlrev_b32 v122, 16, v122
    v_add_f32 v123, v123, v43
    v_cvt_pk_bf16_f32 v123, v123, v123
    v_lshlrev_b32 v123, 16, v123
    v_add_f32 v124, v124, v44
    v_cvt_pk_bf16_f32 v124, v124, v124
    v_lshlrev_b32 v124, 16, v124
    v_add_f32 v125, v125, v45
    v_cvt_pk_bf16_f32 v125, v125, v125
    v_lshlrev_b32 v125, 16, v125
    v_add_f32 v126, v126, v46
    v_cvt_pk_bf16_f32 v126, v126, v126
    v_lshlrev_b32 v126, 16, v126
    v_add_f32 v127, v127, v47
    v_cvt_pk_bf16_f32 v127, v127, v127
    v_lshlrev_b32 v127, 16, v127
    v_add_f32 v128, v128, v48
    v_cvt_pk_bf16_f32 v128, v128, v128
    v_lshlrev_b32 v128, 16, v128
    v_add_f32 v129, v129, v49
    v_cvt_pk_bf16_f32 v129, v129, v129
    v_lshlrev_b32 v129, 16, v129
    v_add_f32 v130, v130, v50
    v_cvt_pk_bf16_f32 v130, v130, v130
    v_lshlrev_b32 v130, 16, v130
    v_add_f32 v131, v131, v51
    v_cvt_pk_bf16_f32 v131, v131, v131
    v_lshlrev_b32 v131, 16, v131
    v_add_f32 v132, v132, v52
    v_cvt_pk_bf16_f32 v132, v132, v132
    v_lshlrev_b32 v132, 16, v132
    v_add_f32 v133, v133, v53
    v_cvt_pk_bf16_f32 v133, v133, v133
    v_lshlrev_b32 v133, 16, v133
    v_add_f32 v134, v134, v54
    v_cvt_pk_bf16_f32 v134, v134, v134
    v_lshlrev_b32 v134, 16, v134
    v_add_f32 v135, v135, v55
    v_cvt_pk_bf16_f32 v135, v135, v135
    v_lshlrev_b32 v135, 16, v135
    v_add_f32 v136, v136, v56
    v_cvt_pk_bf16_f32 v136, v136, v136
    v_lshlrev_b32 v136, 16, v136
    v_add_f32 v137, v137, v57
    v_cvt_pk_bf16_f32 v137, v137, v137
    v_lshlrev_b32 v137, 16, v137
    v_add_f32 v138, v138, v58
    v_cvt_pk_bf16_f32 v138, v138, v138
    v_lshlrev_b32 v138, 16, v138
    v_add_f32 v139, v139, v59
    v_cvt_pk_bf16_f32 v139, v139, v139
    v_lshlrev_b32 v139, 16, v139
    v_add_f32 v140, v140, v60
    v_cvt_pk_bf16_f32 v140, v140, v140
    v_lshlrev_b32 v140, 16, v140
    v_add_f32 v141, v141, v61
    v_cvt_pk_bf16_f32 v141, v141, v141
    v_lshlrev_b32 v141, 16, v141
    v_add_f32 v142, v142, v62
    v_cvt_pk_bf16_f32 v142, v142, v142
    v_lshlrev_b32 v142, 16, v142
    v_add_f32 v143, v143, v63
    v_cvt_pk_bf16_f32 v143, v143, v143
    v_lshlrev_b32 v143, 16, v143
    v_add_f32 v144, v144, v64
    v_cvt_pk_bf16_f32 v144, v144, v144
    v_lshlrev_b32 v144, 16, v144
    v_add_f32 v144, 1.0, v144
    v_cvt_pk_bf16_f32 v144, v144, v144
    v_lshlrev_b32 v144, 16, v144
    v_add_f32 v145, v145, v65
    v_cvt_pk_bf16_f32 v145, v145, v145
    v_lshlrev_b32 v145, 16, v145
    v_add_f32 v145, 1.0, v145
    v_cvt_pk_bf16_f32 v145, v145, v145
    v_lshlrev_b32 v145, 16, v145
    v_add_f32 v146, v146, v66
    v_cvt_pk_bf16_f32 v146, v146, v146
    v_lshlrev_b32 v146, 16, v146
    v_add_f32 v146, 1.0, v146
    v_cvt_pk_bf16_f32 v146, v146, v146
    v_lshlrev_b32 v146, 16, v146
    v_add_f32 v147, v147, v67
    v_cvt_pk_bf16_f32 v147, v147, v147
    v_lshlrev_b32 v147, 16, v147
    v_add_f32 v147, 1.0, v147
    v_cvt_pk_bf16_f32 v147, v147, v147
    v_lshlrev_b32 v147, 16, v147
    v_add_f32 v148, v148, v68
    v_cvt_pk_bf16_f32 v148, v148, v148
    v_lshlrev_b32 v148, 16, v148
    v_add_f32 v148, 1.0, v148
    v_cvt_pk_bf16_f32 v148, v148, v148
    v_lshlrev_b32 v148, 16, v148
    v_add_f32 v149, v149, v69
    v_cvt_pk_bf16_f32 v149, v149, v149
    v_lshlrev_b32 v149, 16, v149
    v_add_f32 v149, 1.0, v149
    v_cvt_pk_bf16_f32 v149, v149, v149
    v_lshlrev_b32 v149, 16, v149
    v_add_f32 v150, v150, v70
    v_cvt_pk_bf16_f32 v150, v150, v150
    v_lshlrev_b32 v150, 16, v150
    v_add_f32 v150, 1.0, v150
    v_cvt_pk_bf16_f32 v150, v150, v150
    v_lshlrev_b32 v150, 16, v150
    v_add_f32 v151, v151, v71
    v_cvt_pk_bf16_f32 v151, v151, v151
    v_lshlrev_b32 v151, 16, v151
    v_add_f32 v151, 1.0, v151
    v_cvt_pk_bf16_f32 v151, v151, v151
    v_lshlrev_b32 v151, 16, v151
    v_add_f32 v152, v152, v72
    v_cvt_pk_bf16_f32 v152, v152, v152
    v_lshlrev_b32 v152, 16, v152
    v_add_f32 v152, 1.0, v152
    v_cvt_pk_bf16_f32 v152, v152, v152
    v_lshlrev_b32 v152, 16, v152
    v_add_f32 v153, v153, v73
    v_cvt_pk_bf16_f32 v153, v153, v153
    v_lshlrev_b32 v153, 16, v153
    v_add_f32 v153, 1.0, v153
    v_cvt_pk_bf16_f32 v153, v153, v153
    v_lshlrev_b32 v153, 16, v153
    v_add_f32 v154, v154, v74
    v_cvt_pk_bf16_f32 v154, v154, v154
    v_lshlrev_b32 v154, 16, v154
    v_add_f32 v154, 1.0, v154
    v_cvt_pk_bf16_f32 v154, v154, v154
    v_lshlrev_b32 v154, 16, v154
    v_add_f32 v155, v155, v75
    v_cvt_pk_bf16_f32 v155, v155, v155
    v_lshlrev_b32 v155, 16, v155
    v_add_f32 v155, 1.0, v155
    v_cvt_pk_bf16_f32 v155, v155, v155
    v_lshlrev_b32 v155, 16, v155
    v_add_f32 v156, v156, v76
    v_cvt_pk_bf16_f32 v156, v156, v156
    v_lshlrev_b32 v156, 16, v156
    v_add_f32 v156, 1.0, v156
    v_cvt_pk_bf16_f32 v156, v156, v156
    v_lshlrev_b32 v156, 16, v156
    v_add_f32 v157, v157, v77
    v_cvt_pk_bf16_f32 v157, v157, v157
    v_lshlrev_b32 v157, 16, v157
    v_add_f32 v157, 1.0, v157
    v_cvt_pk_bf16_f32 v157, v157, v157
    v_lshlrev_b32 v157, 16, v157
    v_add_f32 v158, v158, v78
    v_cvt_pk_bf16_f32 v158, v158, v158
    v_lshlrev_b32 v158, 16, v158
    v_add_f32 v158, 1.0, v158
    v_cvt_pk_bf16_f32 v158, v158, v158
    v_lshlrev_b32 v158, 16, v158
    v_add_f32 v159, v159, v79
    v_cvt_pk_bf16_f32 v159, v159, v159
    v_lshlrev_b32 v159, 16, v159
    v_add_f32 v159, 1.0, v159
    v_cvt_pk_bf16_f32 v159, v159, v159
    v_lshlrev_b32 v159, 16, v159
    s_mov_b32 s52, 0xc00000
    s_lshl_b32 s56, s41, 13
    s_add_u32 s56, s56, 0x6000000
L_b_loop_139:
    s_cmp_eq_u64 s[36:37], 0
    s_cbranch_scc1 L_w_done_102
    s_ff1_i32_b64 s50, s[36:37]
    s_bitset0_b64 s[36:37], s50
    s_lshr_b64 s[74:75], s[72:73], s50
    s_ff1_i32_b64 s51, s[74:75]
    s_add_u32 s51, s51, 1
    s_add_u32 s62, s50, s51
    s_add_u32 s63, s50, s44
    s_lshl_b32 s63, s63, 5
    s_add_u32 s63, s63, s41
    s_lshl_b32 s47, s63, 11
    buffer_load_dwordx4 v[208:211], v10, s[28:31], s47 offen
    buffer_load_dwordx4 v[212:215], v10, s[28:31], s47 offen offset:1024
    s_add_u32 s45, s64, 4096
    s_cmp_lg_u32 s44, 0
    s_cbranch_scc1 L_pw_142
    s_mov_b32 exec_hi, 0
    s_mov_b32 s70, 0
L_wp_143:
    buffer_load_dword v31, v5, s[12:15], s45 offen sc1
    s_add_u32 s70, s70, 1
    s_cmp_ge_u32 s70, 0x200000
    s_cbranch_scc1 L_w_done_102
    s_waitcnt vmcnt(0)
    v_cmp_gt_u32 vcc, s62, v31
    s_nop 1
    s_cbranch_vccz L_wp_143_ok
    s_sleep 2
    s_branch L_wp_143
L_wp_143_ok:
    s_mov_b64 exec, -1
L_pw_142:
    s_barrier
    s_cmp_ge_u32 s44, s51
    s_cbranch_scc1 L_b_skip_140
    s_lshl_b32 s45, s63, 12
    s_add_u32 s45, s45, 0x8000000
    v_lshlrev_b32 v29, 5, v1
    buffer_load_dwordx4 v[64:67], v29, s[12:15], s45 offen offset:0 sc1
    buffer_load_dwordx4 v[68:71], v29, s[12:15], s45 offen offset:16 sc1
    buffer_load_dwordx4 v[72:75], v29, s[12:15], s45 offen offset:2048 sc1
    buffer_load_dwordx4 v[76:79], v29, s[12:15], s45 offen offset:2064 sc1
    s_add_u32 s45, s45, 0x800000
    buffer_load_dwordx4 v[160:163], v29, s[12:15], s45 offen offset:0 sc1
    buffer_load_dwordx4 v[164:167], v29, s[12:15], s45 offen offset:16 sc1
    buffer_load_dwordx4 v[168:171], v29, s[12:15], s45 offen offset:2048 sc1
    buffer_load_dwordx4 v[172:175], v29, s[12:15], s45 offen offset:2064 sc1
    s_add_u32 s45, s45, 0x800000
    buffer_load_dwordx4 v[176:179], v29, s[12:15], s45 offen offset:0 sc1
    buffer_load_dwordx4 v[180:183], v29, s[12:15], s45 offen offset:16 sc1
    buffer_load_dwordx4 v[184:187], v29, s[12:15], s45 offen offset:2048 sc1
    buffer_load_dwordx4 v[188:191], v29, s[12:15], s45 offen offset:2064 sc1
    s_add_u32 s45, s45, 0x800000
    buffer_load_dwordx4 v[192:195], v29, s[12:15], s45 offen offset:0 sc1
    buffer_load_dwordx4 v[196:199], v29, s[12:15], s45 offen offset:16 sc1
    buffer_load_dwordx4 v[200:203], v29, s[12:15], s45 offen offset:2048 sc1
    buffer_load_dwordx4 v[204:207], v29, s[12:15], s45 offen offset:2064 sc1
    s_waitcnt vmcnt(0)
    v_pk_add_f32 v[64:65], v[64:65], v[160:161]
    v_pk_add_f32 v[176:177], v[176:177], v[192:193]
    v_pk_add_f32 v[66:67], v[66:67], v[162:163]
    v_pk_add_f32 v[178:179], v[178:179], v[194:195]
    v_pk_add_f32 v[68:69], v[68:69], v[164:165]
    v_pk_add_f32 v[180:181], v[180:181], v[196:197]
    v_pk_add_f32 v[70:71], v[70:71], v[166:167]
    v_pk_add_f32 v[182:183], v[182:183], v[198:199]
    v_pk_add_f32 v[72:73], v[72:73], v[168:169]
    v_pk_add_f32 v[184:185], v[184:185], v[200:201]
    v_pk_add_f32 v[74:75], v[74:75], v[170:171]
    v_pk_add_f32 v[186:187], v[186:187], v[202:203]
    v_pk_add_f32 v[76:77], v[76:77], v[172:173]
    v_pk_add_f32 v[188:189], v[188:189], v[204:205]
    v_pk_add_f32 v[78:79], v[78:79], v[174:175]
    v_pk_add_f32 v[190:191], v[190:191], v[206:207]
    v_pk_add_f32 v[64:65], v[64:65], v[176:177]
    v_pk_add_f32 v[66:67], v[66:67], v[178:179]
    v_pk_add_f32 v[68:69], v[68:69], v[180:181]
    v_pk_add_f32 v[70:71], v[70:71], v[182:183]
    v_pk_add_f32 v[72:73], v[72:73], v[184:185]
    v_pk_add_f32 v[74:75], v[74:75], v[186:187]
    v_pk_add_f32 v[76:77], v[76:77], v[188:189]
    v_pk_add_f32 v[78:79], v[78:79], v[190:191]
    v_cvt_pk_bf16_f32 v64, v64, v64
    v_lshlrev_b32 v64, 16, v64
    v_cvt_pk_bf16_f32 v65, v65, v65
    v_lshlrev_b32 v65, 16, v65
    v_cvt_pk_bf16_f32 v66, v66, v66
    v_lshlrev_b32 v66, 16, v66
    v_cvt_pk_bf16_f32 v67, v67, v67
    v_lshlrev_b32 v67, 16, v67
    v_cvt_pk_bf16_f32 v68, v68, v68
    v_lshlrev_b32 v68, 16, v68
    v_cvt_pk_bf16_f32 v69, v69, v69
    v_lshlrev_b32 v69, 16, v69
    v_cvt_pk_bf16_f32 v70, v70, v70
    v_lshlrev_b32 v70, 16, v70
    v_cvt_pk_bf16_f32 v71, v71, v71
    v_lshlrev_b32 v71, 16, v71
    v_cvt_pk_bf16_f32 v72, v72, v72
    v_lshlrev_b32 v72, 16, v72
    v_cvt_pk_bf16_f32 v73, v73, v73
    v_lshlrev_b32 v73, 16, v73
    v_cvt_pk_bf16_f32 v74, v74, v74
    v_lshlrev_b32 v74, 16, v74
    v_cvt_pk_bf16_f32 v75, v75, v75
    v_lshlrev_b32 v75, 16, v75
    v_cvt_pk_bf16_f32 v76, v76, v76
    v_lshlrev_b32 v76, 16, v76
    v_cvt_pk_bf16_f32 v77, v77, v77
    v_lshlrev_b32 v77, 16, v77
    v_cvt_pk_bf16_f32 v78, v78, v78
    v_lshlrev_b32 v78, 16, v78
    v_cvt_pk_bf16_f32 v79, v79, v79
    v_lshlrev_b32 v79, 16, v79
    v_lshlrev_b32 v160, 16, v208
    v_and_b32 v161, 0xffff0000, v208
    v_lshlrev_b32 v162, 16, v209
    v_and_b32 v163, 0xffff0000, v209
    v_lshlrev_b32 v164, 16, v210
    v_and_b32 v165, 0xffff0000, v210
    v_lshlrev_b32 v166, 16, v211
    v_and_b32 v167, 0xffff0000, v211
    v_lshlrev_b32 v168, 16, v212
    v_and_b32 v169, 0xffff0000, v212
    v_lshlrev_b32 v170, 16, v213
    v_and_b32 v171, 0xffff0000, v213
    v_lshlrev_b32 v172, 16, v214
    v_and_b32 v173, 0xffff0000, v214
    v_lshlrev_b32 v174, 16, v215
    v_and_b32 v175, 0xffff0000, v215
    v_mul_f32 v64, v64, v112
    v_cvt_pk_bf16_f32 v64, v64, v64
    v_lshlrev_b32 v64, 16, v64
    v_add_f32 v64, v64, v160
    v_mul_f32 v65, v65, v113
    v_cvt_pk_bf16_f32 v65, v65, v65
    v_lshlrev_b32 v65, 16, v65
    v_add_f32 v65, v65, v161
    v_mul_f32 v66, v66, v114
    v_cvt_pk_bf16_f32 v66, v66, v66
    v_lshlrev_b32 v66, 16, v66
    v_add_f32 v66, v66, v162
    v_mul_f32 v67, v67, v115
    v_cvt_pk_bf16_f32 v67, v67, v67
    v_lshlrev_b32 v67, 16, v67
    v_add_f32 v67, v67, v163
    v_mul_f32 v68, v68, v116
    v_cvt_pk_bf16_f32 v68, v68, v68
    v_lshlrev_b32 v68, 16, v68
    v_add_f32 v68, v68, v164
    v_mul_f32 v69, v69, v117
    v_cvt_pk_bf16_f32 v69, v69, v69
    v_lshlrev_b32 v69, 16, v69
    v_add_f32 v69, v69, v165
    v_mul_f32 v70, v70, v118
    v_cvt_pk_bf16_f32 v70, v70, v70
    v_lshlrev_b32 v70, 16, v70
    v_add_f32 v70, v70, v166
    v_mul_f32 v71, v71, v119
    v_cvt_pk_bf16_f32 v71, v71, v71
    v_lshlrev_b32 v71, 16, v71
    v_add_f32 v71, v71, v167
    v_mul_f32 v72, v72, v120
    v_cvt_pk_bf16_f32 v72, v72, v72
    v_lshlrev_b32 v72, 16, v72
    v_add_f32 v72, v72, v168
    v_mul_f32 v73, v73, v121
    v_cvt_pk_bf16_f32 v73, v73, v73
    v_lshlrev_b32 v73, 16, v73
    v_add_f32 v73, v73, v169
    v_mul_f32 v74, v74, v122
    v_cvt_pk_bf16_f32 v74, v74, v74
    v_lshlrev_b32 v74, 16, v74
    v_add_f32 v74, v74, v170
    v_mul_f32 v75, v75, v123
    v_cvt_pk_bf16_f32 v75, v75, v75
    v_lshlrev_b32 v75, 16, v75
    v_add_f32 v75, v75, v171
    v_mul_f32 v76, v76, v124
    v_cvt_pk_bf16_f32 v76, v76, v76
    v_lshlrev_b32 v76, 16, v76
    v_add_f32 v76, v76, v172
    v_mul_f32 v77, v77, v125
    v_cvt_pk_bf16_f32 v77, v77, v77
    v_lshlrev_b32 v77, 16, v77
    v_add_f32 v77, v77, v173
    v_mul_f32 v78, v78, v126
    v_cvt_pk_bf16_f32 v78, v78, v78
    v_lshlrev_b32 v78, 16, v78
    v_add_f32 v78, v78, v174
    v_mul_f32 v79, v79, v127
    v_cvt_pk_bf16_f32 v79, v79, v79
    v_lshlrev_b32 v79, 16, v79
    v_add_f32 v79, v79, v175
    v_cvt_pk_bf16_f32 v208, v64, v65
    v_cvt_pk_bf16_f32 v209, v66, v67
    v_cvt_pk_bf16_f32 v210, v68, v69
    v_cvt_pk_bf16_f32 v211, v70, v71
    v_cvt_pk_bf16_f32 v212, v72, v73
    v_cvt_pk_bf16_f32 v213, v74, v75
    v_cvt_pk_bf16_f32 v214, v76, v77
    v_cvt_pk_bf16_f32 v215, v78, v79
    s_add_u32 s47, s47, 0x800000
    buffer_store_dwordx4 v[208:211], v10, s[12:15], s47 offen sc1
    buffer_store_dwordx4 v[212:215], v10, s[12:15], s47 offen offset:1024 sc1
    v_lshlrev_b32 v64, 16, v208
    v_and_b32 v65, 0xffff0000, v208
    v_lshlrev_b32 v66, 16, v209
    v_and_b32 v67, 0xffff0000, v209
    v_lshlrev_b32 v68, 16, v210
    v_and_b32 v69, 0xffff0000, v210
    v_lshlrev_b32 v70, 16, v211
    v_and_b32 v71, 0xffff0000, v211
    v_lshlrev_b32 v72, 16, v212
    v_and_b32 v73, 0xffff0000, v212
    v_lshlrev_b32 v74, 16, v213
    v_and_b32 v75, 0xffff0000, v213
    v_lshlrev_b32 v76, 16, v214
    v_and_b32 v77, 0xffff0000, v214
    v_lshlrev_b32 v78, 16, v215
    v_and_b32 v79, 0xffff0000, v215
    v_add_f32 v26, v64, v65
    v_add_f32 v26, v26, v66
    v_add_f32 v26, v26, v67
    v_add_f32 v26, v26, v68
    v_add_f32 v26, v26, v69
    v_add_f32 v26, v26, v70
    v_add_f32 v26, v26, v71
    v_add_f32 v26, v26, v72
    v_add_f32 v26, v26, v73
    v_add_f32 v26, v26, v74
    v_add_f32 v26, v26, v75
    v_add_f32 v26, v26, v76
    v_add_f32 v26, v26, v77
    v_add_f32 v26, v26, v78
    v_add_f32 v26, v26, v79
    s_nop 1
    v_add_f32_dpp v26, v26, v26 row_shr:1 row_mask:0xf bank_mask:0xf bound_ctrl:0
    s_nop 1
    v_add_f32_dpp v26, v26, v26 row_shr:2 row_mask:0xf bank_mask:0xf bound_ctrl:0
    s_nop 1
    v_add_f32_dpp v26, v26, v26 row_shr:4 row_mask:0xf bank_mask:0xf bound_ctrl:0
    s_nop 1
    v_add_f32_dpp v26, v26, v26 row_shr:8 row_mask:0xf bank_mask:0xf bound_ctrl:0
    s_nop 1
    v_add_f32_dpp v26, v26, v26 row_bcast:15 row_mask:0xa bank_mask:0xf
    s_nop 1
    v_add_f32_dpp v26, v26, v26 row_bcast:31 row_mask:0xc bank_mask:0xf
    s_nop 1
    v_readlane_b32 s66, v26, 63
    s_nop 1
    v_mov_b32 v27, s66
    v_mul_f32 v27, 0x3a800000, v27
    v_mov_b32 v26, 0
    v_sub_f32 v28, v64, v27
    v_fmac_f32 v26, v28, v28
    v_sub_f32 v28, v65, v27
    v_fmac_f32 v26, v28, v28
    v_sub_f32 v28, v66, v27
    v_fmac_f32 v26, v28, v28
    v_sub_f32 v28, v67, v27
    v_fmac_f32 v26, v28, v28
    v_sub_f32 v28, v68, v27
    v_fmac_f32 v26, v28, v28
    v_sub_f32 v28, v69, v27
    v_fmac_f32 v26, v28, v28
    v_sub_f32 v28, v70, v27
    v_fmac_f32 v26, v28, v28
    v_sub_f32 v28, v71, v27
    v_fmac_f32 v26, v28, v28
    v_sub_f32 v28, v72, v27
    v_fmac_f32 v26, v28, v28
    v_sub_f32 v28, v73, v27
    v_fmac_f32 v26, v28, v28
    v_sub_f32 v28, v74, v27
    v_fmac_f32 v26, v28, v28
    v_sub_f32 v28, v75, v27
    v_fmac_f32 v26, v28, v28
    v_sub_f32 v28, v76, v27
    v_fmac_f32 v26, v28, v28
    v_sub_f32 v28, v77, v27
    v_fmac_f32 v26, v28, v28
    v_sub_f32 v28, v78, v27
    v_fmac_f32 v26, v28, v28
    v_sub_f32 v28, v79, v27
    v_fmac_f32 v26, v28, v28
    s_nop 1
    v_add_f32_dpp v26, v26, v26 row_shr:1 row_mask:0xf bank_mask:0xf bound_ctrl:0
    s_nop 1
    v_add_f32_dpp v26, v26, v26 row_shr:2 row_mask:0xf bank_mask:0xf bound_ctrl:0
    s_nop 1
    v_add_f32_dpp v26, v26, v26 row_shr:4 row_mask:0xf bank_mask:0xf bound_ctrl:0
    s_nop 1
    v_add_f32_dpp v26, v26, v26 row_shr:8 row_mask:0xf bank_mask:0xf bound_ctrl:0
    s_nop 1
    v_add_f32_dpp v26, v26, v26 row_bcast:15 row_mask:0xa bank_mask:0xf
    s_nop 1
    v_add_f32_dpp v26, v26, v26 row_bcast:31 row_mask:0xc bank_mask:0xf
    s_nop 1
    v_readlane_b32 s66, v26, 63
    s_nop 1
    v_mov_b32 v26, s66
    v_mul_f32 v26, 0x3a800000, v26
    v_cvt_pk_bf16_f32 v26, v26, v26
    v_lshlrev_b32 v26, 16, v26
    v_cvt_pk_bf16_f32 v27, v27, v27
    v_lshlrev_b32 v27, 16, v27
    v_add_f32 v26, 0x3727c5ac, v26
    v_cvt_pk_bf16_f32 v26, v26, v26
    v_lshlrev_b32 v26, 16, v26
    v_sqrt_f32 v26, v26
    s_nop 0
    v_cvt_pk_bf16_f32 v26, v26, v26
    v_lshlrev_b32 v26, 16, v26
    v_rcp_f32 v26, v26
    s_nop 0
    v_sub_f32 v64, v64, v27
    v_cvt_pk_bf16_f32 v64, v64, v64
    v_lshlrev_b32 v64, 16, v64
    v_mul_f32 v64, v64, v26
    v_cvt_pk_bf16_f32 v64, v64, v64
    v_lshlrev_b32 v64, 16, v64
    v_sub_f32 v65, v65, v27
    v_cvt_pk_bf16_f32 v65, v65, v65
    v_lshlrev_b32 v65, 16, v65
    v_mul_f32 v65, v65, v26
    v_cvt_pk_bf16_f32 v65, v65, v65
    v_lshlrev_b32 v65, 16, v65
    v_sub_f32 v66, v66, v27
    v_cvt_pk_bf16_f32 v66, v66, v66
    v_lshlrev_b32 v66, 16, v66
    v_mul_f32 v66, v66, v26
    v_cvt_pk_bf16_f32 v66, v66, v66
    v_lshlrev_b32 v66, 16, v66
    v_sub_f32 v67, v67, v27
    v_cvt_pk_bf16_f32 v67, v67, v67
    v_lshlrev_b32 v67, 16, v67
    v_mul_f32 v67, v67, v26
    v_cvt_pk_bf16_f32 v67, v67, v67
    v_lshlrev_b32 v67, 16, v67
    v_sub_f32 v68, v68, v27
    v_cvt_pk_bf16_f32 v68, v68, v68
    v_lshlrev_b32 v68, 16, v68
    v_mul_f32 v68, v68, v26
    v_cvt_pk_bf16_f32 v68, v68, v68
    v_lshlrev_b32 v68, 16, v68
    v_sub_f32 v69, v69, v27
    v_cvt_pk_bf16_f32 v69, v69, v69
    v_lshlrev_b32 v69, 16, v69
    v_mul_f32 v69, v69, v26
    v_cvt_pk_bf16_f32 v69, v69, v69
    v_lshlrev_b32 v69, 16, v69
    v_sub_f32 v70, v70, v27
    v_cvt_pk_bf16_f32 v70, v70, v70
    v_lshlrev_b32 v70, 16, v70
    v_mul_f32 v70, v70, v26
    v_cvt_pk_bf16_f32 v70, v70, v70
    v_lshlrev_b32 v70, 16, v70
    v_sub_f32 v71, v71, v27
    v_cvt_pk_bf16_f32 v71, v71, v71
    v_lshlrev_b32 v71, 16, v71
    v_mul_f32 v71, v71, v26
    v_cvt_pk_bf16_f32 v71, v71, v71
    v_lshlrev_b32 v71, 16, v71
    v_sub_f32 v72, v72, v27
    v_cvt_pk_bf16_f32 v72, v72, v72
    v_lshlrev_b32 v72, 16, v72
    v_mul_f32 v72, v72, v26
    v_cvt_pk_bf16_f32 v72, v72, v72
    v_lshlrev_b32 v72, 16, v72
    v_sub_f32 v73, v73, v27
    v_cvt_pk_bf16_f32 v73, v73, v73
    v_lshlrev_b32 v73, 16, v73
    v_mul_f32 v73, v73, v26
    v_cvt_pk_bf16_f32 v73, v73, v73
    v_lshlrev_b32 v73, 16, v73
    v_sub_f32 v74, v74, v27
    v_cvt_pk_bf16_f32 v74, v74, v74
    v_lshlrev_b32 v74, 16, v74
    v_mul_f32 v74, v74, v26
    v_cvt_pk_bf16_f32 v74, v74, v74
    v_lshlrev_b32 v74, 16, v74
    v_sub_f32 v75, v75, v27
    v_cvt_pk_bf16_f32 v75, v75, v75
    v_lshlrev_b32 v75, 16, v75
    v_mul_f32 v75, v75, v26
    v_cvt_pk_bf16_f32 v75, v75, v75
    v_lshlrev_b32 v75, 16, v75
    v_sub_f32 v76, v76, v27
    v_cvt_pk_bf16_f32 v76, v76, v76
    v_lshlrev_b32 v76, 16, v76
    v_mul_f32 v76, v76, v26
    v_cvt_pk_bf16_f32 v76, v76, v76
    v_lshlrev_b32 v76, 16, v76
    v_sub_f32 v77, v77, v27
    v_cvt_pk_bf16_f32 v77, v77, v77
    v_lshlrev_b32 v77, 16, v77
    v_mul_f32 v77, v77, v26
    v_cvt_pk_bf16_f32 v77, v77, v77
    v_lshlrev_b32 v77, 16, v77
    v_sub_f32 v78, v78, v27
    v_cvt_pk_bf16_f32 v78, v78, v78
    v_lshlrev_b32 v78, 16, v78
    v_mul_f32 v78, v78, v26
    v_cvt_pk_bf16_f32 v78, v78, v78
    v_lshlrev_b32 v78, 16, v78
    v_sub_f32 v79, v79, v27
    v_cvt_pk_bf16_f32 v79, v79, v79
    v_lshlrev_b32 v79, 16, v79
    v_mul_f32 v79, v79, v26
    v_cvt_pk_bf16_f32 v79, v79, v79
    v_lshlrev_b32 v79, 16, v79
    v_mul_f32 v64, v64, v144
    v_cvt_pk_bf16_f32 v64, v64, v64
    v_lshlrev_b32 v64, 16, v64
    v_add_f32 v64, v64, v128
    v_mul_f32 v65, v65, v145
    v_cvt_pk_bf16_f32 v65, v65, v65
    v_lshlrev_b32 v65, 16, v65
    v_add_f32 v65, v65, v129
    v_mul_f32 v66, v66, v146
    v_cvt_pk_bf16_f32 v66, v66, v66
    v_lshlrev_b32 v66, 16, v66
    v_add_f32 v66, v66, v130
    v_mul_f32 v67, v67, v147
    v_cvt_pk_bf16_f32 v67, v67, v67
    v_lshlrev_b32 v67, 16, v67
    v_add_f32 v67, v67, v131
    v_mul_f32 v68, v68, v148
    v_cvt_pk_bf16_f32 v68, v68, v68
    v_lshlrev_b32 v68, 16, v68
    v_add_f32 v68, v68, v132
    v_mul_f32 v69, v69, v149
    v_cvt_pk_bf16_f32 v69, v69, v69
    v_lshlrev_b32 v69, 16, v69
    v_add_f32 v69, v69, v133
    v_mul_f32 v70, v70, v150
    v_cvt_pk_bf16_f32 v70, v70, v70
    v_lshlrev_b32 v70, 16, v70
    v_add_f32 v70, v70, v134
    v_mul_f32 v71, v71, v151
    v_cvt_pk_bf16_f32 v71, v71, v71
    v_lshlrev_b32 v71, 16, v71
    v_add_f32 v71, v71, v135
    v_mul_f32 v72, v72, v152
    v_cvt_pk_bf16_f32 v72, v72, v72
    v_lshlrev_b32 v72, 16, v72
    v_add_f32 v72, v72, v136
    v_mul_f32 v73, v73, v153
    v_cvt_pk_bf16_f32 v73, v73, v73
    v_lshlrev_b32 v73, 16, v73
    v_add_f32 v73, v73, v137
    v_mul_f32 v74, v74, v154
    v_cvt_pk_bf16_f32 v74, v74, v74
    v_lshlrev_b32 v74, 16, v74
    v_add_f32 v74, v74, v138
    v_mul_f32 v75, v75, v155
    v_cvt_pk_bf16_f32 v75, v75, v75
    v_lshlrev_b32 v75, 16, v75
    v_add_f32 v75, v75, v139
    v_mul_f32 v76, v76, v156
    v_cvt_pk_bf16_f32 v76, v76, v76
    v_lshlrev_b32 v76, 16, v76
    v_add_f32 v76, v76, v140
    v_mul_f32 v77, v77, v157
    v_cvt_pk_bf16_f32 v77, v77, v77
    v_lshlrev_b32 v77, 16, v77
    v_add_f32 v77, v77, v141
    v_mul_f32 v78, v78, v158
    v_cvt_pk_bf16_f32 v78, v78, v78
    v_lshlrev_b32 v78, 16, v78
    v_add_f32 v78, v78, v142
    v_mul_f32 v79, v79, v159
    v_cvt_pk_bf16_f32 v79, v79, v79
    v_lshlrev_b32 v79, 16, v79
    v_add_f32 v79, v79, v143
    v_cvt_pk_bf16_f32 v80, v64, v65
    v_cvt_pk_bf16_f32 v81, v66, v67
    v_cvt_pk_bf16_f32 v82, v68, v69
    v_cvt_pk_bf16_f32 v83, v70, v71
    v_cvt_pk_bf16_f32 v84, v72, v73
    v_cvt_pk_bf16_f32 v85, v74, v75
    v_cvt_pk_bf16_f32 v86, v76, v77
    v_cvt_pk_bf16_f32 v87, v78, v79
    s_lshr_b32 s45, s63, 5
    s_lshl_b32 s45, s45, 16
    s_and_b32 s46, s63, 31
    s_lshl_b32 s46, s46, 8
    s_add_u32 s45, s45, s46
    s_add_u32 s45, s45, 0xc00000
    s_add_u32 s46, s45, 32768
    buffer_store_dwordx4 v[80:83], v2, s[12:15], s45 offen sc1
    buffer_store_dwordx4 v[84:87], v2, s[12:15], s46 offen sc1
L_b_skip_140:
    s_waitcnt vmcnt(0)
    s_barrier
    s_cmp_lg_u32 s44, 0
    s_cbranch_scc1 L_pub_144
    v_mov_b32 v30, s62
    v_mov_b32 v31, 0
    s_mov_b64 exec, 1
    buffer_store_dword v30, v31, s[12:15], s65 offen sc1
    s_mov_b64 exec, -1
L_pub_144:
    s_cmp_ge_u32 s41, 28
    s_cbranch_scc1 L_b_loop_139
    s_add_u32 s45, s64, 8192
    s_cmp_lg_u32 s44, 0
    s_cbranch_scc1 L_pw_145
    s_mov_b32 exec_hi, 0
    s_mov_b32 s70, 0
L_wp_146:
    buffer_load_dword v31, v5, s[12:15], s45 offen sc1
    s_add_u32 s70, s70, 1
    s_cmp_ge_u32 s70, 0x200000
    s_cbranch_scc1 L_w_done_102
    s_waitcnt vmcnt(0)
    v_cmp_gt_u32 vcc, s62, v31
    s_nop 1
    s_cbranch_vccz L_wp_146_ok
    s_sleep 1
    s_branch L_wp_146
L_wp_146_ok:
    s_mov_b64 exec, -1
L_pw_145:
    s_barrier
    s_mul_i32 s53, s50, 65536
    s_add_u32 s53, s53, s52
    s_lshl_b32 s54, s44, 13
    s_add_u32 s53, s53, s54
    s_mul_i32 s57, s50, 229376
    s_add_u32 s57, s57, s56
    s_lshl_b32 s45, s44, 11
    s_add_u32 s57, s57, s45
    s_add_u32 s55, s54, 65536
    s_mov_b32 s58, 0
    v_mov_b32 v13, v3
    v_add_u32 v14, 65536, v13
    v_xor_b32 v15, 64, v13
    v_xor_b32 v16, 64, v14
    s_mov_b32 s76, 0x20000000
    s_add_u32 s48, s53, 0
    s_add_u32 s49, s48, 4096
    s_add_u32 m0, s54, 0
    s_nop 0
    buffer_load_dwordx4 v6, s[12:15], s48 offen offset:0 sc1 lds
    s_add_u32 m0, s54, 1024
    s_nop 0
    buffer_load_dwordx4 v9, s[12:15], s48 offen offset:0 sc1 lds
    s_add_u32 m0, s54, 2048
    s_nop 0
    buffer_load_dwordx4 v6, s[12:15], s49 offen offset:0 sc1 lds
    s_add_u32 m0, s54, 3072
    s_nop 0
    buffer_load_dwordx4 v9, s[12:15], s49 offen offset:0 sc1 lds
    s_add_u32 m0, s54, 3968
    s_nop 0
    buffer_load_dwordx4 v6, s[12:15], s48 offen offset:128 sc1 lds
    s_add_u32 m0, s54, 4992
    s_nop 0
    buffer_load_dwordx4 v9, s[12:15], s48 offen offset:128 sc1 lds
    s_add_u32 m0, s54, 6016
    s_nop 0
    buffer_load_dwordx4 v6, s[12:15], s49 offen offset:128 sc1 lds
    s_add_u32 m0, s54, 7040
    s_nop 0
    buffer_load_dwordx4 v9, s[12:15], s49 offen offset:128 sc1 lds
    s_add_u32 s48, s53, 32768
    s_add_u32 s49, s48, 4096
    s_add_u32 s46, s54, 32768
    s_add_u32 m0, s46, 0
    s_nop 0
    buffer_load_dwordx4 v6, s[12:15], s48 offen offset:0 sc1 lds
    s_add_u32 m0, s46, 1024
    s_nop 0
    buffer_load_dwordx4 v9, s[12:15], s48 offen offset:0 sc1 lds
    s_add_u32 m0, s46, 2048
    s_nop 0
    buffer_load_dwordx4 v6, s[12:15], s49 offen offset:0 sc1 lds
    s_add_u32 m0, s46, 3072
    s_nop 0
    buffer_load_dwordx4 v9, s[12:15], s49 offen offset:0 sc1 lds
    s_add_u32 m0, s46, 3968
    s_nop 0
    buffer_load_dwordx4 v6, s[12:15], s48 offen offset:128 sc1 lds
    s_add_u32 m0, s46, 4992
    s_nop 0
    buffer_load_dwordx4 v9, s[12:15], s48 offen offset:128 sc1 lds
    s_add_u32 m0, s46, 6016
    s_nop 0
    buffer_load_dwordx4 v6, s[12:15], s49 offen offset:128 sc1 lds
    s_add_u32 m0, s46, 7040
    s_nop 0
    buffer_load_dwordx4 v9, s[12:15], s49 offen offset:128 sc1 lds
    s_add_u32 s48, s53, 65536
    s_cmp_gt_u32 s51, 1
    s_cselect_b32 s48, s48, 0x20000000
    s_add_u32 s49, s48, 4096
    s_add_u32 m0, s55, 0
    s_nop 0
    buffer_load_dwordx4 v6, s[12:15], s48 offen offset:0 sc1 lds
    s_add_u32 m0, s55, 1024
    s_nop 0
    buffer_load_dwordx4 v9, s[12:15], s48 offen offset:0 sc1 lds
    s_add_u32 m0, s55, 2048
    s_nop 0
    buffer_load_dwordx4 v6, s[12:15], s49 offen offset:0 sc1 lds
    s_add_u32 m0, s55, 3072
    s_nop 0
    buffer_load_dwordx4 v9, s[12:15], s49 offen offset:0 sc1 lds
    s_add_u32 m0, s55, 3968
    s_nop 0
    buffer_load_dwordx4 v6, s[12:15], s48 offen offset:128 sc1 lds
    s_add_u32 m0, s55, 4992
    s_nop 0
    buffer_load_dwordx4 v9, s[12:15], s48 offen offset:128 sc1 lds
    s_add_u32 m0, s55, 6016
    s_nop 0
    buffer_load_dwordx4 v6, s[12:15], s49 offen offset:128 sc1 lds
    s_add_u32 m0, s55, 7040
    s_nop 0
    buffer_load_dwordx4 v9, s[12:15], s49 offen offset:128 sc1 lds
    s_waitcnt vmcnt(16)
    s_barrier
    ds_read_b128 v[32:35], v13 offset:0
    ds_read_b128 v[36:39], v13 offset:2048
    ds_read_b128 v[40:43], v15 offset:0
    ds_read_b128 v[44:47], v15 offset:2048
L_e_loop_147:
    s_add_u32 s48, s53, 98304
    s_add_u32 s46, s58, 1
    s_cmp_lt_u32 s46, s51
    s_cselect_b32 s48, s48, 0x20000000
    s_add_u32 s49, s48, 4096
    s_add_u32 s59, s55, 32768
    s_waitcnt lgkmcnt(2)
    v_mfma_f32_16x16x32_bf16 v[80:83], a[0:3], v[32:35], 0
    ds_read_b128 v[48:51], v13 offset:4096
    ds_read_b128 v[52:55], v13 offset:6144
    v_mfma_f32_16x16x32_bf16 v[84:87], a[4:7], v[32:35], 0
    ds_read_b128 v[56:59], v15 offset:4096
    ds_read_b128 v[60:63], v15 offset:6144
    v_mfma_f32_16x16x32_bf16 v[88:91], a[0:3], v[36:39], 0
    s_add_u32 m0, s59, 0
    s_nop 0
    buffer_load_dwordx4 v6, s[12:15], s48 offen offset:0 sc1 lds
    v_mfma_f32_16x16x32_bf16 v[92:95], a[4:7], v[36:39], 0
    v_lshlrev_b32 v224, 16, v216
    v_and_b32 v225, 0xffff0000, v216
    s_waitcnt lgkmcnt(4)
    v_mfma_f32_16x16x32_bf16 v[80:83], a[8:11], v[40:43], v[80:83]
    ds_read_b128 v[32:35], v13 offset:8192
    ds_read_b128 v[36:39], v13 offset:10240
    v_mfma_f32_16x16x32_bf16 v[84:87], a[12:15], v[40:43], v[84:87]
    v_lshlrev_b32 v226, 16, v217
    v_and_b32 v227, 0xffff0000, v217
    v_mfma_f32_16x16x32_bf16 v[88:91], a[8:11], v[44:47], v[88:91]
    s_add_u32 m0, s59, 1024
    s_nop 0
    buffer_load_dwordx4 v9, s[12:15], s48 offen offset:0 sc1 lds
    v_mfma_f32_16x16x32_bf16 v[92:95], a[12:15], v[44:47], v[92:95]
    v_lshlrev_b32 v228, 16, v218
    v_and_b32 v229, 0xffff0000, v218
    s_waitcnt lgkmcnt(4)
    v_mfma_f32_16x16x32_bf16 v[80:83], a[16:19], v[48:51], v[80:83]
    ds_read_b128 v[40:43], v15 offset:8192
    ds_read_b128 v[44:47], v15 offset:10240
    v_mfma_f32_16x16x32_bf16 v[84:87], a[20:23], v[48:51], v[84:87]
    v_lshlrev_b32 v230, 16, v219
    v_and_b32 v231, 0xffff0000, v219
    v_mfma_f32_16x16x32_bf16 v[88:91], a[16:19], v[52:55], v[88:91]
    s_add_u32 m0, s59, 2048
    s_nop 0
    buffer_load_dwordx4 v6, s[12:15], s49 offen offset:0 sc1 lds
    v_mfma_f32_16x16x32_bf16 v[92:95], a[20:23], v[52:55], v[92:95]
    v_lshlrev_b32 v232, 16, v220
    v_and_b32 v233, 0xffff0000, v220
    s_waitcnt lgkmcnt(4)
    v_mfma_f32_16x16x32_bf16 v[80:83], a[24:27], v[56:59], v[80:83]
    ds_read_b128 v[48:51], v13 offset:12288
    ds_read_b128 v[52:55], v13 offset:14336
    v_mfma_f32_16x16x32_bf16 v[84:87], a[28:31], v[56:59], v[84:87]
    v_lshlrev_b32 v234, 16, v221
    v_and_b32 v235, 0xffff0000, v221
    v_mfma_f32_16x16x32_bf16 v[88:91], a[24:27], v[60:63], v[88:91]
    s_add_u32 m0, s59, 3072
    s_nop 0
    buffer_load_dwordx4 v9, s[12:15], s49 offen offset:0 sc1 lds
    v_mfma_f32_16x16x32_bf16 v[92:95], a[28:31], v[60:63], v[92:95]
    v_lshlrev_b32 v236, 16, v222
    v_and_b32 v237, 0xffff0000, v222
    s_waitcnt lgkmcnt(4)
    v_mfma_f32_16x16x32_bf16 v[80:83], a[32:35], v[32:35], v[80:83]
    ds_read_b128 v[56:59], v15 offset:12288
    ds_read_b128 v[60:63], v15 offset:14336
    v_mfma_f32_16x16x32_bf16 v[84:87], a[36:39], v[32:35], v[84:87]
    v_lshlrev_b32 v238, 16, v223
    v_and_b32 v239, 0xffff0000, v223
    v_mfma_f32_16x16x32_bf16 v[88:91], a[32:35], v[36:39], v[88:91]
    s_add_u32 m0, s59, 3968
    s_nop 0
    buffer_load_dwordx4 v6, s[12:15], s48 offen offset:128 sc1 lds
    v_mfma_f32_16x16x32_bf16 v[92:95], a[36:39], v[36:39], v[92:95]
    v_pk_add_f32 v[224:225], v[224:225], v[96:97]
    v_pk_add_f32 v[226:227], v[226:227], v[98:99]
    s_waitcnt lgkmcnt(4)
    v_mfma_f32_16x16x32_bf16 v[80:83], a[40:43], v[40:43], v[80:83]
    ds_read_b128 v[32:35], v13 offset:16384
    ds_read_b128 v[36:39], v13 offset:18432
    v_mfma_f32_16x16x32_bf16 v[84:87], a[44:47], v[40:43], v[84:87]
    v_pk_add_f32 v[228:229], v[228:229], v[100:101]
    v_pk_add_f32 v[230:231], v[230:231], v[102:103]
    v_mfma_f32_16x16x32_bf16 v[88:91], a[40:43], v[44:47], v[88:91]
    s_add_u32 m0, s59, 4992
    s_nop 0
    buffer_load_dwordx4 v9, s[12:15], s48 offen offset:128 sc1 lds
    v_mfma_f32_16x16x32_bf16 v[92:95], a[44:47], v[44:47], v[92:95]
    v_pk_add_f32 v[232:233], v[232:233], v[96:97]
    v_pk_add_f32 v[234:235], v[234:235], v[98:99]
    s_waitcnt lgkmcnt(4)
    v_mfma_f32_16x16x32_bf16 v[80:83], a[48:51], v[48:51], v[80:83]
    ds_read_b128 v[40:43], v15 offset:16384
    ds_read_b128 v[44:47], v15 offset:18432
    v_mfma_f32_16x16x32_bf16 v[84:87], a[52:55], v[48:51], v[84:87]
    v_pk_add_f32 v[236:237], v[236:237], v[100:101]
    v_pk_add_f32 v[238:239], v[238:239], v[102:103]
    v_mfma_f32_16x16x32_bf16 v[88:91], a[48:51], v[52:55], v[88:91]
    s_add_u32 m0, s59, 6016
    s_nop 0
    buffer_load_dwordx4 v6, s[12:15], s49 offen offset:128 sc1 lds
    v_mfma_f32_16x16x32_bf16 v[92:95], a[52:55], v[52:55], v[92:95]
    v_cvt_pk_bf16_f32 v216, v224, v225
    v_cvt_pk_bf16_f32 v217, v226, v227
    s_waitcnt lgkmcnt(4)
    v_mfma_f32_16x16x32_bf16 v[80:83], a[56:59], v[56:59], v[80:83]
    ds_read_b128 v[48:51], v13 offset:20480
    ds_read_b128 v[52:55], v13 offset:22528
    v_mfma_f32_16x16x32_bf16 v[84:87], a[60:63], v[56:59], v[84:87]
    v_cvt_pk_bf16_f32 v218, v228, v229
    v_cvt_pk_bf16_f32 v219, v230, v231
    v_mfma_f32_16x16x32_bf16 v[88:91], a[56:59], v[60:63], v[88:91]
    s_add_u32 m0, s59, 7040
    s_nop 0
    buffer_load_dwordx4 v9, s[12:15], s49 offen offset:128 sc1 lds
    v_mfma_f32_16x16x32_bf16 v[92:95], a[60:63], v[60:63], v[92:95]
    v_cvt_pk_bf16_f32 v220, v232, v233
    v_cvt_pk_bf16_f32 v221, v234, v235
    s_waitcnt lgkmcnt(4)
    v_mfma_f32_16x16x32_bf16 v[80:83], a[64:67], v[32:35], v[80:83]
    ds_read_b128 v[56:59], v15 offset:20480
    ds_read_b128 v[60:63], v15 offset:22528
    v_mfma_f32_16x16x32_bf16 v[84:87], a[68:71], v[32:35], v[84:87]
    v_cvt_pk_bf16_f32 v222, v236, v237
    v_cvt_pk_bf16_f32 v223, v238, v239
    v_mfma_f32_16x16x32_bf16 v[88:91], a[64:67], v[36:39], v[88:91]
    v_lshlrev_b32 v224, 16, v216
    v_and_b32 v225, 0xffff0000, v216
    v_mfma_f32_16x16x32_bf16 v[92:95], a[68:71], v[36:39], v[92:95]
    v_lshlrev_b32 v226, 16, v217
    v_and_b32 v227, 0xffff0000, v217
    s_waitcnt lgkmcnt(4)
    v_mfma_f32_16x16x32_bf16 v[80:83], a[72:75], v[40:43], v[80:83]
    ds_read_b128 v[32:35], v13 offset:24576
    ds_read_b128 v[36:39], v13 offset:26624
    v_mfma_f32_16x16x32_bf16 v[84:87], a[76:79], v[40:43], v[84:87]
    v_lshlrev_b32 v228, 16, v218
    v_and_b32 v229, 0xffff0000, v218
    v_mfma_f32_16x16x32_bf16 v[88:91], a[72:75], v[44:47], v[88:91]
    v_lshlrev_b32 v230, 16, v219
    v_and_b32 v231, 0xffff0000, v219
    v_mfma_f32_16x16x32_bf16 v[92:95], a[76:79], v[44:47], v[92:95]
    v_lshlrev_b32 v232, 16, v220
    v_and_b32 v233, 0xffff0000, v220
    s_waitcnt lgkmcnt(4)
    v_mfma_f32_16x16x32_bf16 v[80:83], a[80:83], v[48:51], v[80:83]
    ds_read_b128 v[40:43], v15 offset:24576
    ds_read_b128 v[44:47], v15 offset:26624
    v_mfma_f32_16x16x32_bf16 v[84:87], a[84:87], v[48:51], v[84:87]
    v_lshlrev_b32 v234, 16, v221
    v_and_b32 v235, 0xffff0000, v221
    v_mfma_f32_16x16x32_bf16 v[88:91], a[80:83], v[52:55], v[88:91]
    v_lshlrev_b32 v236, 16, v222
    v_and_b32 v237, 0xffff0000, v222
    v_mfma_f32_16x16x32_bf16 v[92:95], a[84:87], v[52:55], v[92:95]
    v_lshlrev_b32 v238, 16, v223
    v_and_b32 v239, 0xffff0000, v223
    s_waitcnt lgkmcnt(4)
    v_mfma_f32_16x16x32_bf16 v[80:83], a[88:91], v[56:59], v[80:83]
    ds_read_b128 v[48:51], v13 offset:28672
    ds_read_b128 v[52:55], v13 offset:30720
    v_mfma_f32_16x16x32_bf16 v[84:87], a[92:95], v[56:59], v[84:87]
    v_pk_mul_f32 v[240:241], v[224:225], v[224:225]
    v_pk_mul_f32 v[242:243], v[226:227], v[226:227]
    v_mfma_f32_16x16x32_bf16 v[88:91], a[88:91], v[60:63], v[88:91]
    v_pk_mul_f32 v[244:245], v[228:229], v[228:229]
    v_pk_mul_f32 v[246:247], v[230:231], v[230:231]
    v_mfma_f32_16x16x32_bf16 v[92:95], a[92:95], v[60:63], v[92:95]
    v_pk_mul_f32 v[248:249], v[232:233], v[232:233]
    v_pk_mul_f32 v[250:251], v[234:235], v[234:235]
    s_waitcnt lgkmcnt(4)
    v_mfma_f32_16x16x32_bf16 v[80:83], a[96:99], v[32:35], v[80:83]
    ds_read_b128 v[56:59], v15 offset:28672
    ds_read_b128 v[60:63], v15 offset:30720
    v_mfma_f32_16x16x32_bf16 v[84:87], a[100:103], v[32:35], v[84:87]
    v_pk_mul_f32 v[252:253], v[236:237], v[236:237]
    v_pk_mul_f32 v[254:255], v[238:239], v[238:239]
    v_mfma_f32_16x16x32_bf16 v[88:91], a[96:99], v[36:39], v[88:91]
    v_pk_fma_f32 v[240:241], v[240:241], v[104:105], v[106:107]
    v_pk_fma_f32 v[242:243], v[242:243], v[104:105], v[106:107]
    v_mfma_f32_16x16x32_bf16 v[92:95], a[100:103], v[36:39], v[92:95]
    v_pk_fma_f32 v[244:245], v[244:245], v[104:105], v[106:107]
    v_pk_fma_f32 v[246:247], v[246:247], v[104:105], v[106:107]
    s_waitcnt lgkmcnt(4)
    v_mfma_f32_16x16x32_bf16 v[80:83], a[104:107], v[40:43], v[80:83]
    v_pk_fma_f32 v[248:249], v[248:249], v[104:105], v[106:107]
    v_pk_fma_f32 v[250:251], v[250:251], v[104:105], v[106:107]
    v_mfma_f32_16x16x32_bf16 v[84:87], a[108:111], v[40:43], v[84:87]
    v_pk_fma_f32 v[252:253], v[252:253], v[104:105], v[106:107]
    v_pk_fma_f32 v[254:255], v[254:255], v[104:105], v[106:107]
    v_mfma_f32_16x16x32_bf16 v[88:91], a[104:107], v[44:47], v[88:91]
    v_pk_mul_f32 v[240:241], v[240:241], v[224:225]
    v_pk_mul_f32 v[242:243], v[242:243], v[226:227]
    v_mfma_f32_16x16x32_bf16 v[92:95], a[108:111], v[44:47], v[92:95]
    v_pk_mul_f32 v[244:245], v[244:245], v[228:229]
    v_pk_mul_f32 v[246:247], v[246:247], v[230:231]
    s_waitcnt vmcnt(16) lgkmcnt(0)
    s_barrier
    v_mfma_f32_16x16x32_bf16 v[80:83], a[112:115], v[48:51], v[80:83]
    ds_read_b128 v[32:35], v13 offset:32768
    ds_read_b128 v[36:39], v13 offset:34816
    v_mfma_f32_16x16x32_bf16 v[84:87], a[116:119], v[48:51], v[84:87]
    v_pk_mul_f32 v[248:249], v[248:249], v[232:233]
    v_pk_mul_f32 v[250:251], v[250:251], v[234:235]
    v_mfma_f32_16x16x32_bf16 v[88:91], a[112:115], v[52:55], v[88:91]
    v_pk_mul_f32 v[252:253], v[252:253], v[236:237]
    v_pk_mul_f32 v[254:255], v[254:255], v[238:239]
    v_mfma_f32_16x16x32_bf16 v[92:95], a[116:119], v[52:55], v[92:95]
    v_exp_f32 v240, v240
    v_mfma_f32_16x16x32_bf16 v[80:83], a[120:123], v[56:59], v[80:83]
    ds_read_b128 v[40:43], v15 offset:32768
    ds_read_b128 v[44:47], v15 offset:34816
    v_mfma_f32_16x16x32_bf16 v[84:87], a[124:127], v[56:59], v[84:87]
    v_exp_f32 v241, v241
    v_exp_f32 v242, v242
    v_mfma_f32_16x16x32_bf16 v[88:91], a[120:123], v[60:63], v[88:91]
    v_exp_f32 v243, v243
    v_mfma_f32_16x16x32_bf16 v[92:95], a[124:127], v[60:63], v[92:95]
    v_exp_f32 v244, v244
    s_add_u32 s48, s53, 131072
    s_add_u32 s46, s58, 2
    s_cmp_lt_u32 s46, s51
    s_cselect_b32 s48, s48, 0x20000000
    s_add_u32 s49, s48, 4096
    s_mov_b32 s59, s54
    s_waitcnt lgkmcnt(2)
    v_mfma_f32_16x16x32_bf16 v[80:83], a[128:131], v[32:35], v[80:83]
    ds_read_b128 v[48:51], v13 offset:36864
    ds_read_b128 v[52:55], v13 offset:38912
    v_mfma_f32_16x16x32_bf16 v[84:87], a[132:135], v[32:35], v[84:87]
    ds_read_b128 v[56:59], v15 offset:36864
    ds_read_b128 v[60:63], v15 offset:38912
    v_mfma_f32_16x16x32_bf16 v[88:91], a[128:131], v[36:39], v[88:91]
    s_add_u32 m0, s59, 0
    s_nop 0
    buffer_load_dwordx4 v6, s[12:15], s48 offen offset:0 sc1 lds
    v_mfma_f32_16x16x32_bf16 v[92:95], a[132:135], v[36:39], v[92:95]
    v_exp_f32 v245, v245
    v_exp_f32 v246, v246
    s_waitcnt lgkmcnt(4)
    v_mfma_f32_16x16x32_bf16 v[80:83], a[136:139], v[40:43], v[80:83]
    ds_read_b128 v[32:35], v13 offset:40960
    ds_read_b128 v[36:39], v13 offset:43008
    v_mfma_f32_16x16x32_bf16 v[84:87], a[140:143], v[40:43], v[84:87]
    v_exp_f32 v247, v247
    v_exp_f32 v248, v248
    v_mfma_f32_16x16x32_bf16 v[88:91], a[136:139], v[44:47], v[88:91]
    s_add_u32 m0, s59, 1024
    s_nop 0
    buffer_load_dwordx4 v9, s[12:15], s48 offen offset:0 sc1 lds
    v_mfma_f32_16x16x32_bf16 v[92:95], a[140:143], v[44:47], v[92:95]
    v_exp_f32 v249, v249
    v_exp_f32 v250, v250
    s_waitcnt lgkmcnt(4)
    v_mfma_f32_16x16x32_bf16 v[80:83], a[144:147], v[48:51], v[80:83]
    ds_read_b128 v[40:43], v15 offset:40960
    ds_read_b128 v[44:47], v15 offset:43008
    v_mfma_f32_16x16x32_bf16 v[84:87], a[148:151], v[48:51], v[84:87]
    v_exp_f32 v251, v251
    v_exp_f32 v252, v252
    v_mfma_f32_16x16x32_bf16 v[88:91], a[144:147], v[52:55], v[88:91]
    s_add_u32 m0, s59, 2048
    s_nop 0
    buffer_load_dwordx4 v6, s[12:15], s49 offen offset:0 sc1 lds
    v_mfma_f32_16x16x32_bf16 v[92:95], a[148:151], v[52:55], v[92:95]
    v_exp_f32 v253, v253
    v_exp_f32 v254, v254
    s_waitcnt lgkmcnt(4)
    v_mfma_f32_16x16x32_bf16 v[80:83], a[152:155], v[56:59], v[80:83]
    ds_read_b128 v[48:51], v13 offset:45056
    ds_read_b128 v[52:55], v13 offset:47104
    v_mfma_f32_16x16x32_bf16 v[84:87], a[156:159], v[56:59], v[84:87]
    v_exp_f32 v255, v255
    v_add_f32 v240, 1.0, v240
    v_mfma_f32_16x16x32_bf16 v[88:91], a[152:155], v[60:63], v[88:91]
    s_add_u32 m0, s59, 3072
    s_nop 0
    buffer_load_dwordx4 v9, s[12:15], s49 offen offset:0 sc1 lds
    v_mfma_f32_16x16x32_bf16 v[92:95], a[156:159], v[60:63], v[92:95]
    v_add_f32 v241, 1.0, v241
    v_add_f32 v242, 1.0, v242
    s_waitcnt lgkmcnt(4)
    v_mfma_f32_16x16x32_bf16 v[80:83], a[160:163], v[32:35], v[80:83]
    ds_read_b128 v[56:59], v15 offset:45056
    ds_read_b128 v[60:63], v15 offset:47104
    v_mfma_f32_16x16x32_bf16 v[84:87], a[164:167], v[32:35], v[84:87]
    v_add_f32 v243, 1.0, v243
    v_add_f32 v244, 1.0, v244
    v_mfma_f32_16x16x32_bf16 v[88:91], a[160:163], v[36:39], v[88:91]
    s_add_u32 m0, s59, 3968
    s_nop 0
    buffer_load_dwordx4 v6, s[12:15], s48 offen offset:128 sc1 lds
    v_mfma_f32_16x16x32_bf16 v[92:95], a[164:167], v[36:39], v[92:95]
    v_add_f32 v245, 1.0, v245
    v_add_f32 v246, 1.0, v246
    s_waitcnt lgkmcnt(4)
    v_mfma_f32_16x16x32_bf16 v[80:83], a[168:171], v[40:43], v[80:83]
    ds_read_b128 v[32:35], v13 offset:49152
    ds_read_b128 v[36:39], v13 offset:51200
    v_mfma_f32_16x16x32_bf16 v[84:87], a[172:175], v[40:43], v[84:87]
    v_add_f32 v247, 1.0, v247
    v_add_f32 v248, 1.0, v248
    v_mfma_f32_16x16x32_bf16 v[88:91], a[168:171], v[44:47], v[88:91]
    s_add_u32 m0, s59, 4992
    s_nop 0
    buffer_load_dwordx4 v9, s[12:15], s48 offen offset:128 sc1 lds
    v_mfma_f32_16x16x32_bf16 v[92:95], a[172:175], v[44:47], v[92:95]
    v_add_f32 v249, 1.0, v249
    v_add_f32 v250, 1.0, v250
    s_waitcnt lgkmcnt(4)
    v_mfma_f32_16x16x32_bf16 v[80:83], a[176:179], v[48:51], v[80:83]
    ds_read_b128 v[40:43], v15 offset:49152
    ds_read_b128 v[44:47], v15 offset:51200
    v_mfma_f32_16x16x32_bf16 v[84:87], a[180:183], v[48:51], v[84:87]
    v_add_f32 v251, 1.0, v251
    v_add_f32 v252, 1.0, v252
    v_mfma_f32_16x16x32_bf16 v[88:91], a[176:179], v[52:55], v[88:91]
    s_add_u32 m0, s59, 6016
    s_nop 0
    buffer_load_dwordx4 v6, s[12:15], s49 offen offset:128 sc1 lds
    v_mfma_f32_16x16x32_bf16 v[92:95], a[180:183], v[52:55], v[92:95]
    v_add_f32 v253, 1.0, v253
    v_add_f32 v254, 1.0, v254
    s_waitcnt lgkmcnt(4)
    v_mfma_f32_16x16x32_bf16 v[80:83], a[184:187], v[56:59], v[80:83]
    ds_read_b128 v[48:51], v13 offset:53248
    ds_read_b128 v[52:55], v13 offset:55296
    v_mfma_f32_16x16x32_bf16 v[84:87], a[188:191], v[56:59], v[84:87]
    v_add_f32 v255, 1.0, v255
    v_rcp_f32 v240, v240
    v_mfma_f32_16x16x32_bf16 v[88:91], a[184:187], v[60:63], v[88:91]
    s_add_u32 m0, s59, 7040
    s_nop 0
    buffer_load_dwordx4 v9, s[12:15], s49 offen offset:128 sc1 lds
    v_mfma_f32_16x16x32_bf16 v[92:95], a[188:191], v[60:63], v[92:95]
    v_rcp_f32 v241, v241
    v_rcp_f32 v242, v242
    s_waitcnt lgkmcnt(4)
    v_mfma_f32_16x16x32_bf16 v[80:83], a[192:195], v[32:35], v[80:83]
    ds_read_b128 v[56:59], v15 offset:53248
    ds_read_b128 v[60:63], v15 offset:55296
    v_mfma_f32_16x16x32_bf16 v[84:87], a[196:199], v[32:35], v[84:87]
    v_rcp_f32 v243, v243
    v_rcp_f32 v244, v244
    v_mfma_f32_16x16x32_bf16 v[88:91], a[192:195], v[36:39], v[88:91]
    v_rcp_f32 v245, v245
    v_rcp_f32 v246, v246
    v_mfma_f32_16x16x32_bf16 v[92:95], a[196:199], v[36:39], v[92:95]
    v_rcp_f32 v247, v247
    v_rcp_f32 v248, v248
    s_waitcnt lgkmcnt(4)
    v_mfma_f32_16x16x32_bf16 v[80:83], a[200:203], v[40:43], v[80:83]
    ds_read_b128 v[32:35], v13 offset:57344
    ds_read_b128 v[36:39], v13 offset:59392
    v_mfma_f32_16x16x32_bf16 v[84:87], a[204:207], v[40:43], v[84:87]
    v_rcp_f32 v249, v249
    v_rcp_f32 v250, v250
    v_mfma_f32_16x16x32_bf16 v[88:91], a[200:203], v[44:47], v[88:91]
    v_rcp_f32 v251, v251
    v_mfma_f32_16x16x32_bf16 v[92:95], a[204:207], v[44:47], v[92:95]
    v_rcp_f32 v252, v252
    s_waitcnt lgkmcnt(4)
    v_mfma_f32_16x16x32_bf16 v[80:83], a[208:211], v[48:51], v[80:83]
    ds_read_b128 v[40:43], v15 offset:57344
    ds_read_b128 v[44:47], v15 offset:59392
    v_mfma_f32_16x16x32_bf16 v[84:87], a[212:215], v[48:51], v[84:87]
    v_rcp_f32 v253, v253
    v_rcp_f32 v254, v254
    v_mfma_f32_16x16x32_bf16 v[88:91], a[208:211], v[52:55], v[88:91]
    v_rcp_f32 v255, v255
    v_mfma_f32_16x16x32_bf16 v[92:95], a[212:215], v[52:55], v[92:95]
    v_pk_mul_f32 v[224:225], v[224:225], v[240:241]
    s_waitcnt lgkmcnt(4)
    v_mfma_f32_16x16x32_bf16 v[80:83], a[216:219], v[56:59], v[80:83]
    ds_read_b128 v[48:51], v13 offset:61440
    ds_read_b128 v[52:55], v13 offset:63488
    v_mfma_f32_16x16x32_bf16 v[84:87], a[220:223], v[56:59], v[84:87]
    v_pk_mul_f32 v[226:227], v[226:227], v[242:243]
    v_pk_mul_f32 v[228:229], v[228:229], v[244:245]
    v_mfma_f32_16x16x32_bf16 v[88:91], a[216:219], v[60:63], v[88:91]
    v_pk_mul_f32 v[230:231], v[230:231], v[246:247]
    v_mfma_f32_16x16x32_bf16 v[92:95], a[220:223], v[60:63], v[92:95]
    v_pk_mul_f32 v[232:233], v[232:233], v[248:249]
    s_waitcnt lgkmcnt(4)
    v_mfma_f32_16x16x32_bf16 v[80:83], a[224:227], v[32:35], v[80:83]
    ds_read_b128 v[56:59], v15 offset:61440
    ds_read_b128 v[60:63], v15 offset:63488
    v_mfma_f32_16x16x32_bf16 v[84:87], a[228:231], v[32:35], v[84:87]
    v_pk_mul_f32 v[234:235], v[234:235], v[250:251]
    v_pk_mul_f32 v[236:237], v[236:237], v[252:253]
    v_mfma_f32_16x16x32_bf16 v[88:91], a[224:227], v[36:39], v[88:91]
    v_pk_mul_f32 v[238:239], v[238:239], v[254:255]
    v_mfma_f32_16x16x32_bf16 v[92:95], a[228:231], v[36:39], v[92:95]
    v_cvt_pk_bf16_f32 v240, v224, v225
    s_waitcnt lgkmcnt(4)
    v_mfma_f32_16x16x32_bf16 v[80:83], a[232:235], v[40:43], v[80:83]
    v_cvt_pk_bf16_f32 v241, v226, v227
    v_mfma_f32_16x16x32_bf16 v[84:87], a[236:239], v[40:43], v[84:87]
    v_cvt_pk_bf16_f32 v242, v228, v229
    v_mfma_f32_16x16x32_bf16 v[88:91], a[232:235], v[44:47], v[88:91]
    v_cvt_pk_bf16_f32 v243, v230, v231
    v_mfma_f32_16x16x32_bf16 v[92:95], a[236:239], v[44:47], v[92:95]
    v_cvt_pk_bf16_f32 v244, v232, v233
    s_waitcnt vmcnt(16) lgkmcnt(0)
    s_barrier
    v_mfma_f32_16x16x32_bf16 v[80:83], a[240:243], v[48:51], v[80:83]
    ds_read_b128 v[32:35], v14 offset:0
    ds_read_b128 v[36:39], v14 offset:2048
    v_mfma_f32_16x16x32_bf16 v[84:87], a[244:247], v[48:51], v[84:87]
    v_cvt_pk_bf16_f32 v245, v234, v235
    v_cvt_pk_bf16_f32 v246, v236, v237
    v_mfma_f32_16x16x32_bf16 v[88:91], a[240:243], v[52:55], v[88:91]
    v_cvt_pk_bf16_f32 v247, v238, v239
    v_mfma_f32_16x16x32_bf16 v[92:95], a[244:247], v[52:55], v[92:95]
    buffer_store_dwordx4 v[240:243], v10, s[12:15], s76 offen sc1
    v_mfma_f32_16x16x32_bf16 v[80:83], a[248:251], v[56:59], v[80:83]
    ds_read_b128 v[40:43], v16 offset:0
    ds_read_b128 v[44:47], v16 offset:2048
    v_mfma_f32_16x16x32_bf16 v[84:87], a[252:255], v[56:59], v[84:87]
    buffer_store_dwordx4 v[244:247], v10, s[12:15], s76 offen offset:1024 sc1
    v_mfma_f32_16x16x32_bf16 v[88:91], a[248:251], v[60:63], v[88:91]
    v_mfma_f32_16x16x32_bf16 v[92:95], a[252:255], v[60:63], v[92:95]
    s_add_u32 s53, s53, 65536
    s_add_u32 s58, s58, 1
    v_swap_b32 v13, v14
    s_xor_b32 s54, s54, 65536
    s_xor_b32 s55, s55, 65536
    s_mov_b32 s76, s57
    v_swap_b32 v15, v16
    s_add_u32 s57, s57, 229376
    v_cvt_pk_bf16_f32 v216, v80, v81
    v_cvt_pk_bf16_f32 v217, v82, v83
    v_cvt_pk_bf16_f32 v218, v84, v85
    v_cvt_pk_bf16_f32 v219, v86, v87
    v_cvt_pk_bf16_f32 v220, v88, v89
    v_cvt_pk_bf16_f32 v221, v90, v91
    v_cvt_pk_bf16_f32 v222, v92, v93
    v_cvt_pk_bf16_f32 v223, v94, v95
    s_cmp_lt_u32 s58, s51
    s_cbranch_scc1 L_e_loop_147
    v_lshlrev_b32 v224, 16, v216
    v_and_b32 v225, 0xffff0000, v216
    v_lshlrev_b32 v226, 16, v217
    v_and_b32 v227, 0xffff0000, v217
    v_lshlrev_b32 v228, 16, v218
    v_and_b32 v229, 0xffff0000, v218
    v_lshlrev_b32 v230, 16, v219
    v_and_b32 v231, 0xffff0000, v219
    v_lshlrev_b32 v232, 16, v220
    v_and_b32 v233, 0xffff0000, v220
    v_lshlrev_b32 v234, 16, v221
    v_and_b32 v235, 0xffff0000, v221
    v_lshlrev_b32 v236, 16, v222
    v_and_b32 v237, 0xffff0000, v222
    v_lshlrev_b32 v238, 16, v223
    v_and_b32 v239, 0xffff0000, v223
    v_pk_add_f32 v[224:225], v[224:225], v[96:97]
    v_pk_add_f32 v[226:227], v[226:227], v[98:99]
    v_pk_add_f32 v[228:229], v[228:229], v[100:101]
    v_pk_add_f32 v[230:231], v[230:231], v[102:103]
    v_pk_add_f32 v[232:233], v[232:233], v[96:97]
    v_pk_add_f32 v[234:235], v[234:235], v[98:99]
    v_pk_add_f32 v[236:237], v[236:237], v[100:101]
    v_pk_add_f32 v[238:239], v[238:239], v[102:103]
    v_cvt_pk_bf16_f32 v216, v224, v225
    v_cvt_pk_bf16_f32 v217, v226, v227
    v_cvt_pk_bf16_f32 v218, v228, v229
    v_cvt_pk_bf16_f32 v219, v230, v231
    v_cvt_pk_bf16_f32 v220, v232, v233
    v_cvt_pk_bf16_f32 v221, v234, v235
    v_cvt_pk_bf16_f32 v222, v236, v237
    v_cvt_pk_bf16_f32 v223, v238, v239
    v_lshlrev_b32 v224, 16, v216
    v_and_b32 v225, 0xffff0000, v216
    v_lshlrev_b32 v226, 16, v217
    v_and_b32 v227, 0xffff0000, v217
    v_lshlrev_b32 v228, 16, v218
    v_and_b32 v229, 0xffff0000, v218
    v_lshlrev_b32 v230, 16, v219
    v_and_b32 v231, 0xffff0000, v219
    v_lshlrev_b32 v232, 16, v220
    v_and_b32 v233, 0xffff0000, v220
    v_lshlrev_b32 v234, 16, v221
    v_and_b32 v235, 0xffff0000, v221
    v_lshlrev_b32 v236, 16, v222
    v_and_b32 v237, 0xffff0000, v222
    v_lshlrev_b32 v238, 16, v223
    v_and_b32 v239, 0xffff0000, v223
    v_pk_mul_f32 v[240:241], v[224:225], v[224:225]
    v_pk_mul_f32 v[242:243], v[226:227], v[226:227]
    v_pk_mul_f32 v[244:245], v[228:229], v[228:229]
    v_pk_mul_f32 v[246:247], v[230:231], v[230:231]
    v_pk_mul_f32 v[248:249], v[232:233], v[232:233]
    v_pk_mul_f32 v[250:251], v[234:235], v[234:235]
    v_pk_mul_f32 v[252:253], v[236:237], v[236:237]
    v_pk_mul_f32 v[254:255], v[238:239], v[238:239]
    v_pk_fma_f32 v[240:241], v[240:241], v[104:105], v[106:107]
    v_pk_fma_f32 v[242:243], v[242:243], v[104:105], v[106:107]
    v_pk_fma_f32 v[244:245], v[244:245], v[104:105], v[106:107]
    v_pk_fma_f32 v[246:247], v[246:247], v[104:105], v[106:107]
    v_pk_fma_f32 v[248:249], v[248:249], v[104:105], v[106:107]
    v_pk_fma_f32 v[250:251], v[250:251], v[104:105], v[106:107]
    v_pk_fma_f32 v[252:253], v[252:253], v[104:105], v[106:107]
    v_pk_fma_f32 v[254:255], v[254:255], v[104:105], v[106:107]
    v_pk_mul_f32 v[240:241], v[240:241], v[224:225]
    v_pk_mul_f32 v[242:243], v[242:243], v[226:227]
    v_pk_mul_f32 v[244:245], v[244:245], v[228:229]
    v_pk_mul_f32 v[246:247], v[246:247], v[230:231]
    v_pk_mul_f32 v[248:249], v[248:249], v[232:233]
    v_pk_mul_f32 v[250:251], v[250:251], v[234:235]
    v_pk_mul_f32 v[252:253], v[252:253], v[236:237]
    v_pk_mul_f32 v[254:255], v[254:255], v[238:239]
    v_exp_f32 v240, v240
    v_exp_f32 v241, v241
    v_exp_f32 v242, v242
    v_exp_f32 v243, v243
    v_exp_f32 v244, v244
    v_exp_f32 v245, v245
    v_exp_f32 v246, v246
    v_exp_f32 v247, v247
    v_exp_f32 v248, v248
    v_exp_f32 v249, v249
    v_exp_f32 v250, v250
    v_exp_f32 v251, v251
    v_exp_f32 v252, v252
    v_exp_f32 v253, v253
    v_exp_f32 v254, v254
    v_exp_f32 v255, v255
    v_add_f32 v240, 1.0, v240
    v_add_f32 v241, 1.0, v241
    v_add_f32 v242, 1.0, v242
    v_add_f32 v243, 1.0, v243
    v_add_f32 v244, 1.0, v244
    v_add_f32 v245, 1.0, v245
    v_add_f32 v246, 1.0, v246
    v_add_f32 v247, 1.0, v247
    v_add_f32 v248, 1.0, v248
    v_add_f32 v249, 1.0, v249
    v_add_f32 v250, 1.0, v250
    v_add_f32 v251, 1.0, v251
    v_add_f32 v252, 1.0, v252
    v_add_f32 v253, 1.0, v253
    v_add_f32 v254, 1.0, v254
    v_add_f32 v255, 1.0, v255
    v_rcp_f32 v240, v240
    v_rcp_f32 v241, v241
    v_rcp_f32 v242, v242
    v_rcp_f32 v243, v243
    v_rcp_f32 v244, v244
    v_rcp_f32 v245, v245
    v_rcp_f32 v246, v246
    v_rcp_f32 v247, v247
    v_rcp_f32 v248, v248
    v_rcp_f32 v249, v249
    v_rcp_f32 v250, v250
    v_rcp_f32 v251, v251
    v_rcp_f32 v252, v252
    v_rcp_f32 v253, v253
    v_rcp_f32 v254, v254
    v_rcp_f32 v255, v255
    v_pk_mul_f32 v[224:225], v[224:225], v[240:241]
    v_pk_mul_f32 v[226:227], v[226:227], v[242:243]
    v_pk_mul_f32 v[228:229], v[228:229], v[244:245]
    v_pk_mul_f32 v[230:231], v[230:231], v[246:247]
    v_pk_mul_f32 v[232:233], v[232:233], v[248:249]
    v_pk_mul_f32 v[234:235], v[234:235], v[250:251]
    v_pk_mul_f32 v[236:237], v[236:237], v[252:253]
    v_pk_mul_f32 v[238:239], v[238:239], v[254:255]
    v_cvt_pk_bf16_f32 v240, v224, v225
    v_cvt_pk_bf16_f32 v241, v226, v227
    v_cvt_pk_bf16_f32 v242, v228, v229
    v_cvt_pk_bf16_f32 v243, v230, v231
    v_cvt_pk_bf16_f32 v244, v232, v233
    v_cvt_pk_bf16_f32 v245, v234, v235
    v_cvt_pk_bf16_f32 v246, v236, v237
    v_cvt_pk_bf16_f32 v247, v238, v239
    buffer_store_dwordx4 v[240:243], v10, s[12:15], s76 offen sc1
    buffer_store_dwordx4 v[244:247], v10, s[12:15], s76 offen offset:1024 sc1
    s_waitcnt lgkmcnt(0)
    s_waitcnt vmcnt(0)
    s_barrier
    s_cmp_lg_u32 s44, 0
    s_cbranch_scc1 L_pub_148
    v_mov_b32 v30, s62
    v_mov_b32 v31, 0
    s_mov_b64 exec, 1
    buffer_store_dword v30, v31, s[12:15], s67 offen sc1
    s_mov_b64 exec, -1
L_pub_148:
    s_branch L_b_loop_139
L_role_c_121:
    s_load_dwordx2 s[6:7], s[0:1], 80
    s_load_dwordx2 s[8:9], s[0:1], 88
    s_load_dwordx2 s[10:11], s[0:1], 112
    s_waitcnt lgkmcnt(0)
    s_mov_b32 s24, s6
    s_and_b32 s25, s7, 0xffff
    s_mov_b32 s26, 0x700000
    s_mov_b32 s27, 0x00020000
    s_mov_b32 s28, s8
    s_and_b32 s29, s9, 0xffff
    s_mov_b32 s30, 0x800
    s_mov_b32 s31, 0x00020000
    s_mov_b32 s32, s10
    s_and_b32 s33, s11, 0xffff
    s_mov_b32 s34, 0x400000
    s_mov_b32 s35, 0x00020000
    s_mul_i32 s46, s38, 1835008
    s_lshl_b32 s45, s68, 8
    s_add_u32 s46, s46, s45
    s_waitcnt vmcnt(0)
    s_barrier
    v_lshrrev_b32 v20, 4, v1
    s_lshl_b32 s45, s44, 2
    v_add_u32 v21, s45, v20
    s_mov_b32 s45, 2048
    v_mul_lo_u32 v21, v21, s45
    v_lshlrev_b32 v22, 2, v20
    v_and_b32 v23, 15, v1
    v_xor_b32 v22, v22, v23
    v_lshlrev_b32 v22, 4, v22
    v_add_u32 v21, v21, v22
    v_bfe_u32 v22, v1, 2, 2
    v_lshlrev_b32 v23, 3, v20
    v_add_u32 v23, v23, v22
    v_lshlrev_b32 v23, 8, v23
    v_xor_b32 v22, s44, v22
    v_lshlrev_b32 v22, 6, v22
    v_add_u32 v23, v23, v22
    v_and_b32 v22, 3, v1
    v_lshlrev_b32 v22, 3, v22
    v_add_u32 v23, v23, v22
    v_add_u32 v24, 65536, v23
    v_add_u32 v25, 131072, v23
    s_lshl_b32 s47, s44, 10
    s_add_u32 s45, s46, 0x0
    s_add_u32 m0, s47, 0
    s_nop 0
    buffer_load_dwordx4 v21, s[24:27], s45 offen  lds
    s_add_u32 s45, s46, 0x8000
    s_add_u32 m0, s47, 4096
    s_nop 0
    buffer_load_dwordx4 v21, s[24:27], s45 offen  lds
    s_add_u32 s45, s46, 0x10000
    s_add_u32 m0, s47, 8192
    s_nop 0
    buffer_load_dwordx4 v21, s[24:27], s45 offen  lds
    s_add_u32 s45, s46, 0x18000
    s_add_u32 m0, s47, 12288
    s_nop 0
    buffer_load_dwordx4 v21, s[24:27], s45 offen  lds
    s_add_u32 s45, s46, 0x20000
    s_add_u32 m0, s47, 16384
    s_nop 0
    buffer_load_dwordx4 v21, s[24:27], s45 offen  lds
    s_add_u32 s45, s46, 0x28000
    s_add_u32 m0, s47, 20480
    s_nop 0
    buffer_load_dwordx4 v21, s[24:27], s45 offen  lds
    s_add_u32 s45, s46, 0x30000
    s_add_u32 m0, s47, 24576
    s_nop 0
    buffer_load_dwordx4 v21, s[24:27], s45 offen  lds
    s_add_u32 s45, s46, 0x38000
    s_add_u32 m0, s47, 28672
    s_nop 0
    buffer_load_dwordx4 v21, s[24:27], s45 offen  lds
    s_add_u32 s45, s46, 0x40000
    s_add_u32 m0, s47, 32768
    s_nop 0
    buffer_load_dwordx4 v21, s[24:27], s45 offen  lds
    s_add_u32 s45, s46, 0x48000
    s_add_u32 m0, s47, 36864
    s_nop 0
    buffer_load_dwordx4 v21, s[24:27], s45 offen  lds
    s_add_u32 s45, s46, 0x50000
    s_add_u32 m0, s47, 40960
    s_nop 0
    buffer_load_dwordx4 v21, s[24:27], s45 offen  lds
    s_add_u32 s45, s46, 0x58000
    s_add_u32 m0, s47, 45056
    s_nop 0
    buffer_load_dwordx4 v21, s[24:27], s45 offen  lds
    s_add_u32 s45, s46, 0x60000
    s_add_u32 m0, s47, 49152
    s_nop 0
    buffer_load_dwordx4 v21, s[24:27], s45 offen  lds
    s_add_u32 s45, s46, 0x68000
    s_add_u32 m0, s47, 53248
    s_nop 0
    buffer_load_dwordx4 v21, s[24:27], s45 offen  lds
    s_add_u32 s45, s46, 0x70000
    s_add_u32 m0, s47, 57344
    s_nop 0
    buffer_load_dwordx4 v21, s[24:27], s45 offen  lds
    s_add_u32 s45, s46, 0x78000
    s_add_u32 m0, s47, 61440
    s_nop 0
    buffer_load_dwordx4 v21, s[24:27], s45 offen  lds
    s_add_u32 s45, s46, 0x80000
    s_add_u32 m0, s47, 65536
    s_nop 0
    buffer_load_dwordx4 v21, s[24:27], s45 offen  lds
    s_add_u32 s45, s46, 0x88000
    s_add_u32 m0, s47, 69632
    s_nop 0
    buffer_load_dwordx4 v21, s[24:27], s45 offen  lds
    s_add_u32 s45, s46, 0x90000
    s_add_u32 m0, s47, 73728
    s_nop 0
    buffer_load_dwordx4 v21, s[24:27], s45 offen  lds
    s_add_u32 s45, s46, 0x98000
    s_add_u32 m0, s47, 77824
    s_nop 0
    buffer_load_dwordx4 v21, s[24:27], s45 offen  lds
    s_add_u32 s45, s46, 0xa0000
    s_add_u32 m0, s47, 81920
    s_nop 0
    buffer_load_dwordx4 v21, s[24:27], s45 offen  lds
    s_add_u32 s45, s46, 0xa8000
    s_add_u32 m0, s47, 86016
    s_nop 0
    buffer_load_dwordx4 v21, s[24:27], s45 offen  lds
    s_add_u32 s45, s46, 0xb0000
    s_add_u32 m0, s47, 90112
    s_nop 0
    buffer_load_dwordx4 v21, s[24:27], s45 offen  lds
    s_add_u32 s45, s46, 0xb8000
    s_add_u32 m0, s47, 94208
    s_nop 0
    buffer_load_dwordx4 v21, s[24:27], s45 offen  lds
    s_add_u32 s45, s46, 0xc0000
    s_add_u32 m0, s47, 98304
    s_nop 0
    buffer_load_dwordx4 v21, s[24:27], s45 offen  lds
    s_add_u32 s45, s46, 0xc8000
    s_add_u32 m0, s47, 102400
    s_nop 0
    buffer_load_dwordx4 v21, s[24:27], s45 offen  lds
    s_add_u32 s45, s46, 0xd0000
    s_add_u32 m0, s47, 106496
    s_nop 0
    buffer_load_dwordx4 v21, s[24:27], s45 offen  lds
    s_add_u32 s45, s46, 0xd8000
    s_add_u32 m0, s47, 110592
    s_nop 0
    buffer_load_dwordx4 v21, s[24:27], s45 offen  lds
    s_add_u32 s45, s46, 0xe0000
    s_add_u32 m0, s47, 114688
    s_nop 0
    buffer_load_dwordx4 v21, s[24:27], s45 offen  lds
    s_add_u32 s45, s46, 0xe8000
    s_add_u32 m0, s47, 118784
    s_nop 0
    buffer_load_dwordx4 v21, s[24:27], s45 offen  lds
    s_add_u32 s45, s46, 0xf0000
    s_add_u32 m0, s47, 122880
    s_nop 0
    buffer_load_dwordx4 v21, s[24:27], s45 offen  lds
    s_add_u32 s45, s46, 0xf8000
    s_add_u32 m0, s47, 126976
    s_nop 0
    buffer_load_dwordx4 v21, s[24:27], s45 offen  lds
    s_waitcnt vmcnt(28)
    s_barrier
    s_add_u32 s45, s46, 0x100000
    s_add_u32 m0, s47, 131072
    s_nop 0
    buffer_load_dwordx4 v21, s[24:27], s45 offen  lds
    s_add_u32 s45, s46, 0x108000
    s_add_u32 m0, s47, 135168
    s_nop 0
    buffer_load_dwordx4 v21, s[24:27], s45 offen  lds
    s_add_u32 s45, s46, 0x110000
    s_add_u32 m0, s47, 139264
    s_nop 0
    buffer_load_dwordx4 v21, s[24:27], s45 offen  lds
    s_add_u32 s45, s46, 0x118000
    s_add_u32 m0, s47, 143360
    s_nop 0
    buffer_load_dwordx4 v21, s[24:27], s45 offen  lds
    ds_read_b64_tr_b16 a[0:1], v23 offset:0
    ds_read_b64_tr_b16 a[2:3], v23 offset:1024
    ds_read_b64_tr_b16 a[4:5], v23 offset:32
    ds_read_b64_tr_b16 a[6:7], v23 offset:1056
    ds_read_b64_tr_b16 a[8:9], v23 offset:8192
    ds_read_b64_tr_b16 a[10:11], v23 offset:9216
    ds_read_b64_tr_b16 a[12:13], v23 offset:8224
    ds_read_b64_tr_b16 a[14:15], v23 offset:9248
    s_waitcnt lgkmcnt(0)
    s_waitcnt vmcnt(28)
    s_barrier
    s_add_u32 s45, s46, 0x120000
    s_add_u32 m0, s47, 0
    s_nop 0
    buffer_load_dwordx4 v21, s[24:27], s45 offen  lds
    s_add_u32 s45, s46, 0x128000
    s_add_u32 m0, s47, 4096
    s_nop 0
    buffer_load_dwordx4 v21, s[24:27], s45 offen  lds
    s_add_u32 s45, s46, 0x130000
    s_add_u32 m0, s47, 8192
    s_nop 0
    buffer_load_dwordx4 v21, s[24:27], s45 offen  lds
    s_add_u32 s45, s46, 0x138000
    s_add_u32 m0, s47, 12288
    s_nop 0
    buffer_load_dwordx4 v21, s[24:27], s45 offen  lds
    ds_read_b64_tr_b16 a[16:17], v23 offset:16384
    ds_read_b64_tr_b16 a[18:19], v23 offset:17408
    ds_read_b64_tr_b16 a[20:21], v23 offset:16416
    ds_read_b64_tr_b16 a[22:23], v23 offset:17440
    ds_read_b64_tr_b16 a[24:25], v23 offset:24576
    ds_read_b64_tr_b16 a[26:27], v23 offset:25600
    ds_read_b64_tr_b16 a[28:29], v23 offset:24608
    ds_read_b64_tr_b16 a[30:31], v23 offset:25632
    s_waitcnt lgkmcnt(0)
    s_waitcnt vmcnt(28)
    s_barrier
    s_add_u32 s45, s46, 0x140000
    s_add_u32 m0, s47, 16384
    s_nop 0
    buffer_load_dwordx4 v21, s[24:27], s45 offen  lds
    s_add_u32 s45, s46, 0x148000
    s_add_u32 m0, s47, 20480
    s_nop 0
    buffer_load_dwordx4 v21, s[24:27], s45 offen  lds
    s_add_u32 s45, s46, 0x150000
    s_add_u32 m0, s47, 24576
    s_nop 0
    buffer_load_dwordx4 v21, s[24:27], s45 offen  lds
    s_add_u32 s45, s46, 0x158000
    s_add_u32 m0, s47, 28672
    s_nop 0
    buffer_load_dwordx4 v21, s[24:27], s45 offen  lds
    ds_read_b64_tr_b16 a[32:33], v23 offset:32768
    ds_read_b64_tr_b16 a[34:35], v23 offset:33792
    ds_read_b64_tr_b16 a[36:37], v23 offset:32800
    ds_read_b64_tr_b16 a[38:39], v23 offset:33824
    ds_read_b64_tr_b16 a[40:41], v23 offset:40960
    ds_read_b64_tr_b16 a[42:43], v23 offset:41984
    ds_read_b64_tr_b16 a[44:45], v23 offset:40992
    ds_read_b64_tr_b16 a[46:47], v23 offset:42016
    s_waitcnt lgkmcnt(0)
    s_waitcnt vmcnt(28)
    s_barrier
    s_add_u32 s45, s46, 0x160000
    s_add_u32 m0, s47, 32768
    s_nop 0
    buffer_load_dwordx4 v21, s[24:27], s45 offen  lds
    s_add_u32 s45, s46, 0x168000
    s_add_u32 m0, s47, 36864
    s_nop 0
    buffer_load_dwordx4 v21, s[24:27], s45 offen  lds
    s_add_u32 s45, s46, 0x170000
    s_add_u32 m0, s47, 40960
    s_nop 0
    buffer_load_dwordx4 v21, s[24:27], s45 offen  lds
    s_add_u32 s45, s46, 0x178000
    s_add_u32 m0, s47, 45056
    s_nop 0
    buffer_load_dwordx4 v21, s[24:27], s45 offen  lds
    ds_read_b64_tr_b16 a[48:49], v23 offset:49152
    ds_read_b64_tr_b16 a[50:51], v23 offset:50176
    ds_read_b64_tr_b16 a[52:53], v23 offset:49184
    ds_read_b64_tr_b16 a[54:55], v23 offset:50208
    ds_read_b64_tr_b16 a[56:57], v23 offset:57344
    ds_read_b64_tr_b16 a[58:59], v23 offset:58368
    ds_read_b64_tr_b16 a[60:61], v23 offset:57376
    ds_read_b64_tr_b16 a[62:63], v23 offset:58400
    s_waitcnt lgkmcnt(0)
    s_waitcnt vmcnt(28)
    s_barrier
    s_add_u32 s45, s46, 0x180000
    s_add_u32 m0, s47, 49152
    s_nop 0
    buffer_load_dwordx4 v21, s[24:27], s45 offen  lds
    s_add_u32 s45, s46, 0x188000
    s_add_u32 m0, s47, 53248
    s_nop 0
    buffer_load_dwordx4 v21, s[24:27], s45 offen  lds
    s_add_u32 s45, s46, 0x190000
    s_add_u32 m0, s47, 57344
    s_nop 0
    buffer_load_dwordx4 v21, s[24:27], s45 offen  lds
    s_add_u32 s45, s46, 0x198000
    s_add_u32 m0, s47, 61440
    s_nop 0
    buffer_load_dwordx4 v21, s[24:27], s45 offen  lds
    ds_read_b64_tr_b16 a[64:65], v24 offset:0
    ds_read_b64_tr_b16 a[66:67], v24 offset:1024
    ds_read_b64_tr_b16 a[68:69], v24 offset:32
    ds_read_b64_tr_b16 a[70:71], v24 offset:1056
    ds_read_b64_tr_b16 a[72:73], v24 offset:8192
    ds_read_b64_tr_b16 a[74:75], v24 offset:9216
    ds_read_b64_tr_b16 a[76:77], v24 offset:8224
    ds_read_b64_tr_b16 a[78:79], v24 offset:9248
    s_waitcnt lgkmcnt(0)
    s_waitcnt vmcnt(28)
    s_barrier
    s_add_u32 s45, s46, 0x1a0000
    s_add_u32 m0, s47, 65536
    s_nop 0
    buffer_load_dwordx4 v21, s[24:27], s45 offen  lds
    s_add_u32 s45, s46, 0x1a8000
    s_add_u32 m0, s47, 69632
    s_nop 0
    buffer_load_dwordx4 v21, s[24:27], s45 offen  lds
    s_add_u32 s45, s46, 0x1b0000
    s_add_u32 m0, s47, 73728
    s_nop 0
    buffer_load_dwordx4 v21, s[24:27], s45 offen  lds
    s_add_u32 s45, s46, 0x1b8000
    s_add_u32 m0, s47, 77824
    s_nop 0
    buffer_load_dwordx4 v21, s[24:27], s45 offen  lds
    ds_read_b64_tr_b16 a[80:81], v24 offset:16384
    ds_read_b64_tr_b16 a[82:83], v24 offset:17408
    ds_read_b64_tr_b16 a[84:85], v24 offset:16416
    ds_read_b64_tr_b16 a[86:87], v24 offset:17440
    ds_read_b64_tr_b16 a[88:89], v24 offset:24576
    ds_read_b64_tr_b16 a[90:91], v24 offset:25600
    ds_read_b64_tr_b16 a[92:93], v24 offset:24608
    ds_read_b64_tr_b16 a[94:95], v24 offset:25632
    s_waitcnt lgkmcnt(0)
    s_waitcnt vmcnt(28)
    s_barrier
    ds_read_b64_tr_b16 a[96:97], v24 offset:32768
    ds_read_b64_tr_b16 a[98:99], v24 offset:33792
    ds_read_b64_tr_b16 a[100:101], v24 offset:32800
    ds_read_b64_tr_b16 a[102:103], v24 offset:33824
    ds_read_b64_tr_b16 a[104:105], v24 offset:40960
    ds_read_b64_tr_b16 a[106:107], v24 offset:41984
    ds_read_b64_tr_b16 a[108:109], v24 offset:40992
    ds_read_b64_tr_b16 a[110:111], v24 offset:42016
    s_waitcnt lgkmcnt(0)
    s_waitcnt vmcnt(24)
    s_barrier
    ds_read_b64_tr_b16 a[112:113], v24 offset:49152
    ds_read_b64_tr_b16 a[114:115], v24 offset:50176
    ds_read_b64_tr_b16 a[116:117], v24 offset:49184
    ds_read_b64_tr_b16 a[118:119], v24 offset:50208
    ds_read_b64_tr_b16 a[120:121], v24 offset:57344
    ds_read_b64_tr_b16 a[122:123], v24 offset:58368
    ds_read_b64_tr_b16 a[124:125], v24 offset:57376
    ds_read_b64_tr_b16 a[126:127], v24 offset:58400
    s_waitcnt lgkmcnt(0)
    s_waitcnt vmcnt(20)
    s_barrier
    ds_read_b64_tr_b16 a[128:129], v25 offset:0
    ds_read_b64_tr_b16 a[130:131], v25 offset:1024
    ds_read_b64_tr_b16 a[132:133], v25 offset:32
    ds_read_b64_tr_b16 a[134:135], v25 offset:1056
    ds_read_b64_tr_b16 a[136:137], v25 offset:8192
    ds_read_b64_tr_b16 a[138:139], v25 offset:9216
    ds_read_b64_tr_b16 a[140:141], v25 offset:8224
    ds_read_b64_tr_b16 a[142:143], v25 offset:9248
    s_waitcnt lgkmcnt(0)
    s_waitcnt vmcnt(16)
    s_barrier
    ds_read_b64_tr_b16 a[144:145], v23 offset:0
    ds_read_b64_tr_b16 a[146:147], v23 offset:1024
    ds_read_b64_tr_b16 a[148:149], v23 offset:32
    ds_read_b64_tr_b16 a[150:151], v23 offset:1056
    ds_read_b64_tr_b16 a[152:153], v23 offset:8192
    ds_read_b64_tr_b16 a[154:155], v23 offset:9216
    ds_read_b64_tr_b16 a[156:157], v23 offset:8224
    ds_read_b64_tr_b16 a[158:159], v23 offset:9248
    s_waitcnt lgkmcnt(0)
    s_waitcnt vmcnt(12)
    s_barrier
    ds_read_b64_tr_b16 a[160:161], v23 offset:16384
    ds_read_b64_tr_b16 a[162:163], v23 offset:17408
    ds_read_b64_tr_b16 a[164:165], v23 offset:16416
    ds_read_b64_tr_b16 a[166:167], v23 offset:17440
    ds_read_b64_tr_b16 a[168:169], v23 offset:24576
    ds_read_b64_tr_b16 a[170:171], v23 offset:25600
    ds_read_b64_tr_b16 a[172:173], v23 offset:24608
    ds_read_b64_tr_b16 a[174:175], v23 offset:25632
    s_waitcnt lgkmcnt(0)
    s_waitcnt vmcnt(8)
    s_barrier
    ds_read_b64_tr_b16 a[176:177], v23 offset:32768
    ds_read_b64_tr_b16 a[178:179], v23 offset:33792
    ds_read_b64_tr_b16 a[180:181], v23 offset:32800
    ds_read_b64_tr_b16 a[182:183], v23 offset:33824
    ds_read_b64_tr_b16 a[184:185], v23 offset:40960
    ds_read_b64_tr_b16 a[186:187], v23 offset:41984
    ds_read_b64_tr_b16 a[188:189], v23 offset:40992
    ds_read_b64_tr_b16 a[190:191], v23 offset:42016
    s_waitcnt lgkmcnt(0)
    s_waitcnt vmcnt(4)
    s_barrier
    ds_read_b64_tr_b16 a[192:193], v23 offset:49152
    ds_read_b64_tr_b16 a[194:195], v23 offset:50176
    ds_read_b64_tr_b16 a[196:197], v23 offset:49184
    ds_read_b64_tr_b16 a[198:199], v23 offset:50208
    ds_read_b64_tr_b16 a[200:201], v23 offset:57344
    ds_read_b64_tr_b16 a[202:203], v23 offset:58368
    ds_read_b64_tr_b16 a[204:205], v23 offset:57376
    ds_read_b64_tr_b16 a[206:207], v23 offset:58400
    s_waitcnt lgkmcnt(0)
    s_waitcnt vmcnt(0)
    s_barrier
    ds_read_b64_tr_b16 a[208:209], v24 offset:0
    ds_read_b64_tr_b16 a[210:211], v24 offset:1024
    ds_read_b64_tr_b16 a[212:213], v24 offset:32
    ds_read_b64_tr_b16 a[214:215], v24 offset:1056
    ds_read_b64_tr_b16 a[216:217], v24 offset:8192
    ds_read_b64_tr_b16 a[218:219], v24 offset:9216
    ds_read_b64_tr_b16 a[220:221], v24 offset:8224
    ds_read_b64_tr_b16 a[222:223], v24 offset:9248
    s_waitcnt lgkmcnt(0)
    s_barrier
    buffer_load_dwordx4 v[80:83], v10, s[28:31], 0 offen
    buffer_load_dwordx4 v[84:87], v10, s[28:31], 0 offen offset:1024
    s_waitcnt vmcnt(0)
    v_lshlrev_b32 v96, 16, v80
    v_and_b32 v97, 0xffff0000, v80
    v_lshlrev_b32 v98, 16, v81
    v_and_b32 v99, 0xffff0000, v81
    v_lshlrev_b32 v100, 16, v82
    v_and_b32 v101, 0xffff0000, v82
    v_lshlrev_b32 v102, 16, v83
    v_and_b32 v103, 0xffff0000, v83
    v_lshlrev_b32 v104, 16, v84
    v_and_b32 v105, 0xffff0000, v84
    v_lshlrev_b32 v106, 16, v85
    v_and_b32 v107, 0xffff0000, v85
    v_lshlrev_b32 v108, 16, v86
    v_and_b32 v109, 0xffff0000, v86
    v_lshlrev_b32 v110, 16, v87
    v_and_b32 v111, 0xffff0000, v87
    s_cmp_lg_u32 s44, 0
    s_cbranch_scc1 L_pd_149
    v_mov_b32 v29, 132
    s_mov_b32 s46, 96
    s_mov_b64 exec, 1
    s_mov_b32 s70, 0
L_wp_150:
    buffer_load_dword v31, v29, s[16:19], 0 offen sc1
    s_add_u32 s70, s70, 1
    s_cmp_ge_u32 s70, 0x200000
    s_cbranch_scc1 L_w_done_102
    s_waitcnt vmcnt(0)
    v_cmp_gt_u32 vcc, s46, v31
    s_nop 1
    s_cbranch_vccz L_wp_150_ok
    s_sleep 3
    s_branch L_wp_150
L_wp_150_ok:
    s_mov_b64 exec, -1
L_pd_149:
    s_barrier
    v_lshlrev_b32 v29, 5, v1
    s_mov_b32 s45, 20480
    buffer_load_dwordx4 v[112:115], v29, s[12:15], s45 offen offset:0 sc1
    buffer_load_dwordx4 v[116:119], v29, s[12:15], s45 offen offset:16 sc1
    buffer_load_dwordx4 v[120:123], v29, s[12:15], s45 offen offset:2048 sc1
    buffer_load_dwordx4 v[124:127], v29, s[12:15], s45 offen offset:2064 sc1
    s_mov_b32 s45, 45056
    buffer_load_dwordx4 v[32:35], v29, s[12:15], s45 offen offset:0 sc1
    buffer_load_dwordx4 v[36:39], v29, s[12:15], s45 offen offset:16 sc1
    buffer_load_dwordx4 v[40:43], v29, s[12:15], s45 offen offset:2048 sc1
    buffer_load_dwordx4 v[44:47], v29, s[12:15], s45 offen offset:2064 sc1
    s_waitcnt vmcnt(0)
    v_add_f32 v112, v112, v32
    v_cvt_pk_bf16_f32 v112, v112, v112
    v_lshlrev_b32 v112, 16, v112
    v_add_f32 v113, v113, v33
    v_cvt_pk_bf16_f32 v113, v113, v113
    v_lshlrev_b32 v113, 16, v113
    v_add_f32 v114, v114, v34
    v_cvt_pk_bf16_f32 v114, v114, v114
    v_lshlrev_b32 v114, 16, v114
    v_add_f32 v115, v115, v35
    v_cvt_pk_bf16_f32 v115, v115, v115
    v_lshlrev_b32 v115, 16, v115
    v_add_f32 v116, v116, v36
    v_cvt_pk_bf16_f32 v116, v116, v116
    v_lshlrev_b32 v116, 16, v116
    v_add_f32 v117, v117, v37
    v_cvt_pk_bf16_f32 v117, v117, v117
    v_lshlrev_b32 v117, 16, v117
    v_add_f32 v118, v118, v38
    v_cvt_pk_bf16_f32 v118, v118, v118
    v_lshlrev_b32 v118, 16, v118
    v_add_f32 v119, v119, v39
    v_cvt_pk_bf16_f32 v119, v119, v119
    v_lshlrev_b32 v119, 16, v119
    v_add_f32 v120, v120, v40
    v_cvt_pk_bf16_f32 v120, v120, v120
    v_lshlrev_b32 v120, 16, v120
    v_add_f32 v121, v121, v41
    v_cvt_pk_bf16_f32 v121, v121, v121
    v_lshlrev_b32 v121, 16, v121
    v_add_f32 v122, v122, v42
    v_cvt_pk_bf16_f32 v122, v122, v122
    v_lshlrev_b32 v122, 16, v122
    v_add_f32 v123, v123, v43
    v_cvt_pk_bf16_f32 v123, v123, v123
    v_lshlrev_b32 v123, 16, v123
    v_add_f32 v124, v124, v44
    v_cvt_pk_bf16_f32 v124, v124, v124
    v_lshlrev_b32 v124, 16, v124
    v_add_f32 v125, v125, v45
    v_cvt_pk_bf16_f32 v125, v125, v125
    v_lshlrev_b32 v125, 16, v125
    v_add_f32 v126, v126, v46
    v_cvt_pk_bf16_f32 v126, v126, v126
    v_lshlrev_b32 v126, 16, v126
    v_add_f32 v127, v127, v47
    v_cvt_pk_bf16_f32 v127, v127, v127
    v_lshlrev_b32 v127, 16, v127
    s_mul_i32 s52, s38, 57344
    s_add_u32 s52, s52, 0x6000000
    s_lshl_b32 s56, s38, 23
    s_lshl_b32 s45, s68, 9
    s_add_u32 s56, s56, s45
    s_add_u32 s56, s56, 0xc000000
L_c_loop_151:
    s_cmp_eq_u64 s[36:37], 0
    s_cbranch_scc1 L_w_done_102
    s_ff1_i32_b64 s50, s[36:37]
    s_bitset0_b64 s[36:37], s50
    s_lshr_b64 s[74:75], s[72:73], s50
    s_ff1_i32_b64 s51, s[74:75]
    s_add_u32 s51, s51, 1
    s_add_u32 s62, s50, s51
    s_mul_i32 s45, s38, 896
    s_add_u32 s45, s45, s64
    s_add_u32 s45, s45, 12288
    s_cmp_lg_u32 s44, 0
    s_cbranch_scc1 L_pw_153
    s_mov_b64 exec, 127
    s_mov_b32 s70, 0
L_wp_154:
    buffer_load_dword v31, v5, s[12:15], s45 offen sc1
    s_add_u32 s70, s70, 1
    s_cmp_ge_u32 s70, 0x200000
    s_cbranch_scc1 L_w_done_102
    s_waitcnt vmcnt(0)
    v_cmp_gt_u32 vcc, s62, v31
    s_nop 1
    s_cbranch_vccz L_wp_154_ok
    s_sleep 2
    s_branch L_wp_154
L_wp_154_ok:
    s_mov_b64 exec, -1
L_pw_153:
    s_barrier
    s_mul_i32 s53, s50, 229376
    s_add_u32 s53, s53, s52
    s_lshl_b32 s54, s44, 13
    s_add_u32 s53, s53, s54
    s_mul_i32 s57, s50, 131072
    s_add_u32 s57, s57, s56
    s_lshl_b32 s45, s44, 7
    s_add_u32 s57, s57, s45
    s_add_u32 s55, s54, 65536
    s_mov_b32 s58, 0
    v_mov_b32 v13, v10
    v_add_u32 v14, 65536, v13
    v_xor_b32 v15, 64, v13
    v_xor_b32 v16, 64, v14
    s_mov_b32 s76, 0x20000000
    s_add_u32 s48, s53, 0
    s_add_u32 s49, s48, 4096
    s_add_u32 m0, s54, 0
    s_nop 0
    buffer_load_dwordx4 v10, s[12:15], s48 offen offset:0 sc1 lds
    buffer_load_dwordx4 v10, s[12:15], s48 offen offset:1024 sc1 lds
    buffer_load_dwordx4 v10, s[12:15], s48 offen offset:2048 sc1 lds
    buffer_load_dwordx4 v10, s[12:15], s48 offen offset:3072 sc1 lds
    s_add_u32 m0, s54, 4096
    s_nop 0
    buffer_load_dwordx4 v10, s[12:15], s49 offen offset:0 sc1 lds
    buffer_load_dwordx4 v10, s[12:15], s49 offen offset:1024 sc1 lds
    buffer_load_dwordx4 v10, s[12:15], s49 offen offset:2048 sc1 lds
    buffer_load_dwordx4 v10, s[12:15], s49 offen offset:3072 sc1 lds
    s_add_u32 s48, s53, 32768
    s_cmp_lt_u32 s44, 3
    s_cselect_b32 s48, s48, 0x20000000
    s_add_u32 s49, s48, 4096
    s_add_u32 s46, s54, 32768
    s_add_u32 m0, s46, 0
    s_nop 0
    buffer_load_dwordx4 v10, s[12:15], s48 offen offset:0 sc1 lds
    buffer_load_dwordx4 v10, s[12:15], s48 offen offset:1024 sc1 lds
    buffer_load_dwordx4 v10, s[12:15], s48 offen offset:2048 sc1 lds
    buffer_load_dwordx4 v10, s[12:15], s48 offen offset:3072 sc1 lds
    s_add_u32 m0, s46, 4096
    s_nop 0
    buffer_load_dwordx4 v10, s[12:15], s49 offen offset:0 sc1 lds
    buffer_load_dwordx4 v10, s[12:15], s49 offen offset:1024 sc1 lds
    buffer_load_dwordx4 v10, s[12:15], s49 offen offset:2048 sc1 lds
    buffer_load_dwordx4 v10, s[12:15], s49 offen offset:3072 sc1 lds
    s_add_u32 s48, s53, 229376
    s_cmp_gt_u32 s51, 1
    s_cselect_b32 s48, s48, 0x20000000
    s_add_u32 s49, s48, 4096
    s_add_u32 m0, s55, 0
    s_nop 0
    buffer_load_dwordx4 v10, s[12:15], s48 offen offset:0 sc1 lds
    buffer_load_dwordx4 v10, s[12:15], s48 offen offset:1024 sc1 lds
    buffer_load_dwordx4 v10, s[12:15], s48 offen offset:2048 sc1 lds
    buffer_load_dwordx4 v10, s[12:15], s48 offen offset:3072 sc1 lds
    s_add_u32 m0, s55, 4096
    s_nop 0
    buffer_load_dwordx4 v10, s[12:15], s49 offen offset:0 sc1 lds
    buffer_load_dwordx4 v10, s[12:15], s49 offen offset:1024 sc1 lds
    buffer_load_dwordx4 v10, s[12:15], s49 offen offset:2048 sc1 lds
    buffer_load_dwordx4 v10, s[12:15], s49 offen offset:3072 sc1 lds
    s_waitcnt vmcnt(16)
    s_barrier
    ds_read_b128 v[32:35], v13 offset:0
    ds_read_b128 v[36:39], v13 offset:1024
    ds_read_b128 v[40:43], v13 offset:2048
    ds_read_b128 v[44:47], v13 offset:3072
L_e_loop_155:
    s_add_u32 s48, s53, 262144
    s_add_u32 s46, s58, 1
    s_cmp_lt_u32 s46, s51
    s_cselect_b32 s48, s48, 0x20000000
    s_cmp_lt_u32 s44, 3
    s_cselect_b32 s48, s48, 0x20000000
    s_add_u32 s49, s48, 4096
    s_add_u32 s59, s55, 32768
    s_waitcnt lgkmcnt(2)
    v_mfma_f32_16x16x32_bf16 v[80:83], a[0:3], v[32:35], 0
    ds_read_b128 v[48:51], v13 offset:4096
    ds_read_b128 v[52:55], v13 offset:5120
    v_mfma_f32_16x16x32_bf16 v[84:87], a[4:7], v[32:35], 0
    ds_read_b128 v[56:59], v13 offset:6144
    ds_read_b128 v[60:63], v13 offset:7168
    v_mfma_f32_16x16x32_bf16 v[88:91], a[0:3], v[36:39], 0
    s_add_u32 m0, s59, 0
    s_nop 0
    buffer_load_dwordx4 v10, s[12:15], s48 offen offset:0 sc1 lds
    v_mfma_f32_16x16x32_bf16 v[92:95], a[4:7], v[36:39], 0
    s_waitcnt lgkmcnt(4)
    v_mfma_f32_16x16x32_bf16 v[80:83], a[8:11], v[40:43], v[80:83]
    ds_read_b128 v[32:35], v13 offset:8192
    ds_read_b128 v[36:39], v13 offset:9216
    v_mfma_f32_16x16x32_bf16 v[84:87], a[12:15], v[40:43], v[84:87]
    v_mfma_f32_16x16x32_bf16 v[88:91], a[8:11], v[44:47], v[88:91]
    buffer_load_dwordx4 v10, s[12:15], s48 offen offset:1024 sc1 lds
    v_mfma_f32_16x16x32_bf16 v[92:95], a[12:15], v[44:47], v[92:95]
    s_waitcnt lgkmcnt(4)
    v_mfma_f32_16x16x32_bf16 v[80:83], a[16:19], v[48:51], v[80:83]
    ds_read_b128 v[40:43], v13 offset:10240
    ds_read_b128 v[44:47], v13 offset:11264
    v_mfma_f32_16x16x32_bf16 v[84:87], a[20:23], v[48:51], v[84:87]
    v_mfma_f32_16x16x32_bf16 v[88:91], a[16:19], v[52:55], v[88:91]
    buffer_load_dwordx4 v10, s[12:15], s48 offen offset:2048 sc1 lds
    v_mfma_f32_16x16x32_bf16 v[92:95], a[20:23], v[52:55], v[92:95]
    s_waitcnt lgkmcnt(4)
    v_mfma_f32_16x16x32_bf16 v[80:83], a[24:27], v[56:59], v[80:83]
    ds_read_b128 v[48:51], v13 offset:12288
    ds_read_b128 v[52:55], v13 offset:13312
    v_mfma_f32_16x16x32_bf16 v[84:87], a[28:31], v[56:59], v[84:87]
    v_mfma_f32_16x16x32_bf16 v[88:91], a[24:27], v[60:63], v[88:91]
    buffer_load_dwordx4 v10, s[12:15], s48 offen offset:3072 sc1 lds
    v_mfma_f32_16x16x32_bf16 v[92:95], a[28:31], v[60:63], v[92:95]
    s_waitcnt lgkmcnt(4)
    v_mfma_f32_16x16x32_bf16 v[80:83], a[32:35], v[32:35], v[80:83]
    ds_read_b128 v[56:59], v13 offset:14336
    ds_read_b128 v[60:63], v13 offset:15360
    v_mfma_f32_16x16x32_bf16 v[84:87], a[36:39], v[32:35], v[84:87]
    v_mfma_f32_16x16x32_bf16 v[88:91], a[32:35], v[36:39], v[88:91]
    s_add_u32 m0, s59, 4096
    s_nop 0
    buffer_load_dwordx4 v10, s[12:15], s49 offen offset:0 sc1 lds
    v_mfma_f32_16x16x32_bf16 v[92:95], a[36:39], v[36:39], v[92:95]
    s_waitcnt lgkmcnt(4)
    v_mfma_f32_16x16x32_bf16 v[80:83], a[40:43], v[40:43], v[80:83]
    ds_read_b128 v[32:35], v13 offset:16384
    ds_read_b128 v[36:39], v13 offset:17408
    v_mfma_f32_16x16x32_bf16 v[84:87], a[44:47], v[40:43], v[84:87]
    v_mfma_f32_16x16x32_bf16 v[88:91], a[40:43], v[44:47], v[88:91]
    buffer_load_dwordx4 v10, s[12:15], s49 offen offset:1024 sc1 lds
    v_mfma_f32_16x16x32_bf16 v[92:95], a[44:47], v[44:47], v[92:95]
    s_waitcnt lgkmcnt(4)
    v_mfma_f32_16x16x32_bf16 v[80:83], a[48:51], v[48:51], v[80:83]
    ds_read_b128 v[40:43], v13 offset:18432
    ds_read_b128 v[44:47], v13 offset:19456
    v_mfma_f32_16x16x32_bf16 v[84:87], a[52:55], v[48:51], v[84:87]
    v_mfma_f32_16x16x32_bf16 v[88:91], a[48:51], v[52:55], v[88:91]
    buffer_load_dwordx4 v10, s[12:15], s49 offen offset:2048 sc1 lds
    v_mfma_f32_16x16x32_bf16 v[92:95], a[52:55], v[52:55], v[92:95]
    s_waitcnt lgkmcnt(4)
    v_mfma_f32_16x16x32_bf16 v[80:83], a[56:59], v[56:59], v[80:83]
    ds_read_b128 v[48:51], v13 offset:20480
    ds_read_b128 v[52:55], v13 offset:21504
    v_mfma_f32_16x16x32_bf16 v[84:87], a[60:63], v[56:59], v[84:87]
    v_mfma_f32_16x16x32_bf16 v[88:91], a[56:59], v[60:63], v[88:91]
    buffer_load_dwordx4 v10, s[12:15], s49 offen offset:3072 sc1 lds
    v_mfma_f32_16x16x32_bf16 v[92:95], a[60:63], v[60:63], v[92:95]
    s_waitcnt lgkmcnt(4)
    v_mfma_f32_16x16x32_bf16 v[80:83], a[64:67], v[32:35], v[80:83]
    ds_read_b128 v[56:59], v13 offset:22528
    ds_read_b128 v[60:63], v13 offset:23552
    v_mfma_f32_16x16x32_bf16 v[84:87], a[68:71], v[32:35], v[84:87]
    v_mfma_f32_16x16x32_bf16 v[88:91], a[64:67], v[36:39], v[88:91]
    v_mfma_f32_16x16x32_bf16 v[92:95], a[68:71], v[36:39], v[92:95]
    s_waitcnt lgkmcnt(4)
    v_mfma_f32_16x16x32_bf16 v[80:83], a[72:75], v[40:43], v[80:83]
    ds_read_b128 v[32:35], v13 offset:24576
    ds_read_b128 v[36:39], v13 offset:25600
    v_mfma_f32_16x16x32_bf16 v[84:87], a[76:79], v[40:43], v[84:87]
    v_mfma_f32_16x16x32_bf16 v[88:91], a[72:75], v[44:47], v[88:91]
    v_mfma_f32_16x16x32_bf16 v[92:95], a[76:79], v[44:47], v[92:95]
    s_waitcnt lgkmcnt(4)
    v_mfma_f32_16x16x32_bf16 v[80:83], a[80:83], v[48:51], v[80:83]
    ds_read_b128 v[40:43], v13 offset:26624
    ds_read_b128 v[44:47], v13 offset:27648
    v_mfma_f32_16x16x32_bf16 v[84:87], a[84:87], v[48:51], v[84:87]
    v_mfma_f32_16x16x32_bf16 v[88:91], a[80:83], v[52:55], v[88:91]
    v_mfma_f32_16x16x32_bf16 v[92:95], a[84:87], v[52:55], v[92:95]
    s_waitcnt lgkmcnt(4)
    v_mfma_f32_16x16x32_bf16 v[80:83], a[88:91], v[56:59], v[80:83]
    ds_read_b128 v[48:51], v13 offset:28672
    ds_read_b128 v[52:55], v13 offset:29696
    v_mfma_f32_16x16x32_bf16 v[84:87], a[92:95], v[56:59], v[84:87]
    v_mfma_f32_16x16x32_bf16 v[88:91], a[88:91], v[60:63], v[88:91]
    v_mfma_f32_16x16x32_bf16 v[92:95], a[92:95], v[60:63], v[92:95]
    s_waitcnt lgkmcnt(4)
    v_mfma_f32_16x16x32_bf16 v[80:83], a[96:99], v[32:35], v[80:83]
    ds_read_b128 v[56:59], v13 offset:30720
    ds_read_b128 v[60:63], v13 offset:31744
    v_mfma_f32_16x16x32_bf16 v[84:87], a[100:103], v[32:35], v[84:87]
    v_mfma_f32_16x16x32_bf16 v[88:91], a[96:99], v[36:39], v[88:91]
    v_mfma_f32_16x16x32_bf16 v[92:95], a[100:103], v[36:39], v[92:95]
    s_waitcnt lgkmcnt(4)
    v_mfma_f32_16x16x32_bf16 v[80:83], a[104:107], v[40:43], v[80:83]
    ds_read_b128 v[216:219], v8 offset:0
    ds_read_b128 v[220:223], v8 offset:1152
    v_mfma_f32_16x16x32_bf16 v[84:87], a[108:111], v[40:43], v[84:87]
    ds_read_b128 v[224:227], v8 offset:2304
    ds_read_b128 v[228:231], v8 offset:3456
    v_mfma_f32_16x16x32_bf16 v[88:91], a[104:107], v[44:47], v[88:91]
    v_mfma_f32_16x16x32_bf16 v[92:95], a[108:111], v[44:47], v[92:95]
    s_waitcnt vmcnt(16) lgkmcnt(0)
    s_barrier
    v_mfma_f32_16x16x32_bf16 v[80:83], a[112:115], v[48:51], v[80:83]
    ds_read_b128 v[32:35], v13 offset:32768
    ds_read_b128 v[36:39], v13 offset:33792
    v_mfma_f32_16x16x32_bf16 v[84:87], a[116:119], v[48:51], v[84:87]
    buffer_store_dwordx4 v[216:219], v11, s[12:15], s76 offen sc1
    v_mfma_f32_16x16x32_bf16 v[88:91], a[112:115], v[52:55], v[88:91]
    s_add_u32 s76, s76, 32768
    v_mfma_f32_16x16x32_bf16 v[92:95], a[116:119], v[52:55], v[92:95]
    buffer_store_dwordx4 v[220:223], v11, s[12:15], s76 offen sc1
    v_mfma_f32_16x16x32_bf16 v[80:83], a[120:123], v[56:59], v[80:83]
    ds_read_b128 v[40:43], v13 offset:34816
    ds_read_b128 v[44:47], v13 offset:35840
    v_mfma_f32_16x16x32_bf16 v[84:87], a[124:127], v[56:59], v[84:87]
    s_add_u32 s76, s76, 32768
    v_mfma_f32_16x16x32_bf16 v[88:91], a[120:123], v[60:63], v[88:91]
    buffer_store_dwordx4 v[224:227], v11, s[12:15], s76 offen sc1
    v_mfma_f32_16x16x32_bf16 v[92:95], a[124:127], v[60:63], v[92:95]
    s_add_u32 s76, s76, 32768
    s_add_u32 s48, s53, 458752
    s_add_u32 s46, s58, 2
    s_cmp_lt_u32 s46, s51
    s_cselect_b32 s48, s48, 0x20000000
    s_add_u32 s49, s48, 4096
    s_mov_b32 s59, s54
    s_waitcnt lgkmcnt(2)
    v_mfma_f32_16x16x32_bf16 v[80:83], a[128:131], v[32:35], v[80:83]
    ds_read_b128 v[48:51], v13 offset:36864
    ds_read_b128 v[52:55], v13 offset:37888
    v_mfma_f32_16x16x32_bf16 v[84:87], a[132:135], v[32:35], v[84:87]
    ds_read_b128 v[56:59], v13 offset:38912
    ds_read_b128 v[60:63], v13 offset:39936
    v_mfma_f32_16x16x32_bf16 v[88:91], a[128:131], v[36:39], v[88:91]
    s_add_u32 m0, s59, 0
    s_nop 0
    buffer_load_dwordx4 v10, s[12:15], s48 offen offset:0 sc1 lds
    v_mfma_f32_16x16x32_bf16 v[92:95], a[132:135], v[36:39], v[92:95]
    buffer_store_dwordx4 v[228:231], v11, s[12:15], s76 offen sc1
    s_waitcnt lgkmcnt(4)
    v_mfma_f32_16x16x32_bf16 v[80:83], a[136:139], v[40:43], v[80:83]
    ds_read_b128 v[32:35], v13 offset:40960
    ds_read_b128 v[36:39], v13 offset:41984
    v_mfma_f32_16x16x32_bf16 v[84:87], a[140:143], v[40:43], v[84:87]
    v_mfma_f32_16x16x32_bf16 v[88:91], a[136:139], v[44:47], v[88:91]
    buffer_load_dwordx4 v10, s[12:15], s48 offen offset:1024 sc1 lds
    v_mfma_f32_16x16x32_bf16 v[92:95], a[140:143], v[44:47], v[92:95]
    s_waitcnt lgkmcnt(4)
    v_mfma_f32_16x16x32_bf16 v[80:83], a[144:147], v[48:51], v[80:83]
    ds_read_b128 v[40:43], v13 offset:43008
    ds_read_b128 v[44:47], v13 offset:44032
    v_mfma_f32_16x16x32_bf16 v[84:87], a[148:151], v[48:51], v[84:87]
    v_mfma_f32_16x16x32_bf16 v[88:91], a[144:147], v[52:55], v[88:91]
    buffer_load_dwordx4 v10, s[12:15], s48 offen offset:2048 sc1 lds
    v_mfma_f32_16x16x32_bf16 v[92:95], a[148:151], v[52:55], v[92:95]
    s_waitcnt lgkmcnt(4)
    v_mfma_f32_16x16x32_bf16 v[80:83], a[152:155], v[56:59], v[80:83]
    ds_read_b128 v[48:51], v13 offset:45056
    ds_read_b128 v[52:55], v13 offset:46080
    v_mfma_f32_16x16x32_bf16 v[84:87], a[156:159], v[56:59], v[84:87]
    v_mfma_f32_16x16x32_bf16 v[88:91], a[152:155], v[60:63], v[88:91]
    buffer_load_dwordx4 v10, s[12:15], s48 offen offset:3072 sc1 lds
    v_mfma_f32_16x16x32_bf16 v[92:95], a[156:159], v[60:63], v[92:95]
    s_waitcnt lgkmcnt(4)
    v_mfma_f32_16x16x32_bf16 v[80:83], a[160:163], v[32:35], v[80:83]
    ds_read_b128 v[56:59], v13 offset:47104
    ds_read_b128 v[60:63], v13 offset:48128
    v_mfma_f32_16x16x32_bf16 v[84:87], a[164:167], v[32:35], v[84:87]
    v_mfma_f32_16x16x32_bf16 v[88:91], a[160:163], v[36:39], v[88:91]
    s_add_u32 m0, s59, 4096
    s_nop 0
    buffer_load_dwordx4 v10, s[12:15], s49 offen offset:0 sc1 lds
    v_mfma_f32_16x16x32_bf16 v[92:95], a[164:167], v[36:39], v[92:95]
    s_waitcnt lgkmcnt(4)
    v_mfma_f32_16x16x32_bf16 v[80:83], a[168:171], v[40:43], v[80:83]
    ds_read_b128 v[32:35], v13 offset:49152
    ds_read_b128 v[36:39], v13 offset:50176
    v_mfma_f32_16x16x32_bf16 v[84:87], a[172:175], v[40:43], v[84:87]
    v_mfma_f32_16x16x32_bf16 v[88:91], a[168:171], v[44:47], v[88:91]
    buffer_load_dwordx4 v10, s[12:15], s49 offen offset:1024 sc1 lds
    v_mfma_f32_16x16x32_bf16 v[92:95], a[172:175], v[44:47], v[92:95]
    s_waitcnt lgkmcnt(4)
    v_mfma_f32_16x16x32_bf16 v[80:83], a[176:179], v[48:51], v[80:83]
    ds_read_b128 v[40:43], v13 offset:51200
    ds_read_b128 v[44:47], v13 offset:52224
    v_mfma_f32_16x16x32_bf16 v[84:87], a[180:183], v[48:51], v[84:87]
    v_mfma_f32_16x16x32_bf16 v[88:91], a[176:179], v[52:55], v[88:91]
    buffer_load_dwordx4 v10, s[12:15], s49 offen offset:2048 sc1 lds
    v_mfma_f32_16x16x32_bf16 v[92:95], a[180:183], v[52:55], v[92:95]
    s_waitcnt lgkmcnt(4)
    v_mfma_f32_16x16x32_bf16 v[80:83], a[184:187], v[56:59], v[80:83]
    ds_read_b128 v[48:51], v13 offset:53248
    ds_read_b128 v[52:55], v13 offset:54272
    v_mfma_f32_16x16x32_bf16 v[84:87], a[188:191], v[56:59], v[84:87]
    v_mfma_f32_16x16x32_bf16 v[88:91], a[184:187], v[60:63], v[88:91]
    buffer_load_dwordx4 v10, s[12:15], s49 offen offset:3072 sc1 lds
    v_mfma_f32_16x16x32_bf16 v[92:95], a[188:191], v[60:63], v[92:95]
    s_waitcnt lgkmcnt(4)
    v_mfma_f32_16x16x32_bf16 v[80:83], a[192:195], v[32:35], v[80:83]
    ds_read_b128 v[56:59], v13 offset:55296
    ds_read_b128 v[60:63], v13 offset:56320
    v_mfma_f32_16x16x32_bf16 v[84:87], a[196:199], v[32:35], v[84:87]
    v_mfma_f32_16x16x32_bf16 v[88:91], a[192:195], v[36:39], v[88:91]
    v_mfma_f32_16x16x32_bf16 v[92:95], a[196:199], v[36:39], v[92:95]
    s_waitcnt lgkmcnt(4)
    v_mfma_f32_16x16x32_bf16 v[80:83], a[200:203], v[40:43], v[80:83]
    v_mfma_f32_16x16x32_bf16 v[84:87], a[204:207], v[40:43], v[84:87]
    v_mfma_f32_16x16x32_bf16 v[88:91], a[200:203], v[44:47], v[88:91]
    v_mfma_f32_16x16x32_bf16 v[92:95], a[204:207], v[44:47], v[92:95]
    s_waitcnt vmcnt(16) lgkmcnt(0)
    s_barrier
    v_mfma_f32_16x16x32_bf16 v[80:83], a[208:211], v[48:51], v[80:83]
    ds_read_b128 v[32:35], v14 offset:0
    ds_read_b128 v[36:39], v14 offset:1024
    v_mfma_f32_16x16x32_bf16 v[84:87], a[212:215], v[48:51], v[84:87]
    v_mfma_f32_16x16x32_bf16 v[88:91], a[208:211], v[52:55], v[88:91]
    v_mfma_f32_16x16x32_bf16 v[92:95], a[212:215], v[52:55], v[92:95]
    v_mfma_f32_16x16x32_bf16 v[80:83], a[216:219], v[56:59], v[80:83]
    ds_read_b128 v[40:43], v14 offset:2048
    ds_read_b128 v[44:47], v14 offset:3072
    v_mfma_f32_16x16x32_bf16 v[84:87], a[220:223], v[56:59], v[84:87]
    v_mfma_f32_16x16x32_bf16 v[88:91], a[216:219], v[60:63], v[88:91]
    v_mfma_f32_16x16x32_bf16 v[92:95], a[220:223], v[60:63], v[92:95]
    s_add_u32 s53, s53, 229376
    s_add_u32 s58, s58, 1
    v_swap_b32 v13, v14
    s_xor_b32 s54, s54, 65536
    s_xor_b32 s55, s55, 65536
    s_mov_b32 s76, s57
    v_swap_b32 v15, v16
    s_add_u32 s57, s57, 131072
    ds_write_b128 v7, v[80:83] offset:0
    ds_write_b128 v7, v[84:87] offset:64
    ds_write_b128 v7, v[88:91] offset:2304
    ds_write_b128 v7, v[92:95] offset:2368
    s_cmp_lt_u32 s58, s51
    s_cbranch_scc1 L_e_loop_155
    s_waitcnt lgkmcnt(0)
    ds_read_b128 v[216:219], v8 offset:0
    ds_read_b128 v[220:223], v8 offset:1152
    ds_read_b128 v[224:227], v8 offset:2304
    ds_read_b128 v[228:231], v8 offset:3456
    s_waitcnt lgkmcnt(0)
    buffer_store_dwordx4 v[216:219], v11, s[12:15], s76 offen sc1
    s_add_u32 s76, s76, 32768
    buffer_store_dwordx4 v[220:223], v11, s[12:15], s76 offen sc1
    s_add_u32 s76, s76, 32768
    buffer_store_dwordx4 v[224:227], v11, s[12:15], s76 offen sc1
    s_add_u32 s76, s76, 32768
    buffer_store_dwordx4 v[228:231], v11, s[12:15], s76 offen sc1
    s_waitcnt vmcnt(0)
    s_barrier
    s_cmp_lg_u32 s44, 0
    s_cbranch_scc1 L_pub_156
    v_mov_b32 v30, s62
    v_mov_b32 v31, 0
    s_mov_b64 exec, 1
    buffer_store_dword v30, v31, s[12:15], s65 offen sc1
    s_mov_b64 exec, -1
L_pub_156:
    s_add_u32 s63, s50, s44
    s_lshl_b32 s63, s63, 5
    s_add_u32 s63, s63, s41
    s_lshl_b32 s47, s63, 11
    s_add_u32 s46, s47, 0x800000
    s_cmp_lt_u32 s44, s51
    s_cselect_b32 s46, s46, 0x20000000
    buffer_load_dwordx4 v[208:211], v10, s[12:15], s46 offen sc1
    buffer_load_dwordx4 v[212:215], v10, s[12:15], s46 offen offset:1024 sc1
    s_add_u32 s45, s64, 16384
    s_cmp_lg_u32 s44, 0
    s_cbranch_scc1 L_pw_157
    s_mov_b32 exec_hi, 0
    s_mov_b32 s70, 0
L_wp_158:
    buffer_load_dword v31, v5, s[12:15], s45 offen sc1
    s_add_u32 s70, s70, 1
    s_cmp_ge_u32 s70, 0x200000
    s_cbranch_scc1 L_w_done_102
    s_waitcnt vmcnt(0)
    v_cmp_gt_u32 vcc, s62, v31
    s_nop 1
    s_cbranch_vccz L_wp_158_ok
    s_sleep 1
    s_branch L_wp_158
L_wp_158_ok:
    s_mov_b64 exec, -1
L_pw_157:
    s_barrier
    s_cmp_ge_u32 s44, s51
    s_cbranch_scc1 L_c_loop_151
    s_lshl_b32 s45, s63, 12
    s_add_u32 s45, s45, 0xc000000
    v_lshlrev_b32 v29, 5, v1
    buffer_load_dwordx4 v[64:67], v29, s[12:15], s45 offen offset:0 sc1
    buffer_load_dwordx4 v[68:71], v29, s[12:15], s45 offen offset:16 sc1
    buffer_load_dwordx4 v[72:75], v29, s[12:15], s45 offen offset:2048 sc1
    buffer_load_dwordx4 v[76:79], v29, s[12:15], s45 offen offset:2064 sc1
    s_add_u32 s45, s45, 0x800000
    buffer_load_dwordx4 v[160:163], v29, s[12:15], s45 offen offset:0 sc1
    buffer_load_dwordx4 v[164:167], v29, s[12:15], s45 offen offset:16 sc1
    buffer_load_dwordx4 v[168:171], v29, s[12:15], s45 offen offset:2048 sc1
    buffer_load_dwordx4 v[172:175], v29, s[12:15], s45 offen offset:2064 sc1
    s_add_u32 s45, s45, 0x800000
    buffer_load_dwordx4 v[176:179], v29, s[12:15], s45 offen offset:0 sc1
    buffer_load_dwordx4 v[180:183], v29, s[12:15], s45 offen offset:16 sc1
    buffer_load_dwordx4 v[184:187], v29, s[12:15], s45 offen offset:2048 sc1
    buffer_load_dwordx4 v[188:191], v29, s[12:15], s45 offen offset:2064 sc1
    s_add_u32 s45, s45, 0x800000
    buffer_load_dwordx4 v[192:195], v29, s[12:15], s45 offen offset:0 sc1
    buffer_load_dwordx4 v[196:199], v29, s[12:15], s45 offen offset:16 sc1
    buffer_load_dwordx4 v[200:203], v29, s[12:15], s45 offen offset:2048 sc1
    buffer_load_dwordx4 v[204:207], v29, s[12:15], s45 offen offset:2064 sc1
    s_waitcnt vmcnt(0)
    v_pk_add_f32 v[64:65], v[64:65], v[160:161]
    v_pk_add_f32 v[176:177], v[176:177], v[192:193]
    v_pk_add_f32 v[66:67], v[66:67], v[162:163]
    v_pk_add_f32 v[178:179], v[178:179], v[194:195]
    v_pk_add_f32 v[68:69], v[68:69], v[164:165]
    v_pk_add_f32 v[180:181], v[180:181], v[196:197]
    v_pk_add_f32 v[70:71], v[70:71], v[166:167]
    v_pk_add_f32 v[182:183], v[182:183], v[198:199]
    v_pk_add_f32 v[72:73], v[72:73], v[168:169]
    v_pk_add_f32 v[184:185], v[184:185], v[200:201]
    v_pk_add_f32 v[74:75], v[74:75], v[170:171]
    v_pk_add_f32 v[186:187], v[186:187], v[202:203]
    v_pk_add_f32 v[76:77], v[76:77], v[172:173]
    v_pk_add_f32 v[188:189], v[188:189], v[204:205]
    v_pk_add_f32 v[78:79], v[78:79], v[174:175]
    v_pk_add_f32 v[190:191], v[190:191], v[206:207]
    v_pk_add_f32 v[64:65], v[64:65], v[176:177]
    v_pk_add_f32 v[66:67], v[66:67], v[178:179]
    v_pk_add_f32 v[68:69], v[68:69], v[180:181]
    v_pk_add_f32 v[70:71], v[70:71], v[182:183]
    v_pk_add_f32 v[72:73], v[72:73], v[184:185]
    v_pk_add_f32 v[74:75], v[74:75], v[186:187]
    v_pk_add_f32 v[76:77], v[76:77], v[188:189]
    v_pk_add_f32 v[78:79], v[78:79], v[190:191]
    v_cvt_pk_bf16_f32 v64, v64, v64
    v_lshlrev_b32 v64, 16, v64
    v_cvt_pk_bf16_f32 v65, v65, v65
    v_lshlrev_b32 v65, 16, v65
    v_cvt_pk_bf16_f32 v66, v66, v66
    v_lshlrev_b32 v66, 16, v66
    v_cvt_pk_bf16_f32 v67, v67, v67
    v_lshlrev_b32 v67, 16, v67
    v_cvt_pk_bf16_f32 v68, v68, v68
    v_lshlrev_b32 v68, 16, v68
    v_cvt_pk_bf16_f32 v69, v69, v69
    v_lshlrev_b32 v69, 16, v69
    v_cvt_pk_bf16_f32 v70, v70, v70
    v_lshlrev_b32 v70, 16, v70
    v_cvt_pk_bf16_f32 v71, v71, v71
    v_lshlrev_b32 v71, 16, v71
    v_cvt_pk_bf16_f32 v72, v72, v72
    v_lshlrev_b32 v72, 16, v72
    v_cvt_pk_bf16_f32 v73, v73, v73
    v_lshlrev_b32 v73, 16, v73
    v_cvt_pk_bf16_f32 v74, v74, v74
    v_lshlrev_b32 v74, 16, v74
    v_cvt_pk_bf16_f32 v75, v75, v75
    v_lshlrev_b32 v75, 16, v75
    v_cvt_pk_bf16_f32 v76, v76, v76
    v_lshlrev_b32 v76, 16, v76
    v_cvt_pk_bf16_f32 v77, v77, v77
    v_lshlrev_b32 v77, 16, v77
    v_cvt_pk_bf16_f32 v78, v78, v78
    v_lshlrev_b32 v78, 16, v78
    v_cvt_pk_bf16_f32 v79, v79, v79
    v_lshlrev_b32 v79, 16, v79
    v_lshlrev_b32 v160, 16, v208
    v_and_b32 v161, 0xffff0000, v208
    v_lshlrev_b32 v162, 16, v209
    v_and_b32 v163, 0xffff0000, v209
    v_lshlrev_b32 v164, 16, v210
    v_and_b32 v165, 0xffff0000, v210
    v_lshlrev_b32 v166, 16, v211
    v_and_b32 v167, 0xffff0000, v211
    v_lshlrev_b32 v168, 16, v212
    v_and_b32 v169, 0xffff0000, v212
    v_lshlrev_b32 v170, 16, v213
    v_and_b32 v171, 0xffff0000, v213
    v_lshlrev_b32 v172, 16, v214
    v_and_b32 v173, 0xffff0000, v214
    v_lshlrev_b32 v174, 16, v215
    v_and_b32 v175, 0xffff0000, v215
    v_add_f32 v64, v64, v96
    v_cvt_pk_bf16_f32 v64, v64, v64
    v_lshlrev_b32 v64, 16, v64
    v_mul_f32 v64, v64, v112
    v_cvt_pk_bf16_f32 v64, v64, v64
    v_lshlrev_b32 v64, 16, v64
    v_add_f32 v64, v64, v160
    v_add_f32 v65, v65, v97
    v_cvt_pk_bf16_f32 v65, v65, v65
    v_lshlrev_b32 v65, 16, v65
    v_mul_f32 v65, v65, v113
    v_cvt_pk_bf16_f32 v65, v65, v65
    v_lshlrev_b32 v65, 16, v65
    v_add_f32 v65, v65, v161
    v_add_f32 v66, v66, v98
    v_cvt_pk_bf16_f32 v66, v66, v66
    v_lshlrev_b32 v66, 16, v66
    v_mul_f32 v66, v66, v114
    v_cvt_pk_bf16_f32 v66, v66, v66
    v_lshlrev_b32 v66, 16, v66
    v_add_f32 v66, v66, v162
    v_add_f32 v67, v67, v99
    v_cvt_pk_bf16_f32 v67, v67, v67
    v_lshlrev_b32 v67, 16, v67
    v_mul_f32 v67, v67, v115
    v_cvt_pk_bf16_f32 v67, v67, v67
    v_lshlrev_b32 v67, 16, v67
    v_add_f32 v67, v67, v163
    v_add_f32 v68, v68, v100
    v_cvt_pk_bf16_f32 v68, v68, v68
    v_lshlrev_b32 v68, 16, v68
    v_mul_f32 v68, v68, v116
    v_cvt_pk_bf16_f32 v68, v68, v68
    v_lshlrev_b32 v68, 16, v68
    v_add_f32 v68, v68, v164
    v_add_f32 v69, v69, v101
    v_cvt_pk_bf16_f32 v69, v69, v69
    v_lshlrev_b32 v69, 16, v69
    v_mul_f32 v69, v69, v117
    v_cvt_pk_bf16_f32 v69, v69, v69
    v_lshlrev_b32 v69, 16, v69
    v_add_f32 v69, v69, v165
    v_add_f32 v70, v70, v102
    v_cvt_pk_bf16_f32 v70, v70, v70
    v_lshlrev_b32 v70, 16, v70
    v_mul_f32 v70, v70, v118
    v_cvt_pk_bf16_f32 v70, v70, v70
    v_lshlrev_b32 v70, 16, v70
    v_add_f32 v70, v70, v166
    v_add_f32 v71, v71, v103
    v_cvt_pk_bf16_f32 v71, v71, v71
    v_lshlrev_b32 v71, 16, v71
    v_mul_f32 v71, v71, v119
    v_cvt_pk_bf16_f32 v71, v71, v71
    v_lshlrev_b32 v71, 16, v71
    v_add_f32 v71, v71, v167
    v_add_f32 v72, v72, v104
    v_cvt_pk_bf16_f32 v72, v72, v72
    v_lshlrev_b32 v72, 16, v72
    v_mul_f32 v72, v72, v120
    v_cvt_pk_bf16_f32 v72, v72, v72
    v_lshlrev_b32 v72, 16, v72
    v_add_f32 v72, v72, v168
    v_add_f32 v73, v73, v105
    v_cvt_pk_bf16_f32 v73, v73, v73
    v_lshlrev_b32 v73, 16, v73
    v_mul_f32 v73, v73, v121
    v_cvt_pk_bf16_f32 v73, v73, v73
    v_lshlrev_b32 v73, 16, v73
    v_add_f32 v73, v73, v169
    v_add_f32 v74, v74, v106
    v_cvt_pk_bf16_f32 v74, v74, v74
    v_lshlrev_b32 v74, 16, v74
    v_mul_f32 v74, v74, v122
    v_cvt_pk_bf16_f32 v74, v74, v74
    v_lshlrev_b32 v74, 16, v74
    v_add_f32 v74, v74, v170
    v_add_f32 v75, v75, v107
    v_cvt_pk_bf16_f32 v75, v75, v75
    v_lshlrev_b32 v75, 16, v75
    v_mul_f32 v75, v75, v123
    v_cvt_pk_bf16_f32 v75, v75, v75
    v_lshlrev_b32 v75, 16, v75
    v_add_f32 v75, v75, v171
    v_add_f32 v76, v76, v108
    v_cvt_pk_bf16_f32 v76, v76, v76
    v_lshlrev_b32 v76, 16, v76
    v_mul_f32 v76, v76, v124
    v_cvt_pk_bf16_f32 v76, v76, v76
    v_lshlrev_b32 v76, 16, v76
    v_add_f32 v76, v76, v172
    v_add_f32 v77, v77, v109
    v_cvt_pk_bf16_f32 v77, v77, v77
    v_lshlrev_b32 v77, 16, v77
    v_mul_f32 v77, v77, v125
    v_cvt_pk_bf16_f32 v77, v77, v77
    v_lshlrev_b32 v77, 16, v77
    v_add_f32 v77, v77, v173
    v_add_f32 v78, v78, v110
    v_cvt_pk_bf16_f32 v78, v78, v78
    v_lshlrev_b32 v78, 16, v78
    v_mul_f32 v78, v78, v126
    v_cvt_pk_bf16_f32 v78, v78, v78
    v_lshlrev_b32 v78, 16, v78
    v_add_f32 v78, v78, v174
    v_add_f32 v79, v79, v111
    v_cvt_pk_bf16_f32 v79, v79, v79
    v_lshlrev_b32 v79, 16, v79
    v_mul_f32 v79, v79, v127
    v_cvt_pk_bf16_f32 v79, v79, v79
    v_lshlrev_b32 v79, 16, v79
    v_add_f32 v79, v79, v175
    v_cvt_pk_bf16_f32 v208, v64, v65
    v_cvt_pk_bf16_f32 v209, v66, v67
    v_cvt_pk_bf16_f32 v210, v68, v69
    v_cvt_pk_bf16_f32 v211, v70, v71
    v_cvt_pk_bf16_f32 v212, v72, v73
    v_cvt_pk_bf16_f32 v213, v74, v75
    v_cvt_pk_bf16_f32 v214, v76, v77
    v_cvt_pk_bf16_f32 v215, v78, v79
    buffer_store_dwordx4 v[208:211], v10, s[32:35], s47 offen
    buffer_store_dwordx4 v[212:215], v10, s[32:35], s47 offen offset:1024
    s_branch L_c_loop_151
L_w_done_102:
    s_endpgm
.section .rodata,"a"
.p2align 6
.amdhsa_kernel adaLN_cond__memory_aug_recurrent_mem_tr__dense_activation_gelu__prompt_kernel
  .amdhsa_next_free_vgpr 512
  .amdhsa_next_free_sgpr 102
  .amdhsa_accum_offset 256
  .amdhsa_group_segment_fixed_size 0
  .amdhsa_kernarg_size 136
  .amdhsa_user_sgpr_count 2
  .amdhsa_user_sgpr_kernarg_segment_ptr 1
  .amdhsa_system_sgpr_workgroup_id_x 1
.end_amdhsa_kernel
```

```asm
; @launch kernel=adaLN_cond__memory_aug_recurrent_mem_tr__dense_activation_gelu__prompt_kernel grid=(256,1,1) block=(256,1,1) lds=163840
.amdgcn_target "amdgcn-amd-amdhsa--gfx950"
.text
.globl adaLN_cond__memory_aug_recurrent_mem_tr__dense_activation_gelu__prompt_kernel
.p2align 8
.type adaLN_cond__memory_aug_recurrent_mem_tr__dense_activation_gelu__prompt_kernel,@function
adaLN_cond__memory_aug_recurrent_mem_tr__dense_activation_gelu__prompt_kernel:
    s_cmp_lt_u32 s2, 256
    s_cbranch_scc1 L_c_done_1_go
    s_endpgm
L_c_done_1_go:
    s_and_b32 s40, s2, 7
    s_load_dwordx4 s[4:7], s[0:1], 16
    s_load_dwordx4 s[8:11], s[0:1], 32
    s_load_dwordx2 s[20:21], s[0:1], 128
    s_load_dwordx2 s[22:23], s[0:1], 120
    s_load_dwordx2 s[50:51], s[0:1], 8
    s_lshr_b32 s41, s2, 3
    s_and_b32 s42, s41, 15
    v_and_b32 v1, 63, v0
    v_lshrrev_b32 v2, 6, v0
    s_nop 0
    v_readfirstlane_b32 s44, v2
    s_waitcnt lgkmcnt(0)
    s_mov_b32 s24, s4
    s_and_b32 s25, s5, 0xffff
    s_mov_b32 s26, 0x800000
    s_mov_b32 s27, 0x00020000
    s_mov_b32 s28, s6
    s_and_b32 s29, s7, 0xffff
    s_mov_b32 s30, 0x800000
    s_mov_b32 s31, 0x00020000
    s_mov_b32 s32, s8
    s_and_b32 s33, s9, 0xffff
    s_mov_b32 s34, 0x800000
    s_mov_b32 s35, 0x00020000
    s_mov_b32 s36, s10
    s_and_b32 s37, s11, 0xffff
    s_mov_b32 s38, 0x800000
    s_mov_b32 s39, 0x00020000
    s_mov_b32 s12, s20
    s_and_b32 s13, s21, 0xffff
    s_mov_b32 s14, 0x10000000
    s_mov_b32 s15, 0x00020000
    s_mov_b32 s16, s22
    s_and_b32 s17, s23, 0xffff
    s_mov_b32 s18, 0x100
    s_mov_b32 s19, 0x00020000
    s_mov_b32 s52, s50
    s_and_b32 s53, s51, 0xffff
    s_mov_b32 s54, 0x4000
    s_mov_b32 s55, 0x00020000
    v_mov_b32 v41, 0
    s_cmp_lg_u32 s2, 1
    s_cbranch_scc1 L_worker_3_a
    s_getreg_b32 s45, hwreg(HW_REG_XCC_ID)
    s_and_b32 s45, s45, 1
    s_add_u32 s45, s45, 1
    v_mov_b32 v40, s45
    buffer_store_dword v40, v41, s[16:19], 0 offen offset:24 sc1
L_worker_3_a:
    s_cmp_eq_u32 s40, 1
    s_cbranch_scc1 L_worker_3_g0
    s_cmp_lt_u32 s40, 3
    s_cbranch_scc1 L_worker_3_q
    s_sub_u32 s40, s40, 2
    s_branch L_worker_3
L_worker_3_q:
    s_mov_b32 s70, 0
L_worker_3_p:
    buffer_load_dword v40, v41, s[16:19], 0 offen offset:24 sc1
    s_add_u32 s70, s70, 1
    s_cmp_ge_u32 s70, 0x200000
    s_cbranch_scc1 L_c_done_1
    s_waitcnt vmcnt(0)
    v_readfirstlane_b32 s45, v40
    s_nop 3
    s_cmp_eq_u32 s45, 0
    s_cbranch_scc1 L_worker_3_p
    s_and_b32 s45, s45, 2
    s_cmp_lg_u32 s45, s40
    s_mov_b32 s40, 1
    s_cbranch_scc1 L_worker_3_no
    s_mov_b32 s40, 0
    s_branch L_worker_3
L_worker_3_g0:
    s_mov_b32 s40, 0
L_worker_3_no:
    s_lshl_b32 s43, s40, 4
    s_add_u32 s43, s43, s42
    s_lshl_b32 s3, s43, 7
    s_lshr_b32 s45, s41, 4
    s_lshl_b32 s45, s45, 4
    s_add_u32 s3, s3, s45
    s_lshl_b32 s45, s44, 2
    s_add_u32 s3, s3, s45
    s_add_u32 s3, s3, 0x11000
    v_mov_b32 v40, 0
    s_mov_b64 exec, 1
    buffer_store_dword v40, v40, s[12:15], s3 offen sc1
    s_mov_b64 exec, -1
    v_and_b32 v21, 8, v1
    v_cmp_eq_u32 s[56:57], 0, v21
    v_mov_b32 v2, 0xeeee
    v_mov_b32 v3, 0x4444
    v_cndmask_b32 v2, v2, v3, s[56:57]
    v_lshlrev_b32 v68, 4, v1
    s_lshl_b32 s45, s44, 12
    v_add_u32 v3, s45, v68
    v_add_u32 v4, 4096, v3
    v_and_b32 v4, 16383, v4
    v_add_u32 v21, 8192, v3
    v_and_b32 v21, 16383, v21
    v_add_u32 v23, 12288, v3
    v_and_b32 v23, 16383, v23
    s_mul_i32 s45, s44, 24576
    s_add_u32 s45, s45, 65536
    v_add_u32 v5, s45, v68
    v_lshrrev_b32 v63, 4, v1
    s_lshl_b32 s45, s44, 2
    v_add_u32 v64, s45, v63
    s_lshr_b32 s45, s44, 1
    s_lshl_b32 s45, s45, 2
    v_add_u32 v65, s45, v63
    v_bfe_u32 v66, v1, 1, 3
    v_xor_b32 v66, v66, v65
    v_lshlrev_b32 v66, 5, v66
    v_and_b32 v67, 1, v1
    v_lshlrev_b32 v67, 4, v67
    v_add_u32 v66, v66, v67
    v_lshlrev_b32 v64, 13, v64
    v_add_u32 v82, v64, v66
    s_lshl_b32 s47, s43, 8
    s_lshl_b32 s48, s44, 10
    v_bfe_u32 v64, v1, 2, 2
    v_bfe_u32 v65, v1, 4, 1
    v_lshlrev_b32 v65, 2, v65
    v_add_u32 v65, v65, v64
    v_lshlrev_b32 v66, 3, v63
    v_add_u32 v66, v66, v64
    v_lshlrev_b32 v66, 8, v66
    v_and_b32 v67, 3, v1
    v_lshlrev_b32 v67, 3, v67
    v_add_u32 v66, v66, v67
    s_lshl_b32 s45, s44, 1
    v_xor_b32 v65, s45, v65
    v_lshlrev_b32 v65, 5, v65
    v_add_u32 v80, v66, v65
    v_xor_b32 v81, 32, v80
    v_lshrrev_b32 v64, 5, v1
    v_mul_u32_u24 v64, 20480, v64
    v_add_u32 v64, 65536, v64
    v_add_u32 v84, v64, v80
    v_add_u32 v85, v64, v81
    v_add_u32 v86, 49152, v84
    v_add_u32 v87, 49152, v85
    v_mov_b32 v40, -1
    v_mov_b32 v41, -1
    v_mov_b32 v42, -1
    v_mov_b32 v43, -1
    v_mov_b32 v44, 0
    s_mov_b32 s68, 0
    s_cmp_ge_u32 s41, 16
    s_cbranch_scc1 L_c_vo_2
    s_lshl_b32 s45, s42, 11
    s_lshr_b32 s46, s44, 1
    s_lshl_b32 s46, s46, 10
    s_add_u32 s45, s45, s46
    s_and_b32 s46, s44, 1
    s_lshl_b32 s46, s46, 7
    s_add_u32 s45, s45, s46
    v_add_u32 v17, s45, v68
    v_mov_b32 v63, 0x20000000
    v_cndmask_b32 v17, v63, v17, s[56:57]
    s_lshl_b32 s62, s40, 17
    s_add_u32 s62, s62, 0x7040000
    s_add_u32 s63, s62, 0
    buffer_store_dwordx4 v[40:43], v17, s[12:15], s63 offen sc1
    s_add_u32 s63, s62, 32768
    buffer_store_dwordx4 v[40:43], v17, s[12:15], s63 offen sc1
    s_add_u32 s63, s62, 65536
    buffer_store_dwordx4 v[40:43], v17, s[12:15], s63 offen sc1
    s_add_u32 s63, s62, 98304
    buffer_store_dwordx4 v[40:43], v17, s[12:15], s63 offen sc1
    s_mov_b64 exec, -1
    s_lshl_b32 s45, s40, 11
    s_lshl_b32 s46, s42, 2
    s_add_u32 s45, s45, s46
    s_add_u32 s45, s45, 0x7080000
    s_lshl_b32 s46, s44, 9
    s_add_u32 s45, s45, s46
    v_lshlrev_b32 v20, 7, v1
    v_add_u32 v20, s45, v20
    v_cmp_gt_u32 vcc, 4, v1
    s_nop 1
    v_cndmask_b32 v20, v63, v20, vcc
    buffer_store_dword v44, v20, s[12:15], 0 offen sc1
    s_add_u32 s79, s41, 0
    s_and_b32 s79, s79, 3
    s_lshl_b32 s79, s79, 19
    s_add_u32 s79, s79, s47
    s_add_u32 s46, s79, 0x0
    s_add_u32 m0, s48, 73728
    s_nop 0
    buffer_load_dwordx4 v82, s[24:27], s46 offen  lds
    s_add_u32 s46, s79, 0x20000
    s_add_u32 m0, s48, 98304
    s_nop 0
    buffer_load_dwordx4 v82, s[24:27], s46 offen  lds
    s_add_u32 s46, s79, 0x40000
    s_add_u32 m0, s48, 122880
    s_nop 0
    buffer_load_dwordx4 v82, s[24:27], s46 offen  lds
    s_add_u32 s46, s79, 0x60000
    s_add_u32 m0, s48, 147456
    s_nop 0
    buffer_load_dwordx4 v82, s[24:27], s46 offen  lds
    s_add_u32 s79, s41, 1
    s_and_b32 s79, s79, 3
    s_lshl_b32 s79, s79, 19
    s_add_u32 s79, s79, s47
    s_add_u32 s46, s79, 0x0
    s_add_u32 m0, s48, 77824
    s_nop 0
    buffer_load_dwordx4 v82, s[24:27], s46 offen  lds
    s_add_u32 s46, s79, 0x20000
    s_add_u32 m0, s48, 102400
    s_nop 0
    buffer_load_dwordx4 v82, s[24:27], s46 offen  lds
    s_add_u32 s46, s79, 0x40000
    s_add_u32 m0, s48, 126976
    s_nop 0
    buffer_load_dwordx4 v82, s[24:27], s46 offen  lds
    s_add_u32 s46, s79, 0x60000
    s_add_u32 m0, s48, 151552
    s_nop 0
    buffer_load_dwordx4 v82, s[24:27], s46 offen  lds
    s_add_u32 s79, s41, 2
    s_and_b32 s79, s79, 3
    s_lshl_b32 s79, s79, 19
    s_add_u32 s79, s79, s47
    s_add_u32 s46, s79, 0x0
    s_add_u32 m0, s48, 81920
    s_nop 0
    buffer_load_dwordx4 v82, s[24:27], s46 offen  lds
    s_add_u32 s46, s79, 0x20000
    s_add_u32 m0, s48, 106496
    s_nop 0
    buffer_load_dwordx4 v82, s[24:27], s46 offen  lds
    s_add_u32 s46, s79, 0x40000
    s_add_u32 m0, s48, 131072
    s_nop 0
    buffer_load_dwordx4 v82, s[24:27], s46 offen  lds
    s_add_u32 s46, s79, 0x60000
    s_add_u32 m0, s48, 155648
    s_nop 0
    buffer_load_dwordx4 v82, s[24:27], s46 offen  lds
    s_add_u32 s79, s41, 3
    s_and_b32 s79, s79, 3
    s_lshl_b32 s79, s79, 19
    s_add_u32 s79, s79, s47
    s_add_u32 s46, s79, 0x0
    s_add_u32 m0, s48, 86016
    s_nop 0
    buffer_load_dwordx4 v82, s[24:27], s46 offen  lds
    s_add_u32 s46, s79, 0x20000
    s_add_u32 m0, s48, 110592
    s_nop 0
    buffer_load_dwordx4 v82, s[24:27], s46 offen  lds
    s_add_u32 s46, s79, 0x40000
    s_add_u32 m0, s48, 135168
    s_nop 0
    buffer_load_dwordx4 v82, s[24:27], s46 offen  lds
    s_add_u32 s46, s79, 0x60000
    s_add_u32 m0, s48, 159744
    s_nop 0
    buffer_load_dwordx4 v82, s[24:27], s46 offen  lds
    s_add_u32 s79, s41, 4
    s_and_b32 s79, s79, 3
    s_lshl_b32 s79, s79, 19
    s_add_u32 s79, s79, s47
    s_add_u32 s46, s79, 0x200000
    s_add_u32 m0, s48, 0
    s_nop 0
    buffer_load_dwordx4 v82, s[24:27], s46 offen  lds
    s_add_u32 s46, s79, 0x220000
    s_add_u32 m0, s48, 4096
    s_nop 0
    buffer_load_dwordx4 v82, s[24:27], s46 offen  lds
    s_add_u32 s46, s79, 0x240000
    s_add_u32 m0, s48, 8192
    s_nop 0
    buffer_load_dwordx4 v82, s[24:27], s46 offen  lds
    s_add_u32 s46, s79, 0x260000
    s_add_u32 m0, s48, 12288
    s_nop 0
    buffer_load_dwordx4 v82, s[24:27], s46 offen  lds
    s_add_u32 s79, s41, 5
    s_and_b32 s79, s79, 3
    s_lshl_b32 s79, s79, 19
    s_add_u32 s79, s79, s47
    s_add_u32 s46, s79, 0x200000
    s_add_u32 m0, s48, 16384
    s_nop 0
    buffer_load_dwordx4 v82, s[24:27], s46 offen  lds
    s_add_u32 s46, s79, 0x220000
    s_add_u32 m0, s48, 20480
    s_nop 0
    buffer_load_dwordx4 v82, s[24:27], s46 offen  lds
    s_add_u32 s46, s79, 0x240000
    s_add_u32 m0, s48, 24576
    s_nop 0
    buffer_load_dwordx4 v82, s[24:27], s46 offen  lds
    s_add_u32 s46, s79, 0x260000
    s_add_u32 m0, s48, 28672
    s_nop 0
    buffer_load_dwordx4 v82, s[24:27], s46 offen  lds
    s_add_u32 s79, s41, 6
    s_and_b32 s79, s79, 3
    s_lshl_b32 s79, s79, 19
    s_add_u32 s79, s79, s47
    s_add_u32 s46, s79, 0x200000
    s_add_u32 m0, s48, 32768
    s_nop 0
    buffer_load_dwordx4 v82, s[24:27], s46 offen  lds
    s_add_u32 s46, s79, 0x220000
    s_add_u32 m0, s48, 36864
    s_nop 0
    buffer_load_dwordx4 v82, s[24:27], s46 offen  lds
    s_add_u32 s46, s79, 0x240000
    s_add_u32 m0, s48, 40960
    s_nop 0
    buffer_load_dwordx4 v82, s[24:27], s46 offen  lds
    s_add_u32 s46, s79, 0x260000
    s_add_u32 m0, s48, 45056
    s_nop 0
    buffer_load_dwordx4 v82, s[24:27], s46 offen  lds
    s_add_u32 s79, s41, 7
    s_and_b32 s79, s79, 3
    s_lshl_b32 s79, s79, 19
    s_add_u32 s79, s79, s47
    s_add_u32 s46, s79, 0x200000
    s_add_u32 m0, s48, 49152
    s_nop 0
    buffer_load_dwordx4 v82, s[24:27], s46 offen  lds
    s_add_u32 s46, s79, 0x220000
    s_add_u32 m0, s48, 53248
    s_nop 0
    buffer_load_dwordx4 v82, s[24:27], s46 offen  lds
    s_add_u32 s46, s79, 0x240000
    s_add_u32 m0, s48, 57344
    s_nop 0
    buffer_load_dwordx4 v82, s[24:27], s46 offen  lds
    s_add_u32 s46, s79, 0x260000
    s_add_u32 m0, s48, 61440
    s_nop 0
    buffer_load_dwordx4 v82, s[24:27], s46 offen  lds
    s_waitcnt vmcnt(28)
    s_barrier
    s_cmp_lg_u32 s44, 0
    s_cbranch_scc1 L_lw_4_0
    ds_read_b64_tr_b16 a[0:1], v84 offset:8192
    ds_read_b64_tr_b16 a[2:3], v84 offset:9216
    ds_read_b64_tr_b16 a[4:5], v86 offset:8192
    ds_read_b64_tr_b16 a[6:7], v86 offset:9216
    ds_read_b64_tr_b16 a[8:9], v85 offset:8192
    ds_read_b64_tr_b16 a[10:11], v85 offset:9216
    ds_read_b64_tr_b16 a[12:13], v87 offset:8192
    ds_read_b64_tr_b16 a[14:15], v87 offset:9216
    s_branch L_lw_4
L_lw_4_0:
    s_cmp_lg_u32 s44, 1
    s_cbranch_scc1 L_lw_4_1
    ds_read_b64_tr_b16 v[160:161], v84 offset:8192
    ds_read_b64_tr_b16 v[162:163], v84 offset:9216
    ds_read_b64_tr_b16 v[164:165], v86 offset:8192
    ds_read_b64_tr_b16 v[166:167], v86 offset:9216
    ds_read_b64_tr_b16 v[56:57], v85 offset:8192
    ds_read_b64_tr_b16 v[58:59], v85 offset:9216
    ds_read_b64_tr_b16 v[60:61], v87 offset:8192
    ds_read_b64_tr_b16 v[62:63], v87 offset:9216
    s_waitcnt lgkmcnt(0)
    ds_write_b128 v5, v[56:59] offset:0
    ds_write_b128 v5, v[60:63] offset:1024
    s_branch L_lw_4
L_lw_4_1:
    s_cmp_lg_u32 s44, 2
    s_cbranch_scc1 L_lw_4_2
    ds_read_b64_tr_b16 a[208:209], v84 offset:8192
    ds_read_b64_tr_b16 a[210:211], v84 offset:9216
    ds_read_b64_tr_b16 a[212:213], v86 offset:8192
    ds_read_b64_tr_b16 a[214:215], v86 offset:9216
    ds_read_b64_tr_b16 v[56:57], v85 offset:8192
    ds_read_b64_tr_b16 v[58:59], v85 offset:9216
    ds_read_b64_tr_b16 v[60:61], v87 offset:8192
    ds_read_b64_tr_b16 v[62:63], v87 offset:9216
    s_waitcnt lgkmcnt(0)
    ds_write_b128 v5, v[56:59] offset:2048
    ds_write_b128 v5, v[60:63] offset:3072
    s_branch L_lw_4
L_lw_4_2:
    ds_read_b64_tr_b16 a[104:105], v84 offset:8192
    ds_read_b64_tr_b16 a[106:107], v84 offset:9216
    ds_read_b64_tr_b16 a[108:109], v86 offset:8192
    ds_read_b64_tr_b16 a[110:111], v86 offset:9216
    ds_read_b64_tr_b16 v[56:57], v85 offset:8192
    ds_read_b64_tr_b16 v[58:59], v85 offset:9216
    ds_read_b64_tr_b16 v[60:61], v87 offset:8192
    ds_read_b64_tr_b16 v[62:63], v87 offset:9216
    s_waitcnt lgkmcnt(0)
    ds_write_b128 v5, v[56:59] offset:4096
    ds_write_b128 v5, v[60:63] offset:5120
L_lw_4:
    s_waitcnt lgkmcnt(0)
    s_waitcnt vmcnt(24)
    s_barrier
    s_cmp_lg_u32 s44, 0
    s_cbranch_scc1 L_hs_5
    s_getreg_b32 s45, hwreg(HW_REG_XCC_ID)
    s_and_b32 s45, s45, 15
    s_mul_i32 s46, s45, s45
    s_lshl_b32 s46, s46, 9
    s_add_u32 s45, s45, s46
    s_cmp_eq_u32 s40, 0
    s_cselect_b32 s46, s45, 0
    s_cselect_b32 s45, 0, s45
    s_lshl_b32 s68, s68, 24
    s_add_u32 s46, s46, s68
    s_add_u32 s45, s45, 16777216
    v_mov_b32 v40, s46
    v_mov_b32 v41, s45
    v_mov_b32 v42, 0
    s_mov_b64 exec, 1
    buffer_atomic_add_x2 v[40:41], v42, s[16:19], 0 offen sc1
    s_mov_b64 exec, -1
L_hs_5:
    s_cmp_lg_u32 s44, 0
    s_cbranch_scc1 L_lw_6_0
    ds_read_b64_tr_b16 a[32:33], v84 offset:12288
    ds_read_b64_tr_b16 a[34:35], v84 offset:13312
    ds_read_b64_tr_b16 a[36:37], v86 offset:12288
    ds_read_b64_tr_b16 a[38:39], v86 offset:13312
    ds_read_b64_tr_b16 a[40:41], v85 offset:12288
    ds_read_b64_tr_b16 a[42:43], v85 offset:13312
    ds_read_b64_tr_b16 a[44:45], v87 offset:12288
    ds_read_b64_tr_b16 a[46:47], v87 offset:13312
    s_branch L_lw_6
L_lw_6_0:
    s_cmp_lg_u32 s44, 1
    s_cbranch_scc1 L_lw_6_1
    ds_read_b64_tr_b16 v[184:185], v84 offset:12288
    ds_read_b64_tr_b16 v[186:187], v84 offset:13312
    ds_read_b64_tr_b16 v[188:189], v86 offset:12288
    ds_read_b64_tr_b16 v[190:191], v86 offset:13312
    ds_read_b64_tr_b16 v[192:193], v85 offset:12288
    ds_read_b64_tr_b16 v[194:195], v85 offset:13312
    ds_read_b64_tr_b16 v[196:197], v87 offset:12288
    ds_read_b64_tr_b16 v[198:199], v87 offset:13312
    s_branch L_lw_6
L_lw_6_1:
    s_cmp_lg_u32 s44, 2
    s_cbranch_scc1 L_lw_6_2
    ds_read_b64_tr_b16 a[232:233], v84 offset:12288
    ds_read_b64_tr_b16 a[234:235], v84 offset:13312
    ds_read_b64_tr_b16 a[236:237], v86 offset:12288
    ds_read_b64_tr_b16 a[238:239], v86 offset:13312
    ds_read_b64_tr_b16 a[240:241], v85 offset:12288
    ds_read_b64_tr_b16 a[242:243], v85 offset:13312
    ds_read_b64_tr_b16 a[244:245], v87 offset:12288
    ds_read_b64_tr_b16 a[246:247], v87 offset:13312
    s_branch L_lw_6
L_lw_6_2:
    ds_read_b64_tr_b16 a[128:129], v84 offset:12288
    ds_read_b64_tr_b16 a[130:131], v84 offset:13312
    ds_read_b64_tr_b16 a[132:133], v86 offset:12288
    ds_read_b64_tr_b16 a[134:135], v86 offset:13312
    ds_read_b64_tr_b16 v[56:57], v85 offset:12288
    ds_read_b64_tr_b16 v[58:59], v85 offset:13312
    ds_read_b64_tr_b16 v[60:61], v87 offset:12288
    ds_read_b64_tr_b16 v[62:63], v87 offset:13312
    s_waitcnt lgkmcnt(0)
    ds_write_b128 v5, v[56:59] offset:6144
    ds_write_b128 v5, v[60:63] offset:7168
L_lw_6:
    s_waitcnt lgkmcnt(0)
    s_waitcnt vmcnt(20)
    s_barrier
    s_cmp_lg_u32 s44, 0
    s_cbranch_scc1 L_lw_7_0
    ds_read_b64_tr_b16 a[64:65], v84 offset:16384
    ds_read_b64_tr_b16 a[66:67], v84 offset:17408
    ds_read_b64_tr_b16 a[68:69], v86 offset:16384
    ds_read_b64_tr_b16 a[70:71], v86 offset:17408
    ds_read_b64_tr_b16 v[56:57], v85 offset:16384
    ds_read_b64_tr_b16 v[58:59], v85 offset:17408
    ds_read_b64_tr_b16 v[60:61], v87 offset:16384
    ds_read_b64_tr_b16 v[62:63], v87 offset:17408
    s_waitcnt lgkmcnt(0)
    ds_write_b128 v5, v[56:59] offset:8192
    ds_write_b128 v5, v[60:63] offset:9216
    s_branch L_lw_7
L_lw_7_0:
    s_cmp_lg_u32 s44, 1
    s_cbranch_scc1 L_lw_7_1
    ds_read_b64_tr_b16 v[208:209], v84 offset:16384
    ds_read_b64_tr_b16 v[210:211], v84 offset:17408
    ds_read_b64_tr_b16 v[212:213], v86 offset:16384
    ds_read_b64_tr_b16 v[214:215], v86 offset:17408
    ds_read_b64_tr_b16 v[56:57], v85 offset:16384
    ds_read_b64_tr_b16 v[58:59], v85 offset:17408
    ds_read_b64_tr_b16 v[60:61], v87 offset:16384
    ds_read_b64_tr_b16 v[62:63], v87 offset:17408
    s_waitcnt lgkmcnt(0)
    ds_write_b128 v5, v[56:59] offset:10240
    ds_write_b128 v5, v[60:63] offset:11264
    s_branch L_lw_7
L_lw_7_1:
    s_cmp_lg_u32 s44, 2
    s_cbranch_scc1 L_lw_7_2
    ds_read_b64_tr_b16 v[104:105], v84 offset:16384
    ds_read_b64_tr_b16 v[106:107], v84 offset:17408
    ds_read_b64_tr_b16 v[108:109], v86 offset:16384
    ds_read_b64_tr_b16 v[110:111], v86 offset:17408
    ds_read_b64_tr_b16 v[56:57], v85 offset:16384
    ds_read_b64_tr_b16 v[58:59], v85 offset:17408
    ds_read_b64_tr_b16 v[60:61], v87 offset:16384
    ds_read_b64_tr_b16 v[62:63], v87 offset:17408
    s_waitcnt lgkmcnt(0)
    ds_write_b128 v5, v[56:59] offset:12288
    ds_write_b128 v5, v[60:63] offset:13312
    s_branch L_lw_7
L_lw_7_2:
    ds_read_b64_tr_b16 a[152:153], v84 offset:16384
    ds_read_b64_tr_b16 a[154:155], v84 offset:17408
    ds_read_b64_tr_b16 a[156:157], v86 offset:16384
    ds_read_b64_tr_b16 a[158:159], v86 offset:17408
    ds_read_b64_tr_b16 v[56:57], v85 offset:16384
    ds_read_b64_tr_b16 v[58:59], v85 offset:17408
    ds_read_b64_tr_b16 v[60:61], v87 offset:16384
    ds_read_b64_tr_b16 v[62:63], v87 offset:17408
    s_waitcnt lgkmcnt(0)
    ds_write_b128 v5, v[56:59] offset:14336
    ds_write_b128 v5, v[60:63] offset:15360
L_lw_7:
    s_waitcnt lgkmcnt(0)
    s_waitcnt vmcnt(16)
    s_barrier
    s_cmp_lg_u32 s44, 0
    s_cbranch_scc1 L_lw_8_0
    ds_read_b64_tr_b16 a[80:81], v84 offset:20480
    ds_read_b64_tr_b16 a[82:83], v84 offset:21504
    ds_read_b64_tr_b16 a[84:85], v86 offset:20480
    ds_read_b64_tr_b16 a[86:87], v86 offset:21504
    ds_read_b64_tr_b16 v[56:57], v85 offset:20480
    ds_read_b64_tr_b16 v[58:59], v85 offset:21504
    ds_read_b64_tr_b16 v[60:61], v87 offset:20480
    ds_read_b64_tr_b16 v[62:63], v87 offset:21504
    s_waitcnt lgkmcnt(0)
    ds_write_b128 v5, v[56:59] offset:16384
    ds_write_b128 v5, v[60:63] offset:17408
    s_branch L_lw_8
L_lw_8_0:
    s_cmp_lg_u32 s44, 1
    s_cbranch_scc1 L_lw_8_1
    ds_read_b64_tr_b16 v[232:233], v84 offset:20480
    ds_read_b64_tr_b16 v[234:235], v84 offset:21504
    ds_read_b64_tr_b16 v[236:237], v86 offset:20480
    ds_read_b64_tr_b16 v[238:239], v86 offset:21504
    ds_read_b64_tr_b16 v[240:241], v85 offset:20480
    ds_read_b64_tr_b16 v[242:243], v85 offset:21504
    ds_read_b64_tr_b16 v[244:245], v87 offset:20480
    ds_read_b64_tr_b16 v[246:247], v87 offset:21504
    s_branch L_lw_8
L_lw_8_1:
    s_cmp_lg_u32 s44, 2
    s_cbranch_scc1 L_lw_8_2
    ds_read_b64_tr_b16 v[128:129], v84 offset:20480
    ds_read_b64_tr_b16 v[130:131], v84 offset:21504
    ds_read_b64_tr_b16 v[132:133], v86 offset:20480
    ds_read_b64_tr_b16 v[134:135], v86 offset:21504
    ds_read_b64_tr_b16 v[136:137], v85 offset:20480
    ds_read_b64_tr_b16 v[138:139], v85 offset:21504
    ds_read_b64_tr_b16 v[140:141], v87 offset:20480
    ds_read_b64_tr_b16 v[142:143], v87 offset:21504
    s_branch L_lw_8
L_lw_8_2:
    ds_read_b64_tr_b16 a[176:177], v84 offset:20480
    ds_read_b64_tr_b16 a[178:179], v84 offset:21504
    ds_read_b64_tr_b16 a[180:181], v86 offset:20480
    ds_read_b64_tr_b16 a[182:183], v86 offset:21504
    ds_read_b64_tr_b16 a[184:185], v85 offset:20480
    ds_read_b64_tr_b16 a[186:187], v85 offset:21504
    ds_read_b64_tr_b16 a[188:189], v87 offset:20480
    ds_read_b64_tr_b16 a[190:191], v87 offset:21504
L_lw_8:
    s_waitcnt lgkmcnt(0)
    s_waitcnt vmcnt(12)
    s_barrier
    s_add_u32 s79, s41, 8
    s_and_b32 s79, s79, 3
    s_lshl_b32 s79, s79, 19
    s_add_u32 s79, s79, s47
    s_add_u32 s46, s79, 0x400000
    s_add_u32 m0, s48, 86016
    s_nop 0
    buffer_load_dwordx4 v82, s[24:27], s46 offen  lds
    s_add_u32 s46, s79, 0x420000
    s_add_u32 m0, s48, 110592
    s_nop 0
    buffer_load_dwordx4 v82, s[24:27], s46 offen  lds
    s_add_u32 s46, s79, 0x440000
    s_add_u32 m0, s48, 135168
    s_nop 0
    buffer_load_dwordx4 v82, s[24:27], s46 offen  lds
    s_add_u32 s46, s79, 0x460000
    s_add_u32 m0, s48, 159744
    s_nop 0
    buffer_load_dwordx4 v82, s[24:27], s46 offen  lds
    s_cmp_lg_u32 s44, 0
    s_cbranch_scc1 L_lw_9_0
    ds_read_b64_tr_b16 a[104:105], v80 offset:0
    ds_read_b64_tr_b16 a[106:107], v80 offset:1024
    ds_read_b64_tr_b16 a[108:109], v80 offset:8192
    ds_read_b64_tr_b16 a[110:111], v80 offset:9216
    ds_read_b64_tr_b16 v[56:57], v81 offset:0
    ds_read_b64_tr_b16 v[58:59], v81 offset:1024
    ds_read_b64_tr_b16 v[60:61], v81 offset:8192
    ds_read_b64_tr_b16 v[62:63], v81 offset:9216
    s_waitcnt lgkmcnt(0)
    ds_write_b128 v5, v[56:59] offset:4096
    ds_write_b128 v5, v[60:63] offset:5120
    s_branch L_lw_9
L_lw_9_0:
    s_cmp_lg_u32 s44, 1
    s_cbranch_scc1 L_lw_9_1
    ds_read_b64_tr_b16 a[0:1], v80 offset:0
    ds_read_b64_tr_b16 a[2:3], v80 offset:1024
    ds_read_b64_tr_b16 a[4:5], v80 offset:8192
    ds_read_b64_tr_b16 a[6:7], v80 offset:9216
    ds_read_b64_tr_b16 a[8:9], v81 offset:0
    ds_read_b64_tr_b16 a[10:11], v81 offset:1024
    ds_read_b64_tr_b16 a[12:13], v81 offset:8192
    ds_read_b64_tr_b16 a[14:15], v81 offset:9216
    s_branch L_lw_9
L_lw_9_1:
    s_cmp_lg_u32 s44, 2
    s_cbranch_scc1 L_lw_9_2
    ds_read_b64_tr_b16 v[160:161], v80 offset:0
    ds_read_b64_tr_b16 v[162:163], v80 offset:1024
    ds_read_b64_tr_b16 v[164:165], v80 offset:8192
    ds_read_b64_tr_b16 v[166:167], v80 offset:9216
    ds_read_b64_tr_b16 v[56:57], v81 offset:0
    ds_read_b64_tr_b16 v[58:59], v81 offset:1024
    ds_read_b64_tr_b16 v[60:61], v81 offset:8192
    ds_read_b64_tr_b16 v[62:63], v81 offset:9216
    s_waitcnt lgkmcnt(0)
    ds_write_b128 v5, v[56:59] offset:0
    ds_write_b128 v5, v[60:63] offset:1024
    s_branch L_lw_9
L_lw_9_2:
    ds_read_b64_tr_b16 a[208:209], v80 offset:0
    ds_read_b64_tr_b16 a[210:211], v80 offset:1024
    ds_read_b64_tr_b16 a[212:213], v80 offset:8192
    ds_read_b64_tr_b16 a[214:215], v80 offset:9216
    ds_read_b64_tr_b16 v[56:57], v81 offset:0
    ds_read_b64_tr_b16 v[58:59], v81 offset:1024
    ds_read_b64_tr_b16 v[60:61], v81 offset:8192
    ds_read_b64_tr_b16 v[62:63], v81 offset:9216
    s_waitcnt lgkmcnt(0)
    ds_write_b128 v5, v[56:59] offset:2048
    ds_write_b128 v5, v[60:63] offset:3072
L_lw_9:
    s_waitcnt lgkmcnt(0)
    s_waitcnt vmcnt(12)
    s_barrier
    s_add_u32 s79, s41, 9
    s_and_b32 s79, s79, 3
    s_lshl_b32 s79, s79, 19
    s_add_u32 s79, s79, s47
    s_add_u32 s46, s79, 0x400000
    s_add_u32 m0, s48, 0
    s_nop 0
    buffer_load_dwordx4 v82, s[24:27], s46 offen  lds
    s_add_u32 s46, s79, 0x420000
    s_add_u32 m0, s48, 4096
    s_nop 0
    buffer_load_dwordx4 v82, s[24:27], s46 offen  lds
    s_add_u32 s46, s79, 0x440000
    s_add_u32 m0, s48, 8192
    s_nop 0
    buffer_load_dwordx4 v82, s[24:27], s46 offen  lds
    s_add_u32 s46, s79, 0x460000
    s_add_u32 m0, s48, 12288
    s_nop 0
    buffer_load_dwordx4 v82, s[24:27], s46 offen  lds
    s_cmp_lg_u32 s44, 0
    s_cbranch_scc1 L_lw_10_0
    ds_read_b64_tr_b16 a[128:129], v80 offset:16384
    ds_read_b64_tr_b16 a[130:131], v80 offset:17408
    ds_read_b64_tr_b16 a[132:133], v80 offset:24576
    ds_read_b64_tr_b16 a[134:135], v80 offset:25600
    ds_read_b64_tr_b16 v[56:57], v81 offset:16384
    ds_read_b64_tr_b16 v[58:59], v81 offset:17408
    ds_read_b64_tr_b16 v[60:61], v81 offset:24576
    ds_read_b64_tr_b16 v[62:63], v81 offset:25600
    s_waitcnt lgkmcnt(0)
    ds_write_b128 v5, v[56:59] offset:6144
    ds_write_b128 v5, v[60:63] offset:7168
    s_branch L_lw_10
L_lw_10_0:
    s_cmp_lg_u32 s44, 1
    s_cbranch_scc1 L_lw_10_1
    ds_read_b64_tr_b16 a[32:33], v80 offset:16384
    ds_read_b64_tr_b16 a[34:35], v80 offset:17408
    ds_read_b64_tr_b16 a[36:37], v80 offset:24576
    ds_read_b64_tr_b16 a[38:39], v80 offset:25600
    ds_read_b64_tr_b16 a[40:41], v81 offset:16384
    ds_read_b64_tr_b16 a[42:43], v81 offset:17408
    ds_read_b64_tr_b16 a[44:45], v81 offset:24576
    ds_read_b64_tr_b16 a[46:47], v81 offset:25600
    s_branch L_lw_10
L_lw_10_1:
    s_cmp_lg_u32 s44, 2
    s_cbranch_scc1 L_lw_10_2
    ds_read_b64_tr_b16 v[184:185], v80 offset:16384
    ds_read_b64_tr_b16 v[186:187], v80 offset:17408
    ds_read_b64_tr_b16 v[188:189], v80 offset:24576
    ds_read_b64_tr_b16 v[190:191], v80 offset:25600
    ds_read_b64_tr_b16 v[192:193], v81 offset:16384
    ds_read_b64_tr_b16 v[194:195], v81 offset:17408
    ds_read_b64_tr_b16 v[196:197], v81 offset:24576
    ds_read_b64_tr_b16 v[198:199], v81 offset:25600
    s_branch L_lw_10
L_lw_10_2:
    ds_read_b64_tr_b16 a[232:233], v80 offset:16384
    ds_read_b64_tr_b16 a[234:235], v80 offset:17408
    ds_read_b64_tr_b16 a[236:237], v80 offset:24576
    ds_read_b64_tr_b16 a[238:239], v80 offset:25600
    ds_read_b64_tr_b16 a[240:241], v81 offset:16384
    ds_read_b64_tr_b16 a[242:243], v81 offset:17408
    ds_read_b64_tr_b16 a[244:245], v81 offset:24576
    ds_read_b64_tr_b16 a[246:247], v81 offset:25600
L_lw_10:
    s_waitcnt lgkmcnt(0)
    s_waitcnt vmcnt(12)
    s_barrier
    s_add_u32 s79, s41, 10
    s_and_b32 s79, s79, 3
    s_lshl_b32 s79, s79, 19
    s_add_u32 s79, s79, s47
    s_add_u32 s46, s79, 0x400000
    s_add_u32 m0, s48, 16384
    s_nop 0
    buffer_load_dwordx4 v82, s[24:27], s46 offen  lds
    s_add_u32 s46, s79, 0x420000
    s_add_u32 m0, s48, 20480
    s_nop 0
    buffer_load_dwordx4 v82, s[24:27], s46 offen  lds
    s_add_u32 s46, s79, 0x440000
    s_add_u32 m0, s48, 24576
    s_nop 0
    buffer_load_dwordx4 v82, s[24:27], s46 offen  lds
    s_add_u32 s46, s79, 0x460000
    s_add_u32 m0, s48, 28672
    s_nop 0
    buffer_load_dwordx4 v82, s[24:27], s46 offen  lds
    s_cmp_lg_u32 s44, 0
    s_cbranch_scc1 L_lw_11_0
    ds_read_b64_tr_b16 a[152:153], v80 offset:32768
    ds_read_b64_tr_b16 a[154:155], v80 offset:33792
    ds_read_b64_tr_b16 a[156:157], v80 offset:40960
    ds_read_b64_tr_b16 a[158:159], v80 offset:41984
    ds_read_b64_tr_b16 v[56:57], v81 offset:32768
    ds_read_b64_tr_b16 v[58:59], v81 offset:33792
    ds_read_b64_tr_b16 v[60:61], v81 offset:40960
    ds_read_b64_tr_b16 v[62:63], v81 offset:41984
    s_waitcnt lgkmcnt(0)
    ds_write_b128 v5, v[56:59] offset:14336
    ds_write_b128 v5, v[60:63] offset:15360
    s_branch L_lw_11
L_lw_11_0:
    s_cmp_lg_u32 s44, 1
    s_cbranch_scc1 L_lw_11_1
    ds_read_b64_tr_b16 a[64:65], v80 offset:32768
    ds_read_b64_tr_b16 a[66:67], v80 offset:33792
    ds_read_b64_tr_b16 a[68:69], v80 offset:40960
    ds_read_b64_tr_b16 a[70:71], v80 offset:41984
    ds_read_b64_tr_b16 v[56:57], v81 offset:32768
    ds_read_b64_tr_b16 v[58:59], v81 offset:33792
    ds_read_b64_tr_b16 v[60:61], v81 offset:40960
    ds_read_b64_tr_b16 v[62:63], v81 offset:41984
    s_waitcnt lgkmcnt(0)
    ds_write_b128 v5, v[56:59] offset:8192
    ds_write_b128 v5, v[60:63] offset:9216
    s_branch L_lw_11
L_lw_11_1:
    s_cmp_lg_u32 s44, 2
    s_cbranch_scc1 L_lw_11_2
    ds_read_b64_tr_b16 v[208:209], v80 offset:32768
    ds_read_b64_tr_b16 v[210:211], v80 offset:33792
    ds_read_b64_tr_b16 v[212:213], v80 offset:40960
    ds_read_b64_tr_b16 v[214:215], v80 offset:41984
    ds_read_b64_tr_b16 v[56:57], v81 offset:32768
    ds_read_b64_tr_b16 v[58:59], v81 offset:33792
    ds_read_b64_tr_b16 v[60:61], v81 offset:40960
    ds_read_b64_tr_b16 v[62:63], v81 offset:41984
    s_waitcnt lgkmcnt(0)
    ds_write_b128 v5, v[56:59] offset:10240
    ds_write_b128 v5, v[60:63] offset:11264
    s_branch L_lw_11
L_lw_11_2:
    ds_read_b64_tr_b16 v[104:105], v80 offset:32768
    ds_read_b64_tr_b16 v[106:107], v80 offset:33792
    ds_read_b64_tr_b16 v[108:109], v80 offset:40960
    ds_read_b64_tr_b16 v[110:111], v80 offset:41984
    ds_read_b64_tr_b16 v[56:57], v81 offset:32768
    ds_read_b64_tr_b16 v[58:59], v81 offset:33792
    ds_read_b64_tr_b16 v[60:61], v81 offset:40960
    ds_read_b64_tr_b16 v[62:63], v81 offset:41984
    s_waitcnt lgkmcnt(0)
    ds_write_b128 v5, v[56:59] offset:12288
    ds_write_b128 v5, v[60:63] offset:13312
L_lw_11:
    s_waitcnt lgkmcnt(0)
    s_waitcnt vmcnt(12)
    s_barrier
    s_add_u32 s79, s41, 11
    s_and_b32 s79, s79, 3
    s_lshl_b32 s79, s79, 19
    s_add_u32 s79, s79, s47
    s_add_u32 s46, s79, 0x400000
    s_add_u32 m0, s48, 32768
    s_nop 0
    buffer_load_dwordx4 v82, s[24:27], s46 offen  lds
    s_add_u32 s46, s79, 0x420000
    s_add_u32 m0, s48, 36864
    s_nop 0
    buffer_load_dwordx4 v82, s[24:27], s46 offen  lds
    s_add_u32 s46, s79, 0x440000
    s_add_u32 m0, s48, 40960
    s_nop 0
    buffer_load_dwordx4 v82, s[24:27], s46 offen  lds
    s_add_u32 s46, s79, 0x460000
    s_add_u32 m0, s48, 45056
    s_nop 0
    buffer_load_dwordx4 v82, s[24:27], s46 offen  lds
    s_cmp_lg_u32 s44, 0
    s_cbranch_scc1 L_lw_12_0
    ds_read_b64_tr_b16 a[176:177], v80 offset:49152
    ds_read_b64_tr_b16 a[178:179], v80 offset:50176
    ds_read_b64_tr_b16 a[180:181], v80 offset:57344
    ds_read_b64_tr_b16 a[182:183], v80 offset:58368
    ds_read_b64_tr_b16 a[184:185], v81 offset:49152
    ds_read_b64_tr_b16 a[186:187], v81 offset:50176
    ds_read_b64_tr_b16 a[188:189], v81 offset:57344
    ds_read_b64_tr_b16 a[190:191], v81 offset:58368
    s_branch L_lw_12
L_lw_12_0:
    s_cmp_lg_u32 s44, 1
    s_cbranch_scc1 L_lw_12_1
    ds_read_b64_tr_b16 a[80:81], v80 offset:49152
    ds_read_b64_tr_b16 a[82:83], v80 offset:50176
    ds_read_b64_tr_b16 a[84:85], v80 offset:57344
    ds_read_b64_tr_b16 a[86:87], v80 offset:58368
    ds_read_b64_tr_b16 v[56:57], v81 offset:49152
    ds_read_b64_tr_b16 v[58:59], v81 offset:50176
    ds_read_b64_tr_b16 v[60:61], v81 offset:57344
    ds_read_b64_tr_b16 v[62:63], v81 offset:58368
    s_waitcnt lgkmcnt(0)
    ds_write_b128 v5, v[56:59] offset:16384
    ds_write_b128 v5, v[60:63] offset:17408
    s_branch L_lw_12
L_lw_12_1:
    s_cmp_lg_u32 s44, 2
    s_cbranch_scc1 L_lw_12_2
    ds_read_b64_tr_b16 v[232:233], v80 offset:49152
    ds_read_b64_tr_b16 v[234:235], v80 offset:50176
    ds_read_b64_tr_b16 v[236:237], v80 offset:57344
    ds_read_b64_tr_b16 v[238:239], v80 offset:58368
    ds_read_b64_tr_b16 v[240:241], v81 offset:49152
    ds_read_b64_tr_b16 v[242:243], v81 offset:50176
    ds_read_b64_tr_b16 v[244:245], v81 offset:57344
    ds_read_b64_tr_b16 v[246:247], v81 offset:58368
    s_branch L_lw_12
L_lw_12_2:
    ds_read_b64_tr_b16 v[128:129], v80 offset:49152
    ds_read_b64_tr_b16 v[130:131], v80 offset:50176
    ds_read_b64_tr_b16 v[132:133], v80 offset:57344
    ds_read_b64_tr_b16 v[134:135], v80 offset:58368
    ds_read_b64_tr_b16 v[136:137], v81 offset:49152
    ds_read_b64_tr_b16 v[138:139], v81 offset:50176
    ds_read_b64_tr_b16 v[140:141], v81 offset:57344
    ds_read_b64_tr_b16 v[142:143], v81 offset:58368
L_lw_12:
    s_waitcnt lgkmcnt(0)
    s_waitcnt vmcnt(12)
    s_barrier
    s_add_u32 s79, s41, 12
    s_and_b32 s79, s79, 3
    s_lshl_b32 s79, s79, 19
    s_add_u32 s79, s79, s47
    s_add_u32 s46, s79, 0x600000
    s_add_u32 m0, s48, 49152
    s_nop 0
    buffer_load_dwordx4 v82, s[24:27], s46 offen  lds
    s_add_u32 s46, s79, 0x620000
    s_add_u32 m0, s48, 53248
    s_nop 0
    buffer_load_dwordx4 v82, s[24:27], s46 offen  lds
    s_add_u32 s46, s79, 0x640000
    s_add_u32 m0, s48, 57344
    s_nop 0
    buffer_load_dwordx4 v82, s[24:27], s46 offen  lds
    s_add_u32 s46, s79, 0x660000
    s_add_u32 m0, s48, 61440
    s_nop 0
    buffer_load_dwordx4 v82, s[24:27], s46 offen  lds
    s_cmp_lg_u32 s44, 0
    s_cbranch_scc1 L_lw_13_0
    ds_read_b64_tr_b16 a[208:209], v84 offset:20480
    ds_read_b64_tr_b16 a[210:211], v84 offset:21504
    ds_read_b64_tr_b16 a[212:213], v86 offset:20480
    ds_read_b64_tr_b16 a[214:215], v86 offset:21504
    ds_read_b64_tr_b16 v[56:57], v85 offset:20480
    ds_read_b64_tr_b16 v[58:59], v85 offset:21504
    ds_read_b64_tr_b16 v[60:61], v87 offset:20480
    ds_read_b64_tr_b16 v[62:63], v87 offset:21504
    s_waitcnt lgkmcnt(0)
    ds_write_b128 v5, v[56:59] offset:2048
    ds_write_b128 v5, v[60:63] offset:3072
    s_branch L_lw_13
L_lw_13_0:
    s_cmp_lg_u32 s44, 1
    s_cbranch_scc1 L_lw_13_1
    ds_read_b64_tr_b16 a[104:105], v84 offset:20480
    ds_read_b64_tr_b16 a[106:107], v84 offset:21504
    ds_read_b64_tr_b16 a[108:109], v86 offset:20480
    ds_read_b64_tr_b16 a[110:111], v86 offset:21504
    ds_read_b64_tr_b16 v[56:57], v85 offset:20480
    ds_read_b64_tr_b16 v[58:59], v85 offset:21504
    ds_read_b64_tr_b16 v[60:61], v87 offset:20480
    ds_read_b64_tr_b16 v[62:63], v87 offset:21504
    s_waitcnt lgkmcnt(0)
    ds_write_b128 v5, v[56:59] offset:4096
    ds_write_b128 v5, v[60:63] offset:5120
    s_branch L_lw_13
L_lw_13_1:
    s_cmp_lg_u32 s44, 2
    s_cbranch_scc1 L_lw_13_2
    ds_read_b64_tr_b16 a[0:1], v84 offset:20480
    ds_read_b64_tr_b16 a[2:3], v84 offset:21504
    ds_read_b64_tr_b16 a[4:5], v86 offset:20480
    ds_read_b64_tr_b16 a[6:7], v86 offset:21504
    ds_read_b64_tr_b16 a[8:9], v85 offset:20480
    ds_read_b64_tr_b16 a[10:11], v85 offset:21504
    ds_read_b64_tr_b16 a[12:13], v87 offset:20480
    ds_read_b64_tr_b16 a[14:15], v87 offset:21504
    s_branch L_lw_13
L_lw_13_2:
    ds_read_b64_tr_b16 v[160:161], v84 offset:20480
    ds_read_b64_tr_b16 v[162:163], v84 offset:21504
    ds_read_b64_tr_b16 v[164:165], v86 offset:20480
    ds_read_b64_tr_b16 v[166:167], v86 offset:21504
    ds_read_b64_tr_b16 v[56:57], v85 offset:20480
    ds_read_b64_tr_b16 v[58:59], v85 offset:21504
    ds_read_b64_tr_b16 v[60:61], v87 offset:20480
    ds_read_b64_tr_b16 v[62:63], v87 offset:21504
    s_waitcnt lgkmcnt(0)
    ds_write_b128 v5, v[56:59] offset:0
    ds_write_b128 v5, v[60:63] offset:1024
L_lw_13:
    s_waitcnt lgkmcnt(0)
    s_waitcnt vmcnt(12)
    s_barrier
    s_add_u32 s79, s41, 13
    s_and_b32 s79, s79, 3
    s_lshl_b32 s79, s79, 19
    s_add_u32 s79, s79, s47
    s_add_u32 s46, s79, 0x600000
    s_add_u32 m0, s48, 86016
    s_nop 0
    buffer_load_dwordx4 v82, s[24:27], s46 offen  lds
    s_add_u32 s46, s79, 0x620000
    s_add_u32 m0, s48, 110592
    s_nop 0
    buffer_load_dwordx4 v82, s[24:27], s46 offen  lds
    s_add_u32 s46, s79, 0x640000
    s_add_u32 m0, s48, 135168
    s_nop 0
    buffer_load_dwordx4 v82, s[24:27], s46 offen  lds
    s_add_u32 s46, s79, 0x660000
    s_add_u32 m0, s48, 159744
    s_nop 0
    buffer_load_dwordx4 v82, s[24:27], s46 offen  lds
    s_cmp_lg_u32 s44, 0
    s_cbranch_scc1 L_lw_14_0
    ds_read_b64_tr_b16 a[232:233], v80 offset:0
    ds_read_b64_tr_b16 a[234:235], v80 offset:1024
    ds_read_b64_tr_b16 a[236:237], v80 offset:8192
    ds_read_b64_tr_b16 a[238:239], v80 offset:9216
    ds_read_b64_tr_b16 a[240:241], v81 offset:0
    ds_read_b64_tr_b16 a[242:243], v81 offset:1024
    ds_read_b64_tr_b16 a[244:245], v81 offset:8192
    ds_read_b64_tr_b16 a[246:247], v81 offset:9216
    s_branch L_lw_14
L_lw_14_0:
    s_cmp_lg_u32 s44, 1
    s_cbranch_scc1 L_lw_14_1
    ds_read_b64_tr_b16 a[128:129], v80 offset:0
    ds_read_b64_tr_b16 a[130:131], v80 offset:1024
    ds_read_b64_tr_b16 a[132:133], v80 offset:8192
    ds_read_b64_tr_b16 a[134:135], v80 offset:9216
    ds_read_b64_tr_b16 v[56:57], v81 offset:0
    ds_read_b64_tr_b16 v[58:59], v81 offset:1024
    ds_read_b64_tr_b16 v[60:61], v81 offset:8192
    ds_read_b64_tr_b16 v[62:63], v81 offset:9216
    s_waitcnt lgkmcnt(0)
    ds_write_b128 v5, v[56:59] offset:6144
    ds_write_b128 v5, v[60:63] offset:7168
    s_branch L_lw_14
L_lw_14_1:
    s_cmp_lg_u32 s44, 2
    s_cbranch_scc1 L_lw_14_2
    ds_read_b64_tr_b16 a[32:33], v80 offset:0
    ds_read_b64_tr_b16 a[34:35], v80 offset:1024
    ds_read_b64_tr_b16 a[36:37], v80 offset:8192
    ds_read_b64_tr_b16 a[38:39], v80 offset:9216
    ds_read_b64_tr_b16 a[40:41], v81 offset:0
    ds_read_b64_tr_b16 a[42:43], v81 offset:1024
    ds_read_b64_tr_b16 a[44:45], v81 offset:8192
    ds_read_b64_tr_b16 a[46:47], v81 offset:9216
    s_branch L_lw_14
L_lw_14_2:
    ds_read_b64_tr_b16 v[184:185], v80 offset:0
    ds_read_b64_tr_b16 v[186:187], v80 offset:1024
    ds_read_b64_tr_b16 v[188:189], v80 offset:8192
    ds_read_b64_tr_b16 v[190:191], v80 offset:9216
    ds_read_b64_tr_b16 v[192:193], v81 offset:0
    ds_read_b64_tr_b16 v[194:195], v81 offset:1024
    ds_read_b64_tr_b16 v[196:197], v81 offset:8192
    ds_read_b64_tr_b16 v[198:199], v81 offset:9216
L_lw_14:
    s_waitcnt lgkmcnt(0)
    s_waitcnt vmcnt(12)
    s_barrier
    s_add_u32 s79, s41, 14
    s_and_b32 s79, s79, 3
    s_lshl_b32 s79, s79, 19
    s_add_u32 s79, s79, s47
    s_add_u32 s46, s79, 0x600000
    s_add_u32 m0, s48, 0
    s_nop 0
    buffer_load_dwordx4 v82, s[24:27], s46 offen  lds
    s_add_u32 s46, s79, 0x620000
    s_add_u32 m0, s48, 4096
    s_nop 0
    buffer_load_dwordx4 v82, s[24:27], s46 offen  lds
    s_add_u32 s46, s79, 0x640000
    s_add_u32 m0, s48, 8192
    s_nop 0
    buffer_load_dwordx4 v82, s[24:27], s46 offen  lds
    s_add_u32 s46, s79, 0x660000
    s_add_u32 m0, s48, 12288
    s_nop 0
    buffer_load_dwordx4 v82, s[24:27], s46 offen  lds
    s_cmp_lg_u32 s44, 0
    s_cbranch_scc1 L_lw_15_0
    ds_read_b64_tr_b16 v[104:105], v80 offset:16384
    ds_read_b64_tr_b16 v[106:107], v80 offset:17408
    ds_read_b64_tr_b16 v[108:109], v80 offset:24576
    ds_read_b64_tr_b16 v[110:111], v80 offset:25600
    ds_read_b64_tr_b16 v[56:57], v81 offset:16384
    ds_read_b64_tr_b16 v[58:59], v81 offset:17408
    ds_read_b64_tr_b16 v[60:61], v81 offset:24576
    ds_read_b64_tr_b16 v[62:63], v81 offset:25600
    s_waitcnt lgkmcnt(0)
    ds_write_b128 v5, v[56:59] offset:12288
    ds_write_b128 v5, v[60:63] offset:13312
    s_branch L_lw_15
L_lw_15_0:
    s_cmp_lg_u32 s44, 1
    s_cbranch_scc1 L_lw_15_1
    ds_read_b64_tr_b16 a[152:153], v80 offset:16384
    ds_read_b64_tr_b16 a[154:155], v80 offset:17408
    ds_read_b64_tr_b16 a[156:157], v80 offset:24576
    ds_read_b64_tr_b16 a[158:159], v80 offset:25600
    ds_read_b64_tr_b16 v[56:57], v81 offset:16384
    ds_read_b64_tr_b16 v[58:59], v81 offset:17408
    ds_read_b64_tr_b16 v[60:61], v81 offset:24576
    ds_read_b64_tr_b16 v[62:63], v81 offset:25600
    s_waitcnt lgkmcnt(0)
    ds_write_b128 v5, v[56:59] offset:14336
    ds_write_b128 v5, v[60:63] offset:15360
    s_branch L_lw_15
L_lw_15_1:
    s_cmp_lg_u32 s44, 2
    s_cbranch_scc1 L_lw_15_2
    ds_read_b64_tr_b16 a[64:65], v80 offset:16384
    ds_read_b64_tr_b16 a[66:67], v80 offset:17408
    ds_read_b64_tr_b16 a[68:69], v80 offset:24576
    ds_read_b64_tr_b16 a[70:71], v80 offset:25600
    ds_read_b64_tr_b16 v[56:57], v81 offset:16384
    ds_read_b64_tr_b16 v[58:59], v81 offset:17408
    ds_read_b64_tr_b16 v[60:61], v81 offset:24576
    ds_read_b64_tr_b16 v[62:63], v81 offset:25600
    s_waitcnt lgkmcnt(0)
    ds_write_b128 v5, v[56:59] offset:8192
    ds_write_b128 v5, v[60:63] offset:9216
    s_branch L_lw_15
L_lw_15_2:
    ds_read_b64_tr_b16 v[208:209], v80 offset:16384
    ds_read_b64_tr_b16 v[210:211], v80 offset:17408
    ds_read_b64_tr_b16 v[212:213], v80 offset:24576
    ds_read_b64_tr_b16 v[214:215], v80 offset:25600
    ds_read_b64_tr_b16 v[56:57], v81 offset:16384
    ds_read_b64_tr_b16 v[58:59], v81 offset:17408
    ds_read_b64_tr_b16 v[60:61], v81 offset:24576
    ds_read_b64_tr_b16 v[62:63], v81 offset:25600
    s_waitcnt lgkmcnt(0)
    ds_write_b128 v5, v[56:59] offset:10240
    ds_write_b128 v5, v[60:63] offset:11264
L_lw_15:
    s_waitcnt lgkmcnt(0)
    s_waitcnt vmcnt(12)
    s_barrier
    s_add_u32 s79, s41, 15
    s_and_b32 s79, s79, 3
    s_lshl_b32 s79, s79, 19
    s_add_u32 s79, s79, s47
    s_add_u32 s46, s79, 0x600000
    s_add_u32 m0, s48, 16384
    s_nop 0
    buffer_load_dwordx4 v82, s[24:27], s46 offen  lds
    s_add_u32 s46, s79, 0x620000
    s_add_u32 m0, s48, 20480
    s_nop 0
    buffer_load_dwordx4 v82, s[24:27], s46 offen  lds
    s_add_u32 s46, s79, 0x640000
    s_add_u32 m0, s48, 24576
    s_nop 0
    buffer_load_dwordx4 v82, s[24:27], s46 offen  lds
    s_add_u32 s46, s79, 0x660000
    s_add_u32 m0, s48, 28672
    s_nop 0
    buffer_load_dwordx4 v82, s[24:27], s46 offen  lds
    s_cmp_lg_u32 s44, 0
    s_cbranch_scc1 L_lw_16_0
    ds_read_b64_tr_b16 v[128:129], v80 offset:32768
    ds_read_b64_tr_b16 v[130:131], v80 offset:33792
    ds_read_b64_tr_b16 v[132:133], v80 offset:40960
    ds_read_b64_tr_b16 v[134:135], v80 offset:41984
    ds_read_b64_tr_b16 v[136:137], v81 offset:32768
    ds_read_b64_tr_b16 v[138:139], v81 offset:33792
    ds_read_b64_tr_b16 v[140:141], v81 offset:40960
    ds_read_b64_tr_b16 v[142:143], v81 offset:41984
    s_branch L_lw_16
L_lw_16_0:
    s_cmp_lg_u32 s44, 1
    s_cbranch_scc1 L_lw_16_1
    ds_read_b64_tr_b16 a[176:177], v80 offset:32768
    ds_read_b64_tr_b16 a[178:179], v80 offset:33792
    ds_read_b64_tr_b16 a[180:181], v80 offset:40960
    ds_read_b64_tr_b16 a[182:183], v80 offset:41984
    ds_read_b64_tr_b16 a[184:185], v81 offset:32768
    ds_read_b64_tr_b16 a[186:187], v81 offset:33792
    ds_read_b64_tr_b16 a[188:189], v81 offset:40960
    ds_read_b64_tr_b16 a[190:191], v81 offset:41984
    s_branch L_lw_16
L_lw_16_1:
    s_cmp_lg_u32 s44, 2
    s_cbranch_scc1 L_lw_16_2
    ds_read_b64_tr_b16 a[80:81], v80 offset:32768
    ds_read_b64_tr_b16 a[82:83], v80 offset:33792
    ds_read_b64_tr_b16 a[84:85], v80 offset:40960
    ds_read_b64_tr_b16 a[86:87], v80 offset:41984
    ds_read_b64_tr_b16 v[56:57], v81 offset:32768
    ds_read_b64_tr_b16 v[58:59], v81 offset:33792
    ds_read_b64_tr_b16 v[60:61], v81 offset:40960
    ds_read_b64_tr_b16 v[62:63], v81 offset:41984
    s_waitcnt lgkmcnt(0)
    ds_write_b128 v5, v[56:59] offset:16384
    ds_write_b128 v5, v[60:63] offset:17408
    s_branch L_lw_16
L_lw_16_2:
    ds_read_b64_tr_b16 v[232:233], v80 offset:32768
    ds_read_b64_tr_b16 v[234:235], v80 offset:33792
    ds_read_b64_tr_b16 v[236:237], v80 offset:40960
    ds_read_b64_tr_b16 v[238:239], v80 offset:41984
    ds_read_b64_tr_b16 v[240:241], v81 offset:32768
    ds_read_b64_tr_b16 v[242:243], v81 offset:33792
    ds_read_b64_tr_b16 v[244:245], v81 offset:40960
    ds_read_b64_tr_b16 v[246:247], v81 offset:41984
L_lw_16:
    s_waitcnt lgkmcnt(0)
    s_waitcnt vmcnt(12)
    s_barrier
    s_add_u32 s79, s41, 0
    s_and_b32 s79, s79, 3
    s_lshl_b32 s79, s79, 19
    s_add_u32 s79, s79, s47
    s_add_u32 s46, s79, 0x0
    s_add_u32 m0, s48, 32768
    s_nop 0
    buffer_load_dwordx4 v82, s[28:31], s46 offen  lds
    s_add_u32 s46, s79, 0x20000
    s_add_u32 m0, s48, 36864
    s_nop 0
    buffer_load_dwordx4 v82, s[28:31], s46 offen  lds
    s_add_u32 s46, s79, 0x40000
    s_add_u32 m0, s48, 40960
    s_nop 0
    buffer_load_dwordx4 v82, s[28:31], s46 offen  lds
    s_add_u32 s46, s79, 0x60000
    s_add_u32 m0, s48, 45056
    s_nop 0
    buffer_load_dwordx4 v82, s[28:31], s46 offen  lds
    s_cmp_lg_u32 s44, 0
    s_cbranch_scc1 L_lw_17_0
    ds_read_b64_tr_b16 v[160:161], v80 offset:49152
    ds_read_b64_tr_b16 v[162:163], v80 offset:50176
    ds_read_b64_tr_b16 v[164:165], v80 offset:57344
    ds_read_b64_tr_b16 v[166:167], v80 offset:58368
    ds_read_b64_tr_b16 v[56:57], v81 offset:49152
    ds_read_b64_tr_b16 v[58:59], v81 offset:50176
    ds_read_b64_tr_b16 v[60:61], v81 offset:57344
    ds_read_b64_tr_b16 v[62:63], v81 offset:58368
    s_waitcnt lgkmcnt(0)
    ds_write_b128 v5, v[56:59] offset:0
    ds_write_b128 v5, v[60:63] offset:1024
    s_branch L_lw_17
L_lw_17_0:
    s_cmp_lg_u32 s44, 1
    s_cbranch_scc1 L_lw_17_1
    ds_read_b64_tr_b16 a[208:209], v80 offset:49152
    ds_read_b64_tr_b16 a[210:211], v80 offset:50176
    ds_read_b64_tr_b16 a[212:213], v80 offset:57344
    ds_read_b64_tr_b16 a[214:215], v80 offset:58368
    ds_read_b64_tr_b16 v[56:57], v81 offset:49152
    ds_read_b64_tr_b16 v[58:59], v81 offset:50176
    ds_read_b64_tr_b16 v[60:61], v81 offset:57344
    ds_read_b64_tr_b16 v[62:63], v81 offset:58368
    s_waitcnt lgkmcnt(0)
    ds_write_b128 v5, v[56:59] offset:2048
    ds_write_b128 v5, v[60:63] offset:3072
    s_branch L_lw_17
L_lw_17_1:
    s_cmp_lg_u32 s44, 2
    s_cbranch_scc1 L_lw_17_2
    ds_read_b64_tr_b16 a[104:105], v80 offset:49152
    ds_read_b64_tr_b16 a[106:107], v80 offset:50176
    ds_read_b64_tr_b16 a[108:109], v80 offset:57344
    ds_read_b64_tr_b16 a[110:111], v80 offset:58368
    ds_read_b64_tr_b16 v[56:57], v81 offset:49152
    ds_read_b64_tr_b16 v[58:59], v81 offset:50176
    ds_read_b64_tr_b16 v[60:61], v81 offset:57344
    ds_read_b64_tr_b16 v[62:63], v81 offset:58368
    s_waitcnt lgkmcnt(0)
    ds_write_b128 v5, v[56:59] offset:4096
    ds_write_b128 v5, v[60:63] offset:5120
    s_branch L_lw_17
L_lw_17_2:
    ds_read_b64_tr_b16 a[0:1], v80 offset:49152
    ds_read_b64_tr_b16 a[2:3], v80 offset:50176
    ds_read_b64_tr_b16 a[4:5], v80 offset:57344
    ds_read_b64_tr_b16 a[6:7], v80 offset:58368
    ds_read_b64_tr_b16 a[8:9], v81 offset:49152
    ds_read_b64_tr_b16 a[10:11], v81 offset:50176
    ds_read_b64_tr_b16 a[12:13], v81 offset:57344
    ds_read_b64_tr_b16 a[14:15], v81 offset:58368
L_lw_17:
    s_waitcnt lgkmcnt(0)
    s_waitcnt vmcnt(12)
    s_barrier
    s_add_u32 s79, s41, 1
    s_and_b32 s79, s79, 3
    s_lshl_b32 s79, s79, 19
    s_add_u32 s79, s79, s47
    s_add_u32 s46, s79, 0x0
    s_add_u32 m0, s48, 49152
    s_nop 0
    buffer_load_dwordx4 v82, s[28:31], s46 offen  lds
    s_add_u32 s46, s79, 0x20000
    s_add_u32 m0, s48, 53248
    s_nop 0
    buffer_load_dwordx4 v82, s[28:31], s46 offen  lds
    s_add_u32 s46, s79, 0x40000
    s_add_u32 m0, s48, 57344
    s_nop 0
    buffer_load_dwordx4 v82, s[28:31], s46 offen  lds
    s_add_u32 s46, s79, 0x60000
    s_add_u32 m0, s48, 61440
    s_nop 0
    buffer_load_dwordx4 v82, s[28:31], s46 offen  lds
    s_cmp_lg_u32 s44, 0
    s_cbranch_scc1 L_lw_18_0
    ds_read_b64_tr_b16 v[184:185], v84 offset:20480
    ds_read_b64_tr_b16 v[186:187], v84 offset:21504
    ds_read_b64_tr_b16 v[188:189], v86 offset:20480
    ds_read_b64_tr_b16 v[190:191], v86 offset:21504
    ds_read_b64_tr_b16 v[192:193], v85 offset:20480
    ds_read_b64_tr_b16 v[194:195], v85 offset:21504
    ds_read_b64_tr_b16 v[196:197], v87 offset:20480
    ds_read_b64_tr_b16 v[198:199], v87 offset:21504
    s_branch L_lw_18
L_lw_18_0:
    s_cmp_lg_u32 s44, 1
    s_cbranch_scc1 L_lw_18_1
    ds_read_b64_tr_b16 a[232:233], v84 offset:20480
    ds_read_b64_tr_b16 a[234:235], v84 offset:21504
    ds_read_b64_tr_b16 a[236:237], v86 offset:20480
    ds_read_b64_tr_b16 a[238:239], v86 offset:21504
    ds_read_b64_tr_b16 a[240:241], v85 offset:20480
    ds_read_b64_tr_b16 a[242:243], v85 offset:21504
    ds_read_b64_tr_b16 a[244:245], v87 offset:20480
    ds_read_b64_tr_b16 a[246:247], v87 offset:21504
    s_branch L_lw_18
L_lw_18_1:
    s_cmp_lg_u32 s44, 2
    s_cbranch_scc1 L_lw_18_2
    ds_read_b64_tr_b16 a[128:129], v84 offset:20480
    ds_read_b64_tr_b16 a[130:131], v84 offset:21504
    ds_read_b64_tr_b16 a[132:133], v86 offset:20480
    ds_read_b64_tr_b16 a[134:135], v86 offset:21504
    ds_read_b64_tr_b16 v[56:57], v85 offset:20480
    ds_read_b64_tr_b16 v[58:59], v85 offset:21504
    ds_read_b64_tr_b16 v[60:61], v87 offset:20480
    ds_read_b64_tr_b16 v[62:63], v87 offset:21504
    s_waitcnt lgkmcnt(0)
    ds_write_b128 v5, v[56:59] offset:6144
    ds_write_b128 v5, v[60:63] offset:7168
    s_branch L_lw_18
L_lw_18_2:
    ds_read_b64_tr_b16 a[32:33], v84 offset:20480
    ds_read_b64_tr_b16 a[34:35], v84 offset:21504
    ds_read_b64_tr_b16 a[36:37], v86 offset:20480
    ds_read_b64_tr_b16 a[38:39], v86 offset:21504
    ds_read_b64_tr_b16 a[40:41], v85 offset:20480
    ds_read_b64_tr_b16 a[42:43], v85 offset:21504
    ds_read_b64_tr_b16 a[44:45], v87 offset:20480
    ds_read_b64_tr_b16 a[46:47], v87 offset:21504
L_lw_18:
    s_waitcnt lgkmcnt(0)
    s_waitcnt vmcnt(12)
    s_barrier
    s_cmp_lg_u32 s44, 0
    s_cbranch_scc1 L_lw_19_0
    ds_read_b64_tr_b16 v[208:209], v80 offset:0
    ds_read_b64_tr_b16 v[210:211], v80 offset:1024
    ds_read_b64_tr_b16 v[212:213], v80 offset:8192
    ds_read_b64_tr_b16 v[214:215], v80 offset:9216
    ds_read_b64_tr_b16 v[56:57], v81 offset:0
    ds_read_b64_tr_b16 v[58:59], v81 offset:1024
    ds_read_b64_tr_b16 v[60:61], v81 offset:8192
    ds_read_b64_tr_b16 v[62:63], v81 offset:9216
    s_waitcnt lgkmcnt(0)
    ds_write_b128 v5, v[56:59] offset:10240
    ds_write_b128 v5, v[60:63] offset:11264
    s_branch L_lw_19
L_lw_19_0:
    s_cmp_lg_u32 s44, 1
    s_cbranch_scc1 L_lw_19_1
    ds_read_b64_tr_b16 v[104:105], v80 offset:0
    ds_read_b64_tr_b16 v[106:107], v80 offset:1024
    ds_read_b64_tr_b16 v[108:109], v80 offset:8192
    ds_read_b64_tr_b16 v[110:111], v80 offset:9216
    ds_read_b64_tr_b16 v[56:57], v81 offset:0
    ds_read_b64_tr_b16 v[58:59], v81 offset:1024
    ds_read_b64_tr_b16 v[60:61], v81 offset:8192
    ds_read_b64_tr_b16 v[62:63], v81 offset:9216
    s_waitcnt lgkmcnt(0)
    ds_write_b128 v5, v[56:59] offset:12288
    ds_write_b128 v5, v[60:63] offset:13312
    s_branch L_lw_19
L_lw_19_1:
    s_cmp_lg_u32 s44, 2
    s_cbranch_scc1 L_lw_19_2
    ds_read_b64_tr_b16 a[152:153], v80 offset:0
    ds_read_b64_tr_b16 a[154:155], v80 offset:1024
    ds_read_b64_tr_b16 a[156:157], v80 offset:8192
    ds_read_b64_tr_b16 a[158:159], v80 offset:9216
    ds_read_b64_tr_b16 v[56:57], v81 offset:0
    ds_read_b64_tr_b16 v[58:59], v81 offset:1024
    ds_read_b64_tr_b16 v[60:61], v81 offset:8192
    ds_read_b64_tr_b16 v[62:63], v81 offset:9216
    s_waitcnt lgkmcnt(0)
    ds_write_b128 v5, v[56:59] offset:14336
    ds_write_b128 v5, v[60:63] offset:15360
    s_branch L_lw_19
L_lw_19_2:
    ds_read_b64_tr_b16 a[64:65], v80 offset:0
    ds_read_b64_tr_b16 a[66:67], v80 offset:1024
    ds_read_b64_tr_b16 a[68:69], v80 offset:8192
    ds_read_b64_tr_b16 a[70:71], v80 offset:9216
    ds_read_b64_tr_b16 v[56:57], v81 offset:0
    ds_read_b64_tr_b16 v[58:59], v81 offset:1024
    ds_read_b64_tr_b16 v[60:61], v81 offset:8192
    ds_read_b64_tr_b16 v[62:63], v81 offset:9216
    s_waitcnt lgkmcnt(0)
    ds_write_b128 v5, v[56:59] offset:8192
    ds_write_b128 v5, v[60:63] offset:9216
L_lw_19:
    s_waitcnt lgkmcnt(0)
    s_waitcnt vmcnt(8)
    s_barrier
    s_add_u32 s79, s41, 2
    s_and_b32 s79, s79, 3
    s_lshl_b32 s79, s79, 19
    s_add_u32 s79, s79, s47
    s_add_u32 s46, s79, 0x0
    s_add_u32 m0, s48, 0
    s_nop 0
    buffer_load_dwordx4 v82, s[28:31], s46 offen  lds
    s_add_u32 s46, s79, 0x20000
    s_add_u32 m0, s48, 4096
    s_nop 0
    buffer_load_dwordx4 v82, s[28:31], s46 offen  lds
    s_add_u32 s46, s79, 0x40000
    s_add_u32 m0, s48, 8192
    s_nop 0
    buffer_load_dwordx4 v82, s[28:31], s46 offen  lds
    s_add_u32 s46, s79, 0x60000
    s_add_u32 m0, s48, 12288
    s_nop 0
    buffer_load_dwordx4 v82, s[28:31], s46 offen  lds
    s_cmp_lg_u32 s44, 0
    s_cbranch_scc1 L_lw_20_0
    ds_read_b64_tr_b16 v[232:233], v80 offset:16384
    ds_read_b64_tr_b16 v[234:235], v80 offset:17408
    ds_read_b64_tr_b16 v[236:237], v80 offset:24576
    ds_read_b64_tr_b16 v[238:239], v80 offset:25600
    ds_read_b64_tr_b16 v[240:241], v81 offset:16384
    ds_read_b64_tr_b16 v[242:243], v81 offset:17408
    ds_read_b64_tr_b16 v[244:245], v81 offset:24576
    ds_read_b64_tr_b16 v[246:247], v81 offset:25600
    s_branch L_lw_20
L_lw_20_0:
    s_cmp_lg_u32 s44, 1
    s_cbranch_scc1 L_lw_20_1
    ds_read_b64_tr_b16 v[128:129], v80 offset:16384
    ds_read_b64_tr_b16 v[130:131], v80 offset:17408
    ds_read_b64_tr_b16 v[132:133], v80 offset:24576
    ds_read_b64_tr_b16 v[134:135], v80 offset:25600
    ds_read_b64_tr_b16 v[136:137], v81 offset:16384
    ds_read_b64_tr_b16 v[138:139], v81 offset:17408
    ds_read_b64_tr_b16 v[140:141], v81 offset:24576
    ds_read_b64_tr_b16 v[142:143], v81 offset:25600
    s_branch L_lw_20
L_lw_20_1:
    s_cmp_lg_u32 s44, 2
    s_cbranch_scc1 L_lw_20_2
    ds_read_b64_tr_b16 a[176:177], v80 offset:16384
    ds_read_b64_tr_b16 a[178:179], v80 offset:17408
    ds_read_b64_tr_b16 a[180:181], v80 offset:24576
    ds_read_b64_tr_b16 a[182:183], v80 offset:25600
    ds_read_b64_tr_b16 a[184:185], v81 offset:16384
    ds_read_b64_tr_b16 a[186:187], v81 offset:17408
    ds_read_b64_tr_b16 a[188:189], v81 offset:24576
    ds_read_b64_tr_b16 a[190:191], v81 offset:25600
    s_branch L_lw_20
L_lw_20_2:
    ds_read_b64_tr_b16 a[80:81], v80 offset:16384
    ds_read_b64_tr_b16 a[82:83], v80 offset:17408
    ds_read_b64_tr_b16 a[84:85], v80 offset:24576
    ds_read_b64_tr_b16 a[86:87], v80 offset:25600
    ds_read_b64_tr_b16 v[56:57], v81 offset:16384
    ds_read_b64_tr_b16 v[58:59], v81 offset:17408
    ds_read_b64_tr_b16 v[60:61], v81 offset:24576
    ds_read_b64_tr_b16 v[62:63], v81 offset:25600
    s_waitcnt lgkmcnt(0)
    ds_write_b128 v5, v[56:59] offset:16384
    ds_write_b128 v5, v[60:63] offset:17408
L_lw_20:
    s_waitcnt lgkmcnt(0)
    s_waitcnt vmcnt(8)
    s_barrier
    s_add_u32 s79, s41, 3
    s_and_b32 s79, s79, 3
    s_lshl_b32 s79, s79, 19
    s_add_u32 s79, s79, s47
    s_add_u32 s46, s79, 0x0
    s_add_u32 m0, s48, 16384
    s_nop 0
    buffer_load_dwordx4 v82, s[28:31], s46 offen  lds
    s_add_u32 s46, s79, 0x20000
    s_add_u32 m0, s48, 20480
    s_nop 0
    buffer_load_dwordx4 v82, s[28:31], s46 offen  lds
    s_add_u32 s46, s79, 0x40000
    s_add_u32 m0, s48, 24576
    s_nop 0
    buffer_load_dwordx4 v82, s[28:31], s46 offen  lds
    s_add_u32 s46, s79, 0x60000
    s_add_u32 m0, s48, 28672
    s_nop 0
    buffer_load_dwordx4 v82, s[28:31], s46 offen  lds
    s_cmp_lg_u32 s44, 0
    s_cbranch_scc1 L_lw_21_0
    ds_read_b64_tr_b16 a[16:17], v80 offset:32768
    ds_read_b64_tr_b16 a[18:19], v80 offset:33792
    ds_read_b64_tr_b16 a[20:21], v80 offset:40960
    ds_read_b64_tr_b16 a[22:23], v80 offset:41984
    ds_read_b64_tr_b16 a[24:25], v81 offset:32768
    ds_read_b64_tr_b16 a[26:27], v81 offset:33792
    ds_read_b64_tr_b16 a[28:29], v81 offset:40960
    ds_read_b64_tr_b16 a[30:31], v81 offset:41984
    s_branch L_lw_21
L_lw_21_0:
    s_cmp_lg_u32 s44, 1
    s_cbranch_scc1 L_lw_21_1
    ds_read_b64_tr_b16 v[168:169], v80 offset:32768
    ds_read_b64_tr_b16 v[170:171], v80 offset:33792
    ds_read_b64_tr_b16 v[172:173], v80 offset:40960
    ds_read_b64_tr_b16 v[174:175], v80 offset:41984
    ds_read_b64_tr_b16 v[176:177], v81 offset:32768
    ds_read_b64_tr_b16 v[178:179], v81 offset:33792
    ds_read_b64_tr_b16 v[180:181], v81 offset:40960
    ds_read_b64_tr_b16 v[182:183], v81 offset:41984
    s_branch L_lw_21
L_lw_21_1:
    s_cmp_lg_u32 s44, 2
    s_cbranch_scc1 L_lw_21_2
    ds_read_b64_tr_b16 a[216:217], v80 offset:32768
    ds_read_b64_tr_b16 a[218:219], v80 offset:33792
    ds_read_b64_tr_b16 a[220:221], v80 offset:40960
    ds_read_b64_tr_b16 a[222:223], v80 offset:41984
    ds_read_b64_tr_b16 a[224:225], v81 offset:32768
    ds_read_b64_tr_b16 a[226:227], v81 offset:33792
    ds_read_b64_tr_b16 a[228:229], v81 offset:40960
    ds_read_b64_tr_b16 a[230:231], v81 offset:41984
    s_branch L_lw_21
L_lw_21_2:
    ds_read_b64_tr_b16 a[112:113], v80 offset:32768
    ds_read_b64_tr_b16 a[114:115], v80 offset:33792
    ds_read_b64_tr_b16 a[116:117], v80 offset:40960
    ds_read_b64_tr_b16 a[118:119], v80 offset:41984
    ds_read_b64_tr_b16 a[120:121], v81 offset:32768
    ds_read_b64_tr_b16 a[122:123], v81 offset:33792
    ds_read_b64_tr_b16 a[124:125], v81 offset:40960
    ds_read_b64_tr_b16 a[126:127], v81 offset:41984
L_lw_21:
    s_waitcnt lgkmcnt(0)
    s_waitcnt vmcnt(8)
    s_barrier
    s_add_u32 s79, s41, 4
    s_and_b32 s79, s79, 3
    s_lshl_b32 s79, s79, 19
    s_add_u32 s79, s79, s47
    s_add_u32 s46, s79, 0x200000
    s_add_u32 m0, s48, 32768
    s_nop 0
    buffer_load_dwordx4 v82, s[28:31], s46 offen  lds
    s_add_u32 s46, s79, 0x220000
    s_add_u32 m0, s48, 36864
    s_nop 0
    buffer_load_dwordx4 v82, s[28:31], s46 offen  lds
    s_add_u32 s46, s79, 0x240000
    s_add_u32 m0, s48, 40960
    s_nop 0
    buffer_load_dwordx4 v82, s[28:31], s46 offen  lds
    s_add_u32 s46, s79, 0x260000
    s_add_u32 m0, s48, 45056
    s_nop 0
    buffer_load_dwordx4 v82, s[28:31], s46 offen  lds
    s_cmp_lg_u32 s44, 0
    s_cbranch_scc1 L_lw_22_0
    ds_read_b64_tr_b16 a[48:49], v80 offset:49152
    ds_read_b64_tr_b16 a[50:51], v80 offset:50176
    ds_read_b64_tr_b16 a[52:53], v80 offset:57344
    ds_read_b64_tr_b16 a[54:55], v80 offset:58368
    ds_read_b64_tr_b16 a[56:57], v81 offset:49152
    ds_read_b64_tr_b16 a[58:59], v81 offset:50176
    ds_read_b64_tr_b16 a[60:61], v81 offset:57344
    ds_read_b64_tr_b16 a[62:63], v81 offset:58368
    s_branch L_lw_22
L_lw_22_0:
    s_cmp_lg_u32 s44, 1
    s_cbranch_scc1 L_lw_22_1
    ds_read_b64_tr_b16 v[200:201], v80 offset:49152
    ds_read_b64_tr_b16 v[202:203], v80 offset:50176
    ds_read_b64_tr_b16 v[204:205], v80 offset:57344
    ds_read_b64_tr_b16 v[206:207], v80 offset:58368
    ds_read_b64_tr_b16 v[56:57], v81 offset:49152
    ds_read_b64_tr_b16 v[58:59], v81 offset:50176
    ds_read_b64_tr_b16 v[60:61], v81 offset:57344
    ds_read_b64_tr_b16 v[62:63], v81 offset:58368
    s_waitcnt lgkmcnt(0)
    ds_write_b128 v5, v[56:59] offset:18432
    ds_write_b128 v5, v[60:63] offset:19456
    s_branch L_lw_22
L_lw_22_1:
    s_cmp_lg_u32 s44, 2
    s_cbranch_scc1 L_lw_22_2
    ds_read_b64_tr_b16 a[248:249], v80 offset:49152
    ds_read_b64_tr_b16 a[250:251], v80 offset:50176
    ds_read_b64_tr_b16 a[252:253], v80 offset:57344
    ds_read_b64_tr_b16 a[254:255], v80 offset:58368
    ds_read_b64_tr_b16 v[96:97], v81 offset:49152
    ds_read_b64_tr_b16 v[98:99], v81 offset:50176
    ds_read_b64_tr_b16 v[100:101], v81 offset:57344
    ds_read_b64_tr_b16 v[102:103], v81 offset:58368
    s_branch L_lw_22
L_lw_22_2:
    ds_read_b64_tr_b16 a[136:137], v80 offset:49152
    ds_read_b64_tr_b16 a[138:139], v80 offset:50176
    ds_read_b64_tr_b16 a[140:141], v80 offset:57344
    ds_read_b64_tr_b16 a[142:143], v80 offset:58368
    ds_read_b64_tr_b16 a[144:145], v81 offset:49152
    ds_read_b64_tr_b16 a[146:147], v81 offset:50176
    ds_read_b64_tr_b16 a[148:149], v81 offset:57344
    ds_read_b64_tr_b16 a[150:151], v81 offset:58368
L_lw_22:
    s_waitcnt lgkmcnt(0)
    s_waitcnt vmcnt(8)
    s_barrier
    s_add_u32 s79, s41, 5
    s_and_b32 s79, s79, 3
    s_lshl_b32 s79, s79, 19
    s_add_u32 s79, s79, s47
    s_add_u32 s46, s79, 0x200000
    s_add_u32 m0, s48, 49152
    s_nop 0
    buffer_load_dwordx4 v82, s[28:31], s46 offen  lds
    s_add_u32 s46, s79, 0x220000
    s_add_u32 m0, s48, 53248
    s_nop 0
    buffer_load_dwordx4 v82, s[28:31], s46 offen  lds
    s_add_u32 s46, s79, 0x240000
    s_add_u32 m0, s48, 57344
    s_nop 0
    buffer_load_dwordx4 v82, s[28:31], s46 offen  lds
    s_add_u32 s46, s79, 0x260000
    s_add_u32 m0, s48, 61440
    s_nop 0
    buffer_load_dwordx4 v82, s[28:31], s46 offen  lds
    s_cmp_lg_u32 s44, 0
    s_cbranch_scc1 L_lw_23_0
    ds_read_b64_tr_b16 a[72:73], v80 offset:0
    ds_read_b64_tr_b16 a[74:75], v80 offset:1024
    ds_read_b64_tr_b16 a[76:77], v80 offset:8192
    ds_read_b64_tr_b16 a[78:79], v80 offset:9216
    ds_read_b64_tr_b16 v[56:57], v81 offset:0
    ds_read_b64_tr_b16 v[58:59], v81 offset:1024
    ds_read_b64_tr_b16 v[60:61], v81 offset:8192
    ds_read_b64_tr_b16 v[62:63], v81 offset:9216
    s_waitcnt lgkmcnt(0)
    ds_write_b128 v5, v[56:59] offset:20480
    ds_write_b128 v5, v[60:63] offset:21504
    s_branch L_lw_23
L_lw_23_0:
    s_cmp_lg_u32 s44, 1
    s_cbranch_scc1 L_lw_23_1
    ds_read_b64_tr_b16 v[216:217], v80 offset:0
    ds_read_b64_tr_b16 v[218:219], v80 offset:1024
    ds_read_b64_tr_b16 v[220:221], v80 offset:8192
    ds_read_b64_tr_b16 v[222:223], v80 offset:9216
    ds_read_b64_tr_b16 v[224:225], v81 offset:0
    ds_read_b64_tr_b16 v[226:227], v81 offset:1024
    ds_read_b64_tr_b16 v[228:229], v81 offset:8192
    ds_read_b64_tr_b16 v[230:231], v81 offset:9216
    s_branch L_lw_23
L_lw_23_1:
    s_cmp_lg_u32 s44, 2
    s_cbranch_scc1 L_lw_23_2
    ds_read_b64_tr_b16 v[112:113], v80 offset:0
    ds_read_b64_tr_b16 v[114:115], v80 offset:1024
    ds_read_b64_tr_b16 v[116:117], v80 offset:8192
    ds_read_b64_tr_b16 v[118:119], v80 offset:9216
    ds_read_b64_tr_b16 v[120:121], v81 offset:0
    ds_read_b64_tr_b16 v[122:123], v81 offset:1024
    ds_read_b64_tr_b16 v[124:125], v81 offset:8192
    ds_read_b64_tr_b16 v[126:127], v81 offset:9216
    s_branch L_lw_23
L_lw_23_2:
    ds_read_b64_tr_b16 a[160:161], v80 offset:0
    ds_read_b64_tr_b16 a[162:163], v80 offset:1024
    ds_read_b64_tr_b16 a[164:165], v80 offset:8192
    ds_read_b64_tr_b16 a[166:167], v80 offset:9216
    ds_read_b64_tr_b16 a[168:169], v81 offset:0
    ds_read_b64_tr_b16 a[170:171], v81 offset:1024
    ds_read_b64_tr_b16 a[172:173], v81 offset:8192
    ds_read_b64_tr_b16 a[174:175], v81 offset:9216
L_lw_23:
    s_waitcnt lgkmcnt(0)
    s_waitcnt vmcnt(8)
    s_barrier
    s_add_u32 s79, s41, 6
    s_and_b32 s79, s79, 3
    s_lshl_b32 s79, s79, 19
    s_add_u32 s79, s79, s47
    s_add_u32 s46, s79, 0x200000
    s_add_u32 m0, s48, 0
    s_nop 0
    buffer_load_dwordx4 v82, s[28:31], s46 offen  lds
    s_add_u32 s46, s79, 0x220000
    s_add_u32 m0, s48, 4096
    s_nop 0
    buffer_load_dwordx4 v82, s[28:31], s46 offen  lds
    s_add_u32 s46, s79, 0x240000
    s_add_u32 m0, s48, 8192
    s_nop 0
    buffer_load_dwordx4 v82, s[28:31], s46 offen  lds
    s_add_u32 s46, s79, 0x260000
    s_add_u32 m0, s48, 12288
    s_nop 0
    buffer_load_dwordx4 v82, s[28:31], s46 offen  lds
    s_cmp_lg_u32 s44, 0
    s_cbranch_scc1 L_lw_24_0
    ds_read_b64_tr_b16 a[88:89], v80 offset:16384
    ds_read_b64_tr_b16 a[90:91], v80 offset:17408
    ds_read_b64_tr_b16 a[92:93], v80 offset:24576
    ds_read_b64_tr_b16 a[94:95], v80 offset:25600
    ds_read_b64_tr_b16 a[96:97], v81 offset:16384
    ds_read_b64_tr_b16 a[98:99], v81 offset:17408
    ds_read_b64_tr_b16 a[100:101], v81 offset:24576
    ds_read_b64_tr_b16 a[102:103], v81 offset:25600
    s_branch L_lw_24
L_lw_24_0:
    s_cmp_lg_u32 s44, 1
    s_cbranch_scc1 L_lw_24_1
    ds_read_b64_tr_b16 v[248:249], v80 offset:16384
    ds_read_b64_tr_b16 v[250:251], v80 offset:17408
    ds_read_b64_tr_b16 v[252:253], v80 offset:24576
    ds_read_b64_tr_b16 v[254:255], v80 offset:25600
    ds_read_b64_tr_b16 v[56:57], v81 offset:16384
    ds_read_b64_tr_b16 v[58:59], v81 offset:17408
    ds_read_b64_tr_b16 v[60:61], v81 offset:24576
    ds_read_b64_tr_b16 v[62:63], v81 offset:25600
    s_waitcnt lgkmcnt(0)
    ds_write_b128 v5, v[56:59] offset:22528
    ds_write_b128 v5, v[60:63] offset:23552
    s_branch L_lw_24
L_lw_24_1:
    s_cmp_lg_u32 s44, 2
    s_cbranch_scc1 L_lw_24_2
    ds_read_b64_tr_b16 v[144:145], v80 offset:16384
    ds_read_b64_tr_b16 v[146:147], v80 offset:17408
    ds_read_b64_tr_b16 v[148:149], v80 offset:24576
    ds_read_b64_tr_b16 v[150:151], v80 offset:25600
    ds_read_b64_tr_b16 v[152:153], v81 offset:16384
    ds_read_b64_tr_b16 v[154:155], v81 offset:17408
    ds_read_b64_tr_b16 v[156:157], v81 offset:24576
    ds_read_b64_tr_b16 v[158:159], v81 offset:25600
    s_branch L_lw_24
L_lw_24_2:
    ds_read_b64_tr_b16 a[192:193], v80 offset:16384
    ds_read_b64_tr_b16 a[194:195], v80 offset:17408
    ds_read_b64_tr_b16 a[196:197], v80 offset:24576
    ds_read_b64_tr_b16 a[198:199], v80 offset:25600
    ds_read_b64_tr_b16 a[200:201], v81 offset:16384
    ds_read_b64_tr_b16 a[202:203], v81 offset:17408
    ds_read_b64_tr_b16 a[204:205], v81 offset:24576
    ds_read_b64_tr_b16 a[206:207], v81 offset:25600
L_lw_24:
    s_waitcnt lgkmcnt(0)
    s_waitcnt vmcnt(8)
    s_barrier
    s_add_u32 s79, s41, 7
    s_and_b32 s79, s79, 3
    s_lshl_b32 s79, s79, 19
    s_add_u32 s79, s79, s47
    s_add_u32 s46, s79, 0x200000
    s_add_u32 m0, s48, 16384
    s_nop 0
    buffer_load_dwordx4 v82, s[28:31], s46 offen  lds
    s_add_u32 s46, s79, 0x220000
    s_add_u32 m0, s48, 20480
    s_nop 0
    buffer_load_dwordx4 v82, s[28:31], s46 offen  lds
    s_add_u32 s46, s79, 0x240000
    s_add_u32 m0, s48, 24576
    s_nop 0
    buffer_load_dwordx4 v82, s[28:31], s46 offen  lds
    s_add_u32 s46, s79, 0x260000
    s_add_u32 m0, s48, 28672
    s_nop 0
    buffer_load_dwordx4 v82, s[28:31], s46 offen  lds
    s_cmp_lg_u32 s44, 0
    s_cbranch_scc1 L_lw_25_0
    ds_read_b64_tr_b16 a[112:113], v80 offset:32768
    ds_read_b64_tr_b16 a[114:115], v80 offset:33792
    ds_read_b64_tr_b16 a[116:117], v80 offset:40960
    ds_read_b64_tr_b16 a[118:119], v80 offset:41984
    ds_read_b64_tr_b16 a[120:121], v81 offset:32768
    ds_read_b64_tr_b16 a[122:123], v81 offset:33792
    ds_read_b64_tr_b16 a[124:125], v81 offset:40960
    ds_read_b64_tr_b16 a[126:127], v81 offset:41984
    s_branch L_lw_25
L_lw_25_0:
    s_cmp_lg_u32 s44, 1
    s_cbranch_scc1 L_lw_25_1
    ds_read_b64_tr_b16 a[16:17], v80 offset:32768
    ds_read_b64_tr_b16 a[18:19], v80 offset:33792
    ds_read_b64_tr_b16 a[20:21], v80 offset:40960
    ds_read_b64_tr_b16 a[22:23], v80 offset:41984
    ds_read_b64_tr_b16 a[24:25], v81 offset:32768
    ds_read_b64_tr_b16 a[26:27], v81 offset:33792
    ds_read_b64_tr_b16 a[28:29], v81 offset:40960
    ds_read_b64_tr_b16 a[30:31], v81 offset:41984
    s_branch L_lw_25
L_lw_25_1:
    s_cmp_lg_u32 s44, 2
    s_cbranch_scc1 L_lw_25_2
    ds_read_b64_tr_b16 v[168:169], v80 offset:32768
    ds_read_b64_tr_b16 v[170:171], v80 offset:33792
    ds_read_b64_tr_b16 v[172:173], v80 offset:40960
    ds_read_b64_tr_b16 v[174:175], v80 offset:41984
    ds_read_b64_tr_b16 v[176:177], v81 offset:32768
    ds_read_b64_tr_b16 v[178:179], v81 offset:33792
    ds_read_b64_tr_b16 v[180:181], v81 offset:40960
    ds_read_b64_tr_b16 v[182:183], v81 offset:41984
    s_branch L_lw_25
L_lw_25_2:
    ds_read_b64_tr_b16 a[216:217], v80 offset:32768
    ds_read_b64_tr_b16 a[218:219], v80 offset:33792
    ds_read_b64_tr_b16 a[220:221], v80 offset:40960
    ds_read_b64_tr_b16 a[222:223], v80 offset:41984
    ds_read_b64_tr_b16 a[224:225], v81 offset:32768
    ds_read_b64_tr_b16 a[226:227], v81 offset:33792
    ds_read_b64_tr_b16 a[228:229], v81 offset:40960
    ds_read_b64_tr_b16 a[230:231], v81 offset:41984
L_lw_25:
    s_waitcnt lgkmcnt(0)
    s_waitcnt vmcnt(8)
    s_barrier
    s_add_u32 s79, s41, 8
    s_and_b32 s79, s79, 3
    s_lshl_b32 s79, s79, 19
    s_add_u32 s79, s79, s47
    s_add_u32 s46, s79, 0x400000
    s_add_u32 m0, s48, 32768
    s_nop 0
    buffer_load_dwordx4 v82, s[28:31], s46 offen  lds
    s_add_u32 s46, s79, 0x420000
    s_add_u32 m0, s48, 36864
    s_nop 0
    buffer_load_dwordx4 v82, s[28:31], s46 offen  lds
    s_add_u32 s46, s79, 0x440000
    s_add_u32 m0, s48, 40960
    s_nop 0
    buffer_load_dwordx4 v82, s[28:31], s46 offen  lds
    s_add_u32 s46, s79, 0x460000
    s_add_u32 m0, s48, 45056
    s_nop 0
    buffer_load_dwordx4 v82, s[28:31], s46 offen  lds
    s_cmp_lg_u32 s44, 0
    s_cbranch_scc1 L_lw_26_0
    ds_read_b64_tr_b16 a[136:137], v80 offset:49152
    ds_read_b64_tr_b16 a[138:139], v80 offset:50176
    ds_read_b64_tr_b16 a[140:141], v80 offset:57344
    ds_read_b64_tr_b16 a[142:143], v80 offset:58368
    ds_read_b64_tr_b16 a[144:145], v81 offset:49152
    ds_read_b64_tr_b16 a[146:147], v81 offset:50176
    ds_read_b64_tr_b16 a[148:149], v81 offset:57344
    ds_read_b64_tr_b16 a[150:151], v81 offset:58368
    s_branch L_lw_26
L_lw_26_0:
    s_cmp_lg_u32 s44, 1
    s_cbranch_scc1 L_lw_26_1
    ds_read_b64_tr_b16 a[48:49], v80 offset:49152
    ds_read_b64_tr_b16 a[50:51], v80 offset:50176
    ds_read_b64_tr_b16 a[52:53], v80 offset:57344
    ds_read_b64_tr_b16 a[54:55], v80 offset:58368
    ds_read_b64_tr_b16 a[56:57], v81 offset:49152
    ds_read_b64_tr_b16 a[58:59], v81 offset:50176
    ds_read_b64_tr_b16 a[60:61], v81 offset:57344
    ds_read_b64_tr_b16 a[62:63], v81 offset:58368
    s_branch L_lw_26
L_lw_26_1:
    s_cmp_lg_u32 s44, 2
    s_cbranch_scc1 L_lw_26_2
    ds_read_b64_tr_b16 v[200:201], v80 offset:49152
    ds_read_b64_tr_b16 v[202:203], v80 offset:50176
    ds_read_b64_tr_b16 v[204:205], v80 offset:57344
    ds_read_b64_tr_b16 v[206:207], v80 offset:58368
    ds_read_b64_tr_b16 v[56:57], v81 offset:49152
    ds_read_b64_tr_b16 v[58:59], v81 offset:50176
    ds_read_b64_tr_b16 v[60:61], v81 offset:57344
    ds_read_b64_tr_b16 v[62:63], v81 offset:58368
    s_waitcnt lgkmcnt(0)
    ds_write_b128 v5, v[56:59] offset:18432
    ds_write_b128 v5, v[60:63] offset:19456
    s_branch L_lw_26
L_lw_26_2:
    ds_read_b64_tr_b16 a[248:249], v80 offset:49152
    ds_read_b64_tr_b16 a[250:251], v80 offset:50176
    ds_read_b64_tr_b16 a[252:253], v80 offset:57344
    ds_read_b64_tr_b16 a[254:255], v80 offset:58368
    ds_read_b64_tr_b16 v[96:97], v81 offset:49152
    ds_read_b64_tr_b16 v[98:99], v81 offset:50176
    ds_read_b64_tr_b16 v[100:101], v81 offset:57344
    ds_read_b64_tr_b16 v[102:103], v81 offset:58368
L_lw_26:
    s_waitcnt lgkmcnt(0)
    s_waitcnt vmcnt(8)
    s_barrier
    s_add_u32 s79, s41, 9
    s_and_b32 s79, s79, 3
    s_lshl_b32 s79, s79, 19
    s_add_u32 s79, s79, s47
    s_add_u32 s46, s79, 0x400000
    s_add_u32 m0, s48, 49152
    s_nop 0
    buffer_load_dwordx4 v82, s[28:31], s46 offen  lds
    s_add_u32 s46, s79, 0x420000
    s_add_u32 m0, s48, 53248
    s_nop 0
    buffer_load_dwordx4 v82, s[28:31], s46 offen  lds
    s_add_u32 s46, s79, 0x440000
    s_add_u32 m0, s48, 57344
    s_nop 0
    buffer_load_dwordx4 v82, s[28:31], s46 offen  lds
    s_add_u32 s46, s79, 0x460000
    s_add_u32 m0, s48, 61440
    s_nop 0
    buffer_load_dwordx4 v82, s[28:31], s46 offen  lds
    s_cmp_lg_u32 s44, 0
    s_cbranch_scc1 L_lw_27_0
    ds_read_b64_tr_b16 a[160:161], v80 offset:0
    ds_read_b64_tr_b16 a[162:163], v80 offset:1024
    ds_read_b64_tr_b16 a[164:165], v80 offset:8192
    ds_read_b64_tr_b16 a[166:167], v80 offset:9216
    ds_read_b64_tr_b16 a[168:169], v81 offset:0
    ds_read_b64_tr_b16 a[170:171], v81 offset:1024
    ds_read_b64_tr_b16 a[172:173], v81 offset:8192
    ds_read_b64_tr_b16 a[174:175], v81 offset:9216
    s_branch L_lw_27
L_lw_27_0:
    s_cmp_lg_u32 s44, 1
    s_cbranch_scc1 L_lw_27_1
    ds_read_b64_tr_b16 a[72:73], v80 offset:0
    ds_read_b64_tr_b16 a[74:75], v80 offset:1024
    ds_read_b64_tr_b16 a[76:77], v80 offset:8192
    ds_read_b64_tr_b16 a[78:79], v80 offset:9216
    ds_read_b64_tr_b16 v[56:57], v81 offset:0
    ds_read_b64_tr_b16 v[58:59], v81 offset:1024
    ds_read_b64_tr_b16 v[60:61], v81 offset:8192
    ds_read_b64_tr_b16 v[62:63], v81 offset:9216
    s_waitcnt lgkmcnt(0)
    ds_write_b128 v5, v[56:59] offset:20480
    ds_write_b128 v5, v[60:63] offset:21504
    s_branch L_lw_27
L_lw_27_1:
    s_cmp_lg_u32 s44, 2
    s_cbranch_scc1 L_lw_27_2
    ds_read_b64_tr_b16 v[216:217], v80 offset:0
    ds_read_b64_tr_b16 v[218:219], v80 offset:1024
    ds_read_b64_tr_b16 v[220:221], v80 offset:8192
    ds_read_b64_tr_b16 v[222:223], v80 offset:9216
    ds_read_b64_tr_b16 v[224:225], v81 offset:0
    ds_read_b64_tr_b16 v[226:227], v81 offset:1024
    ds_read_b64_tr_b16 v[228:229], v81 offset:8192
    ds_read_b64_tr_b16 v[230:231], v81 offset:9216
    s_branch L_lw_27
L_lw_27_2:
    ds_read_b64_tr_b16 v[112:113], v80 offset:0
    ds_read_b64_tr_b16 v[114:115], v80 offset:1024
    ds_read_b64_tr_b16 v[116:117], v80 offset:8192
    ds_read_b64_tr_b16 v[118:119], v80 offset:9216
    ds_read_b64_tr_b16 v[120:121], v81 offset:0
    ds_read_b64_tr_b16 v[122:123], v81 offset:1024
    ds_read_b64_tr_b16 v[124:125], v81 offset:8192
    ds_read_b64_tr_b16 v[126:127], v81 offset:9216
L_lw_27:
    s_waitcnt lgkmcnt(0)
    s_waitcnt vmcnt(8)
    s_barrier
    s_add_u32 s79, s41, 10
    s_and_b32 s79, s79, 3
    s_lshl_b32 s79, s79, 19
    s_add_u32 s79, s79, s47
    s_add_u32 s46, s79, 0x400000
    s_add_u32 m0, s48, 0
    s_nop 0
    buffer_load_dwordx4 v82, s[28:31], s46 offen  lds
    s_add_u32 s46, s79, 0x420000
    s_add_u32 m0, s48, 4096
    s_nop 0
    buffer_load_dwordx4 v82, s[28:31], s46 offen  lds
    s_add_u32 s46, s79, 0x440000
    s_add_u32 m0, s48, 8192
    s_nop 0
    buffer_load_dwordx4 v82, s[28:31], s46 offen  lds
    s_add_u32 s46, s79, 0x460000
    s_add_u32 m0, s48, 12288
    s_nop 0
    buffer_load_dwordx4 v82, s[28:31], s46 offen  lds
    s_cmp_lg_u32 s44, 0
    s_cbranch_scc1 L_lw_28_0
    ds_read_b64_tr_b16 a[192:193], v80 offset:16384
    ds_read_b64_tr_b16 a[194:195], v80 offset:17408
    ds_read_b64_tr_b16 a[196:197], v80 offset:24576
    ds_read_b64_tr_b16 a[198:199], v80 offset:25600
    ds_read_b64_tr_b16 a[200:201], v81 offset:16384
    ds_read_b64_tr_b16 a[202:203], v81 offset:17408
    ds_read_b64_tr_b16 a[204:205], v81 offset:24576
    ds_read_b64_tr_b16 a[206:207], v81 offset:25600
    s_branch L_lw_28
L_lw_28_0:
    s_cmp_lg_u32 s44, 1
    s_cbranch_scc1 L_lw_28_1
    ds_read_b64_tr_b16 a[88:89], v80 offset:16384
    ds_read_b64_tr_b16 a[90:91], v80 offset:17408
    ds_read_b64_tr_b16 a[92:93], v80 offset:24576
    ds_read_b64_tr_b16 a[94:95], v80 offset:25600
    ds_read_b64_tr_b16 a[96:97], v81 offset:16384
    ds_read_b64_tr_b16 a[98:99], v81 offset:17408
    ds_read_b64_tr_b16 a[100:101], v81 offset:24576
    ds_read_b64_tr_b16 a[102:103], v81 offset:25600
    s_branch L_lw_28
L_lw_28_1:
    s_cmp_lg_u32 s44, 2
    s_cbranch_scc1 L_lw_28_2
    ds_read_b64_tr_b16 v[248:249], v80 offset:16384
    ds_read_b64_tr_b16 v[250:251], v80 offset:17408
    ds_read_b64_tr_b16 v[252:253], v80 offset:24576
    ds_read_b64_tr_b16 v[254:255], v80 offset:25600
    ds_read_b64_tr_b16 v[56:57], v81 offset:16384
    ds_read_b64_tr_b16 v[58:59], v81 offset:17408
    ds_read_b64_tr_b16 v[60:61], v81 offset:24576
    ds_read_b64_tr_b16 v[62:63], v81 offset:25600
    s_waitcnt lgkmcnt(0)
    ds_write_b128 v5, v[56:59] offset:22528
    ds_write_b128 v5, v[60:63] offset:23552
    s_branch L_lw_28
L_lw_28_2:
    ds_read_b64_tr_b16 v[144:145], v80 offset:16384
    ds_read_b64_tr_b16 v[146:147], v80 offset:17408
    ds_read_b64_tr_b16 v[148:149], v80 offset:24576
    ds_read_b64_tr_b16 v[150:151], v80 offset:25600
    ds_read_b64_tr_b16 v[152:153], v81 offset:16384
    ds_read_b64_tr_b16 v[154:155], v81 offset:17408
    ds_read_b64_tr_b16 v[156:157], v81 offset:24576
    ds_read_b64_tr_b16 v[158:159], v81 offset:25600
L_lw_28:
    s_waitcnt lgkmcnt(0)
    s_waitcnt vmcnt(8)
    s_barrier
    s_add_u32 s79, s41, 11
    s_and_b32 s79, s79, 3
    s_lshl_b32 s79, s79, 19
    s_add_u32 s79, s79, s47
    s_add_u32 s46, s79, 0x400000
    s_add_u32 m0, s48, 16384
    s_nop 0
    buffer_load_dwordx4 v82, s[28:31], s46 offen  lds
    s_add_u32 s46, s79, 0x420000
    s_add_u32 m0, s48, 20480
    s_nop 0
    buffer_load_dwordx4 v82, s[28:31], s46 offen  lds
    s_add_u32 s46, s79, 0x440000
    s_add_u32 m0, s48, 24576
    s_nop 0
    buffer_load_dwordx4 v82, s[28:31], s46 offen  lds
    s_add_u32 s46, s79, 0x460000
    s_add_u32 m0, s48, 28672
    s_nop 0
    buffer_load_dwordx4 v82, s[28:31], s46 offen  lds
    s_cmp_lg_u32 s44, 0
    s_cbranch_scc1 L_lw_29_0
    ds_read_b64_tr_b16 a[216:217], v80 offset:32768
    ds_read_b64_tr_b16 a[218:219], v80 offset:33792
    ds_read_b64_tr_b16 a[220:221], v80 offset:40960
    ds_read_b64_tr_b16 a[222:223], v80 offset:41984
    ds_read_b64_tr_b16 a[224:225], v81 offset:32768
    ds_read_b64_tr_b16 a[226:227], v81 offset:33792
    ds_read_b64_tr_b16 a[228:229], v81 offset:40960
    ds_read_b64_tr_b16 a[230:231], v81 offset:41984
    s_branch L_lw_29
L_lw_29_0:
    s_cmp_lg_u32 s44, 1
    s_cbranch_scc1 L_lw_29_1
    ds_read_b64_tr_b16 a[112:113], v80 offset:32768
    ds_read_b64_tr_b16 a[114:115], v80 offset:33792
    ds_read_b64_tr_b16 a[116:117], v80 offset:40960
    ds_read_b64_tr_b16 a[118:119], v80 offset:41984
    ds_read_b64_tr_b16 a[120:121], v81 offset:32768
    ds_read_b64_tr_b16 a[122:123], v81 offset:33792
    ds_read_b64_tr_b16 a[124:125], v81 offset:40960
    ds_read_b64_tr_b16 a[126:127], v81 offset:41984
    s_branch L_lw_29
L_lw_29_1:
    s_cmp_lg_u32 s44, 2
    s_cbranch_scc1 L_lw_29_2
    ds_read_b64_tr_b16 a[16:17], v80 offset:32768
    ds_read_b64_tr_b16 a[18:19], v80 offset:33792
    ds_read_b64_tr_b16 a[20:21], v80 offset:40960
    ds_read_b64_tr_b16 a[22:23], v80 offset:41984
    ds_read_b64_tr_b16 a[24:25], v81 offset:32768
    ds_read_b64_tr_b16 a[26:27], v81 offset:33792
    ds_read_b64_tr_b16 a[28:29], v81 offset:40960
    ds_read_b64_tr_b16 a[30:31], v81 offset:41984
    s_branch L_lw_29
L_lw_29_2:
    ds_read_b64_tr_b16 v[168:169], v80 offset:32768
    ds_read_b64_tr_b16 v[170:171], v80 offset:33792
    ds_read_b64_tr_b16 v[172:173], v80 offset:40960
    ds_read_b64_tr_b16 v[174:175], v80 offset:41984
    ds_read_b64_tr_b16 v[176:177], v81 offset:32768
    ds_read_b64_tr_b16 v[178:179], v81 offset:33792
    ds_read_b64_tr_b16 v[180:181], v81 offset:40960
    ds_read_b64_tr_b16 v[182:183], v81 offset:41984
L_lw_29:
    s_waitcnt lgkmcnt(0)
    s_waitcnt vmcnt(8)
    s_barrier
    s_add_u32 s79, s41, 12
    s_and_b32 s79, s79, 3
    s_lshl_b32 s79, s79, 19
    s_add_u32 s79, s79, s47
    s_add_u32 s46, s79, 0x600000
    s_add_u32 m0, s48, 32768
    s_nop 0
    buffer_load_dwordx4 v82, s[28:31], s46 offen  lds
    s_add_u32 s46, s79, 0x620000
    s_add_u32 m0, s48, 36864
    s_nop 0
    buffer_load_dwordx4 v82, s[28:31], s46 offen  lds
    s_add_u32 s46, s79, 0x640000
    s_add_u32 m0, s48, 40960
    s_nop 0
    buffer_load_dwordx4 v82, s[28:31], s46 offen  lds
    s_add_u32 s46, s79, 0x660000
    s_add_u32 m0, s48, 45056
    s_nop 0
    buffer_load_dwordx4 v82, s[28:31], s46 offen  lds
    s_cmp_lg_u32 s44, 0
    s_cbranch_scc1 L_lw_30_0
    ds_read_b64_tr_b16 a[248:249], v80 offset:49152
    ds_read_b64_tr_b16 a[250:251], v80 offset:50176
    ds_read_b64_tr_b16 a[252:253], v80 offset:57344
    ds_read_b64_tr_b16 a[254:255], v80 offset:58368
    ds_read_b64_tr_b16 v[96:97], v81 offset:49152
    ds_read_b64_tr_b16 v[98:99], v81 offset:50176
    ds_read_b64_tr_b16 v[100:101], v81 offset:57344
    ds_read_b64_tr_b16 v[102:103], v81 offset:58368
    s_branch L_lw_30
L_lw_30_0:
    s_cmp_lg_u32 s44, 1
    s_cbranch_scc1 L_lw_30_1
    ds_read_b64_tr_b16 a[136:137], v80 offset:49152
    ds_read_b64_tr_b16 a[138:139], v80 offset:50176
    ds_read_b64_tr_b16 a[140:141], v80 offset:57344
    ds_read_b64_tr_b16 a[142:143], v80 offset:58368
    ds_read_b64_tr_b16 a[144:145], v81 offset:49152
    ds_read_b64_tr_b16 a[146:147], v81 offset:50176
    ds_read_b64_tr_b16 a[148:149], v81 offset:57344
    ds_read_b64_tr_b16 a[150:151], v81 offset:58368
    s_branch L_lw_30
L_lw_30_1:
    s_cmp_lg_u32 s44, 2
    s_cbranch_scc1 L_lw_30_2
    ds_read_b64_tr_b16 a[48:49], v80 offset:49152
    ds_read_b64_tr_b16 a[50:51], v80 offset:50176
    ds_read_b64_tr_b16 a[52:53], v80 offset:57344
    ds_read_b64_tr_b16 a[54:55], v80 offset:58368
    ds_read_b64_tr_b16 a[56:57], v81 offset:49152
    ds_read_b64_tr_b16 a[58:59], v81 offset:50176
    ds_read_b64_tr_b16 a[60:61], v81 offset:57344
    ds_read_b64_tr_b16 a[62:63], v81 offset:58368
    s_branch L_lw_30
L_lw_30_2:
    ds_read_b64_tr_b16 v[200:201], v80 offset:49152
    ds_read_b64_tr_b16 v[202:203], v80 offset:50176
    ds_read_b64_tr_b16 v[204:205], v80 offset:57344
    ds_read_b64_tr_b16 v[206:207], v80 offset:58368
    ds_read_b64_tr_b16 v[56:57], v81 offset:49152
    ds_read_b64_tr_b16 v[58:59], v81 offset:50176
    ds_read_b64_tr_b16 v[60:61], v81 offset:57344
    ds_read_b64_tr_b16 v[62:63], v81 offset:58368
    s_waitcnt lgkmcnt(0)
    ds_write_b128 v5, v[56:59] offset:18432
    ds_write_b128 v5, v[60:63] offset:19456
L_lw_30:
    s_waitcnt lgkmcnt(0)
    s_waitcnt vmcnt(8)
    s_barrier
    s_add_u32 s79, s41, 13
    s_and_b32 s79, s79, 3
    s_lshl_b32 s79, s79, 19
    s_add_u32 s79, s79, s47
    s_add_u32 s46, s79, 0x600000
    s_add_u32 m0, s48, 49152
    s_nop 0
    buffer_load_dwordx4 v82, s[28:31], s46 offen  lds
    s_add_u32 s46, s79, 0x620000
    s_add_u32 m0, s48, 53248
    s_nop 0
    buffer_load_dwordx4 v82, s[28:31], s46 offen  lds
    s_add_u32 s46, s79, 0x640000
    s_add_u32 m0, s48, 57344
    s_nop 0
    buffer_load_dwordx4 v82, s[28:31], s46 offen  lds
    s_add_u32 s46, s79, 0x660000
    s_add_u32 m0, s48, 61440
    s_nop 0
    buffer_load_dwordx4 v82, s[28:31], s46 offen  lds
    s_cmp_lg_u32 s44, 0
    s_cbranch_scc1 L_lw_31_0
    ds_read_b64_tr_b16 v[112:113], v80 offset:0
    ds_read_b64_tr_b16 v[114:115], v80 offset:1024
    ds_read_b64_tr_b16 v[116:117], v80 offset:8192
    ds_read_b64_tr_b16 v[118:119], v80 offset:9216
    ds_read_b64_tr_b16 v[120:121], v81 offset:0
    ds_read_b64_tr_b16 v[122:123], v81 offset:1024
    ds_read_b64_tr_b16 v[124:125], v81 offset:8192
    ds_read_b64_tr_b16 v[126:127], v81 offset:9216
    s_branch L_lw_31
L_lw_31_0:
    s_cmp_lg_u32 s44, 1
    s_cbranch_scc1 L_lw_31_1
    ds_read_b64_tr_b16 a[160:161], v80 offset:0
    ds_read_b64_tr_b16 a[162:163], v80 offset:1024
    ds_read_b64_tr_b16 a[164:165], v80 offset:8192
    ds_read_b64_tr_b16 a[166:167], v80 offset:9216
    ds_read_b64_tr_b16 a[168:169], v81 offset:0
    ds_read_b64_tr_b16 a[170:171], v81 offset:1024
    ds_read_b64_tr_b16 a[172:173], v81 offset:8192
    ds_read_b64_tr_b16 a[174:175], v81 offset:9216
    s_branch L_lw_31
L_lw_31_1:
    s_cmp_lg_u32 s44, 2
    s_cbranch_scc1 L_lw_31_2
    ds_read_b64_tr_b16 a[72:73], v80 offset:0
    ds_read_b64_tr_b16 a[74:75], v80 offset:1024
    ds_read_b64_tr_b16 a[76:77], v80 offset:8192
    ds_read_b64_tr_b16 a[78:79], v80 offset:9216
    ds_read_b64_tr_b16 v[56:57], v81 offset:0
    ds_read_b64_tr_b16 v[58:59], v81 offset:1024
    ds_read_b64_tr_b16 v[60:61], v81 offset:8192
    ds_read_b64_tr_b16 v[62:63], v81 offset:9216
    s_waitcnt lgkmcnt(0)
    ds_write_b128 v5, v[56:59] offset:20480
    ds_write_b128 v5, v[60:63] offset:21504
    s_branch L_lw_31
L_lw_31_2:
    ds_read_b64_tr_b16 v[216:217], v80 offset:0
    ds_read_b64_tr_b16 v[218:219], v80 offset:1024
    ds_read_b64_tr_b16 v[220:221], v80 offset:8192
    ds_read_b64_tr_b16 v[222:223], v80 offset:9216
    ds_read_b64_tr_b16 v[224:225], v81 offset:0
    ds_read_b64_tr_b16 v[226:227], v81 offset:1024
    ds_read_b64_tr_b16 v[228:229], v81 offset:8192
    ds_read_b64_tr_b16 v[230:231], v81 offset:9216
L_lw_31:
    s_waitcnt lgkmcnt(0)
    s_waitcnt vmcnt(8)
    s_barrier
    s_add_u32 s79, s41, 14
    s_and_b32 s79, s79, 3
    s_lshl_b32 s79, s79, 19
    s_add_u32 s79, s79, s47
    s_add_u32 s46, s79, 0x600000
    s_add_u32 m0, s48, 0
    s_nop 0
    buffer_load_dwordx4 v82, s[28:31], s46 offen  lds
    s_add_u32 s46, s79, 0x620000
    s_add_u32 m0, s48, 4096
    s_nop 0
    buffer_load_dwordx4 v82, s[28:31], s46 offen  lds
    s_add_u32 s46, s79, 0x640000
    s_add_u32 m0, s48, 8192
    s_nop 0
    buffer_load_dwordx4 v82, s[28:31], s46 offen  lds
    s_add_u32 s46, s79, 0x660000
    s_add_u32 m0, s48, 12288
    s_nop 0
    buffer_load_dwordx4 v82, s[28:31], s46 offen  lds
    s_cmp_lg_u32 s44, 0
    s_cbranch_scc1 L_lw_32_0
    ds_read_b64_tr_b16 v[144:145], v80 offset:16384
    ds_read_b64_tr_b16 v[146:147], v80 offset:17408
    ds_read_b64_tr_b16 v[148:149], v80 offset:24576
    ds_read_b64_tr_b16 v[150:151], v80 offset:25600
    ds_read_b64_tr_b16 v[152:153], v81 offset:16384
    ds_read_b64_tr_b16 v[154:155], v81 offset:17408
    ds_read_b64_tr_b16 v[156:157], v81 offset:24576
    ds_read_b64_tr_b16 v[158:159], v81 offset:25600
    s_branch L_lw_32
L_lw_32_0:
    s_cmp_lg_u32 s44, 1
    s_cbranch_scc1 L_lw_32_1
    ds_read_b64_tr_b16 a[192:193], v80 offset:16384
    ds_read_b64_tr_b16 a[194:195], v80 offset:17408
    ds_read_b64_tr_b16 a[196:197], v80 offset:24576
    ds_read_b64_tr_b16 a[198:199], v80 offset:25600
    ds_read_b64_tr_b16 a[200:201], v81 offset:16384
    ds_read_b64_tr_b16 a[202:203], v81 offset:17408
    ds_read_b64_tr_b16 a[204:205], v81 offset:24576
    ds_read_b64_tr_b16 a[206:207], v81 offset:25600
    s_branch L_lw_32
L_lw_32_1:
    s_cmp_lg_u32 s44, 2
    s_cbranch_scc1 L_lw_32_2
    ds_read_b64_tr_b16 a[88:89], v80 offset:16384
    ds_read_b64_tr_b16 a[90:91], v80 offset:17408
    ds_read_b64_tr_b16 a[92:93], v80 offset:24576
    ds_read_b64_tr_b16 a[94:95], v80 offset:25600
    ds_read_b64_tr_b16 a[96:97], v81 offset:16384
    ds_read_b64_tr_b16 a[98:99], v81 offset:17408
    ds_read_b64_tr_b16 a[100:101], v81 offset:24576
    ds_read_b64_tr_b16 a[102:103], v81 offset:25600
    s_branch L_lw_32
L_lw_32_2:
    ds_read_b64_tr_b16 v[248:249], v80 offset:16384
    ds_read_b64_tr_b16 v[250:251], v80 offset:17408
    ds_read_b64_tr_b16 v[252:253], v80 offset:24576
    ds_read_b64_tr_b16 v[254:255], v80 offset:25600
    ds_read_b64_tr_b16 v[56:57], v81 offset:16384
    ds_read_b64_tr_b16 v[58:59], v81 offset:17408
    ds_read_b64_tr_b16 v[60:61], v81 offset:24576
    ds_read_b64_tr_b16 v[62:63], v81 offset:25600
    s_waitcnt lgkmcnt(0)
    ds_write_b128 v5, v[56:59] offset:22528
    ds_write_b128 v5, v[60:63] offset:23552
L_lw_32:
    s_waitcnt lgkmcnt(0)
    s_waitcnt vmcnt(8)
    s_barrier
    s_add_u32 s79, s41, 15
    s_and_b32 s79, s79, 3
    s_lshl_b32 s79, s79, 19
    s_add_u32 s79, s79, s47
    s_add_u32 s46, s79, 0x600000
    s_add_u32 m0, s48, 16384
    s_nop 0
    buffer_load_dwordx4 v82, s[28:31], s46 offen  lds
    s_add_u32 s46, s79, 0x620000
    s_add_u32 m0, s48, 20480
    s_nop 0
    buffer_load_dwordx4 v82, s[28:31], s46 offen  lds
    s_add_u32 s46, s79, 0x640000
    s_add_u32 m0, s48, 24576
    s_nop 0
    buffer_load_dwordx4 v82, s[28:31], s46 offen  lds
    s_add_u32 s46, s79, 0x660000
    s_add_u32 m0, s48, 28672
    s_nop 0
    buffer_load_dwordx4 v82, s[28:31], s46 offen  lds
    s_cmp_lg_u32 s44, 0
    s_cbranch_scc1 L_lw_33_0
    ds_read_b64_tr_b16 v[168:169], v80 offset:32768
    ds_read_b64_tr_b16 v[170:171], v80 offset:33792
    ds_read_b64_tr_b16 v[172:173], v80 offset:40960
    ds_read_b64_tr_b16 v[174:175], v80 offset:41984
    ds_read_b64_tr_b16 v[176:177], v81 offset:32768
    ds_read_b64_tr_b16 v[178:179], v81 offset:33792
    ds_read_b64_tr_b16 v[180:181], v81 offset:40960
    ds_read_b64_tr_b16 v[182:183], v81 offset:41984
    s_branch L_lw_33
L_lw_33_0:
    s_cmp_lg_u32 s44, 1
    s_cbranch_scc1 L_lw_33_1
    ds_read_b64_tr_b16 a[216:217], v80 offset:32768
    ds_read_b64_tr_b16 a[218:219], v80 offset:33792
    ds_read_b64_tr_b16 a[220:221], v80 offset:40960
    ds_read_b64_tr_b16 a[222:223], v80 offset:41984
    ds_read_b64_tr_b16 a[224:225], v81 offset:32768
    ds_read_b64_tr_b16 a[226:227], v81 offset:33792
    ds_read_b64_tr_b16 a[228:229], v81 offset:40960
    ds_read_b64_tr_b16 a[230:231], v81 offset:41984
    s_branch L_lw_33
L_lw_33_1:
    s_cmp_lg_u32 s44, 2
    s_cbranch_scc1 L_lw_33_2
    ds_read_b64_tr_b16 a[112:113], v80 offset:32768
    ds_read_b64_tr_b16 a[114:115], v80 offset:33792
    ds_read_b64_tr_b16 a[116:117], v80 offset:40960
    ds_read_b64_tr_b16 a[118:119], v80 offset:41984
    ds_read_b64_tr_b16 a[120:121], v81 offset:32768
    ds_read_b64_tr_b16 a[122:123], v81 offset:33792
    ds_read_b64_tr_b16 a[124:125], v81 offset:40960
    ds_read_b64_tr_b16 a[126:127], v81 offset:41984
    s_branch L_lw_33
L_lw_33_2:
    ds_read_b64_tr_b16 a[16:17], v80 offset:32768
    ds_read_b64_tr_b16 a[18:19], v80 offset:33792
    ds_read_b64_tr_b16 a[20:21], v80 offset:40960
    ds_read_b64_tr_b16 a[22:23], v80 offset:41984
    ds_read_b64_tr_b16 a[24:25], v81 offset:32768
    ds_read_b64_tr_b16 a[26:27], v81 offset:33792
    ds_read_b64_tr_b16 a[28:29], v81 offset:40960
    ds_read_b64_tr_b16 a[30:31], v81 offset:41984
L_lw_33:
    s_waitcnt lgkmcnt(0)
    s_waitcnt vmcnt(8)
    s_barrier
    s_cmp_lg_u32 s44, 0
    s_cbranch_scc1 L_lw_34_0
    ds_read_b64_tr_b16 v[200:201], v80 offset:49152
    ds_read_b64_tr_b16 v[202:203], v80 offset:50176
    ds_read_b64_tr_b16 v[204:205], v80 offset:57344
    ds_read_b64_tr_b16 v[206:207], v80 offset:58368
    ds_read_b64_tr_b16 v[56:57], v81 offset:49152
    ds_read_b64_tr_b16 v[58:59], v81 offset:50176
    ds_read_b64_tr_b16 v[60:61], v81 offset:57344
    ds_read_b64_tr_b16 v[62:63], v81 offset:58368
    s_waitcnt lgkmcnt(0)
    ds_write_b128 v5, v[56:59] offset:18432
    ds_write_b128 v5, v[60:63] offset:19456
    s_branch L_lw_34
L_lw_34_0:
    s_cmp_lg_u32 s44, 1
    s_cbranch_scc1 L_lw_34_1
    ds_read_b64_tr_b16 a[248:249], v80 offset:49152
    ds_read_b64_tr_b16 a[250:251], v80 offset:50176
    ds_read_b64_tr_b16 a[252:253], v80 offset:57344
    ds_read_b64_tr_b16 a[254:255], v80 offset:58368
    ds_read_b64_tr_b16 v[96:97], v81 offset:49152
    ds_read_b64_tr_b16 v[98:99], v81 offset:50176
    ds_read_b64_tr_b16 v[100:101], v81 offset:57344
    ds_read_b64_tr_b16 v[102:103], v81 offset:58368
    s_branch L_lw_34
L_lw_34_1:
    s_cmp_lg_u32 s44, 2
    s_cbranch_scc1 L_lw_34_2
    ds_read_b64_tr_b16 a[136:137], v80 offset:49152
    ds_read_b64_tr_b16 a[138:139], v80 offset:50176
    ds_read_b64_tr_b16 a[140:141], v80 offset:57344
    ds_read_b64_tr_b16 a[142:143], v80 offset:58368
    ds_read_b64_tr_b16 a[144:145], v81 offset:49152
    ds_read_b64_tr_b16 a[146:147], v81 offset:50176
    ds_read_b64_tr_b16 a[148:149], v81 offset:57344
    ds_read_b64_tr_b16 a[150:151], v81 offset:58368
    s_branch L_lw_34
L_lw_34_2:
    ds_read_b64_tr_b16 a[48:49], v80 offset:49152
    ds_read_b64_tr_b16 a[50:51], v80 offset:50176
    ds_read_b64_tr_b16 a[52:53], v80 offset:57344
    ds_read_b64_tr_b16 a[54:55], v80 offset:58368
    ds_read_b64_tr_b16 a[56:57], v81 offset:49152
    ds_read_b64_tr_b16 a[58:59], v81 offset:50176
    ds_read_b64_tr_b16 a[60:61], v81 offset:57344
    ds_read_b64_tr_b16 a[62:63], v81 offset:58368
L_lw_34:
    s_waitcnt lgkmcnt(0)
    s_waitcnt vmcnt(4)
    s_barrier
    s_cmp_lg_u32 s44, 0
    s_cbranch_scc1 L_lw_35_0
    ds_read_b64_tr_b16 v[216:217], v80 offset:0
    ds_read_b64_tr_b16 v[218:219], v80 offset:1024
    ds_read_b64_tr_b16 v[220:221], v80 offset:8192
    ds_read_b64_tr_b16 v[222:223], v80 offset:9216
    ds_read_b64_tr_b16 v[224:225], v81 offset:0
    ds_read_b64_tr_b16 v[226:227], v81 offset:1024
    ds_read_b64_tr_b16 v[228:229], v81 offset:8192
    ds_read_b64_tr_b16 v[230:231], v81 offset:9216
    s_branch L_lw_35
L_lw_35_0:
    s_cmp_lg_u32 s44, 1
    s_cbranch_scc1 L_lw_35_1
    ds_read_b64_tr_b16 v[112:113], v80 offset:0
    ds_read_b64_tr_b16 v[114:115], v80 offset:1024
    ds_read_b64_tr_b16 v[116:117], v80 offset:8192
    ds_read_b64_tr_b16 v[118:119], v80 offset:9216
    ds_read_b64_tr_b16 v[120:121], v81 offset:0
    ds_read_b64_tr_b16 v[122:123], v81 offset:1024
    ds_read_b64_tr_b16 v[124:125], v81 offset:8192
    ds_read_b64_tr_b16 v[126:127], v81 offset:9216
    s_branch L_lw_35
L_lw_35_1:
    s_cmp_lg_u32 s44, 2
    s_cbranch_scc1 L_lw_35_2
    ds_read_b64_tr_b16 a[160:161], v80 offset:0
    ds_read_b64_tr_b16 a[162:163], v80 offset:1024
    ds_read_b64_tr_b16 a[164:165], v80 offset:8192
    ds_read_b64_tr_b16 a[166:167], v80 offset:9216
    ds_read_b64_tr_b16 a[168:169], v81 offset:0
    ds_read_b64_tr_b16 a[170:171], v81 offset:1024
    ds_read_b64_tr_b16 a[172:173], v81 offset:8192
    ds_read_b64_tr_b16 a[174:175], v81 offset:9216
    s_branch L_lw_35
L_lw_35_2:
    ds_read_b64_tr_b16 a[72:73], v80 offset:0
    ds_read_b64_tr_b16 a[74:75], v80 offset:1024
    ds_read_b64_tr_b16 a[76:77], v80 offset:8192
    ds_read_b64_tr_b16 a[78:79], v80 offset:9216
    ds_read_b64_tr_b16 v[56:57], v81 offset:0
    ds_read_b64_tr_b16 v[58:59], v81 offset:1024
    ds_read_b64_tr_b16 v[60:61], v81 offset:8192
    ds_read_b64_tr_b16 v[62:63], v81 offset:9216
    s_waitcnt lgkmcnt(0)
    ds_write_b128 v5, v[56:59] offset:20480
    ds_write_b128 v5, v[60:63] offset:21504
L_lw_35:
    s_waitcnt lgkmcnt(0)
    s_waitcnt vmcnt(0)
    s_barrier
    s_cmp_lg_u32 s44, 0
    s_cbranch_scc1 L_lw_36_0
    ds_read_b64_tr_b16 v[248:249], v80 offset:16384
    ds_read_b64_tr_b16 v[250:251], v80 offset:17408
    ds_read_b64_tr_b16 v[252:253], v80 offset:24576
    ds_read_b64_tr_b16 v[254:255], v80 offset:25600
    ds_read_b64_tr_b16 v[56:57], v81 offset:16384
    ds_read_b64_tr_b16 v[58:59], v81 offset:17408
    ds_read_b64_tr_b16 v[60:61], v81 offset:24576
    ds_read_b64_tr_b16 v[62:63], v81 offset:25600
    s_waitcnt lgkmcnt(0)
    ds_write_b128 v5, v[56:59] offset:22528
    ds_write_b128 v5, v[60:63] offset:23552
    s_branch L_lw_36
L_lw_36_0:
    s_cmp_lg_u32 s44, 1
    s_cbranch_scc1 L_lw_36_1
    ds_read_b64_tr_b16 v[144:145], v80 offset:16384
    ds_read_b64_tr_b16 v[146:147], v80 offset:17408
    ds_read_b64_tr_b16 v[148:149], v80 offset:24576
    ds_read_b64_tr_b16 v[150:151], v80 offset:25600
    ds_read_b64_tr_b16 v[152:153], v81 offset:16384
    ds_read_b64_tr_b16 v[154:155], v81 offset:17408
    ds_read_b64_tr_b16 v[156:157], v81 offset:24576
    ds_read_b64_tr_b16 v[158:159], v81 offset:25600
    s_branch L_lw_36
L_lw_36_1:
    s_cmp_lg_u32 s44, 2
    s_cbranch_scc1 L_lw_36_2
    ds_read_b64_tr_b16 a[192:193], v80 offset:16384
    ds_read_b64_tr_b16 a[194:195], v80 offset:17408
    ds_read_b64_tr_b16 a[196:197], v80 offset:24576
    ds_read_b64_tr_b16 a[198:199], v80 offset:25600
    ds_read_b64_tr_b16 a[200:201], v81 offset:16384
    ds_read_b64_tr_b16 a[202:203], v81 offset:17408
    ds_read_b64_tr_b16 a[204:205], v81 offset:24576
    ds_read_b64_tr_b16 a[206:207], v81 offset:25600
    s_branch L_lw_36
L_lw_36_2:
    ds_read_b64_tr_b16 a[88:89], v80 offset:16384
    ds_read_b64_tr_b16 a[90:91], v80 offset:17408
    ds_read_b64_tr_b16 a[92:93], v80 offset:24576
    ds_read_b64_tr_b16 a[94:95], v80 offset:25600
    ds_read_b64_tr_b16 a[96:97], v81 offset:16384
    ds_read_b64_tr_b16 a[98:99], v81 offset:17408
    ds_read_b64_tr_b16 a[100:101], v81 offset:24576
    ds_read_b64_tr_b16 a[102:103], v81 offset:25600
L_lw_36:
    s_waitcnt lgkmcnt(0)
    s_barrier
    v_and_b32 v63, 15, v1
    v_lshrrev_b32 v64, 4, v1
    v_lshrrev_b32 v65, 5, v1
    v_lshlrev_b32 v65, 4, v65
    v_add_u32 v65, v65, v63
    v_lshlrev_b32 v65, 4, v65
    v_and_b32 v66, 1, v64
    v_lshlrev_b32 v66, 3, v66
    s_lshl_b32 s45, s44, 9
    s_add_u32 s45, s45, 53248
    v_add3_u32 v6, v65, v66, s45
    v_bfe_u32 v65, v1, 2, 2
    v_lshlrev_b32 v66, 3, v64
    v_add_u32 v65, v65, v66
    v_lshlrev_b32 v65, 4, v65
    v_and_b32 v66, 1, v1
    v_lshlrev_b32 v66, 3, v66
    v_add_u32 v65, v65, v66
    v_add_u32 v7, 53248, v65
    v_bfe_u32 v65, v1, 2, 1
    v_lshlrev_b32 v65, 4, v65
    v_bfe_u32 v66, v1, 3, 1
    v_lshlrev_b32 v66, 2, v66
    v_and_b32 v67, 3, v1
    v_add3_u32 v65, v65, v66, v67
    v_lshlrev_b32 v65, 5, v65
    v_lshlrev_b32 v66, 3, v64
    s_lshl_b32 s45, s44, 10
    s_add_u32 s45, s45, 55296
    v_add3_u32 v18, v65, v66, s45
    v_lshlrev_b32 v16, 3, v1
    v_lshlrev_b32 v8, 4, v1
    v_mov_b32 v14, v8
    v_lshrrev_b32 v65, 2, v1
    v_lshlrev_b32 v65, 4, v65
    v_and_b32 v66, 1, v1
    v_lshlrev_b32 v66, 3, v66
    s_lshl_b32 s45, s44, 11
    v_add3_u32 v65, v65, v66, s45
    v_and_b32 v66, 2, v1
    v_lshlrev_b32 v66, 7, v66
    v_add_u32 v9, v65, v66
    s_lshl_b32 s45, s43, 11
    s_lshl_b32 s46, s44, 9
    s_add_u32 s45, s45, s46
    s_add_u32 s51, s45, 0x7020000
    s_lshl_b32 s63, s43, 19
    s_add_u32 s63, s63, 0x3000000
    s_mov_b32 s50, 0
    s_lshl_b32 s64, s44, 11
    s_add_u32 s63, s63, s64
    s_add_u32 s64, s64, 16384
    s_add_u32 s65, s64, 8192
    s_lshl_b32 s66, s43, 12
    s_add_u32 s66, s66, 0x1000000
    s_mov_b32 s69, 16384
    s_mov_b32 s52, 0x3e0293ee
    v_and_b32 v19, 3, v1
    v_lshlrev_b32 v19, 10, v19
    s_lshl_b32 s45, s44, 12
    s_add_u32 s45, s45, 1020
    v_add_u32 v19, s45, v19
    v_mov_b32 v29, 128
    s_mov_b32 s46, 96
    s_mov_b64 exec, 1
    s_mov_b32 s70, 0
L_wp_37:
    buffer_load_dword v31, v29, s[16:19], 0 offen sc1
    s_add_u32 s70, s70, 1
    s_cmp_ge_u32 s70, 0x200000
    s_cbranch_scc1 L_c_done_1
    s_waitcnt vmcnt(0)
    v_cmp_gt_u32 vcc, s46, v31
    s_nop 1
    s_cbranch_vccz L_wp_37_ok
    s_sleep 2
    s_branch L_wp_37
L_wp_37_ok:
    s_mov_b64 exec, -1
    s_mov_b32 s47, 0
    s_cmp_lt_u32 s47, s50
    s_cbranch_scc1 L_kv_rdy_38
    s_lshl_b32 s45, s43, 7
    s_add_u32 s45, s45, 0x10014
    v_mov_b32 v0, 0
    s_mov_b32 s70, 0
L_kv_rdy_38_p:
    buffer_load_dwordx2 v[10:11], v0, s[12:15], s45 offen sc1
    s_add_u32 s70, s70, 1
    s_cmp_ge_u32 s70, 0x200000
    s_cbranch_scc1 L_c_done_1
    s_waitcnt vmcnt(0)
    v_min_u32 v10, v10, v11
    s_nop 0
    v_readfirstlane_b32 s50, v10
    s_nop 3
    s_cmp_lt_u32 s47, s50
    s_cbranch_scc1 L_kv_rdy_38
    s_sleep 2
    s_branch L_kv_rdy_38_p
L_kv_rdy_38:
    s_mov_b32 m0, s64
    s_add_u32 s46, s63, 0x1000000
    buffer_load_dwordx4 v14, s[12:15], s63 offen sc1 lds
    buffer_load_dwordx4 v14, s[12:15], s63 offen offset:1024 sc1 lds
    s_mov_b32 m0, s65
    s_add_u32 s63, s63, 8192
    buffer_load_dwordx4 v14, s[12:15], s46 offen sc1 lds
    buffer_load_dwordx4 v14, s[12:15], s46 offen offset:1024 sc1 lds
    s_add_u32 s64, s64, 16384
    s_add_u32 s65, s65, 16384
    s_mov_b32 s70, 0
    v_mov_b32 v41, 0
L_hw_39:
    buffer_load_dwordx2 v[44:45], v41, s[16:19], 0 offen sc1
    s_add_u32 s70, s70, 1
    s_cmp_ge_u32 s70, 0x100000
    s_cbranch_scc1 L_c_done_1
    s_waitcnt vmcnt(0)
    v_readfirstlane_b32 s45, v44
    v_readfirstlane_b32 s46, v45
    s_nop 3
    s_lshr_b32 s47, s46, 24
    s_cmp_lg_u32 s47, 64
    s_cbranch_scc1 L_hw_39
    s_lshr_b32 s68, s45, 24
    s_and_b32 s47, s45, 511
    s_mul_i32 s47, s47, s47
    s_bfe_u32 s45, s45, 0xf0009
    s_lshl_b32 s45, s45, 5
    s_sub_u32 s45, s45, s47
    s_and_b32 s47, s46, 511
    s_mul_i32 s47, s47, s47
    s_bfe_u32 s46, s46, 0xf0009
    s_lshl_b32 s46, s46, 5
    s_sub_u32 s46, s46, s47
    s_or_b32 s45, s45, s46
    s_cmp_eq_u32 s45, 0
    s_cselect_b32 s67, 1, 0
    s_mov_b32 s24, s12
    s_mov_b32 s25, s13
    s_mov_b32 s28, s12
    s_mov_b32 s29, s13
    s_cmp_eq_u32 s67, 1
    s_cselect_b32 s26, s14, 0
    s_cselect_b32 s30, 0, s14
    s_cmp_ge_u32 s68, 16
    s_cselect_b32 s68, 8192, 0
    s_mov_b32 s6, 0x0
    s_mov_b32 s7, 0xd5400000
    s_mov_b32 s60, 0
    s_lshl_b32 s58, s40, 16
    s_add_u32 s58, s58, 0x7000000
    s_mov_b32 s61, s58
    s_lshl_b32 s59, s40, 17
    s_add_u32 s59, s59, 0x7040000
    s_mov_b32 s62, s59
    s_add_u32 s32, s41, 0
    s_and_b32 s32, s32, 3
    s_lshl_b32 s32, s32, 10
    s_add_u32 s33, s41, 1
    s_and_b32 s33, s33, 3
    s_lshl_b32 s33, s33, 10
    s_add_u32 s34, s41, 2
    s_and_b32 s34, s34, 3
    s_lshl_b32 s34, s34, 10
    s_add_u32 s35, s41, 3
    s_and_b32 s35, s35, 3
    s_lshl_b32 s35, s35, 10
L_q_loop_40:
    ds_read_b128 v[56:59], v5 offset:8192
    ds_read_b128 v[60:63], v5 offset:9216
    ds_read_b128 v[64:67], v5 offset:20480
    ds_read_b128 v[68:71], v5 offset:21504
    ds_read_b128 v[72:75], v5 offset:16384
    ds_read_b128 v[76:79], v5 offset:17408
    ds_read_b128 v[80:83], v5 offset:4096
    ds_read_b128 v[84:87], v5 offset:5120
    ds_read_b128 v[88:91], v5 offset:6144
    ds_read_b128 v[92:95], v5 offset:7168
    s_add_u32 s46, s60, 1
    v_mov_b32 v15, s46
    v_mov_b32 v0, -1
    s_add_u32 s8, s61, s32
    s_add_u32 s9, s61, s33
    s_add_u32 s10, s61, s34
    s_add_u32 s11, s61, s35
    s_cmp_eq_u32 s60, 0
    s_cbranch_scc1 L_q_first_41
    s_sleep 16
    s_mov_b64 exec, 15
    buffer_load_dword v10, v19, s[12:15], s61 offen sc1
    s_nop 15
    buffer_load_dword v11, v19, s[12:15], s61 offen sc1
    s_nop 15
    buffer_load_dword v12, v19, s[12:15], s61 offen sc1
    s_nop 15
    buffer_load_dword v13, v19, s[12:15], s61 offen sc1
    s_mov_b32 s70, 0
L_pp_42:
    s_waitcnt vmcnt(3)
    v_cmp_eq_u32 vcc, -1, v10
    s_add_u32 s70, s70, 1
    s_nop 0
    s_cbranch_vccz L_ppd_43
    buffer_load_dword v10, v19, s[12:15], s61 offen sc1
    s_waitcnt vmcnt(3)
    v_cmp_eq_u32 vcc, -1, v11
    s_add_u32 s70, s70, 1
    s_nop 0
    s_cbranch_vccz L_ppd_43
    buffer_load_dword v11, v19, s[12:15], s61 offen sc1
    s_waitcnt vmcnt(3)
    v_cmp_eq_u32 vcc, -1, v12
    s_add_u32 s70, s70, 1
    s_nop 0
    s_cbranch_vccz L_ppd_43
    buffer_load_dword v12, v19, s[12:15], s61 offen sc1
    s_waitcnt vmcnt(3)
    v_cmp_eq_u32 vcc, -1, v13
    s_add_u32 s70, s70, 1
    s_nop 0
    s_cbranch_vccz L_ppd_43
    buffer_load_dword v13, v19, s[12:15], s61 offen sc1
    s_cmp_lt_u32 s70, 0x400000
    s_cbranch_scc1 L_pp_42
    s_branch L_c_done_1
L_ppd_43:
    s_mov_b64 exec, -1
L_q_first_41:
    s_waitcnt lgkmcnt(0)
    buffer_load_dwordx4 v[40:43], v3, s[12:15], s8 offen sc1
    v_mov_b32 v24, 0
    v_mov_b32 v25, 0
    v_mov_b32 v26, 0
    v_mov_b32 v27, 0
    v_mov_b32 v28, 0
    buffer_load_dwordx4 v[44:47], v3, s[12:15], s9 offen sc1
    v_mov_b32 v29, 0
    v_mov_b32 v30, 0
    v_mov_b32 v31, 0
    v_mov_b32 v32, 0
    v_mov_b32 v33, 0
    buffer_load_dwordx4 v[48:51], v3, s[12:15], s10 offen sc1
    v_mov_b32 v34, 0
    v_mov_b32 v35, 0
    v_mov_b32 v36, 0
    v_mov_b32 v37, 0
    v_mov_b32 v38, 0
    buffer_load_dwordx4 v[52:55], v3, s[12:15], s11 offen sc1
    s_mov_b32 s70, 0
    v_mov_b32 v39, 0
    s_waitcnt vmcnt(3)
    v_max3_u32 v22, v40, v41, v42
    ds_write_b128 v3, v[40:43] offset:0
    v_max_u32 v22, v22, v43
    v_cmp_eq_u32 vcc, -1, v22
    s_nop 0
    s_nop 0
    s_cbranch_vccnz L_mg_44_r0
L_mg_44_c0:
    v_smfmac_f32_16x16x64_bf16 v[24:27], v[40:43], a[0:7], v2
    s_waitcnt vmcnt(2)
    v_max3_u32 v22, v44, v45, v46
    v_smfmac_f32_16x16x64_bf16 v[28:31], v[40:43], a[8:15], v2
    ds_write_b128 v3, v[44:47] offset:1024
    v_max_u32 v22, v22, v47
    v_smfmac_f32_16x16x64_bf16 v[32:35], v[40:43], a[16:23], v2
    v_cmp_eq_u32 vcc, -1, v22
    v_smfmac_f32_16x16x64_bf16 v[36:39], v[40:43], a[24:31], v2
    s_nop 0
    s_cbranch_vccnz L_mg_44_r1
L_mg_44_c1:
    v_smfmac_f32_16x16x64_bf16 v[24:27], v[44:47], a[32:39], v2
    s_waitcnt vmcnt(1)
    v_max3_u32 v22, v48, v49, v50
    v_smfmac_f32_16x16x64_bf16 v[28:31], v[44:47], a[40:47], v2
    ds_write_b128 v3, v[48:51] offset:2048
    v_max_u32 v22, v22, v51
    v_smfmac_f32_16x16x64_bf16 v[32:35], v[44:47], a[48:55], v2
    v_cmp_eq_u32 vcc, -1, v22
    v_smfmac_f32_16x16x64_bf16 v[36:39], v[44:47], a[56:63], v2
    s_nop 0
    s_cbranch_vccnz L_mg_44_r2
L_mg_44_c2:
    s_waitcnt vmcnt(0)
    v_max3_u32 v22, v52, v53, v54
    ds_write_b128 v3, v[52:55] offset:3072
    v_max_u32 v22, v22, v55
    v_cmp_eq_u32 vcc, -1, v22
    s_waitcnt lgkmcnt(0)
    s_nop 0
    s_cbranch_vccnz L_mg_44_r3
L_mg_44_c3:
    s_barrier
    ds_read_b128 v[40:43], v4 offset:0
    ds_read_b128 v[44:47], v4 offset:1024
    v_smfmac_f32_16x16x64_bf16 v[24:27], v[48:51], a[64:71], v2
    v_smfmac_f32_16x16x64_bf16 v[28:31], v[48:51], v[56:63], v2
    ds_read_b128 v[56:59], v5 offset:14336
    v_smfmac_f32_16x16x64_bf16 v[32:35], v[48:51], a[72:79], v2
    ds_read_b128 v[60:63], v5 offset:15360
    v_smfmac_f32_16x16x64_bf16 v[36:39], v[48:51], v[64:71], v2
    ds_read_b128 v[48:51], v4 offset:2048
    v_smfmac_f32_16x16x64_bf16 v[24:27], v[52:55], a[80:87], v2
    ds_read_b128 v[64:67], v5 offset:2048
    v_smfmac_f32_16x16x64_bf16 v[28:31], v[52:55], v[72:79], v2
    ds_read_b128 v[68:71], v5 offset:3072
    v_smfmac_f32_16x16x64_bf16 v[32:35], v[52:55], a[88:95], v2
    ds_read_b128 v[72:75], v5 offset:12288
    v_smfmac_f32_16x16x64_bf16 v[36:39], v[52:55], a[96:103], v2
    ds_read_b128 v[52:55], v4 offset:3072
    s_waitcnt lgkmcnt(4)
    v_smfmac_f32_16x16x64_bf16 v[24:27], v[40:43], a[104:111], v2
    ds_read_b128 v[76:79], v5 offset:13312
    v_smfmac_f32_16x16x64_bf16 v[28:31], v[40:43], v[80:87], v2
    ds_read_b128 v[80:83], v5 offset:0
    v_smfmac_f32_16x16x64_bf16 v[32:35], v[40:43], a[112:119], v2
    ds_read_b128 v[84:87], v5 offset:1024
    v_smfmac_f32_16x16x64_bf16 v[36:39], v[40:43], a[120:127], v2
    ds_read_b128 v[40:43], v21 offset:0
    v_smfmac_f32_16x16x64_bf16 v[24:27], v[44:47], a[128:135], v2
    v_smfmac_f32_16x16x64_bf16 v[28:31], v[44:47], v[88:95], v2
    ds_read_b128 v[88:91], v5 offset:10240
    v_smfmac_f32_16x16x64_bf16 v[32:35], v[44:47], a[136:143], v2
    ds_read_b128 v[92:95], v5 offset:11264
    v_smfmac_f32_16x16x64_bf16 v[36:39], v[44:47], a[144:151], v2
    ds_read_b128 v[44:47], v21 offset:1024
    v_smfmac_f32_16x16x64_bf16 v[24:27], v[48:51], a[152:159], v2
    v_smfmac_f32_16x16x64_bf16 v[28:31], v[48:51], v[56:63], v2
    ds_read_b128 v[48:51], v21 offset:2048
    s_waitcnt lgkmcnt(3)
    v_smfmac_f32_16x16x64_bf16 v[24:27], v[52:55], a[176:183], v2
    ds_read_b128 v[56:59], v5 offset:22528
    v_smfmac_f32_16x16x64_bf16 v[28:31], v[52:55], a[184:191], v2
    ds_read_b128 v[52:55], v21 offset:3072
    v_smfmac_f32_16x16x64_bf16 v[24:27], v[40:43], a[208:215], v2
    ds_read_b128 v[60:63], v5 offset:23552
    v_smfmac_f32_16x16x64_bf16 v[28:31], v[40:43], v[64:71], v2
    ds_read_b128 v[40:43], v23 offset:0
    s_waitcnt lgkmcnt(4)
    v_smfmac_f32_16x16x64_bf16 v[24:27], v[44:47], a[232:239], v2
    ds_read_b128 v[64:67], v5 offset:18432
    v_smfmac_f32_16x16x64_bf16 v[28:31], v[44:47], a[240:247], v2
    ds_read_b128 v[44:47], v23 offset:1024
    v_smfmac_f32_16x16x64_bf16 v[24:27], v[48:51], v[104:111], v2
    ds_read_b128 v[68:71], v5 offset:19456
    v_smfmac_f32_16x16x64_bf16 v[28:31], v[48:51], v[72:79], v2
    ds_read_b128 v[48:51], v23 offset:2048
    s_waitcnt lgkmcnt(4)
    v_smfmac_f32_16x16x64_bf16 v[24:27], v[52:55], v[128:135], v2
    v_smfmac_f32_16x16x64_bf16 v[28:31], v[52:55], v[136:143], v2
    ds_read_b128 v[52:55], v23 offset:3072
    v_smfmac_f32_16x16x64_bf16 v[24:27], v[40:43], v[160:167], v2
    v_smfmac_f32_16x16x64_bf16 v[28:31], v[40:43], v[80:87], v2
    s_waitcnt lgkmcnt(1)
    v_smfmac_f32_16x16x64_bf16 v[24:27], v[44:47], v[184:191], v2
    v_smfmac_f32_16x16x64_bf16 v[28:31], v[44:47], v[192:199], v2
    v_smfmac_f32_16x16x64_bf16 v[24:27], v[48:51], v[208:215], v2
    v_smfmac_f32_16x16x64_bf16 v[28:31], v[48:51], v[88:95], v2
    s_waitcnt lgkmcnt(0)
    v_smfmac_f32_16x16x64_bf16 v[24:27], v[52:55], v[232:239], v2
    v_smfmac_f32_16x16x64_bf16 v[28:31], v[52:55], v[240:247], v2
    v_smfmac_f32_16x16x64_bf16 v[32:35], v[52:55], v[248:255], v2
    ds_read_b128 v[72:75], v8 offset:20480
    v_smfmac_f32_16x16x64_bf16 v[36:39], v[52:55], v[56:63], v2
    ds_read_b128 v[52:55], v21 offset:3072
    v_smfmac_f32_16x16x64_bf16 v[32:35], v[48:51], v[216:223], v2
    ds_read_b128 v[76:79], v8 offset:21504
    s_nop 1
    v_permlane32_swap_b32 v24, v28
    v_smfmac_f32_16x16x64_bf16 v[36:39], v[48:51], v[224:231], v2
    ds_read_b128 v[48:51], v21 offset:2048
    v_permlane32_swap_b32 v25, v29
    v_smfmac_f32_16x16x64_bf16 v[32:35], v[44:47], v[200:207], v2
    v_permlane32_swap_b32 v26, v30
    v_permlane32_swap_b32 v27, v31
    v_smfmac_f32_16x16x64_bf16 v[36:39], v[44:47], v[64:71], v2
    ds_read_b128 v[44:47], v21 offset:1024
    v_add_f32 v24, v24, v28
    v_smfmac_f32_16x16x64_bf16 v[32:35], v[40:43], v[168:175], v2
    v_add_f32 v25, v25, v29
    v_add_f32 v26, v26, v30
    v_smfmac_f32_16x16x64_bf16 v[36:39], v[40:43], v[176:183], v2
    ds_read_b128 v[40:43], v21 offset:0
    v_add_f32 v27, v27, v31
    s_waitcnt lgkmcnt(2)
    v_smfmac_f32_16x16x64_bf16 v[32:35], v[52:55], v[144:151], v2
    v_cvt_pk_bf16_f32 v24, v24, v25
    v_cvt_pk_bf16_f32 v25, v26, v27
    v_smfmac_f32_16x16x64_bf16 v[36:39], v[52:55], v[152:159], v2
    ds_read_b128 v[52:55], v4 offset:3072
    ds_write_b64 v6, v[24:25]
    v_smfmac_f32_16x16x64_bf16 v[32:35], v[48:51], v[112:119], v2
    ds_read_b128 v[56:59], v8 offset:16384
    ds_read_b128 v[60:63], v8 offset:17408
    v_smfmac_f32_16x16x64_bf16 v[36:39], v[48:51], v[120:127], v2
    ds_read_b128 v[48:51], v4 offset:2048
    s_waitcnt lgkmcnt(5)
    v_smfmac_f32_16x16x64_bf16 v[32:35], v[44:47], a[248:255], v2
    ds_read_b128 v[64:67], v8 offset:18432
    ds_read_b128 v[68:71], v8 offset:19456
    v_smfmac_f32_16x16x64_bf16 v[36:39], v[44:47], v[96:103], v2
    s_waitcnt lgkmcnt(5)
    s_barrier
    ds_read_b64_tr_b16 v[80:81], v7 offset:0
    v_smfmac_f32_16x16x64_bf16 v[32:35], v[40:43], a[216:223], v2
    ds_read_b64_tr_b16 v[82:83], v7 offset:64
    ds_read_b64_tr_b16 v[84:85], v7 offset:512
    v_smfmac_f32_16x16x64_bf16 v[36:39], v[40:43], a[224:231], v2
    ds_read_b64_tr_b16 v[86:87], v7 offset:576
    ds_read_b64_tr_b16 v[88:89], v7 offset:1024
    v_smfmac_f32_16x16x64_bf16 v[32:35], v[52:55], a[192:199], v2
    ds_read_b64_tr_b16 v[90:91], v7 offset:1088
    v_smfmac_f32_16x16x64_bf16 v[36:39], v[52:55], a[200:207], v2
    ds_read_b64_tr_b16 v[92:93], v7 offset:1536
    s_waitcnt lgkmcnt(6)
    v_smfmac_f32_16x16x64_bf16 v[32:35], v[48:51], a[160:167], v2
    ds_read_b64_tr_b16 v[94:95], v7 offset:1600
    v_smfmac_f32_16x16x64_bf16 v[36:39], v[48:51], a[168:175], v2
    s_waitcnt lgkmcnt(3)
    v_mfma_f32_16x16x32_bf16 v[24:27], v[56:59], v[80:83], 0
    ds_read_b128 v[56:59], v8 offset:22528
    v_mfma_f32_16x16x32_bf16 v[28:31], v[60:63], v[80:83], 0
    ds_read_b128 v[60:63], v8 offset:23552
    v_mfma_f32_16x16x32_bf16 v[24:27], v[64:67], v[84:87], v[24:27]
    s_nop 1
    v_cvt_pk_bf16_f32 v32, v32, v33
    v_cvt_pk_bf16_f32 v33, v34, v35
    v_cvt_pk_bf16_f32 v34, v36, v37
    v_cvt_pk_bf16_f32 v35, v38, v39
    ds_write2_b64 v18, v[32:33], v[34:35] offset1:32
    v_mfma_f32_16x16x32_bf16 v[28:31], v[68:71], v[84:87], v[28:31]
    s_waitcnt lgkmcnt(3)
    v_mfma_f32_16x16x32_bf16 v[24:27], v[72:75], v[88:91], v[24:27]
    ds_read_b64_tr_b16 v[64:65], v9 offset:24576
    v_mfma_f32_16x16x32_bf16 v[28:31], v[76:79], v[88:91], v[28:31]
    ds_read_b64_tr_b16 v[66:67], v9 offset:25600
    s_waitcnt lgkmcnt(3)
    v_mfma_f32_16x16x32_bf16 v[24:27], v[56:59], v[92:95], v[24:27]
    ds_read_b64_tr_b16 v[68:69], v9 offset:25088
    v_mfma_f32_16x16x32_bf16 v[28:31], v[60:63], v[92:95], v[28:31]
    ds_read_b64_tr_b16 v[70:71], v9 offset:26112
    v_mov_b32 v57, 0
    v_mov_b32 v58, 0
    s_waitcnt lgkmcnt(4)
    s_barrier
    ds_read_b64_tr_b16 v[40:41], v16 offset:55296
    ds_read_b64_tr_b16 v[42:43], v16 offset:55808
    ds_read_b64_tr_b16 v[44:45], v16 offset:56320
    ds_read_b64_tr_b16 v[46:47], v16 offset:56832
    ds_read_b64_tr_b16 v[48:49], v16 offset:57344
    ds_read_b64_tr_b16 v[50:51], v16 offset:57856
    ds_read_b64_tr_b16 v[52:53], v16 offset:58368
    ds_read_b64_tr_b16 v[54:55], v16 offset:58880
    s_cmp_eq_u32 s60, 63
    s_cbranch_scc1 L_q_last_45
    v_max3_f32 v11, v24, v25, v26
    v_max3_f32 v13, v27, v28, v29
    s_waitcnt lgkmcnt(4)
    v_mfma_f32_16x16x32_bf16 v[36:39], v[40:43], v[80:83], 0
    v_max3_f32 v11, v11, v30, v31
    v_max_f32 v11, v11, v13
    v_mfma_f32_16x16x32_bf16 v[36:39], v[44:47], v[84:87], v[36:39]
    v_mul_f32 v10, s52, v11
    s_waitcnt lgkmcnt(0)
    v_mfma_f32_16x16x32_bf16 v[36:39], v[48:51], v[88:91], v[36:39]
    v_fma_f32 v24, v24, s52, -v10
    v_fma_f32 v25, v25, s52, -v10
    v_mfma_f32_16x16x32_bf16 v[36:39], v[52:55], v[92:95], v[36:39]
    v_fma_f32 v26, v26, s52, -v10
    v_fma_f32 v27, v27, s52, -v10
    v_fma_f32 v28, v28, s52, -v10
    v_fma_f32 v29, v29, s52, -v10
    v_fma_f32 v30, v30, s52, -v10
    v_fma_f32 v31, v31, s52, -v10
    v_exp_f32 v24, v24
    v_exp_f32 v25, v25
    v_permlane32_swap_b32 v36, v38
    v_permlane32_swap_b32 v37, v39
    v_pk_add_f32 v[36:37], v[36:37], v[38:39]
    v_max3_f32 v12, v36, v37, v11
    v_max3_f32 v13, v36, v37, v11
    v_exp_f32 v26, v26
    v_exp_f32 v27, v27
    buffer_load_dwordx2 v[0:1], v16, s[12:15], s51 offen sc1
    v_permlane32_swap_b32 v12, v13
    v_max_f32 v22, v12, v13
    v_max_f32 v13, v12, v13
    v_exp_f32 v28, v28
    v_exp_f32 v29, v29
    v_permlane16_swap_b32 v22, v13
    v_max_f32 v12, v22, v13
    v_mul_f32 v12, s52, v12
    v_sub_f32 v10, v10, v12
    v_pk_fma_f32 v[36:37], v[36:37], s[52:53], v[12:13] op_sel_hi:[1,0,0] neg_lo:[0,0,1] neg_hi:[0,0,1]
    v_exp_f32 v10, v10
    v_exp_f32 v30, v30
    v_exp_f32 v31, v31
    v_exp_f32 v36, v36
    v_exp_f32 v37, v37
    v_pk_mul_f32 v[24:25], v[24:25], v[10:11] op_sel_hi:[1,0]
    v_pk_mul_f32 v[26:27], v[26:27], v[10:11] op_sel_hi:[1,0]
    v_pk_mul_f32 v[28:29], v[28:29], v[10:11] op_sel_hi:[1,0]
    v_pk_mul_f32 v[30:31], v[30:31], v[10:11] op_sel_hi:[1,0]
    v_cvt_pk_bf16_f32 v60, v24, v25
    v_cvt_pk_bf16_f32 v61, v26, v27
    v_cvt_pk_bf16_f32 v62, v28, v29
    v_cvt_pk_bf16_f32 v63, v30, v31
    v_cvt_pk_bf16_f32 v56, v36, v37
    v_cvt_pk_bf16_f32 v59, v36, v37
    buffer_store_dword v15, v20, s[24:27], 0 offen
    v_mfma_f32_16x16x32_bf16 v[72:75], v[64:67], v[60:63], 0
    v_add_f32 v10, v24, v25
    v_add_f32 v11, v26, v27
    v_mfma_f32_16x16x32_bf16 v[76:79], v[68:71], v[60:63], 0
    v_add_f32 v10, v10, v28
    s_waitcnt vmcnt(1)
L_q_vm_46:
    v_max_u32 v22, v0, v1
    v_cmp_eq_u32 vcc, -1, v22
    v_add_f32 v12, v11, v29
    v_add_f32 v13, v10, v30
    s_cbranch_vccnz L_q_vm_46_r
    v_mfma_f32_16x16x16_bf16 v[72:75], v[0:1], v[56:57], v[72:75]
    v_add_f32 v11, v12, v31
    v_add_f32 v10, v13, v36
    v_mfma_f32_16x16x16_bf16 v[76:79], v[0:1], v[58:59], v[76:79]
    v_add_f32 v11, v11, v37
    v_add_f32 v12, v10, v11
    v_add_f32 v13, v10, v11
    s_nop 1
    v_permlane32_swap_b32 v12, v13
    v_add_f32 v22, v12, v13
    v_add_f32 v13, v12, v13
    s_nop 1
    v_permlane16_swap_b32 v22, v13
    v_add_f32 v12, v22, v13
    v_rcp_f32 v12, v12
    s_nop 0
    v_pk_mul_f32 v[72:73], v[72:73], v[12:13] op_sel_hi:[1,0]
    v_pk_mul_f32 v[74:75], v[74:75], v[12:13] op_sel_hi:[1,0]
    v_pk_mul_f32 v[76:77], v[76:77], v[12:13] op_sel_hi:[1,0]
    v_pk_mul_f32 v[78:79], v[78:79], v[12:13] op_sel_hi:[1,0]
    v_cvt_pk_bf16_f32 v72, v72, v73
    v_cvt_pk_bf16_f32 v73, v74, v75
    v_cvt_pk_bf16_f32 v74, v76, v77
    v_cvt_pk_bf16_f32 v75, v78, v79
    buffer_store_dwordx4 v[72:75], v17, s[24:27], s62 offen
    buffer_store_dwordx4 v[72:75], v17, s[28:31], s62 offen sc1
    buffer_store_dword v15, v20, s[28:31], 0 offen sc1
    v_mov_b32 v60, -1
    v_mov_b32 v61, -1
    v_mov_b32 v62, -1
    v_mov_b32 v63, -1
    s_add_u32 s45, s60, 3
    s_and_b32 s45, s45, 3
    s_lshl_b32 s45, s45, 15
    s_add_u32 s45, s45, s59
    buffer_store_dwordx4 v[60:63], v17, s[24:27], s45 offen
    buffer_store_dwordx4 v[60:63], v17, s[28:31], s45 offen sc1
L_q_last_45:
    s_waitcnt lgkmcnt(0)
    v_lshlrev_b32 v22, 1, v16
    s_cmp_lg_u32 s44, 0
    s_cbranch_scc1 L_q_km_47_0
    buffer_store_dwordx4 v[40:43], v22, s[12:15], s66 offen offset:0 sc1
L_q_km_47_0:
    s_cmp_lg_u32 s44, 1
    s_cbranch_scc1 L_q_km_47_1
    buffer_store_dwordx4 v[44:47], v22, s[12:15], s66 offen offset:1024 sc1
L_q_km_47_1:
    s_cmp_lg_u32 s44, 2
    s_cbranch_scc1 L_q_km_47_2
    buffer_store_dwordx4 v[48:51], v22, s[12:15], s66 offen offset:2048 sc1
L_q_km_47_2:
    s_cmp_lg_u32 s44, 3
    s_cbranch_scc1 L_q_km_47_3
    buffer_store_dwordx4 v[52:55], v22, s[12:15], s66 offen offset:3072 sc1
L_q_km_47_3:
    s_cmp_eq_u32 s60, 63
    s_cbranch_scc1 L_q_fin_48
    s_cmp_eq_u32 s60, 62
    s_cbranch_scc1 L_q_fin_48_n
    s_add_u32 s47, s60, 1
    s_cmp_lt_u32 s47, s50
    s_cbranch_scc1 L_kv_rdy_49
    s_lshl_b32 s45, s43, 7
    s_add_u32 s45, s45, 0x10014
    v_mov_b32 v0, 0
    s_mov_b32 s70, 0
L_kv_rdy_49_p:
    buffer_load_dwordx2 v[10:11], v0, s[12:15], s45 offen sc1
    s_add_u32 s70, s70, 1
    s_cmp_ge_u32 s70, 0x200000
    s_cbranch_scc1 L_c_done_1
    s_waitcnt vmcnt(0)
    v_min_u32 v10, v10, v11
    s_nop 0
    v_readfirstlane_b32 s50, v10
    s_nop 3
    s_cmp_lt_u32 s47, s50
    s_cbranch_scc1 L_kv_rdy_49
    s_sleep 2
    s_branch L_kv_rdy_49_p
L_kv_rdy_49:
    s_mov_b32 m0, s64
    s_add_u32 s46, s63, 0x1000000
    buffer_load_dwordx4 v14, s[12:15], s63 offen sc1 lds
    buffer_load_dwordx4 v14, s[12:15], s63 offen offset:1024 sc1 lds
    s_mov_b32 m0, s65
    s_add_u32 s63, s63, 8192
    buffer_load_dwordx4 v14, s[12:15], s46 offen sc1 lds
    buffer_load_dwordx4 v14, s[12:15], s46 offen offset:1024 sc1 lds
L_q_fin_48_n:
    s_add_u32 s47, s60, 1
    s_bitcmp1_b64 s[6:7], s47
    s_cselect_b32 s47, s47, s60
    s_cbranch_scc0 L_q_fin_48_m
    s_waitcnt vmcnt(0)
L_q_fin_48_m:
    v_mov_b32 v22, s47
    v_mov_b32 v0, 0
    s_mov_b64 exec, 1
    buffer_store_dword v22, v0, s[12:15], s3 offen sc1
    s_mov_b64 exec, -1
    s_mov_b64 exec, -1
    v_add_u32 v8, s69, v8
    v_add_u32 v9, s69, v9
    s_sub_u32 s64, s64, s69
    s_sub_u32 s65, s65, s69
    s_sub_u32 s69, 0, s69
    s_add_u32 s66, s66, 131072
    s_xor_b32 s51, s51, 65536
    s_add_u32 s60, s60, 1
    s_and_b32 s45, s60, 3
    s_lshl_b32 s46, s45, 14
    s_add_u32 s61, s58, s46
    s_lshl_b32 s46, s45, 15
    s_add_u32 s62, s59, s46
    s_branch L_q_loop_40
L_q_fin_48:
    s_waitcnt vmcnt(0)
    v_mov_b32 v22, 64
    v_mov_b32 v0, 0
    s_mov_b64 exec, 1
    buffer_store_dword v22, v0, s[12:15], s3 offen sc1
    s_mov_b64 exec, -1
    s_endpgm
L_q_vm_46_r:
    buffer_load_dwordx2 v[0:1], v16, s[12:15], s51 offen sc1
    s_add_u32 s70, s70, 1
    s_cmp_lt_u32 s70, 0x100000
    s_waitcnt vmcnt(0)
    s_cbranch_scc1 L_q_vm_46
    s_endpgm
L_mg_44_r0:
    buffer_load_dwordx4 v[40:43], v3, s[12:15], s8 offen sc1
    buffer_load_dwordx4 v[44:47], v3, s[12:15], s9 offen sc1
    buffer_load_dwordx4 v[48:51], v3, s[12:15], s10 offen sc1
    buffer_load_dwordx4 v[52:55], v3, s[12:15], s11 offen sc1
    s_add_u32 s70, s70, 1
    s_cmp_ge_u32 s70, 0x100000
    s_cbranch_scc1 L_c_done_1
    s_waitcnt vmcnt(3)
    ds_write_b128 v3, v[40:43] offset:0
    v_max3_u32 v22, v40, v41, v42
    v_max_u32 v22, v22, v43
    v_cmp_eq_u32 vcc, -1, v22
    s_waitcnt lgkmcnt(0)
    s_nop 0
    s_cbranch_vccnz L_mg_44_r0
    s_branch L_mg_44_c0
L_mg_44_r1:
    buffer_load_dwordx4 v[44:47], v3, s[12:15], s9 offen sc1
    buffer_load_dwordx4 v[48:51], v3, s[12:15], s10 offen sc1
    buffer_load_dwordx4 v[52:55], v3, s[12:15], s11 offen sc1
    s_add_u32 s70, s70, 1
    s_cmp_ge_u32 s70, 0x100000
    s_cbranch_scc1 L_c_done_1
    s_waitcnt vmcnt(2)
    ds_write_b128 v3, v[44:47] offset:1024
    v_max3_u32 v22, v44, v45, v46
    v_max_u32 v22, v22, v47
    v_cmp_eq_u32 vcc, -1, v22
    s_waitcnt lgkmcnt(0)
    s_nop 0
    s_cbranch_vccnz L_mg_44_r1
    s_branch L_mg_44_c1
L_mg_44_r2:
    buffer_load_dwordx4 v[48:51], v3, s[12:15], s10 offen sc1
    buffer_load_dwordx4 v[52:55], v3, s[12:15], s11 offen sc1
    s_add_u32 s70, s70, 1
    s_cmp_ge_u32 s70, 0x100000
    s_cbranch_scc1 L_c_done_1
    s_waitcnt vmcnt(1)
    ds_write_b128 v3, v[48:51] offset:2048
    v_max3_u32 v22, v48, v49, v50
    v_max_u32 v22, v22, v51
    v_cmp_eq_u32 vcc, -1, v22
    s_waitcnt lgkmcnt(0)
    s_nop 0
    s_cbranch_vccnz L_mg_44_r2
    s_branch L_mg_44_c2
L_mg_44_r3:
    buffer_load_dwordx4 v[52:55], v3, s[12:15], s11 offen sc1
    s_add_u32 s70, s70, 1
    s_cmp_ge_u32 s70, 0x100000
    s_cbranch_scc1 L_c_done_1
    s_waitcnt vmcnt(0)
    ds_write_b128 v3, v[52:55] offset:3072
    v_max3_u32 v22, v52, v53, v54
    v_max_u32 v22, v22, v55
    v_cmp_eq_u32 vcc, -1, v22
    s_waitcnt lgkmcnt(0)
    s_nop 0
    s_cbranch_vccnz L_mg_44_r3
    s_branch L_mg_44_c3
L_c_vo_2:
    s_lshl_b32 s45, s43, 11
    s_lshl_b32 s46, s44, 9
    s_add_u32 s45, s45, s46
    v_lshlrev_b32 v10, 3, v1
    v_add_u32 v10, s45, v10
    v_lshlrev_b32 v11, 3, v0
    v_bfe_u32 v69, v1, 4, 1
    v_lshlrev_b32 v69, 2, v69
    v_lshrrev_b32 v63, 5, v1
    v_lshlrev_b32 v63, 1, v63
    v_and_b32 v64, 1, v1
    v_add3_u32 v69, v69, v63, v64
    v_bfe_u32 v63, v1, 1, 1
    v_lshlrev_b32 v63, 3, v63
    v_add_u32 v63, v63, v69
    v_lshlrev_b32 v63, 4, v63
    v_bfe_u32 v64, v1, 2, 2
    v_lshlrev_b32 v64, 2, v64
    s_lshl_b32 s45, s42, 10
    s_lshl_b32 s46, s44, 8
    s_add_u32 s45, s45, s46
    v_add3_u32 v12, v63, v64, s45
    v_and_b32 v64, 1, v1
    v_cmp_eq_u32 vcc, 0, v64
    v_mov_b32 v9, 0x07060302
    v_mov_b32 v63, 0x01000504
    v_cndmask_b32 v9, v9, v63, vcc
    s_lshl_b32 s63, s40, 19
    s_lshl_b32 s45, s42, 15
    s_add_u32 s63, s63, s45
    s_add_u32 s63, s63, 0x7100000
    s_xor_b32 s64, s63, 524288
    s_lshl_b32 s45, s40, 12
    s_lshl_b32 s46, s44, 9
    s_add_u32 s45, s45, s46
    s_lshl_b32 s46, s42, 2
    s_add_u32 s45, s45, s46
    s_add_u32 s45, s45, 0x7082000
    v_lshlrev_b32 v20, 7, v1
    v_add_u32 v20, s45, v20
    v_mov_b32 v63, 0x20000000
    v_cmp_gt_u32 vcc, 4, v1
    s_nop 1
    v_cndmask_b32 v20, v63, v20, vcc
    buffer_store_dword v44, v20, s[12:15], 0 offen sc1
    s_mov_b32 s45, 0x7020000
    buffer_store_dwordx2 v[40:41], v10, s[12:15], s45 offen sc1
    s_mov_b32 s45, 0x7030000
    buffer_store_dwordx2 v[40:41], v10, s[12:15], s45 offen sc1
    s_add_u32 s45, s63, 0
    buffer_store_dwordx2 v[40:41], v11, s[12:15], s45 offen sc1
    s_add_u32 s45, s63, 4096
    buffer_store_dwordx2 v[40:41], v11, s[12:15], s45 offen sc1
    s_add_u32 s45, s63, 8192
    buffer_store_dwordx2 v[40:41], v11, s[12:15], s45 offen sc1
    s_add_u32 s45, s63, 12288
    buffer_store_dwordx2 v[40:41], v11, s[12:15], s45 offen sc1
    s_add_u32 s45, s63, 16384
    buffer_store_dwordx2 v[40:41], v11, s[12:15], s45 offen sc1
    s_add_u32 s45, s63, 20480
    buffer_store_dwordx2 v[40:41], v11, s[12:15], s45 offen sc1
    s_add_u32 s45, s63, 24576
    buffer_store_dwordx2 v[40:41], v11, s[12:15], s45 offen sc1
    s_add_u32 s45, s63, 28672
    buffer_store_dwordx2 v[40:41], v11, s[12:15], s45 offen sc1
    s_lshl_b32 s61, s40, 16
    s_add_u32 s61, s61, 0x7000000
    s_add_u32 s45, s61, 16384
    buffer_store_dword v40, v12, s[12:15], s45 offen sc1
    s_add_u32 s45, s61, 32768
    buffer_store_dword v40, v12, s[12:15], s45 offen sc1
    s_add_u32 s45, s61, 49152
    buffer_store_dword v40, v12, s[12:15], s45 offen sc1
    v_lshlrev_b32 v63, 11, v69
    v_and_b32 v64, 14, v1
    v_lshlrev_b32 v64, 1, v64
    v_add_u32 v63, v63, v64
    s_lshl_b32 s45, s42, 7
    s_lshl_b32 s46, s44, 5
    s_add_u32 s45, s45, s46
    buffer_load_dword v45, v63, s[52:55], s45 offen
    s_mov_b32 s76, -1
    s_mov_b32 s77, -1
    v_lshrrev_b32 v63, 3, v1
    v_lshlrev_b32 v63, 11, v63
    v_bfe_u32 v64, v1, 1, 2
    v_and_b32 v65, 1, v1
    v_lshlrev_b32 v65, 4, v65
    v_add_u32 v63, v63, v65
    v_xor_b32 v66, 0, v64
    v_lshlrev_b32 v66, 5, v66
    v_add_u32 v70, v63, v66
    v_xor_b32 v66, 1, v64
    v_lshlrev_b32 v66, 5, v66
    v_add_u32 v71, v63, v66
    v_xor_b32 v66, 2, v64
    v_lshlrev_b32 v66, 5, v66
    v_add_u32 v72, v63, v66
    v_xor_b32 v66, 3, v64
    v_lshlrev_b32 v66, 5, v66
    v_add_u32 v73, v63, v66
    v_bfe_u32 v63, v1, 3, 1
    v_lshlrev_b32 v63, 1, v63
    v_bfe_u32 v64, v1, 4, 1
    v_add_u32 v63, v63, v64
    v_lshlrev_b32 v64, 3, v63
    v_lshrrev_b32 v65, 5, v1
    v_lshlrev_b32 v65, 2, v65
    v_add_u32 v64, v64, v65
    v_bfe_u32 v65, v1, 2, 1
    v_add_u32 v64, v64, v65
    v_lshlrev_b32 v64, 7, v64
    v_and_b32 v65, 3, v1
    v_lshlrev_b32 v65, 3, v65
    v_add_u32 v64, v64, v65
    s_lshl_b32 s45, s44, 12
    v_add_u32 v64, s45, v64
    s_add_u32 s45, s44, 1
    s_and_b32 s45, s45, 3
    v_xor_b32 v65, s45, v63
    v_lshlrev_b32 v65, 5, v65
    v_add_u32 v74, v64, v65
    s_mul_i32 s45, s44, 20480
    s_add_u32 s45, s45, 65536
    v_add_u32 v88, s45, v74
    s_add_u32 s45, s44, 2
    s_and_b32 s45, s45, 3
    v_xor_b32 v65, s45, v63
    v_lshlrev_b32 v65, 5, v65
    v_add_u32 v75, v64, v65
    s_mul_i32 s45, s44, 20480
    s_add_u32 s45, s45, 65536
    v_add_u32 v89, s45, v75
    s_add_u32 s45, s44, 3
    s_and_b32 s45, s45, 3
    v_xor_b32 v65, s45, v63
    v_lshlrev_b32 v65, 5, v65
    v_add_u32 v76, v64, v65
    s_mul_i32 s45, s44, 20480
    s_add_u32 s45, s45, 65536
    v_add_u32 v90, s45, v76
    s_add_u32 s45, s44, 4
    s_and_b32 s45, s45, 3
    v_xor_b32 v65, s45, v63
    v_lshlrev_b32 v65, 5, v65
    v_add_u32 v77, v64, v65
    s_mul_i32 s45, s44, 20480
    s_add_u32 s45, s45, 65536
    v_add_u32 v91, s45, v77
    s_mul_i32 s65, s44, 24576
    s_lshl_b32 s49, s40, 22
    s_lshl_b32 s45, s44, 20
    s_add_u32 s49, s49, s45
    s_lshl_b32 s45, s42, 7
    s_add_u32 s49, s49, s45
    s_lshl_b32 s50, s44, 12
    s_mul_i32 s69, s42, 1
    s_add_u32 s51, s69, 0
    s_and_b32 s51, s51, 7
    s_lshl_b32 s51, s51, 17
    s_add_u32 s51, s51, s49
    s_add_u32 s46, s51, 0x0
    s_add_u32 m0, s65, 65536
    s_nop 0
    buffer_load_dwordx4 v70, s[36:39], s46 offen  lds
    s_add_u32 s46, s51, 0x8000
    s_add_u32 m0, s65, 66560
    s_nop 0
    buffer_load_dwordx4 v71, s[36:39], s46 offen  lds
    s_add_u32 s46, s51, 0x10000
    s_add_u32 m0, s65, 67584
    s_nop 0
    buffer_load_dwordx4 v72, s[36:39], s46 offen  lds
    s_add_u32 s46, s51, 0x18000
    s_add_u32 m0, s65, 68608
    s_nop 0
    buffer_load_dwordx4 v73, s[36:39], s46 offen  lds
    s_add_u32 s51, s69, 0
    s_and_b32 s51, s51, 7
    s_lshl_b32 s51, s51, 17
    s_add_u32 s51, s51, s49
    s_add_u32 s46, s51, 0x4000
    s_add_u32 m0, s65, 69632
    s_nop 0
    buffer_load_dwordx4 v70, s[36:39], s46 offen  lds
    s_add_u32 s46, s51, 0xc000
    s_add_u32 m0, s65, 70656
    s_nop 0
    buffer_load_dwordx4 v71, s[36:39], s46 offen  lds
    s_add_u32 s46, s51, 0x14000
    s_add_u32 m0, s65, 71680
    s_nop 0
    buffer_load_dwordx4 v72, s[36:39], s46 offen  lds
    s_add_u32 s46, s51, 0x1c000
    s_add_u32 m0, s65, 72704
    s_nop 0
    buffer_load_dwordx4 v73, s[36:39], s46 offen  lds
    s_add_u32 s51, s69, 1
    s_and_b32 s51, s51, 7
    s_lshl_b32 s51, s51, 17
    s_add_u32 s51, s51, s49
    s_add_u32 s46, s51, 0x0
    s_add_u32 m0, s65, 73728
    s_nop 0
    buffer_load_dwordx4 v70, s[36:39], s46 offen  lds
    s_add_u32 s46, s51, 0x8000
    s_add_u32 m0, s65, 74752
    s_nop 0
    buffer_load_dwordx4 v71, s[36:39], s46 offen  lds
    s_add_u32 s46, s51, 0x10000
    s_add_u32 m0, s65, 75776
    s_nop 0
    buffer_load_dwordx4 v72, s[36:39], s46 offen  lds
    s_add_u32 s46, s51, 0x18000
    s_add_u32 m0, s65, 76800
    s_nop 0
    buffer_load_dwordx4 v73, s[36:39], s46 offen  lds
    s_add_u32 s51, s69, 1
    s_and_b32 s51, s51, 7
    s_lshl_b32 s51, s51, 17
    s_add_u32 s51, s51, s49
    s_add_u32 s46, s51, 0x4000
    s_add_u32 m0, s65, 77824
    s_nop 0
    buffer_load_dwordx4 v70, s[36:39], s46 offen  lds
    s_add_u32 s46, s51, 0xc000
    s_add_u32 m0, s65, 78848
    s_nop 0
    buffer_load_dwordx4 v71, s[36:39], s46 offen  lds
    s_add_u32 s46, s51, 0x14000
    s_add_u32 m0, s65, 79872
    s_nop 0
    buffer_load_dwordx4 v72, s[36:39], s46 offen  lds
    s_add_u32 s46, s51, 0x1c000
    s_add_u32 m0, s65, 80896
    s_nop 0
    buffer_load_dwordx4 v73, s[36:39], s46 offen  lds
    s_add_u32 s51, s69, 2
    s_and_b32 s51, s51, 7
    s_lshl_b32 s51, s51, 17
    s_add_u32 s51, s51, s49
    s_add_u32 s46, s51, 0x0
    s_add_u32 m0, s65, 81920
    s_nop 0
    buffer_load_dwordx4 v70, s[36:39], s46 offen  lds
    s_add_u32 s46, s51, 0x8000
    s_add_u32 m0, s65, 82944
    s_nop 0
    buffer_load_dwordx4 v71, s[36:39], s46 offen  lds
    s_add_u32 s46, s51, 0x10000
    s_add_u32 m0, s65, 83968
    s_nop 0
    buffer_load_dwordx4 v72, s[36:39], s46 offen  lds
    s_add_u32 s46, s51, 0x18000
    s_add_u32 m0, s65, 84992
    s_nop 0
    buffer_load_dwordx4 v73, s[36:39], s46 offen  lds
    s_add_u32 s51, s69, 2
    s_and_b32 s51, s51, 7
    s_lshl_b32 s51, s51, 17
    s_add_u32 s51, s51, s49
    s_add_u32 s46, s51, 0x4000
    s_add_u32 m0, s65, 86016
    s_nop 0
    buffer_load_dwordx4 v70, s[36:39], s46 offen  lds
    s_add_u32 s46, s51, 0xc000
    s_add_u32 m0, s65, 87040
    s_nop 0
    buffer_load_dwordx4 v71, s[36:39], s46 offen  lds
    s_add_u32 s46, s51, 0x14000
    s_add_u32 m0, s65, 88064
    s_nop 0
    buffer_load_dwordx4 v72, s[36:39], s46 offen  lds
    s_add_u32 s46, s51, 0x1c000
    s_add_u32 m0, s65, 89088
    s_nop 0
    buffer_load_dwordx4 v73, s[36:39], s46 offen  lds
    s_add_u32 s51, s69, 3
    s_and_b32 s51, s51, 7
    s_lshl_b32 s51, s51, 17
    s_add_u32 s51, s51, s49
    s_add_u32 s46, s51, 0x0
    s_add_u32 m0, s50, 0
    s_nop 0
    buffer_load_dwordx4 v70, s[36:39], s46 offen  lds
    s_add_u32 s46, s51, 0x8000
    s_add_u32 m0, s50, 1024
    s_nop 0
    buffer_load_dwordx4 v71, s[36:39], s46 offen  lds
    s_add_u32 s46, s51, 0x10000
    s_add_u32 m0, s50, 2048
    s_nop 0
    buffer_load_dwordx4 v72, s[36:39], s46 offen  lds
    s_add_u32 s46, s51, 0x18000
    s_add_u32 m0, s50, 3072
    s_nop 0
    buffer_load_dwordx4 v73, s[36:39], s46 offen  lds
    s_add_u32 s51, s69, 3
    s_and_b32 s51, s51, 7
    s_lshl_b32 s51, s51, 17
    s_add_u32 s51, s51, s49
    s_add_u32 s46, s51, 0x4000
    s_add_u32 m0, s50, 16384
    s_nop 0
    buffer_load_dwordx4 v70, s[36:39], s46 offen  lds
    s_add_u32 s46, s51, 0xc000
    s_add_u32 m0, s50, 17408
    s_nop 0
    buffer_load_dwordx4 v71, s[36:39], s46 offen  lds
    s_add_u32 s46, s51, 0x14000
    s_add_u32 m0, s50, 18432
    s_nop 0
    buffer_load_dwordx4 v72, s[36:39], s46 offen  lds
    s_add_u32 s46, s51, 0x1c000
    s_add_u32 m0, s50, 19456
    s_nop 0
    buffer_load_dwordx4 v73, s[36:39], s46 offen  lds
    s_add_u32 s51, s69, 4
    s_and_b32 s51, s51, 7
    s_lshl_b32 s51, s51, 17
    s_add_u32 s51, s51, s49
    s_add_u32 s46, s51, 0x0
    s_add_u32 m0, s50, 32768
    s_nop 0
    buffer_load_dwordx4 v70, s[36:39], s46 offen  lds
    s_add_u32 s46, s51, 0x8000
    s_add_u32 m0, s50, 33792
    s_nop 0
    buffer_load_dwordx4 v71, s[36:39], s46 offen  lds
    s_add_u32 s46, s51, 0x10000
    s_add_u32 m0, s50, 34816
    s_nop 0
    buffer_load_dwordx4 v72, s[36:39], s46 offen  lds
    s_add_u32 s46, s51, 0x18000
    s_add_u32 m0, s50, 35840
    s_nop 0
    buffer_load_dwordx4 v73, s[36:39], s46 offen  lds
    s_add_u32 s51, s69, 4
    s_and_b32 s51, s51, 7
    s_lshl_b32 s51, s51, 17
    s_add_u32 s51, s51, s49
    s_add_u32 s46, s51, 0x4000
    s_add_u32 m0, s50, 49152
    s_nop 0
    buffer_load_dwordx4 v70, s[36:39], s46 offen  lds
    s_add_u32 s46, s51, 0xc000
    s_add_u32 m0, s50, 50176
    s_nop 0
    buffer_load_dwordx4 v71, s[36:39], s46 offen  lds
    s_add_u32 s46, s51, 0x14000
    s_add_u32 m0, s50, 51200
    s_nop 0
    buffer_load_dwordx4 v72, s[36:39], s46 offen  lds
    s_add_u32 s46, s51, 0x1c000
    s_add_u32 m0, s50, 52224
    s_nop 0
    buffer_load_dwordx4 v73, s[36:39], s46 offen  lds
    s_waitcnt vmcnt(40)
    v_min_u32 v45, -2, v45
    buffer_store_dword v45, v12, s[12:15], s61 offen sc1
    s_waitcnt vmcnt(36)
    s_barrier
    ds_read_b64_tr_b16 a[160:161], v88 offset:0
    ds_read_b64_tr_b16 a[162:163], v88 offset:256
    ds_read_b64_tr_b16 a[168:169], v89 offset:0
    ds_read_b64_tr_b16 a[170:171], v89 offset:256
    ds_read_b64_tr_b16 a[176:177], v90 offset:0
    ds_read_b64_tr_b16 a[178:179], v90 offset:256
    ds_read_b64_tr_b16 a[184:185], v91 offset:0
    ds_read_b64_tr_b16 a[186:187], v91 offset:256
L_lw_50:
    s_waitcnt lgkmcnt(0)
    s_cmp_lg_u32 s44, 0
    s_cbranch_scc1 L_v_probe_51
    s_add_u32 s45, s63, 0
    s_memtime s[72:73]
    s_waitcnt lgkmcnt(0)
    s_load_dword s78, s[20:21], s45
    s_waitcnt lgkmcnt(0)
    s_memtime s[74:75]
    s_waitcnt lgkmcnt(0)
    s_sub_u32 s45, s74, s72
    s_min_u32 s76, s76, s45
    s_cmp_lt_u32 s77, s76
    s_cselect_b32 s68, 1, 0
L_v_probe_51:
    s_waitcnt vmcnt(32)
    s_barrier
    s_add_u32 s51, s69, 5
    s_and_b32 s51, s51, 7
    s_lshl_b32 s51, s51, 17
    s_add_u32 s51, s51, s49
    s_add_u32 s46, s51, 0x0
    s_add_u32 m0, s65, 65536
    s_nop 0
    buffer_load_dwordx4 v70, s[36:39], s46 offen  lds
    s_add_u32 s46, s51, 0x8000
    s_add_u32 m0, s65, 66560
    s_nop 0
    buffer_load_dwordx4 v71, s[36:39], s46 offen  lds
    s_add_u32 s46, s51, 0x10000
    s_add_u32 m0, s65, 67584
    s_nop 0
    buffer_load_dwordx4 v72, s[36:39], s46 offen  lds
    s_add_u32 s46, s51, 0x18000
    s_add_u32 m0, s65, 68608
    s_nop 0
    buffer_load_dwordx4 v73, s[36:39], s46 offen  lds
    ds_read_b64_tr_b16 a[164:165], v88 offset:4096
    ds_read_b64_tr_b16 a[166:167], v88 offset:4352
    ds_read_b64_tr_b16 a[172:173], v89 offset:4096
    ds_read_b64_tr_b16 a[174:175], v89 offset:4352
    ds_read_b64_tr_b16 a[180:181], v90 offset:4096
    ds_read_b64_tr_b16 a[182:183], v90 offset:4352
    ds_read_b64_tr_b16 a[188:189], v91 offset:4096
    ds_read_b64_tr_b16 a[190:191], v91 offset:4352
L_lw_52:
    s_waitcnt lgkmcnt(0)
    s_cmp_lg_u32 s44, 0
    s_cbranch_scc1 L_v_probe_53
    s_add_u32 s45, s63, 8192
    s_memtime s[72:73]
    s_waitcnt lgkmcnt(0)
    s_load_dword s78, s[20:21], s45
    s_waitcnt lgkmcnt(0)
    s_memtime s[74:75]
    s_waitcnt lgkmcnt(0)
    s_sub_u32 s45, s74, s72
    s_min_u32 s77, s77, s45
    s_cmp_lt_u32 s77, s76
    s_cselect_b32 s68, 1, 0
L_v_probe_53:
    s_waitcnt vmcnt(32)
    s_barrier
    s_add_u32 s51, s69, 5
    s_and_b32 s51, s51, 7
    s_lshl_b32 s51, s51, 17
    s_add_u32 s51, s51, s49
    s_add_u32 s46, s51, 0x4000
    s_add_u32 m0, s65, 69632
    s_nop 0
    buffer_load_dwordx4 v70, s[36:39], s46 offen  lds
    s_add_u32 s46, s51, 0xc000
    s_add_u32 m0, s65, 70656
    s_nop 0
    buffer_load_dwordx4 v71, s[36:39], s46 offen  lds
    s_add_u32 s46, s51, 0x14000
    s_add_u32 m0, s65, 71680
    s_nop 0
    buffer_load_dwordx4 v72, s[36:39], s46 offen  lds
    s_add_u32 s46, s51, 0x1c000
    s_add_u32 m0, s65, 72704
    s_nop 0
    buffer_load_dwordx4 v73, s[36:39], s46 offen  lds
    ds_read_b64_tr_b16 a[192:193], v88 offset:8192
    ds_read_b64_tr_b16 a[194:195], v88 offset:8448
    ds_read_b64_tr_b16 a[200:201], v89 offset:8192
    ds_read_b64_tr_b16 a[202:203], v89 offset:8448
    ds_read_b64_tr_b16 a[208:209], v90 offset:8192
    ds_read_b64_tr_b16 a[210:211], v90 offset:8448
    ds_read_b64_tr_b16 a[216:217], v91 offset:8192
    ds_read_b64_tr_b16 a[218:219], v91 offset:8448
L_lw_54:
    s_waitcnt lgkmcnt(0)
    s_cmp_lg_u32 s44, 0
    s_cbranch_scc1 L_v_probe_55
    s_add_u32 s45, s63, 128
    s_memtime s[72:73]
    s_waitcnt lgkmcnt(0)
    s_load_dword s78, s[20:21], s45
    s_waitcnt lgkmcnt(0)
    s_memtime s[74:75]
    s_waitcnt lgkmcnt(0)
    s_sub_u32 s45, s74, s72
    s_min_u32 s76, s76, s45
    s_cmp_lt_u32 s77, s76
    s_cselect_b32 s68, 1, 0
L_v_probe_55:
    s_waitcnt vmcnt(32)
    s_barrier
    s_add_u32 s51, s69, 6
    s_and_b32 s51, s51, 7
    s_lshl_b32 s51, s51, 17
    s_add_u32 s51, s51, s49
    s_add_u32 s46, s51, 0x0
    s_add_u32 m0, s65, 73728
    s_nop 0
    buffer_load_dwordx4 v70, s[36:39], s46 offen  lds
    s_add_u32 s46, s51, 0x8000
    s_add_u32 m0, s65, 74752
    s_nop 0
    buffer_load_dwordx4 v71, s[36:39], s46 offen  lds
    s_add_u32 s46, s51, 0x10000
    s_add_u32 m0, s65, 75776
    s_nop 0
    buffer_load_dwordx4 v72, s[36:39], s46 offen  lds
    s_add_u32 s46, s51, 0x18000
    s_add_u32 m0, s65, 76800
    s_nop 0
    buffer_load_dwordx4 v73, s[36:39], s46 offen  lds
    ds_read_b64_tr_b16 a[196:197], v88 offset:12288
    ds_read_b64_tr_b16 a[198:199], v88 offset:12544
    ds_read_b64_tr_b16 a[204:205], v89 offset:12288
    ds_read_b64_tr_b16 a[206:207], v89 offset:12544
    ds_read_b64_tr_b16 a[212:213], v90 offset:12288
    ds_read_b64_tr_b16 a[214:215], v90 offset:12544
    ds_read_b64_tr_b16 a[220:221], v91 offset:12288
    ds_read_b64_tr_b16 a[222:223], v91 offset:12544
L_lw_56:
    s_waitcnt lgkmcnt(0)
    s_cmp_lg_u32 s44, 0
    s_cbranch_scc1 L_v_probe_57
    s_add_u32 s45, s63, 8320
    s_memtime s[72:73]
    s_waitcnt lgkmcnt(0)
    s_load_dword s78, s[20:21], s45
    s_waitcnt lgkmcnt(0)
    s_memtime s[74:75]
    s_waitcnt lgkmcnt(0)
    s_sub_u32 s45, s74, s72
    s_min_u32 s77, s77, s45
    s_cmp_lt_u32 s77, s76
    s_cselect_b32 s68, 1, 0
L_v_probe_57:
    s_waitcnt vmcnt(32)
    s_barrier
    s_add_u32 s51, s69, 6
    s_and_b32 s51, s51, 7
    s_lshl_b32 s51, s51, 17
    s_add_u32 s51, s51, s49
    s_add_u32 s46, s51, 0x4000
    s_add_u32 m0, s65, 77824
    s_nop 0
    buffer_load_dwordx4 v70, s[36:39], s46 offen  lds
    s_add_u32 s46, s51, 0xc000
    s_add_u32 m0, s65, 78848
    s_nop 0
    buffer_load_dwordx4 v71, s[36:39], s46 offen  lds
    s_add_u32 s46, s51, 0x14000
    s_add_u32 m0, s65, 79872
    s_nop 0
    buffer_load_dwordx4 v72, s[36:39], s46 offen  lds
    s_add_u32 s46, s51, 0x1c000
    s_add_u32 m0, s65, 80896
    s_nop 0
    buffer_load_dwordx4 v73, s[36:39], s46 offen  lds
    ds_read_b64_tr_b16 a[224:225], v88 offset:16384
    ds_read_b64_tr_b16 a[226:227], v88 offset:16640
    ds_read_b64_tr_b16 a[232:233], v89 offset:16384
    ds_read_b64_tr_b16 a[234:235], v89 offset:16640
    ds_read_b64_tr_b16 a[240:241], v90 offset:16384
    ds_read_b64_tr_b16 a[242:243], v90 offset:16640
    ds_read_b64_tr_b16 a[248:249], v91 offset:16384
    ds_read_b64_tr_b16 a[250:251], v91 offset:16640
L_lw_58:
    s_waitcnt lgkmcnt(0)
    s_cmp_lg_u32 s44, 0
    s_cbranch_scc1 L_v_probe_59
    s_add_u32 s45, s63, 256
    s_memtime s[72:73]
    s_waitcnt lgkmcnt(0)
    s_load_dword s78, s[20:21], s45
    s_waitcnt lgkmcnt(0)
    s_memtime s[74:75]
    s_waitcnt lgkmcnt(0)
    s_sub_u32 s45, s74, s72
    s_min_u32 s76, s76, s45
    s_cmp_lt_u32 s77, s76
    s_cselect_b32 s68, 1, 0
L_v_probe_59:
    s_waitcnt vmcnt(32)
    s_barrier
    s_add_u32 s51, s69, 7
    s_and_b32 s51, s51, 7
    s_lshl_b32 s51, s51, 17
    s_add_u32 s51, s51, s49
    s_add_u32 s46, s51, 0x0
    s_add_u32 m0, s65, 81920
    s_nop 0
    buffer_load_dwordx4 v70, s[36:39], s46 offen  lds
    s_add_u32 s46, s51, 0x8000
    s_add_u32 m0, s65, 82944
    s_nop 0
    buffer_load_dwordx4 v71, s[36:39], s46 offen  lds
    s_add_u32 s46, s51, 0x10000
    s_add_u32 m0, s65, 83968
    s_nop 0
    buffer_load_dwordx4 v72, s[36:39], s46 offen  lds
    s_add_u32 s46, s51, 0x18000
    s_add_u32 m0, s65, 84992
    s_nop 0
    buffer_load_dwordx4 v73, s[36:39], s46 offen  lds
    ds_read_b64_tr_b16 a[228:229], v88 offset:20480
    ds_read_b64_tr_b16 a[230:231], v88 offset:20736
    ds_read_b64_tr_b16 a[236:237], v89 offset:20480
    ds_read_b64_tr_b16 a[238:239], v89 offset:20736
    ds_read_b64_tr_b16 a[244:245], v90 offset:20480
    ds_read_b64_tr_b16 a[246:247], v90 offset:20736
    ds_read_b64_tr_b16 a[252:253], v91 offset:20480
    ds_read_b64_tr_b16 a[254:255], v91 offset:20736
L_lw_60:
    s_waitcnt lgkmcnt(0)
    s_cmp_lg_u32 s44, 0
    s_cbranch_scc1 L_v_probe_61
    s_add_u32 s45, s63, 8448
    s_memtime s[72:73]
    s_waitcnt lgkmcnt(0)
    s_load_dword s78, s[20:21], s45
    s_waitcnt lgkmcnt(0)
    s_memtime s[74:75]
    s_waitcnt lgkmcnt(0)
    s_sub_u32 s45, s74, s72
    s_min_u32 s77, s77, s45
    s_cmp_lt_u32 s77, s76
    s_cselect_b32 s68, 1, 0
L_v_probe_61:
    s_waitcnt vmcnt(32)
    s_barrier
    s_add_u32 s51, s69, 7
    s_and_b32 s51, s51, 7
    s_lshl_b32 s51, s51, 17
    s_add_u32 s51, s51, s49
    s_add_u32 s46, s51, 0x4000
    s_add_u32 m0, s65, 86016
    s_nop 0
    buffer_load_dwordx4 v70, s[36:39], s46 offen  lds
    s_add_u32 s46, s51, 0xc000
    s_add_u32 m0, s65, 87040
    s_nop 0
    buffer_load_dwordx4 v71, s[36:39], s46 offen  lds
    s_add_u32 s46, s51, 0x14000
    s_add_u32 m0, s65, 88064
    s_nop 0
    buffer_load_dwordx4 v72, s[36:39], s46 offen  lds
    s_add_u32 s46, s51, 0x1c000
    s_add_u32 m0, s65, 89088
    s_nop 0
    buffer_load_dwordx4 v73, s[36:39], s46 offen  lds
    ds_read_b64_tr_b16 v[96:97], v74 offset:0
    ds_read_b64_tr_b16 v[98:99], v74 offset:256
    ds_read_b64_tr_b16 v[104:105], v75 offset:0
    ds_read_b64_tr_b16 v[106:107], v75 offset:256
    ds_read_b64_tr_b16 v[112:113], v76 offset:0
    ds_read_b64_tr_b16 v[114:115], v76 offset:256
    ds_read_b64_tr_b16 v[120:121], v77 offset:0
    ds_read_b64_tr_b16 v[122:123], v77 offset:256
L_lw_62:
    s_waitcnt lgkmcnt(0)
    s_cmp_lg_u32 s44, 0
    s_cbranch_scc1 L_v_probe_63
    s_add_u32 s45, s63, 384
    s_memtime s[72:73]
    s_waitcnt lgkmcnt(0)
    s_load_dword s78, s[20:21], s45
    s_waitcnt lgkmcnt(0)
    s_memtime s[74:75]
    s_waitcnt lgkmcnt(0)
    s_sub_u32 s45, s74, s72
    s_min_u32 s76, s76, s45
    s_cmp_lt_u32 s77, s76
    s_cselect_b32 s68, 1, 0
L_v_probe_63:
    s_waitcnt vmcnt(32)
    s_barrier
    s_add_u32 s79, s41, 0
    s_and_b32 s79, s79, 3
    s_lshl_b32 s79, s79, 19
    s_add_u32 s79, s79, s47
    s_add_u32 s46, s79, 0x0
    s_add_u32 m0, s48, 0
    s_nop 0
    buffer_load_dwordx4 v82, s[32:35], s46 offen  lds
    s_add_u32 s46, s79, 0x20000
    s_add_u32 m0, s48, 4096
    s_nop 0
    buffer_load_dwordx4 v82, s[32:35], s46 offen  lds
    s_add_u32 s46, s79, 0x40000
    s_add_u32 m0, s48, 8192
    s_nop 0
    buffer_load_dwordx4 v82, s[32:35], s46 offen  lds
    s_add_u32 s46, s79, 0x60000
    s_add_u32 m0, s48, 12288
    s_nop 0
    buffer_load_dwordx4 v82, s[32:35], s46 offen  lds
    ds_read_b64_tr_b16 v[100:101], v74 offset:16384
    ds_read_b64_tr_b16 v[102:103], v74 offset:16640
    ds_read_b64_tr_b16 v[108:109], v75 offset:16384
    ds_read_b64_tr_b16 v[110:111], v75 offset:16640
    ds_read_b64_tr_b16 v[116:117], v76 offset:16384
    ds_read_b64_tr_b16 v[118:119], v76 offset:16640
    ds_read_b64_tr_b16 v[124:125], v77 offset:16384
    ds_read_b64_tr_b16 v[126:127], v77 offset:16640
L_lw_64:
    s_waitcnt lgkmcnt(0)
    s_cmp_lg_u32 s44, 0
    s_cbranch_scc1 L_v_probe_65
    s_add_u32 s45, s63, 8576
    s_memtime s[72:73]
    s_waitcnt lgkmcnt(0)
    s_load_dword s78, s[20:21], s45
    s_waitcnt lgkmcnt(0)
    s_memtime s[74:75]
    s_waitcnt lgkmcnt(0)
    s_sub_u32 s45, s74, s72
    s_min_u32 s77, s77, s45
    s_cmp_lt_u32 s77, s76
    s_cselect_b32 s68, 1, 0
L_v_probe_65:
    s_waitcnt vmcnt(32)
    s_barrier
    s_add_u32 s79, s41, 1
    s_and_b32 s79, s79, 3
    s_lshl_b32 s79, s79, 19
    s_add_u32 s79, s79, s47
    s_add_u32 s46, s79, 0x0
    s_add_u32 m0, s48, 16384
    s_nop 0
    buffer_load_dwordx4 v82, s[32:35], s46 offen  lds
    s_add_u32 s46, s79, 0x20000
    s_add_u32 m0, s48, 20480
    s_nop 0
    buffer_load_dwordx4 v82, s[32:35], s46 offen  lds
    s_add_u32 s46, s79, 0x40000
    s_add_u32 m0, s48, 24576
    s_nop 0
    buffer_load_dwordx4 v82, s[32:35], s46 offen  lds
    s_add_u32 s46, s79, 0x60000
    s_add_u32 m0, s48, 28672
    s_nop 0
    buffer_load_dwordx4 v82, s[32:35], s46 offen  lds
    ds_read_b64_tr_b16 v[128:129], v74 offset:32768
    ds_read_b64_tr_b16 v[130:131], v74 offset:33024
    ds_read_b64_tr_b16 v[136:137], v75 offset:32768
    ds_read_b64_tr_b16 v[138:139], v75 offset:33024
    ds_read_b64_tr_b16 v[144:145], v76 offset:32768
    ds_read_b64_tr_b16 v[146:147], v76 offset:33024
    ds_read_b64_tr_b16 v[152:153], v77 offset:32768
    ds_read_b64_tr_b16 v[154:155], v77 offset:33024
L_lw_66:
    s_waitcnt lgkmcnt(0)
    s_cmp_lg_u32 s44, 0
    s_cbranch_scc1 L_v_probe_67
    s_add_u32 s45, s63, 512
    s_memtime s[72:73]
    s_waitcnt lgkmcnt(0)
    s_load_dword s78, s[20:21], s45
    s_waitcnt lgkmcnt(0)
    s_memtime s[74:75]
    s_waitcnt lgkmcnt(0)
    s_sub_u32 s45, s74, s72
    s_min_u32 s76, s76, s45
    s_cmp_lt_u32 s77, s76
    s_cselect_b32 s68, 1, 0
L_v_probe_67:
    s_waitcnt vmcnt(32)
    s_barrier
    s_add_u32 s79, s41, 2
    s_and_b32 s79, s79, 3
    s_lshl_b32 s79, s79, 19
    s_add_u32 s79, s79, s47
    s_add_u32 s46, s79, 0x0
    s_add_u32 m0, s48, 32768
    s_nop 0
    buffer_load_dwordx4 v82, s[32:35], s46 offen  lds
    s_add_u32 s46, s79, 0x20000
    s_add_u32 m0, s48, 36864
    s_nop 0
    buffer_load_dwordx4 v82, s[32:35], s46 offen  lds
    s_add_u32 s46, s79, 0x40000
    s_add_u32 m0, s48, 40960
    s_nop 0
    buffer_load_dwordx4 v82, s[32:35], s46 offen  lds
    s_add_u32 s46, s79, 0x60000
    s_add_u32 m0, s48, 45056
    s_nop 0
    buffer_load_dwordx4 v82, s[32:35], s46 offen  lds
    ds_read_b64_tr_b16 v[132:133], v74 offset:49152
    ds_read_b64_tr_b16 v[134:135], v74 offset:49408
    ds_read_b64_tr_b16 v[140:141], v75 offset:49152
    ds_read_b64_tr_b16 v[142:143], v75 offset:49408
    ds_read_b64_tr_b16 v[148:149], v76 offset:49152
    ds_read_b64_tr_b16 v[150:151], v76 offset:49408
    ds_read_b64_tr_b16 v[156:157], v77 offset:49152
    ds_read_b64_tr_b16 v[158:159], v77 offset:49408
L_lw_68:
    s_waitcnt lgkmcnt(0)
    s_cmp_lg_u32 s44, 0
    s_cbranch_scc1 L_v_probe_69
    s_add_u32 s45, s63, 8704
    s_memtime s[72:73]
    s_waitcnt lgkmcnt(0)
    s_load_dword s78, s[20:21], s45
    s_waitcnt lgkmcnt(0)
    s_memtime s[74:75]
    s_waitcnt lgkmcnt(0)
    s_sub_u32 s45, s74, s72
    s_min_u32 s77, s77, s45
    s_cmp_lt_u32 s77, s76
    s_cselect_b32 s68, 1, 0
L_v_probe_69:
    s_waitcnt vmcnt(32)
    s_barrier
    s_add_u32 s79, s41, 3
    s_and_b32 s79, s79, 3
    s_lshl_b32 s79, s79, 19
    s_add_u32 s79, s79, s47
    s_add_u32 s46, s79, 0x0
    s_add_u32 m0, s48, 49152
    s_nop 0
    buffer_load_dwordx4 v82, s[32:35], s46 offen  lds
    s_add_u32 s46, s79, 0x20000
    s_add_u32 m0, s48, 53248
    s_nop 0
    buffer_load_dwordx4 v82, s[32:35], s46 offen  lds
    s_add_u32 s46, s79, 0x40000
    s_add_u32 m0, s48, 57344
    s_nop 0
    buffer_load_dwordx4 v82, s[32:35], s46 offen  lds
    s_add_u32 s46, s79, 0x60000
    s_add_u32 m0, s48, 61440
    s_nop 0
    buffer_load_dwordx4 v82, s[32:35], s46 offen  lds
    ds_read_b64_tr_b16 v[160:161], v88 offset:0
    ds_read_b64_tr_b16 v[162:163], v88 offset:256
    ds_read_b64_tr_b16 v[168:169], v89 offset:0
    ds_read_b64_tr_b16 v[170:171], v89 offset:256
    ds_read_b64_tr_b16 v[176:177], v90 offset:0
    ds_read_b64_tr_b16 v[178:179], v90 offset:256
    ds_read_b64_tr_b16 v[184:185], v91 offset:0
    ds_read_b64_tr_b16 v[186:187], v91 offset:256
L_lw_70:
    s_waitcnt lgkmcnt(0)
    s_waitcnt vmcnt(32)
    s_barrier
    s_cmp_lg_u32 s44, 0
    s_cbranch_scc1 L_hs_71
    s_getreg_b32 s45, hwreg(HW_REG_XCC_ID)
    s_and_b32 s45, s45, 15
    s_mul_i32 s46, s45, s45
    s_lshl_b32 s46, s46, 9
    s_add_u32 s45, s45, s46
    s_cmp_eq_u32 s40, 0
    s_cselect_b32 s46, s45, 0
    s_cselect_b32 s45, 0, s45
    s_lshl_b32 s68, s68, 24
    s_add_u32 s46, s46, s68
    s_add_u32 s45, s45, 16777216
    v_mov_b32 v40, s46
    v_mov_b32 v41, s45
    v_mov_b32 v42, 0
    s_mov_b64 exec, 1
    buffer_atomic_add_x2 v[40:41], v42, s[16:19], 0 offen sc1
    s_mov_b64 exec, -1
L_hs_71:
    ds_read_b64_tr_b16 v[164:165], v88 offset:4096
    ds_read_b64_tr_b16 v[166:167], v88 offset:4352
    ds_read_b64_tr_b16 v[172:173], v89 offset:4096
    ds_read_b64_tr_b16 v[174:175], v89 offset:4352
    ds_read_b64_tr_b16 v[180:181], v90 offset:4096
    ds_read_b64_tr_b16 v[182:183], v90 offset:4352
    ds_read_b64_tr_b16 v[188:189], v91 offset:4096
    ds_read_b64_tr_b16 v[190:191], v91 offset:4352
L_lw_72:
    s_waitcnt lgkmcnt(0)
    s_waitcnt vmcnt(28)
    s_barrier
    ds_read_b64_tr_b16 v[192:193], v88 offset:8192
    ds_read_b64_tr_b16 v[194:195], v88 offset:8448
    ds_read_b64_tr_b16 v[200:201], v89 offset:8192
    ds_read_b64_tr_b16 v[202:203], v89 offset:8448
    ds_read_b64_tr_b16 v[208:209], v90 offset:8192
    ds_read_b64_tr_b16 v[210:211], v90 offset:8448
    ds_read_b64_tr_b16 v[216:217], v91 offset:8192
    ds_read_b64_tr_b16 v[218:219], v91 offset:8448
L_lw_73:
    s_waitcnt lgkmcnt(0)
    s_waitcnt vmcnt(24)
    s_barrier
    ds_read_b64_tr_b16 v[196:197], v88 offset:12288
    ds_read_b64_tr_b16 v[198:199], v88 offset:12544
    ds_read_b64_tr_b16 v[204:205], v89 offset:12288
    ds_read_b64_tr_b16 v[206:207], v89 offset:12544
    ds_read_b64_tr_b16 v[212:213], v90 offset:12288
    ds_read_b64_tr_b16 v[214:215], v90 offset:12544
    ds_read_b64_tr_b16 v[220:221], v91 offset:12288
    ds_read_b64_tr_b16 v[222:223], v91 offset:12544
L_lw_74:
    s_waitcnt lgkmcnt(0)
    s_waitcnt vmcnt(20)
    s_barrier
    ds_read_b64_tr_b16 v[224:225], v88 offset:16384
    ds_read_b64_tr_b16 v[226:227], v88 offset:16640
    ds_read_b64_tr_b16 v[232:233], v89 offset:16384
    ds_read_b64_tr_b16 v[234:235], v89 offset:16640
    ds_read_b64_tr_b16 v[240:241], v90 offset:16384
    ds_read_b64_tr_b16 v[242:243], v90 offset:16640
    ds_read_b64_tr_b16 v[248:249], v91 offset:16384
    ds_read_b64_tr_b16 v[250:251], v91 offset:16640
L_lw_75:
    s_waitcnt lgkmcnt(0)
    s_waitcnt vmcnt(16)
    s_barrier
    ds_read_b64_tr_b16 v[228:229], v88 offset:20480
    ds_read_b64_tr_b16 v[230:231], v88 offset:20736
    ds_read_b64_tr_b16 v[236:237], v89 offset:20480
    ds_read_b64_tr_b16 v[238:239], v89 offset:20736
    ds_read_b64_tr_b16 v[244:245], v90 offset:20480
    ds_read_b64_tr_b16 v[246:247], v90 offset:20736
    ds_read_b64_tr_b16 v[252:253], v91 offset:20480
    ds_read_b64_tr_b16 v[254:255], v91 offset:20736
L_lw_76:
    s_waitcnt lgkmcnt(0)
    s_waitcnt vmcnt(12)
    s_barrier
    s_cmp_lg_u32 s44, 0
    s_cbranch_scc1 L_lw_77_0
    ds_read_b64_tr_b16 a[0:1], v80 offset:0
    ds_read_b64_tr_b16 a[2:3], v80 offset:1024
    ds_read_b64_tr_b16 a[4:5], v80 offset:8192
    ds_read_b64_tr_b16 a[6:7], v80 offset:9216
    ds_read_b64_tr_b16 a[8:9], v81 offset:0
    ds_read_b64_tr_b16 a[10:11], v81 offset:1024
    ds_read_b64_tr_b16 a[12:13], v81 offset:8192
    ds_read_b64_tr_b16 a[14:15], v81 offset:9216
    s_branch L_lw_77
L_lw_77_0:
    s_cmp_lg_u32 s44, 1
    s_cbranch_scc1 L_lw_77_1
    ds_read_b64_tr_b16 a[120:121], v80 offset:0
    ds_read_b64_tr_b16 a[122:123], v80 offset:1024
    ds_read_b64_tr_b16 a[124:125], v80 offset:8192
    ds_read_b64_tr_b16 a[126:127], v80 offset:9216
    ds_read_b64_tr_b16 v[56:57], v81 offset:0
    ds_read_b64_tr_b16 v[58:59], v81 offset:1024
    ds_read_b64_tr_b16 v[60:61], v81 offset:8192
    ds_read_b64_tr_b16 v[62:63], v81 offset:9216
    s_waitcnt lgkmcnt(0)
    ds_write_b128 v5, v[56:59] offset:0
    ds_write_b128 v5, v[60:63] offset:1024
    s_branch L_lw_77
L_lw_77_1:
    s_cmp_lg_u32 s44, 2
    s_cbranch_scc1 L_lw_77_2
    ds_read_b64_tr_b16 a[80:81], v80 offset:0
    ds_read_b64_tr_b16 a[82:83], v80 offset:1024
    ds_read_b64_tr_b16 a[84:85], v80 offset:8192
    ds_read_b64_tr_b16 a[86:87], v80 offset:9216
    ds_read_b64_tr_b16 v[56:57], v81 offset:0
    ds_read_b64_tr_b16 v[58:59], v81 offset:1024
    ds_read_b64_tr_b16 v[60:61], v81 offset:8192
    ds_read_b64_tr_b16 v[62:63], v81 offset:9216
    s_waitcnt lgkmcnt(0)
    ds_write_b128 v5, v[56:59] offset:2048
    ds_write_b128 v5, v[60:63] offset:3072
    s_branch L_lw_77
L_lw_77_2:
    ds_read_b64_tr_b16 a[48:49], v80 offset:0
    ds_read_b64_tr_b16 a[50:51], v80 offset:1024
    ds_read_b64_tr_b16 a[52:53], v80 offset:8192
    ds_read_b64_tr_b16 a[54:55], v80 offset:9216
    ds_read_b64_tr_b16 v[56:57], v81 offset:0
    ds_read_b64_tr_b16 v[58:59], v81 offset:1024
    ds_read_b64_tr_b16 v[60:61], v81 offset:8192
    ds_read_b64_tr_b16 v[62:63], v81 offset:9216
    s_waitcnt lgkmcnt(0)
    ds_write_b128 v5, v[56:59] offset:4096
    ds_write_b128 v5, v[60:63] offset:5120
L_lw_77:
    s_waitcnt lgkmcnt(0)
    s_waitcnt vmcnt(8)
    s_barrier
    s_add_u32 s79, s41, 4
    s_and_b32 s79, s79, 3
    s_lshl_b32 s79, s79, 19
    s_add_u32 s79, s79, s47
    s_add_u32 s46, s79, 0x200000
    s_add_u32 m0, s48, 0
    s_nop 0
    buffer_load_dwordx4 v82, s[32:35], s46 offen  lds
    s_add_u32 s46, s79, 0x220000
    s_add_u32 m0, s48, 4096
    s_nop 0
    buffer_load_dwordx4 v82, s[32:35], s46 offen  lds
    s_add_u32 s46, s79, 0x240000
    s_add_u32 m0, s48, 8192
    s_nop 0
    buffer_load_dwordx4 v82, s[32:35], s46 offen  lds
    s_add_u32 s46, s79, 0x260000
    s_add_u32 m0, s48, 12288
    s_nop 0
    buffer_load_dwordx4 v82, s[32:35], s46 offen  lds
    s_cmp_lg_u32 s44, 0
    s_cbranch_scc1 L_lw_78_0
    ds_read_b64_tr_b16 a[16:17], v80 offset:16384
    ds_read_b64_tr_b16 a[18:19], v80 offset:17408
    ds_read_b64_tr_b16 a[20:21], v80 offset:24576
    ds_read_b64_tr_b16 a[22:23], v80 offset:25600
    ds_read_b64_tr_b16 a[24:25], v81 offset:16384
    ds_read_b64_tr_b16 a[26:27], v81 offset:17408
    ds_read_b64_tr_b16 a[28:29], v81 offset:24576
    ds_read_b64_tr_b16 a[30:31], v81 offset:25600
    s_branch L_lw_78
L_lw_78_0:
    s_cmp_lg_u32 s44, 1
    s_cbranch_scc1 L_lw_78_1
    ds_read_b64_tr_b16 a[128:129], v80 offset:16384
    ds_read_b64_tr_b16 a[130:131], v80 offset:17408
    ds_read_b64_tr_b16 a[132:133], v80 offset:24576
    ds_read_b64_tr_b16 a[134:135], v80 offset:25600
    ds_read_b64_tr_b16 a[136:137], v81 offset:16384
    ds_read_b64_tr_b16 a[138:139], v81 offset:17408
    ds_read_b64_tr_b16 a[140:141], v81 offset:24576
    ds_read_b64_tr_b16 a[142:143], v81 offset:25600
    s_branch L_lw_78
L_lw_78_1:
    s_cmp_lg_u32 s44, 2
    s_cbranch_scc1 L_lw_78_2
    ds_read_b64_tr_b16 a[88:89], v80 offset:16384
    ds_read_b64_tr_b16 a[90:91], v80 offset:17408
    ds_read_b64_tr_b16 a[92:93], v80 offset:24576
    ds_read_b64_tr_b16 a[94:95], v80 offset:25600
    ds_read_b64_tr_b16 a[96:97], v81 offset:16384
    ds_read_b64_tr_b16 a[98:99], v81 offset:17408
    ds_read_b64_tr_b16 a[100:101], v81 offset:24576
    ds_read_b64_tr_b16 a[102:103], v81 offset:25600
    s_branch L_lw_78
L_lw_78_2:
    ds_read_b64_tr_b16 a[56:57], v80 offset:16384
    ds_read_b64_tr_b16 a[58:59], v80 offset:17408
    ds_read_b64_tr_b16 a[60:61], v80 offset:24576
    ds_read_b64_tr_b16 a[62:63], v80 offset:25600
    ds_read_b64_tr_b16 v[56:57], v81 offset:16384
    ds_read_b64_tr_b16 v[58:59], v81 offset:17408
    ds_read_b64_tr_b16 v[60:61], v81 offset:24576
    ds_read_b64_tr_b16 v[62:63], v81 offset:25600
    s_waitcnt lgkmcnt(0)
    ds_write_b128 v5, v[56:59] offset:6144
    ds_write_b128 v5, v[60:63] offset:7168
L_lw_78:
    s_waitcnt lgkmcnt(0)
    s_waitcnt vmcnt(8)
    s_barrier
    s_add_u32 s79, s41, 5
    s_and_b32 s79, s79, 3
    s_lshl_b32 s79, s79, 19
    s_add_u32 s79, s79, s47
    s_add_u32 s46, s79, 0x200000
    s_add_u32 m0, s48, 16384
    s_nop 0
    buffer_load_dwordx4 v82, s[32:35], s46 offen  lds
    s_add_u32 s46, s79, 0x220000
    s_add_u32 m0, s48, 20480
    s_nop 0
    buffer_load_dwordx4 v82, s[32:35], s46 offen  lds
    s_add_u32 s46, s79, 0x240000
    s_add_u32 m0, s48, 24576
    s_nop 0
    buffer_load_dwordx4 v82, s[32:35], s46 offen  lds
    s_add_u32 s46, s79, 0x260000
    s_add_u32 m0, s48, 28672
    s_nop 0
    buffer_load_dwordx4 v82, s[32:35], s46 offen  lds
    s_cmp_lg_u32 s44, 0
    s_cbranch_scc1 L_lw_79_0
    ds_read_b64_tr_b16 a[32:33], v80 offset:32768
    ds_read_b64_tr_b16 a[34:35], v80 offset:33792
    ds_read_b64_tr_b16 a[36:37], v80 offset:40960
    ds_read_b64_tr_b16 a[38:39], v80 offset:41984
    ds_read_b64_tr_b16 v[56:57], v81 offset:32768
    ds_read_b64_tr_b16 v[58:59], v81 offset:33792
    ds_read_b64_tr_b16 v[60:61], v81 offset:40960
    ds_read_b64_tr_b16 v[62:63], v81 offset:41984
    s_waitcnt lgkmcnt(0)
    ds_write_b128 v5, v[56:59] offset:8192
    ds_write_b128 v5, v[60:63] offset:9216
    s_branch L_lw_79
L_lw_79_0:
    s_cmp_lg_u32 s44, 1
    s_cbranch_scc1 L_lw_79_1
    ds_read_b64_tr_b16 a[144:145], v80 offset:32768
    ds_read_b64_tr_b16 a[146:147], v80 offset:33792
    ds_read_b64_tr_b16 a[148:149], v80 offset:40960
    ds_read_b64_tr_b16 a[150:151], v80 offset:41984
    ds_read_b64_tr_b16 v[56:57], v81 offset:32768
    ds_read_b64_tr_b16 v[58:59], v81 offset:33792
    ds_read_b64_tr_b16 v[60:61], v81 offset:40960
    ds_read_b64_tr_b16 v[62:63], v81 offset:41984
    s_waitcnt lgkmcnt(0)
    ds_write_b128 v5, v[56:59] offset:10240
    ds_write_b128 v5, v[60:63] offset:11264
    s_branch L_lw_79
L_lw_79_1:
    s_cmp_lg_u32 s44, 2
    s_cbranch_scc1 L_lw_79_2
    ds_read_b64_tr_b16 a[104:105], v80 offset:32768
    ds_read_b64_tr_b16 a[106:107], v80 offset:33792
    ds_read_b64_tr_b16 a[108:109], v80 offset:40960
    ds_read_b64_tr_b16 a[110:111], v80 offset:41984
    ds_read_b64_tr_b16 v[56:57], v81 offset:32768
    ds_read_b64_tr_b16 v[58:59], v81 offset:33792
    ds_read_b64_tr_b16 v[60:61], v81 offset:40960
    ds_read_b64_tr_b16 v[62:63], v81 offset:41984
    s_waitcnt lgkmcnt(0)
    ds_write_b128 v5, v[56:59] offset:12288
    ds_write_b128 v5, v[60:63] offset:13312
    s_branch L_lw_79
L_lw_79_2:
    ds_read_b64_tr_b16 a[64:65], v80 offset:32768
    ds_read_b64_tr_b16 a[66:67], v80 offset:33792
    ds_read_b64_tr_b16 a[68:69], v80 offset:40960
    ds_read_b64_tr_b16 a[70:71], v80 offset:41984
    ds_read_b64_tr_b16 v[56:57], v81 offset:32768
    ds_read_b64_tr_b16 v[58:59], v81 offset:33792
    ds_read_b64_tr_b16 v[60:61], v81 offset:40960
    ds_read_b64_tr_b16 v[62:63], v81 offset:41984
    s_waitcnt lgkmcnt(0)
    ds_write_b128 v5, v[56:59] offset:14336
    ds_write_b128 v5, v[60:63] offset:15360
L_lw_79:
    s_waitcnt lgkmcnt(0)
    s_waitcnt vmcnt(8)
    s_barrier
    s_add_u32 s79, s41, 6
    s_and_b32 s79, s79, 3
    s_lshl_b32 s79, s79, 19
    s_add_u32 s79, s79, s47
    s_add_u32 s46, s79, 0x200000
    s_add_u32 m0, s48, 32768
    s_nop 0
    buffer_load_dwordx4 v82, s[32:35], s46 offen  lds
    s_add_u32 s46, s79, 0x220000
    s_add_u32 m0, s48, 36864
    s_nop 0
    buffer_load_dwordx4 v82, s[32:35], s46 offen  lds
    s_add_u32 s46, s79, 0x240000
    s_add_u32 m0, s48, 40960
    s_nop 0
    buffer_load_dwordx4 v82, s[32:35], s46 offen  lds
    s_add_u32 s46, s79, 0x260000
    s_add_u32 m0, s48, 45056
    s_nop 0
    buffer_load_dwordx4 v82, s[32:35], s46 offen  lds
    s_cmp_lg_u32 s44, 0
    s_cbranch_scc1 L_lw_80_0
    ds_read_b64_tr_b16 a[40:41], v80 offset:49152
    ds_read_b64_tr_b16 a[42:43], v80 offset:50176
    ds_read_b64_tr_b16 a[44:45], v80 offset:57344
    ds_read_b64_tr_b16 a[46:47], v80 offset:58368
    ds_read_b64_tr_b16 v[56:57], v81 offset:49152
    ds_read_b64_tr_b16 v[58:59], v81 offset:50176
    ds_read_b64_tr_b16 v[60:61], v81 offset:57344
    ds_read_b64_tr_b16 v[62:63], v81 offset:58368
    s_waitcnt lgkmcnt(0)
    ds_write_b128 v5, v[56:59] offset:16384
    ds_write_b128 v5, v[60:63] offset:17408
    s_branch L_lw_80
L_lw_80_0:
    s_cmp_lg_u32 s44, 1
    s_cbranch_scc1 L_lw_80_1
    ds_read_b64_tr_b16 a[152:153], v80 offset:49152
    ds_read_b64_tr_b16 a[154:155], v80 offset:50176
    ds_read_b64_tr_b16 a[156:157], v80 offset:57344
    ds_read_b64_tr_b16 a[158:159], v80 offset:58368
    ds_read_b64_tr_b16 v[56:57], v81 offset:49152
    ds_read_b64_tr_b16 v[58:59], v81 offset:50176
    ds_read_b64_tr_b16 v[60:61], v81 offset:57344
    ds_read_b64_tr_b16 v[62:63], v81 offset:58368
    s_waitcnt lgkmcnt(0)
    ds_write_b128 v5, v[56:59] offset:18432
    ds_write_b128 v5, v[60:63] offset:19456
    s_branch L_lw_80
L_lw_80_1:
    s_cmp_lg_u32 s44, 2
    s_cbranch_scc1 L_lw_80_2
    ds_read_b64_tr_b16 a[112:113], v80 offset:49152
    ds_read_b64_tr_b16 a[114:115], v80 offset:50176
    ds_read_b64_tr_b16 a[116:117], v80 offset:57344
    ds_read_b64_tr_b16 a[118:119], v80 offset:58368
    ds_read_b64_tr_b16 v[56:57], v81 offset:49152
    ds_read_b64_tr_b16 v[58:59], v81 offset:50176
    ds_read_b64_tr_b16 v[60:61], v81 offset:57344
    ds_read_b64_tr_b16 v[62:63], v81 offset:58368
    s_waitcnt lgkmcnt(0)
    ds_write_b128 v5, v[56:59] offset:20480
    ds_write_b128 v5, v[60:63] offset:21504
    s_branch L_lw_80
L_lw_80_2:
    ds_read_b64_tr_b16 a[72:73], v80 offset:49152
    ds_read_b64_tr_b16 a[74:75], v80 offset:50176
    ds_read_b64_tr_b16 a[76:77], v80 offset:57344
    ds_read_b64_tr_b16 a[78:79], v80 offset:58368
    ds_read_b64_tr_b16 v[56:57], v81 offset:49152
    ds_read_b64_tr_b16 v[58:59], v81 offset:50176
    ds_read_b64_tr_b16 v[60:61], v81 offset:57344
    ds_read_b64_tr_b16 v[62:63], v81 offset:58368
    s_waitcnt lgkmcnt(0)
    ds_write_b128 v5, v[56:59] offset:22528
    ds_write_b128 v5, v[60:63] offset:23552
L_lw_80:
    s_waitcnt lgkmcnt(0)
    s_waitcnt vmcnt(8)
    s_barrier
    s_add_u32 s79, s41, 7
    s_and_b32 s79, s79, 3
    s_lshl_b32 s79, s79, 19
    s_add_u32 s79, s79, s47
    s_add_u32 s46, s79, 0x200000
    s_add_u32 m0, s48, 49152
    s_nop 0
    buffer_load_dwordx4 v82, s[32:35], s46 offen  lds
    s_add_u32 s46, s79, 0x220000
    s_add_u32 m0, s48, 53248
    s_nop 0
    buffer_load_dwordx4 v82, s[32:35], s46 offen  lds
    s_add_u32 s46, s79, 0x240000
    s_add_u32 m0, s48, 57344
    s_nop 0
    buffer_load_dwordx4 v82, s[32:35], s46 offen  lds
    s_add_u32 s46, s79, 0x260000
    s_add_u32 m0, s48, 61440
    s_nop 0
    buffer_load_dwordx4 v82, s[32:35], s46 offen  lds
    s_cmp_lg_u32 s44, 0
    s_cbranch_scc1 L_lw_81_0
    ds_read_b64_tr_b16 a[48:49], v80 offset:0
    ds_read_b64_tr_b16 a[50:51], v80 offset:1024
    ds_read_b64_tr_b16 a[52:53], v80 offset:8192
    ds_read_b64_tr_b16 a[54:55], v80 offset:9216
    ds_read_b64_tr_b16 v[56:57], v81 offset:0
    ds_read_b64_tr_b16 v[58:59], v81 offset:1024
    ds_read_b64_tr_b16 v[60:61], v81 offset:8192
    ds_read_b64_tr_b16 v[62:63], v81 offset:9216
    s_waitcnt lgkmcnt(0)
    ds_write_b128 v5, v[56:59] offset:4096
    ds_write_b128 v5, v[60:63] offset:5120
    s_branch L_lw_81
L_lw_81_0:
    s_cmp_lg_u32 s44, 1
    s_cbranch_scc1 L_lw_81_1
    ds_read_b64_tr_b16 a[0:1], v80 offset:0
    ds_read_b64_tr_b16 a[2:3], v80 offset:1024
    ds_read_b64_tr_b16 a[4:5], v80 offset:8192
    ds_read_b64_tr_b16 a[6:7], v80 offset:9216
    ds_read_b64_tr_b16 a[8:9], v81 offset:0
    ds_read_b64_tr_b16 a[10:11], v81 offset:1024
    ds_read_b64_tr_b16 a[12:13], v81 offset:8192
    ds_read_b64_tr_b16 a[14:15], v81 offset:9216
    s_branch L_lw_81
L_lw_81_1:
    s_cmp_lg_u32 s44, 2
    s_cbranch_scc1 L_lw_81_2
    ds_read_b64_tr_b16 a[120:121], v80 offset:0
    ds_read_b64_tr_b16 a[122:123], v80 offset:1024
    ds_read_b64_tr_b16 a[124:125], v80 offset:8192
    ds_read_b64_tr_b16 a[126:127], v80 offset:9216
    ds_read_b64_tr_b16 v[56:57], v81 offset:0
    ds_read_b64_tr_b16 v[58:59], v81 offset:1024
    ds_read_b64_tr_b16 v[60:61], v81 offset:8192
    ds_read_b64_tr_b16 v[62:63], v81 offset:9216
    s_waitcnt lgkmcnt(0)
    ds_write_b128 v5, v[56:59] offset:0
    ds_write_b128 v5, v[60:63] offset:1024
    s_branch L_lw_81
L_lw_81_2:
    ds_read_b64_tr_b16 a[80:81], v80 offset:0
    ds_read_b64_tr_b16 a[82:83], v80 offset:1024
    ds_read_b64_tr_b16 a[84:85], v80 offset:8192
    ds_read_b64_tr_b16 a[86:87], v80 offset:9216
    ds_read_b64_tr_b16 v[56:57], v81 offset:0
    ds_read_b64_tr_b16 v[58:59], v81 offset:1024
    ds_read_b64_tr_b16 v[60:61], v81 offset:8192
    ds_read_b64_tr_b16 v[62:63], v81 offset:9216
    s_waitcnt lgkmcnt(0)
    ds_write_b128 v5, v[56:59] offset:2048
    ds_write_b128 v5, v[60:63] offset:3072
L_lw_81:
    s_waitcnt lgkmcnt(0)
    s_waitcnt vmcnt(8)
    s_barrier
    s_add_u32 s79, s41, 8
    s_and_b32 s79, s79, 3
    s_lshl_b32 s79, s79, 19
    s_add_u32 s79, s79, s47
    s_add_u32 s46, s79, 0x400000
    s_add_u32 m0, s48, 0
    s_nop 0
    buffer_load_dwordx4 v82, s[32:35], s46 offen  lds
    s_add_u32 s46, s79, 0x420000
    s_add_u32 m0, s48, 4096
    s_nop 0
    buffer_load_dwordx4 v82, s[32:35], s46 offen  lds
    s_add_u32 s46, s79, 0x440000
    s_add_u32 m0, s48, 8192
    s_nop 0
    buffer_load_dwordx4 v82, s[32:35], s46 offen  lds
    s_add_u32 s46, s79, 0x460000
    s_add_u32 m0, s48, 12288
    s_nop 0
    buffer_load_dwordx4 v82, s[32:35], s46 offen  lds
    s_cmp_lg_u32 s44, 0
    s_cbranch_scc1 L_lw_82_0
    ds_read_b64_tr_b16 a[56:57], v80 offset:16384
    ds_read_b64_tr_b16 a[58:59], v80 offset:17408
    ds_read_b64_tr_b16 a[60:61], v80 offset:24576
    ds_read_b64_tr_b16 a[62:63], v80 offset:25600
    ds_read_b64_tr_b16 v[56:57], v81 offset:16384
    ds_read_b64_tr_b16 v[58:59], v81 offset:17408
    ds_read_b64_tr_b16 v[60:61], v81 offset:24576
    ds_read_b64_tr_b16 v[62:63], v81 offset:25600
    s_waitcnt lgkmcnt(0)
    ds_write_b128 v5, v[56:59] offset:6144
    ds_write_b128 v5, v[60:63] offset:7168
    s_branch L_lw_82
L_lw_82_0:
    s_cmp_lg_u32 s44, 1
    s_cbranch_scc1 L_lw_82_1
    ds_read_b64_tr_b16 a[16:17], v80 offset:16384
    ds_read_b64_tr_b16 a[18:19], v80 offset:17408
    ds_read_b64_tr_b16 a[20:21], v80 offset:24576
    ds_read_b64_tr_b16 a[22:23], v80 offset:25600
    ds_read_b64_tr_b16 a[24:25], v81 offset:16384
    ds_read_b64_tr_b16 a[26:27], v81 offset:17408
    ds_read_b64_tr_b16 a[28:29], v81 offset:24576
    ds_read_b64_tr_b16 a[30:31], v81 offset:25600
    s_branch L_lw_82
L_lw_82_1:
    s_cmp_lg_u32 s44, 2
    s_cbranch_scc1 L_lw_82_2
    ds_read_b64_tr_b16 a[128:129], v80 offset:16384
    ds_read_b64_tr_b16 a[130:131], v80 offset:17408
    ds_read_b64_tr_b16 a[132:133], v80 offset:24576
    ds_read_b64_tr_b16 a[134:135], v80 offset:25600
    ds_read_b64_tr_b16 a[136:137], v81 offset:16384
    ds_read_b64_tr_b16 a[138:139], v81 offset:17408
    ds_read_b64_tr_b16 a[140:141], v81 offset:24576
    ds_read_b64_tr_b16 a[142:143], v81 offset:25600
    s_branch L_lw_82
L_lw_82_2:
    ds_read_b64_tr_b16 a[88:89], v80 offset:16384
    ds_read_b64_tr_b16 a[90:91], v80 offset:17408
    ds_read_b64_tr_b16 a[92:93], v80 offset:24576
    ds_read_b64_tr_b16 a[94:95], v80 offset:25600
    ds_read_b64_tr_b16 a[96:97], v81 offset:16384
    ds_read_b64_tr_b16 a[98:99], v81 offset:17408
    ds_read_b64_tr_b16 a[100:101], v81 offset:24576
    ds_read_b64_tr_b16 a[102:103], v81 offset:25600
L_lw_82:
    s_waitcnt lgkmcnt(0)
    s_waitcnt vmcnt(8)
    s_barrier
    s_add_u32 s79, s41, 9
    s_and_b32 s79, s79, 3
    s_lshl_b32 s79, s79, 19
    s_add_u32 s79, s79, s47
    s_add_u32 s46, s79, 0x400000
    s_add_u32 m0, s48, 16384
    s_nop 0
    buffer_load_dwordx4 v82, s[32:35], s46 offen  lds
    s_add_u32 s46, s79, 0x420000
    s_add_u32 m0, s48, 20480
    s_nop 0
    buffer_load_dwordx4 v82, s[32:35], s46 offen  lds
    s_add_u32 s46, s79, 0x440000
    s_add_u32 m0, s48, 24576
    s_nop 0
    buffer_load_dwordx4 v82, s[32:35], s46 offen  lds
    s_add_u32 s46, s79, 0x460000
    s_add_u32 m0, s48, 28672
    s_nop 0
    buffer_load_dwordx4 v82, s[32:35], s46 offen  lds
    s_cmp_lg_u32 s44, 0
    s_cbranch_scc1 L_lw_83_0
    ds_read_b64_tr_b16 a[64:65], v80 offset:32768
    ds_read_b64_tr_b16 a[66:67], v80 offset:33792
    ds_read_b64_tr_b16 a[68:69], v80 offset:40960
    ds_read_b64_tr_b16 a[70:71], v80 offset:41984
    ds_read_b64_tr_b16 v[56:57], v81 offset:32768
    ds_read_b64_tr_b16 v[58:59], v81 offset:33792
    ds_read_b64_tr_b16 v[60:61], v81 offset:40960
    ds_read_b64_tr_b16 v[62:63], v81 offset:41984
    s_waitcnt lgkmcnt(0)
    ds_write_b128 v5, v[56:59] offset:14336
    ds_write_b128 v5, v[60:63] offset:15360
    s_branch L_lw_83
L_lw_83_0:
    s_cmp_lg_u32 s44, 1
    s_cbranch_scc1 L_lw_83_1
    ds_read_b64_tr_b16 a[32:33], v80 offset:32768
    ds_read_b64_tr_b16 a[34:35], v80 offset:33792
    ds_read_b64_tr_b16 a[36:37], v80 offset:40960
    ds_read_b64_tr_b16 a[38:39], v80 offset:41984
    ds_read_b64_tr_b16 v[56:57], v81 offset:32768
    ds_read_b64_tr_b16 v[58:59], v81 offset:33792
    ds_read_b64_tr_b16 v[60:61], v81 offset:40960
    ds_read_b64_tr_b16 v[62:63], v81 offset:41984
    s_waitcnt lgkmcnt(0)
    ds_write_b128 v5, v[56:59] offset:8192
    ds_write_b128 v5, v[60:63] offset:9216
    s_branch L_lw_83
L_lw_83_1:
    s_cmp_lg_u32 s44, 2
    s_cbranch_scc1 L_lw_83_2
    ds_read_b64_tr_b16 a[144:145], v80 offset:32768
    ds_read_b64_tr_b16 a[146:147], v80 offset:33792
    ds_read_b64_tr_b16 a[148:149], v80 offset:40960
    ds_read_b64_tr_b16 a[150:151], v80 offset:41984
    ds_read_b64_tr_b16 v[56:57], v81 offset:32768
    ds_read_b64_tr_b16 v[58:59], v81 offset:33792
    ds_read_b64_tr_b16 v[60:61], v81 offset:40960
    ds_read_b64_tr_b16 v[62:63], v81 offset:41984
    s_waitcnt lgkmcnt(0)
    ds_write_b128 v5, v[56:59] offset:10240
    ds_write_b128 v5, v[60:63] offset:11264
    s_branch L_lw_83
L_lw_83_2:
    ds_read_b64_tr_b16 a[104:105], v80 offset:32768
    ds_read_b64_tr_b16 a[106:107], v80 offset:33792
    ds_read_b64_tr_b16 a[108:109], v80 offset:40960
    ds_read_b64_tr_b16 a[110:111], v80 offset:41984
    ds_read_b64_tr_b16 v[56:57], v81 offset:32768
    ds_read_b64_tr_b16 v[58:59], v81 offset:33792
    ds_read_b64_tr_b16 v[60:61], v81 offset:40960
    ds_read_b64_tr_b16 v[62:63], v81 offset:41984
    s_waitcnt lgkmcnt(0)
    ds_write_b128 v5, v[56:59] offset:12288
    ds_write_b128 v5, v[60:63] offset:13312
L_lw_83:
    s_waitcnt lgkmcnt(0)
    s_waitcnt vmcnt(8)
    s_barrier
    s_add_u32 s79, s41, 10
    s_and_b32 s79, s79, 3
    s_lshl_b32 s79, s79, 19
    s_add_u32 s79, s79, s47
    s_add_u32 s46, s79, 0x400000
    s_add_u32 m0, s48, 32768
    s_nop 0
    buffer_load_dwordx4 v82, s[32:35], s46 offen  lds
    s_add_u32 s46, s79, 0x420000
    s_add_u32 m0, s48, 36864
    s_nop 0
    buffer_load_dwordx4 v82, s[32:35], s46 offen  lds
    s_add_u32 s46, s79, 0x440000
    s_add_u32 m0, s48, 40960
    s_nop 0
    buffer_load_dwordx4 v82, s[32:35], s46 offen  lds
    s_add_u32 s46, s79, 0x460000
    s_add_u32 m0, s48, 45056
    s_nop 0
    buffer_load_dwordx4 v82, s[32:35], s46 offen  lds
    s_cmp_lg_u32 s44, 0
    s_cbranch_scc1 L_lw_84_0
    ds_read_b64_tr_b16 a[72:73], v80 offset:49152
    ds_read_b64_tr_b16 a[74:75], v80 offset:50176
    ds_read_b64_tr_b16 a[76:77], v80 offset:57344
    ds_read_b64_tr_b16 a[78:79], v80 offset:58368
    ds_read_b64_tr_b16 v[56:57], v81 offset:49152
    ds_read_b64_tr_b16 v[58:59], v81 offset:50176
    ds_read_b64_tr_b16 v[60:61], v81 offset:57344
    ds_read_b64_tr_b16 v[62:63], v81 offset:58368
    s_waitcnt lgkmcnt(0)
    ds_write_b128 v5, v[56:59] offset:22528
    ds_write_b128 v5, v[60:63] offset:23552
    s_branch L_lw_84
L_lw_84_0:
    s_cmp_lg_u32 s44, 1
    s_cbranch_scc1 L_lw_84_1
    ds_read_b64_tr_b16 a[40:41], v80 offset:49152
    ds_read_b64_tr_b16 a[42:43], v80 offset:50176
    ds_read_b64_tr_b16 a[44:45], v80 offset:57344
    ds_read_b64_tr_b16 a[46:47], v80 offset:58368
    ds_read_b64_tr_b16 v[56:57], v81 offset:49152
    ds_read_b64_tr_b16 v[58:59], v81 offset:50176
    ds_read_b64_tr_b16 v[60:61], v81 offset:57344
    ds_read_b64_tr_b16 v[62:63], v81 offset:58368
    s_waitcnt lgkmcnt(0)
    ds_write_b128 v5, v[56:59] offset:16384
    ds_write_b128 v5, v[60:63] offset:17408
    s_branch L_lw_84
L_lw_84_1:
    s_cmp_lg_u32 s44, 2
    s_cbranch_scc1 L_lw_84_2
    ds_read_b64_tr_b16 a[152:153], v80 offset:49152
    ds_read_b64_tr_b16 a[154:155], v80 offset:50176
    ds_read_b64_tr_b16 a[156:157], v80 offset:57344
    ds_read_b64_tr_b16 a[158:159], v80 offset:58368
    ds_read_b64_tr_b16 v[56:57], v81 offset:49152
    ds_read_b64_tr_b16 v[58:59], v81 offset:50176
    ds_read_b64_tr_b16 v[60:61], v81 offset:57344
    ds_read_b64_tr_b16 v[62:63], v81 offset:58368
    s_waitcnt lgkmcnt(0)
    ds_write_b128 v5, v[56:59] offset:18432
    ds_write_b128 v5, v[60:63] offset:19456
    s_branch L_lw_84
L_lw_84_2:
    ds_read_b64_tr_b16 a[112:113], v80 offset:49152
    ds_read_b64_tr_b16 a[114:115], v80 offset:50176
    ds_read_b64_tr_b16 a[116:117], v80 offset:57344
    ds_read_b64_tr_b16 a[118:119], v80 offset:58368
    ds_read_b64_tr_b16 v[56:57], v81 offset:49152
    ds_read_b64_tr_b16 v[58:59], v81 offset:50176
    ds_read_b64_tr_b16 v[60:61], v81 offset:57344
    ds_read_b64_tr_b16 v[62:63], v81 offset:58368
    s_waitcnt lgkmcnt(0)
    ds_write_b128 v5, v[56:59] offset:20480
    ds_write_b128 v5, v[60:63] offset:21504
L_lw_84:
    s_waitcnt lgkmcnt(0)
    s_waitcnt vmcnt(8)
    s_barrier
    s_add_u32 s79, s41, 11
    s_and_b32 s79, s79, 3
    s_lshl_b32 s79, s79, 19
    s_add_u32 s79, s79, s47
    s_add_u32 s46, s79, 0x400000
    s_add_u32 m0, s48, 49152
    s_nop 0
    buffer_load_dwordx4 v82, s[32:35], s46 offen  lds
    s_add_u32 s46, s79, 0x420000
    s_add_u32 m0, s48, 53248
    s_nop 0
    buffer_load_dwordx4 v82, s[32:35], s46 offen  lds
    s_add_u32 s46, s79, 0x440000
    s_add_u32 m0, s48, 57344
    s_nop 0
    buffer_load_dwordx4 v82, s[32:35], s46 offen  lds
    s_add_u32 s46, s79, 0x460000
    s_add_u32 m0, s48, 61440
    s_nop 0
    buffer_load_dwordx4 v82, s[32:35], s46 offen  lds
    s_cmp_lg_u32 s44, 0
    s_cbranch_scc1 L_lw_85_0
    ds_read_b64_tr_b16 a[80:81], v80 offset:0
    ds_read_b64_tr_b16 a[82:83], v80 offset:1024
    ds_read_b64_tr_b16 a[84:85], v80 offset:8192
    ds_read_b64_tr_b16 a[86:87], v80 offset:9216
    ds_read_b64_tr_b16 v[56:57], v81 offset:0
    ds_read_b64_tr_b16 v[58:59], v81 offset:1024
    ds_read_b64_tr_b16 v[60:61], v81 offset:8192
    ds_read_b64_tr_b16 v[62:63], v81 offset:9216
    s_waitcnt lgkmcnt(0)
    ds_write_b128 v5, v[56:59] offset:2048
    ds_write_b128 v5, v[60:63] offset:3072
    s_branch L_lw_85
L_lw_85_0:
    s_cmp_lg_u32 s44, 1
    s_cbranch_scc1 L_lw_85_1
    ds_read_b64_tr_b16 a[48:49], v80 offset:0
    ds_read_b64_tr_b16 a[50:51], v80 offset:1024
    ds_read_b64_tr_b16 a[52:53], v80 offset:8192
    ds_read_b64_tr_b16 a[54:55], v80 offset:9216
    ds_read_b64_tr_b16 v[56:57], v81 offset:0
    ds_read_b64_tr_b16 v[58:59], v81 offset:1024
    ds_read_b64_tr_b16 v[60:61], v81 offset:8192
    ds_read_b64_tr_b16 v[62:63], v81 offset:9216
    s_waitcnt lgkmcnt(0)
    ds_write_b128 v5, v[56:59] offset:4096
    ds_write_b128 v5, v[60:63] offset:5120
    s_branch L_lw_85
L_lw_85_1:
    s_cmp_lg_u32 s44, 2
    s_cbranch_scc1 L_lw_85_2
    ds_read_b64_tr_b16 a[0:1], v80 offset:0
    ds_read_b64_tr_b16 a[2:3], v80 offset:1024
    ds_read_b64_tr_b16 a[4:5], v80 offset:8192
    ds_read_b64_tr_b16 a[6:7], v80 offset:9216
    ds_read_b64_tr_b16 a[8:9], v81 offset:0
    ds_read_b64_tr_b16 a[10:11], v81 offset:1024
    ds_read_b64_tr_b16 a[12:13], v81 offset:8192
    ds_read_b64_tr_b16 a[14:15], v81 offset:9216
    s_branch L_lw_85
L_lw_85_2:
    ds_read_b64_tr_b16 a[120:121], v80 offset:0
    ds_read_b64_tr_b16 a[122:123], v80 offset:1024
    ds_read_b64_tr_b16 a[124:125], v80 offset:8192
    ds_read_b64_tr_b16 a[126:127], v80 offset:9216
    ds_read_b64_tr_b16 v[56:57], v81 offset:0
    ds_read_b64_tr_b16 v[58:59], v81 offset:1024
    ds_read_b64_tr_b16 v[60:61], v81 offset:8192
    ds_read_b64_tr_b16 v[62:63], v81 offset:9216
    s_waitcnt lgkmcnt(0)
    ds_write_b128 v5, v[56:59] offset:0
    ds_write_b128 v5, v[60:63] offset:1024
L_lw_85:
    s_waitcnt lgkmcnt(0)
    s_waitcnt vmcnt(8)
    s_barrier
    s_add_u32 s79, s41, 12
    s_and_b32 s79, s79, 3
    s_lshl_b32 s79, s79, 19
    s_add_u32 s79, s79, s47
    s_add_u32 s46, s79, 0x600000
    s_add_u32 m0, s48, 0
    s_nop 0
    buffer_load_dwordx4 v82, s[32:35], s46 offen  lds
    s_add_u32 s46, s79, 0x620000
    s_add_u32 m0, s48, 4096
    s_nop 0
    buffer_load_dwordx4 v82, s[32:35], s46 offen  lds
    s_add_u32 s46, s79, 0x640000
    s_add_u32 m0, s48, 8192
    s_nop 0
    buffer_load_dwordx4 v82, s[32:35], s46 offen  lds
    s_add_u32 s46, s79, 0x660000
    s_add_u32 m0, s48, 12288
    s_nop 0
    buffer_load_dwordx4 v82, s[32:35], s46 offen  lds
    s_cmp_lg_u32 s44, 0
    s_cbranch_scc1 L_lw_86_0
    ds_read_b64_tr_b16 a[88:89], v80 offset:16384
    ds_read_b64_tr_b16 a[90:91], v80 offset:17408
    ds_read_b64_tr_b16 a[92:93], v80 offset:24576
    ds_read_b64_tr_b16 a[94:95], v80 offset:25600
    ds_read_b64_tr_b16 a[96:97], v81 offset:16384
    ds_read_b64_tr_b16 a[98:99], v81 offset:17408
    ds_read_b64_tr_b16 a[100:101], v81 offset:24576
    ds_read_b64_tr_b16 a[102:103], v81 offset:25600
    s_branch L_lw_86
L_lw_86_0:
    s_cmp_lg_u32 s44, 1
    s_cbranch_scc1 L_lw_86_1
    ds_read_b64_tr_b16 a[56:57], v80 offset:16384
    ds_read_b64_tr_b16 a[58:59], v80 offset:17408
    ds_read_b64_tr_b16 a[60:61], v80 offset:24576
    ds_read_b64_tr_b16 a[62:63], v80 offset:25600
    ds_read_b64_tr_b16 v[56:57], v81 offset:16384
    ds_read_b64_tr_b16 v[58:59], v81 offset:17408
    ds_read_b64_tr_b16 v[60:61], v81 offset:24576
    ds_read_b64_tr_b16 v[62:63], v81 offset:25600
    s_waitcnt lgkmcnt(0)
    ds_write_b128 v5, v[56:59] offset:6144
    ds_write_b128 v5, v[60:63] offset:7168
    s_branch L_lw_86
L_lw_86_1:
    s_cmp_lg_u32 s44, 2
    s_cbranch_scc1 L_lw_86_2
    ds_read_b64_tr_b16 a[16:17], v80 offset:16384
    ds_read_b64_tr_b16 a[18:19], v80 offset:17408
    ds_read_b64_tr_b16 a[20:21], v80 offset:24576
    ds_read_b64_tr_b16 a[22:23], v80 offset:25600
    ds_read_b64_tr_b16 a[24:25], v81 offset:16384
    ds_read_b64_tr_b16 a[26:27], v81 offset:17408
    ds_read_b64_tr_b16 a[28:29], v81 offset:24576
    ds_read_b64_tr_b16 a[30:31], v81 offset:25600
    s_branch L_lw_86
L_lw_86_2:
    ds_read_b64_tr_b16 a[128:129], v80 offset:16384
    ds_read_b64_tr_b16 a[130:131], v80 offset:17408
    ds_read_b64_tr_b16 a[132:133], v80 offset:24576
    ds_read_b64_tr_b16 a[134:135], v80 offset:25600
    ds_read_b64_tr_b16 a[136:137], v81 offset:16384
    ds_read_b64_tr_b16 a[138:139], v81 offset:17408
    ds_read_b64_tr_b16 a[140:141], v81 offset:24576
    ds_read_b64_tr_b16 a[142:143], v81 offset:25600
L_lw_86:
    s_waitcnt lgkmcnt(0)
    s_waitcnt vmcnt(8)
    s_barrier
    s_add_u32 s79, s41, 13
    s_and_b32 s79, s79, 3
    s_lshl_b32 s79, s79, 19
    s_add_u32 s79, s79, s47
    s_add_u32 s46, s79, 0x600000
    s_add_u32 m0, s48, 16384
    s_nop 0
    buffer_load_dwordx4 v82, s[32:35], s46 offen  lds
    s_add_u32 s46, s79, 0x620000
    s_add_u32 m0, s48, 20480
    s_nop 0
    buffer_load_dwordx4 v82, s[32:35], s46 offen  lds
    s_add_u32 s46, s79, 0x640000
    s_add_u32 m0, s48, 24576
    s_nop 0
    buffer_load_dwordx4 v82, s[32:35], s46 offen  lds
    s_add_u32 s46, s79, 0x660000
    s_add_u32 m0, s48, 28672
    s_nop 0
    buffer_load_dwordx4 v82, s[32:35], s46 offen  lds
    s_cmp_lg_u32 s44, 0
    s_cbranch_scc1 L_lw_87_0
    ds_read_b64_tr_b16 a[104:105], v80 offset:32768
    ds_read_b64_tr_b16 a[106:107], v80 offset:33792
    ds_read_b64_tr_b16 a[108:109], v80 offset:40960
    ds_read_b64_tr_b16 a[110:111], v80 offset:41984
    ds_read_b64_tr_b16 v[56:57], v81 offset:32768
    ds_read_b64_tr_b16 v[58:59], v81 offset:33792
    ds_read_b64_tr_b16 v[60:61], v81 offset:40960
    ds_read_b64_tr_b16 v[62:63], v81 offset:41984
    s_waitcnt lgkmcnt(0)
    ds_write_b128 v5, v[56:59] offset:12288
    ds_write_b128 v5, v[60:63] offset:13312
    s_branch L_lw_87
L_lw_87_0:
    s_cmp_lg_u32 s44, 1
    s_cbranch_scc1 L_lw_87_1
    ds_read_b64_tr_b16 a[64:65], v80 offset:32768
    ds_read_b64_tr_b16 a[66:67], v80 offset:33792
    ds_read_b64_tr_b16 a[68:69], v80 offset:40960
    ds_read_b64_tr_b16 a[70:71], v80 offset:41984
    ds_read_b64_tr_b16 v[56:57], v81 offset:32768
    ds_read_b64_tr_b16 v[58:59], v81 offset:33792
    ds_read_b64_tr_b16 v[60:61], v81 offset:40960
    ds_read_b64_tr_b16 v[62:63], v81 offset:41984
    s_waitcnt lgkmcnt(0)
    ds_write_b128 v5, v[56:59] offset:14336
    ds_write_b128 v5, v[60:63] offset:15360
    s_branch L_lw_87
L_lw_87_1:
    s_cmp_lg_u32 s44, 2
    s_cbranch_scc1 L_lw_87_2
    ds_read_b64_tr_b16 a[32:33], v80 offset:32768
    ds_read_b64_tr_b16 a[34:35], v80 offset:33792
    ds_read_b64_tr_b16 a[36:37], v80 offset:40960
    ds_read_b64_tr_b16 a[38:39], v80 offset:41984
    ds_read_b64_tr_b16 v[56:57], v81 offset:32768
    ds_read_b64_tr_b16 v[58:59], v81 offset:33792
    ds_read_b64_tr_b16 v[60:61], v81 offset:40960
    ds_read_b64_tr_b16 v[62:63], v81 offset:41984
    s_waitcnt lgkmcnt(0)
    ds_write_b128 v5, v[56:59] offset:8192
    ds_write_b128 v5, v[60:63] offset:9216
    s_branch L_lw_87
L_lw_87_2:
    ds_read_b64_tr_b16 a[144:145], v80 offset:32768
    ds_read_b64_tr_b16 a[146:147], v80 offset:33792
    ds_read_b64_tr_b16 a[148:149], v80 offset:40960
    ds_read_b64_tr_b16 a[150:151], v80 offset:41984
    ds_read_b64_tr_b16 v[56:57], v81 offset:32768
    ds_read_b64_tr_b16 v[58:59], v81 offset:33792
    ds_read_b64_tr_b16 v[60:61], v81 offset:40960
    ds_read_b64_tr_b16 v[62:63], v81 offset:41984
    s_waitcnt lgkmcnt(0)
    ds_write_b128 v5, v[56:59] offset:10240
    ds_write_b128 v5, v[60:63] offset:11264
L_lw_87:
    s_waitcnt lgkmcnt(0)
    s_waitcnt vmcnt(8)
    s_barrier
    s_add_u32 s79, s41, 14
    s_and_b32 s79, s79, 3
    s_lshl_b32 s79, s79, 19
    s_add_u32 s79, s79, s47
    s_add_u32 s46, s79, 0x600000
    s_add_u32 m0, s48, 32768
    s_nop 0
    buffer_load_dwordx4 v82, s[32:35], s46 offen  lds
    s_add_u32 s46, s79, 0x620000
    s_add_u32 m0, s48, 36864
    s_nop 0
    buffer_load_dwordx4 v82, s[32:35], s46 offen  lds
    s_add_u32 s46, s79, 0x640000
    s_add_u32 m0, s48, 40960
    s_nop 0
    buffer_load_dwordx4 v82, s[32:35], s46 offen  lds
    s_add_u32 s46, s79, 0x660000
    s_add_u32 m0, s48, 45056
    s_nop 0
    buffer_load_dwordx4 v82, s[32:35], s46 offen  lds
    s_cmp_lg_u32 s44, 0
    s_cbranch_scc1 L_lw_88_0
    ds_read_b64_tr_b16 a[112:113], v80 offset:49152
    ds_read_b64_tr_b16 a[114:115], v80 offset:50176
    ds_read_b64_tr_b16 a[116:117], v80 offset:57344
    ds_read_b64_tr_b16 a[118:119], v80 offset:58368
    ds_read_b64_tr_b16 v[56:57], v81 offset:49152
    ds_read_b64_tr_b16 v[58:59], v81 offset:50176
    ds_read_b64_tr_b16 v[60:61], v81 offset:57344
    ds_read_b64_tr_b16 v[62:63], v81 offset:58368
    s_waitcnt lgkmcnt(0)
    ds_write_b128 v5, v[56:59] offset:20480
    ds_write_b128 v5, v[60:63] offset:21504
    s_branch L_lw_88
L_lw_88_0:
    s_cmp_lg_u32 s44, 1
    s_cbranch_scc1 L_lw_88_1
    ds_read_b64_tr_b16 a[72:73], v80 offset:49152
    ds_read_b64_tr_b16 a[74:75], v80 offset:50176
    ds_read_b64_tr_b16 a[76:77], v80 offset:57344
    ds_read_b64_tr_b16 a[78:79], v80 offset:58368
    ds_read_b64_tr_b16 v[56:57], v81 offset:49152
    ds_read_b64_tr_b16 v[58:59], v81 offset:50176
    ds_read_b64_tr_b16 v[60:61], v81 offset:57344
    ds_read_b64_tr_b16 v[62:63], v81 offset:58368
    s_waitcnt lgkmcnt(0)
    ds_write_b128 v5, v[56:59] offset:22528
    ds_write_b128 v5, v[60:63] offset:23552
    s_branch L_lw_88
L_lw_88_1:
    s_cmp_lg_u32 s44, 2
    s_cbranch_scc1 L_lw_88_2
    ds_read_b64_tr_b16 a[40:41], v80 offset:49152
    ds_read_b64_tr_b16 a[42:43], v80 offset:50176
    ds_read_b64_tr_b16 a[44:45], v80 offset:57344
    ds_read_b64_tr_b16 a[46:47], v80 offset:58368
    ds_read_b64_tr_b16 v[56:57], v81 offset:49152
    ds_read_b64_tr_b16 v[58:59], v81 offset:50176
    ds_read_b64_tr_b16 v[60:61], v81 offset:57344
    ds_read_b64_tr_b16 v[62:63], v81 offset:58368
    s_waitcnt lgkmcnt(0)
    ds_write_b128 v5, v[56:59] offset:16384
    ds_write_b128 v5, v[60:63] offset:17408
    s_branch L_lw_88
L_lw_88_2:
    ds_read_b64_tr_b16 a[152:153], v80 offset:49152
    ds_read_b64_tr_b16 a[154:155], v80 offset:50176
    ds_read_b64_tr_b16 a[156:157], v80 offset:57344
    ds_read_b64_tr_b16 a[158:159], v80 offset:58368
    ds_read_b64_tr_b16 v[56:57], v81 offset:49152
    ds_read_b64_tr_b16 v[58:59], v81 offset:50176
    ds_read_b64_tr_b16 v[60:61], v81 offset:57344
    ds_read_b64_tr_b16 v[62:63], v81 offset:58368
    s_waitcnt lgkmcnt(0)
    ds_write_b128 v5, v[56:59] offset:18432
    ds_write_b128 v5, v[60:63] offset:19456
L_lw_88:
    s_waitcnt lgkmcnt(0)
    s_waitcnt vmcnt(8)
    s_barrier
    s_add_u32 s79, s41, 15
    s_and_b32 s79, s79, 3
    s_lshl_b32 s79, s79, 19
    s_add_u32 s79, s79, s47
    s_add_u32 s46, s79, 0x600000
    s_add_u32 m0, s48, 49152
    s_nop 0
    buffer_load_dwordx4 v82, s[32:35], s46 offen  lds
    s_add_u32 s46, s79, 0x620000
    s_add_u32 m0, s48, 53248
    s_nop 0
    buffer_load_dwordx4 v82, s[32:35], s46 offen  lds
    s_add_u32 s46, s79, 0x640000
    s_add_u32 m0, s48, 57344
    s_nop 0
    buffer_load_dwordx4 v82, s[32:35], s46 offen  lds
    s_add_u32 s46, s79, 0x660000
    s_add_u32 m0, s48, 61440
    s_nop 0
    buffer_load_dwordx4 v82, s[32:35], s46 offen  lds
    s_cmp_lg_u32 s44, 0
    s_cbranch_scc1 L_lw_89_0
    ds_read_b64_tr_b16 a[120:121], v80 offset:0
    ds_read_b64_tr_b16 a[122:123], v80 offset:1024
    ds_read_b64_tr_b16 a[124:125], v80 offset:8192
    ds_read_b64_tr_b16 a[126:127], v80 offset:9216
    ds_read_b64_tr_b16 v[56:57], v81 offset:0
    ds_read_b64_tr_b16 v[58:59], v81 offset:1024
    ds_read_b64_tr_b16 v[60:61], v81 offset:8192
    ds_read_b64_tr_b16 v[62:63], v81 offset:9216
    s_waitcnt lgkmcnt(0)
    ds_write_b128 v5, v[56:59] offset:0
    ds_write_b128 v5, v[60:63] offset:1024
    s_branch L_lw_89
L_lw_89_0:
    s_cmp_lg_u32 s44, 1
    s_cbranch_scc1 L_lw_89_1
    ds_read_b64_tr_b16 a[80:81], v80 offset:0
    ds_read_b64_tr_b16 a[82:83], v80 offset:1024
    ds_read_b64_tr_b16 a[84:85], v80 offset:8192
    ds_read_b64_tr_b16 a[86:87], v80 offset:9216
    ds_read_b64_tr_b16 v[56:57], v81 offset:0
    ds_read_b64_tr_b16 v[58:59], v81 offset:1024
    ds_read_b64_tr_b16 v[60:61], v81 offset:8192
    ds_read_b64_tr_b16 v[62:63], v81 offset:9216
    s_waitcnt lgkmcnt(0)
    ds_write_b128 v5, v[56:59] offset:2048
    ds_write_b128 v5, v[60:63] offset:3072
    s_branch L_lw_89
L_lw_89_1:
    s_cmp_lg_u32 s44, 2
    s_cbranch_scc1 L_lw_89_2
    ds_read_b64_tr_b16 a[48:49], v80 offset:0
    ds_read_b64_tr_b16 a[50:51], v80 offset:1024
    ds_read_b64_tr_b16 a[52:53], v80 offset:8192
    ds_read_b64_tr_b16 a[54:55], v80 offset:9216
    ds_read_b64_tr_b16 v[56:57], v81 offset:0
    ds_read_b64_tr_b16 v[58:59], v81 offset:1024
    ds_read_b64_tr_b16 v[60:61], v81 offset:8192
    ds_read_b64_tr_b16 v[62:63], v81 offset:9216
    s_waitcnt lgkmcnt(0)
    ds_write_b128 v5, v[56:59] offset:4096
    ds_write_b128 v5, v[60:63] offset:5120
    s_branch L_lw_89
L_lw_89_2:
    ds_read_b64_tr_b16 a[0:1], v80 offset:0
    ds_read_b64_tr_b16 a[2:3], v80 offset:1024
    ds_read_b64_tr_b16 a[4:5], v80 offset:8192
    ds_read_b64_tr_b16 a[6:7], v80 offset:9216
    ds_read_b64_tr_b16 a[8:9], v81 offset:0
    ds_read_b64_tr_b16 a[10:11], v81 offset:1024
    ds_read_b64_tr_b16 a[12:13], v81 offset:8192
    ds_read_b64_tr_b16 a[14:15], v81 offset:9216
L_lw_89:
    s_waitcnt lgkmcnt(0)
    s_waitcnt vmcnt(8)
    s_barrier
    s_cmp_lg_u32 s44, 0
    s_cbranch_scc1 L_lw_90_0
    ds_read_b64_tr_b16 a[128:129], v80 offset:16384
    ds_read_b64_tr_b16 a[130:131], v80 offset:17408
    ds_read_b64_tr_b16 a[132:133], v80 offset:24576
    ds_read_b64_tr_b16 a[134:135], v80 offset:25600
    ds_read_b64_tr_b16 a[136:137], v81 offset:16384
    ds_read_b64_tr_b16 a[138:139], v81 offset:17408
    ds_read_b64_tr_b16 a[140:141], v81 offset:24576
    ds_read_b64_tr_b16 a[142:143], v81 offset:25600
    s_branch L_lw_90
L_lw_90_0:
    s_cmp_lg_u32 s44, 1
    s_cbranch_scc1 L_lw_90_1
    ds_read_b64_tr_b16 a[88:89], v80 offset:16384
    ds_read_b64_tr_b16 a[90:91], v80 offset:17408
    ds_read_b64_tr_b16 a[92:93], v80 offset:24576
    ds_read_b64_tr_b16 a[94:95], v80 offset:25600
    ds_read_b64_tr_b16 a[96:97], v81 offset:16384
    ds_read_b64_tr_b16 a[98:99], v81 offset:17408
    ds_read_b64_tr_b16 a[100:101], v81 offset:24576
    ds_read_b64_tr_b16 a[102:103], v81 offset:25600
    s_branch L_lw_90
L_lw_90_1:
    s_cmp_lg_u32 s44, 2
    s_cbranch_scc1 L_lw_90_2
    ds_read_b64_tr_b16 a[56:57], v80 offset:16384
    ds_read_b64_tr_b16 a[58:59], v80 offset:17408
    ds_read_b64_tr_b16 a[60:61], v80 offset:24576
    ds_read_b64_tr_b16 a[62:63], v80 offset:25600
    ds_read_b64_tr_b16 v[56:57], v81 offset:16384
    ds_read_b64_tr_b16 v[58:59], v81 offset:17408
    ds_read_b64_tr_b16 v[60:61], v81 offset:24576
    ds_read_b64_tr_b16 v[62:63], v81 offset:25600
    s_waitcnt lgkmcnt(0)
    ds_write_b128 v5, v[56:59] offset:6144
    ds_write_b128 v5, v[60:63] offset:7168
    s_branch L_lw_90
L_lw_90_2:
    ds_read_b64_tr_b16 a[16:17], v80 offset:16384
    ds_read_b64_tr_b16 a[18:19], v80 offset:17408
    ds_read_b64_tr_b16 a[20:21], v80 offset:24576
    ds_read_b64_tr_b16 a[22:23], v80 offset:25600
    ds_read_b64_tr_b16 a[24:25], v81 offset:16384
    ds_read_b64_tr_b16 a[26:27], v81 offset:17408
    ds_read_b64_tr_b16 a[28:29], v81 offset:24576
    ds_read_b64_tr_b16 a[30:31], v81 offset:25600
L_lw_90:
    s_waitcnt lgkmcnt(0)
    s_waitcnt vmcnt(4)
    s_barrier
    s_cmp_lg_u32 s44, 0
    s_cbranch_scc1 L_lw_91_0
    ds_read_b64_tr_b16 a[144:145], v80 offset:32768
    ds_read_b64_tr_b16 a[146:147], v80 offset:33792
    ds_read_b64_tr_b16 a[148:149], v80 offset:40960
    ds_read_b64_tr_b16 a[150:151], v80 offset:41984
    ds_read_b64_tr_b16 v[56:57], v81 offset:32768
    ds_read_b64_tr_b16 v[58:59], v81 offset:33792
    ds_read_b64_tr_b16 v[60:61], v81 offset:40960
    ds_read_b64_tr_b16 v[62:63], v81 offset:41984
    s_waitcnt lgkmcnt(0)
    ds_write_b128 v5, v[56:59] offset:10240
    ds_write_b128 v5, v[60:63] offset:11264
    s_branch L_lw_91
L_lw_91_0:
    s_cmp_lg_u32 s44, 1
    s_cbranch_scc1 L_lw_91_1
    ds_read_b64_tr_b16 a[104:105], v80 offset:32768
    ds_read_b64_tr_b16 a[106:107], v80 offset:33792
    ds_read_b64_tr_b16 a[108:109], v80 offset:40960
    ds_read_b64_tr_b16 a[110:111], v80 offset:41984
    ds_read_b64_tr_b16 v[56:57], v81 offset:32768
    ds_read_b64_tr_b16 v[58:59], v81 offset:33792
    ds_read_b64_tr_b16 v[60:61], v81 offset:40960
    ds_read_b64_tr_b16 v[62:63], v81 offset:41984
    s_waitcnt lgkmcnt(0)
    ds_write_b128 v5, v[56:59] offset:12288
    ds_write_b128 v5, v[60:63] offset:13312
    s_branch L_lw_91
L_lw_91_1:
    s_cmp_lg_u32 s44, 2
    s_cbranch_scc1 L_lw_91_2
    ds_read_b64_tr_b16 a[64:65], v80 offset:32768
    ds_read_b64_tr_b16 a[66:67], v80 offset:33792
    ds_read_b64_tr_b16 a[68:69], v80 offset:40960
    ds_read_b64_tr_b16 a[70:71], v80 offset:41984
    ds_read_b64_tr_b16 v[56:57], v81 offset:32768
    ds_read_b64_tr_b16 v[58:59], v81 offset:33792
    ds_read_b64_tr_b16 v[60:61], v81 offset:40960
    ds_read_b64_tr_b16 v[62:63], v81 offset:41984
    s_waitcnt lgkmcnt(0)
    ds_write_b128 v5, v[56:59] offset:14336
    ds_write_b128 v5, v[60:63] offset:15360
    s_branch L_lw_91
L_lw_91_2:
    ds_read_b64_tr_b16 a[32:33], v80 offset:32768
    ds_read_b64_tr_b16 a[34:35], v80 offset:33792
    ds_read_b64_tr_b16 a[36:37], v80 offset:40960
    ds_read_b64_tr_b16 a[38:39], v80 offset:41984
    ds_read_b64_tr_b16 v[56:57], v81 offset:32768
    ds_read_b64_tr_b16 v[58:59], v81 offset:33792
    ds_read_b64_tr_b16 v[60:61], v81 offset:40960
    ds_read_b64_tr_b16 v[62:63], v81 offset:41984
    s_waitcnt lgkmcnt(0)
    ds_write_b128 v5, v[56:59] offset:8192
    ds_write_b128 v5, v[60:63] offset:9216
L_lw_91:
    s_waitcnt lgkmcnt(0)
    s_waitcnt vmcnt(0)
    s_barrier
    s_cmp_lg_u32 s44, 0
    s_cbranch_scc1 L_lw_92_0
    ds_read_b64_tr_b16 a[152:153], v80 offset:49152
    ds_read_b64_tr_b16 a[154:155], v80 offset:50176
    ds_read_b64_tr_b16 a[156:157], v80 offset:57344
    ds_read_b64_tr_b16 a[158:159], v80 offset:58368
    ds_read_b64_tr_b16 v[56:57], v81 offset:49152
    ds_read_b64_tr_b16 v[58:59], v81 offset:50176
    ds_read_b64_tr_b16 v[60:61], v81 offset:57344
    ds_read_b64_tr_b16 v[62:63], v81 offset:58368
    s_waitcnt lgkmcnt(0)
    ds_write_b128 v5, v[56:59] offset:18432
    ds_write_b128 v5, v[60:63] offset:19456
    s_branch L_lw_92
L_lw_92_0:
    s_cmp_lg_u32 s44, 1
    s_cbranch_scc1 L_lw_92_1
    ds_read_b64_tr_b16 a[112:113], v80 offset:49152
    ds_read_b64_tr_b16 a[114:115], v80 offset:50176
    ds_read_b64_tr_b16 a[116:117], v80 offset:57344
    ds_read_b64_tr_b16 a[118:119], v80 offset:58368
    ds_read_b64_tr_b16 v[56:57], v81 offset:49152
    ds_read_b64_tr_b16 v[58:59], v81 offset:50176
    ds_read_b64_tr_b16 v[60:61], v81 offset:57344
    ds_read_b64_tr_b16 v[62:63], v81 offset:58368
    s_waitcnt lgkmcnt(0)
    ds_write_b128 v5, v[56:59] offset:20480
    ds_write_b128 v5, v[60:63] offset:21504
    s_branch L_lw_92
L_lw_92_1:
    s_cmp_lg_u32 s44, 2
    s_cbranch_scc1 L_lw_92_2
    ds_read_b64_tr_b16 a[72:73], v80 offset:49152
    ds_read_b64_tr_b16 a[74:75], v80 offset:50176
    ds_read_b64_tr_b16 a[76:77], v80 offset:57344
    ds_read_b64_tr_b16 a[78:79], v80 offset:58368
    ds_read_b64_tr_b16 v[56:57], v81 offset:49152
    ds_read_b64_tr_b16 v[58:59], v81 offset:50176
    ds_read_b64_tr_b16 v[60:61], v81 offset:57344
    ds_read_b64_tr_b16 v[62:63], v81 offset:58368
    s_waitcnt lgkmcnt(0)
    ds_write_b128 v5, v[56:59] offset:22528
    ds_write_b128 v5, v[60:63] offset:23552
    s_branch L_lw_92
L_lw_92_2:
    ds_read_b64_tr_b16 a[40:41], v80 offset:49152
    ds_read_b64_tr_b16 a[42:43], v80 offset:50176
    ds_read_b64_tr_b16 a[44:45], v80 offset:57344
    ds_read_b64_tr_b16 a[46:47], v80 offset:58368
    ds_read_b64_tr_b16 v[56:57], v81 offset:49152
    ds_read_b64_tr_b16 v[58:59], v81 offset:50176
    ds_read_b64_tr_b16 v[60:61], v81 offset:57344
    ds_read_b64_tr_b16 v[62:63], v81 offset:58368
    s_waitcnt lgkmcnt(0)
    ds_write_b128 v5, v[56:59] offset:16384
    ds_write_b128 v5, v[60:63] offset:17408
L_lw_92:
    s_waitcnt lgkmcnt(0)
    s_barrier
    v_lshlrev_b32 v68, 4, v1
    s_mul_i32 s45, s44, 3072
    s_add_u32 s45, s45, 53248
    v_add_u32 v6, s45, v68
    s_sub_u32 s45, s44, 1
    s_and_b32 s45, s45, 3
    s_mul_i32 s45, s45, 3072
    s_add_u32 s45, s45, 53248
    v_add_u32 v7, s45, v68
    s_sub_u32 s45, s44, 2
    s_and_b32 s45, s45, 3
    s_mul_i32 s45, s45, 3072
    s_add_u32 s45, s45, 54272
    v_add_u32 v8, s45, v68
    s_sub_u32 s45, s44, 3
    s_and_b32 s45, s45, 3
    s_mul_i32 s45, s45, 3072
    s_add_u32 s45, s45, 55296
    v_add_u32 v18, s45, v68
    v_lshlrev_b32 v68, 4, v1
    s_add_u32 s45, s69, 0
    s_and_b32 s45, s45, 7
    s_lshl_b32 s45, s45, 10
    s_lshl_b32 s46, s44, 13
    s_add_u32 s45, s45, s46
    v_add_u32 v80, s45, v68
    s_add_u32 s45, s69, 1
    s_and_b32 s45, s45, 7
    s_lshl_b32 s45, s45, 10
    s_lshl_b32 s46, s44, 13
    s_add_u32 s45, s45, s46
    v_add_u32 v81, s45, v68
    s_add_u32 s45, s69, 2
    s_and_b32 s45, s45, 7
    s_lshl_b32 s45, s45, 10
    s_lshl_b32 s46, s44, 13
    s_add_u32 s45, s45, s46
    v_add_u32 v82, s45, v68
    s_add_u32 s45, s69, 3
    s_and_b32 s45, s45, 7
    s_lshl_b32 s45, s45, 10
    s_lshl_b32 s46, s44, 13
    s_add_u32 s45, s45, s46
    v_add_u32 v83, s45, v68
    s_add_u32 s45, s69, 4
    s_and_b32 s45, s45, 7
    s_lshl_b32 s45, s45, 10
    s_lshl_b32 s46, s44, 13
    s_add_u32 s45, s45, s46
    v_add_u32 v84, s45, v68
    s_add_u32 s45, s69, 5
    s_and_b32 s45, s45, 7
    s_lshl_b32 s45, s45, 10
    s_lshl_b32 s46, s44, 13
    s_add_u32 s45, s45, s46
    v_add_u32 v85, s45, v68
    s_add_u32 s45, s69, 6
    s_and_b32 s45, s45, 7
    s_lshl_b32 s45, s45, 10
    s_lshl_b32 s46, s44, 13
    s_add_u32 s45, s45, s46
    v_add_u32 v86, s45, v68
    s_add_u32 s45, s69, 7
    s_and_b32 s45, s45, 7
    s_lshl_b32 s45, s45, 10
    s_lshl_b32 s46, s44, 13
    s_add_u32 s45, s45, s46
    v_add_u32 v87, s45, v68
    s_lshl_b32 s45, s40, 4
    s_add_u32 s45, s45, s42
    s_lshl_b32 s45, s45, 7
    s_lshl_b32 s46, s44, 4
    s_add_u32 s45, s45, s46
    s_add_u32 s45, s45, 0x7080000
    v_and_b32 v13, 3, v1
    v_lshlrev_b32 v13, 2, v13
    v_add_u32 v13, s45, v13
    s_mov_b32 s66, 0x1800000
    v_mov_b32 v14, -1
    v_mov_b32 v15, -1
    s_mov_b32 s70, 0
    v_mov_b32 v41, 0
L_hw_93:
    buffer_load_dwordx2 v[44:45], v41, s[16:19], 0 offen sc1
    s_add_u32 s70, s70, 1
    s_cmp_ge_u32 s70, 0x100000
    s_cbranch_scc1 L_c_done_1
    s_waitcnt vmcnt(0)
    v_readfirstlane_b32 s45, v44
    v_readfirstlane_b32 s46, v45
    s_nop 3
    s_lshr_b32 s47, s46, 24
    s_cmp_lg_u32 s47, 64
    s_cbranch_scc1 L_hw_93
    s_lshr_b32 s68, s45, 24
    s_and_b32 s47, s45, 511
    s_mul_i32 s47, s47, s47
    s_bfe_u32 s45, s45, 0xf0009
    s_lshl_b32 s45, s45, 5
    s_sub_u32 s45, s45, s47
    s_and_b32 s47, s46, 511
    s_mul_i32 s47, s47, s47
    s_bfe_u32 s46, s46, 0xf0009
    s_lshl_b32 s46, s46, 5
    s_sub_u32 s46, s46, s47
    s_or_b32 s45, s45, s46
    s_cmp_eq_u32 s45, 0
    s_cselect_b32 s67, 1, 0
    s_mov_b32 s24, s12
    s_mov_b32 s25, s13
    s_mov_b32 s28, s12
    s_mov_b32 s29, s13
    s_cmp_eq_u32 s67, 1
    s_cselect_b32 s26, s14, 0
    s_cselect_b32 s30, 0, s14
    s_cmp_ge_u32 s68, 16
    s_cselect_b32 s68, 8192, 0
    s_mov_b32 s6, 0x0
    s_mov_b32 s7, 0xd5400000
    s_mov_b32 s60, 0
    s_lshl_b32 s58, s40, 16
    s_add_u32 s58, s58, 0x7000000
    s_mov_b32 s61, s58
    s_lshl_b32 s59, s40, 17
    s_add_u32 s59, s59, 0x7040000
    s_mov_b32 s62, s59
    s_add_u32 s32, s41, 0
    s_and_b32 s32, s32, 3
    s_lshl_b32 s32, s32, 10
    s_add_u32 s33, s41, 1
    s_and_b32 s33, s33, 3
    s_lshl_b32 s33, s33, 10
    s_add_u32 s34, s41, 2
    s_and_b32 s34, s34, 3
    s_lshl_b32 s34, s34, 10
    s_add_u32 s35, s41, 3
    s_and_b32 s35, s35, 3
    s_lshl_b32 s35, s35, 10
    s_add_u32 s63, s63, s68
    s_add_u32 s64, s64, s68
    ds_read_b128 v[56:59], v5 offset:8192
    ds_read_b128 v[60:63], v5 offset:9216
    ds_read_b128 v[64:67], v5 offset:16384
    ds_read_b128 v[68:71], v5 offset:17408
    ds_read_b128 v[72:75], v5 offset:4096
    ds_read_b128 v[76:79], v5 offset:5120
    ds_read_b128 v[88:91], v5 offset:6144
    ds_read_b128 v[92:95], v5 offset:7168
    ds_read_b128 v[32:35], v5 offset:14336
    ds_read_b128 v[36:39], v5 offset:15360
L_v_loop_94:
    s_add_u32 s8, s61, s32
    s_add_u32 s9, s61, s33
    s_add_u32 s10, s61, s34
    s_add_u32 s11, s61, s35
    s_nop 15
    s_nop 15
    s_waitcnt lgkmcnt(0)
    buffer_load_dwordx4 v[40:43], v3, s[12:15], s8 offen sc1
    v_mov_b32 v24, 0
    v_mov_b32 v25, 0
    v_mov_b32 v26, 0
    v_mov_b32 v27, 0
    v_mov_b32 v28, 0
    buffer_load_dwordx4 v[44:47], v3, s[12:15], s9 offen sc1
    v_mov_b32 v29, 0
    v_mov_b32 v30, 0
    v_mov_b32 v31, 0
    s_nop 1
    buffer_load_dwordx4 v[48:51], v3, s[12:15], s10 offen sc1
    s_nop 4
    buffer_load_dwordx4 v[52:55], v3, s[12:15], s11 offen sc1
    s_mov_b32 s70, 0
    s_waitcnt vmcnt(3)
    v_max3_u32 v22, v40, v41, v42
    ds_write_b128 v3, v[40:43] offset:0
    v_max_u32 v22, v22, v43
    v_cmp_eq_u32 vcc, -1, v22
    s_nop 0
    s_nop 0
    s_cbranch_vccnz L_mg_95_r0
L_mg_95_c0:
    v_smfmac_f32_16x16x64_bf16 v[24:27], v[40:43], a[0:7], v2
    s_waitcnt vmcnt(2)
    v_max3_u32 v22, v44, v45, v46
    ds_write_b128 v3, v[44:47] offset:1024
    v_max_u32 v22, v22, v47
    v_cmp_eq_u32 vcc, -1, v22
    v_smfmac_f32_16x16x64_bf16 v[28:31], v[40:43], a[8:15], v2
    s_nop 0
    s_cbranch_vccnz L_mg_95_r1
L_mg_95_c1:
    v_smfmac_f32_16x16x64_bf16 v[24:27], v[44:47], a[16:23], v2
    s_waitcnt vmcnt(1)
    v_max3_u32 v22, v48, v49, v50
    ds_write_b128 v3, v[48:51] offset:2048
    v_max_u32 v22, v22, v51
    v_cmp_eq_u32 vcc, -1, v22
    v_smfmac_f32_16x16x64_bf16 v[28:31], v[44:47], a[24:31], v2
    s_nop 0
    s_cbranch_vccnz L_mg_95_r2
L_mg_95_c2:
    s_waitcnt vmcnt(0)
    v_max3_u32 v22, v52, v53, v54
    ds_write_b128 v3, v[52:55] offset:3072
    v_max_u32 v22, v22, v55
    v_cmp_eq_u32 vcc, -1, v22
    s_waitcnt lgkmcnt(0)
    s_nop 0
    s_cbranch_vccnz L_mg_95_r3
L_mg_95_c3:
    s_barrier
    ds_read_b128 v[40:43], v4 offset:0
    ds_read_b128 v[44:47], v4 offset:1024
    v_smfmac_f32_16x16x64_bf16 v[24:27], v[48:51], a[32:39], v2
    v_smfmac_f32_16x16x64_bf16 v[28:31], v[48:51], v[56:63], v2
    ds_read_b128 v[48:51], v4 offset:2048
    v_smfmac_f32_16x16x64_bf16 v[24:27], v[52:55], a[40:47], v2
    ds_read_b128 v[56:59], v5 offset:22528
    v_smfmac_f32_16x16x64_bf16 v[28:31], v[52:55], v[64:71], v2
    ds_read_b128 v[52:55], v4 offset:3072
    ds_read_b128 v[60:63], v5 offset:23552
    s_waitcnt lgkmcnt(4)
    v_smfmac_f32_16x16x64_bf16 v[24:27], v[40:43], a[48:55], v2
    ds_read_b128 v[64:67], v5 offset:2048
    v_smfmac_f32_16x16x64_bf16 v[28:31], v[40:43], v[72:79], v2
    ds_read_b128 v[40:43], v21 offset:0
    ds_read_b128 v[68:71], v5 offset:3072
    v_smfmac_f32_16x16x64_bf16 v[24:27], v[44:47], a[56:63], v2
    ds_read_b128 v[72:75], v5 offset:12288
    v_smfmac_f32_16x16x64_bf16 v[28:31], v[44:47], v[88:95], v2
    ds_read_b128 v[44:47], v21 offset:1024
    ds_read_b128 v[76:79], v5 offset:13312
    s_waitcnt lgkmcnt(6)
    v_smfmac_f32_16x16x64_bf16 v[24:27], v[48:51], a[64:71], v2
    ds_read_b128 v[88:91], v5 offset:20480
    v_smfmac_f32_16x16x64_bf16 v[28:31], v[48:51], v[32:39], v2
    ds_read_b128 v[48:51], v21 offset:2048
    ds_read_b128 v[92:95], v5 offset:21504
    v_smfmac_f32_16x16x64_bf16 v[24:27], v[52:55], a[72:79], v2
    ds_read_b128 v[32:35], v5 offset:0
    v_smfmac_f32_16x16x64_bf16 v[28:31], v[52:55], v[56:63], v2
    ds_read_b128 v[52:55], v21 offset:3072
    ds_read_b128 v[36:39], v5 offset:1024
    s_waitcnt lgkmcnt(6)
    v_smfmac_f32_16x16x64_bf16 v[24:27], v[40:43], a[80:87], v2
    ds_read_b128 v[56:59], v5 offset:10240
    v_smfmac_f32_16x16x64_bf16 v[28:31], v[40:43], v[64:71], v2
    ds_read_b128 v[40:43], v23 offset:0
    ds_read_b128 v[60:63], v5 offset:11264
    v_smfmac_f32_16x16x64_bf16 v[24:27], v[44:47], a[88:95], v2
    ds_read_b128 v[64:67], v5 offset:18432
    v_smfmac_f32_16x16x64_bf16 v[28:31], v[44:47], a[96:103], v2
    ds_read_b128 v[44:47], v23 offset:1024
    s_waitcnt lgkmcnt(5)
    v_smfmac_f32_16x16x64_bf16 v[24:27], v[48:51], a[104:111], v2
    ds_read_b128 v[68:71], v5 offset:19456
    v_smfmac_f32_16x16x64_bf16 v[28:31], v[48:51], v[72:79], v2
    ds_read_b128 v[48:51], v23 offset:2048
    v_smfmac_f32_16x16x64_bf16 v[24:27], v[52:55], a[112:119], v2
    v_smfmac_f32_16x16x64_bf16 v[28:31], v[52:55], v[88:95], v2
    ds_read_b128 v[52:55], v23 offset:3072
    s_waitcnt lgkmcnt(3)
    v_smfmac_f32_16x16x64_bf16 v[24:27], v[40:43], a[120:127], v2
    v_smfmac_f32_16x16x64_bf16 v[28:31], v[40:43], v[32:39], v2
    v_smfmac_f32_16x16x64_bf16 v[24:27], v[44:47], a[128:135], v2
    v_smfmac_f32_16x16x64_bf16 v[28:31], v[44:47], a[136:143], v2
    s_waitcnt lgkmcnt(0)
    v_smfmac_f32_16x16x64_bf16 v[24:27], v[48:51], a[144:151], v2
    v_smfmac_f32_16x16x64_bf16 v[28:31], v[48:51], v[56:63], v2
    v_smfmac_f32_16x16x64_bf16 v[24:27], v[52:55], a[152:159], v2
    v_smfmac_f32_16x16x64_bf16 v[28:31], v[52:55], v[64:71], v2
    s_and_b32 s45, s60, 1
    s_lshl_b32 s45, s45, 16
    s_add_u32 s45, s45, 0x7020000
    s_xor_b32 s46, s45, 65536
    s_nop 3
    v_permlane32_swap_b32 v24, v26
    v_permlane32_swap_b32 v25, v27
    v_permlane32_swap_b32 v28, v30
    v_permlane32_swap_b32 v29, v31
    v_pk_add_f32 v[24:25], v[24:25], v[26:27]
    v_pk_add_f32 v[28:29], v[28:29], v[30:31]
    v_cvt_pk_bf16_f32 v16, v24, v25
    v_cvt_pk_bf16_f32 v17, v28, v29
    s_add_u32 s47, s60, 3
    s_and_b32 s47, s47, 3
    s_lshl_b32 s47, s47, 14
    s_add_u32 s47, s47, s58
    buffer_store_dwordx2 v[16:17], v10, s[24:27], s45 offen
    buffer_store_dwordx2 v[14:15], v10, s[24:27], s46 offen
    buffer_store_dword v14, v12, s[24:27], s47 offen
    buffer_store_dwordx2 v[16:17], v10, s[28:31], s45 offen sc1
    buffer_store_dwordx2 v[14:15], v10, s[28:31], s46 offen sc1
    buffer_store_dword v14, v12, s[28:31], s47 offen sc1
    buffer_store_dwordx2 v[16:17], v10, s[12:15], s66 offen sc1
    s_cmp_eq_u32 s60, 63
    s_cbranch_scc1 L_v_fin_96
    v_mov_b32 v22, s60
    v_mov_b32 v0, 0
    s_mov_b64 exec, 1
    buffer_store_dword v22, v0, s[12:15], s3 offen sc1
    s_mov_b64 exec, -1
    s_and_b32 s65, s60, 1
    s_lshl_b32 s65, s65, 12
    s_and_b32 s45, s60, 2
    s_lshl_b32 s45, s45, 13
    s_add_u32 s65, s65, s45
    s_xor_b32 s45, s65, 16384
    s_add_u32 s45, s45, s63
    buffer_store_dwordx2 v[14:15], v11, s[12:15], s45 offen sc1
    s_add_u32 s48, s63, s65
    s_add_u32 s49, s64, s65
    s_sleep 12
    s_mov_b64 exec, 15
    buffer_load_dword v88, v13, s[12:15], 0 offen sc1
    s_nop 15
    buffer_load_dword v89, v13, s[12:15], 0 offen sc1
    s_nop 15
    buffer_load_dword v90, v13, s[12:15], 0 offen sc1
    s_nop 15
    buffer_load_dword v91, v13, s[12:15], 0 offen sc1
    s_mov_b32 s70, 0
L_pp_97:
    s_waitcnt vmcnt(3)
    v_cmp_ge_u32 vcc, s60, v88
    s_add_u32 s70, s70, 1
    s_nop 0
    s_cbranch_vccz L_ppd_98
    buffer_load_dword v88, v13, s[12:15], 0 offen sc1
    s_waitcnt vmcnt(3)
    v_cmp_ge_u32 vcc, s60, v89
    s_add_u32 s70, s70, 1
    s_nop 0
    s_cbranch_vccz L_ppd_98
    buffer_load_dword v89, v13, s[12:15], 0 offen sc1
    s_waitcnt vmcnt(3)
    v_cmp_ge_u32 vcc, s60, v90
    s_add_u32 s70, s70, 1
    s_nop 0
    s_cbranch_vccz L_ppd_98
    buffer_load_dword v90, v13, s[12:15], 0 offen sc1
    s_waitcnt vmcnt(3)
    v_cmp_ge_u32 vcc, s60, v91
    s_add_u32 s70, s70, 1
    s_nop 0
    s_cbranch_vccz L_ppd_98
    buffer_load_dword v91, v13, s[12:15], 0 offen sc1
    s_cmp_lt_u32 s70, 0x400000
    s_cbranch_scc1 L_pp_97
    s_branch L_c_done_1
L_ppd_98:
    s_mov_b64 exec, -1
    s_nop 15
    s_nop 11
    s_mov_b32 s70, 0
    buffer_load_dwordx4 v[40:43], v80, s[12:15], s62 offen sc1
    v_mov_b32 v24, 0
    v_mov_b32 v25, 0
    v_mov_b32 v26, 0
    v_mov_b32 v27, 0
    s_nop 3
    buffer_load_dwordx4 v[44:47], v81, s[12:15], s62 offen sc1
    v_mov_b32 v28, 0
    v_mov_b32 v29, 0
    v_mov_b32 v30, 0
    v_mov_b32 v31, 0
    s_nop 3
    buffer_load_dwordx4 v[48:51], v82, s[12:15], s62 offen sc1
    v_mov_b32 v32, 0
    v_mov_b32 v33, 0
    v_mov_b32 v34, 0
    v_mov_b32 v35, 0
    s_nop 3
    buffer_load_dwordx4 v[52:55], v83, s[12:15], s62 offen sc1
    v_mov_b32 v36, 0
    v_mov_b32 v37, 0
    v_mov_b32 v38, 0
    v_mov_b32 v39, 0
    s_nop 3
    buffer_load_dwordx4 v[56:59], v84, s[12:15], s62 offen sc1
    s_nop 7
    buffer_load_dwordx4 v[60:63], v85, s[12:15], s62 offen sc1
    s_waitcnt vmcnt(5)
    v_cmp_eq_u32 vcc, -1, v43
    s_nop 1
    s_cbranch_vccnz L_v_og_99_r0
L_v_og_99_c0:
    v_smfmac_f32_16x16x64_bf16 v[24:27], v[40:43], a[160:167], v2
    s_waitcnt vmcnt(4)
    v_smfmac_f32_16x16x64_bf16 v[28:31], v[40:43], a[168:175], v2
    v_cmp_eq_u32 vcc, -1, v47
    v_smfmac_f32_16x16x64_bf16 v[32:35], v[40:43], a[176:183], v2
    buffer_load_dwordx4 v[64:67], v86, s[12:15], s62 offen sc1
    v_smfmac_f32_16x16x64_bf16 v[36:39], v[40:43], a[184:191], v2
    s_cbranch_vccnz L_v_og_99_r1
L_v_og_99_c1:
    v_smfmac_f32_16x16x64_bf16 v[24:27], v[44:47], a[192:199], v2
    s_waitcnt vmcnt(4)
    v_smfmac_f32_16x16x64_bf16 v[28:31], v[44:47], a[200:207], v2
    v_cmp_eq_u32 vcc, -1, v51
    v_smfmac_f32_16x16x64_bf16 v[32:35], v[44:47], a[208:215], v2
    buffer_load_dwordx4 v[68:71], v87, s[12:15], s62 offen sc1
    v_smfmac_f32_16x16x64_bf16 v[36:39], v[44:47], a[216:223], v2
    s_cbranch_vccnz L_v_og_99_r2
L_v_og_99_c2:
    v_smfmac_f32_16x16x64_bf16 v[24:27], v[48:51], a[224:231], v2
    s_waitcnt vmcnt(4)
    v_smfmac_f32_16x16x64_bf16 v[28:31], v[48:51], a[232:239], v2
    v_cmp_eq_u32 vcc, -1, v55
    v_smfmac_f32_16x16x64_bf16 v[32:35], v[48:51], a[240:247], v2
    v_smfmac_f32_16x16x64_bf16 v[36:39], v[48:51], a[248:255], v2
    s_cbranch_vccnz L_v_og_99_r3
L_v_og_99_c3:
    v_smfmac_f32_16x16x64_bf16 v[24:27], v[52:55], v[96:103], v2
    s_waitcnt vmcnt(3)
    v_cmp_eq_u32 vcc, -1, v59
    v_smfmac_f32_16x16x64_bf16 v[28:31], v[52:55], v[104:111], v2
    v_smfmac_f32_16x16x64_bf16 v[32:35], v[52:55], v[112:119], v2
    s_cbranch_vccnz L_v_og_99_r4
L_v_og_99_c4:
    v_smfmac_f32_16x16x64_bf16 v[24:27], v[56:59], v[128:135], v2
    s_waitcnt vmcnt(2)
    v_cmp_eq_u32 vcc, -1, v63
    v_smfmac_f32_16x16x64_bf16 v[28:31], v[56:59], v[136:143], v2
    v_smfmac_f32_16x16x64_bf16 v[32:35], v[56:59], v[144:151], v2
    s_cbranch_vccnz L_v_og_99_r5
L_v_og_99_c5:
    v_smfmac_f32_16x16x64_bf16 v[24:27], v[60:63], v[160:167], v2
    s_waitcnt vmcnt(1)
    v_cmp_eq_u32 vcc, -1, v67
    v_smfmac_f32_16x16x64_bf16 v[28:31], v[60:63], v[168:175], v2
    v_smfmac_f32_16x16x64_bf16 v[32:35], v[60:63], v[176:183], v2
    s_cbranch_vccnz L_v_og_99_r6
L_v_og_99_c6:
    v_smfmac_f32_16x16x64_bf16 v[24:27], v[64:67], v[192:199], v2
    s_waitcnt vmcnt(0)
    v_cmp_eq_u32 vcc, -1, v71
    v_smfmac_f32_16x16x64_bf16 v[28:31], v[64:67], v[200:207], v2
    v_smfmac_f32_16x16x64_bf16 v[32:35], v[64:67], v[208:215], v2
    s_cbranch_vccnz L_v_og_99_r7
L_v_og_99_c7:
    v_smfmac_f32_16x16x64_bf16 v[24:27], v[68:71], v[224:231], v2
    v_smfmac_f32_16x16x64_bf16 v[28:31], v[68:71], v[232:239], v2
    v_smfmac_f32_16x16x64_bf16 v[32:35], v[68:71], v[240:247], v2
    v_smfmac_f32_16x16x64_bf16 v[36:39], v[52:55], v[120:127], v2
    s_add_u32 s46, s60, 1
    v_smfmac_f32_16x16x64_bf16 v[36:39], v[56:59], v[152:159], v2
    s_and_b32 s45, s46, 3
    v_smfmac_f32_16x16x64_bf16 v[36:39], v[60:63], v[184:191], v2
    s_mov_b32 s60, s46
    ds_write_b128 v6, v[24:27] offset:0
    v_smfmac_f32_16x16x64_bf16 v[36:39], v[64:67], v[216:223], v2
    ds_write_b128 v6, v[28:31] offset:1024
    v_smfmac_f32_16x16x64_bf16 v[36:39], v[68:71], v[248:255], v2
    ds_write_b128 v6, v[32:35] offset:2048
    s_lshl_b32 s46, s45, 14
    s_add_u32 s61, s58, s46
    s_lshl_b32 s46, s45, 15
    s_add_u32 s62, s59, s46
    s_waitcnt lgkmcnt(0)
    s_barrier
    ds_read_b128 v[40:43], v7
    ds_read_b128 v[44:47], v8
    ds_read_b128 v[48:51], v18
    s_waitcnt lgkmcnt(2)
    v_pk_add_f32 v[36:37], v[36:37], v[40:41]
    v_pk_add_f32 v[38:39], v[38:39], v[42:43]
    s_waitcnt lgkmcnt(1)
    v_pk_add_f32 v[36:37], v[36:37], v[44:45]
    v_pk_add_f32 v[38:39], v[38:39], v[46:47]
    s_waitcnt lgkmcnt(0)
    v_pk_add_f32 v[36:37], v[36:37], v[48:49]
    v_pk_add_f32 v[38:39], v[38:39], v[50:51]
    s_nop 1
    v_permlane32_swap_b32 v36, v38
    v_permlane32_swap_b32 v37, v39
    v_pk_add_f32 v[24:25], v[36:37], v[38:39]
    buffer_store_dwordx2 v[24:25], v11, s[12:15], s48 offen sc1
    s_bitcmp1_b64 s[6:7], s60
    s_cbranch_scc0 L_v_eag_100
    v_mov_b32 v22, s60
    v_mov_b32 v0, 0
    s_mov_b64 exec, 1
    buffer_store_dword v22, v0, s[12:15], s3 offen sc1
    s_mov_b64 exec, -1
L_v_eag_100:
    ds_read_b128 v[56:59], v5 offset:8192
    ds_read_b128 v[60:63], v5 offset:9216
    ds_read_b128 v[64:67], v5 offset:16384
    ds_read_b128 v[68:71], v5 offset:17408
    ds_read_b128 v[72:75], v5 offset:4096
    ds_read_b128 v[76:79], v5 offset:5120
    ds_read_b128 v[88:91], v5 offset:6144
    ds_read_b128 v[92:95], v5 offset:7168
    ds_read_b128 v[32:35], v5 offset:14336
    ds_read_b128 v[36:39], v5 offset:15360
    s_sleep 4
    buffer_load_dwordx2 v[40:41], v11, s[12:15], s49 offen sc1
    s_mov_b32 s70, 0
L_v_xp_101:
    s_waitcnt vmcnt(0)
    v_max_u32 v22, v40, v41
    v_cmp_eq_u32 vcc, -1, v22
    v_pk_add_f32 v[28:29], v[24:25], v[40:41]
    v_cvt_pk_bf16_f32 v28, v28, v29
    s_cbranch_vccz L_v_xp_101_ok
    buffer_load_dwordx2 v[40:41], v11, s[12:15], s49 offen sc1
    s_add_u32 s70, s70, 1
    s_cmp_lt_u32 s70, 0x100000
    s_cbranch_scc1 L_v_xp_101
    s_branch L_c_done_1
L_v_xp_101_ok:
    s_add_u32 s66, s66, 65536
    v_mov_b32_dpp v29, v28 quad_perm:[1,0,3,2] row_mask:0xf bank_mask:0xf
    v_perm_b32 v28, v28, v29, v9
    buffer_store_dword v28, v12, s[24:27], s61 offen
    buffer_store_dword v28, v12, s[28:31], s61 offen sc1
    s_branch L_v_loop_94
L_v_fin_96:
    s_waitcnt vmcnt(0)
    v_mov_b32 v22, 64
    v_mov_b32 v0, 0
    s_mov_b64 exec, 1
    buffer_store_dword v22, v0, s[12:15], s3 offen sc1
    s_mov_b64 exec, -1
L_c_done_1:
    s_endpgm
L_v_og_99_r0:
    buffer_load_dwordx4 v[40:43], v80, s[12:15], s62 offen sc1
    buffer_load_dwordx4 v[44:47], v81, s[12:15], s62 offen sc1
    buffer_load_dwordx4 v[48:51], v82, s[12:15], s62 offen sc1
    buffer_load_dwordx4 v[52:55], v83, s[12:15], s62 offen sc1
    buffer_load_dwordx4 v[56:59], v84, s[12:15], s62 offen sc1
    buffer_load_dwordx4 v[60:63], v85, s[12:15], s62 offen sc1
    s_add_u32 s70, s70, 1
    s_cmp_ge_u32 s70, 0x100000
    s_cbranch_scc1 L_c_done_1
    s_waitcnt vmcnt(5)
    v_cmp_eq_u32 vcc, -1, v43
    s_nop 1
    s_cbranch_vccnz L_v_og_99_r0
    s_branch L_v_og_99_c0
L_v_og_99_r1:
    buffer_load_dwordx4 v[44:47], v81, s[12:15], s62 offen sc1
    buffer_load_dwordx4 v[48:51], v82, s[12:15], s62 offen sc1
    buffer_load_dwordx4 v[52:55], v83, s[12:15], s62 offen sc1
    buffer_load_dwordx4 v[56:59], v84, s[12:15], s62 offen sc1
    buffer_load_dwordx4 v[60:63], v85, s[12:15], s62 offen sc1
    buffer_load_dwordx4 v[64:67], v86, s[12:15], s62 offen sc1
    s_add_u32 s70, s70, 1
    s_cmp_ge_u32 s70, 0x100000
    s_cbranch_scc1 L_c_done_1
    s_waitcnt vmcnt(5)
    v_cmp_eq_u32 vcc, -1, v47
    s_nop 1
    s_cbranch_vccnz L_v_og_99_r1
    s_branch L_v_og_99_c1
L_v_og_99_r2:
    buffer_load_dwordx4 v[48:51], v82, s[12:15], s62 offen sc1
    buffer_load_dwordx4 v[52:55], v83, s[12:15], s62 offen sc1
    buffer_load_dwordx4 v[56:59], v84, s[12:15], s62 offen sc1
    buffer_load_dwordx4 v[60:63], v85, s[12:15], s62 offen sc1
    buffer_load_dwordx4 v[64:67], v86, s[12:15], s62 offen sc1
    buffer_load_dwordx4 v[68:71], v87, s[12:15], s62 offen sc1
    s_add_u32 s70, s70, 1
    s_cmp_ge_u32 s70, 0x100000
    s_cbranch_scc1 L_c_done_1
    s_waitcnt vmcnt(5)
    v_cmp_eq_u32 vcc, -1, v51
    s_nop 1
    s_cbranch_vccnz L_v_og_99_r2
    s_branch L_v_og_99_c2
L_v_og_99_r3:
    buffer_load_dwordx4 v[52:55], v83, s[12:15], s62 offen sc1
    buffer_load_dwordx4 v[56:59], v84, s[12:15], s62 offen sc1
    buffer_load_dwordx4 v[60:63], v85, s[12:15], s62 offen sc1
    buffer_load_dwordx4 v[64:67], v86, s[12:15], s62 offen sc1
    buffer_load_dwordx4 v[68:71], v87, s[12:15], s62 offen sc1
    s_add_u32 s70, s70, 1
    s_cmp_ge_u32 s70, 0x100000
    s_cbranch_scc1 L_c_done_1
    s_waitcnt vmcnt(4)
    v_cmp_eq_u32 vcc, -1, v55
    s_nop 1
    s_cbranch_vccnz L_v_og_99_r3
    s_branch L_v_og_99_c3
L_v_og_99_r4:
    buffer_load_dwordx4 v[56:59], v84, s[12:15], s62 offen sc1
    buffer_load_dwordx4 v[60:63], v85, s[12:15], s62 offen sc1
    buffer_load_dwordx4 v[64:67], v86, s[12:15], s62 offen sc1
    buffer_load_dwordx4 v[68:71], v87, s[12:15], s62 offen sc1
    s_add_u32 s70, s70, 1
    s_cmp_ge_u32 s70, 0x100000
    s_cbranch_scc1 L_c_done_1
    s_waitcnt vmcnt(3)
    v_cmp_eq_u32 vcc, -1, v59
    s_nop 1
    s_cbranch_vccnz L_v_og_99_r4
    s_branch L_v_og_99_c4
L_v_og_99_r5:
    buffer_load_dwordx4 v[60:63], v85, s[12:15], s62 offen sc1
    buffer_load_dwordx4 v[64:67], v86, s[12:15], s62 offen sc1
    buffer_load_dwordx4 v[68:71], v87, s[12:15], s62 offen sc1
    s_add_u32 s70, s70, 1
    s_cmp_ge_u32 s70, 0x100000
    s_cbranch_scc1 L_c_done_1
    s_waitcnt vmcnt(2)
    v_cmp_eq_u32 vcc, -1, v63
    s_nop 1
    s_cbranch_vccnz L_v_og_99_r5
    s_branch L_v_og_99_c5
L_v_og_99_r6:
    buffer_load_dwordx4 v[64:67], v86, s[12:15], s62 offen sc1
    buffer_load_dwordx4 v[68:71], v87, s[12:15], s62 offen sc1
    s_add_u32 s70, s70, 1
    s_cmp_ge_u32 s70, 0x100000
    s_cbranch_scc1 L_c_done_1
    s_waitcnt vmcnt(1)
    v_cmp_eq_u32 vcc, -1, v67
    s_nop 1
    s_cbranch_vccnz L_v_og_99_r6
    s_branch L_v_og_99_c6
L_v_og_99_r7:
    buffer_load_dwordx4 v[68:71], v87, s[12:15], s62 offen sc1
    s_add_u32 s70, s70, 1
    s_cmp_ge_u32 s70, 0x100000
    s_cbranch_scc1 L_c_done_1
    s_waitcnt vmcnt(0)
    v_cmp_eq_u32 vcc, -1, v71
    s_nop 1
    s_cbranch_vccnz L_v_og_99_r7
    s_branch L_v_og_99_c7
L_mg_95_r0:
    buffer_load_dwordx4 v[40:43], v3, s[12:15], s8 offen sc1
    buffer_load_dwordx4 v[44:47], v3, s[12:15], s9 offen sc1
    buffer_load_dwordx4 v[48:51], v3, s[12:15], s10 offen sc1
    buffer_load_dwordx4 v[52:55], v3, s[12:15], s11 offen sc1
    s_add_u32 s70, s70, 1
    s_cmp_ge_u32 s70, 0x100000
    s_cbranch_scc1 L_c_done_1
    s_waitcnt vmcnt(3)
    ds_write_b128 v3, v[40:43] offset:0
    v_max3_u32 v22, v40, v41, v42
    v_max_u32 v22, v22, v43
    v_cmp_eq_u32 vcc, -1, v22
    s_waitcnt lgkmcnt(0)
    s_nop 0
    s_cbranch_vccnz L_mg_95_r0
    s_branch L_mg_95_c0
L_mg_95_r1:
    buffer_load_dwordx4 v[44:47], v3, s[12:15], s9 offen sc1
    buffer_load_dwordx4 v[48:51], v3, s[12:15], s10 offen sc1
    buffer_load_dwordx4 v[52:55], v3, s[12:15], s11 offen sc1
    s_add_u32 s70, s70, 1
    s_cmp_ge_u32 s70, 0x100000
    s_cbranch_scc1 L_c_done_1
    s_waitcnt vmcnt(2)
    ds_write_b128 v3, v[44:47] offset:1024
    v_max3_u32 v22, v44, v45, v46
    v_max_u32 v22, v22, v47
    v_cmp_eq_u32 vcc, -1, v22
    s_waitcnt lgkmcnt(0)
    s_nop 0
    s_cbranch_vccnz L_mg_95_r1
    s_branch L_mg_95_c1
L_mg_95_r2:
    buffer_load_dwordx4 v[48:51], v3, s[12:15], s10 offen sc1
    buffer_load_dwordx4 v[52:55], v3, s[12:15], s11 offen sc1
    s_add_u32 s70, s70, 1
    s_cmp_ge_u32 s70, 0x100000
    s_cbranch_scc1 L_c_done_1
    s_waitcnt vmcnt(1)
    ds_write_b128 v3, v[48:51] offset:2048
    v_max3_u32 v22, v48, v49, v50
    v_max_u32 v22, v22, v51
    v_cmp_eq_u32 vcc, -1, v22
    s_waitcnt lgkmcnt(0)
    s_nop 0
    s_cbranch_vccnz L_mg_95_r2
    s_branch L_mg_95_c2
L_mg_95_r3:
    buffer_load_dwordx4 v[52:55], v3, s[12:15], s11 offen sc1
    s_add_u32 s70, s70, 1
    s_cmp_ge_u32 s70, 0x100000
    s_cbranch_scc1 L_c_done_1
    s_waitcnt vmcnt(0)
    ds_write_b128 v3, v[52:55] offset:3072
    v_max3_u32 v22, v52, v53, v54
    v_max_u32 v22, v22, v55
    v_cmp_eq_u32 vcc, -1, v22
    s_waitcnt lgkmcnt(0)
    s_nop 0
    s_cbranch_vccnz L_mg_95_r3
    s_branch L_mg_95_c3
L_worker_3:
    s_lshr_b32 s41, s2, 3
    s_and_b32 s42, s40, 1
    s_lshr_b32 s43, s40, 1
    s_lshl_b32 s39, s43, 5
    s_add_u32 s39, s39, s41
    s_load_dwordx2 s[4:5], s[0:1], 0
    s_waitcnt lgkmcnt(0)
    s_mov_b32 s28, s4
    s_and_b32 s29, s5, 0xffff
    s_mov_b32 s30, 0x400000
    s_mov_b32 s31, 0x00020000
    v_lshrrev_b32 v2, 4, v1
    v_and_b32 v4, 15, v1
    v_lshrrev_b32 v3, 1, v4
    v_xor_b32 v3, v3, v2
    v_lshlrev_b32 v3, 4, v3
    v_lshlrev_b32 v6, 7, v4
    v_add_u32 v3, v3, v6
    v_mul_u32_u24 v7, 144, v4
    v_lshlrev_b32 v6, 4, v2
    s_mul_i32 s45, s44, 4608
    s_add_u32 s45, s45, 131072
    v_add3_u32 v7, v7, v6, s45
    v_lshrrev_b32 v9, 3, v1
    v_mul_u32_u24 v8, 144, v9
    v_and_b32 v6, 7, v1
    v_lshlrev_b32 v6, 4, v6
    v_add3_u32 v8, v8, v6, s45
    v_lshlrev_b32 v11, 12, v9
    v_add_u32 v11, v11, v6
    v_lshlrev_b32 v2, 13, v2
    v_lshlrev_b32 v6, 4, v4
    v_add_u32 v2, v2, v6
    v_lshrrev_b32 v6, 3, v1
    v_lshrrev_b32 v9, 4, v1
    v_and_b32 v4, 7, v1
    v_xor_b32 v9, v9, v4
    v_lshlrev_b32 v9, 4, v9
    v_lshlrev_b32 v6, 8, v6
    v_add_u32 v6, v6, v9
    v_xor_b32 v9, 64, v6
    v_add_u32 v9, 2048, v9
    v_lshlrev_b32 v10, 4, v1
    v_lshlrev_b32 v12, 2, v1
    v_lshlrev_b32 v5, 7, v1
    s_lshl_b32 s61, s41, 7
    s_lshl_b32 s45, s43, 2
    s_add_u32 s61, s61, s45
    s_add_u32 s61, s61, 0x10010
    s_mul_i32 s64, s42, 24576
    s_add_u32 s64, s64, 0x12000
    s_lshl_b32 s45, s41, 7
    s_add_u32 s65, s64, s45
    s_lshl_b32 s45, s43, 13
    s_add_u32 s65, s65, s45
    s_add_u32 s67, s65, 4096
    s_cmp_lg_u32 s42, 0
    s_cbranch_scc1 L_w_kv_103
    v_mov_b32 v30, 0
    v_mov_b32 v31, 0
    v_mov_b32 v29, 24576
    s_mov_b64 exec, 1
    buffer_store_dword v30, v31, s[12:15], s61 offen sc1
    buffer_store_dword v30, v31, s[12:15], s65 offen sc1
    buffer_store_dword v30, v31, s[12:15], s67 offen sc1
    buffer_store_dword v30, v29, s[12:15], s65 offen sc1
    buffer_store_dword v30, v29, s[12:15], s67 offen sc1
    s_mov_b64 exec, -1
    s_lshl_b32 s63, s39, 2
    s_add_u32 s63, s63, s44
    s_load_dwordx2 s[4:5], s[0:1], 96
    s_load_dwordx2 s[6:7], s[0:1], 104
    v_and_b32 v14, 7, v0
    v_lshrrev_b32 v15, 3, v0
    s_waitcnt lgkmcnt(0)
    s_mov_b32 s32, s4
    s_and_b32 s33, s5, 0xffff
    s_mov_b32 s34, 0x800
    s_mov_b32 s35, 0x00020000
    s_mov_b32 s24, s6
    s_and_b32 s25, s7, 0xffff
    s_mov_b32 s26, 0xc00000
    s_mov_b32 s27, 0x00020000
    s_and_b32 s47, s39, 1
    s_lshl_b32 s45, s47, 10
    v_lshlrev_b32 v16, 5, v15
    buffer_load_dwordx4 v[104:107], v16, s[32:35], s45 offen
    buffer_load_dwordx4 v[108:111], v16, s[32:35], s45 offen offset:16
    s_mov_b32 s45, 196608
    v_mul_lo_u32 v17, v15, s45
    v_lshlrev_b32 v18, 4, v14
    v_add_u32 v17, v17, v18
    s_lshr_b32 s46, s39, 1
    s_lshl_b32 s46, s46, 7
    s_mul_i32 s45, s47, 6291456
    s_add_u32 s46, s46, s45
    buffer_load_dwordx4 v[32:35], v17, s[24:27], s46 offen
    v_add_u32 v17, 12288, v17
    buffer_load_dwordx4 v[36:39], v17, s[24:27], s46 offen
    v_add_u32 v17, 12288, v17
    buffer_load_dwordx4 v[40:43], v17, s[24:27], s46 offen
    v_add_u32 v17, 12288, v17
    buffer_load_dwordx4 v[44:47], v17, s[24:27], s46 offen
    v_add_u32 v17, 12288, v17
    buffer_load_dwordx4 v[48:51], v17, s[24:27], s46 offen
    v_add_u32 v17, 12288, v17
    buffer_load_dwordx4 v[52:55], v17, s[24:27], s46 offen
    v_add_u32 v17, 12288, v17
    buffer_load_dwordx4 v[56:59], v17, s[24:27], s46 offen
    v_add_u32 v17, 12288, v17
    buffer_load_dwordx4 v[60:63], v17, s[24:27], s46 offen
    v_add_u32 v17, 12288, v17
    buffer_load_dwordx4 v[64:67], v17, s[24:27], s46 offen
    v_add_u32 v17, 12288, v17
    buffer_load_dwordx4 v[68:71], v17, s[24:27], s46 offen
    v_add_u32 v17, 12288, v17
    buffer_load_dwordx4 v[72:75], v17, s[24:27], s46 offen
    v_add_u32 v17, 12288, v17
    buffer_load_dwordx4 v[76:79], v17, s[24:27], s46 offen
    v_add_u32 v17, 12288, v17
    buffer_load_dwordx4 v[80:83], v17, s[24:27], s46 offen
    v_add_u32 v17, 12288, v17
    buffer_load_dwordx4 v[84:87], v17, s[24:27], s46 offen
    v_add_u32 v17, 12288, v17
    buffer_load_dwordx4 v[88:91], v17, s[24:27], s46 offen
    v_add_u32 v17, 12288, v17
    buffer_load_dwordx4 v[92:95], v17, s[24:27], s46 offen
    s_add_u32 s45, s63, 0
    s_lshl_b32 s45, s45, 11
    buffer_load_dwordx4 v[128:131], v10, s[28:31], s45 offen
    buffer_load_dwordx4 v[132:135], v10, s[28:31], s45 offen offset:1024
    s_add_u32 s45, s63, 384
    s_lshl_b32 s45, s45, 11
    buffer_load_dwordx4 v[136:139], v10, s[28:31], s45 offen
    buffer_load_dwordx4 v[140:143], v10, s[28:31], s45 offen offset:1024
    s_add_u32 s45, s63, 768
    s_lshl_b32 s45, s45, 11
    buffer_load_dwordx4 v[144:147], v10, s[28:31], s45 offen
    buffer_load_dwordx4 v[148:151], v10, s[28:31], s45 offen offset:1024
    s_add_u32 s45, s63, 1152
    s_lshl_b32 s45, s45, 11
    buffer_load_dwordx4 v[152:155], v10, s[28:31], s45 offen
    buffer_load_dwordx4 v[156:159], v10, s[28:31], s45 offen offset:1024
    s_add_u32 s45, s63, 1536
    s_lshl_b32 s45, s45, 11
    buffer_load_dwordx4 v[160:163], v10, s[28:31], s45 offen
    buffer_load_dwordx4 v[164:167], v10, s[28:31], s45 offen offset:1024
    s_add_u32 s45, s63, 1920
    s_lshl_b32 s45, s45, 11
    buffer_load_dwordx4 v[168:171], v10, s[28:31], s45 offen
    buffer_load_dwordx4 v[172:175], v10, s[28:31], s45 offen offset:1024
    s_waitcnt vmcnt(28)
    v_lshlrev_b32 v112, 16, v104
    v_and_b32 v113, 0xffff0000, v104
    v_lshlrev_b32 v114, 16, v105
    v_and_b32 v115, 0xffff0000, v105
    v_lshlrev_b32 v116, 16, v106
    v_and_b32 v117, 0xffff0000, v106
    v_lshlrev_b32 v118, 16, v107
    v_and_b32 v119, 0xffff0000, v107
    v_lshlrev_b32 v120, 16, v108
    v_and_b32 v121, 0xffff0000, v108
    v_lshlrev_b32 v122, 16, v109
    v_and_b32 v123, 0xffff0000, v109
    v_lshlrev_b32 v124, 16, v110
    v_and_b32 v125, 0xffff0000, v110
    v_lshlrev_b32 v126, 16, v111
    v_and_b32 v127, 0xffff0000, v111
    v_mul_f32 v18, 0xbfb8aa3b, v112
    v_exp_f32 v18, v18
    s_nop 0
    v_add_f32 v18, 1.0, v18
    v_rcp_f32 v18, v18
    s_nop 0
    v_mul_f32 v112, v112, v18
    v_cvt_pk_bf16_f32 v112, v112, v112
    v_lshlrev_b32 v112, 16, v112
    v_mul_f32 v18, 0xbfb8aa3b, v113
    v_exp_f32 v18, v18
    s_nop 0
    v_add_f32 v18, 1.0, v18
    v_rcp_f32 v18, v18
    s_nop 0
    v_mul_f32 v113, v113, v18
    v_cvt_pk_bf16_f32 v113, v113, v113
    v_lshlrev_b32 v113, 16, v113
    v_mul_f32 v18, 0xbfb8aa3b, v114
    v_exp_f32 v18, v18
    s_nop 0
    v_add_f32 v18, 1.0, v18
    v_rcp_f32 v18, v18
    s_nop 0
    v_mul_f32 v114, v114, v18
    v_cvt_pk_bf16_f32 v114, v114, v114
    v_lshlrev_b32 v114, 16, v114
    v_mul_f32 v18, 0xbfb8aa3b, v115
    v_exp_f32 v18, v18
    s_nop 0
    v_add_f32 v18, 1.0, v18
    v_rcp_f32 v18, v18
    s_nop 0
    v_mul_f32 v115, v115, v18
    v_cvt_pk_bf16_f32 v115, v115, v115
    v_lshlrev_b32 v115, 16, v115
    v_mul_f32 v18, 0xbfb8aa3b, v116
    v_exp_f32 v18, v18
    s_nop 0
    v_add_f32 v18, 1.0, v18
    v_rcp_f32 v18, v18
    s_nop 0
    v_mul_f32 v116, v116, v18
    v_cvt_pk_bf16_f32 v116, v116, v116
    v_lshlrev_b32 v116, 16, v116
    v_mul_f32 v18, 0xbfb8aa3b, v117
    v_exp_f32 v18, v18
    s_nop 0
    v_add_f32 v18, 1.0, v18
    v_rcp_f32 v18, v18
    s_nop 0
    v_mul_f32 v117, v117, v18
    v_cvt_pk_bf16_f32 v117, v117, v117
    v_lshlrev_b32 v117, 16, v117
    v_mul_f32 v18, 0xbfb8aa3b, v118
    v_exp_f32 v18, v18
    s_nop 0
    v_add_f32 v18, 1.0, v18
    v_rcp_f32 v18, v18
    s_nop 0
    v_mul_f32 v118, v118, v18
    v_cvt_pk_bf16_f32 v118, v118, v118
    v_lshlrev_b32 v118, 16, v118
    v_mul_f32 v18, 0xbfb8aa3b, v119
    v_exp_f32 v18, v18
    s_nop 0
    v_add_f32 v18, 1.0, v18
    v_rcp_f32 v18, v18
    s_nop 0
    v_mul_f32 v119, v119, v18
    v_cvt_pk_bf16_f32 v119, v119, v119
    v_lshlrev_b32 v119, 16, v119
    v_mul_f32 v18, 0xbfb8aa3b, v120
    v_exp_f32 v18, v18
    s_nop 0
    v_add_f32 v18, 1.0, v18
    v_rcp_f32 v18, v18
    s_nop 0
    v_mul_f32 v120, v120, v18
    v_cvt_pk_bf16_f32 v120, v120, v120
    v_lshlrev_b32 v120, 16, v120
    v_mul_f32 v18, 0xbfb8aa3b, v121
    v_exp_f32 v18, v18
    s_nop 0
    v_add_f32 v18, 1.0, v18
    v_rcp_f32 v18, v18
    s_nop 0
    v_mul_f32 v121, v121, v18
    v_cvt_pk_bf16_f32 v121, v121, v121
    v_lshlrev_b32 v121, 16, v121
    v_mul_f32 v18, 0xbfb8aa3b, v122
    v_exp_f32 v18, v18
    s_nop 0
    v_add_f32 v18, 1.0, v18
    v_rcp_f32 v18, v18
    s_nop 0
    v_mul_f32 v122, v122, v18
    v_cvt_pk_bf16_f32 v122, v122, v122
    v_lshlrev_b32 v122, 16, v122
    v_mul_f32 v18, 0xbfb8aa3b, v123
    v_exp_f32 v18, v18
    s_nop 0
    v_add_f32 v18, 1.0, v18
    v_rcp_f32 v18, v18
    s_nop 0
    v_mul_f32 v123, v123, v18
    v_cvt_pk_bf16_f32 v123, v123, v123
    v_lshlrev_b32 v123, 16, v123
    v_mul_f32 v18, 0xbfb8aa3b, v124
    v_exp_f32 v18, v18
    s_nop 0
    v_add_f32 v18, 1.0, v18
    v_rcp_f32 v18, v18
    s_nop 0
    v_mul_f32 v124, v124, v18
    v_cvt_pk_bf16_f32 v124, v124, v124
    v_lshlrev_b32 v124, 16, v124
    v_mul_f32 v18, 0xbfb8aa3b, v125
    v_exp_f32 v18, v18
    s_nop 0
    v_add_f32 v18, 1.0, v18
    v_rcp_f32 v18, v18
    s_nop 0
    v_mul_f32 v125, v125, v18
    v_cvt_pk_bf16_f32 v125, v125, v125
    v_lshlrev_b32 v125, 16, v125
    v_mul_f32 v18, 0xbfb8aa3b, v126
    v_exp_f32 v18, v18
    s_nop 0
    v_add_f32 v18, 1.0, v18
    v_rcp_f32 v18, v18
    s_nop 0
    v_mul_f32 v126, v126, v18
    v_cvt_pk_bf16_f32 v126, v126, v126
    v_lshlrev_b32 v126, 16, v126
    v_mul_f32 v18, 0xbfb8aa3b, v127
    v_exp_f32 v18, v18
    s_nop 0
    v_add_f32 v18, 1.0, v18
    v_rcp_f32 v18, v18
    s_nop 0
    v_mul_f32 v127, v127, v18
    v_cvt_pk_bf16_f32 v127, v127, v127
    v_lshlrev_b32 v127, 16, v127
    v_mov_b32 v96, 0
    v_mov_b32 v97, 0
    v_mov_b32 v98, 0
    v_mov_b32 v99, 0
    v_mov_b32 v100, 0
    v_mov_b32 v101, 0
    v_mov_b32 v102, 0
    v_mov_b32 v103, 0
    s_waitcnt vmcnt(27)
    v_lshlrev_b32 v18, 16, v32
    v_and_b32 v19, 0xffff0000, v32
    v_fmac_f32 v96, v18, v112
    v_fmac_f32 v97, v19, v112
    v_lshlrev_b32 v18, 16, v33
    v_and_b32 v19, 0xffff0000, v33
    v_fmac_f32 v98, v18, v112
    v_fmac_f32 v99, v19, v112
    v_lshlrev_b32 v18, 16, v34
    v_and_b32 v19, 0xffff0000, v34
    v_fmac_f32 v100, v18, v112
    v_fmac_f32 v101, v19, v112
    v_lshlrev_b32 v18, 16, v35
    v_and_b32 v19, 0xffff0000, v35
    v_fmac_f32 v102, v18, v112
    v_fmac_f32 v103, v19, v112
    s_waitcnt vmcnt(26)
    v_lshlrev_b32 v18, 16, v36
    v_and_b32 v19, 0xffff0000, v36
    v_fmac_f32 v96, v18, v113
    v_fmac_f32 v97, v19, v113
    v_lshlrev_b32 v18, 16, v37
    v_and_b32 v19, 0xffff0000, v37
    v_fmac_f32 v98, v18, v113
    v_fmac_f32 v99, v19, v113
    v_lshlrev_b32 v18, 16, v38
    v_and_b32 v19, 0xffff0000, v38
    v_fmac_f32 v100, v18, v113
    v_fmac_f32 v101, v19, v113
    v_lshlrev_b32 v18, 16, v39
    v_and_b32 v19, 0xffff0000, v39
    v_fmac_f32 v102, v18, v113
    v_fmac_f32 v103, v19, v113
    s_waitcnt vmcnt(25)
    v_lshlrev_b32 v18, 16, v40
    v_and_b32 v19, 0xffff0000, v40
    v_fmac_f32 v96, v18, v114
    v_fmac_f32 v97, v19, v114
    v_lshlrev_b32 v18, 16, v41
    v_and_b32 v19, 0xffff0000, v41
    v_fmac_f32 v98, v18, v114
    v_fmac_f32 v99, v19, v114
    v_lshlrev_b32 v18, 16, v42
    v_and_b32 v19, 0xffff0000, v42
    v_fmac_f32 v100, v18, v114
    v_fmac_f32 v101, v19, v114
    v_lshlrev_b32 v18, 16, v43
    v_and_b32 v19, 0xffff0000, v43
    v_fmac_f32 v102, v18, v114
    v_fmac_f32 v103, v19, v114
    s_waitcnt vmcnt(24)
    v_lshlrev_b32 v18, 16, v44
    v_and_b32 v19, 0xffff0000, v44
    v_fmac_f32 v96, v18, v115
    v_fmac_f32 v97, v19, v115
    v_lshlrev_b32 v18, 16, v45
    v_and_b32 v19, 0xffff0000, v45
    v_fmac_f32 v98, v18, v115
    v_fmac_f32 v99, v19, v115
    v_lshlrev_b32 v18, 16, v46
    v_and_b32 v19, 0xffff0000, v46
    v_fmac_f32 v100, v18, v115
    v_fmac_f32 v101, v19, v115
    v_lshlrev_b32 v18, 16, v47
    v_and_b32 v19, 0xffff0000, v47
    v_fmac_f32 v102, v18, v115
    v_fmac_f32 v103, v19, v115
    s_waitcnt vmcnt(23)
    v_lshlrev_b32 v18, 16, v48
    v_and_b32 v19, 0xffff0000, v48
    v_fmac_f32 v96, v18, v116
    v_fmac_f32 v97, v19, v116
    v_lshlrev_b32 v18, 16, v49
    v_and_b32 v19, 0xffff0000, v49
    v_fmac_f32 v98, v18, v116
    v_fmac_f32 v99, v19, v116
    v_lshlrev_b32 v18, 16, v50
    v_and_b32 v19, 0xffff0000, v50
    v_fmac_f32 v100, v18, v116
    v_fmac_f32 v101, v19, v116
    v_lshlrev_b32 v18, 16, v51
    v_and_b32 v19, 0xffff0000, v51
    v_fmac_f32 v102, v18, v116
    v_fmac_f32 v103, v19, v116
    s_waitcnt vmcnt(22)
    v_lshlrev_b32 v18, 16, v52
    v_and_b32 v19, 0xffff0000, v52
    v_fmac_f32 v96, v18, v117
    v_fmac_f32 v97, v19, v117
    v_lshlrev_b32 v18, 16, v53
    v_and_b32 v19, 0xffff0000, v53
    v_fmac_f32 v98, v18, v117
    v_fmac_f32 v99, v19, v117
    v_lshlrev_b32 v18, 16, v54
    v_and_b32 v19, 0xffff0000, v54
    v_fmac_f32 v100, v18, v117
    v_fmac_f32 v101, v19, v117
    v_lshlrev_b32 v18, 16, v55
    v_and_b32 v19, 0xffff0000, v55
    v_fmac_f32 v102, v18, v117
    v_fmac_f32 v103, v19, v117
    s_waitcnt vmcnt(21)
    v_lshlrev_b32 v18, 16, v56
    v_and_b32 v19, 0xffff0000, v56
    v_fmac_f32 v96, v18, v118
    v_fmac_f32 v97, v19, v118
    v_lshlrev_b32 v18, 16, v57
    v_and_b32 v19, 0xffff0000, v57
    v_fmac_f32 v98, v18, v118
    v_fmac_f32 v99, v19, v118
    v_lshlrev_b32 v18, 16, v58
    v_and_b32 v19, 0xffff0000, v58
    v_fmac_f32 v100, v18, v118
    v_fmac_f32 v101, v19, v118
    v_lshlrev_b32 v18, 16, v59
    v_and_b32 v19, 0xffff0000, v59
    v_fmac_f32 v102, v18, v118
    v_fmac_f32 v103, v19, v118
    s_waitcnt vmcnt(20)
    v_lshlrev_b32 v18, 16, v60
    v_and_b32 v19, 0xffff0000, v60
    v_fmac_f32 v96, v18, v119
    v_fmac_f32 v97, v19, v119
    v_lshlrev_b32 v18, 16, v61
    v_and_b32 v19, 0xffff0000, v61
    v_fmac_f32 v98, v18, v119
    v_fmac_f32 v99, v19, v119
    v_lshlrev_b32 v18, 16, v62
    v_and_b32 v19, 0xffff0000, v62
    v_fmac_f32 v100, v18, v119
    v_fmac_f32 v101, v19, v119
    v_lshlrev_b32 v18, 16, v63
    v_and_b32 v19, 0xffff0000, v63
    v_fmac_f32 v102, v18, v119
    v_fmac_f32 v103, v19, v119
    s_waitcnt vmcnt(19)
    v_lshlrev_b32 v18, 16, v64
    v_and_b32 v19, 0xffff0000, v64
    v_fmac_f32 v96, v18, v120
    v_fmac_f32 v97, v19, v120
    v_lshlrev_b32 v18, 16, v65
    v_and_b32 v19, 0xffff0000, v65
    v_fmac_f32 v98, v18, v120
    v_fmac_f32 v99, v19, v120
    v_lshlrev_b32 v18, 16, v66
    v_and_b32 v19, 0xffff0000, v66
    v_fmac_f32 v100, v18, v120
    v_fmac_f32 v101, v19, v120
    v_lshlrev_b32 v18, 16, v67
    v_and_b32 v19, 0xffff0000, v67
    v_fmac_f32 v102, v18, v120
    v_fmac_f32 v103, v19, v120
    s_waitcnt vmcnt(18)
    v_lshlrev_b32 v18, 16, v68
    v_and_b32 v19, 0xffff0000, v68
    v_fmac_f32 v96, v18, v121
    v_fmac_f32 v97, v19, v121
    v_lshlrev_b32 v18, 16, v69
    v_and_b32 v19, 0xffff0000, v69
    v_fmac_f32 v98, v18, v121
    v_fmac_f32 v99, v19, v121
    v_lshlrev_b32 v18, 16, v70
    v_and_b32 v19, 0xffff0000, v70
    v_fmac_f32 v100, v18, v121
    v_fmac_f32 v101, v19, v121
    v_lshlrev_b32 v18, 16, v71
    v_and_b32 v19, 0xffff0000, v71
    v_fmac_f32 v102, v18, v121
    v_fmac_f32 v103, v19, v121
    s_waitcnt vmcnt(17)
    v_lshlrev_b32 v18, 16, v72
    v_and_b32 v19, 0xffff0000, v72
    v_fmac_f32 v96, v18, v122
    v_fmac_f32 v97, v19, v122
    v_lshlrev_b32 v18, 16, v73
    v_and_b32 v19, 0xffff0000, v73
    v_fmac_f32 v98, v18, v122
    v_fmac_f32 v99, v19, v122
    v_lshlrev_b32 v18, 16, v74
    v_and_b32 v19, 0xffff0000, v74
    v_fmac_f32 v100, v18, v122
    v_fmac_f32 v101, v19, v122
    v_lshlrev_b32 v18, 16, v75
    v_and_b32 v19, 0xffff0000, v75
    v_fmac_f32 v102, v18, v122
    v_fmac_f32 v103, v19, v122
    s_waitcnt vmcnt(16)
    v_lshlrev_b32 v18, 16, v76
    v_and_b32 v19, 0xffff0000, v76
    v_fmac_f32 v96, v18, v123
    v_fmac_f32 v97, v19, v123
    v_lshlrev_b32 v18, 16, v77
    v_and_b32 v19, 0xffff0000, v77
    v_fmac_f32 v98, v18, v123
    v_fmac_f32 v99, v19, v123
    v_lshlrev_b32 v18, 16, v78
    v_and_b32 v19, 0xffff0000, v78
    v_fmac_f32 v100, v18, v123
    v_fmac_f32 v101, v19, v123
    v_lshlrev_b32 v18, 16, v79
    v_and_b32 v19, 0xffff0000, v79
    v_fmac_f32 v102, v18, v123
    v_fmac_f32 v103, v19, v123
    s_waitcnt vmcnt(15)
    v_lshlrev_b32 v18, 16, v80
    v_and_b32 v19, 0xffff0000, v80
    v_fmac_f32 v96, v18, v124
    v_fmac_f32 v97, v19, v124
    v_lshlrev_b32 v18, 16, v81
    v_and_b32 v19, 0xffff0000, v81
    v_fmac_f32 v98, v18, v124
    v_fmac_f32 v99, v19, v124
    v_lshlrev_b32 v18, 16, v82
    v_and_b32 v19, 0xffff0000, v82
    v_fmac_f32 v100, v18, v124
    v_fmac_f32 v101, v19, v124
    v_lshlrev_b32 v18, 16, v83
    v_and_b32 v19, 0xffff0000, v83
    v_fmac_f32 v102, v18, v124
    v_fmac_f32 v103, v19, v124
    s_waitcnt vmcnt(14)
    v_lshlrev_b32 v18, 16, v84
    v_and_b32 v19, 0xffff0000, v84
    v_fmac_f32 v96, v18, v125
    v_fmac_f32 v97, v19, v125
    v_lshlrev_b32 v18, 16, v85
    v_and_b32 v19, 0xffff0000, v85
    v_fmac_f32 v98, v18, v125
    v_fmac_f32 v99, v19, v125
    v_lshlrev_b32 v18, 16, v86
    v_and_b32 v19, 0xffff0000, v86
    v_fmac_f32 v100, v18, v125
    v_fmac_f32 v101, v19, v125
    v_lshlrev_b32 v18, 16, v87
    v_and_b32 v19, 0xffff0000, v87
    v_fmac_f32 v102, v18, v125
    v_fmac_f32 v103, v19, v125
    s_waitcnt vmcnt(13)
    v_lshlrev_b32 v18, 16, v88
    v_and_b32 v19, 0xffff0000, v88
    v_fmac_f32 v96, v18, v126
    v_fmac_f32 v97, v19, v126
    v_lshlrev_b32 v18, 16, v89
    v_and_b32 v19, 0xffff0000, v89
    v_fmac_f32 v98, v18, v126
    v_fmac_f32 v99, v19, v126
    v_lshlrev_b32 v18, 16, v90
    v_and_b32 v19, 0xffff0000, v90
    v_fmac_f32 v100, v18, v126
    v_fmac_f32 v101, v19, v126
    v_lshlrev_b32 v18, 16, v91
    v_and_b32 v19, 0xffff0000, v91
    v_fmac_f32 v102, v18, v126
    v_fmac_f32 v103, v19, v126
    s_waitcnt vmcnt(12)
    v_lshlrev_b32 v18, 16, v92
    v_and_b32 v19, 0xffff0000, v92
    v_fmac_f32 v96, v18, v127
    v_fmac_f32 v97, v19, v127
    v_lshlrev_b32 v18, 16, v93
    v_and_b32 v19, 0xffff0000, v93
    v_fmac_f32 v98, v18, v127
    v_fmac_f32 v99, v19, v127
    v_lshlrev_b32 v18, 16, v94
    v_and_b32 v19, 0xffff0000, v94
    v_fmac_f32 v100, v18, v127
    v_fmac_f32 v101, v19, v127
    v_lshlrev_b32 v18, 16, v95
    v_and_b32 v19, 0xffff0000, v95
    v_fmac_f32 v102, v18, v127
    v_fmac_f32 v103, v19, v127
    v_lshlrev_b32 v16, 5, v0
    ds_write_b128 v16, v[96:99]
    ds_write_b128 v16, v[100:103] offset:16
    s_waitcnt lgkmcnt(0)
    s_barrier
    s_cmp_lg_u32 s44, 0
    s_cbranch_scc1 L_mod_fin_105
    v_mov_b32 v18, 0
    ds_read_b32 v32, v12 offset:0
    ds_read_b32 v33, v12 offset:256
    ds_read_b32 v34, v12 offset:512
    ds_read_b32 v35, v12 offset:768
    ds_read_b32 v36, v12 offset:1024
    ds_read_b32 v37, v12 offset:1280
    ds_read_b32 v38, v12 offset:1536
    ds_read_b32 v39, v12 offset:1792
    ds_read_b32 v40, v12 offset:2048
    ds_read_b32 v41, v12 offset:2304
    ds_read_b32 v42, v12 offset:2560
    ds_read_b32 v43, v12 offset:2816
    ds_read_b32 v44, v12 offset:3072
    ds_read_b32 v45, v12 offset:3328
    ds_read_b32 v46, v12 offset:3584
    ds_read_b32 v47, v12 offset:3840
    s_waitcnt lgkmcnt(0)
    v_add_f32 v18, v18, v32
    v_add_f32 v18, v18, v33
    v_add_f32 v18, v18, v34
    v_add_f32 v18, v18, v35
    v_add_f32 v18, v18, v36
    v_add_f32 v18, v18, v37
    v_add_f32 v18, v18, v38
    v_add_f32 v18, v18, v39
    v_add_f32 v18, v18, v40
    v_add_f32 v18, v18, v41
    v_add_f32 v18, v18, v42
    v_add_f32 v18, v18, v43
    v_add_f32 v18, v18, v44
    v_add_f32 v18, v18, v45
    v_add_f32 v18, v18, v46
    v_add_f32 v18, v18, v47
    ds_read_b32 v32, v12 offset:4096
    ds_read_b32 v33, v12 offset:4352
    ds_read_b32 v34, v12 offset:4608
    ds_read_b32 v35, v12 offset:4864
    ds_read_b32 v36, v12 offset:5120
    ds_read_b32 v37, v12 offset:5376
    ds_read_b32 v38, v12 offset:5632
    ds_read_b32 v39, v12 offset:5888
    ds_read_b32 v40, v12 offset:6144
    ds_read_b32 v41, v12 offset:6400
    ds_read_b32 v42, v12 offset:6656
    ds_read_b32 v43, v12 offset:6912
    ds_read_b32 v44, v12 offset:7168
    ds_read_b32 v45, v12 offset:7424
    ds_read_b32 v46, v12 offset:7680
    ds_read_b32 v47, v12 offset:7936
    s_waitcnt lgkmcnt(0)
    v_add_f32 v18, v18, v32
    v_add_f32 v18, v18, v33
    v_add_f32 v18, v18, v34
    v_add_f32 v18, v18, v35
    v_add_f32 v18, v18, v36
    v_add_f32 v18, v18, v37
    v_add_f32 v18, v18, v38
    v_add_f32 v18, v18, v39
    v_add_f32 v18, v18, v40
    v_add_f32 v18, v18, v41
    v_add_f32 v18, v18, v42
    v_add_f32 v18, v18, v43
    v_add_f32 v18, v18, v44
    v_add_f32 v18, v18, v45
    v_add_f32 v18, v18, v46
    v_add_f32 v18, v18, v47
    s_lshr_b32 s45, s39, 1
    s_lshl_b32 s45, s45, 8
    s_mul_i32 s46, s47, 24576
    s_add_u32 s45, s45, s46
    buffer_store_dword v18, v12, s[12:15], s45 offen sc1
L_mod_fin_105:
    s_waitcnt vmcnt(0)
    s_barrier
    s_cmp_lg_u32 s44, 0
    s_cbranch_scc1 L_cnt_106
    v_mov_b32 v30, 1
    v_mov_b32 v31, 0
    s_mov_b64 exec, 1
    buffer_atomic_add v30, v31, s[16:19], 0 offen offset:128 sc1
    s_mov_b64 exec, -1
L_cnt_106:
    v_lshlrev_b32 v192, 16, v128
    v_and_b32 v193, 0xffff0000, v128
    v_lshlrev_b32 v194, 16, v129
    v_and_b32 v195, 0xffff0000, v129
    v_lshlrev_b32 v196, 16, v130
    v_and_b32 v197, 0xffff0000, v130
    v_lshlrev_b32 v198, 16, v131
    v_and_b32 v199, 0xffff0000, v131
    v_lshlrev_b32 v200, 16, v132
    v_and_b32 v201, 0xffff0000, v132
    v_lshlrev_b32 v202, 16, v133
    v_and_b32 v203, 0xffff0000, v133
    v_lshlrev_b32 v204, 16, v134
    v_and_b32 v205, 0xffff0000, v134
    v_lshlrev_b32 v206, 16, v135
    v_and_b32 v207, 0xffff0000, v135
    v_add_f32 v26, v192, v193
    v_add_f32 v26, v26, v194
    v_add_f32 v26, v26, v195
    v_add_f32 v26, v26, v196
    v_add_f32 v26, v26, v197
    v_add_f32 v26, v26, v198
    v_add_f32 v26, v26, v199
    v_add_f32 v26, v26, v200
    v_add_f32 v26, v26, v201
    v_add_f32 v26, v26, v202
    v_add_f32 v26, v26, v203
    v_add_f32 v26, v26, v204
    v_add_f32 v26, v26, v205
    v_add_f32 v26, v26, v206
    v_add_f32 v26, v26, v207
    s_nop 1
    v_add_f32_dpp v26, v26, v26 row_shr:1 row_mask:0xf bank_mask:0xf bound_ctrl:0
    s_nop 1
    v_add_f32_dpp v26, v26, v26 row_shr:2 row_mask:0xf bank_mask:0xf bound_ctrl:0
    s_nop 1
    v_add_f32_dpp v26, v26, v26 row_shr:4 row_mask:0xf bank_mask:0xf bound_ctrl:0
    s_nop 1
    v_add_f32_dpp v26, v26, v26 row_shr:8 row_mask:0xf bank_mask:0xf bound_ctrl:0
    s_nop 1
    v_add_f32_dpp v26, v26, v26 row_bcast:15 row_mask:0xa bank_mask:0xf
    s_nop 1
    v_add_f32_dpp v26, v26, v26 row_bcast:31 row_mask:0xc bank_mask:0xf
    s_nop 1
    v_readlane_b32 s66, v26, 63
    s_nop 1
    v_mov_b32 v27, s66
    v_mul_f32 v27, 0x3a800000, v27
    v_mov_b32 v26, 0
    v_sub_f32 v28, v192, v27
    v_fmac_f32 v26, v28, v28
    v_sub_f32 v28, v193, v27
    v_fmac_f32 v26, v28, v28
    v_sub_f32 v28, v194, v27
    v_fmac_f32 v26, v28, v28
    v_sub_f32 v28, v195, v27
    v_fmac_f32 v26, v28, v28
    v_sub_f32 v28, v196, v27
    v_fmac_f32 v26, v28, v28
    v_sub_f32 v28, v197, v27
    v_fmac_f32 v26, v28, v28
    v_sub_f32 v28, v198, v27
    v_fmac_f32 v26, v28, v28
    v_sub_f32 v28, v199, v27
    v_fmac_f32 v26, v28, v28
    v_sub_f32 v28, v200, v27
    v_fmac_f32 v26, v28, v28
    v_sub_f32 v28, v201, v27
    v_fmac_f32 v26, v28, v28
    v_sub_f32 v28, v202, v27
    v_fmac_f32 v26, v28, v28
    v_sub_f32 v28, v203, v27
    v_fmac_f32 v26, v28, v28
    v_sub_f32 v28, v204, v27
    v_fmac_f32 v26, v28, v28
    v_sub_f32 v28, v205, v27
    v_fmac_f32 v26, v28, v28
    v_sub_f32 v28, v206, v27
    v_fmac_f32 v26, v28, v28
    v_sub_f32 v28, v207, v27
    v_fmac_f32 v26, v28, v28
    s_nop 1
    v_add_f32_dpp v26, v26, v26 row_shr:1 row_mask:0xf bank_mask:0xf bound_ctrl:0
    s_nop 1
    v_add_f32_dpp v26, v26, v26 row_shr:2 row_mask:0xf bank_mask:0xf bound_ctrl:0
    s_nop 1
    v_add_f32_dpp v26, v26, v26 row_shr:4 row_mask:0xf bank_mask:0xf bound_ctrl:0
    s_nop 1
    v_add_f32_dpp v26, v26, v26 row_shr:8 row_mask:0xf bank_mask:0xf bound_ctrl:0
    s_nop 1
    v_add_f32_dpp v26, v26, v26 row_bcast:15 row_mask:0xa bank_mask:0xf
    s_nop 1
    v_add_f32_dpp v26, v26, v26 row_bcast:31 row_mask:0xc bank_mask:0xf
    s_nop 1
    v_readlane_b32 s66, v26, 63
    s_nop 1
    v_mov_b32 v26, s66
    v_mul_f32 v26, 0x3a800000, v26
    v_cvt_pk_bf16_f32 v26, v26, v26
    v_lshlrev_b32 v26, 16, v26
    v_cvt_pk_bf16_f32 v27, v27, v27
    v_lshlrev_b32 v27, 16, v27
    v_add_f32 v26, 0x3727c5ac, v26
    v_cvt_pk_bf16_f32 v26, v26, v26
    v_lshlrev_b32 v26, 16, v26
    v_sqrt_f32 v26, v26
    s_nop 0
    v_cvt_pk_bf16_f32 v26, v26, v26
    v_lshlrev_b32 v26, 16, v26
    v_rcp_f32 v26, v26
    s_nop 0
    v_sub_f32 v192, v192, v27
    v_cvt_pk_bf16_f32 v192, v192, v192
    v_lshlrev_b32 v192, 16, v192
    v_mul_f32 v192, v192, v26
    v_cvt_pk_bf16_f32 v192, v192, v192
    v_lshlrev_b32 v192, 16, v192
    v_sub_f32 v193, v193, v27
    v_cvt_pk_bf16_f32 v193, v193, v193
    v_lshlrev_b32 v193, 16, v193
    v_mul_f32 v193, v193, v26
    v_cvt_pk_bf16_f32 v193, v193, v193
    v_lshlrev_b32 v193, 16, v193
    v_sub_f32 v194, v194, v27
    v_cvt_pk_bf16_f32 v194, v194, v194
    v_lshlrev_b32 v194, 16, v194
    v_mul_f32 v194, v194, v26
    v_cvt_pk_bf16_f32 v194, v194, v194
    v_lshlrev_b32 v194, 16, v194
    v_sub_f32 v195, v195, v27
    v_cvt_pk_bf16_f32 v195, v195, v195
    v_lshlrev_b32 v195, 16, v195
    v_mul_f32 v195, v195, v26
    v_cvt_pk_bf16_f32 v195, v195, v195
    v_lshlrev_b32 v195, 16, v195
    v_sub_f32 v196, v196, v27
    v_cvt_pk_bf16_f32 v196, v196, v196
    v_lshlrev_b32 v196, 16, v196
    v_mul_f32 v196, v196, v26
    v_cvt_pk_bf16_f32 v196, v196, v196
    v_lshlrev_b32 v196, 16, v196
    v_sub_f32 v197, v197, v27
    v_cvt_pk_bf16_f32 v197, v197, v197
    v_lshlrev_b32 v197, 16, v197
    v_mul_f32 v197, v197, v26
    v_cvt_pk_bf16_f32 v197, v197, v197
    v_lshlrev_b32 v197, 16, v197
    v_sub_f32 v198, v198, v27
    v_cvt_pk_bf16_f32 v198, v198, v198
    v_lshlrev_b32 v198, 16, v198
    v_mul_f32 v198, v198, v26
    v_cvt_pk_bf16_f32 v198, v198, v198
    v_lshlrev_b32 v198, 16, v198
    v_sub_f32 v199, v199, v27
    v_cvt_pk_bf16_f32 v199, v199, v199
    v_lshlrev_b32 v199, 16, v199
    v_mul_f32 v199, v199, v26
    v_cvt_pk_bf16_f32 v199, v199, v199
    v_lshlrev_b32 v199, 16, v199
    v_sub_f32 v200, v200, v27
    v_cvt_pk_bf16_f32 v200, v200, v200
    v_lshlrev_b32 v200, 16, v200
    v_mul_f32 v200, v200, v26
    v_cvt_pk_bf16_f32 v200, v200, v200
    v_lshlrev_b32 v200, 16, v200
    v_sub_f32 v201, v201, v27
    v_cvt_pk_bf16_f32 v201, v201, v201
    v_lshlrev_b32 v201, 16, v201
    v_mul_f32 v201, v201, v26
    v_cvt_pk_bf16_f32 v201, v201, v201
    v_lshlrev_b32 v201, 16, v201
    v_sub_f32 v202, v202, v27
    v_cvt_pk_bf16_f32 v202, v202, v202
    v_lshlrev_b32 v202, 16, v202
    v_mul_f32 v202, v202, v26
    v_cvt_pk_bf16_f32 v202, v202, v202
    v_lshlrev_b32 v202, 16, v202
    v_sub_f32 v203, v203, v27
    v_cvt_pk_bf16_f32 v203, v203, v203
    v_lshlrev_b32 v203, 16, v203
    v_mul_f32 v203, v203, v26
    v_cvt_pk_bf16_f32 v203, v203, v203
    v_lshlrev_b32 v203, 16, v203
    v_sub_f32 v204, v204, v27
    v_cvt_pk_bf16_f32 v204, v204, v204
    v_lshlrev_b32 v204, 16, v204
    v_mul_f32 v204, v204, v26
    v_cvt_pk_bf16_f32 v204, v204, v204
    v_lshlrev_b32 v204, 16, v204
    v_sub_f32 v205, v205, v27
    v_cvt_pk_bf16_f32 v205, v205, v205
    v_lshlrev_b32 v205, 16, v205
    v_mul_f32 v205, v205, v26
    v_cvt_pk_bf16_f32 v205, v205, v205
    v_lshlrev_b32 v205, 16, v205
    v_sub_f32 v206, v206, v27
    v_cvt_pk_bf16_f32 v206, v206, v206
    v_lshlrev_b32 v206, 16, v206
    v_mul_f32 v206, v206, v26
    v_cvt_pk_bf16_f32 v206, v206, v206
    v_lshlrev_b32 v206, 16, v206
    v_sub_f32 v207, v207, v27
    v_cvt_pk_bf16_f32 v207, v207, v207
    v_lshlrev_b32 v207, 16, v207
    v_mul_f32 v207, v207, v26
    v_cvt_pk_bf16_f32 v207, v207, v207
    v_lshlrev_b32 v207, 16, v207
    v_lshlrev_b32 v208, 16, v136
    v_and_b32 v209, 0xffff0000, v136
    v_lshlrev_b32 v210, 16, v137
    v_and_b32 v211, 0xffff0000, v137
    v_lshlrev_b32 v212, 16, v138
    v_and_b32 v213, 0xffff0000, v138
    v_lshlrev_b32 v214, 16, v139
    v_and_b32 v215, 0xffff0000, v139
    v_lshlrev_b32 v216, 16, v140
    v_and_b32 v217, 0xffff0000, v140
    v_lshlrev_b32 v218, 16, v141
    v_and_b32 v219, 0xffff0000, v141
    v_lshlrev_b32 v220, 16, v142
    v_and_b32 v221, 0xffff0000, v142
    v_lshlrev_b32 v222, 16, v143
    v_and_b32 v223, 0xffff0000, v143
    v_add_f32 v26, v208, v209
    v_add_f32 v26, v26, v210
    v_add_f32 v26, v26, v211
    v_add_f32 v26, v26, v212
    v_add_f32 v26, v26, v213
    v_add_f32 v26, v26, v214
    v_add_f32 v26, v26, v215
    v_add_f32 v26, v26, v216
    v_add_f32 v26, v26, v217
    v_add_f32 v26, v26, v218
    v_add_f32 v26, v26, v219
    v_add_f32 v26, v26, v220
    v_add_f32 v26, v26, v221
    v_add_f32 v26, v26, v222
    v_add_f32 v26, v26, v223
    s_nop 1
    v_add_f32_dpp v26, v26, v26 row_shr:1 row_mask:0xf bank_mask:0xf bound_ctrl:0
    s_nop 1
    v_add_f32_dpp v26, v26, v26 row_shr:2 row_mask:0xf bank_mask:0xf bound_ctrl:0
    s_nop 1
    v_add_f32_dpp v26, v26, v26 row_shr:4 row_mask:0xf bank_mask:0xf bound_ctrl:0
    s_nop 1
    v_add_f32_dpp v26, v26, v26 row_shr:8 row_mask:0xf bank_mask:0xf bound_ctrl:0
    s_nop 1
    v_add_f32_dpp v26, v26, v26 row_bcast:15 row_mask:0xa bank_mask:0xf
    s_nop 1
    v_add_f32_dpp v26, v26, v26 row_bcast:31 row_mask:0xc bank_mask:0xf
    s_nop 1
    v_readlane_b32 s66, v26, 63
    s_nop 1
    v_mov_b32 v27, s66
    v_mul_f32 v27, 0x3a800000, v27
    v_mov_b32 v26, 0
    v_sub_f32 v28, v208, v27
    v_fmac_f32 v26, v28, v28
    v_sub_f32 v28, v209, v27
    v_fmac_f32 v26, v28, v28
    v_sub_f32 v28, v210, v27
    v_fmac_f32 v26, v28, v28
    v_sub_f32 v28, v211, v27
    v_fmac_f32 v26, v28, v28
    v_sub_f32 v28, v212, v27
    v_fmac_f32 v26, v28, v28
    v_sub_f32 v28, v213, v27
    v_fmac_f32 v26, v28, v28
    v_sub_f32 v28, v214, v27
    v_fmac_f32 v26, v28, v28
    v_sub_f32 v28, v215, v27
    v_fmac_f32 v26, v28, v28
    v_sub_f32 v28, v216, v27
    v_fmac_f32 v26, v28, v28
    v_sub_f32 v28, v217, v27
    v_fmac_f32 v26, v28, v28
    v_sub_f32 v28, v218, v27
    v_fmac_f32 v26, v28, v28
    v_sub_f32 v28, v219, v27
    v_fmac_f32 v26, v28, v28
    v_sub_f32 v28, v220, v27
    v_fmac_f32 v26, v28, v28
    v_sub_f32 v28, v221, v27
    v_fmac_f32 v26, v28, v28
    v_sub_f32 v28, v222, v27
    v_fmac_f32 v26, v28, v28
    v_sub_f32 v28, v223, v27
    v_fmac_f32 v26, v28, v28
    s_nop 1
    v_add_f32_dpp v26, v26, v26 row_shr:1 row_mask:0xf bank_mask:0xf bound_ctrl:0
    s_nop 1
    v_add_f32_dpp v26, v26, v26 row_shr:2 row_mask:0xf bank_mask:0xf bound_ctrl:0
    s_nop 1
    v_add_f32_dpp v26, v26, v26 row_shr:4 row_mask:0xf bank_mask:0xf bound_ctrl:0
    s_nop 1
    v_add_f32_dpp v26, v26, v26 row_shr:8 row_mask:0xf bank_mask:0xf bound_ctrl:0
    s_nop 1
    v_add_f32_dpp v26, v26, v26 row_bcast:15 row_mask:0xa bank_mask:0xf
    s_nop 1
    v_add_f32_dpp v26, v26, v26 row_bcast:31 row_mask:0xc bank_mask:0xf
    s_nop 1
    v_readlane_b32 s66, v26, 63
    s_nop 1
    v_mov_b32 v26, s66
    v_mul_f32 v26, 0x3a800000, v26
    v_cvt_pk_bf16_f32 v26, v26, v26
    v_lshlrev_b32 v26, 16, v26
    v_cvt_pk_bf16_f32 v27, v27, v27
    v_lshlrev_b32 v27, 16, v27
    v_add_f32 v26, 0x3727c5ac, v26
    v_cvt_pk_bf16_f32 v26, v26, v26
    v_lshlrev_b32 v26, 16, v26
    v_sqrt_f32 v26, v26
    s_nop 0
    v_cvt_pk_bf16_f32 v26, v26, v26
    v_lshlrev_b32 v26, 16, v26
    v_rcp_f32 v26, v26
    s_nop 0
    v_sub_f32 v208, v208, v27
    v_cvt_pk_bf16_f32 v208, v208, v208
    v_lshlrev_b32 v208, 16, v208
    v_mul_f32 v208, v208, v26
    v_cvt_pk_bf16_f32 v208, v208, v208
    v_lshlrev_b32 v208, 16, v208
    v_sub_f32 v209, v209, v27
    v_cvt_pk_bf16_f32 v209, v209, v209
    v_lshlrev_b32 v209, 16, v209
    v_mul_f32 v209, v209, v26
    v_cvt_pk_bf16_f32 v209, v209, v209
    v_lshlrev_b32 v209, 16, v209
    v_sub_f32 v210, v210, v27
    v_cvt_pk_bf16_f32 v210, v210, v210
    v_lshlrev_b32 v210, 16, v210
    v_mul_f32 v210, v210, v26
    v_cvt_pk_bf16_f32 v210, v210, v210
    v_lshlrev_b32 v210, 16, v210
    v_sub_f32 v211, v211, v27
    v_cvt_pk_bf16_f32 v211, v211, v211
    v_lshlrev_b32 v211, 16, v211
    v_mul_f32 v211, v211, v26
    v_cvt_pk_bf16_f32 v211, v211, v211
    v_lshlrev_b32 v211, 16, v211
    v_sub_f32 v212, v212, v27
    v_cvt_pk_bf16_f32 v212, v212, v212
    v_lshlrev_b32 v212, 16, v212
    v_mul_f32 v212, v212, v26
    v_cvt_pk_bf16_f32 v212, v212, v212
    v_lshlrev_b32 v212, 16, v212
    v_sub_f32 v213, v213, v27
    v_cvt_pk_bf16_f32 v213, v213, v213
    v_lshlrev_b32 v213, 16, v213
    v_mul_f32 v213, v213, v26
    v_cvt_pk_bf16_f32 v213, v213, v213
    v_lshlrev_b32 v213, 16, v213
    v_sub_f32 v214, v214, v27
    v_cvt_pk_bf16_f32 v214, v214, v214
    v_lshlrev_b32 v214, 16, v214
    v_mul_f32 v214, v214, v26
    v_cvt_pk_bf16_f32 v214, v214, v214
    v_lshlrev_b32 v214, 16, v214
    v_sub_f32 v215, v215, v27
    v_cvt_pk_bf16_f32 v215, v215, v215
    v_lshlrev_b32 v215, 16, v215
    v_mul_f32 v215, v215, v26
    v_cvt_pk_bf16_f32 v215, v215, v215
    v_lshlrev_b32 v215, 16, v215
    v_sub_f32 v216, v216, v27
    v_cvt_pk_bf16_f32 v216, v216, v216
    v_lshlrev_b32 v216, 16, v216
    v_mul_f32 v216, v216, v26
    v_cvt_pk_bf16_f32 v216, v216, v216
    v_lshlrev_b32 v216, 16, v216
    v_sub_f32 v217, v217, v27
    v_cvt_pk_bf16_f32 v217, v217, v217
    v_lshlrev_b32 v217, 16, v217
    v_mul_f32 v217, v217, v26
    v_cvt_pk_bf16_f32 v217, v217, v217
    v_lshlrev_b32 v217, 16, v217
    v_sub_f32 v218, v218, v27
    v_cvt_pk_bf16_f32 v218, v218, v218
    v_lshlrev_b32 v218, 16, v218
    v_mul_f32 v218, v218, v26
    v_cvt_pk_bf16_f32 v218, v218, v218
    v_lshlrev_b32 v218, 16, v218
    v_sub_f32 v219, v219, v27
    v_cvt_pk_bf16_f32 v219, v219, v219
    v_lshlrev_b32 v219, 16, v219
    v_mul_f32 v219, v219, v26
    v_cvt_pk_bf16_f32 v219, v219, v219
    v_lshlrev_b32 v219, 16, v219
    v_sub_f32 v220, v220, v27
    v_cvt_pk_bf16_f32 v220, v220, v220
    v_lshlrev_b32 v220, 16, v220
    v_mul_f32 v220, v220, v26
    v_cvt_pk_bf16_f32 v220, v220, v220
    v_lshlrev_b32 v220, 16, v220
    v_sub_f32 v221, v221, v27
    v_cvt_pk_bf16_f32 v221, v221, v221
    v_lshlrev_b32 v221, 16, v221
    v_mul_f32 v221, v221, v26
    v_cvt_pk_bf16_f32 v221, v221, v221
    v_lshlrev_b32 v221, 16, v221
    v_sub_f32 v222, v222, v27
    v_cvt_pk_bf16_f32 v222, v222, v222
    v_lshlrev_b32 v222, 16, v222
    v_mul_f32 v222, v222, v26
    v_cvt_pk_bf16_f32 v222, v222, v222
    v_lshlrev_b32 v222, 16, v222
    v_sub_f32 v223, v223, v27
    v_cvt_pk_bf16_f32 v223, v223, v223
    v_lshlrev_b32 v223, 16, v223
    v_mul_f32 v223, v223, v26
    v_cvt_pk_bf16_f32 v223, v223, v223
    v_lshlrev_b32 v223, 16, v223
    s_cmp_lg_u32 s44, 0
    s_cbranch_scc1 L_pd_107
    v_mov_b32 v29, 128
    s_mov_b32 s46, 96
    s_mov_b64 exec, 1
    s_mov_b32 s70, 0
L_wp_108:
    buffer_load_dword v31, v29, s[16:19], 0 offen sc1
    s_add_u32 s70, s70, 1
    s_cmp_ge_u32 s70, 0x200000
    s_cbranch_scc1 L_w_done_102
    s_waitcnt vmcnt(0)
    v_cmp_gt_u32 vcc, s46, v31
    s_nop 1
    s_cbranch_vccz L_wp_108_ok
    s_sleep 1
    s_branch L_wp_108
L_wp_108_ok:
    s_mov_b64 exec, -1
L_pd_107:
    s_barrier
    v_lshlrev_b32 v29, 5, v1
    s_mov_b32 s45, 0
    buffer_load_dwordx4 v[96:99], v29, s[12:15], s45 offen offset:0 sc1
    buffer_load_dwordx4 v[100:103], v29, s[12:15], s45 offen offset:16 sc1
    buffer_load_dwordx4 v[104:107], v29, s[12:15], s45 offen offset:2048 sc1
    buffer_load_dwordx4 v[108:111], v29, s[12:15], s45 offen offset:2064 sc1
    s_mov_b32 s45, 24576
    buffer_load_dwordx4 v[32:35], v29, s[12:15], s45 offen offset:0 sc1
    buffer_load_dwordx4 v[36:39], v29, s[12:15], s45 offen offset:16 sc1
    buffer_load_dwordx4 v[40:43], v29, s[12:15], s45 offen offset:2048 sc1
    buffer_load_dwordx4 v[44:47], v29, s[12:15], s45 offen offset:2064 sc1
    s_mov_b32 s45, 4096
    buffer_load_dwordx4 v[112:115], v29, s[12:15], s45 offen offset:0 sc1
    buffer_load_dwordx4 v[116:119], v29, s[12:15], s45 offen offset:16 sc1
    buffer_load_dwordx4 v[120:123], v29, s[12:15], s45 offen offset:2048 sc1
    buffer_load_dwordx4 v[124:127], v29, s[12:15], s45 offen offset:2064 sc1
    s_mov_b32 s45, 28672
    buffer_load_dwordx4 v[48:51], v29, s[12:15], s45 offen offset:0 sc1
    buffer_load_dwordx4 v[52:55], v29, s[12:15], s45 offen offset:16 sc1
    buffer_load_dwordx4 v[56:59], v29, s[12:15], s45 offen offset:2048 sc1
    buffer_load_dwordx4 v[60:63], v29, s[12:15], s45 offen offset:2064 sc1
    s_waitcnt vmcnt(0)
    v_add_f32 v96, v96, v32
    v_cvt_pk_bf16_f32 v96, v96, v96
    v_lshlrev_b32 v96, 16, v96
    v_add_f32 v97, v97, v33
    v_cvt_pk_bf16_f32 v97, v97, v97
    v_lshlrev_b32 v97, 16, v97
    v_add_f32 v98, v98, v34
    v_cvt_pk_bf16_f32 v98, v98, v98
    v_lshlrev_b32 v98, 16, v98
    v_add_f32 v99, v99, v35
    v_cvt_pk_bf16_f32 v99, v99, v99
    v_lshlrev_b32 v99, 16, v99
    v_add_f32 v100, v100, v36
    v_cvt_pk_bf16_f32 v100, v100, v100
    v_lshlrev_b32 v100, 16, v100
    v_add_f32 v101, v101, v37
    v_cvt_pk_bf16_f32 v101, v101, v101
    v_lshlrev_b32 v101, 16, v101
    v_add_f32 v102, v102, v38
    v_cvt_pk_bf16_f32 v102, v102, v102
    v_lshlrev_b32 v102, 16, v102
    v_add_f32 v103, v103, v39
    v_cvt_pk_bf16_f32 v103, v103, v103
    v_lshlrev_b32 v103, 16, v103
    v_add_f32 v104, v104, v40
    v_cvt_pk_bf16_f32 v104, v104, v104
    v_lshlrev_b32 v104, 16, v104
    v_add_f32 v105, v105, v41
    v_cvt_pk_bf16_f32 v105, v105, v105
    v_lshlrev_b32 v105, 16, v105
    v_add_f32 v106, v106, v42
    v_cvt_pk_bf16_f32 v106, v106, v106
    v_lshlrev_b32 v106, 16, v106
    v_add_f32 v107, v107, v43
    v_cvt_pk_bf16_f32 v107, v107, v107
    v_lshlrev_b32 v107, 16, v107
    v_add_f32 v108, v108, v44
    v_cvt_pk_bf16_f32 v108, v108, v108
    v_lshlrev_b32 v108, 16, v108
    v_add_f32 v109, v109, v45
    v_cvt_pk_bf16_f32 v109, v109, v109
    v_lshlrev_b32 v109, 16, v109
    v_add_f32 v110, v110, v46
    v_cvt_pk_bf16_f32 v110, v110, v110
    v_lshlrev_b32 v110, 16, v110
    v_add_f32 v111, v111, v47
    v_cvt_pk_bf16_f32 v111, v111, v111
    v_lshlrev_b32 v111, 16, v111
    v_add_f32 v112, v112, v48
    v_cvt_pk_bf16_f32 v112, v112, v112
    v_lshlrev_b32 v112, 16, v112
    v_add_f32 v112, 1.0, v112
    v_cvt_pk_bf16_f32 v112, v112, v112
    v_lshlrev_b32 v112, 16, v112
    v_add_f32 v113, v113, v49
    v_cvt_pk_bf16_f32 v113, v113, v113
    v_lshlrev_b32 v113, 16, v113
    v_add_f32 v113, 1.0, v113
    v_cvt_pk_bf16_f32 v113, v113, v113
    v_lshlrev_b32 v113, 16, v113
    v_add_f32 v114, v114, v50
    v_cvt_pk_bf16_f32 v114, v114, v114
    v_lshlrev_b32 v114, 16, v114
    v_add_f32 v114, 1.0, v114
    v_cvt_pk_bf16_f32 v114, v114, v114
    v_lshlrev_b32 v114, 16, v114
    v_add_f32 v115, v115, v51
    v_cvt_pk_bf16_f32 v115, v115, v115
    v_lshlrev_b32 v115, 16, v115
    v_add_f32 v115, 1.0, v115
    v_cvt_pk_bf16_f32 v115, v115, v115
    v_lshlrev_b32 v115, 16, v115
    v_add_f32 v116, v116, v52
    v_cvt_pk_bf16_f32 v116, v116, v116
    v_lshlrev_b32 v116, 16, v116
    v_add_f32 v116, 1.0, v116
    v_cvt_pk_bf16_f32 v116, v116, v116
    v_lshlrev_b32 v116, 16, v116
    v_add_f32 v117, v117, v53
    v_cvt_pk_bf16_f32 v117, v117, v117
    v_lshlrev_b32 v117, 16, v117
    v_add_f32 v117, 1.0, v117
    v_cvt_pk_bf16_f32 v117, v117, v117
    v_lshlrev_b32 v117, 16, v117
    v_add_f32 v118, v118, v54
    v_cvt_pk_bf16_f32 v118, v118, v118
    v_lshlrev_b32 v118, 16, v118
    v_add_f32 v118, 1.0, v118
    v_cvt_pk_bf16_f32 v118, v118, v118
    v_lshlrev_b32 v118, 16, v118
    v_add_f32 v119, v119, v55
    v_cvt_pk_bf16_f32 v119, v119, v119
    v_lshlrev_b32 v119, 16, v119
    v_add_f32 v119, 1.0, v119
    v_cvt_pk_bf16_f32 v119, v119, v119
    v_lshlrev_b32 v119, 16, v119
    v_add_f32 v120, v120, v56
    v_cvt_pk_bf16_f32 v120, v120, v120
    v_lshlrev_b32 v120, 16, v120
    v_add_f32 v120, 1.0, v120
    v_cvt_pk_bf16_f32 v120, v120, v120
    v_lshlrev_b32 v120, 16, v120
    v_add_f32 v121, v121, v57
    v_cvt_pk_bf16_f32 v121, v121, v121
    v_lshlrev_b32 v121, 16, v121
    v_add_f32 v121, 1.0, v121
    v_cvt_pk_bf16_f32 v121, v121, v121
    v_lshlrev_b32 v121, 16, v121
    v_add_f32 v122, v122, v58
    v_cvt_pk_bf16_f32 v122, v122, v122
    v_lshlrev_b32 v122, 16, v122
    v_add_f32 v122, 1.0, v122
    v_cvt_pk_bf16_f32 v122, v122, v122
    v_lshlrev_b32 v122, 16, v122
    v_add_f32 v123, v123, v59
    v_cvt_pk_bf16_f32 v123, v123, v123
    v_lshlrev_b32 v123, 16, v123
    v_add_f32 v123, 1.0, v123
    v_cvt_pk_bf16_f32 v123, v123, v123
    v_lshlrev_b32 v123, 16, v123
    v_add_f32 v124, v124, v60
    v_cvt_pk_bf16_f32 v124, v124, v124
    v_lshlrev_b32 v124, 16, v124
    v_add_f32 v124, 1.0, v124
    v_cvt_pk_bf16_f32 v124, v124, v124
    v_lshlrev_b32 v124, 16, v124
    v_add_f32 v125, v125, v61
    v_cvt_pk_bf16_f32 v125, v125, v125
    v_lshlrev_b32 v125, 16, v125
    v_add_f32 v125, 1.0, v125
    v_cvt_pk_bf16_f32 v125, v125, v125
    v_lshlrev_b32 v125, 16, v125
    v_add_f32 v126, v126, v62
    v_cvt_pk_bf16_f32 v126, v126, v126
    v_lshlrev_b32 v126, 16, v126
    v_add_f32 v126, 1.0, v126
    v_cvt_pk_bf16_f32 v126, v126, v126
    v_lshlrev_b32 v126, 16, v126
    v_add_f32 v127, v127, v63
    v_cvt_pk_bf16_f32 v127, v127, v127
    v_lshlrev_b32 v127, 16, v127
    v_add_f32 v127, 1.0, v127
    v_cvt_pk_bf16_f32 v127, v127, v127
    v_lshlrev_b32 v127, 16, v127
    v_mul_f32 v192, v192, v112
    v_cvt_pk_bf16_f32 v192, v192, v192
    v_lshlrev_b32 v192, 16, v192
    v_add_f32 v192, v192, v96
    v_mul_f32 v193, v193, v113
    v_cvt_pk_bf16_f32 v193, v193, v193
    v_lshlrev_b32 v193, 16, v193
    v_add_f32 v193, v193, v97
    v_mul_f32 v194, v194, v114
    v_cvt_pk_bf16_f32 v194, v194, v194
    v_lshlrev_b32 v194, 16, v194
    v_add_f32 v194, v194, v98
    v_mul_f32 v195, v195, v115
    v_cvt_pk_bf16_f32 v195, v195, v195
    v_lshlrev_b32 v195, 16, v195
    v_add_f32 v195, v195, v99
    v_mul_f32 v196, v196, v116
    v_cvt_pk_bf16_f32 v196, v196, v196
    v_lshlrev_b32 v196, 16, v196
    v_add_f32 v196, v196, v100
    v_mul_f32 v197, v197, v117
    v_cvt_pk_bf16_f32 v197, v197, v197
    v_lshlrev_b32 v197, 16, v197
    v_add_f32 v197, v197, v101
    v_mul_f32 v198, v198, v118
    v_cvt_pk_bf16_f32 v198, v198, v198
    v_lshlrev_b32 v198, 16, v198
    v_add_f32 v198, v198, v102
    v_mul_f32 v199, v199, v119
    v_cvt_pk_bf16_f32 v199, v199, v199
    v_lshlrev_b32 v199, 16, v199
    v_add_f32 v199, v199, v103
    v_mul_f32 v200, v200, v120
    v_cvt_pk_bf16_f32 v200, v200, v200
    v_lshlrev_b32 v200, 16, v200
    v_add_f32 v200, v200, v104
    v_mul_f32 v201, v201, v121
    v_cvt_pk_bf16_f32 v201, v201, v201
    v_lshlrev_b32 v201, 16, v201
    v_add_f32 v201, v201, v105
    v_mul_f32 v202, v202, v122
    v_cvt_pk_bf16_f32 v202, v202, v202
    v_lshlrev_b32 v202, 16, v202
    v_add_f32 v202, v202, v106
    v_mul_f32 v203, v203, v123
    v_cvt_pk_bf16_f32 v203, v203, v203
    v_lshlrev_b32 v203, 16, v203
    v_add_f32 v203, v203, v107
    v_mul_f32 v204, v204, v124
    v_cvt_pk_bf16_f32 v204, v204, v204
    v_lshlrev_b32 v204, 16, v204
    v_add_f32 v204, v204, v108
    v_mul_f32 v205, v205, v125
    v_cvt_pk_bf16_f32 v205, v205, v205
    v_lshlrev_b32 v205, 16, v205
    v_add_f32 v205, v205, v109
    v_mul_f32 v206, v206, v126
    v_cvt_pk_bf16_f32 v206, v206, v206
    v_lshlrev_b32 v206, 16, v206
    v_add_f32 v206, v206, v110
    v_mul_f32 v207, v207, v127
    v_cvt_pk_bf16_f32 v207, v207, v207
    v_lshlrev_b32 v207, 16, v207
    v_add_f32 v207, v207, v111
    v_cvt_pk_bf16_f32 v80, v192, v193
    v_cvt_pk_bf16_f32 v81, v194, v195
    v_cvt_pk_bf16_f32 v82, v196, v197
    v_cvt_pk_bf16_f32 v83, v198, v199
    v_cvt_pk_bf16_f32 v84, v200, v201
    v_cvt_pk_bf16_f32 v85, v202, v203
    v_cvt_pk_bf16_f32 v86, v204, v205
    v_cvt_pk_bf16_f32 v87, v206, v207
    s_lshr_b32 s45, s63, 5
    s_lshl_b32 s45, s45, 16
    s_and_b32 s46, s63, 31
    s_lshl_b32 s46, s46, 8
    s_add_u32 s45, s45, s46
    s_add_u32 s45, s45, 0x400000
    s_add_u32 s46, s45, 32768
    buffer_store_dwordx4 v[80:83], v2, s[12:15], s45 offen sc1
    buffer_store_dwordx4 v[84:87], v2, s[12:15], s46 offen sc1
    s_add_u32 s63, s63, 384
    v_mul_f32 v208, v208, v112
    v_cvt_pk_bf16_f32 v208, v208, v208
    v_lshlrev_b32 v208, 16, v208
    v_add_f32 v208, v208, v96
    v_mul_f32 v209, v209, v113
    v_cvt_pk_bf16_f32 v209, v209, v209
    v_lshlrev_b32 v209, 16, v209
    v_add_f32 v209, v209, v97
    v_mul_f32 v210, v210, v114
    v_cvt_pk_bf16_f32 v210, v210, v210
    v_lshlrev_b32 v210, 16, v210
    v_add_f32 v210, v210, v98
    v_mul_f32 v211, v211, v115
    v_cvt_pk_bf16_f32 v211, v211, v211
    v_lshlrev_b32 v211, 16, v211
    v_add_f32 v211, v211, v99
    v_mul_f32 v212, v212, v116
    v_cvt_pk_bf16_f32 v212, v212, v212
    v_lshlrev_b32 v212, 16, v212
    v_add_f32 v212, v212, v100
    v_mul_f32 v213, v213, v117
    v_cvt_pk_bf16_f32 v213, v213, v213
    v_lshlrev_b32 v213, 16, v213
    v_add_f32 v213, v213, v101
    v_mul_f32 v214, v214, v118
    v_cvt_pk_bf16_f32 v214, v214, v214
    v_lshlrev_b32 v214, 16, v214
    v_add_f32 v214, v214, v102
    v_mul_f32 v215, v215, v119
    v_cvt_pk_bf16_f32 v215, v215, v215
    v_lshlrev_b32 v215, 16, v215
    v_add_f32 v215, v215, v103
    v_mul_f32 v216, v216, v120
    v_cvt_pk_bf16_f32 v216, v216, v216
    v_lshlrev_b32 v216, 16, v216
    v_add_f32 v216, v216, v104
    v_mul_f32 v217, v217, v121
    v_cvt_pk_bf16_f32 v217, v217, v217
    v_lshlrev_b32 v217, 16, v217
    v_add_f32 v217, v217, v105
    v_mul_f32 v218, v218, v122
    v_cvt_pk_bf16_f32 v218, v218, v218
    v_lshlrev_b32 v218, 16, v218
    v_add_f32 v218, v218, v106
    v_mul_f32 v219, v219, v123
    v_cvt_pk_bf16_f32 v219, v219, v219
    v_lshlrev_b32 v219, 16, v219
    v_add_f32 v219, v219, v107
    v_mul_f32 v220, v220, v124
    v_cvt_pk_bf16_f32 v220, v220, v220
    v_lshlrev_b32 v220, 16, v220
    v_add_f32 v220, v220, v108
    v_mul_f32 v221, v221, v125
    v_cvt_pk_bf16_f32 v221, v221, v221
    v_lshlrev_b32 v221, 16, v221
    v_add_f32 v221, v221, v109
    v_mul_f32 v222, v222, v126
    v_cvt_pk_bf16_f32 v222, v222, v222
    v_lshlrev_b32 v222, 16, v222
    v_add_f32 v222, v222, v110
    v_mul_f32 v223, v223, v127
    v_cvt_pk_bf16_f32 v223, v223, v223
    v_lshlrev_b32 v223, 16, v223
    v_add_f32 v223, v223, v111
    v_cvt_pk_bf16_f32 v88, v208, v209
    v_cvt_pk_bf16_f32 v89, v210, v211
    v_cvt_pk_bf16_f32 v90, v212, v213
    v_cvt_pk_bf16_f32 v91, v214, v215
    v_cvt_pk_bf16_f32 v92, v216, v217
    v_cvt_pk_bf16_f32 v93, v218, v219
    v_cvt_pk_bf16_f32 v94, v220, v221
    v_cvt_pk_bf16_f32 v95, v222, v223
    s_lshr_b32 s45, s63, 5
    s_lshl_b32 s45, s45, 16
    s_and_b32 s46, s63, 31
    s_lshl_b32 s46, s46, 8
    s_add_u32 s45, s45, s46
    s_add_u32 s45, s45, 0x400000
    s_add_u32 s46, s45, 32768
    buffer_store_dwordx4 v[88:91], v2, s[12:15], s45 offen sc1
    buffer_store_dwordx4 v[92:95], v2, s[12:15], s46 offen sc1
    s_waitcnt vmcnt(2)
    s_barrier
    s_cmp_lg_u32 s44, 0
    s_cbranch_scc1 L_cnt_110
    v_mov_b32 v30, 1
    v_mov_b32 v31, 0
    s_mov_b64 exec, 1
    buffer_atomic_add v30, v31, s[16:19], 0 offen offset:64 sc1
    s_mov_b64 exec, -1
L_cnt_110:
    s_add_u32 s63, s63, 384
    v_lshlrev_b32 v64, 16, v144
    v_and_b32 v65, 0xffff0000, v144
    v_lshlrev_b32 v66, 16, v145
    v_and_b32 v67, 0xffff0000, v145
    v_lshlrev_b32 v68, 16, v146
    v_and_b32 v69, 0xffff0000, v146
    v_lshlrev_b32 v70, 16, v147
    v_and_b32 v71, 0xffff0000, v147
    v_lshlrev_b32 v72, 16, v148
    v_and_b32 v73, 0xffff0000, v148
    v_lshlrev_b32 v74, 16, v149
    v_and_b32 v75, 0xffff0000, v149
    v_lshlrev_b32 v76, 16, v150
    v_and_b32 v77, 0xffff0000, v150
    v_lshlrev_b32 v78, 16, v151
    v_and_b32 v79, 0xffff0000, v151
    v_add_f32 v26, v64, v65
    v_add_f32 v26, v26, v66
    v_add_f32 v26, v26, v67
    v_add_f32 v26, v26, v68
    v_add_f32 v26, v26, v69
    v_add_f32 v26, v26, v70
    v_add_f32 v26, v26, v71
    v_add_f32 v26, v26, v72
    v_add_f32 v26, v26, v73
    v_add_f32 v26, v26, v74
    v_add_f32 v26, v26, v75
    v_add_f32 v26, v26, v76
    v_add_f32 v26, v26, v77
    v_add_f32 v26, v26, v78
    v_add_f32 v26, v26, v79
    s_nop 1
    v_add_f32_dpp v26, v26, v26 row_shr:1 row_mask:0xf bank_mask:0xf bound_ctrl:0
    s_nop 1
    v_add_f32_dpp v26, v26, v26 row_shr:2 row_mask:0xf bank_mask:0xf bound_ctrl:0
    s_nop 1
    v_add_f32_dpp v26, v26, v26 row_shr:4 row_mask:0xf bank_mask:0xf bound_ctrl:0
    s_nop 1
    v_add_f32_dpp v26, v26, v26 row_shr:8 row_mask:0xf bank_mask:0xf bound_ctrl:0
    s_nop 1
    v_add_f32_dpp v26, v26, v26 row_bcast:15 row_mask:0xa bank_mask:0xf
    s_nop 1
    v_add_f32_dpp v26, v26, v26 row_bcast:31 row_mask:0xc bank_mask:0xf
    s_nop 1
    v_readlane_b32 s66, v26, 63
    s_nop 1
    v_mov_b32 v27, s66
    v_mul_f32 v27, 0x3a800000, v27
    v_mov_b32 v26, 0
    v_sub_f32 v28, v64, v27
    v_fmac_f32 v26, v28, v28
    v_sub_f32 v28, v65, v27
    v_fmac_f32 v26, v28, v28
    v_sub_f32 v28, v66, v27
    v_fmac_f32 v26, v28, v28
    v_sub_f32 v28, v67, v27
    v_fmac_f32 v26, v28, v28
    v_sub_f32 v28, v68, v27
    v_fmac_f32 v26, v28, v28
    v_sub_f32 v28, v69, v27
    v_fmac_f32 v26, v28, v28
    v_sub_f32 v28, v70, v27
    v_fmac_f32 v26, v28, v28
    v_sub_f32 v28, v71, v27
    v_fmac_f32 v26, v28, v28
    v_sub_f32 v28, v72, v27
    v_fmac_f32 v26, v28, v28
    v_sub_f32 v28, v73, v27
    v_fmac_f32 v26, v28, v28
    v_sub_f32 v28, v74, v27
    v_fmac_f32 v26, v28, v28
    v_sub_f32 v28, v75, v27
    v_fmac_f32 v26, v28, v28
    v_sub_f32 v28, v76, v27
    v_fmac_f32 v26, v28, v28
    v_sub_f32 v28, v77, v27
    v_fmac_f32 v26, v28, v28
    v_sub_f32 v28, v78, v27
    v_fmac_f32 v26, v28, v28
    v_sub_f32 v28, v79, v27
    v_fmac_f32 v26, v28, v28
    s_nop 1
    v_add_f32_dpp v26, v26, v26 row_shr:1 row_mask:0xf bank_mask:0xf bound_ctrl:0
    s_nop 1
    v_add_f32_dpp v26, v26, v26 row_shr:2 row_mask:0xf bank_mask:0xf bound_ctrl:0
    s_nop 1
    v_add_f32_dpp v26, v26, v26 row_shr:4 row_mask:0xf bank_mask:0xf bound_ctrl:0
    s_nop 1
    v_add_f32_dpp v26, v26, v26 row_shr:8 row_mask:0xf bank_mask:0xf bound_ctrl:0
    s_nop 1
    v_add_f32_dpp v26, v26, v26 row_bcast:15 row_mask:0xa bank_mask:0xf
    s_nop 1
    v_add_f32_dpp v26, v26, v26 row_bcast:31 row_mask:0xc bank_mask:0xf
    s_nop 1
    v_readlane_b32 s66, v26, 63
    s_nop 1
    v_mov_b32 v26, s66
    v_mul_f32 v26, 0x3a800000, v26
    v_cvt_pk_bf16_f32 v26, v26, v26
    v_lshlrev_b32 v26, 16, v26
    v_cvt_pk_bf16_f32 v27, v27, v27
    v_lshlrev_b32 v27, 16, v27
    v_add_f32 v26, 0x3727c5ac, v26
    v_cvt_pk_bf16_f32 v26, v26, v26
    v_lshlrev_b32 v26, 16, v26
    v_sqrt_f32 v26, v26
    s_nop 0
    v_cvt_pk_bf16_f32 v26, v26, v26
    v_lshlrev_b32 v26, 16, v26
    v_rcp_f32 v26, v26
    s_nop 0
    v_sub_f32 v64, v64, v27
    v_cvt_pk_bf16_f32 v64, v64, v64
    v_lshlrev_b32 v64, 16, v64
    v_mul_f32 v64, v64, v26
    v_cvt_pk_bf16_f32 v64, v64, v64
    v_lshlrev_b32 v64, 16, v64
    v_sub_f32 v65, v65, v27
    v_cvt_pk_bf16_f32 v65, v65, v65
    v_lshlrev_b32 v65, 16, v65
    v_mul_f32 v65, v65, v26
    v_cvt_pk_bf16_f32 v65, v65, v65
    v_lshlrev_b32 v65, 16, v65
    v_sub_f32 v66, v66, v27
    v_cvt_pk_bf16_f32 v66, v66, v66
    v_lshlrev_b32 v66, 16, v66
    v_mul_f32 v66, v66, v26
    v_cvt_pk_bf16_f32 v66, v66, v66
    v_lshlrev_b32 v66, 16, v66
    v_sub_f32 v67, v67, v27
    v_cvt_pk_bf16_f32 v67, v67, v67
    v_lshlrev_b32 v67, 16, v67
    v_mul_f32 v67, v67, v26
    v_cvt_pk_bf16_f32 v67, v67, v67
    v_lshlrev_b32 v67, 16, v67
    v_sub_f32 v68, v68, v27
    v_cvt_pk_bf16_f32 v68, v68, v68
    v_lshlrev_b32 v68, 16, v68
    v_mul_f32 v68, v68, v26
    v_cvt_pk_bf16_f32 v68, v68, v68
    v_lshlrev_b32 v68, 16, v68
    v_sub_f32 v69, v69, v27
    v_cvt_pk_bf16_f32 v69, v69, v69
    v_lshlrev_b32 v69, 16, v69
    v_mul_f32 v69, v69, v26
    v_cvt_pk_bf16_f32 v69, v69, v69
    v_lshlrev_b32 v69, 16, v69
    v_sub_f32 v70, v70, v27
    v_cvt_pk_bf16_f32 v70, v70, v70
    v_lshlrev_b32 v70, 16, v70
    v_mul_f32 v70, v70, v26
    v_cvt_pk_bf16_f32 v70, v70, v70
    v_lshlrev_b32 v70, 16, v70
    v_sub_f32 v71, v71, v27
    v_cvt_pk_bf16_f32 v71, v71, v71
    v_lshlrev_b32 v71, 16, v71
    v_mul_f32 v71, v71, v26
    v_cvt_pk_bf16_f32 v71, v71, v71
    v_lshlrev_b32 v71, 16, v71
    v_sub_f32 v72, v72, v27
    v_cvt_pk_bf16_f32 v72, v72, v72
    v_lshlrev_b32 v72, 16, v72
    v_mul_f32 v72, v72, v26
    v_cvt_pk_bf16_f32 v72, v72, v72
    v_lshlrev_b32 v72, 16, v72
    v_sub_f32 v73, v73, v27
    v_cvt_pk_bf16_f32 v73, v73, v73
    v_lshlrev_b32 v73, 16, v73
    v_mul_f32 v73, v73, v26
    v_cvt_pk_bf16_f32 v73, v73, v73
    v_lshlrev_b32 v73, 16, v73
    v_sub_f32 v74, v74, v27
    v_cvt_pk_bf16_f32 v74, v74, v74
    v_lshlrev_b32 v74, 16, v74
    v_mul_f32 v74, v74, v26
    v_cvt_pk_bf16_f32 v74, v74, v74
    v_lshlrev_b32 v74, 16, v74
    v_sub_f32 v75, v75, v27
    v_cvt_pk_bf16_f32 v75, v75, v75
    v_lshlrev_b32 v75, 16, v75
    v_mul_f32 v75, v75, v26
    v_cvt_pk_bf16_f32 v75, v75, v75
    v_lshlrev_b32 v75, 16, v75
    v_sub_f32 v76, v76, v27
    v_cvt_pk_bf16_f32 v76, v76, v76
    v_lshlrev_b32 v76, 16, v76
    v_mul_f32 v76, v76, v26
    v_cvt_pk_bf16_f32 v76, v76, v76
    v_lshlrev_b32 v76, 16, v76
    v_sub_f32 v77, v77, v27
    v_cvt_pk_bf16_f32 v77, v77, v77
    v_lshlrev_b32 v77, 16, v77
    v_mul_f32 v77, v77, v26
    v_cvt_pk_bf16_f32 v77, v77, v77
    v_lshlrev_b32 v77, 16, v77
    v_sub_f32 v78, v78, v27
    v_cvt_pk_bf16_f32 v78, v78, v78
    v_lshlrev_b32 v78, 16, v78
    v_mul_f32 v78, v78, v26
    v_cvt_pk_bf16_f32 v78, v78, v78
    v_lshlrev_b32 v78, 16, v78
    v_sub_f32 v79, v79, v27
    v_cvt_pk_bf16_f32 v79, v79, v79
    v_lshlrev_b32 v79, 16, v79
    v_mul_f32 v79, v79, v26
    v_cvt_pk_bf16_f32 v79, v79, v79
    v_lshlrev_b32 v79, 16, v79
    v_mul_f32 v64, v64, v112
    v_cvt_pk_bf16_f32 v64, v64, v64
    v_lshlrev_b32 v64, 16, v64
    v_add_f32 v64, v64, v96
    v_mul_f32 v65, v65, v113
    v_cvt_pk_bf16_f32 v65, v65, v65
    v_lshlrev_b32 v65, 16, v65
    v_add_f32 v65, v65, v97
    v_mul_f32 v66, v66, v114
    v_cvt_pk_bf16_f32 v66, v66, v66
    v_lshlrev_b32 v66, 16, v66
    v_add_f32 v66, v66, v98
    v_mul_f32 v67, v67, v115
    v_cvt_pk_bf16_f32 v67, v67, v67
    v_lshlrev_b32 v67, 16, v67
    v_add_f32 v67, v67, v99
    v_mul_f32 v68, v68, v116
    v_cvt_pk_bf16_f32 v68, v68, v68
    v_lshlrev_b32 v68, 16, v68
    v_add_f32 v68, v68, v100
    v_mul_f32 v69, v69, v117
    v_cvt_pk_bf16_f32 v69, v69, v69
    v_lshlrev_b32 v69, 16, v69
    v_add_f32 v69, v69, v101
    v_mul_f32 v70, v70, v118
    v_cvt_pk_bf16_f32 v70, v70, v70
    v_lshlrev_b32 v70, 16, v70
    v_add_f32 v70, v70, v102
    v_mul_f32 v71, v71, v119
    v_cvt_pk_bf16_f32 v71, v71, v71
    v_lshlrev_b32 v71, 16, v71
    v_add_f32 v71, v71, v103
    v_mul_f32 v72, v72, v120
    v_cvt_pk_bf16_f32 v72, v72, v72
    v_lshlrev_b32 v72, 16, v72
    v_add_f32 v72, v72, v104
    v_mul_f32 v73, v73, v121
    v_cvt_pk_bf16_f32 v73, v73, v73
    v_lshlrev_b32 v73, 16, v73
    v_add_f32 v73, v73, v105
    v_mul_f32 v74, v74, v122
    v_cvt_pk_bf16_f32 v74, v74, v74
    v_lshlrev_b32 v74, 16, v74
    v_add_f32 v74, v74, v106
    v_mul_f32 v75, v75, v123
    v_cvt_pk_bf16_f32 v75, v75, v75
    v_lshlrev_b32 v75, 16, v75
    v_add_f32 v75, v75, v107
    v_mul_f32 v76, v76, v124
    v_cvt_pk_bf16_f32 v76, v76, v76
    v_lshlrev_b32 v76, 16, v76
    v_add_f32 v76, v76, v108
    v_mul_f32 v77, v77, v125
    v_cvt_pk_bf16_f32 v77, v77, v77
    v_lshlrev_b32 v77, 16, v77
    v_add_f32 v77, v77, v109
    v_mul_f32 v78, v78, v126
    v_cvt_pk_bf16_f32 v78, v78, v78
    v_lshlrev_b32 v78, 16, v78
    v_add_f32 v78, v78, v110
    v_mul_f32 v79, v79, v127
    v_cvt_pk_bf16_f32 v79, v79, v79
    v_lshlrev_b32 v79, 16, v79
    v_add_f32 v79, v79, v111
    v_cvt_pk_bf16_f32 v80, v64, v65
    v_cvt_pk_bf16_f32 v81, v66, v67
    v_cvt_pk_bf16_f32 v82, v68, v69
    v_cvt_pk_bf16_f32 v83, v70, v71
    v_cvt_pk_bf16_f32 v84, v72, v73
    v_cvt_pk_bf16_f32 v85, v74, v75
    v_cvt_pk_bf16_f32 v86, v76, v77
    v_cvt_pk_bf16_f32 v87, v78, v79
    s_lshr_b32 s45, s63, 5
    s_lshl_b32 s45, s45, 16
    s_and_b32 s46, s63, 31
    s_lshl_b32 s46, s46, 8
    s_add_u32 s45, s45, s46
    s_add_u32 s45, s45, 0x400000
    s_add_u32 s46, s45, 32768
    buffer_store_dwordx4 v[80:83], v2, s[12:15], s45 offen sc1
    buffer_store_dwordx4 v[84:87], v2, s[12:15], s46 offen sc1
    s_add_u32 s63, s63, 384
    v_lshlrev_b32 v64, 16, v152
    v_and_b32 v65, 0xffff0000, v152
    v_lshlrev_b32 v66, 16, v153
    v_and_b32 v67, 0xffff0000, v153
    v_lshlrev_b32 v68, 16, v154
    v_and_b32 v69, 0xffff0000, v154
    v_lshlrev_b32 v70, 16, v155
    v_and_b32 v71, 0xffff0000, v155
    v_lshlrev_b32 v72, 16, v156
    v_and_b32 v73, 0xffff0000, v156
    v_lshlrev_b32 v74, 16, v157
    v_and_b32 v75, 0xffff0000, v157
    v_lshlrev_b32 v76, 16, v158
    v_and_b32 v77, 0xffff0000, v158
    v_lshlrev_b32 v78, 16, v159
    v_and_b32 v79, 0xffff0000, v159
    v_add_f32 v26, v64, v65
    v_add_f32 v26, v26, v66
    v_add_f32 v26, v26, v67
    v_add_f32 v26, v26, v68
    v_add_f32 v26, v26, v69
    v_add_f32 v26, v26, v70
    v_add_f32 v26, v26, v71
    v_add_f32 v26, v26, v72
    v_add_f32 v26, v26, v73
    v_add_f32 v26, v26, v74
    v_add_f32 v26, v26, v75
    v_add_f32 v26, v26, v76
    v_add_f32 v26, v26, v77
    v_add_f32 v26, v26, v78
    v_add_f32 v26, v26, v79
    s_nop 1
    v_add_f32_dpp v26, v26, v26 row_shr:1 row_mask:0xf bank_mask:0xf bound_ctrl:0
    s_nop 1
    v_add_f32_dpp v26, v26, v26 row_shr:2 row_mask:0xf bank_mask:0xf bound_ctrl:0
    s_nop 1
    v_add_f32_dpp v26, v26, v26 row_shr:4 row_mask:0xf bank_mask:0xf bound_ctrl:0
    s_nop 1
    v_add_f32_dpp v26, v26, v26 row_shr:8 row_mask:0xf bank_mask:0xf bound_ctrl:0
    s_nop 1
    v_add_f32_dpp v26, v26, v26 row_bcast:15 row_mask:0xa bank_mask:0xf
    s_nop 1
    v_add_f32_dpp v26, v26, v26 row_bcast:31 row_mask:0xc bank_mask:0xf
    s_nop 1
    v_readlane_b32 s66, v26, 63
    s_nop 1
    v_mov_b32 v27, s66
    v_mul_f32 v27, 0x3a800000, v27
    v_mov_b32 v26, 0
    v_sub_f32 v28, v64, v27
    v_fmac_f32 v26, v28, v28
    v_sub_f32 v28, v65, v27
    v_fmac_f32 v26, v28, v28
    v_sub_f32 v28, v66, v27
    v_fmac_f32 v26, v28, v28
    v_sub_f32 v28, v67, v27
    v_fmac_f32 v26, v28, v28
    v_sub_f32 v28, v68, v27
    v_fmac_f32 v26, v28, v28
    v_sub_f32 v28, v69, v27
    v_fmac_f32 v26, v28, v28
    v_sub_f32 v28, v70, v27
    v_fmac_f32 v26, v28, v28
    v_sub_f32 v28, v71, v27
    v_fmac_f32 v26, v28, v28
    v_sub_f32 v28, v72, v27
    v_fmac_f32 v26, v28, v28
    v_sub_f32 v28, v73, v27
    v_fmac_f32 v26, v28, v28
    v_sub_f32 v28, v74, v27
    v_fmac_f32 v26, v28, v28
    v_sub_f32 v28, v75, v27
    v_fmac_f32 v26, v28, v28
    v_sub_f32 v28, v76, v27
    v_fmac_f32 v26, v28, v28
    v_sub_f32 v28, v77, v27
    v_fmac_f32 v26, v28, v28
    v_sub_f32 v28, v78, v27
    v_fmac_f32 v26, v28, v28
    v_sub_f32 v28, v79, v27
    v_fmac_f32 v26, v28, v28
    s_nop 1
    v_add_f32_dpp v26, v26, v26 row_shr:1 row_mask:0xf bank_mask:0xf bound_ctrl:0
    s_nop 1
    v_add_f32_dpp v26, v26, v26 row_shr:2 row_mask:0xf bank_mask:0xf bound_ctrl:0
    s_nop 1
    v_add_f32_dpp v26, v26, v26 row_shr:4 row_mask:0xf bank_mask:0xf bound_ctrl:0
    s_nop 1
    v_add_f32_dpp v26, v26, v26 row_shr:8 row_mask:0xf bank_mask:0xf bound_ctrl:0
    s_nop 1
    v_add_f32_dpp v26, v26, v26 row_bcast:15 row_mask:0xa bank_mask:0xf
    s_nop 1
    v_add_f32_dpp v26, v26, v26 row_bcast:31 row_mask:0xc bank_mask:0xf
    s_nop 1
    v_readlane_b32 s66, v26, 63
    s_nop 1
    v_mov_b32 v26, s66
    v_mul_f32 v26, 0x3a800000, v26
    v_cvt_pk_bf16_f32 v26, v26, v26
    v_lshlrev_b32 v26, 16, v26
    v_cvt_pk_bf16_f32 v27, v27, v27
    v_lshlrev_b32 v27, 16, v27
    v_add_f32 v26, 0x3727c5ac, v26
    v_cvt_pk_bf16_f32 v26, v26, v26
    v_lshlrev_b32 v26, 16, v26
    v_sqrt_f32 v26, v26
    s_nop 0
    v_cvt_pk_bf16_f32 v26, v26, v26
    v_lshlrev_b32 v26, 16, v26
    v_rcp_f32 v26, v26
    s_nop 0
    v_sub_f32 v64, v64, v27
    v_cvt_pk_bf16_f32 v64, v64, v64
    v_lshlrev_b32 v64, 16, v64
    v_mul_f32 v64, v64, v26
    v_cvt_pk_bf16_f32 v64, v64, v64
    v_lshlrev_b32 v64, 16, v64
    v_sub_f32 v65, v65, v27
    v_cvt_pk_bf16_f32 v65, v65, v65
    v_lshlrev_b32 v65, 16, v65
    v_mul_f32 v65, v65, v26
    v_cvt_pk_bf16_f32 v65, v65, v65
    v_lshlrev_b32 v65, 16, v65
    v_sub_f32 v66, v66, v27
    v_cvt_pk_bf16_f32 v66, v66, v66
    v_lshlrev_b32 v66, 16, v66
    v_mul_f32 v66, v66, v26
    v_cvt_pk_bf16_f32 v66, v66, v66
    v_lshlrev_b32 v66, 16, v66
    v_sub_f32 v67, v67, v27
    v_cvt_pk_bf16_f32 v67, v67, v67
    v_lshlrev_b32 v67, 16, v67
    v_mul_f32 v67, v67, v26
    v_cvt_pk_bf16_f32 v67, v67, v67
    v_lshlrev_b32 v67, 16, v67
    v_sub_f32 v68, v68, v27
    v_cvt_pk_bf16_f32 v68, v68, v68
    v_lshlrev_b32 v68, 16, v68
    v_mul_f32 v68, v68, v26
    v_cvt_pk_bf16_f32 v68, v68, v68
    v_lshlrev_b32 v68, 16, v68
    v_sub_f32 v69, v69, v27
    v_cvt_pk_bf16_f32 v69, v69, v69
    v_lshlrev_b32 v69, 16, v69
    v_mul_f32 v69, v69, v26
    v_cvt_pk_bf16_f32 v69, v69, v69
    v_lshlrev_b32 v69, 16, v69
    v_sub_f32 v70, v70, v27
    v_cvt_pk_bf16_f32 v70, v70, v70
    v_lshlrev_b32 v70, 16, v70
    v_mul_f32 v70, v70, v26
    v_cvt_pk_bf16_f32 v70, v70, v70
    v_lshlrev_b32 v70, 16, v70
    v_sub_f32 v71, v71, v27
    v_cvt_pk_bf16_f32 v71, v71, v71
    v_lshlrev_b32 v71, 16, v71
    v_mul_f32 v71, v71, v26
    v_cvt_pk_bf16_f32 v71, v71, v71
    v_lshlrev_b32 v71, 16, v71
    v_sub_f32 v72, v72, v27
    v_cvt_pk_bf16_f32 v72, v72, v72
    v_lshlrev_b32 v72, 16, v72
    v_mul_f32 v72, v72, v26
    v_cvt_pk_bf16_f32 v72, v72, v72
    v_lshlrev_b32 v72, 16, v72
    v_sub_f32 v73, v73, v27
    v_cvt_pk_bf16_f32 v73, v73, v73
    v_lshlrev_b32 v73, 16, v73
    v_mul_f32 v73, v73, v26
    v_cvt_pk_bf16_f32 v73, v73, v73
    v_lshlrev_b32 v73, 16, v73
    v_sub_f32 v74, v74, v27
    v_cvt_pk_bf16_f32 v74, v74, v74
    v_lshlrev_b32 v74, 16, v74
    v_mul_f32 v74, v74, v26
    v_cvt_pk_bf16_f32 v74, v74, v74
    v_lshlrev_b32 v74, 16, v74
    v_sub_f32 v75, v75, v27
    v_cvt_pk_bf16_f32 v75, v75, v75
    v_lshlrev_b32 v75, 16, v75
    v_mul_f32 v75, v75, v26
    v_cvt_pk_bf16_f32 v75, v75, v75
    v_lshlrev_b32 v75, 16, v75
    v_sub_f32 v76, v76, v27
    v_cvt_pk_bf16_f32 v76, v76, v76
    v_lshlrev_b32 v76, 16, v76
    v_mul_f32 v76, v76, v26
    v_cvt_pk_bf16_f32 v76, v76, v76
    v_lshlrev_b32 v76, 16, v76
    v_sub_f32 v77, v77, v27
    v_cvt_pk_bf16_f32 v77, v77, v77
    v_lshlrev_b32 v77, 16, v77
    v_mul_f32 v77, v77, v26
    v_cvt_pk_bf16_f32 v77, v77, v77
    v_lshlrev_b32 v77, 16, v77
    v_sub_f32 v78, v78, v27
    v_cvt_pk_bf16_f32 v78, v78, v78
    v_lshlrev_b32 v78, 16, v78
    v_mul_f32 v78, v78, v26
    v_cvt_pk_bf16_f32 v78, v78, v78
    v_lshlrev_b32 v78, 16, v78
    v_sub_f32 v79, v79, v27
    v_cvt_pk_bf16_f32 v79, v79, v79
    v_lshlrev_b32 v79, 16, v79
    v_mul_f32 v79, v79, v26
    v_cvt_pk_bf16_f32 v79, v79, v79
    v_lshlrev_b32 v79, 16, v79
    v_mul_f32 v64, v64, v112
    v_cvt_pk_bf16_f32 v64, v64, v64
    v_lshlrev_b32 v64, 16, v64
    v_add_f32 v64, v64, v96
    v_mul_f32 v65, v65, v113
    v_cvt_pk_bf16_f32 v65, v65, v65
    v_lshlrev_b32 v65, 16, v65
    v_add_f32 v65, v65, v97
    v_mul_f32 v66, v66, v114
    v_cvt_pk_bf16_f32 v66, v66, v66
    v_lshlrev_b32 v66, 16, v66
    v_add_f32 v66, v66, v98
    v_mul_f32 v67, v67, v115
    v_cvt_pk_bf16_f32 v67, v67, v67
    v_lshlrev_b32 v67, 16, v67
    v_add_f32 v67, v67, v99
    v_mul_f32 v68, v68, v116
    v_cvt_pk_bf16_f32 v68, v68, v68
    v_lshlrev_b32 v68, 16, v68
    v_add_f32 v68, v68, v100
    v_mul_f32 v69, v69, v117
    v_cvt_pk_bf16_f32 v69, v69, v69
    v_lshlrev_b32 v69, 16, v69
    v_add_f32 v69, v69, v101
    v_mul_f32 v70, v70, v118
    v_cvt_pk_bf16_f32 v70, v70, v70
    v_lshlrev_b32 v70, 16, v70
    v_add_f32 v70, v70, v102
    v_mul_f32 v71, v71, v119
    v_cvt_pk_bf16_f32 v71, v71, v71
    v_lshlrev_b32 v71, 16, v71
    v_add_f32 v71, v71, v103
    v_mul_f32 v72, v72, v120
    v_cvt_pk_bf16_f32 v72, v72, v72
    v_lshlrev_b32 v72, 16, v72
    v_add_f32 v72, v72, v104
    v_mul_f32 v73, v73, v121
    v_cvt_pk_bf16_f32 v73, v73, v73
    v_lshlrev_b32 v73, 16, v73
    v_add_f32 v73, v73, v105
    v_mul_f32 v74, v74, v122
    v_cvt_pk_bf16_f32 v74, v74, v74
    v_lshlrev_b32 v74, 16, v74
    v_add_f32 v74, v74, v106
    v_mul_f32 v75, v75, v123
    v_cvt_pk_bf16_f32 v75, v75, v75
    v_lshlrev_b32 v75, 16, v75
    v_add_f32 v75, v75, v107
    v_mul_f32 v76, v76, v124
    v_cvt_pk_bf16_f32 v76, v76, v76
    v_lshlrev_b32 v76, 16, v76
    v_add_f32 v76, v76, v108
    v_mul_f32 v77, v77, v125
    v_cvt_pk_bf16_f32 v77, v77, v77
    v_lshlrev_b32 v77, 16, v77
    v_add_f32 v77, v77, v109
    v_mul_f32 v78, v78, v126
    v_cvt_pk_bf16_f32 v78, v78, v78
    v_lshlrev_b32 v78, 16, v78
    v_add_f32 v78, v78, v110
    v_mul_f32 v79, v79, v127
    v_cvt_pk_bf16_f32 v79, v79, v79
    v_lshlrev_b32 v79, 16, v79
    v_add_f32 v79, v79, v111
    v_cvt_pk_bf16_f32 v80, v64, v65
    v_cvt_pk_bf16_f32 v81, v66, v67
    v_cvt_pk_bf16_f32 v82, v68, v69
    v_cvt_pk_bf16_f32 v83, v70, v71
    v_cvt_pk_bf16_f32 v84, v72, v73
    v_cvt_pk_bf16_f32 v85, v74, v75
    v_cvt_pk_bf16_f32 v86, v76, v77
    v_cvt_pk_bf16_f32 v87, v78, v79
    s_lshr_b32 s45, s63, 5
    s_lshl_b32 s45, s45, 16
    s_and_b32 s46, s63, 31
    s_lshl_b32 s46, s46, 8
    s_add_u32 s45, s45, s46
    s_add_u32 s45, s45, 0x400000
    s_add_u32 s46, s45, 32768
    buffer_store_dwordx4 v[80:83], v2, s[12:15], s45 offen sc1
    buffer_store_dwordx4 v[84:87], v2, s[12:15], s46 offen sc1
    s_add_u32 s63, s63, 384
    v_lshlrev_b32 v64, 16, v160
    v_and_b32 v65, 0xffff0000, v160
    v_lshlrev_b32 v66, 16, v161
    v_and_b32 v67, 0xffff0000, v161
    v_lshlrev_b32 v68, 16, v162
    v_and_b32 v69, 0xffff0000, v162
    v_lshlrev_b32 v70, 16, v163
    v_and_b32 v71, 0xffff0000, v163
    v_lshlrev_b32 v72, 16, v164
    v_and_b32 v73, 0xffff0000, v164
    v_lshlrev_b32 v74, 16, v165
    v_and_b32 v75, 0xffff0000, v165
    v_lshlrev_b32 v76, 16, v166
    v_and_b32 v77, 0xffff0000, v166
    v_lshlrev_b32 v78, 16, v167
    v_and_b32 v79, 0xffff0000, v167
    v_add_f32 v26, v64, v65
    v_add_f32 v26, v26, v66
    v_add_f32 v26, v26, v67
    v_add_f32 v26, v26, v68
    v_add_f32 v26, v26, v69
    v_add_f32 v26, v26, v70
    v_add_f32 v26, v26, v71
    v_add_f32 v26, v26, v72
    v_add_f32 v26, v26, v73
    v_add_f32 v26, v26, v74
    v_add_f32 v26, v26, v75
    v_add_f32 v26, v26, v76
    v_add_f32 v26, v26, v77
    v_add_f32 v26, v26, v78
    v_add_f32 v26, v26, v79
    s_nop 1
    v_add_f32_dpp v26, v26, v26 row_shr:1 row_mask:0xf bank_mask:0xf bound_ctrl:0
    s_nop 1
    v_add_f32_dpp v26, v26, v26 row_shr:2 row_mask:0xf bank_mask:0xf bound_ctrl:0
    s_nop 1
    v_add_f32_dpp v26, v26, v26 row_shr:4 row_mask:0xf bank_mask:0xf bound_ctrl:0
    s_nop 1
    v_add_f32_dpp v26, v26, v26 row_shr:8 row_mask:0xf bank_mask:0xf bound_ctrl:0
    s_nop 1
    v_add_f32_dpp v26, v26, v26 row_bcast:15 row_mask:0xa bank_mask:0xf
    s_nop 1
    v_add_f32_dpp v26, v26, v26 row_bcast:31 row_mask:0xc bank_mask:0xf
    s_nop 1
    v_readlane_b32 s66, v26, 63
    s_nop 1
    v_mov_b32 v27, s66
    v_mul_f32 v27, 0x3a800000, v27
    v_mov_b32 v26, 0
    v_sub_f32 v28, v64, v27
    v_fmac_f32 v26, v28, v28
    v_sub_f32 v28, v65, v27
    v_fmac_f32 v26, v28, v28
    v_sub_f32 v28, v66, v27
    v_fmac_f32 v26, v28, v28
    v_sub_f32 v28, v67, v27
    v_fmac_f32 v26, v28, v28
    v_sub_f32 v28, v68, v27
    v_fmac_f32 v26, v28, v28
    v_sub_f32 v28, v69, v27
    v_fmac_f32 v26, v28, v28
    v_sub_f32 v28, v70, v27
    v_fmac_f32 v26, v28, v28
    v_sub_f32 v28, v71, v27
    v_fmac_f32 v26, v28, v28
    v_sub_f32 v28, v72, v27
    v_fmac_f32 v26, v28, v28
    v_sub_f32 v28, v73, v27
    v_fmac_f32 v26, v28, v28
    v_sub_f32 v28, v74, v27
    v_fmac_f32 v26, v28, v28
    v_sub_f32 v28, v75, v27
    v_fmac_f32 v26, v28, v28
    v_sub_f32 v28, v76, v27
    v_fmac_f32 v26, v28, v28
    v_sub_f32 v28, v77, v27
    v_fmac_f32 v26, v28, v28
    v_sub_f32 v28, v78, v27
    v_fmac_f32 v26, v28, v28
    v_sub_f32 v28, v79, v27
    v_fmac_f32 v26, v28, v28
    s_nop 1
    v_add_f32_dpp v26, v26, v26 row_shr:1 row_mask:0xf bank_mask:0xf bound_ctrl:0
    s_nop 1
    v_add_f32_dpp v26, v26, v26 row_shr:2 row_mask:0xf bank_mask:0xf bound_ctrl:0
    s_nop 1
    v_add_f32_dpp v26, v26, v26 row_shr:4 row_mask:0xf bank_mask:0xf bound_ctrl:0
    s_nop 1
    v_add_f32_dpp v26, v26, v26 row_shr:8 row_mask:0xf bank_mask:0xf bound_ctrl:0
    s_nop 1
    v_add_f32_dpp v26, v26, v26 row_bcast:15 row_mask:0xa bank_mask:0xf
    s_nop 1
    v_add_f32_dpp v26, v26, v26 row_bcast:31 row_mask:0xc bank_mask:0xf
    s_nop 1
    v_readlane_b32 s66, v26, 63
    s_nop 1
    v_mov_b32 v26, s66
    v_mul_f32 v26, 0x3a800000, v26
    v_cvt_pk_bf16_f32 v26, v26, v26
    v_lshlrev_b32 v26, 16, v26
    v_cvt_pk_bf16_f32 v27, v27, v27
    v_lshlrev_b32 v27, 16, v27
    v_add_f32 v26, 0x3727c5ac, v26
    v_cvt_pk_bf16_f32 v26, v26, v26
    v_lshlrev_b32 v26, 16, v26
    v_sqrt_f32 v26, v26
    s_nop 0
    v_cvt_pk_bf16_f32 v26, v26, v26
    v_lshlrev_b32 v26, 16, v26
    v_rcp_f32 v26, v26
    s_nop 0
    v_sub_f32 v64, v64, v27
    v_cvt_pk_bf16_f32 v64, v64, v64
    v_lshlrev_b32 v64, 16, v64
    v_mul_f32 v64, v64, v26
    v_cvt_pk_bf16_f32 v64, v64, v64
    v_lshlrev_b32 v64, 16, v64
    v_sub_f32 v65, v65, v27
    v_cvt_pk_bf16_f32 v65, v65, v65
    v_lshlrev_b32 v65, 16, v65
    v_mul_f32 v65, v65, v26
    v_cvt_pk_bf16_f32 v65, v65, v65
    v_lshlrev_b32 v65, 16, v65
    v_sub_f32 v66, v66, v27
    v_cvt_pk_bf16_f32 v66, v66, v66
    v_lshlrev_b32 v66, 16, v66
    v_mul_f32 v66, v66, v26
    v_cvt_pk_bf16_f32 v66, v66, v66
    v_lshlrev_b32 v66, 16, v66
    v_sub_f32 v67, v67, v27
    v_cvt_pk_bf16_f32 v67, v67, v67
    v_lshlrev_b32 v67, 16, v67
    v_mul_f32 v67, v67, v26
    v_cvt_pk_bf16_f32 v67, v67, v67
    v_lshlrev_b32 v67, 16, v67
    v_sub_f32 v68, v68, v27
    v_cvt_pk_bf16_f32 v68, v68, v68
    v_lshlrev_b32 v68, 16, v68
    v_mul_f32 v68, v68, v26
    v_cvt_pk_bf16_f32 v68, v68, v68
    v_lshlrev_b32 v68, 16, v68
    v_sub_f32 v69, v69, v27
    v_cvt_pk_bf16_f32 v69, v69, v69
    v_lshlrev_b32 v69, 16, v69
    v_mul_f32 v69, v69, v26
    v_cvt_pk_bf16_f32 v69, v69, v69
    v_lshlrev_b32 v69, 16, v69
    v_sub_f32 v70, v70, v27
    v_cvt_pk_bf16_f32 v70, v70, v70
    v_lshlrev_b32 v70, 16, v70
    v_mul_f32 v70, v70, v26
    v_cvt_pk_bf16_f32 v70, v70, v70
    v_lshlrev_b32 v70, 16, v70
    v_sub_f32 v71, v71, v27
    v_cvt_pk_bf16_f32 v71, v71, v71
    v_lshlrev_b32 v71, 16, v71
    v_mul_f32 v71, v71, v26
    v_cvt_pk_bf16_f32 v71, v71, v71
    v_lshlrev_b32 v71, 16, v71
    v_sub_f32 v72, v72, v27
    v_cvt_pk_bf16_f32 v72, v72, v72
    v_lshlrev_b32 v72, 16, v72
    v_mul_f32 v72, v72, v26
    v_cvt_pk_bf16_f32 v72, v72, v72
    v_lshlrev_b32 v72, 16, v72
    v_sub_f32 v73, v73, v27
    v_cvt_pk_bf16_f32 v73, v73, v73
    v_lshlrev_b32 v73, 16, v73
    v_mul_f32 v73, v73, v26
    v_cvt_pk_bf16_f32 v73, v73, v73
    v_lshlrev_b32 v73, 16, v73
    v_sub_f32 v74, v74, v27
    v_cvt_pk_bf16_f32 v74, v74, v74
    v_lshlrev_b32 v74, 16, v74
    v_mul_f32 v74, v74, v26
    v_cvt_pk_bf16_f32 v74, v74, v74
    v_lshlrev_b32 v74, 16, v74
    v_sub_f32 v75, v75, v27
    v_cvt_pk_bf16_f32 v75, v75, v75
    v_lshlrev_b32 v75, 16, v75
    v_mul_f32 v75, v75, v26
    v_cvt_pk_bf16_f32 v75, v75, v75
    v_lshlrev_b32 v75, 16, v75
    v_sub_f32 v76, v76, v27
    v_cvt_pk_bf16_f32 v76, v76, v76
    v_lshlrev_b32 v76, 16, v76
    v_mul_f32 v76, v76, v26
    v_cvt_pk_bf16_f32 v76, v76, v76
    v_lshlrev_b32 v76, 16, v76
    v_sub_f32 v77, v77, v27
    v_cvt_pk_bf16_f32 v77, v77, v77
    v_lshlrev_b32 v77, 16, v77
    v_mul_f32 v77, v77, v26
    v_cvt_pk_bf16_f32 v77, v77, v77
    v_lshlrev_b32 v77, 16, v77
    v_sub_f32 v78, v78, v27
    v_cvt_pk_bf16_f32 v78, v78, v78
    v_lshlrev_b32 v78, 16, v78
    v_mul_f32 v78, v78, v26
    v_cvt_pk_bf16_f32 v78, v78, v78
    v_lshlrev_b32 v78, 16, v78
    v_sub_f32 v79, v79, v27
    v_cvt_pk_bf16_f32 v79, v79, v79
    v_lshlrev_b32 v79, 16, v79
    v_mul_f32 v79, v79, v26
    v_cvt_pk_bf16_f32 v79, v79, v79
    v_lshlrev_b32 v79, 16, v79
    v_mul_f32 v64, v64, v112
    v_cvt_pk_bf16_f32 v64, v64, v64
    v_lshlrev_b32 v64, 16, v64
    v_add_f32 v64, v64, v96
    v_mul_f32 v65, v65, v113
    v_cvt_pk_bf16_f32 v65, v65, v65
    v_lshlrev_b32 v65, 16, v65
    v_add_f32 v65, v65, v97
    v_mul_f32 v66, v66, v114
    v_cvt_pk_bf16_f32 v66, v66, v66
    v_lshlrev_b32 v66, 16, v66
    v_add_f32 v66, v66, v98
    v_mul_f32 v67, v67, v115
    v_cvt_pk_bf16_f32 v67, v67, v67
    v_lshlrev_b32 v67, 16, v67
    v_add_f32 v67, v67, v99
    v_mul_f32 v68, v68, v116
    v_cvt_pk_bf16_f32 v68, v68, v68
    v_lshlrev_b32 v68, 16, v68
    v_add_f32 v68, v68, v100
    v_mul_f32 v69, v69, v117
    v_cvt_pk_bf16_f32 v69, v69, v69
    v_lshlrev_b32 v69, 16, v69
    v_add_f32 v69, v69, v101
    v_mul_f32 v70, v70, v118
    v_cvt_pk_bf16_f32 v70, v70, v70
    v_lshlrev_b32 v70, 16, v70
    v_add_f32 v70, v70, v102
    v_mul_f32 v71, v71, v119
    v_cvt_pk_bf16_f32 v71, v71, v71
    v_lshlrev_b32 v71, 16, v71
    v_add_f32 v71, v71, v103
    v_mul_f32 v72, v72, v120
    v_cvt_pk_bf16_f32 v72, v72, v72
    v_lshlrev_b32 v72, 16, v72
    v_add_f32 v72, v72, v104
    v_mul_f32 v73, v73, v121
    v_cvt_pk_bf16_f32 v73, v73, v73
    v_lshlrev_b32 v73, 16, v73
    v_add_f32 v73, v73, v105
    v_mul_f32 v74, v74, v122
    v_cvt_pk_bf16_f32 v74, v74, v74
    v_lshlrev_b32 v74, 16, v74
    v_add_f32 v74, v74, v106
    v_mul_f32 v75, v75, v123
    v_cvt_pk_bf16_f32 v75, v75, v75
    v_lshlrev_b32 v75, 16, v75
    v_add_f32 v75, v75, v107
    v_mul_f32 v76, v76, v124
    v_cvt_pk_bf16_f32 v76, v76, v76
    v_lshlrev_b32 v76, 16, v76
    v_add_f32 v76, v76, v108
    v_mul_f32 v77, v77, v125
    v_cvt_pk_bf16_f32 v77, v77, v77
    v_lshlrev_b32 v77, 16, v77
    v_add_f32 v77, v77, v109
    v_mul_f32 v78, v78, v126
    v_cvt_pk_bf16_f32 v78, v78, v78
    v_lshlrev_b32 v78, 16, v78
    v_add_f32 v78, v78, v110
    v_mul_f32 v79, v79, v127
    v_cvt_pk_bf16_f32 v79, v79, v79
    v_lshlrev_b32 v79, 16, v79
    v_add_f32 v79, v79, v111
    v_cvt_pk_bf16_f32 v80, v64, v65
    v_cvt_pk_bf16_f32 v81, v66, v67
    v_cvt_pk_bf16_f32 v82, v68, v69
    v_cvt_pk_bf16_f32 v83, v70, v71
    v_cvt_pk_bf16_f32 v84, v72, v73
    v_cvt_pk_bf16_f32 v85, v74, v75
    v_cvt_pk_bf16_f32 v86, v76, v77
    v_cvt_pk_bf16_f32 v87, v78, v79
    s_lshr_b32 s45, s63, 5
    s_lshl_b32 s45, s45, 16
    s_and_b32 s46, s63, 31
    s_lshl_b32 s46, s46, 8
    s_add_u32 s45, s45, s46
    s_add_u32 s45, s45, 0x400000
    s_add_u32 s46, s45, 32768
    buffer_store_dwordx4 v[80:83], v2, s[12:15], s45 offen sc1
    buffer_store_dwordx4 v[84:87], v2, s[12:15], s46 offen sc1
    s_add_u32 s63, s63, 384
    s_cmp_ge_u32 s63, 2048
    s_cbranch_scc1 L_ln_done_109
    v_lshlrev_b32 v64, 16, v168
    v_and_b32 v65, 0xffff0000, v168
    v_lshlrev_b32 v66, 16, v169
    v_and_b32 v67, 0xffff0000, v169
    v_lshlrev_b32 v68, 16, v170
    v_and_b32 v69, 0xffff0000, v170
    v_lshlrev_b32 v70, 16, v171
    v_and_b32 v71, 0xffff0000, v171
    v_lshlrev_b32 v72, 16, v172
    v_and_b32 v73, 0xffff0000, v172
    v_lshlrev_b32 v74, 16, v173
    v_and_b32 v75, 0xffff0000, v173
    v_lshlrev_b32 v76, 16, v174
    v_and_b32 v77, 0xffff0000, v174
    v_lshlrev_b32 v78, 16, v175
    v_and_b32 v79, 0xffff0000, v175
    v_add_f32 v26, v64, v65
    v_add_f32 v26, v26, v66
    v_add_f32 v26, v26, v67
    v_add_f32 v26, v26, v68
    v_add_f32 v26, v26, v69
    v_add_f32 v26, v26, v70
    v_add_f32 v26, v26, v71
    v_add_f32 v26, v26, v72
    v_add_f32 v26, v26, v73
    v_add_f32 v26, v26, v74
    v_add_f32 v26, v26, v75
    v_add_f32 v26, v26, v76
    v_add_f32 v26, v26, v77
    v_add_f32 v26, v26, v78
    v_add_f32 v26, v26, v79
    s_nop 1
    v_add_f32_dpp v26, v26, v26 row_shr:1 row_mask:0xf bank_mask:0xf bound_ctrl:0
    s_nop 1
    v_add_f32_dpp v26, v26, v26 row_shr:2 row_mask:0xf bank_mask:0xf bound_ctrl:0
    s_nop 1
    v_add_f32_dpp v26, v26, v26 row_shr:4 row_mask:0xf bank_mask:0xf bound_ctrl:0
    s_nop 1
    v_add_f32_dpp v26, v26, v26 row_shr:8 row_mask:0xf bank_mask:0xf bound_ctrl:0
    s_nop 1
    v_add_f32_dpp v26, v26, v26 row_bcast:15 row_mask:0xa bank_mask:0xf
    s_nop 1
    v_add_f32_dpp v26, v26, v26 row_bcast:31 row_mask:0xc bank_mask:0xf
    s_nop 1
    v_readlane_b32 s66, v26, 63
    s_nop 1
    v_mov_b32 v27, s66
    v_mul_f32 v27, 0x3a800000, v27
    v_mov_b32 v26, 0
    v_sub_f32 v28, v64, v27
    v_fmac_f32 v26, v28, v28
    v_sub_f32 v28, v65, v27
    v_fmac_f32 v26, v28, v28
    v_sub_f32 v28, v66, v27
    v_fmac_f32 v26, v28, v28
    v_sub_f32 v28, v67, v27
    v_fmac_f32 v26, v28, v28
    v_sub_f32 v28, v68, v27
    v_fmac_f32 v26, v28, v28
    v_sub_f32 v28, v69, v27
    v_fmac_f32 v26, v28, v28
    v_sub_f32 v28, v70, v27
    v_fmac_f32 v26, v28, v28
    v_sub_f32 v28, v71, v27
    v_fmac_f32 v26, v28, v28
    v_sub_f32 v28, v72, v27
    v_fmac_f32 v26, v28, v28
    v_sub_f32 v28, v73, v27
    v_fmac_f32 v26, v28, v28
    v_sub_f32 v28, v74, v27
    v_fmac_f32 v26, v28, v28
    v_sub_f32 v28, v75, v27
    v_fmac_f32 v26, v28, v28
    v_sub_f32 v28, v76, v27
    v_fmac_f32 v26, v28, v28
    v_sub_f32 v28, v77, v27
    v_fmac_f32 v26, v28, v28
    v_sub_f32 v28, v78, v27
    v_fmac_f32 v26, v28, v28
    v_sub_f32 v28, v79, v27
    v_fmac_f32 v26, v28, v28
    s_nop 1
    v_add_f32_dpp v26, v26, v26 row_shr:1 row_mask:0xf bank_mask:0xf bound_ctrl:0
    s_nop 1
    v_add_f32_dpp v26, v26, v26 row_shr:2 row_mask:0xf bank_mask:0xf bound_ctrl:0
    s_nop 1
    v_add_f32_dpp v26, v26, v26 row_shr:4 row_mask:0xf bank_mask:0xf bound_ctrl:0
    s_nop 1
    v_add_f32_dpp v26, v26, v26 row_shr:8 row_mask:0xf bank_mask:0xf bound_ctrl:0
    s_nop 1
    v_add_f32_dpp v26, v26, v26 row_bcast:15 row_mask:0xa bank_mask:0xf
    s_nop 1
    v_add_f32_dpp v26, v26, v26 row_bcast:31 row_mask:0xc bank_mask:0xf
    s_nop 1
    v_readlane_b32 s66, v26, 63
    s_nop 1
    v_mov_b32 v26, s66
    v_mul_f32 v26, 0x3a800000, v26
    v_cvt_pk_bf16_f32 v26, v26, v26
    v_lshlrev_b32 v26, 16, v26
    v_cvt_pk_bf16_f32 v27, v27, v27
    v_lshlrev_b32 v27, 16, v27
    v_add_f32 v26, 0x3727c5ac, v26
    v_cvt_pk_bf16_f32 v26, v26, v26
    v_lshlrev_b32 v26, 16, v26
    v_sqrt_f32 v26, v26
    s_nop 0
    v_cvt_pk_bf16_f32 v26, v26, v26
    v_lshlrev_b32 v26, 16, v26
    v_rcp_f32 v26, v26
    s_nop 0
    v_sub_f32 v64, v64, v27
    v_cvt_pk_bf16_f32 v64, v64, v64
    v_lshlrev_b32 v64, 16, v64
    v_mul_f32 v64, v64, v26
    v_cvt_pk_bf16_f32 v64, v64, v64
    v_lshlrev_b32 v64, 16, v64
    v_sub_f32 v65, v65, v27
    v_cvt_pk_bf16_f32 v65, v65, v65
    v_lshlrev_b32 v65, 16, v65
    v_mul_f32 v65, v65, v26
    v_cvt_pk_bf16_f32 v65, v65, v65
    v_lshlrev_b32 v65, 16, v65
    v_sub_f32 v66, v66, v27
    v_cvt_pk_bf16_f32 v66, v66, v66
    v_lshlrev_b32 v66, 16, v66
    v_mul_f32 v66, v66, v26
    v_cvt_pk_bf16_f32 v66, v66, v66
    v_lshlrev_b32 v66, 16, v66
    v_sub_f32 v67, v67, v27
    v_cvt_pk_bf16_f32 v67, v67, v67
    v_lshlrev_b32 v67, 16, v67
    v_mul_f32 v67, v67, v26
    v_cvt_pk_bf16_f32 v67, v67, v67
    v_lshlrev_b32 v67, 16, v67
    v_sub_f32 v68, v68, v27
    v_cvt_pk_bf16_f32 v68, v68, v68
    v_lshlrev_b32 v68, 16, v68
    v_mul_f32 v68, v68, v26
    v_cvt_pk_bf16_f32 v68, v68, v68
    v_lshlrev_b32 v68, 16, v68
    v_sub_f32 v69, v69, v27
    v_cvt_pk_bf16_f32 v69, v69, v69
    v_lshlrev_b32 v69, 16, v69
    v_mul_f32 v69, v69, v26
    v_cvt_pk_bf16_f32 v69, v69, v69
    v_lshlrev_b32 v69, 16, v69
    v_sub_f32 v70, v70, v27
    v_cvt_pk_bf16_f32 v70, v70, v70
    v_lshlrev_b32 v70, 16, v70
    v_mul_f32 v70, v70, v26
    v_cvt_pk_bf16_f32 v70, v70, v70
    v_lshlrev_b32 v70, 16, v70
    v_sub_f32 v71, v71, v27
    v_cvt_pk_bf16_f32 v71, v71, v71
    v_lshlrev_b32 v71, 16, v71
    v_mul_f32 v71, v71, v26
    v_cvt_pk_bf16_f32 v71, v71, v71
    v_lshlrev_b32 v71, 16, v71
    v_sub_f32 v72, v72, v27
    v_cvt_pk_bf16_f32 v72, v72, v72
    v_lshlrev_b32 v72, 16, v72
    v_mul_f32 v72, v72, v26
    v_cvt_pk_bf16_f32 v72, v72, v72
    v_lshlrev_b32 v72, 16, v72
    v_sub_f32 v73, v73, v27
    v_cvt_pk_bf16_f32 v73, v73, v73
    v_lshlrev_b32 v73, 16, v73
    v_mul_f32 v73, v73, v26
    v_cvt_pk_bf16_f32 v73, v73, v73
    v_lshlrev_b32 v73, 16, v73
    v_sub_f32 v74, v74, v27
    v_cvt_pk_bf16_f32 v74, v74, v74
    v_lshlrev_b32 v74, 16, v74
    v_mul_f32 v74, v74, v26
    v_cvt_pk_bf16_f32 v74, v74, v74
    v_lshlrev_b32 v74, 16, v74
    v_sub_f32 v75, v75, v27
    v_cvt_pk_bf16_f32 v75, v75, v75
    v_lshlrev_b32 v75, 16, v75
    v_mul_f32 v75, v75, v26
    v_cvt_pk_bf16_f32 v75, v75, v75
    v_lshlrev_b32 v75, 16, v75
    v_sub_f32 v76, v76, v27
    v_cvt_pk_bf16_f32 v76, v76, v76
    v_lshlrev_b32 v76, 16, v76
    v_mul_f32 v76, v76, v26
    v_cvt_pk_bf16_f32 v76, v76, v76
    v_lshlrev_b32 v76, 16, v76
    v_sub_f32 v77, v77, v27
    v_cvt_pk_bf16_f32 v77, v77, v77
    v_lshlrev_b32 v77, 16, v77
    v_mul_f32 v77, v77, v26
    v_cvt_pk_bf16_f32 v77, v77, v77
    v_lshlrev_b32 v77, 16, v77
    v_sub_f32 v78, v78, v27
    v_cvt_pk_bf16_f32 v78, v78, v78
    v_lshlrev_b32 v78, 16, v78
    v_mul_f32 v78, v78, v26
    v_cvt_pk_bf16_f32 v78, v78, v78
    v_lshlrev_b32 v78, 16, v78
    v_sub_f32 v79, v79, v27
    v_cvt_pk_bf16_f32 v79, v79, v79
    v_lshlrev_b32 v79, 16, v79
    v_mul_f32 v79, v79, v26
    v_cvt_pk_bf16_f32 v79, v79, v79
    v_lshlrev_b32 v79, 16, v79
    v_mul_f32 v64, v64, v112
    v_cvt_pk_bf16_f32 v64, v64, v64
    v_lshlrev_b32 v64, 16, v64
    v_add_f32 v64, v64, v96
    v_mul_f32 v65, v65, v113
    v_cvt_pk_bf16_f32 v65, v65, v65
    v_lshlrev_b32 v65, 16, v65
    v_add_f32 v65, v65, v97
    v_mul_f32 v66, v66, v114
    v_cvt_pk_bf16_f32 v66, v66, v66
    v_lshlrev_b32 v66, 16, v66
    v_add_f32 v66, v66, v98
    v_mul_f32 v67, v67, v115
    v_cvt_pk_bf16_f32 v67, v67, v67
    v_lshlrev_b32 v67, 16, v67
    v_add_f32 v67, v67, v99
    v_mul_f32 v68, v68, v116
    v_cvt_pk_bf16_f32 v68, v68, v68
    v_lshlrev_b32 v68, 16, v68
    v_add_f32 v68, v68, v100
    v_mul_f32 v69, v69, v117
    v_cvt_pk_bf16_f32 v69, v69, v69
    v_lshlrev_b32 v69, 16, v69
    v_add_f32 v69, v69, v101
    v_mul_f32 v70, v70, v118
    v_cvt_pk_bf16_f32 v70, v70, v70
    v_lshlrev_b32 v70, 16, v70
    v_add_f32 v70, v70, v102
    v_mul_f32 v71, v71, v119
    v_cvt_pk_bf16_f32 v71, v71, v71
    v_lshlrev_b32 v71, 16, v71
    v_add_f32 v71, v71, v103
    v_mul_f32 v72, v72, v120
    v_cvt_pk_bf16_f32 v72, v72, v72
    v_lshlrev_b32 v72, 16, v72
    v_add_f32 v72, v72, v104
    v_mul_f32 v73, v73, v121
    v_cvt_pk_bf16_f32 v73, v73, v73
    v_lshlrev_b32 v73, 16, v73
    v_add_f32 v73, v73, v105
    v_mul_f32 v74, v74, v122
    v_cvt_pk_bf16_f32 v74, v74, v74
    v_lshlrev_b32 v74, 16, v74
    v_add_f32 v74, v74, v106
    v_mul_f32 v75, v75, v123
    v_cvt_pk_bf16_f32 v75, v75, v75
    v_lshlrev_b32 v75, 16, v75
    v_add_f32 v75, v75, v107
    v_mul_f32 v76, v76, v124
    v_cvt_pk_bf16_f32 v76, v76, v76
    v_lshlrev_b32 v76, 16, v76
    v_add_f32 v76, v76, v108
    v_mul_f32 v77, v77, v125
    v_cvt_pk_bf16_f32 v77, v77, v77
    v_lshlrev_b32 v77, 16, v77
    v_add_f32 v77, v77, v109
    v_mul_f32 v78, v78, v126
    v_cvt_pk_bf16_f32 v78, v78, v78
    v_lshlrev_b32 v78, 16, v78
    v_add_f32 v78, v78, v110
    v_mul_f32 v79, v79, v127
    v_cvt_pk_bf16_f32 v79, v79, v79
    v_lshlrev_b32 v79, 16, v79
    v_add_f32 v79, v79, v111
    v_cvt_pk_bf16_f32 v80, v64, v65
    v_cvt_pk_bf16_f32 v81, v66, v67
    v_cvt_pk_bf16_f32 v82, v68, v69
    v_cvt_pk_bf16_f32 v83, v70, v71
    v_cvt_pk_bf16_f32 v84, v72, v73
    v_cvt_pk_bf16_f32 v85, v74, v75
    v_cvt_pk_bf16_f32 v86, v76, v77
    v_cvt_pk_bf16_f32 v87, v78, v79
    s_lshr_b32 s45, s63, 5
    s_lshl_b32 s45, s45, 16
    s_and_b32 s46, s63, 31
    s_lshl_b32 s46, s46, 8
    s_add_u32 s45, s45, s46
    s_add_u32 s45, s45, 0x400000
    s_add_u32 s46, s45, 32768
    buffer_store_dwordx4 v[80:83], v2, s[12:15], s45 offen sc1
    buffer_store_dwordx4 v[84:87], v2, s[12:15], s46 offen sc1
    s_add_u32 s63, s63, 384
L_ln_done_109:
    s_waitcnt vmcnt(0)
    s_barrier
    s_cmp_lg_u32 s44, 0
    s_cbranch_scc1 L_cnt_111
    v_mov_b32 v30, 1
    v_mov_b32 v31, 0
    s_mov_b64 exec, 1
    buffer_atomic_add v30, v31, s[16:19], 0 offen offset:196 sc1
    s_mov_b64 exec, -1
L_cnt_111:
    s_add_u32 s39, s39, 96
    s_load_dwordx2 s[4:5], s[0:1], 96
    s_load_dwordx2 s[6:7], s[0:1], 104
    v_and_b32 v14, 7, v0
    v_lshrrev_b32 v15, 3, v0
    s_waitcnt lgkmcnt(0)
    s_mov_b32 s32, s4
    s_and_b32 s33, s5, 0xffff
    s_mov_b32 s34, 0x800
    s_mov_b32 s35, 0x00020000
    s_mov_b32 s24, s6
    s_and_b32 s25, s7, 0xffff
    s_mov_b32 s26, 0xc00000
    s_mov_b32 s27, 0x00020000
    s_and_b32 s47, s39, 1
    s_lshl_b32 s45, s47, 10
    v_lshlrev_b32 v16, 5, v15
    buffer_load_dwordx4 v[104:107], v16, s[32:35], s45 offen
    buffer_load_dwordx4 v[108:111], v16, s[32:35], s45 offen offset:16
    s_mov_b32 s45, 196608
    v_mul_lo_u32 v17, v15, s45
    v_lshlrev_b32 v18, 4, v14
    v_add_u32 v17, v17, v18
    s_lshr_b32 s46, s39, 1
    s_lshl_b32 s46, s46, 7
    s_mul_i32 s45, s47, 6291456
    s_add_u32 s46, s46, s45
    buffer_load_dwordx4 v[32:35], v17, s[24:27], s46 offen
    v_add_u32 v17, 12288, v17
    buffer_load_dwordx4 v[36:39], v17, s[24:27], s46 offen
    v_add_u32 v17, 12288, v17
    buffer_load_dwordx4 v[40:43], v17, s[24:27], s46 offen
    v_add_u32 v17, 12288, v17
    buffer_load_dwordx4 v[44:47], v17, s[24:27], s46 offen
    v_add_u32 v17, 12288, v17
    buffer_load_dwordx4 v[48:51], v17, s[24:27], s46 offen
    v_add_u32 v17, 12288, v17
    buffer_load_dwordx4 v[52:55], v17, s[24:27], s46 offen
    v_add_u32 v17, 12288, v17
    buffer_load_dwordx4 v[56:59], v17, s[24:27], s46 offen
    v_add_u32 v17, 12288, v17
    buffer_load_dwordx4 v[60:63], v17, s[24:27], s46 offen
    v_add_u32 v17, 12288, v17
    buffer_load_dwordx4 v[64:67], v17, s[24:27], s46 offen
    v_add_u32 v17, 12288, v17
    buffer_load_dwordx4 v[68:71], v17, s[24:27], s46 offen
    v_add_u32 v17, 12288, v17
    buffer_load_dwordx4 v[72:75], v17, s[24:27], s46 offen
    v_add_u32 v17, 12288, v17
    buffer_load_dwordx4 v[76:79], v17, s[24:27], s46 offen
    v_add_u32 v17, 12288, v17
    buffer_load_dwordx4 v[80:83], v17, s[24:27], s46 offen
    v_add_u32 v17, 12288, v17
    buffer_load_dwordx4 v[84:87], v17, s[24:27], s46 offen
    v_add_u32 v17, 12288, v17
    buffer_load_dwordx4 v[88:91], v17, s[24:27], s46 offen
    v_add_u32 v17, 12288, v17
    buffer_load_dwordx4 v[92:95], v17, s[24:27], s46 offen
    s_waitcnt vmcnt(16)
    v_lshlrev_b32 v112, 16, v104
    v_and_b32 v113, 0xffff0000, v104
    v_lshlrev_b32 v114, 16, v105
    v_and_b32 v115, 0xffff0000, v105
    v_lshlrev_b32 v116, 16, v106
    v_and_b32 v117, 0xffff0000, v106
    v_lshlrev_b32 v118, 16, v107
    v_and_b32 v119, 0xffff0000, v107
    v_lshlrev_b32 v120, 16, v108
    v_and_b32 v121, 0xffff0000, v108
    v_lshlrev_b32 v122, 16, v109
    v_and_b32 v123, 0xffff0000, v109
    v_lshlrev_b32 v124, 16, v110
    v_and_b32 v125, 0xffff0000, v110
    v_lshlrev_b32 v126, 16, v111
    v_and_b32 v127, 0xffff0000, v111
    v_mul_f32 v18, 0xbfb8aa3b, v112
    v_exp_f32 v18, v18
    s_nop 0
    v_add_f32 v18, 1.0, v18
    v_rcp_f32 v18, v18
    s_nop 0
    v_mul_f32 v112, v112, v18
    v_cvt_pk_bf16_f32 v112, v112, v112
    v_lshlrev_b32 v112, 16, v112
    v_mul_f32 v18, 0xbfb8aa3b, v113
    v_exp_f32 v18, v18
    s_nop 0
    v_add_f32 v18, 1.0, v18
    v_rcp_f32 v18, v18
    s_nop 0
    v_mul_f32 v113, v113, v18
    v_cvt_pk_bf16_f32 v113, v113, v113
    v_lshlrev_b32 v113, 16, v113
    v_mul_f32 v18, 0xbfb8aa3b, v114
    v_exp_f32 v18, v18
    s_nop 0
    v_add_f32 v18, 1.0, v18
    v_rcp_f32 v18, v18
    s_nop 0
    v_mul_f32 v114, v114, v18
    v_cvt_pk_bf16_f32 v114, v114, v114
    v_lshlrev_b32 v114, 16, v114
    v_mul_f32 v18, 0xbfb8aa3b, v115
    v_exp_f32 v18, v18
    s_nop 0
    v_add_f32 v18, 1.0, v18
    v_rcp_f32 v18, v18
    s_nop 0
    v_mul_f32 v115, v115, v18
    v_cvt_pk_bf16_f32 v115, v115, v115
    v_lshlrev_b32 v115, 16, v115
    v_mul_f32 v18, 0xbfb8aa3b, v116
    v_exp_f32 v18, v18
    s_nop 0
    v_add_f32 v18, 1.0, v18
    v_rcp_f32 v18, v18
    s_nop 0
    v_mul_f32 v116, v116, v18
    v_cvt_pk_bf16_f32 v116, v116, v116
    v_lshlrev_b32 v116, 16, v116
    v_mul_f32 v18, 0xbfb8aa3b, v117
    v_exp_f32 v18, v18
    s_nop 0
    v_add_f32 v18, 1.0, v18
    v_rcp_f32 v18, v18
    s_nop 0
    v_mul_f32 v117, v117, v18
    v_cvt_pk_bf16_f32 v117, v117, v117
    v_lshlrev_b32 v117, 16, v117
    v_mul_f32 v18, 0xbfb8aa3b, v118
    v_exp_f32 v18, v18
    s_nop 0
    v_add_f32 v18, 1.0, v18
    v_rcp_f32 v18, v18
    s_nop 0
    v_mul_f32 v118, v118, v18
    v_cvt_pk_bf16_f32 v118, v118, v118
    v_lshlrev_b32 v118, 16, v118
    v_mul_f32 v18, 0xbfb8aa3b, v119
    v_exp_f32 v18, v18
    s_nop 0
    v_add_f32 v18, 1.0, v18
    v_rcp_f32 v18, v18
    s_nop 0
    v_mul_f32 v119, v119, v18
    v_cvt_pk_bf16_f32 v119, v119, v119
    v_lshlrev_b32 v119, 16, v119
    v_mul_f32 v18, 0xbfb8aa3b, v120
    v_exp_f32 v18, v18
    s_nop 0
    v_add_f32 v18, 1.0, v18
    v_rcp_f32 v18, v18
    s_nop 0
    v_mul_f32 v120, v120, v18
    v_cvt_pk_bf16_f32 v120, v120, v120
    v_lshlrev_b32 v120, 16, v120
    v_mul_f32 v18, 0xbfb8aa3b, v121
    v_exp_f32 v18, v18
    s_nop 0
    v_add_f32 v18, 1.0, v18
    v_rcp_f32 v18, v18
    s_nop 0
    v_mul_f32 v121, v121, v18
    v_cvt_pk_bf16_f32 v121, v121, v121
    v_lshlrev_b32 v121, 16, v121
    v_mul_f32 v18, 0xbfb8aa3b, v122
    v_exp_f32 v18, v18
    s_nop 0
    v_add_f32 v18, 1.0, v18
    v_rcp_f32 v18, v18
    s_nop 0
    v_mul_f32 v122, v122, v18
    v_cvt_pk_bf16_f32 v122, v122, v122
    v_lshlrev_b32 v122, 16, v122
    v_mul_f32 v18, 0xbfb8aa3b, v123
    v_exp_f32 v18, v18
    s_nop 0
    v_add_f32 v18, 1.0, v18
    v_rcp_f32 v18, v18
    s_nop 0
    v_mul_f32 v123, v123, v18
    v_cvt_pk_bf16_f32 v123, v123, v123
    v_lshlrev_b32 v123, 16, v123
    v_mul_f32 v18, 0xbfb8aa3b, v124
    v_exp_f32 v18, v18
    s_nop 0
    v_add_f32 v18, 1.0, v18
    v_rcp_f32 v18, v18
    s_nop 0
    v_mul_f32 v124, v124, v18
    v_cvt_pk_bf16_f32 v124, v124, v124
    v_lshlrev_b32 v124, 16, v124
    v_mul_f32 v18, 0xbfb8aa3b, v125
    v_exp_f32 v18, v18
    s_nop 0
    v_add_f32 v18, 1.0, v18
    v_rcp_f32 v18, v18
    s_nop 0
    v_mul_f32 v125, v125, v18
    v_cvt_pk_bf16_f32 v125, v125, v125
    v_lshlrev_b32 v125, 16, v125
    v_mul_f32 v18, 0xbfb8aa3b, v126
    v_exp_f32 v18, v18
    s_nop 0
    v_add_f32 v18, 1.0, v18
    v_rcp_f32 v18, v18
    s_nop 0
    v_mul_f32 v126, v126, v18
    v_cvt_pk_bf16_f32 v126, v126, v126
    v_lshlrev_b32 v126, 16, v126
    v_mul_f32 v18, 0xbfb8aa3b, v127
    v_exp_f32 v18, v18
    s_nop 0
    v_add_f32 v18, 1.0, v18
    v_rcp_f32 v18, v18
    s_nop 0
    v_mul_f32 v127, v127, v18
    v_cvt_pk_bf16_f32 v127, v127, v127
    v_lshlrev_b32 v127, 16, v127
    v_mov_b32 v96, 0
    v_mov_b32 v97, 0
    v_mov_b32 v98, 0
    v_mov_b32 v99, 0
    v_mov_b32 v100, 0
    v_mov_b32 v101, 0
    v_mov_b32 v102, 0
    v_mov_b32 v103, 0
    s_waitcnt vmcnt(15)
    v_lshlrev_b32 v18, 16, v32
    v_and_b32 v19, 0xffff0000, v32
    v_fmac_f32 v96, v18, v112
    v_fmac_f32 v97, v19, v112
    v_lshlrev_b32 v18, 16, v33
    v_and_b32 v19, 0xffff0000, v33
    v_fmac_f32 v98, v18, v112
    v_fmac_f32 v99, v19, v112
    v_lshlrev_b32 v18, 16, v34
    v_and_b32 v19, 0xffff0000, v34
    v_fmac_f32 v100, v18, v112
    v_fmac_f32 v101, v19, v112
    v_lshlrev_b32 v18, 16, v35
    v_and_b32 v19, 0xffff0000, v35
    v_fmac_f32 v102, v18, v112
    v_fmac_f32 v103, v19, v112
    s_waitcnt vmcnt(14)
    v_lshlrev_b32 v18, 16, v36
    v_and_b32 v19, 0xffff0000, v36
    v_fmac_f32 v96, v18, v113
    v_fmac_f32 v97, v19, v113
    v_lshlrev_b32 v18, 16, v37
    v_and_b32 v19, 0xffff0000, v37
    v_fmac_f32 v98, v18, v113
    v_fmac_f32 v99, v19, v113
    v_lshlrev_b32 v18, 16, v38
    v_and_b32 v19, 0xffff0000, v38
    v_fmac_f32 v100, v18, v113
    v_fmac_f32 v101, v19, v113
    v_lshlrev_b32 v18, 16, v39
    v_and_b32 v19, 0xffff0000, v39
    v_fmac_f32 v102, v18, v113
    v_fmac_f32 v103, v19, v113
    s_waitcnt vmcnt(13)
    v_lshlrev_b32 v18, 16, v40
    v_and_b32 v19, 0xffff0000, v40
    v_fmac_f32 v96, v18, v114
    v_fmac_f32 v97, v19, v114
    v_lshlrev_b32 v18, 16, v41
    v_and_b32 v19, 0xffff0000, v41
    v_fmac_f32 v98, v18, v114
    v_fmac_f32 v99, v19, v114
    v_lshlrev_b32 v18, 16, v42
    v_and_b32 v19, 0xffff0000, v42
    v_fmac_f32 v100, v18, v114
    v_fmac_f32 v101, v19, v114
    v_lshlrev_b32 v18, 16, v43
    v_and_b32 v19, 0xffff0000, v43
    v_fmac_f32 v102, v18, v114
    v_fmac_f32 v103, v19, v114
    s_waitcnt vmcnt(12)
    v_lshlrev_b32 v18, 16, v44
    v_and_b32 v19, 0xffff0000, v44
    v_fmac_f32 v96, v18, v115
    v_fmac_f32 v97, v19, v115
    v_lshlrev_b32 v18, 16, v45
    v_and_b32 v19, 0xffff0000, v45
    v_fmac_f32 v98, v18, v115
    v_fmac_f32 v99, v19, v115
    v_lshlrev_b32 v18, 16, v46
    v_and_b32 v19, 0xffff0000, v46
    v_fmac_f32 v100, v18, v115
    v_fmac_f32 v101, v19, v115
    v_lshlrev_b32 v18, 16, v47
    v_and_b32 v19, 0xffff0000, v47
    v_fmac_f32 v102, v18, v115
    v_fmac_f32 v103, v19, v115
    s_waitcnt vmcnt(11)
    v_lshlrev_b32 v18, 16, v48
    v_and_b32 v19, 0xffff0000, v48
    v_fmac_f32 v96, v18, v116
    v_fmac_f32 v97, v19, v116
    v_lshlrev_b32 v18, 16, v49
    v_and_b32 v19, 0xffff0000, v49
    v_fmac_f32 v98, v18, v116
    v_fmac_f32 v99, v19, v116
    v_lshlrev_b32 v18, 16, v50
    v_and_b32 v19, 0xffff0000, v50
    v_fmac_f32 v100, v18, v116
    v_fmac_f32 v101, v19, v116
    v_lshlrev_b32 v18, 16, v51
    v_and_b32 v19, 0xffff0000, v51
    v_fmac_f32 v102, v18, v116
    v_fmac_f32 v103, v19, v116
    s_waitcnt vmcnt(10)
    v_lshlrev_b32 v18, 16, v52
    v_and_b32 v19, 0xffff0000, v52
    v_fmac_f32 v96, v18, v117
    v_fmac_f32 v97, v19, v117
    v_lshlrev_b32 v18, 16, v53
    v_and_b32 v19, 0xffff0000, v53
    v_fmac_f32 v98, v18, v117
    v_fmac_f32 v99, v19, v117
    v_lshlrev_b32 v18, 16, v54
    v_and_b32 v19, 0xffff0000, v54
    v_fmac_f32 v100, v18, v117
    v_fmac_f32 v101, v19, v117
    v_lshlrev_b32 v18, 16, v55
    v_and_b32 v19, 0xffff0000, v55
    v_fmac_f32 v102, v18, v117
    v_fmac_f32 v103, v19, v117
    s_waitcnt vmcnt(9)
    v_lshlrev_b32 v18, 16, v56
    v_and_b32 v19, 0xffff0000, v56
    v_fmac_f32 v96, v18, v118
    v_fmac_f32 v97, v19, v118
    v_lshlrev_b32 v18, 16, v57
    v_and_b32 v19, 0xffff0000, v57
    v_fmac_f32 v98, v18, v118
    v_fmac_f32 v99, v19, v118
    v_lshlrev_b32 v18, 16, v58
    v_and_b32 v19, 0xffff0000, v58
    v_fmac_f32 v100, v18, v118
    v_fmac_f32 v101, v19, v118
    v_lshlrev_b32 v18, 16, v59
    v_and_b32 v19, 0xffff0000, v59
    v_fmac_f32 v102, v18, v118
    v_fmac_f32 v103, v19, v118
    s_waitcnt vmcnt(8)
    v_lshlrev_b32 v18, 16, v60
    v_and_b32 v19, 0xffff0000, v60
    v_fmac_f32 v96, v18, v119
    v_fmac_f32 v97, v19, v119
    v_lshlrev_b32 v18, 16, v61
    v_and_b32 v19, 0xffff0000, v61
    v_fmac_f32 v98, v18, v119
    v_fmac_f32 v99, v19, v119
    v_lshlrev_b32 v18, 16, v62
    v_and_b32 v19, 0xffff0000, v62
    v_fmac_f32 v100, v18, v119
    v_fmac_f32 v101, v19, v119
    v_lshlrev_b32 v18, 16, v63
    v_and_b32 v19, 0xffff0000, v63
    v_fmac_f32 v102, v18, v119
    v_fmac_f32 v103, v19, v119
    s_waitcnt vmcnt(7)
    v_lshlrev_b32 v18, 16, v64
    v_and_b32 v19, 0xffff0000, v64
    v_fmac_f32 v96, v18, v120
    v_fmac_f32 v97, v19, v120
    v_lshlrev_b32 v18, 16, v65
    v_and_b32 v19, 0xffff0000, v65
    v_fmac_f32 v98, v18, v120
    v_fmac_f32 v99, v19, v120
    v_lshlrev_b32 v18, 16, v66
    v_and_b32 v19, 0xffff0000, v66
    v_fmac_f32 v100, v18, v120
    v_fmac_f32 v101, v19, v120
    v_lshlrev_b32 v18, 16, v67
    v_and_b32 v19, 0xffff0000, v67
    v_fmac_f32 v102, v18, v120
    v_fmac_f32 v103, v19, v120
    s_waitcnt vmcnt(6)
    v_lshlrev_b32 v18, 16, v68
    v_and_b32 v19, 0xffff0000, v68
    v_fmac_f32 v96, v18, v121
    v_fmac_f32 v97, v19, v121
    v_lshlrev_b32 v18, 16, v69
    v_and_b32 v19, 0xffff0000, v69
    v_fmac_f32 v98, v18, v121
    v_fmac_f32 v99, v19, v121
    v_lshlrev_b32 v18, 16, v70
    v_and_b32 v19, 0xffff0000, v70
    v_fmac_f32 v100, v18, v121
    v_fmac_f32 v101, v19, v121
    v_lshlrev_b32 v18, 16, v71
    v_and_b32 v19, 0xffff0000, v71
    v_fmac_f32 v102, v18, v121
    v_fmac_f32 v103, v19, v121
    s_waitcnt vmcnt(5)
    v_lshlrev_b32 v18, 16, v72
    v_and_b32 v19, 0xffff0000, v72
    v_fmac_f32 v96, v18, v122
    v_fmac_f32 v97, v19, v122
    v_lshlrev_b32 v18, 16, v73
    v_and_b32 v19, 0xffff0000, v73
    v_fmac_f32 v98, v18, v122
    v_fmac_f32 v99, v19, v122
    v_lshlrev_b32 v18, 16, v74
    v_and_b32 v19, 0xffff0000, v74
    v_fmac_f32 v100, v18, v122
    v_fmac_f32 v101, v19, v122
    v_lshlrev_b32 v18, 16, v75
    v_and_b32 v19, 0xffff0000, v75
    v_fmac_f32 v102, v18, v122
    v_fmac_f32 v103, v19, v122
    s_waitcnt vmcnt(4)
    v_lshlrev_b32 v18, 16, v76
    v_and_b32 v19, 0xffff0000, v76
    v_fmac_f32 v96, v18, v123
    v_fmac_f32 v97, v19, v123
    v_lshlrev_b32 v18, 16, v77
    v_and_b32 v19, 0xffff0000, v77
    v_fmac_f32 v98, v18, v123
    v_fmac_f32 v99, v19, v123
    v_lshlrev_b32 v18, 16, v78
    v_and_b32 v19, 0xffff0000, v78
    v_fmac_f32 v100, v18, v123
    v_fmac_f32 v101, v19, v123
    v_lshlrev_b32 v18, 16, v79
    v_and_b32 v19, 0xffff0000, v79
    v_fmac_f32 v102, v18, v123
    v_fmac_f32 v103, v19, v123
    s_waitcnt vmcnt(3)
    v_lshlrev_b32 v18, 16, v80
    v_and_b32 v19, 0xffff0000, v80
    v_fmac_f32 v96, v18, v124
    v_fmac_f32 v97, v19, v124
    v_lshlrev_b32 v18, 16, v81
    v_and_b32 v19, 0xffff0000, v81
    v_fmac_f32 v98, v18, v124
    v_fmac_f32 v99, v19, v124
    v_lshlrev_b32 v18, 16, v82
    v_and_b32 v19, 0xffff0000, v82
    v_fmac_f32 v100, v18, v124
    v_fmac_f32 v101, v19, v124
    v_lshlrev_b32 v18, 16, v83
    v_and_b32 v19, 0xffff0000, v83
    v_fmac_f32 v102, v18, v124
    v_fmac_f32 v103, v19, v124
    s_waitcnt vmcnt(2)
    v_lshlrev_b32 v18, 16, v84
    v_and_b32 v19, 0xffff0000, v84
    v_fmac_f32 v96, v18, v125
    v_fmac_f32 v97, v19, v125
    v_lshlrev_b32 v18, 16, v85
    v_and_b32 v19, 0xffff0000, v85
    v_fmac_f32 v98, v18, v125
    v_fmac_f32 v99, v19, v125
    v_lshlrev_b32 v18, 16, v86
    v_and_b32 v19, 0xffff0000, v86
    v_fmac_f32 v100, v18, v125
    v_fmac_f32 v101, v19, v125
    v_lshlrev_b32 v18, 16, v87
    v_and_b32 v19, 0xffff0000, v87
    v_fmac_f32 v102, v18, v125
    v_fmac_f32 v103, v19, v125
    s_waitcnt vmcnt(1)
    v_lshlrev_b32 v18, 16, v88
    v_and_b32 v19, 0xffff0000, v88
    v_fmac_f32 v96, v18, v126
    v_fmac_f32 v97, v19, v126
    v_lshlrev_b32 v18, 16, v89
    v_and_b32 v19, 0xffff0000, v89
    v_fmac_f32 v98, v18, v126
    v_fmac_f32 v99, v19, v126
    v_lshlrev_b32 v18, 16, v90
    v_and_b32 v19, 0xffff0000, v90
    v_fmac_f32 v100, v18, v126
    v_fmac_f32 v101, v19, v126
    v_lshlrev_b32 v18, 16, v91
    v_and_b32 v19, 0xffff0000, v91
    v_fmac_f32 v102, v18, v126
    v_fmac_f32 v103, v19, v126
    s_waitcnt vmcnt(0)
    v_lshlrev_b32 v18, 16, v92
    v_and_b32 v19, 0xffff0000, v92
    v_fmac_f32 v96, v18, v127
    v_fmac_f32 v97, v19, v127
    v_lshlrev_b32 v18, 16, v93
    v_and_b32 v19, 0xffff0000, v93
    v_fmac_f32 v98, v18, v127
    v_fmac_f32 v99, v19, v127
    v_lshlrev_b32 v18, 16, v94
    v_and_b32 v19, 0xffff0000, v94
    v_fmac_f32 v100, v18, v127
    v_fmac_f32 v101, v19, v127
    v_lshlrev_b32 v18, 16, v95
    v_and_b32 v19, 0xffff0000, v95
    v_fmac_f32 v102, v18, v127
    v_fmac_f32 v103, v19, v127
    v_lshlrev_b32 v16, 5, v0
    ds_write_b128 v16, v[96:99]
    ds_write_b128 v16, v[100:103] offset:16
    s_waitcnt lgkmcnt(0)
    s_barrier
    s_cmp_lg_u32 s44, 0
    s_cbranch_scc1 L_mod_fin_112
    v_mov_b32 v18, 0
    ds_read_b32 v32, v12 offset:0
    ds_read_b32 v33, v12 offset:256
    ds_read_b32 v34, v12 offset:512
    ds_read_b32 v35, v12 offset:768
    ds_read_b32 v36, v12 offset:1024
    ds_read_b32 v37, v12 offset:1280
    ds_read_b32 v38, v12 offset:1536
    ds_read_b32 v39, v12 offset:1792
    ds_read_b32 v40, v12 offset:2048
    ds_read_b32 v41, v12 offset:2304
    ds_read_b32 v42, v12 offset:2560
    ds_read_b32 v43, v12 offset:2816
    ds_read_b32 v44, v12 offset:3072
    ds_read_b32 v45, v12 offset:3328
    ds_read_b32 v46, v12 offset:3584
    ds_read_b32 v47, v12 offset:3840
    s_waitcnt lgkmcnt(0)
    v_add_f32 v18, v18, v32
    v_add_f32 v18, v18, v33
    v_add_f32 v18, v18, v34
    v_add_f32 v18, v18, v35
    v_add_f32 v18, v18, v36
    v_add_f32 v18, v18, v37
    v_add_f32 v18, v18, v38
    v_add_f32 v18, v18, v39
    v_add_f32 v18, v18, v40
    v_add_f32 v18, v18, v41
    v_add_f32 v18, v18, v42
    v_add_f32 v18, v18, v43
    v_add_f32 v18, v18, v44
    v_add_f32 v18, v18, v45
    v_add_f32 v18, v18, v46
    v_add_f32 v18, v18, v47
    ds_read_b32 v32, v12 offset:4096
    ds_read_b32 v33, v12 offset:4352
    ds_read_b32 v34, v12 offset:4608
    ds_read_b32 v35, v12 offset:4864
    ds_read_b32 v36, v12 offset:5120
    ds_read_b32 v37, v12 offset:5376
    ds_read_b32 v38, v12 offset:5632
    ds_read_b32 v39, v12 offset:5888
    ds_read_b32 v40, v12 offset:6144
    ds_read_b32 v41, v12 offset:6400
    ds_read_b32 v42, v12 offset:6656
    ds_read_b32 v43, v12 offset:6912
    ds_read_b32 v44, v12 offset:7168
    ds_read_b32 v45, v12 offset:7424
    ds_read_b32 v46, v12 offset:7680
    ds_read_b32 v47, v12 offset:7936
    s_waitcnt lgkmcnt(0)
    v_add_f32 v18, v18, v32
    v_add_f32 v18, v18, v33
    v_add_f32 v18, v18, v34
    v_add_f32 v18, v18, v35
    v_add_f32 v18, v18, v36
    v_add_f32 v18, v18, v37
    v_add_f32 v18, v18, v38
    v_add_f32 v18, v18, v39
    v_add_f32 v18, v18, v40
    v_add_f32 v18, v18, v41
    v_add_f32 v18, v18, v42
    v_add_f32 v18, v18, v43
    v_add_f32 v18, v18, v44
    v_add_f32 v18, v18, v45
    v_add_f32 v18, v18, v46
    v_add_f32 v18, v18, v47
    s_lshr_b32 s45, s39, 1
    s_lshl_b32 s45, s45, 8
    s_mul_i32 s46, s47, 24576
    s_add_u32 s45, s45, s46
    buffer_store_dword v18, v12, s[12:15], s45 offen sc1
L_mod_fin_112:
    s_waitcnt vmcnt(0)
    s_barrier
    s_cmp_lg_u32 s44, 0
    s_cbranch_scc1 L_cnt_113
    v_mov_b32 v30, 1
    v_mov_b32 v31, 0
    s_mov_b64 exec, 1
    buffer_atomic_add v30, v31, s[16:19], 0 offen offset:132 sc1
    s_mov_b64 exec, -1
L_cnt_113:
    s_branch L_w_roles_104
L_w_kv_103:
    s_lshl_b32 s45, s43, 3
    s_add_u32 s45, s45, 16
    s_load_dwordx2 s[6:7], s[0:1], s45
    s_waitcnt lgkmcnt(0)
    s_mov_b32 s24, s6
    s_and_b32 s25, s7, 0xffff
    s_mov_b32 s26, 0x800000
    s_mov_b32 s27, 0x00020000
    s_lshl_b32 s46, s41, 8
    s_barrier
    v_lshrrev_b32 v20, 4, v1
    s_lshl_b32 s45, s44, 2
    v_add_u32 v21, s45, v20
    s_mov_b32 s45, 8192
    v_mul_lo_u32 v21, v21, s45
    v_lshlrev_b32 v22, 2, v20
    v_and_b32 v23, 15, v1
    v_xor_b32 v22, v22, v23
    v_lshlrev_b32 v22, 4, v22
    v_add_u32 v21, v21, v22
    v_bfe_u32 v22, v1, 2, 2
    v_lshlrev_b32 v23, 3, v20
    v_add_u32 v23, v23, v22
    v_lshlrev_b32 v23, 8, v23
    v_xor_b32 v22, s44, v22
    v_lshlrev_b32 v22, 6, v22
    v_add_u32 v23, v23, v22
    v_and_b32 v22, 3, v1
    v_lshlrev_b32 v22, 4, v22
    v_add_u32 v23, v23, v22
    v_add_u32 v24, 65536, v23
    v_add_u32 v25, 131072, v23
    s_lshl_b32 s47, s44, 10
    s_add_u32 s45, s46, 0x0
    s_add_u32 m0, s47, 0
    s_nop 0
    buffer_load_dwordx4 v21, s[24:27], s45 offen  lds
    s_add_u32 s45, s46, 0x20000
    s_add_u32 m0, s47, 4096
    s_nop 0
    buffer_load_dwordx4 v21, s[24:27], s45 offen  lds
    s_add_u32 s45, s46, 0x40000
    s_add_u32 m0, s47, 8192
    s_nop 0
    buffer_load_dwordx4 v21, s[24:27], s45 offen  lds
    s_add_u32 s45, s46, 0x60000
    s_add_u32 m0, s47, 12288
    s_nop 0
    buffer_load_dwordx4 v21, s[24:27], s45 offen  lds
    s_add_u32 s45, s46, 0x80000
    s_add_u32 m0, s47, 16384
    s_nop 0
    buffer_load_dwordx4 v21, s[24:27], s45 offen  lds
    s_add_u32 s45, s46, 0xa0000
    s_add_u32 m0, s47, 20480
    s_nop 0
    buffer_load_dwordx4 v21, s[24:27], s45 offen  lds
    s_add_u32 s45, s46, 0xc0000
    s_add_u32 m0, s47, 24576
    s_nop 0
    buffer_load_dwordx4 v21, s[24:27], s45 offen  lds
    s_add_u32 s45, s46, 0xe0000
    s_add_u32 m0, s47, 28672
    s_nop 0
    buffer_load_dwordx4 v21, s[24:27], s45 offen  lds
    s_add_u32 s45, s46, 0x100000
    s_add_u32 m0, s47, 32768
    s_nop 0
    buffer_load_dwordx4 v21, s[24:27], s45 offen  lds
    s_add_u32 s45, s46, 0x120000
    s_add_u32 m0, s47, 36864
    s_nop 0
    buffer_load_dwordx4 v21, s[24:27], s45 offen  lds
    s_add_u32 s45, s46, 0x140000
    s_add_u32 m0, s47, 40960
    s_nop 0
    buffer_load_dwordx4 v21, s[24:27], s45 offen  lds
    s_add_u32 s45, s46, 0x160000
    s_add_u32 m0, s47, 45056
    s_nop 0
    buffer_load_dwordx4 v21, s[24:27], s45 offen  lds
    s_add_u32 s45, s46, 0x180000
    s_add_u32 m0, s47, 49152
    s_nop 0
    buffer_load_dwordx4 v21, s[24:27], s45 offen  lds
    s_add_u32 s45, s46, 0x1a0000
    s_add_u32 m0, s47, 53248
    s_nop 0
    buffer_load_dwordx4 v21, s[24:27], s45 offen  lds
    s_add_u32 s45, s46, 0x1c0000
    s_add_u32 m0, s47, 57344
    s_nop 0
    buffer_load_dwordx4 v21, s[24:27], s45 offen  lds
    s_add_u32 s45, s46, 0x1e0000
    s_add_u32 m0, s47, 61440
    s_nop 0
    buffer_load_dwordx4 v21, s[24:27], s45 offen  lds
    s_add_u32 s45, s46, 0x200000
    s_add_u32 m0, s47, 65536
    s_nop 0
    buffer_load_dwordx4 v21, s[24:27], s45 offen  lds
    s_add_u32 s45, s46, 0x220000
    s_add_u32 m0, s47, 69632
    s_nop 0
    buffer_load_dwordx4 v21, s[24:27], s45 offen  lds
    s_add_u32 s45, s46, 0x240000
    s_add_u32 m0, s47, 73728
    s_nop 0
    buffer_load_dwordx4 v21, s[24:27], s45 offen  lds
    s_add_u32 s45, s46, 0x260000
    s_add_u32 m0, s47, 77824
    s_nop 0
    buffer_load_dwordx4 v21, s[24:27], s45 offen  lds
    s_add_u32 s45, s46, 0x280000
    s_add_u32 m0, s47, 81920
    s_nop 0
    buffer_load_dwordx4 v21, s[24:27], s45 offen  lds
    s_add_u32 s45, s46, 0x2a0000
    s_add_u32 m0, s47, 86016
    s_nop 0
    buffer_load_dwordx4 v21, s[24:27], s45 offen  lds
    s_add_u32 s45, s46, 0x2c0000
    s_add_u32 m0, s47, 90112
    s_nop 0
    buffer_load_dwordx4 v21, s[24:27], s45 offen  lds
    s_add_u32 s45, s46, 0x2e0000
    s_add_u32 m0, s47, 94208
    s_nop 0
    buffer_load_dwordx4 v21, s[24:27], s45 offen  lds
    s_add_u32 s45, s46, 0x300000
    s_add_u32 m0, s47, 98304
    s_nop 0
    buffer_load_dwordx4 v21, s[24:27], s45 offen  lds
    s_add_u32 s45, s46, 0x320000
    s_add_u32 m0, s47, 102400
    s_nop 0
    buffer_load_dwordx4 v21, s[24:27], s45 offen  lds
    s_add_u32 s45, s46, 0x340000
    s_add_u32 m0, s47, 106496
    s_nop 0
    buffer_load_dwordx4 v21, s[24:27], s45 offen  lds
    s_add_u32 s45, s46, 0x360000
    s_add_u32 m0, s47, 110592
    s_nop 0
    buffer_load_dwordx4 v21, s[24:27], s45 offen  lds
    s_add_u32 s45, s46, 0x380000
    s_add_u32 m0, s47, 114688
    s_nop 0
    buffer_load_dwordx4 v21, s[24:27], s45 offen  lds
    s_add_u32 s45, s46, 0x3a0000
    s_add_u32 m0, s47, 118784
    s_nop 0
    buffer_load_dwordx4 v21, s[24:27], s45 offen  lds
    s_add_u32 s45, s46, 0x3c0000
    s_add_u32 m0, s47, 122880
    s_nop 0
    buffer_load_dwordx4 v21, s[24:27], s45 offen  lds
    s_add_u32 s45, s46, 0x3e0000
    s_add_u32 m0, s47, 126976
    s_nop 0
    buffer_load_dwordx4 v21, s[24:27], s45 offen  lds
    s_waitcnt vmcnt(28)
    s_barrier
    s_add_u32 s45, s46, 0x400000
    s_add_u32 m0, s47, 131072
    s_nop 0
    buffer_load_dwordx4 v21, s[24:27], s45 offen  lds
    s_add_u32 s45, s46, 0x420000
    s_add_u32 m0, s47, 135168
    s_nop 0
    buffer_load_dwordx4 v21, s[24:27], s45 offen  lds
    s_add_u32 s45, s46, 0x440000
    s_add_u32 m0, s47, 139264
    s_nop 0
    buffer_load_dwordx4 v21, s[24:27], s45 offen  lds
    s_add_u32 s45, s46, 0x460000
    s_add_u32 m0, s47, 143360
    s_nop 0
    buffer_load_dwordx4 v21, s[24:27], s45 offen  lds
    ds_read_b64_tr_b16 a[0:1], v23 offset:0
    ds_read_b64_tr_b16 a[2:3], v23 offset:1024
    ds_read_b64_tr_b16 a[4:5], v23 offset:8
    ds_read_b64_tr_b16 a[6:7], v23 offset:1032
    ds_read_b64_tr_b16 a[8:9], v23 offset:8192
    ds_read_b64_tr_b16 a[10:11], v23 offset:9216
    ds_read_b64_tr_b16 a[12:13], v23 offset:8200
    ds_read_b64_tr_b16 a[14:15], v23 offset:9224
    s_waitcnt lgkmcnt(0)
    s_waitcnt vmcnt(28)
    s_barrier
    s_add_u32 s45, s46, 0x480000
    s_add_u32 m0, s47, 0
    s_nop 0
    buffer_load_dwordx4 v21, s[24:27], s45 offen  lds
    s_add_u32 s45, s46, 0x4a0000
    s_add_u32 m0, s47, 4096
    s_nop 0
    buffer_load_dwordx4 v21, s[24:27], s45 offen  lds
    s_add_u32 s45, s46, 0x4c0000
    s_add_u32 m0, s47, 8192
    s_nop 0
    buffer_load_dwordx4 v21, s[24:27], s45 offen  lds
    s_add_u32 s45, s46, 0x4e0000
    s_add_u32 m0, s47, 12288
    s_nop 0
    buffer_load_dwordx4 v21, s[24:27], s45 offen  lds
    ds_read_b64_tr_b16 a[16:17], v23 offset:16384
    ds_read_b64_tr_b16 a[18:19], v23 offset:17408
    ds_read_b64_tr_b16 a[20:21], v23 offset:16392
    ds_read_b64_tr_b16 a[22:23], v23 offset:17416
    ds_read_b64_tr_b16 a[24:25], v23 offset:24576
    ds_read_b64_tr_b16 a[26:27], v23 offset:25600
    ds_read_b64_tr_b16 a[28:29], v23 offset:24584
    ds_read_b64_tr_b16 a[30:31], v23 offset:25608
    s_waitcnt lgkmcnt(0)
    s_waitcnt vmcnt(28)
    s_barrier
    s_add_u32 s45, s46, 0x500000
    s_add_u32 m0, s47, 16384
    s_nop 0
    buffer_load_dwordx4 v21, s[24:27], s45 offen  lds
    s_add_u32 s45, s46, 0x520000
    s_add_u32 m0, s47, 20480
    s_nop 0
    buffer_load_dwordx4 v21, s[24:27], s45 offen  lds
    s_add_u32 s45, s46, 0x540000
    s_add_u32 m0, s47, 24576
    s_nop 0
    buffer_load_dwordx4 v21, s[24:27], s45 offen  lds
    s_add_u32 s45, s46, 0x560000
    s_add_u32 m0, s47, 28672
    s_nop 0
    buffer_load_dwordx4 v21, s[24:27], s45 offen  lds
    ds_read_b64_tr_b16 a[32:33], v23 offset:32768
    ds_read_b64_tr_b16 a[34:35], v23 offset:33792
    ds_read_b64_tr_b16 a[36:37], v23 offset:32776
    ds_read_b64_tr_b16 a[38:39], v23 offset:33800
    ds_read_b64_tr_b16 a[40:41], v23 offset:40960
    ds_read_b64_tr_b16 a[42:43], v23 offset:41984
    ds_read_b64_tr_b16 a[44:45], v23 offset:40968
    ds_read_b64_tr_b16 a[46:47], v23 offset:41992
    s_waitcnt lgkmcnt(0)
    s_waitcnt vmcnt(28)
    s_barrier
    s_add_u32 s45, s46, 0x580000
    s_add_u32 m0, s47, 32768
    s_nop 0
    buffer_load_dwordx4 v21, s[24:27], s45 offen  lds
    s_add_u32 s45, s46, 0x5a0000
    s_add_u32 m0, s47, 36864
    s_nop 0
    buffer_load_dwordx4 v21, s[24:27], s45 offen  lds
    s_add_u32 s45, s46, 0x5c0000
    s_add_u32 m0, s47, 40960
    s_nop 0
    buffer_load_dwordx4 v21, s[24:27], s45 offen  lds
    s_add_u32 s45, s46, 0x5e0000
    s_add_u32 m0, s47, 45056
    s_nop 0
    buffer_load_dwordx4 v21, s[24:27], s45 offen  lds
    ds_read_b64_tr_b16 a[48:49], v23 offset:49152
    ds_read_b64_tr_b16 a[50:51], v23 offset:50176
    ds_read_b64_tr_b16 a[52:53], v23 offset:49160
    ds_read_b64_tr_b16 a[54:55], v23 offset:50184
    ds_read_b64_tr_b16 a[56:57], v23 offset:57344
    ds_read_b64_tr_b16 a[58:59], v23 offset:58368
    ds_read_b64_tr_b16 a[60:61], v23 offset:57352
    ds_read_b64_tr_b16 a[62:63], v23 offset:58376
    s_waitcnt lgkmcnt(0)
    s_waitcnt vmcnt(28)
    s_barrier
    s_add_u32 s45, s46, 0x600000
    s_add_u32 m0, s47, 49152
    s_nop 0
    buffer_load_dwordx4 v21, s[24:27], s45 offen  lds
    s_add_u32 s45, s46, 0x620000
    s_add_u32 m0, s47, 53248
    s_nop 0
    buffer_load_dwordx4 v21, s[24:27], s45 offen  lds
    s_add_u32 s45, s46, 0x640000
    s_add_u32 m0, s47, 57344
    s_nop 0
    buffer_load_dwordx4 v21, s[24:27], s45 offen  lds
    s_add_u32 s45, s46, 0x660000
    s_add_u32 m0, s47, 61440
    s_nop 0
    buffer_load_dwordx4 v21, s[24:27], s45 offen  lds
    ds_read_b64_tr_b16 a[64:65], v24 offset:0
    ds_read_b64_tr_b16 a[66:67], v24 offset:1024
    ds_read_b64_tr_b16 a[68:69], v24 offset:8
    ds_read_b64_tr_b16 a[70:71], v24 offset:1032
    ds_read_b64_tr_b16 a[72:73], v24 offset:8192
    ds_read_b64_tr_b16 a[74:75], v24 offset:9216
    ds_read_b64_tr_b16 a[76:77], v24 offset:8200
    ds_read_b64_tr_b16 a[78:79], v24 offset:9224
    s_waitcnt lgkmcnt(0)
    s_waitcnt vmcnt(28)
    s_barrier
    s_add_u32 s45, s46, 0x680000
    s_add_u32 m0, s47, 65536
    s_nop 0
    buffer_load_dwordx4 v21, s[24:27], s45 offen  lds
    s_add_u32 s45, s46, 0x6a0000
    s_add_u32 m0, s47, 69632
    s_nop 0
    buffer_load_dwordx4 v21, s[24:27], s45 offen  lds
    s_add_u32 s45, s46, 0x6c0000
    s_add_u32 m0, s47, 73728
    s_nop 0
    buffer_load_dwordx4 v21, s[24:27], s45 offen  lds
    s_add_u32 s45, s46, 0x6e0000
    s_add_u32 m0, s47, 77824
    s_nop 0
    buffer_load_dwordx4 v21, s[24:27], s45 offen  lds
    ds_read_b64_tr_b16 a[80:81], v24 offset:16384
    ds_read_b64_tr_b16 a[82:83], v24 offset:17408
    ds_read_b64_tr_b16 a[84:85], v24 offset:16392
    ds_read_b64_tr_b16 a[86:87], v24 offset:17416
    ds_read_b64_tr_b16 a[88:89], v24 offset:24576
    ds_read_b64_tr_b16 a[90:91], v24 offset:25600
    ds_read_b64_tr_b16 a[92:93], v24 offset:24584
    ds_read_b64_tr_b16 a[94:95], v24 offset:25608
    s_waitcnt lgkmcnt(0)
    s_waitcnt vmcnt(28)
    s_barrier
    s_add_u32 s45, s46, 0x700000
    s_add_u32 m0, s47, 81920
    s_nop 0
    buffer_load_dwordx4 v21, s[24:27], s45 offen  lds
    s_add_u32 s45, s46, 0x720000
    s_add_u32 m0, s47, 86016
    s_nop 0
    buffer_load_dwordx4 v21, s[24:27], s45 offen  lds
    s_add_u32 s45, s46, 0x740000
    s_add_u32 m0, s47, 90112
    s_nop 0
    buffer_load_dwordx4 v21, s[24:27], s45 offen  lds
    s_add_u32 s45, s46, 0x760000
    s_add_u32 m0, s47, 94208
    s_nop 0
    buffer_load_dwordx4 v21, s[24:27], s45 offen  lds
    ds_read_b64_tr_b16 a[96:97], v24 offset:32768
    ds_read_b64_tr_b16 a[98:99], v24 offset:33792
    ds_read_b64_tr_b16 a[100:101], v24 offset:32776
    ds_read_b64_tr_b16 a[102:103], v24 offset:33800
    ds_read_b64_tr_b16 a[104:105], v24 offset:40960
    ds_read_b64_tr_b16 a[106:107], v24 offset:41984
    ds_read_b64_tr_b16 a[108:109], v24 offset:40968
    ds_read_b64_tr_b16 a[110:111], v24 offset:41992
    s_waitcnt lgkmcnt(0)
    s_waitcnt vmcnt(28)
    s_barrier
    s_add_u32 s45, s46, 0x780000
    s_add_u32 m0, s47, 98304
    s_nop 0
    buffer_load_dwordx4 v21, s[24:27], s45 offen  lds
    s_add_u32 s45, s46, 0x7a0000
    s_add_u32 m0, s47, 102400
    s_nop 0
    buffer_load_dwordx4 v21, s[24:27], s45 offen  lds
    s_add_u32 s45, s46, 0x7c0000
    s_add_u32 m0, s47, 106496
    s_nop 0
    buffer_load_dwordx4 v21, s[24:27], s45 offen  lds
    s_add_u32 s45, s46, 0x7e0000
    s_add_u32 m0, s47, 110592
    s_nop 0
    buffer_load_dwordx4 v21, s[24:27], s45 offen  lds
    ds_read_b64_tr_b16 a[112:113], v24 offset:49152
    ds_read_b64_tr_b16 a[114:115], v24 offset:50176
    ds_read_b64_tr_b16 a[116:117], v24 offset:49160
    ds_read_b64_tr_b16 a[118:119], v24 offset:50184
    ds_read_b64_tr_b16 a[120:121], v24 offset:57344
    ds_read_b64_tr_b16 a[122:123], v24 offset:58368
    ds_read_b64_tr_b16 a[124:125], v24 offset:57352
    ds_read_b64_tr_b16 a[126:127], v24 offset:58376
    s_waitcnt lgkmcnt(0)
    s_waitcnt vmcnt(28)
    s_barrier
    ds_read_b64_tr_b16 a[128:129], v25 offset:0
    ds_read_b64_tr_b16 a[130:131], v25 offset:1024
    ds_read_b64_tr_b16 a[132:133], v25 offset:8
    ds_read_b64_tr_b16 a[134:135], v25 offset:1032
    ds_read_b64_tr_b16 a[136:137], v25 offset:8192
    ds_read_b64_tr_b16 a[138:139], v25 offset:9216
    ds_read_b64_tr_b16 a[140:141], v25 offset:8200
    ds_read_b64_tr_b16 a[142:143], v25 offset:9224
    s_waitcnt lgkmcnt(0)
    s_waitcnt vmcnt(24)
    s_barrier
    ds_read_b64_tr_b16 a[144:145], v23 offset:0
    ds_read_b64_tr_b16 a[146:147], v23 offset:1024
    ds_read_b64_tr_b16 a[148:149], v23 offset:8
    ds_read_b64_tr_b16 a[150:151], v23 offset:1032
    ds_read_b64_tr_b16 a[152:153], v23 offset:8192
    ds_read_b64_tr_b16 a[154:155], v23 offset:9216
    ds_read_b64_tr_b16 a[156:157], v23 offset:8200
    ds_read_b64_tr_b16 a[158:159], v23 offset:9224
    s_waitcnt lgkmcnt(0)
    s_waitcnt vmcnt(20)
    s_barrier
    ds_read_b64_tr_b16 a[160:161], v23 offset:16384
    ds_read_b64_tr_b16 a[162:163], v23 offset:17408
    ds_read_b64_tr_b16 a[164:165], v23 offset:16392
    ds_read_b64_tr_b16 a[166:167], v23 offset:17416
    ds_read_b64_tr_b16 a[168:169], v23 offset:24576
    ds_read_b64_tr_b16 a[170:171], v23 offset:25600
    ds_read_b64_tr_b16 a[172:173], v23 offset:24584
    ds_read_b64_tr_b16 a[174:175], v23 offset:25608
    s_waitcnt lgkmcnt(0)
    s_waitcnt vmcnt(16)
    s_barrier
    ds_read_b64_tr_b16 a[176:177], v23 offset:32768
    ds_read_b64_tr_b16 a[178:179], v23 offset:33792
    ds_read_b64_tr_b16 a[180:181], v23 offset:32776
    ds_read_b64_tr_b16 a[182:183], v23 offset:33800
    ds_read_b64_tr_b16 a[184:185], v23 offset:40960
    ds_read_b64_tr_b16 a[186:187], v23 offset:41984
    ds_read_b64_tr_b16 a[188:189], v23 offset:40968
    ds_read_b64_tr_b16 a[190:191], v23 offset:41992
    s_waitcnt lgkmcnt(0)
    s_waitcnt vmcnt(12)
    s_barrier
    ds_read_b64_tr_b16 a[192:193], v23 offset:49152
    ds_read_b64_tr_b16 a[194:195], v23 offset:50176
    ds_read_b64_tr_b16 a[196:197], v23 offset:49160
    ds_read_b64_tr_b16 a[198:199], v23 offset:50184
    ds_read_b64_tr_b16 a[200:201], v23 offset:57344
    ds_read_b64_tr_b16 a[202:203], v23 offset:58368
    ds_read_b64_tr_b16 a[204:205], v23 offset:57352
    ds_read_b64_tr_b16 a[206:207], v23 offset:58376
    s_waitcnt lgkmcnt(0)
    s_waitcnt vmcnt(8)
    s_barrier
    ds_read_b64_tr_b16 a[208:209], v24 offset:0
    ds_read_b64_tr_b16 a[210:211], v24 offset:1024
    ds_read_b64_tr_b16 a[212:213], v24 offset:8
    ds_read_b64_tr_b16 a[214:215], v24 offset:1032
    ds_read_b64_tr_b16 a[216:217], v24 offset:8192
    ds_read_b64_tr_b16 a[218:219], v24 offset:9216
    ds_read_b64_tr_b16 a[220:221], v24 offset:8200
    ds_read_b64_tr_b16 a[222:223], v24 offset:9224
    s_waitcnt lgkmcnt(0)
    s_waitcnt vmcnt(4)
    s_barrier
    ds_read_b64_tr_b16 a[224:225], v24 offset:16384
    ds_read_b64_tr_b16 a[226:227], v24 offset:17408
    ds_read_b64_tr_b16 a[228:229], v24 offset:16392
    ds_read_b64_tr_b16 a[230:231], v24 offset:17416
    ds_read_b64_tr_b16 a[232:233], v24 offset:24576
    ds_read_b64_tr_b16 a[234:235], v24 offset:25600
    ds_read_b64_tr_b16 a[236:237], v24 offset:24584
    ds_read_b64_tr_b16 a[238:239], v24 offset:25608
    s_waitcnt lgkmcnt(0)
    s_waitcnt vmcnt(0)
    s_barrier
    ds_read_b64_tr_b16 a[240:241], v24 offset:32768
    ds_read_b64_tr_b16 a[242:243], v24 offset:33792
    ds_read_b64_tr_b16 a[244:245], v24 offset:32776
    ds_read_b64_tr_b16 a[246:247], v24 offset:33800
    ds_read_b64_tr_b16 a[248:249], v24 offset:40960
    ds_read_b64_tr_b16 a[250:251], v24 offset:41984
    ds_read_b64_tr_b16 a[252:253], v24 offset:40968
    ds_read_b64_tr_b16 a[254:255], v24 offset:41992
    s_waitcnt lgkmcnt(0)
    s_barrier
    s_mov_b32 s60, 0
    s_mov_b32 s51, 1
    s_mov_b32 s71, 64
    s_mov_b32 s52, 0x400000
    s_lshl_b32 s56, s39, 19
    s_add_u32 s56, s56, 0x2000000
L_w_qkv_114:
    s_cmp_lg_u32 s44, 0
    s_cbranch_scc1 L_pd_115
    v_mov_b32 v29, s71
    s_mov_b32 s46, 96
    s_mov_b64 exec, 1
    s_mov_b32 s70, 0
L_wp_116:
    buffer_load_dword v31, v29, s[16:19], 0 offen sc1
    s_add_u32 s70, s70, 1
    s_cmp_ge_u32 s70, 0x200000
    s_cbranch_scc1 L_w_done_102
    s_waitcnt vmcnt(0)
    v_cmp_gt_u32 vcc, s46, v31
    s_nop 1
    s_cbranch_vccz L_wp_116_ok
    s_sleep 3
    s_branch L_wp_116
L_wp_116_ok:
    s_mov_b64 exec, -1
L_pd_115:
    s_barrier
    s_mov_b32 s50, s60
    s_mul_i32 s53, s50, 65536
    s_add_u32 s53, s53, s52
    s_lshl_b32 s54, s44, 13
    s_add_u32 s53, s53, s54
    s_mul_i32 s57, s50, 8192
    s_add_u32 s57, s57, s56
    s_lshl_b32 s45, s44, 11
    s_add_u32 s57, s57, s45
    s_add_u32 s55, s54, 65536
    s_mov_b32 s58, 0
    v_mov_b32 v13, v3
    v_add_u32 v14, 65536, v13
    v_xor_b32 v15, 64, v13
    v_xor_b32 v16, 64, v14
    s_mov_b32 s76, 0x20000000
    s_add_u32 s48, s53, 0
    s_add_u32 s49, s48, 4096
    s_add_u32 m0, s54, 0
    s_nop 0
    buffer_load_dwordx4 v6, s[12:15], s48 offen offset:0 sc1 lds
    s_add_u32 m0, s54, 1024
    s_nop 0
    buffer_load_dwordx4 v9, s[12:15], s48 offen offset:0 sc1 lds
    s_add_u32 m0, s54, 2048
    s_nop 0
    buffer_load_dwordx4 v6, s[12:15], s49 offen offset:0 sc1 lds
    s_add_u32 m0, s54, 3072
    s_nop 0
    buffer_load_dwordx4 v9, s[12:15], s49 offen offset:0 sc1 lds
    s_add_u32 m0, s54, 3968
    s_nop 0
    buffer_load_dwordx4 v6, s[12:15], s48 offen offset:128 sc1 lds
    s_add_u32 m0, s54, 4992
    s_nop 0
    buffer_load_dwordx4 v9, s[12:15], s48 offen offset:128 sc1 lds
    s_add_u32 m0, s54, 6016
    s_nop 0
    buffer_load_dwordx4 v6, s[12:15], s49 offen offset:128 sc1 lds
    s_add_u32 m0, s54, 7040
    s_nop 0
    buffer_load_dwordx4 v9, s[12:15], s49 offen offset:128 sc1 lds
    s_add_u32 s48, s53, 32768
    s_add_u32 s49, s48, 4096
    s_add_u32 s46, s54, 32768
    s_add_u32 m0, s46, 0
    s_nop 0
    buffer_load_dwordx4 v6, s[12:15], s48 offen offset:0 sc1 lds
    s_add_u32 m0, s46, 1024
    s_nop 0
    buffer_load_dwordx4 v9, s[12:15], s48 offen offset:0 sc1 lds
    s_add_u32 m0, s46, 2048
    s_nop 0
    buffer_load_dwordx4 v6, s[12:15], s49 offen offset:0 sc1 lds
    s_add_u32 m0, s46, 3072
    s_nop 0
    buffer_load_dwordx4 v9, s[12:15], s49 offen offset:0 sc1 lds
    s_add_u32 m0, s46, 3968
    s_nop 0
    buffer_load_dwordx4 v6, s[12:15], s48 offen offset:128 sc1 lds
    s_add_u32 m0, s46, 4992
    s_nop 0
    buffer_load_dwordx4 v9, s[12:15], s48 offen offset:128 sc1 lds
    s_add_u32 m0, s46, 6016
    s_nop 0
    buffer_load_dwordx4 v6, s[12:15], s49 offen offset:128 sc1 lds
    s_add_u32 m0, s46, 7040
    s_nop 0
    buffer_load_dwordx4 v9, s[12:15], s49 offen offset:128 sc1 lds
    s_add_u32 s48, s53, 65536
    s_cmp_gt_u32 s51, 1
    s_cselect_b32 s48, s48, 0x20000000
    s_add_u32 s49, s48, 4096
    s_add_u32 m0, s55, 0
    s_nop 0
    buffer_load_dwordx4 v6, s[12:15], s48 offen offset:0 sc1 lds
    s_add_u32 m0, s55, 1024
    s_nop 0
    buffer_load_dwordx4 v9, s[12:15], s48 offen offset:0 sc1 lds
    s_add_u32 m0, s55, 2048
    s_nop 0
    buffer_load_dwordx4 v6, s[12:15], s49 offen offset:0 sc1 lds
    s_add_u32 m0, s55, 3072
    s_nop 0
    buffer_load_dwordx4 v9, s[12:15], s49 offen offset:0 sc1 lds
    s_add_u32 m0, s55, 3968
    s_nop 0
    buffer_load_dwordx4 v6, s[12:15], s48 offen offset:128 sc1 lds
    s_add_u32 m0, s55, 4992
    s_nop 0
    buffer_load_dwordx4 v9, s[12:15], s48 offen offset:128 sc1 lds
    s_add_u32 m0, s55, 6016
    s_nop 0
    buffer_load_dwordx4 v6, s[12:15], s49 offen offset:128 sc1 lds
    s_add_u32 m0, s55, 7040
    s_nop 0
    buffer_load_dwordx4 v9, s[12:15], s49 offen offset:128 sc1 lds
    s_waitcnt vmcnt(16)
    s_barrier
    ds_read_b128 v[32:35], v13 offset:0
    ds_read_b128 v[36:39], v13 offset:2048
    ds_read_b128 v[40:43], v15 offset:0
    ds_read_b128 v[44:47], v15 offset:2048
L_e_loop_117:
    s_add_u32 s48, s53, 98304
    s_add_u32 s46, s58, 1
    s_cmp_lt_u32 s46, s51
    s_cselect_b32 s48, s48, 0x20000000
    s_add_u32 s49, s48, 4096
    s_add_u32 s59, s55, 32768
    s_waitcnt lgkmcnt(2)
    v_mfma_f32_16x16x32_bf16 v[80:83], a[0:3], v[32:35], 0
    ds_read_b128 v[48:51], v13 offset:4096
    ds_read_b128 v[52:55], v13 offset:6144
    v_mfma_f32_16x16x32_bf16 v[84:87], a[4:7], v[32:35], 0
    ds_read_b128 v[56:59], v15 offset:4096
    ds_read_b128 v[60:63], v15 offset:6144
    v_mfma_f32_16x16x32_bf16 v[88:91], a[0:3], v[36:39], 0
    s_add_u32 m0, s59, 0
    s_nop 0
    buffer_load_dwordx4 v6, s[12:15], s48 offen offset:0 sc1 lds
    v_mfma_f32_16x16x32_bf16 v[92:95], a[4:7], v[36:39], 0
    s_waitcnt lgkmcnt(4)
    v_mfma_f32_16x16x32_bf16 v[80:83], a[8:11], v[40:43], v[80:83]
    ds_read_b128 v[32:35], v13 offset:8192
    ds_read_b128 v[36:39], v13 offset:10240
    v_mfma_f32_16x16x32_bf16 v[84:87], a[12:15], v[40:43], v[84:87]
    v_mfma_f32_16x16x32_bf16 v[88:91], a[8:11], v[44:47], v[88:91]
    s_add_u32 m0, s59, 1024
    s_nop 0
    buffer_load_dwordx4 v9, s[12:15], s48 offen offset:0 sc1 lds
    v_mfma_f32_16x16x32_bf16 v[92:95], a[12:15], v[44:47], v[92:95]
    s_waitcnt lgkmcnt(4)
    v_mfma_f32_16x16x32_bf16 v[80:83], a[16:19], v[48:51], v[80:83]
    ds_read_b128 v[40:43], v15 offset:8192
    ds_read_b128 v[44:47], v15 offset:10240
    v_mfma_f32_16x16x32_bf16 v[84:87], a[20:23], v[48:51], v[84:87]
    v_mfma_f32_16x16x32_bf16 v[88:91], a[16:19], v[52:55], v[88:91]
    s_add_u32 m0, s59, 2048
    s_nop 0
    buffer_load_dwordx4 v6, s[12:15], s49 offen offset:0 sc1 lds
    v_mfma_f32_16x16x32_bf16 v[92:95], a[20:23], v[52:55], v[92:95]
    s_waitcnt lgkmcnt(4)
    v_mfma_f32_16x16x32_bf16 v[80:83], a[24:27], v[56:59], v[80:83]
    ds_read_b128 v[48:51], v13 offset:12288
    ds_read_b128 v[52:55], v13 offset:14336
    v_mfma_f32_16x16x32_bf16 v[84:87], a[28:31], v[56:59], v[84:87]
    v_mfma_f32_16x16x32_bf16 v[88:91], a[24:27], v[60:63], v[88:91]
    s_add_u32 m0, s59, 3072
    s_nop 0
    buffer_load_dwordx4 v9, s[12:15], s49 offen offset:0 sc1 lds
    v_mfma_f32_16x16x32_bf16 v[92:95], a[28:31], v[60:63], v[92:95]
    s_waitcnt lgkmcnt(4)
    v_mfma_f32_16x16x32_bf16 v[80:83], a[32:35], v[32:35], v[80:83]
    ds_read_b128 v[56:59], v15 offset:12288
    ds_read_b128 v[60:63], v15 offset:14336
    v_mfma_f32_16x16x32_bf16 v[84:87], a[36:39], v[32:35], v[84:87]
    v_mfma_f32_16x16x32_bf16 v[88:91], a[32:35], v[36:39], v[88:91]
    s_add_u32 m0, s59, 3968
    s_nop 0
    buffer_load_dwordx4 v6, s[12:15], s48 offen offset:128 sc1 lds
    v_mfma_f32_16x16x32_bf16 v[92:95], a[36:39], v[36:39], v[92:95]
    s_waitcnt lgkmcnt(4)
    v_mfma_f32_16x16x32_bf16 v[80:83], a[40:43], v[40:43], v[80:83]
    ds_read_b128 v[32:35], v13 offset:16384
    ds_read_b128 v[36:39], v13 offset:18432
    v_mfma_f32_16x16x32_bf16 v[84:87], a[44:47], v[40:43], v[84:87]
    v_mfma_f32_16x16x32_bf16 v[88:91], a[40:43], v[44:47], v[88:91]
    s_add_u32 m0, s59, 4992
    s_nop 0
    buffer_load_dwordx4 v9, s[12:15], s48 offen offset:128 sc1 lds
    v_mfma_f32_16x16x32_bf16 v[92:95], a[44:47], v[44:47], v[92:95]
    s_waitcnt lgkmcnt(4)
    v_mfma_f32_16x16x32_bf16 v[80:83], a[48:51], v[48:51], v[80:83]
    ds_read_b128 v[40:43], v15 offset:16384
    ds_read_b128 v[44:47], v15 offset:18432
    v_mfma_f32_16x16x32_bf16 v[84:87], a[52:55], v[48:51], v[84:87]
    v_mfma_f32_16x16x32_bf16 v[88:91], a[48:51], v[52:55], v[88:91]
    s_add_u32 m0, s59, 6016
    s_nop 0
    buffer_load_dwordx4 v6, s[12:15], s49 offen offset:128 sc1 lds
    v_mfma_f32_16x16x32_bf16 v[92:95], a[52:55], v[52:55], v[92:95]
    s_waitcnt lgkmcnt(4)
    v_mfma_f32_16x16x32_bf16 v[80:83], a[56:59], v[56:59], v[80:83]
    ds_read_b128 v[48:51], v13 offset:20480
    ds_read_b128 v[52:55], v13 offset:22528
    v_mfma_f32_16x16x32_bf16 v[84:87], a[60:63], v[56:59], v[84:87]
    v_mfma_f32_16x16x32_bf16 v[88:91], a[56:59], v[60:63], v[88:91]
    s_add_u32 m0, s59, 7040
    s_nop 0
    buffer_load_dwordx4 v9, s[12:15], s49 offen offset:128 sc1 lds
    v_mfma_f32_16x16x32_bf16 v[92:95], a[60:63], v[60:63], v[92:95]
    s_waitcnt lgkmcnt(4)
    v_mfma_f32_16x16x32_bf16 v[80:83], a[64:67], v[32:35], v[80:83]
    ds_read_b128 v[56:59], v15 offset:20480
    ds_read_b128 v[60:63], v15 offset:22528
    v_mfma_f32_16x16x32_bf16 v[84:87], a[68:71], v[32:35], v[84:87]
    v_mfma_f32_16x16x32_bf16 v[88:91], a[64:67], v[36:39], v[88:91]
    v_mfma_f32_16x16x32_bf16 v[92:95], a[68:71], v[36:39], v[92:95]
    s_waitcnt lgkmcnt(4)
    v_mfma_f32_16x16x32_bf16 v[80:83], a[72:75], v[40:43], v[80:83]
    ds_read_b128 v[32:35], v13 offset:24576
    ds_read_b128 v[36:39], v13 offset:26624
    v_mfma_f32_16x16x32_bf16 v[84:87], a[76:79], v[40:43], v[84:87]
    v_mfma_f32_16x16x32_bf16 v[88:91], a[72:75], v[44:47], v[88:91]
    v_mfma_f32_16x16x32_bf16 v[92:95], a[76:79], v[44:47], v[92:95]
    s_waitcnt lgkmcnt(4)
    v_mfma_f32_16x16x32_bf16 v[80:83], a[80:83], v[48:51], v[80:83]
    ds_read_b128 v[40:43], v15 offset:24576
    ds_read_b128 v[44:47], v15 offset:26624
    v_mfma_f32_16x16x32_bf16 v[84:87], a[84:87], v[48:51], v[84:87]
    v_mfma_f32_16x16x32_bf16 v[88:91], a[80:83], v[52:55], v[88:91]
    v_mfma_f32_16x16x32_bf16 v[92:95], a[84:87], v[52:55], v[92:95]
    s_waitcnt lgkmcnt(4)
    v_mfma_f32_16x16x32_bf16 v[80:83], a[88:91], v[56:59], v[80:83]
    ds_read_b128 v[48:51], v13 offset:28672
    ds_read_b128 v[52:55], v13 offset:30720
    v_mfma_f32_16x16x32_bf16 v[84:87], a[92:95], v[56:59], v[84:87]
    v_mfma_f32_16x16x32_bf16 v[88:91], a[88:91], v[60:63], v[88:91]
    v_mfma_f32_16x16x32_bf16 v[92:95], a[92:95], v[60:63], v[92:95]
    s_waitcnt lgkmcnt(4)
    v_mfma_f32_16x16x32_bf16 v[80:83], a[96:99], v[32:35], v[80:83]
    ds_read_b128 v[56:59], v15 offset:28672
    ds_read_b128 v[60:63], v15 offset:30720
    v_mfma_f32_16x16x32_bf16 v[84:87], a[100:103], v[32:35], v[84:87]
    v_mfma_f32_16x16x32_bf16 v[88:91], a[96:99], v[36:39], v[88:91]
    v_mfma_f32_16x16x32_bf16 v[92:95], a[100:103], v[36:39], v[92:95]
    s_waitcnt lgkmcnt(4)
    v_mfma_f32_16x16x32_bf16 v[80:83], a[104:107], v[40:43], v[80:83]
    v_mfma_f32_16x16x32_bf16 v[84:87], a[108:111], v[40:43], v[84:87]
    v_mfma_f32_16x16x32_bf16 v[88:91], a[104:107], v[44:47], v[88:91]
    v_mfma_f32_16x16x32_bf16 v[92:95], a[108:111], v[44:47], v[92:95]
    s_waitcnt vmcnt(16) lgkmcnt(0)
    s_barrier
    v_mfma_f32_16x16x32_bf16 v[80:83], a[112:115], v[48:51], v[80:83]
    ds_read_b128 v[32:35], v13 offset:32768
    ds_read_b128 v[36:39], v13 offset:34816
    v_mfma_f32_16x16x32_bf16 v[84:87], a[116:119], v[48:51], v[84:87]
    v_mfma_f32_16x16x32_bf16 v[88:91], a[112:115], v[52:55], v[88:91]
    v_mfma_f32_16x16x32_bf16 v[92:95], a[116:119], v[52:55], v[92:95]
    v_mfma_f32_16x16x32_bf16 v[80:83], a[120:123], v[56:59], v[80:83]
    ds_read_b128 v[40:43], v15 offset:32768
    ds_read_b128 v[44:47], v15 offset:34816
    v_mfma_f32_16x16x32_bf16 v[84:87], a[124:127], v[56:59], v[84:87]
    v_mfma_f32_16x16x32_bf16 v[88:91], a[120:123], v[60:63], v[88:91]
    v_mfma_f32_16x16x32_bf16 v[92:95], a[124:127], v[60:63], v[92:95]
    s_add_u32 s48, s53, 131072
    s_add_u32 s46, s58, 2
    s_cmp_lt_u32 s46, s51
    s_cselect_b32 s48, s48, 0x20000000
    s_add_u32 s49, s48, 4096
    s_mov_b32 s59, s54
    s_waitcnt lgkmcnt(2)
    v_mfma_f32_16x16x32_bf16 v[80:83], a[128:131], v[32:35], v[80:83]
    ds_read_b128 v[48:51], v13 offset:36864
    ds_read_b128 v[52:55], v13 offset:38912
    v_mfma_f32_16x16x32_bf16 v[84:87], a[132:135], v[32:35], v[84:87]
    ds_read_b128 v[56:59], v15 offset:36864
    ds_read_b128 v[60:63], v15 offset:38912
    v_mfma_f32_16x16x32_bf16 v[88:91], a[128:131], v[36:39], v[88:91]
    s_add_u32 m0, s59, 0
    s_nop 0
    buffer_load_dwordx4 v6, s[12:15], s48 offen offset:0 sc1 lds
    v_mfma_f32_16x16x32_bf16 v[92:95], a[132:135], v[36:39], v[92:95]
    s_waitcnt lgkmcnt(4)
    v_mfma_f32_16x16x32_bf16 v[80:83], a[136:139], v[40:43], v[80:83]
    ds_read_b128 v[32:35], v13 offset:40960
    ds_read_b128 v[36:39], v13 offset:43008
    v_mfma_f32_16x16x32_bf16 v[84:87], a[140:143], v[40:43], v[84:87]
    v_mfma_f32_16x16x32_bf16 v[88:91], a[136:139], v[44:47], v[88:91]
    s_add_u32 m0, s59, 1024
    s_nop 0
    buffer_load_dwordx4 v9, s[12:15], s48 offen offset:0 sc1 lds
    v_mfma_f32_16x16x32_bf16 v[92:95], a[140:143], v[44:47], v[92:95]
    s_waitcnt lgkmcnt(4)
    v_mfma_f32_16x16x32_bf16 v[80:83], a[144:147], v[48:51], v[80:83]
    ds_read_b128 v[40:43], v15 offset:40960
    ds_read_b128 v[44:47], v15 offset:43008
    v_mfma_f32_16x16x32_bf16 v[84:87], a[148:151], v[48:51], v[84:87]
    v_mfma_f32_16x16x32_bf16 v[88:91], a[144:147], v[52:55], v[88:91]
    s_add_u32 m0, s59, 2048
    s_nop 0
    buffer_load_dwordx4 v6, s[12:15], s49 offen offset:0 sc1 lds
    v_mfma_f32_16x16x32_bf16 v[92:95], a[148:151], v[52:55], v[92:95]
    s_waitcnt lgkmcnt(4)
    v_mfma_f32_16x16x32_bf16 v[80:83], a[152:155], v[56:59], v[80:83]
    ds_read_b128 v[48:51], v13 offset:45056
    ds_read_b128 v[52:55], v13 offset:47104
    v_mfma_f32_16x16x32_bf16 v[84:87], a[156:159], v[56:59], v[84:87]
    v_mfma_f32_16x16x32_bf16 v[88:91], a[152:155], v[60:63], v[88:91]
    s_add_u32 m0, s59, 3072
    s_nop 0
    buffer_load_dwordx4 v9, s[12:15], s49 offen offset:0 sc1 lds
    v_mfma_f32_16x16x32_bf16 v[92:95], a[156:159], v[60:63], v[92:95]
    s_waitcnt lgkmcnt(4)
    v_mfma_f32_16x16x32_bf16 v[80:83], a[160:163], v[32:35], v[80:83]
    ds_read_b128 v[56:59], v15 offset:45056
    ds_read_b128 v[60:63], v15 offset:47104
    v_mfma_f32_16x16x32_bf16 v[84:87], a[164:167], v[32:35], v[84:87]
    v_mfma_f32_16x16x32_bf16 v[88:91], a[160:163], v[36:39], v[88:91]
    s_add_u32 m0, s59, 3968
    s_nop 0
    buffer_load_dwordx4 v6, s[12:15], s48 offen offset:128 sc1 lds
    v_mfma_f32_16x16x32_bf16 v[92:95], a[164:167], v[36:39], v[92:95]
    s_waitcnt lgkmcnt(4)
    v_mfma_f32_16x16x32_bf16 v[80:83], a[168:171], v[40:43], v[80:83]
    ds_read_b128 v[32:35], v13 offset:49152
    ds_read_b128 v[36:39], v13 offset:51200
    v_mfma_f32_16x16x32_bf16 v[84:87], a[172:175], v[40:43], v[84:87]
    v_mfma_f32_16x16x32_bf16 v[88:91], a[168:171], v[44:47], v[88:91]
    s_add_u32 m0, s59, 4992
    s_nop 0
    buffer_load_dwordx4 v9, s[12:15], s48 offen offset:128 sc1 lds
    v_mfma_f32_16x16x32_bf16 v[92:95], a[172:175], v[44:47], v[92:95]
    s_waitcnt lgkmcnt(4)
    v_mfma_f32_16x16x32_bf16 v[80:83], a[176:179], v[48:51], v[80:83]
    ds_read_b128 v[40:43], v15 offset:49152
    ds_read_b128 v[44:47], v15 offset:51200
    v_mfma_f32_16x16x32_bf16 v[84:87], a[180:183], v[48:51], v[84:87]
    v_mfma_f32_16x16x32_bf16 v[88:91], a[176:179], v[52:55], v[88:91]
    s_add_u32 m0, s59, 6016
    s_nop 0
    buffer_load_dwordx4 v6, s[12:15], s49 offen offset:128 sc1 lds
    v_mfma_f32_16x16x32_bf16 v[92:95], a[180:183], v[52:55], v[92:95]
    s_waitcnt lgkmcnt(4)
    v_mfma_f32_16x16x32_bf16 v[80:83], a[184:187], v[56:59], v[80:83]
    ds_read_b128 v[48:51], v13 offset:53248
    ds_read_b128 v[52:55], v13 offset:55296
    v_mfma_f32_16x16x32_bf16 v[84:87], a[188:191], v[56:59], v[84:87]
    v_mfma_f32_16x16x32_bf16 v[88:91], a[184:187], v[60:63], v[88:91]
    s_add_u32 m0, s59, 7040
    s_nop 0
    buffer_load_dwordx4 v9, s[12:15], s49 offen offset:128 sc1 lds
    v_mfma_f32_16x16x32_bf16 v[92:95], a[188:191], v[60:63], v[92:95]
    s_waitcnt lgkmcnt(4)
    v_mfma_f32_16x16x32_bf16 v[80:83], a[192:195], v[32:35], v[80:83]
    ds_read_b128 v[56:59], v15 offset:53248
    ds_read_b128 v[60:63], v15 offset:55296
    v_mfma_f32_16x16x32_bf16 v[84:87], a[196:199], v[32:35], v[84:87]
    v_mfma_f32_16x16x32_bf16 v[88:91], a[192:195], v[36:39], v[88:91]
    v_mfma_f32_16x16x32_bf16 v[92:95], a[196:199], v[36:39], v[92:95]
    s_waitcnt lgkmcnt(4)
    v_mfma_f32_16x16x32_bf16 v[80:83], a[200:203], v[40:43], v[80:83]
    ds_read_b128 v[32:35], v13 offset:57344
    ds_read_b128 v[36:39], v13 offset:59392
    v_mfma_f32_16x16x32_bf16 v[84:87], a[204:207], v[40:43], v[84:87]
    v_mfma_f32_16x16x32_bf16 v[88:91], a[200:203], v[44:47], v[88:91]
    v_mfma_f32_16x16x32_bf16 v[92:95], a[204:207], v[44:47], v[92:95]
    s_waitcnt lgkmcnt(4)
    v_mfma_f32_16x16x32_bf16 v[80:83], a[208:211], v[48:51], v[80:83]
    ds_read_b128 v[40:43], v15 offset:57344
    ds_read_b128 v[44:47], v15 offset:59392
    v_mfma_f32_16x16x32_bf16 v[84:87], a[212:215], v[48:51], v[84:87]
    v_mfma_f32_16x16x32_bf16 v[88:91], a[208:211], v[52:55], v[88:91]
    v_mfma_f32_16x16x32_bf16 v[92:95], a[212:215], v[52:55], v[92:95]
    s_waitcnt lgkmcnt(4)
    v_mfma_f32_16x16x32_bf16 v[80:83], a[216:219], v[56:59], v[80:83]
    ds_read_b128 v[48:51], v13 offset:61440
    ds_read_b128 v[52:55], v13 offset:63488
    v_mfma_f32_16x16x32_bf16 v[84:87], a[220:223], v[56:59], v[84:87]
    v_mfma_f32_16x16x32_bf16 v[88:91], a[216:219], v[60:63], v[88:91]
    v_mfma_f32_16x16x32_bf16 v[92:95], a[220:223], v[60:63], v[92:95]
    s_waitcnt lgkmcnt(4)
    v_mfma_f32_16x16x32_bf16 v[80:83], a[224:227], v[32:35], v[80:83]
    ds_read_b128 v[56:59], v15 offset:61440
    ds_read_b128 v[60:63], v15 offset:63488
    v_mfma_f32_16x16x32_bf16 v[84:87], a[228:231], v[32:35], v[84:87]
    v_mfma_f32_16x16x32_bf16 v[88:91], a[224:227], v[36:39], v[88:91]
    v_mfma_f32_16x16x32_bf16 v[92:95], a[228:231], v[36:39], v[92:95]
    s_waitcnt lgkmcnt(4)
    v_mfma_f32_16x16x32_bf16 v[80:83], a[232:235], v[40:43], v[80:83]
    v_mfma_f32_16x16x32_bf16 v[84:87], a[236:239], v[40:43], v[84:87]
    v_mfma_f32_16x16x32_bf16 v[88:91], a[232:235], v[44:47], v[88:91]
    v_mfma_f32_16x16x32_bf16 v[92:95], a[236:239], v[44:47], v[92:95]
    s_waitcnt vmcnt(16) lgkmcnt(0)
    s_barrier
    s_cmp_lg_u32 s44, 0
    s_cbranch_scc1 L_e_pr_118
    s_add_u32 s45, s58, s60
    v_mov_b32 v30, s45
    v_mov_b32 v31, 0
    s_mov_b64 exec, 1
    buffer_store_dword v30, v31, s[12:15], s61 offen sc1
    s_mov_b64 exec, -1
L_e_pr_118:
    v_mfma_f32_16x16x32_bf16 v[80:83], a[240:243], v[48:51], v[80:83]
    ds_read_b128 v[32:35], v14 offset:0
    ds_read_b128 v[36:39], v14 offset:2048
    v_mfma_f32_16x16x32_bf16 v[84:87], a[244:247], v[48:51], v[84:87]
    v_mfma_f32_16x16x32_bf16 v[88:91], a[240:243], v[52:55], v[88:91]
    v_mfma_f32_16x16x32_bf16 v[92:95], a[244:247], v[52:55], v[92:95]
    v_mfma_f32_16x16x32_bf16 v[80:83], a[248:251], v[56:59], v[80:83]
    ds_read_b128 v[40:43], v16 offset:0
    ds_read_b128 v[44:47], v16 offset:2048
    v_mfma_f32_16x16x32_bf16 v[84:87], a[252:255], v[56:59], v[84:87]
    v_mfma_f32_16x16x32_bf16 v[88:91], a[248:251], v[60:63], v[88:91]
    v_mfma_f32_16x16x32_bf16 v[92:95], a[252:255], v[60:63], v[92:95]
    s_add_u32 s53, s53, 65536
    s_add_u32 s58, s58, 1
    v_swap_b32 v13, v14
    s_xor_b32 s54, s54, 65536
    s_xor_b32 s55, s55, 65536
    s_mov_b32 s76, s57
    v_swap_b32 v15, v16
    s_add_u32 s57, s57, 8192
    v_cvt_pk_bf16_f32 v216, v80, v81
    v_cvt_pk_bf16_f32 v217, v82, v83
    v_cvt_pk_bf16_f32 v218, v84, v85
    v_cvt_pk_bf16_f32 v219, v86, v87
    v_cvt_pk_bf16_f32 v220, v88, v89
    v_cvt_pk_bf16_f32 v221, v90, v91
    v_cvt_pk_bf16_f32 v222, v92, v93
    v_cvt_pk_bf16_f32 v223, v94, v95
    buffer_store_dwordx4 v[216:219], v10, s[12:15], s76 offen sc1
    buffer_store_dwordx4 v[220:223], v10, s[12:15], s76 offen offset:1024 sc1
    s_cmp_lt_u32 s58, s51
    s_cbranch_scc1 L_e_loop_117
    s_waitcnt lgkmcnt(0)
    s_add_u32 s60, s60, s51
    s_waitcnt vmcnt(0)
    s_barrier
    s_cmp_lg_u32 s44, 0
    s_cbranch_scc1 L_pub_119
    v_mov_b32 v30, s60
    v_mov_b32 v31, 0
    s_mov_b64 exec, 1
    buffer_store_dword v30, v31, s[12:15], s61 offen sc1
    s_mov_b64 exec, -1
L_pub_119:
    s_cmp_eq_u32 s60, 1
    s_cselect_b32 s51, 11, 52
    s_cselect_b32 s71, s71, 196
    s_cmp_lt_u32 s60, 64
    s_cbranch_scc1 L_w_qkv_114
L_w_roles_104:
    s_mov_b32 s36, 0x10111111
    s_mov_b32 s37, 0x91081010
    s_cmp_eq_u32 s42, 0
    s_cselect_b32 s36, s36, 0x1000000
    s_cselect_b32 s37, s37, 0x44410101
    s_mov_b32 s72, 0x88888888
    s_mov_b32 s73, 0xeaa48888
    s_lshr_b32 s38, s41, 3
    s_and_b32 s68, s41, 7
    s_cmp_eq_u32 s43, 1
    s_cbranch_scc1 L_role_b_120
    s_cmp_eq_u32 s43, 2
    s_cbranch_scc1 L_role_c_121
    s_load_dwordx2 s[6:7], s[0:1], 40
    s_waitcnt lgkmcnt(0)
    s_mov_b32 s24, s6
    s_and_b32 s25, s7, 0xffff
    s_mov_b32 s26, 0x800000
    s_mov_b32 s27, 0x00020000
    s_lshl_b32 s46, s38, 21
    s_lshl_b32 s45, s68, 8
    s_add_u32 s46, s46, s45
    s_waitcnt vmcnt(0)
    s_barrier
    v_lshrrev_b32 v20, 4, v1
    s_lshl_b32 s45, s44, 2
    v_add_u32 v21, s45, v20
    s_mov_b32 s45, 2048
    v_mul_lo_u32 v21, v21, s45
    v_lshlrev_b32 v22, 2, v20
    v_and_b32 v23, 15, v1
    v_xor_b32 v22, v22, v23
    v_lshlrev_b32 v22, 4, v22
    v_add_u32 v21, v21, v22
    v_bfe_u32 v22, v1, 2, 2
    v_lshlrev_b32 v23, 2, v20
    v_add_u32 v23, v23, v22
    v_lshlrev_b32 v23, 8, v23
    v_xor_b32 v22, s44, v22
    v_lshlrev_b32 v22, 6, v22
    v_add_u32 v23, v23, v22
    v_and_b32 v22, 3, v1
    v_lshlrev_b32 v22, 3, v22
    v_add_u32 v23, v23, v22
    v_add_u32 v24, 65536, v23
    v_add_u32 v25, 131072, v23
    s_lshl_b32 s47, s44, 10
    s_add_u32 s45, s46, 0x0
    s_add_u32 m0, s47, 0
    s_nop 0
    buffer_load_dwordx4 v21, s[24:27], s45 offen  lds
    s_add_u32 s45, s46, 0x8000
    s_add_u32 m0, s47, 4096
    s_nop 0
    buffer_load_dwordx4 v21, s[24:27], s45 offen  lds
    s_add_u32 s45, s46, 0x10000
    s_add_u32 m0, s47, 8192
    s_nop 0
    buffer_load_dwordx4 v21, s[24:27], s45 offen  lds
    s_add_u32 s45, s46, 0x18000
    s_add_u32 m0, s47, 12288
    s_nop 0
    buffer_load_dwordx4 v21, s[24:27], s45 offen  lds
    s_add_u32 s45, s46, 0x20000
    s_add_u32 m0, s47, 16384
    s_nop 0
    buffer_load_dwordx4 v21, s[24:27], s45 offen  lds
    s_add_u32 s45, s46, 0x28000
    s_add_u32 m0, s47, 20480
    s_nop 0
    buffer_load_dwordx4 v21, s[24:27], s45 offen  lds
    s_add_u32 s45, s46, 0x30000
    s_add_u32 m0, s47, 24576
    s_nop 0
    buffer_load_dwordx4 v21, s[24:27], s45 offen  lds
    s_add_u32 s45, s46, 0x38000
    s_add_u32 m0, s47, 28672
    s_nop 0
    buffer_load_dwordx4 v21, s[24:27], s45 offen  lds
    s_add_u32 s45, s46, 0x40000
    s_add_u32 m0, s47, 32768
    s_nop 0
    buffer_load_dwordx4 v21, s[24:27], s45 offen  lds
    s_add_u32 s45, s46, 0x48000
    s_add_u32 m0, s47, 36864
    s_nop 0
    buffer_load_dwordx4 v21, s[24:27], s45 offen  lds
    s_add_u32 s45, s46, 0x50000
    s_add_u32 m0, s47, 40960
    s_nop 0
    buffer_load_dwordx4 v21, s[24:27], s45 offen  lds
    s_add_u32 s45, s46, 0x58000
    s_add_u32 m0, s47, 45056
    s_nop 0
    buffer_load_dwordx4 v21, s[24:27], s45 offen  lds
    s_add_u32 s45, s46, 0x60000
    s_add_u32 m0, s47, 49152
    s_nop 0
    buffer_load_dwordx4 v21, s[24:27], s45 offen  lds
    s_add_u32 s45, s46, 0x68000
    s_add_u32 m0, s47, 53248
    s_nop 0
    buffer_load_dwordx4 v21, s[24:27], s45 offen  lds
    s_add_u32 s45, s46, 0x70000
    s_add_u32 m0, s47, 57344
    s_nop 0
    buffer_load_dwordx4 v21, s[24:27], s45 offen  lds
    s_add_u32 s45, s46, 0x78000
    s_add_u32 m0, s47, 61440
    s_nop 0
    buffer_load_dwordx4 v21, s[24:27], s45 offen  lds
    s_add_u32 s45, s46, 0x80000
    s_add_u32 m0, s47, 65536
    s_nop 0
    buffer_load_dwordx4 v21, s[24:27], s45 offen  lds
    s_add_u32 s45, s46, 0x88000
    s_add_u32 m0, s47, 69632
    s_nop 0
    buffer_load_dwordx4 v21, s[24:27], s45 offen  lds
    s_add_u32 s45, s46, 0x90000
    s_add_u32 m0, s47, 73728
    s_nop 0
    buffer_load_dwordx4 v21, s[24:27], s45 offen  lds
    s_add_u32 s45, s46, 0x98000
    s_add_u32 m0, s47, 77824
    s_nop 0
    buffer_load_dwordx4 v21, s[24:27], s45 offen  lds
    s_add_u32 s45, s46, 0xa0000
    s_add_u32 m0, s47, 81920
    s_nop 0
    buffer_load_dwordx4 v21, s[24:27], s45 offen  lds
    s_add_u32 s45, s46, 0xa8000
    s_add_u32 m0, s47, 86016
    s_nop 0
    buffer_load_dwordx4 v21, s[24:27], s45 offen  lds
    s_add_u32 s45, s46, 0xb0000
    s_add_u32 m0, s47, 90112
    s_nop 0
    buffer_load_dwordx4 v21, s[24:27], s45 offen  lds
    s_add_u32 s45, s46, 0xb8000
    s_add_u32 m0, s47, 94208
    s_nop 0
    buffer_load_dwordx4 v21, s[24:27], s45 offen  lds
    s_add_u32 s45, s46, 0xc0000
    s_add_u32 m0, s47, 98304
    s_nop 0
    buffer_load_dwordx4 v21, s[24:27], s45 offen  lds
    s_add_u32 s45, s46, 0xc8000
    s_add_u32 m0, s47, 102400
    s_nop 0
    buffer_load_dwordx4 v21, s[24:27], s45 offen  lds
    s_add_u32 s45, s46, 0xd0000
    s_add_u32 m0, s47, 106496
    s_nop 0
    buffer_load_dwordx4 v21, s[24:27], s45 offen  lds
    s_add_u32 s45, s46, 0xd8000
    s_add_u32 m0, s47, 110592
    s_nop 0
    buffer_load_dwordx4 v21, s[24:27], s45 offen  lds
    s_add_u32 s45, s46, 0xe0000
    s_add_u32 m0, s47, 114688
    s_nop 0
    buffer_load_dwordx4 v21, s[24:27], s45 offen  lds
    s_add_u32 s45, s46, 0xe8000
    s_add_u32 m0, s47, 118784
    s_nop 0
    buffer_load_dwordx4 v21, s[24:27], s45 offen  lds
    s_add_u32 s45, s46, 0xf0000
    s_add_u32 m0, s47, 122880
    s_nop 0
    buffer_load_dwordx4 v21, s[24:27], s45 offen  lds
    s_add_u32 s45, s46, 0xf8000
    s_add_u32 m0, s47, 126976
    s_nop 0
    buffer_load_dwordx4 v21, s[24:27], s45 offen  lds
    s_waitcnt vmcnt(28)
    s_barrier
    s_add_u32 s45, s46, 0x100000
    s_add_u32 m0, s47, 131072
    s_nop 0
    buffer_load_dwordx4 v21, s[24:27], s45 offen  lds
    s_add_u32 s45, s46, 0x108000
    s_add_u32 m0, s47, 135168
    s_nop 0
    buffer_load_dwordx4 v21, s[24:27], s45 offen  lds
    s_add_u32 s45, s46, 0x110000
    s_add_u32 m0, s47, 139264
    s_nop 0
    buffer_load_dwordx4 v21, s[24:27], s45 offen  lds
    s_add_u32 s45, s46, 0x118000
    s_add_u32 m0, s47, 143360
    s_nop 0
    buffer_load_dwordx4 v21, s[24:27], s45 offen  lds
    ds_read_b64_tr_b16 a[0:1], v23 offset:0
    ds_read_b64_tr_b16 a[2:3], v23 offset:4096
    ds_read_b64_tr_b16 a[4:5], v23 offset:32
    ds_read_b64_tr_b16 a[6:7], v23 offset:4128
    ds_read_b64_tr_b16 a[8:9], v23 offset:8192
    ds_read_b64_tr_b16 a[10:11], v23 offset:12288
    ds_read_b64_tr_b16 a[12:13], v23 offset:8224
    ds_read_b64_tr_b16 a[14:15], v23 offset:12320
    s_waitcnt lgkmcnt(0)
    s_waitcnt vmcnt(28)
    s_barrier
    s_add_u32 s45, s46, 0x120000
    s_add_u32 m0, s47, 0
    s_nop 0
    buffer_load_dwordx4 v21, s[24:27], s45 offen  lds
    s_add_u32 s45, s46, 0x128000
    s_add_u32 m0, s47, 4096
    s_nop 0
    buffer_load_dwordx4 v21, s[24:27], s45 offen  lds
    s_add_u32 s45, s46, 0x130000
    s_add_u32 m0, s47, 8192
    s_nop 0
    buffer_load_dwordx4 v21, s[24:27], s45 offen  lds
    s_add_u32 s45, s46, 0x138000
    s_add_u32 m0, s47, 12288
    s_nop 0
    buffer_load_dwordx4 v21, s[24:27], s45 offen  lds
    ds_read_b64_tr_b16 a[16:17], v23 offset:16384
    ds_read_b64_tr_b16 a[18:19], v23 offset:20480
    ds_read_b64_tr_b16 a[20:21], v23 offset:16416
    ds_read_b64_tr_b16 a[22:23], v23 offset:20512
    ds_read_b64_tr_b16 a[24:25], v23 offset:24576
    ds_read_b64_tr_b16 a[26:27], v23 offset:28672
    ds_read_b64_tr_b16 a[28:29], v23 offset:24608
    ds_read_b64_tr_b16 a[30:31], v23 offset:28704
    s_waitcnt lgkmcnt(0)
    s_waitcnt vmcnt(28)
    s_barrier
    s_add_u32 s45, s46, 0x140000
    s_add_u32 m0, s47, 16384
    s_nop 0
    buffer_load_dwordx4 v21, s[24:27], s45 offen  lds
    s_add_u32 s45, s46, 0x148000
    s_add_u32 m0, s47, 20480
    s_nop 0
    buffer_load_dwordx4 v21, s[24:27], s45 offen  lds
    s_add_u32 s45, s46, 0x150000
    s_add_u32 m0, s47, 24576
    s_nop 0
    buffer_load_dwordx4 v21, s[24:27], s45 offen  lds
    s_add_u32 s45, s46, 0x158000
    s_add_u32 m0, s47, 28672
    s_nop 0
    buffer_load_dwordx4 v21, s[24:27], s45 offen  lds
    ds_read_b64_tr_b16 a[32:33], v23 offset:32768
    ds_read_b64_tr_b16 a[34:35], v23 offset:36864
    ds_read_b64_tr_b16 a[36:37], v23 offset:32800
    ds_read_b64_tr_b16 a[38:39], v23 offset:36896
    ds_read_b64_tr_b16 a[40:41], v23 offset:40960
    ds_read_b64_tr_b16 a[42:43], v23 offset:45056
    ds_read_b64_tr_b16 a[44:45], v23 offset:40992
    ds_read_b64_tr_b16 a[46:47], v23 offset:45088
    s_waitcnt lgkmcnt(0)
    s_waitcnt vmcnt(28)
    s_barrier
    s_add_u32 s45, s46, 0x160000
    s_add_u32 m0, s47, 32768
    s_nop 0
    buffer_load_dwordx4 v21, s[24:27], s45 offen  lds
    s_add_u32 s45, s46, 0x168000
    s_add_u32 m0, s47, 36864
    s_nop 0
    buffer_load_dwordx4 v21, s[24:27], s45 offen  lds
    s_add_u32 s45, s46, 0x170000
    s_add_u32 m0, s47, 40960
    s_nop 0
    buffer_load_dwordx4 v21, s[24:27], s45 offen  lds
    s_add_u32 s45, s46, 0x178000
    s_add_u32 m0, s47, 45056
    s_nop 0
    buffer_load_dwordx4 v21, s[24:27], s45 offen  lds
    ds_read_b64_tr_b16 a[48:49], v23 offset:49152
    ds_read_b64_tr_b16 a[50:51], v23 offset:53248
    ds_read_b64_tr_b16 a[52:53], v23 offset:49184
    ds_read_b64_tr_b16 a[54:55], v23 offset:53280
    ds_read_b64_tr_b16 a[56:57], v23 offset:57344
    ds_read_b64_tr_b16 a[58:59], v23 offset:61440
    ds_read_b64_tr_b16 a[60:61], v23 offset:57376
    ds_read_b64_tr_b16 a[62:63], v23 offset:61472
    s_waitcnt lgkmcnt(0)
    s_waitcnt vmcnt(28)
    s_barrier
    s_add_u32 s45, s46, 0x180000
    s_add_u32 m0, s47, 49152
    s_nop 0
    buffer_load_dwordx4 v21, s[24:27], s45 offen  lds
    s_add_u32 s45, s46, 0x188000
    s_add_u32 m0, s47, 53248
    s_nop 0
    buffer_load_dwordx4 v21, s[24:27], s45 offen  lds
    s_add_u32 s45, s46, 0x190000
    s_add_u32 m0, s47, 57344
    s_nop 0
    buffer_load_dwordx4 v21, s[24:27], s45 offen  lds
    s_add_u32 s45, s46, 0x198000
    s_add_u32 m0, s47, 61440
    s_nop 0
    buffer_load_dwordx4 v21, s[24:27], s45 offen  lds
    ds_read_b64_tr_b16 a[64:65], v24 offset:0
    ds_read_b64_tr_b16 a[66:67], v24 offset:4096
    ds_read_b64_tr_b16 a[68:69], v24 offset:32
    ds_read_b64_tr_b16 a[70:71], v24 offset:4128
    ds_read_b64_tr_b16 a[72:73], v24 offset:8192
    ds_read_b64_tr_b16 a[74:75], v24 offset:12288
    ds_read_b64_tr_b16 a[76:77], v24 offset:8224
    ds_read_b64_tr_b16 a[78:79], v24 offset:12320
    s_waitcnt lgkmcnt(0)
    s_waitcnt vmcnt(28)
    s_barrier
    s_add_u32 s45, s46, 0x1a0000
    s_add_u32 m0, s47, 65536
    s_nop 0
    buffer_load_dwordx4 v21, s[24:27], s45 offen  lds
    s_add_u32 s45, s46, 0x1a8000
    s_add_u32 m0, s47, 69632
    s_nop 0
    buffer_load_dwordx4 v21, s[24:27], s45 offen  lds
    s_add_u32 s45, s46, 0x1b0000
    s_add_u32 m0, s47, 73728
    s_nop 0
    buffer_load_dwordx4 v21, s[24:27], s45 offen  lds
    s_add_u32 s45, s46, 0x1b8000
    s_add_u32 m0, s47, 77824
    s_nop 0
    buffer_load_dwordx4 v21, s[24:27], s45 offen  lds
    ds_read_b64_tr_b16 a[80:81], v24 offset:16384
    ds_read_b64_tr_b16 a[82:83], v24 offset:20480
    ds_read_b64_tr_b16 a[84:85], v24 offset:16416
    ds_read_b64_tr_b16 a[86:87], v24 offset:20512
    ds_read_b64_tr_b16 a[88:89], v24 offset:24576
    ds_read_b64_tr_b16 a[90:91], v24 offset:28672
    ds_read_b64_tr_b16 a[92:93], v24 offset:24608
    ds_read_b64_tr_b16 a[94:95], v24 offset:28704
    s_waitcnt lgkmcnt(0)
    s_waitcnt vmcnt(28)
    s_barrier
    s_add_u32 s45, s46, 0x1c0000
    s_add_u32 m0, s47, 81920
    s_nop 0
    buffer_load_dwordx4 v21, s[24:27], s45 offen  lds
    s_add_u32 s45, s46, 0x1c8000
    s_add_u32 m0, s47, 86016
    s_nop 0
    buffer_load_dwordx4 v21, s[24:27], s45 offen  lds
    s_add_u32 s45, s46, 0x1d0000
    s_add_u32 m0, s47, 90112
    s_nop 0
    buffer_load_dwordx4 v21, s[24:27], s45 offen  lds
    s_add_u32 s45, s46, 0x1d8000
    s_add_u32 m0, s47, 94208
    s_nop 0
    buffer_load_dwordx4 v21, s[24:27], s45 offen  lds
    ds_read_b64_tr_b16 a[96:97], v24 offset:32768
    ds_read_b64_tr_b16 a[98:99], v24 offset:36864
    ds_read_b64_tr_b16 a[100:101], v24 offset:32800
    ds_read_b64_tr_b16 a[102:103], v24 offset:36896
    ds_read_b64_tr_b16 a[104:105], v24 offset:40960
    ds_read_b64_tr_b16 a[106:107], v24 offset:45056
    ds_read_b64_tr_b16 a[108:109], v24 offset:40992
    ds_read_b64_tr_b16 a[110:111], v24 offset:45088
    s_waitcnt lgkmcnt(0)
    s_waitcnt vmcnt(28)
    s_barrier
    s_add_u32 s45, s46, 0x1e0000
    s_add_u32 m0, s47, 98304
    s_nop 0
    buffer_load_dwordx4 v21, s[24:27], s45 offen  lds
    s_add_u32 s45, s46, 0x1e8000
    s_add_u32 m0, s47, 102400
    s_nop 0
    buffer_load_dwordx4 v21, s[24:27], s45 offen  lds
    s_add_u32 s45, s46, 0x1f0000
    s_add_u32 m0, s47, 106496
    s_nop 0
    buffer_load_dwordx4 v21, s[24:27], s45 offen  lds
    s_add_u32 s45, s46, 0x1f8000
    s_add_u32 m0, s47, 110592
    s_nop 0
    buffer_load_dwordx4 v21, s[24:27], s45 offen  lds
    ds_read_b64_tr_b16 a[112:113], v24 offset:49152
    ds_read_b64_tr_b16 a[114:115], v24 offset:53248
    ds_read_b64_tr_b16 a[116:117], v24 offset:49184
    ds_read_b64_tr_b16 a[118:119], v24 offset:53280
    ds_read_b64_tr_b16 a[120:121], v24 offset:57344
    ds_read_b64_tr_b16 a[122:123], v24 offset:61440
    ds_read_b64_tr_b16 a[124:125], v24 offset:57376
    ds_read_b64_tr_b16 a[126:127], v24 offset:61472
    s_waitcnt lgkmcnt(0)
    s_waitcnt vmcnt(28)
    s_barrier
    ds_read_b64_tr_b16 a[128:129], v25 offset:0
    ds_read_b64_tr_b16 a[130:131], v25 offset:4096
    ds_read_b64_tr_b16 a[132:133], v25 offset:32
    ds_read_b64_tr_b16 a[134:135], v25 offset:4128
    ds_read_b64_tr_b16 a[136:137], v25 offset:8192
    ds_read_b64_tr_b16 a[138:139], v25 offset:12288
    ds_read_b64_tr_b16 a[140:141], v25 offset:8224
    ds_read_b64_tr_b16 a[142:143], v25 offset:12320
    s_waitcnt lgkmcnt(0)
    s_waitcnt vmcnt(24)
    s_barrier
    ds_read_b64_tr_b16 a[144:145], v23 offset:0
    ds_read_b64_tr_b16 a[146:147], v23 offset:4096
    ds_read_b64_tr_b16 a[148:149], v23 offset:32
    ds_read_b64_tr_b16 a[150:151], v23 offset:4128
    ds_read_b64_tr_b16 a[152:153], v23 offset:8192
    ds_read_b64_tr_b16 a[154:155], v23 offset:12288
    ds_read_b64_tr_b16 a[156:157], v23 offset:8224
    ds_read_b64_tr_b16 a[158:159], v23 offset:12320
    s_waitcnt lgkmcnt(0)
    s_waitcnt vmcnt(20)
    s_barrier
    ds_read_b64_tr_b16 a[160:161], v23 offset:16384
    ds_read_b64_tr_b16 a[162:163], v23 offset:20480
    ds_read_b64_tr_b16 a[164:165], v23 offset:16416
    ds_read_b64_tr_b16 a[166:167], v23 offset:20512
    ds_read_b64_tr_b16 a[168:169], v23 offset:24576
    ds_read_b64_tr_b16 a[170:171], v23 offset:28672
    ds_read_b64_tr_b16 a[172:173], v23 offset:24608
    ds_read_b64_tr_b16 a[174:175], v23 offset:28704
    s_waitcnt lgkmcnt(0)
    s_waitcnt vmcnt(16)
    s_barrier
    ds_read_b64_tr_b16 a[176:177], v23 offset:32768
    ds_read_b64_tr_b16 a[178:179], v23 offset:36864
    ds_read_b64_tr_b16 a[180:181], v23 offset:32800
    ds_read_b64_tr_b16 a[182:183], v23 offset:36896
    ds_read_b64_tr_b16 a[184:185], v23 offset:40960
    ds_read_b64_tr_b16 a[186:187], v23 offset:45056
    ds_read_b64_tr_b16 a[188:189], v23 offset:40992
    ds_read_b64_tr_b16 a[190:191], v23 offset:45088
    s_waitcnt lgkmcnt(0)
    s_waitcnt vmcnt(12)
    s_barrier
    ds_read_b64_tr_b16 a[192:193], v23 offset:49152
    ds_read_b64_tr_b16 a[194:195], v23 offset:53248
    ds_read_b64_tr_b16 a[196:197], v23 offset:49184
    ds_read_b64_tr_b16 a[198:199], v23 offset:53280
    ds_read_b64_tr_b16 a[200:201], v23 offset:57344
    ds_read_b64_tr_b16 a[202:203], v23 offset:61440
    ds_read_b64_tr_b16 a[204:205], v23 offset:57376
    ds_read_b64_tr_b16 a[206:207], v23 offset:61472
    s_waitcnt lgkmcnt(0)
    s_waitcnt vmcnt(8)
    s_barrier
    ds_read_b64_tr_b16 a[208:209], v24 offset:0
    ds_read_b64_tr_b16 a[210:211], v24 offset:4096
    ds_read_b64_tr_b16 a[212:213], v24 offset:32
    ds_read_b64_tr_b16 a[214:215], v24 offset:4128
    ds_read_b64_tr_b16 a[216:217], v24 offset:8192
    ds_read_b64_tr_b16 a[218:219], v24 offset:12288
    ds_read_b64_tr_b16 a[220:221], v24 offset:8224
    ds_read_b64_tr_b16 a[222:223], v24 offset:12320
    s_waitcnt lgkmcnt(0)
    s_waitcnt vmcnt(4)
    s_barrier
    ds_read_b64_tr_b16 a[224:225], v24 offset:16384
    ds_read_b64_tr_b16 a[226:227], v24 offset:20480
    ds_read_b64_tr_b16 a[228:229], v24 offset:16416
    ds_read_b64_tr_b16 a[230:231], v24 offset:20512
    ds_read_b64_tr_b16 a[232:233], v24 offset:24576
    ds_read_b64_tr_b16 a[234:235], v24 offset:28672
    ds_read_b64_tr_b16 a[236:237], v24 offset:24608
    ds_read_b64_tr_b16 a[238:239], v24 offset:28704
    s_waitcnt lgkmcnt(0)
    s_waitcnt vmcnt(0)
    s_barrier
    ds_read_b64_tr_b16 a[240:241], v24 offset:32768
    ds_read_b64_tr_b16 a[242:243], v24 offset:36864
    ds_read_b64_tr_b16 a[244:245], v24 offset:32800
    ds_read_b64_tr_b16 a[246:247], v24 offset:36896
    ds_read_b64_tr_b16 a[248:249], v24 offset:40960
    ds_read_b64_tr_b16 a[250:251], v24 offset:45056
    ds_read_b64_tr_b16 a[252:253], v24 offset:40992
    ds_read_b64_tr_b16 a[254:255], v24 offset:45088
    s_waitcnt lgkmcnt(0)
    s_barrier
    s_lshl_b32 s52, s38, 16
    s_add_u32 s52, s52, 0x5000000
    s_lshl_b32 s56, s38, 23
    s_lshl_b32 s45, s68, 9
    s_add_u32 s56, s56, s45
    s_add_u32 s56, s56, 0x8000000
    s_cmp_lg_u32 s44, 0
    s_cbranch_scc1 L_pd_122
    v_mov_b32 v29, 4
    s_mov_b32 s46, 1073741824
    s_mov_b64 exec, 1
    s_mov_b32 s70, 0
L_wp_123:
    buffer_load_dword v31, v29, s[16:19], 0 offen sc1
    s_add_u32 s70, s70, 1
    s_cmp_ge_u32 s70, 0x200000
    s_cbranch_scc1 L_w_done_102
    s_waitcnt vmcnt(0)
    v_cmp_gt_u32 vcc, s46, v31
    s_nop 1
    s_cbranch_vccz L_wp_123_ok
    s_sleep 3
    s_branch L_wp_123
L_wp_123_ok:
    s_mov_b64 exec, -1
L_pd_122:
    s_barrier
L_a_loop_124:
    s_cmp_eq_u64 s[36:37], 0
    s_cbranch_scc1 L_w_done_102
    s_ff1_i32_b64 s50, s[36:37]
    s_bitset0_b64 s[36:37], s50
    s_lshr_b64 s[74:75], s[72:73], s50
    s_ff1_i32_b64 s51, s[74:75]
    s_add_u32 s51, s51, 1
    s_add_u32 s62, s50, s51
    s_add_u32 s63, s50, s44
    s_lshl_b32 s45, s41, 7
    s_add_u32 s45, s45, 0x10010
    s_cmp_lg_u32 s44, 0
    s_cbranch_scc1 L_pw_126
    s_mov_b64 exec, 7
    s_mov_b32 s70, 0
L_wp_127:
    buffer_load_dword v31, v12, s[12:15], s45 offen sc1
    s_add_u32 s70, s70, 1
    s_cmp_ge_u32 s70, 0x200000
    s_cbranch_scc1 L_w_done_102
    s_waitcnt vmcnt(0)
    v_cmp_gt_u32 vcc, s62, v31
    s_nop 1
    s_cbranch_vccz L_wp_127_ok
    s_sleep 2
    s_branch L_wp_127
L_wp_127_ok:
    s_mov_b64 exec, -1
L_pw_126:
    s_barrier
    s_cmp_ge_u32 s44, s51
    s_cbranch_scc1 L_xs1_128
    s_lshl_b32 s45, s41, 19
    s_lshl_b32 s46, s63, 13
    s_add_u32 s45, s45, s46
    s_add_u32 s45, s45, 0x2000000
    s_add_u32 s46, s45, 4096
    s_add_u32 s48, s45, 16777216
    s_add_u32 s49, s48, 4096
    s_add_u32 s76, s48, 16777216
    s_add_u32 s77, s76, 4096
    s_lshl_b32 s47, s44, 13
    s_mov_b32 m0, s47
    v_and_b32 v14, 15, v1
    v_lshrrev_b32 v16, 4, v1
    buffer_load_dwordx4 v10, s[12:15], s76 offen offset:0 sc1 lds
    buffer_load_dwordx4 v10, s[12:15], s76 offen offset:1024 sc1 lds
    buffer_load_dwordx4 v10, s[12:15], s76 offen offset:2048 sc1 lds
    buffer_load_dwordx4 v10, s[12:15], s76 offen offset:3072 sc1 lds
    s_add_u32 m0, s47, 4096
    s_nop 0
    buffer_load_dwordx4 v10, s[12:15], s77 offen offset:0 sc1 lds
    buffer_load_dwordx4 v10, s[12:15], s77 offen offset:1024 sc1 lds
    buffer_load_dwordx4 v10, s[12:15], s77 offen offset:2048 sc1 lds
    buffer_load_dwordx4 v10, s[12:15], s77 offen offset:3072 sc1 lds
    buffer_load_dwordx4 v[128:131], v10, s[12:15], s45 offen offset:0 sc1
    buffer_load_dwordx4 v[160:163], v10, s[12:15], s48 offen offset:0 sc1
    buffer_load_dwordx4 v[144:147], v10, s[12:15], s45 offen offset:1024 sc1
    buffer_load_dwordx4 v[176:179], v10, s[12:15], s48 offen offset:1024 sc1
    buffer_load_dwordx4 v[132:135], v10, s[12:15], s45 offen offset:2048 sc1
    buffer_load_dwordx4 v[164:167], v10, s[12:15], s48 offen offset:2048 sc1
    buffer_load_dwordx4 v[148:151], v10, s[12:15], s45 offen offset:3072 sc1
    buffer_load_dwordx4 v[180:183], v10, s[12:15], s48 offen offset:3072 sc1
    buffer_load_dwordx4 v[136:139], v10, s[12:15], s46 offen offset:0 sc1
    buffer_load_dwordx4 v[168:171], v10, s[12:15], s49 offen offset:0 sc1
    buffer_load_dwordx4 v[152:155], v10, s[12:15], s46 offen offset:1024 sc1
    buffer_load_dwordx4 v[184:187], v10, s[12:15], s49 offen offset:1024 sc1
    buffer_load_dwordx4 v[140:143], v10, s[12:15], s46 offen offset:2048 sc1
    buffer_load_dwordx4 v[172:175], v10, s[12:15], s49 offen offset:2048 sc1
    buffer_load_dwordx4 v[156:159], v10, s[12:15], s46 offen offset:3072 sc1
    buffer_load_dwordx4 v[188:191], v10, s[12:15], s49 offen offset:3072 sc1
    s_waitcnt vmcnt(0)
    v_mfma_f32_16x16x32_bf16 v[32:35], v[160:163], v[128:131], 0
    v_mfma_f32_16x16x32_bf16 v[36:39], v[160:163], v[144:147], 0
    v_mfma_f32_16x16x32_bf16 v[44:47], v[176:179], v[144:147], 0
    v_mfma_f32_16x16x32_bf16 v[32:35], v[164:167], v[132:135], v[32:35]
    v_mfma_f32_16x16x32_bf16 v[36:39], v[164:167], v[148:151], v[36:39]
    v_mfma_f32_16x16x32_bf16 v[44:47], v[180:183], v[148:151], v[44:47]
    v_mfma_f32_16x16x32_bf16 v[32:35], v[168:171], v[136:139], v[32:35]
    v_mfma_f32_16x16x32_bf16 v[36:39], v[168:171], v[152:155], v[36:39]
    v_mfma_f32_16x16x32_bf16 v[44:47], v[184:187], v[152:155], v[44:47]
    v_mfma_f32_16x16x32_bf16 v[32:35], v[172:175], v[140:143], v[32:35]
    v_mfma_f32_16x16x32_bf16 v[36:39], v[172:175], v[156:159], v[36:39]
    v_mfma_f32_16x16x32_bf16 v[44:47], v[188:191], v[156:159], v[44:47]
    v_lshlrev_b32 v19, 2, v16
    v_lshrrev_b32 v20, 2, v1
    v_lshlrev_b32 v20, 4, v20
    v_and_b32 v21, 1, v1
    v_lshlrev_b32 v21, 3, v21
    v_add3_u32 v20, v20, v21, s47
    v_and_b32 v21, 2, v1
    v_lshlrev_b32 v21, 7, v21
    v_add_u32 v20, v20, v21
    v_mov_b32 v22, 0xff800000
    ds_read_b64_tr_b16 v[208:209], v20 offset:0
    ds_read_b64_tr_b16 v[210:211], v20 offset:1024
    ds_read_b64_tr_b16 v[212:213], v20 offset:512
    ds_read_b64_tr_b16 v[214:215], v20 offset:1536
    ds_read_b64_tr_b16 v[216:217], v20 offset:2048
    ds_read_b64_tr_b16 v[218:219], v20 offset:3072
    ds_read_b64_tr_b16 v[220:221], v20 offset:2560
    ds_read_b64_tr_b16 v[222:223], v20 offset:3584
    ds_read_b64_tr_b16 v[224:225], v20 offset:4096
    ds_read_b64_tr_b16 v[226:227], v20 offset:5120
    ds_read_b64_tr_b16 v[228:229], v20 offset:4608
    ds_read_b64_tr_b16 v[230:231], v20 offset:5632
    ds_read_b64_tr_b16 v[232:233], v20 offset:6144
    ds_read_b64_tr_b16 v[234:235], v20 offset:7168
    ds_read_b64_tr_b16 v[236:237], v20 offset:6656
    ds_read_b64_tr_b16 v[238:239], v20 offset:7680
    v_add_u32 v21, 0, v19
    v_cmp_gt_u32 vcc, v21, v14
    s_nop 1
    v_cndmask_b32 v32, v32, v22, vcc
    v_cndmask_b32 v44, v44, v22, vcc
    v_add_u32 v21, 1, v19
    v_cmp_gt_u32 vcc, v21, v14
    s_nop 1
    v_cndmask_b32 v33, v33, v22, vcc
    v_cndmask_b32 v45, v45, v22, vcc
    v_add_u32 v21, 2, v19
    v_cmp_gt_u32 vcc, v21, v14
    s_nop 1
    v_cndmask_b32 v34, v34, v22, vcc
    v_cndmask_b32 v46, v46, v22, vcc
    v_add_u32 v21, 3, v19
    v_cmp_gt_u32 vcc, v21, v14
    s_nop 1
    v_cndmask_b32 v35, v35, v22, vcc
    v_cndmask_b32 v47, v47, v22, vcc
L_xs1_128:
    s_lshl_b32 s45, s41, 7
    s_add_u32 s45, s45, 0x11000
    s_cmp_lg_u32 s44, 0
    s_cbranch_scc1 L_pw_130
    s_mov_b64 exec, 255
    s_mov_b32 s70, 0
L_wp_131:
    buffer_load_dword v31, v12, s[12:15], s45 offen sc1
    s_add_u32 s70, s70, 1
    s_cmp_ge_u32 s70, 0x200000
    s_cbranch_scc1 L_w_done_102
    s_waitcnt vmcnt(0)
    v_cmp_gt_u32 vcc, s62, v31
    s_nop 1
    s_cbranch_vccz L_wp_131_ok
    s_sleep 2
    s_branch L_wp_131
L_wp_131_ok:
    s_mov_b64 exec, -1
L_pw_130:
    s_barrier
    s_cmp_ge_u32 s44, s51
    s_cbranch_scc1 L_xs2_129
    s_lshl_b32 s45, s63, 17
    s_lshl_b32 s46, s41, 12
    s_add_u32 s45, s45, s46
    s_lshr_b32 s46, s45, 1
    s_add_u32 s45, s45, 0x1000000
    s_add_u32 s46, s46, 0x1800000
    v_lshlrev_b32 v21, 3, v1
    buffer_load_dwordx4 v[192:195], v10, s[12:15], s45 offen offset:0 sc1
    buffer_load_dwordx4 v[196:199], v10, s[12:15], s45 offen offset:1024 sc1
    buffer_load_dwordx4 v[200:203], v10, s[12:15], s45 offen offset:2048 sc1
    buffer_load_dwordx4 v[204:207], v10, s[12:15], s45 offen offset:3072 sc1
    buffer_load_dwordx2 v[240:241], v21, s[12:15], s46 offen offset:0 sc1
    buffer_load_dwordx2 v[242:243], v21, s[12:15], s46 offen offset:512 sc1
    buffer_load_dwordx2 v[244:245], v21, s[12:15], s46 offen offset:1024 sc1
    buffer_load_dwordx2 v[246:247], v21, s[12:15], s46 offen offset:1536 sc1
    s_waitcnt vmcnt(4)
    v_mfma_f32_16x16x32_bf16 v[48:51], v[192:195], v[128:131], 0
    v_mfma_f32_16x16x32_bf16 v[52:55], v[192:195], v[144:147], 0
    v_mfma_f32_16x16x32_bf16 v[48:51], v[196:199], v[132:135], v[48:51]
    v_mfma_f32_16x16x32_bf16 v[52:55], v[196:199], v[148:151], v[52:55]
    v_mfma_f32_16x16x32_bf16 v[48:51], v[200:203], v[136:139], v[48:51]
    v_mfma_f32_16x16x32_bf16 v[52:55], v[200:203], v[152:155], v[52:55]
    v_mfma_f32_16x16x32_bf16 v[48:51], v[204:207], v[140:143], v[48:51]
    v_mfma_f32_16x16x32_bf16 v[52:55], v[204:207], v[156:159], v[52:55]
    s_mov_b32 s45, 0x3e0293ee
    s_nop 6
    v_permlane32_swap_b32 v48, v50
    v_permlane32_swap_b32 v49, v51
    v_pk_add_f32 v[48:49], v[48:49], v[50:51]
    v_permlane32_swap_b32 v52, v54
    v_permlane32_swap_b32 v53, v55
    v_pk_add_f32 v[52:53], v[52:53], v[54:55]
    v_max_f32 v22, v32, v33
    v_max3_f32 v22, v22, v34, v35
    v_max3_f32 v22, v22, v48, v49
    v_max_f32 v23, v36, v37
    v_max3_f32 v23, v23, v38, v39
    v_max3_f32 v23, v23, v44, v45
    v_max3_f32 v23, v23, v46, v47
    v_max3_f32 v23, v23, v52, v53
    v_mov_b32 v24, v22
    v_mov_b32 v25, v23
    s_nop 0
    v_permlane32_swap_b32 v22, v24
    v_permlane32_swap_b32 v23, v25
    v_max_f32 v22, v22, v24
    v_max_f32 v23, v23, v25
    v_mov_b32 v24, v22
    v_mov_b32 v25, v23
    s_nop 0
    v_permlane16_swap_b32 v22, v24
    v_permlane16_swap_b32 v23, v25
    v_max_f32 v22, v22, v24
    v_max_f32 v23, v23, v25
    v_mul_f32 v22, s45, v22
    v_mul_f32 v23, s45, v23
    v_fma_f32 v32, v32, s45, -v22
    v_fma_f32 v33, v33, s45, -v22
    v_fma_f32 v34, v34, s45, -v22
    v_fma_f32 v35, v35, s45, -v22
    v_fma_f32 v48, v48, s45, -v22
    v_fma_f32 v49, v49, s45, -v22
    v_exp_f32 v32, v32
    v_exp_f32 v33, v33
    v_exp_f32 v34, v34
    v_exp_f32 v35, v35
    v_exp_f32 v48, v48
    v_exp_f32 v49, v49
    v_fma_f32 v36, v36, s45, -v23
    v_fma_f32 v37, v37, s45, -v23
    v_fma_f32 v38, v38, s45, -v23
    v_fma_f32 v39, v39, s45, -v23
    v_fma_f32 v44, v44, s45, -v23
    v_fma_f32 v45, v45, s45, -v23
    v_fma_f32 v46, v46, s45, -v23
    v_fma_f32 v47, v47, s45, -v23
    v_fma_f32 v52, v52, s45, -v23
    v_fma_f32 v53, v53, s45, -v23
    v_exp_f32 v36, v36
    v_exp_f32 v37, v37
    v_exp_f32 v38, v38
    v_exp_f32 v39, v39
    v_exp_f32 v44, v44
    v_exp_f32 v45, v45
    v_exp_f32 v46, v46
    v_exp_f32 v47, v47
    v_exp_f32 v52, v52
    v_exp_f32 v53, v53
    v_add_f32 v22, v32, v33
    v_add_f32 v22, v22, v34
    v_add_f32 v22, v22, v35
    v_add_f32 v22, v22, v48
    v_add_f32 v22, v22, v49
    v_add_f32 v23, v36, v37
    v_add_f32 v23, v23, v38
    v_add_f32 v23, v23, v39
    v_add_f32 v23, v23, v44
    v_add_f32 v23, v23, v45
    v_add_f32 v23, v23, v46
    v_add_f32 v23, v23, v47
    v_add_f32 v23, v23, v52
    v_add_f32 v23, v23, v53
    v_mov_b32 v24, v22
    v_mov_b32 v25, v23
    s_nop 0
    v_permlane32_swap_b32 v22, v24
    v_permlane32_swap_b32 v23, v25
    v_add_f32 v22, v22, v24
    v_add_f32 v23, v23, v25
    v_mov_b32 v24, v22
    v_mov_b32 v25, v23
    s_nop 0
    v_permlane16_swap_b32 v22, v24
    v_permlane16_swap_b32 v23, v25
    v_add_f32 v22, v22, v24
    v_add_f32 v23, v23, v25
    v_rcp_f32 v22, v22
    v_rcp_f32 v23, v23
    s_nop 0
    v_mul_f32 v32, v32, v22
    v_mul_f32 v33, v33, v22
    v_mul_f32 v34, v34, v22
    v_mul_f32 v35, v35, v22
    v_mul_f32 v48, v48, v22
    v_mul_f32 v49, v49, v22
    v_mul_f32 v36, v36, v23
    v_mul_f32 v37, v37, v23
    v_mul_f32 v38, v38, v23
    v_mul_f32 v39, v39, v23
    v_mul_f32 v44, v44, v23
    v_mul_f32 v45, v45, v23
    v_mul_f32 v46, v46, v23
    v_mul_f32 v47, v47, v23
    v_mul_f32 v52, v52, v23
    v_mul_f32 v53, v53, v23
    v_cvt_pk_bf16_f32 v128, v32, v33
    v_cvt_pk_bf16_f32 v129, v34, v35
    v_mov_b32 v130, 0
    v_mov_b32 v131, 0
    v_cvt_pk_bf16_f32 v132, v48, v49
    v_mov_b32 v133, 0
    v_mov_b32 v134, 0
    v_cvt_pk_bf16_f32 v135, v48, v49
    v_cvt_pk_bf16_f32 v136, v36, v37
    v_cvt_pk_bf16_f32 v137, v38, v39
    v_cvt_pk_bf16_f32 v138, v44, v45
    v_cvt_pk_bf16_f32 v139, v46, v47
    v_cvt_pk_bf16_f32 v140, v52, v53
    v_mov_b32 v141, 0
    v_mov_b32 v142, 0
    v_cvt_pk_bf16_f32 v143, v52, v53
    s_waitcnt vmcnt(0) lgkmcnt(0)
    s_nop 0
    v_mfma_f32_16x16x32_bf16 v[64:67], v[208:211], v[128:131], 0
    v_mfma_f32_16x16x32_bf16 v[68:71], v[212:215], v[128:131], 0
    v_mfma_f32_16x16x32_bf16 v[72:75], v[216:219], v[128:131], 0
    v_mfma_f32_16x16x32_bf16 v[76:79], v[220:223], v[128:131], 0
    v_mfma_f32_16x16x32_bf16 v[80:83], v[224:227], v[128:131], 0
    v_mfma_f32_16x16x32_bf16 v[84:87], v[228:231], v[128:131], 0
    v_mfma_f32_16x16x32_bf16 v[88:91], v[232:235], v[128:131], 0
    v_mfma_f32_16x16x32_bf16 v[92:95], v[236:239], v[128:131], 0
    v_mfma_f32_16x16x16_bf16 v[64:67], v[240:241], v[132:133], v[64:67]
    v_mfma_f32_16x16x16_bf16 v[68:71], v[240:241], v[134:135], v[68:71]
    v_mfma_f32_16x16x16_bf16 v[72:75], v[242:243], v[132:133], v[72:75]
    v_mfma_f32_16x16x16_bf16 v[76:79], v[242:243], v[134:135], v[76:79]
    v_mfma_f32_16x16x16_bf16 v[80:83], v[244:245], v[132:133], v[80:83]
    v_mfma_f32_16x16x16_bf16 v[84:87], v[244:245], v[134:135], v[84:87]
    v_mfma_f32_16x16x16_bf16 v[88:91], v[246:247], v[132:133], v[88:91]
    v_mfma_f32_16x16x16_bf16 v[92:95], v[246:247], v[134:135], v[92:95]
    v_mfma_f32_16x16x32_bf16 v[96:99], v[208:211], v[136:139], 0
    v_mfma_f32_16x16x32_bf16 v[100:103], v[212:215], v[136:139], 0
    v_mfma_f32_16x16x32_bf16 v[104:107], v[216:219], v[136:139], 0
    v_mfma_f32_16x16x32_bf16 v[108:111], v[220:223], v[136:139], 0
    v_mfma_f32_16x16x32_bf16 v[112:115], v[224:227], v[136:139], 0
    v_mfma_f32_16x16x32_bf16 v[116:119], v[228:231], v[136:139], 0
    v_mfma_f32_16x16x32_bf16 v[120:123], v[232:235], v[136:139], 0
    v_mfma_f32_16x16x32_bf16 v[124:127], v[236:239], v[136:139], 0
    v_mfma_f32_16x16x16_bf16 v[96:99], v[240:241], v[140:141], v[96:99]
    v_mfma_f32_16x16x16_bf16 v[100:103], v[240:241], v[142:143], v[100:103]
    v_mfma_f32_16x16x16_bf16 v[104:107], v[242:243], v[140:141], v[104:107]
    v_mfma_f32_16x16x16_bf16 v[108:111], v[242:243], v[142:143], v[108:111]
    v_mfma_f32_16x16x16_bf16 v[112:115], v[244:245], v[140:141], v[112:115]
    v_mfma_f32_16x16x16_bf16 v[116:119], v[244:245], v[142:143], v[116:119]
    v_mfma_f32_16x16x16_bf16 v[120:123], v[246:247], v[140:141], v[120:123]
    v_mfma_f32_16x16x16_bf16 v[124:127], v[246:247], v[142:143], v[124:127]
    s_lshl_b32 s45, s63, 18
    s_lshl_b32 s46, s41, 13
    s_add_u32 s45, s45, s46
    s_add_u32 s45, s45, 0x5000000
    s_add_u32 s46, s45, 4096
    v_cvt_pk_bf16_f32 v64, v64, v65
    v_cvt_pk_bf16_f32 v65, v66, v67
    v_cvt_pk_bf16_f32 v66, v68, v69
    v_cvt_pk_bf16_f32 v67, v70, v71
    buffer_store_dwordx4 v[64:67], v10, s[12:15], s45 offen offset:0 sc1
    v_cvt_pk_bf16_f32 v72, v72, v73
    v_cvt_pk_bf16_f32 v73, v74, v75
    v_cvt_pk_bf16_f32 v74, v76, v77
    v_cvt_pk_bf16_f32 v75, v78, v79
    buffer_store_dwordx4 v[72:75], v10, s[12:15], s45 offen offset:2048 sc1
    v_cvt_pk_bf16_f32 v80, v80, v81
    v_cvt_pk_bf16_f32 v81, v82, v83
    v_cvt_pk_bf16_f32 v82, v84, v85
    v_cvt_pk_bf16_f32 v83, v86, v87
    buffer_store_dwordx4 v[80:83], v10, s[12:15], s46 offen offset:0 sc1
    v_cvt_pk_bf16_f32 v88, v88, v89
    v_cvt_pk_bf16_f32 v89, v90, v91
    v_cvt_pk_bf16_f32 v90, v92, v93
    v_cvt_pk_bf16_f32 v91, v94, v95
    buffer_store_dwordx4 v[88:91], v10, s[12:15], s46 offen offset:2048 sc1
    v_cvt_pk_bf16_f32 v96, v96, v97
    v_cvt_pk_bf16_f32 v97, v98, v99
    v_cvt_pk_bf16_f32 v98, v100, v101
    v_cvt_pk_bf16_f32 v99, v102, v103
    buffer_store_dwordx4 v[96:99], v10, s[12:15], s45 offen offset:1024 sc1
    v_cvt_pk_bf16_f32 v104, v104, v105
    v_cvt_pk_bf16_f32 v105, v106, v107
    v_cvt_pk_bf16_f32 v106, v108, v109
    v_cvt_pk_bf16_f32 v107, v110, v111
    buffer_store_dwordx4 v[104:107], v10, s[12:15], s45 offen offset:3072 sc1
    v_cvt_pk_bf16_f32 v112, v112, v113
    v_cvt_pk_bf16_f32 v113, v114, v115
    v_cvt_pk_bf16_f32 v114, v116, v117
    v_cvt_pk_bf16_f32 v115, v118, v119
    buffer_store_dwordx4 v[112:115], v10, s[12:15], s46 offen offset:1024 sc1
    v_cvt_pk_bf16_f32 v120, v120, v121
    v_cvt_pk_bf16_f32 v121, v122, v123
    v_cvt_pk_bf16_f32 v122, v124, v125
    v_cvt_pk_bf16_f32 v123, v126, v127
    buffer_store_dwordx4 v[120:123], v10, s[12:15], s46 offen offset:3072 sc1
L_xs2_129:
    s_waitcnt vmcnt(0)
    s_barrier
    s_cmp_lg_u32 s44, 0
    s_cbranch_scc1 L_pub_132
    v_mov_b32 v30, s62
    v_mov_b32 v31, 0
    s_mov_b64 exec, 1
    buffer_store_dword v30, v31, s[12:15], s65 offen sc1
    s_mov_b64 exec, -1
L_pub_132:
    s_lshl_b32 s45, s38, 10
    s_add_u32 s45, s45, s64
    s_cmp_lg_u32 s44, 0
    s_cbranch_scc1 L_pw_133
    s_mov_b64 exec, 255
    s_mov_b32 s70, 0
L_wp_134:
    buffer_load_dword v31, v5, s[12:15], s45 offen sc1
    s_add_u32 s70, s70, 1
    s_cmp_ge_u32 s70, 0x200000
    s_cbranch_scc1 L_w_done_102
    s_waitcnt vmcnt(0)
    v_cmp_gt_u32 vcc, s62, v31
    s_nop 1
    s_cbranch_vccz L_wp_134_ok
    s_sleep 1
    s_branch L_wp_134
L_wp_134_ok:
    s_mov_b64 exec, -1
L_pw_133:
    s_barrier
    s_mul_i32 s53, s50, 262144
    s_add_u32 s53, s53, s52
    s_lshl_b32 s54, s44, 13
    s_add_u32 s53, s53, s54
    s_mul_i32 s57, s50, 131072
    s_add_u32 s57, s57, s56
    s_lshl_b32 s45, s44, 7
    s_add_u32 s57, s57, s45
    s_add_u32 s55, s54, 65536
    s_mov_b32 s58, 0
    v_mov_b32 v13, v10
    v_add_u32 v14, 65536, v13
    v_xor_b32 v15, 64, v13
    v_xor_b32 v16, 64, v14
    s_mov_b32 s76, 0x20000000
    s_add_u32 s48, s53, 0
    s_add_u32 s49, s48, 4096
    s_add_u32 m0, s54, 0
    s_nop 0
    buffer_load_dwordx4 v10, s[12:15], s48 offen offset:0 sc1 lds
    buffer_load_dwordx4 v10, s[12:15], s48 offen offset:1024 sc1 lds
    buffer_load_dwordx4 v10, s[12:15], s48 offen offset:2048 sc1 lds
    buffer_load_dwordx4 v10, s[12:15], s48 offen offset:3072 sc1 lds
    s_add_u32 m0, s54, 4096
    s_nop 0
    buffer_load_dwordx4 v10, s[12:15], s49 offen offset:0 sc1 lds
    buffer_load_dwordx4 v10, s[12:15], s49 offen offset:1024 sc1 lds
    buffer_load_dwordx4 v10, s[12:15], s49 offen offset:2048 sc1 lds
    buffer_load_dwordx4 v10, s[12:15], s49 offen offset:3072 sc1 lds
    s_add_u32 s48, s53, 32768
    s_add_u32 s49, s48, 4096
    s_add_u32 s46, s54, 32768
    s_add_u32 m0, s46, 0
    s_nop 0
    buffer_load_dwordx4 v10, s[12:15], s48 offen offset:0 sc1 lds
    buffer_load_dwordx4 v10, s[12:15], s48 offen offset:1024 sc1 lds
    buffer_load_dwordx4 v10, s[12:15], s48 offen offset:2048 sc1 lds
    buffer_load_dwordx4 v10, s[12:15], s48 offen offset:3072 sc1 lds
    s_add_u32 m0, s46, 4096
    s_nop 0
    buffer_load_dwordx4 v10, s[12:15], s49 offen offset:0 sc1 lds
    buffer_load_dwordx4 v10, s[12:15], s49 offen offset:1024 sc1 lds
    buffer_load_dwordx4 v10, s[12:15], s49 offen offset:2048 sc1 lds
    buffer_load_dwordx4 v10, s[12:15], s49 offen offset:3072 sc1 lds
    s_add_u32 s48, s53, 262144
    s_cmp_gt_u32 s51, 1
    s_cselect_b32 s48, s48, 0x20000000
    s_add_u32 s49, s48, 4096
    s_add_u32 m0, s55, 0
    s_nop 0
    buffer_load_dwordx4 v10, s[12:15], s48 offen offset:0 sc1 lds
    buffer_load_dwordx4 v10, s[12:15], s48 offen offset:1024 sc1 lds
    buffer_load_dwordx4 v10, s[12:15], s48 offen offset:2048 sc1 lds
    buffer_load_dwordx4 v10, s[12:15], s48 offen offset:3072 sc1 lds
    s_add_u32 m0, s55, 4096
    s_nop 0
    buffer_load_dwordx4 v10, s[12:15], s49 offen offset:0 sc1 lds
    buffer_load_dwordx4 v10, s[12:15], s49 offen offset:1024 sc1 lds
    buffer_load_dwordx4 v10, s[12:15], s49 offen offset:2048 sc1 lds
    buffer_load_dwordx4 v10, s[12:15], s49 offen offset:3072 sc1 lds
    s_waitcnt vmcnt(16)
    s_barrier
    ds_read_b128 v[32:35], v13 offset:0
    ds_read_b128 v[36:39], v13 offset:1024
    ds_read_b128 v[40:43], v13 offset:2048
    ds_read_b128 v[44:47], v13 offset:3072
L_e_loop_135:
    s_add_u32 s48, s53, 294912
    s_add_u32 s46, s58, 1
    s_cmp_lt_u32 s46, s51
    s_cselect_b32 s48, s48, 0x20000000
    s_add_u32 s49, s48, 4096
    s_add_u32 s59, s55, 32768
    s_waitcnt lgkmcnt(2)
    v_mfma_f32_16x16x32_bf16 v[80:83], a[0:3], v[32:35], 0
    ds_read_b128 v[48:51], v13 offset:4096
    ds_read_b128 v[52:55], v13 offset:5120
    v_mfma_f32_16x16x32_bf16 v[84:87], a[4:7], v[32:35], 0
    ds_read_b128 v[56:59], v13 offset:6144
    ds_read_b128 v[60:63], v13 offset:7168
    v_mfma_f32_16x16x32_bf16 v[88:91], a[0:3], v[36:39], 0
    s_add_u32 m0, s59, 0
    s_nop 0
    buffer_load_dwordx4 v10, s[12:15], s48 offen offset:0 sc1 lds
    v_mfma_f32_16x16x32_bf16 v[92:95], a[4:7], v[36:39], 0
    s_waitcnt lgkmcnt(4)
    v_mfma_f32_16x16x32_bf16 v[80:83], a[8:11], v[40:43], v[80:83]
    ds_read_b128 v[32:35], v13 offset:8192
    ds_read_b128 v[36:39], v13 offset:9216
    v_mfma_f32_16x16x32_bf16 v[84:87], a[12:15], v[40:43], v[84:87]
    v_mfma_f32_16x16x32_bf16 v[88:91], a[8:11], v[44:47], v[88:91]
    buffer_load_dwordx4 v10, s[12:15], s48 offen offset:1024 sc1 lds
    v_mfma_f32_16x16x32_bf16 v[92:95], a[12:15], v[44:47], v[92:95]
    s_waitcnt lgkmcnt(4)
    v_mfma_f32_16x16x32_bf16 v[80:83], a[16:19], v[48:51], v[80:83]
    ds_read_b128 v[40:43], v13 offset:10240
    ds_read_b128 v[44:47], v13 offset:11264
    v_mfma_f32_16x16x32_bf16 v[84:87], a[20:23], v[48:51], v[84:87]
    v_mfma_f32_16x16x32_bf16 v[88:91], a[16:19], v[52:55], v[88:91]
    buffer_load_dwordx4 v10, s[12:15], s48 offen offset:2048 sc1 lds
    v_mfma_f32_16x16x32_bf16 v[92:95], a[20:23], v[52:55], v[92:95]
    s_waitcnt lgkmcnt(4)
    v_mfma_f32_16x16x32_bf16 v[80:83], a[24:27], v[56:59], v[80:83]
    ds_read_b128 v[48:51], v13 offset:12288
    ds_read_b128 v[52:55], v13 offset:13312
    v_mfma_f32_16x16x32_bf16 v[84:87], a[28:31], v[56:59], v[84:87]
    v_mfma_f32_16x16x32_bf16 v[88:91], a[24:27], v[60:63], v[88:91]
    buffer_load_dwordx4 v10, s[12:15], s48 offen offset:3072 sc1 lds
    v_mfma_f32_16x16x32_bf16 v[92:95], a[28:31], v[60:63], v[92:95]
    s_waitcnt lgkmcnt(4)
    v_mfma_f32_16x16x32_bf16 v[80:83], a[32:35], v[32:35], v[80:83]
    ds_read_b128 v[56:59], v13 offset:14336
    ds_read_b128 v[60:63], v13 offset:15360
    v_mfma_f32_16x16x32_bf16 v[84:87], a[36:39], v[32:35], v[84:87]
    v_mfma_f32_16x16x32_bf16 v[88:91], a[32:35], v[36:39], v[88:91]
    s_add_u32 m0, s59, 4096
    s_nop 0
    buffer_load_dwordx4 v10, s[12:15], s49 offen offset:0 sc1 lds
    v_mfma_f32_16x16x32_bf16 v[92:95], a[36:39], v[36:39], v[92:95]
    s_waitcnt lgkmcnt(4)
    v_mfma_f32_16x16x32_bf16 v[80:83], a[40:43], v[40:43], v[80:83]
    ds_read_b128 v[32:35], v13 offset:16384
    ds_read_b128 v[36:39], v13 offset:17408
    v_mfma_f32_16x16x32_bf16 v[84:87], a[44:47], v[40:43], v[84:87]
    v_mfma_f32_16x16x32_bf16 v[88:91], a[40:43], v[44:47], v[88:91]
    buffer_load_dwordx4 v10, s[12:15], s49 offen offset:1024 sc1 lds
    v_mfma_f32_16x16x32_bf16 v[92:95], a[44:47], v[44:47], v[92:95]
    s_waitcnt lgkmcnt(4)
    v_mfma_f32_16x16x32_bf16 v[80:83], a[48:51], v[48:51], v[80:83]
    ds_read_b128 v[40:43], v13 offset:18432
    ds_read_b128 v[44:47], v13 offset:19456
    v_mfma_f32_16x16x32_bf16 v[84:87], a[52:55], v[48:51], v[84:87]
    v_mfma_f32_16x16x32_bf16 v[88:91], a[48:51], v[52:55], v[88:91]
    buffer_load_dwordx4 v10, s[12:15], s49 offen offset:2048 sc1 lds
    v_mfma_f32_16x16x32_bf16 v[92:95], a[52:55], v[52:55], v[92:95]
    s_waitcnt lgkmcnt(4)
    v_mfma_f32_16x16x32_bf16 v[80:83], a[56:59], v[56:59], v[80:83]
    ds_read_b128 v[48:51], v13 offset:20480
    ds_read_b128 v[52:55], v13 offset:21504
    v_mfma_f32_16x16x32_bf16 v[84:87], a[60:63], v[56:59], v[84:87]
    v_mfma_f32_16x16x32_bf16 v[88:91], a[56:59], v[60:63], v[88:91]
    buffer_load_dwordx4 v10, s[12:15], s49 offen offset:3072 sc1 lds
    v_mfma_f32_16x16x32_bf16 v[92:95], a[60:63], v[60:63], v[92:95]
    s_waitcnt lgkmcnt(4)
    v_mfma_f32_16x16x32_bf16 v[80:83], a[64:67], v[32:35], v[80:83]
    ds_read_b128 v[56:59], v13 offset:22528
    ds_read_b128 v[60:63], v13 offset:23552
    v_mfma_f32_16x16x32_bf16 v[84:87], a[68:71], v[32:35], v[84:87]
    v_mfma_f32_16x16x32_bf16 v[88:91], a[64:67], v[36:39], v[88:91]
    v_mfma_f32_16x16x32_bf16 v[92:95], a[68:71], v[36:39], v[92:95]
    s_waitcnt lgkmcnt(4)
    v_mfma_f32_16x16x32_bf16 v[80:83], a[72:75], v[40:43], v[80:83]
    ds_read_b128 v[32:35], v13 offset:24576
    ds_read_b128 v[36:39], v13 offset:25600
    v_mfma_f32_16x16x32_bf16 v[84:87], a[76:79], v[40:43], v[84:87]
    v_mfma_f32_16x16x32_bf16 v[88:91], a[72:75], v[44:47], v[88:91]
    v_mfma_f32_16x16x32_bf16 v[92:95], a[76:79], v[44:47], v[92:95]
    s_waitcnt lgkmcnt(4)
    v_mfma_f32_16x16x32_bf16 v[80:83], a[80:83], v[48:51], v[80:83]
    ds_read_b128 v[40:43], v13 offset:26624
    ds_read_b128 v[44:47], v13 offset:27648
    v_mfma_f32_16x16x32_bf16 v[84:87], a[84:87], v[48:51], v[84:87]
    v_mfma_f32_16x16x32_bf16 v[88:91], a[80:83], v[52:55], v[88:91]
    v_mfma_f32_16x16x32_bf16 v[92:95], a[84:87], v[52:55], v[92:95]
    s_waitcnt lgkmcnt(4)
    v_mfma_f32_16x16x32_bf16 v[80:83], a[88:91], v[56:59], v[80:83]
    ds_read_b128 v[48:51], v13 offset:28672
    ds_read_b128 v[52:55], v13 offset:29696
    v_mfma_f32_16x16x32_bf16 v[84:87], a[92:95], v[56:59], v[84:87]
    v_mfma_f32_16x16x32_bf16 v[88:91], a[88:91], v[60:63], v[88:91]
    v_mfma_f32_16x16x32_bf16 v[92:95], a[92:95], v[60:63], v[92:95]
    s_waitcnt lgkmcnt(4)
    v_mfma_f32_16x16x32_bf16 v[80:83], a[96:99], v[32:35], v[80:83]
    ds_read_b128 v[56:59], v13 offset:30720
    ds_read_b128 v[60:63], v13 offset:31744
    v_mfma_f32_16x16x32_bf16 v[84:87], a[100:103], v[32:35], v[84:87]
    v_mfma_f32_16x16x32_bf16 v[88:91], a[96:99], v[36:39], v[88:91]
    v_mfma_f32_16x16x32_bf16 v[92:95], a[100:103], v[36:39], v[92:95]
    s_waitcnt lgkmcnt(4)
    v_mfma_f32_16x16x32_bf16 v[80:83], a[104:107], v[40:43], v[80:83]
    ds_read_b128 v[216:219], v8 offset:0
    ds_read_b128 v[220:223], v8 offset:1152
    v_mfma_f32_16x16x32_bf16 v[84:87], a[108:111], v[40:43], v[84:87]
    ds_read_b128 v[224:227], v8 offset:2304
    ds_read_b128 v[228:231], v8 offset:3456
    v_mfma_f32_16x16x32_bf16 v[88:91], a[104:107], v[44:47], v[88:91]
    v_mfma_f32_16x16x32_bf16 v[92:95], a[108:111], v[44:47], v[92:95]
    s_waitcnt vmcnt(16) lgkmcnt(0)
    s_barrier
    v_mfma_f32_16x16x32_bf16 v[80:83], a[112:115], v[48:51], v[80:83]
    ds_read_b128 v[32:35], v13 offset:32768
    ds_read_b128 v[36:39], v13 offset:33792
    v_mfma_f32_16x16x32_bf16 v[84:87], a[116:119], v[48:51], v[84:87]
    buffer_store_dwordx4 v[216:219], v11, s[12:15], s76 offen sc1
    v_mfma_f32_16x16x32_bf16 v[88:91], a[112:115], v[52:55], v[88:91]
    s_add_u32 s76, s76, 32768
    v_mfma_f32_16x16x32_bf16 v[92:95], a[116:119], v[52:55], v[92:95]
    buffer_store_dwordx4 v[220:223], v11, s[12:15], s76 offen sc1
    v_mfma_f32_16x16x32_bf16 v[80:83], a[120:123], v[56:59], v[80:83]
    ds_read_b128 v[40:43], v13 offset:34816
    ds_read_b128 v[44:47], v13 offset:35840
    v_mfma_f32_16x16x32_bf16 v[84:87], a[124:127], v[56:59], v[84:87]
    s_add_u32 s76, s76, 32768
    v_mfma_f32_16x16x32_bf16 v[88:91], a[120:123], v[60:63], v[88:91]
    buffer_store_dwordx4 v[224:227], v11, s[12:15], s76 offen sc1
    v_mfma_f32_16x16x32_bf16 v[92:95], a[124:127], v[60:63], v[92:95]
    s_add_u32 s76, s76, 32768
    s_add_u32 s48, s53, 524288
    s_add_u32 s46, s58, 2
    s_cmp_lt_u32 s46, s51
    s_cselect_b32 s48, s48, 0x20000000
    s_add_u32 s49, s48, 4096
    s_mov_b32 s59, s54
    s_waitcnt lgkmcnt(2)
    v_mfma_f32_16x16x32_bf16 v[80:83], a[128:131], v[32:35], v[80:83]
    ds_read_b128 v[48:51], v13 offset:36864
    ds_read_b128 v[52:55], v13 offset:37888
    v_mfma_f32_16x16x32_bf16 v[84:87], a[132:135], v[32:35], v[84:87]
    ds_read_b128 v[56:59], v13 offset:38912
    ds_read_b128 v[60:63], v13 offset:39936
    v_mfma_f32_16x16x32_bf16 v[88:91], a[128:131], v[36:39], v[88:91]
    s_add_u32 m0, s59, 0
    s_nop 0
    buffer_load_dwordx4 v10, s[12:15], s48 offen offset:0 sc1 lds
    v_mfma_f32_16x16x32_bf16 v[92:95], a[132:135], v[36:39], v[92:95]
    buffer_store_dwordx4 v[228:231], v11, s[12:15], s76 offen sc1
    s_waitcnt lgkmcnt(4)
    v_mfma_f32_16x16x32_bf16 v[80:83], a[136:139], v[40:43], v[80:83]
    ds_read_b128 v[32:35], v13 offset:40960
    ds_read_b128 v[36:39], v13 offset:41984
    v_mfma_f32_16x16x32_bf16 v[84:87], a[140:143], v[40:43], v[84:87]
    v_mfma_f32_16x16x32_bf16 v[88:91], a[136:139], v[44:47], v[88:91]
    buffer_load_dwordx4 v10, s[12:15], s48 offen offset:1024 sc1 lds
    v_mfma_f32_16x16x32_bf16 v[92:95], a[140:143], v[44:47], v[92:95]
    s_waitcnt lgkmcnt(4)
    v_mfma_f32_16x16x32_bf16 v[80:83], a[144:147], v[48:51], v[80:83]
    ds_read_b128 v[40:43], v13 offset:43008
    ds_read_b128 v[44:47], v13 offset:44032
    v_mfma_f32_16x16x32_bf16 v[84:87], a[148:151], v[48:51], v[84:87]
    v_mfma_f32_16x16x32_bf16 v[88:91], a[144:147], v[52:55], v[88:91]
    buffer_load_dwordx4 v10, s[12:15], s48 offen offset:2048 sc1 lds
    v_mfma_f32_16x16x32_bf16 v[92:95], a[148:151], v[52:55], v[92:95]
    s_waitcnt lgkmcnt(4)
    v_mfma_f32_16x16x32_bf16 v[80:83], a[152:155], v[56:59], v[80:83]
    ds_read_b128 v[48:51], v13 offset:45056
    ds_read_b128 v[52:55], v13 offset:46080
    v_mfma_f32_16x16x32_bf16 v[84:87], a[156:159], v[56:59], v[84:87]
    v_mfma_f32_16x16x32_bf16 v[88:91], a[152:155], v[60:63], v[88:91]
    buffer_load_dwordx4 v10, s[12:15], s48 offen offset:3072 sc1 lds
    v_mfma_f32_16x16x32_bf16 v[92:95], a[156:159], v[60:63], v[92:95]
    s_waitcnt lgkmcnt(4)
    v_mfma_f32_16x16x32_bf16 v[80:83], a[160:163], v[32:35], v[80:83]
    ds_read_b128 v[56:59], v13 offset:47104
    ds_read_b128 v[60:63], v13 offset:48128
    v_mfma_f32_16x16x32_bf16 v[84:87], a[164:167], v[32:35], v[84:87]
    v_mfma_f32_16x16x32_bf16 v[88:91], a[160:163], v[36:39], v[88:91]
    s_add_u32 m0, s59, 4096
    s_nop 0
    buffer_load_dwordx4 v10, s[12:15], s49 offen offset:0 sc1 lds
    v_mfma_f32_16x16x32_bf16 v[92:95], a[164:167], v[36:39], v[92:95]
    s_waitcnt lgkmcnt(4)
    v_mfma_f32_16x16x32_bf16 v[80:83], a[168:171], v[40:43], v[80:83]
    ds_read_b128 v[32:35], v13 offset:49152
    ds_read_b128 v[36:39], v13 offset:50176
    v_mfma_f32_16x16x32_bf16 v[84:87], a[172:175], v[40:43], v[84:87]
    v_mfma_f32_16x16x32_bf16 v[88:91], a[168:171], v[44:47], v[88:91]
    buffer_load_dwordx4 v10, s[12:15], s49 offen offset:1024 sc1 lds
    v_mfma_f32_16x16x32_bf16 v[92:95], a[172:175], v[44:47], v[92:95]
    s_waitcnt lgkmcnt(4)
    v_mfma_f32_16x16x32_bf16 v[80:83], a[176:179], v[48:51], v[80:83]
    ds_read_b128 v[40:43], v13 offset:51200
    ds_read_b128 v[44:47], v13 offset:52224
    v_mfma_f32_16x16x32_bf16 v[84:87], a[180:183], v[48:51], v[84:87]
    v_mfma_f32_16x16x32_bf16 v[88:91], a[176:179], v[52:55], v[88:91]
    buffer_load_dwordx4 v10, s[12:15], s49 offen offset:2048 sc1 lds
    v_mfma_f32_16x16x32_bf16 v[92:95], a[180:183], v[52:55], v[92:95]
    s_waitcnt lgkmcnt(4)
    v_mfma_f32_16x16x32_bf16 v[80:83], a[184:187], v[56:59], v[80:83]
    ds_read_b128 v[48:51], v13 offset:53248
    ds_read_b128 v[52:55], v13 offset:54272
    v_mfma_f32_16x16x32_bf16 v[84:87], a[188:191], v[56:59], v[84:87]
    v_mfma_f32_16x16x32_bf16 v[88:91], a[184:187], v[60:63], v[88:91]
    buffer_load_dwordx4 v10, s[12:15], s49 offen offset:3072 sc1 lds
    v_mfma_f32_16x16x32_bf16 v[92:95], a[188:191], v[60:63], v[92:95]
    s_waitcnt lgkmcnt(4)
    v_mfma_f32_16x16x32_bf16 v[80:83], a[192:195], v[32:35], v[80:83]
    ds_read_b128 v[56:59], v13 offset:55296
    ds_read_b128 v[60:63], v13 offset:56320
    v_mfma_f32_16x16x32_bf16 v[84:87], a[196:199], v[32:35], v[84:87]
    v_mfma_f32_16x16x32_bf16 v[88:91], a[192:195], v[36:39], v[88:91]
    v_mfma_f32_16x16x32_bf16 v[92:95], a[196:199], v[36:39], v[92:95]
    s_waitcnt lgkmcnt(4)
    v_mfma_f32_16x16x32_bf16 v[80:83], a[200:203], v[40:43], v[80:83]
    ds_read_b128 v[32:35], v13 offset:57344
    ds_read_b128 v[36:39], v13 offset:58368
    v_mfma_f32_16x16x32_bf16 v[84:87], a[204:207], v[40:43], v[84:87]
    v_mfma_f32_16x16x32_bf16 v[88:91], a[200:203], v[44:47], v[88:91]
    v_mfma_f32_16x16x32_bf16 v[92:95], a[204:207], v[44:47], v[92:95]
    s_waitcnt lgkmcnt(4)
    v_mfma_f32_16x16x32_bf16 v[80:83], a[208:211], v[48:51], v[80:83]
    ds_read_b128 v[40:43], v13 offset:59392
    ds_read_b128 v[44:47], v13 offset:60416
    v_mfma_f32_16x16x32_bf16 v[84:87], a[212:215], v[48:51], v[84:87]
    v_mfma_f32_16x16x32_bf16 v[88:91], a[208:211], v[52:55], v[88:91]
    v_mfma_f32_16x16x32_bf16 v[92:95], a[212:215], v[52:55], v[92:95]
    s_waitcnt lgkmcnt(4)
    v_mfma_f32_16x16x32_bf16 v[80:83], a[216:219], v[56:59], v[80:83]
    ds_read_b128 v[48:51], v13 offset:61440
    ds_read_b128 v[52:55], v13 offset:62464
    v_mfma_f32_16x16x32_bf16 v[84:87], a[220:223], v[56:59], v[84:87]
    v_mfma_f32_16x16x32_bf16 v[88:91], a[216:219], v[60:63], v[88:91]
    v_mfma_f32_16x16x32_bf16 v[92:95], a[220:223], v[60:63], v[92:95]
    s_waitcnt lgkmcnt(4)
    v_mfma_f32_16x16x32_bf16 v[80:83], a[224:227], v[32:35], v[80:83]
    ds_read_b128 v[56:59], v13 offset:63488
    ds_read_b128 v[60:63], v13 offset:64512
    v_mfma_f32_16x16x32_bf16 v[84:87], a[228:231], v[32:35], v[84:87]
    v_mfma_f32_16x16x32_bf16 v[88:91], a[224:227], v[36:39], v[88:91]
    v_mfma_f32_16x16x32_bf16 v[92:95], a[228:231], v[36:39], v[92:95]
    s_waitcnt lgkmcnt(4)
    v_mfma_f32_16x16x32_bf16 v[80:83], a[232:235], v[40:43], v[80:83]
    v_mfma_f32_16x16x32_bf16 v[84:87], a[236:239], v[40:43], v[84:87]
    v_mfma_f32_16x16x32_bf16 v[88:91], a[232:235], v[44:47], v[88:91]
    v_mfma_f32_16x16x32_bf16 v[92:95], a[236:239], v[44:47], v[92:95]
    s_waitcnt vmcnt(16) lgkmcnt(0)
    s_barrier
    v_mfma_f32_16x16x32_bf16 v[80:83], a[240:243], v[48:51], v[80:83]
    ds_read_b128 v[32:35], v14 offset:0
    ds_read_b128 v[36:39], v14 offset:1024
    v_mfma_f32_16x16x32_bf16 v[84:87], a[244:247], v[48:51], v[84:87]
    v_mfma_f32_16x16x32_bf16 v[88:91], a[240:243], v[52:55], v[88:91]
    v_mfma_f32_16x16x32_bf16 v[92:95], a[244:247], v[52:55], v[92:95]
    v_mfma_f32_16x16x32_bf16 v[80:83], a[248:251], v[56:59], v[80:83]
    ds_read_b128 v[40:43], v14 offset:2048
    ds_read_b128 v[44:47], v14 offset:3072
    v_mfma_f32_16x16x32_bf16 v[84:87], a[252:255], v[56:59], v[84:87]
    v_mfma_f32_16x16x32_bf16 v[88:91], a[248:251], v[60:63], v[88:91]
    v_mfma_f32_16x16x32_bf16 v[92:95], a[252:255], v[60:63], v[92:95]
    s_add_u32 s53, s53, 262144
    s_add_u32 s58, s58, 1
    v_swap_b32 v13, v14
    s_xor_b32 s54, s54, 65536
    s_xor_b32 s55, s55, 65536
    s_mov_b32 s76, s57
    v_swap_b32 v15, v16
    s_add_u32 s57, s57, 131072
    ds_write_b128 v7, v[80:83] offset:0
    ds_write_b128 v7, v[84:87] offset:64
    ds_write_b128 v7, v[88:91] offset:2304
    ds_write_b128 v7, v[92:95] offset:2368
    s_cmp_lt_u32 s58, s51
    s_cbranch_scc1 L_e_loop_135
    s_waitcnt lgkmcnt(0)
    ds_read_b128 v[216:219], v8 offset:0
    ds_read_b128 v[220:223], v8 offset:1152
    ds_read_b128 v[224:227], v8 offset:2304
    ds_read_b128 v[228:231], v8 offset:3456
    s_waitcnt lgkmcnt(0)
    buffer_store_dwordx4 v[216:219], v11, s[12:15], s76 offen sc1
    s_add_u32 s76, s76, 32768
    buffer_store_dwordx4 v[220:223], v11, s[12:15], s76 offen sc1
    s_add_u32 s76, s76, 32768
    buffer_store_dwordx4 v[224:227], v11, s[12:15], s76 offen sc1
    s_add_u32 s76, s76, 32768
    buffer_store_dwordx4 v[228:231], v11, s[12:15], s76 offen sc1
    s_waitcnt vmcnt(0)
    s_barrier
    s_cmp_lg_u32 s44, 0
    s_cbranch_scc1 L_pub_136
    v_mov_b32 v30, s62
    v_mov_b32 v31, 0
    s_mov_b64 exec, 1
    buffer_store_dword v30, v31, s[12:15], s67 offen sc1
    s_mov_b64 exec, -1
L_pub_136:
    s_branch L_a_loop_124
L_role_b_120:
    s_load_dwordx2 s[6:7], s[0:1], 64
    s_load_dwordx2 s[8:9], s[0:1], 72
    s_waitcnt lgkmcnt(0)
    s_mov_b32 s24, s6
    s_and_b32 s25, s7, 0xffff
    s_mov_b32 s26, 0x700000
    s_mov_b32 s27, 0x00020000
    s_mov_b32 s32, s8
    s_and_b32 s33, s9, 0xffff
    s_mov_b32 s34, 0x1c00
    s_mov_b32 s35, 0x00020000
    s_min_u32 s45, s41, 27
    s_lshl_b32 s46, s45, 8
    s_waitcnt vmcnt(0)
    s_barrier
    v_lshrrev_b32 v20, 4, v1
    s_lshl_b32 s45, s44, 2
    v_add_u32 v21, s45, v20
    s_mov_b32 s45, 7168
    v_mul_lo_u32 v21, v21, s45
    v_lshlrev_b32 v22, 2, v20
    v_and_b32 v23, 15, v1
    v_xor_b32 v22, v22, v23
    v_lshlrev_b32 v22, 4, v22
    v_add_u32 v21, v21, v22
    v_bfe_u32 v22, v1, 2, 2
    v_lshlrev_b32 v23, 3, v20
    v_add_u32 v23, v23, v22
    v_lshlrev_b32 v23, 8, v23
    v_xor_b32 v22, s44, v22
    v_lshlrev_b32 v22, 6, v22
    v_add_u32 v23, v23, v22
    v_and_b32 v22, 3, v1
    v_lshlrev_b32 v22, 4, v22
    v_add_u32 v23, v23, v22
    v_add_u32 v24, 65536, v23
    v_add_u32 v25, 131072, v23
    s_lshl_b32 s47, s44, 10
    s_add_u32 s45, s46, 0x0
    s_add_u32 m0, s47, 0
    s_nop 0
    buffer_load_dwordx4 v21, s[24:27], s45 offen  lds
    s_add_u32 s45, s46, 0x1c000
    s_add_u32 m0, s47, 4096
    s_nop 0
    buffer_load_dwordx4 v21, s[24:27], s45 offen  lds
    s_add_u32 s45, s46, 0x38000
    s_add_u32 m0, s47, 8192
    s_nop 0
    buffer_load_dwordx4 v21, s[24:27], s45 offen  lds
    s_add_u32 s45, s46, 0x54000
    s_add_u32 m0, s47, 12288
    s_nop 0
    buffer_load_dwordx4 v21, s[24:27], s45 offen  lds
    s_add_u32 s45, s46, 0x70000
    s_add_u32 m0, s47, 16384
    s_nop 0
    buffer_load_dwordx4 v21, s[24:27], s45 offen  lds
    s_add_u32 s45, s46, 0x8c000
    s_add_u32 m0, s47, 20480
    s_nop 0
    buffer_load_dwordx4 v21, s[24:27], s45 offen  lds
    s_add_u32 s45, s46, 0xa8000
    s_add_u32 m0, s47, 24576
    s_nop 0
    buffer_load_dwordx4 v21, s[24:27], s45 offen  lds
    s_add_u32 s45, s46, 0xc4000
    s_add_u32 m0, s47, 28672
    s_nop 0
    buffer_load_dwordx4 v21, s[24:27], s45 offen  lds
    s_add_u32 s45, s46, 0xe0000
    s_add_u32 m0, s47, 32768
    s_nop 0
    buffer_load_dwordx4 v21, s[24:27], s45 offen  lds
    s_add_u32 s45, s46, 0xfc000
    s_add_u32 m0, s47, 36864
    s_nop 0
    buffer_load_dwordx4 v21, s[24:27], s45 offen  lds
    s_add_u32 s45, s46, 0x118000
    s_add_u32 m0, s47, 40960
    s_nop 0
    buffer_load_dwordx4 v21, s[24:27], s45 offen  lds
    s_add_u32 s45, s46, 0x134000
    s_add_u32 m0, s47, 45056
    s_nop 0
    buffer_load_dwordx4 v21, s[24:27], s45 offen  lds
    s_add_u32 s45, s46, 0x150000
    s_add_u32 m0, s47, 49152
    s_nop 0
    buffer_load_dwordx4 v21, s[24:27], s45 offen  lds
    s_add_u32 s45, s46, 0x16c000
    s_add_u32 m0, s47, 53248
    s_nop 0
    buffer_load_dwordx4 v21, s[24:27], s45 offen  lds
    s_add_u32 s45, s46, 0x188000
    s_add_u32 m0, s47, 57344
    s_nop 0
    buffer_load_dwordx4 v21, s[24:27], s45 offen  lds
    s_add_u32 s45, s46, 0x1a4000
    s_add_u32 m0, s47, 61440
    s_nop 0
    buffer_load_dwordx4 v21, s[24:27], s45 offen  lds
    s_add_u32 s45, s46, 0x1c0000
    s_add_u32 m0, s47, 65536
    s_nop 0
    buffer_load_dwordx4 v21, s[24:27], s45 offen  lds
    s_add_u32 s45, s46, 0x1dc000
    s_add_u32 m0, s47, 69632
    s_nop 0
    buffer_load_dwordx4 v21, s[24:27], s45 offen  lds
    s_add_u32 s45, s46, 0x1f8000
    s_add_u32 m0, s47, 73728
    s_nop 0
    buffer_load_dwordx4 v21, s[24:27], s45 offen  lds
    s_add_u32 s45, s46, 0x214000
    s_add_u32 m0, s47, 77824
    s_nop 0
    buffer_load_dwordx4 v21, s[24:27], s45 offen  lds
    s_add_u32 s45, s46, 0x230000
    s_add_u32 m0, s47, 81920
    s_nop 0
    buffer_load_dwordx4 v21, s[24:27], s45 offen  lds
    s_add_u32 s45, s46, 0x24c000
    s_add_u32 m0, s47, 86016
    s_nop 0
    buffer_load_dwordx4 v21, s[24:27], s45 offen  lds
    s_add_u32 s45, s46, 0x268000
    s_add_u32 m0, s47, 90112
    s_nop 0
    buffer_load_dwordx4 v21, s[24:27], s45 offen  lds
    s_add_u32 s45, s46, 0x284000
    s_add_u32 m0, s47, 94208
    s_nop 0
    buffer_load_dwordx4 v21, s[24:27], s45 offen  lds
    s_add_u32 s45, s46, 0x2a0000
    s_add_u32 m0, s47, 98304
    s_nop 0
    buffer_load_dwordx4 v21, s[24:27], s45 offen  lds
    s_add_u32 s45, s46, 0x2bc000
    s_add_u32 m0, s47, 102400
    s_nop 0
    buffer_load_dwordx4 v21, s[24:27], s45 offen  lds
    s_add_u32 s45, s46, 0x2d8000
    s_add_u32 m0, s47, 106496
    s_nop 0
    buffer_load_dwordx4 v21, s[24:27], s45 offen  lds
    s_add_u32 s45, s46, 0x2f4000
    s_add_u32 m0, s47, 110592
    s_nop 0
    buffer_load_dwordx4 v21, s[24:27], s45 offen  lds
    s_add_u32 s45, s46, 0x310000
    s_add_u32 m0, s47, 114688
    s_nop 0
    buffer_load_dwordx4 v21, s[24:27], s45 offen  lds
    s_add_u32 s45, s46, 0x32c000
    s_add_u32 m0, s47, 118784
    s_nop 0
    buffer_load_dwordx4 v21, s[24:27], s45 offen  lds
    s_add_u32 s45, s46, 0x348000
    s_add_u32 m0, s47, 122880
    s_nop 0
    buffer_load_dwordx4 v21, s[24:27], s45 offen  lds
    s_add_u32 s45, s46, 0x364000
    s_add_u32 m0, s47, 126976
    s_nop 0
    buffer_load_dwordx4 v21, s[24:27], s45 offen  lds
    s_waitcnt vmcnt(28)
    s_barrier
    s_add_u32 s45, s46, 0x380000
    s_add_u32 m0, s47, 131072
    s_nop 0
    buffer_load_dwordx4 v21, s[24:27], s45 offen  lds
    s_add_u32 s45, s46, 0x39c000
    s_add_u32 m0, s47, 135168
    s_nop 0
    buffer_load_dwordx4 v21, s[24:27], s45 offen  lds
    s_add_u32 s45, s46, 0x3b8000
    s_add_u32 m0, s47, 139264
    s_nop 0
    buffer_load_dwordx4 v21, s[24:27], s45 offen  lds
    s_add_u32 s45, s46, 0x3d4000
    s_add_u32 m0, s47, 143360
    s_nop 0
    buffer_load_dwordx4 v21, s[24:27], s45 offen  lds
    ds_read_b64_tr_b16 a[0:1], v23 offset:0
    ds_read_b64_tr_b16 a[2:3], v23 offset:1024
    ds_read_b64_tr_b16 a[4:5], v23 offset:8
    ds_read_b64_tr_b16 a[6:7], v23 offset:1032
    ds_read_b64_tr_b16 a[8:9], v23 offset:8192
    ds_read_b64_tr_b16 a[10:11], v23 offset:9216
    ds_read_b64_tr_b16 a[12:13], v23 offset:8200
    ds_read_b64_tr_b16 a[14:15], v23 offset:9224
    s_waitcnt lgkmcnt(0)
    s_waitcnt vmcnt(28)
    s_barrier
    s_add_u32 s45, s46, 0x3f0000
    s_add_u32 m0, s47, 0
    s_nop 0
    buffer_load_dwordx4 v21, s[24:27], s45 offen  lds
    s_add_u32 s45, s46, 0x40c000
    s_add_u32 m0, s47, 4096
    s_nop 0
    buffer_load_dwordx4 v21, s[24:27], s45 offen  lds
    s_add_u32 s45, s46, 0x428000
    s_add_u32 m0, s47, 8192
    s_nop 0
    buffer_load_dwordx4 v21, s[24:27], s45 offen  lds
    s_add_u32 s45, s46, 0x444000
    s_add_u32 m0, s47, 12288
    s_nop 0
    buffer_load_dwordx4 v21, s[24:27], s45 offen  lds
    ds_read_b64_tr_b16 a[16:17], v23 offset:16384
    ds_read_b64_tr_b16 a[18:19], v23 offset:17408
    ds_read_b64_tr_b16 a[20:21], v23 offset:16392
    ds_read_b64_tr_b16 a[22:23], v23 offset:17416
    ds_read_b64_tr_b16 a[24:25], v23 offset:24576
    ds_read_b64_tr_b16 a[26:27], v23 offset:25600
    ds_read_b64_tr_b16 a[28:29], v23 offset:24584
    ds_read_b64_tr_b16 a[30:31], v23 offset:25608
    s_waitcnt lgkmcnt(0)
    s_waitcnt vmcnt(28)
    s_barrier
    s_add_u32 s45, s46, 0x460000
    s_add_u32 m0, s47, 16384
    s_nop 0
    buffer_load_dwordx4 v21, s[24:27], s45 offen  lds
    s_add_u32 s45, s46, 0x47c000
    s_add_u32 m0, s47, 20480
    s_nop 0
    buffer_load_dwordx4 v21, s[24:27], s45 offen  lds
    s_add_u32 s45, s46, 0x498000
    s_add_u32 m0, s47, 24576
    s_nop 0
    buffer_load_dwordx4 v21, s[24:27], s45 offen  lds
    s_add_u32 s45, s46, 0x4b4000
    s_add_u32 m0, s47, 28672
    s_nop 0
    buffer_load_dwordx4 v21, s[24:27], s45 offen  lds
    ds_read_b64_tr_b16 a[32:33], v23 offset:32768
    ds_read_b64_tr_b16 a[34:35], v23 offset:33792
    ds_read_b64_tr_b16 a[36:37], v23 offset:32776
    ds_read_b64_tr_b16 a[38:39], v23 offset:33800
    ds_read_b64_tr_b16 a[40:41], v23 offset:40960
    ds_read_b64_tr_b16 a[42:43], v23 offset:41984
    ds_read_b64_tr_b16 a[44:45], v23 offset:40968
    ds_read_b64_tr_b16 a[46:47], v23 offset:41992
    s_waitcnt lgkmcnt(0)
    s_waitcnt vmcnt(28)
    s_barrier
    s_add_u32 s45, s46, 0x4d0000
    s_add_u32 m0, s47, 32768
    s_nop 0
    buffer_load_dwordx4 v21, s[24:27], s45 offen  lds
    s_add_u32 s45, s46, 0x4ec000
    s_add_u32 m0, s47, 36864
    s_nop 0
    buffer_load_dwordx4 v21, s[24:27], s45 offen  lds
    s_add_u32 s45, s46, 0x508000
    s_add_u32 m0, s47, 40960
    s_nop 0
    buffer_load_dwordx4 v21, s[24:27], s45 offen  lds
    s_add_u32 s45, s46, 0x524000
    s_add_u32 m0, s47, 45056
    s_nop 0
    buffer_load_dwordx4 v21, s[24:27], s45 offen  lds
    ds_read_b64_tr_b16 a[48:49], v23 offset:49152
    ds_read_b64_tr_b16 a[50:51], v23 offset:50176
    ds_read_b64_tr_b16 a[52:53], v23 offset:49160
    ds_read_b64_tr_b16 a[54:55], v23 offset:50184
    ds_read_b64_tr_b16 a[56:57], v23 offset:57344
    ds_read_b64_tr_b16 a[58:59], v23 offset:58368
    ds_read_b64_tr_b16 a[60:61], v23 offset:57352
    ds_read_b64_tr_b16 a[62:63], v23 offset:58376
    s_waitcnt lgkmcnt(0)
    s_waitcnt vmcnt(28)
    s_barrier
    s_add_u32 s45, s46, 0x540000
    s_add_u32 m0, s47, 49152
    s_nop 0
    buffer_load_dwordx4 v21, s[24:27], s45 offen  lds
    s_add_u32 s45, s46, 0x55c000
    s_add_u32 m0, s47, 53248
    s_nop 0
    buffer_load_dwordx4 v21, s[24:27], s45 offen  lds
    s_add_u32 s45, s46, 0x578000
    s_add_u32 m0, s47, 57344
    s_nop 0
    buffer_load_dwordx4 v21, s[24:27], s45 offen  lds
    s_add_u32 s45, s46, 0x594000
    s_add_u32 m0, s47, 61440
    s_nop 0
    buffer_load_dwordx4 v21, s[24:27], s45 offen  lds
    ds_read_b64_tr_b16 a[64:65], v24 offset:0
    ds_read_b64_tr_b16 a[66:67], v24 offset:1024
    ds_read_b64_tr_b16 a[68:69], v24 offset:8
    ds_read_b64_tr_b16 a[70:71], v24 offset:1032
    ds_read_b64_tr_b16 a[72:73], v24 offset:8192
    ds_read_b64_tr_b16 a[74:75], v24 offset:9216
    ds_read_b64_tr_b16 a[76:77], v24 offset:8200
    ds_read_b64_tr_b16 a[78:79], v24 offset:9224
    s_waitcnt lgkmcnt(0)
    s_waitcnt vmcnt(28)
    s_barrier
    s_add_u32 s45, s46, 0x5b0000
    s_add_u32 m0, s47, 65536
    s_nop 0
    buffer_load_dwordx4 v21, s[24:27], s45 offen  lds
    s_add_u32 s45, s46, 0x5cc000
    s_add_u32 m0, s47, 69632
    s_nop 0
    buffer_load_dwordx4 v21, s[24:27], s45 offen  lds
    s_add_u32 s45, s46, 0x5e8000
    s_add_u32 m0, s47, 73728
    s_nop 0
    buffer_load_dwordx4 v21, s[24:27], s45 offen  lds
    s_add_u32 s45, s46, 0x604000
    s_add_u32 m0, s47, 77824
    s_nop 0
    buffer_load_dwordx4 v21, s[24:27], s45 offen  lds
    ds_read_b64_tr_b16 a[80:81], v24 offset:16384
    ds_read_b64_tr_b16 a[82:83], v24 offset:17408
    ds_read_b64_tr_b16 a[84:85], v24 offset:16392
    ds_read_b64_tr_b16 a[86:87], v24 offset:17416
    ds_read_b64_tr_b16 a[88:89], v24 offset:24576
    ds_read_b64_tr_b16 a[90:91], v24 offset:25600
    ds_read_b64_tr_b16 a[92:93], v24 offset:24584
    ds_read_b64_tr_b16 a[94:95], v24 offset:25608
    s_waitcnt lgkmcnt(0)
    s_waitcnt vmcnt(28)
    s_barrier
    s_add_u32 s45, s46, 0x620000
    s_add_u32 m0, s47, 81920
    s_nop 0
    buffer_load_dwordx4 v21, s[24:27], s45 offen  lds
    s_add_u32 s45, s46, 0x63c000
    s_add_u32 m0, s47, 86016
    s_nop 0
    buffer_load_dwordx4 v21, s[24:27], s45 offen  lds
    s_add_u32 s45, s46, 0x658000
    s_add_u32 m0, s47, 90112
    s_nop 0
    buffer_load_dwordx4 v21, s[24:27], s45 offen  lds
    s_add_u32 s45, s46, 0x674000
    s_add_u32 m0, s47, 94208
    s_nop 0
    buffer_load_dwordx4 v21, s[24:27], s45 offen  lds
    ds_read_b64_tr_b16 a[96:97], v24 offset:32768
    ds_read_b64_tr_b16 a[98:99], v24 offset:33792
    ds_read_b64_tr_b16 a[100:101], v24 offset:32776
    ds_read_b64_tr_b16 a[102:103], v24 offset:33800
    ds_read_b64_tr_b16 a[104:105], v24 offset:40960
    ds_read_b64_tr_b16 a[106:107], v24 offset:41984
    ds_read_b64_tr_b16 a[108:109], v24 offset:40968
    ds_read_b64_tr_b16 a[110:111], v24 offset:41992
    s_waitcnt lgkmcnt(0)
    s_waitcnt vmcnt(28)
    s_barrier
    s_add_u32 s45, s46, 0x690000
    s_add_u32 m0, s47, 98304
    s_nop 0
    buffer_load_dwordx4 v21, s[24:27], s45 offen  lds
    s_add_u32 s45, s46, 0x6ac000
    s_add_u32 m0, s47, 102400
    s_nop 0
    buffer_load_dwordx4 v21, s[24:27], s45 offen  lds
    s_add_u32 s45, s46, 0x6c8000
    s_add_u32 m0, s47, 106496
    s_nop 0
    buffer_load_dwordx4 v21, s[24:27], s45 offen  lds
    s_add_u32 s45, s46, 0x6e4000
    s_add_u32 m0, s47, 110592
    s_nop 0
    buffer_load_dwordx4 v21, s[24:27], s45 offen  lds
    ds_read_b64_tr_b16 a[112:113], v24 offset:49152
    ds_read_b64_tr_b16 a[114:115], v24 offset:50176
    ds_read_b64_tr_b16 a[116:117], v24 offset:49160
    ds_read_b64_tr_b16 a[118:119], v24 offset:50184
    ds_read_b64_tr_b16 a[120:121], v24 offset:57344
    ds_read_b64_tr_b16 a[122:123], v24 offset:58368
    ds_read_b64_tr_b16 a[124:125], v24 offset:57352
    ds_read_b64_tr_b16 a[126:127], v24 offset:58376
    s_waitcnt lgkmcnt(0)
    s_waitcnt vmcnt(28)
    s_barrier
    ds_read_b64_tr_b16 a[128:129], v25 offset:0
    ds_read_b64_tr_b16 a[130:131], v25 offset:1024
    ds_read_b64_tr_b16 a[132:133], v25 offset:8
    ds_read_b64_tr_b16 a[134:135], v25 offset:1032
    ds_read_b64_tr_b16 a[136:137], v25 offset:8192
    ds_read_b64_tr_b16 a[138:139], v25 offset:9216
    ds_read_b64_tr_b16 a[140:141], v25 offset:8200
    ds_read_b64_tr_b16 a[142:143], v25 offset:9224
    s_waitcnt lgkmcnt(0)
    s_waitcnt vmcnt(24)
    s_barrier
    ds_read_b64_tr_b16 a[144:145], v23 offset:0
    ds_read_b64_tr_b16 a[146:147], v23 offset:1024
    ds_read_b64_tr_b16 a[148:149], v23 offset:8
    ds_read_b64_tr_b16 a[150:151], v23 offset:1032
    ds_read_b64_tr_b16 a[152:153], v23 offset:8192
    ds_read_b64_tr_b16 a[154:155], v23 offset:9216
    ds_read_b64_tr_b16 a[156:157], v23 offset:8200
    ds_read_b64_tr_b16 a[158:159], v23 offset:9224
    s_waitcnt lgkmcnt(0)
    s_waitcnt vmcnt(20)
    s_barrier
    ds_read_b64_tr_b16 a[160:161], v23 offset:16384
    ds_read_b64_tr_b16 a[162:163], v23 offset:17408
    ds_read_b64_tr_b16 a[164:165], v23 offset:16392
    ds_read_b64_tr_b16 a[166:167], v23 offset:17416
    ds_read_b64_tr_b16 a[168:169], v23 offset:24576
    ds_read_b64_tr_b16 a[170:171], v23 offset:25600
    ds_read_b64_tr_b16 a[172:173], v23 offset:24584
    ds_read_b64_tr_b16 a[174:175], v23 offset:25608
    s_waitcnt lgkmcnt(0)
    s_waitcnt vmcnt(16)
    s_barrier
    ds_read_b64_tr_b16 a[176:177], v23 offset:32768
    ds_read_b64_tr_b16 a[178:179], v23 offset:33792
    ds_read_b64_tr_b16 a[180:181], v23 offset:32776
    ds_read_b64_tr_b16 a[182:183], v23 offset:33800
    ds_read_b64_tr_b16 a[184:185], v23 offset:40960
    ds_read_b64_tr_b16 a[186:187], v23 offset:41984
    ds_read_b64_tr_b16 a[188:189], v23 offset:40968
    ds_read_b64_tr_b16 a[190:191], v23 offset:41992
    s_waitcnt lgkmcnt(0)
    s_waitcnt vmcnt(12)
    s_barrier
    ds_read_b64_tr_b16 a[192:193], v23 offset:49152
    ds_read_b64_tr_b16 a[194:195], v23 offset:50176
    ds_read_b64_tr_b16 a[196:197], v23 offset:49160
    ds_read_b64_tr_b16 a[198:199], v23 offset:50184
    ds_read_b64_tr_b16 a[200:201], v23 offset:57344
    ds_read_b64_tr_b16 a[202:203], v23 offset:58368
    ds_read_b64_tr_b16 a[204:205], v23 offset:57352
    ds_read_b64_tr_b16 a[206:207], v23 offset:58376
    s_waitcnt lgkmcnt(0)
    s_waitcnt vmcnt(8)
    s_barrier
    ds_read_b64_tr_b16 a[208:209], v24 offset:0
    ds_read_b64_tr_b16 a[210:211], v24 offset:1024
    ds_read_b64_tr_b16 a[212:213], v24 offset:8
    ds_read_b64_tr_b16 a[214:215], v24 offset:1032
    ds_read_b64_tr_b16 a[216:217], v24 offset:8192
    ds_read_b64_tr_b16 a[218:219], v24 offset:9216
    ds_read_b64_tr_b16 a[220:221], v24 offset:8200
    ds_read_b64_tr_b16 a[222:223], v24 offset:9224
    s_waitcnt lgkmcnt(0)
    s_waitcnt vmcnt(4)
    s_barrier
    ds_read_b64_tr_b16 a[224:225], v24 offset:16384
    ds_read_b64_tr_b16 a[226:227], v24 offset:17408
    ds_read_b64_tr_b16 a[228:229], v24 offset:16392
    ds_read_b64_tr_b16 a[230:231], v24 offset:17416
    ds_read_b64_tr_b16 a[232:233], v24 offset:24576
    ds_read_b64_tr_b16 a[234:235], v24 offset:25600
    ds_read_b64_tr_b16 a[236:237], v24 offset:24584
    ds_read_b64_tr_b16 a[238:239], v24 offset:25608
    s_waitcnt lgkmcnt(0)
    s_waitcnt vmcnt(0)
    s_barrier
    ds_read_b64_tr_b16 a[240:241], v24 offset:32768
    ds_read_b64_tr_b16 a[242:243], v24 offset:33792
    ds_read_b64_tr_b16 a[244:245], v24 offset:32776
    ds_read_b64_tr_b16 a[246:247], v24 offset:33800
    ds_read_b64_tr_b16 a[248:249], v24 offset:40960
    ds_read_b64_tr_b16 a[250:251], v24 offset:41984
    ds_read_b64_tr_b16 a[252:253], v24 offset:40968
    ds_read_b64_tr_b16 a[254:255], v24 offset:41992
    s_waitcnt lgkmcnt(0)
    s_barrier
    s_min_u32 s45, s41, 27
    s_lshl_b32 s45, s45, 8
    s_lshl_b32 s46, s44, 6
    s_add_u32 s45, s45, s46
    v_lshrrev_b32 v29, 4, v1
    v_lshlrev_b32 v29, 4, v29
    buffer_load_dwordx4 v[80:83], v29, s[32:35], s45 offen
    s_waitcnt vmcnt(0)
    v_lshlrev_b32 v96, 16, v80
    v_and_b32 v97, 0xffff0000, v80
    v_lshlrev_b32 v98, 16, v81
    v_and_b32 v99, 0xffff0000, v81
    v_lshlrev_b32 v100, 16, v82
    v_and_b32 v101, 0xffff0000, v82
    v_lshlrev_b32 v102, 16, v83
    v_and_b32 v103, 0xffff0000, v83
    v_mov_b32 v104, 0xbdd2d3e8
    v_mov_b32 v105, v104
    v_mov_b32 v106, 0xc0135761
    v_mov_b32 v107, v106
    s_cmp_lg_u32 s44, 0
    s_cbranch_scc1 L_pd_137
    v_mov_b32 v29, 132
    s_mov_b32 s46, 96
    s_mov_b64 exec, 1
    s_mov_b32 s70, 0
L_wp_138:
    buffer_load_dword v31, v29, s[16:19], 0 offen sc1
    s_add_u32 s70, s70, 1
    s_cmp_ge_u32 s70, 0x200000
    s_cbranch_scc1 L_w_done_102
    s_waitcnt vmcnt(0)
    v_cmp_gt_u32 vcc, s46, v31
    s_nop 1
    s_cbranch_vccz L_wp_138_ok
    s_sleep 3
    s_branch L_wp_138
L_wp_138_ok:
    s_mov_b64 exec, -1
L_pd_137:
    s_barrier
    v_lshlrev_b32 v29, 5, v1
    s_mov_b32 s45, 8192
    buffer_load_dwordx4 v[112:115], v29, s[12:15], s45 offen offset:0 sc1
    buffer_load_dwordx4 v[116:119], v29, s[12:15], s45 offen offset:16 sc1
    buffer_load_dwordx4 v[120:123], v29, s[12:15], s45 offen offset:2048 sc1
    buffer_load_dwordx4 v[124:127], v29, s[12:15], s45 offen offset:2064 sc1
    s_mov_b32 s45, 32768
    buffer_load_dwordx4 v[32:35], v29, s[12:15], s45 offen offset:0 sc1
    buffer_load_dwordx4 v[36:39], v29, s[12:15], s45 offen offset:16 sc1
    buffer_load_dwordx4 v[40:43], v29, s[12:15], s45 offen offset:2048 sc1
    buffer_load_dwordx4 v[44:47], v29, s[12:15], s45 offen offset:2064 sc1
    s_mov_b32 s45, 12288
    buffer_load_dwordx4 v[128:131], v29, s[12:15], s45 offen offset:0 sc1
    buffer_load_dwordx4 v[132:135], v29, s[12:15], s45 offen offset:16 sc1
    buffer_load_dwordx4 v[136:139], v29, s[12:15], s45 offen offset:2048 sc1
    buffer_load_dwordx4 v[140:143], v29, s[12:15], s45 offen offset:2064 sc1
    s_mov_b32 s45, 36864
    buffer_load_dwordx4 v[48:51], v29, s[12:15], s45 offen offset:0 sc1
    buffer_load_dwordx4 v[52:55], v29, s[12:15], s45 offen offset:16 sc1
    buffer_load_dwordx4 v[56:59], v29, s[12:15], s45 offen offset:2048 sc1
    buffer_load_dwordx4 v[60:63], v29, s[12:15], s45 offen offset:2064 sc1
    s_mov_b32 s45, 16384
    buffer_load_dwordx4 v[144:147], v29, s[12:15], s45 offen offset:0 sc1
    buffer_load_dwordx4 v[148:151], v29, s[12:15], s45 offen offset:16 sc1
    buffer_load_dwordx4 v[152:155], v29, s[12:15], s45 offen offset:2048 sc1
    buffer_load_dwordx4 v[156:159], v29, s[12:15], s45 offen offset:2064 sc1
    s_mov_b32 s45, 40960
    buffer_load_dwordx4 v[64:67], v29, s[12:15], s45 offen offset:0 sc1
    buffer_load_dwordx4 v[68:71], v29, s[12:15], s45 offen offset:16 sc1
    buffer_load_dwordx4 v[72:75], v29, s[12:15], s45 offen offset:2048 sc1
    buffer_load_dwordx4 v[76:79], v29, s[12:15], s45 offen offset:2064 sc1
    s_waitcnt vmcnt(0)
    v_add_f32 v112, v112, v32
    v_cvt_pk_bf16_f32 v112, v112, v112
    v_lshlrev_b32 v112, 16, v112
    v_add_f32 v113, v113, v33
    v_cvt_pk_bf16_f32 v113, v113, v113
    v_lshlrev_b32 v113, 16, v113
    v_add_f32 v114, v114, v34
    v_cvt_pk_bf16_f32 v114, v114, v114
    v_lshlrev_b32 v114, 16, v114
    v_add_f32 v115, v115, v35
    v_cvt_pk_bf16_f32 v115, v115, v115
    v_lshlrev_b32 v115, 16, v115
    v_add_f32 v116, v116, v36
    v_cvt_pk_bf16_f32 v116, v116, v116
    v_lshlrev_b32 v116, 16, v116
    v_add_f32 v117, v117, v37
    v_cvt_pk_bf16_f32 v117, v117, v117
    v_lshlrev_b32 v117, 16, v117
    v_add_f32 v118, v118, v38
    v_cvt_pk_bf16_f32 v118, v118, v118
    v_lshlrev_b32 v118, 16, v118
    v_add_f32 v119, v119, v39
    v_cvt_pk_bf16_f32 v119, v119, v119
    v_lshlrev_b32 v119, 16, v119
    v_add_f32 v120, v120, v40
    v_cvt_pk_bf16_f32 v120, v120, v120
    v_lshlrev_b32 v120, 16, v120
    v_add_f32 v121, v121, v41
    v_cvt_pk_bf16_f32 v121, v121, v121
    v_lshlrev_b32 v121, 16, v121
    v_add_f32 v122, v122, v42
    v_cvt_pk_bf16_f32 v122, v122, v122
    v_lshlrev_b32 v122, 16, v122
    v_add_f32 v123, v123, v43
    v_cvt_pk_bf16_f32 v123, v123, v123
    v_lshlrev_b32 v123, 16, v123
    v_add_f32 v124, v124, v44
    v_cvt_pk_bf16_f32 v124, v124, v124
    v_lshlrev_b32 v124, 16, v124
    v_add_f32 v125, v125, v45
    v_cvt_pk_bf16_f32 v125, v125, v125
    v_lshlrev_b32 v125, 16, v125
    v_add_f32 v126, v126, v46
    v_cvt_pk_bf16_f32 v126, v126, v126
    v_lshlrev_b32 v126, 16, v126
    v_add_f32 v127, v127, v47
    v_cvt_pk_bf16_f32 v127, v127, v127
    v_lshlrev_b32 v127, 16, v127
    v_add_f32 v128, v128, v48
    v_cvt_pk_bf16_f32 v128, v128, v128
    v_lshlrev_b32 v128, 16, v128
    v_add_f32 v129, v129, v49
    v_cvt_pk_bf16_f32 v129, v129, v129
    v_lshlrev_b32 v129, 16, v129
    v_add_f32 v130, v130, v50
    v_cvt_pk_bf16_f32 v130, v130, v130
    v_lshlrev_b32 v130, 16, v130
    v_add_f32 v131, v131, v51
    v_cvt_pk_bf16_f32 v131, v131, v131
    v_lshlrev_b32 v131, 16, v131
    v_add_f32 v132, v132, v52
    v_cvt_pk_bf16_f32 v132, v132, v132
    v_lshlrev_b32 v132, 16, v132
    v_add_f32 v133, v133, v53
    v_cvt_pk_bf16_f32 v133, v133, v133
    v_lshlrev_b32 v133, 16, v133
    v_add_f32 v134, v134, v54
    v_cvt_pk_bf16_f32 v134, v134, v134
    v_lshlrev_b32 v134, 16, v134
    v_add_f32 v135, v135, v55
    v_cvt_pk_bf16_f32 v135, v135, v135
    v_lshlrev_b32 v135, 16, v135
    v_add_f32 v136, v136, v56
    v_cvt_pk_bf16_f32 v136, v136, v136
    v_lshlrev_b32 v136, 16, v136
    v_add_f32 v137, v137, v57
    v_cvt_pk_bf16_f32 v137, v137, v137
    v_lshlrev_b32 v137, 16, v137
    v_add_f32 v138, v138, v58
    v_cvt_pk_bf16_f32 v138, v138, v138
    v_lshlrev_b32 v138, 16, v138
    v_add_f32 v139, v139, v59
    v_cvt_pk_bf16_f32 v139, v139, v139
    v_lshlrev_b32 v139, 16, v139
    v_add_f32 v140, v140, v60
    v_cvt_pk_bf16_f32 v140, v140, v140
    v_lshlrev_b32 v140, 16, v140
    v_add_f32 v141, v141, v61
    v_cvt_pk_bf16_f32 v141, v141, v141
    v_lshlrev_b32 v141, 16, v141
    v_add_f32 v142, v142, v62
    v_cvt_pk_bf16_f32 v142, v142, v142
    v_lshlrev_b32 v142, 16, v142
    v_add_f32 v143, v143, v63
    v_cvt_pk_bf16_f32 v143, v143, v143
    v_lshlrev_b32 v143, 16, v143
    v_add_f32 v144, v144, v64
    v_cvt_pk_bf16_f32 v144, v144, v144
    v_lshlrev_b32 v144, 16, v144
    v_add_f32 v144, 1.0, v144
    v_cvt_pk_bf16_f32 v144, v144, v144
    v_lshlrev_b32 v144, 16, v144
    v_add_f32 v145, v145, v65
    v_cvt_pk_bf16_f32 v145, v145, v145
    v_lshlrev_b32 v145, 16, v145
    v_add_f32 v145, 1.0, v145
    v_cvt_pk_bf16_f32 v145, v145, v145
    v_lshlrev_b32 v145, 16, v145
    v_add_f32 v146, v146, v66
    v_cvt_pk_bf16_f32 v146, v146, v146
    v_lshlrev_b32 v146, 16, v146
    v_add_f32 v146, 1.0, v146
    v_cvt_pk_bf16_f32 v146, v146, v146
    v_lshlrev_b32 v146, 16, v146
    v_add_f32 v147, v147, v67
    v_cvt_pk_bf16_f32 v147, v147, v147
    v_lshlrev_b32 v147, 16, v147
    v_add_f32 v147, 1.0, v147
    v_cvt_pk_bf16_f32 v147, v147, v147
    v_lshlrev_b32 v147, 16, v147
    v_add_f32 v148, v148, v68
    v_cvt_pk_bf16_f32 v148, v148, v148
    v_lshlrev_b32 v148, 16, v148
    v_add_f32 v148, 1.0, v148
    v_cvt_pk_bf16_f32 v148, v148, v148
    v_lshlrev_b32 v148, 16, v148
    v_add_f32 v149, v149, v69
    v_cvt_pk_bf16_f32 v149, v149, v149
    v_lshlrev_b32 v149, 16, v149
    v_add_f32 v149, 1.0, v149
    v_cvt_pk_bf16_f32 v149, v149, v149
    v_lshlrev_b32 v149, 16, v149
    v_add_f32 v150, v150, v70
    v_cvt_pk_bf16_f32 v150, v150, v150
    v_lshlrev_b32 v150, 16, v150
    v_add_f32 v150, 1.0, v150
    v_cvt_pk_bf16_f32 v150, v150, v150
    v_lshlrev_b32 v150, 16, v150
    v_add_f32 v151, v151, v71
    v_cvt_pk_bf16_f32 v151, v151, v151
    v_lshlrev_b32 v151, 16, v151
    v_add_f32 v151, 1.0, v151
    v_cvt_pk_bf16_f32 v151, v151, v151
    v_lshlrev_b32 v151, 16, v151
    v_add_f32 v152, v152, v72
    v_cvt_pk_bf16_f32 v152, v152, v152
    v_lshlrev_b32 v152, 16, v152
    v_add_f32 v152, 1.0, v152
    v_cvt_pk_bf16_f32 v152, v152, v152
    v_lshlrev_b32 v152, 16, v152
    v_add_f32 v153, v153, v73
    v_cvt_pk_bf16_f32 v153, v153, v153
    v_lshlrev_b32 v153, 16, v153
    v_add_f32 v153, 1.0, v153
    v_cvt_pk_bf16_f32 v153, v153, v153
    v_lshlrev_b32 v153, 16, v153
    v_add_f32 v154, v154, v74
    v_cvt_pk_bf16_f32 v154, v154, v154
    v_lshlrev_b32 v154, 16, v154
    v_add_f32 v154, 1.0, v154
    v_cvt_pk_bf16_f32 v154, v154, v154
    v_lshlrev_b32 v154, 16, v154
    v_add_f32 v155, v155, v75
    v_cvt_pk_bf16_f32 v155, v155, v155
    v_lshlrev_b32 v155, 16, v155
    v_add_f32 v155, 1.0, v155
    v_cvt_pk_bf16_f32 v155, v155, v155
    v_lshlrev_b32 v155, 16, v155
    v_add_f32 v156, v156, v76
    v_cvt_pk_bf16_f32 v156, v156, v156
    v_lshlrev_b32 v156, 16, v156
    v_add_f32 v156, 1.0, v156
    v_cvt_pk_bf16_f32 v156, v156, v156
    v_lshlrev_b32 v156, 16, v156
    v_add_f32 v157, v157, v77
    v_cvt_pk_bf16_f32 v157, v157, v157
    v_lshlrev_b32 v157, 16, v157
    v_add_f32 v157, 1.0, v157
    v_cvt_pk_bf16_f32 v157, v157, v157
    v_lshlrev_b32 v157, 16, v157
    v_add_f32 v158, v158, v78
    v_cvt_pk_bf16_f32 v158, v158, v158
    v_lshlrev_b32 v158, 16, v158
    v_add_f32 v158, 1.0, v158
    v_cvt_pk_bf16_f32 v158, v158, v158
    v_lshlrev_b32 v158, 16, v158
    v_add_f32 v159, v159, v79
    v_cvt_pk_bf16_f32 v159, v159, v159
    v_lshlrev_b32 v159, 16, v159
    v_add_f32 v159, 1.0, v159
    v_cvt_pk_bf16_f32 v159, v159, v159
    v_lshlrev_b32 v159, 16, v159
    s_mov_b32 s52, 0xc00000
    s_lshl_b32 s56, s41, 13
    s_add_u32 s56, s56, 0x6000000
L_b_loop_139:
    s_cmp_eq_u64 s[36:37], 0
    s_cbranch_scc1 L_w_done_102
    s_ff1_i32_b64 s50, s[36:37]
    s_bitset0_b64 s[36:37], s50
    s_lshr_b64 s[74:75], s[72:73], s50
    s_ff1_i32_b64 s51, s[74:75]
    s_add_u32 s51, s51, 1
    s_add_u32 s62, s50, s51
    s_add_u32 s63, s50, s44
    s_lshl_b32 s63, s63, 5
    s_add_u32 s63, s63, s41
    s_lshl_b32 s47, s63, 11
    buffer_load_dwordx4 v[208:211], v10, s[28:31], s47 offen
    buffer_load_dwordx4 v[212:215], v10, s[28:31], s47 offen offset:1024
    s_add_u32 s45, s64, 4096
    s_cmp_lg_u32 s44, 0
    s_cbranch_scc1 L_pw_142
    s_mov_b32 exec_hi, 0
    s_mov_b32 s70, 0
L_wp_143:
    buffer_load_dword v31, v5, s[12:15], s45 offen sc1
    s_add_u32 s70, s70, 1
    s_cmp_ge_u32 s70, 0x200000
    s_cbranch_scc1 L_w_done_102
    s_waitcnt vmcnt(0)
    v_cmp_gt_u32 vcc, s62, v31
    s_nop 1
    s_cbranch_vccz L_wp_143_ok
    s_sleep 2
    s_branch L_wp_143
L_wp_143_ok:
    s_mov_b64 exec, -1
L_pw_142:
    s_barrier
    s_cmp_ge_u32 s44, s51
    s_cbranch_scc1 L_b_skip_140
    s_lshl_b32 s45, s63, 12
    s_add_u32 s45, s45, 0x8000000
    v_lshlrev_b32 v29, 5, v1
    buffer_load_dwordx4 v[64:67], v29, s[12:15], s45 offen offset:0 sc1
    buffer_load_dwordx4 v[68:71], v29, s[12:15], s45 offen offset:16 sc1
    buffer_load_dwordx4 v[72:75], v29, s[12:15], s45 offen offset:2048 sc1
    buffer_load_dwordx4 v[76:79], v29, s[12:15], s45 offen offset:2064 sc1
    s_add_u32 s45, s45, 0x800000
    buffer_load_dwordx4 v[160:163], v29, s[12:15], s45 offen offset:0 sc1
    buffer_load_dwordx4 v[164:167], v29, s[12:15], s45 offen offset:16 sc1
    buffer_load_dwordx4 v[168:171], v29, s[12:15], s45 offen offset:2048 sc1
    buffer_load_dwordx4 v[172:175], v29, s[12:15], s45 offen offset:2064 sc1
    s_add_u32 s45, s45, 0x800000
    buffer_load_dwordx4 v[176:179], v29, s[12:15], s45 offen offset:0 sc1
    buffer_load_dwordx4 v[180:183], v29, s[12:15], s45 offen offset:16 sc1
    buffer_load_dwordx4 v[184:187], v29, s[12:15], s45 offen offset:2048 sc1
    buffer_load_dwordx4 v[188:191], v29, s[12:15], s45 offen offset:2064 sc1
    s_add_u32 s45, s45, 0x800000
    buffer_load_dwordx4 v[192:195], v29, s[12:15], s45 offen offset:0 sc1
    buffer_load_dwordx4 v[196:199], v29, s[12:15], s45 offen offset:16 sc1
    buffer_load_dwordx4 v[200:203], v29, s[12:15], s45 offen offset:2048 sc1
    buffer_load_dwordx4 v[204:207], v29, s[12:15], s45 offen offset:2064 sc1
    s_waitcnt vmcnt(0)
    v_pk_add_f32 v[64:65], v[64:65], v[160:161]
    v_pk_add_f32 v[176:177], v[176:177], v[192:193]
    v_pk_add_f32 v[66:67], v[66:67], v[162:163]
    v_pk_add_f32 v[178:179], v[178:179], v[194:195]
    v_pk_add_f32 v[68:69], v[68:69], v[164:165]
    v_pk_add_f32 v[180:181], v[180:181], v[196:197]
    v_pk_add_f32 v[70:71], v[70:71], v[166:167]
    v_pk_add_f32 v[182:183], v[182:183], v[198:199]
    v_pk_add_f32 v[72:73], v[72:73], v[168:169]
    v_pk_add_f32 v[184:185], v[184:185], v[200:201]
    v_pk_add_f32 v[74:75], v[74:75], v[170:171]
    v_pk_add_f32 v[186:187], v[186:187], v[202:203]
    v_pk_add_f32 v[76:77], v[76:77], v[172:173]
    v_pk_add_f32 v[188:189], v[188:189], v[204:205]
    v_pk_add_f32 v[78:79], v[78:79], v[174:175]
    v_pk_add_f32 v[190:191], v[190:191], v[206:207]
    v_pk_add_f32 v[64:65], v[64:65], v[176:177]
    v_pk_add_f32 v[66:67], v[66:67], v[178:179]
    v_pk_add_f32 v[68:69], v[68:69], v[180:181]
    v_pk_add_f32 v[70:71], v[70:71], v[182:183]
    v_pk_add_f32 v[72:73], v[72:73], v[184:185]
    v_pk_add_f32 v[74:75], v[74:75], v[186:187]
    v_pk_add_f32 v[76:77], v[76:77], v[188:189]
    v_pk_add_f32 v[78:79], v[78:79], v[190:191]
    v_cvt_pk_bf16_f32 v64, v64, v64
    v_lshlrev_b32 v64, 16, v64
    v_cvt_pk_bf16_f32 v65, v65, v65
    v_lshlrev_b32 v65, 16, v65
    v_cvt_pk_bf16_f32 v66, v66, v66
    v_lshlrev_b32 v66, 16, v66
    v_cvt_pk_bf16_f32 v67, v67, v67
    v_lshlrev_b32 v67, 16, v67
    v_cvt_pk_bf16_f32 v68, v68, v68
    v_lshlrev_b32 v68, 16, v68
    v_cvt_pk_bf16_f32 v69, v69, v69
    v_lshlrev_b32 v69, 16, v69
    v_cvt_pk_bf16_f32 v70, v70, v70
    v_lshlrev_b32 v70, 16, v70
    v_cvt_pk_bf16_f32 v71, v71, v71
    v_lshlrev_b32 v71, 16, v71
    v_cvt_pk_bf16_f32 v72, v72, v72
    v_lshlrev_b32 v72, 16, v72
    v_cvt_pk_bf16_f32 v73, v73, v73
    v_lshlrev_b32 v73, 16, v73
    v_cvt_pk_bf16_f32 v74, v74, v74
    v_lshlrev_b32 v74, 16, v74
    v_cvt_pk_bf16_f32 v75, v75, v75
    v_lshlrev_b32 v75, 16, v75
    v_cvt_pk_bf16_f32 v76, v76, v76
    v_lshlrev_b32 v76, 16, v76
    v_cvt_pk_bf16_f32 v77, v77, v77
    v_lshlrev_b32 v77, 16, v77
    v_cvt_pk_bf16_f32 v78, v78, v78
    v_lshlrev_b32 v78, 16, v78
    v_cvt_pk_bf16_f32 v79, v79, v79
    v_lshlrev_b32 v79, 16, v79
    v_lshlrev_b32 v160, 16, v208
    v_and_b32 v161, 0xffff0000, v208
    v_lshlrev_b32 v162, 16, v209
    v_and_b32 v163, 0xffff0000, v209
    v_lshlrev_b32 v164, 16, v210
    v_and_b32 v165, 0xffff0000, v210
    v_lshlrev_b32 v166, 16, v211
    v_and_b32 v167, 0xffff0000, v211
    v_lshlrev_b32 v168, 16, v212
    v_and_b32 v169, 0xffff0000, v212
    v_lshlrev_b32 v170, 16, v213
    v_and_b32 v171, 0xffff0000, v213
    v_lshlrev_b32 v172, 16, v214
    v_and_b32 v173, 0xffff0000, v214
    v_lshlrev_b32 v174, 16, v215
    v_and_b32 v175, 0xffff0000, v215
    v_mul_f32 v64, v64, v112
    v_cvt_pk_bf16_f32 v64, v64, v64
    v_lshlrev_b32 v64, 16, v64
    v_add_f32 v64, v64, v160
    v_mul_f32 v65, v65, v113
    v_cvt_pk_bf16_f32 v65, v65, v65
    v_lshlrev_b32 v65, 16, v65
    v_add_f32 v65, v65, v161
    v_mul_f32 v66, v66, v114
    v_cvt_pk_bf16_f32 v66, v66, v66
    v_lshlrev_b32 v66, 16, v66
    v_add_f32 v66, v66, v162
    v_mul_f32 v67, v67, v115
    v_cvt_pk_bf16_f32 v67, v67, v67
    v_lshlrev_b32 v67, 16, v67
    v_add_f32 v67, v67, v163
    v_mul_f32 v68, v68, v116
    v_cvt_pk_bf16_f32 v68, v68, v68
    v_lshlrev_b32 v68, 16, v68
    v_add_f32 v68, v68, v164
    v_mul_f32 v69, v69, v117
    v_cvt_pk_bf16_f32 v69, v69, v69
    v_lshlrev_b32 v69, 16, v69
    v_add_f32 v69, v69, v165
    v_mul_f32 v70, v70, v118
    v_cvt_pk_bf16_f32 v70, v70, v70
    v_lshlrev_b32 v70, 16, v70
    v_add_f32 v70, v70, v166
    v_mul_f32 v71, v71, v119
    v_cvt_pk_bf16_f32 v71, v71, v71
    v_lshlrev_b32 v71, 16, v71
    v_add_f32 v71, v71, v167
    v_mul_f32 v72, v72, v120
    v_cvt_pk_bf16_f32 v72, v72, v72
    v_lshlrev_b32 v72, 16, v72
    v_add_f32 v72, v72, v168
    v_mul_f32 v73, v73, v121
    v_cvt_pk_bf16_f32 v73, v73, v73
    v_lshlrev_b32 v73, 16, v73
    v_add_f32 v73, v73, v169
    v_mul_f32 v74, v74, v122
    v_cvt_pk_bf16_f32 v74, v74, v74
    v_lshlrev_b32 v74, 16, v74
    v_add_f32 v74, v74, v170
    v_mul_f32 v75, v75, v123
    v_cvt_pk_bf16_f32 v75, v75, v75
    v_lshlrev_b32 v75, 16, v75
    v_add_f32 v75, v75, v171
    v_mul_f32 v76, v76, v124
    v_cvt_pk_bf16_f32 v76, v76, v76
    v_lshlrev_b32 v76, 16, v76
    v_add_f32 v76, v76, v172
    v_mul_f32 v77, v77, v125
    v_cvt_pk_bf16_f32 v77, v77, v77
    v_lshlrev_b32 v77, 16, v77
    v_add_f32 v77, v77, v173
    v_mul_f32 v78, v78, v126
    v_cvt_pk_bf16_f32 v78, v78, v78
    v_lshlrev_b32 v78, 16, v78
    v_add_f32 v78, v78, v174
    v_mul_f32 v79, v79, v127
    v_cvt_pk_bf16_f32 v79, v79, v79
    v_lshlrev_b32 v79, 16, v79
    v_add_f32 v79, v79, v175
    v_cvt_pk_bf16_f32 v208, v64, v65
    v_cvt_pk_bf16_f32 v209, v66, v67
    v_cvt_pk_bf16_f32 v210, v68, v69
    v_cvt_pk_bf16_f32 v211, v70, v71
    v_cvt_pk_bf16_f32 v212, v72, v73
    v_cvt_pk_bf16_f32 v213, v74, v75
    v_cvt_pk_bf16_f32 v214, v76, v77
    v_cvt_pk_bf16_f32 v215, v78, v79
    s_add_u32 s47, s47, 0x800000
    buffer_store_dwordx4 v[208:211], v10, s[12:15], s47 offen sc1
    buffer_store_dwordx4 v[212:215], v10, s[12:15], s47 offen offset:1024 sc1
    v_lshlrev_b32 v64, 16, v208
    v_and_b32 v65, 0xffff0000, v208
    v_lshlrev_b32 v66, 16, v209
    v_and_b32 v67, 0xffff0000, v209
    v_lshlrev_b32 v68, 16, v210
    v_and_b32 v69, 0xffff0000, v210
    v_lshlrev_b32 v70, 16, v211
    v_and_b32 v71, 0xffff0000, v211
    v_lshlrev_b32 v72, 16, v212
    v_and_b32 v73, 0xffff0000, v212
    v_lshlrev_b32 v74, 16, v213
    v_and_b32 v75, 0xffff0000, v213
    v_lshlrev_b32 v76, 16, v214
    v_and_b32 v77, 0xffff0000, v214
    v_lshlrev_b32 v78, 16, v215
    v_and_b32 v79, 0xffff0000, v215
    v_add_f32 v26, v64, v65
    v_add_f32 v26, v26, v66
    v_add_f32 v26, v26, v67
    v_add_f32 v26, v26, v68
    v_add_f32 v26, v26, v69
    v_add_f32 v26, v26, v70
    v_add_f32 v26, v26, v71
    v_add_f32 v26, v26, v72
    v_add_f32 v26, v26, v73
    v_add_f32 v26, v26, v74
    v_add_f32 v26, v26, v75
    v_add_f32 v26, v26, v76
    v_add_f32 v26, v26, v77
    v_add_f32 v26, v26, v78
    v_add_f32 v26, v26, v79
    s_nop 1
    v_add_f32_dpp v26, v26, v26 row_shr:1 row_mask:0xf bank_mask:0xf bound_ctrl:0
    s_nop 1
    v_add_f32_dpp v26, v26, v26 row_shr:2 row_mask:0xf bank_mask:0xf bound_ctrl:0
    s_nop 1
    v_add_f32_dpp v26, v26, v26 row_shr:4 row_mask:0xf bank_mask:0xf bound_ctrl:0
    s_nop 1
    v_add_f32_dpp v26, v26, v26 row_shr:8 row_mask:0xf bank_mask:0xf bound_ctrl:0
    s_nop 1
    v_add_f32_dpp v26, v26, v26 row_bcast:15 row_mask:0xa bank_mask:0xf
    s_nop 1
    v_add_f32_dpp v26, v26, v26 row_bcast:31 row_mask:0xc bank_mask:0xf
    s_nop 1
    v_readlane_b32 s66, v26, 63
    s_nop 1
    v_mov_b32 v27, s66
    v_mul_f32 v27, 0x3a800000, v27
    v_mov_b32 v26, 0
    v_sub_f32 v28, v64, v27
    v_fmac_f32 v26, v28, v28
    v_sub_f32 v28, v65, v27
    v_fmac_f32 v26, v28, v28
    v_sub_f32 v28, v66, v27
    v_fmac_f32 v26, v28, v28
    v_sub_f32 v28, v67, v27
    v_fmac_f32 v26, v28, v28
    v_sub_f32 v28, v68, v27
    v_fmac_f32 v26, v28, v28
    v_sub_f32 v28, v69, v27
    v_fmac_f32 v26, v28, v28
    v_sub_f32 v28, v70, v27
    v_fmac_f32 v26, v28, v28
    v_sub_f32 v28, v71, v27
    v_fmac_f32 v26, v28, v28
    v_sub_f32 v28, v72, v27
    v_fmac_f32 v26, v28, v28
    v_sub_f32 v28, v73, v27
    v_fmac_f32 v26, v28, v28
    v_sub_f32 v28, v74, v27
    v_fmac_f32 v26, v28, v28
    v_sub_f32 v28, v75, v27
    v_fmac_f32 v26, v28, v28
    v_sub_f32 v28, v76, v27
    v_fmac_f32 v26, v28, v28
    v_sub_f32 v28, v77, v27
    v_fmac_f32 v26, v28, v28
    v_sub_f32 v28, v78, v27
    v_fmac_f32 v26, v28, v28
    v_sub_f32 v28, v79, v27
    v_fmac_f32 v26, v28, v28
    s_nop 1
    v_add_f32_dpp v26, v26, v26 row_shr:1 row_mask:0xf bank_mask:0xf bound_ctrl:0
    s_nop 1
    v_add_f32_dpp v26, v26, v26 row_shr:2 row_mask:0xf bank_mask:0xf bound_ctrl:0
    s_nop 1
    v_add_f32_dpp v26, v26, v26 row_shr:4 row_mask:0xf bank_mask:0xf bound_ctrl:0
    s_nop 1
    v_add_f32_dpp v26, v26, v26 row_shr:8 row_mask:0xf bank_mask:0xf bound_ctrl:0
    s_nop 1
    v_add_f32_dpp v26, v26, v26 row_bcast:15 row_mask:0xa bank_mask:0xf
    s_nop 1
    v_add_f32_dpp v26, v26, v26 row_bcast:31 row_mask:0xc bank_mask:0xf
    s_nop 1
    v_readlane_b32 s66, v26, 63
    s_nop 1
    v_mov_b32 v26, s66
    v_mul_f32 v26, 0x3a800000, v26
    v_cvt_pk_bf16_f32 v26, v26, v26
    v_lshlrev_b32 v26, 16, v26
    v_cvt_pk_bf16_f32 v27, v27, v27
    v_lshlrev_b32 v27, 16, v27
    v_add_f32 v26, 0x3727c5ac, v26
    v_cvt_pk_bf16_f32 v26, v26, v26
    v_lshlrev_b32 v26, 16, v26
    v_sqrt_f32 v26, v26
    s_nop 0
    v_cvt_pk_bf16_f32 v26, v26, v26
    v_lshlrev_b32 v26, 16, v26
    v_rcp_f32 v26, v26
    s_nop 0
    v_sub_f32 v64, v64, v27
    v_cvt_pk_bf16_f32 v64, v64, v64
    v_lshlrev_b32 v64, 16, v64
    v_mul_f32 v64, v64, v26
    v_cvt_pk_bf16_f32 v64, v64, v64
    v_lshlrev_b32 v64, 16, v64
    v_sub_f32 v65, v65, v27
    v_cvt_pk_bf16_f32 v65, v65, v65
    v_lshlrev_b32 v65, 16, v65
    v_mul_f32 v65, v65, v26
    v_cvt_pk_bf16_f32 v65, v65, v65
    v_lshlrev_b32 v65, 16, v65
    v_sub_f32 v66, v66, v27
    v_cvt_pk_bf16_f32 v66, v66, v66
    v_lshlrev_b32 v66, 16, v66
    v_mul_f32 v66, v66, v26
    v_cvt_pk_bf16_f32 v66, v66, v66
    v_lshlrev_b32 v66, 16, v66
    v_sub_f32 v67, v67, v27
    v_cvt_pk_bf16_f32 v67, v67, v67
    v_lshlrev_b32 v67, 16, v67
    v_mul_f32 v67, v67, v26
    v_cvt_pk_bf16_f32 v67, v67, v67
    v_lshlrev_b32 v67, 16, v67
    v_sub_f32 v68, v68, v27
    v_cvt_pk_bf16_f32 v68, v68, v68
    v_lshlrev_b32 v68, 16, v68
    v_mul_f32 v68, v68, v26
    v_cvt_pk_bf16_f32 v68, v68, v68
    v_lshlrev_b32 v68, 16, v68
    v_sub_f32 v69, v69, v27
    v_cvt_pk_bf16_f32 v69, v69, v69
    v_lshlrev_b32 v69, 16, v69
    v_mul_f32 v69, v69, v26
    v_cvt_pk_bf16_f32 v69, v69, v69
    v_lshlrev_b32 v69, 16, v69
    v_sub_f32 v70, v70, v27
    v_cvt_pk_bf16_f32 v70, v70, v70
    v_lshlrev_b32 v70, 16, v70
    v_mul_f32 v70, v70, v26
    v_cvt_pk_bf16_f32 v70, v70, v70
    v_lshlrev_b32 v70, 16, v70
    v_sub_f32 v71, v71, v27
    v_cvt_pk_bf16_f32 v71, v71, v71
    v_lshlrev_b32 v71, 16, v71
    v_mul_f32 v71, v71, v26
    v_cvt_pk_bf16_f32 v71, v71, v71
    v_lshlrev_b32 v71, 16, v71
    v_sub_f32 v72, v72, v27
    v_cvt_pk_bf16_f32 v72, v72, v72
    v_lshlrev_b32 v72, 16, v72
    v_mul_f32 v72, v72, v26
    v_cvt_pk_bf16_f32 v72, v72, v72
    v_lshlrev_b32 v72, 16, v72
    v_sub_f32 v73, v73, v27
    v_cvt_pk_bf16_f32 v73, v73, v73
    v_lshlrev_b32 v73, 16, v73
    v_mul_f32 v73, v73, v26
    v_cvt_pk_bf16_f32 v73, v73, v73
    v_lshlrev_b32 v73, 16, v73
    v_sub_f32 v74, v74, v27
    v_cvt_pk_bf16_f32 v74, v74, v74
    v_lshlrev_b32 v74, 16, v74
    v_mul_f32 v74, v74, v26
    v_cvt_pk_bf16_f32 v74, v74, v74
    v_lshlrev_b32 v74, 16, v74
    v_sub_f32 v75, v75, v27
    v_cvt_pk_bf16_f32 v75, v75, v75
    v_lshlrev_b32 v75, 16, v75
    v_mul_f32 v75, v75, v26
    v_cvt_pk_bf16_f32 v75, v75, v75
    v_lshlrev_b32 v75, 16, v75
    v_sub_f32 v76, v76, v27
    v_cvt_pk_bf16_f32 v76, v76, v76
    v_lshlrev_b32 v76, 16, v76
    v_mul_f32 v76, v76, v26
    v_cvt_pk_bf16_f32 v76, v76, v76
    v_lshlrev_b32 v76, 16, v76
    v_sub_f32 v77, v77, v27
    v_cvt_pk_bf16_f32 v77, v77, v77
    v_lshlrev_b32 v77, 16, v77
    v_mul_f32 v77, v77, v26
    v_cvt_pk_bf16_f32 v77, v77, v77
    v_lshlrev_b32 v77, 16, v77
    v_sub_f32 v78, v78, v27
    v_cvt_pk_bf16_f32 v78, v78, v78
    v_lshlrev_b32 v78, 16, v78
    v_mul_f32 v78, v78, v26
    v_cvt_pk_bf16_f32 v78, v78, v78
    v_lshlrev_b32 v78, 16, v78
    v_sub_f32 v79, v79, v27
    v_cvt_pk_bf16_f32 v79, v79, v79
    v_lshlrev_b32 v79, 16, v79
    v_mul_f32 v79, v79, v26
    v_cvt_pk_bf16_f32 v79, v79, v79
    v_lshlrev_b32 v79, 16, v79
    v_mul_f32 v64, v64, v144
    v_cvt_pk_bf16_f32 v64, v64, v64
    v_lshlrev_b32 v64, 16, v64
    v_add_f32 v64, v64, v128
    v_mul_f32 v65, v65, v145
    v_cvt_pk_bf16_f32 v65, v65, v65
    v_lshlrev_b32 v65, 16, v65
    v_add_f32 v65, v65, v129
    v_mul_f32 v66, v66, v146
    v_cvt_pk_bf16_f32 v66, v66, v66
    v_lshlrev_b32 v66, 16, v66
    v_add_f32 v66, v66, v130
    v_mul_f32 v67, v67, v147
    v_cvt_pk_bf16_f32 v67, v67, v67
    v_lshlrev_b32 v67, 16, v67
    v_add_f32 v67, v67, v131
    v_mul_f32 v68, v68, v148
    v_cvt_pk_bf16_f32 v68, v68, v68
    v_lshlrev_b32 v68, 16, v68
    v_add_f32 v68, v68, v132
    v_mul_f32 v69, v69, v149
    v_cvt_pk_bf16_f32 v69, v69, v69
    v_lshlrev_b32 v69, 16, v69
    v_add_f32 v69, v69, v133
    v_mul_f32 v70, v70, v150
    v_cvt_pk_bf16_f32 v70, v70, v70
    v_lshlrev_b32 v70, 16, v70
    v_add_f32 v70, v70, v134
    v_mul_f32 v71, v71, v151
    v_cvt_pk_bf16_f32 v71, v71, v71
    v_lshlrev_b32 v71, 16, v71
    v_add_f32 v71, v71, v135
    v_mul_f32 v72, v72, v152
    v_cvt_pk_bf16_f32 v72, v72, v72
    v_lshlrev_b32 v72, 16, v72
    v_add_f32 v72, v72, v136
    v_mul_f32 v73, v73, v153
    v_cvt_pk_bf16_f32 v73, v73, v73
    v_lshlrev_b32 v73, 16, v73
    v_add_f32 v73, v73, v137
    v_mul_f32 v74, v74, v154
    v_cvt_pk_bf16_f32 v74, v74, v74
    v_lshlrev_b32 v74, 16, v74
    v_add_f32 v74, v74, v138
    v_mul_f32 v75, v75, v155
    v_cvt_pk_bf16_f32 v75, v75, v75
    v_lshlrev_b32 v75, 16, v75
    v_add_f32 v75, v75, v139
    v_mul_f32 v76, v76, v156
    v_cvt_pk_bf16_f32 v76, v76, v76
    v_lshlrev_b32 v76, 16, v76
    v_add_f32 v76, v76, v140
    v_mul_f32 v77, v77, v157
    v_cvt_pk_bf16_f32 v77, v77, v77
    v_lshlrev_b32 v77, 16, v77
    v_add_f32 v77, v77, v141
    v_mul_f32 v78, v78, v158
    v_cvt_pk_bf16_f32 v78, v78, v78
    v_lshlrev_b32 v78, 16, v78
    v_add_f32 v78, v78, v142
    v_mul_f32 v79, v79, v159
    v_cvt_pk_bf16_f32 v79, v79, v79
    v_lshlrev_b32 v79, 16, v79
    v_add_f32 v79, v79, v143
    v_cvt_pk_bf16_f32 v80, v64, v65
    v_cvt_pk_bf16_f32 v81, v66, v67
    v_cvt_pk_bf16_f32 v82, v68, v69
    v_cvt_pk_bf16_f32 v83, v70, v71
    v_cvt_pk_bf16_f32 v84, v72, v73
    v_cvt_pk_bf16_f32 v85, v74, v75
    v_cvt_pk_bf16_f32 v86, v76, v77
    v_cvt_pk_bf16_f32 v87, v78, v79
    s_lshr_b32 s45, s63, 5
    s_lshl_b32 s45, s45, 16
    s_and_b32 s46, s63, 31
    s_lshl_b32 s46, s46, 8
    s_add_u32 s45, s45, s46
    s_add_u32 s45, s45, 0xc00000
    s_add_u32 s46, s45, 32768
    buffer_store_dwordx4 v[80:83], v2, s[12:15], s45 offen sc1
    buffer_store_dwordx4 v[84:87], v2, s[12:15], s46 offen sc1
L_b_skip_140:
    s_waitcnt vmcnt(0)
    s_barrier
    s_cmp_lg_u32 s44, 0
    s_cbranch_scc1 L_pub_144
    v_mov_b32 v30, s62
    v_mov_b32 v31, 0
    s_mov_b64 exec, 1
    buffer_store_dword v30, v31, s[12:15], s65 offen sc1
    s_mov_b64 exec, -1
L_pub_144:
    s_cmp_ge_u32 s41, 28
    s_cbranch_scc1 L_b_loop_139
    s_add_u32 s45, s64, 8192
    s_cmp_lg_u32 s44, 0
    s_cbranch_scc1 L_pw_145
    s_mov_b32 exec_hi, 0
    s_mov_b32 s70, 0
L_wp_146:
    buffer_load_dword v31, v5, s[12:15], s45 offen sc1
    s_add_u32 s70, s70, 1
    s_cmp_ge_u32 s70, 0x200000
    s_cbranch_scc1 L_w_done_102
    s_waitcnt vmcnt(0)
    v_cmp_gt_u32 vcc, s62, v31
    s_nop 1
    s_cbranch_vccz L_wp_146_ok
    s_sleep 1
    s_branch L_wp_146
L_wp_146_ok:
    s_mov_b64 exec, -1
L_pw_145:
    s_barrier
    s_mul_i32 s53, s50, 65536
    s_add_u32 s53, s53, s52
    s_lshl_b32 s54, s44, 13
    s_add_u32 s53, s53, s54
    s_mul_i32 s57, s50, 229376
    s_add_u32 s57, s57, s56
    s_lshl_b32 s45, s44, 11
    s_add_u32 s57, s57, s45
    s_add_u32 s55, s54, 65536
    s_mov_b32 s58, 0
    v_mov_b32 v13, v3
    v_add_u32 v14, 65536, v13
    v_xor_b32 v15, 64, v13
    v_xor_b32 v16, 64, v14
    s_mov_b32 s76, 0x20000000
    s_add_u32 s48, s53, 0
    s_add_u32 s49, s48, 4096
    s_add_u32 m0, s54, 0
    s_nop 0
    buffer_load_dwordx4 v6, s[12:15], s48 offen offset:0 sc1 lds
    s_add_u32 m0, s54, 1024
    s_nop 0
    buffer_load_dwordx4 v9, s[12:15], s48 offen offset:0 sc1 lds
    s_add_u32 m0, s54, 2048
    s_nop 0
    buffer_load_dwordx4 v6, s[12:15], s49 offen offset:0 sc1 lds
    s_add_u32 m0, s54, 3072
    s_nop 0
    buffer_load_dwordx4 v9, s[12:15], s49 offen offset:0 sc1 lds
    s_add_u32 m0, s54, 3968
    s_nop 0
    buffer_load_dwordx4 v6, s[12:15], s48 offen offset:128 sc1 lds
    s_add_u32 m0, s54, 4992
    s_nop 0
    buffer_load_dwordx4 v9, s[12:15], s48 offen offset:128 sc1 lds
    s_add_u32 m0, s54, 6016
    s_nop 0
    buffer_load_dwordx4 v6, s[12:15], s49 offen offset:128 sc1 lds
    s_add_u32 m0, s54, 7040
    s_nop 0
    buffer_load_dwordx4 v9, s[12:15], s49 offen offset:128 sc1 lds
    s_add_u32 s48, s53, 32768
    s_add_u32 s49, s48, 4096
    s_add_u32 s46, s54, 32768
    s_add_u32 m0, s46, 0
    s_nop 0
    buffer_load_dwordx4 v6, s[12:15], s48 offen offset:0 sc1 lds
    s_add_u32 m0, s46, 1024
    s_nop 0
    buffer_load_dwordx4 v9, s[12:15], s48 offen offset:0 sc1 lds
    s_add_u32 m0, s46, 2048
    s_nop 0
    buffer_load_dwordx4 v6, s[12:15], s49 offen offset:0 sc1 lds
    s_add_u32 m0, s46, 3072
    s_nop 0
    buffer_load_dwordx4 v9, s[12:15], s49 offen offset:0 sc1 lds
    s_add_u32 m0, s46, 3968
    s_nop 0
    buffer_load_dwordx4 v6, s[12:15], s48 offen offset:128 sc1 lds
    s_add_u32 m0, s46, 4992
    s_nop 0
    buffer_load_dwordx4 v9, s[12:15], s48 offen offset:128 sc1 lds
    s_add_u32 m0, s46, 6016
    s_nop 0
    buffer_load_dwordx4 v6, s[12:15], s49 offen offset:128 sc1 lds
    s_add_u32 m0, s46, 7040
    s_nop 0
    buffer_load_dwordx4 v9, s[12:15], s49 offen offset:128 sc1 lds
    s_add_u32 s48, s53, 65536
    s_cmp_gt_u32 s51, 1
    s_cselect_b32 s48, s48, 0x20000000
    s_add_u32 s49, s48, 4096
    s_add_u32 m0, s55, 0
    s_nop 0
    buffer_load_dwordx4 v6, s[12:15], s48 offen offset:0 sc1 lds
    s_add_u32 m0, s55, 1024
    s_nop 0
    buffer_load_dwordx4 v9, s[12:15], s48 offen offset:0 sc1 lds
    s_add_u32 m0, s55, 2048
    s_nop 0
    buffer_load_dwordx4 v6, s[12:15], s49 offen offset:0 sc1 lds
    s_add_u32 m0, s55, 3072
    s_nop 0
    buffer_load_dwordx4 v9, s[12:15], s49 offen offset:0 sc1 lds
    s_add_u32 m0, s55, 3968
    s_nop 0
    buffer_load_dwordx4 v6, s[12:15], s48 offen offset:128 sc1 lds
    s_add_u32 m0, s55, 4992
    s_nop 0
    buffer_load_dwordx4 v9, s[12:15], s48 offen offset:128 sc1 lds
    s_add_u32 m0, s55, 6016
    s_nop 0
    buffer_load_dwordx4 v6, s[12:15], s49 offen offset:128 sc1 lds
    s_add_u32 m0, s55, 7040
    s_nop 0
    buffer_load_dwordx4 v9, s[12:15], s49 offen offset:128 sc1 lds
    s_waitcnt vmcnt(16)
    s_barrier
    ds_read_b128 v[32:35], v13 offset:0
    ds_read_b128 v[36:39], v13 offset:2048
    ds_read_b128 v[40:43], v15 offset:0
    ds_read_b128 v[44:47], v15 offset:2048
L_e_loop_147:
    s_add_u32 s48, s53, 98304
    s_add_u32 s46, s58, 1
    s_cmp_lt_u32 s46, s51
    s_cselect_b32 s48, s48, 0x20000000
    s_add_u32 s49, s48, 4096
    s_add_u32 s59, s55, 32768
    s_waitcnt lgkmcnt(2)
    v_mfma_f32_16x16x32_bf16 v[80:83], a[0:3], v[32:35], 0
    ds_read_b128 v[48:51], v13 offset:4096
    ds_read_b128 v[52:55], v13 offset:6144
    v_mfma_f32_16x16x32_bf16 v[84:87], a[4:7], v[32:35], 0
    ds_read_b128 v[56:59], v15 offset:4096
    ds_read_b128 v[60:63], v15 offset:6144
    v_mfma_f32_16x16x32_bf16 v[88:91], a[0:3], v[36:39], 0
    s_add_u32 m0, s59, 0
    s_nop 0
    buffer_load_dwordx4 v6, s[12:15], s48 offen offset:0 sc1 lds
    v_mfma_f32_16x16x32_bf16 v[92:95], a[4:7], v[36:39], 0
    v_lshlrev_b32 v224, 16, v216
    v_and_b32 v225, 0xffff0000, v216
    s_waitcnt lgkmcnt(4)
    v_mfma_f32_16x16x32_bf16 v[80:83], a[8:11], v[40:43], v[80:83]
    ds_read_b128 v[32:35], v13 offset:8192
    ds_read_b128 v[36:39], v13 offset:10240
    v_mfma_f32_16x16x32_bf16 v[84:87], a[12:15], v[40:43], v[84:87]
    v_lshlrev_b32 v226, 16, v217
    v_and_b32 v227, 0xffff0000, v217
    v_mfma_f32_16x16x32_bf16 v[88:91], a[8:11], v[44:47], v[88:91]
    s_add_u32 m0, s59, 1024
    s_nop 0
    buffer_load_dwordx4 v9, s[12:15], s48 offen offset:0 sc1 lds
    v_mfma_f32_16x16x32_bf16 v[92:95], a[12:15], v[44:47], v[92:95]
    v_lshlrev_b32 v228, 16, v218
    v_and_b32 v229, 0xffff0000, v218
    s_waitcnt lgkmcnt(4)
    v_mfma_f32_16x16x32_bf16 v[80:83], a[16:19], v[48:51], v[80:83]
    ds_read_b128 v[40:43], v15 offset:8192
    ds_read_b128 v[44:47], v15 offset:10240
    v_mfma_f32_16x16x32_bf16 v[84:87], a[20:23], v[48:51], v[84:87]
    v_lshlrev_b32 v230, 16, v219
    v_and_b32 v231, 0xffff0000, v219
    v_mfma_f32_16x16x32_bf16 v[88:91], a[16:19], v[52:55], v[88:91]
    s_add_u32 m0, s59, 2048
    s_nop 0
    buffer_load_dwordx4 v6, s[12:15], s49 offen offset:0 sc1 lds
    v_mfma_f32_16x16x32_bf16 v[92:95], a[20:23], v[52:55], v[92:95]
    v_lshlrev_b32 v232, 16, v220
    v_and_b32 v233, 0xffff0000, v220
    s_waitcnt lgkmcnt(4)
    v_mfma_f32_16x16x32_bf16 v[80:83], a[24:27], v[56:59], v[80:83]
    ds_read_b128 v[48:51], v13 offset:12288
    ds_read_b128 v[52:55], v13 offset:14336
    v_mfma_f32_16x16x32_bf16 v[84:87], a[28:31], v[56:59], v[84:87]
    v_lshlrev_b32 v234, 16, v221
    v_and_b32 v235, 0xffff0000, v221
    v_mfma_f32_16x16x32_bf16 v[88:91], a[24:27], v[60:63], v[88:91]
    s_add_u32 m0, s59, 3072
    s_nop 0
    buffer_load_dwordx4 v9, s[12:15], s49 offen offset:0 sc1 lds
    v_mfma_f32_16x16x32_bf16 v[92:95], a[28:31], v[60:63], v[92:95]
    v_lshlrev_b32 v236, 16, v222
    v_and_b32 v237, 0xffff0000, v222
    s_waitcnt lgkmcnt(4)
    v_mfma_f32_16x16x32_bf16 v[80:83], a[32:35], v[32:35], v[80:83]
    ds_read_b128 v[56:59], v15 offset:12288
    ds_read_b128 v[60:63], v15 offset:14336
    v_mfma_f32_16x16x32_bf16 v[84:87], a[36:39], v[32:35], v[84:87]
    v_lshlrev_b32 v238, 16, v223
    v_and_b32 v239, 0xffff0000, v223
    v_mfma_f32_16x16x32_bf16 v[88:91], a[32:35], v[36:39], v[88:91]
    s_add_u32 m0, s59, 3968
    s_nop 0
    buffer_load_dwordx4 v6, s[12:15], s48 offen offset:128 sc1 lds
    v_mfma_f32_16x16x32_bf16 v[92:95], a[36:39], v[36:39], v[92:95]
    v_pk_add_f32 v[224:225], v[224:225], v[96:97]
    v_pk_add_f32 v[226:227], v[226:227], v[98:99]
    s_waitcnt lgkmcnt(4)
    v_mfma_f32_16x16x32_bf16 v[80:83], a[40:43], v[40:43], v[80:83]
    ds_read_b128 v[32:35], v13 offset:16384
    ds_read_b128 v[36:39], v13 offset:18432
    v_mfma_f32_16x16x32_bf16 v[84:87], a[44:47], v[40:43], v[84:87]
    v_pk_add_f32 v[228:229], v[228:229], v[100:101]
    v_pk_add_f32 v[230:231], v[230:231], v[102:103]
    v_mfma_f32_16x16x32_bf16 v[88:91], a[40:43], v[44:47], v[88:91]
    s_add_u32 m0, s59, 4992
    s_nop 0
    buffer_load_dwordx4 v9, s[12:15], s48 offen offset:128 sc1 lds
    v_mfma_f32_16x16x32_bf16 v[92:95], a[44:47], v[44:47], v[92:95]
    v_pk_add_f32 v[232:233], v[232:233], v[96:97]
    v_pk_add_f32 v[234:235], v[234:235], v[98:99]
    s_waitcnt lgkmcnt(4)
    v_mfma_f32_16x16x32_bf16 v[80:83], a[48:51], v[48:51], v[80:83]
    ds_read_b128 v[40:43], v15 offset:16384
    ds_read_b128 v[44:47], v15 offset:18432
    v_mfma_f32_16x16x32_bf16 v[84:87], a[52:55], v[48:51], v[84:87]
    v_pk_add_f32 v[236:237], v[236:237], v[100:101]
    v_pk_add_f32 v[238:239], v[238:239], v[102:103]
    v_mfma_f32_16x16x32_bf16 v[88:91], a[48:51], v[52:55], v[88:91]
    s_add_u32 m0, s59, 6016
    s_nop 0
    buffer_load_dwordx4 v6, s[12:15], s49 offen offset:128 sc1 lds
    v_mfma_f32_16x16x32_bf16 v[92:95], a[52:55], v[52:55], v[92:95]
    v_cvt_pk_bf16_f32 v216, v224, v225
    v_cvt_pk_bf16_f32 v217, v226, v227
    s_waitcnt lgkmcnt(4)
    v_mfma_f32_16x16x32_bf16 v[80:83], a[56:59], v[56:59], v[80:83]
    ds_read_b128 v[48:51], v13 offset:20480
    ds_read_b128 v[52:55], v13 offset:22528
    v_mfma_f32_16x16x32_bf16 v[84:87], a[60:63], v[56:59], v[84:87]
    v_cvt_pk_bf16_f32 v218, v228, v229
    v_cvt_pk_bf16_f32 v219, v230, v231
    v_mfma_f32_16x16x32_bf16 v[88:91], a[56:59], v[60:63], v[88:91]
    s_add_u32 m0, s59, 7040
    s_nop 0
    buffer_load_dwordx4 v9, s[12:15], s49 offen offset:128 sc1 lds
    v_mfma_f32_16x16x32_bf16 v[92:95], a[60:63], v[60:63], v[92:95]
    v_cvt_pk_bf16_f32 v220, v232, v233
    v_cvt_pk_bf16_f32 v221, v234, v235
    s_waitcnt lgkmcnt(4)
    v_mfma_f32_16x16x32_bf16 v[80:83], a[64:67], v[32:35], v[80:83]
    ds_read_b128 v[56:59], v15 offset:20480
    ds_read_b128 v[60:63], v15 offset:22528
    v_mfma_f32_16x16x32_bf16 v[84:87], a[68:71], v[32:35], v[84:87]
    v_cvt_pk_bf16_f32 v222, v236, v237
    v_cvt_pk_bf16_f32 v223, v238, v239
    v_mfma_f32_16x16x32_bf16 v[88:91], a[64:67], v[36:39], v[88:91]
    v_lshlrev_b32 v224, 16, v216
    v_and_b32 v225, 0xffff0000, v216
    v_mfma_f32_16x16x32_bf16 v[92:95], a[68:71], v[36:39], v[92:95]
    v_lshlrev_b32 v226, 16, v217
    v_and_b32 v227, 0xffff0000, v217
    s_waitcnt lgkmcnt(4)
    v_mfma_f32_16x16x32_bf16 v[80:83], a[72:75], v[40:43], v[80:83]
    ds_read_b128 v[32:35], v13 offset:24576
    ds_read_b128 v[36:39], v13 offset:26624
    v_mfma_f32_16x16x32_bf16 v[84:87], a[76:79], v[40:43], v[84:87]
    v_lshlrev_b32 v228, 16, v218
    v_and_b32 v229, 0xffff0000, v218
    v_mfma_f32_16x16x32_bf16 v[88:91], a[72:75], v[44:47], v[88:91]
    v_lshlrev_b32 v230, 16, v219
    v_and_b32 v231, 0xffff0000, v219
    v_mfma_f32_16x16x32_bf16 v[92:95], a[76:79], v[44:47], v[92:95]
    v_lshlrev_b32 v232, 16, v220
    v_and_b32 v233, 0xffff0000, v220
    s_waitcnt lgkmcnt(4)
    v_mfma_f32_16x16x32_bf16 v[80:83], a[80:83], v[48:51], v[80:83]
    ds_read_b128 v[40:43], v15 offset:24576
    ds_read_b128 v[44:47], v15 offset:26624
    v_mfma_f32_16x16x32_bf16 v[84:87], a[84:87], v[48:51], v[84:87]
    v_lshlrev_b32 v234, 16, v221
    v_and_b32 v235, 0xffff0000, v221
    v_mfma_f32_16x16x32_bf16 v[88:91], a[80:83], v[52:55], v[88:91]
    v_lshlrev_b32 v236, 16, v222
    v_and_b32 v237, 0xffff0000, v222
    v_mfma_f32_16x16x32_bf16 v[92:95], a[84:87], v[52:55], v[92:95]
    v_lshlrev_b32 v238, 16, v223
    v_and_b32 v239, 0xffff0000, v223
    s_waitcnt lgkmcnt(4)
    v_mfma_f32_16x16x32_bf16 v[80:83], a[88:91], v[56:59], v[80:83]
    ds_read_b128 v[48:51], v13 offset:28672
    ds_read_b128 v[52:55], v13 offset:30720
    v_mfma_f32_16x16x32_bf16 v[84:87], a[92:95], v[56:59], v[84:87]
    v_pk_mul_f32 v[240:241], v[224:225], v[224:225]
    v_pk_mul_f32 v[242:243], v[226:227], v[226:227]
    v_mfma_f32_16x16x32_bf16 v[88:91], a[88:91], v[60:63], v[88:91]
    v_pk_mul_f32 v[244:245], v[228:229], v[228:229]
    v_pk_mul_f32 v[246:247], v[230:231], v[230:231]
    v_mfma_f32_16x16x32_bf16 v[92:95], a[92:95], v[60:63], v[92:95]
    v_pk_mul_f32 v[248:249], v[232:233], v[232:233]
    v_pk_mul_f32 v[250:251], v[234:235], v[234:235]
    s_waitcnt lgkmcnt(4)
    v_mfma_f32_16x16x32_bf16 v[80:83], a[96:99], v[32:35], v[80:83]
    ds_read_b128 v[56:59], v15 offset:28672
    ds_read_b128 v[60:63], v15 offset:30720
    v_mfma_f32_16x16x32_bf16 v[84:87], a[100:103], v[32:35], v[84:87]
    v_pk_mul_f32 v[252:253], v[236:237], v[236:237]
    v_pk_mul_f32 v[254:255], v[238:239], v[238:239]
    v_mfma_f32_16x16x32_bf16 v[88:91], a[96:99], v[36:39], v[88:91]
    v_pk_fma_f32 v[240:241], v[240:241], v[104:105], v[106:107]
    v_pk_fma_f32 v[242:243], v[242:243], v[104:105], v[106:107]
    v_mfma_f32_16x16x32_bf16 v[92:95], a[100:103], v[36:39], v[92:95]
    v_pk_fma_f32 v[244:245], v[244:245], v[104:105], v[106:107]
    v_pk_fma_f32 v[246:247], v[246:247], v[104:105], v[106:107]
    s_waitcnt lgkmcnt(4)
    v_mfma_f32_16x16x32_bf16 v[80:83], a[104:107], v[40:43], v[80:83]
    v_pk_fma_f32 v[248:249], v[248:249], v[104:105], v[106:107]
    v_pk_fma_f32 v[250:251], v[250:251], v[104:105], v[106:107]
    v_mfma_f32_16x16x32_bf16 v[84:87], a[108:111], v[40:43], v[84:87]
    v_pk_fma_f32 v[252:253], v[252:253], v[104:105], v[106:107]
    v_pk_fma_f32 v[254:255], v[254:255], v[104:105], v[106:107]
    v_mfma_f32_16x16x32_bf16 v[88:91], a[104:107], v[44:47], v[88:91]
    v_pk_mul_f32 v[240:241], v[240:241], v[224:225]
    v_pk_mul_f32 v[242:243], v[242:243], v[226:227]
    v_mfma_f32_16x16x32_bf16 v[92:95], a[108:111], v[44:47], v[92:95]
    v_pk_mul_f32 v[244:245], v[244:245], v[228:229]
    v_pk_mul_f32 v[246:247], v[246:247], v[230:231]
    s_waitcnt vmcnt(16) lgkmcnt(0)
    s_barrier
    v_mfma_f32_16x16x32_bf16 v[80:83], a[112:115], v[48:51], v[80:83]
    ds_read_b128 v[32:35], v13 offset:32768
    ds_read_b128 v[36:39], v13 offset:34816
    v_mfma_f32_16x16x32_bf16 v[84:87], a[116:119], v[48:51], v[84:87]
    v_pk_mul_f32 v[248:249], v[248:249], v[232:233]
    v_pk_mul_f32 v[250:251], v[250:251], v[234:235]
    v_mfma_f32_16x16x32_bf16 v[88:91], a[112:115], v[52:55], v[88:91]
    v_pk_mul_f32 v[252:253], v[252:253], v[236:237]
    v_pk_mul_f32 v[254:255], v[254:255], v[238:239]
    v_mfma_f32_16x16x32_bf16 v[92:95], a[116:119], v[52:55], v[92:95]
    v_exp_f32 v240, v240
    v_mfma_f32_16x16x32_bf16 v[80:83], a[120:123], v[56:59], v[80:83]
    ds_read_b128 v[40:43], v15 offset:32768
    ds_read_b128 v[44:47], v15 offset:34816
    v_mfma_f32_16x16x32_bf16 v[84:87], a[124:127], v[56:59], v[84:87]
    v_exp_f32 v241, v241
    v_exp_f32 v242, v242
    v_mfma_f32_16x16x32_bf16 v[88:91], a[120:123], v[60:63], v[88:91]
    v_exp_f32 v243, v243
    v_mfma_f32_16x16x32_bf16 v[92:95], a[124:127], v[60:63], v[92:95]
    v_exp_f32 v244, v244
    s_add_u32 s48, s53, 131072
    s_add_u32 s46, s58, 2
    s_cmp_lt_u32 s46, s51
    s_cselect_b32 s48, s48, 0x20000000
    s_add_u32 s49, s48, 4096
    s_mov_b32 s59, s54
    s_waitcnt lgkmcnt(2)
    v_mfma_f32_16x16x32_bf16 v[80:83], a[128:131], v[32:35], v[80:83]
    ds_read_b128 v[48:51], v13 offset:36864
    ds_read_b128 v[52:55], v13 offset:38912
    v_mfma_f32_16x16x32_bf16 v[84:87], a[132:135], v[32:35], v[84:87]
    ds_read_b128 v[56:59], v15 offset:36864
    ds_read_b128 v[60:63], v15 offset:38912
    v_mfma_f32_16x16x32_bf16 v[88:91], a[128:131], v[36:39], v[88:91]
    s_add_u32 m0, s59, 0
    s_nop 0
    buffer_load_dwordx4 v6, s[12:15], s48 offen offset:0 sc1 lds
    v_mfma_f32_16x16x32_bf16 v[92:95], a[132:135], v[36:39], v[92:95]
    v_exp_f32 v245, v245
    v_exp_f32 v246, v246
    s_waitcnt lgkmcnt(4)
    v_mfma_f32_16x16x32_bf16 v[80:83], a[136:139], v[40:43], v[80:83]
    ds_read_b128 v[32:35], v13 offset:40960
    ds_read_b128 v[36:39], v13 offset:43008
    v_mfma_f32_16x16x32_bf16 v[84:87], a[140:143], v[40:43], v[84:87]
    v_exp_f32 v247, v247
    v_exp_f32 v248, v248
    v_mfma_f32_16x16x32_bf16 v[88:91], a[136:139], v[44:47], v[88:91]
    s_add_u32 m0, s59, 1024
    s_nop 0
    buffer_load_dwordx4 v9, s[12:15], s48 offen offset:0 sc1 lds
    v_mfma_f32_16x16x32_bf16 v[92:95], a[140:143], v[44:47], v[92:95]
    v_exp_f32 v249, v249
    v_exp_f32 v250, v250
    s_waitcnt lgkmcnt(4)
    v_mfma_f32_16x16x32_bf16 v[80:83], a[144:147], v[48:51], v[80:83]
    ds_read_b128 v[40:43], v15 offset:40960
    ds_read_b128 v[44:47], v15 offset:43008
    v_mfma_f32_16x16x32_bf16 v[84:87], a[148:151], v[48:51], v[84:87]
    v_exp_f32 v251, v251
    v_exp_f32 v252, v252
    v_mfma_f32_16x16x32_bf16 v[88:91], a[144:147], v[52:55], v[88:91]
    s_add_u32 m0, s59, 2048
    s_nop 0
    buffer_load_dwordx4 v6, s[12:15], s49 offen offset:0 sc1 lds
    v_mfma_f32_16x16x32_bf16 v[92:95], a[148:151], v[52:55], v[92:95]
    v_exp_f32 v253, v253
    v_exp_f32 v254, v254
    s_waitcnt lgkmcnt(4)
    v_mfma_f32_16x16x32_bf16 v[80:83], a[152:155], v[56:59], v[80:83]
    ds_read_b128 v[48:51], v13 offset:45056
    ds_read_b128 v[52:55], v13 offset:47104
    v_mfma_f32_16x16x32_bf16 v[84:87], a[156:159], v[56:59], v[84:87]
    v_exp_f32 v255, v255
    v_add_f32 v240, 1.0, v240
    v_mfma_f32_16x16x32_bf16 v[88:91], a[152:155], v[60:63], v[88:91]
    s_add_u32 m0, s59, 3072
    s_nop 0
    buffer_load_dwordx4 v9, s[12:15], s49 offen offset:0 sc1 lds
    v_mfma_f32_16x16x32_bf16 v[92:95], a[156:159], v[60:63], v[92:95]
    v_add_f32 v241, 1.0, v241
    v_add_f32 v242, 1.0, v242
    s_waitcnt lgkmcnt(4)
    v_mfma_f32_16x16x32_bf16 v[80:83], a[160:163], v[32:35], v[80:83]
    ds_read_b128 v[56:59], v15 offset:45056
    ds_read_b128 v[60:63], v15 offset:47104
    v_mfma_f32_16x16x32_bf16 v[84:87], a[164:167], v[32:35], v[84:87]
    v_add_f32 v243, 1.0, v243
    v_add_f32 v244, 1.0, v244
    v_mfma_f32_16x16x32_bf16 v[88:91], a[160:163], v[36:39], v[88:91]
    s_add_u32 m0, s59, 3968
    s_nop 0
    buffer_load_dwordx4 v6, s[12:15], s48 offen offset:128 sc1 lds
    v_mfma_f32_16x16x32_bf16 v[92:95], a[164:167], v[36:39], v[92:95]
    v_add_f32 v245, 1.0, v245
    v_add_f32 v246, 1.0, v246
    s_waitcnt lgkmcnt(4)
    v_mfma_f32_16x16x32_bf16 v[80:83], a[168:171], v[40:43], v[80:83]
    ds_read_b128 v[32:35], v13 offset:49152
    ds_read_b128 v[36:39], v13 offset:51200
    v_mfma_f32_16x16x32_bf16 v[84:87], a[172:175], v[40:43], v[84:87]
    v_add_f32 v247, 1.0, v247
    v_add_f32 v248, 1.0, v248
    v_mfma_f32_16x16x32_bf16 v[88:91], a[168:171], v[44:47], v[88:91]
    s_add_u32 m0, s59, 4992
    s_nop 0
    buffer_load_dwordx4 v9, s[12:15], s48 offen offset:128 sc1 lds
    v_mfma_f32_16x16x32_bf16 v[92:95], a[172:175], v[44:47], v[92:95]
    v_add_f32 v249, 1.0, v249
    v_add_f32 v250, 1.0, v250
    s_waitcnt lgkmcnt(4)
    v_mfma_f32_16x16x32_bf16 v[80:83], a[176:179], v[48:51], v[80:83]
    ds_read_b128 v[40:43], v15 offset:49152
    ds_read_b128 v[44:47], v15 offset:51200
    v_mfma_f32_16x16x32_bf16 v[84:87], a[180:183], v[48:51], v[84:87]
    v_add_f32 v251, 1.0, v251
    v_add_f32 v252, 1.0, v252
    v_mfma_f32_16x16x32_bf16 v[88:91], a[176:179], v[52:55], v[88:91]
    s_add_u32 m0, s59, 6016
    s_nop 0
    buffer_load_dwordx4 v6, s[12:15], s49 offen offset:128 sc1 lds
    v_mfma_f32_16x16x32_bf16 v[92:95], a[180:183], v[52:55], v[92:95]
    v_add_f32 v253, 1.0, v253
    v_add_f32 v254, 1.0, v254
    s_waitcnt lgkmcnt(4)
    v_mfma_f32_16x16x32_bf16 v[80:83], a[184:187], v[56:59], v[80:83]
    ds_read_b128 v[48:51], v13 offset:53248
    ds_read_b128 v[52:55], v13 offset:55296
    v_mfma_f32_16x16x32_bf16 v[84:87], a[188:191], v[56:59], v[84:87]
    v_add_f32 v255, 1.0, v255
    v_rcp_f32 v240, v240
    v_mfma_f32_16x16x32_bf16 v[88:91], a[184:187], v[60:63], v[88:91]
    s_add_u32 m0, s59, 7040
    s_nop 0
    buffer_load_dwordx4 v9, s[12:15], s49 offen offset:128 sc1 lds
    v_mfma_f32_16x16x32_bf16 v[92:95], a[188:191], v[60:63], v[92:95]
    v_rcp_f32 v241, v241
    v_rcp_f32 v242, v242
    s_waitcnt lgkmcnt(4)
    v_mfma_f32_16x16x32_bf16 v[80:83], a[192:195], v[32:35], v[80:83]
    ds_read_b128 v[56:59], v15 offset:53248
    ds_read_b128 v[60:63], v15 offset:55296
    v_mfma_f32_16x16x32_bf16 v[84:87], a[196:199], v[32:35], v[84:87]
    v_rcp_f32 v243, v243
    v_rcp_f32 v244, v244
    v_mfma_f32_16x16x32_bf16 v[88:91], a[192:195], v[36:39], v[88:91]
    v_rcp_f32 v245, v245
    v_rcp_f32 v246, v246
    v_mfma_f32_16x16x32_bf16 v[92:95], a[196:199], v[36:39], v[92:95]
    v_rcp_f32 v247, v247
    v_rcp_f32 v248, v248
    s_waitcnt lgkmcnt(4)
    v_mfma_f32_16x16x32_bf16 v[80:83], a[200:203], v[40:43], v[80:83]
    ds_read_b128 v[32:35], v13 offset:57344
    ds_read_b128 v[36:39], v13 offset:59392
    v_mfma_f32_16x16x32_bf16 v[84:87], a[204:207], v[40:43], v[84:87]
    v_rcp_f32 v249, v249
    v_rcp_f32 v250, v250
    v_mfma_f32_16x16x32_bf16 v[88:91], a[200:203], v[44:47], v[88:91]
    v_rcp_f32 v251, v251
    v_mfma_f32_16x16x32_bf16 v[92:95], a[204:207], v[44:47], v[92:95]
    v_rcp_f32 v252, v252
    s_waitcnt lgkmcnt(4)
    v_mfma_f32_16x16x32_bf16 v[80:83], a[208:211], v[48:51], v[80:83]
    ds_read_b128 v[40:43], v15 offset:57344
    ds_read_b128 v[44:47], v15 offset:59392
    v_mfma_f32_16x16x32_bf16 v[84:87], a[212:215], v[48:51], v[84:87]
    v_rcp_f32 v253, v253
    v_rcp_f32 v254, v254
    v_mfma_f32_16x16x32_bf16 v[88:91], a[208:211], v[52:55], v[88:91]
    v_rcp_f32 v255, v255
    v_mfma_f32_16x16x32_bf16 v[92:95], a[212:215], v[52:55], v[92:95]
    v_pk_mul_f32 v[224:225], v[224:225], v[240:241]
    s_waitcnt lgkmcnt(4)
    v_mfma_f32_16x16x32_bf16 v[80:83], a[216:219], v[56:59], v[80:83]
    ds_read_b128 v[48:51], v13 offset:61440
    ds_read_b128 v[52:55], v13 offset:63488
    v_mfma_f32_16x16x32_bf16 v[84:87], a[220:223], v[56:59], v[84:87]
    v_pk_mul_f32 v[226:227], v[226:227], v[242:243]
    v_pk_mul_f32 v[228:229], v[228:229], v[244:245]
    v_mfma_f32_16x16x32_bf16 v[88:91], a[216:219], v[60:63], v[88:91]
    v_pk_mul_f32 v[230:231], v[230:231], v[246:247]
    v_mfma_f32_16x16x32_bf16 v[92:95], a[220:223], v[60:63], v[92:95]
    v_pk_mul_f32 v[232:233], v[232:233], v[248:249]
    s_waitcnt lgkmcnt(4)
    v_mfma_f32_16x16x32_bf16 v[80:83], a[224:227], v[32:35], v[80:83]
    ds_read_b128 v[56:59], v15 offset:61440
    ds_read_b128 v[60:63], v15 offset:63488
    v_mfma_f32_16x16x32_bf16 v[84:87], a[228:231], v[32:35], v[84:87]
    v_pk_mul_f32 v[234:235], v[234:235], v[250:251]
    v_pk_mul_f32 v[236:237], v[236:237], v[252:253]
    v_mfma_f32_16x16x32_bf16 v[88:91], a[224:227], v[36:39], v[88:91]
    v_pk_mul_f32 v[238:239], v[238:239], v[254:255]
    v_mfma_f32_16x16x32_bf16 v[92:95], a[228:231], v[36:39], v[92:95]
    v_cvt_pk_bf16_f32 v240, v224, v225
    s_waitcnt lgkmcnt(4)
    v_mfma_f32_16x16x32_bf16 v[80:83], a[232:235], v[40:43], v[80:83]
    v_cvt_pk_bf16_f32 v241, v226, v227
    v_mfma_f32_16x16x32_bf16 v[84:87], a[236:239], v[40:43], v[84:87]
    v_cvt_pk_bf16_f32 v242, v228, v229
    v_mfma_f32_16x16x32_bf16 v[88:91], a[232:235], v[44:47], v[88:91]
    v_cvt_pk_bf16_f32 v243, v230, v231
    v_mfma_f32_16x16x32_bf16 v[92:95], a[236:239], v[44:47], v[92:95]
    v_cvt_pk_bf16_f32 v244, v232, v233
    s_waitcnt vmcnt(16) lgkmcnt(0)
    s_barrier
    v_mfma_f32_16x16x32_bf16 v[80:83], a[240:243], v[48:51], v[80:83]
    ds_read_b128 v[32:35], v14 offset:0
    ds_read_b128 v[36:39], v14 offset:2048
    v_mfma_f32_16x16x32_bf16 v[84:87], a[244:247], v[48:51], v[84:87]
    v_cvt_pk_bf16_f32 v245, v234, v235
    v_cvt_pk_bf16_f32 v246, v236, v237
    v_mfma_f32_16x16x32_bf16 v[88:91], a[240:243], v[52:55], v[88:91]
    v_cvt_pk_bf16_f32 v247, v238, v239
    v_mfma_f32_16x16x32_bf16 v[92:95], a[244:247], v[52:55], v[92:95]
    buffer_store_dwordx4 v[240:243], v10, s[12:15], s76 offen sc1
    v_mfma_f32_16x16x32_bf16 v[80:83], a[248:251], v[56:59], v[80:83]
    ds_read_b128 v[40:43], v16 offset:0
    ds_read_b128 v[44:47], v16 offset:2048
    v_mfma_f32_16x16x32_bf16 v[84:87], a[252:255], v[56:59], v[84:87]
    buffer_store_dwordx4 v[244:247], v10, s[12:15], s76 offen offset:1024 sc1
    v_mfma_f32_16x16x32_bf16 v[88:91], a[248:251], v[60:63], v[88:91]
    v_mfma_f32_16x16x32_bf16 v[92:95], a[252:255], v[60:63], v[92:95]
    s_add_u32 s53, s53, 65536
    s_add_u32 s58, s58, 1
    v_swap_b32 v13, v14
    s_xor_b32 s54, s54, 65536
    s_xor_b32 s55, s55, 65536
    s_mov_b32 s76, s57
    v_swap_b32 v15, v16
    s_add_u32 s57, s57, 229376
    v_cvt_pk_bf16_f32 v216, v80, v81
    v_cvt_pk_bf16_f32 v217, v82, v83
    v_cvt_pk_bf16_f32 v218, v84, v85
    v_cvt_pk_bf16_f32 v219, v86, v87
    v_cvt_pk_bf16_f32 v220, v88, v89
    v_cvt_pk_bf16_f32 v221, v90, v91
    v_cvt_pk_bf16_f32 v222, v92, v93
    v_cvt_pk_bf16_f32 v223, v94, v95
    s_cmp_lt_u32 s58, s51
    s_cbranch_scc1 L_e_loop_147
    v_lshlrev_b32 v224, 16, v216
    v_and_b32 v225, 0xffff0000, v216
    v_lshlrev_b32 v226, 16, v217
    v_and_b32 v227, 0xffff0000, v217
    v_lshlrev_b32 v228, 16, v218
    v_and_b32 v229, 0xffff0000, v218
    v_lshlrev_b32 v230, 16, v219
    v_and_b32 v231, 0xffff0000, v219
    v_lshlrev_b32 v232, 16, v220
    v_and_b32 v233, 0xffff0000, v220
    v_lshlrev_b32 v234, 16, v221
    v_and_b32 v235, 0xffff0000, v221
    v_lshlrev_b32 v236, 16, v222
    v_and_b32 v237, 0xffff0000, v222
    v_lshlrev_b32 v238, 16, v223
    v_and_b32 v239, 0xffff0000, v223
    v_pk_add_f32 v[224:225], v[224:225], v[96:97]
    v_pk_add_f32 v[226:227], v[226:227], v[98:99]
    v_pk_add_f32 v[228:229], v[228:229], v[100:101]
    v_pk_add_f32 v[230:231], v[230:231], v[102:103]
    v_pk_add_f32 v[232:233], v[232:233], v[96:97]
    v_pk_add_f32 v[234:235], v[234:235], v[98:99]
    v_pk_add_f32 v[236:237], v[236:237], v[100:101]
    v_pk_add_f32 v[238:239], v[238:239], v[102:103]
    v_cvt_pk_bf16_f32 v216, v224, v225
    v_cvt_pk_bf16_f32 v217, v226, v227
    v_cvt_pk_bf16_f32 v218, v228, v229
    v_cvt_pk_bf16_f32 v219, v230, v231
    v_cvt_pk_bf16_f32 v220, v232, v233
    v_cvt_pk_bf16_f32 v221, v234, v235
    v_cvt_pk_bf16_f32 v222, v236, v237
    v_cvt_pk_bf16_f32 v223, v238, v239
    v_lshlrev_b32 v224, 16, v216
    v_and_b32 v225, 0xffff0000, v216
    v_lshlrev_b32 v226, 16, v217
    v_and_b32 v227, 0xffff0000, v217
    v_lshlrev_b32 v228, 16, v218
    v_and_b32 v229, 0xffff0000, v218
    v_lshlrev_b32 v230, 16, v219
    v_and_b32 v231, 0xffff0000, v219
    v_lshlrev_b32 v232, 16, v220
    v_and_b32 v233, 0xffff0000, v220
    v_lshlrev_b32 v234, 16, v221
    v_and_b32 v235, 0xffff0000, v221
    v_lshlrev_b32 v236, 16, v222
    v_and_b32 v237, 0xffff0000, v222
    v_lshlrev_b32 v238, 16, v223
    v_and_b32 v239, 0xffff0000, v223
    v_pk_mul_f32 v[240:241], v[224:225], v[224:225]
    v_pk_mul_f32 v[242:243], v[226:227], v[226:227]
    v_pk_mul_f32 v[244:245], v[228:229], v[228:229]
    v_pk_mul_f32 v[246:247], v[230:231], v[230:231]
    v_pk_mul_f32 v[248:249], v[232:233], v[232:233]
    v_pk_mul_f32 v[250:251], v[234:235], v[234:235]
    v_pk_mul_f32 v[252:253], v[236:237], v[236:237]
    v_pk_mul_f32 v[254:255], v[238:239], v[238:239]
    v_pk_fma_f32 v[240:241], v[240:241], v[104:105], v[106:107]
    v_pk_fma_f32 v[242:243], v[242:243], v[104:105], v[106:107]
    v_pk_fma_f32 v[244:245], v[244:245], v[104:105], v[106:107]
    v_pk_fma_f32 v[246:247], v[246:247], v[104:105], v[106:107]
    v_pk_fma_f32 v[248:249], v[248:249], v[104:105], v[106:107]
    v_pk_fma_f32 v[250:251], v[250:251], v[104:105], v[106:107]
    v_pk_fma_f32 v[252:253], v[252:253], v[104:105], v[106:107]
    v_pk_fma_f32 v[254:255], v[254:255], v[104:105], v[106:107]
    v_pk_mul_f32 v[240:241], v[240:241], v[224:225]
    v_pk_mul_f32 v[242:243], v[242:243], v[226:227]
    v_pk_mul_f32 v[244:245], v[244:245], v[228:229]
    v_pk_mul_f32 v[246:247], v[246:247], v[230:231]
    v_pk_mul_f32 v[248:249], v[248:249], v[232:233]
    v_pk_mul_f32 v[250:251], v[250:251], v[234:235]
    v_pk_mul_f32 v[252:253], v[252:253], v[236:237]
    v_pk_mul_f32 v[254:255], v[254:255], v[238:239]
    v_exp_f32 v240, v240
    v_exp_f32 v241, v241
    v_exp_f32 v242, v242
    v_exp_f32 v243, v243
    v_exp_f32 v244, v244
    v_exp_f32 v245, v245
    v_exp_f32 v246, v246
    v_exp_f32 v247, v247
    v_exp_f32 v248, v248
    v_exp_f32 v249, v249
    v_exp_f32 v250, v250
    v_exp_f32 v251, v251
    v_exp_f32 v252, v252
    v_exp_f32 v253, v253
    v_exp_f32 v254, v254
    v_exp_f32 v255, v255
    v_add_f32 v240, 1.0, v240
    v_add_f32 v241, 1.0, v241
    v_add_f32 v242, 1.0, v242
    v_add_f32 v243, 1.0, v243
    v_add_f32 v244, 1.0, v244
    v_add_f32 v245, 1.0, v245
    v_add_f32 v246, 1.0, v246
    v_add_f32 v247, 1.0, v247
    v_add_f32 v248, 1.0, v248
    v_add_f32 v249, 1.0, v249
    v_add_f32 v250, 1.0, v250
    v_add_f32 v251, 1.0, v251
    v_add_f32 v252, 1.0, v252
    v_add_f32 v253, 1.0, v253
    v_add_f32 v254, 1.0, v254
    v_add_f32 v255, 1.0, v255
    v_rcp_f32 v240, v240
    v_rcp_f32 v241, v241
    v_rcp_f32 v242, v242
    v_rcp_f32 v243, v243
    v_rcp_f32 v244, v244
    v_rcp_f32 v245, v245
    v_rcp_f32 v246, v246
    v_rcp_f32 v247, v247
    v_rcp_f32 v248, v248
    v_rcp_f32 v249, v249
    v_rcp_f32 v250, v250
    v_rcp_f32 v251, v251
    v_rcp_f32 v252, v252
    v_rcp_f32 v253, v253
    v_rcp_f32 v254, v254
    v_rcp_f32 v255, v255
    v_pk_mul_f32 v[224:225], v[224:225], v[240:241]
    v_pk_mul_f32 v[226:227], v[226:227], v[242:243]
    v_pk_mul_f32 v[228:229], v[228:229], v[244:245]
    v_pk_mul_f32 v[230:231], v[230:231], v[246:247]
    v_pk_mul_f32 v[232:233], v[232:233], v[248:249]
    v_pk_mul_f32 v[234:235], v[234:235], v[250:251]
    v_pk_mul_f32 v[236:237], v[236:237], v[252:253]
    v_pk_mul_f32 v[238:239], v[238:239], v[254:255]
    v_cvt_pk_bf16_f32 v240, v224, v225
    v_cvt_pk_bf16_f32 v241, v226, v227
    v_cvt_pk_bf16_f32 v242, v228, v229
    v_cvt_pk_bf16_f32 v243, v230, v231
    v_cvt_pk_bf16_f32 v244, v232, v233
    v_cvt_pk_bf16_f32 v245, v234, v235
    v_cvt_pk_bf16_f32 v246, v236, v237
    v_cvt_pk_bf16_f32 v247, v238, v239
    buffer_store_dwordx4 v[240:243], v10, s[12:15], s76 offen sc1
    buffer_store_dwordx4 v[244:247], v10, s[12:15], s76 offen offset:1024 sc1
    s_waitcnt lgkmcnt(0)
    s_waitcnt vmcnt(0)
    s_barrier
    s_cmp_lg_u32 s44, 0
    s_cbranch_scc1 L_pub_148
    v_mov_b32 v30, s62
    v_mov_b32 v31, 0
    s_mov_b64 exec, 1
    buffer_store_dword v30, v31, s[12:15], s67 offen sc1
    s_mov_b64 exec, -1
L_pub_148:
    s_branch L_b_loop_139
L_role_c_121:
    s_load_dwordx2 s[6:7], s[0:1], 80
    s_load_dwordx2 s[8:9], s[0:1], 88
    s_load_dwordx2 s[10:11], s[0:1], 112
    s_waitcnt lgkmcnt(0)
    s_mov_b32 s24, s6
    s_and_b32 s25, s7, 0xffff
    s_mov_b32 s26, 0x700000
    s_mov_b32 s27, 0x00020000
    s_mov_b32 s28, s8
    s_and_b32 s29, s9, 0xffff
    s_mov_b32 s30, 0x800
    s_mov_b32 s31, 0x00020000
    s_mov_b32 s32, s10
    s_and_b32 s33, s11, 0xffff
    s_mov_b32 s34, 0x400000
    s_mov_b32 s35, 0x00020000
    s_mul_i32 s46, s38, 1835008
    s_lshl_b32 s45, s68, 8
    s_add_u32 s46, s46, s45
    s_waitcnt vmcnt(0)
    s_barrier
    v_lshrrev_b32 v20, 4, v1
    s_lshl_b32 s45, s44, 2
    v_add_u32 v21, s45, v20
    s_mov_b32 s45, 2048
    v_mul_lo_u32 v21, v21, s45
    v_lshlrev_b32 v22, 2, v20
    v_and_b32 v23, 15, v1
    v_xor_b32 v22, v22, v23
    v_lshlrev_b32 v22, 4, v22
    v_add_u32 v21, v21, v22
    v_bfe_u32 v22, v1, 2, 2
    v_lshlrev_b32 v23, 3, v20
    v_add_u32 v23, v23, v22
    v_lshlrev_b32 v23, 8, v23
    v_xor_b32 v22, s44, v22
    v_lshlrev_b32 v22, 6, v22
    v_add_u32 v23, v23, v22
    v_and_b32 v22, 3, v1
    v_lshlrev_b32 v22, 3, v22
    v_add_u32 v23, v23, v22
    v_add_u32 v24, 65536, v23
    v_add_u32 v25, 131072, v23
    s_lshl_b32 s47, s44, 10
    s_add_u32 s45, s46, 0x0
    s_add_u32 m0, s47, 0
    s_nop 0
    buffer_load_dwordx4 v21, s[24:27], s45 offen  lds
    s_add_u32 s45, s46, 0x8000
    s_add_u32 m0, s47, 4096
    s_nop 0
    buffer_load_dwordx4 v21, s[24:27], s45 offen  lds
    s_add_u32 s45, s46, 0x10000
    s_add_u32 m0, s47, 8192
    s_nop 0
    buffer_load_dwordx4 v21, s[24:27], s45 offen  lds
    s_add_u32 s45, s46, 0x18000
    s_add_u32 m0, s47, 12288
    s_nop 0
    buffer_load_dwordx4 v21, s[24:27], s45 offen  lds
    s_add_u32 s45, s46, 0x20000
    s_add_u32 m0, s47, 16384
    s_nop 0
    buffer_load_dwordx4 v21, s[24:27], s45 offen  lds
    s_add_u32 s45, s46, 0x28000
    s_add_u32 m0, s47, 20480
    s_nop 0
    buffer_load_dwordx4 v21, s[24:27], s45 offen  lds
    s_add_u32 s45, s46, 0x30000
    s_add_u32 m0, s47, 24576
    s_nop 0
    buffer_load_dwordx4 v21, s[24:27], s45 offen  lds
    s_add_u32 s45, s46, 0x38000
    s_add_u32 m0, s47, 28672
    s_nop 0
    buffer_load_dwordx4 v21, s[24:27], s45 offen  lds
    s_add_u32 s45, s46, 0x40000
    s_add_u32 m0, s47, 32768
    s_nop 0
    buffer_load_dwordx4 v21, s[24:27], s45 offen  lds
    s_add_u32 s45, s46, 0x48000
    s_add_u32 m0, s47, 36864
    s_nop 0
    buffer_load_dwordx4 v21, s[24:27], s45 offen  lds
    s_add_u32 s45, s46, 0x50000
    s_add_u32 m0, s47, 40960
    s_nop 0
    buffer_load_dwordx4 v21, s[24:27], s45 offen  lds
    s_add_u32 s45, s46, 0x58000
    s_add_u32 m0, s47, 45056
    s_nop 0
    buffer_load_dwordx4 v21, s[24:27], s45 offen  lds
    s_add_u32 s45, s46, 0x60000
    s_add_u32 m0, s47, 49152
    s_nop 0
    buffer_load_dwordx4 v21, s[24:27], s45 offen  lds
    s_add_u32 s45, s46, 0x68000
    s_add_u32 m0, s47, 53248
    s_nop 0
    buffer_load_dwordx4 v21, s[24:27], s45 offen  lds
    s_add_u32 s45, s46, 0x70000
    s_add_u32 m0, s47, 57344
    s_nop 0
    buffer_load_dwordx4 v21, s[24:27], s45 offen  lds
    s_add_u32 s45, s46, 0x78000
    s_add_u32 m0, s47, 61440
    s_nop 0
    buffer_load_dwordx4 v21, s[24:27], s45 offen  lds
    s_add_u32 s45, s46, 0x80000
    s_add_u32 m0, s47, 65536
    s_nop 0
    buffer_load_dwordx4 v21, s[24:27], s45 offen  lds
    s_add_u32 s45, s46, 0x88000
    s_add_u32 m0, s47, 69632
    s_nop 0
    buffer_load_dwordx4 v21, s[24:27], s45 offen  lds
    s_add_u32 s45, s46, 0x90000
    s_add_u32 m0, s47, 73728
    s_nop 0
    buffer_load_dwordx4 v21, s[24:27], s45 offen  lds
    s_add_u32 s45, s46, 0x98000
    s_add_u32 m0, s47, 77824
    s_nop 0
    buffer_load_dwordx4 v21, s[24:27], s45 offen  lds
    s_add_u32 s45, s46, 0xa0000
    s_add_u32 m0, s47, 81920
    s_nop 0
    buffer_load_dwordx4 v21, s[24:27], s45 offen  lds
    s_add_u32 s45, s46, 0xa8000
    s_add_u32 m0, s47, 86016
    s_nop 0
    buffer_load_dwordx4 v21, s[24:27], s45 offen  lds
    s_add_u32 s45, s46, 0xb0000
    s_add_u32 m0, s47, 90112
    s_nop 0
    buffer_load_dwordx4 v21, s[24:27], s45 offen  lds
    s_add_u32 s45, s46, 0xb8000
    s_add_u32 m0, s47, 94208
    s_nop 0
    buffer_load_dwordx4 v21, s[24:27], s45 offen  lds
    s_add_u32 s45, s46, 0xc0000
    s_add_u32 m0, s47, 98304
    s_nop 0
    buffer_load_dwordx4 v21, s[24:27], s45 offen  lds
    s_add_u32 s45, s46, 0xc8000
    s_add_u32 m0, s47, 102400
    s_nop 0
    buffer_load_dwordx4 v21, s[24:27], s45 offen  lds
    s_add_u32 s45, s46, 0xd0000
    s_add_u32 m0, s47, 106496
    s_nop 0
    buffer_load_dwordx4 v21, s[24:27], s45 offen  lds
    s_add_u32 s45, s46, 0xd8000
    s_add_u32 m0, s47, 110592
    s_nop 0
    buffer_load_dwordx4 v21, s[24:27], s45 offen  lds
    s_add_u32 s45, s46, 0xe0000
    s_add_u32 m0, s47, 114688
    s_nop 0
    buffer_load_dwordx4 v21, s[24:27], s45 offen  lds
    s_add_u32 s45, s46, 0xe8000
    s_add_u32 m0, s47, 118784
    s_nop 0
    buffer_load_dwordx4 v21, s[24:27], s45 offen  lds
    s_add_u32 s45, s46, 0xf0000
    s_add_u32 m0, s47, 122880
    s_nop 0
    buffer_load_dwordx4 v21, s[24:27], s45 offen  lds
    s_add_u32 s45, s46, 0xf8000
    s_add_u32 m0, s47, 126976
    s_nop 0
    buffer_load_dwordx4 v21, s[24:27], s45 offen  lds
    s_waitcnt vmcnt(28)
    s_barrier
    s_add_u32 s45, s46, 0x100000
    s_add_u32 m0, s47, 131072
    s_nop 0
    buffer_load_dwordx4 v21, s[24:27], s45 offen  lds
    s_add_u32 s45, s46, 0x108000
    s_add_u32 m0, s47, 135168
    s_nop 0
    buffer_load_dwordx4 v21, s[24:27], s45 offen  lds
    s_add_u32 s45, s46, 0x110000
    s_add_u32 m0, s47, 139264
    s_nop 0
    buffer_load_dwordx4 v21, s[24:27], s45 offen  lds
    s_add_u32 s45, s46, 0x118000
    s_add_u32 m0, s47, 143360
    s_nop 0
    buffer_load_dwordx4 v21, s[24:27], s45 offen  lds
    ds_read_b64_tr_b16 a[0:1], v23 offset:0
    ds_read_b64_tr_b16 a[2:3], v23 offset:1024
    ds_read_b64_tr_b16 a[4:5], v23 offset:32
    ds_read_b64_tr_b16 a[6:7], v23 offset:1056
    ds_read_b64_tr_b16 a[8:9], v23 offset:8192
    ds_read_b64_tr_b16 a[10:11], v23 offset:9216
    ds_read_b64_tr_b16 a[12:13], v23 offset:8224
    ds_read_b64_tr_b16 a[14:15], v23 offset:9248
    s_waitcnt lgkmcnt(0)
    s_waitcnt vmcnt(28)
    s_barrier
    s_add_u32 s45, s46, 0x120000
    s_add_u32 m0, s47, 0
    s_nop 0
    buffer_load_dwordx4 v21, s[24:27], s45 offen  lds
    s_add_u32 s45, s46, 0x128000
    s_add_u32 m0, s47, 4096
    s_nop 0
    buffer_load_dwordx4 v21, s[24:27], s45 offen  lds
    s_add_u32 s45, s46, 0x130000
    s_add_u32 m0, s47, 8192
    s_nop 0
    buffer_load_dwordx4 v21, s[24:27], s45 offen  lds
    s_add_u32 s45, s46, 0x138000
    s_add_u32 m0, s47, 12288
    s_nop 0
    buffer_load_dwordx4 v21, s[24:27], s45 offen  lds
    ds_read_b64_tr_b16 a[16:17], v23 offset:16384
    ds_read_b64_tr_b16 a[18:19], v23 offset:17408
    ds_read_b64_tr_b16 a[20:21], v23 offset:16416
    ds_read_b64_tr_b16 a[22:23], v23 offset:17440
    ds_read_b64_tr_b16 a[24:25], v23 offset:24576
    ds_read_b64_tr_b16 a[26:27], v23 offset:25600
    ds_read_b64_tr_b16 a[28:29], v23 offset:24608
    ds_read_b64_tr_b16 a[30:31], v23 offset:25632
    s_waitcnt lgkmcnt(0)
    s_waitcnt vmcnt(28)
    s_barrier
    s_add_u32 s45, s46, 0x140000
    s_add_u32 m0, s47, 16384
    s_nop 0
    buffer_load_dwordx4 v21, s[24:27], s45 offen  lds
    s_add_u32 s45, s46, 0x148000
    s_add_u32 m0, s47, 20480
    s_nop 0
    buffer_load_dwordx4 v21, s[24:27], s45 offen  lds
    s_add_u32 s45, s46, 0x150000
    s_add_u32 m0, s47, 24576
    s_nop 0
    buffer_load_dwordx4 v21, s[24:27], s45 offen  lds
    s_add_u32 s45, s46, 0x158000
    s_add_u32 m0, s47, 28672
    s_nop 0
    buffer_load_dwordx4 v21, s[24:27], s45 offen  lds
    ds_read_b64_tr_b16 a[32:33], v23 offset:32768
    ds_read_b64_tr_b16 a[34:35], v23 offset:33792
    ds_read_b64_tr_b16 a[36:37], v23 offset:32800
    ds_read_b64_tr_b16 a[38:39], v23 offset:33824
    ds_read_b64_tr_b16 a[40:41], v23 offset:40960
    ds_read_b64_tr_b16 a[42:43], v23 offset:41984
    ds_read_b64_tr_b16 a[44:45], v23 offset:40992
    ds_read_b64_tr_b16 a[46:47], v23 offset:42016
    s_waitcnt lgkmcnt(0)
    s_waitcnt vmcnt(28)
    s_barrier
    s_add_u32 s45, s46, 0x160000
    s_add_u32 m0, s47, 32768
    s_nop 0
    buffer_load_dwordx4 v21, s[24:27], s45 offen  lds
    s_add_u32 s45, s46, 0x168000
    s_add_u32 m0, s47, 36864
    s_nop 0
    buffer_load_dwordx4 v21, s[24:27], s45 offen  lds
    s_add_u32 s45, s46, 0x170000
    s_add_u32 m0, s47, 40960
    s_nop 0
    buffer_load_dwordx4 v21, s[24:27], s45 offen  lds
    s_add_u32 s45, s46, 0x178000
    s_add_u32 m0, s47, 45056
    s_nop 0
    buffer_load_dwordx4 v21, s[24:27], s45 offen  lds
    ds_read_b64_tr_b16 a[48:49], v23 offset:49152
    ds_read_b64_tr_b16 a[50:51], v23 offset:50176
    ds_read_b64_tr_b16 a[52:53], v23 offset:49184
    ds_read_b64_tr_b16 a[54:55], v23 offset:50208
    ds_read_b64_tr_b16 a[56:57], v23 offset:57344
    ds_read_b64_tr_b16 a[58:59], v23 offset:58368
    ds_read_b64_tr_b16 a[60:61], v23 offset:57376
    ds_read_b64_tr_b16 a[62:63], v23 offset:58400
    s_waitcnt lgkmcnt(0)
    s_waitcnt vmcnt(28)
    s_barrier
    s_add_u32 s45, s46, 0x180000
    s_add_u32 m0, s47, 49152
    s_nop 0
    buffer_load_dwordx4 v21, s[24:27], s45 offen  lds
    s_add_u32 s45, s46, 0x188000
    s_add_u32 m0, s47, 53248
    s_nop 0
    buffer_load_dwordx4 v21, s[24:27], s45 offen  lds
    s_add_u32 s45, s46, 0x190000
    s_add_u32 m0, s47, 57344
    s_nop 0
    buffer_load_dwordx4 v21, s[24:27], s45 offen  lds
    s_add_u32 s45, s46, 0x198000
    s_add_u32 m0, s47, 61440
    s_nop 0
    buffer_load_dwordx4 v21, s[24:27], s45 offen  lds
    ds_read_b64_tr_b16 a[64:65], v24 offset:0
    ds_read_b64_tr_b16 a[66:67], v24 offset:1024
    ds_read_b64_tr_b16 a[68:69], v24 offset:32
    ds_read_b64_tr_b16 a[70:71], v24 offset:1056
    ds_read_b64_tr_b16 a[72:73], v24 offset:8192
    ds_read_b64_tr_b16 a[74:75], v24 offset:9216
    ds_read_b64_tr_b16 a[76:77], v24 offset:8224
    ds_read_b64_tr_b16 a[78:79], v24 offset:9248
    s_waitcnt lgkmcnt(0)
    s_waitcnt vmcnt(28)
    s_barrier
    s_add_u32 s45, s46, 0x1a0000
    s_add_u32 m0, s47, 65536
    s_nop 0
    buffer_load_dwordx4 v21, s[24:27], s45 offen  lds
    s_add_u32 s45, s46, 0x1a8000
    s_add_u32 m0, s47, 69632
    s_nop 0
    buffer_load_dwordx4 v21, s[24:27], s45 offen  lds
    s_add_u32 s45, s46, 0x1b0000
    s_add_u32 m0, s47, 73728
    s_nop 0
    buffer_load_dwordx4 v21, s[24:27], s45 offen  lds
    s_add_u32 s45, s46, 0x1b8000
    s_add_u32 m0, s47, 77824
    s_nop 0
    buffer_load_dwordx4 v21, s[24:27], s45 offen  lds
    ds_read_b64_tr_b16 a[80:81], v24 offset:16384
    ds_read_b64_tr_b16 a[82:83], v24 offset:17408
    ds_read_b64_tr_b16 a[84:85], v24 offset:16416
    ds_read_b64_tr_b16 a[86:87], v24 offset:17440
    ds_read_b64_tr_b16 a[88:89], v24 offset:24576
    ds_read_b64_tr_b16 a[90:91], v24 offset:25600
    ds_read_b64_tr_b16 a[92:93], v24 offset:24608
    ds_read_b64_tr_b16 a[94:95], v24 offset:25632
    s_waitcnt lgkmcnt(0)
    s_waitcnt vmcnt(28)
    s_barrier
    ds_read_b64_tr_b16 a[96:97], v24 offset:32768
    ds_read_b64_tr_b16 a[98:99], v24 offset:33792
    ds_read_b64_tr_b16 a[100:101], v24 offset:32800
    ds_read_b64_tr_b16 a[102:103], v24 offset:33824
    ds_read_b64_tr_b16 a[104:105], v24 offset:40960
    ds_read_b64_tr_b16 a[106:107], v24 offset:41984
    ds_read_b64_tr_b16 a[108:109], v24 offset:40992
    ds_read_b64_tr_b16 a[110:111], v24 offset:42016
    s_waitcnt lgkmcnt(0)
    s_waitcnt vmcnt(24)
    s_barrier
    ds_read_b64_tr_b16 a[112:113], v24 offset:49152
    ds_read_b64_tr_b16 a[114:115], v24 offset:50176
    ds_read_b64_tr_b16 a[116:117], v24 offset:49184
    ds_read_b64_tr_b16 a[118:119], v24 offset:50208
    ds_read_b64_tr_b16 a[120:121], v24 offset:57344
    ds_read_b64_tr_b16 a[122:123], v24 offset:58368
    ds_read_b64_tr_b16 a[124:125], v24 offset:57376
    ds_read_b64_tr_b16 a[126:127], v24 offset:58400
    s_waitcnt lgkmcnt(0)
    s_waitcnt vmcnt(20)
    s_barrier
    ds_read_b64_tr_b16 a[128:129], v25 offset:0
    ds_read_b64_tr_b16 a[130:131], v25 offset:1024
    ds_read_b64_tr_b16 a[132:133], v25 offset:32
    ds_read_b64_tr_b16 a[134:135], v25 offset:1056
    ds_read_b64_tr_b16 a[136:137], v25 offset:8192
    ds_read_b64_tr_b16 a[138:139], v25 offset:9216
    ds_read_b64_tr_b16 a[140:141], v25 offset:8224
    ds_read_b64_tr_b16 a[142:143], v25 offset:9248
    s_waitcnt lgkmcnt(0)
    s_waitcnt vmcnt(16)
    s_barrier
    ds_read_b64_tr_b16 a[144:145], v23 offset:0
    ds_read_b64_tr_b16 a[146:147], v23 offset:1024
    ds_read_b64_tr_b16 a[148:149], v23 offset:32
    ds_read_b64_tr_b16 a[150:151], v23 offset:1056
    ds_read_b64_tr_b16 a[152:153], v23 offset:8192
    ds_read_b64_tr_b16 a[154:155], v23 offset:9216
    ds_read_b64_tr_b16 a[156:157], v23 offset:8224
    ds_read_b64_tr_b16 a[158:159], v23 offset:9248
    s_waitcnt lgkmcnt(0)
    s_waitcnt vmcnt(12)
    s_barrier
    ds_read_b64_tr_b16 a[160:161], v23 offset:16384
    ds_read_b64_tr_b16 a[162:163], v23 offset:17408
    ds_read_b64_tr_b16 a[164:165], v23 offset:16416
    ds_read_b64_tr_b16 a[166:167], v23 offset:17440
    ds_read_b64_tr_b16 a[168:169], v23 offset:24576
    ds_read_b64_tr_b16 a[170:171], v23 offset:25600
    ds_read_b64_tr_b16 a[172:173], v23 offset:24608
    ds_read_b64_tr_b16 a[174:175], v23 offset:25632
    s_waitcnt lgkmcnt(0)
    s_waitcnt vmcnt(8)
    s_barrier
    ds_read_b64_tr_b16 a[176:177], v23 offset:32768
    ds_read_b64_tr_b16 a[178:179], v23 offset:33792
    ds_read_b64_tr_b16 a[180:181], v23 offset:32800
    ds_read_b64_tr_b16 a[182:183], v23 offset:33824
    ds_read_b64_tr_b16 a[184:185], v23 offset:40960
    ds_read_b64_tr_b16 a[186:187], v23 offset:41984
    ds_read_b64_tr_b16 a[188:189], v23 offset:40992
    ds_read_b64_tr_b16 a[190:191], v23 offset:42016
    s_waitcnt lgkmcnt(0)
    s_waitcnt vmcnt(4)
    s_barrier
    ds_read_b64_tr_b16 a[192:193], v23 offset:49152
    ds_read_b64_tr_b16 a[194:195], v23 offset:50176
    ds_read_b64_tr_b16 a[196:197], v23 offset:49184
    ds_read_b64_tr_b16 a[198:199], v23 offset:50208
    ds_read_b64_tr_b16 a[200:201], v23 offset:57344
    ds_read_b64_tr_b16 a[202:203], v23 offset:58368
    ds_read_b64_tr_b16 a[204:205], v23 offset:57376
    ds_read_b64_tr_b16 a[206:207], v23 offset:58400
    s_waitcnt lgkmcnt(0)
    s_waitcnt vmcnt(0)
    s_barrier
    ds_read_b64_tr_b16 a[208:209], v24 offset:0
    ds_read_b64_tr_b16 a[210:211], v24 offset:1024
    ds_read_b64_tr_b16 a[212:213], v24 offset:32
    ds_read_b64_tr_b16 a[214:215], v24 offset:1056
    ds_read_b64_tr_b16 a[216:217], v24 offset:8192
    ds_read_b64_tr_b16 a[218:219], v24 offset:9216
    ds_read_b64_tr_b16 a[220:221], v24 offset:8224
    ds_read_b64_tr_b16 a[222:223], v24 offset:9248
    s_waitcnt lgkmcnt(0)
    s_barrier
    buffer_load_dwordx4 v[80:83], v10, s[28:31], 0 offen
    buffer_load_dwordx4 v[84:87], v10, s[28:31], 0 offen offset:1024
    s_waitcnt vmcnt(0)
    v_lshlrev_b32 v96, 16, v80
    v_and_b32 v97, 0xffff0000, v80
    v_lshlrev_b32 v98, 16, v81
    v_and_b32 v99, 0xffff0000, v81
    v_lshlrev_b32 v100, 16, v82
    v_and_b32 v101, 0xffff0000, v82
    v_lshlrev_b32 v102, 16, v83
    v_and_b32 v103, 0xffff0000, v83
    v_lshlrev_b32 v104, 16, v84
    v_and_b32 v105, 0xffff0000, v84
    v_lshlrev_b32 v106, 16, v85
    v_and_b32 v107, 0xffff0000, v85
    v_lshlrev_b32 v108, 16, v86
    v_and_b32 v109, 0xffff0000, v86
    v_lshlrev_b32 v110, 16, v87
    v_and_b32 v111, 0xffff0000, v87
    s_cmp_lg_u32 s44, 0
    s_cbranch_scc1 L_pd_149
    v_mov_b32 v29, 132
    s_mov_b32 s46, 96
    s_mov_b64 exec, 1
    s_mov_b32 s70, 0
L_wp_150:
    buffer_load_dword v31, v29, s[16:19], 0 offen sc1
    s_add_u32 s70, s70, 1
    s_cmp_ge_u32 s70, 0x200000
    s_cbranch_scc1 L_w_done_102
    s_waitcnt vmcnt(0)
    v_cmp_gt_u32 vcc, s46, v31
    s_nop 1
    s_cbranch_vccz L_wp_150_ok
    s_sleep 3
    s_branch L_wp_150
L_wp_150_ok:
    s_mov_b64 exec, -1
L_pd_149:
    s_barrier
    v_lshlrev_b32 v29, 5, v1
    s_mov_b32 s45, 20480
    buffer_load_dwordx4 v[112:115], v29, s[12:15], s45 offen offset:0 sc1
    buffer_load_dwordx4 v[116:119], v29, s[12:15], s45 offen offset:16 sc1
    buffer_load_dwordx4 v[120:123], v29, s[12:15], s45 offen offset:2048 sc1
    buffer_load_dwordx4 v[124:127], v29, s[12:15], s45 offen offset:2064 sc1
    s_mov_b32 s45, 45056
    buffer_load_dwordx4 v[32:35], v29, s[12:15], s45 offen offset:0 sc1
    buffer_load_dwordx4 v[36:39], v29, s[12:15], s45 offen offset:16 sc1
    buffer_load_dwordx4 v[40:43], v29, s[12:15], s45 offen offset:2048 sc1
    buffer_load_dwordx4 v[44:47], v29, s[12:15], s45 offen offset:2064 sc1
    s_waitcnt vmcnt(0)
    v_add_f32 v112, v112, v32
    v_cvt_pk_bf16_f32 v112, v112, v112
    v_lshlrev_b32 v112, 16, v112
    v_add_f32 v113, v113, v33
    v_cvt_pk_bf16_f32 v113, v113, v113
    v_lshlrev_b32 v113, 16, v113
    v_add_f32 v114, v114, v34
    v_cvt_pk_bf16_f32 v114, v114, v114
    v_lshlrev_b32 v114, 16, v114
    v_add_f32 v115, v115, v35
    v_cvt_pk_bf16_f32 v115, v115, v115
    v_lshlrev_b32 v115, 16, v115
    v_add_f32 v116, v116, v36
    v_cvt_pk_bf16_f32 v116, v116, v116
    v_lshlrev_b32 v116, 16, v116
    v_add_f32 v117, v117, v37
    v_cvt_pk_bf16_f32 v117, v117, v117
    v_lshlrev_b32 v117, 16, v117
    v_add_f32 v118, v118, v38
    v_cvt_pk_bf16_f32 v118, v118, v118
    v_lshlrev_b32 v118, 16, v118
    v_add_f32 v119, v119, v39
    v_cvt_pk_bf16_f32 v119, v119, v119
    v_lshlrev_b32 v119, 16, v119
    v_add_f32 v120, v120, v40
    v_cvt_pk_bf16_f32 v120, v120, v120
    v_lshlrev_b32 v120, 16, v120
    v_add_f32 v121, v121, v41
    v_cvt_pk_bf16_f32 v121, v121, v121
    v_lshlrev_b32 v121, 16, v121
    v_add_f32 v122, v122, v42
    v_cvt_pk_bf16_f32 v122, v122, v122
    v_lshlrev_b32 v122, 16, v122
    v_add_f32 v123, v123, v43
    v_cvt_pk_bf16_f32 v123, v123, v123
    v_lshlrev_b32 v123, 16, v123
    v_add_f32 v124, v124, v44
    v_cvt_pk_bf16_f32 v124, v124, v124
    v_lshlrev_b32 v124, 16, v124
    v_add_f32 v125, v125, v45
    v_cvt_pk_bf16_f32 v125, v125, v125
    v_lshlrev_b32 v125, 16, v125
    v_add_f32 v126, v126, v46
    v_cvt_pk_bf16_f32 v126, v126, v126
    v_lshlrev_b32 v126, 16, v126
    v_add_f32 v127, v127, v47
    v_cvt_pk_bf16_f32 v127, v127, v127
    v_lshlrev_b32 v127, 16, v127
    s_mul_i32 s52, s38, 57344
    s_add_u32 s52, s52, 0x6000000
    s_lshl_b32 s56, s38, 23
    s_lshl_b32 s45, s68, 9
    s_add_u32 s56, s56, s45
    s_add_u32 s56, s56, 0xc000000
L_c_loop_151:
    s_cmp_eq_u64 s[36:37], 0
    s_cbranch_scc1 L_w_done_102
    s_ff1_i32_b64 s50, s[36:37]
    s_bitset0_b64 s[36:37], s50
    s_lshr_b64 s[74:75], s[72:73], s50
    s_ff1_i32_b64 s51, s[74:75]
    s_add_u32 s51, s51, 1
    s_add_u32 s62, s50, s51
    s_mul_i32 s45, s38, 896
    s_add_u32 s45, s45, s64
    s_add_u32 s45, s45, 12288
    s_cmp_lg_u32 s44, 0
    s_cbranch_scc1 L_pw_153
    s_mov_b64 exec, 127
    s_mov_b32 s70, 0
L_wp_154:
    buffer_load_dword v31, v5, s[12:15], s45 offen sc1
    s_add_u32 s70, s70, 1
    s_cmp_ge_u32 s70, 0x200000
    s_cbranch_scc1 L_w_done_102
    s_waitcnt vmcnt(0)
    v_cmp_gt_u32 vcc, s62, v31
    s_nop 1
    s_cbranch_vccz L_wp_154_ok
    s_sleep 2
    s_branch L_wp_154
L_wp_154_ok:
    s_mov_b64 exec, -1
L_pw_153:
    s_barrier
    s_mul_i32 s53, s50, 229376
    s_add_u32 s53, s53, s52
    s_lshl_b32 s54, s44, 13
    s_add_u32 s53, s53, s54
    s_mul_i32 s57, s50, 131072
    s_add_u32 s57, s57, s56
    s_lshl_b32 s45, s44, 7
    s_add_u32 s57, s57, s45
    s_add_u32 s55, s54, 65536
    s_mov_b32 s58, 0
    v_mov_b32 v13, v10
    v_add_u32 v14, 65536, v13
    v_xor_b32 v15, 64, v13
    v_xor_b32 v16, 64, v14
    s_mov_b32 s76, 0x20000000
    s_add_u32 s48, s53, 0
    s_add_u32 s49, s48, 4096
    s_add_u32 m0, s54, 0
    s_nop 0
    buffer_load_dwordx4 v10, s[12:15], s48 offen offset:0 sc1 lds
    buffer_load_dwordx4 v10, s[12:15], s48 offen offset:1024 sc1 lds
    buffer_load_dwordx4 v10, s[12:15], s48 offen offset:2048 sc1 lds
    buffer_load_dwordx4 v10, s[12:15], s48 offen offset:3072 sc1 lds
    s_add_u32 m0, s54, 4096
    s_nop 0
    buffer_load_dwordx4 v10, s[12:15], s49 offen offset:0 sc1 lds
    buffer_load_dwordx4 v10, s[12:15], s49 offen offset:1024 sc1 lds
    buffer_load_dwordx4 v10, s[12:15], s49 offen offset:2048 sc1 lds
    buffer_load_dwordx4 v10, s[12:15], s49 offen offset:3072 sc1 lds
    s_add_u32 s48, s53, 32768
    s_cmp_lt_u32 s44, 3
    s_cselect_b32 s48, s48, 0x20000000
    s_add_u32 s49, s48, 4096
    s_add_u32 s46, s54, 32768
    s_add_u32 m0, s46, 0
    s_nop 0
    buffer_load_dwordx4 v10, s[12:15], s48 offen offset:0 sc1 lds
    buffer_load_dwordx4 v10, s[12:15], s48 offen offset:1024 sc1 lds
    buffer_load_dwordx4 v10, s[12:15], s48 offen offset:2048 sc1 lds
    buffer_load_dwordx4 v10, s[12:15], s48 offen offset:3072 sc1 lds
    s_add_u32 m0, s46, 4096
    s_nop 0
    buffer_load_dwordx4 v10, s[12:15], s49 offen offset:0 sc1 lds
    buffer_load_dwordx4 v10, s[12:15], s49 offen offset:1024 sc1 lds
    buffer_load_dwordx4 v10, s[12:15], s49 offen offset:2048 sc1 lds
    buffer_load_dwordx4 v10, s[12:15], s49 offen offset:3072 sc1 lds
    s_add_u32 s48, s53, 229376
    s_cmp_gt_u32 s51, 1
    s_cselect_b32 s48, s48, 0x20000000
    s_add_u32 s49, s48, 4096
    s_add_u32 m0, s55, 0
    s_nop 0
    buffer_load_dwordx4 v10, s[12:15], s48 offen offset:0 sc1 lds
    buffer_load_dwordx4 v10, s[12:15], s48 offen offset:1024 sc1 lds
    buffer_load_dwordx4 v10, s[12:15], s48 offen offset:2048 sc1 lds
    buffer_load_dwordx4 v10, s[12:15], s48 offen offset:3072 sc1 lds
    s_add_u32 m0, s55, 4096
    s_nop 0
    buffer_load_dwordx4 v10, s[12:15], s49 offen offset:0 sc1 lds
    buffer_load_dwordx4 v10, s[12:15], s49 offen offset:1024 sc1 lds
    buffer_load_dwordx4 v10, s[12:15], s49 offen offset:2048 sc1 lds
    buffer_load_dwordx4 v10, s[12:15], s49 offen offset:3072 sc1 lds
    s_waitcnt vmcnt(16)
    s_barrier
    ds_read_b128 v[32:35], v13 offset:0
    ds_read_b128 v[36:39], v13 offset:1024
    ds_read_b128 v[40:43], v13 offset:2048
    ds_read_b128 v[44:47], v13 offset:3072
L_e_loop_155:
    s_add_u32 s48, s53, 262144
    s_add_u32 s46, s58, 1
    s_cmp_lt_u32 s46, s51
    s_cselect_b32 s48, s48, 0x20000000
    s_cmp_lt_u32 s44, 3
    s_cselect_b32 s48, s48, 0x20000000
    s_add_u32 s49, s48, 4096
    s_add_u32 s59, s55, 32768
    s_waitcnt lgkmcnt(2)
    v_mfma_f32_16x16x32_bf16 v[80:83], a[0:3], v[32:35], 0
    ds_read_b128 v[48:51], v13 offset:4096
    ds_read_b128 v[52:55], v13 offset:5120
    v_mfma_f32_16x16x32_bf16 v[84:87], a[4:7], v[32:35], 0
    ds_read_b128 v[56:59], v13 offset:6144
    ds_read_b128 v[60:63], v13 offset:7168
    v_mfma_f32_16x16x32_bf16 v[88:91], a[0:3], v[36:39], 0
    s_add_u32 m0, s59, 0
    s_nop 0
    buffer_load_dwordx4 v10, s[12:15], s48 offen offset:0 sc1 lds
    v_mfma_f32_16x16x32_bf16 v[92:95], a[4:7], v[36:39], 0
    s_waitcnt lgkmcnt(4)
    v_mfma_f32_16x16x32_bf16 v[80:83], a[8:11], v[40:43], v[80:83]
    ds_read_b128 v[32:35], v13 offset:8192
    ds_read_b128 v[36:39], v13 offset:9216
    v_mfma_f32_16x16x32_bf16 v[84:87], a[12:15], v[40:43], v[84:87]
    v_mfma_f32_16x16x32_bf16 v[88:91], a[8:11], v[44:47], v[88:91]
    buffer_load_dwordx4 v10, s[12:15], s48 offen offset:1024 sc1 lds
    v_mfma_f32_16x16x32_bf16 v[92:95], a[12:15], v[44:47], v[92:95]
    s_waitcnt lgkmcnt(4)
    v_mfma_f32_16x16x32_bf16 v[80:83], a[16:19], v[48:51], v[80:83]
    ds_read_b128 v[40:43], v13 offset:10240
    ds_read_b128 v[44:47], v13 offset:11264
    v_mfma_f32_16x16x32_bf16 v[84:87], a[20:23], v[48:51], v[84:87]
    v_mfma_f32_16x16x32_bf16 v[88:91], a[16:19], v[52:55], v[88:91]
    buffer_load_dwordx4 v10, s[12:15], s48 offen offset:2048 sc1 lds
    v_mfma_f32_16x16x32_bf16 v[92:95], a[20:23], v[52:55], v[92:95]
    s_waitcnt lgkmcnt(4)
    v_mfma_f32_16x16x32_bf16 v[80:83], a[24:27], v[56:59], v[80:83]
    ds_read_b128 v[48:51], v13 offset:12288
    ds_read_b128 v[52:55], v13 offset:13312
    v_mfma_f32_16x16x32_bf16 v[84:87], a[28:31], v[56:59], v[84:87]
    v_mfma_f32_16x16x32_bf16 v[88:91], a[24:27], v[60:63], v[88:91]
    buffer_load_dwordx4 v10, s[12:15], s48 offen offset:3072 sc1 lds
    v_mfma_f32_16x16x32_bf16 v[92:95], a[28:31], v[60:63], v[92:95]
    s_waitcnt lgkmcnt(4)
    v_mfma_f32_16x16x32_bf16 v[80:83], a[32:35], v[32:35], v[80:83]
    ds_read_b128 v[56:59], v13 offset:14336
    ds_read_b128 v[60:63], v13 offset:15360
    v_mfma_f32_16x16x32_bf16 v[84:87], a[36:39], v[32:35], v[84:87]
    v_mfma_f32_16x16x32_bf16 v[88:91], a[32:35], v[36:39], v[88:91]
    s_add_u32 m0, s59, 4096
    s_nop 0
    buffer_load_dwordx4 v10, s[12:15], s49 offen offset:0 sc1 lds
    v_mfma_f32_16x16x32_bf16 v[92:95], a[36:39], v[36:39], v[92:95]
    s_waitcnt lgkmcnt(4)
    v_mfma_f32_16x16x32_bf16 v[80:83], a[40:43], v[40:43], v[80:83]
    ds_read_b128 v[32:35], v13 offset:16384
    ds_read_b128 v[36:39], v13 offset:17408
    v_mfma_f32_16x16x32_bf16 v[84:87], a[44:47], v[40:43], v[84:87]
    v_mfma_f32_16x16x32_bf16 v[88:91], a[40:43], v[44:47], v[88:91]
    buffer_load_dwordx4 v10, s[12:15], s49 offen offset:1024 sc1 lds
    v_mfma_f32_16x16x32_bf16 v[92:95], a[44:47], v[44:47], v[92:95]
    s_waitcnt lgkmcnt(4)
    v_mfma_f32_16x16x32_bf16 v[80:83], a[48:51], v[48:51], v[80:83]
    ds_read_b128 v[40:43], v13 offset:18432
    ds_read_b128 v[44:47], v13 offset:19456
    v_mfma_f32_16x16x32_bf16 v[84:87], a[52:55], v[48:51], v[84:87]
    v_mfma_f32_16x16x32_bf16 v[88:91], a[48:51], v[52:55], v[88:91]
    buffer_load_dwordx4 v10, s[12:15], s49 offen offset:2048 sc1 lds
    v_mfma_f32_16x16x32_bf16 v[92:95], a[52:55], v[52:55], v[92:95]
    s_waitcnt lgkmcnt(4)
    v_mfma_f32_16x16x32_bf16 v[80:83], a[56:59], v[56:59], v[80:83]
    ds_read_b128 v[48:51], v13 offset:20480
    ds_read_b128 v[52:55], v13 offset:21504
    v_mfma_f32_16x16x32_bf16 v[84:87], a[60:63], v[56:59], v[84:87]
    v_mfma_f32_16x16x32_bf16 v[88:91], a[56:59], v[60:63], v[88:91]
    buffer_load_dwordx4 v10, s[12:15], s49 offen offset:3072 sc1 lds
    v_mfma_f32_16x16x32_bf16 v[92:95], a[60:63], v[60:63], v[92:95]
    s_waitcnt lgkmcnt(4)
    v_mfma_f32_16x16x32_bf16 v[80:83], a[64:67], v[32:35], v[80:83]
    ds_read_b128 v[56:59], v13 offset:22528
    ds_read_b128 v[60:63], v13 offset:23552
    v_mfma_f32_16x16x32_bf16 v[84:87], a[68:71], v[32:35], v[84:87]
    v_mfma_f32_16x16x32_bf16 v[88:91], a[64:67], v[36:39], v[88:91]
    v_mfma_f32_16x16x32_bf16 v[92:95], a[68:71], v[36:39], v[92:95]
    s_waitcnt lgkmcnt(4)
    v_mfma_f32_16x16x32_bf16 v[80:83], a[72:75], v[40:43], v[80:83]
    ds_read_b128 v[32:35], v13 offset:24576
    ds_read_b128 v[36:39], v13 offset:25600
    v_mfma_f32_16x16x32_bf16 v[84:87], a[76:79], v[40:43], v[84:87]
    v_mfma_f32_16x16x32_bf16 v[88:91], a[72:75], v[44:47], v[88:91]
    v_mfma_f32_16x16x32_bf16 v[92:95], a[76:79], v[44:47], v[92:95]
    s_waitcnt lgkmcnt(4)
    v_mfma_f32_16x16x32_bf16 v[80:83], a[80:83], v[48:51], v[80:83]
    ds_read_b128 v[40:43], v13 offset:26624
    ds_read_b128 v[44:47], v13 offset:27648
    v_mfma_f32_16x16x32_bf16 v[84:87], a[84:87], v[48:51], v[84:87]
    v_mfma_f32_16x16x32_bf16 v[88:91], a[80:83], v[52:55], v[88:91]
    v_mfma_f32_16x16x32_bf16 v[92:95], a[84:87], v[52:55], v[92:95]
    s_waitcnt lgkmcnt(4)
    v_mfma_f32_16x16x32_bf16 v[80:83], a[88:91], v[56:59], v[80:83]
    ds_read_b128 v[48:51], v13 offset:28672
    ds_read_b128 v[52:55], v13 offset:29696
    v_mfma_f32_16x16x32_bf16 v[84:87], a[92:95], v[56:59], v[84:87]
    v_mfma_f32_16x16x32_bf16 v[88:91], a[88:91], v[60:63], v[88:91]
    v_mfma_f32_16x16x32_bf16 v[92:95], a[92:95], v[60:63], v[92:95]
    s_waitcnt lgkmcnt(4)
    v_mfma_f32_16x16x32_bf16 v[80:83], a[96:99], v[32:35], v[80:83]
    ds_read_b128 v[56:59], v13 offset:30720
    ds_read_b128 v[60:63], v13 offset:31744
    v_mfma_f32_16x16x32_bf16 v[84:87], a[100:103], v[32:35], v[84:87]
    v_mfma_f32_16x16x32_bf16 v[88:91], a[96:99], v[36:39], v[88:91]
    v_mfma_f32_16x16x32_bf16 v[92:95], a[100:103], v[36:39], v[92:95]
    s_waitcnt lgkmcnt(4)
    v_mfma_f32_16x16x32_bf16 v[80:83], a[104:107], v[40:43], v[80:83]
    ds_read_b128 v[216:219], v8 offset:0
    ds_read_b128 v[220:223], v8 offset:1152
    v_mfma_f32_16x16x32_bf16 v[84:87], a[108:111], v[40:43], v[84:87]
    ds_read_b128 v[224:227], v8 offset:2304
    ds_read_b128 v[228:231], v8 offset:3456
    v_mfma_f32_16x16x32_bf16 v[88:91], a[104:107], v[44:47], v[88:91]
    v_mfma_f32_16x16x32_bf16 v[92:95], a[108:111], v[44:47], v[92:95]
    s_waitcnt vmcnt(16) lgkmcnt(0)
    s_barrier
    v_mfma_f32_16x16x32_bf16 v[80:83], a[112:115], v[48:51], v[80:83]
    ds_read_b128 v[32:35], v13 offset:32768
    ds_read_b128 v[36:39], v13 offset:33792
    v_mfma_f32_16x16x32_bf16 v[84:87], a[116:119], v[48:51], v[84:87]
    buffer_store_dwordx4 v[216:219], v11, s[12:15], s76 offen sc1
    v_mfma_f32_16x16x32_bf16 v[88:91], a[112:115], v[52:55], v[88:91]
    s_add_u32 s76, s76, 32768
    v_mfma_f32_16x16x32_bf16 v[92:95], a[116:119], v[52:55], v[92:95]
    buffer_store_dwordx4 v[220:223], v11, s[12:15], s76 offen sc1
    v_mfma_f32_16x16x32_bf16 v[80:83], a[120:123], v[56:59], v[80:83]
    ds_read_b128 v[40:43], v13 offset:34816
    ds_read_b128 v[44:47], v13 offset:35840
    v_mfma_f32_16x16x32_bf16 v[84:87], a[124:127], v[56:59], v[84:87]
    s_add_u32 s76, s76, 32768
    v_mfma_f32_16x16x32_bf16 v[88:91], a[120:123], v[60:63], v[88:91]
    buffer_store_dwordx4 v[224:227], v11, s[12:15], s76 offen sc1
    v_mfma_f32_16x16x32_bf16 v[92:95], a[124:127], v[60:63], v[92:95]
    s_add_u32 s76, s76, 32768
    s_add_u32 s48, s53, 458752
    s_add_u32 s46, s58, 2
    s_cmp_lt_u32 s46, s51
    s_cselect_b32 s48, s48, 0x20000000
    s_add_u32 s49, s48, 4096
    s_mov_b32 s59, s54
    s_waitcnt lgkmcnt(2)
    v_mfma_f32_16x16x32_bf16 v[80:83], a[128:131], v[32:35], v[80:83]
    ds_read_b128 v[48:51], v13 offset:36864
    ds_read_b128 v[52:55], v13 offset:37888
    v_mfma_f32_16x16x32_bf16 v[84:87], a[132:135], v[32:35], v[84:87]
    ds_read_b128 v[56:59], v13 offset:38912
    ds_read_b128 v[60:63], v13 offset:39936
    v_mfma_f32_16x16x32_bf16 v[88:91], a[128:131], v[36:39], v[88:91]
    s_add_u32 m0, s59, 0
    s_nop 0
    buffer_load_dwordx4 v10, s[12:15], s48 offen offset:0 sc1 lds
    v_mfma_f32_16x16x32_bf16 v[92:95], a[132:135], v[36:39], v[92:95]
    buffer_store_dwordx4 v[228:231], v11, s[12:15], s76 offen sc1
    s_waitcnt lgkmcnt(4)
    v_mfma_f32_16x16x32_bf16 v[80:83], a[136:139], v[40:43], v[80:83]
    ds_read_b128 v[32:35], v13 offset:40960
    ds_read_b128 v[36:39], v13 offset:41984
    v_mfma_f32_16x16x32_bf16 v[84:87], a[140:143], v[40:43], v[84:87]
    v_mfma_f32_16x16x32_bf16 v[88:91], a[136:139], v[44:47], v[88:91]
    buffer_load_dwordx4 v10, s[12:15], s48 offen offset:1024 sc1 lds
    v_mfma_f32_16x16x32_bf16 v[92:95], a[140:143], v[44:47], v[92:95]
    s_waitcnt lgkmcnt(4)
    v_mfma_f32_16x16x32_bf16 v[80:83], a[144:147], v[48:51], v[80:83]
    ds_read_b128 v[40:43], v13 offset:43008
    ds_read_b128 v[44:47], v13 offset:44032
    v_mfma_f32_16x16x32_bf16 v[84:87], a[148:151], v[48:51], v[84:87]
    v_mfma_f32_16x16x32_bf16 v[88:91], a[144:147], v[52:55], v[88:91]
    buffer_load_dwordx4 v10, s[12:15], s48 offen offset:2048 sc1 lds
    v_mfma_f32_16x16x32_bf16 v[92:95], a[148:151], v[52:55], v[92:95]
    s_waitcnt lgkmcnt(4)
    v_mfma_f32_16x16x32_bf16 v[80:83], a[152:155], v[56:59], v[80:83]
    ds_read_b128 v[48:51], v13 offset:45056
    ds_read_b128 v[52:55], v13 offset:46080
    v_mfma_f32_16x16x32_bf16 v[84:87], a[156:159], v[56:59], v[84:87]
    v_mfma_f32_16x16x32_bf16 v[88:91], a[152:155], v[60:63], v[88:91]
    buffer_load_dwordx4 v10, s[12:15], s48 offen offset:3072 sc1 lds
    v_mfma_f32_16x16x32_bf16 v[92:95], a[156:159], v[60:63], v[92:95]
    s_waitcnt lgkmcnt(4)
    v_mfma_f32_16x16x32_bf16 v[80:83], a[160:163], v[32:35], v[80:83]
    ds_read_b128 v[56:59], v13 offset:47104
    ds_read_b128 v[60:63], v13 offset:48128
    v_mfma_f32_16x16x32_bf16 v[84:87], a[164:167], v[32:35], v[84:87]
    v_mfma_f32_16x16x32_bf16 v[88:91], a[160:163], v[36:39], v[88:91]
    s_add_u32 m0, s59, 4096
    s_nop 0
    buffer_load_dwordx4 v10, s[12:15], s49 offen offset:0 sc1 lds
    v_mfma_f32_16x16x32_bf16 v[92:95], a[164:167], v[36:39], v[92:95]
    s_waitcnt lgkmcnt(4)
    v_mfma_f32_16x16x32_bf16 v[80:83], a[168:171], v[40:43], v[80:83]
    ds_read_b128 v[32:35], v13 offset:49152
    ds_read_b128 v[36:39], v13 offset:50176
    v_mfma_f32_16x16x32_bf16 v[84:87], a[172:175], v[40:43], v[84:87]
    v_mfma_f32_16x16x32_bf16 v[88:91], a[168:171], v[44:47], v[88:91]
    buffer_load_dwordx4 v10, s[12:15], s49 offen offset:1024 sc1 lds
    v_mfma_f32_16x16x32_bf16 v[92:95], a[172:175], v[44:47], v[92:95]
    s_waitcnt lgkmcnt(4)
    v_mfma_f32_16x16x32_bf16 v[80:83], a[176:179], v[48:51], v[80:83]
    ds_read_b128 v[40:43], v13 offset:51200
    ds_read_b128 v[44:47], v13 offset:52224
    v_mfma_f32_16x16x32_bf16 v[84:87], a[180:183], v[48:51], v[84:87]
    v_mfma_f32_16x16x32_bf16 v[88:91], a[176:179], v[52:55], v[88:91]
    buffer_load_dwordx4 v10, s[12:15], s49 offen offset:2048 sc1 lds
    v_mfma_f32_16x16x32_bf16 v[92:95], a[180:183], v[52:55], v[92:95]
    s_waitcnt lgkmcnt(4)
    v_mfma_f32_16x16x32_bf16 v[80:83], a[184:187], v[56:59], v[80:83]
    ds_read_b128 v[48:51], v13 offset:53248
    ds_read_b128 v[52:55], v13 offset:54272
    v_mfma_f32_16x16x32_bf16 v[84:87], a[188:191], v[56:59], v[84:87]
    v_mfma_f32_16x16x32_bf16 v[88:91], a[184:187], v[60:63], v[88:91]
    buffer_load_dwordx4 v10, s[12:15], s49 offen offset:3072 sc1 lds
    v_mfma_f32_16x16x32_bf16 v[92:95], a[188:191], v[60:63], v[92:95]
    s_waitcnt lgkmcnt(4)
    v_mfma_f32_16x16x32_bf16 v[80:83], a[192:195], v[32:35], v[80:83]
    ds_read_b128 v[56:59], v13 offset:55296
    ds_read_b128 v[60:63], v13 offset:56320
    v_mfma_f32_16x16x32_bf16 v[84:87], a[196:199], v[32:35], v[84:87]
    v_mfma_f32_16x16x32_bf16 v[88:91], a[192:195], v[36:39], v[88:91]
    v_mfma_f32_16x16x32_bf16 v[92:95], a[196:199], v[36:39], v[92:95]
    s_waitcnt lgkmcnt(4)
    v_mfma_f32_16x16x32_bf16 v[80:83], a[200:203], v[40:43], v[80:83]
    v_mfma_f32_16x16x32_bf16 v[84:87], a[204:207], v[40:43], v[84:87]
    v_mfma_f32_16x16x32_bf16 v[88:91], a[200:203], v[44:47], v[88:91]
    v_mfma_f32_16x16x32_bf16 v[92:95], a[204:207], v[44:47], v[92:95]
    s_waitcnt vmcnt(16) lgkmcnt(0)
    s_barrier
    v_mfma_f32_16x16x32_bf16 v[80:83], a[208:211], v[48:51], v[80:83]
    ds_read_b128 v[32:35], v14 offset:0
    ds_read_b128 v[36:39], v14 offset:1024
    v_mfma_f32_16x16x32_bf16 v[84:87], a[212:215], v[48:51], v[84:87]
    v_mfma_f32_16x16x32_bf16 v[88:91], a[208:211], v[52:55], v[88:91]
    v_mfma_f32_16x16x32_bf16 v[92:95], a[212:215], v[52:55], v[92:95]
    v_mfma_f32_16x16x32_bf16 v[80:83], a[216:219], v[56:59], v[80:83]
    ds_read_b128 v[40:43], v14 offset:2048
    ds_read_b128 v[44:47], v14 offset:3072
    v_mfma_f32_16x16x32_bf16 v[84:87], a[220:223], v[56:59], v[84:87]
    v_mfma_f32_16x16x32_bf16 v[88:91], a[216:219], v[60:63], v[88:91]
    v_mfma_f32_16x16x32_bf16 v[92:95], a[220:223], v[60:63], v[92:95]
    s_add_u32 s53, s53, 229376
    s_add_u32 s58, s58, 1
    v_swap_b32 v13, v14
    s_xor_b32 s54, s54, 65536
    s_xor_b32 s55, s55, 65536
    s_mov_b32 s76, s57
    v_swap_b32 v15, v16
    s_add_u32 s57, s57, 131072
    ds_write_b128 v7, v[80:83] offset:0
    ds_write_b128 v7, v[84:87] offset:64
    ds_write_b128 v7, v[88:91] offset:2304
    ds_write_b128 v7, v[92:95] offset:2368
    s_cmp_lt_u32 s58, s51
    s_cbranch_scc1 L_e_loop_155
    s_waitcnt lgkmcnt(0)
    ds_read_b128 v[216:219], v8 offset:0
    ds_read_b128 v[220:223], v8 offset:1152
    ds_read_b128 v[224:227], v8 offset:2304
    ds_read_b128 v[228:231], v8 offset:3456
    s_waitcnt lgkmcnt(0)
    buffer_store_dwordx4 v[216:219], v11, s[12:15], s76 offen sc1
    s_add_u32 s76, s76, 32768
    buffer_store_dwordx4 v[220:223], v11, s[12:15], s76 offen sc1
    s_add_u32 s76, s76, 32768
    buffer_store_dwordx4 v[224:227], v11, s[12:15], s76 offen sc1
    s_add_u32 s76, s76, 32768
    buffer_store_dwordx4 v[228:231], v11, s[12:15], s76 offen sc1
    s_waitcnt vmcnt(0)
    s_barrier
    s_cmp_lg_u32 s44, 0
    s_cbranch_scc1 L_pub_156
    v_mov_b32 v30, s62
    v_mov_b32 v31, 0
    s_mov_b64 exec, 1
    buffer_store_dword v30, v31, s[12:15], s65 offen sc1
    s_mov_b64 exec, -1
L_pub_156:
    s_add_u32 s63, s50, s44
    s_lshl_b32 s63, s63, 5
    s_add_u32 s63, s63, s41
    s_lshl_b32 s47, s63, 11
    s_add_u32 s46, s47, 0x800000
    s_cmp_lt_u32 s44, s51
    s_cselect_b32 s46, s46, 0x20000000
    buffer_load_dwordx4 v[208:211], v10, s[12:15], s46 offen sc1
    buffer_load_dwordx4 v[212:215], v10, s[12:15], s46 offen offset:1024 sc1
    s_add_u32 s45, s64, 16384
    s_cmp_lg_u32 s44, 0
    s_cbranch_scc1 L_pw_157
    s_mov_b32 exec_hi, 0
    s_mov_b32 s70, 0
L_wp_158:
    buffer_load_dword v31, v5, s[12:15], s45 offen sc1
    s_add_u32 s70, s70, 1
    s_cmp_ge_u32 s70, 0x200000
    s_cbranch_scc1 L_w_done_102
    s_waitcnt vmcnt(0)
    v_cmp_gt_u32 vcc, s62, v31
    s_nop 1
    s_cbranch_vccz L_wp_158_ok
    s_sleep 1
    s_branch L_wp_158
L_wp_158_ok:
    s_mov_b64 exec, -1
L_pw_157:
    s_barrier
    s_cmp_ge_u32 s44, s51
    s_cbranch_scc1 L_c_loop_151
    s_lshl_b32 s45, s63, 12
    s_add_u32 s45, s45, 0xc000000
    v_lshlrev_b32 v29, 5, v1
    buffer_load_dwordx4 v[64:67], v29, s[12:15], s45 offen offset:0 sc1
    buffer_load_dwordx4 v[68:71], v29, s[12:15], s45 offen offset:16 sc1
    buffer_load_dwordx4 v[72:75], v29, s[12:15], s45 offen offset:2048 sc1
    buffer_load_dwordx4 v[76:79], v29, s[12:15], s45 offen offset:2064 sc1
    s_add_u32 s45, s45, 0x800000
    buffer_load_dwordx4 v[160:163], v29, s[12:15], s45 offen offset:0 sc1
    buffer_load_dwordx4 v[164:167], v29, s[12:15], s45 offen offset:16 sc1
    buffer_load_dwordx4 v[168:171], v29, s[12:15], s45 offen offset:2048 sc1
    buffer_load_dwordx4 v[172:175], v29, s[12:15], s45 offen offset:2064 sc1
    s_add_u32 s45, s45, 0x800000
    buffer_load_dwordx4 v[176:179], v29, s[12:15], s45 offen offset:0 sc1
    buffer_load_dwordx4 v[180:183], v29, s[12:15], s45 offen offset:16 sc1
    buffer_load_dwordx4 v[184:187], v29, s[12:15], s45 offen offset:2048 sc1
    buffer_load_dwordx4 v[188:191], v29, s[12:15], s45 offen offset:2064 sc1
    s_add_u32 s45, s45, 0x800000
    buffer_load_dwordx4 v[192:195], v29, s[12:15], s45 offen offset:0 sc1
    buffer_load_dwordx4 v[196:199], v29, s[12:15], s45 offen offset:16 sc1
    buffer_load_dwordx4 v[200:203], v29, s[12:15], s45 offen offset:2048 sc1
    buffer_load_dwordx4 v[204:207], v29, s[12:15], s45 offen offset:2064 sc1
    s_waitcnt vmcnt(0)
    v_pk_add_f32 v[64:65], v[64:65], v[160:161]
    v_pk_add_f32 v[176:177], v[176:177], v[192:193]
    v_pk_add_f32 v[66:67], v[66:67], v[162:163]
    v_pk_add_f32 v[178:179], v[178:179], v[194:195]
    v_pk_add_f32 v[68:69], v[68:69], v[164:165]
    v_pk_add_f32 v[180:181], v[180:181], v[196:197]
    v_pk_add_f32 v[70:71], v[70:71], v[166:167]
    v_pk_add_f32 v[182:183], v[182:183], v[198:199]
    v_pk_add_f32 v[72:73], v[72:73], v[168:169]
    v_pk_add_f32 v[184:185], v[184:185], v[200:201]
    v_pk_add_f32 v[74:75], v[74:75], v[170:171]
    v_pk_add_f32 v[186:187], v[186:187], v[202:203]
    v_pk_add_f32 v[76:77], v[76:77], v[172:173]
    v_pk_add_f32 v[188:189], v[188:189], v[204:205]
    v_pk_add_f32 v[78:79], v[78:79], v[174:175]
    v_pk_add_f32 v[190:191], v[190:191], v[206:207]
    v_pk_add_f32 v[64:65], v[64:65], v[176:177]
    v_pk_add_f32 v[66:67], v[66:67], v[178:179]
    v_pk_add_f32 v[68:69], v[68:69], v[180:181]
    v_pk_add_f32 v[70:71], v[70:71], v[182:183]
    v_pk_add_f32 v[72:73], v[72:73], v[184:185]
    v_pk_add_f32 v[74:75], v[74:75], v[186:187]
    v_pk_add_f32 v[76:77], v[76:77], v[188:189]
    v_pk_add_f32 v[78:79], v[78:79], v[190:191]
    v_cvt_pk_bf16_f32 v64, v64, v64
    v_lshlrev_b32 v64, 16, v64
    v_cvt_pk_bf16_f32 v65, v65, v65
    v_lshlrev_b32 v65, 16, v65
    v_cvt_pk_bf16_f32 v66, v66, v66
    v_lshlrev_b32 v66, 16, v66
    v_cvt_pk_bf16_f32 v67, v67, v67
    v_lshlrev_b32 v67, 16, v67
    v_cvt_pk_bf16_f32 v68, v68, v68
    v_lshlrev_b32 v68, 16, v68
    v_cvt_pk_bf16_f32 v69, v69, v69
    v_lshlrev_b32 v69, 16, v69
    v_cvt_pk_bf16_f32 v70, v70, v70
    v_lshlrev_b32 v70, 16, v70
    v_cvt_pk_bf16_f32 v71, v71, v71
    v_lshlrev_b32 v71, 16, v71
    v_cvt_pk_bf16_f32 v72, v72, v72
    v_lshlrev_b32 v72, 16, v72
    v_cvt_pk_bf16_f32 v73, v73, v73
    v_lshlrev_b32 v73, 16, v73
    v_cvt_pk_bf16_f32 v74, v74, v74
    v_lshlrev_b32 v74, 16, v74
    v_cvt_pk_bf16_f32 v75, v75, v75
    v_lshlrev_b32 v75, 16, v75
    v_cvt_pk_bf16_f32 v76, v76, v76
    v_lshlrev_b32 v76, 16, v76
    v_cvt_pk_bf16_f32 v77, v77, v77
    v_lshlrev_b32 v77, 16, v77
    v_cvt_pk_bf16_f32 v78, v78, v78
    v_lshlrev_b32 v78, 16, v78
    v_cvt_pk_bf16_f32 v79, v79, v79
    v_lshlrev_b32 v79, 16, v79
    v_lshlrev_b32 v160, 16, v208
    v_and_b32 v161, 0xffff0000, v208
    v_lshlrev_b32 v162, 16, v209
    v_and_b32 v163, 0xffff0000, v209
    v_lshlrev_b32 v164, 16, v210
    v_and_b32 v165, 0xffff0000, v210
    v_lshlrev_b32 v166, 16, v211
    v_and_b32 v167, 0xffff0000, v211
    v_lshlrev_b32 v168, 16, v212
    v_and_b32 v169, 0xffff0000, v212
    v_lshlrev_b32 v170, 16, v213
    v_and_b32 v171, 0xffff0000, v213
    v_lshlrev_b32 v172, 16, v214
    v_and_b32 v173, 0xffff0000, v214
    v_lshlrev_b32 v174, 16, v215
    v_and_b32 v175, 0xffff0000, v215
    v_add_f32 v64, v64, v96
    v_cvt_pk_bf16_f32 v64, v64, v64
    v_lshlrev_b32 v64, 16, v64
    v_mul_f32 v64, v64, v112
    v_cvt_pk_bf16_f32 v64, v64, v64
    v_lshlrev_b32 v64, 16, v64
    v_add_f32 v64, v64, v160
    v_add_f32 v65, v65, v97
    v_cvt_pk_bf16_f32 v65, v65, v65
    v_lshlrev_b32 v65, 16, v65
    v_mul_f32 v65, v65, v113
    v_cvt_pk_bf16_f32 v65, v65, v65
    v_lshlrev_b32 v65, 16, v65
    v_add_f32 v65, v65, v161
    v_add_f32 v66, v66, v98
    v_cvt_pk_bf16_f32 v66, v66, v66
    v_lshlrev_b32 v66, 16, v66
    v_mul_f32 v66, v66, v114
    v_cvt_pk_bf16_f32 v66, v66, v66
    v_lshlrev_b32 v66, 16, v66
    v_add_f32 v66, v66, v162
    v_add_f32 v67, v67, v99
    v_cvt_pk_bf16_f32 v67, v67, v67
    v_lshlrev_b32 v67, 16, v67
    v_mul_f32 v67, v67, v115
    v_cvt_pk_bf16_f32 v67, v67, v67
    v_lshlrev_b32 v67, 16, v67
    v_add_f32 v67, v67, v163
    v_add_f32 v68, v68, v100
    v_cvt_pk_bf16_f32 v68, v68, v68
    v_lshlrev_b32 v68, 16, v68
    v_mul_f32 v68, v68, v116
    v_cvt_pk_bf16_f32 v68, v68, v68
    v_lshlrev_b32 v68, 16, v68
    v_add_f32 v68, v68, v164
    v_add_f32 v69, v69, v101
    v_cvt_pk_bf16_f32 v69, v69, v69
    v_lshlrev_b32 v69, 16, v69
    v_mul_f32 v69, v69, v117
    v_cvt_pk_bf16_f32 v69, v69, v69
    v_lshlrev_b32 v69, 16, v69
    v_add_f32 v69, v69, v165
    v_add_f32 v70, v70, v102
    v_cvt_pk_bf16_f32 v70, v70, v70
    v_lshlrev_b32 v70, 16, v70
    v_mul_f32 v70, v70, v118
    v_cvt_pk_bf16_f32 v70, v70, v70
    v_lshlrev_b32 v70, 16, v70
    v_add_f32 v70, v70, v166
    v_add_f32 v71, v71, v103
    v_cvt_pk_bf16_f32 v71, v71, v71
    v_lshlrev_b32 v71, 16, v71
    v_mul_f32 v71, v71, v119
    v_cvt_pk_bf16_f32 v71, v71, v71
    v_lshlrev_b32 v71, 16, v71
    v_add_f32 v71, v71, v167
    v_add_f32 v72, v72, v104
    v_cvt_pk_bf16_f32 v72, v72, v72
    v_lshlrev_b32 v72, 16, v72
    v_mul_f32 v72, v72, v120
    v_cvt_pk_bf16_f32 v72, v72, v72
    v_lshlrev_b32 v72, 16, v72
    v_add_f32 v72, v72, v168
    v_add_f32 v73, v73, v105
    v_cvt_pk_bf16_f32 v73, v73, v73
    v_lshlrev_b32 v73, 16, v73
    v_mul_f32 v73, v73, v121
    v_cvt_pk_bf16_f32 v73, v73, v73
    v_lshlrev_b32 v73, 16, v73
    v_add_f32 v73, v73, v169
    v_add_f32 v74, v74, v106
    v_cvt_pk_bf16_f32 v74, v74, v74
    v_lshlrev_b32 v74, 16, v74
    v_mul_f32 v74, v74, v122
    v_cvt_pk_bf16_f32 v74, v74, v74
    v_lshlrev_b32 v74, 16, v74
    v_add_f32 v74, v74, v170
    v_add_f32 v75, v75, v107
    v_cvt_pk_bf16_f32 v75, v75, v75
    v_lshlrev_b32 v75, 16, v75
    v_mul_f32 v75, v75, v123
    v_cvt_pk_bf16_f32 v75, v75, v75
    v_lshlrev_b32 v75, 16, v75
    v_add_f32 v75, v75, v171
    v_add_f32 v76, v76, v108
    v_cvt_pk_bf16_f32 v76, v76, v76
    v_lshlrev_b32 v76, 16, v76
    v_mul_f32 v76, v76, v124
    v_cvt_pk_bf16_f32 v76, v76, v76
    v_lshlrev_b32 v76, 16, v76
    v_add_f32 v76, v76, v172
    v_add_f32 v77, v77, v109
    v_cvt_pk_bf16_f32 v77, v77, v77
    v_lshlrev_b32 v77, 16, v77
    v_mul_f32 v77, v77, v125
    v_cvt_pk_bf16_f32 v77, v77, v77
    v_lshlrev_b32 v77, 16, v77
    v_add_f32 v77, v77, v173
    v_add_f32 v78, v78, v110
    v_cvt_pk_bf16_f32 v78, v78, v78
    v_lshlrev_b32 v78, 16, v78
    v_mul_f32 v78, v78, v126
    v_cvt_pk_bf16_f32 v78, v78, v78
    v_lshlrev_b32 v78, 16, v78
    v_add_f32 v78, v78, v174
    v_add_f32 v79, v79, v111
    v_cvt_pk_bf16_f32 v79, v79, v79
    v_lshlrev_b32 v79, 16, v79
    v_mul_f32 v79, v79, v127
    v_cvt_pk_bf16_f32 v79, v79, v79
    v_lshlrev_b32 v79, 16, v79
    v_add_f32 v79, v79, v175
    v_cvt_pk_bf16_f32 v208, v64, v65
    v_cvt_pk_bf16_f32 v209, v66, v67
    v_cvt_pk_bf16_f32 v210, v68, v69
    v_cvt_pk_bf16_f32 v211, v70, v71
    v_cvt_pk_bf16_f32 v212, v72, v73
    v_cvt_pk_bf16_f32 v213, v74, v75
    v_cvt_pk_bf16_f32 v214, v76, v77
    v_cvt_pk_bf16_f32 v215, v78, v79
    buffer_store_dwordx4 v[208:211], v10, s[32:35], s47 offen
    buffer_store_dwordx4 v[212:215], v10, s[32:35], s47 offen offset:1024
    s_branch L_c_loop_151
L_w_done_102:
    s_endpgm
.section .rodata,"a"
.p2align 6
.amdhsa_kernel adaLN_cond__memory_aug_recurrent_mem_tr__dense_activation_gelu__prompt_kernel
  .amdhsa_next_free_vgpr 512
  .amdhsa_next_free_sgpr 102
  .amdhsa_accum_offset 256
  .amdhsa_group_segment_fixed_size 0
  .amdhsa_kernarg_size 136
  .amdhsa_user_sgpr_count 2
  .amdhsa_user_sgpr_kernarg_segment_ptr 1
  .amdhsa_system_sgpr_workgroup_id_x 1
.end_amdhsa_kernel
```

```asm
; @launch kernel=adaLN_cond__memory_aug_recurrent_mem_tr__dense_activation_gelu__prompt_kernel grid=(256,1,1) block=(256,1,1) lds=163840
.amdgcn_target "amdgcn-amd-amdhsa--gfx950"
.text
.globl adaLN_cond__memory_aug_recurrent_mem_tr__dense_activation_gelu__prompt_kernel
.p2align 8
.type adaLN_cond__memory_aug_recurrent_mem_tr__dense_activation_gelu__prompt_kernel,@function
adaLN_cond__memory_aug_recurrent_mem_tr__dense_activation_gelu__prompt_kernel:
    s_cmp_lt_u32 s2, 256
    s_cbranch_scc1 L_c_done_1_go
    s_endpgm
L_c_done_1_go:
    s_and_b32 s40, s2, 7
    s_load_dwordx4 s[4:7], s[0:1], 16
    s_load_dwordx4 s[8:11], s[0:1], 32
    s_load_dwordx2 s[20:21], s[0:1], 128
    s_load_dwordx2 s[22:23], s[0:1], 120
    s_load_dwordx2 s[50:51], s[0:1], 8
    s_lshr_b32 s41, s2, 3
    s_and_b32 s42, s41, 15
    v_and_b32 v1, 63, v0
    v_lshrrev_b32 v2, 6, v0
    s_nop 0
    v_readfirstlane_b32 s44, v2
    s_waitcnt lgkmcnt(0)
    s_mov_b32 s24, s4
    s_and_b32 s25, s5, 0xffff
    s_mov_b32 s26, 0x800000
    s_mov_b32 s27, 0x00020000
    s_mov_b32 s28, s6
    s_and_b32 s29, s7, 0xffff
    s_mov_b32 s30, 0x800000
    s_mov_b32 s31, 0x00020000
    s_mov_b32 s32, s8
    s_and_b32 s33, s9, 0xffff
    s_mov_b32 s34, 0x800000
    s_mov_b32 s35, 0x00020000
    s_mov_b32 s36, s10
    s_and_b32 s37, s11, 0xffff
    s_mov_b32 s38, 0x800000
    s_mov_b32 s39, 0x00020000
    s_mov_b32 s12, s20
    s_and_b32 s13, s21, 0xffff
    s_mov_b32 s14, 0x10000000
    s_mov_b32 s15, 0x00020000
    s_mov_b32 s16, s22
    s_and_b32 s17, s23, 0xffff
    s_mov_b32 s18, 0x100
    s_mov_b32 s19, 0x00020000
    s_mov_b32 s52, s50
    s_and_b32 s53, s51, 0xffff
    s_mov_b32 s54, 0x4000
    s_mov_b32 s55, 0x00020000
    v_mov_b32 v41, 0
    s_cmp_lg_u32 s2, 1
    s_cbranch_scc1 L_worker_3_a
    s_getreg_b32 s45, hwreg(HW_REG_XCC_ID)
    s_and_b32 s45, s45, 1
    s_add_u32 s45, s45, 1
    v_mov_b32 v40, s45
    buffer_store_dword v40, v41, s[16:19], 0 offen offset:24 sc1
L_worker_3_a:
    s_cmp_eq_u32 s40, 1
    s_cbranch_scc1 L_worker_3_g0
    s_cmp_lt_u32 s40, 3
    s_cbranch_scc1 L_worker_3_q
    s_sub_u32 s40, s40, 2
    s_branch L_worker_3
L_worker_3_q:
    s_mov_b32 s70, 0
L_worker_3_p:
    buffer_load_dword v40, v41, s[16:19], 0 offen offset:24 sc1
    s_add_u32 s70, s70, 1
    s_cmp_ge_u32 s70, 0x200000
    s_cbranch_scc1 L_c_done_1
    s_waitcnt vmcnt(0)
    v_readfirstlane_b32 s45, v40
    s_nop 3
    s_cmp_eq_u32 s45, 0
    s_cbranch_scc1 L_worker_3_p
    s_and_b32 s45, s45, 2
    s_cmp_lg_u32 s45, s40
    s_mov_b32 s40, 1
    s_cbranch_scc1 L_worker_3_no
    s_mov_b32 s40, 0
    s_branch L_worker_3
L_worker_3_g0:
    s_mov_b32 s40, 0
L_worker_3_no:
    s_lshl_b32 s43, s40, 4
    s_add_u32 s43, s43, s42
    s_lshl_b32 s3, s43, 7
    s_lshr_b32 s45, s41, 4
    s_lshl_b32 s45, s45, 4
    s_add_u32 s3, s3, s45
    s_lshl_b32 s45, s44, 2
    s_add_u32 s3, s3, s45
    s_add_u32 s3, s3, 0x11000
    v_mov_b32 v40, 0
    s_mov_b64 exec, 1
    buffer_store_dword v40, v40, s[12:15], s3 offen sc1
    s_mov_b64 exec, -1
    v_and_b32 v21, 8, v1
    v_cmp_eq_u32 s[56:57], 0, v21
    v_mov_b32 v2, 0xeeee
    v_mov_b32 v3, 0x4444
    v_cndmask_b32 v2, v2, v3, s[56:57]
    v_lshlrev_b32 v68, 4, v1
    s_lshl_b32 s45, s44, 12
    v_add_u32 v3, s45, v68
    v_add_u32 v4, 4096, v3
    v_and_b32 v4, 16383, v4
    v_add_u32 v21, 8192, v3
    v_and_b32 v21, 16383, v21
    v_add_u32 v23, 12288, v3
    v_and_b32 v23, 16383, v23
    s_mul_i32 s45, s44, 24576
    s_add_u32 s45, s45, 65536
    v_add_u32 v5, s45, v68
    v_lshrrev_b32 v63, 4, v1
    s_lshl_b32 s45, s44, 2
    v_add_u32 v64, s45, v63
    s_lshr_b32 s45, s44, 1
    s_lshl_b32 s45, s45, 2
    v_add_u32 v65, s45, v63
    v_bfe_u32 v66, v1, 1, 3
    v_xor_b32 v66, v66, v65
    v_lshlrev_b32 v66, 5, v66
    v_and_b32 v67, 1, v1
    v_lshlrev_b32 v67, 4, v67
    v_add_u32 v66, v66, v67
    v_lshlrev_b32 v64, 13, v64
    v_add_u32 v82, v64, v66
    s_lshl_b32 s47, s43, 8
    s_lshl_b32 s48, s44, 10
    v_bfe_u32 v64, v1, 2, 2
    v_bfe_u32 v65, v1, 4, 1
    v_lshlrev_b32 v65, 2, v65
    v_add_u32 v65, v65, v64
    v_lshlrev_b32 v66, 3, v63
    v_add_u32 v66, v66, v64
    v_lshlrev_b32 v66, 8, v66
    v_and_b32 v67, 3, v1
    v_lshlrev_b32 v67, 3, v67
    v_add_u32 v66, v66, v67
    s_lshl_b32 s45, s44, 1
    v_xor_b32 v65, s45, v65
    v_lshlrev_b32 v65, 5, v65
    v_add_u32 v80, v66, v65
    v_xor_b32 v81, 32, v80
    v_lshrrev_b32 v64, 5, v1
    v_mul_u32_u24 v64, 20480, v64
    v_add_u32 v64, 65536, v64
    v_add_u32 v84, v64, v80
    v_add_u32 v85, v64, v81
    v_add_u32 v86, 49152, v84
    v_add_u32 v87, 49152, v85
    v_mov_b32 v40, -1
    v_mov_b32 v41, -1
    v_mov_b32 v42, -1
    v_mov_b32 v43, -1
    v_mov_b32 v44, 0
    s_mov_b32 s68, 0
    s_cmp_ge_u32 s41, 16
    s_cbranch_scc1 L_c_vo_2
    s_lshl_b32 s45, s42, 11
    s_lshr_b32 s46, s44, 1
    s_lshl_b32 s46, s46, 10
    s_add_u32 s45, s45, s46
    s_and_b32 s46, s44, 1
    s_lshl_b32 s46, s46, 7
    s_add_u32 s45, s45, s46
    v_add_u32 v17, s45, v68
    v_mov_b32 v63, 0x20000000
    v_cndmask_b32 v17, v63, v17, s[56:57]
    s_lshl_b32 s62, s40, 17
    s_add_u32 s62, s62, 0x7040000
    s_add_u32 s63, s62, 0
    buffer_store_dwordx4 v[40:43], v17, s[12:15], s63 offen sc1
    s_add_u32 s63, s62, 32768
    buffer_store_dwordx4 v[40:43], v17, s[12:15], s63 offen sc1
    s_add_u32 s63, s62, 65536
    buffer_store_dwordx4 v[40:43], v17, s[12:15], s63 offen sc1
    s_add_u32 s63, s62, 98304
    buffer_store_dwordx4 v[40:43], v17, s[12:15], s63 offen sc1
    s_mov_b64 exec, -1
    s_lshl_b32 s45, s40, 11
    s_lshl_b32 s46, s42, 2
    s_add_u32 s45, s45, s46
    s_add_u32 s45, s45, 0x7080000
    s_lshl_b32 s46, s44, 9
    s_add_u32 s45, s45, s46
    v_lshlrev_b32 v20, 7, v1
    v_add_u32 v20, s45, v20
    v_cmp_gt_u32 vcc, 4, v1
    s_nop 1
    v_cndmask_b32 v20, v63, v20, vcc
    buffer_store_dword v44, v20, s[12:15], 0 offen sc1
    s_add_u32 s79, s41, 0
    s_and_b32 s79, s79, 3
    s_lshl_b32 s79, s79, 19
    s_add_u32 s79, s79, s47
    s_add_u32 s46, s79, 0x0
    s_add_u32 m0, s48, 73728
    s_nop 0
    buffer_load_dwordx4 v82, s[24:27], s46 offen  lds
    s_add_u32 s46, s79, 0x20000
    s_add_u32 m0, s48, 98304
    s_nop 0
    buffer_load_dwordx4 v82, s[24:27], s46 offen  lds
    s_add_u32 s46, s79, 0x40000
    s_add_u32 m0, s48, 122880
    s_nop 0
    buffer_load_dwordx4 v82, s[24:27], s46 offen  lds
    s_add_u32 s46, s79, 0x60000
    s_add_u32 m0, s48, 147456
    s_nop 0
    buffer_load_dwordx4 v82, s[24:27], s46 offen  lds
    s_add_u32 s79, s41, 1
    s_and_b32 s79, s79, 3
    s_lshl_b32 s79, s79, 19
    s_add_u32 s79, s79, s47
    s_add_u32 s46, s79, 0x0
    s_add_u32 m0, s48, 77824
    s_nop 0
    buffer_load_dwordx4 v82, s[24:27], s46 offen  lds
    s_add_u32 s46, s79, 0x20000
    s_add_u32 m0, s48, 102400
    s_nop 0
    buffer_load_dwordx4 v82, s[24:27], s46 offen  lds
    s_add_u32 s46, s79, 0x40000
    s_add_u32 m0, s48, 126976
    s_nop 0
    buffer_load_dwordx4 v82, s[24:27], s46 offen  lds
    s_add_u32 s46, s79, 0x60000
    s_add_u32 m0, s48, 151552
    s_nop 0
    buffer_load_dwordx4 v82, s[24:27], s46 offen  lds
    s_add_u32 s79, s41, 2
    s_and_b32 s79, s79, 3
    s_lshl_b32 s79, s79, 19
    s_add_u32 s79, s79, s47
    s_add_u32 s46, s79, 0x0
    s_add_u32 m0, s48, 81920
    s_nop 0
    buffer_load_dwordx4 v82, s[24:27], s46 offen  lds
    s_add_u32 s46, s79, 0x20000
    s_add_u32 m0, s48, 106496
    s_nop 0
    buffer_load_dwordx4 v82, s[24:27], s46 offen  lds
    s_add_u32 s46, s79, 0x40000
    s_add_u32 m0, s48, 131072
    s_nop 0
    buffer_load_dwordx4 v82, s[24:27], s46 offen  lds
    s_add_u32 s46, s79, 0x60000
    s_add_u32 m0, s48, 155648
    s_nop 0
    buffer_load_dwordx4 v82, s[24:27], s46 offen  lds
    s_add_u32 s79, s41, 3
    s_and_b32 s79, s79, 3
    s_lshl_b32 s79, s79, 19
    s_add_u32 s79, s79, s47
    s_add_u32 s46, s79, 0x0
    s_add_u32 m0, s48, 86016
    s_nop 0
    buffer_load_dwordx4 v82, s[24:27], s46 offen  lds
    s_add_u32 s46, s79, 0x20000
    s_add_u32 m0, s48, 110592
    s_nop 0
    buffer_load_dwordx4 v82, s[24:27], s46 offen  lds
    s_add_u32 s46, s79, 0x40000
    s_add_u32 m0, s48, 135168
    s_nop 0
    buffer_load_dwordx4 v82, s[24:27], s46 offen  lds
    s_add_u32 s46, s79, 0x60000
    s_add_u32 m0, s48, 159744
    s_nop 0
    buffer_load_dwordx4 v82, s[24:27], s46 offen  lds
    s_add_u32 s79, s41, 4
    s_and_b32 s79, s79, 3
    s_lshl_b32 s79, s79, 19
    s_add_u32 s79, s79, s47
    s_add_u32 s46, s79, 0x200000
    s_add_u32 m0, s48, 0
    s_nop 0
    buffer_load_dwordx4 v82, s[24:27], s46 offen  lds
    s_add_u32 s46, s79, 0x220000
    s_add_u32 m0, s48, 4096
    s_nop 0
    buffer_load_dwordx4 v82, s[24:27], s46 offen  lds
    s_add_u32 s46, s79, 0x240000
    s_add_u32 m0, s48, 8192
    s_nop 0
    buffer_load_dwordx4 v82, s[24:27], s46 offen  lds
    s_add_u32 s46, s79, 0x260000
    s_add_u32 m0, s48, 12288
    s_nop 0
    buffer_load_dwordx4 v82, s[24:27], s46 offen  lds
    s_add_u32 s79, s41, 5
    s_and_b32 s79, s79, 3
    s_lshl_b32 s79, s79, 19
    s_add_u32 s79, s79, s47
    s_add_u32 s46, s79, 0x200000
    s_add_u32 m0, s48, 16384
    s_nop 0
    buffer_load_dwordx4 v82, s[24:27], s46 offen  lds
    s_add_u32 s46, s79, 0x220000
    s_add_u32 m0, s48, 20480
    s_nop 0
    buffer_load_dwordx4 v82, s[24:27], s46 offen  lds
    s_add_u32 s46, s79, 0x240000
    s_add_u32 m0, s48, 24576
    s_nop 0
    buffer_load_dwordx4 v82, s[24:27], s46 offen  lds
    s_add_u32 s46, s79, 0x260000
    s_add_u32 m0, s48, 28672
    s_nop 0
    buffer_load_dwordx4 v82, s[24:27], s46 offen  lds
    s_add_u32 s79, s41, 6
    s_and_b32 s79, s79, 3
    s_lshl_b32 s79, s79, 19
    s_add_u32 s79, s79, s47
    s_add_u32 s46, s79, 0x200000
    s_add_u32 m0, s48, 32768
    s_nop 0
    buffer_load_dwordx4 v82, s[24:27], s46 offen  lds
    s_add_u32 s46, s79, 0x220000
    s_add_u32 m0, s48, 36864
    s_nop 0
    buffer_load_dwordx4 v82, s[24:27], s46 offen  lds
    s_add_u32 s46, s79, 0x240000
    s_add_u32 m0, s48, 40960
    s_nop 0
    buffer_load_dwordx4 v82, s[24:27], s46 offen  lds
    s_add_u32 s46, s79, 0x260000
    s_add_u32 m0, s48, 45056
    s_nop 0
    buffer_load_dwordx4 v82, s[24:27], s46 offen  lds
    s_add_u32 s79, s41, 7
    s_and_b32 s79, s79, 3
    s_lshl_b32 s79, s79, 19
    s_add_u32 s79, s79, s47
    s_add_u32 s46, s79, 0x200000
    s_add_u32 m0, s48, 49152
    s_nop 0
    buffer_load_dwordx4 v82, s[24:27], s46 offen  lds
    s_add_u32 s46, s79, 0x220000
    s_add_u32 m0, s48, 53248
    s_nop 0
    buffer_load_dwordx4 v82, s[24:27], s46 offen  lds
    s_add_u32 s46, s79, 0x240000
    s_add_u32 m0, s48, 57344
    s_nop 0
    buffer_load_dwordx4 v82, s[24:27], s46 offen  lds
    s_add_u32 s46, s79, 0x260000
    s_add_u32 m0, s48, 61440
    s_nop 0
    buffer_load_dwordx4 v82, s[24:27], s46 offen  lds
    s_waitcnt vmcnt(28)
    s_barrier
    s_cmp_lg_u32 s44, 0
    s_cbranch_scc1 L_lw_4_0
    ds_read_b64_tr_b16 a[0:1], v84 offset:8192
    ds_read_b64_tr_b16 a[2:3], v84 offset:9216
    ds_read_b64_tr_b16 a[4:5], v86 offset:8192
    ds_read_b64_tr_b16 a[6:7], v86 offset:9216
    ds_read_b64_tr_b16 a[8:9], v85 offset:8192
    ds_read_b64_tr_b16 a[10:11], v85 offset:9216
    ds_read_b64_tr_b16 a[12:13], v87 offset:8192
    ds_read_b64_tr_b16 a[14:15], v87 offset:9216
    s_branch L_lw_4
L_lw_4_0:
    s_cmp_lg_u32 s44, 1
    s_cbranch_scc1 L_lw_4_1
    ds_read_b64_tr_b16 v[160:161], v84 offset:8192
    ds_read_b64_tr_b16 v[162:163], v84 offset:9216
    ds_read_b64_tr_b16 v[164:165], v86 offset:8192
    ds_read_b64_tr_b16 v[166:167], v86 offset:9216
    ds_read_b64_tr_b16 v[56:57], v85 offset:8192
    ds_read_b64_tr_b16 v[58:59], v85 offset:9216
    ds_read_b64_tr_b16 v[60:61], v87 offset:8192
    ds_read_b64_tr_b16 v[62:63], v87 offset:9216
    s_waitcnt lgkmcnt(0)
    ds_write_b128 v5, v[56:59] offset:0
    ds_write_b128 v5, v[60:63] offset:1024
    s_branch L_lw_4
L_lw_4_1:
    s_cmp_lg_u32 s44, 2
    s_cbranch_scc1 L_lw_4_2
    ds_read_b64_tr_b16 a[208:209], v84 offset:8192
    ds_read_b64_tr_b16 a[210:211], v84 offset:9216
    ds_read_b64_tr_b16 a[212:213], v86 offset:8192
    ds_read_b64_tr_b16 a[214:215], v86 offset:9216
    ds_read_b64_tr_b16 v[56:57], v85 offset:8192
    ds_read_b64_tr_b16 v[58:59], v85 offset:9216
    ds_read_b64_tr_b16 v[60:61], v87 offset:8192
    ds_read_b64_tr_b16 v[62:63], v87 offset:9216
    s_waitcnt lgkmcnt(0)
    ds_write_b128 v5, v[56:59] offset:2048
    ds_write_b128 v5, v[60:63] offset:3072
    s_branch L_lw_4
L_lw_4_2:
    ds_read_b64_tr_b16 a[104:105], v84 offset:8192
    ds_read_b64_tr_b16 a[106:107], v84 offset:9216
    ds_read_b64_tr_b16 a[108:109], v86 offset:8192
    ds_read_b64_tr_b16 a[110:111], v86 offset:9216
    ds_read_b64_tr_b16 v[56:57], v85 offset:8192
    ds_read_b64_tr_b16 v[58:59], v85 offset:9216
    ds_read_b64_tr_b16 v[60:61], v87 offset:8192
    ds_read_b64_tr_b16 v[62:63], v87 offset:9216
    s_waitcnt lgkmcnt(0)
    ds_write_b128 v5, v[56:59] offset:4096
    ds_write_b128 v5, v[60:63] offset:5120
L_lw_4:
    s_waitcnt lgkmcnt(0)
    s_waitcnt vmcnt(24)
    s_barrier
    s_cmp_lg_u32 s44, 0
    s_cbranch_scc1 L_hs_5
    s_getreg_b32 s45, hwreg(HW_REG_XCC_ID)
    s_and_b32 s45, s45, 15
    s_mul_i32 s46, s45, s45
    s_lshl_b32 s46, s46, 9
    s_add_u32 s45, s45, s46
    s_cmp_eq_u32 s40, 0
    s_cselect_b32 s46, s45, 0
    s_cselect_b32 s45, 0, s45
    s_lshl_b32 s68, s68, 24
    s_add_u32 s46, s46, s68
    s_add_u32 s45, s45, 16777216
    v_mov_b32 v40, s46
    v_mov_b32 v41, s45
    v_mov_b32 v42, 0
    s_mov_b64 exec, 1
    buffer_atomic_add_x2 v[40:41], v42, s[16:19], 0 offen sc1
    s_mov_b64 exec, -1
L_hs_5:
    s_cmp_lg_u32 s44, 0
    s_cbranch_scc1 L_lw_6_0
    ds_read_b64_tr_b16 a[32:33], v84 offset:12288
    ds_read_b64_tr_b16 a[34:35], v84 offset:13312
    ds_read_b64_tr_b16 a[36:37], v86 offset:12288
    ds_read_b64_tr_b16 a[38:39], v86 offset:13312
    ds_read_b64_tr_b16 a[40:41], v85 offset:12288
    ds_read_b64_tr_b16 a[42:43], v85 offset:13312
    ds_read_b64_tr_b16 a[44:45], v87 offset:12288
    ds_read_b64_tr_b16 a[46:47], v87 offset:13312
    s_branch L_lw_6
L_lw_6_0:
    s_cmp_lg_u32 s44, 1
    s_cbranch_scc1 L_lw_6_1
    ds_read_b64_tr_b16 v[184:185], v84 offset:12288
    ds_read_b64_tr_b16 v[186:187], v84 offset:13312
    ds_read_b64_tr_b16 v[188:189], v86 offset:12288
    ds_read_b64_tr_b16 v[190:191], v86 offset:13312
    ds_read_b64_tr_b16 v[192:193], v85 offset:12288
    ds_read_b64_tr_b16 v[194:195], v85 offset:13312
    ds_read_b64_tr_b16 v[196:197], v87 offset:12288
    ds_read_b64_tr_b16 v[198:199], v87 offset:13312
    s_branch L_lw_6
L_lw_6_1:
    s_cmp_lg_u32 s44, 2
    s_cbranch_scc1 L_lw_6_2
    ds_read_b64_tr_b16 a[232:233], v84 offset:12288
    ds_read_b64_tr_b16 a[234:235], v84 offset:13312
    ds_read_b64_tr_b16 a[236:237], v86 offset:12288
    ds_read_b64_tr_b16 a[238:239], v86 offset:13312
    ds_read_b64_tr_b16 a[240:241], v85 offset:12288
    ds_read_b64_tr_b16 a[242:243], v85 offset:13312
    ds_read_b64_tr_b16 a[244:245], v87 offset:12288
    ds_read_b64_tr_b16 a[246:247], v87 offset:13312
    s_branch L_lw_6
L_lw_6_2:
    ds_read_b64_tr_b16 a[128:129], v84 offset:12288
    ds_read_b64_tr_b16 a[130:131], v84 offset:13312
    ds_read_b64_tr_b16 a[132:133], v86 offset:12288
    ds_read_b64_tr_b16 a[134:135], v86 offset:13312
    ds_read_b64_tr_b16 v[56:57], v85 offset:12288
    ds_read_b64_tr_b16 v[58:59], v85 offset:13312
    ds_read_b64_tr_b16 v[60:61], v87 offset:12288
    ds_read_b64_tr_b16 v[62:63], v87 offset:13312
    s_waitcnt lgkmcnt(0)
    ds_write_b128 v5, v[56:59] offset:6144
    ds_write_b128 v5, v[60:63] offset:7168
L_lw_6:
    s_waitcnt lgkmcnt(0)
    s_waitcnt vmcnt(20)
    s_barrier
    s_cmp_lg_u32 s44, 0
    s_cbranch_scc1 L_lw_7_0
    ds_read_b64_tr_b16 a[64:65], v84 offset:16384
    ds_read_b64_tr_b16 a[66:67], v84 offset:17408
    ds_read_b64_tr_b16 a[68:69], v86 offset:16384
    ds_read_b64_tr_b16 a[70:71], v86 offset:17408
    ds_read_b64_tr_b16 v[56:57], v85 offset:16384
    ds_read_b64_tr_b16 v[58:59], v85 offset:17408
    ds_read_b64_tr_b16 v[60:61], v87 offset:16384
    ds_read_b64_tr_b16 v[62:63], v87 offset:17408
    s_waitcnt lgkmcnt(0)
    ds_write_b128 v5, v[56:59] offset:8192
    ds_write_b128 v5, v[60:63] offset:9216
    s_branch L_lw_7
L_lw_7_0:
    s_cmp_lg_u32 s44, 1
    s_cbranch_scc1 L_lw_7_1
    ds_read_b64_tr_b16 v[208:209], v84 offset:16384
    ds_read_b64_tr_b16 v[210:211], v84 offset:17408
    ds_read_b64_tr_b16 v[212:213], v86 offset:16384
    ds_read_b64_tr_b16 v[214:215], v86 offset:17408
    ds_read_b64_tr_b16 v[56:57], v85 offset:16384
    ds_read_b64_tr_b16 v[58:59], v85 offset:17408
    ds_read_b64_tr_b16 v[60:61], v87 offset:16384
    ds_read_b64_tr_b16 v[62:63], v87 offset:17408
    s_waitcnt lgkmcnt(0)
    ds_write_b128 v5, v[56:59] offset:10240
    ds_write_b128 v5, v[60:63] offset:11264
    s_branch L_lw_7
L_lw_7_1:
    s_cmp_lg_u32 s44, 2
    s_cbranch_scc1 L_lw_7_2
    ds_read_b64_tr_b16 v[104:105], v84 offset:16384
    ds_read_b64_tr_b16 v[106:107], v84 offset:17408
    ds_read_b64_tr_b16 v[108:109], v86 offset:16384
    ds_read_b64_tr_b16 v[110:111], v86 offset:17408
    ds_read_b64_tr_b16 v[56:57], v85 offset:16384
    ds_read_b64_tr_b16 v[58:59], v85 offset:17408
    ds_read_b64_tr_b16 v[60:61], v87 offset:16384
    ds_read_b64_tr_b16 v[62:63], v87 offset:17408
    s_waitcnt lgkmcnt(0)
    ds_write_b128 v5, v[56:59] offset:12288
    ds_write_b128 v5, v[60:63] offset:13312
    s_branch L_lw_7
L_lw_7_2:
    ds_read_b64_tr_b16 a[152:153], v84 offset:16384
    ds_read_b64_tr_b16 a[154:155], v84 offset:17408
    ds_read_b64_tr_b16 a[156:157], v86 offset:16384
    ds_read_b64_tr_b16 a[158:159], v86 offset:17408
    ds_read_b64_tr_b16 v[56:57], v85 offset:16384
    ds_read_b64_tr_b16 v[58:59], v85 offset:17408
    ds_read_b64_tr_b16 v[60:61], v87 offset:16384
    ds_read_b64_tr_b16 v[62:63], v87 offset:17408
    s_waitcnt lgkmcnt(0)
    ds_write_b128 v5, v[56:59] offset:14336
    ds_write_b128 v5, v[60:63] offset:15360
L_lw_7:
    s_waitcnt lgkmcnt(0)
    s_waitcnt vmcnt(16)
    s_barrier
    s_cmp_lg_u32 s44, 0
    s_cbranch_scc1 L_lw_8_0
    ds_read_b64_tr_b16 a[80:81], v84 offset:20480
    ds_read_b64_tr_b16 a[82:83], v84 offset:21504
    ds_read_b64_tr_b16 a[84:85], v86 offset:20480
    ds_read_b64_tr_b16 a[86:87], v86 offset:21504
    ds_read_b64_tr_b16 v[56:57], v85 offset:20480
    ds_read_b64_tr_b16 v[58:59], v85 offset:21504
    ds_read_b64_tr_b16 v[60:61], v87 offset:20480
    ds_read_b64_tr_b16 v[62:63], v87 offset:21504
    s_waitcnt lgkmcnt(0)
    ds_write_b128 v5, v[56:59] offset:16384
    ds_write_b128 v5, v[60:63] offset:17408
    s_branch L_lw_8
L_lw_8_0:
    s_cmp_lg_u32 s44, 1
    s_cbranch_scc1 L_lw_8_1
    ds_read_b64_tr_b16 v[232:233], v84 offset:20480
    ds_read_b64_tr_b16 v[234:235], v84 offset:21504
    ds_read_b64_tr_b16 v[236:237], v86 offset:20480
    ds_read_b64_tr_b16 v[238:239], v86 offset:21504
    ds_read_b64_tr_b16 v[240:241], v85 offset:20480
    ds_read_b64_tr_b16 v[242:243], v85 offset:21504
    ds_read_b64_tr_b16 v[244:245], v87 offset:20480
    ds_read_b64_tr_b16 v[246:247], v87 offset:21504
    s_branch L_lw_8
L_lw_8_1:
    s_cmp_lg_u32 s44, 2
    s_cbranch_scc1 L_lw_8_2
    ds_read_b64_tr_b16 v[128:129], v84 offset:20480
    ds_read_b64_tr_b16 v[130:131], v84 offset:21504
    ds_read_b64_tr_b16 v[132:133], v86 offset:20480
    ds_read_b64_tr_b16 v[134:135], v86 offset:21504
    ds_read_b64_tr_b16 v[136:137], v85 offset:20480
    ds_read_b64_tr_b16 v[138:139], v85 offset:21504
    ds_read_b64_tr_b16 v[140:141], v87 offset:20480
    ds_read_b64_tr_b16 v[142:143], v87 offset:21504
    s_branch L_lw_8
L_lw_8_2:
    ds_read_b64_tr_b16 a[176:177], v84 offset:20480
    ds_read_b64_tr_b16 a[178:179], v84 offset:21504
    ds_read_b64_tr_b16 a[180:181], v86 offset:20480
    ds_read_b64_tr_b16 a[182:183], v86 offset:21504
    ds_read_b64_tr_b16 a[184:185], v85 offset:20480
    ds_read_b64_tr_b16 a[186:187], v85 offset:21504
    ds_read_b64_tr_b16 a[188:189], v87 offset:20480
    ds_read_b64_tr_b16 a[190:191], v87 offset:21504
L_lw_8:
    s_waitcnt lgkmcnt(0)
    s_waitcnt vmcnt(12)
    s_barrier
    s_add_u32 s79, s41, 8
    s_and_b32 s79, s79, 3
    s_lshl_b32 s79, s79, 19
    s_add_u32 s79, s79, s47
    s_add_u32 s46, s79, 0x400000
    s_add_u32 m0, s48, 86016
    s_nop 0
    buffer_load_dwordx4 v82, s[24:27], s46 offen  lds
    s_add_u32 s46, s79, 0x420000
    s_add_u32 m0, s48, 110592
    s_nop 0
    buffer_load_dwordx4 v82, s[24:27], s46 offen  lds
    s_add_u32 s46, s79, 0x440000
    s_add_u32 m0, s48, 135168
    s_nop 0
    buffer_load_dwordx4 v82, s[24:27], s46 offen  lds
    s_add_u32 s46, s79, 0x460000
    s_add_u32 m0, s48, 159744
    s_nop 0
    buffer_load_dwordx4 v82, s[24:27], s46 offen  lds
    s_cmp_lg_u32 s44, 0
    s_cbranch_scc1 L_lw_9_0
    ds_read_b64_tr_b16 a[104:105], v80 offset:0
    ds_read_b64_tr_b16 a[106:107], v80 offset:1024
    ds_read_b64_tr_b16 a[108:109], v80 offset:8192
    ds_read_b64_tr_b16 a[110:111], v80 offset:9216
    ds_read_b64_tr_b16 v[56:57], v81 offset:0
    ds_read_b64_tr_b16 v[58:59], v81 offset:1024
    ds_read_b64_tr_b16 v[60:61], v81 offset:8192
    ds_read_b64_tr_b16 v[62:63], v81 offset:9216
    s_waitcnt lgkmcnt(0)
    ds_write_b128 v5, v[56:59] offset:4096
    ds_write_b128 v5, v[60:63] offset:5120
    s_branch L_lw_9
L_lw_9_0:
    s_cmp_lg_u32 s44, 1
    s_cbranch_scc1 L_lw_9_1
    ds_read_b64_tr_b16 a[0:1], v80 offset:0
    ds_read_b64_tr_b16 a[2:3], v80 offset:1024
    ds_read_b64_tr_b16 a[4:5], v80 offset:8192
    ds_read_b64_tr_b16 a[6:7], v80 offset:9216
    ds_read_b64_tr_b16 a[8:9], v81 offset:0
    ds_read_b64_tr_b16 a[10:11], v81 offset:1024
    ds_read_b64_tr_b16 a[12:13], v81 offset:8192
    ds_read_b64_tr_b16 a[14:15], v81 offset:9216
    s_branch L_lw_9
L_lw_9_1:
    s_cmp_lg_u32 s44, 2
    s_cbranch_scc1 L_lw_9_2
    ds_read_b64_tr_b16 v[160:161], v80 offset:0
    ds_read_b64_tr_b16 v[162:163], v80 offset:1024
    ds_read_b64_tr_b16 v[164:165], v80 offset:8192
    ds_read_b64_tr_b16 v[166:167], v80 offset:9216
    ds_read_b64_tr_b16 v[56:57], v81 offset:0
    ds_read_b64_tr_b16 v[58:59], v81 offset:1024
    ds_read_b64_tr_b16 v[60:61], v81 offset:8192
    ds_read_b64_tr_b16 v[62:63], v81 offset:9216
    s_waitcnt lgkmcnt(0)
    ds_write_b128 v5, v[56:59] offset:0
    ds_write_b128 v5, v[60:63] offset:1024
    s_branch L_lw_9
L_lw_9_2:
    ds_read_b64_tr_b16 a[208:209], v80 offset:0
    ds_read_b64_tr_b16 a[210:211], v80 offset:1024
    ds_read_b64_tr_b16 a[212:213], v80 offset:8192
    ds_read_b64_tr_b16 a[214:215], v80 offset:9216
    ds_read_b64_tr_b16 v[56:57], v81 offset:0
    ds_read_b64_tr_b16 v[58:59], v81 offset:1024
    ds_read_b64_tr_b16 v[60:61], v81 offset:8192
    ds_read_b64_tr_b16 v[62:63], v81 offset:9216
    s_waitcnt lgkmcnt(0)
    ds_write_b128 v5, v[56:59] offset:2048
    ds_write_b128 v5, v[60:63] offset:3072
L_lw_9:
    s_waitcnt lgkmcnt(0)
    s_waitcnt vmcnt(12)
    s_barrier
    s_add_u32 s79, s41, 9
    s_and_b32 s79, s79, 3
    s_lshl_b32 s79, s79, 19
    s_add_u32 s79, s79, s47
    s_add_u32 s46, s79, 0x400000
    s_add_u32 m0, s48, 0
    s_nop 0
    buffer_load_dwordx4 v82, s[24:27], s46 offen  lds
    s_add_u32 s46, s79, 0x420000
    s_add_u32 m0, s48, 4096
    s_nop 0
    buffer_load_dwordx4 v82, s[24:27], s46 offen  lds
    s_add_u32 s46, s79, 0x440000
    s_add_u32 m0, s48, 8192
    s_nop 0
    buffer_load_dwordx4 v82, s[24:27], s46 offen  lds
    s_add_u32 s46, s79, 0x460000
    s_add_u32 m0, s48, 12288
    s_nop 0
    buffer_load_dwordx4 v82, s[24:27], s46 offen  lds
    s_cmp_lg_u32 s44, 0
    s_cbranch_scc1 L_lw_10_0
    ds_read_b64_tr_b16 a[128:129], v80 offset:16384
    ds_read_b64_tr_b16 a[130:131], v80 offset:17408
    ds_read_b64_tr_b16 a[132:133], v80 offset:24576
    ds_read_b64_tr_b16 a[134:135], v80 offset:25600
    ds_read_b64_tr_b16 v[56:57], v81 offset:16384
    ds_read_b64_tr_b16 v[58:59], v81 offset:17408
    ds_read_b64_tr_b16 v[60:61], v81 offset:24576
    ds_read_b64_tr_b16 v[62:63], v81 offset:25600
    s_waitcnt lgkmcnt(0)
    ds_write_b128 v5, v[56:59] offset:6144
    ds_write_b128 v5, v[60:63] offset:7168
    s_branch L_lw_10
L_lw_10_0:
    s_cmp_lg_u32 s44, 1
    s_cbranch_scc1 L_lw_10_1
    ds_read_b64_tr_b16 a[32:33], v80 offset:16384
    ds_read_b64_tr_b16 a[34:35], v80 offset:17408
    ds_read_b64_tr_b16 a[36:37], v80 offset:24576
    ds_read_b64_tr_b16 a[38:39], v80 offset:25600
    ds_read_b64_tr_b16 a[40:41], v81 offset:16384
    ds_read_b64_tr_b16 a[42:43], v81 offset:17408
    ds_read_b64_tr_b16 a[44:45], v81 offset:24576
    ds_read_b64_tr_b16 a[46:47], v81 offset:25600
    s_branch L_lw_10
L_lw_10_1:
    s_cmp_lg_u32 s44, 2
    s_cbranch_scc1 L_lw_10_2
    ds_read_b64_tr_b16 v[184:185], v80 offset:16384
    ds_read_b64_tr_b16 v[186:187], v80 offset:17408
    ds_read_b64_tr_b16 v[188:189], v80 offset:24576
    ds_read_b64_tr_b16 v[190:191], v80 offset:25600
    ds_read_b64_tr_b16 v[192:193], v81 offset:16384
    ds_read_b64_tr_b16 v[194:195], v81 offset:17408
    ds_read_b64_tr_b16 v[196:197], v81 offset:24576
    ds_read_b64_tr_b16 v[198:199], v81 offset:25600
    s_branch L_lw_10
L_lw_10_2:
    ds_read_b64_tr_b16 a[232:233], v80 offset:16384
    ds_read_b64_tr_b16 a[234:235], v80 offset:17408
    ds_read_b64_tr_b16 a[236:237], v80 offset:24576
    ds_read_b64_tr_b16 a[238:239], v80 offset:25600
    ds_read_b64_tr_b16 a[240:241], v81 offset:16384
    ds_read_b64_tr_b16 a[242:243], v81 offset:17408
    ds_read_b64_tr_b16 a[244:245], v81 offset:24576
    ds_read_b64_tr_b16 a[246:247], v81 offset:25600
L_lw_10:
    s_waitcnt lgkmcnt(0)
    s_waitcnt vmcnt(12)
    s_barrier
    s_add_u32 s79, s41, 10
    s_and_b32 s79, s79, 3
    s_lshl_b32 s79, s79, 19
    s_add_u32 s79, s79, s47
    s_add_u32 s46, s79, 0x400000
    s_add_u32 m0, s48, 16384
    s_nop 0
    buffer_load_dwordx4 v82, s[24:27], s46 offen  lds
    s_add_u32 s46, s79, 0x420000
    s_add_u32 m0, s48, 20480
    s_nop 0
    buffer_load_dwordx4 v82, s[24:27], s46 offen  lds
    s_add_u32 s46, s79, 0x440000
    s_add_u32 m0, s48, 24576
    s_nop 0
    buffer_load_dwordx4 v82, s[24:27], s46 offen  lds
    s_add_u32 s46, s79, 0x460000
    s_add_u32 m0, s48, 28672
    s_nop 0
    buffer_load_dwordx4 v82, s[24:27], s46 offen  lds
    s_cmp_lg_u32 s44, 0
    s_cbranch_scc1 L_lw_11_0
    ds_read_b64_tr_b16 a[152:153], v80 offset:32768
    ds_read_b64_tr_b16 a[154:155], v80 offset:33792
    ds_read_b64_tr_b16 a[156:157], v80 offset:40960
    ds_read_b64_tr_b16 a[158:159], v80 offset:41984
    ds_read_b64_tr_b16 v[56:57], v81 offset:32768
    ds_read_b64_tr_b16 v[58:59], v81 offset:33792
    ds_read_b64_tr_b16 v[60:61], v81 offset:40960
    ds_read_b64_tr_b16 v[62:63], v81 offset:41984
    s_waitcnt lgkmcnt(0)
    ds_write_b128 v5, v[56:59] offset:14336
    ds_write_b128 v5, v[60:63] offset:15360
    s_branch L_lw_11
L_lw_11_0:
    s_cmp_lg_u32 s44, 1
    s_cbranch_scc1 L_lw_11_1
    ds_read_b64_tr_b16 a[64:65], v80 offset:32768
    ds_read_b64_tr_b16 a[66:67], v80 offset:33792
    ds_read_b64_tr_b16 a[68:69], v80 offset:40960
    ds_read_b64_tr_b16 a[70:71], v80 offset:41984
    ds_read_b64_tr_b16 v[56:57], v81 offset:32768
    ds_read_b64_tr_b16 v[58:59], v81 offset:33792
    ds_read_b64_tr_b16 v[60:61], v81 offset:40960
    ds_read_b64_tr_b16 v[62:63], v81 offset:41984
    s_waitcnt lgkmcnt(0)
    ds_write_b128 v5, v[56:59] offset:8192
    ds_write_b128 v5, v[60:63] offset:9216
    s_branch L_lw_11
L_lw_11_1:
    s_cmp_lg_u32 s44, 2
    s_cbranch_scc1 L_lw_11_2
    ds_read_b64_tr_b16 v[208:209], v80 offset:32768
    ds_read_b64_tr_b16 v[210:211], v80 offset:33792
    ds_read_b64_tr_b16 v[212:213], v80 offset:40960
    ds_read_b64_tr_b16 v[214:215], v80 offset:41984
    ds_read_b64_tr_b16 v[56:57], v81 offset:32768
    ds_read_b64_tr_b16 v[58:59], v81 offset:33792
    ds_read_b64_tr_b16 v[60:61], v81 offset:40960
    ds_read_b64_tr_b16 v[62:63], v81 offset:41984
    s_waitcnt lgkmcnt(0)
    ds_write_b128 v5, v[56:59] offset:10240
    ds_write_b128 v5, v[60:63] offset:11264
    s_branch L_lw_11
L_lw_11_2:
    ds_read_b64_tr_b16 v[104:105], v80 offset:32768
    ds_read_b64_tr_b16 v[106:107], v80 offset:33792
    ds_read_b64_tr_b16 v[108:109], v80 offset:40960
    ds_read_b64_tr_b16 v[110:111], v80 offset:41984
    ds_read_b64_tr_b16 v[56:57], v81 offset:32768
    ds_read_b64_tr_b16 v[58:59], v81 offset:33792
    ds_read_b64_tr_b16 v[60:61], v81 offset:40960
    ds_read_b64_tr_b16 v[62:63], v81 offset:41984
    s_waitcnt lgkmcnt(0)
    ds_write_b128 v5, v[56:59] offset:12288
    ds_write_b128 v5, v[60:63] offset:13312
L_lw_11:
    s_waitcnt lgkmcnt(0)
    s_waitcnt vmcnt(12)
    s_barrier
    s_add_u32 s79, s41, 11
    s_and_b32 s79, s79, 3
    s_lshl_b32 s79, s79, 19
    s_add_u32 s79, s79, s47
    s_add_u32 s46, s79, 0x400000
    s_add_u32 m0, s48, 32768
    s_nop 0
    buffer_load_dwordx4 v82, s[24:27], s46 offen  lds
    s_add_u32 s46, s79, 0x420000
    s_add_u32 m0, s48, 36864
    s_nop 0
    buffer_load_dwordx4 v82, s[24:27], s46 offen  lds
    s_add_u32 s46, s79, 0x440000
    s_add_u32 m0, s48, 40960
    s_nop 0
    buffer_load_dwordx4 v82, s[24:27], s46 offen  lds
    s_add_u32 s46, s79, 0x460000
    s_add_u32 m0, s48, 45056
    s_nop 0
    buffer_load_dwordx4 v82, s[24:27], s46 offen  lds
    s_cmp_lg_u32 s44, 0
    s_cbranch_scc1 L_lw_12_0
    ds_read_b64_tr_b16 a[176:177], v80 offset:49152
    ds_read_b64_tr_b16 a[178:179], v80 offset:50176
    ds_read_b64_tr_b16 a[180:181], v80 offset:57344
    ds_read_b64_tr_b16 a[182:183], v80 offset:58368
    ds_read_b64_tr_b16 a[184:185], v81 offset:49152
    ds_read_b64_tr_b16 a[186:187], v81 offset:50176
    ds_read_b64_tr_b16 a[188:189], v81 offset:57344
    ds_read_b64_tr_b16 a[190:191], v81 offset:58368
    s_branch L_lw_12
L_lw_12_0:
    s_cmp_lg_u32 s44, 1
    s_cbranch_scc1 L_lw_12_1
    ds_read_b64_tr_b16 a[80:81], v80 offset:49152
    ds_read_b64_tr_b16 a[82:83], v80 offset:50176
    ds_read_b64_tr_b16 a[84:85], v80 offset:57344
    ds_read_b64_tr_b16 a[86:87], v80 offset:58368
    ds_read_b64_tr_b16 v[56:57], v81 offset:49152
    ds_read_b64_tr_b16 v[58:59], v81 offset:50176
    ds_read_b64_tr_b16 v[60:61], v81 offset:57344
    ds_read_b64_tr_b16 v[62:63], v81 offset:58368
    s_waitcnt lgkmcnt(0)
    ds_write_b128 v5, v[56:59] offset:16384
    ds_write_b128 v5, v[60:63] offset:17408
    s_branch L_lw_12
L_lw_12_1:
    s_cmp_lg_u32 s44, 2
    s_cbranch_scc1 L_lw_12_2
    ds_read_b64_tr_b16 v[232:233], v80 offset:49152
    ds_read_b64_tr_b16 v[234:235], v80 offset:50176
    ds_read_b64_tr_b16 v[236:237], v80 offset:57344
    ds_read_b64_tr_b16 v[238:239], v80 offset:58368
    ds_read_b64_tr_b16 v[240:241], v81 offset:49152
    ds_read_b64_tr_b16 v[242:243], v81 offset:50176
    ds_read_b64_tr_b16 v[244:245], v81 offset:57344
    ds_read_b64_tr_b16 v[246:247], v81 offset:58368
    s_branch L_lw_12
L_lw_12_2:
    ds_read_b64_tr_b16 v[128:129], v80 offset:49152
    ds_read_b64_tr_b16 v[130:131], v80 offset:50176
    ds_read_b64_tr_b16 v[132:133], v80 offset:57344
    ds_read_b64_tr_b16 v[134:135], v80 offset:58368
    ds_read_b64_tr_b16 v[136:137], v81 offset:49152
    ds_read_b64_tr_b16 v[138:139], v81 offset:50176
    ds_read_b64_tr_b16 v[140:141], v81 offset:57344
    ds_read_b64_tr_b16 v[142:143], v81 offset:58368
L_lw_12:
    s_waitcnt lgkmcnt(0)
    s_waitcnt vmcnt(12)
    s_barrier
    s_add_u32 s79, s41, 12
    s_and_b32 s79, s79, 3
    s_lshl_b32 s79, s79, 19
    s_add_u32 s79, s79, s47
    s_add_u32 s46, s79, 0x600000
    s_add_u32 m0, s48, 49152
    s_nop 0
    buffer_load_dwordx4 v82, s[24:27], s46 offen  lds
    s_add_u32 s46, s79, 0x620000
    s_add_u32 m0, s48, 53248
    s_nop 0
    buffer_load_dwordx4 v82, s[24:27], s46 offen  lds
    s_add_u32 s46, s79, 0x640000
    s_add_u32 m0, s48, 57344
    s_nop 0
    buffer_load_dwordx4 v82, s[24:27], s46 offen  lds
    s_add_u32 s46, s79, 0x660000
    s_add_u32 m0, s48, 61440
    s_nop 0
    buffer_load_dwordx4 v82, s[24:27], s46 offen  lds
    s_cmp_lg_u32 s44, 0
    s_cbranch_scc1 L_lw_13_0
    ds_read_b64_tr_b16 a[208:209], v84 offset:20480
    ds_read_b64_tr_b16 a[210:211], v84 offset:21504
    ds_read_b64_tr_b16 a[212:213], v86 offset:20480
    ds_read_b64_tr_b16 a[214:215], v86 offset:21504
    ds_read_b64_tr_b16 v[56:57], v85 offset:20480
    ds_read_b64_tr_b16 v[58:59], v85 offset:21504
    ds_read_b64_tr_b16 v[60:61], v87 offset:20480
    ds_read_b64_tr_b16 v[62:63], v87 offset:21504
    s_waitcnt lgkmcnt(0)
    ds_write_b128 v5, v[56:59] offset:2048
    ds_write_b128 v5, v[60:63] offset:3072
    s_branch L_lw_13
L_lw_13_0:
    s_cmp_lg_u32 s44, 1
    s_cbranch_scc1 L_lw_13_1
    ds_read_b64_tr_b16 a[104:105], v84 offset:20480
    ds_read_b64_tr_b16 a[106:107], v84 offset:21504
    ds_read_b64_tr_b16 a[108:109], v86 offset:20480
    ds_read_b64_tr_b16 a[110:111], v86 offset:21504
    ds_read_b64_tr_b16 v[56:57], v85 offset:20480
    ds_read_b64_tr_b16 v[58:59], v85 offset:21504
    ds_read_b64_tr_b16 v[60:61], v87 offset:20480
    ds_read_b64_tr_b16 v[62:63], v87 offset:21504
    s_waitcnt lgkmcnt(0)
    ds_write_b128 v5, v[56:59] offset:4096
    ds_write_b128 v5, v[60:63] offset:5120
    s_branch L_lw_13
L_lw_13_1:
    s_cmp_lg_u32 s44, 2
    s_cbranch_scc1 L_lw_13_2
    ds_read_b64_tr_b16 a[0:1], v84 offset:20480
    ds_read_b64_tr_b16 a[2:3], v84 offset:21504
    ds_read_b64_tr_b16 a[4:5], v86 offset:20480
    ds_read_b64_tr_b16 a[6:7], v86 offset:21504
    ds_read_b64_tr_b16 a[8:9], v85 offset:20480
    ds_read_b64_tr_b16 a[10:11], v85 offset:21504
    ds_read_b64_tr_b16 a[12:13], v87 offset:20480
    ds_read_b64_tr_b16 a[14:15], v87 offset:21504
    s_branch L_lw_13
L_lw_13_2:
    ds_read_b64_tr_b16 v[160:161], v84 offset:20480
    ds_read_b64_tr_b16 v[162:163], v84 offset:21504
    ds_read_b64_tr_b16 v[164:165], v86 offset:20480
    ds_read_b64_tr_b16 v[166:167], v86 offset:21504
    ds_read_b64_tr_b16 v[56:57], v85 offset:20480
    ds_read_b64_tr_b16 v[58:59], v85 offset:21504
    ds_read_b64_tr_b16 v[60:61], v87 offset:20480
    ds_read_b64_tr_b16 v[62:63], v87 offset:21504
    s_waitcnt lgkmcnt(0)
    ds_write_b128 v5, v[56:59] offset:0
    ds_write_b128 v5, v[60:63] offset:1024
L_lw_13:
    s_waitcnt lgkmcnt(0)
    s_waitcnt vmcnt(12)
    s_barrier
    s_add_u32 s79, s41, 13
    s_and_b32 s79, s79, 3
    s_lshl_b32 s79, s79, 19
    s_add_u32 s79, s79, s47
    s_add_u32 s46, s79, 0x600000
    s_add_u32 m0, s48, 86016
    s_nop 0
    buffer_load_dwordx4 v82, s[24:27], s46 offen  lds
    s_add_u32 s46, s79, 0x620000
    s_add_u32 m0, s48, 110592
    s_nop 0
    buffer_load_dwordx4 v82, s[24:27], s46 offen  lds
    s_add_u32 s46, s79, 0x640000
    s_add_u32 m0, s48, 135168
    s_nop 0
    buffer_load_dwordx4 v82, s[24:27], s46 offen  lds
    s_add_u32 s46, s79, 0x660000
    s_add_u32 m0, s48, 159744
    s_nop 0
    buffer_load_dwordx4 v82, s[24:27], s46 offen  lds
    s_cmp_lg_u32 s44, 0
    s_cbranch_scc1 L_lw_14_0
    ds_read_b64_tr_b16 a[232:233], v80 offset:0
    ds_read_b64_tr_b16 a[234:235], v80 offset:1024
    ds_read_b64_tr_b16 a[236:237], v80 offset:8192
    ds_read_b64_tr_b16 a[238:239], v80 offset:9216
    ds_read_b64_tr_b16 a[240:241], v81 offset:0
    ds_read_b64_tr_b16 a[242:243], v81 offset:1024
    ds_read_b64_tr_b16 a[244:245], v81 offset:8192
    ds_read_b64_tr_b16 a[246:247], v81 offset:9216
    s_branch L_lw_14
L_lw_14_0:
    s_cmp_lg_u32 s44, 1
    s_cbranch_scc1 L_lw_14_1
    ds_read_b64_tr_b16 a[128:129], v80 offset:0
    ds_read_b64_tr_b16 a[130:131], v80 offset:1024
    ds_read_b64_tr_b16 a[132:133], v80 offset:8192
    ds_read_b64_tr_b16 a[134:135], v80 offset:9216
    ds_read_b64_tr_b16 v[56:57], v81 offset:0
    ds_read_b64_tr_b16 v[58:59], v81 offset:1024
    ds_read_b64_tr_b16 v[60:61], v81 offset:8192
    ds_read_b64_tr_b16 v[62:63], v81 offset:9216
    s_waitcnt lgkmcnt(0)
    ds_write_b128 v5, v[56:59] offset:6144
    ds_write_b128 v5, v[60:63] offset:7168
    s_branch L_lw_14
L_lw_14_1:
    s_cmp_lg_u32 s44, 2
    s_cbranch_scc1 L_lw_14_2
    ds_read_b64_tr_b16 a[32:33], v80 offset:0
    ds_read_b64_tr_b16 a[34:35], v80 offset:1024
    ds_read_b64_tr_b16 a[36:37], v80 offset:8192
    ds_read_b64_tr_b16 a[38:39], v80 offset:9216
    ds_read_b64_tr_b16 a[40:41], v81 offset:0
    ds_read_b64_tr_b16 a[42:43], v81 offset:1024
    ds_read_b64_tr_b16 a[44:45], v81 offset:8192
    ds_read_b64_tr_b16 a[46:47], v81 offset:9216
    s_branch L_lw_14
L_lw_14_2:
    ds_read_b64_tr_b16 v[184:185], v80 offset:0
    ds_read_b64_tr_b16 v[186:187], v80 offset:1024
    ds_read_b64_tr_b16 v[188:189], v80 offset:8192
    ds_read_b64_tr_b16 v[190:191], v80 offset:9216
    ds_read_b64_tr_b16 v[192:193], v81 offset:0
    ds_read_b64_tr_b16 v[194:195], v81 offset:1024
    ds_read_b64_tr_b16 v[196:197], v81 offset:8192
    ds_read_b64_tr_b16 v[198:199], v81 offset:9216
L_lw_14:
    s_waitcnt lgkmcnt(0)
    s_waitcnt vmcnt(12)
    s_barrier
    s_add_u32 s79, s41, 14
    s_and_b32 s79, s79, 3
    s_lshl_b32 s79, s79, 19
    s_add_u32 s79, s79, s47
    s_add_u32 s46, s79, 0x600000
    s_add_u32 m0, s48, 0
    s_nop 0
    buffer_load_dwordx4 v82, s[24:27], s46 offen  lds
    s_add_u32 s46, s79, 0x620000
    s_add_u32 m0, s48, 4096
    s_nop 0
    buffer_load_dwordx4 v82, s[24:27], s46 offen  lds
    s_add_u32 s46, s79, 0x640000
    s_add_u32 m0, s48, 8192
    s_nop 0
    buffer_load_dwordx4 v82, s[24:27], s46 offen  lds
    s_add_u32 s46, s79, 0x660000
    s_add_u32 m0, s48, 12288
    s_nop 0
    buffer_load_dwordx4 v82, s[24:27], s46 offen  lds
    s_cmp_lg_u32 s44, 0
    s_cbranch_scc1 L_lw_15_0
    ds_read_b64_tr_b16 v[104:105], v80 offset:16384
    ds_read_b64_tr_b16 v[106:107], v80 offset:17408
    ds_read_b64_tr_b16 v[108:109], v80 offset:24576
    ds_read_b64_tr_b16 v[110:111], v80 offset:25600
    ds_read_b64_tr_b16 v[56:57], v81 offset:16384
    ds_read_b64_tr_b16 v[58:59], v81 offset:17408
    ds_read_b64_tr_b16 v[60:61], v81 offset:24576
    ds_read_b64_tr_b16 v[62:63], v81 offset:25600
    s_waitcnt lgkmcnt(0)
    ds_write_b128 v5, v[56:59] offset:12288
    ds_write_b128 v5, v[60:63] offset:13312
    s_branch L_lw_15
L_lw_15_0:
    s_cmp_lg_u32 s44, 1
    s_cbranch_scc1 L_lw_15_1
    ds_read_b64_tr_b16 a[152:153], v80 offset:16384
    ds_read_b64_tr_b16 a[154:155], v80 offset:17408
    ds_read_b64_tr_b16 a[156:157], v80 offset:24576
    ds_read_b64_tr_b16 a[158:159], v80 offset:25600
    ds_read_b64_tr_b16 v[56:57], v81 offset:16384
    ds_read_b64_tr_b16 v[58:59], v81 offset:17408
    ds_read_b64_tr_b16 v[60:61], v81 offset:24576
    ds_read_b64_tr_b16 v[62:63], v81 offset:25600
    s_waitcnt lgkmcnt(0)
    ds_write_b128 v5, v[56:59] offset:14336
    ds_write_b128 v5, v[60:63] offset:15360
    s_branch L_lw_15
L_lw_15_1:
    s_cmp_lg_u32 s44, 2
    s_cbranch_scc1 L_lw_15_2
    ds_read_b64_tr_b16 a[64:65], v80 offset:16384
    ds_read_b64_tr_b16 a[66:67], v80 offset:17408
    ds_read_b64_tr_b16 a[68:69], v80 offset:24576
    ds_read_b64_tr_b16 a[70:71], v80 offset:25600
    ds_read_b64_tr_b16 v[56:57], v81 offset:16384
    ds_read_b64_tr_b16 v[58:59], v81 offset:17408
    ds_read_b64_tr_b16 v[60:61], v81 offset:24576
    ds_read_b64_tr_b16 v[62:63], v81 offset:25600
    s_waitcnt lgkmcnt(0)
    ds_write_b128 v5, v[56:59] offset:8192
    ds_write_b128 v5, v[60:63] offset:9216
    s_branch L_lw_15
L_lw_15_2:
    ds_read_b64_tr_b16 v[208:209], v80 offset:16384
    ds_read_b64_tr_b16 v[210:211], v80 offset:17408
    ds_read_b64_tr_b16 v[212:213], v80 offset:24576
    ds_read_b64_tr_b16 v[214:215], v80 offset:25600
    ds_read_b64_tr_b16 v[56:57], v81 offset:16384
    ds_read_b64_tr_b16 v[58:59], v81 offset:17408
    ds_read_b64_tr_b16 v[60:61], v81 offset:24576
    ds_read_b64_tr_b16 v[62:63], v81 offset:25600
    s_waitcnt lgkmcnt(0)
    ds_write_b128 v5, v[56:59] offset:10240
    ds_write_b128 v5, v[60:63] offset:11264
L_lw_15:
    s_waitcnt lgkmcnt(0)
    s_waitcnt vmcnt(12)
    s_barrier
    s_add_u32 s79, s41, 15
    s_and_b32 s79, s79, 3
    s_lshl_b32 s79, s79, 19
    s_add_u32 s79, s79, s47
    s_add_u32 s46, s79, 0x600000
    s_add_u32 m0, s48, 16384
    s_nop 0
    buffer_load_dwordx4 v82, s[24:27], s46 offen  lds
    s_add_u32 s46, s79, 0x620000
    s_add_u32 m0, s48, 20480
    s_nop 0
    buffer_load_dwordx4 v82, s[24:27], s46 offen  lds
    s_add_u32 s46, s79, 0x640000
    s_add_u32 m0, s48, 24576
    s_nop 0
    buffer_load_dwordx4 v82, s[24:27], s46 offen  lds
    s_add_u32 s46, s79, 0x660000
    s_add_u32 m0, s48, 28672
    s_nop 0
    buffer_load_dwordx4 v82, s[24:27], s46 offen  lds
    s_cmp_lg_u32 s44, 0
    s_cbranch_scc1 L_lw_16_0
    ds_read_b64_tr_b16 v[128:129], v80 offset:32768
    ds_read_b64_tr_b16 v[130:131], v80 offset:33792
    ds_read_b64_tr_b16 v[132:133], v80 offset:40960
    ds_read_b64_tr_b16 v[134:135], v80 offset:41984
    ds_read_b64_tr_b16 v[136:137], v81 offset:32768
    ds_read_b64_tr_b16 v[138:139], v81 offset:33792
    ds_read_b64_tr_b16 v[140:141], v81 offset:40960
    ds_read_b64_tr_b16 v[142:143], v81 offset:41984
    s_branch L_lw_16
L_lw_16_0:
    s_cmp_lg_u32 s44, 1
    s_cbranch_scc1 L_lw_16_1
    ds_read_b64_tr_b16 a[176:177], v80 offset:32768
    ds_read_b64_tr_b16 a[178:179], v80 offset:33792
    ds_read_b64_tr_b16 a[180:181], v80 offset:40960
    ds_read_b64_tr_b16 a[182:183], v80 offset:41984
    ds_read_b64_tr_b16 a[184:185], v81 offset:32768
    ds_read_b64_tr_b16 a[186:187], v81 offset:33792
    ds_read_b64_tr_b16 a[188:189], v81 offset:40960
    ds_read_b64_tr_b16 a[190:191], v81 offset:41984
    s_branch L_lw_16
L_lw_16_1:
    s_cmp_lg_u32 s44, 2
    s_cbranch_scc1 L_lw_16_2
    ds_read_b64_tr_b16 a[80:81], v80 offset:32768
    ds_read_b64_tr_b16 a[82:83], v80 offset:33792
    ds_read_b64_tr_b16 a[84:85], v80 offset:40960
    ds_read_b64_tr_b16 a[86:87], v80 offset:41984
    ds_read_b64_tr_b16 v[56:57], v81 offset:32768
    ds_read_b64_tr_b16 v[58:59], v81 offset:33792
    ds_read_b64_tr_b16 v[60:61], v81 offset:40960
    ds_read_b64_tr_b16 v[62:63], v81 offset:41984
    s_waitcnt lgkmcnt(0)
    ds_write_b128 v5, v[56:59] offset:16384
    ds_write_b128 v5, v[60:63] offset:17408
    s_branch L_lw_16
L_lw_16_2:
    ds_read_b64_tr_b16 v[232:233], v80 offset:32768
    ds_read_b64_tr_b16 v[234:235], v80 offset:33792
    ds_read_b64_tr_b16 v[236:237], v80 offset:40960
    ds_read_b64_tr_b16 v[238:239], v80 offset:41984
    ds_read_b64_tr_b16 v[240:241], v81 offset:32768
    ds_read_b64_tr_b16 v[242:243], v81 offset:33792
    ds_read_b64_tr_b16 v[244:245], v81 offset:40960
    ds_read_b64_tr_b16 v[246:247], v81 offset:41984
L_lw_16:
    s_waitcnt lgkmcnt(0)
    s_waitcnt vmcnt(12)
    s_barrier
    s_add_u32 s79, s41, 0
    s_and_b32 s79, s79, 3
    s_lshl_b32 s79, s79, 19
    s_add_u32 s79, s79, s47
    s_add_u32 s46, s79, 0x0
    s_add_u32 m0, s48, 32768
    s_nop 0
    buffer_load_dwordx4 v82, s[28:31], s46 offen  lds
    s_add_u32 s46, s79, 0x20000
    s_add_u32 m0, s48, 36864
    s_nop 0
    buffer_load_dwordx4 v82, s[28:31], s46 offen  lds
    s_add_u32 s46, s79, 0x40000
    s_add_u32 m0, s48, 40960
    s_nop 0
    buffer_load_dwordx4 v82, s[28:31], s46 offen  lds
    s_add_u32 s46, s79, 0x60000
    s_add_u32 m0, s48, 45056
    s_nop 0
    buffer_load_dwordx4 v82, s[28:31], s46 offen  lds
    s_cmp_lg_u32 s44, 0
    s_cbranch_scc1 L_lw_17_0
    ds_read_b64_tr_b16 v[160:161], v80 offset:49152
    ds_read_b64_tr_b16 v[162:163], v80 offset:50176
    ds_read_b64_tr_b16 v[164:165], v80 offset:57344
    ds_read_b64_tr_b16 v[166:167], v80 offset:58368
    ds_read_b64_tr_b16 v[56:57], v81 offset:49152
    ds_read_b64_tr_b16 v[58:59], v81 offset:50176
    ds_read_b64_tr_b16 v[60:61], v81 offset:57344
    ds_read_b64_tr_b16 v[62:63], v81 offset:58368
    s_waitcnt lgkmcnt(0)
    ds_write_b128 v5, v[56:59] offset:0
    ds_write_b128 v5, v[60:63] offset:1024
    s_branch L_lw_17
L_lw_17_0:
    s_cmp_lg_u32 s44, 1
    s_cbranch_scc1 L_lw_17_1
    ds_read_b64_tr_b16 a[208:209], v80 offset:49152
    ds_read_b64_tr_b16 a[210:211], v80 offset:50176
    ds_read_b64_tr_b16 a[212:213], v80 offset:57344
    ds_read_b64_tr_b16 a[214:215], v80 offset:58368
    ds_read_b64_tr_b16 v[56:57], v81 offset:49152
    ds_read_b64_tr_b16 v[58:59], v81 offset:50176
    ds_read_b64_tr_b16 v[60:61], v81 offset:57344
    ds_read_b64_tr_b16 v[62:63], v81 offset:58368
    s_waitcnt lgkmcnt(0)
    ds_write_b128 v5, v[56:59] offset:2048
    ds_write_b128 v5, v[60:63] offset:3072
    s_branch L_lw_17
L_lw_17_1:
    s_cmp_lg_u32 s44, 2
    s_cbranch_scc1 L_lw_17_2
    ds_read_b64_tr_b16 a[104:105], v80 offset:49152
    ds_read_b64_tr_b16 a[106:107], v80 offset:50176
    ds_read_b64_tr_b16 a[108:109], v80 offset:57344
    ds_read_b64_tr_b16 a[110:111], v80 offset:58368
    ds_read_b64_tr_b16 v[56:57], v81 offset:49152
    ds_read_b64_tr_b16 v[58:59], v81 offset:50176
    ds_read_b64_tr_b16 v[60:61], v81 offset:57344
    ds_read_b64_tr_b16 v[62:63], v81 offset:58368
    s_waitcnt lgkmcnt(0)
    ds_write_b128 v5, v[56:59] offset:4096
    ds_write_b128 v5, v[60:63] offset:5120
    s_branch L_lw_17
L_lw_17_2:
    ds_read_b64_tr_b16 a[0:1], v80 offset:49152
    ds_read_b64_tr_b16 a[2:3], v80 offset:50176
    ds_read_b64_tr_b16 a[4:5], v80 offset:57344
    ds_read_b64_tr_b16 a[6:7], v80 offset:58368
    ds_read_b64_tr_b16 a[8:9], v81 offset:49152
    ds_read_b64_tr_b16 a[10:11], v81 offset:50176
    ds_read_b64_tr_b16 a[12:13], v81 offset:57344
    ds_read_b64_tr_b16 a[14:15], v81 offset:58368
L_lw_17:
    s_waitcnt lgkmcnt(0)
    s_waitcnt vmcnt(12)
    s_barrier
    s_add_u32 s79, s41, 1
    s_and_b32 s79, s79, 3
    s_lshl_b32 s79, s79, 19
    s_add_u32 s79, s79, s47
    s_add_u32 s46, s79, 0x0
    s_add_u32 m0, s48, 49152
    s_nop 0
    buffer_load_dwordx4 v82, s[28:31], s46 offen  lds
    s_add_u32 s46, s79, 0x20000
    s_add_u32 m0, s48, 53248
    s_nop 0
    buffer_load_dwordx4 v82, s[28:31], s46 offen  lds
    s_add_u32 s46, s79, 0x40000
    s_add_u32 m0, s48, 57344
    s_nop 0
    buffer_load_dwordx4 v82, s[28:31], s46 offen  lds
    s_add_u32 s46, s79, 0x60000
    s_add_u32 m0, s48, 61440
    s_nop 0
    buffer_load_dwordx4 v82, s[28:31], s46 offen  lds
    s_cmp_lg_u32 s44, 0
    s_cbranch_scc1 L_lw_18_0
    ds_read_b64_tr_b16 v[184:185], v84 offset:20480
    ds_read_b64_tr_b16 v[186:187], v84 offset:21504
    ds_read_b64_tr_b16 v[188:189], v86 offset:20480
    ds_read_b64_tr_b16 v[190:191], v86 offset:21504
    ds_read_b64_tr_b16 v[192:193], v85 offset:20480
    ds_read_b64_tr_b16 v[194:195], v85 offset:21504
    ds_read_b64_tr_b16 v[196:197], v87 offset:20480
    ds_read_b64_tr_b16 v[198:199], v87 offset:21504
    s_branch L_lw_18
L_lw_18_0:
    s_cmp_lg_u32 s44, 1
    s_cbranch_scc1 L_lw_18_1
    ds_read_b64_tr_b16 a[232:233], v84 offset:20480
    ds_read_b64_tr_b16 a[234:235], v84 offset:21504
    ds_read_b64_tr_b16 a[236:237], v86 offset:20480
    ds_read_b64_tr_b16 a[238:239], v86 offset:21504
    ds_read_b64_tr_b16 a[240:241], v85 offset:20480
    ds_read_b64_tr_b16 a[242:243], v85 offset:21504
    ds_read_b64_tr_b16 a[244:245], v87 offset:20480
    ds_read_b64_tr_b16 a[246:247], v87 offset:21504
    s_branch L_lw_18
L_lw_18_1:
    s_cmp_lg_u32 s44, 2
    s_cbranch_scc1 L_lw_18_2
    ds_read_b64_tr_b16 a[128:129], v84 offset:20480
    ds_read_b64_tr_b16 a[130:131], v84 offset:21504
    ds_read_b64_tr_b16 a[132:133], v86 offset:20480
    ds_read_b64_tr_b16 a[134:135], v86 offset:21504
    ds_read_b64_tr_b16 v[56:57], v85 offset:20480
    ds_read_b64_tr_b16 v[58:59], v85 offset:21504
    ds_read_b64_tr_b16 v[60:61], v87 offset:20480
    ds_read_b64_tr_b16 v[62:63], v87 offset:21504
    s_waitcnt lgkmcnt(0)
    ds_write_b128 v5, v[56:59] offset:6144
    ds_write_b128 v5, v[60:63] offset:7168
    s_branch L_lw_18
L_lw_18_2:
    ds_read_b64_tr_b16 a[32:33], v84 offset:20480
    ds_read_b64_tr_b16 a[34:35], v84 offset:21504
    ds_read_b64_tr_b16 a[36:37], v86 offset:20480
    ds_read_b64_tr_b16 a[38:39], v86 offset:21504
    ds_read_b64_tr_b16 a[40:41], v85 offset:20480
    ds_read_b64_tr_b16 a[42:43], v85 offset:21504
    ds_read_b64_tr_b16 a[44:45], v87 offset:20480
    ds_read_b64_tr_b16 a[46:47], v87 offset:21504
L_lw_18:
    s_waitcnt lgkmcnt(0)
    s_waitcnt vmcnt(12)
    s_barrier
    s_cmp_lg_u32 s44, 0
    s_cbranch_scc1 L_lw_19_0
    ds_read_b64_tr_b16 v[208:209], v80 offset:0
    ds_read_b64_tr_b16 v[210:211], v80 offset:1024
    ds_read_b64_tr_b16 v[212:213], v80 offset:8192
    ds_read_b64_tr_b16 v[214:215], v80 offset:9216
    ds_read_b64_tr_b16 v[56:57], v81 offset:0
    ds_read_b64_tr_b16 v[58:59], v81 offset:1024
    ds_read_b64_tr_b16 v[60:61], v81 offset:8192
    ds_read_b64_tr_b16 v[62:63], v81 offset:9216
    s_waitcnt lgkmcnt(0)
    ds_write_b128 v5, v[56:59] offset:10240
    ds_write_b128 v5, v[60:63] offset:11264
    s_branch L_lw_19
L_lw_19_0:
    s_cmp_lg_u32 s44, 1
    s_cbranch_scc1 L_lw_19_1
    ds_read_b64_tr_b16 v[104:105], v80 offset:0
    ds_read_b64_tr_b16 v[106:107], v80 offset:1024
    ds_read_b64_tr_b16 v[108:109], v80 offset:8192
    ds_read_b64_tr_b16 v[110:111], v80 offset:9216
    ds_read_b64_tr_b16 v[56:57], v81 offset:0
    ds_read_b64_tr_b16 v[58:59], v81 offset:1024
    ds_read_b64_tr_b16 v[60:61], v81 offset:8192
    ds_read_b64_tr_b16 v[62:63], v81 offset:9216
    s_waitcnt lgkmcnt(0)
    ds_write_b128 v5, v[56:59] offset:12288
    ds_write_b128 v5, v[60:63] offset:13312
    s_branch L_lw_19
L_lw_19_1:
    s_cmp_lg_u32 s44, 2
    s_cbranch_scc1 L_lw_19_2
    ds_read_b64_tr_b16 a[152:153], v80 offset:0
    ds_read_b64_tr_b16 a[154:155], v80 offset:1024
    ds_read_b64_tr_b16 a[156:157], v80 offset:8192
    ds_read_b64_tr_b16 a[158:159], v80 offset:9216
    ds_read_b64_tr_b16 v[56:57], v81 offset:0
    ds_read_b64_tr_b16 v[58:59], v81 offset:1024
    ds_read_b64_tr_b16 v[60:61], v81 offset:8192
    ds_read_b64_tr_b16 v[62:63], v81 offset:9216
    s_waitcnt lgkmcnt(0)
    ds_write_b128 v5, v[56:59] offset:14336
    ds_write_b128 v5, v[60:63] offset:15360
    s_branch L_lw_19
L_lw_19_2:
    ds_read_b64_tr_b16 a[64:65], v80 offset:0
    ds_read_b64_tr_b16 a[66:67], v80 offset:1024
    ds_read_b64_tr_b16 a[68:69], v80 offset:8192
    ds_read_b64_tr_b16 a[70:71], v80 offset:9216
    ds_read_b64_tr_b16 v[56:57], v81 offset:0
    ds_read_b64_tr_b16 v[58:59], v81 offset:1024
    ds_read_b64_tr_b16 v[60:61], v81 offset:8192
    ds_read_b64_tr_b16 v[62:63], v81 offset:9216
    s_waitcnt lgkmcnt(0)
    ds_write_b128 v5, v[56:59] offset:8192
    ds_write_b128 v5, v[60:63] offset:9216
L_lw_19:
    s_waitcnt lgkmcnt(0)
    s_waitcnt vmcnt(8)
    s_barrier
    s_add_u32 s79, s41, 2
    s_and_b32 s79, s79, 3
    s_lshl_b32 s79, s79, 19
    s_add_u32 s79, s79, s47
    s_add_u32 s46, s79, 0x0
    s_add_u32 m0, s48, 0
    s_nop 0
    buffer_load_dwordx4 v82, s[28:31], s46 offen  lds
    s_add_u32 s46, s79, 0x20000
    s_add_u32 m0, s48, 4096
    s_nop 0
    buffer_load_dwordx4 v82, s[28:31], s46 offen  lds
    s_add_u32 s46, s79, 0x40000
    s_add_u32 m0, s48, 8192
    s_nop 0
    buffer_load_dwordx4 v82, s[28:31], s46 offen  lds
    s_add_u32 s46, s79, 0x60000
    s_add_u32 m0, s48, 12288
    s_nop 0
    buffer_load_dwordx4 v82, s[28:31], s46 offen  lds
    s_cmp_lg_u32 s44, 0
    s_cbranch_scc1 L_lw_20_0
    ds_read_b64_tr_b16 v[232:233], v80 offset:16384
    ds_read_b64_tr_b16 v[234:235], v80 offset:17408
    ds_read_b64_tr_b16 v[236:237], v80 offset:24576
    ds_read_b64_tr_b16 v[238:239], v80 offset:25600
    ds_read_b64_tr_b16 v[240:241], v81 offset:16384
    ds_read_b64_tr_b16 v[242:243], v81 offset:17408
    ds_read_b64_tr_b16 v[244:245], v81 offset:24576
    ds_read_b64_tr_b16 v[246:247], v81 offset:25600
    s_branch L_lw_20
L_lw_20_0:
    s_cmp_lg_u32 s44, 1
    s_cbranch_scc1 L_lw_20_1
    ds_read_b64_tr_b16 v[128:129], v80 offset:16384
    ds_read_b64_tr_b16 v[130:131], v80 offset:17408
    ds_read_b64_tr_b16 v[132:133], v80 offset:24576
    ds_read_b64_tr_b16 v[134:135], v80 offset:25600
    ds_read_b64_tr_b16 v[136:137], v81 offset:16384
    ds_read_b64_tr_b16 v[138:139], v81 offset:17408
    ds_read_b64_tr_b16 v[140:141], v81 offset:24576
    ds_read_b64_tr_b16 v[142:143], v81 offset:25600
    s_branch L_lw_20
L_lw_20_1:
    s_cmp_lg_u32 s44, 2
    s_cbranch_scc1 L_lw_20_2
    ds_read_b64_tr_b16 a[176:177], v80 offset:16384
    ds_read_b64_tr_b16 a[178:179], v80 offset:17408
    ds_read_b64_tr_b16 a[180:181], v80 offset:24576
    ds_read_b64_tr_b16 a[182:183], v80 offset:25600
    ds_read_b64_tr_b16 a[184:185], v81 offset:16384
    ds_read_b64_tr_b16 a[186:187], v81 offset:17408
    ds_read_b64_tr_b16 a[188:189], v81 offset:24576
    ds_read_b64_tr_b16 a[190:191], v81 offset:25600
    s_branch L_lw_20
L_lw_20_2:
    ds_read_b64_tr_b16 a[80:81], v80 offset:16384
    ds_read_b64_tr_b16 a[82:83], v80 offset:17408
    ds_read_b64_tr_b16 a[84:85], v80 offset:24576
    ds_read_b64_tr_b16 a[86:87], v80 offset:25600
    ds_read_b64_tr_b16 v[56:57], v81 offset:16384
    ds_read_b64_tr_b16 v[58:59], v81 offset:17408
    ds_read_b64_tr_b16 v[60:61], v81 offset:24576
    ds_read_b64_tr_b16 v[62:63], v81 offset:25600
    s_waitcnt lgkmcnt(0)
    ds_write_b128 v5, v[56:59] offset:16384
    ds_write_b128 v5, v[60:63] offset:17408
L_lw_20:
    s_waitcnt lgkmcnt(0)
    s_waitcnt vmcnt(8)
    s_barrier
    s_add_u32 s79, s41, 3
    s_and_b32 s79, s79, 3
    s_lshl_b32 s79, s79, 19
    s_add_u32 s79, s79, s47
    s_add_u32 s46, s79, 0x0
    s_add_u32 m0, s48, 16384
    s_nop 0
    buffer_load_dwordx4 v82, s[28:31], s46 offen  lds
    s_add_u32 s46, s79, 0x20000
    s_add_u32 m0, s48, 20480
    s_nop 0
    buffer_load_dwordx4 v82, s[28:31], s46 offen  lds
    s_add_u32 s46, s79, 0x40000
    s_add_u32 m0, s48, 24576
    s_nop 0
    buffer_load_dwordx4 v82, s[28:31], s46 offen  lds
    s_add_u32 s46, s79, 0x60000
    s_add_u32 m0, s48, 28672
    s_nop 0
    buffer_load_dwordx4 v82, s[28:31], s46 offen  lds
    s_cmp_lg_u32 s44, 0
    s_cbranch_scc1 L_lw_21_0
    ds_read_b64_tr_b16 a[16:17], v80 offset:32768
    ds_read_b64_tr_b16 a[18:19], v80 offset:33792
    ds_read_b64_tr_b16 a[20:21], v80 offset:40960
    ds_read_b64_tr_b16 a[22:23], v80 offset:41984
    ds_read_b64_tr_b16 a[24:25], v81 offset:32768
    ds_read_b64_tr_b16 a[26:27], v81 offset:33792
    ds_read_b64_tr_b16 a[28:29], v81 offset:40960
    ds_read_b64_tr_b16 a[30:31], v81 offset:41984
    s_branch L_lw_21
L_lw_21_0:
    s_cmp_lg_u32 s44, 1
    s_cbranch_scc1 L_lw_21_1
    ds_read_b64_tr_b16 v[168:169], v80 offset:32768
    ds_read_b64_tr_b16 v[170:171], v80 offset:33792
    ds_read_b64_tr_b16 v[172:173], v80 offset:40960
    ds_read_b64_tr_b16 v[174:175], v80 offset:41984
    ds_read_b64_tr_b16 v[176:177], v81 offset:32768
    ds_read_b64_tr_b16 v[178:179], v81 offset:33792
    ds_read_b64_tr_b16 v[180:181], v81 offset:40960
    ds_read_b64_tr_b16 v[182:183], v81 offset:41984
    s_branch L_lw_21
L_lw_21_1:
    s_cmp_lg_u32 s44, 2
    s_cbranch_scc1 L_lw_21_2
    ds_read_b64_tr_b16 a[216:217], v80 offset:32768
    ds_read_b64_tr_b16 a[218:219], v80 offset:33792
    ds_read_b64_tr_b16 a[220:221], v80 offset:40960
    ds_read_b64_tr_b16 a[222:223], v80 offset:41984
    ds_read_b64_tr_b16 a[224:225], v81 offset:32768
    ds_read_b64_tr_b16 a[226:227], v81 offset:33792
    ds_read_b64_tr_b16 a[228:229], v81 offset:40960
    ds_read_b64_tr_b16 a[230:231], v81 offset:41984
    s_branch L_lw_21
L_lw_21_2:
    ds_read_b64_tr_b16 a[112:113], v80 offset:32768
    ds_read_b64_tr_b16 a[114:115], v80 offset:33792
    ds_read_b64_tr_b16 a[116:117], v80 offset:40960
    ds_read_b64_tr_b16 a[118:119], v80 offset:41984
    ds_read_b64_tr_b16 a[120:121], v81 offset:32768
    ds_read_b64_tr_b16 a[122:123], v81 offset:33792
    ds_read_b64_tr_b16 a[124:125], v81 offset:40960
    ds_read_b64_tr_b16 a[126:127], v81 offset:41984
L_lw_21:
    s_waitcnt lgkmcnt(0)
    s_waitcnt vmcnt(8)
    s_barrier
    s_add_u32 s79, s41, 4
    s_and_b32 s79, s79, 3
    s_lshl_b32 s79, s79, 19
    s_add_u32 s79, s79, s47
    s_add_u32 s46, s79, 0x200000
    s_add_u32 m0, s48, 32768
    s_nop 0
    buffer_load_dwordx4 v82, s[28:31], s46 offen  lds
    s_add_u32 s46, s79, 0x220000
    s_add_u32 m0, s48, 36864
    s_nop 0
    buffer_load_dwordx4 v82, s[28:31], s46 offen  lds
    s_add_u32 s46, s79, 0x240000
    s_add_u32 m0, s48, 40960
    s_nop 0
    buffer_load_dwordx4 v82, s[28:31], s46 offen  lds
    s_add_u32 s46, s79, 0x260000
    s_add_u32 m0, s48, 45056
    s_nop 0
    buffer_load_dwordx4 v82, s[28:31], s46 offen  lds
    s_cmp_lg_u32 s44, 0
    s_cbranch_scc1 L_lw_22_0
    ds_read_b64_tr_b16 a[48:49], v80 offset:49152
    ds_read_b64_tr_b16 a[50:51], v80 offset:50176
    ds_read_b64_tr_b16 a[52:53], v80 offset:57344
    ds_read_b64_tr_b16 a[54:55], v80 offset:58368
    ds_read_b64_tr_b16 a[56:57], v81 offset:49152
    ds_read_b64_tr_b16 a[58:59], v81 offset:50176
    ds_read_b64_tr_b16 a[60:61], v81 offset:57344
    ds_read_b64_tr_b16 a[62:63], v81 offset:58368
    s_branch L_lw_22
L_lw_22_0:
    s_cmp_lg_u32 s44, 1
    s_cbranch_scc1 L_lw_22_1
    ds_read_b64_tr_b16 v[200:201], v80 offset:49152
    ds_read_b64_tr_b16 v[202:203], v80 offset:50176
    ds_read_b64_tr_b16 v[204:205], v80 offset:57344
    ds_read_b64_tr_b16 v[206:207], v80 offset:58368
    ds_read_b64_tr_b16 v[56:57], v81 offset:49152
    ds_read_b64_tr_b16 v[58:59], v81 offset:50176
    ds_read_b64_tr_b16 v[60:61], v81 offset:57344
    ds_read_b64_tr_b16 v[62:63], v81 offset:58368
    s_waitcnt lgkmcnt(0)
    ds_write_b128 v5, v[56:59] offset:18432
    ds_write_b128 v5, v[60:63] offset:19456
    s_branch L_lw_22
L_lw_22_1:
    s_cmp_lg_u32 s44, 2
    s_cbranch_scc1 L_lw_22_2
    ds_read_b64_tr_b16 a[248:249], v80 offset:49152
    ds_read_b64_tr_b16 a[250:251], v80 offset:50176
    ds_read_b64_tr_b16 a[252:253], v80 offset:57344
    ds_read_b64_tr_b16 a[254:255], v80 offset:58368
    ds_read_b64_tr_b16 v[96:97], v81 offset:49152
    ds_read_b64_tr_b16 v[98:99], v81 offset:50176
    ds_read_b64_tr_b16 v[100:101], v81 offset:57344
    ds_read_b64_tr_b16 v[102:103], v81 offset:58368
    s_branch L_lw_22
L_lw_22_2:
    ds_read_b64_tr_b16 a[136:137], v80 offset:49152
    ds_read_b64_tr_b16 a[138:139], v80 offset:50176
    ds_read_b64_tr_b16 a[140:141], v80 offset:57344
    ds_read_b64_tr_b16 a[142:143], v80 offset:58368
    ds_read_b64_tr_b16 a[144:145], v81 offset:49152
    ds_read_b64_tr_b16 a[146:147], v81 offset:50176
    ds_read_b64_tr_b16 a[148:149], v81 offset:57344
    ds_read_b64_tr_b16 a[150:151], v81 offset:58368
L_lw_22:
    s_waitcnt lgkmcnt(0)
    s_waitcnt vmcnt(8)
    s_barrier
    s_add_u32 s79, s41, 5
    s_and_b32 s79, s79, 3
    s_lshl_b32 s79, s79, 19
    s_add_u32 s79, s79, s47
    s_add_u32 s46, s79, 0x200000
    s_add_u32 m0, s48, 49152
    s_nop 0
    buffer_load_dwordx4 v82, s[28:31], s46 offen  lds
    s_add_u32 s46, s79, 0x220000
    s_add_u32 m0, s48, 53248
    s_nop 0
    buffer_load_dwordx4 v82, s[28:31], s46 offen  lds
    s_add_u32 s46, s79, 0x240000
    s_add_u32 m0, s48, 57344
    s_nop 0
    buffer_load_dwordx4 v82, s[28:31], s46 offen  lds
    s_add_u32 s46, s79, 0x260000
    s_add_u32 m0, s48, 61440
    s_nop 0
    buffer_load_dwordx4 v82, s[28:31], s46 offen  lds
    s_cmp_lg_u32 s44, 0
    s_cbranch_scc1 L_lw_23_0
    ds_read_b64_tr_b16 a[72:73], v80 offset:0
    ds_read_b64_tr_b16 a[74:75], v80 offset:1024
    ds_read_b64_tr_b16 a[76:77], v80 offset:8192
    ds_read_b64_tr_b16 a[78:79], v80 offset:9216
    ds_read_b64_tr_b16 v[56:57], v81 offset:0
    ds_read_b64_tr_b16 v[58:59], v81 offset:1024
    ds_read_b64_tr_b16 v[60:61], v81 offset:8192
    ds_read_b64_tr_b16 v[62:63], v81 offset:9216
    s_waitcnt lgkmcnt(0)
    ds_write_b128 v5, v[56:59] offset:20480
    ds_write_b128 v5, v[60:63] offset:21504
    s_branch L_lw_23
L_lw_23_0:
    s_cmp_lg_u32 s44, 1
    s_cbranch_scc1 L_lw_23_1
    ds_read_b64_tr_b16 v[216:217], v80 offset:0
    ds_read_b64_tr_b16 v[218:219], v80 offset:1024
    ds_read_b64_tr_b16 v[220:221], v80 offset:8192
    ds_read_b64_tr_b16 v[222:223], v80 offset:9216
    ds_read_b64_tr_b16 v[224:225], v81 offset:0
    ds_read_b64_tr_b16 v[226:227], v81 offset:1024
    ds_read_b64_tr_b16 v[228:229], v81 offset:8192
    ds_read_b64_tr_b16 v[230:231], v81 offset:9216
    s_branch L_lw_23
L_lw_23_1:
    s_cmp_lg_u32 s44, 2
    s_cbranch_scc1 L_lw_23_2
    ds_read_b64_tr_b16 v[112:113], v80 offset:0
    ds_read_b64_tr_b16 v[114:115], v80 offset:1024
    ds_read_b64_tr_b16 v[116:117], v80 offset:8192
    ds_read_b64_tr_b16 v[118:119], v80 offset:9216
    ds_read_b64_tr_b16 v[120:121], v81 offset:0
    ds_read_b64_tr_b16 v[122:123], v81 offset:1024
    ds_read_b64_tr_b16 v[124:125], v81 offset:8192
    ds_read_b64_tr_b16 v[126:127], v81 offset:9216
    s_branch L_lw_23
L_lw_23_2:
    ds_read_b64_tr_b16 a[160:161], v80 offset:0
    ds_read_b64_tr_b16 a[162:163], v80 offset:1024
    ds_read_b64_tr_b16 a[164:165], v80 offset:8192
    ds_read_b64_tr_b16 a[166:167], v80 offset:9216
    ds_read_b64_tr_b16 a[168:169], v81 offset:0
    ds_read_b64_tr_b16 a[170:171], v81 offset:1024
    ds_read_b64_tr_b16 a[172:173], v81 offset:8192
    ds_read_b64_tr_b16 a[174:175], v81 offset:9216
L_lw_23:
    s_waitcnt lgkmcnt(0)
    s_waitcnt vmcnt(8)
    s_barrier
    s_add_u32 s79, s41, 6
    s_and_b32 s79, s79, 3
    s_lshl_b32 s79, s79, 19
    s_add_u32 s79, s79, s47
    s_add_u32 s46, s79, 0x200000
    s_add_u32 m0, s48, 0
    s_nop 0
    buffer_load_dwordx4 v82, s[28:31], s46 offen  lds
    s_add_u32 s46, s79, 0x220000
    s_add_u32 m0, s48, 4096
    s_nop 0
    buffer_load_dwordx4 v82, s[28:31], s46 offen  lds
    s_add_u32 s46, s79, 0x240000
    s_add_u32 m0, s48, 8192
    s_nop 0
    buffer_load_dwordx4 v82, s[28:31], s46 offen  lds
    s_add_u32 s46, s79, 0x260000
    s_add_u32 m0, s48, 12288
    s_nop 0
    buffer_load_dwordx4 v82, s[28:31], s46 offen  lds
    s_cmp_lg_u32 s44, 0
    s_cbranch_scc1 L_lw_24_0
    ds_read_b64_tr_b16 a[88:89], v80 offset:16384
    ds_read_b64_tr_b16 a[90:91], v80 offset:17408
    ds_read_b64_tr_b16 a[92:93], v80 offset:24576
    ds_read_b64_tr_b16 a[94:95], v80 offset:25600
    ds_read_b64_tr_b16 a[96:97], v81 offset:16384
    ds_read_b64_tr_b16 a[98:99], v81 offset:17408
    ds_read_b64_tr_b16 a[100:101], v81 offset:24576
    ds_read_b64_tr_b16 a[102:103], v81 offset:25600
    s_branch L_lw_24
L_lw_24_0:
    s_cmp_lg_u32 s44, 1
    s_cbranch_scc1 L_lw_24_1
    ds_read_b64_tr_b16 v[248:249], v80 offset:16384
    ds_read_b64_tr_b16 v[250:251], v80 offset:17408
    ds_read_b64_tr_b16 v[252:253], v80 offset:24576
    ds_read_b64_tr_b16 v[254:255], v80 offset:25600
    ds_read_b64_tr_b16 v[56:57], v81 offset:16384
    ds_read_b64_tr_b16 v[58:59], v81 offset:17408
    ds_read_b64_tr_b16 v[60:61], v81 offset:24576
    ds_read_b64_tr_b16 v[62:63], v81 offset:25600
    s_waitcnt lgkmcnt(0)
    ds_write_b128 v5, v[56:59] offset:22528
    ds_write_b128 v5, v[60:63] offset:23552
    s_branch L_lw_24
L_lw_24_1:
    s_cmp_lg_u32 s44, 2
    s_cbranch_scc1 L_lw_24_2
    ds_read_b64_tr_b16 v[144:145], v80 offset:16384
    ds_read_b64_tr_b16 v[146:147], v80 offset:17408
    ds_read_b64_tr_b16 v[148:149], v80 offset:24576
    ds_read_b64_tr_b16 v[150:151], v80 offset:25600
    ds_read_b64_tr_b16 v[152:153], v81 offset:16384
    ds_read_b64_tr_b16 v[154:155], v81 offset:17408
    ds_read_b64_tr_b16 v[156:157], v81 offset:24576
    ds_read_b64_tr_b16 v[158:159], v81 offset:25600
    s_branch L_lw_24
L_lw_24_2:
    ds_read_b64_tr_b16 a[192:193], v80 offset:16384
    ds_read_b64_tr_b16 a[194:195], v80 offset:17408
    ds_read_b64_tr_b16 a[196:197], v80 offset:24576
    ds_read_b64_tr_b16 a[198:199], v80 offset:25600
    ds_read_b64_tr_b16 a[200:201], v81 offset:16384
    ds_read_b64_tr_b16 a[202:203], v81 offset:17408
    ds_read_b64_tr_b16 a[204:205], v81 offset:24576
    ds_read_b64_tr_b16 a[206:207], v81 offset:25600
L_lw_24:
    s_waitcnt lgkmcnt(0)
    s_waitcnt vmcnt(8)
    s_barrier
    s_add_u32 s79, s41, 7
    s_and_b32 s79, s79, 3
    s_lshl_b32 s79, s79, 19
    s_add_u32 s79, s79, s47
    s_add_u32 s46, s79, 0x200000
    s_add_u32 m0, s48, 16384
    s_nop 0
    buffer_load_dwordx4 v82, s[28:31], s46 offen  lds
    s_add_u32 s46, s79, 0x220000
    s_add_u32 m0, s48, 20480
    s_nop 0
    buffer_load_dwordx4 v82, s[28:31], s46 offen  lds
    s_add_u32 s46, s79, 0x240000
    s_add_u32 m0, s48, 24576
    s_nop 0
    buffer_load_dwordx4 v82, s[28:31], s46 offen  lds
    s_add_u32 s46, s79, 0x260000
    s_add_u32 m0, s48, 28672
    s_nop 0
    buffer_load_dwordx4 v82, s[28:31], s46 offen  lds
    s_cmp_lg_u32 s44, 0
    s_cbranch_scc1 L_lw_25_0
    ds_read_b64_tr_b16 a[112:113], v80 offset:32768
    ds_read_b64_tr_b16 a[114:115], v80 offset:33792
    ds_read_b64_tr_b16 a[116:117], v80 offset:40960
    ds_read_b64_tr_b16 a[118:119], v80 offset:41984
    ds_read_b64_tr_b16 a[120:121], v81 offset:32768
    ds_read_b64_tr_b16 a[122:123], v81 offset:33792
    ds_read_b64_tr_b16 a[124:125], v81 offset:40960
    ds_read_b64_tr_b16 a[126:127], v81 offset:41984
    s_branch L_lw_25
L_lw_25_0:
    s_cmp_lg_u32 s44, 1
    s_cbranch_scc1 L_lw_25_1
    ds_read_b64_tr_b16 a[16:17], v80 offset:32768
    ds_read_b64_tr_b16 a[18:19], v80 offset:33792
    ds_read_b64_tr_b16 a[20:21], v80 offset:40960
    ds_read_b64_tr_b16 a[22:23], v80 offset:41984
    ds_read_b64_tr_b16 a[24:25], v81 offset:32768
    ds_read_b64_tr_b16 a[26:27], v81 offset:33792
    ds_read_b64_tr_b16 a[28:29], v81 offset:40960
    ds_read_b64_tr_b16 a[30:31], v81 offset:41984
    s_branch L_lw_25
L_lw_25_1:
    s_cmp_lg_u32 s44, 2
    s_cbranch_scc1 L_lw_25_2
    ds_read_b64_tr_b16 v[168:169], v80 offset:32768
    ds_read_b64_tr_b16 v[170:171], v80 offset:33792
    ds_read_b64_tr_b16 v[172:173], v80 offset:40960
    ds_read_b64_tr_b16 v[174:175], v80 offset:41984
    ds_read_b64_tr_b16 v[176:177], v81 offset:32768
    ds_read_b64_tr_b16 v[178:179], v81 offset:33792
    ds_read_b64_tr_b16 v[180:181], v81 offset:40960
    ds_read_b64_tr_b16 v[182:183], v81 offset:41984
    s_branch L_lw_25
L_lw_25_2:
    ds_read_b64_tr_b16 a[216:217], v80 offset:32768
    ds_read_b64_tr_b16 a[218:219], v80 offset:33792
    ds_read_b64_tr_b16 a[220:221], v80 offset:40960
    ds_read_b64_tr_b16 a[222:223], v80 offset:41984
    ds_read_b64_tr_b16 a[224:225], v81 offset:32768
    ds_read_b64_tr_b16 a[226:227], v81 offset:33792
    ds_read_b64_tr_b16 a[228:229], v81 offset:40960
    ds_read_b64_tr_b16 a[230:231], v81 offset:41984
L_lw_25:
    s_waitcnt lgkmcnt(0)
    s_waitcnt vmcnt(8)
    s_barrier
    s_add_u32 s79, s41, 8
    s_and_b32 s79, s79, 3
    s_lshl_b32 s79, s79, 19
    s_add_u32 s79, s79, s47
    s_add_u32 s46, s79, 0x400000
    s_add_u32 m0, s48, 32768
    s_nop 0
    buffer_load_dwordx4 v82, s[28:31], s46 offen  lds
    s_add_u32 s46, s79, 0x420000
    s_add_u32 m0, s48, 36864
    s_nop 0
    buffer_load_dwordx4 v82, s[28:31], s46 offen  lds
    s_add_u32 s46, s79, 0x440000
    s_add_u32 m0, s48, 40960
    s_nop 0
    buffer_load_dwordx4 v82, s[28:31], s46 offen  lds
    s_add_u32 s46, s79, 0x460000
    s_add_u32 m0, s48, 45056
    s_nop 0
    buffer_load_dwordx4 v82, s[28:31], s46 offen  lds
    s_cmp_lg_u32 s44, 0
    s_cbranch_scc1 L_lw_26_0
    ds_read_b64_tr_b16 a[136:137], v80 offset:49152
    ds_read_b64_tr_b16 a[138:139], v80 offset:50176
    ds_read_b64_tr_b16 a[140:141], v80 offset:57344
    ds_read_b64_tr_b16 a[142:143], v80 offset:58368
    ds_read_b64_tr_b16 a[144:145], v81 offset:49152
    ds_read_b64_tr_b16 a[146:147], v81 offset:50176
    ds_read_b64_tr_b16 a[148:149], v81 offset:57344
    ds_read_b64_tr_b16 a[150:151], v81 offset:58368
    s_branch L_lw_26
L_lw_26_0:
    s_cmp_lg_u32 s44, 1
    s_cbranch_scc1 L_lw_26_1
    ds_read_b64_tr_b16 a[48:49], v80 offset:49152
    ds_read_b64_tr_b16 a[50:51], v80 offset:50176
    ds_read_b64_tr_b16 a[52:53], v80 offset:57344
    ds_read_b64_tr_b16 a[54:55], v80 offset:58368
    ds_read_b64_tr_b16 a[56:57], v81 offset:49152
    ds_read_b64_tr_b16 a[58:59], v81 offset:50176
    ds_read_b64_tr_b16 a[60:61], v81 offset:57344
    ds_read_b64_tr_b16 a[62:63], v81 offset:58368
    s_branch L_lw_26
L_lw_26_1:
    s_cmp_lg_u32 s44, 2
    s_cbranch_scc1 L_lw_26_2
    ds_read_b64_tr_b16 v[200:201], v80 offset:49152
    ds_read_b64_tr_b16 v[202:203], v80 offset:50176
    ds_read_b64_tr_b16 v[204:205], v80 offset:57344
    ds_read_b64_tr_b16 v[206:207], v80 offset:58368
    ds_read_b64_tr_b16 v[56:57], v81 offset:49152
    ds_read_b64_tr_b16 v[58:59], v81 offset:50176
    ds_read_b64_tr_b16 v[60:61], v81 offset:57344
    ds_read_b64_tr_b16 v[62:63], v81 offset:58368
    s_waitcnt lgkmcnt(0)
    ds_write_b128 v5, v[56:59] offset:18432
    ds_write_b128 v5, v[60:63] offset:19456
    s_branch L_lw_26
L_lw_26_2:
    ds_read_b64_tr_b16 a[248:249], v80 offset:49152
    ds_read_b64_tr_b16 a[250:251], v80 offset:50176
    ds_read_b64_tr_b16 a[252:253], v80 offset:57344
    ds_read_b64_tr_b16 a[254:255], v80 offset:58368
    ds_read_b64_tr_b16 v[96:97], v81 offset:49152
    ds_read_b64_tr_b16 v[98:99], v81 offset:50176
    ds_read_b64_tr_b16 v[100:101], v81 offset:57344
    ds_read_b64_tr_b16 v[102:103], v81 offset:58368
L_lw_26:
    s_waitcnt lgkmcnt(0)
    s_waitcnt vmcnt(8)
    s_barrier
    s_add_u32 s79, s41, 9
    s_and_b32 s79, s79, 3
    s_lshl_b32 s79, s79, 19
    s_add_u32 s79, s79, s47
    s_add_u32 s46, s79, 0x400000
    s_add_u32 m0, s48, 49152
    s_nop 0
    buffer_load_dwordx4 v82, s[28:31], s46 offen  lds
    s_add_u32 s46, s79, 0x420000
    s_add_u32 m0, s48, 53248
    s_nop 0
    buffer_load_dwordx4 v82, s[28:31], s46 offen  lds
    s_add_u32 s46, s79, 0x440000
    s_add_u32 m0, s48, 57344
    s_nop 0
    buffer_load_dwordx4 v82, s[28:31], s46 offen  lds
    s_add_u32 s46, s79, 0x460000
    s_add_u32 m0, s48, 61440
    s_nop 0
    buffer_load_dwordx4 v82, s[28:31], s46 offen  lds
    s_cmp_lg_u32 s44, 0
    s_cbranch_scc1 L_lw_27_0
    ds_read_b64_tr_b16 a[160:161], v80 offset:0
    ds_read_b64_tr_b16 a[162:163], v80 offset:1024
    ds_read_b64_tr_b16 a[164:165], v80 offset:8192
    ds_read_b64_tr_b16 a[166:167], v80 offset:9216
    ds_read_b64_tr_b16 a[168:169], v81 offset:0
    ds_read_b64_tr_b16 a[170:171], v81 offset:1024
    ds_read_b64_tr_b16 a[172:173], v81 offset:8192
    ds_read_b64_tr_b16 a[174:175], v81 offset:9216
    s_branch L_lw_27
L_lw_27_0:
    s_cmp_lg_u32 s44, 1
    s_cbranch_scc1 L_lw_27_1
    ds_read_b64_tr_b16 a[72:73], v80 offset:0
    ds_read_b64_tr_b16 a[74:75], v80 offset:1024
    ds_read_b64_tr_b16 a[76:77], v80 offset:8192
    ds_read_b64_tr_b16 a[78:79], v80 offset:9216
    ds_read_b64_tr_b16 v[56:57], v81 offset:0
    ds_read_b64_tr_b16 v[58:59], v81 offset:1024
    ds_read_b64_tr_b16 v[60:61], v81 offset:8192
    ds_read_b64_tr_b16 v[62:63], v81 offset:9216
    s_waitcnt lgkmcnt(0)
    ds_write_b128 v5, v[56:59] offset:20480
    ds_write_b128 v5, v[60:63] offset:21504
    s_branch L_lw_27
L_lw_27_1:
    s_cmp_lg_u32 s44, 2
    s_cbranch_scc1 L_lw_27_2
    ds_read_b64_tr_b16 v[216:217], v80 offset:0
    ds_read_b64_tr_b16 v[218:219], v80 offset:1024
    ds_read_b64_tr_b16 v[220:221], v80 offset:8192
    ds_read_b64_tr_b16 v[222:223], v80 offset:9216
    ds_read_b64_tr_b16 v[224:225], v81 offset:0
    ds_read_b64_tr_b16 v[226:227], v81 offset:1024
    ds_read_b64_tr_b16 v[228:229], v81 offset:8192
    ds_read_b64_tr_b16 v[230:231], v81 offset:9216
    s_branch L_lw_27
L_lw_27_2:
    ds_read_b64_tr_b16 v[112:113], v80 offset:0
    ds_read_b64_tr_b16 v[114:115], v80 offset:1024
    ds_read_b64_tr_b16 v[116:117], v80 offset:8192
    ds_read_b64_tr_b16 v[118:119], v80 offset:9216
    ds_read_b64_tr_b16 v[120:121], v81 offset:0
    ds_read_b64_tr_b16 v[122:123], v81 offset:1024
    ds_read_b64_tr_b16 v[124:125], v81 offset:8192
    ds_read_b64_tr_b16 v[126:127], v81 offset:9216
L_lw_27:
    s_waitcnt lgkmcnt(0)
    s_waitcnt vmcnt(8)
    s_barrier
    s_add_u32 s79, s41, 10
    s_and_b32 s79, s79, 3
    s_lshl_b32 s79, s79, 19
    s_add_u32 s79, s79, s47
    s_add_u32 s46, s79, 0x400000
    s_add_u32 m0, s48, 0
    s_nop 0
    buffer_load_dwordx4 v82, s[28:31], s46 offen  lds
    s_add_u32 s46, s79, 0x420000
    s_add_u32 m0, s48, 4096
    s_nop 0
    buffer_load_dwordx4 v82, s[28:31], s46 offen  lds
    s_add_u32 s46, s79, 0x440000
    s_add_u32 m0, s48, 8192
    s_nop 0
    buffer_load_dwordx4 v82, s[28:31], s46 offen  lds
    s_add_u32 s46, s79, 0x460000
    s_add_u32 m0, s48, 12288
    s_nop 0
    buffer_load_dwordx4 v82, s[28:31], s46 offen  lds
    s_cmp_lg_u32 s44, 0
    s_cbranch_scc1 L_lw_28_0
    ds_read_b64_tr_b16 a[192:193], v80 offset:16384
    ds_read_b64_tr_b16 a[194:195], v80 offset:17408
    ds_read_b64_tr_b16 a[196:197], v80 offset:24576
    ds_read_b64_tr_b16 a[198:199], v80 offset:25600
    ds_read_b64_tr_b16 a[200:201], v81 offset:16384
    ds_read_b64_tr_b16 a[202:203], v81 offset:17408
    ds_read_b64_tr_b16 a[204:205], v81 offset:24576
    ds_read_b64_tr_b16 a[206:207], v81 offset:25600
    s_branch L_lw_28
L_lw_28_0:
    s_cmp_lg_u32 s44, 1
    s_cbranch_scc1 L_lw_28_1
    ds_read_b64_tr_b16 a[88:89], v80 offset:16384
    ds_read_b64_tr_b16 a[90:91], v80 offset:17408
    ds_read_b64_tr_b16 a[92:93], v80 offset:24576
    ds_read_b64_tr_b16 a[94:95], v80 offset:25600
    ds_read_b64_tr_b16 a[96:97], v81 offset:16384
    ds_read_b64_tr_b16 a[98:99], v81 offset:17408
    ds_read_b64_tr_b16 a[100:101], v81 offset:24576
    ds_read_b64_tr_b16 a[102:103], v81 offset:25600
    s_branch L_lw_28
L_lw_28_1:
    s_cmp_lg_u32 s44, 2
    s_cbranch_scc1 L_lw_28_2
    ds_read_b64_tr_b16 v[248:249], v80 offset:16384
    ds_read_b64_tr_b16 v[250:251], v80 offset:17408
    ds_read_b64_tr_b16 v[252:253], v80 offset:24576
    ds_read_b64_tr_b16 v[254:255], v80 offset:25600
    ds_read_b64_tr_b16 v[56:57], v81 offset:16384
    ds_read_b64_tr_b16 v[58:59], v81 offset:17408
    ds_read_b64_tr_b16 v[60:61], v81 offset:24576
    ds_read_b64_tr_b16 v[62:63], v81 offset:25600
    s_waitcnt lgkmcnt(0)
    ds_write_b128 v5, v[56:59] offset:22528
    ds_write_b128 v5, v[60:63] offset:23552
    s_branch L_lw_28
L_lw_28_2:
    ds_read_b64_tr_b16 v[144:145], v80 offset:16384
    ds_read_b64_tr_b16 v[146:147], v80 offset:17408
    ds_read_b64_tr_b16 v[148:149], v80 offset:24576
    ds_read_b64_tr_b16 v[150:151], v80 offset:25600
    ds_read_b64_tr_b16 v[152:153], v81 offset:16384
    ds_read_b64_tr_b16 v[154:155], v81 offset:17408
    ds_read_b64_tr_b16 v[156:157], v81 offset:24576
    ds_read_b64_tr_b16 v[158:159], v81 offset:25600
L_lw_28:
    s_waitcnt lgkmcnt(0)
    s_waitcnt vmcnt(8)
    s_barrier
    s_add_u32 s79, s41, 11
    s_and_b32 s79, s79, 3
    s_lshl_b32 s79, s79, 19
    s_add_u32 s79, s79, s47
    s_add_u32 s46, s79, 0x400000
    s_add_u32 m0, s48, 16384
    s_nop 0
    buffer_load_dwordx4 v82, s[28:31], s46 offen  lds
    s_add_u32 s46, s79, 0x420000
    s_add_u32 m0, s48, 20480
    s_nop 0
    buffer_load_dwordx4 v82, s[28:31], s46 offen  lds
    s_add_u32 s46, s79, 0x440000
    s_add_u32 m0, s48, 24576
    s_nop 0
    buffer_load_dwordx4 v82, s[28:31], s46 offen  lds
    s_add_u32 s46, s79, 0x460000
    s_add_u32 m0, s48, 28672
    s_nop 0
    buffer_load_dwordx4 v82, s[28:31], s46 offen  lds
    s_cmp_lg_u32 s44, 0
    s_cbranch_scc1 L_lw_29_0
    ds_read_b64_tr_b16 a[216:217], v80 offset:32768
    ds_read_b64_tr_b16 a[218:219], v80 offset:33792
    ds_read_b64_tr_b16 a[220:221], v80 offset:40960
    ds_read_b64_tr_b16 a[222:223], v80 offset:41984
    ds_read_b64_tr_b16 a[224:225], v81 offset:32768
    ds_read_b64_tr_b16 a[226:227], v81 offset:33792
    ds_read_b64_tr_b16 a[228:229], v81 offset:40960
    ds_read_b64_tr_b16 a[230:231], v81 offset:41984
    s_branch L_lw_29
L_lw_29_0:
    s_cmp_lg_u32 s44, 1
    s_cbranch_scc1 L_lw_29_1
    ds_read_b64_tr_b16 a[112:113], v80 offset:32768
    ds_read_b64_tr_b16 a[114:115], v80 offset:33792
    ds_read_b64_tr_b16 a[116:117], v80 offset:40960
    ds_read_b64_tr_b16 a[118:119], v80 offset:41984
    ds_read_b64_tr_b16 a[120:121], v81 offset:32768
    ds_read_b64_tr_b16 a[122:123], v81 offset:33792
    ds_read_b64_tr_b16 a[124:125], v81 offset:40960
    ds_read_b64_tr_b16 a[126:127], v81 offset:41984
    s_branch L_lw_29
L_lw_29_1:
    s_cmp_lg_u32 s44, 2
    s_cbranch_scc1 L_lw_29_2
    ds_read_b64_tr_b16 a[16:17], v80 offset:32768
    ds_read_b64_tr_b16 a[18:19], v80 offset:33792
    ds_read_b64_tr_b16 a[20:21], v80 offset:40960
    ds_read_b64_tr_b16 a[22:23], v80 offset:41984
    ds_read_b64_tr_b16 a[24:25], v81 offset:32768
    ds_read_b64_tr_b16 a[26:27], v81 offset:33792
    ds_read_b64_tr_b16 a[28:29], v81 offset:40960
    ds_read_b64_tr_b16 a[30:31], v81 offset:41984
    s_branch L_lw_29
L_lw_29_2:
    ds_read_b64_tr_b16 v[168:169], v80 offset:32768
    ds_read_b64_tr_b16 v[170:171], v80 offset:33792
    ds_read_b64_tr_b16 v[172:173], v80 offset:40960
    ds_read_b64_tr_b16 v[174:175], v80 offset:41984
    ds_read_b64_tr_b16 v[176:177], v81 offset:32768
    ds_read_b64_tr_b16 v[178:179], v81 offset:33792
    ds_read_b64_tr_b16 v[180:181], v81 offset:40960
    ds_read_b64_tr_b16 v[182:183], v81 offset:41984
L_lw_29:
    s_waitcnt lgkmcnt(0)
    s_waitcnt vmcnt(8)
    s_barrier
    s_add_u32 s79, s41, 12
    s_and_b32 s79, s79, 3
    s_lshl_b32 s79, s79, 19
    s_add_u32 s79, s79, s47
    s_add_u32 s46, s79, 0x600000
    s_add_u32 m0, s48, 32768
    s_nop 0
    buffer_load_dwordx4 v82, s[28:31], s46 offen  lds
    s_add_u32 s46, s79, 0x620000
    s_add_u32 m0, s48, 36864
    s_nop 0
    buffer_load_dwordx4 v82, s[28:31], s46 offen  lds
    s_add_u32 s46, s79, 0x640000
    s_add_u32 m0, s48, 40960
    s_nop 0
    buffer_load_dwordx4 v82, s[28:31], s46 offen  lds
    s_add_u32 s46, s79, 0x660000
    s_add_u32 m0, s48, 45056
    s_nop 0
    buffer_load_dwordx4 v82, s[28:31], s46 offen  lds
    s_cmp_lg_u32 s44, 0
    s_cbranch_scc1 L_lw_30_0
    ds_read_b64_tr_b16 a[248:249], v80 offset:49152
    ds_read_b64_tr_b16 a[250:251], v80 offset:50176
    ds_read_b64_tr_b16 a[252:253], v80 offset:57344
    ds_read_b64_tr_b16 a[254:255], v80 offset:58368
    ds_read_b64_tr_b16 v[96:97], v81 offset:49152
    ds_read_b64_tr_b16 v[98:99], v81 offset:50176
    ds_read_b64_tr_b16 v[100:101], v81 offset:57344
    ds_read_b64_tr_b16 v[102:103], v81 offset:58368
    s_branch L_lw_30
L_lw_30_0:
    s_cmp_lg_u32 s44, 1
    s_cbranch_scc1 L_lw_30_1
    ds_read_b64_tr_b16 a[136:137], v80 offset:49152
    ds_read_b64_tr_b16 a[138:139], v80 offset:50176
    ds_read_b64_tr_b16 a[140:141], v80 offset:57344
    ds_read_b64_tr_b16 a[142:143], v80 offset:58368
    ds_read_b64_tr_b16 a[144:145], v81 offset:49152
    ds_read_b64_tr_b16 a[146:147], v81 offset:50176
    ds_read_b64_tr_b16 a[148:149], v81 offset:57344
    ds_read_b64_tr_b16 a[150:151], v81 offset:58368
    s_branch L_lw_30
L_lw_30_1:
    s_cmp_lg_u32 s44, 2
    s_cbranch_scc1 L_lw_30_2
    ds_read_b64_tr_b16 a[48:49], v80 offset:49152
    ds_read_b64_tr_b16 a[50:51], v80 offset:50176
    ds_read_b64_tr_b16 a[52:53], v80 offset:57344
    ds_read_b64_tr_b16 a[54:55], v80 offset:58368
    ds_read_b64_tr_b16 a[56:57], v81 offset:49152
    ds_read_b64_tr_b16 a[58:59], v81 offset:50176
    ds_read_b64_tr_b16 a[60:61], v81 offset:57344
    ds_read_b64_tr_b16 a[62:63], v81 offset:58368
    s_branch L_lw_30
L_lw_30_2:
    ds_read_b64_tr_b16 v[200:201], v80 offset:49152
    ds_read_b64_tr_b16 v[202:203], v80 offset:50176
    ds_read_b64_tr_b16 v[204:205], v80 offset:57344
    ds_read_b64_tr_b16 v[206:207], v80 offset:58368
    ds_read_b64_tr_b16 v[56:57], v81 offset:49152
    ds_read_b64_tr_b16 v[58:59], v81 offset:50176
    ds_read_b64_tr_b16 v[60:61], v81 offset:57344
    ds_read_b64_tr_b16 v[62:63], v81 offset:58368
    s_waitcnt lgkmcnt(0)
    ds_write_b128 v5, v[56:59] offset:18432
    ds_write_b128 v5, v[60:63] offset:19456
L_lw_30:
    s_waitcnt lgkmcnt(0)
    s_waitcnt vmcnt(8)
    s_barrier
    s_add_u32 s79, s41, 13
    s_and_b32 s79, s79, 3
    s_lshl_b32 s79, s79, 19
    s_add_u32 s79, s79, s47
    s_add_u32 s46, s79, 0x600000
    s_add_u32 m0, s48, 49152
    s_nop 0
    buffer_load_dwordx4 v82, s[28:31], s46 offen  lds
    s_add_u32 s46, s79, 0x620000
    s_add_u32 m0, s48, 53248
    s_nop 0
    buffer_load_dwordx4 v82, s[28:31], s46 offen  lds
    s_add_u32 s46, s79, 0x640000
    s_add_u32 m0, s48, 57344
    s_nop 0
    buffer_load_dwordx4 v82, s[28:31], s46 offen  lds
    s_add_u32 s46, s79, 0x660000
    s_add_u32 m0, s48, 61440
    s_nop 0
    buffer_load_dwordx4 v82, s[28:31], s46 offen  lds
    s_cmp_lg_u32 s44, 0
    s_cbranch_scc1 L_lw_31_0
    ds_read_b64_tr_b16 v[112:113], v80 offset:0
    ds_read_b64_tr_b16 v[114:115], v80 offset:1024
    ds_read_b64_tr_b16 v[116:117], v80 offset:8192
    ds_read_b64_tr_b16 v[118:119], v80 offset:9216
    ds_read_b64_tr_b16 v[120:121], v81 offset:0
    ds_read_b64_tr_b16 v[122:123], v81 offset:1024
    ds_read_b64_tr_b16 v[124:125], v81 offset:8192
    ds_read_b64_tr_b16 v[126:127], v81 offset:9216
    s_branch L_lw_31
L_lw_31_0:
    s_cmp_lg_u32 s44, 1
    s_cbranch_scc1 L_lw_31_1
    ds_read_b64_tr_b16 a[160:161], v80 offset:0
    ds_read_b64_tr_b16 a[162:163], v80 offset:1024
    ds_read_b64_tr_b16 a[164:165], v80 offset:8192
    ds_read_b64_tr_b16 a[166:167], v80 offset:9216
    ds_read_b64_tr_b16 a[168:169], v81 offset:0
    ds_read_b64_tr_b16 a[170:171], v81 offset:1024
    ds_read_b64_tr_b16 a[172:173], v81 offset:8192
    ds_read_b64_tr_b16 a[174:175], v81 offset:9216
    s_branch L_lw_31
L_lw_31_1:
    s_cmp_lg_u32 s44, 2
    s_cbranch_scc1 L_lw_31_2
    ds_read_b64_tr_b16 a[72:73], v80 offset:0
    ds_read_b64_tr_b16 a[74:75], v80 offset:1024
    ds_read_b64_tr_b16 a[76:77], v80 offset:8192
    ds_read_b64_tr_b16 a[78:79], v80 offset:9216
    ds_read_b64_tr_b16 v[56:57], v81 offset:0
    ds_read_b64_tr_b16 v[58:59], v81 offset:1024
    ds_read_b64_tr_b16 v[60:61], v81 offset:8192
    ds_read_b64_tr_b16 v[62:63], v81 offset:9216
    s_waitcnt lgkmcnt(0)
    ds_write_b128 v5, v[56:59] offset:20480
    ds_write_b128 v5, v[60:63] offset:21504
    s_branch L_lw_31
L_lw_31_2:
    ds_read_b64_tr_b16 v[216:217], v80 offset:0
    ds_read_b64_tr_b16 v[218:219], v80 offset:1024
    ds_read_b64_tr_b16 v[220:221], v80 offset:8192
    ds_read_b64_tr_b16 v[222:223], v80 offset:9216
    ds_read_b64_tr_b16 v[224:225], v81 offset:0
    ds_read_b64_tr_b16 v[226:227], v81 offset:1024
    ds_read_b64_tr_b16 v[228:229], v81 offset:8192
    ds_read_b64_tr_b16 v[230:231], v81 offset:9216
L_lw_31:
    s_waitcnt lgkmcnt(0)
    s_waitcnt vmcnt(8)
    s_barrier
    s_add_u32 s79, s41, 14
    s_and_b32 s79, s79, 3
    s_lshl_b32 s79, s79, 19
    s_add_u32 s79, s79, s47
    s_add_u32 s46, s79, 0x600000
    s_add_u32 m0, s48, 0
    s_nop 0
    buffer_load_dwordx4 v82, s[28:31], s46 offen  lds
    s_add_u32 s46, s79, 0x620000
    s_add_u32 m0, s48, 4096
    s_nop 0
    buffer_load_dwordx4 v82, s[28:31], s46 offen  lds
    s_add_u32 s46, s79, 0x640000
    s_add_u32 m0, s48, 8192
    s_nop 0
    buffer_load_dwordx4 v82, s[28:31], s46 offen  lds
    s_add_u32 s46, s79, 0x660000
    s_add_u32 m0, s48, 12288
    s_nop 0
    buffer_load_dwordx4 v82, s[28:31], s46 offen  lds
    s_cmp_lg_u32 s44, 0
    s_cbranch_scc1 L_lw_32_0
    ds_read_b64_tr_b16 v[144:145], v80 offset:16384
    ds_read_b64_tr_b16 v[146:147], v80 offset:17408
    ds_read_b64_tr_b16 v[148:149], v80 offset:24576
    ds_read_b64_tr_b16 v[150:151], v80 offset:25600
    ds_read_b64_tr_b16 v[152:153], v81 offset:16384
    ds_read_b64_tr_b16 v[154:155], v81 offset:17408
    ds_read_b64_tr_b16 v[156:157], v81 offset:24576
    ds_read_b64_tr_b16 v[158:159], v81 offset:25600
    s_branch L_lw_32
L_lw_32_0:
    s_cmp_lg_u32 s44, 1
    s_cbranch_scc1 L_lw_32_1
    ds_read_b64_tr_b16 a[192:193], v80 offset:16384
    ds_read_b64_tr_b16 a[194:195], v80 offset:17408
    ds_read_b64_tr_b16 a[196:197], v80 offset:24576
    ds_read_b64_tr_b16 a[198:199], v80 offset:25600
    ds_read_b64_tr_b16 a[200:201], v81 offset:16384
    ds_read_b64_tr_b16 a[202:203], v81 offset:17408
    ds_read_b64_tr_b16 a[204:205], v81 offset:24576
    ds_read_b64_tr_b16 a[206:207], v81 offset:25600
    s_branch L_lw_32
L_lw_32_1:
    s_cmp_lg_u32 s44, 2
    s_cbranch_scc1 L_lw_32_2
    ds_read_b64_tr_b16 a[88:89], v80 offset:16384
    ds_read_b64_tr_b16 a[90:91], v80 offset:17408
    ds_read_b64_tr_b16 a[92:93], v80 offset:24576
    ds_read_b64_tr_b16 a[94:95], v80 offset:25600
    ds_read_b64_tr_b16 a[96:97], v81 offset:16384
    ds_read_b64_tr_b16 a[98:99], v81 offset:17408
    ds_read_b64_tr_b16 a[100:101], v81 offset:24576
    ds_read_b64_tr_b16 a[102:103], v81 offset:25600
    s_branch L_lw_32
L_lw_32_2:
    ds_read_b64_tr_b16 v[248:249], v80 offset:16384
    ds_read_b64_tr_b16 v[250:251], v80 offset:17408
    ds_read_b64_tr_b16 v[252:253], v80 offset:24576
    ds_read_b64_tr_b16 v[254:255], v80 offset:25600
    ds_read_b64_tr_b16 v[56:57], v81 offset:16384
    ds_read_b64_tr_b16 v[58:59], v81 offset:17408
    ds_read_b64_tr_b16 v[60:61], v81 offset:24576
    ds_read_b64_tr_b16 v[62:63], v81 offset:25600
    s_waitcnt lgkmcnt(0)
    ds_write_b128 v5, v[56:59] offset:22528
    ds_write_b128 v5, v[60:63] offset:23552
L_lw_32:
    s_waitcnt lgkmcnt(0)
    s_waitcnt vmcnt(8)
    s_barrier
    s_add_u32 s79, s41, 15
    s_and_b32 s79, s79, 3
    s_lshl_b32 s79, s79, 19
    s_add_u32 s79, s79, s47
    s_add_u32 s46, s79, 0x600000
    s_add_u32 m0, s48, 16384
    s_nop 0
    buffer_load_dwordx4 v82, s[28:31], s46 offen  lds
    s_add_u32 s46, s79, 0x620000
    s_add_u32 m0, s48, 20480
    s_nop 0
    buffer_load_dwordx4 v82, s[28:31], s46 offen  lds
    s_add_u32 s46, s79, 0x640000
    s_add_u32 m0, s48, 24576
    s_nop 0
    buffer_load_dwordx4 v82, s[28:31], s46 offen  lds
    s_add_u32 s46, s79, 0x660000
    s_add_u32 m0, s48, 28672
    s_nop 0
    buffer_load_dwordx4 v82, s[28:31], s46 offen  lds
    s_cmp_lg_u32 s44, 0
    s_cbranch_scc1 L_lw_33_0
    ds_read_b64_tr_b16 v[168:169], v80 offset:32768
    ds_read_b64_tr_b16 v[170:171], v80 offset:33792
    ds_read_b64_tr_b16 v[172:173], v80 offset:40960
    ds_read_b64_tr_b16 v[174:175], v80 offset:41984
    ds_read_b64_tr_b16 v[176:177], v81 offset:32768
    ds_read_b64_tr_b16 v[178:179], v81 offset:33792
    ds_read_b64_tr_b16 v[180:181], v81 offset:40960
    ds_read_b64_tr_b16 v[182:183], v81 offset:41984
    s_branch L_lw_33
L_lw_33_0:
    s_cmp_lg_u32 s44, 1
    s_cbranch_scc1 L_lw_33_1
    ds_read_b64_tr_b16 a[216:217], v80 offset:32768
    ds_read_b64_tr_b16 a[218:219], v80 offset:33792
    ds_read_b64_tr_b16 a[220:221], v80 offset:40960
    ds_read_b64_tr_b16 a[222:223], v80 offset:41984
    ds_read_b64_tr_b16 a[224:225], v81 offset:32768
    ds_read_b64_tr_b16 a[226:227], v81 offset:33792
    ds_read_b64_tr_b16 a[228:229], v81 offset:40960
    ds_read_b64_tr_b16 a[230:231], v81 offset:41984
    s_branch L_lw_33
L_lw_33_1:
    s_cmp_lg_u32 s44, 2
    s_cbranch_scc1 L_lw_33_2
    ds_read_b64_tr_b16 a[112:113], v80 offset:32768
    ds_read_b64_tr_b16 a[114:115], v80 offset:33792
    ds_read_b64_tr_b16 a[116:117], v80 offset:40960
    ds_read_b64_tr_b16 a[118:119], v80 offset:41984
    ds_read_b64_tr_b16 a[120:121], v81 offset:32768
    ds_read_b64_tr_b16 a[122:123], v81 offset:33792
    ds_read_b64_tr_b16 a[124:125], v81 offset:40960
    ds_read_b64_tr_b16 a[126:127], v81 offset:41984
    s_branch L_lw_33
L_lw_33_2:
    ds_read_b64_tr_b16 a[16:17], v80 offset:32768
    ds_read_b64_tr_b16 a[18:19], v80 offset:33792
    ds_read_b64_tr_b16 a[20:21], v80 offset:40960
    ds_read_b64_tr_b16 a[22:23], v80 offset:41984
    ds_read_b64_tr_b16 a[24:25], v81 offset:32768
    ds_read_b64_tr_b16 a[26:27], v81 offset:33792
    ds_read_b64_tr_b16 a[28:29], v81 offset:40960
    ds_read_b64_tr_b16 a[30:31], v81 offset:41984
L_lw_33:
    s_waitcnt lgkmcnt(0)
    s_waitcnt vmcnt(8)
    s_barrier
    s_cmp_lg_u32 s44, 0
    s_cbranch_scc1 L_lw_34_0
    ds_read_b64_tr_b16 v[200:201], v80 offset:49152
    ds_read_b64_tr_b16 v[202:203], v80 offset:50176
    ds_read_b64_tr_b16 v[204:205], v80 offset:57344
    ds_read_b64_tr_b16 v[206:207], v80 offset:58368
    ds_read_b64_tr_b16 v[56:57], v81 offset:49152
    ds_read_b64_tr_b16 v[58:59], v81 offset:50176
    ds_read_b64_tr_b16 v[60:61], v81 offset:57344
    ds_read_b64_tr_b16 v[62:63], v81 offset:58368
    s_waitcnt lgkmcnt(0)
    ds_write_b128 v5, v[56:59] offset:18432
    ds_write_b128 v5, v[60:63] offset:19456
    s_branch L_lw_34
L_lw_34_0:
    s_cmp_lg_u32 s44, 1
    s_cbranch_scc1 L_lw_34_1
    ds_read_b64_tr_b16 a[248:249], v80 offset:49152
    ds_read_b64_tr_b16 a[250:251], v80 offset:50176
    ds_read_b64_tr_b16 a[252:253], v80 offset:57344
    ds_read_b64_tr_b16 a[254:255], v80 offset:58368
    ds_read_b64_tr_b16 v[96:97], v81 offset:49152
    ds_read_b64_tr_b16 v[98:99], v81 offset:50176
    ds_read_b64_tr_b16 v[100:101], v81 offset:57344
    ds_read_b64_tr_b16 v[102:103], v81 offset:58368
    s_branch L_lw_34
L_lw_34_1:
    s_cmp_lg_u32 s44, 2
    s_cbranch_scc1 L_lw_34_2
    ds_read_b64_tr_b16 a[136:137], v80 offset:49152
    ds_read_b64_tr_b16 a[138:139], v80 offset:50176
    ds_read_b64_tr_b16 a[140:141], v80 offset:57344
    ds_read_b64_tr_b16 a[142:143], v80 offset:58368
    ds_read_b64_tr_b16 a[144:145], v81 offset:49152
    ds_read_b64_tr_b16 a[146:147], v81 offset:50176
    ds_read_b64_tr_b16 a[148:149], v81 offset:57344
    ds_read_b64_tr_b16 a[150:151], v81 offset:58368
    s_branch L_lw_34
L_lw_34_2:
    ds_read_b64_tr_b16 a[48:49], v80 offset:49152
    ds_read_b64_tr_b16 a[50:51], v80 offset:50176
    ds_read_b64_tr_b16 a[52:53], v80 offset:57344
    ds_read_b64_tr_b16 a[54:55], v80 offset:58368
    ds_read_b64_tr_b16 a[56:57], v81 offset:49152
    ds_read_b64_tr_b16 a[58:59], v81 offset:50176
    ds_read_b64_tr_b16 a[60:61], v81 offset:57344
    ds_read_b64_tr_b16 a[62:63], v81 offset:58368
L_lw_34:
    s_waitcnt lgkmcnt(0)
    s_waitcnt vmcnt(4)
    s_barrier
    s_cmp_lg_u32 s44, 0
    s_cbranch_scc1 L_lw_35_0
    ds_read_b64_tr_b16 v[216:217], v80 offset:0
    ds_read_b64_tr_b16 v[218:219], v80 offset:1024
    ds_read_b64_tr_b16 v[220:221], v80 offset:8192
    ds_read_b64_tr_b16 v[222:223], v80 offset:9216
    ds_read_b64_tr_b16 v[224:225], v81 offset:0
    ds_read_b64_tr_b16 v[226:227], v81 offset:1024
    ds_read_b64_tr_b16 v[228:229], v81 offset:8192
    ds_read_b64_tr_b16 v[230:231], v81 offset:9216
    s_branch L_lw_35
L_lw_35_0:
    s_cmp_lg_u32 s44, 1
    s_cbranch_scc1 L_lw_35_1
    ds_read_b64_tr_b16 v[112:113], v80 offset:0
    ds_read_b64_tr_b16 v[114:115], v80 offset:1024
    ds_read_b64_tr_b16 v[116:117], v80 offset:8192
    ds_read_b64_tr_b16 v[118:119], v80 offset:9216
    ds_read_b64_tr_b16 v[120:121], v81 offset:0
    ds_read_b64_tr_b16 v[122:123], v81 offset:1024
    ds_read_b64_tr_b16 v[124:125], v81 offset:8192
    ds_read_b64_tr_b16 v[126:127], v81 offset:9216
    s_branch L_lw_35
L_lw_35_1:
    s_cmp_lg_u32 s44, 2
    s_cbranch_scc1 L_lw_35_2
    ds_read_b64_tr_b16 a[160:161], v80 offset:0
    ds_read_b64_tr_b16 a[162:163], v80 offset:1024
    ds_read_b64_tr_b16 a[164:165], v80 offset:8192
    ds_read_b64_tr_b16 a[166:167], v80 offset:9216
    ds_read_b64_tr_b16 a[168:169], v81 offset:0
    ds_read_b64_tr_b16 a[170:171], v81 offset:1024
    ds_read_b64_tr_b16 a[172:173], v81 offset:8192
    ds_read_b64_tr_b16 a[174:175], v81 offset:9216
    s_branch L_lw_35
L_lw_35_2:
    ds_read_b64_tr_b16 a[72:73], v80 offset:0
    ds_read_b64_tr_b16 a[74:75], v80 offset:1024
    ds_read_b64_tr_b16 a[76:77], v80 offset:8192
    ds_read_b64_tr_b16 a[78:79], v80 offset:9216
    ds_read_b64_tr_b16 v[56:57], v81 offset:0
    ds_read_b64_tr_b16 v[58:59], v81 offset:1024
    ds_read_b64_tr_b16 v[60:61], v81 offset:8192
    ds_read_b64_tr_b16 v[62:63], v81 offset:9216
    s_waitcnt lgkmcnt(0)
    ds_write_b128 v5, v[56:59] offset:20480
    ds_write_b128 v5, v[60:63] offset:21504
L_lw_35:
    s_waitcnt lgkmcnt(0)
    s_waitcnt vmcnt(0)
    s_barrier
    s_cmp_lg_u32 s44, 0
    s_cbranch_scc1 L_lw_36_0
    ds_read_b64_tr_b16 v[248:249], v80 offset:16384
    ds_read_b64_tr_b16 v[250:251], v80 offset:17408
    ds_read_b64_tr_b16 v[252:253], v80 offset:24576
    ds_read_b64_tr_b16 v[254:255], v80 offset:25600
    ds_read_b64_tr_b16 v[56:57], v81 offset:16384
    ds_read_b64_tr_b16 v[58:59], v81 offset:17408
    ds_read_b64_tr_b16 v[60:61], v81 offset:24576
    ds_read_b64_tr_b16 v[62:63], v81 offset:25600
    s_waitcnt lgkmcnt(0)
    ds_write_b128 v5, v[56:59] offset:22528
    ds_write_b128 v5, v[60:63] offset:23552
    s_branch L_lw_36
L_lw_36_0:
    s_cmp_lg_u32 s44, 1
    s_cbranch_scc1 L_lw_36_1
    ds_read_b64_tr_b16 v[144:145], v80 offset:16384
    ds_read_b64_tr_b16 v[146:147], v80 offset:17408
    ds_read_b64_tr_b16 v[148:149], v80 offset:24576
    ds_read_b64_tr_b16 v[150:151], v80 offset:25600
    ds_read_b64_tr_b16 v[152:153], v81 offset:16384
    ds_read_b64_tr_b16 v[154:155], v81 offset:17408
    ds_read_b64_tr_b16 v[156:157], v81 offset:24576
    ds_read_b64_tr_b16 v[158:159], v81 offset:25600
    s_branch L_lw_36
L_lw_36_1:
    s_cmp_lg_u32 s44, 2
    s_cbranch_scc1 L_lw_36_2
    ds_read_b64_tr_b16 a[192:193], v80 offset:16384
    ds_read_b64_tr_b16 a[194:195], v80 offset:17408
    ds_read_b64_tr_b16 a[196:197], v80 offset:24576
    ds_read_b64_tr_b16 a[198:199], v80 offset:25600
    ds_read_b64_tr_b16 a[200:201], v81 offset:16384
    ds_read_b64_tr_b16 a[202:203], v81 offset:17408
    ds_read_b64_tr_b16 a[204:205], v81 offset:24576
    ds_read_b64_tr_b16 a[206:207], v81 offset:25600
    s_branch L_lw_36
L_lw_36_2:
    ds_read_b64_tr_b16 a[88:89], v80 offset:16384
    ds_read_b64_tr_b16 a[90:91], v80 offset:17408
    ds_read_b64_tr_b16 a[92:93], v80 offset:24576
    ds_read_b64_tr_b16 a[94:95], v80 offset:25600
    ds_read_b64_tr_b16 a[96:97], v81 offset:16384
    ds_read_b64_tr_b16 a[98:99], v81 offset:17408
    ds_read_b64_tr_b16 a[100:101], v81 offset:24576
    ds_read_b64_tr_b16 a[102:103], v81 offset:25600
L_lw_36:
    s_waitcnt lgkmcnt(0)
    s_barrier
    v_and_b32 v63, 15, v1
    v_lshrrev_b32 v64, 4, v1
    v_lshrrev_b32 v65, 5, v1
    v_lshlrev_b32 v65, 4, v65
    v_add_u32 v65, v65, v63
    v_lshlrev_b32 v65, 4, v65
    v_and_b32 v66, 1, v64
    v_lshlrev_b32 v66, 3, v66
    s_lshl_b32 s45, s44, 9
    s_add_u32 s45, s45, 53248
    v_add3_u32 v6, v65, v66, s45
    v_bfe_u32 v65, v1, 2, 2
    v_lshlrev_b32 v66, 3, v64
    v_add_u32 v65, v65, v66
    v_lshlrev_b32 v65, 4, v65
    v_and_b32 v66, 1, v1
    v_lshlrev_b32 v66, 3, v66
    v_add_u32 v65, v65, v66
    v_add_u32 v7, 53248, v65
    v_bfe_u32 v65, v1, 2, 1
    v_lshlrev_b32 v65, 4, v65
    v_bfe_u32 v66, v1, 3, 1
    v_lshlrev_b32 v66, 2, v66
    v_and_b32 v67, 3, v1
    v_add3_u32 v65, v65, v66, v67
    v_lshlrev_b32 v65, 5, v65
    v_lshlrev_b32 v66, 3, v64
    s_lshl_b32 s45, s44, 10
    s_add_u32 s45, s45, 55296
    v_add3_u32 v18, v65, v66, s45
    v_lshlrev_b32 v16, 3, v1
    v_lshlrev_b32 v8, 4, v1
    v_mov_b32 v14, v8
    v_lshrrev_b32 v65, 2, v1
    v_lshlrev_b32 v65, 4, v65
    v_and_b32 v66, 1, v1
    v_lshlrev_b32 v66, 3, v66
    s_lshl_b32 s45, s44, 11
    v_add3_u32 v65, v65, v66, s45
    v_and_b32 v66, 2, v1
    v_lshlrev_b32 v66, 7, v66
    v_add_u32 v9, v65, v66
    s_lshl_b32 s45, s43, 11
    s_lshl_b32 s46, s44, 9
    s_add_u32 s45, s45, s46
    s_add_u32 s51, s45, 0x7020000
    s_lshl_b32 s63, s43, 19
    s_add_u32 s63, s63, 0x3000000
    s_mov_b32 s50, 0
    s_lshl_b32 s64, s44, 11
    s_add_u32 s63, s63, s64
    s_add_u32 s64, s64, 16384
    s_add_u32 s65, s64, 8192
    s_lshl_b32 s66, s43, 12
    s_add_u32 s66, s66, 0x1000000
    s_mov_b32 s69, 16384
    s_mov_b32 s52, 0x3e0293ee
    v_and_b32 v19, 3, v1
    v_lshlrev_b32 v19, 10, v19
    s_lshl_b32 s45, s44, 12
    s_add_u32 s45, s45, 1020
    v_add_u32 v19, s45, v19
    v_mov_b32 v29, 128
    s_mov_b32 s46, 96
    s_mov_b64 exec, 1
    s_mov_b32 s70, 0
L_wp_37:
    buffer_load_dword v31, v29, s[16:19], 0 offen sc1
    s_add_u32 s70, s70, 1
    s_cmp_ge_u32 s70, 0x200000
    s_cbranch_scc1 L_c_done_1
    s_waitcnt vmcnt(0)
    v_cmp_gt_u32 vcc, s46, v31
    s_nop 1
    s_cbranch_vccz L_wp_37_ok
    s_sleep 2
    s_branch L_wp_37
L_wp_37_ok:
    s_mov_b64 exec, -1
    s_mov_b32 s47, 0
    s_cmp_lt_u32 s47, s50
    s_cbranch_scc1 L_kv_rdy_38
    s_lshl_b32 s45, s43, 7
    s_add_u32 s45, s45, 0x10014
    v_mov_b32 v0, 0
    s_mov_b32 s70, 0
L_kv_rdy_38_p:
    buffer_load_dwordx2 v[10:11], v0, s[12:15], s45 offen sc1
    s_add_u32 s70, s70, 1
    s_cmp_ge_u32 s70, 0x200000
    s_cbranch_scc1 L_c_done_1
    s_waitcnt vmcnt(0)
    v_min_u32 v10, v10, v11
    s_nop 0
    v_readfirstlane_b32 s50, v10
    s_nop 3
    s_cmp_lt_u32 s47, s50
    s_cbranch_scc1 L_kv_rdy_38
    s_sleep 2
    s_branch L_kv_rdy_38_p
L_kv_rdy_38:
    s_mov_b32 m0, s64
    s_add_u32 s46, s63, 0x1000000
    buffer_load_dwordx4 v14, s[12:15], s63 offen sc1 lds
    buffer_load_dwordx4 v14, s[12:15], s63 offen offset:1024 sc1 lds
    s_mov_b32 m0, s65
    s_add_u32 s63, s63, 8192
    buffer_load_dwordx4 v14, s[12:15], s46 offen sc1 lds
    buffer_load_dwordx4 v14, s[12:15], s46 offen offset:1024 sc1 lds
    s_add_u32 s64, s64, 16384
    s_add_u32 s65, s65, 16384
    s_mov_b32 s70, 0
    v_mov_b32 v41, 0
L_hw_39:
    buffer_load_dwordx2 v[44:45], v41, s[16:19], 0 offen sc1
    s_add_u32 s70, s70, 1
    s_cmp_ge_u32 s70, 0x100000
    s_cbranch_scc1 L_c_done_1
    s_waitcnt vmcnt(0)
    v_readfirstlane_b32 s45, v44
    v_readfirstlane_b32 s46, v45
    s_nop 3
    s_lshr_b32 s47, s46, 24
    s_cmp_lg_u32 s47, 64
    s_cbranch_scc1 L_hw_39
    s_lshr_b32 s68, s45, 24
    s_and_b32 s47, s45, 511
    s_mul_i32 s47, s47, s47
    s_bfe_u32 s45, s45, 0xf0009
    s_lshl_b32 s45, s45, 5
    s_sub_u32 s45, s45, s47
    s_and_b32 s47, s46, 511
    s_mul_i32 s47, s47, s47
    s_bfe_u32 s46, s46, 0xf0009
    s_lshl_b32 s46, s46, 5
    s_sub_u32 s46, s46, s47
    s_or_b32 s45, s45, s46
    s_cmp_eq_u32 s45, 0
    s_cselect_b32 s67, 1, 0
    s_mov_b32 s24, s12
    s_mov_b32 s25, s13
    s_mov_b32 s28, s12
    s_mov_b32 s29, s13
    s_cmp_eq_u32 s67, 1
    s_cselect_b32 s26, s14, 0
    s_cselect_b32 s30, 0, s14
    s_cmp_ge_u32 s68, 16
    s_cselect_b32 s68, 8192, 0
    s_mov_b32 s6, 0x0
    s_mov_b32 s7, 0xfea00000
    s_mov_b32 s60, 0
    s_lshl_b32 s58, s40, 16
    s_add_u32 s58, s58, 0x7000000
    s_mov_b32 s61, s58
    s_lshl_b32 s59, s40, 17
    s_add_u32 s59, s59, 0x7040000
    s_mov_b32 s62, s59
    s_add_u32 s32, s41, 0
    s_and_b32 s32, s32, 3
    s_lshl_b32 s32, s32, 10
    s_add_u32 s33, s41, 1
    s_and_b32 s33, s33, 3
    s_lshl_b32 s33, s33, 10
    s_add_u32 s34, s41, 2
    s_and_b32 s34, s34, 3
    s_lshl_b32 s34, s34, 10
    s_add_u32 s35, s41, 3
    s_and_b32 s35, s35, 3
    s_lshl_b32 s35, s35, 10
L_q_loop_40:
    ds_read_b128 v[56:59], v5 offset:8192
    ds_read_b128 v[60:63], v5 offset:9216
    ds_read_b128 v[64:67], v5 offset:20480
    ds_read_b128 v[68:71], v5 offset:21504
    ds_read_b128 v[72:75], v5 offset:16384
    ds_read_b128 v[76:79], v5 offset:17408
    ds_read_b128 v[80:83], v5 offset:4096
    ds_read_b128 v[84:87], v5 offset:5120
    ds_read_b128 v[88:91], v5 offset:6144
    ds_read_b128 v[92:95], v5 offset:7168
    s_add_u32 s46, s60, 1
    v_mov_b32 v15, s46
    v_mov_b32 v0, -1
    s_add_u32 s8, s61, s32
    s_add_u32 s9, s61, s33
    s_add_u32 s10, s61, s34
    s_add_u32 s11, s61, s35
    s_cmp_eq_u32 s60, 0
    s_cbranch_scc1 L_q_first_41
    s_sleep 16
    s_mov_b64 exec, 15
    buffer_load_dword v10, v19, s[12:15], s61 offen sc1
    s_nop 15
    buffer_load_dword v11, v19, s[12:15], s61 offen sc1
    s_nop 15
    buffer_load_dword v12, v19, s[12:15], s61 offen sc1
    s_nop 15
    buffer_load_dword v13, v19, s[12:15], s61 offen sc1
    s_mov_b32 s70, 0
L_pp_42:
    s_waitcnt vmcnt(3)
    v_cmp_eq_u32 vcc, -1, v10
    s_add_u32 s70, s70, 1
    s_nop 0
    s_cbranch_vccz L_ppd_43
    buffer_load_dword v10, v19, s[12:15], s61 offen sc1
    s_waitcnt vmcnt(3)
    v_cmp_eq_u32 vcc, -1, v11
    s_add_u32 s70, s70, 1
    s_nop 0
    s_cbranch_vccz L_ppd_43
    buffer_load_dword v11, v19, s[12:15], s61 offen sc1
    s_waitcnt vmcnt(3)
    v_cmp_eq_u32 vcc, -1, v12
    s_add_u32 s70, s70, 1
    s_nop 0
    s_cbranch_vccz L_ppd_43
    buffer_load_dword v12, v19, s[12:15], s61 offen sc1
    s_waitcnt vmcnt(3)
    v_cmp_eq_u32 vcc, -1, v13
    s_add_u32 s70, s70, 1
    s_nop 0
    s_cbranch_vccz L_ppd_43
    buffer_load_dword v13, v19, s[12:15], s61 offen sc1
    s_cmp_lt_u32 s70, 0x400000
    s_cbranch_scc1 L_pp_42
    s_branch L_c_done_1
L_ppd_43:
    s_mov_b64 exec, -1
L_q_first_41:
    s_waitcnt lgkmcnt(0)
    buffer_load_dwordx4 v[40:43], v3, s[12:15], s8 offen sc1
    v_mov_b32 v24, 0
    v_mov_b32 v25, 0
    v_mov_b32 v26, 0
    v_mov_b32 v27, 0
    v_mov_b32 v28, 0
    buffer_load_dwordx4 v[44:47], v3, s[12:15], s9 offen sc1
    v_mov_b32 v29, 0
    v_mov_b32 v30, 0
    v_mov_b32 v31, 0
    v_mov_b32 v32, 0
    v_mov_b32 v33, 0
    buffer_load_dwordx4 v[48:51], v3, s[12:15], s10 offen sc1
    v_mov_b32 v34, 0
    v_mov_b32 v35, 0
    v_mov_b32 v36, 0
    v_mov_b32 v37, 0
    v_mov_b32 v38, 0
    buffer_load_dwordx4 v[52:55], v3, s[12:15], s11 offen sc1
    s_mov_b32 s70, 0
    v_mov_b32 v39, 0
    s_waitcnt vmcnt(3)
    v_max3_u32 v22, v40, v41, v42
    ds_write_b128 v3, v[40:43] offset:0
    v_max_u32 v22, v22, v43
    v_cmp_eq_u32 vcc, -1, v22
    s_nop 0
    s_nop 0
    s_cbranch_vccnz L_mg_44_r0
L_mg_44_c0:
    v_smfmac_f32_16x16x64_bf16 v[24:27], v[40:43], a[0:7], v2
    s_waitcnt vmcnt(2)
    v_max3_u32 v22, v44, v45, v46
    v_smfmac_f32_16x16x64_bf16 v[28:31], v[40:43], a[8:15], v2
    ds_write_b128 v3, v[44:47] offset:1024
    v_max_u32 v22, v22, v47
    v_smfmac_f32_16x16x64_bf16 v[32:35], v[40:43], a[16:23], v2
    v_cmp_eq_u32 vcc, -1, v22
    v_smfmac_f32_16x16x64_bf16 v[36:39], v[40:43], a[24:31], v2
    s_nop 0
    s_cbranch_vccnz L_mg_44_r1
L_mg_44_c1:
    v_smfmac_f32_16x16x64_bf16 v[24:27], v[44:47], a[32:39], v2
    s_waitcnt vmcnt(1)
    v_max3_u32 v22, v48, v49, v50
    v_smfmac_f32_16x16x64_bf16 v[28:31], v[44:47], a[40:47], v2
    ds_write_b128 v3, v[48:51] offset:2048
    v_max_u32 v22, v22, v51
    v_smfmac_f32_16x16x64_bf16 v[32:35], v[44:47], a[48:55], v2
    v_cmp_eq_u32 vcc, -1, v22
    v_smfmac_f32_16x16x64_bf16 v[36:39], v[44:47], a[56:63], v2
    s_nop 0
    s_cbranch_vccnz L_mg_44_r2
L_mg_44_c2:
    s_waitcnt vmcnt(0)
    v_max3_u32 v22, v52, v53, v54
    ds_write_b128 v3, v[52:55] offset:3072
    v_max_u32 v22, v22, v55
    v_cmp_eq_u32 vcc, -1, v22
    s_waitcnt lgkmcnt(0)
    s_nop 0
    s_cbranch_vccnz L_mg_44_r3
L_mg_44_c3:
    s_barrier
    ds_read_b128 v[40:43], v4 offset:0
    ds_read_b128 v[44:47], v4 offset:1024
    v_smfmac_f32_16x16x64_bf16 v[24:27], v[48:51], a[64:71], v2
    v_smfmac_f32_16x16x64_bf16 v[28:31], v[48:51], v[56:63], v2
    ds_read_b128 v[56:59], v5 offset:14336
    v_smfmac_f32_16x16x64_bf16 v[32:35], v[48:51], a[72:79], v2
    ds_read_b128 v[60:63], v5 offset:15360
    v_smfmac_f32_16x16x64_bf16 v[36:39], v[48:51], v[64:71], v2
    ds_read_b128 v[48:51], v4 offset:2048
    v_smfmac_f32_16x16x64_bf16 v[24:27], v[52:55], a[80:87], v2
    ds_read_b128 v[64:67], v5 offset:2048
    v_smfmac_f32_16x16x64_bf16 v[28:31], v[52:55], v[72:79], v2
    ds_read_b128 v[68:71], v5 offset:3072
    v_smfmac_f32_16x16x64_bf16 v[32:35], v[52:55], a[88:95], v2
    ds_read_b128 v[72:75], v5 offset:12288
    v_smfmac_f32_16x16x64_bf16 v[36:39], v[52:55], a[96:103], v2
    ds_read_b128 v[52:55], v4 offset:3072
    s_waitcnt lgkmcnt(4)
    v_smfmac_f32_16x16x64_bf16 v[24:27], v[40:43], a[104:111], v2
    ds_read_b128 v[76:79], v5 offset:13312
    v_smfmac_f32_16x16x64_bf16 v[28:31], v[40:43], v[80:87], v2
    ds_read_b128 v[80:83], v5 offset:0
    v_smfmac_f32_16x16x64_bf16 v[32:35], v[40:43], a[112:119], v2
    ds_read_b128 v[84:87], v5 offset:1024
    v_smfmac_f32_16x16x64_bf16 v[36:39], v[40:43], a[120:127], v2
    ds_read_b128 v[40:43], v21 offset:0
    v_smfmac_f32_16x16x64_bf16 v[24:27], v[44:47], a[128:135], v2
    v_smfmac_f32_16x16x64_bf16 v[28:31], v[44:47], v[88:95], v2
    ds_read_b128 v[88:91], v5 offset:10240
    v_smfmac_f32_16x16x64_bf16 v[32:35], v[44:47], a[136:143], v2
    ds_read_b128 v[92:95], v5 offset:11264
    v_smfmac_f32_16x16x64_bf16 v[36:39], v[44:47], a[144:151], v2
    ds_read_b128 v[44:47], v21 offset:1024
    v_smfmac_f32_16x16x64_bf16 v[24:27], v[48:51], a[152:159], v2
    v_smfmac_f32_16x16x64_bf16 v[28:31], v[48:51], v[56:63], v2
    ds_read_b128 v[48:51], v21 offset:2048
    s_waitcnt lgkmcnt(3)
    v_smfmac_f32_16x16x64_bf16 v[24:27], v[52:55], a[176:183], v2
    ds_read_b128 v[56:59], v5 offset:22528
    v_smfmac_f32_16x16x64_bf16 v[28:31], v[52:55], a[184:191], v2
    ds_read_b128 v[52:55], v21 offset:3072
    v_smfmac_f32_16x16x64_bf16 v[24:27], v[40:43], a[208:215], v2
    ds_read_b128 v[60:63], v5 offset:23552
    v_smfmac_f32_16x16x64_bf16 v[28:31], v[40:43], v[64:71], v2
    ds_read_b128 v[40:43], v23 offset:0
    s_waitcnt lgkmcnt(4)
    v_smfmac_f32_16x16x64_bf16 v[24:27], v[44:47], a[232:239], v2
    ds_read_b128 v[64:67], v5 offset:18432
    v_smfmac_f32_16x16x64_bf16 v[28:31], v[44:47], a[240:247], v2
    ds_read_b128 v[44:47], v23 offset:1024
    v_smfmac_f32_16x16x64_bf16 v[24:27], v[48:51], v[104:111], v2
    ds_read_b128 v[68:71], v5 offset:19456
    v_smfmac_f32_16x16x64_bf16 v[28:31], v[48:51], v[72:79], v2
    ds_read_b128 v[48:51], v23 offset:2048
    s_waitcnt lgkmcnt(4)
    v_smfmac_f32_16x16x64_bf16 v[24:27], v[52:55], v[128:135], v2
    v_smfmac_f32_16x16x64_bf16 v[28:31], v[52:55], v[136:143], v2
    ds_read_b128 v[52:55], v23 offset:3072
    v_smfmac_f32_16x16x64_bf16 v[24:27], v[40:43], v[160:167], v2
    v_smfmac_f32_16x16x64_bf16 v[28:31], v[40:43], v[80:87], v2
    s_waitcnt lgkmcnt(1)
    v_smfmac_f32_16x16x64_bf16 v[24:27], v[44:47], v[184:191], v2
    v_smfmac_f32_16x16x64_bf16 v[28:31], v[44:47], v[192:199], v2
    v_smfmac_f32_16x16x64_bf16 v[24:27], v[48:51], v[208:215], v2
    v_smfmac_f32_16x16x64_bf16 v[28:31], v[48:51], v[88:95], v2
    s_waitcnt lgkmcnt(0)
    v_smfmac_f32_16x16x64_bf16 v[24:27], v[52:55], v[232:239], v2
    v_smfmac_f32_16x16x64_bf16 v[28:31], v[52:55], v[240:247], v2
    v_smfmac_f32_16x16x64_bf16 v[32:35], v[52:55], v[248:255], v2
    ds_read_b128 v[72:75], v8 offset:20480
    v_smfmac_f32_16x16x64_bf16 v[36:39], v[52:55], v[56:63], v2
    ds_read_b128 v[52:55], v21 offset:3072
    v_smfmac_f32_16x16x64_bf16 v[32:35], v[48:51], v[216:223], v2
    ds_read_b128 v[76:79], v8 offset:21504
    s_nop 1
    v_permlane32_swap_b32 v24, v28
    v_smfmac_f32_16x16x64_bf16 v[36:39], v[48:51], v[224:231], v2
    ds_read_b128 v[48:51], v21 offset:2048
    v_permlane32_swap_b32 v25, v29
    v_smfmac_f32_16x16x64_bf16 v[32:35], v[44:47], v[200:207], v2
    v_permlane32_swap_b32 v26, v30
    v_permlane32_swap_b32 v27, v31
    v_smfmac_f32_16x16x64_bf16 v[36:39], v[44:47], v[64:71], v2
    ds_read_b128 v[44:47], v21 offset:1024
    v_add_f32 v24, v24, v28
    v_smfmac_f32_16x16x64_bf16 v[32:35], v[40:43], v[168:175], v2
    v_add_f32 v25, v25, v29
    v_add_f32 v26, v26, v30
    v_smfmac_f32_16x16x64_bf16 v[36:39], v[40:43], v[176:183], v2
    ds_read_b128 v[40:43], v21 offset:0
    v_add_f32 v27, v27, v31
    s_waitcnt lgkmcnt(2)
    v_smfmac_f32_16x16x64_bf16 v[32:35], v[52:55], v[144:151], v2
    v_cvt_pk_bf16_f32 v24, v24, v25
    v_cvt_pk_bf16_f32 v25, v26, v27
    v_smfmac_f32_16x16x64_bf16 v[36:39], v[52:55], v[152:159], v2
    ds_read_b128 v[52:55], v4 offset:3072
    ds_write_b64 v6, v[24:25]
    v_smfmac_f32_16x16x64_bf16 v[32:35], v[48:51], v[112:119], v2
    ds_read_b128 v[56:59], v8 offset:16384
    ds_read_b128 v[60:63], v8 offset:17408
    v_smfmac_f32_16x16x64_bf16 v[36:39], v[48:51], v[120:127], v2
    ds_read_b128 v[48:51], v4 offset:2048
    s_waitcnt lgkmcnt(5)
    v_smfmac_f32_16x16x64_bf16 v[32:35], v[44:47], a[248:255], v2
    ds_read_b128 v[64:67], v8 offset:18432
    ds_read_b128 v[68:71], v8 offset:19456
    v_smfmac_f32_16x16x64_bf16 v[36:39], v[44:47], v[96:103], v2
    s_waitcnt lgkmcnt(5)
    s_barrier
    ds_read_b64_tr_b16 v[80:81], v7 offset:0
    v_smfmac_f32_16x16x64_bf16 v[32:35], v[40:43], a[216:223], v2
    ds_read_b64_tr_b16 v[82:83], v7 offset:64
    ds_read_b64_tr_b16 v[84:85], v7 offset:512
    v_smfmac_f32_16x16x64_bf16 v[36:39], v[40:43], a[224:231], v2
    ds_read_b64_tr_b16 v[86:87], v7 offset:576
    ds_read_b64_tr_b16 v[88:89], v7 offset:1024
    v_smfmac_f32_16x16x64_bf16 v[32:35], v[52:55], a[192:199], v2
    ds_read_b64_tr_b16 v[90:91], v7 offset:1088
    v_smfmac_f32_16x16x64_bf16 v[36:39], v[52:55], a[200:207], v2
    ds_read_b64_tr_b16 v[92:93], v7 offset:1536
    s_waitcnt lgkmcnt(6)
    v_smfmac_f32_16x16x64_bf16 v[32:35], v[48:51], a[160:167], v2
    ds_read_b64_tr_b16 v[94:95], v7 offset:1600
    v_smfmac_f32_16x16x64_bf16 v[36:39], v[48:51], a[168:175], v2
    s_waitcnt lgkmcnt(3)
    v_mfma_f32_16x16x32_bf16 v[24:27], v[56:59], v[80:83], 0
    ds_read_b128 v[56:59], v8 offset:22528
    v_mfma_f32_16x16x32_bf16 v[28:31], v[60:63], v[80:83], 0
    ds_read_b128 v[60:63], v8 offset:23552
    v_mfma_f32_16x16x32_bf16 v[24:27], v[64:67], v[84:87], v[24:27]
    s_nop 1
    v_cvt_pk_bf16_f32 v32, v32, v33
    v_cvt_pk_bf16_f32 v33, v34, v35
    v_cvt_pk_bf16_f32 v34, v36, v37
    v_cvt_pk_bf16_f32 v35, v38, v39
    ds_write2_b64 v18, v[32:33], v[34:35] offset1:32
    v_mfma_f32_16x16x32_bf16 v[28:31], v[68:71], v[84:87], v[28:31]
    s_waitcnt lgkmcnt(3)
    v_mfma_f32_16x16x32_bf16 v[24:27], v[72:75], v[88:91], v[24:27]
    ds_read_b64_tr_b16 v[64:65], v9 offset:24576
    v_mfma_f32_16x16x32_bf16 v[28:31], v[76:79], v[88:91], v[28:31]
    ds_read_b64_tr_b16 v[66:67], v9 offset:25600
    s_waitcnt lgkmcnt(3)
    v_mfma_f32_16x16x32_bf16 v[24:27], v[56:59], v[92:95], v[24:27]
    ds_read_b64_tr_b16 v[68:69], v9 offset:25088
    v_mfma_f32_16x16x32_bf16 v[28:31], v[60:63], v[92:95], v[28:31]
    ds_read_b64_tr_b16 v[70:71], v9 offset:26112
    v_mov_b32 v57, 0
    v_mov_b32 v58, 0
    s_waitcnt lgkmcnt(4)
    s_barrier
    ds_read_b64_tr_b16 v[40:41], v16 offset:55296
    ds_read_b64_tr_b16 v[42:43], v16 offset:55808
    ds_read_b64_tr_b16 v[44:45], v16 offset:56320
    ds_read_b64_tr_b16 v[46:47], v16 offset:56832
    ds_read_b64_tr_b16 v[48:49], v16 offset:57344
    ds_read_b64_tr_b16 v[50:51], v16 offset:57856
    ds_read_b64_tr_b16 v[52:53], v16 offset:58368
    ds_read_b64_tr_b16 v[54:55], v16 offset:58880
    s_cmp_eq_u32 s60, 63
    s_cbranch_scc1 L_q_last_45
    v_max3_f32 v11, v24, v25, v26
    v_max3_f32 v13, v27, v28, v29
    s_waitcnt lgkmcnt(4)
    v_mfma_f32_16x16x32_bf16 v[36:39], v[40:43], v[80:83], 0
    v_max3_f32 v11, v11, v30, v31
    v_max_f32 v11, v11, v13
    v_mfma_f32_16x16x32_bf16 v[36:39], v[44:47], v[84:87], v[36:39]
    v_mul_f32 v10, s52, v11
    s_waitcnt lgkmcnt(0)
    v_mfma_f32_16x16x32_bf16 v[36:39], v[48:51], v[88:91], v[36:39]
    v_fma_f32 v24, v24, s52, -v10
    v_fma_f32 v25, v25, s52, -v10
    v_mfma_f32_16x16x32_bf16 v[36:39], v[52:55], v[92:95], v[36:39]
    v_fma_f32 v26, v26, s52, -v10
    v_fma_f32 v27, v27, s52, -v10
    v_fma_f32 v28, v28, s52, -v10
    v_fma_f32 v29, v29, s52, -v10
    v_fma_f32 v30, v30, s52, -v10
    v_fma_f32 v31, v31, s52, -v10
    v_exp_f32 v24, v24
    v_exp_f32 v25, v25
    v_permlane32_swap_b32 v36, v38
    v_permlane32_swap_b32 v37, v39
    v_pk_add_f32 v[36:37], v[36:37], v[38:39]
    v_max3_f32 v12, v36, v37, v11
    v_max3_f32 v13, v36, v37, v11
    v_exp_f32 v26, v26
    v_exp_f32 v27, v27
    buffer_load_dwordx2 v[0:1], v16, s[12:15], s51 offen sc1
    v_permlane32_swap_b32 v12, v13
    v_max_f32 v22, v12, v13
    v_max_f32 v13, v12, v13
    v_exp_f32 v28, v28
    v_exp_f32 v29, v29
    v_permlane16_swap_b32 v22, v13
    v_max_f32 v12, v22, v13
    v_mul_f32 v12, s52, v12
    v_sub_f32 v10, v10, v12
    v_pk_fma_f32 v[36:37], v[36:37], s[52:53], v[12:13] op_sel_hi:[1,0,0] neg_lo:[0,0,1] neg_hi:[0,0,1]
    v_exp_f32 v10, v10
    v_exp_f32 v30, v30
    v_exp_f32 v31, v31
    v_exp_f32 v36, v36
    v_exp_f32 v37, v37
    v_pk_mul_f32 v[24:25], v[24:25], v[10:11] op_sel_hi:[1,0]
    v_pk_mul_f32 v[26:27], v[26:27], v[10:11] op_sel_hi:[1,0]
    v_pk_mul_f32 v[28:29], v[28:29], v[10:11] op_sel_hi:[1,0]
    v_pk_mul_f32 v[30:31], v[30:31], v[10:11] op_sel_hi:[1,0]
    v_cvt_pk_bf16_f32 v60, v24, v25
    v_cvt_pk_bf16_f32 v61, v26, v27
    v_cvt_pk_bf16_f32 v62, v28, v29
    v_cvt_pk_bf16_f32 v63, v30, v31
    v_cvt_pk_bf16_f32 v56, v36, v37
    v_cvt_pk_bf16_f32 v59, v36, v37
    buffer_store_dword v15, v20, s[24:27], 0 offen
    v_mfma_f32_16x16x32_bf16 v[72:75], v[64:67], v[60:63], 0
    v_add_f32 v10, v24, v25
    v_add_f32 v11, v26, v27
    v_mfma_f32_16x16x32_bf16 v[76:79], v[68:71], v[60:63], 0
    v_add_f32 v10, v10, v28
    s_waitcnt vmcnt(1)
L_q_vm_46:
    v_max_u32 v22, v0, v1
    v_cmp_eq_u32 vcc, -1, v22
    v_add_f32 v12, v11, v29
    v_add_f32 v13, v10, v30
    s_cbranch_vccnz L_q_vm_46_r
    v_mfma_f32_16x16x16_bf16 v[72:75], v[0:1], v[56:57], v[72:75]
    v_add_f32 v11, v12, v31
    v_add_f32 v10, v13, v36
    v_mfma_f32_16x16x16_bf16 v[76:79], v[0:1], v[58:59], v[76:79]
    v_add_f32 v11, v11, v37
    v_add_f32 v12, v10, v11
    v_add_f32 v13, v10, v11
    s_nop 1
    v_permlane32_swap_b32 v12, v13
    v_add_f32 v22, v12, v13
    v_add_f32 v13, v12, v13
    s_nop 1
    v_permlane16_swap_b32 v22, v13
    v_add_f32 v12, v22, v13
    v_rcp_f32 v12, v12
    s_nop 0
    v_pk_mul_f32 v[72:73], v[72:73], v[12:13] op_sel_hi:[1,0]
    v_pk_mul_f32 v[74:75], v[74:75], v[12:13] op_sel_hi:[1,0]
    v_pk_mul_f32 v[76:77], v[76:77], v[12:13] op_sel_hi:[1,0]
    v_pk_mul_f32 v[78:79], v[78:79], v[12:13] op_sel_hi:[1,0]
    v_cvt_pk_bf16_f32 v72, v72, v73
    v_cvt_pk_bf16_f32 v73, v74, v75
    v_cvt_pk_bf16_f32 v74, v76, v77
    v_cvt_pk_bf16_f32 v75, v78, v79
    buffer_store_dwordx4 v[72:75], v17, s[24:27], s62 offen
    buffer_store_dwordx4 v[72:75], v17, s[28:31], s62 offen sc1
    buffer_store_dword v15, v20, s[28:31], 0 offen sc1
    v_mov_b32 v60, -1
    v_mov_b32 v61, -1
    v_mov_b32 v62, -1
    v_mov_b32 v63, -1
    s_add_u32 s45, s60, 3
    s_and_b32 s45, s45, 3
    s_lshl_b32 s45, s45, 15
    s_add_u32 s45, s45, s59
    buffer_store_dwordx4 v[60:63], v17, s[24:27], s45 offen
    buffer_store_dwordx4 v[60:63], v17, s[28:31], s45 offen sc1
L_q_last_45:
    s_waitcnt lgkmcnt(0)
    v_lshlrev_b32 v22, 1, v16
    s_cmp_lg_u32 s44, 0
    s_cbranch_scc1 L_q_km_47_0
    buffer_store_dwordx4 v[40:43], v22, s[12:15], s66 offen offset:0 sc1
L_q_km_47_0:
    s_cmp_lg_u32 s44, 1
    s_cbranch_scc1 L_q_km_47_1
    buffer_store_dwordx4 v[44:47], v22, s[12:15], s66 offen offset:1024 sc1
L_q_km_47_1:
    s_cmp_lg_u32 s44, 2
    s_cbranch_scc1 L_q_km_47_2
    buffer_store_dwordx4 v[48:51], v22, s[12:15], s66 offen offset:2048 sc1
L_q_km_47_2:
    s_cmp_lg_u32 s44, 3
    s_cbranch_scc1 L_q_km_47_3
    buffer_store_dwordx4 v[52:55], v22, s[12:15], s66 offen offset:3072 sc1
L_q_km_47_3:
    s_cmp_eq_u32 s60, 63
    s_cbranch_scc1 L_q_fin_48
    s_cmp_eq_u32 s60, 62
    s_cbranch_scc1 L_q_fin_48_n
    s_add_u32 s47, s60, 1
    s_cmp_lt_u32 s47, s50
    s_cbranch_scc1 L_kv_rdy_49
    s_lshl_b32 s45, s43, 7
    s_add_u32 s45, s45, 0x10014
    v_mov_b32 v0, 0
    s_mov_b32 s70, 0
L_kv_rdy_49_p:
    buffer_load_dwordx2 v[10:11], v0, s[12:15], s45 offen sc1
    s_add_u32 s70, s70, 1
    s_cmp_ge_u32 s70, 0x200000
    s_cbranch_scc1 L_c_done_1
    s_waitcnt vmcnt(0)
    v_min_u32 v10, v10, v11
    s_nop 0
    v_readfirstlane_b32 s50, v10
    s_nop 3
    s_cmp_lt_u32 s47, s50
    s_cbranch_scc1 L_kv_rdy_49
    s_sleep 2
    s_branch L_kv_rdy_49_p
L_kv_rdy_49:
    s_mov_b32 m0, s64
    s_add_u32 s46, s63, 0x1000000
    buffer_load_dwordx4 v14, s[12:15], s63 offen sc1 lds
    buffer_load_dwordx4 v14, s[12:15], s63 offen offset:1024 sc1 lds
    s_mov_b32 m0, s65
    s_add_u32 s63, s63, 8192
    buffer_load_dwordx4 v14, s[12:15], s46 offen sc1 lds
    buffer_load_dwordx4 v14, s[12:15], s46 offen offset:1024 sc1 lds
L_q_fin_48_n:
    s_add_u32 s47, s60, 1
    s_bitcmp1_b64 s[6:7], s47
    s_cselect_b32 s47, s47, s60
    s_cbranch_scc0 L_q_fin_48_m
    s_waitcnt vmcnt(0)
L_q_fin_48_m:
    v_mov_b32 v22, s47
    v_mov_b32 v0, 0
    s_mov_b64 exec, 1
    buffer_store_dword v22, v0, s[12:15], s3 offen sc1
    s_mov_b64 exec, -1
    s_mov_b64 exec, -1
    v_add_u32 v8, s69, v8
    v_add_u32 v9, s69, v9
    s_sub_u32 s64, s64, s69
    s_sub_u32 s65, s65, s69
    s_sub_u32 s69, 0, s69
    s_add_u32 s66, s66, 131072
    s_xor_b32 s51, s51, 65536
    s_add_u32 s60, s60, 1
    s_and_b32 s45, s60, 3
    s_lshl_b32 s46, s45, 14
    s_add_u32 s61, s58, s46
    s_lshl_b32 s46, s45, 15
    s_add_u32 s62, s59, s46
    s_branch L_q_loop_40
L_q_fin_48:
    s_waitcnt vmcnt(0)
    v_mov_b32 v22, 64
    v_mov_b32 v0, 0
    s_mov_b64 exec, 1
    buffer_store_dword v22, v0, s[12:15], s3 offen sc1
    s_mov_b64 exec, -1
    s_endpgm
L_q_vm_46_r:
    buffer_load_dwordx2 v[0:1], v16, s[12:15], s51 offen sc1
    s_add_u32 s70, s70, 1
    s_cmp_lt_u32 s70, 0x100000
    s_waitcnt vmcnt(0)
    s_cbranch_scc1 L_q_vm_46
    s_endpgm
L_mg_44_r0:
    buffer_load_dwordx4 v[40:43], v3, s[12:15], s8 offen sc1
    buffer_load_dwordx4 v[44:47], v3, s[12:15], s9 offen sc1
    buffer_load_dwordx4 v[48:51], v3, s[12:15], s10 offen sc1
    buffer_load_dwordx4 v[52:55], v3, s[12:15], s11 offen sc1
    s_add_u32 s70, s70, 1
    s_cmp_ge_u32 s70, 0x100000
    s_cbranch_scc1 L_c_done_1
    s_waitcnt vmcnt(3)
    ds_write_b128 v3, v[40:43] offset:0
    v_max3_u32 v22, v40, v41, v42
    v_max_u32 v22, v22, v43
    v_cmp_eq_u32 vcc, -1, v22
    s_waitcnt lgkmcnt(0)
    s_nop 0
    s_cbranch_vccnz L_mg_44_r0
    s_branch L_mg_44_c0
L_mg_44_r1:
    buffer_load_dwordx4 v[44:47], v3, s[12:15], s9 offen sc1
    buffer_load_dwordx4 v[48:51], v3, s[12:15], s10 offen sc1
    buffer_load_dwordx4 v[52:55], v3, s[12:15], s11 offen sc1
    s_add_u32 s70, s70, 1
    s_cmp_ge_u32 s70, 0x100000
    s_cbranch_scc1 L_c_done_1
    s_waitcnt vmcnt(2)
    ds_write_b128 v3, v[44:47] offset:1024
    v_max3_u32 v22, v44, v45, v46
    v_max_u32 v22, v22, v47
    v_cmp_eq_u32 vcc, -1, v22
    s_waitcnt lgkmcnt(0)
    s_nop 0
    s_cbranch_vccnz L_mg_44_r1
    s_branch L_mg_44_c1
L_mg_44_r2:
    buffer_load_dwordx4 v[48:51], v3, s[12:15], s10 offen sc1
    buffer_load_dwordx4 v[52:55], v3, s[12:15], s11 offen sc1
    s_add_u32 s70, s70, 1
    s_cmp_ge_u32 s70, 0x100000
    s_cbranch_scc1 L_c_done_1
    s_waitcnt vmcnt(1)
    ds_write_b128 v3, v[48:51] offset:2048
    v_max3_u32 v22, v48, v49, v50
    v_max_u32 v22, v22, v51
    v_cmp_eq_u32 vcc, -1, v22
    s_waitcnt lgkmcnt(0)
    s_nop 0
    s_cbranch_vccnz L_mg_44_r2
    s_branch L_mg_44_c2
L_mg_44_r3:
    buffer_load_dwordx4 v[52:55], v3, s[12:15], s11 offen sc1
    s_add_u32 s70, s70, 1
    s_cmp_ge_u32 s70, 0x100000
    s_cbranch_scc1 L_c_done_1
    s_waitcnt vmcnt(0)
    ds_write_b128 v3, v[52:55] offset:3072
    v_max3_u32 v22, v52, v53, v54
    v_max_u32 v22, v22, v55
    v_cmp_eq_u32 vcc, -1, v22
    s_waitcnt lgkmcnt(0)
    s_nop 0
    s_cbranch_vccnz L_mg_44_r3
    s_branch L_mg_44_c3
L_c_vo_2:
    s_lshl_b32 s45, s43, 11
    s_lshl_b32 s46, s44, 9
    s_add_u32 s45, s45, s46
    v_lshlrev_b32 v10, 3, v1
    v_add_u32 v10, s45, v10
    v_lshlrev_b32 v11, 3, v0
    v_bfe_u32 v69, v1, 4, 1
    v_lshlrev_b32 v69, 2, v69
    v_lshrrev_b32 v63, 5, v1
    v_lshlrev_b32 v63, 1, v63
    v_and_b32 v64, 1, v1
    v_add3_u32 v69, v69, v63, v64
    v_bfe_u32 v63, v1, 1, 1
    v_lshlrev_b32 v63, 3, v63
    v_add_u32 v63, v63, v69
    v_lshlrev_b32 v63, 4, v63
    v_bfe_u32 v64, v1, 2, 2
    v_lshlrev_b32 v64, 2, v64
    s_lshl_b32 s45, s42, 10
    s_lshl_b32 s46, s44, 8
    s_add_u32 s45, s45, s46
    v_add3_u32 v12, v63, v64, s45
    v_and_b32 v64, 1, v1
    v_cmp_eq_u32 vcc, 0, v64
    v_mov_b32 v9, 0x07060302
    v_mov_b32 v63, 0x01000504
    v_cndmask_b32 v9, v9, v63, vcc
    s_lshl_b32 s63, s40, 19
    s_lshl_b32 s45, s42, 15
    s_add_u32 s63, s63, s45
    s_add_u32 s63, s63, 0x7100000
    s_xor_b32 s64, s63, 524288
    s_lshl_b32 s45, s40, 12
    s_lshl_b32 s46, s44, 9
    s_add_u32 s45, s45, s46
    s_lshl_b32 s46, s42, 2
    s_add_u32 s45, s45, s46
    s_add_u32 s45, s45, 0x7082000
    v_lshlrev_b32 v20, 7, v1
    v_add_u32 v20, s45, v20
    v_mov_b32 v63, 0x20000000
    v_cmp_gt_u32 vcc, 4, v1
    s_nop 1
    v_cndmask_b32 v20, v63, v20, vcc
    buffer_store_dword v44, v20, s[12:15], 0 offen sc1
    s_mov_b32 s45, 0x7020000
    buffer_store_dwordx2 v[40:41], v10, s[12:15], s45 offen sc1
    s_mov_b32 s45, 0x7030000
    buffer_store_dwordx2 v[40:41], v10, s[12:15], s45 offen sc1
    s_add_u32 s45, s63, 0
    buffer_store_dwordx2 v[40:41], v11, s[12:15], s45 offen sc1
    s_add_u32 s45, s63, 4096
    buffer_store_dwordx2 v[40:41], v11, s[12:15], s45 offen sc1
    s_add_u32 s45, s63, 8192
    buffer_store_dwordx2 v[40:41], v11, s[12:15], s45 offen sc1
    s_add_u32 s45, s63, 12288
    buffer_store_dwordx2 v[40:41], v11, s[12:15], s45 offen sc1
    s_add_u32 s45, s63, 16384
    buffer_store_dwordx2 v[40:41], v11, s[12:15], s45 offen sc1
    s_add_u32 s45, s63, 20480
    buffer_store_dwordx2 v[40:41], v11, s[12:15], s45 offen sc1
    s_add_u32 s45, s63, 24576
    buffer_store_dwordx2 v[40:41], v11, s[12:15], s45 offen sc1
    s_add_u32 s45, s63, 28672
    buffer_store_dwordx2 v[40:41], v11, s[12:15], s45 offen sc1
    s_lshl_b32 s61, s40, 16
    s_add_u32 s61, s61, 0x7000000
    s_add_u32 s45, s61, 16384
    buffer_store_dword v40, v12, s[12:15], s45 offen sc1
    s_add_u32 s45, s61, 32768
    buffer_store_dword v40, v12, s[12:15], s45 offen sc1
    s_add_u32 s45, s61, 49152
    buffer_store_dword v40, v12, s[12:15], s45 offen sc1
    v_lshlrev_b32 v63, 11, v69
    v_and_b32 v64, 14, v1
    v_lshlrev_b32 v64, 1, v64
    v_add_u32 v63, v63, v64
    s_lshl_b32 s45, s42, 7
    s_lshl_b32 s46, s44, 5
    s_add_u32 s45, s45, s46
    buffer_load_dword v45, v63, s[52:55], s45 offen
    s_mov_b32 s76, -1
    s_mov_b32 s77, -1
    v_lshrrev_b32 v63, 3, v1
    v_lshlrev_b32 v63, 11, v63
    v_bfe_u32 v64, v1, 1, 2
    v_and_b32 v65, 1, v1
    v_lshlrev_b32 v65, 4, v65
    v_add_u32 v63, v63, v65
    v_xor_b32 v66, 0, v64
    v_lshlrev_b32 v66, 5, v66
    v_add_u32 v70, v63, v66
    v_xor_b32 v66, 1, v64
    v_lshlrev_b32 v66, 5, v66
    v_add_u32 v71, v63, v66
    v_xor_b32 v66, 2, v64
    v_lshlrev_b32 v66, 5, v66
    v_add_u32 v72, v63, v66
    v_xor_b32 v66, 3, v64
    v_lshlrev_b32 v66, 5, v66
    v_add_u32 v73, v63, v66
    v_bfe_u32 v63, v1, 3, 1
    v_lshlrev_b32 v63, 1, v63
    v_bfe_u32 v64, v1, 4, 1
    v_add_u32 v63, v63, v64
    v_lshlrev_b32 v64, 3, v63
    v_lshrrev_b32 v65, 5, v1
    v_lshlrev_b32 v65, 2, v65
    v_add_u32 v64, v64, v65
    v_bfe_u32 v65, v1, 2, 1
    v_add_u32 v64, v64, v65
    v_lshlrev_b32 v64, 7, v64
    v_and_b32 v65, 3, v1
    v_lshlrev_b32 v65, 3, v65
    v_add_u32 v64, v64, v65
    s_lshl_b32 s45, s44, 12
    v_add_u32 v64, s45, v64
    s_add_u32 s45, s44, 1
    s_and_b32 s45, s45, 3
    v_xor_b32 v65, s45, v63
    v_lshlrev_b32 v65, 5, v65
    v_add_u32 v74, v64, v65
    s_mul_i32 s45, s44, 20480
    s_add_u32 s45, s45, 65536
    v_add_u32 v88, s45, v74
    s_add_u32 s45, s44, 2
    s_and_b32 s45, s45, 3
    v_xor_b32 v65, s45, v63
    v_lshlrev_b32 v65, 5, v65
    v_add_u32 v75, v64, v65
    s_mul_i32 s45, s44, 20480
    s_add_u32 s45, s45, 65536
    v_add_u32 v89, s45, v75
    s_add_u32 s45, s44, 3
    s_and_b32 s45, s45, 3
    v_xor_b32 v65, s45, v63
    v_lshlrev_b32 v65, 5, v65
    v_add_u32 v76, v64, v65
    s_mul_i32 s45, s44, 20480
    s_add_u32 s45, s45, 65536
    v_add_u32 v90, s45, v76
    s_add_u32 s45, s44, 4
    s_and_b32 s45, s45, 3
    v_xor_b32 v65, s45, v63
    v_lshlrev_b32 v65, 5, v65
    v_add_u32 v77, v64, v65
    s_mul_i32 s45, s44, 20480
    s_add_u32 s45, s45, 65536
    v_add_u32 v91, s45, v77
    s_mul_i32 s65, s44, 24576
    s_lshl_b32 s49, s40, 22
    s_lshl_b32 s45, s44, 20
    s_add_u32 s49, s49, s45
    s_lshl_b32 s45, s42, 7
    s_add_u32 s49, s49, s45
    s_lshl_b32 s50, s44, 12
    s_mul_i32 s69, s42, 1
    s_add_u32 s51, s69, 0
    s_and_b32 s51, s51, 7
    s_lshl_b32 s51, s51, 17
    s_add_u32 s51, s51, s49
    s_add_u32 s46, s51, 0x0
    s_add_u32 m0, s65, 65536
    s_nop 0
    buffer_load_dwordx4 v70, s[36:39], s46 offen  lds
    s_add_u32 s46, s51, 0x8000
    s_add_u32 m0, s65, 66560
    s_nop 0
    buffer_load_dwordx4 v71, s[36:39], s46 offen  lds
    s_add_u32 s46, s51, 0x10000
    s_add_u32 m0, s65, 67584
    s_nop 0
    buffer_load_dwordx4 v72, s[36:39], s46 offen  lds
    s_add_u32 s46, s51, 0x18000
    s_add_u32 m0, s65, 68608
    s_nop 0
    buffer_load_dwordx4 v73, s[36:39], s46 offen  lds
    s_add_u32 s51, s69, 0
    s_and_b32 s51, s51, 7
    s_lshl_b32 s51, s51, 17
    s_add_u32 s51, s51, s49
    s_add_u32 s46, s51, 0x4000
    s_add_u32 m0, s65, 69632
    s_nop 0
    buffer_load_dwordx4 v70, s[36:39], s46 offen  lds
    s_add_u32 s46, s51, 0xc000
    s_add_u32 m0, s65, 70656
    s_nop 0
    buffer_load_dwordx4 v71, s[36:39], s46 offen  lds
    s_add_u32 s46, s51, 0x14000
    s_add_u32 m0, s65, 71680
    s_nop 0
    buffer_load_dwordx4 v72, s[36:39], s46 offen  lds
    s_add_u32 s46, s51, 0x1c000
    s_add_u32 m0, s65, 72704
    s_nop 0
    buffer_load_dwordx4 v73, s[36:39], s46 offen  lds
    s_add_u32 s51, s69, 1
    s_and_b32 s51, s51, 7
    s_lshl_b32 s51, s51, 17
    s_add_u32 s51, s51, s49
    s_add_u32 s46, s51, 0x0
    s_add_u32 m0, s65, 73728
    s_nop 0
    buffer_load_dwordx4 v70, s[36:39], s46 offen  lds
    s_add_u32 s46, s51, 0x8000
    s_add_u32 m0, s65, 74752
    s_nop 0
    buffer_load_dwordx4 v71, s[36:39], s46 offen  lds
    s_add_u32 s46, s51, 0x10000
    s_add_u32 m0, s65, 75776
    s_nop 0
    buffer_load_dwordx4 v72, s[36:39], s46 offen  lds
    s_add_u32 s46, s51, 0x18000
    s_add_u32 m0, s65, 76800
    s_nop 0
    buffer_load_dwordx4 v73, s[36:39], s46 offen  lds
    s_add_u32 s51, s69, 1
    s_and_b32 s51, s51, 7
    s_lshl_b32 s51, s51, 17
    s_add_u32 s51, s51, s49
    s_add_u32 s46, s51, 0x4000
    s_add_u32 m0, s65, 77824
    s_nop 0
    buffer_load_dwordx4 v70, s[36:39], s46 offen  lds
    s_add_u32 s46, s51, 0xc000
    s_add_u32 m0, s65, 78848
    s_nop 0
    buffer_load_dwordx4 v71, s[36:39], s46 offen  lds
    s_add_u32 s46, s51, 0x14000
    s_add_u32 m0, s65, 79872
    s_nop 0
    buffer_load_dwordx4 v72, s[36:39], s46 offen  lds
    s_add_u32 s46, s51, 0x1c000
    s_add_u32 m0, s65, 80896
    s_nop 0
    buffer_load_dwordx4 v73, s[36:39], s46 offen  lds
    s_add_u32 s51, s69, 2
    s_and_b32 s51, s51, 7
    s_lshl_b32 s51, s51, 17
    s_add_u32 s51, s51, s49
    s_add_u32 s46, s51, 0x0
    s_add_u32 m0, s65, 81920
    s_nop 0
    buffer_load_dwordx4 v70, s[36:39], s46 offen  lds
    s_add_u32 s46, s51, 0x8000
    s_add_u32 m0, s65, 82944
    s_nop 0
    buffer_load_dwordx4 v71, s[36:39], s46 offen  lds
    s_add_u32 s46, s51, 0x10000
    s_add_u32 m0, s65, 83968
    s_nop 0
    buffer_load_dwordx4 v72, s[36:39], s46 offen  lds
    s_add_u32 s46, s51, 0x18000
    s_add_u32 m0, s65, 84992
    s_nop 0
    buffer_load_dwordx4 v73, s[36:39], s46 offen  lds
    s_add_u32 s51, s69, 2
    s_and_b32 s51, s51, 7
    s_lshl_b32 s51, s51, 17
    s_add_u32 s51, s51, s49
    s_add_u32 s46, s51, 0x4000
    s_add_u32 m0, s65, 86016
    s_nop 0
    buffer_load_dwordx4 v70, s[36:39], s46 offen  lds
    s_add_u32 s46, s51, 0xc000
    s_add_u32 m0, s65, 87040
    s_nop 0
    buffer_load_dwordx4 v71, s[36:39], s46 offen  lds
    s_add_u32 s46, s51, 0x14000
    s_add_u32 m0, s65, 88064
    s_nop 0
    buffer_load_dwordx4 v72, s[36:39], s46 offen  lds
    s_add_u32 s46, s51, 0x1c000
    s_add_u32 m0, s65, 89088
    s_nop 0
    buffer_load_dwordx4 v73, s[36:39], s46 offen  lds
    s_add_u32 s51, s69, 3
    s_and_b32 s51, s51, 7
    s_lshl_b32 s51, s51, 17
    s_add_u32 s51, s51, s49
    s_add_u32 s46, s51, 0x0
    s_add_u32 m0, s50, 0
    s_nop 0
    buffer_load_dwordx4 v70, s[36:39], s46 offen  lds
    s_add_u32 s46, s51, 0x8000
    s_add_u32 m0, s50, 1024
    s_nop 0
    buffer_load_dwordx4 v71, s[36:39], s46 offen  lds
    s_add_u32 s46, s51, 0x10000
    s_add_u32 m0, s50, 2048
    s_nop 0
    buffer_load_dwordx4 v72, s[36:39], s46 offen  lds
    s_add_u32 s46, s51, 0x18000
    s_add_u32 m0, s50, 3072
    s_nop 0
    buffer_load_dwordx4 v73, s[36:39], s46 offen  lds
    s_add_u32 s51, s69, 3
    s_and_b32 s51, s51, 7
    s_lshl_b32 s51, s51, 17
    s_add_u32 s51, s51, s49
    s_add_u32 s46, s51, 0x4000
    s_add_u32 m0, s50, 16384
    s_nop 0
    buffer_load_dwordx4 v70, s[36:39], s46 offen  lds
    s_add_u32 s46, s51, 0xc000
    s_add_u32 m0, s50, 17408
    s_nop 0
    buffer_load_dwordx4 v71, s[36:39], s46 offen  lds
    s_add_u32 s46, s51, 0x14000
    s_add_u32 m0, s50, 18432
    s_nop 0
    buffer_load_dwordx4 v72, s[36:39], s46 offen  lds
    s_add_u32 s46, s51, 0x1c000
    s_add_u32 m0, s50, 19456
    s_nop 0
    buffer_load_dwordx4 v73, s[36:39], s46 offen  lds
    s_add_u32 s51, s69, 4
    s_and_b32 s51, s51, 7
    s_lshl_b32 s51, s51, 17
    s_add_u32 s51, s51, s49
    s_add_u32 s46, s51, 0x0
    s_add_u32 m0, s50, 32768
    s_nop 0
    buffer_load_dwordx4 v70, s[36:39], s46 offen  lds
    s_add_u32 s46, s51, 0x8000
    s_add_u32 m0, s50, 33792
    s_nop 0
    buffer_load_dwordx4 v71, s[36:39], s46 offen  lds
    s_add_u32 s46, s51, 0x10000
    s_add_u32 m0, s50, 34816
    s_nop 0
    buffer_load_dwordx4 v72, s[36:39], s46 offen  lds
    s_add_u32 s46, s51, 0x18000
    s_add_u32 m0, s50, 35840
    s_nop 0
    buffer_load_dwordx4 v73, s[36:39], s46 offen  lds
    s_add_u32 s51, s69, 4
    s_and_b32 s51, s51, 7
    s_lshl_b32 s51, s51, 17
    s_add_u32 s51, s51, s49
    s_add_u32 s46, s51, 0x4000
    s_add_u32 m0, s50, 49152
    s_nop 0
    buffer_load_dwordx4 v70, s[36:39], s46 offen  lds
    s_add_u32 s46, s51, 0xc000
    s_add_u32 m0, s50, 50176
    s_nop 0
    buffer_load_dwordx4 v71, s[36:39], s46 offen  lds
    s_add_u32 s46, s51, 0x14000
    s_add_u32 m0, s50, 51200
    s_nop 0
    buffer_load_dwordx4 v72, s[36:39], s46 offen  lds
    s_add_u32 s46, s51, 0x1c000
    s_add_u32 m0, s50, 52224
    s_nop 0
    buffer_load_dwordx4 v73, s[36:39], s46 offen  lds
    s_waitcnt vmcnt(40)
    v_min_u32 v45, -2, v45
    buffer_store_dword v45, v12, s[12:15], s61 offen sc1
    s_waitcnt vmcnt(36)
    s_barrier
    ds_read_b64_tr_b16 a[160:161], v88 offset:0
    ds_read_b64_tr_b16 a[162:163], v88 offset:256
    ds_read_b64_tr_b16 a[168:169], v89 offset:0
    ds_read_b64_tr_b16 a[170:171], v89 offset:256
    ds_read_b64_tr_b16 a[176:177], v90 offset:0
    ds_read_b64_tr_b16 a[178:179], v90 offset:256
    ds_read_b64_tr_b16 a[184:185], v91 offset:0
    ds_read_b64_tr_b16 a[186:187], v91 offset:256
L_lw_50:
    s_waitcnt lgkmcnt(0)
    s_cmp_lg_u32 s44, 0
    s_cbranch_scc1 L_v_probe_51
    s_add_u32 s45, s63, 0
    s_memtime s[72:73]
    s_waitcnt lgkmcnt(0)
    s_load_dword s78, s[20:21], s45
    s_waitcnt lgkmcnt(0)
    s_memtime s[74:75]
    s_waitcnt lgkmcnt(0)
    s_sub_u32 s45, s74, s72
    s_min_u32 s76, s76, s45
    s_cmp_lt_u32 s77, s76
    s_cselect_b32 s68, 1, 0
L_v_probe_51:
    s_waitcnt vmcnt(32)
    s_barrier
    s_add_u32 s51, s69, 5
    s_and_b32 s51, s51, 7
    s_lshl_b32 s51, s51, 17
    s_add_u32 s51, s51, s49
    s_add_u32 s46, s51, 0x0
    s_add_u32 m0, s65, 65536
    s_nop 0
    buffer_load_dwordx4 v70, s[36:39], s46 offen  lds
    s_add_u32 s46, s51, 0x8000
    s_add_u32 m0, s65, 66560
    s_nop 0
    buffer_load_dwordx4 v71, s[36:39], s46 offen  lds
    s_add_u32 s46, s51, 0x10000
    s_add_u32 m0, s65, 67584
    s_nop 0
    buffer_load_dwordx4 v72, s[36:39], s46 offen  lds
    s_add_u32 s46, s51, 0x18000
    s_add_u32 m0, s65, 68608
    s_nop 0
    buffer_load_dwordx4 v73, s[36:39], s46 offen  lds
    ds_read_b64_tr_b16 a[164:165], v88 offset:4096
    ds_read_b64_tr_b16 a[166:167], v88 offset:4352
    ds_read_b64_tr_b16 a[172:173], v89 offset:4096
    ds_read_b64_tr_b16 a[174:175], v89 offset:4352
    ds_read_b64_tr_b16 a[180:181], v90 offset:4096
    ds_read_b64_tr_b16 a[182:183], v90 offset:4352
    ds_read_b64_tr_b16 a[188:189], v91 offset:4096
    ds_read_b64_tr_b16 a[190:191], v91 offset:4352
L_lw_52:
    s_waitcnt lgkmcnt(0)
    s_cmp_lg_u32 s44, 0
    s_cbranch_scc1 L_v_probe_53
    s_add_u32 s45, s63, 8192
    s_memtime s[72:73]
    s_waitcnt lgkmcnt(0)
    s_load_dword s78, s[20:21], s45
    s_waitcnt lgkmcnt(0)
    s_memtime s[74:75]
    s_waitcnt lgkmcnt(0)
    s_sub_u32 s45, s74, s72
    s_min_u32 s77, s77, s45
    s_cmp_lt_u32 s77, s76
    s_cselect_b32 s68, 1, 0
L_v_probe_53:
    s_waitcnt vmcnt(32)
    s_barrier
    s_add_u32 s51, s69, 5
    s_and_b32 s51, s51, 7
    s_lshl_b32 s51, s51, 17
    s_add_u32 s51, s51, s49
    s_add_u32 s46, s51, 0x4000
    s_add_u32 m0, s65, 69632
    s_nop 0
    buffer_load_dwordx4 v70, s[36:39], s46 offen  lds
    s_add_u32 s46, s51, 0xc000
    s_add_u32 m0, s65, 70656
    s_nop 0
    buffer_load_dwordx4 v71, s[36:39], s46 offen  lds
    s_add_u32 s46, s51, 0x14000
    s_add_u32 m0, s65, 71680
    s_nop 0
    buffer_load_dwordx4 v72, s[36:39], s46 offen  lds
    s_add_u32 s46, s51, 0x1c000
    s_add_u32 m0, s65, 72704
    s_nop 0
    buffer_load_dwordx4 v73, s[36:39], s46 offen  lds
    ds_read_b64_tr_b16 a[192:193], v88 offset:8192
    ds_read_b64_tr_b16 a[194:195], v88 offset:8448
    ds_read_b64_tr_b16 a[200:201], v89 offset:8192
    ds_read_b64_tr_b16 a[202:203], v89 offset:8448
    ds_read_b64_tr_b16 a[208:209], v90 offset:8192
    ds_read_b64_tr_b16 a[210:211], v90 offset:8448
    ds_read_b64_tr_b16 a[216:217], v91 offset:8192
    ds_read_b64_tr_b16 a[218:219], v91 offset:8448
L_lw_54:
    s_waitcnt lgkmcnt(0)
    s_cmp_lg_u32 s44, 0
    s_cbranch_scc1 L_v_probe_55
    s_add_u32 s45, s63, 128
    s_memtime s[72:73]
    s_waitcnt lgkmcnt(0)
    s_load_dword s78, s[20:21], s45
    s_waitcnt lgkmcnt(0)
    s_memtime s[74:75]
    s_waitcnt lgkmcnt(0)
    s_sub_u32 s45, s74, s72
    s_min_u32 s76, s76, s45
    s_cmp_lt_u32 s77, s76
    s_cselect_b32 s68, 1, 0
L_v_probe_55:
    s_waitcnt vmcnt(32)
    s_barrier
    s_add_u32 s51, s69, 6
    s_and_b32 s51, s51, 7
    s_lshl_b32 s51, s51, 17
    s_add_u32 s51, s51, s49
    s_add_u32 s46, s51, 0x0
    s_add_u32 m0, s65, 73728
    s_nop 0
    buffer_load_dwordx4 v70, s[36:39], s46 offen  lds
    s_add_u32 s46, s51, 0x8000
    s_add_u32 m0, s65, 74752
    s_nop 0
    buffer_load_dwordx4 v71, s[36:39], s46 offen  lds
    s_add_u32 s46, s51, 0x10000
    s_add_u32 m0, s65, 75776
    s_nop 0
    buffer_load_dwordx4 v72, s[36:39], s46 offen  lds
    s_add_u32 s46, s51, 0x18000
    s_add_u32 m0, s65, 76800
    s_nop 0
    buffer_load_dwordx4 v73, s[36:39], s46 offen  lds
    ds_read_b64_tr_b16 a[196:197], v88 offset:12288
    ds_read_b64_tr_b16 a[198:199], v88 offset:12544
    ds_read_b64_tr_b16 a[204:205], v89 offset:12288
    ds_read_b64_tr_b16 a[206:207], v89 offset:12544
    ds_read_b64_tr_b16 a[212:213], v90 offset:12288
    ds_read_b64_tr_b16 a[214:215], v90 offset:12544
    ds_read_b64_tr_b16 a[220:221], v91 offset:12288
    ds_read_b64_tr_b16 a[222:223], v91 offset:12544
L_lw_56:
    s_waitcnt lgkmcnt(0)
    s_cmp_lg_u32 s44, 0
    s_cbranch_scc1 L_v_probe_57
    s_add_u32 s45, s63, 8320
    s_memtime s[72:73]
    s_waitcnt lgkmcnt(0)
    s_load_dword s78, s[20:21], s45
    s_waitcnt lgkmcnt(0)
    s_memtime s[74:75]
    s_waitcnt lgkmcnt(0)
    s_sub_u32 s45, s74, s72
    s_min_u32 s77, s77, s45
    s_cmp_lt_u32 s77, s76
    s_cselect_b32 s68, 1, 0
L_v_probe_57:
    s_waitcnt vmcnt(32)
    s_barrier
    s_add_u32 s51, s69, 6
    s_and_b32 s51, s51, 7
    s_lshl_b32 s51, s51, 17
    s_add_u32 s51, s51, s49
    s_add_u32 s46, s51, 0x4000
    s_add_u32 m0, s65, 77824
    s_nop 0
    buffer_load_dwordx4 v70, s[36:39], s46 offen  lds
    s_add_u32 s46, s51, 0xc000
    s_add_u32 m0, s65, 78848
    s_nop 0
    buffer_load_dwordx4 v71, s[36:39], s46 offen  lds
    s_add_u32 s46, s51, 0x14000
    s_add_u32 m0, s65, 79872
    s_nop 0
    buffer_load_dwordx4 v72, s[36:39], s46 offen  lds
    s_add_u32 s46, s51, 0x1c000
    s_add_u32 m0, s65, 80896
    s_nop 0
    buffer_load_dwordx4 v73, s[36:39], s46 offen  lds
    ds_read_b64_tr_b16 a[224:225], v88 offset:16384
    ds_read_b64_tr_b16 a[226:227], v88 offset:16640
    ds_read_b64_tr_b16 a[232:233], v89 offset:16384
    ds_read_b64_tr_b16 a[234:235], v89 offset:16640
    ds_read_b64_tr_b16 a[240:241], v90 offset:16384
    ds_read_b64_tr_b16 a[242:243], v90 offset:16640
    ds_read_b64_tr_b16 a[248:249], v91 offset:16384
    ds_read_b64_tr_b16 a[250:251], v91 offset:16640
L_lw_58:
    s_waitcnt lgkmcnt(0)
    s_cmp_lg_u32 s44, 0
    s_cbranch_scc1 L_v_probe_59
    s_add_u32 s45, s63, 256
    s_memtime s[72:73]
    s_waitcnt lgkmcnt(0)
    s_load_dword s78, s[20:21], s45
    s_waitcnt lgkmcnt(0)
    s_memtime s[74:75]
    s_waitcnt lgkmcnt(0)
    s_sub_u32 s45, s74, s72
    s_min_u32 s76, s76, s45
    s_cmp_lt_u32 s77, s76
    s_cselect_b32 s68, 1, 0
L_v_probe_59:
    s_waitcnt vmcnt(32)
    s_barrier
    s_add_u32 s51, s69, 7
    s_and_b32 s51, s51, 7
    s_lshl_b32 s51, s51, 17
    s_add_u32 s51, s51, s49
    s_add_u32 s46, s51, 0x0
    s_add_u32 m0, s65, 81920
    s_nop 0
    buffer_load_dwordx4 v70, s[36:39], s46 offen  lds
    s_add_u32 s46, s51, 0x8000
    s_add_u32 m0, s65, 82944
    s_nop 0
    buffer_load_dwordx4 v71, s[36:39], s46 offen  lds
    s_add_u32 s46, s51, 0x10000
    s_add_u32 m0, s65, 83968
    s_nop 0
    buffer_load_dwordx4 v72, s[36:39], s46 offen  lds
    s_add_u32 s46, s51, 0x18000
    s_add_u32 m0, s65, 84992
    s_nop 0
    buffer_load_dwordx4 v73, s[36:39], s46 offen  lds
    ds_read_b64_tr_b16 a[228:229], v88 offset:20480
    ds_read_b64_tr_b16 a[230:231], v88 offset:20736
    ds_read_b64_tr_b16 a[236:237], v89 offset:20480
    ds_read_b64_tr_b16 a[238:239], v89 offset:20736
    ds_read_b64_tr_b16 a[244:245], v90 offset:20480
    ds_read_b64_tr_b16 a[246:247], v90 offset:20736
    ds_read_b64_tr_b16 a[252:253], v91 offset:20480
    ds_read_b64_tr_b16 a[254:255], v91 offset:20736
L_lw_60:
    s_waitcnt lgkmcnt(0)
    s_cmp_lg_u32 s44, 0
    s_cbranch_scc1 L_v_probe_61
    s_add_u32 s45, s63, 8448
    s_memtime s[72:73]
    s_waitcnt lgkmcnt(0)
    s_load_dword s78, s[20:21], s45
    s_waitcnt lgkmcnt(0)
    s_memtime s[74:75]
    s_waitcnt lgkmcnt(0)
    s_sub_u32 s45, s74, s72
    s_min_u32 s77, s77, s45
    s_cmp_lt_u32 s77, s76
    s_cselect_b32 s68, 1, 0
L_v_probe_61:
    s_waitcnt vmcnt(32)
    s_barrier
    s_add_u32 s51, s69, 7
    s_and_b32 s51, s51, 7
    s_lshl_b32 s51, s51, 17
    s_add_u32 s51, s51, s49
    s_add_u32 s46, s51, 0x4000
    s_add_u32 m0, s65, 86016
    s_nop 0
    buffer_load_dwordx4 v70, s[36:39], s46 offen  lds
    s_add_u32 s46, s51, 0xc000
    s_add_u32 m0, s65, 87040
    s_nop 0
    buffer_load_dwordx4 v71, s[36:39], s46 offen  lds
    s_add_u32 s46, s51, 0x14000
    s_add_u32 m0, s65, 88064
    s_nop 0
    buffer_load_dwordx4 v72, s[36:39], s46 offen  lds
    s_add_u32 s46, s51, 0x1c000
    s_add_u32 m0, s65, 89088
    s_nop 0
    buffer_load_dwordx4 v73, s[36:39], s46 offen  lds
    ds_read_b64_tr_b16 v[96:97], v74 offset:0
    ds_read_b64_tr_b16 v[98:99], v74 offset:256
    ds_read_b64_tr_b16 v[104:105], v75 offset:0
    ds_read_b64_tr_b16 v[106:107], v75 offset:256
    ds_read_b64_tr_b16 v[112:113], v76 offset:0
    ds_read_b64_tr_b16 v[114:115], v76 offset:256
    ds_read_b64_tr_b16 v[120:121], v77 offset:0
    ds_read_b64_tr_b16 v[122:123], v77 offset:256
L_lw_62:
    s_waitcnt lgkmcnt(0)
    s_cmp_lg_u32 s44, 0
    s_cbranch_scc1 L_v_probe_63
    s_add_u32 s45, s63, 384
    s_memtime s[72:73]
    s_waitcnt lgkmcnt(0)
    s_load_dword s78, s[20:21], s45
    s_waitcnt lgkmcnt(0)
    s_memtime s[74:75]
    s_waitcnt lgkmcnt(0)
    s_sub_u32 s45, s74, s72
    s_min_u32 s76, s76, s45
    s_cmp_lt_u32 s77, s76
    s_cselect_b32 s68, 1, 0
L_v_probe_63:
    s_waitcnt vmcnt(32)
    s_barrier
    s_add_u32 s79, s41, 0
    s_and_b32 s79, s79, 3
    s_lshl_b32 s79, s79, 19
    s_add_u32 s79, s79, s47
    s_add_u32 s46, s79, 0x0
    s_add_u32 m0, s48, 0
    s_nop 0
    buffer_load_dwordx4 v82, s[32:35], s46 offen  lds
    s_add_u32 s46, s79, 0x20000
    s_add_u32 m0, s48, 4096
    s_nop 0
    buffer_load_dwordx4 v82, s[32:35], s46 offen  lds
    s_add_u32 s46, s79, 0x40000
    s_add_u32 m0, s48, 8192
    s_nop 0
    buffer_load_dwordx4 v82, s[32:35], s46 offen  lds
    s_add_u32 s46, s79, 0x60000
    s_add_u32 m0, s48, 12288
    s_nop 0
    buffer_load_dwordx4 v82, s[32:35], s46 offen  lds
    ds_read_b64_tr_b16 v[100:101], v74 offset:16384
    ds_read_b64_tr_b16 v[102:103], v74 offset:16640
    ds_read_b64_tr_b16 v[108:109], v75 offset:16384
    ds_read_b64_tr_b16 v[110:111], v75 offset:16640
    ds_read_b64_tr_b16 v[116:117], v76 offset:16384
    ds_read_b64_tr_b16 v[118:119], v76 offset:16640
    ds_read_b64_tr_b16 v[124:125], v77 offset:16384
    ds_read_b64_tr_b16 v[126:127], v77 offset:16640
L_lw_64:
    s_waitcnt lgkmcnt(0)
    s_cmp_lg_u32 s44, 0
    s_cbranch_scc1 L_v_probe_65
    s_add_u32 s45, s63, 8576
    s_memtime s[72:73]
    s_waitcnt lgkmcnt(0)
    s_load_dword s78, s[20:21], s45
    s_waitcnt lgkmcnt(0)
    s_memtime s[74:75]
    s_waitcnt lgkmcnt(0)
    s_sub_u32 s45, s74, s72
    s_min_u32 s77, s77, s45
    s_cmp_lt_u32 s77, s76
    s_cselect_b32 s68, 1, 0
L_v_probe_65:
    s_waitcnt vmcnt(32)
    s_barrier
    s_add_u32 s79, s41, 1
    s_and_b32 s79, s79, 3
    s_lshl_b32 s79, s79, 19
    s_add_u32 s79, s79, s47
    s_add_u32 s46, s79, 0x0
    s_add_u32 m0, s48, 16384
    s_nop 0
    buffer_load_dwordx4 v82, s[32:35], s46 offen  lds
    s_add_u32 s46, s79, 0x20000
    s_add_u32 m0, s48, 20480
    s_nop 0
    buffer_load_dwordx4 v82, s[32:35], s46 offen  lds
    s_add_u32 s46, s79, 0x40000
    s_add_u32 m0, s48, 24576
    s_nop 0
    buffer_load_dwordx4 v82, s[32:35], s46 offen  lds
    s_add_u32 s46, s79, 0x60000
    s_add_u32 m0, s48, 28672
    s_nop 0
    buffer_load_dwordx4 v82, s[32:35], s46 offen  lds
    ds_read_b64_tr_b16 v[128:129], v74 offset:32768
    ds_read_b64_tr_b16 v[130:131], v74 offset:33024
    ds_read_b64_tr_b16 v[136:137], v75 offset:32768
    ds_read_b64_tr_b16 v[138:139], v75 offset:33024
    ds_read_b64_tr_b16 v[144:145], v76 offset:32768
    ds_read_b64_tr_b16 v[146:147], v76 offset:33024
    ds_read_b64_tr_b16 v[152:153], v77 offset:32768
    ds_read_b64_tr_b16 v[154:155], v77 offset:33024
L_lw_66:
    s_waitcnt lgkmcnt(0)
    s_cmp_lg_u32 s44, 0
    s_cbranch_scc1 L_v_probe_67
    s_add_u32 s45, s63, 512
    s_memtime s[72:73]
    s_waitcnt lgkmcnt(0)
    s_load_dword s78, s[20:21], s45
    s_waitcnt lgkmcnt(0)
    s_memtime s[74:75]
    s_waitcnt lgkmcnt(0)
    s_sub_u32 s45, s74, s72
    s_min_u32 s76, s76, s45
    s_cmp_lt_u32 s77, s76
    s_cselect_b32 s68, 1, 0
L_v_probe_67:
    s_waitcnt vmcnt(32)
    s_barrier
    s_add_u32 s79, s41, 2
    s_and_b32 s79, s79, 3
    s_lshl_b32 s79, s79, 19
    s_add_u32 s79, s79, s47
    s_add_u32 s46, s79, 0x0
    s_add_u32 m0, s48, 32768
    s_nop 0
    buffer_load_dwordx4 v82, s[32:35], s46 offen  lds
    s_add_u32 s46, s79, 0x20000
    s_add_u32 m0, s48, 36864
    s_nop 0
    buffer_load_dwordx4 v82, s[32:35], s46 offen  lds
    s_add_u32 s46, s79, 0x40000
    s_add_u32 m0, s48, 40960
    s_nop 0
    buffer_load_dwordx4 v82, s[32:35], s46 offen  lds
    s_add_u32 s46, s79, 0x60000
    s_add_u32 m0, s48, 45056
    s_nop 0
    buffer_load_dwordx4 v82, s[32:35], s46 offen  lds
    ds_read_b64_tr_b16 v[132:133], v74 offset:49152
    ds_read_b64_tr_b16 v[134:135], v74 offset:49408
    ds_read_b64_tr_b16 v[140:141], v75 offset:49152
    ds_read_b64_tr_b16 v[142:143], v75 offset:49408
    ds_read_b64_tr_b16 v[148:149], v76 offset:49152
    ds_read_b64_tr_b16 v[150:151], v76 offset:49408
    ds_read_b64_tr_b16 v[156:157], v77 offset:49152
    ds_read_b64_tr_b16 v[158:159], v77 offset:49408
L_lw_68:
    s_waitcnt lgkmcnt(0)
    s_cmp_lg_u32 s44, 0
    s_cbranch_scc1 L_v_probe_69
    s_add_u32 s45, s63, 8704
    s_memtime s[72:73]
    s_waitcnt lgkmcnt(0)
    s_load_dword s78, s[20:21], s45
    s_waitcnt lgkmcnt(0)
    s_memtime s[74:75]
    s_waitcnt lgkmcnt(0)
    s_sub_u32 s45, s74, s72
    s_min_u32 s77, s77, s45
    s_cmp_lt_u32 s77, s76
    s_cselect_b32 s68, 1, 0
L_v_probe_69:
    s_waitcnt vmcnt(32)
    s_barrier
    s_add_u32 s79, s41, 3
    s_and_b32 s79, s79, 3
    s_lshl_b32 s79, s79, 19
    s_add_u32 s79, s79, s47
    s_add_u32 s46, s79, 0x0
    s_add_u32 m0, s48, 49152
    s_nop 0
    buffer_load_dwordx4 v82, s[32:35], s46 offen  lds
    s_add_u32 s46, s79, 0x20000
    s_add_u32 m0, s48, 53248
    s_nop 0
    buffer_load_dwordx4 v82, s[32:35], s46 offen  lds
    s_add_u32 s46, s79, 0x40000
    s_add_u32 m0, s48, 57344
    s_nop 0
    buffer_load_dwordx4 v82, s[32:35], s46 offen  lds
    s_add_u32 s46, s79, 0x60000
    s_add_u32 m0, s48, 61440
    s_nop 0
    buffer_load_dwordx4 v82, s[32:35], s46 offen  lds
    ds_read_b64_tr_b16 v[160:161], v88 offset:0
    ds_read_b64_tr_b16 v[162:163], v88 offset:256
    ds_read_b64_tr_b16 v[168:169], v89 offset:0
    ds_read_b64_tr_b16 v[170:171], v89 offset:256
    ds_read_b64_tr_b16 v[176:177], v90 offset:0
    ds_read_b64_tr_b16 v[178:179], v90 offset:256
    ds_read_b64_tr_b16 v[184:185], v91 offset:0
    ds_read_b64_tr_b16 v[186:187], v91 offset:256
L_lw_70:
    s_waitcnt lgkmcnt(0)
    s_waitcnt vmcnt(32)
    s_barrier
    s_cmp_lg_u32 s44, 0
    s_cbranch_scc1 L_hs_71
    s_getreg_b32 s45, hwreg(HW_REG_XCC_ID)
    s_and_b32 s45, s45, 15
    s_mul_i32 s46, s45, s45
    s_lshl_b32 s46, s46, 9
    s_add_u32 s45, s45, s46
    s_cmp_eq_u32 s40, 0
    s_cselect_b32 s46, s45, 0
    s_cselect_b32 s45, 0, s45
    s_lshl_b32 s68, s68, 24
    s_add_u32 s46, s46, s68
    s_add_u32 s45, s45, 16777216
    v_mov_b32 v40, s46
    v_mov_b32 v41, s45
    v_mov_b32 v42, 0
    s_mov_b64 exec, 1
    buffer_atomic_add_x2 v[40:41], v42, s[16:19], 0 offen sc1
    s_mov_b64 exec, -1
L_hs_71:
    ds_read_b64_tr_b16 v[164:165], v88 offset:4096
    ds_read_b64_tr_b16 v[166:167], v88 offset:4352
    ds_read_b64_tr_b16 v[172:173], v89 offset:4096
    ds_read_b64_tr_b16 v[174:175], v89 offset:4352
    ds_read_b64_tr_b16 v[180:181], v90 offset:4096
    ds_read_b64_tr_b16 v[182:183], v90 offset:4352
    ds_read_b64_tr_b16 v[188:189], v91 offset:4096
    ds_read_b64_tr_b16 v[190:191], v91 offset:4352
L_lw_72:
    s_waitcnt lgkmcnt(0)
    s_waitcnt vmcnt(28)
    s_barrier
    ds_read_b64_tr_b16 v[192:193], v88 offset:8192
    ds_read_b64_tr_b16 v[194:195], v88 offset:8448
    ds_read_b64_tr_b16 v[200:201], v89 offset:8192
    ds_read_b64_tr_b16 v[202:203], v89 offset:8448
    ds_read_b64_tr_b16 v[208:209], v90 offset:8192
    ds_read_b64_tr_b16 v[210:211], v90 offset:8448
    ds_read_b64_tr_b16 v[216:217], v91 offset:8192
    ds_read_b64_tr_b16 v[218:219], v91 offset:8448
L_lw_73:
    s_waitcnt lgkmcnt(0)
    s_waitcnt vmcnt(24)
    s_barrier
    ds_read_b64_tr_b16 v[196:197], v88 offset:12288
    ds_read_b64_tr_b16 v[198:199], v88 offset:12544
    ds_read_b64_tr_b16 v[204:205], v89 offset:12288
    ds_read_b64_tr_b16 v[206:207], v89 offset:12544
    ds_read_b64_tr_b16 v[212:213], v90 offset:12288
    ds_read_b64_tr_b16 v[214:215], v90 offset:12544
    ds_read_b64_tr_b16 v[220:221], v91 offset:12288
    ds_read_b64_tr_b16 v[222:223], v91 offset:12544
L_lw_74:
    s_waitcnt lgkmcnt(0)
    s_waitcnt vmcnt(20)
    s_barrier
    ds_read_b64_tr_b16 v[224:225], v88 offset:16384
    ds_read_b64_tr_b16 v[226:227], v88 offset:16640
    ds_read_b64_tr_b16 v[232:233], v89 offset:16384
    ds_read_b64_tr_b16 v[234:235], v89 offset:16640
    ds_read_b64_tr_b16 v[240:241], v90 offset:16384
    ds_read_b64_tr_b16 v[242:243], v90 offset:16640
    ds_read_b64_tr_b16 v[248:249], v91 offset:16384
    ds_read_b64_tr_b16 v[250:251], v91 offset:16640
L_lw_75:
    s_waitcnt lgkmcnt(0)
    s_waitcnt vmcnt(16)
    s_barrier
    ds_read_b64_tr_b16 v[228:229], v88 offset:20480
    ds_read_b64_tr_b16 v[230:231], v88 offset:20736
    ds_read_b64_tr_b16 v[236:237], v89 offset:20480
    ds_read_b64_tr_b16 v[238:239], v89 offset:20736
    ds_read_b64_tr_b16 v[244:245], v90 offset:20480
    ds_read_b64_tr_b16 v[246:247], v90 offset:20736
    ds_read_b64_tr_b16 v[252:253], v91 offset:20480
    ds_read_b64_tr_b16 v[254:255], v91 offset:20736
L_lw_76:
    s_waitcnt lgkmcnt(0)
    s_waitcnt vmcnt(12)
    s_barrier
    s_cmp_lg_u32 s44, 0
    s_cbranch_scc1 L_lw_77_0
    ds_read_b64_tr_b16 a[0:1], v80 offset:0
    ds_read_b64_tr_b16 a[2:3], v80 offset:1024
    ds_read_b64_tr_b16 a[4:5], v80 offset:8192
    ds_read_b64_tr_b16 a[6:7], v80 offset:9216
    ds_read_b64_tr_b16 a[8:9], v81 offset:0
    ds_read_b64_tr_b16 a[10:11], v81 offset:1024
    ds_read_b64_tr_b16 a[12:13], v81 offset:8192
    ds_read_b64_tr_b16 a[14:15], v81 offset:9216
    s_branch L_lw_77
L_lw_77_0:
    s_cmp_lg_u32 s44, 1
    s_cbranch_scc1 L_lw_77_1
    ds_read_b64_tr_b16 a[120:121], v80 offset:0
    ds_read_b64_tr_b16 a[122:123], v80 offset:1024
    ds_read_b64_tr_b16 a[124:125], v80 offset:8192
    ds_read_b64_tr_b16 a[126:127], v80 offset:9216
    ds_read_b64_tr_b16 v[56:57], v81 offset:0
    ds_read_b64_tr_b16 v[58:59], v81 offset:1024
    ds_read_b64_tr_b16 v[60:61], v81 offset:8192
    ds_read_b64_tr_b16 v[62:63], v81 offset:9216
    s_waitcnt lgkmcnt(0)
    ds_write_b128 v5, v[56:59] offset:0
    ds_write_b128 v5, v[60:63] offset:1024
    s_branch L_lw_77
L_lw_77_1:
    s_cmp_lg_u32 s44, 2
    s_cbranch_scc1 L_lw_77_2
    ds_read_b64_tr_b16 a[80:81], v80 offset:0
    ds_read_b64_tr_b16 a[82:83], v80 offset:1024
    ds_read_b64_tr_b16 a[84:85], v80 offset:8192
    ds_read_b64_tr_b16 a[86:87], v80 offset:9216
    ds_read_b64_tr_b16 v[56:57], v81 offset:0
    ds_read_b64_tr_b16 v[58:59], v81 offset:1024
    ds_read_b64_tr_b16 v[60:61], v81 offset:8192
    ds_read_b64_tr_b16 v[62:63], v81 offset:9216
    s_waitcnt lgkmcnt(0)
    ds_write_b128 v5, v[56:59] offset:2048
    ds_write_b128 v5, v[60:63] offset:3072
    s_branch L_lw_77
L_lw_77_2:
    ds_read_b64_tr_b16 a[48:49], v80 offset:0
    ds_read_b64_tr_b16 a[50:51], v80 offset:1024
    ds_read_b64_tr_b16 a[52:53], v80 offset:8192
    ds_read_b64_tr_b16 a[54:55], v80 offset:9216
    ds_read_b64_tr_b16 v[56:57], v81 offset:0
    ds_read_b64_tr_b16 v[58:59], v81 offset:1024
    ds_read_b64_tr_b16 v[60:61], v81 offset:8192
    ds_read_b64_tr_b16 v[62:63], v81 offset:9216
    s_waitcnt lgkmcnt(0)
    ds_write_b128 v5, v[56:59] offset:4096
    ds_write_b128 v5, v[60:63] offset:5120
L_lw_77:
    s_waitcnt lgkmcnt(0)
    s_waitcnt vmcnt(8)
    s_barrier
    s_add_u32 s79, s41, 4
    s_and_b32 s79, s79, 3
    s_lshl_b32 s79, s79, 19
    s_add_u32 s79, s79, s47
    s_add_u32 s46, s79, 0x200000
    s_add_u32 m0, s48, 0
    s_nop 0
    buffer_load_dwordx4 v82, s[32:35], s46 offen  lds
    s_add_u32 s46, s79, 0x220000
    s_add_u32 m0, s48, 4096
    s_nop 0
    buffer_load_dwordx4 v82, s[32:35], s46 offen  lds
    s_add_u32 s46, s79, 0x240000
    s_add_u32 m0, s48, 8192
    s_nop 0
    buffer_load_dwordx4 v82, s[32:35], s46 offen  lds
    s_add_u32 s46, s79, 0x260000
    s_add_u32 m0, s48, 12288
    s_nop 0
    buffer_load_dwordx4 v82, s[32:35], s46 offen  lds
    s_cmp_lg_u32 s44, 0
    s_cbranch_scc1 L_lw_78_0
    ds_read_b64_tr_b16 a[16:17], v80 offset:16384
    ds_read_b64_tr_b16 a[18:19], v80 offset:17408
    ds_read_b64_tr_b16 a[20:21], v80 offset:24576
    ds_read_b64_tr_b16 a[22:23], v80 offset:25600
    ds_read_b64_tr_b16 a[24:25], v81 offset:16384
    ds_read_b64_tr_b16 a[26:27], v81 offset:17408
    ds_read_b64_tr_b16 a[28:29], v81 offset:24576
    ds_read_b64_tr_b16 a[30:31], v81 offset:25600
    s_branch L_lw_78
L_lw_78_0:
    s_cmp_lg_u32 s44, 1
    s_cbranch_scc1 L_lw_78_1
    ds_read_b64_tr_b16 a[128:129], v80 offset:16384
    ds_read_b64_tr_b16 a[130:131], v80 offset:17408
    ds_read_b64_tr_b16 a[132:133], v80 offset:24576
    ds_read_b64_tr_b16 a[134:135], v80 offset:25600
    ds_read_b64_tr_b16 a[136:137], v81 offset:16384
    ds_read_b64_tr_b16 a[138:139], v81 offset:17408
    ds_read_b64_tr_b16 a[140:141], v81 offset:24576
    ds_read_b64_tr_b16 a[142:143], v81 offset:25600
    s_branch L_lw_78
L_lw_78_1:
    s_cmp_lg_u32 s44, 2
    s_cbranch_scc1 L_lw_78_2
    ds_read_b64_tr_b16 a[88:89], v80 offset:16384
    ds_read_b64_tr_b16 a[90:91], v80 offset:17408
    ds_read_b64_tr_b16 a[92:93], v80 offset:24576
    ds_read_b64_tr_b16 a[94:95], v80 offset:25600
    ds_read_b64_tr_b16 a[96:97], v81 offset:16384
    ds_read_b64_tr_b16 a[98:99], v81 offset:17408
    ds_read_b64_tr_b16 a[100:101], v81 offset:24576
    ds_read_b64_tr_b16 a[102:103], v81 offset:25600
    s_branch L_lw_78
L_lw_78_2:
    ds_read_b64_tr_b16 a[56:57], v80 offset:16384
    ds_read_b64_tr_b16 a[58:59], v80 offset:17408
    ds_read_b64_tr_b16 a[60:61], v80 offset:24576
    ds_read_b64_tr_b16 a[62:63], v80 offset:25600
    ds_read_b64_tr_b16 v[56:57], v81 offset:16384
    ds_read_b64_tr_b16 v[58:59], v81 offset:17408
    ds_read_b64_tr_b16 v[60:61], v81 offset:24576
    ds_read_b64_tr_b16 v[62:63], v81 offset:25600
    s_waitcnt lgkmcnt(0)
    ds_write_b128 v5, v[56:59] offset:6144
    ds_write_b128 v5, v[60:63] offset:7168
L_lw_78:
    s_waitcnt lgkmcnt(0)
    s_waitcnt vmcnt(8)
    s_barrier
    s_add_u32 s79, s41, 5
    s_and_b32 s79, s79, 3
    s_lshl_b32 s79, s79, 19
    s_add_u32 s79, s79, s47
    s_add_u32 s46, s79, 0x200000
    s_add_u32 m0, s48, 16384
    s_nop 0
    buffer_load_dwordx4 v82, s[32:35], s46 offen  lds
    s_add_u32 s46, s79, 0x220000
    s_add_u32 m0, s48, 20480
    s_nop 0
    buffer_load_dwordx4 v82, s[32:35], s46 offen  lds
    s_add_u32 s46, s79, 0x240000
    s_add_u32 m0, s48, 24576
    s_nop 0
    buffer_load_dwordx4 v82, s[32:35], s46 offen  lds
    s_add_u32 s46, s79, 0x260000
    s_add_u32 m0, s48, 28672
    s_nop 0
    buffer_load_dwordx4 v82, s[32:35], s46 offen  lds
    s_cmp_lg_u32 s44, 0
    s_cbranch_scc1 L_lw_79_0
    ds_read_b64_tr_b16 a[32:33], v80 offset:32768
    ds_read_b64_tr_b16 a[34:35], v80 offset:33792
    ds_read_b64_tr_b16 a[36:37], v80 offset:40960
    ds_read_b64_tr_b16 a[38:39], v80 offset:41984
    ds_read_b64_tr_b16 v[56:57], v81 offset:32768
    ds_read_b64_tr_b16 v[58:59], v81 offset:33792
    ds_read_b64_tr_b16 v[60:61], v81 offset:40960
    ds_read_b64_tr_b16 v[62:63], v81 offset:41984
    s_waitcnt lgkmcnt(0)
    ds_write_b128 v5, v[56:59] offset:8192
    ds_write_b128 v5, v[60:63] offset:9216
    s_branch L_lw_79
L_lw_79_0:
    s_cmp_lg_u32 s44, 1
    s_cbranch_scc1 L_lw_79_1
    ds_read_b64_tr_b16 a[144:145], v80 offset:32768
    ds_read_b64_tr_b16 a[146:147], v80 offset:33792
    ds_read_b64_tr_b16 a[148:149], v80 offset:40960
    ds_read_b64_tr_b16 a[150:151], v80 offset:41984
    ds_read_b64_tr_b16 v[56:57], v81 offset:32768
    ds_read_b64_tr_b16 v[58:59], v81 offset:33792
    ds_read_b64_tr_b16 v[60:61], v81 offset:40960
    ds_read_b64_tr_b16 v[62:63], v81 offset:41984
    s_waitcnt lgkmcnt(0)
    ds_write_b128 v5, v[56:59] offset:10240
    ds_write_b128 v5, v[60:63] offset:11264
    s_branch L_lw_79
L_lw_79_1:
    s_cmp_lg_u32 s44, 2
    s_cbranch_scc1 L_lw_79_2
    ds_read_b64_tr_b16 a[104:105], v80 offset:32768
    ds_read_b64_tr_b16 a[106:107], v80 offset:33792
    ds_read_b64_tr_b16 a[108:109], v80 offset:40960
    ds_read_b64_tr_b16 a[110:111], v80 offset:41984
    ds_read_b64_tr_b16 v[56:57], v81 offset:32768
    ds_read_b64_tr_b16 v[58:59], v81 offset:33792
    ds_read_b64_tr_b16 v[60:61], v81 offset:40960
    ds_read_b64_tr_b16 v[62:63], v81 offset:41984
    s_waitcnt lgkmcnt(0)
    ds_write_b128 v5, v[56:59] offset:12288
    ds_write_b128 v5, v[60:63] offset:13312
    s_branch L_lw_79
L_lw_79_2:
    ds_read_b64_tr_b16 a[64:65], v80 offset:32768
    ds_read_b64_tr_b16 a[66:67], v80 offset:33792
    ds_read_b64_tr_b16 a[68:69], v80 offset:40960
    ds_read_b64_tr_b16 a[70:71], v80 offset:41984
    ds_read_b64_tr_b16 v[56:57], v81 offset:32768
    ds_read_b64_tr_b16 v[58:59], v81 offset:33792
    ds_read_b64_tr_b16 v[60:61], v81 offset:40960
    ds_read_b64_tr_b16 v[62:63], v81 offset:41984
    s_waitcnt lgkmcnt(0)
    ds_write_b128 v5, v[56:59] offset:14336
    ds_write_b128 v5, v[60:63] offset:15360
L_lw_79:
    s_waitcnt lgkmcnt(0)
    s_waitcnt vmcnt(8)
    s_barrier
    s_add_u32 s79, s41, 6
    s_and_b32 s79, s79, 3
    s_lshl_b32 s79, s79, 19
    s_add_u32 s79, s79, s47
    s_add_u32 s46, s79, 0x200000
    s_add_u32 m0, s48, 32768
    s_nop 0
    buffer_load_dwordx4 v82, s[32:35], s46 offen  lds
    s_add_u32 s46, s79, 0x220000
    s_add_u32 m0, s48, 36864
    s_nop 0
    buffer_load_dwordx4 v82, s[32:35], s46 offen  lds
    s_add_u32 s46, s79, 0x240000
    s_add_u32 m0, s48, 40960
    s_nop 0
    buffer_load_dwordx4 v82, s[32:35], s46 offen  lds
    s_add_u32 s46, s79, 0x260000
    s_add_u32 m0, s48, 45056
    s_nop 0
    buffer_load_dwordx4 v82, s[32:35], s46 offen  lds
    s_cmp_lg_u32 s44, 0
    s_cbranch_scc1 L_lw_80_0
    ds_read_b64_tr_b16 a[40:41], v80 offset:49152
    ds_read_b64_tr_b16 a[42:43], v80 offset:50176
    ds_read_b64_tr_b16 a[44:45], v80 offset:57344
    ds_read_b64_tr_b16 a[46:47], v80 offset:58368
    ds_read_b64_tr_b16 v[56:57], v81 offset:49152
    ds_read_b64_tr_b16 v[58:59], v81 offset:50176
    ds_read_b64_tr_b16 v[60:61], v81 offset:57344
    ds_read_b64_tr_b16 v[62:63], v81 offset:58368
    s_waitcnt lgkmcnt(0)
    ds_write_b128 v5, v[56:59] offset:16384
    ds_write_b128 v5, v[60:63] offset:17408
    s_branch L_lw_80
L_lw_80_0:
    s_cmp_lg_u32 s44, 1
    s_cbranch_scc1 L_lw_80_1
    ds_read_b64_tr_b16 a[152:153], v80 offset:49152
    ds_read_b64_tr_b16 a[154:155], v80 offset:50176
    ds_read_b64_tr_b16 a[156:157], v80 offset:57344
    ds_read_b64_tr_b16 a[158:159], v80 offset:58368
    ds_read_b64_tr_b16 v[56:57], v81 offset:49152
    ds_read_b64_tr_b16 v[58:59], v81 offset:50176
    ds_read_b64_tr_b16 v[60:61], v81 offset:57344
    ds_read_b64_tr_b16 v[62:63], v81 offset:58368
    s_waitcnt lgkmcnt(0)
    ds_write_b128 v5, v[56:59] offset:18432
    ds_write_b128 v5, v[60:63] offset:19456
    s_branch L_lw_80
L_lw_80_1:
    s_cmp_lg_u32 s44, 2
    s_cbranch_scc1 L_lw_80_2
    ds_read_b64_tr_b16 a[112:113], v80 offset:49152
    ds_read_b64_tr_b16 a[114:115], v80 offset:50176
    ds_read_b64_tr_b16 a[116:117], v80 offset:57344
    ds_read_b64_tr_b16 a[118:119], v80 offset:58368
    ds_read_b64_tr_b16 v[56:57], v81 offset:49152
    ds_read_b64_tr_b16 v[58:59], v81 offset:50176
    ds_read_b64_tr_b16 v[60:61], v81 offset:57344
    ds_read_b64_tr_b16 v[62:63], v81 offset:58368
    s_waitcnt lgkmcnt(0)
    ds_write_b128 v5, v[56:59] offset:20480
    ds_write_b128 v5, v[60:63] offset:21504
    s_branch L_lw_80
L_lw_80_2:
    ds_read_b64_tr_b16 a[72:73], v80 offset:49152
    ds_read_b64_tr_b16 a[74:75], v80 offset:50176
    ds_read_b64_tr_b16 a[76:77], v80 offset:57344
    ds_read_b64_tr_b16 a[78:79], v80 offset:58368
    ds_read_b64_tr_b16 v[56:57], v81 offset:49152
    ds_read_b64_tr_b16 v[58:59], v81 offset:50176
    ds_read_b64_tr_b16 v[60:61], v81 offset:57344
    ds_read_b64_tr_b16 v[62:63], v81 offset:58368
    s_waitcnt lgkmcnt(0)
    ds_write_b128 v5, v[56:59] offset:22528
    ds_write_b128 v5, v[60:63] offset:23552
L_lw_80:
    s_waitcnt lgkmcnt(0)
    s_waitcnt vmcnt(8)
    s_barrier
    s_add_u32 s79, s41, 7
    s_and_b32 s79, s79, 3
    s_lshl_b32 s79, s79, 19
    s_add_u32 s79, s79, s47
    s_add_u32 s46, s79, 0x200000
    s_add_u32 m0, s48, 49152
    s_nop 0
    buffer_load_dwordx4 v82, s[32:35], s46 offen  lds
    s_add_u32 s46, s79, 0x220000
    s_add_u32 m0, s48, 53248
    s_nop 0
    buffer_load_dwordx4 v82, s[32:35], s46 offen  lds
    s_add_u32 s46, s79, 0x240000
    s_add_u32 m0, s48, 57344
    s_nop 0
    buffer_load_dwordx4 v82, s[32:35], s46 offen  lds
    s_add_u32 s46, s79, 0x260000
    s_add_u32 m0, s48, 61440
    s_nop 0
    buffer_load_dwordx4 v82, s[32:35], s46 offen  lds
    s_cmp_lg_u32 s44, 0
    s_cbranch_scc1 L_lw_81_0
    ds_read_b64_tr_b16 a[48:49], v80 offset:0
    ds_read_b64_tr_b16 a[50:51], v80 offset:1024
    ds_read_b64_tr_b16 a[52:53], v80 offset:8192
    ds_read_b64_tr_b16 a[54:55], v80 offset:9216
    ds_read_b64_tr_b16 v[56:57], v81 offset:0
    ds_read_b64_tr_b16 v[58:59], v81 offset:1024
    ds_read_b64_tr_b16 v[60:61], v81 offset:8192
    ds_read_b64_tr_b16 v[62:63], v81 offset:9216
    s_waitcnt lgkmcnt(0)
    ds_write_b128 v5, v[56:59] offset:4096
    ds_write_b128 v5, v[60:63] offset:5120
    s_branch L_lw_81
L_lw_81_0:
    s_cmp_lg_u32 s44, 1
    s_cbranch_scc1 L_lw_81_1
    ds_read_b64_tr_b16 a[0:1], v80 offset:0
    ds_read_b64_tr_b16 a[2:3], v80 offset:1024
    ds_read_b64_tr_b16 a[4:5], v80 offset:8192
    ds_read_b64_tr_b16 a[6:7], v80 offset:9216
    ds_read_b64_tr_b16 a[8:9], v81 offset:0
    ds_read_b64_tr_b16 a[10:11], v81 offset:1024
    ds_read_b64_tr_b16 a[12:13], v81 offset:8192
    ds_read_b64_tr_b16 a[14:15], v81 offset:9216
    s_branch L_lw_81
L_lw_81_1:
    s_cmp_lg_u32 s44, 2
    s_cbranch_scc1 L_lw_81_2
    ds_read_b64_tr_b16 a[120:121], v80 offset:0
    ds_read_b64_tr_b16 a[122:123], v80 offset:1024
    ds_read_b64_tr_b16 a[124:125], v80 offset:8192
    ds_read_b64_tr_b16 a[126:127], v80 offset:9216
    ds_read_b64_tr_b16 v[56:57], v81 offset:0
    ds_read_b64_tr_b16 v[58:59], v81 offset:1024
    ds_read_b64_tr_b16 v[60:61], v81 offset:8192
    ds_read_b64_tr_b16 v[62:63], v81 offset:9216
    s_waitcnt lgkmcnt(0)
    ds_write_b128 v5, v[56:59] offset:0
    ds_write_b128 v5, v[60:63] offset:1024
    s_branch L_lw_81
L_lw_81_2:
    ds_read_b64_tr_b16 a[80:81], v80 offset:0
    ds_read_b64_tr_b16 a[82:83], v80 offset:1024
    ds_read_b64_tr_b16 a[84:85], v80 offset:8192
    ds_read_b64_tr_b16 a[86:87], v80 offset:9216
    ds_read_b64_tr_b16 v[56:57], v81 offset:0
    ds_read_b64_tr_b16 v[58:59], v81 offset:1024
    ds_read_b64_tr_b16 v[60:61], v81 offset:8192
    ds_read_b64_tr_b16 v[62:63], v81 offset:9216
    s_waitcnt lgkmcnt(0)
    ds_write_b128 v5, v[56:59] offset:2048
    ds_write_b128 v5, v[60:63] offset:3072
L_lw_81:
    s_waitcnt lgkmcnt(0)
    s_waitcnt vmcnt(8)
    s_barrier
    s_add_u32 s79, s41, 8
    s_and_b32 s79, s79, 3
    s_lshl_b32 s79, s79, 19
    s_add_u32 s79, s79, s47
    s_add_u32 s46, s79, 0x400000
    s_add_u32 m0, s48, 0
    s_nop 0
    buffer_load_dwordx4 v82, s[32:35], s46 offen  lds
    s_add_u32 s46, s79, 0x420000
    s_add_u32 m0, s48, 4096
    s_nop 0
    buffer_load_dwordx4 v82, s[32:35], s46 offen  lds
    s_add_u32 s46, s79, 0x440000
    s_add_u32 m0, s48, 8192
    s_nop 0
    buffer_load_dwordx4 v82, s[32:35], s46 offen  lds
    s_add_u32 s46, s79, 0x460000
    s_add_u32 m0, s48, 12288
    s_nop 0
    buffer_load_dwordx4 v82, s[32:35], s46 offen  lds
    s_cmp_lg_u32 s44, 0
    s_cbranch_scc1 L_lw_82_0
    ds_read_b64_tr_b16 a[56:57], v80 offset:16384
    ds_read_b64_tr_b16 a[58:59], v80 offset:17408
    ds_read_b64_tr_b16 a[60:61], v80 offset:24576
    ds_read_b64_tr_b16 a[62:63], v80 offset:25600
    ds_read_b64_tr_b16 v[56:57], v81 offset:16384
    ds_read_b64_tr_b16 v[58:59], v81 offset:17408
    ds_read_b64_tr_b16 v[60:61], v81 offset:24576
    ds_read_b64_tr_b16 v[62:63], v81 offset:25600
    s_waitcnt lgkmcnt(0)
    ds_write_b128 v5, v[56:59] offset:6144
    ds_write_b128 v5, v[60:63] offset:7168
    s_branch L_lw_82
L_lw_82_0:
    s_cmp_lg_u32 s44, 1
    s_cbranch_scc1 L_lw_82_1
    ds_read_b64_tr_b16 a[16:17], v80 offset:16384
    ds_read_b64_tr_b16 a[18:19], v80 offset:17408
    ds_read_b64_tr_b16 a[20:21], v80 offset:24576
    ds_read_b64_tr_b16 a[22:23], v80 offset:25600
    ds_read_b64_tr_b16 a[24:25], v81 offset:16384
    ds_read_b64_tr_b16 a[26:27], v81 offset:17408
    ds_read_b64_tr_b16 a[28:29], v81 offset:24576
    ds_read_b64_tr_b16 a[30:31], v81 offset:25600
    s_branch L_lw_82
L_lw_82_1:
    s_cmp_lg_u32 s44, 2
    s_cbranch_scc1 L_lw_82_2
    ds_read_b64_tr_b16 a[128:129], v80 offset:16384
    ds_read_b64_tr_b16 a[130:131], v80 offset:17408
    ds_read_b64_tr_b16 a[132:133], v80 offset:24576
    ds_read_b64_tr_b16 a[134:135], v80 offset:25600
    ds_read_b64_tr_b16 a[136:137], v81 offset:16384
    ds_read_b64_tr_b16 a[138:139], v81 offset:17408
    ds_read_b64_tr_b16 a[140:141], v81 offset:24576
    ds_read_b64_tr_b16 a[142:143], v81 offset:25600
    s_branch L_lw_82
L_lw_82_2:
    ds_read_b64_tr_b16 a[88:89], v80 offset:16384
    ds_read_b64_tr_b16 a[90:91], v80 offset:17408
    ds_read_b64_tr_b16 a[92:93], v80 offset:24576
    ds_read_b64_tr_b16 a[94:95], v80 offset:25600
    ds_read_b64_tr_b16 a[96:97], v81 offset:16384
    ds_read_b64_tr_b16 a[98:99], v81 offset:17408
    ds_read_b64_tr_b16 a[100:101], v81 offset:24576
    ds_read_b64_tr_b16 a[102:103], v81 offset:25600
L_lw_82:
    s_waitcnt lgkmcnt(0)
    s_waitcnt vmcnt(8)
    s_barrier
    s_add_u32 s79, s41, 9
    s_and_b32 s79, s79, 3
    s_lshl_b32 s79, s79, 19
    s_add_u32 s79, s79, s47
    s_add_u32 s46, s79, 0x400000
    s_add_u32 m0, s48, 16384
    s_nop 0
    buffer_load_dwordx4 v82, s[32:35], s46 offen  lds
    s_add_u32 s46, s79, 0x420000
    s_add_u32 m0, s48, 20480
    s_nop 0
    buffer_load_dwordx4 v82, s[32:35], s46 offen  lds
    s_add_u32 s46, s79, 0x440000
    s_add_u32 m0, s48, 24576
    s_nop 0
    buffer_load_dwordx4 v82, s[32:35], s46 offen  lds
    s_add_u32 s46, s79, 0x460000
    s_add_u32 m0, s48, 28672
    s_nop 0
    buffer_load_dwordx4 v82, s[32:35], s46 offen  lds
    s_cmp_lg_u32 s44, 0
    s_cbranch_scc1 L_lw_83_0
    ds_read_b64_tr_b16 a[64:65], v80 offset:32768
    ds_read_b64_tr_b16 a[66:67], v80 offset:33792
    ds_read_b64_tr_b16 a[68:69], v80 offset:40960
    ds_read_b64_tr_b16 a[70:71], v80 offset:41984
    ds_read_b64_tr_b16 v[56:57], v81 offset:32768
    ds_read_b64_tr_b16 v[58:59], v81 offset:33792
    ds_read_b64_tr_b16 v[60:61], v81 offset:40960
    ds_read_b64_tr_b16 v[62:63], v81 offset:41984
    s_waitcnt lgkmcnt(0)
    ds_write_b128 v5, v[56:59] offset:14336
    ds_write_b128 v5, v[60:63] offset:15360
    s_branch L_lw_83
L_lw_83_0:
    s_cmp_lg_u32 s44, 1
    s_cbranch_scc1 L_lw_83_1
    ds_read_b64_tr_b16 a[32:33], v80 offset:32768
    ds_read_b64_tr_b16 a[34:35], v80 offset:33792
    ds_read_b64_tr_b16 a[36:37], v80 offset:40960
    ds_read_b64_tr_b16 a[38:39], v80 offset:41984
    ds_read_b64_tr_b16 v[56:57], v81 offset:32768
    ds_read_b64_tr_b16 v[58:59], v81 offset:33792
    ds_read_b64_tr_b16 v[60:61], v81 offset:40960
    ds_read_b64_tr_b16 v[62:63], v81 offset:41984
    s_waitcnt lgkmcnt(0)
    ds_write_b128 v5, v[56:59] offset:8192
    ds_write_b128 v5, v[60:63] offset:9216
    s_branch L_lw_83
L_lw_83_1:
    s_cmp_lg_u32 s44, 2
    s_cbranch_scc1 L_lw_83_2
    ds_read_b64_tr_b16 a[144:145], v80 offset:32768
    ds_read_b64_tr_b16 a[146:147], v80 offset:33792
    ds_read_b64_tr_b16 a[148:149], v80 offset:40960
    ds_read_b64_tr_b16 a[150:151], v80 offset:41984
    ds_read_b64_tr_b16 v[56:57], v81 offset:32768
    ds_read_b64_tr_b16 v[58:59], v81 offset:33792
    ds_read_b64_tr_b16 v[60:61], v81 offset:40960
    ds_read_b64_tr_b16 v[62:63], v81 offset:41984
    s_waitcnt lgkmcnt(0)
    ds_write_b128 v5, v[56:59] offset:10240
    ds_write_b128 v5, v[60:63] offset:11264
    s_branch L_lw_83
L_lw_83_2:
    ds_read_b64_tr_b16 a[104:105], v80 offset:32768
    ds_read_b64_tr_b16 a[106:107], v80 offset:33792
    ds_read_b64_tr_b16 a[108:109], v80 offset:40960
    ds_read_b64_tr_b16 a[110:111], v80 offset:41984
    ds_read_b64_tr_b16 v[56:57], v81 offset:32768
    ds_read_b64_tr_b16 v[58:59], v81 offset:33792
    ds_read_b64_tr_b16 v[60:61], v81 offset:40960
    ds_read_b64_tr_b16 v[62:63], v81 offset:41984
    s_waitcnt lgkmcnt(0)
    ds_write_b128 v5, v[56:59] offset:12288
    ds_write_b128 v5, v[60:63] offset:13312
L_lw_83:
    s_waitcnt lgkmcnt(0)
    s_waitcnt vmcnt(8)
    s_barrier
    s_add_u32 s79, s41, 10
    s_and_b32 s79, s79, 3
    s_lshl_b32 s79, s79, 19
    s_add_u32 s79, s79, s47
    s_add_u32 s46, s79, 0x400000
    s_add_u32 m0, s48, 32768
    s_nop 0
    buffer_load_dwordx4 v82, s[32:35], s46 offen  lds
    s_add_u32 s46, s79, 0x420000
    s_add_u32 m0, s48, 36864
    s_nop 0
    buffer_load_dwordx4 v82, s[32:35], s46 offen  lds
    s_add_u32 s46, s79, 0x440000
    s_add_u32 m0, s48, 40960
    s_nop 0
    buffer_load_dwordx4 v82, s[32:35], s46 offen  lds
    s_add_u32 s46, s79, 0x460000
    s_add_u32 m0, s48, 45056
    s_nop 0
    buffer_load_dwordx4 v82, s[32:35], s46 offen  lds
    s_cmp_lg_u32 s44, 0
    s_cbranch_scc1 L_lw_84_0
    ds_read_b64_tr_b16 a[72:73], v80 offset:49152
    ds_read_b64_tr_b16 a[74:75], v80 offset:50176
    ds_read_b64_tr_b16 a[76:77], v80 offset:57344
    ds_read_b64_tr_b16 a[78:79], v80 offset:58368
    ds_read_b64_tr_b16 v[56:57], v81 offset:49152
    ds_read_b64_tr_b16 v[58:59], v81 offset:50176
    ds_read_b64_tr_b16 v[60:61], v81 offset:57344
    ds_read_b64_tr_b16 v[62:63], v81 offset:58368
    s_waitcnt lgkmcnt(0)
    ds_write_b128 v5, v[56:59] offset:22528
    ds_write_b128 v5, v[60:63] offset:23552
    s_branch L_lw_84
L_lw_84_0:
    s_cmp_lg_u32 s44, 1
    s_cbranch_scc1 L_lw_84_1
    ds_read_b64_tr_b16 a[40:41], v80 offset:49152
    ds_read_b64_tr_b16 a[42:43], v80 offset:50176
    ds_read_b64_tr_b16 a[44:45], v80 offset:57344
    ds_read_b64_tr_b16 a[46:47], v80 offset:58368
    ds_read_b64_tr_b16 v[56:57], v81 offset:49152
    ds_read_b64_tr_b16 v[58:59], v81 offset:50176
    ds_read_b64_tr_b16 v[60:61], v81 offset:57344
    ds_read_b64_tr_b16 v[62:63], v81 offset:58368
    s_waitcnt lgkmcnt(0)
    ds_write_b128 v5, v[56:59] offset:16384
    ds_write_b128 v5, v[60:63] offset:17408
    s_branch L_lw_84
L_lw_84_1:
    s_cmp_lg_u32 s44, 2
    s_cbranch_scc1 L_lw_84_2
    ds_read_b64_tr_b16 a[152:153], v80 offset:49152
    ds_read_b64_tr_b16 a[154:155], v80 offset:50176
    ds_read_b64_tr_b16 a[156:157], v80 offset:57344
    ds_read_b64_tr_b16 a[158:159], v80 offset:58368
    ds_read_b64_tr_b16 v[56:57], v81 offset:49152
    ds_read_b64_tr_b16 v[58:59], v81 offset:50176
    ds_read_b64_tr_b16 v[60:61], v81 offset:57344
    ds_read_b64_tr_b16 v[62:63], v81 offset:58368
    s_waitcnt lgkmcnt(0)
    ds_write_b128 v5, v[56:59] offset:18432
    ds_write_b128 v5, v[60:63] offset:19456
    s_branch L_lw_84
L_lw_84_2:
    ds_read_b64_tr_b16 a[112:113], v80 offset:49152
    ds_read_b64_tr_b16 a[114:115], v80 offset:50176
    ds_read_b64_tr_b16 a[116:117], v80 offset:57344
    ds_read_b64_tr_b16 a[118:119], v80 offset:58368
    ds_read_b64_tr_b16 v[56:57], v81 offset:49152
    ds_read_b64_tr_b16 v[58:59], v81 offset:50176
    ds_read_b64_tr_b16 v[60:61], v81 offset:57344
    ds_read_b64_tr_b16 v[62:63], v81 offset:58368
    s_waitcnt lgkmcnt(0)
    ds_write_b128 v5, v[56:59] offset:20480
    ds_write_b128 v5, v[60:63] offset:21504
L_lw_84:
    s_waitcnt lgkmcnt(0)
    s_waitcnt vmcnt(8)
    s_barrier
    s_add_u32 s79, s41, 11
    s_and_b32 s79, s79, 3
    s_lshl_b32 s79, s79, 19
    s_add_u32 s79, s79, s47
    s_add_u32 s46, s79, 0x400000
    s_add_u32 m0, s48, 49152
    s_nop 0
    buffer_load_dwordx4 v82, s[32:35], s46 offen  lds
    s_add_u32 s46, s79, 0x420000
    s_add_u32 m0, s48, 53248
    s_nop 0
    buffer_load_dwordx4 v82, s[32:35], s46 offen  lds
    s_add_u32 s46, s79, 0x440000
    s_add_u32 m0, s48, 57344
    s_nop 0
    buffer_load_dwordx4 v82, s[32:35], s46 offen  lds
    s_add_u32 s46, s79, 0x460000
    s_add_u32 m0, s48, 61440
    s_nop 0
    buffer_load_dwordx4 v82, s[32:35], s46 offen  lds
    s_cmp_lg_u32 s44, 0
    s_cbranch_scc1 L_lw_85_0
    ds_read_b64_tr_b16 a[80:81], v80 offset:0
    ds_read_b64_tr_b16 a[82:83], v80 offset:1024
    ds_read_b64_tr_b16 a[84:85], v80 offset:8192
    ds_read_b64_tr_b16 a[86:87], v80 offset:9216
    ds_read_b64_tr_b16 v[56:57], v81 offset:0
    ds_read_b64_tr_b16 v[58:59], v81 offset:1024
    ds_read_b64_tr_b16 v[60:61], v81 offset:8192
    ds_read_b64_tr_b16 v[62:63], v81 offset:9216
    s_waitcnt lgkmcnt(0)
    ds_write_b128 v5, v[56:59] offset:2048
    ds_write_b128 v5, v[60:63] offset:3072
    s_branch L_lw_85
L_lw_85_0:
    s_cmp_lg_u32 s44, 1
    s_cbranch_scc1 L_lw_85_1
    ds_read_b64_tr_b16 a[48:49], v80 offset:0
    ds_read_b64_tr_b16 a[50:51], v80 offset:1024
    ds_read_b64_tr_b16 a[52:53], v80 offset:8192
    ds_read_b64_tr_b16 a[54:55], v80 offset:9216
    ds_read_b64_tr_b16 v[56:57], v81 offset:0
    ds_read_b64_tr_b16 v[58:59], v81 offset:1024
    ds_read_b64_tr_b16 v[60:61], v81 offset:8192
    ds_read_b64_tr_b16 v[62:63], v81 offset:9216
    s_waitcnt lgkmcnt(0)
    ds_write_b128 v5, v[56:59] offset:4096
    ds_write_b128 v5, v[60:63] offset:5120
    s_branch L_lw_85
L_lw_85_1:
    s_cmp_lg_u32 s44, 2
    s_cbranch_scc1 L_lw_85_2
    ds_read_b64_tr_b16 a[0:1], v80 offset:0
    ds_read_b64_tr_b16 a[2:3], v80 offset:1024
    ds_read_b64_tr_b16 a[4:5], v80 offset:8192
    ds_read_b64_tr_b16 a[6:7], v80 offset:9216
    ds_read_b64_tr_b16 a[8:9], v81 offset:0
    ds_read_b64_tr_b16 a[10:11], v81 offset:1024
    ds_read_b64_tr_b16 a[12:13], v81 offset:8192
    ds_read_b64_tr_b16 a[14:15], v81 offset:9216
    s_branch L_lw_85
L_lw_85_2:
    ds_read_b64_tr_b16 a[120:121], v80 offset:0
    ds_read_b64_tr_b16 a[122:123], v80 offset:1024
    ds_read_b64_tr_b16 a[124:125], v80 offset:8192
    ds_read_b64_tr_b16 a[126:127], v80 offset:9216
    ds_read_b64_tr_b16 v[56:57], v81 offset:0
    ds_read_b64_tr_b16 v[58:59], v81 offset:1024
    ds_read_b64_tr_b16 v[60:61], v81 offset:8192
    ds_read_b64_tr_b16 v[62:63], v81 offset:9216
    s_waitcnt lgkmcnt(0)
    ds_write_b128 v5, v[56:59] offset:0
    ds_write_b128 v5, v[60:63] offset:1024
L_lw_85:
    s_waitcnt lgkmcnt(0)
    s_waitcnt vmcnt(8)
    s_barrier
    s_add_u32 s79, s41, 12
    s_and_b32 s79, s79, 3
    s_lshl_b32 s79, s79, 19
    s_add_u32 s79, s79, s47
    s_add_u32 s46, s79, 0x600000
    s_add_u32 m0, s48, 0
    s_nop 0
    buffer_load_dwordx4 v82, s[32:35], s46 offen  lds
    s_add_u32 s46, s79, 0x620000
    s_add_u32 m0, s48, 4096
    s_nop 0
    buffer_load_dwordx4 v82, s[32:35], s46 offen  lds
    s_add_u32 s46, s79, 0x640000
    s_add_u32 m0, s48, 8192
    s_nop 0
    buffer_load_dwordx4 v82, s[32:35], s46 offen  lds
    s_add_u32 s46, s79, 0x660000
    s_add_u32 m0, s48, 12288
    s_nop 0
    buffer_load_dwordx4 v82, s[32:35], s46 offen  lds
    s_cmp_lg_u32 s44, 0
    s_cbranch_scc1 L_lw_86_0
    ds_read_b64_tr_b16 a[88:89], v80 offset:16384
    ds_read_b64_tr_b16 a[90:91], v80 offset:17408
    ds_read_b64_tr_b16 a[92:93], v80 offset:24576
    ds_read_b64_tr_b16 a[94:95], v80 offset:25600
    ds_read_b64_tr_b16 a[96:97], v81 offset:16384
    ds_read_b64_tr_b16 a[98:99], v81 offset:17408
    ds_read_b64_tr_b16 a[100:101], v81 offset:24576
    ds_read_b64_tr_b16 a[102:103], v81 offset:25600
    s_branch L_lw_86
L_lw_86_0:
    s_cmp_lg_u32 s44, 1
    s_cbranch_scc1 L_lw_86_1
    ds_read_b64_tr_b16 a[56:57], v80 offset:16384
    ds_read_b64_tr_b16 a[58:59], v80 offset:17408
    ds_read_b64_tr_b16 a[60:61], v80 offset:24576
    ds_read_b64_tr_b16 a[62:63], v80 offset:25600
    ds_read_b64_tr_b16 v[56:57], v81 offset:16384
    ds_read_b64_tr_b16 v[58:59], v81 offset:17408
    ds_read_b64_tr_b16 v[60:61], v81 offset:24576
    ds_read_b64_tr_b16 v[62:63], v81 offset:25600
    s_waitcnt lgkmcnt(0)
    ds_write_b128 v5, v[56:59] offset:6144
    ds_write_b128 v5, v[60:63] offset:7168
    s_branch L_lw_86
L_lw_86_1:
    s_cmp_lg_u32 s44, 2
    s_cbranch_scc1 L_lw_86_2
    ds_read_b64_tr_b16 a[16:17], v80 offset:16384
    ds_read_b64_tr_b16 a[18:19], v80 offset:17408
    ds_read_b64_tr_b16 a[20:21], v80 offset:24576
    ds_read_b64_tr_b16 a[22:23], v80 offset:25600
    ds_read_b64_tr_b16 a[24:25], v81 offset:16384
    ds_read_b64_tr_b16 a[26:27], v81 offset:17408
    ds_read_b64_tr_b16 a[28:29], v81 offset:24576
    ds_read_b64_tr_b16 a[30:31], v81 offset:25600
    s_branch L_lw_86
L_lw_86_2:
    ds_read_b64_tr_b16 a[128:129], v80 offset:16384
    ds_read_b64_tr_b16 a[130:131], v80 offset:17408
    ds_read_b64_tr_b16 a[132:133], v80 offset:24576
    ds_read_b64_tr_b16 a[134:135], v80 offset:25600
    ds_read_b64_tr_b16 a[136:137], v81 offset:16384
    ds_read_b64_tr_b16 a[138:139], v81 offset:17408
    ds_read_b64_tr_b16 a[140:141], v81 offset:24576
    ds_read_b64_tr_b16 a[142:143], v81 offset:25600
L_lw_86:
    s_waitcnt lgkmcnt(0)
    s_waitcnt vmcnt(8)
    s_barrier
    s_add_u32 s79, s41, 13
    s_and_b32 s79, s79, 3
    s_lshl_b32 s79, s79, 19
    s_add_u32 s79, s79, s47
    s_add_u32 s46, s79, 0x600000
    s_add_u32 m0, s48, 16384
    s_nop 0
    buffer_load_dwordx4 v82, s[32:35], s46 offen  lds
    s_add_u32 s46, s79, 0x620000
    s_add_u32 m0, s48, 20480
    s_nop 0
    buffer_load_dwordx4 v82, s[32:35], s46 offen  lds
    s_add_u32 s46, s79, 0x640000
    s_add_u32 m0, s48, 24576
    s_nop 0
    buffer_load_dwordx4 v82, s[32:35], s46 offen  lds
    s_add_u32 s46, s79, 0x660000
    s_add_u32 m0, s48, 28672
    s_nop 0
    buffer_load_dwordx4 v82, s[32:35], s46 offen  lds
    s_cmp_lg_u32 s44, 0
    s_cbranch_scc1 L_lw_87_0
    ds_read_b64_tr_b16 a[104:105], v80 offset:32768
    ds_read_b64_tr_b16 a[106:107], v80 offset:33792
    ds_read_b64_tr_b16 a[108:109], v80 offset:40960
    ds_read_b64_tr_b16 a[110:111], v80 offset:41984
    ds_read_b64_tr_b16 v[56:57], v81 offset:32768
    ds_read_b64_tr_b16 v[58:59], v81 offset:33792
    ds_read_b64_tr_b16 v[60:61], v81 offset:40960
    ds_read_b64_tr_b16 v[62:63], v81 offset:41984
    s_waitcnt lgkmcnt(0)
    ds_write_b128 v5, v[56:59] offset:12288
    ds_write_b128 v5, v[60:63] offset:13312
    s_branch L_lw_87
L_lw_87_0:
    s_cmp_lg_u32 s44, 1
    s_cbranch_scc1 L_lw_87_1
    ds_read_b64_tr_b16 a[64:65], v80 offset:32768
    ds_read_b64_tr_b16 a[66:67], v80 offset:33792
    ds_read_b64_tr_b16 a[68:69], v80 offset:40960
    ds_read_b64_tr_b16 a[70:71], v80 offset:41984
    ds_read_b64_tr_b16 v[56:57], v81 offset:32768
    ds_read_b64_tr_b16 v[58:59], v81 offset:33792
    ds_read_b64_tr_b16 v[60:61], v81 offset:40960
    ds_read_b64_tr_b16 v[62:63], v81 offset:41984
    s_waitcnt lgkmcnt(0)
    ds_write_b128 v5, v[56:59] offset:14336
    ds_write_b128 v5, v[60:63] offset:15360
    s_branch L_lw_87
L_lw_87_1:
    s_cmp_lg_u32 s44, 2
    s_cbranch_scc1 L_lw_87_2
    ds_read_b64_tr_b16 a[32:33], v80 offset:32768
    ds_read_b64_tr_b16 a[34:35], v80 offset:33792
    ds_read_b64_tr_b16 a[36:37], v80 offset:40960
    ds_read_b64_tr_b16 a[38:39], v80 offset:41984
    ds_read_b64_tr_b16 v[56:57], v81 offset:32768
    ds_read_b64_tr_b16 v[58:59], v81 offset:33792
    ds_read_b64_tr_b16 v[60:61], v81 offset:40960
    ds_read_b64_tr_b16 v[62:63], v81 offset:41984
    s_waitcnt lgkmcnt(0)
    ds_write_b128 v5, v[56:59] offset:8192
    ds_write_b128 v5, v[60:63] offset:9216
    s_branch L_lw_87
L_lw_87_2:
    ds_read_b64_tr_b16 a[144:145], v80 offset:32768
    ds_read_b64_tr_b16 a[146:147], v80 offset:33792
    ds_read_b64_tr_b16 a[148:149], v80 offset:40960
    ds_read_b64_tr_b16 a[150:151], v80 offset:41984
    ds_read_b64_tr_b16 v[56:57], v81 offset:32768
    ds_read_b64_tr_b16 v[58:59], v81 offset:33792
    ds_read_b64_tr_b16 v[60:61], v81 offset:40960
    ds_read_b64_tr_b16 v[62:63], v81 offset:41984
    s_waitcnt lgkmcnt(0)
    ds_write_b128 v5, v[56:59] offset:10240
    ds_write_b128 v5, v[60:63] offset:11264
L_lw_87:
    s_waitcnt lgkmcnt(0)
    s_waitcnt vmcnt(8)
    s_barrier
    s_add_u32 s79, s41, 14
    s_and_b32 s79, s79, 3
    s_lshl_b32 s79, s79, 19
    s_add_u32 s79, s79, s47
    s_add_u32 s46, s79, 0x600000
    s_add_u32 m0, s48, 32768
    s_nop 0
    buffer_load_dwordx4 v82, s[32:35], s46 offen  lds
    s_add_u32 s46, s79, 0x620000
    s_add_u32 m0, s48, 36864
    s_nop 0
    buffer_load_dwordx4 v82, s[32:35], s46 offen  lds
    s_add_u32 s46, s79, 0x640000
    s_add_u32 m0, s48, 40960
    s_nop 0
    buffer_load_dwordx4 v82, s[32:35], s46 offen  lds
    s_add_u32 s46, s79, 0x660000
    s_add_u32 m0, s48, 45056
    s_nop 0
    buffer_load_dwordx4 v82, s[32:35], s46 offen  lds
    s_cmp_lg_u32 s44, 0
    s_cbranch_scc1 L_lw_88_0
    ds_read_b64_tr_b16 a[112:113], v80 offset:49152
    ds_read_b64_tr_b16 a[114:115], v80 offset:50176
    ds_read_b64_tr_b16 a[116:117], v80 offset:57344
    ds_read_b64_tr_b16 a[118:119], v80 offset:58368
    ds_read_b64_tr_b16 v[56:57], v81 offset:49152
    ds_read_b64_tr_b16 v[58:59], v81 offset:50176
    ds_read_b64_tr_b16 v[60:61], v81 offset:57344
    ds_read_b64_tr_b16 v[62:63], v81 offset:58368
    s_waitcnt lgkmcnt(0)
    ds_write_b128 v5, v[56:59] offset:20480
    ds_write_b128 v5, v[60:63] offset:21504
    s_branch L_lw_88
L_lw_88_0:
    s_cmp_lg_u32 s44, 1
    s_cbranch_scc1 L_lw_88_1
    ds_read_b64_tr_b16 a[72:73], v80 offset:49152
    ds_read_b64_tr_b16 a[74:75], v80 offset:50176
    ds_read_b64_tr_b16 a[76:77], v80 offset:57344
    ds_read_b64_tr_b16 a[78:79], v80 offset:58368
    ds_read_b64_tr_b16 v[56:57], v81 offset:49152
    ds_read_b64_tr_b16 v[58:59], v81 offset:50176
    ds_read_b64_tr_b16 v[60:61], v81 offset:57344
    ds_read_b64_tr_b16 v[62:63], v81 offset:58368
    s_waitcnt lgkmcnt(0)
    ds_write_b128 v5, v[56:59] offset:22528
    ds_write_b128 v5, v[60:63] offset:23552
    s_branch L_lw_88
L_lw_88_1:
    s_cmp_lg_u32 s44, 2
    s_cbranch_scc1 L_lw_88_2
    ds_read_b64_tr_b16 a[40:41], v80 offset:49152
    ds_read_b64_tr_b16 a[42:43], v80 offset:50176
    ds_read_b64_tr_b16 a[44:45], v80 offset:57344
    ds_read_b64_tr_b16 a[46:47], v80 offset:58368
    ds_read_b64_tr_b16 v[56:57], v81 offset:49152
    ds_read_b64_tr_b16 v[58:59], v81 offset:50176
    ds_read_b64_tr_b16 v[60:61], v81 offset:57344
    ds_read_b64_tr_b16 v[62:63], v81 offset:58368
    s_waitcnt lgkmcnt(0)
    ds_write_b128 v5, v[56:59] offset:16384
    ds_write_b128 v5, v[60:63] offset:17408
    s_branch L_lw_88
L_lw_88_2:
    ds_read_b64_tr_b16 a[152:153], v80 offset:49152
    ds_read_b64_tr_b16 a[154:155], v80 offset:50176
    ds_read_b64_tr_b16 a[156:157], v80 offset:57344
    ds_read_b64_tr_b16 a[158:159], v80 offset:58368
    ds_read_b64_tr_b16 v[56:57], v81 offset:49152
    ds_read_b64_tr_b16 v[58:59], v81 offset:50176
    ds_read_b64_tr_b16 v[60:61], v81 offset:57344
    ds_read_b64_tr_b16 v[62:63], v81 offset:58368
    s_waitcnt lgkmcnt(0)
    ds_write_b128 v5, v[56:59] offset:18432
    ds_write_b128 v5, v[60:63] offset:19456
L_lw_88:
    s_waitcnt lgkmcnt(0)
    s_waitcnt vmcnt(8)
    s_barrier
    s_add_u32 s79, s41, 15
    s_and_b32 s79, s79, 3
    s_lshl_b32 s79, s79, 19
    s_add_u32 s79, s79, s47
    s_add_u32 s46, s79, 0x600000
    s_add_u32 m0, s48, 49152
    s_nop 0
    buffer_load_dwordx4 v82, s[32:35], s46 offen  lds
    s_add_u32 s46, s79, 0x620000
    s_add_u32 m0, s48, 53248
    s_nop 0
    buffer_load_dwordx4 v82, s[32:35], s46 offen  lds
    s_add_u32 s46, s79, 0x640000
    s_add_u32 m0, s48, 57344
    s_nop 0
    buffer_load_dwordx4 v82, s[32:35], s46 offen  lds
    s_add_u32 s46, s79, 0x660000
    s_add_u32 m0, s48, 61440
    s_nop 0
    buffer_load_dwordx4 v82, s[32:35], s46 offen  lds
    s_cmp_lg_u32 s44, 0
    s_cbranch_scc1 L_lw_89_0
    ds_read_b64_tr_b16 a[120:121], v80 offset:0
    ds_read_b64_tr_b16 a[122:123], v80 offset:1024
    ds_read_b64_tr_b16 a[124:125], v80 offset:8192
    ds_read_b64_tr_b16 a[126:127], v80 offset:9216
    ds_read_b64_tr_b16 v[56:57], v81 offset:0
    ds_read_b64_tr_b16 v[58:59], v81 offset:1024
    ds_read_b64_tr_b16 v[60:61], v81 offset:8192
    ds_read_b64_tr_b16 v[62:63], v81 offset:9216
    s_waitcnt lgkmcnt(0)
    ds_write_b128 v5, v[56:59] offset:0
    ds_write_b128 v5, v[60:63] offset:1024
    s_branch L_lw_89
L_lw_89_0:
    s_cmp_lg_u32 s44, 1
    s_cbranch_scc1 L_lw_89_1
    ds_read_b64_tr_b16 a[80:81], v80 offset:0
    ds_read_b64_tr_b16 a[82:83], v80 offset:1024
    ds_read_b64_tr_b16 a[84:85], v80 offset:8192
    ds_read_b64_tr_b16 a[86:87], v80 offset:9216
    ds_read_b64_tr_b16 v[56:57], v81 offset:0
    ds_read_b64_tr_b16 v[58:59], v81 offset:1024
    ds_read_b64_tr_b16 v[60:61], v81 offset:8192
    ds_read_b64_tr_b16 v[62:63], v81 offset:9216
    s_waitcnt lgkmcnt(0)
    ds_write_b128 v5, v[56:59] offset:2048
    ds_write_b128 v5, v[60:63] offset:3072
    s_branch L_lw_89
L_lw_89_1:
    s_cmp_lg_u32 s44, 2
    s_cbranch_scc1 L_lw_89_2
    ds_read_b64_tr_b16 a[48:49], v80 offset:0
    ds_read_b64_tr_b16 a[50:51], v80 offset:1024
    ds_read_b64_tr_b16 a[52:53], v80 offset:8192
    ds_read_b64_tr_b16 a[54:55], v80 offset:9216
    ds_read_b64_tr_b16 v[56:57], v81 offset:0
    ds_read_b64_tr_b16 v[58:59], v81 offset:1024
    ds_read_b64_tr_b16 v[60:61], v81 offset:8192
    ds_read_b64_tr_b16 v[62:63], v81 offset:9216
    s_waitcnt lgkmcnt(0)
    ds_write_b128 v5, v[56:59] offset:4096
    ds_write_b128 v5, v[60:63] offset:5120
    s_branch L_lw_89
L_lw_89_2:
    ds_read_b64_tr_b16 a[0:1], v80 offset:0
    ds_read_b64_tr_b16 a[2:3], v80 offset:1024
    ds_read_b64_tr_b16 a[4:5], v80 offset:8192
    ds_read_b64_tr_b16 a[6:7], v80 offset:9216
    ds_read_b64_tr_b16 a[8:9], v81 offset:0
    ds_read_b64_tr_b16 a[10:11], v81 offset:1024
    ds_read_b64_tr_b16 a[12:13], v81 offset:8192
    ds_read_b64_tr_b16 a[14:15], v81 offset:9216
L_lw_89:
    s_waitcnt lgkmcnt(0)
    s_waitcnt vmcnt(8)
    s_barrier
    s_cmp_lg_u32 s44, 0
    s_cbranch_scc1 L_lw_90_0
    ds_read_b64_tr_b16 a[128:129], v80 offset:16384
    ds_read_b64_tr_b16 a[130:131], v80 offset:17408
    ds_read_b64_tr_b16 a[132:133], v80 offset:24576
    ds_read_b64_tr_b16 a[134:135], v80 offset:25600
    ds_read_b64_tr_b16 a[136:137], v81 offset:16384
    ds_read_b64_tr_b16 a[138:139], v81 offset:17408
    ds_read_b64_tr_b16 a[140:141], v81 offset:24576
    ds_read_b64_tr_b16 a[142:143], v81 offset:25600
    s_branch L_lw_90
L_lw_90_0:
    s_cmp_lg_u32 s44, 1
    s_cbranch_scc1 L_lw_90_1
    ds_read_b64_tr_b16 a[88:89], v80 offset:16384
    ds_read_b64_tr_b16 a[90:91], v80 offset:17408
    ds_read_b64_tr_b16 a[92:93], v80 offset:24576
    ds_read_b64_tr_b16 a[94:95], v80 offset:25600
    ds_read_b64_tr_b16 a[96:97], v81 offset:16384
    ds_read_b64_tr_b16 a[98:99], v81 offset:17408
    ds_read_b64_tr_b16 a[100:101], v81 offset:24576
    ds_read_b64_tr_b16 a[102:103], v81 offset:25600
    s_branch L_lw_90
L_lw_90_1:
    s_cmp_lg_u32 s44, 2
    s_cbranch_scc1 L_lw_90_2
    ds_read_b64_tr_b16 a[56:57], v80 offset:16384
    ds_read_b64_tr_b16 a[58:59], v80 offset:17408
    ds_read_b64_tr_b16 a[60:61], v80 offset:24576
    ds_read_b64_tr_b16 a[62:63], v80 offset:25600
    ds_read_b64_tr_b16 v[56:57], v81 offset:16384
    ds_read_b64_tr_b16 v[58:59], v81 offset:17408
    ds_read_b64_tr_b16 v[60:61], v81 offset:24576
    ds_read_b64_tr_b16 v[62:63], v81 offset:25600
    s_waitcnt lgkmcnt(0)
    ds_write_b128 v5, v[56:59] offset:6144
    ds_write_b128 v5, v[60:63] offset:7168
    s_branch L_lw_90
L_lw_90_2:
    ds_read_b64_tr_b16 a[16:17], v80 offset:16384
    ds_read_b64_tr_b16 a[18:19], v80 offset:17408
    ds_read_b64_tr_b16 a[20:21], v80 offset:24576
    ds_read_b64_tr_b16 a[22:23], v80 offset:25600
    ds_read_b64_tr_b16 a[24:25], v81 offset:16384
    ds_read_b64_tr_b16 a[26:27], v81 offset:17408
    ds_read_b64_tr_b16 a[28:29], v81 offset:24576
    ds_read_b64_tr_b16 a[30:31], v81 offset:25600
L_lw_90:
    s_waitcnt lgkmcnt(0)
    s_waitcnt vmcnt(4)
    s_barrier
    s_cmp_lg_u32 s44, 0
    s_cbranch_scc1 L_lw_91_0
    ds_read_b64_tr_b16 a[144:145], v80 offset:32768
    ds_read_b64_tr_b16 a[146:147], v80 offset:33792
    ds_read_b64_tr_b16 a[148:149], v80 offset:40960
    ds_read_b64_tr_b16 a[150:151], v80 offset:41984
    ds_read_b64_tr_b16 v[56:57], v81 offset:32768
    ds_read_b64_tr_b16 v[58:59], v81 offset:33792
    ds_read_b64_tr_b16 v[60:61], v81 offset:40960
    ds_read_b64_tr_b16 v[62:63], v81 offset:41984
    s_waitcnt lgkmcnt(0)
    ds_write_b128 v5, v[56:59] offset:10240
    ds_write_b128 v5, v[60:63] offset:11264
    s_branch L_lw_91
L_lw_91_0:
    s_cmp_lg_u32 s44, 1
    s_cbranch_scc1 L_lw_91_1
    ds_read_b64_tr_b16 a[104:105], v80 offset:32768
    ds_read_b64_tr_b16 a[106:107], v80 offset:33792
    ds_read_b64_tr_b16 a[108:109], v80 offset:40960
    ds_read_b64_tr_b16 a[110:111], v80 offset:41984
    ds_read_b64_tr_b16 v[56:57], v81 offset:32768
    ds_read_b64_tr_b16 v[58:59], v81 offset:33792
    ds_read_b64_tr_b16 v[60:61], v81 offset:40960
    ds_read_b64_tr_b16 v[62:63], v81 offset:41984
    s_waitcnt lgkmcnt(0)
    ds_write_b128 v5, v[56:59] offset:12288
    ds_write_b128 v5, v[60:63] offset:13312
    s_branch L_lw_91
L_lw_91_1:
    s_cmp_lg_u32 s44, 2
    s_cbranch_scc1 L_lw_91_2
    ds_read_b64_tr_b16 a[64:65], v80 offset:32768
    ds_read_b64_tr_b16 a[66:67], v80 offset:33792
    ds_read_b64_tr_b16 a[68:69], v80 offset:40960
    ds_read_b64_tr_b16 a[70:71], v80 offset:41984
    ds_read_b64_tr_b16 v[56:57], v81 offset:32768
    ds_read_b64_tr_b16 v[58:59], v81 offset:33792
    ds_read_b64_tr_b16 v[60:61], v81 offset:40960
    ds_read_b64_tr_b16 v[62:63], v81 offset:41984
    s_waitcnt lgkmcnt(0)
    ds_write_b128 v5, v[56:59] offset:14336
    ds_write_b128 v5, v[60:63] offset:15360
    s_branch L_lw_91
L_lw_91_2:
    ds_read_b64_tr_b16 a[32:33], v80 offset:32768
    ds_read_b64_tr_b16 a[34:35], v80 offset:33792
    ds_read_b64_tr_b16 a[36:37], v80 offset:40960
    ds_read_b64_tr_b16 a[38:39], v80 offset:41984
    ds_read_b64_tr_b16 v[56:57], v81 offset:32768
    ds_read_b64_tr_b16 v[58:59], v81 offset:33792
    ds_read_b64_tr_b16 v[60:61], v81 offset:40960
    ds_read_b64_tr_b16 v[62:63], v81 offset:41984
    s_waitcnt lgkmcnt(0)
    ds_write_b128 v5, v[56:59] offset:8192
    ds_write_b128 v5, v[60:63] offset:9216
L_lw_91:
    s_waitcnt lgkmcnt(0)
    s_waitcnt vmcnt(0)
    s_barrier
    s_cmp_lg_u32 s44, 0
    s_cbranch_scc1 L_lw_92_0
    ds_read_b64_tr_b16 a[152:153], v80 offset:49152
    ds_read_b64_tr_b16 a[154:155], v80 offset:50176
    ds_read_b64_tr_b16 a[156:157], v80 offset:57344
    ds_read_b64_tr_b16 a[158:159], v80 offset:58368
    ds_read_b64_tr_b16 v[56:57], v81 offset:49152
    ds_read_b64_tr_b16 v[58:59], v81 offset:50176
    ds_read_b64_tr_b16 v[60:61], v81 offset:57344
    ds_read_b64_tr_b16 v[62:63], v81 offset:58368
    s_waitcnt lgkmcnt(0)
    ds_write_b128 v5, v[56:59] offset:18432
    ds_write_b128 v5, v[60:63] offset:19456
    s_branch L_lw_92
L_lw_92_0:
    s_cmp_lg_u32 s44, 1
    s_cbranch_scc1 L_lw_92_1
    ds_read_b64_tr_b16 a[112:113], v80 offset:49152
    ds_read_b64_tr_b16 a[114:115], v80 offset:50176
    ds_read_b64_tr_b16 a[116:117], v80 offset:57344
    ds_read_b64_tr_b16 a[118:119], v80 offset:58368
    ds_read_b64_tr_b16 v[56:57], v81 offset:49152
    ds_read_b64_tr_b16 v[58:59], v81 offset:50176
    ds_read_b64_tr_b16 v[60:61], v81 offset:57344
    ds_read_b64_tr_b16 v[62:63], v81 offset:58368
    s_waitcnt lgkmcnt(0)
    ds_write_b128 v5, v[56:59] offset:20480
    ds_write_b128 v5, v[60:63] offset:21504
    s_branch L_lw_92
L_lw_92_1:
    s_cmp_lg_u32 s44, 2
    s_cbranch_scc1 L_lw_92_2
    ds_read_b64_tr_b16 a[72:73], v80 offset:49152
    ds_read_b64_tr_b16 a[74:75], v80 offset:50176
    ds_read_b64_tr_b16 a[76:77], v80 offset:57344
    ds_read_b64_tr_b16 a[78:79], v80 offset:58368
    ds_read_b64_tr_b16 v[56:57], v81 offset:49152
    ds_read_b64_tr_b16 v[58:59], v81 offset:50176
    ds_read_b64_tr_b16 v[60:61], v81 offset:57344
    ds_read_b64_tr_b16 v[62:63], v81 offset:58368
    s_waitcnt lgkmcnt(0)
    ds_write_b128 v5, v[56:59] offset:22528
    ds_write_b128 v5, v[60:63] offset:23552
    s_branch L_lw_92
L_lw_92_2:
    ds_read_b64_tr_b16 a[40:41], v80 offset:49152
    ds_read_b64_tr_b16 a[42:43], v80 offset:50176
    ds_read_b64_tr_b16 a[44:45], v80 offset:57344
    ds_read_b64_tr_b16 a[46:47], v80 offset:58368
    ds_read_b64_tr_b16 v[56:57], v81 offset:49152
    ds_read_b64_tr_b16 v[58:59], v81 offset:50176
    ds_read_b64_tr_b16 v[60:61], v81 offset:57344
    ds_read_b64_tr_b16 v[62:63], v81 offset:58368
    s_waitcnt lgkmcnt(0)
    ds_write_b128 v5, v[56:59] offset:16384
    ds_write_b128 v5, v[60:63] offset:17408
L_lw_92:
    s_waitcnt lgkmcnt(0)
    s_barrier
    v_lshlrev_b32 v68, 4, v1
    s_mul_i32 s45, s44, 3072
    s_add_u32 s45, s45, 53248
    v_add_u32 v6, s45, v68
    s_sub_u32 s45, s44, 1
    s_and_b32 s45, s45, 3
    s_mul_i32 s45, s45, 3072
    s_add_u32 s45, s45, 53248
    v_add_u32 v7, s45, v68
    s_sub_u32 s45, s44, 2
    s_and_b32 s45, s45, 3
    s_mul_i32 s45, s45, 3072
    s_add_u32 s45, s45, 54272
    v_add_u32 v8, s45, v68
    s_sub_u32 s45, s44, 3
    s_and_b32 s45, s45, 3
    s_mul_i32 s45, s45, 3072
    s_add_u32 s45, s45, 55296
    v_add_u32 v18, s45, v68
    v_lshlrev_b32 v68, 4, v1
    s_add_u32 s45, s69, 0
    s_and_b32 s45, s45, 7
    s_lshl_b32 s45, s45, 10
    s_lshl_b32 s46, s44, 13
    s_add_u32 s45, s45, s46
    v_add_u32 v80, s45, v68
    s_add_u32 s45, s69, 1
    s_and_b32 s45, s45, 7
    s_lshl_b32 s45, s45, 10
    s_lshl_b32 s46, s44, 13
    s_add_u32 s45, s45, s46
    v_add_u32 v81, s45, v68
    s_add_u32 s45, s69, 2
    s_and_b32 s45, s45, 7
    s_lshl_b32 s45, s45, 10
    s_lshl_b32 s46, s44, 13
    s_add_u32 s45, s45, s46
    v_add_u32 v82, s45, v68
    s_add_u32 s45, s69, 3
    s_and_b32 s45, s45, 7
    s_lshl_b32 s45, s45, 10
    s_lshl_b32 s46, s44, 13
    s_add_u32 s45, s45, s46
    v_add_u32 v83, s45, v68
    s_add_u32 s45, s69, 4
    s_and_b32 s45, s45, 7
    s_lshl_b32 s45, s45, 10
    s_lshl_b32 s46, s44, 13
    s_add_u32 s45, s45, s46
    v_add_u32 v84, s45, v68
    s_add_u32 s45, s69, 5
    s_and_b32 s45, s45, 7
    s_lshl_b32 s45, s45, 10
    s_lshl_b32 s46, s44, 13
    s_add_u32 s45, s45, s46
    v_add_u32 v85, s45, v68
    s_add_u32 s45, s69, 6
    s_and_b32 s45, s45, 7
    s_lshl_b32 s45, s45, 10
    s_lshl_b32 s46, s44, 13
    s_add_u32 s45, s45, s46
    v_add_u32 v86, s45, v68
    s_add_u32 s45, s69, 7
    s_and_b32 s45, s45, 7
    s_lshl_b32 s45, s45, 10
    s_lshl_b32 s46, s44, 13
    s_add_u32 s45, s45, s46
    v_add_u32 v87, s45, v68
    s_lshl_b32 s45, s40, 4
    s_add_u32 s45, s45, s42
    s_lshl_b32 s45, s45, 7
    s_lshl_b32 s46, s44, 4
    s_add_u32 s45, s45, s46
    s_add_u32 s45, s45, 0x7080000
    v_and_b32 v13, 3, v1
    v_lshlrev_b32 v13, 2, v13
    v_add_u32 v13, s45, v13
    s_mov_b32 s66, 0x1800000
    v_mov_b32 v14, -1
    v_mov_b32 v15, -1
    s_mov_b32 s70, 0
    v_mov_b32 v41, 0
L_hw_93:
    buffer_load_dwordx2 v[44:45], v41, s[16:19], 0 offen sc1
    s_add_u32 s70, s70, 1
    s_cmp_ge_u32 s70, 0x100000
    s_cbranch_scc1 L_c_done_1
    s_waitcnt vmcnt(0)
    v_readfirstlane_b32 s45, v44
    v_readfirstlane_b32 s46, v45
    s_nop 3
    s_lshr_b32 s47, s46, 24
    s_cmp_lg_u32 s47, 64
    s_cbranch_scc1 L_hw_93
    s_lshr_b32 s68, s45, 24
    s_and_b32 s47, s45, 511
    s_mul_i32 s47, s47, s47
    s_bfe_u32 s45, s45, 0xf0009
    s_lshl_b32 s45, s45, 5
    s_sub_u32 s45, s45, s47
    s_and_b32 s47, s46, 511
    s_mul_i32 s47, s47, s47
    s_bfe_u32 s46, s46, 0xf0009
    s_lshl_b32 s46, s46, 5
    s_sub_u32 s46, s46, s47
    s_or_b32 s45, s45, s46
    s_cmp_eq_u32 s45, 0
    s_cselect_b32 s67, 1, 0
    s_mov_b32 s24, s12
    s_mov_b32 s25, s13
    s_mov_b32 s28, s12
    s_mov_b32 s29, s13
    s_cmp_eq_u32 s67, 1
    s_cselect_b32 s26, s14, 0
    s_cselect_b32 s30, 0, s14
    s_cmp_ge_u32 s68, 16
    s_cselect_b32 s68, 8192, 0
    s_mov_b32 s6, 0x0
    s_mov_b32 s7, 0xfea00000
    s_mov_b32 s60, 0
    s_lshl_b32 s58, s40, 16
    s_add_u32 s58, s58, 0x7000000
    s_mov_b32 s61, s58
    s_lshl_b32 s59, s40, 17
    s_add_u32 s59, s59, 0x7040000
    s_mov_b32 s62, s59
    s_add_u32 s32, s41, 0
    s_and_b32 s32, s32, 3
    s_lshl_b32 s32, s32, 10
    s_add_u32 s33, s41, 1
    s_and_b32 s33, s33, 3
    s_lshl_b32 s33, s33, 10
    s_add_u32 s34, s41, 2
    s_and_b32 s34, s34, 3
    s_lshl_b32 s34, s34, 10
    s_add_u32 s35, s41, 3
    s_and_b32 s35, s35, 3
    s_lshl_b32 s35, s35, 10
    s_add_u32 s63, s63, s68
    s_add_u32 s64, s64, s68
    ds_read_b128 v[56:59], v5 offset:8192
    ds_read_b128 v[60:63], v5 offset:9216
    ds_read_b128 v[64:67], v5 offset:16384
    ds_read_b128 v[68:71], v5 offset:17408
    ds_read_b128 v[72:75], v5 offset:4096
    ds_read_b128 v[76:79], v5 offset:5120
    ds_read_b128 v[88:91], v5 offset:6144
    ds_read_b128 v[92:95], v5 offset:7168
    ds_read_b128 v[32:35], v5 offset:14336
    ds_read_b128 v[36:39], v5 offset:15360
L_v_loop_94:
    s_add_u32 s8, s61, s32
    s_add_u32 s9, s61, s33
    s_add_u32 s10, s61, s34
    s_add_u32 s11, s61, s35
    s_nop 15
    s_nop 15
    s_waitcnt lgkmcnt(0)
    buffer_load_dwordx4 v[40:43], v3, s[12:15], s8 offen sc1
    v_mov_b32 v24, 0
    v_mov_b32 v25, 0
    v_mov_b32 v26, 0
    v_mov_b32 v27, 0
    v_mov_b32 v28, 0
    buffer_load_dwordx4 v[44:47], v3, s[12:15], s9 offen sc1
    v_mov_b32 v29, 0
    v_mov_b32 v30, 0
    v_mov_b32 v31, 0
    s_nop 1
    buffer_load_dwordx4 v[48:51], v3, s[12:15], s10 offen sc1
    s_nop 4
    buffer_load_dwordx4 v[52:55], v3, s[12:15], s11 offen sc1
    s_mov_b32 s70, 0
    s_waitcnt vmcnt(3)
    v_max3_u32 v22, v40, v41, v42
    ds_write_b128 v3, v[40:43] offset:0
    v_max_u32 v22, v22, v43
    v_cmp_eq_u32 vcc, -1, v22
    s_nop 0
    s_nop 0
    s_cbranch_vccnz L_mg_95_r0
L_mg_95_c0:
    v_smfmac_f32_16x16x64_bf16 v[24:27], v[40:43], a[0:7], v2
    s_waitcnt vmcnt(2)
    v_max3_u32 v22, v44, v45, v46
    ds_write_b128 v3, v[44:47] offset:1024
    v_max_u32 v22, v22, v47
    v_cmp_eq_u32 vcc, -1, v22
    v_smfmac_f32_16x16x64_bf16 v[28:31], v[40:43], a[8:15], v2
    s_nop 0
    s_cbranch_vccnz L_mg_95_r1
L_mg_95_c1:
    v_smfmac_f32_16x16x64_bf16 v[24:27], v[44:47], a[16:23], v2
    s_waitcnt vmcnt(1)
    v_max3_u32 v22, v48, v49, v50
    ds_write_b128 v3, v[48:51] offset:2048
    v_max_u32 v22, v22, v51
    v_cmp_eq_u32 vcc, -1, v22
    v_smfmac_f32_16x16x64_bf16 v[28:31], v[44:47], a[24:31], v2
    s_nop 0
    s_cbranch_vccnz L_mg_95_r2
L_mg_95_c2:
    s_waitcnt vmcnt(0)
    v_max3_u32 v22, v52, v53, v54
    ds_write_b128 v3, v[52:55] offset:3072
    v_max_u32 v22, v22, v55
    v_cmp_eq_u32 vcc, -1, v22
    s_waitcnt lgkmcnt(0)
    s_nop 0
    s_cbranch_vccnz L_mg_95_r3
L_mg_95_c3:
    s_barrier
    ds_read_b128 v[40:43], v4 offset:0
    ds_read_b128 v[44:47], v4 offset:1024
    v_smfmac_f32_16x16x64_bf16 v[24:27], v[48:51], a[32:39], v2
    v_smfmac_f32_16x16x64_bf16 v[28:31], v[48:51], v[56:63], v2
    ds_read_b128 v[48:51], v4 offset:2048
    v_smfmac_f32_16x16x64_bf16 v[24:27], v[52:55], a[40:47], v2
    ds_read_b128 v[56:59], v5 offset:22528
    v_smfmac_f32_16x16x64_bf16 v[28:31], v[52:55], v[64:71], v2
    ds_read_b128 v[52:55], v4 offset:3072
    ds_read_b128 v[60:63], v5 offset:23552
    s_waitcnt lgkmcnt(4)
    v_smfmac_f32_16x16x64_bf16 v[24:27], v[40:43], a[48:55], v2
    ds_read_b128 v[64:67], v5 offset:2048
    v_smfmac_f32_16x16x64_bf16 v[28:31], v[40:43], v[72:79], v2
    ds_read_b128 v[40:43], v21 offset:0
    ds_read_b128 v[68:71], v5 offset:3072
    v_smfmac_f32_16x16x64_bf16 v[24:27], v[44:47], a[56:63], v2
    ds_read_b128 v[72:75], v5 offset:12288
    v_smfmac_f32_16x16x64_bf16 v[28:31], v[44:47], v[88:95], v2
    ds_read_b128 v[44:47], v21 offset:1024
    ds_read_b128 v[76:79], v5 offset:13312
    s_waitcnt lgkmcnt(6)
    v_smfmac_f32_16x16x64_bf16 v[24:27], v[48:51], a[64:71], v2
    ds_read_b128 v[88:91], v5 offset:20480
    v_smfmac_f32_16x16x64_bf16 v[28:31], v[48:51], v[32:39], v2
    ds_read_b128 v[48:51], v21 offset:2048
    ds_read_b128 v[92:95], v5 offset:21504
    v_smfmac_f32_16x16x64_bf16 v[24:27], v[52:55], a[72:79], v2
    ds_read_b128 v[32:35], v5 offset:0
    v_smfmac_f32_16x16x64_bf16 v[28:31], v[52:55], v[56:63], v2
    ds_read_b128 v[52:55], v21 offset:3072
    ds_read_b128 v[36:39], v5 offset:1024
    s_waitcnt lgkmcnt(6)
    v_smfmac_f32_16x16x64_bf16 v[24:27], v[40:43], a[80:87], v2
    ds_read_b128 v[56:59], v5 offset:10240
    v_smfmac_f32_16x16x64_bf16 v[28:31], v[40:43], v[64:71], v2
    ds_read_b128 v[40:43], v23 offset:0
    ds_read_b128 v[60:63], v5 offset:11264
    v_smfmac_f32_16x16x64_bf16 v[24:27], v[44:47], a[88:95], v2
    ds_read_b128 v[64:67], v5 offset:18432
    v_smfmac_f32_16x16x64_bf16 v[28:31], v[44:47], a[96:103], v2
    ds_read_b128 v[44:47], v23 offset:1024
    s_waitcnt lgkmcnt(5)
    v_smfmac_f32_16x16x64_bf16 v[24:27], v[48:51], a[104:111], v2
    ds_read_b128 v[68:71], v5 offset:19456
    v_smfmac_f32_16x16x64_bf16 v[28:31], v[48:51], v[72:79], v2
    ds_read_b128 v[48:51], v23 offset:2048
    v_smfmac_f32_16x16x64_bf16 v[24:27], v[52:55], a[112:119], v2
    v_smfmac_f32_16x16x64_bf16 v[28:31], v[52:55], v[88:95], v2
    ds_read_b128 v[52:55], v23 offset:3072
    s_waitcnt lgkmcnt(3)
    v_smfmac_f32_16x16x64_bf16 v[24:27], v[40:43], a[120:127], v2
    v_smfmac_f32_16x16x64_bf16 v[28:31], v[40:43], v[32:39], v2
    v_smfmac_f32_16x16x64_bf16 v[24:27], v[44:47], a[128:135], v2
    v_smfmac_f32_16x16x64_bf16 v[28:31], v[44:47], a[136:143], v2
    s_waitcnt lgkmcnt(0)
    v_smfmac_f32_16x16x64_bf16 v[24:27], v[48:51], a[144:151], v2
    v_smfmac_f32_16x16x64_bf16 v[28:31], v[48:51], v[56:63], v2
    v_smfmac_f32_16x16x64_bf16 v[24:27], v[52:55], a[152:159], v2
    v_smfmac_f32_16x16x64_bf16 v[28:31], v[52:55], v[64:71], v2
    s_and_b32 s45, s60, 1
    s_lshl_b32 s45, s45, 16
    s_add_u32 s45, s45, 0x7020000
    s_xor_b32 s46, s45, 65536
    s_nop 3
    v_permlane32_swap_b32 v24, v26
    v_permlane32_swap_b32 v25, v27
    v_permlane32_swap_b32 v28, v30
    v_permlane32_swap_b32 v29, v31
    v_pk_add_f32 v[24:25], v[24:25], v[26:27]
    v_pk_add_f32 v[28:29], v[28:29], v[30:31]
    v_cvt_pk_bf16_f32 v16, v24, v25
    v_cvt_pk_bf16_f32 v17, v28, v29
    s_add_u32 s47, s60, 3
    s_and_b32 s47, s47, 3
    s_lshl_b32 s47, s47, 14
    s_add_u32 s47, s47, s58
    buffer_store_dwordx2 v[16:17], v10, s[24:27], s45 offen
    buffer_store_dwordx2 v[14:15], v10, s[24:27], s46 offen
    buffer_store_dword v14, v12, s[24:27], s47 offen
    buffer_store_dwordx2 v[16:17], v10, s[28:31], s45 offen sc1
    buffer_store_dwordx2 v[14:15], v10, s[28:31], s46 offen sc1
    buffer_store_dword v14, v12, s[28:31], s47 offen sc1
    buffer_store_dwordx2 v[16:17], v10, s[12:15], s66 offen sc1
    s_cmp_eq_u32 s60, 63
    s_cbranch_scc1 L_v_fin_96
    v_mov_b32 v22, s60
    v_mov_b32 v0, 0
    s_mov_b64 exec, 1
    buffer_store_dword v22, v0, s[12:15], s3 offen sc1
    s_mov_b64 exec, -1
    s_and_b32 s65, s60, 1
    s_lshl_b32 s65, s65, 12
    s_and_b32 s45, s60, 2
    s_lshl_b32 s45, s45, 13
    s_add_u32 s65, s65, s45
    s_xor_b32 s45, s65, 16384
    s_add_u32 s45, s45, s63
    buffer_store_dwordx2 v[14:15], v11, s[12:15], s45 offen sc1
    s_add_u32 s48, s63, s65
    s_add_u32 s49, s64, s65
    s_sleep 12
    s_mov_b64 exec, 15
    buffer_load_dword v88, v13, s[12:15], 0 offen sc1
    s_nop 15
    buffer_load_dword v89, v13, s[12:15], 0 offen sc1
    s_nop 15
    buffer_load_dword v90, v13, s[12:15], 0 offen sc1
    s_nop 15
    buffer_load_dword v91, v13, s[12:15], 0 offen sc1
    s_mov_b32 s70, 0
L_pp_97:
    s_waitcnt vmcnt(3)
    v_cmp_ge_u32 vcc, s60, v88
    s_add_u32 s70, s70, 1
    s_nop 0
    s_cbranch_vccz L_ppd_98
    buffer_load_dword v88, v13, s[12:15], 0 offen sc1
    s_waitcnt vmcnt(3)
    v_cmp_ge_u32 vcc, s60, v89
    s_add_u32 s70, s70, 1
    s_nop 0
    s_cbranch_vccz L_ppd_98
    buffer_load_dword v89, v13, s[12:15], 0 offen sc1
    s_waitcnt vmcnt(3)
    v_cmp_ge_u32 vcc, s60, v90
    s_add_u32 s70, s70, 1
    s_nop 0
    s_cbranch_vccz L_ppd_98
    buffer_load_dword v90, v13, s[12:15], 0 offen sc1
    s_waitcnt vmcnt(3)
    v_cmp_ge_u32 vcc, s60, v91
    s_add_u32 s70, s70, 1
    s_nop 0
    s_cbranch_vccz L_ppd_98
    buffer_load_dword v91, v13, s[12:15], 0 offen sc1
    s_cmp_lt_u32 s70, 0x400000
    s_cbranch_scc1 L_pp_97
    s_branch L_c_done_1
L_ppd_98:
    s_mov_b64 exec, -1
    s_nop 15
    s_nop 11
    s_mov_b32 s70, 0
    buffer_load_dwordx4 v[40:43], v80, s[12:15], s62 offen sc1
    v_mov_b32 v24, 0
    v_mov_b32 v25, 0
    v_mov_b32 v26, 0
    v_mov_b32 v27, 0
    s_nop 3
    buffer_load_dwordx4 v[44:47], v81, s[12:15], s62 offen sc1
    v_mov_b32 v28, 0
    v_mov_b32 v29, 0
    v_mov_b32 v30, 0
    v_mov_b32 v31, 0
    s_nop 3
    buffer_load_dwordx4 v[48:51], v82, s[12:15], s62 offen sc1
    v_mov_b32 v32, 0
    v_mov_b32 v33, 0
    v_mov_b32 v34, 0
    v_mov_b32 v35, 0
    s_nop 3
    buffer_load_dwordx4 v[52:55], v83, s[12:15], s62 offen sc1
    v_mov_b32 v36, 0
    v_mov_b32 v37, 0
    v_mov_b32 v38, 0
    v_mov_b32 v39, 0
    s_nop 3
    buffer_load_dwordx4 v[56:59], v84, s[12:15], s62 offen sc1
    s_nop 7
    buffer_load_dwordx4 v[60:63], v85, s[12:15], s62 offen sc1
    s_waitcnt vmcnt(5)
    v_cmp_eq_u32 vcc, -1, v43
    s_nop 1
    s_cbranch_vccnz L_v_og_99_r0
L_v_og_99_c0:
    v_smfmac_f32_16x16x64_bf16 v[24:27], v[40:43], a[160:167], v2
    s_waitcnt vmcnt(4)
    v_smfmac_f32_16x16x64_bf16 v[28:31], v[40:43], a[168:175], v2
    v_cmp_eq_u32 vcc, -1, v47
    v_smfmac_f32_16x16x64_bf16 v[32:35], v[40:43], a[176:183], v2
    buffer_load_dwordx4 v[64:67], v86, s[12:15], s62 offen sc1
    v_smfmac_f32_16x16x64_bf16 v[36:39], v[40:43], a[184:191], v2
    s_cbranch_vccnz L_v_og_99_r1
L_v_og_99_c1:
    v_smfmac_f32_16x16x64_bf16 v[24:27], v[44:47], a[192:199], v2
    s_waitcnt vmcnt(4)
    v_smfmac_f32_16x16x64_bf16 v[28:31], v[44:47], a[200:207], v2
    v_cmp_eq_u32 vcc, -1, v51
    v_smfmac_f32_16x16x64_bf16 v[32:35], v[44:47], a[208:215], v2
    buffer_load_dwordx4 v[68:71], v87, s[12:15], s62 offen sc1
    v_smfmac_f32_16x16x64_bf16 v[36:39], v[44:47], a[216:223], v2
    s_cbranch_vccnz L_v_og_99_r2
L_v_og_99_c2:
    v_smfmac_f32_16x16x64_bf16 v[24:27], v[48:51], a[224:231], v2
    s_waitcnt vmcnt(4)
    v_smfmac_f32_16x16x64_bf16 v[28:31], v[48:51], a[232:239], v2
    v_cmp_eq_u32 vcc, -1, v55
    v_smfmac_f32_16x16x64_bf16 v[32:35], v[48:51], a[240:247], v2
    v_smfmac_f32_16x16x64_bf16 v[36:39], v[48:51], a[248:255], v2
    s_cbranch_vccnz L_v_og_99_r3
L_v_og_99_c3:
    v_smfmac_f32_16x16x64_bf16 v[24:27], v[52:55], v[96:103], v2
    s_waitcnt vmcnt(3)
    v_cmp_eq_u32 vcc, -1, v59
    v_smfmac_f32_16x16x64_bf16 v[28:31], v[52:55], v[104:111], v2
    v_smfmac_f32_16x16x64_bf16 v[32:35], v[52:55], v[112:119], v2
    s_cbranch_vccnz L_v_og_99_r4
L_v_og_99_c4:
    v_smfmac_f32_16x16x64_bf16 v[24:27], v[56:59], v[128:135], v2
    s_waitcnt vmcnt(2)
    v_cmp_eq_u32 vcc, -1, v63
    v_smfmac_f32_16x16x64_bf16 v[28:31], v[56:59], v[136:143], v2
    v_smfmac_f32_16x16x64_bf16 v[32:35], v[56:59], v[144:151], v2
    s_cbranch_vccnz L_v_og_99_r5
L_v_og_99_c5:
    v_smfmac_f32_16x16x64_bf16 v[24:27], v[60:63], v[160:167], v2
    s_waitcnt vmcnt(1)
    v_cmp_eq_u32 vcc, -1, v67
    v_smfmac_f32_16x16x64_bf16 v[28:31], v[60:63], v[168:175], v2
    v_smfmac_f32_16x16x64_bf16 v[32:35], v[60:63], v[176:183], v2
    s_cbranch_vccnz L_v_og_99_r6
L_v_og_99_c6:
    v_smfmac_f32_16x16x64_bf16 v[24:27], v[64:67], v[192:199], v2
    s_waitcnt vmcnt(0)
    v_cmp_eq_u32 vcc, -1, v71
    v_smfmac_f32_16x16x64_bf16 v[28:31], v[64:67], v[200:207], v2
    v_smfmac_f32_16x16x64_bf16 v[32:35], v[64:67], v[208:215], v2
    s_cbranch_vccnz L_v_og_99_r7
L_v_og_99_c7:
    v_smfmac_f32_16x16x64_bf16 v[24:27], v[68:71], v[224:231], v2
    v_smfmac_f32_16x16x64_bf16 v[28:31], v[68:71], v[232:239], v2
    v_smfmac_f32_16x16x64_bf16 v[32:35], v[68:71], v[240:247], v2
    v_smfmac_f32_16x16x64_bf16 v[36:39], v[52:55], v[120:127], v2
    s_add_u32 s46, s60, 1
    v_smfmac_f32_16x16x64_bf16 v[36:39], v[56:59], v[152:159], v2
    s_and_b32 s45, s46, 3
    v_smfmac_f32_16x16x64_bf16 v[36:39], v[60:63], v[184:191], v2
    s_mov_b32 s60, s46
    ds_write_b128 v6, v[24:27] offset:0
    v_smfmac_f32_16x16x64_bf16 v[36:39], v[64:67], v[216:223], v2
    ds_write_b128 v6, v[28:31] offset:1024
    v_smfmac_f32_16x16x64_bf16 v[36:39], v[68:71], v[248:255], v2
    ds_write_b128 v6, v[32:35] offset:2048
    s_lshl_b32 s46, s45, 14
    s_add_u32 s61, s58, s46
    s_lshl_b32 s46, s45, 15
    s_add_u32 s62, s59, s46
    s_waitcnt lgkmcnt(0)
    s_barrier
    ds_read_b128 v[40:43], v7
    ds_read_b128 v[44:47], v8
    ds_read_b128 v[48:51], v18
    s_waitcnt lgkmcnt(2)
    v_pk_add_f32 v[36:37], v[36:37], v[40:41]
    v_pk_add_f32 v[38:39], v[38:39], v[42:43]
    s_waitcnt lgkmcnt(1)
    v_pk_add_f32 v[36:37], v[36:37], v[44:45]
    v_pk_add_f32 v[38:39], v[38:39], v[46:47]
    s_waitcnt lgkmcnt(0)
    v_pk_add_f32 v[36:37], v[36:37], v[48:49]
    v_pk_add_f32 v[38:39], v[38:39], v[50:51]
    s_nop 1
    v_permlane32_swap_b32 v36, v38
    v_permlane32_swap_b32 v37, v39
    v_pk_add_f32 v[24:25], v[36:37], v[38:39]
    buffer_store_dwordx2 v[24:25], v11, s[12:15], s48 offen sc1
    s_bitcmp1_b64 s[6:7], s60
    s_cbranch_scc0 L_v_eag_100
    v_mov_b32 v22, s60
    v_mov_b32 v0, 0
    s_mov_b64 exec, 1
    buffer_store_dword v22, v0, s[12:15], s3 offen sc1
    s_mov_b64 exec, -1
L_v_eag_100:
    ds_read_b128 v[56:59], v5 offset:8192
    ds_read_b128 v[60:63], v5 offset:9216
    ds_read_b128 v[64:67], v5 offset:16384
    ds_read_b128 v[68:71], v5 offset:17408
    ds_read_b128 v[72:75], v5 offset:4096
    ds_read_b128 v[76:79], v5 offset:5120
    ds_read_b128 v[88:91], v5 offset:6144
    ds_read_b128 v[92:95], v5 offset:7168
    ds_read_b128 v[32:35], v5 offset:14336
    ds_read_b128 v[36:39], v5 offset:15360
    s_sleep 4
    buffer_load_dwordx2 v[40:41], v11, s[12:15], s49 offen sc1
    s_mov_b32 s70, 0
L_v_xp_101:
    s_waitcnt vmcnt(0)
    v_max_u32 v22, v40, v41
    v_cmp_eq_u32 vcc, -1, v22
    v_pk_add_f32 v[28:29], v[24:25], v[40:41]
    v_cvt_pk_bf16_f32 v28, v28, v29
    s_cbranch_vccz L_v_xp_101_ok
    buffer_load_dwordx2 v[40:41], v11, s[12:15], s49 offen sc1
    s_add_u32 s70, s70, 1
    s_cmp_lt_u32 s70, 0x100000
    s_cbranch_scc1 L_v_xp_101
    s_branch L_c_done_1
L_v_xp_101_ok:
    s_add_u32 s66, s66, 65536
    v_mov_b32_dpp v29, v28 quad_perm:[1,0,3,2] row_mask:0xf bank_mask:0xf
    v_perm_b32 v28, v28, v29, v9
    buffer_store_dword v28, v12, s[24:27], s61 offen
    buffer_store_dword v28, v12, s[28:31], s61 offen sc1
    s_branch L_v_loop_94
L_v_fin_96:
    s_waitcnt vmcnt(0)
    v_mov_b32 v22, 64
    v_mov_b32 v0, 0
    s_mov_b64 exec, 1
    buffer_store_dword v22, v0, s[12:15], s3 offen sc1
    s_mov_b64 exec, -1
L_c_done_1:
    s_endpgm
L_v_og_99_r0:
    buffer_load_dwordx4 v[40:43], v80, s[12:15], s62 offen sc1
    buffer_load_dwordx4 v[44:47], v81, s[12:15], s62 offen sc1
    buffer_load_dwordx4 v[48:51], v82, s[12:15], s62 offen sc1
    buffer_load_dwordx4 v[52:55], v83, s[12:15], s62 offen sc1
    buffer_load_dwordx4 v[56:59], v84, s[12:15], s62 offen sc1
    buffer_load_dwordx4 v[60:63], v85, s[12:15], s62 offen sc1
    s_add_u32 s70, s70, 1
    s_cmp_ge_u32 s70, 0x100000
    s_cbranch_scc1 L_c_done_1
    s_waitcnt vmcnt(5)
    v_cmp_eq_u32 vcc, -1, v43
    s_nop 1
    s_cbranch_vccnz L_v_og_99_r0
    s_branch L_v_og_99_c0
L_v_og_99_r1:
    buffer_load_dwordx4 v[44:47], v81, s[12:15], s62 offen sc1
    buffer_load_dwordx4 v[48:51], v82, s[12:15], s62 offen sc1
    buffer_load_dwordx4 v[52:55], v83, s[12:15], s62 offen sc1
    buffer_load_dwordx4 v[56:59], v84, s[12:15], s62 offen sc1
    buffer_load_dwordx4 v[60:63], v85, s[12:15], s62 offen sc1
    buffer_load_dwordx4 v[64:67], v86, s[12:15], s62 offen sc1
    s_add_u32 s70, s70, 1
    s_cmp_ge_u32 s70, 0x100000
    s_cbranch_scc1 L_c_done_1
    s_waitcnt vmcnt(5)
    v_cmp_eq_u32 vcc, -1, v47
    s_nop 1
    s_cbranch_vccnz L_v_og_99_r1
    s_branch L_v_og_99_c1
L_v_og_99_r2:
    buffer_load_dwordx4 v[48:51], v82, s[12:15], s62 offen sc1
    buffer_load_dwordx4 v[52:55], v83, s[12:15], s62 offen sc1
    buffer_load_dwordx4 v[56:59], v84, s[12:15], s62 offen sc1
    buffer_load_dwordx4 v[60:63], v85, s[12:15], s62 offen sc1
    buffer_load_dwordx4 v[64:67], v86, s[12:15], s62 offen sc1
    buffer_load_dwordx4 v[68:71], v87, s[12:15], s62 offen sc1
    s_add_u32 s70, s70, 1
    s_cmp_ge_u32 s70, 0x100000
    s_cbranch_scc1 L_c_done_1
    s_waitcnt vmcnt(5)
    v_cmp_eq_u32 vcc, -1, v51
    s_nop 1
    s_cbranch_vccnz L_v_og_99_r2
    s_branch L_v_og_99_c2
L_v_og_99_r3:
    buffer_load_dwordx4 v[52:55], v83, s[12:15], s62 offen sc1
    buffer_load_dwordx4 v[56:59], v84, s[12:15], s62 offen sc1
    buffer_load_dwordx4 v[60:63], v85, s[12:15], s62 offen sc1
    buffer_load_dwordx4 v[64:67], v86, s[12:15], s62 offen sc1
    buffer_load_dwordx4 v[68:71], v87, s[12:15], s62 offen sc1
    s_add_u32 s70, s70, 1
    s_cmp_ge_u32 s70, 0x100000
    s_cbranch_scc1 L_c_done_1
    s_waitcnt vmcnt(4)
    v_cmp_eq_u32 vcc, -1, v55
    s_nop 1
    s_cbranch_vccnz L_v_og_99_r3
    s_branch L_v_og_99_c3
L_v_og_99_r4:
    buffer_load_dwordx4 v[56:59], v84, s[12:15], s62 offen sc1
    buffer_load_dwordx4 v[60:63], v85, s[12:15], s62 offen sc1
    buffer_load_dwordx4 v[64:67], v86, s[12:15], s62 offen sc1
    buffer_load_dwordx4 v[68:71], v87, s[12:15], s62 offen sc1
    s_add_u32 s70, s70, 1
    s_cmp_ge_u32 s70, 0x100000
    s_cbranch_scc1 L_c_done_1
    s_waitcnt vmcnt(3)
    v_cmp_eq_u32 vcc, -1, v59
    s_nop 1
    s_cbranch_vccnz L_v_og_99_r4
    s_branch L_v_og_99_c4
L_v_og_99_r5:
    buffer_load_dwordx4 v[60:63], v85, s[12:15], s62 offen sc1
    buffer_load_dwordx4 v[64:67], v86, s[12:15], s62 offen sc1
    buffer_load_dwordx4 v[68:71], v87, s[12:15], s62 offen sc1
    s_add_u32 s70, s70, 1
    s_cmp_ge_u32 s70, 0x100000
    s_cbranch_scc1 L_c_done_1
    s_waitcnt vmcnt(2)
    v_cmp_eq_u32 vcc, -1, v63
    s_nop 1
    s_cbranch_vccnz L_v_og_99_r5
    s_branch L_v_og_99_c5
L_v_og_99_r6:
    buffer_load_dwordx4 v[64:67], v86, s[12:15], s62 offen sc1
    buffer_load_dwordx4 v[68:71], v87, s[12:15], s62 offen sc1
    s_add_u32 s70, s70, 1
    s_cmp_ge_u32 s70, 0x100000
    s_cbranch_scc1 L_c_done_1
    s_waitcnt vmcnt(1)
    v_cmp_eq_u32 vcc, -1, v67
    s_nop 1
    s_cbranch_vccnz L_v_og_99_r6
    s_branch L_v_og_99_c6
L_v_og_99_r7:
    buffer_load_dwordx4 v[68:71], v87, s[12:15], s62 offen sc1
    s_add_u32 s70, s70, 1
    s_cmp_ge_u32 s70, 0x100000
    s_cbranch_scc1 L_c_done_1
    s_waitcnt vmcnt(0)
    v_cmp_eq_u32 vcc, -1, v71
    s_nop 1
    s_cbranch_vccnz L_v_og_99_r7
    s_branch L_v_og_99_c7
L_mg_95_r0:
    buffer_load_dwordx4 v[40:43], v3, s[12:15], s8 offen sc1
    buffer_load_dwordx4 v[44:47], v3, s[12:15], s9 offen sc1
    buffer_load_dwordx4 v[48:51], v3, s[12:15], s10 offen sc1
    buffer_load_dwordx4 v[52:55], v3, s[12:15], s11 offen sc1
    s_add_u32 s70, s70, 1
    s_cmp_ge_u32 s70, 0x100000
    s_cbranch_scc1 L_c_done_1
    s_waitcnt vmcnt(3)
    ds_write_b128 v3, v[40:43] offset:0
    v_max3_u32 v22, v40, v41, v42
    v_max_u32 v22, v22, v43
    v_cmp_eq_u32 vcc, -1, v22
    s_waitcnt lgkmcnt(0)
    s_nop 0
    s_cbranch_vccnz L_mg_95_r0
    s_branch L_mg_95_c0
L_mg_95_r1:
    buffer_load_dwordx4 v[44:47], v3, s[12:15], s9 offen sc1
    buffer_load_dwordx4 v[48:51], v3, s[12:15], s10 offen sc1
    buffer_load_dwordx4 v[52:55], v3, s[12:15], s11 offen sc1
    s_add_u32 s70, s70, 1
    s_cmp_ge_u32 s70, 0x100000
    s_cbranch_scc1 L_c_done_1
    s_waitcnt vmcnt(2)
    ds_write_b128 v3, v[44:47] offset:1024
    v_max3_u32 v22, v44, v45, v46
    v_max_u32 v22, v22, v47
    v_cmp_eq_u32 vcc, -1, v22
    s_waitcnt lgkmcnt(0)
    s_nop 0
    s_cbranch_vccnz L_mg_95_r1
    s_branch L_mg_95_c1
L_mg_95_r2:
    buffer_load_dwordx4 v[48:51], v3, s[12:15], s10 offen sc1
    buffer_load_dwordx4 v[52:55], v3, s[12:15], s11 offen sc1
    s_add_u32 s70, s70, 1
    s_cmp_ge_u32 s70, 0x100000
    s_cbranch_scc1 L_c_done_1
    s_waitcnt vmcnt(1)
    ds_write_b128 v3, v[48:51] offset:2048
    v_max3_u32 v22, v48, v49, v50
    v_max_u32 v22, v22, v51
    v_cmp_eq_u32 vcc, -1, v22
    s_waitcnt lgkmcnt(0)
    s_nop 0
    s_cbranch_vccnz L_mg_95_r2
    s_branch L_mg_95_c2
L_mg_95_r3:
    buffer_load_dwordx4 v[52:55], v3, s[12:15], s11 offen sc1
    s_add_u32 s70, s70, 1
    s_cmp_ge_u32 s70, 0x100000
    s_cbranch_scc1 L_c_done_1
    s_waitcnt vmcnt(0)
    ds_write_b128 v3, v[52:55] offset:3072
    v_max3_u32 v22, v52, v53, v54
    v_max_u32 v22, v22, v55
    v_cmp_eq_u32 vcc, -1, v22
    s_waitcnt lgkmcnt(0)
    s_nop 0
    s_cbranch_vccnz L_mg_95_r3
    s_branch L_mg_95_c3
L_worker_3:
    s_lshr_b32 s41, s2, 3
    s_and_b32 s42, s40, 1
    s_lshr_b32 s43, s40, 1
    s_lshl_b32 s39, s43, 5
    s_add_u32 s39, s39, s41
    s_load_dwordx2 s[4:5], s[0:1], 0
    s_waitcnt lgkmcnt(0)
    s_mov_b32 s28, s4
    s_and_b32 s29, s5, 0xffff
    s_mov_b32 s30, 0x400000
    s_mov_b32 s31, 0x00020000
    v_lshrrev_b32 v2, 4, v1
    v_and_b32 v4, 15, v1
    v_lshrrev_b32 v3, 1, v4
    v_xor_b32 v3, v3, v2
    v_lshlrev_b32 v3, 4, v3
    v_lshlrev_b32 v6, 7, v4
    v_add_u32 v3, v3, v6
    v_mul_u32_u24 v7, 144, v4
    v_lshlrev_b32 v6, 4, v2
    s_mul_i32 s45, s44, 4608
    s_add_u32 s45, s45, 131072
    v_add3_u32 v7, v7, v6, s45
    v_lshrrev_b32 v9, 3, v1
    v_mul_u32_u24 v8, 144, v9
    v_and_b32 v6, 7, v1
    v_lshlrev_b32 v6, 4, v6
    v_add3_u32 v8, v8, v6, s45
    v_lshlrev_b32 v11, 12, v9
    v_add_u32 v11, v11, v6
    v_lshlrev_b32 v2, 13, v2
    v_lshlrev_b32 v6, 4, v4
    v_add_u32 v2, v2, v6
    v_lshrrev_b32 v6, 3, v1
    v_lshrrev_b32 v9, 4, v1
    v_and_b32 v4, 7, v1
    v_xor_b32 v9, v9, v4
    v_lshlrev_b32 v9, 4, v9
    v_lshlrev_b32 v6, 8, v6
    v_add_u32 v6, v6, v9
    v_xor_b32 v9, 64, v6
    v_add_u32 v9, 2048, v9
    v_lshlrev_b32 v10, 4, v1
    v_lshlrev_b32 v12, 2, v1
    v_lshlrev_b32 v5, 7, v1
    s_lshl_b32 s61, s41, 7
    s_lshl_b32 s45, s43, 2
    s_add_u32 s61, s61, s45
    s_add_u32 s61, s61, 0x10010
    s_mul_i32 s64, s42, 24576
    s_add_u32 s64, s64, 0x12000
    s_lshl_b32 s45, s41, 7
    s_add_u32 s65, s64, s45
    s_lshl_b32 s45, s43, 13
    s_add_u32 s65, s65, s45
    s_add_u32 s67, s65, 4096
    s_cmp_lg_u32 s42, 0
    s_cbranch_scc1 L_w_kv_103
    v_mov_b32 v30, 0
    v_mov_b32 v31, 0
    v_mov_b32 v29, 24576
    s_mov_b64 exec, 1
    buffer_store_dword v30, v31, s[12:15], s61 offen sc1
    buffer_store_dword v30, v31, s[12:15], s65 offen sc1
    buffer_store_dword v30, v31, s[12:15], s67 offen sc1
    buffer_store_dword v30, v29, s[12:15], s65 offen sc1
    buffer_store_dword v30, v29, s[12:15], s67 offen sc1
    s_mov_b64 exec, -1
    s_lshl_b32 s63, s39, 2
    s_add_u32 s63, s63, s44
    s_load_dwordx2 s[4:5], s[0:1], 96
    s_load_dwordx2 s[6:7], s[0:1], 104
    v_and_b32 v14, 7, v0
    v_lshrrev_b32 v15, 3, v0
    s_waitcnt lgkmcnt(0)
    s_mov_b32 s32, s4
    s_and_b32 s33, s5, 0xffff
    s_mov_b32 s34, 0x800
    s_mov_b32 s35, 0x00020000
    s_mov_b32 s24, s6
    s_and_b32 s25, s7, 0xffff
    s_mov_b32 s26, 0xc00000
    s_mov_b32 s27, 0x00020000
    s_and_b32 s47, s39, 1
    s_lshl_b32 s45, s47, 10
    v_lshlrev_b32 v16, 5, v15
    buffer_load_dwordx4 v[104:107], v16, s[32:35], s45 offen
    buffer_load_dwordx4 v[108:111], v16, s[32:35], s45 offen offset:16
    s_mov_b32 s45, 196608
    v_mul_lo_u32 v17, v15, s45
    v_lshlrev_b32 v18, 4, v14
    v_add_u32 v17, v17, v18
    s_lshr_b32 s46, s39, 1
    s_lshl_b32 s46, s46, 7
    s_mul_i32 s45, s47, 6291456
    s_add_u32 s46, s46, s45
    buffer_load_dwordx4 v[32:35], v17, s[24:27], s46 offen
    v_add_u32 v17, 12288, v17
    buffer_load_dwordx4 v[36:39], v17, s[24:27], s46 offen
    v_add_u32 v17, 12288, v17
    buffer_load_dwordx4 v[40:43], v17, s[24:27], s46 offen
    v_add_u32 v17, 12288, v17
    buffer_load_dwordx4 v[44:47], v17, s[24:27], s46 offen
    v_add_u32 v17, 12288, v17
    buffer_load_dwordx4 v[48:51], v17, s[24:27], s46 offen
    v_add_u32 v17, 12288, v17
    buffer_load_dwordx4 v[52:55], v17, s[24:27], s46 offen
    v_add_u32 v17, 12288, v17
    buffer_load_dwordx4 v[56:59], v17, s[24:27], s46 offen
    v_add_u32 v17, 12288, v17
    buffer_load_dwordx4 v[60:63], v17, s[24:27], s46 offen
    v_add_u32 v17, 12288, v17
    buffer_load_dwordx4 v[64:67], v17, s[24:27], s46 offen
    v_add_u32 v17, 12288, v17
    buffer_load_dwordx4 v[68:71], v17, s[24:27], s46 offen
    v_add_u32 v17, 12288, v17
    buffer_load_dwordx4 v[72:75], v17, s[24:27], s46 offen
    v_add_u32 v17, 12288, v17
    buffer_load_dwordx4 v[76:79], v17, s[24:27], s46 offen
    v_add_u32 v17, 12288, v17
    buffer_load_dwordx4 v[80:83], v17, s[24:27], s46 offen
    v_add_u32 v17, 12288, v17
    buffer_load_dwordx4 v[84:87], v17, s[24:27], s46 offen
    v_add_u32 v17, 12288, v17
    buffer_load_dwordx4 v[88:91], v17, s[24:27], s46 offen
    v_add_u32 v17, 12288, v17
    buffer_load_dwordx4 v[92:95], v17, s[24:27], s46 offen
    s_add_u32 s45, s63, 0
    s_lshl_b32 s45, s45, 11
    buffer_load_dwordx4 v[128:131], v10, s[28:31], s45 offen
    buffer_load_dwordx4 v[132:135], v10, s[28:31], s45 offen offset:1024
    s_add_u32 s45, s63, 384
    s_lshl_b32 s45, s45, 11
    buffer_load_dwordx4 v[136:139], v10, s[28:31], s45 offen
    buffer_load_dwordx4 v[140:143], v10, s[28:31], s45 offen offset:1024
    s_add_u32 s45, s63, 768
    s_lshl_b32 s45, s45, 11
    buffer_load_dwordx4 v[144:147], v10, s[28:31], s45 offen
    buffer_load_dwordx4 v[148:151], v10, s[28:31], s45 offen offset:1024
    s_add_u32 s45, s63, 1152
    s_lshl_b32 s45, s45, 11
    buffer_load_dwordx4 v[152:155], v10, s[28:31], s45 offen
    buffer_load_dwordx4 v[156:159], v10, s[28:31], s45 offen offset:1024
    s_add_u32 s45, s63, 1536
    s_lshl_b32 s45, s45, 11
    buffer_load_dwordx4 v[160:163], v10, s[28:31], s45 offen
    buffer_load_dwordx4 v[164:167], v10, s[28:31], s45 offen offset:1024
    s_add_u32 s45, s63, 1920
    s_lshl_b32 s45, s45, 11
    buffer_load_dwordx4 v[168:171], v10, s[28:31], s45 offen
    buffer_load_dwordx4 v[172:175], v10, s[28:31], s45 offen offset:1024
    s_waitcnt vmcnt(28)
    v_lshlrev_b32 v112, 16, v104
    v_and_b32 v113, 0xffff0000, v104
    v_lshlrev_b32 v114, 16, v105
    v_and_b32 v115, 0xffff0000, v105
    v_lshlrev_b32 v116, 16, v106
    v_and_b32 v117, 0xffff0000, v106
    v_lshlrev_b32 v118, 16, v107
    v_and_b32 v119, 0xffff0000, v107
    v_lshlrev_b32 v120, 16, v108
    v_and_b32 v121, 0xffff0000, v108
    v_lshlrev_b32 v122, 16, v109
    v_and_b32 v123, 0xffff0000, v109
    v_lshlrev_b32 v124, 16, v110
    v_and_b32 v125, 0xffff0000, v110
    v_lshlrev_b32 v126, 16, v111
    v_and_b32 v127, 0xffff0000, v111
    v_mul_f32 v18, 0xbfb8aa3b, v112
    v_exp_f32 v18, v18
    s_nop 0
    v_add_f32 v18, 1.0, v18
    v_rcp_f32 v18, v18
    s_nop 0
    v_mul_f32 v112, v112, v18
    v_cvt_pk_bf16_f32 v112, v112, v112
    v_lshlrev_b32 v112, 16, v112
    v_mul_f32 v18, 0xbfb8aa3b, v113
    v_exp_f32 v18, v18
    s_nop 0
    v_add_f32 v18, 1.0, v18
    v_rcp_f32 v18, v18
    s_nop 0
    v_mul_f32 v113, v113, v18
    v_cvt_pk_bf16_f32 v113, v113, v113
    v_lshlrev_b32 v113, 16, v113
    v_mul_f32 v18, 0xbfb8aa3b, v114
    v_exp_f32 v18, v18
    s_nop 0
    v_add_f32 v18, 1.0, v18
    v_rcp_f32 v18, v18
    s_nop 0
    v_mul_f32 v114, v114, v18
    v_cvt_pk_bf16_f32 v114, v114, v114
    v_lshlrev_b32 v114, 16, v114
    v_mul_f32 v18, 0xbfb8aa3b, v115
    v_exp_f32 v18, v18
    s_nop 0
    v_add_f32 v18, 1.0, v18
    v_rcp_f32 v18, v18
    s_nop 0
    v_mul_f32 v115, v115, v18
    v_cvt_pk_bf16_f32 v115, v115, v115
    v_lshlrev_b32 v115, 16, v115
    v_mul_f32 v18, 0xbfb8aa3b, v116
    v_exp_f32 v18, v18
    s_nop 0
    v_add_f32 v18, 1.0, v18
    v_rcp_f32 v18, v18
    s_nop 0
    v_mul_f32 v116, v116, v18
    v_cvt_pk_bf16_f32 v116, v116, v116
    v_lshlrev_b32 v116, 16, v116
    v_mul_f32 v18, 0xbfb8aa3b, v117
    v_exp_f32 v18, v18
    s_nop 0
    v_add_f32 v18, 1.0, v18
    v_rcp_f32 v18, v18
    s_nop 0
    v_mul_f32 v117, v117, v18
    v_cvt_pk_bf16_f32 v117, v117, v117
    v_lshlrev_b32 v117, 16, v117
    v_mul_f32 v18, 0xbfb8aa3b, v118
    v_exp_f32 v18, v18
    s_nop 0
    v_add_f32 v18, 1.0, v18
    v_rcp_f32 v18, v18
    s_nop 0
    v_mul_f32 v118, v118, v18
    v_cvt_pk_bf16_f32 v118, v118, v118
    v_lshlrev_b32 v118, 16, v118
    v_mul_f32 v18, 0xbfb8aa3b, v119
    v_exp_f32 v18, v18
    s_nop 0
    v_add_f32 v18, 1.0, v18
    v_rcp_f32 v18, v18
    s_nop 0
    v_mul_f32 v119, v119, v18
    v_cvt_pk_bf16_f32 v119, v119, v119
    v_lshlrev_b32 v119, 16, v119
    v_mul_f32 v18, 0xbfb8aa3b, v120
    v_exp_f32 v18, v18
    s_nop 0
    v_add_f32 v18, 1.0, v18
    v_rcp_f32 v18, v18
    s_nop 0
    v_mul_f32 v120, v120, v18
    v_cvt_pk_bf16_f32 v120, v120, v120
    v_lshlrev_b32 v120, 16, v120
    v_mul_f32 v18, 0xbfb8aa3b, v121
    v_exp_f32 v18, v18
    s_nop 0
    v_add_f32 v18, 1.0, v18
    v_rcp_f32 v18, v18
    s_nop 0
    v_mul_f32 v121, v121, v18
    v_cvt_pk_bf16_f32 v121, v121, v121
    v_lshlrev_b32 v121, 16, v121
    v_mul_f32 v18, 0xbfb8aa3b, v122
    v_exp_f32 v18, v18
    s_nop 0
    v_add_f32 v18, 1.0, v18
    v_rcp_f32 v18, v18
    s_nop 0
    v_mul_f32 v122, v122, v18
    v_cvt_pk_bf16_f32 v122, v122, v122
    v_lshlrev_b32 v122, 16, v122
    v_mul_f32 v18, 0xbfb8aa3b, v123
    v_exp_f32 v18, v18
    s_nop 0
    v_add_f32 v18, 1.0, v18
    v_rcp_f32 v18, v18
    s_nop 0
    v_mul_f32 v123, v123, v18
    v_cvt_pk_bf16_f32 v123, v123, v123
    v_lshlrev_b32 v123, 16, v123
    v_mul_f32 v18, 0xbfb8aa3b, v124
    v_exp_f32 v18, v18
    s_nop 0
    v_add_f32 v18, 1.0, v18
    v_rcp_f32 v18, v18
    s_nop 0
    v_mul_f32 v124, v124, v18
    v_cvt_pk_bf16_f32 v124, v124, v124
    v_lshlrev_b32 v124, 16, v124
    v_mul_f32 v18, 0xbfb8aa3b, v125
    v_exp_f32 v18, v18
    s_nop 0
    v_add_f32 v18, 1.0, v18
    v_rcp_f32 v18, v18
    s_nop 0
    v_mul_f32 v125, v125, v18
    v_cvt_pk_bf16_f32 v125, v125, v125
    v_lshlrev_b32 v125, 16, v125
    v_mul_f32 v18, 0xbfb8aa3b, v126
    v_exp_f32 v18, v18
    s_nop 0
    v_add_f32 v18, 1.0, v18
    v_rcp_f32 v18, v18
    s_nop 0
    v_mul_f32 v126, v126, v18
    v_cvt_pk_bf16_f32 v126, v126, v126
    v_lshlrev_b32 v126, 16, v126
    v_mul_f32 v18, 0xbfb8aa3b, v127
    v_exp_f32 v18, v18
    s_nop 0
    v_add_f32 v18, 1.0, v18
    v_rcp_f32 v18, v18
    s_nop 0
    v_mul_f32 v127, v127, v18
    v_cvt_pk_bf16_f32 v127, v127, v127
    v_lshlrev_b32 v127, 16, v127
    v_mov_b32 v96, 0
    v_mov_b32 v97, 0
    v_mov_b32 v98, 0
    v_mov_b32 v99, 0
    v_mov_b32 v100, 0
    v_mov_b32 v101, 0
    v_mov_b32 v102, 0
    v_mov_b32 v103, 0
    s_waitcnt vmcnt(27)
    v_lshlrev_b32 v18, 16, v32
    v_and_b32 v19, 0xffff0000, v32
    v_fmac_f32 v96, v18, v112
    v_fmac_f32 v97, v19, v112
    v_lshlrev_b32 v18, 16, v33
    v_and_b32 v19, 0xffff0000, v33
    v_fmac_f32 v98, v18, v112
    v_fmac_f32 v99, v19, v112
    v_lshlrev_b32 v18, 16, v34
    v_and_b32 v19, 0xffff0000, v34
    v_fmac_f32 v100, v18, v112
    v_fmac_f32 v101, v19, v112
    v_lshlrev_b32 v18, 16, v35
    v_and_b32 v19, 0xffff0000, v35
    v_fmac_f32 v102, v18, v112
    v_fmac_f32 v103, v19, v112
    s_waitcnt vmcnt(26)
    v_lshlrev_b32 v18, 16, v36
    v_and_b32 v19, 0xffff0000, v36
    v_fmac_f32 v96, v18, v113
    v_fmac_f32 v97, v19, v113
    v_lshlrev_b32 v18, 16, v37
    v_and_b32 v19, 0xffff0000, v37
    v_fmac_f32 v98, v18, v113
    v_fmac_f32 v99, v19, v113
    v_lshlrev_b32 v18, 16, v38
    v_and_b32 v19, 0xffff0000, v38
    v_fmac_f32 v100, v18, v113
    v_fmac_f32 v101, v19, v113
    v_lshlrev_b32 v18, 16, v39
    v_and_b32 v19, 0xffff0000, v39
    v_fmac_f32 v102, v18, v113
    v_fmac_f32 v103, v19, v113
    s_waitcnt vmcnt(25)
    v_lshlrev_b32 v18, 16, v40
    v_and_b32 v19, 0xffff0000, v40
    v_fmac_f32 v96, v18, v114
    v_fmac_f32 v97, v19, v114
    v_lshlrev_b32 v18, 16, v41
    v_and_b32 v19, 0xffff0000, v41
    v_fmac_f32 v98, v18, v114
    v_fmac_f32 v99, v19, v114
    v_lshlrev_b32 v18, 16, v42
    v_and_b32 v19, 0xffff0000, v42
    v_fmac_f32 v100, v18, v114
    v_fmac_f32 v101, v19, v114
    v_lshlrev_b32 v18, 16, v43
    v_and_b32 v19, 0xffff0000, v43
    v_fmac_f32 v102, v18, v114
    v_fmac_f32 v103, v19, v114
    s_waitcnt vmcnt(24)
    v_lshlrev_b32 v18, 16, v44
    v_and_b32 v19, 0xffff0000, v44
    v_fmac_f32 v96, v18, v115
    v_fmac_f32 v97, v19, v115
    v_lshlrev_b32 v18, 16, v45
    v_and_b32 v19, 0xffff0000, v45
    v_fmac_f32 v98, v18, v115
    v_fmac_f32 v99, v19, v115
    v_lshlrev_b32 v18, 16, v46
    v_and_b32 v19, 0xffff0000, v46
    v_fmac_f32 v100, v18, v115
    v_fmac_f32 v101, v19, v115
    v_lshlrev_b32 v18, 16, v47
    v_and_b32 v19, 0xffff0000, v47
    v_fmac_f32 v102, v18, v115
    v_fmac_f32 v103, v19, v115
    s_waitcnt vmcnt(23)
    v_lshlrev_b32 v18, 16, v48
    v_and_b32 v19, 0xffff0000, v48
    v_fmac_f32 v96, v18, v116
    v_fmac_f32 v97, v19, v116
    v_lshlrev_b32 v18, 16, v49
    v_and_b32 v19, 0xffff0000, v49
    v_fmac_f32 v98, v18, v116
    v_fmac_f32 v99, v19, v116
    v_lshlrev_b32 v18, 16, v50
    v_and_b32 v19, 0xffff0000, v50
    v_fmac_f32 v100, v18, v116
    v_fmac_f32 v101, v19, v116
    v_lshlrev_b32 v18, 16, v51
    v_and_b32 v19, 0xffff0000, v51
    v_fmac_f32 v102, v18, v116
    v_fmac_f32 v103, v19, v116
    s_waitcnt vmcnt(22)
    v_lshlrev_b32 v18, 16, v52
    v_and_b32 v19, 0xffff0000, v52
    v_fmac_f32 v96, v18, v117
    v_fmac_f32 v97, v19, v117
    v_lshlrev_b32 v18, 16, v53
    v_and_b32 v19, 0xffff0000, v53
    v_fmac_f32 v98, v18, v117
    v_fmac_f32 v99, v19, v117
    v_lshlrev_b32 v18, 16, v54
    v_and_b32 v19, 0xffff0000, v54
    v_fmac_f32 v100, v18, v117
    v_fmac_f32 v101, v19, v117
    v_lshlrev_b32 v18, 16, v55
    v_and_b32 v19, 0xffff0000, v55
    v_fmac_f32 v102, v18, v117
    v_fmac_f32 v103, v19, v117
    s_waitcnt vmcnt(21)
    v_lshlrev_b32 v18, 16, v56
    v_and_b32 v19, 0xffff0000, v56
    v_fmac_f32 v96, v18, v118
    v_fmac_f32 v97, v19, v118
    v_lshlrev_b32 v18, 16, v57
    v_and_b32 v19, 0xffff0000, v57
    v_fmac_f32 v98, v18, v118
    v_fmac_f32 v99, v19, v118
    v_lshlrev_b32 v18, 16, v58
    v_and_b32 v19, 0xffff0000, v58
    v_fmac_f32 v100, v18, v118
    v_fmac_f32 v101, v19, v118
    v_lshlrev_b32 v18, 16, v59
    v_and_b32 v19, 0xffff0000, v59
    v_fmac_f32 v102, v18, v118
    v_fmac_f32 v103, v19, v118
    s_waitcnt vmcnt(20)
    v_lshlrev_b32 v18, 16, v60
    v_and_b32 v19, 0xffff0000, v60
    v_fmac_f32 v96, v18, v119
    v_fmac_f32 v97, v19, v119
    v_lshlrev_b32 v18, 16, v61
    v_and_b32 v19, 0xffff0000, v61
    v_fmac_f32 v98, v18, v119
    v_fmac_f32 v99, v19, v119
    v_lshlrev_b32 v18, 16, v62
    v_and_b32 v19, 0xffff0000, v62
    v_fmac_f32 v100, v18, v119
    v_fmac_f32 v101, v19, v119
    v_lshlrev_b32 v18, 16, v63
    v_and_b32 v19, 0xffff0000, v63
    v_fmac_f32 v102, v18, v119
    v_fmac_f32 v103, v19, v119
    s_waitcnt vmcnt(19)
    v_lshlrev_b32 v18, 16, v64
    v_and_b32 v19, 0xffff0000, v64
    v_fmac_f32 v96, v18, v120
    v_fmac_f32 v97, v19, v120
    v_lshlrev_b32 v18, 16, v65
    v_and_b32 v19, 0xffff0000, v65
    v_fmac_f32 v98, v18, v120
    v_fmac_f32 v99, v19, v120
    v_lshlrev_b32 v18, 16, v66
    v_and_b32 v19, 0xffff0000, v66
    v_fmac_f32 v100, v18, v120
    v_fmac_f32 v101, v19, v120
    v_lshlrev_b32 v18, 16, v67
    v_and_b32 v19, 0xffff0000, v67
    v_fmac_f32 v102, v18, v120
    v_fmac_f32 v103, v19, v120
    s_waitcnt vmcnt(18)
    v_lshlrev_b32 v18, 16, v68
    v_and_b32 v19, 0xffff0000, v68
    v_fmac_f32 v96, v18, v121
    v_fmac_f32 v97, v19, v121
    v_lshlrev_b32 v18, 16, v69
    v_and_b32 v19, 0xffff0000, v69
    v_fmac_f32 v98, v18, v121
    v_fmac_f32 v99, v19, v121
    v_lshlrev_b32 v18, 16, v70
    v_and_b32 v19, 0xffff0000, v70
    v_fmac_f32 v100, v18, v121
    v_fmac_f32 v101, v19, v121
    v_lshlrev_b32 v18, 16, v71
    v_and_b32 v19, 0xffff0000, v71
    v_fmac_f32 v102, v18, v121
    v_fmac_f32 v103, v19, v121
    s_waitcnt vmcnt(17)
    v_lshlrev_b32 v18, 16, v72
    v_and_b32 v19, 0xffff0000, v72
    v_fmac_f32 v96, v18, v122
    v_fmac_f32 v97, v19, v122
    v_lshlrev_b32 v18, 16, v73
    v_and_b32 v19, 0xffff0000, v73
    v_fmac_f32 v98, v18, v122
    v_fmac_f32 v99, v19, v122
    v_lshlrev_b32 v18, 16, v74
    v_and_b32 v19, 0xffff0000, v74
    v_fmac_f32 v100, v18, v122
    v_fmac_f32 v101, v19, v122
    v_lshlrev_b32 v18, 16, v75
    v_and_b32 v19, 0xffff0000, v75
    v_fmac_f32 v102, v18, v122
    v_fmac_f32 v103, v19, v122
    s_waitcnt vmcnt(16)
    v_lshlrev_b32 v18, 16, v76
    v_and_b32 v19, 0xffff0000, v76
    v_fmac_f32 v96, v18, v123
    v_fmac_f32 v97, v19, v123
    v_lshlrev_b32 v18, 16, v77
    v_and_b32 v19, 0xffff0000, v77
    v_fmac_f32 v98, v18, v123
    v_fmac_f32 v99, v19, v123
    v_lshlrev_b32 v18, 16, v78
    v_and_b32 v19, 0xffff0000, v78
    v_fmac_f32 v100, v18, v123
    v_fmac_f32 v101, v19, v123
    v_lshlrev_b32 v18, 16, v79
    v_and_b32 v19, 0xffff0000, v79
    v_fmac_f32 v102, v18, v123
    v_fmac_f32 v103, v19, v123
    s_waitcnt vmcnt(15)
    v_lshlrev_b32 v18, 16, v80
    v_and_b32 v19, 0xffff0000, v80
    v_fmac_f32 v96, v18, v124
    v_fmac_f32 v97, v19, v124
    v_lshlrev_b32 v18, 16, v81
    v_and_b32 v19, 0xffff0000, v81
    v_fmac_f32 v98, v18, v124
    v_fmac_f32 v99, v19, v124
    v_lshlrev_b32 v18, 16, v82
    v_and_b32 v19, 0xffff0000, v82
    v_fmac_f32 v100, v18, v124
    v_fmac_f32 v101, v19, v124
    v_lshlrev_b32 v18, 16, v83
    v_and_b32 v19, 0xffff0000, v83
    v_fmac_f32 v102, v18, v124
    v_fmac_f32 v103, v19, v124
    s_waitcnt vmcnt(14)
    v_lshlrev_b32 v18, 16, v84
    v_and_b32 v19, 0xffff0000, v84
    v_fmac_f32 v96, v18, v125
    v_fmac_f32 v97, v19, v125
    v_lshlrev_b32 v18, 16, v85
    v_and_b32 v19, 0xffff0000, v85
    v_fmac_f32 v98, v18, v125
    v_fmac_f32 v99, v19, v125
    v_lshlrev_b32 v18, 16, v86
    v_and_b32 v19, 0xffff0000, v86
    v_fmac_f32 v100, v18, v125
    v_fmac_f32 v101, v19, v125
    v_lshlrev_b32 v18, 16, v87
    v_and_b32 v19, 0xffff0000, v87
    v_fmac_f32 v102, v18, v125
    v_fmac_f32 v103, v19, v125
    s_waitcnt vmcnt(13)
    v_lshlrev_b32 v18, 16, v88
    v_and_b32 v19, 0xffff0000, v88
    v_fmac_f32 v96, v18, v126
    v_fmac_f32 v97, v19, v126
    v_lshlrev_b32 v18, 16, v89
    v_and_b32 v19, 0xffff0000, v89
    v_fmac_f32 v98, v18, v126
    v_fmac_f32 v99, v19, v126
    v_lshlrev_b32 v18, 16, v90
    v_and_b32 v19, 0xffff0000, v90
    v_fmac_f32 v100, v18, v126
    v_fmac_f32 v101, v19, v126
    v_lshlrev_b32 v18, 16, v91
    v_and_b32 v19, 0xffff0000, v91
    v_fmac_f32 v102, v18, v126
    v_fmac_f32 v103, v19, v126
    s_waitcnt vmcnt(12)
    v_lshlrev_b32 v18, 16, v92
    v_and_b32 v19, 0xffff0000, v92
    v_fmac_f32 v96, v18, v127
    v_fmac_f32 v97, v19, v127
    v_lshlrev_b32 v18, 16, v93
    v_and_b32 v19, 0xffff0000, v93
    v_fmac_f32 v98, v18, v127
    v_fmac_f32 v99, v19, v127
    v_lshlrev_b32 v18, 16, v94
    v_and_b32 v19, 0xffff0000, v94
    v_fmac_f32 v100, v18, v127
    v_fmac_f32 v101, v19, v127
    v_lshlrev_b32 v18, 16, v95
    v_and_b32 v19, 0xffff0000, v95
    v_fmac_f32 v102, v18, v127
    v_fmac_f32 v103, v19, v127
    v_lshlrev_b32 v16, 5, v0
    ds_write_b128 v16, v[96:99]
    ds_write_b128 v16, v[100:103] offset:16
    s_waitcnt lgkmcnt(0)
    s_barrier
    s_cmp_lg_u32 s44, 0
    s_cbranch_scc1 L_mod_fin_105
    v_mov_b32 v18, 0
    ds_read_b32 v32, v12 offset:0
    ds_read_b32 v33, v12 offset:256
    ds_read_b32 v34, v12 offset:512
    ds_read_b32 v35, v12 offset:768
    ds_read_b32 v36, v12 offset:1024
    ds_read_b32 v37, v12 offset:1280
    ds_read_b32 v38, v12 offset:1536
    ds_read_b32 v39, v12 offset:1792
    ds_read_b32 v40, v12 offset:2048
    ds_read_b32 v41, v12 offset:2304
    ds_read_b32 v42, v12 offset:2560
    ds_read_b32 v43, v12 offset:2816
    ds_read_b32 v44, v12 offset:3072
    ds_read_b32 v45, v12 offset:3328
    ds_read_b32 v46, v12 offset:3584
    ds_read_b32 v47, v12 offset:3840
    s_waitcnt lgkmcnt(0)
    v_add_f32 v18, v18, v32
    v_add_f32 v18, v18, v33
    v_add_f32 v18, v18, v34
    v_add_f32 v18, v18, v35
    v_add_f32 v18, v18, v36
    v_add_f32 v18, v18, v37
    v_add_f32 v18, v18, v38
    v_add_f32 v18, v18, v39
    v_add_f32 v18, v18, v40
    v_add_f32 v18, v18, v41
    v_add_f32 v18, v18, v42
    v_add_f32 v18, v18, v43
    v_add_f32 v18, v18, v44
    v_add_f32 v18, v18, v45
    v_add_f32 v18, v18, v46
    v_add_f32 v18, v18, v47
    ds_read_b32 v32, v12 offset:4096
    ds_read_b32 v33, v12 offset:4352
    ds_read_b32 v34, v12 offset:4608
    ds_read_b32 v35, v12 offset:4864
    ds_read_b32 v36, v12 offset:5120
    ds_read_b32 v37, v12 offset:5376
    ds_read_b32 v38, v12 offset:5632
    ds_read_b32 v39, v12 offset:5888
    ds_read_b32 v40, v12 offset:6144
    ds_read_b32 v41, v12 offset:6400
    ds_read_b32 v42, v12 offset:6656
    ds_read_b32 v43, v12 offset:6912
    ds_read_b32 v44, v12 offset:7168
    ds_read_b32 v45, v12 offset:7424
    ds_read_b32 v46, v12 offset:7680
    ds_read_b32 v47, v12 offset:7936
    s_waitcnt lgkmcnt(0)
    v_add_f32 v18, v18, v32
    v_add_f32 v18, v18, v33
    v_add_f32 v18, v18, v34
    v_add_f32 v18, v18, v35
    v_add_f32 v18, v18, v36
    v_add_f32 v18, v18, v37
    v_add_f32 v18, v18, v38
    v_add_f32 v18, v18, v39
    v_add_f32 v18, v18, v40
    v_add_f32 v18, v18, v41
    v_add_f32 v18, v18, v42
    v_add_f32 v18, v18, v43
    v_add_f32 v18, v18, v44
    v_add_f32 v18, v18, v45
    v_add_f32 v18, v18, v46
    v_add_f32 v18, v18, v47
    s_lshr_b32 s45, s39, 1
    s_lshl_b32 s45, s45, 8
    s_mul_i32 s46, s47, 24576
    s_add_u32 s45, s45, s46
    buffer_store_dword v18, v12, s[12:15], s45 offen sc1
L_mod_fin_105:
    s_waitcnt vmcnt(0)
    s_barrier
    s_cmp_lg_u32 s44, 0
    s_cbranch_scc1 L_cnt_106
    v_mov_b32 v30, 1
    v_mov_b32 v31, 0
    s_mov_b64 exec, 1
    buffer_atomic_add v30, v31, s[16:19], 0 offen offset:128 sc1
    s_mov_b64 exec, -1
L_cnt_106:
    v_lshlrev_b32 v192, 16, v128
    v_and_b32 v193, 0xffff0000, v128
    v_lshlrev_b32 v194, 16, v129
    v_and_b32 v195, 0xffff0000, v129
    v_lshlrev_b32 v196, 16, v130
    v_and_b32 v197, 0xffff0000, v130
    v_lshlrev_b32 v198, 16, v131
    v_and_b32 v199, 0xffff0000, v131
    v_lshlrev_b32 v200, 16, v132
    v_and_b32 v201, 0xffff0000, v132
    v_lshlrev_b32 v202, 16, v133
    v_and_b32 v203, 0xffff0000, v133
    v_lshlrev_b32 v204, 16, v134
    v_and_b32 v205, 0xffff0000, v134
    v_lshlrev_b32 v206, 16, v135
    v_and_b32 v207, 0xffff0000, v135
    v_add_f32 v26, v192, v193
    v_add_f32 v26, v26, v194
    v_add_f32 v26, v26, v195
    v_add_f32 v26, v26, v196
    v_add_f32 v26, v26, v197
    v_add_f32 v26, v26, v198
    v_add_f32 v26, v26, v199
    v_add_f32 v26, v26, v200
    v_add_f32 v26, v26, v201
    v_add_f32 v26, v26, v202
    v_add_f32 v26, v26, v203
    v_add_f32 v26, v26, v204
    v_add_f32 v26, v26, v205
    v_add_f32 v26, v26, v206
    v_add_f32 v26, v26, v207
    s_nop 1
    v_add_f32_dpp v26, v26, v26 row_shr:1 row_mask:0xf bank_mask:0xf bound_ctrl:0
    s_nop 1
    v_add_f32_dpp v26, v26, v26 row_shr:2 row_mask:0xf bank_mask:0xf bound_ctrl:0
    s_nop 1
    v_add_f32_dpp v26, v26, v26 row_shr:4 row_mask:0xf bank_mask:0xf bound_ctrl:0
    s_nop 1
    v_add_f32_dpp v26, v26, v26 row_shr:8 row_mask:0xf bank_mask:0xf bound_ctrl:0
    s_nop 1
    v_add_f32_dpp v26, v26, v26 row_bcast:15 row_mask:0xa bank_mask:0xf
    s_nop 1
    v_add_f32_dpp v26, v26, v26 row_bcast:31 row_mask:0xc bank_mask:0xf
    s_nop 1
    v_readlane_b32 s66, v26, 63
    s_nop 1
    v_mov_b32 v27, s66
    v_mul_f32 v27, 0x3a800000, v27
    v_mov_b32 v26, 0
    v_sub_f32 v28, v192, v27
    v_fmac_f32 v26, v28, v28
    v_sub_f32 v28, v193, v27
    v_fmac_f32 v26, v28, v28
    v_sub_f32 v28, v194, v27
    v_fmac_f32 v26, v28, v28
    v_sub_f32 v28, v195, v27
    v_fmac_f32 v26, v28, v28
    v_sub_f32 v28, v196, v27
    v_fmac_f32 v26, v28, v28
    v_sub_f32 v28, v197, v27
    v_fmac_f32 v26, v28, v28
    v_sub_f32 v28, v198, v27
    v_fmac_f32 v26, v28, v28
    v_sub_f32 v28, v199, v27
    v_fmac_f32 v26, v28, v28
    v_sub_f32 v28, v200, v27
    v_fmac_f32 v26, v28, v28
    v_sub_f32 v28, v201, v27
    v_fmac_f32 v26, v28, v28
    v_sub_f32 v28, v202, v27
    v_fmac_f32 v26, v28, v28
    v_sub_f32 v28, v203, v27
    v_fmac_f32 v26, v28, v28
    v_sub_f32 v28, v204, v27
    v_fmac_f32 v26, v28, v28
    v_sub_f32 v28, v205, v27
    v_fmac_f32 v26, v28, v28
    v_sub_f32 v28, v206, v27
    v_fmac_f32 v26, v28, v28
    v_sub_f32 v28, v207, v27
    v_fmac_f32 v26, v28, v28
    s_nop 1
    v_add_f32_dpp v26, v26, v26 row_shr:1 row_mask:0xf bank_mask:0xf bound_ctrl:0
    s_nop 1
    v_add_f32_dpp v26, v26, v26 row_shr:2 row_mask:0xf bank_mask:0xf bound_ctrl:0
    s_nop 1
    v_add_f32_dpp v26, v26, v26 row_shr:4 row_mask:0xf bank_mask:0xf bound_ctrl:0
    s_nop 1
    v_add_f32_dpp v26, v26, v26 row_shr:8 row_mask:0xf bank_mask:0xf bound_ctrl:0
    s_nop 1
    v_add_f32_dpp v26, v26, v26 row_bcast:15 row_mask:0xa bank_mask:0xf
    s_nop 1
    v_add_f32_dpp v26, v26, v26 row_bcast:31 row_mask:0xc bank_mask:0xf
    s_nop 1
    v_readlane_b32 s66, v26, 63
    s_nop 1
    v_mov_b32 v26, s66
    v_mul_f32 v26, 0x3a800000, v26
    v_cvt_pk_bf16_f32 v26, v26, v26
    v_lshlrev_b32 v26, 16, v26
    v_cvt_pk_bf16_f32 v27, v27, v27
    v_lshlrev_b32 v27, 16, v27
    v_add_f32 v26, 0x3727c5ac, v26
    v_cvt_pk_bf16_f32 v26, v26, v26
    v_lshlrev_b32 v26, 16, v26
    v_sqrt_f32 v26, v26
    s_nop 0
    v_cvt_pk_bf16_f32 v26, v26, v26
    v_lshlrev_b32 v26, 16, v26
    v_rcp_f32 v26, v26
    s_nop 0
    v_sub_f32 v192, v192, v27
    v_cvt_pk_bf16_f32 v192, v192, v192
    v_lshlrev_b32 v192, 16, v192
    v_mul_f32 v192, v192, v26
    v_cvt_pk_bf16_f32 v192, v192, v192
    v_lshlrev_b32 v192, 16, v192
    v_sub_f32 v193, v193, v27
    v_cvt_pk_bf16_f32 v193, v193, v193
    v_lshlrev_b32 v193, 16, v193
    v_mul_f32 v193, v193, v26
    v_cvt_pk_bf16_f32 v193, v193, v193
    v_lshlrev_b32 v193, 16, v193
    v_sub_f32 v194, v194, v27
    v_cvt_pk_bf16_f32 v194, v194, v194
    v_lshlrev_b32 v194, 16, v194
    v_mul_f32 v194, v194, v26
    v_cvt_pk_bf16_f32 v194, v194, v194
    v_lshlrev_b32 v194, 16, v194
    v_sub_f32 v195, v195, v27
    v_cvt_pk_bf16_f32 v195, v195, v195
    v_lshlrev_b32 v195, 16, v195
    v_mul_f32 v195, v195, v26
    v_cvt_pk_bf16_f32 v195, v195, v195
    v_lshlrev_b32 v195, 16, v195
    v_sub_f32 v196, v196, v27
    v_cvt_pk_bf16_f32 v196, v196, v196
    v_lshlrev_b32 v196, 16, v196
    v_mul_f32 v196, v196, v26
    v_cvt_pk_bf16_f32 v196, v196, v196
    v_lshlrev_b32 v196, 16, v196
    v_sub_f32 v197, v197, v27
    v_cvt_pk_bf16_f32 v197, v197, v197
    v_lshlrev_b32 v197, 16, v197
    v_mul_f32 v197, v197, v26
    v_cvt_pk_bf16_f32 v197, v197, v197
    v_lshlrev_b32 v197, 16, v197
    v_sub_f32 v198, v198, v27
    v_cvt_pk_bf16_f32 v198, v198, v198
    v_lshlrev_b32 v198, 16, v198
    v_mul_f32 v198, v198, v26
    v_cvt_pk_bf16_f32 v198, v198, v198
    v_lshlrev_b32 v198, 16, v198
    v_sub_f32 v199, v199, v27
    v_cvt_pk_bf16_f32 v199, v199, v199
    v_lshlrev_b32 v199, 16, v199
    v_mul_f32 v199, v199, v26
    v_cvt_pk_bf16_f32 v199, v199, v199
    v_lshlrev_b32 v199, 16, v199
    v_sub_f32 v200, v200, v27
    v_cvt_pk_bf16_f32 v200, v200, v200
    v_lshlrev_b32 v200, 16, v200
    v_mul_f32 v200, v200, v26
    v_cvt_pk_bf16_f32 v200, v200, v200
    v_lshlrev_b32 v200, 16, v200
    v_sub_f32 v201, v201, v27
    v_cvt_pk_bf16_f32 v201, v201, v201
    v_lshlrev_b32 v201, 16, v201
    v_mul_f32 v201, v201, v26
    v_cvt_pk_bf16_f32 v201, v201, v201
    v_lshlrev_b32 v201, 16, v201
    v_sub_f32 v202, v202, v27
    v_cvt_pk_bf16_f32 v202, v202, v202
    v_lshlrev_b32 v202, 16, v202
    v_mul_f32 v202, v202, v26
    v_cvt_pk_bf16_f32 v202, v202, v202
    v_lshlrev_b32 v202, 16, v202
    v_sub_f32 v203, v203, v27
    v_cvt_pk_bf16_f32 v203, v203, v203
    v_lshlrev_b32 v203, 16, v203
    v_mul_f32 v203, v203, v26
    v_cvt_pk_bf16_f32 v203, v203, v203
    v_lshlrev_b32 v203, 16, v203
    v_sub_f32 v204, v204, v27
    v_cvt_pk_bf16_f32 v204, v204, v204
    v_lshlrev_b32 v204, 16, v204
    v_mul_f32 v204, v204, v26
    v_cvt_pk_bf16_f32 v204, v204, v204
    v_lshlrev_b32 v204, 16, v204
    v_sub_f32 v205, v205, v27
    v_cvt_pk_bf16_f32 v205, v205, v205
    v_lshlrev_b32 v205, 16, v205
    v_mul_f32 v205, v205, v26
    v_cvt_pk_bf16_f32 v205, v205, v205
    v_lshlrev_b32 v205, 16, v205
    v_sub_f32 v206, v206, v27
    v_cvt_pk_bf16_f32 v206, v206, v206
    v_lshlrev_b32 v206, 16, v206
    v_mul_f32 v206, v206, v26
    v_cvt_pk_bf16_f32 v206, v206, v206
    v_lshlrev_b32 v206, 16, v206
    v_sub_f32 v207, v207, v27
    v_cvt_pk_bf16_f32 v207, v207, v207
    v_lshlrev_b32 v207, 16, v207
    v_mul_f32 v207, v207, v26
    v_cvt_pk_bf16_f32 v207, v207, v207
    v_lshlrev_b32 v207, 16, v207
    v_lshlrev_b32 v208, 16, v136
    v_and_b32 v209, 0xffff0000, v136
    v_lshlrev_b32 v210, 16, v137
    v_and_b32 v211, 0xffff0000, v137
    v_lshlrev_b32 v212, 16, v138
    v_and_b32 v213, 0xffff0000, v138
    v_lshlrev_b32 v214, 16, v139
    v_and_b32 v215, 0xffff0000, v139
    v_lshlrev_b32 v216, 16, v140
    v_and_b32 v217, 0xffff0000, v140
    v_lshlrev_b32 v218, 16, v141
    v_and_b32 v219, 0xffff0000, v141
    v_lshlrev_b32 v220, 16, v142
    v_and_b32 v221, 0xffff0000, v142
    v_lshlrev_b32 v222, 16, v143
    v_and_b32 v223, 0xffff0000, v143
    v_add_f32 v26, v208, v209
    v_add_f32 v26, v26, v210
    v_add_f32 v26, v26, v211
    v_add_f32 v26, v26, v212
    v_add_f32 v26, v26, v213
    v_add_f32 v26, v26, v214
    v_add_f32 v26, v26, v215
    v_add_f32 v26, v26, v216
    v_add_f32 v26, v26, v217
    v_add_f32 v26, v26, v218
    v_add_f32 v26, v26, v219
    v_add_f32 v26, v26, v220
    v_add_f32 v26, v26, v221
    v_add_f32 v26, v26, v222
    v_add_f32 v26, v26, v223
    s_nop 1
    v_add_f32_dpp v26, v26, v26 row_shr:1 row_mask:0xf bank_mask:0xf bound_ctrl:0
    s_nop 1
    v_add_f32_dpp v26, v26, v26 row_shr:2 row_mask:0xf bank_mask:0xf bound_ctrl:0
    s_nop 1
    v_add_f32_dpp v26, v26, v26 row_shr:4 row_mask:0xf bank_mask:0xf bound_ctrl:0
    s_nop 1
    v_add_f32_dpp v26, v26, v26 row_shr:8 row_mask:0xf bank_mask:0xf bound_ctrl:0
    s_nop 1
    v_add_f32_dpp v26, v26, v26 row_bcast:15 row_mask:0xa bank_mask:0xf
    s_nop 1
    v_add_f32_dpp v26, v26, v26 row_bcast:31 row_mask:0xc bank_mask:0xf
    s_nop 1
    v_readlane_b32 s66, v26, 63
    s_nop 1
    v_mov_b32 v27, s66
    v_mul_f32 v27, 0x3a800000, v27
    v_mov_b32 v26, 0
    v_sub_f32 v28, v208, v27
    v_fmac_f32 v26, v28, v28
    v_sub_f32 v28, v209, v27
    v_fmac_f32 v26, v28, v28
    v_sub_f32 v28, v210, v27
    v_fmac_f32 v26, v28, v28
    v_sub_f32 v28, v211, v27
    v_fmac_f32 v26, v28, v28
    v_sub_f32 v28, v212, v27
    v_fmac_f32 v26, v28, v28
    v_sub_f32 v28, v213, v27
    v_fmac_f32 v26, v28, v28
    v_sub_f32 v28, v214, v27
    v_fmac_f32 v26, v28, v28
    v_sub_f32 v28, v215, v27
    v_fmac_f32 v26, v28, v28
    v_sub_f32 v28, v216, v27
    v_fmac_f32 v26, v28, v28
    v_sub_f32 v28, v217, v27
    v_fmac_f32 v26, v28, v28
    v_sub_f32 v28, v218, v27
    v_fmac_f32 v26, v28, v28
    v_sub_f32 v28, v219, v27
    v_fmac_f32 v26, v28, v28
    v_sub_f32 v28, v220, v27
    v_fmac_f32 v26, v28, v28
    v_sub_f32 v28, v221, v27
    v_fmac_f32 v26, v28, v28
    v_sub_f32 v28, v222, v27
    v_fmac_f32 v26, v28, v28
    v_sub_f32 v28, v223, v27
    v_fmac_f32 v26, v28, v28
    s_nop 1
    v_add_f32_dpp v26, v26, v26 row_shr:1 row_mask:0xf bank_mask:0xf bound_ctrl:0
    s_nop 1
    v_add_f32_dpp v26, v26, v26 row_shr:2 row_mask:0xf bank_mask:0xf bound_ctrl:0
    s_nop 1
    v_add_f32_dpp v26, v26, v26 row_shr:4 row_mask:0xf bank_mask:0xf bound_ctrl:0
    s_nop 1
    v_add_f32_dpp v26, v26, v26 row_shr:8 row_mask:0xf bank_mask:0xf bound_ctrl:0
    s_nop 1
    v_add_f32_dpp v26, v26, v26 row_bcast:15 row_mask:0xa bank_mask:0xf
    s_nop 1
    v_add_f32_dpp v26, v26, v26 row_bcast:31 row_mask:0xc bank_mask:0xf
    s_nop 1
    v_readlane_b32 s66, v26, 63
    s_nop 1
    v_mov_b32 v26, s66
    v_mul_f32 v26, 0x3a800000, v26
    v_cvt_pk_bf16_f32 v26, v26, v26
    v_lshlrev_b32 v26, 16, v26
    v_cvt_pk_bf16_f32 v27, v27, v27
    v_lshlrev_b32 v27, 16, v27
    v_add_f32 v26, 0x3727c5ac, v26
    v_cvt_pk_bf16_f32 v26, v26, v26
    v_lshlrev_b32 v26, 16, v26
    v_sqrt_f32 v26, v26
    s_nop 0
    v_cvt_pk_bf16_f32 v26, v26, v26
    v_lshlrev_b32 v26, 16, v26
    v_rcp_f32 v26, v26
    s_nop 0
    v_sub_f32 v208, v208, v27
    v_cvt_pk_bf16_f32 v208, v208, v208
    v_lshlrev_b32 v208, 16, v208
    v_mul_f32 v208, v208, v26
    v_cvt_pk_bf16_f32 v208, v208, v208
    v_lshlrev_b32 v208, 16, v208
    v_sub_f32 v209, v209, v27
    v_cvt_pk_bf16_f32 v209, v209, v209
    v_lshlrev_b32 v209, 16, v209
    v_mul_f32 v209, v209, v26
    v_cvt_pk_bf16_f32 v209, v209, v209
    v_lshlrev_b32 v209, 16, v209
    v_sub_f32 v210, v210, v27
    v_cvt_pk_bf16_f32 v210, v210, v210
    v_lshlrev_b32 v210, 16, v210
    v_mul_f32 v210, v210, v26
    v_cvt_pk_bf16_f32 v210, v210, v210
    v_lshlrev_b32 v210, 16, v210
    v_sub_f32 v211, v211, v27
    v_cvt_pk_bf16_f32 v211, v211, v211
    v_lshlrev_b32 v211, 16, v211
    v_mul_f32 v211, v211, v26
    v_cvt_pk_bf16_f32 v211, v211, v211
    v_lshlrev_b32 v211, 16, v211
    v_sub_f32 v212, v212, v27
    v_cvt_pk_bf16_f32 v212, v212, v212
    v_lshlrev_b32 v212, 16, v212
    v_mul_f32 v212, v212, v26
    v_cvt_pk_bf16_f32 v212, v212, v212
    v_lshlrev_b32 v212, 16, v212
    v_sub_f32 v213, v213, v27
    v_cvt_pk_bf16_f32 v213, v213, v213
    v_lshlrev_b32 v213, 16, v213
    v_mul_f32 v213, v213, v26
    v_cvt_pk_bf16_f32 v213, v213, v213
    v_lshlrev_b32 v213, 16, v213
    v_sub_f32 v214, v214, v27
    v_cvt_pk_bf16_f32 v214, v214, v214
    v_lshlrev_b32 v214, 16, v214
    v_mul_f32 v214, v214, v26
    v_cvt_pk_bf16_f32 v214, v214, v214
    v_lshlrev_b32 v214, 16, v214
    v_sub_f32 v215, v215, v27
    v_cvt_pk_bf16_f32 v215, v215, v215
    v_lshlrev_b32 v215, 16, v215
    v_mul_f32 v215, v215, v26
    v_cvt_pk_bf16_f32 v215, v215, v215
    v_lshlrev_b32 v215, 16, v215
    v_sub_f32 v216, v216, v27
    v_cvt_pk_bf16_f32 v216, v216, v216
    v_lshlrev_b32 v216, 16, v216
    v_mul_f32 v216, v216, v26
    v_cvt_pk_bf16_f32 v216, v216, v216
    v_lshlrev_b32 v216, 16, v216
    v_sub_f32 v217, v217, v27
    v_cvt_pk_bf16_f32 v217, v217, v217
    v_lshlrev_b32 v217, 16, v217
    v_mul_f32 v217, v217, v26
    v_cvt_pk_bf16_f32 v217, v217, v217
    v_lshlrev_b32 v217, 16, v217
    v_sub_f32 v218, v218, v27
    v_cvt_pk_bf16_f32 v218, v218, v218
    v_lshlrev_b32 v218, 16, v218
    v_mul_f32 v218, v218, v26
    v_cvt_pk_bf16_f32 v218, v218, v218
    v_lshlrev_b32 v218, 16, v218
    v_sub_f32 v219, v219, v27
    v_cvt_pk_bf16_f32 v219, v219, v219
    v_lshlrev_b32 v219, 16, v219
    v_mul_f32 v219, v219, v26
    v_cvt_pk_bf16_f32 v219, v219, v219
    v_lshlrev_b32 v219, 16, v219
    v_sub_f32 v220, v220, v27
    v_cvt_pk_bf16_f32 v220, v220, v220
    v_lshlrev_b32 v220, 16, v220
    v_mul_f32 v220, v220, v26
    v_cvt_pk_bf16_f32 v220, v220, v220
    v_lshlrev_b32 v220, 16, v220
    v_sub_f32 v221, v221, v27
    v_cvt_pk_bf16_f32 v221, v221, v221
    v_lshlrev_b32 v221, 16, v221
    v_mul_f32 v221, v221, v26
    v_cvt_pk_bf16_f32 v221, v221, v221
    v_lshlrev_b32 v221, 16, v221
    v_sub_f32 v222, v222, v27
    v_cvt_pk_bf16_f32 v222, v222, v222
    v_lshlrev_b32 v222, 16, v222
    v_mul_f32 v222, v222, v26
    v_cvt_pk_bf16_f32 v222, v222, v222
    v_lshlrev_b32 v222, 16, v222
    v_sub_f32 v223, v223, v27
    v_cvt_pk_bf16_f32 v223, v223, v223
    v_lshlrev_b32 v223, 16, v223
    v_mul_f32 v223, v223, v26
    v_cvt_pk_bf16_f32 v223, v223, v223
    v_lshlrev_b32 v223, 16, v223
    s_cmp_lg_u32 s44, 0
    s_cbranch_scc1 L_pd_107
    v_mov_b32 v29, 128
    s_mov_b32 s46, 96
    s_mov_b64 exec, 1
    s_mov_b32 s70, 0
L_wp_108:
    buffer_load_dword v31, v29, s[16:19], 0 offen sc1
    s_add_u32 s70, s70, 1
    s_cmp_ge_u32 s70, 0x200000
    s_cbranch_scc1 L_w_done_102
    s_waitcnt vmcnt(0)
    v_cmp_gt_u32 vcc, s46, v31
    s_nop 1
    s_cbranch_vccz L_wp_108_ok
    s_sleep 1
    s_branch L_wp_108
L_wp_108_ok:
    s_mov_b64 exec, -1
L_pd_107:
    s_barrier
    v_lshlrev_b32 v29, 5, v1
    s_mov_b32 s45, 0
    buffer_load_dwordx4 v[96:99], v29, s[12:15], s45 offen offset:0 sc1
    buffer_load_dwordx4 v[100:103], v29, s[12:15], s45 offen offset:16 sc1
    buffer_load_dwordx4 v[104:107], v29, s[12:15], s45 offen offset:2048 sc1
    buffer_load_dwordx4 v[108:111], v29, s[12:15], s45 offen offset:2064 sc1
    s_mov_b32 s45, 24576
    buffer_load_dwordx4 v[32:35], v29, s[12:15], s45 offen offset:0 sc1
    buffer_load_dwordx4 v[36:39], v29, s[12:15], s45 offen offset:16 sc1
    buffer_load_dwordx4 v[40:43], v29, s[12:15], s45 offen offset:2048 sc1
    buffer_load_dwordx4 v[44:47], v29, s[12:15], s45 offen offset:2064 sc1
    s_mov_b32 s45, 4096
    buffer_load_dwordx4 v[112:115], v29, s[12:15], s45 offen offset:0 sc1
    buffer_load_dwordx4 v[116:119], v29, s[12:15], s45 offen offset:16 sc1
    buffer_load_dwordx4 v[120:123], v29, s[12:15], s45 offen offset:2048 sc1
    buffer_load_dwordx4 v[124:127], v29, s[12:15], s45 offen offset:2064 sc1
    s_mov_b32 s45, 28672
    buffer_load_dwordx4 v[48:51], v29, s[12:15], s45 offen offset:0 sc1
    buffer_load_dwordx4 v[52:55], v29, s[12:15], s45 offen offset:16 sc1
    buffer_load_dwordx4 v[56:59], v29, s[12:15], s45 offen offset:2048 sc1
    buffer_load_dwordx4 v[60:63], v29, s[12:15], s45 offen offset:2064 sc1
    s_waitcnt vmcnt(0)
    v_add_f32 v96, v96, v32
    v_cvt_pk_bf16_f32 v96, v96, v96
    v_lshlrev_b32 v96, 16, v96
    v_add_f32 v97, v97, v33
    v_cvt_pk_bf16_f32 v97, v97, v97
    v_lshlrev_b32 v97, 16, v97
    v_add_f32 v98, v98, v34
    v_cvt_pk_bf16_f32 v98, v98, v98
    v_lshlrev_b32 v98, 16, v98
    v_add_f32 v99, v99, v35
    v_cvt_pk_bf16_f32 v99, v99, v99
    v_lshlrev_b32 v99, 16, v99
    v_add_f32 v100, v100, v36
    v_cvt_pk_bf16_f32 v100, v100, v100
    v_lshlrev_b32 v100, 16, v100
    v_add_f32 v101, v101, v37
    v_cvt_pk_bf16_f32 v101, v101, v101
    v_lshlrev_b32 v101, 16, v101
    v_add_f32 v102, v102, v38
    v_cvt_pk_bf16_f32 v102, v102, v102
    v_lshlrev_b32 v102, 16, v102
    v_add_f32 v103, v103, v39
    v_cvt_pk_bf16_f32 v103, v103, v103
    v_lshlrev_b32 v103, 16, v103
    v_add_f32 v104, v104, v40
    v_cvt_pk_bf16_f32 v104, v104, v104
    v_lshlrev_b32 v104, 16, v104
    v_add_f32 v105, v105, v41
    v_cvt_pk_bf16_f32 v105, v105, v105
    v_lshlrev_b32 v105, 16, v105
    v_add_f32 v106, v106, v42
    v_cvt_pk_bf16_f32 v106, v106, v106
    v_lshlrev_b32 v106, 16, v106
    v_add_f32 v107, v107, v43
    v_cvt_pk_bf16_f32 v107, v107, v107
    v_lshlrev_b32 v107, 16, v107
    v_add_f32 v108, v108, v44
    v_cvt_pk_bf16_f32 v108, v108, v108
    v_lshlrev_b32 v108, 16, v108
    v_add_f32 v109, v109, v45
    v_cvt_pk_bf16_f32 v109, v109, v109
    v_lshlrev_b32 v109, 16, v109
    v_add_f32 v110, v110, v46
    v_cvt_pk_bf16_f32 v110, v110, v110
    v_lshlrev_b32 v110, 16, v110
    v_add_f32 v111, v111, v47
    v_cvt_pk_bf16_f32 v111, v111, v111
    v_lshlrev_b32 v111, 16, v111
    v_add_f32 v112, v112, v48
    v_cvt_pk_bf16_f32 v112, v112, v112
    v_lshlrev_b32 v112, 16, v112
    v_add_f32 v112, 1.0, v112
    v_cvt_pk_bf16_f32 v112, v112, v112
    v_lshlrev_b32 v112, 16, v112
    v_add_f32 v113, v113, v49
    v_cvt_pk_bf16_f32 v113, v113, v113
    v_lshlrev_b32 v113, 16, v113
    v_add_f32 v113, 1.0, v113
    v_cvt_pk_bf16_f32 v113, v113, v113
    v_lshlrev_b32 v113, 16, v113
    v_add_f32 v114, v114, v50
    v_cvt_pk_bf16_f32 v114, v114, v114
    v_lshlrev_b32 v114, 16, v114
    v_add_f32 v114, 1.0, v114
    v_cvt_pk_bf16_f32 v114, v114, v114
    v_lshlrev_b32 v114, 16, v114
    v_add_f32 v115, v115, v51
    v_cvt_pk_bf16_f32 v115, v115, v115
    v_lshlrev_b32 v115, 16, v115
    v_add_f32 v115, 1.0, v115
    v_cvt_pk_bf16_f32 v115, v115, v115
    v_lshlrev_b32 v115, 16, v115
    v_add_f32 v116, v116, v52
    v_cvt_pk_bf16_f32 v116, v116, v116
    v_lshlrev_b32 v116, 16, v116
    v_add_f32 v116, 1.0, v116
    v_cvt_pk_bf16_f32 v116, v116, v116
    v_lshlrev_b32 v116, 16, v116
    v_add_f32 v117, v117, v53
    v_cvt_pk_bf16_f32 v117, v117, v117
    v_lshlrev_b32 v117, 16, v117
    v_add_f32 v117, 1.0, v117
    v_cvt_pk_bf16_f32 v117, v117, v117
    v_lshlrev_b32 v117, 16, v117
    v_add_f32 v118, v118, v54
    v_cvt_pk_bf16_f32 v118, v118, v118
    v_lshlrev_b32 v118, 16, v118
    v_add_f32 v118, 1.0, v118
    v_cvt_pk_bf16_f32 v118, v118, v118
    v_lshlrev_b32 v118, 16, v118
    v_add_f32 v119, v119, v55
    v_cvt_pk_bf16_f32 v119, v119, v119
    v_lshlrev_b32 v119, 16, v119
    v_add_f32 v119, 1.0, v119
    v_cvt_pk_bf16_f32 v119, v119, v119
    v_lshlrev_b32 v119, 16, v119
    v_add_f32 v120, v120, v56
    v_cvt_pk_bf16_f32 v120, v120, v120
    v_lshlrev_b32 v120, 16, v120
    v_add_f32 v120, 1.0, v120
    v_cvt_pk_bf16_f32 v120, v120, v120
    v_lshlrev_b32 v120, 16, v120
    v_add_f32 v121, v121, v57
    v_cvt_pk_bf16_f32 v121, v121, v121
    v_lshlrev_b32 v121, 16, v121
    v_add_f32 v121, 1.0, v121
    v_cvt_pk_bf16_f32 v121, v121, v121
    v_lshlrev_b32 v121, 16, v121
    v_add_f32 v122, v122, v58
    v_cvt_pk_bf16_f32 v122, v122, v122
    v_lshlrev_b32 v122, 16, v122
    v_add_f32 v122, 1.0, v122
    v_cvt_pk_bf16_f32 v122, v122, v122
    v_lshlrev_b32 v122, 16, v122
    v_add_f32 v123, v123, v59
    v_cvt_pk_bf16_f32 v123, v123, v123
    v_lshlrev_b32 v123, 16, v123
    v_add_f32 v123, 1.0, v123
    v_cvt_pk_bf16_f32 v123, v123, v123
    v_lshlrev_b32 v123, 16, v123
    v_add_f32 v124, v124, v60
    v_cvt_pk_bf16_f32 v124, v124, v124
    v_lshlrev_b32 v124, 16, v124
    v_add_f32 v124, 1.0, v124
    v_cvt_pk_bf16_f32 v124, v124, v124
    v_lshlrev_b32 v124, 16, v124
    v_add_f32 v125, v125, v61
    v_cvt_pk_bf16_f32 v125, v125, v125
    v_lshlrev_b32 v125, 16, v125
    v_add_f32 v125, 1.0, v125
    v_cvt_pk_bf16_f32 v125, v125, v125
    v_lshlrev_b32 v125, 16, v125
    v_add_f32 v126, v126, v62
    v_cvt_pk_bf16_f32 v126, v126, v126
    v_lshlrev_b32 v126, 16, v126
    v_add_f32 v126, 1.0, v126
    v_cvt_pk_bf16_f32 v126, v126, v126
    v_lshlrev_b32 v126, 16, v126
    v_add_f32 v127, v127, v63
    v_cvt_pk_bf16_f32 v127, v127, v127
    v_lshlrev_b32 v127, 16, v127
    v_add_f32 v127, 1.0, v127
    v_cvt_pk_bf16_f32 v127, v127, v127
    v_lshlrev_b32 v127, 16, v127
    v_mul_f32 v192, v192, v112
    v_cvt_pk_bf16_f32 v192, v192, v192
    v_lshlrev_b32 v192, 16, v192
    v_add_f32 v192, v192, v96
    v_mul_f32 v193, v193, v113
    v_cvt_pk_bf16_f32 v193, v193, v193
    v_lshlrev_b32 v193, 16, v193
    v_add_f32 v193, v193, v97
    v_mul_f32 v194, v194, v114
    v_cvt_pk_bf16_f32 v194, v194, v194
    v_lshlrev_b32 v194, 16, v194
    v_add_f32 v194, v194, v98
    v_mul_f32 v195, v195, v115
    v_cvt_pk_bf16_f32 v195, v195, v195
    v_lshlrev_b32 v195, 16, v195
    v_add_f32 v195, v195, v99
    v_mul_f32 v196, v196, v116
    v_cvt_pk_bf16_f32 v196, v196, v196
    v_lshlrev_b32 v196, 16, v196
    v_add_f32 v196, v196, v100
    v_mul_f32 v197, v197, v117
    v_cvt_pk_bf16_f32 v197, v197, v197
    v_lshlrev_b32 v197, 16, v197
    v_add_f32 v197, v197, v101
    v_mul_f32 v198, v198, v118
    v_cvt_pk_bf16_f32 v198, v198, v198
    v_lshlrev_b32 v198, 16, v198
    v_add_f32 v198, v198, v102
    v_mul_f32 v199, v199, v119
    v_cvt_pk_bf16_f32 v199, v199, v199
    v_lshlrev_b32 v199, 16, v199
    v_add_f32 v199, v199, v103
    v_mul_f32 v200, v200, v120
    v_cvt_pk_bf16_f32 v200, v200, v200
    v_lshlrev_b32 v200, 16, v200
    v_add_f32 v200, v200, v104
    v_mul_f32 v201, v201, v121
    v_cvt_pk_bf16_f32 v201, v201, v201
    v_lshlrev_b32 v201, 16, v201
    v_add_f32 v201, v201, v105
    v_mul_f32 v202, v202, v122
    v_cvt_pk_bf16_f32 v202, v202, v202
    v_lshlrev_b32 v202, 16, v202
    v_add_f32 v202, v202, v106
    v_mul_f32 v203, v203, v123
    v_cvt_pk_bf16_f32 v203, v203, v203
    v_lshlrev_b32 v203, 16, v203
    v_add_f32 v203, v203, v107
    v_mul_f32 v204, v204, v124
    v_cvt_pk_bf16_f32 v204, v204, v204
    v_lshlrev_b32 v204, 16, v204
    v_add_f32 v204, v204, v108
    v_mul_f32 v205, v205, v125
    v_cvt_pk_bf16_f32 v205, v205, v205
    v_lshlrev_b32 v205, 16, v205
    v_add_f32 v205, v205, v109
    v_mul_f32 v206, v206, v126
    v_cvt_pk_bf16_f32 v206, v206, v206
    v_lshlrev_b32 v206, 16, v206
    v_add_f32 v206, v206, v110
    v_mul_f32 v207, v207, v127
    v_cvt_pk_bf16_f32 v207, v207, v207
    v_lshlrev_b32 v207, 16, v207
    v_add_f32 v207, v207, v111
    v_cvt_pk_bf16_f32 v80, v192, v193
    v_cvt_pk_bf16_f32 v81, v194, v195
    v_cvt_pk_bf16_f32 v82, v196, v197
    v_cvt_pk_bf16_f32 v83, v198, v199
    v_cvt_pk_bf16_f32 v84, v200, v201
    v_cvt_pk_bf16_f32 v85, v202, v203
    v_cvt_pk_bf16_f32 v86, v204, v205
    v_cvt_pk_bf16_f32 v87, v206, v207
    s_lshr_b32 s45, s63, 5
    s_lshl_b32 s45, s45, 16
    s_and_b32 s46, s63, 31
    s_lshl_b32 s46, s46, 8
    s_add_u32 s45, s45, s46
    s_add_u32 s45, s45, 0x400000
    s_add_u32 s46, s45, 32768
    buffer_store_dwordx4 v[80:83], v2, s[12:15], s45 offen sc1
    buffer_store_dwordx4 v[84:87], v2, s[12:15], s46 offen sc1
    s_add_u32 s63, s63, 384
    v_mul_f32 v208, v208, v112
    v_cvt_pk_bf16_f32 v208, v208, v208
    v_lshlrev_b32 v208, 16, v208
    v_add_f32 v208, v208, v96
    v_mul_f32 v209, v209, v113
    v_cvt_pk_bf16_f32 v209, v209, v209
    v_lshlrev_b32 v209, 16, v209
    v_add_f32 v209, v209, v97
    v_mul_f32 v210, v210, v114
    v_cvt_pk_bf16_f32 v210, v210, v210
    v_lshlrev_b32 v210, 16, v210
    v_add_f32 v210, v210, v98
    v_mul_f32 v211, v211, v115
    v_cvt_pk_bf16_f32 v211, v211, v211
    v_lshlrev_b32 v211, 16, v211
    v_add_f32 v211, v211, v99
    v_mul_f32 v212, v212, v116
    v_cvt_pk_bf16_f32 v212, v212, v212
    v_lshlrev_b32 v212, 16, v212
    v_add_f32 v212, v212, v100
    v_mul_f32 v213, v213, v117
    v_cvt_pk_bf16_f32 v213, v213, v213
    v_lshlrev_b32 v213, 16, v213
    v_add_f32 v213, v213, v101
    v_mul_f32 v214, v214, v118
    v_cvt_pk_bf16_f32 v214, v214, v214
    v_lshlrev_b32 v214, 16, v214
    v_add_f32 v214, v214, v102
    v_mul_f32 v215, v215, v119
    v_cvt_pk_bf16_f32 v215, v215, v215
    v_lshlrev_b32 v215, 16, v215
    v_add_f32 v215, v215, v103
    v_mul_f32 v216, v216, v120
    v_cvt_pk_bf16_f32 v216, v216, v216
    v_lshlrev_b32 v216, 16, v216
    v_add_f32 v216, v216, v104
    v_mul_f32 v217, v217, v121
    v_cvt_pk_bf16_f32 v217, v217, v217
    v_lshlrev_b32 v217, 16, v217
    v_add_f32 v217, v217, v105
    v_mul_f32 v218, v218, v122
    v_cvt_pk_bf16_f32 v218, v218, v218
    v_lshlrev_b32 v218, 16, v218
    v_add_f32 v218, v218, v106
    v_mul_f32 v219, v219, v123
    v_cvt_pk_bf16_f32 v219, v219, v219
    v_lshlrev_b32 v219, 16, v219
    v_add_f32 v219, v219, v107
    v_mul_f32 v220, v220, v124
    v_cvt_pk_bf16_f32 v220, v220, v220
    v_lshlrev_b32 v220, 16, v220
    v_add_f32 v220, v220, v108
    v_mul_f32 v221, v221, v125
    v_cvt_pk_bf16_f32 v221, v221, v221
    v_lshlrev_b32 v221, 16, v221
    v_add_f32 v221, v221, v109
    v_mul_f32 v222, v222, v126
    v_cvt_pk_bf16_f32 v222, v222, v222
    v_lshlrev_b32 v222, 16, v222
    v_add_f32 v222, v222, v110
    v_mul_f32 v223, v223, v127
    v_cvt_pk_bf16_f32 v223, v223, v223
    v_lshlrev_b32 v223, 16, v223
    v_add_f32 v223, v223, v111
    v_cvt_pk_bf16_f32 v88, v208, v209
    v_cvt_pk_bf16_f32 v89, v210, v211
    v_cvt_pk_bf16_f32 v90, v212, v213
    v_cvt_pk_bf16_f32 v91, v214, v215
    v_cvt_pk_bf16_f32 v92, v216, v217
    v_cvt_pk_bf16_f32 v93, v218, v219
    v_cvt_pk_bf16_f32 v94, v220, v221
    v_cvt_pk_bf16_f32 v95, v222, v223
    s_lshr_b32 s45, s63, 5
    s_lshl_b32 s45, s45, 16
    s_and_b32 s46, s63, 31
    s_lshl_b32 s46, s46, 8
    s_add_u32 s45, s45, s46
    s_add_u32 s45, s45, 0x400000
    s_add_u32 s46, s45, 32768
    buffer_store_dwordx4 v[88:91], v2, s[12:15], s45 offen sc1
    buffer_store_dwordx4 v[92:95], v2, s[12:15], s46 offen sc1
    s_waitcnt vmcnt(2)
    s_barrier
    s_cmp_lg_u32 s44, 0
    s_cbranch_scc1 L_cnt_110
    v_mov_b32 v30, 1
    v_mov_b32 v31, 0
    s_mov_b64 exec, 1
    buffer_atomic_add v30, v31, s[16:19], 0 offen offset:64 sc1
    s_mov_b64 exec, -1
L_cnt_110:
    s_add_u32 s63, s63, 384
    v_lshlrev_b32 v64, 16, v144
    v_and_b32 v65, 0xffff0000, v144
    v_lshlrev_b32 v66, 16, v145
    v_and_b32 v67, 0xffff0000, v145
    v_lshlrev_b32 v68, 16, v146
    v_and_b32 v69, 0xffff0000, v146
    v_lshlrev_b32 v70, 16, v147
    v_and_b32 v71, 0xffff0000, v147
    v_lshlrev_b32 v72, 16, v148
    v_and_b32 v73, 0xffff0000, v148
    v_lshlrev_b32 v74, 16, v149
    v_and_b32 v75, 0xffff0000, v149
    v_lshlrev_b32 v76, 16, v150
    v_and_b32 v77, 0xffff0000, v150
    v_lshlrev_b32 v78, 16, v151
    v_and_b32 v79, 0xffff0000, v151
    v_add_f32 v26, v64, v65
    v_add_f32 v26, v26, v66
    v_add_f32 v26, v26, v67
    v_add_f32 v26, v26, v68
    v_add_f32 v26, v26, v69
    v_add_f32 v26, v26, v70
    v_add_f32 v26, v26, v71
    v_add_f32 v26, v26, v72
    v_add_f32 v26, v26, v73
    v_add_f32 v26, v26, v74
    v_add_f32 v26, v26, v75
    v_add_f32 v26, v26, v76
    v_add_f32 v26, v26, v77
    v_add_f32 v26, v26, v78
    v_add_f32 v26, v26, v79
    s_nop 1
    v_add_f32_dpp v26, v26, v26 row_shr:1 row_mask:0xf bank_mask:0xf bound_ctrl:0
    s_nop 1
    v_add_f32_dpp v26, v26, v26 row_shr:2 row_mask:0xf bank_mask:0xf bound_ctrl:0
    s_nop 1
    v_add_f32_dpp v26, v26, v26 row_shr:4 row_mask:0xf bank_mask:0xf bound_ctrl:0
    s_nop 1
    v_add_f32_dpp v26, v26, v26 row_shr:8 row_mask:0xf bank_mask:0xf bound_ctrl:0
    s_nop 1
    v_add_f32_dpp v26, v26, v26 row_bcast:15 row_mask:0xa bank_mask:0xf
    s_nop 1
    v_add_f32_dpp v26, v26, v26 row_bcast:31 row_mask:0xc bank_mask:0xf
    s_nop 1
    v_readlane_b32 s66, v26, 63
    s_nop 1
    v_mov_b32 v27, s66
    v_mul_f32 v27, 0x3a800000, v27
    v_mov_b32 v26, 0
    v_sub_f32 v28, v64, v27
    v_fmac_f32 v26, v28, v28
    v_sub_f32 v28, v65, v27
    v_fmac_f32 v26, v28, v28
    v_sub_f32 v28, v66, v27
    v_fmac_f32 v26, v28, v28
    v_sub_f32 v28, v67, v27
    v_fmac_f32 v26, v28, v28
    v_sub_f32 v28, v68, v27
    v_fmac_f32 v26, v28, v28
    v_sub_f32 v28, v69, v27
    v_fmac_f32 v26, v28, v28
    v_sub_f32 v28, v70, v27
    v_fmac_f32 v26, v28, v28
    v_sub_f32 v28, v71, v27
    v_fmac_f32 v26, v28, v28
    v_sub_f32 v28, v72, v27
    v_fmac_f32 v26, v28, v28
    v_sub_f32 v28, v73, v27
    v_fmac_f32 v26, v28, v28
    v_sub_f32 v28, v74, v27
    v_fmac_f32 v26, v28, v28
    v_sub_f32 v28, v75, v27
    v_fmac_f32 v26, v28, v28
    v_sub_f32 v28, v76, v27
    v_fmac_f32 v26, v28, v28
    v_sub_f32 v28, v77, v27
    v_fmac_f32 v26, v28, v28
    v_sub_f32 v28, v78, v27
    v_fmac_f32 v26, v28, v28
    v_sub_f32 v28, v79, v27
    v_fmac_f32 v26, v28, v28
    s_nop 1
    v_add_f32_dpp v26, v26, v26 row_shr:1 row_mask:0xf bank_mask:0xf bound_ctrl:0
    s_nop 1
    v_add_f32_dpp v26, v26, v26 row_shr:2 row_mask:0xf bank_mask:0xf bound_ctrl:0
    s_nop 1
    v_add_f32_dpp v26, v26, v26 row_shr:4 row_mask:0xf bank_mask:0xf bound_ctrl:0
    s_nop 1
    v_add_f32_dpp v26, v26, v26 row_shr:8 row_mask:0xf bank_mask:0xf bound_ctrl:0
    s_nop 1
    v_add_f32_dpp v26, v26, v26 row_bcast:15 row_mask:0xa bank_mask:0xf
    s_nop 1
    v_add_f32_dpp v26, v26, v26 row_bcast:31 row_mask:0xc bank_mask:0xf
    s_nop 1
    v_readlane_b32 s66, v26, 63
    s_nop 1
    v_mov_b32 v26, s66
    v_mul_f32 v26, 0x3a800000, v26
    v_cvt_pk_bf16_f32 v26, v26, v26
    v_lshlrev_b32 v26, 16, v26
    v_cvt_pk_bf16_f32 v27, v27, v27
    v_lshlrev_b32 v27, 16, v27
    v_add_f32 v26, 0x3727c5ac, v26
    v_cvt_pk_bf16_f32 v26, v26, v26
    v_lshlrev_b32 v26, 16, v26
    v_sqrt_f32 v26, v26
    s_nop 0
    v_cvt_pk_bf16_f32 v26, v26, v26
    v_lshlrev_b32 v26, 16, v26
    v_rcp_f32 v26, v26
    s_nop 0
    v_sub_f32 v64, v64, v27
    v_cvt_pk_bf16_f32 v64, v64, v64
    v_lshlrev_b32 v64, 16, v64
    v_mul_f32 v64, v64, v26
    v_cvt_pk_bf16_f32 v64, v64, v64
    v_lshlrev_b32 v64, 16, v64
    v_sub_f32 v65, v65, v27
    v_cvt_pk_bf16_f32 v65, v65, v65
    v_lshlrev_b32 v65, 16, v65
    v_mul_f32 v65, v65, v26
    v_cvt_pk_bf16_f32 v65, v65, v65
    v_lshlrev_b32 v65, 16, v65
    v_sub_f32 v66, v66, v27
    v_cvt_pk_bf16_f32 v66, v66, v66
    v_lshlrev_b32 v66, 16, v66
    v_mul_f32 v66, v66, v26
    v_cvt_pk_bf16_f32 v66, v66, v66
    v_lshlrev_b32 v66, 16, v66
    v_sub_f32 v67, v67, v27
    v_cvt_pk_bf16_f32 v67, v67, v67
    v_lshlrev_b32 v67, 16, v67
    v_mul_f32 v67, v67, v26
    v_cvt_pk_bf16_f32 v67, v67, v67
    v_lshlrev_b32 v67, 16, v67
    v_sub_f32 v68, v68, v27
    v_cvt_pk_bf16_f32 v68, v68, v68
    v_lshlrev_b32 v68, 16, v68
    v_mul_f32 v68, v68, v26
    v_cvt_pk_bf16_f32 v68, v68, v68
    v_lshlrev_b32 v68, 16, v68
    v_sub_f32 v69, v69, v27
    v_cvt_pk_bf16_f32 v69, v69, v69
    v_lshlrev_b32 v69, 16, v69
    v_mul_f32 v69, v69, v26
    v_cvt_pk_bf16_f32 v69, v69, v69
    v_lshlrev_b32 v69, 16, v69
    v_sub_f32 v70, v70, v27
    v_cvt_pk_bf16_f32 v70, v70, v70
    v_lshlrev_b32 v70, 16, v70
    v_mul_f32 v70, v70, v26
    v_cvt_pk_bf16_f32 v70, v70, v70
    v_lshlrev_b32 v70, 16, v70
    v_sub_f32 v71, v71, v27
    v_cvt_pk_bf16_f32 v71, v71, v71
    v_lshlrev_b32 v71, 16, v71
    v_mul_f32 v71, v71, v26
    v_cvt_pk_bf16_f32 v71, v71, v71
    v_lshlrev_b32 v71, 16, v71
    v_sub_f32 v72, v72, v27
    v_cvt_pk_bf16_f32 v72, v72, v72
    v_lshlrev_b32 v72, 16, v72
    v_mul_f32 v72, v72, v26
    v_cvt_pk_bf16_f32 v72, v72, v72
    v_lshlrev_b32 v72, 16, v72
    v_sub_f32 v73, v73, v27
    v_cvt_pk_bf16_f32 v73, v73, v73
    v_lshlrev_b32 v73, 16, v73
    v_mul_f32 v73, v73, v26
    v_cvt_pk_bf16_f32 v73, v73, v73
    v_lshlrev_b32 v73, 16, v73
    v_sub_f32 v74, v74, v27
    v_cvt_pk_bf16_f32 v74, v74, v74
    v_lshlrev_b32 v74, 16, v74
    v_mul_f32 v74, v74, v26
    v_cvt_pk_bf16_f32 v74, v74, v74
    v_lshlrev_b32 v74, 16, v74
    v_sub_f32 v75, v75, v27
    v_cvt_pk_bf16_f32 v75, v75, v75
    v_lshlrev_b32 v75, 16, v75
    v_mul_f32 v75, v75, v26
    v_cvt_pk_bf16_f32 v75, v75, v75
    v_lshlrev_b32 v75, 16, v75
    v_sub_f32 v76, v76, v27
    v_cvt_pk_bf16_f32 v76, v76, v76
    v_lshlrev_b32 v76, 16, v76
    v_mul_f32 v76, v76, v26
    v_cvt_pk_bf16_f32 v76, v76, v76
    v_lshlrev_b32 v76, 16, v76
    v_sub_f32 v77, v77, v27
    v_cvt_pk_bf16_f32 v77, v77, v77
    v_lshlrev_b32 v77, 16, v77
    v_mul_f32 v77, v77, v26
    v_cvt_pk_bf16_f32 v77, v77, v77
    v_lshlrev_b32 v77, 16, v77
    v_sub_f32 v78, v78, v27
    v_cvt_pk_bf16_f32 v78, v78, v78
    v_lshlrev_b32 v78, 16, v78
    v_mul_f32 v78, v78, v26
    v_cvt_pk_bf16_f32 v78, v78, v78
    v_lshlrev_b32 v78, 16, v78
    v_sub_f32 v79, v79, v27
    v_cvt_pk_bf16_f32 v79, v79, v79
    v_lshlrev_b32 v79, 16, v79
    v_mul_f32 v79, v79, v26
    v_cvt_pk_bf16_f32 v79, v79, v79
    v_lshlrev_b32 v79, 16, v79
    v_mul_f32 v64, v64, v112
    v_cvt_pk_bf16_f32 v64, v64, v64
    v_lshlrev_b32 v64, 16, v64
    v_add_f32 v64, v64, v96
    v_mul_f32 v65, v65, v113
    v_cvt_pk_bf16_f32 v65, v65, v65
    v_lshlrev_b32 v65, 16, v65
    v_add_f32 v65, v65, v97
    v_mul_f32 v66, v66, v114
    v_cvt_pk_bf16_f32 v66, v66, v66
    v_lshlrev_b32 v66, 16, v66
    v_add_f32 v66, v66, v98
    v_mul_f32 v67, v67, v115
    v_cvt_pk_bf16_f32 v67, v67, v67
    v_lshlrev_b32 v67, 16, v67
    v_add_f32 v67, v67, v99
    v_mul_f32 v68, v68, v116
    v_cvt_pk_bf16_f32 v68, v68, v68
    v_lshlrev_b32 v68, 16, v68
    v_add_f32 v68, v68, v100
    v_mul_f32 v69, v69, v117
    v_cvt_pk_bf16_f32 v69, v69, v69
    v_lshlrev_b32 v69, 16, v69
    v_add_f32 v69, v69, v101
    v_mul_f32 v70, v70, v118
    v_cvt_pk_bf16_f32 v70, v70, v70
    v_lshlrev_b32 v70, 16, v70
    v_add_f32 v70, v70, v102
    v_mul_f32 v71, v71, v119
    v_cvt_pk_bf16_f32 v71, v71, v71
    v_lshlrev_b32 v71, 16, v71
    v_add_f32 v71, v71, v103
    v_mul_f32 v72, v72, v120
    v_cvt_pk_bf16_f32 v72, v72, v72
    v_lshlrev_b32 v72, 16, v72
    v_add_f32 v72, v72, v104
    v_mul_f32 v73, v73, v121
    v_cvt_pk_bf16_f32 v73, v73, v73
    v_lshlrev_b32 v73, 16, v73
    v_add_f32 v73, v73, v105
    v_mul_f32 v74, v74, v122
    v_cvt_pk_bf16_f32 v74, v74, v74
    v_lshlrev_b32 v74, 16, v74
    v_add_f32 v74, v74, v106
    v_mul_f32 v75, v75, v123
    v_cvt_pk_bf16_f32 v75, v75, v75
    v_lshlrev_b32 v75, 16, v75
    v_add_f32 v75, v75, v107
    v_mul_f32 v76, v76, v124
    v_cvt_pk_bf16_f32 v76, v76, v76
    v_lshlrev_b32 v76, 16, v76
    v_add_f32 v76, v76, v108
    v_mul_f32 v77, v77, v125
    v_cvt_pk_bf16_f32 v77, v77, v77
    v_lshlrev_b32 v77, 16, v77
    v_add_f32 v77, v77, v109
    v_mul_f32 v78, v78, v126
    v_cvt_pk_bf16_f32 v78, v78, v78
    v_lshlrev_b32 v78, 16, v78
    v_add_f32 v78, v78, v110
    v_mul_f32 v79, v79, v127
    v_cvt_pk_bf16_f32 v79, v79, v79
    v_lshlrev_b32 v79, 16, v79
    v_add_f32 v79, v79, v111
    v_cvt_pk_bf16_f32 v80, v64, v65
    v_cvt_pk_bf16_f32 v81, v66, v67
    v_cvt_pk_bf16_f32 v82, v68, v69
    v_cvt_pk_bf16_f32 v83, v70, v71
    v_cvt_pk_bf16_f32 v84, v72, v73
    v_cvt_pk_bf16_f32 v85, v74, v75
    v_cvt_pk_bf16_f32 v86, v76, v77
    v_cvt_pk_bf16_f32 v87, v78, v79
    s_lshr_b32 s45, s63, 5
    s_lshl_b32 s45, s45, 16
    s_and_b32 s46, s63, 31
    s_lshl_b32 s46, s46, 8
    s_add_u32 s45, s45, s46
    s_add_u32 s45, s45, 0x400000
    s_add_u32 s46, s45, 32768
    buffer_store_dwordx4 v[80:83], v2, s[12:15], s45 offen sc1
    buffer_store_dwordx4 v[84:87], v2, s[12:15], s46 offen sc1
    s_add_u32 s63, s63, 384
    v_lshlrev_b32 v64, 16, v152
    v_and_b32 v65, 0xffff0000, v152
    v_lshlrev_b32 v66, 16, v153
    v_and_b32 v67, 0xffff0000, v153
    v_lshlrev_b32 v68, 16, v154
    v_and_b32 v69, 0xffff0000, v154
    v_lshlrev_b32 v70, 16, v155
    v_and_b32 v71, 0xffff0000, v155
    v_lshlrev_b32 v72, 16, v156
    v_and_b32 v73, 0xffff0000, v156
    v_lshlrev_b32 v74, 16, v157
    v_and_b32 v75, 0xffff0000, v157
    v_lshlrev_b32 v76, 16, v158
    v_and_b32 v77, 0xffff0000, v158
    v_lshlrev_b32 v78, 16, v159
    v_and_b32 v79, 0xffff0000, v159
    v_add_f32 v26, v64, v65
    v_add_f32 v26, v26, v66
    v_add_f32 v26, v26, v67
    v_add_f32 v26, v26, v68
    v_add_f32 v26, v26, v69
    v_add_f32 v26, v26, v70
    v_add_f32 v26, v26, v71
    v_add_f32 v26, v26, v72
    v_add_f32 v26, v26, v73
    v_add_f32 v26, v26, v74
    v_add_f32 v26, v26, v75
    v_add_f32 v26, v26, v76
    v_add_f32 v26, v26, v77
    v_add_f32 v26, v26, v78
    v_add_f32 v26, v26, v79
    s_nop 1
    v_add_f32_dpp v26, v26, v26 row_shr:1 row_mask:0xf bank_mask:0xf bound_ctrl:0
    s_nop 1
    v_add_f32_dpp v26, v26, v26 row_shr:2 row_mask:0xf bank_mask:0xf bound_ctrl:0
    s_nop 1
    v_add_f32_dpp v26, v26, v26 row_shr:4 row_mask:0xf bank_mask:0xf bound_ctrl:0
    s_nop 1
    v_add_f32_dpp v26, v26, v26 row_shr:8 row_mask:0xf bank_mask:0xf bound_ctrl:0
    s_nop 1
    v_add_f32_dpp v26, v26, v26 row_bcast:15 row_mask:0xa bank_mask:0xf
    s_nop 1
    v_add_f32_dpp v26, v26, v26 row_bcast:31 row_mask:0xc bank_mask:0xf
    s_nop 1
    v_readlane_b32 s66, v26, 63
    s_nop 1
    v_mov_b32 v27, s66
    v_mul_f32 v27, 0x3a800000, v27
    v_mov_b32 v26, 0
    v_sub_f32 v28, v64, v27
    v_fmac_f32 v26, v28, v28
    v_sub_f32 v28, v65, v27
    v_fmac_f32 v26, v28, v28
    v_sub_f32 v28, v66, v27
    v_fmac_f32 v26, v28, v28
    v_sub_f32 v28, v67, v27
    v_fmac_f32 v26, v28, v28
    v_sub_f32 v28, v68, v27
    v_fmac_f32 v26, v28, v28
    v_sub_f32 v28, v69, v27
    v_fmac_f32 v26, v28, v28
    v_sub_f32 v28, v70, v27
    v_fmac_f32 v26, v28, v28
    v_sub_f32 v28, v71, v27
    v_fmac_f32 v26, v28, v28
    v_sub_f32 v28, v72, v27
    v_fmac_f32 v26, v28, v28
    v_sub_f32 v28, v73, v27
    v_fmac_f32 v26, v28, v28
    v_sub_f32 v28, v74, v27
    v_fmac_f32 v26, v28, v28
    v_sub_f32 v28, v75, v27
    v_fmac_f32 v26, v28, v28
    v_sub_f32 v28, v76, v27
    v_fmac_f32 v26, v28, v28
    v_sub_f32 v28, v77, v27
    v_fmac_f32 v26, v28, v28
    v_sub_f32 v28, v78, v27
    v_fmac_f32 v26, v28, v28
    v_sub_f32 v28, v79, v27
    v_fmac_f32 v26, v28, v28
    s_nop 1
    v_add_f32_dpp v26, v26, v26 row_shr:1 row_mask:0xf bank_mask:0xf bound_ctrl:0
    s_nop 1
    v_add_f32_dpp v26, v26, v26 row_shr:2 row_mask:0xf bank_mask:0xf bound_ctrl:0
    s_nop 1
    v_add_f32_dpp v26, v26, v26 row_shr:4 row_mask:0xf bank_mask:0xf bound_ctrl:0
    s_nop 1
    v_add_f32_dpp v26, v26, v26 row_shr:8 row_mask:0xf bank_mask:0xf bound_ctrl:0
    s_nop 1
    v_add_f32_dpp v26, v26, v26 row_bcast:15 row_mask:0xa bank_mask:0xf
    s_nop 1
    v_add_f32_dpp v26, v26, v26 row_bcast:31 row_mask:0xc bank_mask:0xf
    s_nop 1
    v_readlane_b32 s66, v26, 63
    s_nop 1
    v_mov_b32 v26, s66
    v_mul_f32 v26, 0x3a800000, v26
    v_cvt_pk_bf16_f32 v26, v26, v26
    v_lshlrev_b32 v26, 16, v26
    v_cvt_pk_bf16_f32 v27, v27, v27
    v_lshlrev_b32 v27, 16, v27
    v_add_f32 v26, 0x3727c5ac, v26
    v_cvt_pk_bf16_f32 v26, v26, v26
    v_lshlrev_b32 v26, 16, v26
    v_sqrt_f32 v26, v26
    s_nop 0
    v_cvt_pk_bf16_f32 v26, v26, v26
    v_lshlrev_b32 v26, 16, v26
    v_rcp_f32 v26, v26
    s_nop 0
    v_sub_f32 v64, v64, v27
    v_cvt_pk_bf16_f32 v64, v64, v64
    v_lshlrev_b32 v64, 16, v64
    v_mul_f32 v64, v64, v26
    v_cvt_pk_bf16_f32 v64, v64, v64
    v_lshlrev_b32 v64, 16, v64
    v_sub_f32 v65, v65, v27
    v_cvt_pk_bf16_f32 v65, v65, v65
    v_lshlrev_b32 v65, 16, v65
    v_mul_f32 v65, v65, v26
    v_cvt_pk_bf16_f32 v65, v65, v65
    v_lshlrev_b32 v65, 16, v65
    v_sub_f32 v66, v66, v27
    v_cvt_pk_bf16_f32 v66, v66, v66
    v_lshlrev_b32 v66, 16, v66
    v_mul_f32 v66, v66, v26
    v_cvt_pk_bf16_f32 v66, v66, v66
    v_lshlrev_b32 v66, 16, v66
    v_sub_f32 v67, v67, v27
    v_cvt_pk_bf16_f32 v67, v67, v67
    v_lshlrev_b32 v67, 16, v67
    v_mul_f32 v67, v67, v26
    v_cvt_pk_bf16_f32 v67, v67, v67
    v_lshlrev_b32 v67, 16, v67
    v_sub_f32 v68, v68, v27
    v_cvt_pk_bf16_f32 v68, v68, v68
    v_lshlrev_b32 v68, 16, v68
    v_mul_f32 v68, v68, v26
    v_cvt_pk_bf16_f32 v68, v68, v68
    v_lshlrev_b32 v68, 16, v68
    v_sub_f32 v69, v69, v27
    v_cvt_pk_bf16_f32 v69, v69, v69
    v_lshlrev_b32 v69, 16, v69
    v_mul_f32 v69, v69, v26
    v_cvt_pk_bf16_f32 v69, v69, v69
    v_lshlrev_b32 v69, 16, v69
    v_sub_f32 v70, v70, v27
    v_cvt_pk_bf16_f32 v70, v70, v70
    v_lshlrev_b32 v70, 16, v70
    v_mul_f32 v70, v70, v26
    v_cvt_pk_bf16_f32 v70, v70, v70
    v_lshlrev_b32 v70, 16, v70
    v_sub_f32 v71, v71, v27
    v_cvt_pk_bf16_f32 v71, v71, v71
    v_lshlrev_b32 v71, 16, v71
    v_mul_f32 v71, v71, v26
    v_cvt_pk_bf16_f32 v71, v71, v71
    v_lshlrev_b32 v71, 16, v71
    v_sub_f32 v72, v72, v27
    v_cvt_pk_bf16_f32 v72, v72, v72
    v_lshlrev_b32 v72, 16, v72
    v_mul_f32 v72, v72, v26
    v_cvt_pk_bf16_f32 v72, v72, v72
    v_lshlrev_b32 v72, 16, v72
    v_sub_f32 v73, v73, v27
    v_cvt_pk_bf16_f32 v73, v73, v73
    v_lshlrev_b32 v73, 16, v73
    v_mul_f32 v73, v73, v26
    v_cvt_pk_bf16_f32 v73, v73, v73
    v_lshlrev_b32 v73, 16, v73
    v_sub_f32 v74, v74, v27
    v_cvt_pk_bf16_f32 v74, v74, v74
    v_lshlrev_b32 v74, 16, v74
    v_mul_f32 v74, v74, v26
    v_cvt_pk_bf16_f32 v74, v74, v74
    v_lshlrev_b32 v74, 16, v74
    v_sub_f32 v75, v75, v27
    v_cvt_pk_bf16_f32 v75, v75, v75
    v_lshlrev_b32 v75, 16, v75
    v_mul_f32 v75, v75, v26
    v_cvt_pk_bf16_f32 v75, v75, v75
    v_lshlrev_b32 v75, 16, v75
    v_sub_f32 v76, v76, v27
    v_cvt_pk_bf16_f32 v76, v76, v76
    v_lshlrev_b32 v76, 16, v76
    v_mul_f32 v76, v76, v26
    v_cvt_pk_bf16_f32 v76, v76, v76
    v_lshlrev_b32 v76, 16, v76
    v_sub_f32 v77, v77, v27
    v_cvt_pk_bf16_f32 v77, v77, v77
    v_lshlrev_b32 v77, 16, v77
    v_mul_f32 v77, v77, v26
    v_cvt_pk_bf16_f32 v77, v77, v77
    v_lshlrev_b32 v77, 16, v77
    v_sub_f32 v78, v78, v27
    v_cvt_pk_bf16_f32 v78, v78, v78
    v_lshlrev_b32 v78, 16, v78
    v_mul_f32 v78, v78, v26
    v_cvt_pk_bf16_f32 v78, v78, v78
    v_lshlrev_b32 v78, 16, v78
    v_sub_f32 v79, v79, v27
    v_cvt_pk_bf16_f32 v79, v79, v79
    v_lshlrev_b32 v79, 16, v79
    v_mul_f32 v79, v79, v26
    v_cvt_pk_bf16_f32 v79, v79, v79
    v_lshlrev_b32 v79, 16, v79
    v_mul_f32 v64, v64, v112
    v_cvt_pk_bf16_f32 v64, v64, v64
    v_lshlrev_b32 v64, 16, v64
    v_add_f32 v64, v64, v96
    v_mul_f32 v65, v65, v113
    v_cvt_pk_bf16_f32 v65, v65, v65
    v_lshlrev_b32 v65, 16, v65
    v_add_f32 v65, v65, v97
    v_mul_f32 v66, v66, v114
    v_cvt_pk_bf16_f32 v66, v66, v66
    v_lshlrev_b32 v66, 16, v66
    v_add_f32 v66, v66, v98
    v_mul_f32 v67, v67, v115
    v_cvt_pk_bf16_f32 v67, v67, v67
    v_lshlrev_b32 v67, 16, v67
    v_add_f32 v67, v67, v99
    v_mul_f32 v68, v68, v116
    v_cvt_pk_bf16_f32 v68, v68, v68
    v_lshlrev_b32 v68, 16, v68
    v_add_f32 v68, v68, v100
    v_mul_f32 v69, v69, v117
    v_cvt_pk_bf16_f32 v69, v69, v69
    v_lshlrev_b32 v69, 16, v69
    v_add_f32 v69, v69, v101
    v_mul_f32 v70, v70, v118
    v_cvt_pk_bf16_f32 v70, v70, v70
    v_lshlrev_b32 v70, 16, v70
    v_add_f32 v70, v70, v102
    v_mul_f32 v71, v71, v119
    v_cvt_pk_bf16_f32 v71, v71, v71
    v_lshlrev_b32 v71, 16, v71
    v_add_f32 v71, v71, v103
    v_mul_f32 v72, v72, v120
    v_cvt_pk_bf16_f32 v72, v72, v72
    v_lshlrev_b32 v72, 16, v72
    v_add_f32 v72, v72, v104
    v_mul_f32 v73, v73, v121
    v_cvt_pk_bf16_f32 v73, v73, v73
    v_lshlrev_b32 v73, 16, v73
    v_add_f32 v73, v73, v105
    v_mul_f32 v74, v74, v122
    v_cvt_pk_bf16_f32 v74, v74, v74
    v_lshlrev_b32 v74, 16, v74
    v_add_f32 v74, v74, v106
    v_mul_f32 v75, v75, v123
    v_cvt_pk_bf16_f32 v75, v75, v75
    v_lshlrev_b32 v75, 16, v75
    v_add_f32 v75, v75, v107
    v_mul_f32 v76, v76, v124
    v_cvt_pk_bf16_f32 v76, v76, v76
    v_lshlrev_b32 v76, 16, v76
    v_add_f32 v76, v76, v108
    v_mul_f32 v77, v77, v125
    v_cvt_pk_bf16_f32 v77, v77, v77
    v_lshlrev_b32 v77, 16, v77
    v_add_f32 v77, v77, v109
    v_mul_f32 v78, v78, v126
    v_cvt_pk_bf16_f32 v78, v78, v78
    v_lshlrev_b32 v78, 16, v78
    v_add_f32 v78, v78, v110
    v_mul_f32 v79, v79, v127
    v_cvt_pk_bf16_f32 v79, v79, v79
    v_lshlrev_b32 v79, 16, v79
    v_add_f32 v79, v79, v111
    v_cvt_pk_bf16_f32 v80, v64, v65
    v_cvt_pk_bf16_f32 v81, v66, v67
    v_cvt_pk_bf16_f32 v82, v68, v69
    v_cvt_pk_bf16_f32 v83, v70, v71
    v_cvt_pk_bf16_f32 v84, v72, v73
    v_cvt_pk_bf16_f32 v85, v74, v75
    v_cvt_pk_bf16_f32 v86, v76, v77
    v_cvt_pk_bf16_f32 v87, v78, v79
    s_lshr_b32 s45, s63, 5
    s_lshl_b32 s45, s45, 16
    s_and_b32 s46, s63, 31
    s_lshl_b32 s46, s46, 8
    s_add_u32 s45, s45, s46
    s_add_u32 s45, s45, 0x400000
    s_add_u32 s46, s45, 32768
    buffer_store_dwordx4 v[80:83], v2, s[12:15], s45 offen sc1
    buffer_store_dwordx4 v[84:87], v2, s[12:15], s46 offen sc1
    s_add_u32 s63, s63, 384
    v_lshlrev_b32 v64, 16, v160
    v_and_b32 v65, 0xffff0000, v160
    v_lshlrev_b32 v66, 16, v161
    v_and_b32 v67, 0xffff0000, v161
    v_lshlrev_b32 v68, 16, v162
    v_and_b32 v69, 0xffff0000, v162
    v_lshlrev_b32 v70, 16, v163
    v_and_b32 v71, 0xffff0000, v163
    v_lshlrev_b32 v72, 16, v164
    v_and_b32 v73, 0xffff0000, v164
    v_lshlrev_b32 v74, 16, v165
    v_and_b32 v75, 0xffff0000, v165
    v_lshlrev_b32 v76, 16, v166
    v_and_b32 v77, 0xffff0000, v166
    v_lshlrev_b32 v78, 16, v167
    v_and_b32 v79, 0xffff0000, v167
    v_add_f32 v26, v64, v65
    v_add_f32 v26, v26, v66
    v_add_f32 v26, v26, v67
    v_add_f32 v26, v26, v68
    v_add_f32 v26, v26, v69
    v_add_f32 v26, v26, v70
    v_add_f32 v26, v26, v71
    v_add_f32 v26, v26, v72
    v_add_f32 v26, v26, v73
    v_add_f32 v26, v26, v74
    v_add_f32 v26, v26, v75
    v_add_f32 v26, v26, v76
    v_add_f32 v26, v26, v77
    v_add_f32 v26, v26, v78
    v_add_f32 v26, v26, v79
    s_nop 1
    v_add_f32_dpp v26, v26, v26 row_shr:1 row_mask:0xf bank_mask:0xf bound_ctrl:0
    s_nop 1
    v_add_f32_dpp v26, v26, v26 row_shr:2 row_mask:0xf bank_mask:0xf bound_ctrl:0
    s_nop 1
    v_add_f32_dpp v26, v26, v26 row_shr:4 row_mask:0xf bank_mask:0xf bound_ctrl:0
    s_nop 1
    v_add_f32_dpp v26, v26, v26 row_shr:8 row_mask:0xf bank_mask:0xf bound_ctrl:0
    s_nop 1
    v_add_f32_dpp v26, v26, v26 row_bcast:15 row_mask:0xa bank_mask:0xf
    s_nop 1
    v_add_f32_dpp v26, v26, v26 row_bcast:31 row_mask:0xc bank_mask:0xf
    s_nop 1
    v_readlane_b32 s66, v26, 63
    s_nop 1
    v_mov_b32 v27, s66
    v_mul_f32 v27, 0x3a800000, v27
    v_mov_b32 v26, 0
    v_sub_f32 v28, v64, v27
    v_fmac_f32 v26, v28, v28
    v_sub_f32 v28, v65, v27
    v_fmac_f32 v26, v28, v28
    v_sub_f32 v28, v66, v27
    v_fmac_f32 v26, v28, v28
    v_sub_f32 v28, v67, v27
    v_fmac_f32 v26, v28, v28
    v_sub_f32 v28, v68, v27
    v_fmac_f32 v26, v28, v28
    v_sub_f32 v28, v69, v27
    v_fmac_f32 v26, v28, v28
    v_sub_f32 v28, v70, v27
    v_fmac_f32 v26, v28, v28
    v_sub_f32 v28, v71, v27
    v_fmac_f32 v26, v28, v28
    v_sub_f32 v28, v72, v27
    v_fmac_f32 v26, v28, v28
    v_sub_f32 v28, v73, v27
    v_fmac_f32 v26, v28, v28
    v_sub_f32 v28, v74, v27
    v_fmac_f32 v26, v28, v28
    v_sub_f32 v28, v75, v27
    v_fmac_f32 v26, v28, v28
    v_sub_f32 v28, v76, v27
    v_fmac_f32 v26, v28, v28
    v_sub_f32 v28, v77, v27
    v_fmac_f32 v26, v28, v28
    v_sub_f32 v28, v78, v27
    v_fmac_f32 v26, v28, v28
    v_sub_f32 v28, v79, v27
    v_fmac_f32 v26, v28, v28
    s_nop 1
    v_add_f32_dpp v26, v26, v26 row_shr:1 row_mask:0xf bank_mask:0xf bound_ctrl:0
    s_nop 1
    v_add_f32_dpp v26, v26, v26 row_shr:2 row_mask:0xf bank_mask:0xf bound_ctrl:0
    s_nop 1
    v_add_f32_dpp v26, v26, v26 row_shr:4 row_mask:0xf bank_mask:0xf bound_ctrl:0
    s_nop 1
    v_add_f32_dpp v26, v26, v26 row_shr:8 row_mask:0xf bank_mask:0xf bound_ctrl:0
    s_nop 1
    v_add_f32_dpp v26, v26, v26 row_bcast:15 row_mask:0xa bank_mask:0xf
    s_nop 1
    v_add_f32_dpp v26, v26, v26 row_bcast:31 row_mask:0xc bank_mask:0xf
    s_nop 1
    v_readlane_b32 s66, v26, 63
    s_nop 1
    v_mov_b32 v26, s66
    v_mul_f32 v26, 0x3a800000, v26
    v_cvt_pk_bf16_f32 v26, v26, v26
    v_lshlrev_b32 v26, 16, v26
    v_cvt_pk_bf16_f32 v27, v27, v27
    v_lshlrev_b32 v27, 16, v27
    v_add_f32 v26, 0x3727c5ac, v26
    v_cvt_pk_bf16_f32 v26, v26, v26
    v_lshlrev_b32 v26, 16, v26
    v_sqrt_f32 v26, v26
    s_nop 0
    v_cvt_pk_bf16_f32 v26, v26, v26
    v_lshlrev_b32 v26, 16, v26
    v_rcp_f32 v26, v26
    s_nop 0
    v_sub_f32 v64, v64, v27
    v_cvt_pk_bf16_f32 v64, v64, v64
    v_lshlrev_b32 v64, 16, v64
    v_mul_f32 v64, v64, v26
    v_cvt_pk_bf16_f32 v64, v64, v64
    v_lshlrev_b32 v64, 16, v64
    v_sub_f32 v65, v65, v27
    v_cvt_pk_bf16_f32 v65, v65, v65
    v_lshlrev_b32 v65, 16, v65
    v_mul_f32 v65, v65, v26
    v_cvt_pk_bf16_f32 v65, v65, v65
    v_lshlrev_b32 v65, 16, v65
    v_sub_f32 v66, v66, v27
    v_cvt_pk_bf16_f32 v66, v66, v66
    v_lshlrev_b32 v66, 16, v66
    v_mul_f32 v66, v66, v26
    v_cvt_pk_bf16_f32 v66, v66, v66
    v_lshlrev_b32 v66, 16, v66
    v_sub_f32 v67, v67, v27
    v_cvt_pk_bf16_f32 v67, v67, v67
    v_lshlrev_b32 v67, 16, v67
    v_mul_f32 v67, v67, v26
    v_cvt_pk_bf16_f32 v67, v67, v67
    v_lshlrev_b32 v67, 16, v67
    v_sub_f32 v68, v68, v27
    v_cvt_pk_bf16_f32 v68, v68, v68
    v_lshlrev_b32 v68, 16, v68
    v_mul_f32 v68, v68, v26
    v_cvt_pk_bf16_f32 v68, v68, v68
    v_lshlrev_b32 v68, 16, v68
    v_sub_f32 v69, v69, v27
    v_cvt_pk_bf16_f32 v69, v69, v69
    v_lshlrev_b32 v69, 16, v69
    v_mul_f32 v69, v69, v26
    v_cvt_pk_bf16_f32 v69, v69, v69
    v_lshlrev_b32 v69, 16, v69
    v_sub_f32 v70, v70, v27
    v_cvt_pk_bf16_f32 v70, v70, v70
    v_lshlrev_b32 v70, 16, v70
    v_mul_f32 v70, v70, v26
    v_cvt_pk_bf16_f32 v70, v70, v70
    v_lshlrev_b32 v70, 16, v70
    v_sub_f32 v71, v71, v27
    v_cvt_pk_bf16_f32 v71, v71, v71
    v_lshlrev_b32 v71, 16, v71
    v_mul_f32 v71, v71, v26
    v_cvt_pk_bf16_f32 v71, v71, v71
    v_lshlrev_b32 v71, 16, v71
    v_sub_f32 v72, v72, v27
    v_cvt_pk_bf16_f32 v72, v72, v72
    v_lshlrev_b32 v72, 16, v72
    v_mul_f32 v72, v72, v26
    v_cvt_pk_bf16_f32 v72, v72, v72
    v_lshlrev_b32 v72, 16, v72
    v_sub_f32 v73, v73, v27
    v_cvt_pk_bf16_f32 v73, v73, v73
    v_lshlrev_b32 v73, 16, v73
    v_mul_f32 v73, v73, v26
    v_cvt_pk_bf16_f32 v73, v73, v73
    v_lshlrev_b32 v73, 16, v73
    v_sub_f32 v74, v74, v27
    v_cvt_pk_bf16_f32 v74, v74, v74
    v_lshlrev_b32 v74, 16, v74
    v_mul_f32 v74, v74, v26
    v_cvt_pk_bf16_f32 v74, v74, v74
    v_lshlrev_b32 v74, 16, v74
    v_sub_f32 v75, v75, v27
    v_cvt_pk_bf16_f32 v75, v75, v75
    v_lshlrev_b32 v75, 16, v75
    v_mul_f32 v75, v75, v26
    v_cvt_pk_bf16_f32 v75, v75, v75
    v_lshlrev_b32 v75, 16, v75
    v_sub_f32 v76, v76, v27
    v_cvt_pk_bf16_f32 v76, v76, v76
    v_lshlrev_b32 v76, 16, v76
    v_mul_f32 v76, v76, v26
    v_cvt_pk_bf16_f32 v76, v76, v76
    v_lshlrev_b32 v76, 16, v76
    v_sub_f32 v77, v77, v27
    v_cvt_pk_bf16_f32 v77, v77, v77
    v_lshlrev_b32 v77, 16, v77
    v_mul_f32 v77, v77, v26
    v_cvt_pk_bf16_f32 v77, v77, v77
    v_lshlrev_b32 v77, 16, v77
    v_sub_f32 v78, v78, v27
    v_cvt_pk_bf16_f32 v78, v78, v78
    v_lshlrev_b32 v78, 16, v78
    v_mul_f32 v78, v78, v26
    v_cvt_pk_bf16_f32 v78, v78, v78
    v_lshlrev_b32 v78, 16, v78
    v_sub_f32 v79, v79, v27
    v_cvt_pk_bf16_f32 v79, v79, v79
    v_lshlrev_b32 v79, 16, v79
    v_mul_f32 v79, v79, v26
    v_cvt_pk_bf16_f32 v79, v79, v79
    v_lshlrev_b32 v79, 16, v79
    v_mul_f32 v64, v64, v112
    v_cvt_pk_bf16_f32 v64, v64, v64
    v_lshlrev_b32 v64, 16, v64
    v_add_f32 v64, v64, v96
    v_mul_f32 v65, v65, v113
    v_cvt_pk_bf16_f32 v65, v65, v65
    v_lshlrev_b32 v65, 16, v65
    v_add_f32 v65, v65, v97
    v_mul_f32 v66, v66, v114
    v_cvt_pk_bf16_f32 v66, v66, v66
    v_lshlrev_b32 v66, 16, v66
    v_add_f32 v66, v66, v98
    v_mul_f32 v67, v67, v115
    v_cvt_pk_bf16_f32 v67, v67, v67
    v_lshlrev_b32 v67, 16, v67
    v_add_f32 v67, v67, v99
    v_mul_f32 v68, v68, v116
    v_cvt_pk_bf16_f32 v68, v68, v68
    v_lshlrev_b32 v68, 16, v68
    v_add_f32 v68, v68, v100
    v_mul_f32 v69, v69, v117
    v_cvt_pk_bf16_f32 v69, v69, v69
    v_lshlrev_b32 v69, 16, v69
    v_add_f32 v69, v69, v101
    v_mul_f32 v70, v70, v118
    v_cvt_pk_bf16_f32 v70, v70, v70
    v_lshlrev_b32 v70, 16, v70
    v_add_f32 v70, v70, v102
    v_mul_f32 v71, v71, v119
    v_cvt_pk_bf16_f32 v71, v71, v71
    v_lshlrev_b32 v71, 16, v71
    v_add_f32 v71, v71, v103
    v_mul_f32 v72, v72, v120
    v_cvt_pk_bf16_f32 v72, v72, v72
    v_lshlrev_b32 v72, 16, v72
    v_add_f32 v72, v72, v104
    v_mul_f32 v73, v73, v121
    v_cvt_pk_bf16_f32 v73, v73, v73
    v_lshlrev_b32 v73, 16, v73
    v_add_f32 v73, v73, v105
    v_mul_f32 v74, v74, v122
    v_cvt_pk_bf16_f32 v74, v74, v74
    v_lshlrev_b32 v74, 16, v74
    v_add_f32 v74, v74, v106
    v_mul_f32 v75, v75, v123
    v_cvt_pk_bf16_f32 v75, v75, v75
    v_lshlrev_b32 v75, 16, v75
    v_add_f32 v75, v75, v107
    v_mul_f32 v76, v76, v124
    v_cvt_pk_bf16_f32 v76, v76, v76
    v_lshlrev_b32 v76, 16, v76
    v_add_f32 v76, v76, v108
    v_mul_f32 v77, v77, v125
    v_cvt_pk_bf16_f32 v77, v77, v77
    v_lshlrev_b32 v77, 16, v77
    v_add_f32 v77, v77, v109
    v_mul_f32 v78, v78, v126
    v_cvt_pk_bf16_f32 v78, v78, v78
    v_lshlrev_b32 v78, 16, v78
    v_add_f32 v78, v78, v110
    v_mul_f32 v79, v79, v127
    v_cvt_pk_bf16_f32 v79, v79, v79
    v_lshlrev_b32 v79, 16, v79
    v_add_f32 v79, v79, v111
    v_cvt_pk_bf16_f32 v80, v64, v65
    v_cvt_pk_bf16_f32 v81, v66, v67
    v_cvt_pk_bf16_f32 v82, v68, v69
    v_cvt_pk_bf16_f32 v83, v70, v71
    v_cvt_pk_bf16_f32 v84, v72, v73
    v_cvt_pk_bf16_f32 v85, v74, v75
    v_cvt_pk_bf16_f32 v86, v76, v77
    v_cvt_pk_bf16_f32 v87, v78, v79
    s_lshr_b32 s45, s63, 5
    s_lshl_b32 s45, s45, 16
    s_and_b32 s46, s63, 31
    s_lshl_b32 s46, s46, 8
    s_add_u32 s45, s45, s46
    s_add_u32 s45, s45, 0x400000
    s_add_u32 s46, s45, 32768
    buffer_store_dwordx4 v[80:83], v2, s[12:15], s45 offen sc1
    buffer_store_dwordx4 v[84:87], v2, s[12:15], s46 offen sc1
    s_add_u32 s63, s63, 384
    s_cmp_ge_u32 s63, 2048
    s_cbranch_scc1 L_ln_done_109
    v_lshlrev_b32 v64, 16, v168
    v_and_b32 v65, 0xffff0000, v168
    v_lshlrev_b32 v66, 16, v169
    v_and_b32 v67, 0xffff0000, v169
    v_lshlrev_b32 v68, 16, v170
    v_and_b32 v69, 0xffff0000, v170
    v_lshlrev_b32 v70, 16, v171
    v_and_b32 v71, 0xffff0000, v171
    v_lshlrev_b32 v72, 16, v172
    v_and_b32 v73, 0xffff0000, v172
    v_lshlrev_b32 v74, 16, v173
    v_and_b32 v75, 0xffff0000, v173
    v_lshlrev_b32 v76, 16, v174
    v_and_b32 v77, 0xffff0000, v174
    v_lshlrev_b32 v78, 16, v175
    v_and_b32 v79, 0xffff0000, v175
    v_add_f32 v26, v64, v65
    v_add_f32 v26, v26, v66
    v_add_f32 v26, v26, v67
    v_add_f32 v26, v26, v68
    v_add_f32 v26, v26, v69
    v_add_f32 v26, v26, v70
    v_add_f32 v26, v26, v71
    v_add_f32 v26, v26, v72
    v_add_f32 v26, v26, v73
    v_add_f32 v26, v26, v74
    v_add_f32 v26, v26, v75
    v_add_f32 v26, v26, v76
    v_add_f32 v26, v26, v77
    v_add_f32 v26, v26, v78
    v_add_f32 v26, v26, v79
    s_nop 1
    v_add_f32_dpp v26, v26, v26 row_shr:1 row_mask:0xf bank_mask:0xf bound_ctrl:0
    s_nop 1
    v_add_f32_dpp v26, v26, v26 row_shr:2 row_mask:0xf bank_mask:0xf bound_ctrl:0
    s_nop 1
    v_add_f32_dpp v26, v26, v26 row_shr:4 row_mask:0xf bank_mask:0xf bound_ctrl:0
    s_nop 1
    v_add_f32_dpp v26, v26, v26 row_shr:8 row_mask:0xf bank_mask:0xf bound_ctrl:0
    s_nop 1
    v_add_f32_dpp v26, v26, v26 row_bcast:15 row_mask:0xa bank_mask:0xf
    s_nop 1
    v_add_f32_dpp v26, v26, v26 row_bcast:31 row_mask:0xc bank_mask:0xf
    s_nop 1
    v_readlane_b32 s66, v26, 63
    s_nop 1
    v_mov_b32 v27, s66
    v_mul_f32 v27, 0x3a800000, v27
    v_mov_b32 v26, 0
    v_sub_f32 v28, v64, v27
    v_fmac_f32 v26, v28, v28
    v_sub_f32 v28, v65, v27
    v_fmac_f32 v26, v28, v28
    v_sub_f32 v28, v66, v27
    v_fmac_f32 v26, v28, v28
    v_sub_f32 v28, v67, v27
    v_fmac_f32 v26, v28, v28
    v_sub_f32 v28, v68, v27
    v_fmac_f32 v26, v28, v28
    v_sub_f32 v28, v69, v27
    v_fmac_f32 v26, v28, v28
    v_sub_f32 v28, v70, v27
    v_fmac_f32 v26, v28, v28
    v_sub_f32 v28, v71, v27
    v_fmac_f32 v26, v28, v28
    v_sub_f32 v28, v72, v27
    v_fmac_f32 v26, v28, v28
    v_sub_f32 v28, v73, v27
    v_fmac_f32 v26, v28, v28
    v_sub_f32 v28, v74, v27
    v_fmac_f32 v26, v28, v28
    v_sub_f32 v28, v75, v27
    v_fmac_f32 v26, v28, v28
    v_sub_f32 v28, v76, v27
    v_fmac_f32 v26, v28, v28
    v_sub_f32 v28, v77, v27
    v_fmac_f32 v26, v28, v28
    v_sub_f32 v28, v78, v27
    v_fmac_f32 v26, v28, v28
    v_sub_f32 v28, v79, v27
    v_fmac_f32 v26, v28, v28
    s_nop 1
    v_add_f32_dpp v26, v26, v26 row_shr:1 row_mask:0xf bank_mask:0xf bound_ctrl:0
    s_nop 1
    v_add_f32_dpp v26, v26, v26 row_shr:2 row_mask:0xf bank_mask:0xf bound_ctrl:0
    s_nop 1
    v_add_f32_dpp v26, v26, v26 row_shr:4 row_mask:0xf bank_mask:0xf bound_ctrl:0
    s_nop 1
    v_add_f32_dpp v26, v26, v26 row_shr:8 row_mask:0xf bank_mask:0xf bound_ctrl:0
    s_nop 1
    v_add_f32_dpp v26, v26, v26 row_bcast:15 row_mask:0xa bank_mask:0xf
    s_nop 1
    v_add_f32_dpp v26, v26, v26 row_bcast:31 row_mask:0xc bank_mask:0xf
    s_nop 1
    v_readlane_b32 s66, v26, 63
    s_nop 1
    v_mov_b32 v26, s66
    v_mul_f32 v26, 0x3a800000, v26
    v_cvt_pk_bf16_f32 v26, v26, v26
    v_lshlrev_b32 v26, 16, v26
    v_cvt_pk_bf16_f32 v27, v27, v27
    v_lshlrev_b32 v27, 16, v27
    v_add_f32 v26, 0x3727c5ac, v26
    v_cvt_pk_bf16_f32 v26, v26, v26
    v_lshlrev_b32 v26, 16, v26
    v_sqrt_f32 v26, v26
    s_nop 0
    v_cvt_pk_bf16_f32 v26, v26, v26
    v_lshlrev_b32 v26, 16, v26
    v_rcp_f32 v26, v26
    s_nop 0
    v_sub_f32 v64, v64, v27
    v_cvt_pk_bf16_f32 v64, v64, v64
    v_lshlrev_b32 v64, 16, v64
    v_mul_f32 v64, v64, v26
    v_cvt_pk_bf16_f32 v64, v64, v64
    v_lshlrev_b32 v64, 16, v64
    v_sub_f32 v65, v65, v27
    v_cvt_pk_bf16_f32 v65, v65, v65
    v_lshlrev_b32 v65, 16, v65
    v_mul_f32 v65, v65, v26
    v_cvt_pk_bf16_f32 v65, v65, v65
    v_lshlrev_b32 v65, 16, v65
    v_sub_f32 v66, v66, v27
    v_cvt_pk_bf16_f32 v66, v66, v66
    v_lshlrev_b32 v66, 16, v66
    v_mul_f32 v66, v66, v26
    v_cvt_pk_bf16_f32 v66, v66, v66
    v_lshlrev_b32 v66, 16, v66
    v_sub_f32 v67, v67, v27
    v_cvt_pk_bf16_f32 v67, v67, v67
    v_lshlrev_b32 v67, 16, v67
    v_mul_f32 v67, v67, v26
    v_cvt_pk_bf16_f32 v67, v67, v67
    v_lshlrev_b32 v67, 16, v67
    v_sub_f32 v68, v68, v27
    v_cvt_pk_bf16_f32 v68, v68, v68
    v_lshlrev_b32 v68, 16, v68
    v_mul_f32 v68, v68, v26
    v_cvt_pk_bf16_f32 v68, v68, v68
    v_lshlrev_b32 v68, 16, v68
    v_sub_f32 v69, v69, v27
    v_cvt_pk_bf16_f32 v69, v69, v69
    v_lshlrev_b32 v69, 16, v69
    v_mul_f32 v69, v69, v26
    v_cvt_pk_bf16_f32 v69, v69, v69
    v_lshlrev_b32 v69, 16, v69
    v_sub_f32 v70, v70, v27
    v_cvt_pk_bf16_f32 v70, v70, v70
    v_lshlrev_b32 v70, 16, v70
    v_mul_f32 v70, v70, v26
    v_cvt_pk_bf16_f32 v70, v70, v70
    v_lshlrev_b32 v70, 16, v70
    v_sub_f32 v71, v71, v27
    v_cvt_pk_bf16_f32 v71, v71, v71
    v_lshlrev_b32 v71, 16, v71
    v_mul_f32 v71, v71, v26
    v_cvt_pk_bf16_f32 v71, v71, v71
    v_lshlrev_b32 v71, 16, v71
    v_sub_f32 v72, v72, v27
    v_cvt_pk_bf16_f32 v72, v72, v72
    v_lshlrev_b32 v72, 16, v72
    v_mul_f32 v72, v72, v26
    v_cvt_pk_bf16_f32 v72, v72, v72
    v_lshlrev_b32 v72, 16, v72
    v_sub_f32 v73, v73, v27
    v_cvt_pk_bf16_f32 v73, v73, v73
    v_lshlrev_b32 v73, 16, v73
    v_mul_f32 v73, v73, v26
    v_cvt_pk_bf16_f32 v73, v73, v73
    v_lshlrev_b32 v73, 16, v73
    v_sub_f32 v74, v74, v27
    v_cvt_pk_bf16_f32 v74, v74, v74
    v_lshlrev_b32 v74, 16, v74
    v_mul_f32 v74, v74, v26
    v_cvt_pk_bf16_f32 v74, v74, v74
    v_lshlrev_b32 v74, 16, v74
    v_sub_f32 v75, v75, v27
    v_cvt_pk_bf16_f32 v75, v75, v75
    v_lshlrev_b32 v75, 16, v75
    v_mul_f32 v75, v75, v26
    v_cvt_pk_bf16_f32 v75, v75, v75
    v_lshlrev_b32 v75, 16, v75
    v_sub_f32 v76, v76, v27
    v_cvt_pk_bf16_f32 v76, v76, v76
    v_lshlrev_b32 v76, 16, v76
    v_mul_f32 v76, v76, v26
    v_cvt_pk_bf16_f32 v76, v76, v76
    v_lshlrev_b32 v76, 16, v76
    v_sub_f32 v77, v77, v27
    v_cvt_pk_bf16_f32 v77, v77, v77
    v_lshlrev_b32 v77, 16, v77
    v_mul_f32 v77, v77, v26
    v_cvt_pk_bf16_f32 v77, v77, v77
    v_lshlrev_b32 v77, 16, v77
    v_sub_f32 v78, v78, v27
    v_cvt_pk_bf16_f32 v78, v78, v78
    v_lshlrev_b32 v78, 16, v78
    v_mul_f32 v78, v78, v26
    v_cvt_pk_bf16_f32 v78, v78, v78
    v_lshlrev_b32 v78, 16, v78
    v_sub_f32 v79, v79, v27
    v_cvt_pk_bf16_f32 v79, v79, v79
    v_lshlrev_b32 v79, 16, v79
    v_mul_f32 v79, v79, v26
    v_cvt_pk_bf16_f32 v79, v79, v79
    v_lshlrev_b32 v79, 16, v79
    v_mul_f32 v64, v64, v112
    v_cvt_pk_bf16_f32 v64, v64, v64
    v_lshlrev_b32 v64, 16, v64
    v_add_f32 v64, v64, v96
    v_mul_f32 v65, v65, v113
    v_cvt_pk_bf16_f32 v65, v65, v65
    v_lshlrev_b32 v65, 16, v65
    v_add_f32 v65, v65, v97
    v_mul_f32 v66, v66, v114
    v_cvt_pk_bf16_f32 v66, v66, v66
    v_lshlrev_b32 v66, 16, v66
    v_add_f32 v66, v66, v98
    v_mul_f32 v67, v67, v115
    v_cvt_pk_bf16_f32 v67, v67, v67
    v_lshlrev_b32 v67, 16, v67
    v_add_f32 v67, v67, v99
    v_mul_f32 v68, v68, v116
    v_cvt_pk_bf16_f32 v68, v68, v68
    v_lshlrev_b32 v68, 16, v68
    v_add_f32 v68, v68, v100
    v_mul_f32 v69, v69, v117
    v_cvt_pk_bf16_f32 v69, v69, v69
    v_lshlrev_b32 v69, 16, v69
    v_add_f32 v69, v69, v101
    v_mul_f32 v70, v70, v118
    v_cvt_pk_bf16_f32 v70, v70, v70
    v_lshlrev_b32 v70, 16, v70
    v_add_f32 v70, v70, v102
    v_mul_f32 v71, v71, v119
    v_cvt_pk_bf16_f32 v71, v71, v71
    v_lshlrev_b32 v71, 16, v71
    v_add_f32 v71, v71, v103
    v_mul_f32 v72, v72, v120
    v_cvt_pk_bf16_f32 v72, v72, v72
    v_lshlrev_b32 v72, 16, v72
    v_add_f32 v72, v72, v104
    v_mul_f32 v73, v73, v121
    v_cvt_pk_bf16_f32 v73, v73, v73
    v_lshlrev_b32 v73, 16, v73
    v_add_f32 v73, v73, v105
    v_mul_f32 v74, v74, v122
    v_cvt_pk_bf16_f32 v74, v74, v74
    v_lshlrev_b32 v74, 16, v74
    v_add_f32 v74, v74, v106
    v_mul_f32 v75, v75, v123
    v_cvt_pk_bf16_f32 v75, v75, v75
    v_lshlrev_b32 v75, 16, v75
    v_add_f32 v75, v75, v107
    v_mul_f32 v76, v76, v124
    v_cvt_pk_bf16_f32 v76, v76, v76
    v_lshlrev_b32 v76, 16, v76
    v_add_f32 v76, v76, v108
    v_mul_f32 v77, v77, v125
    v_cvt_pk_bf16_f32 v77, v77, v77
    v_lshlrev_b32 v77, 16, v77
    v_add_f32 v77, v77, v109
    v_mul_f32 v78, v78, v126
    v_cvt_pk_bf16_f32 v78, v78, v78
    v_lshlrev_b32 v78, 16, v78
    v_add_f32 v78, v78, v110
    v_mul_f32 v79, v79, v127
    v_cvt_pk_bf16_f32 v79, v79, v79
    v_lshlrev_b32 v79, 16, v79
    v_add_f32 v79, v79, v111
    v_cvt_pk_bf16_f32 v80, v64, v65
    v_cvt_pk_bf16_f32 v81, v66, v67
    v_cvt_pk_bf16_f32 v82, v68, v69
    v_cvt_pk_bf16_f32 v83, v70, v71
    v_cvt_pk_bf16_f32 v84, v72, v73
    v_cvt_pk_bf16_f32 v85, v74, v75
    v_cvt_pk_bf16_f32 v86, v76, v77
    v_cvt_pk_bf16_f32 v87, v78, v79
    s_lshr_b32 s45, s63, 5
    s_lshl_b32 s45, s45, 16
    s_and_b32 s46, s63, 31
    s_lshl_b32 s46, s46, 8
    s_add_u32 s45, s45, s46
    s_add_u32 s45, s45, 0x400000
    s_add_u32 s46, s45, 32768
    buffer_store_dwordx4 v[80:83], v2, s[12:15], s45 offen sc1
    buffer_store_dwordx4 v[84:87], v2, s[12:15], s46 offen sc1
    s_add_u32 s63, s63, 384
L_ln_done_109:
    s_waitcnt vmcnt(0)
    s_barrier
    s_cmp_lg_u32 s44, 0
    s_cbranch_scc1 L_cnt_111
    v_mov_b32 v30, 1
    v_mov_b32 v31, 0
    s_mov_b64 exec, 1
    buffer_atomic_add v30, v31, s[16:19], 0 offen offset:196 sc1
    s_mov_b64 exec, -1
L_cnt_111:
    s_add_u32 s39, s39, 96
    s_load_dwordx2 s[4:5], s[0:1], 96
    s_load_dwordx2 s[6:7], s[0:1], 104
    v_and_b32 v14, 7, v0
    v_lshrrev_b32 v15, 3, v0
    s_waitcnt lgkmcnt(0)
    s_mov_b32 s32, s4
    s_and_b32 s33, s5, 0xffff
    s_mov_b32 s34, 0x800
    s_mov_b32 s35, 0x00020000
    s_mov_b32 s24, s6
    s_and_b32 s25, s7, 0xffff
    s_mov_b32 s26, 0xc00000
    s_mov_b32 s27, 0x00020000
    s_and_b32 s47, s39, 1
    s_lshl_b32 s45, s47, 10
    v_lshlrev_b32 v16, 5, v15
    buffer_load_dwordx4 v[104:107], v16, s[32:35], s45 offen
    buffer_load_dwordx4 v[108:111], v16, s[32:35], s45 offen offset:16
    s_mov_b32 s45, 196608
    v_mul_lo_u32 v17, v15, s45
    v_lshlrev_b32 v18, 4, v14
    v_add_u32 v17, v17, v18
    s_lshr_b32 s46, s39, 1
    s_lshl_b32 s46, s46, 7
    s_mul_i32 s45, s47, 6291456
    s_add_u32 s46, s46, s45
    buffer_load_dwordx4 v[32:35], v17, s[24:27], s46 offen
    v_add_u32 v17, 12288, v17
    buffer_load_dwordx4 v[36:39], v17, s[24:27], s46 offen
    v_add_u32 v17, 12288, v17
    buffer_load_dwordx4 v[40:43], v17, s[24:27], s46 offen
    v_add_u32 v17, 12288, v17
    buffer_load_dwordx4 v[44:47], v17, s[24:27], s46 offen
    v_add_u32 v17, 12288, v17
    buffer_load_dwordx4 v[48:51], v17, s[24:27], s46 offen
    v_add_u32 v17, 12288, v17
    buffer_load_dwordx4 v[52:55], v17, s[24:27], s46 offen
    v_add_u32 v17, 12288, v17
    buffer_load_dwordx4 v[56:59], v17, s[24:27], s46 offen
    v_add_u32 v17, 12288, v17
    buffer_load_dwordx4 v[60:63], v17, s[24:27], s46 offen
    v_add_u32 v17, 12288, v17
    buffer_load_dwordx4 v[64:67], v17, s[24:27], s46 offen
    v_add_u32 v17, 12288, v17
    buffer_load_dwordx4 v[68:71], v17, s[24:27], s46 offen
    v_add_u32 v17, 12288, v17
    buffer_load_dwordx4 v[72:75], v17, s[24:27], s46 offen
    v_add_u32 v17, 12288, v17
    buffer_load_dwordx4 v[76:79], v17, s[24:27], s46 offen
    v_add_u32 v17, 12288, v17
    buffer_load_dwordx4 v[80:83], v17, s[24:27], s46 offen
    v_add_u32 v17, 12288, v17
    buffer_load_dwordx4 v[84:87], v17, s[24:27], s46 offen
    v_add_u32 v17, 12288, v17
    buffer_load_dwordx4 v[88:91], v17, s[24:27], s46 offen
    v_add_u32 v17, 12288, v17
    buffer_load_dwordx4 v[92:95], v17, s[24:27], s46 offen
    s_waitcnt vmcnt(16)
    v_lshlrev_b32 v112, 16, v104
    v_and_b32 v113, 0xffff0000, v104
    v_lshlrev_b32 v114, 16, v105
    v_and_b32 v115, 0xffff0000, v105
    v_lshlrev_b32 v116, 16, v106
    v_and_b32 v117, 0xffff0000, v106
    v_lshlrev_b32 v118, 16, v107
    v_and_b32 v119, 0xffff0000, v107
    v_lshlrev_b32 v120, 16, v108
    v_and_b32 v121, 0xffff0000, v108
    v_lshlrev_b32 v122, 16, v109
    v_and_b32 v123, 0xffff0000, v109
    v_lshlrev_b32 v124, 16, v110
    v_and_b32 v125, 0xffff0000, v110
    v_lshlrev_b32 v126, 16, v111
    v_and_b32 v127, 0xffff0000, v111
    v_mul_f32 v18, 0xbfb8aa3b, v112
    v_exp_f32 v18, v18
    s_nop 0
    v_add_f32 v18, 1.0, v18
    v_rcp_f32 v18, v18
    s_nop 0
    v_mul_f32 v112, v112, v18
    v_cvt_pk_bf16_f32 v112, v112, v112
    v_lshlrev_b32 v112, 16, v112
    v_mul_f32 v18, 0xbfb8aa3b, v113
    v_exp_f32 v18, v18
    s_nop 0
    v_add_f32 v18, 1.0, v18
    v_rcp_f32 v18, v18
    s_nop 0
    v_mul_f32 v113, v113, v18
    v_cvt_pk_bf16_f32 v113, v113, v113
    v_lshlrev_b32 v113, 16, v113
    v_mul_f32 v18, 0xbfb8aa3b, v114
    v_exp_f32 v18, v18
    s_nop 0
    v_add_f32 v18, 1.0, v18
    v_rcp_f32 v18, v18
    s_nop 0
    v_mul_f32 v114, v114, v18
    v_cvt_pk_bf16_f32 v114, v114, v114
    v_lshlrev_b32 v114, 16, v114
    v_mul_f32 v18, 0xbfb8aa3b, v115
    v_exp_f32 v18, v18
    s_nop 0
    v_add_f32 v18, 1.0, v18
    v_rcp_f32 v18, v18
    s_nop 0
    v_mul_f32 v115, v115, v18
    v_cvt_pk_bf16_f32 v115, v115, v115
    v_lshlrev_b32 v115, 16, v115
    v_mul_f32 v18, 0xbfb8aa3b, v116
    v_exp_f32 v18, v18
    s_nop 0
    v_add_f32 v18, 1.0, v18
    v_rcp_f32 v18, v18
    s_nop 0
    v_mul_f32 v116, v116, v18
    v_cvt_pk_bf16_f32 v116, v116, v116
    v_lshlrev_b32 v116, 16, v116
    v_mul_f32 v18, 0xbfb8aa3b, v117
    v_exp_f32 v18, v18
    s_nop 0
    v_add_f32 v18, 1.0, v18
    v_rcp_f32 v18, v18
    s_nop 0
    v_mul_f32 v117, v117, v18
    v_cvt_pk_bf16_f32 v117, v117, v117
    v_lshlrev_b32 v117, 16, v117
    v_mul_f32 v18, 0xbfb8aa3b, v118
    v_exp_f32 v18, v18
    s_nop 0
    v_add_f32 v18, 1.0, v18
    v_rcp_f32 v18, v18
    s_nop 0
    v_mul_f32 v118, v118, v18
    v_cvt_pk_bf16_f32 v118, v118, v118
    v_lshlrev_b32 v118, 16, v118
    v_mul_f32 v18, 0xbfb8aa3b, v119
    v_exp_f32 v18, v18
    s_nop 0
    v_add_f32 v18, 1.0, v18
    v_rcp_f32 v18, v18
    s_nop 0
    v_mul_f32 v119, v119, v18
    v_cvt_pk_bf16_f32 v119, v119, v119
    v_lshlrev_b32 v119, 16, v119
    v_mul_f32 v18, 0xbfb8aa3b, v120
    v_exp_f32 v18, v18
    s_nop 0
    v_add_f32 v18, 1.0, v18
    v_rcp_f32 v18, v18
    s_nop 0
    v_mul_f32 v120, v120, v18
    v_cvt_pk_bf16_f32 v120, v120, v120
    v_lshlrev_b32 v120, 16, v120
    v_mul_f32 v18, 0xbfb8aa3b, v121
    v_exp_f32 v18, v18
    s_nop 0
    v_add_f32 v18, 1.0, v18
    v_rcp_f32 v18, v18
    s_nop 0
    v_mul_f32 v121, v121, v18
    v_cvt_pk_bf16_f32 v121, v121, v121
    v_lshlrev_b32 v121, 16, v121
    v_mul_f32 v18, 0xbfb8aa3b, v122
    v_exp_f32 v18, v18
    s_nop 0
    v_add_f32 v18, 1.0, v18
    v_rcp_f32 v18, v18
    s_nop 0
    v_mul_f32 v122, v122, v18
    v_cvt_pk_bf16_f32 v122, v122, v122
    v_lshlrev_b32 v122, 16, v122
    v_mul_f32 v18, 0xbfb8aa3b, v123
    v_exp_f32 v18, v18
    s_nop 0
    v_add_f32 v18, 1.0, v18
    v_rcp_f32 v18, v18
    s_nop 0
    v_mul_f32 v123, v123, v18
    v_cvt_pk_bf16_f32 v123, v123, v123
    v_lshlrev_b32 v123, 16, v123
    v_mul_f32 v18, 0xbfb8aa3b, v124
    v_exp_f32 v18, v18
    s_nop 0
    v_add_f32 v18, 1.0, v18
    v_rcp_f32 v18, v18
    s_nop 0
    v_mul_f32 v124, v124, v18
    v_cvt_pk_bf16_f32 v124, v124, v124
    v_lshlrev_b32 v124, 16, v124
    v_mul_f32 v18, 0xbfb8aa3b, v125
    v_exp_f32 v18, v18
    s_nop 0
    v_add_f32 v18, 1.0, v18
    v_rcp_f32 v18, v18
    s_nop 0
    v_mul_f32 v125, v125, v18
    v_cvt_pk_bf16_f32 v125, v125, v125
    v_lshlrev_b32 v125, 16, v125
    v_mul_f32 v18, 0xbfb8aa3b, v126
    v_exp_f32 v18, v18
    s_nop 0
    v_add_f32 v18, 1.0, v18
    v_rcp_f32 v18, v18
    s_nop 0
    v_mul_f32 v126, v126, v18
    v_cvt_pk_bf16_f32 v126, v126, v126
    v_lshlrev_b32 v126, 16, v126
    v_mul_f32 v18, 0xbfb8aa3b, v127
    v_exp_f32 v18, v18
    s_nop 0
    v_add_f32 v18, 1.0, v18
    v_rcp_f32 v18, v18
    s_nop 0
    v_mul_f32 v127, v127, v18
    v_cvt_pk_bf16_f32 v127, v127, v127
    v_lshlrev_b32 v127, 16, v127
    v_mov_b32 v96, 0
    v_mov_b32 v97, 0
    v_mov_b32 v98, 0
    v_mov_b32 v99, 0
    v_mov_b32 v100, 0
    v_mov_b32 v101, 0
    v_mov_b32 v102, 0
    v_mov_b32 v103, 0
    s_waitcnt vmcnt(15)
    v_lshlrev_b32 v18, 16, v32
    v_and_b32 v19, 0xffff0000, v32
    v_fmac_f32 v96, v18, v112
    v_fmac_f32 v97, v19, v112
    v_lshlrev_b32 v18, 16, v33
    v_and_b32 v19, 0xffff0000, v33
    v_fmac_f32 v98, v18, v112
    v_fmac_f32 v99, v19, v112
    v_lshlrev_b32 v18, 16, v34
    v_and_b32 v19, 0xffff0000, v34
    v_fmac_f32 v100, v18, v112
    v_fmac_f32 v101, v19, v112
    v_lshlrev_b32 v18, 16, v35
    v_and_b32 v19, 0xffff0000, v35
    v_fmac_f32 v102, v18, v112
    v_fmac_f32 v103, v19, v112
    s_waitcnt vmcnt(14)
    v_lshlrev_b32 v18, 16, v36
    v_and_b32 v19, 0xffff0000, v36
    v_fmac_f32 v96, v18, v113
    v_fmac_f32 v97, v19, v113
    v_lshlrev_b32 v18, 16, v37
    v_and_b32 v19, 0xffff0000, v37
    v_fmac_f32 v98, v18, v113
    v_fmac_f32 v99, v19, v113
    v_lshlrev_b32 v18, 16, v38
    v_and_b32 v19, 0xffff0000, v38
    v_fmac_f32 v100, v18, v113
    v_fmac_f32 v101, v19, v113
    v_lshlrev_b32 v18, 16, v39
    v_and_b32 v19, 0xffff0000, v39
    v_fmac_f32 v102, v18, v113
    v_fmac_f32 v103, v19, v113
    s_waitcnt vmcnt(13)
    v_lshlrev_b32 v18, 16, v40
    v_and_b32 v19, 0xffff0000, v40
    v_fmac_f32 v96, v18, v114
    v_fmac_f32 v97, v19, v114
    v_lshlrev_b32 v18, 16, v41
    v_and_b32 v19, 0xffff0000, v41
    v_fmac_f32 v98, v18, v114
    v_fmac_f32 v99, v19, v114
    v_lshlrev_b32 v18, 16, v42
    v_and_b32 v19, 0xffff0000, v42
    v_fmac_f32 v100, v18, v114
    v_fmac_f32 v101, v19, v114
    v_lshlrev_b32 v18, 16, v43
    v_and_b32 v19, 0xffff0000, v43
    v_fmac_f32 v102, v18, v114
    v_fmac_f32 v103, v19, v114
    s_waitcnt vmcnt(12)
    v_lshlrev_b32 v18, 16, v44
    v_and_b32 v19, 0xffff0000, v44
    v_fmac_f32 v96, v18, v115
    v_fmac_f32 v97, v19, v115
    v_lshlrev_b32 v18, 16, v45
    v_and_b32 v19, 0xffff0000, v45
    v_fmac_f32 v98, v18, v115
    v_fmac_f32 v99, v19, v115
    v_lshlrev_b32 v18, 16, v46
    v_and_b32 v19, 0xffff0000, v46
    v_fmac_f32 v100, v18, v115
    v_fmac_f32 v101, v19, v115
    v_lshlrev_b32 v18, 16, v47
    v_and_b32 v19, 0xffff0000, v47
    v_fmac_f32 v102, v18, v115
    v_fmac_f32 v103, v19, v115
    s_waitcnt vmcnt(11)
    v_lshlrev_b32 v18, 16, v48
    v_and_b32 v19, 0xffff0000, v48
    v_fmac_f32 v96, v18, v116
    v_fmac_f32 v97, v19, v116
    v_lshlrev_b32 v18, 16, v49
    v_and_b32 v19, 0xffff0000, v49
    v_fmac_f32 v98, v18, v116
    v_fmac_f32 v99, v19, v116
    v_lshlrev_b32 v18, 16, v50
    v_and_b32 v19, 0xffff0000, v50
    v_fmac_f32 v100, v18, v116
    v_fmac_f32 v101, v19, v116
    v_lshlrev_b32 v18, 16, v51
    v_and_b32 v19, 0xffff0000, v51
    v_fmac_f32 v102, v18, v116
    v_fmac_f32 v103, v19, v116
    s_waitcnt vmcnt(10)
    v_lshlrev_b32 v18, 16, v52
    v_and_b32 v19, 0xffff0000, v52
    v_fmac_f32 v96, v18, v117
    v_fmac_f32 v97, v19, v117
    v_lshlrev_b32 v18, 16, v53
    v_and_b32 v19, 0xffff0000, v53
    v_fmac_f32 v98, v18, v117
    v_fmac_f32 v99, v19, v117
    v_lshlrev_b32 v18, 16, v54
    v_and_b32 v19, 0xffff0000, v54
    v_fmac_f32 v100, v18, v117
    v_fmac_f32 v101, v19, v117
    v_lshlrev_b32 v18, 16, v55
    v_and_b32 v19, 0xffff0000, v55
    v_fmac_f32 v102, v18, v117
    v_fmac_f32 v103, v19, v117
    s_waitcnt vmcnt(9)
    v_lshlrev_b32 v18, 16, v56
    v_and_b32 v19, 0xffff0000, v56
    v_fmac_f32 v96, v18, v118
    v_fmac_f32 v97, v19, v118
    v_lshlrev_b32 v18, 16, v57
    v_and_b32 v19, 0xffff0000, v57
    v_fmac_f32 v98, v18, v118
    v_fmac_f32 v99, v19, v118
    v_lshlrev_b32 v18, 16, v58
    v_and_b32 v19, 0xffff0000, v58
    v_fmac_f32 v100, v18, v118
    v_fmac_f32 v101, v19, v118
    v_lshlrev_b32 v18, 16, v59
    v_and_b32 v19, 0xffff0000, v59
    v_fmac_f32 v102, v18, v118
    v_fmac_f32 v103, v19, v118
    s_waitcnt vmcnt(8)
    v_lshlrev_b32 v18, 16, v60
    v_and_b32 v19, 0xffff0000, v60
    v_fmac_f32 v96, v18, v119
    v_fmac_f32 v97, v19, v119
    v_lshlrev_b32 v18, 16, v61
    v_and_b32 v19, 0xffff0000, v61
    v_fmac_f32 v98, v18, v119
    v_fmac_f32 v99, v19, v119
    v_lshlrev_b32 v18, 16, v62
    v_and_b32 v19, 0xffff0000, v62
    v_fmac_f32 v100, v18, v119
    v_fmac_f32 v101, v19, v119
    v_lshlrev_b32 v18, 16, v63
    v_and_b32 v19, 0xffff0000, v63
    v_fmac_f32 v102, v18, v119
    v_fmac_f32 v103, v19, v119
    s_waitcnt vmcnt(7)
    v_lshlrev_b32 v18, 16, v64
    v_and_b32 v19, 0xffff0000, v64
    v_fmac_f32 v96, v18, v120
    v_fmac_f32 v97, v19, v120
    v_lshlrev_b32 v18, 16, v65
    v_and_b32 v19, 0xffff0000, v65
    v_fmac_f32 v98, v18, v120
    v_fmac_f32 v99, v19, v120
    v_lshlrev_b32 v18, 16, v66
    v_and_b32 v19, 0xffff0000, v66
    v_fmac_f32 v100, v18, v120
    v_fmac_f32 v101, v19, v120
    v_lshlrev_b32 v18, 16, v67
    v_and_b32 v19, 0xffff0000, v67
    v_fmac_f32 v102, v18, v120
    v_fmac_f32 v103, v19, v120
    s_waitcnt vmcnt(6)
    v_lshlrev_b32 v18, 16, v68
    v_and_b32 v19, 0xffff0000, v68
    v_fmac_f32 v96, v18, v121
    v_fmac_f32 v97, v19, v121
    v_lshlrev_b32 v18, 16, v69
    v_and_b32 v19, 0xffff0000, v69
    v_fmac_f32 v98, v18, v121
    v_fmac_f32 v99, v19, v121
    v_lshlrev_b32 v18, 16, v70
    v_and_b32 v19, 0xffff0000, v70
    v_fmac_f32 v100, v18, v121
    v_fmac_f32 v101, v19, v121
    v_lshlrev_b32 v18, 16, v71
    v_and_b32 v19, 0xffff0000, v71
    v_fmac_f32 v102, v18, v121
    v_fmac_f32 v103, v19, v121
    s_waitcnt vmcnt(5)
    v_lshlrev_b32 v18, 16, v72
    v_and_b32 v19, 0xffff0000, v72
    v_fmac_f32 v96, v18, v122
    v_fmac_f32 v97, v19, v122
    v_lshlrev_b32 v18, 16, v73
    v_and_b32 v19, 0xffff0000, v73
    v_fmac_f32 v98, v18, v122
    v_fmac_f32 v99, v19, v122
    v_lshlrev_b32 v18, 16, v74
    v_and_b32 v19, 0xffff0000, v74
    v_fmac_f32 v100, v18, v122
    v_fmac_f32 v101, v19, v122
    v_lshlrev_b32 v18, 16, v75
    v_and_b32 v19, 0xffff0000, v75
    v_fmac_f32 v102, v18, v122
    v_fmac_f32 v103, v19, v122
    s_waitcnt vmcnt(4)
    v_lshlrev_b32 v18, 16, v76
    v_and_b32 v19, 0xffff0000, v76
    v_fmac_f32 v96, v18, v123
    v_fmac_f32 v97, v19, v123
    v_lshlrev_b32 v18, 16, v77
    v_and_b32 v19, 0xffff0000, v77
    v_fmac_f32 v98, v18, v123
    v_fmac_f32 v99, v19, v123
    v_lshlrev_b32 v18, 16, v78
    v_and_b32 v19, 0xffff0000, v78
    v_fmac_f32 v100, v18, v123
    v_fmac_f32 v101, v19, v123
    v_lshlrev_b32 v18, 16, v79
    v_and_b32 v19, 0xffff0000, v79
    v_fmac_f32 v102, v18, v123
    v_fmac_f32 v103, v19, v123
    s_waitcnt vmcnt(3)
    v_lshlrev_b32 v18, 16, v80
    v_and_b32 v19, 0xffff0000, v80
    v_fmac_f32 v96, v18, v124
    v_fmac_f32 v97, v19, v124
    v_lshlrev_b32 v18, 16, v81
    v_and_b32 v19, 0xffff0000, v81
    v_fmac_f32 v98, v18, v124
    v_fmac_f32 v99, v19, v124
    v_lshlrev_b32 v18, 16, v82
    v_and_b32 v19, 0xffff0000, v82
    v_fmac_f32 v100, v18, v124
    v_fmac_f32 v101, v19, v124
    v_lshlrev_b32 v18, 16, v83
    v_and_b32 v19, 0xffff0000, v83
    v_fmac_f32 v102, v18, v124
    v_fmac_f32 v103, v19, v124
    s_waitcnt vmcnt(2)
    v_lshlrev_b32 v18, 16, v84
    v_and_b32 v19, 0xffff0000, v84
    v_fmac_f32 v96, v18, v125
    v_fmac_f32 v97, v19, v125
    v_lshlrev_b32 v18, 16, v85
    v_and_b32 v19, 0xffff0000, v85
    v_fmac_f32 v98, v18, v125
    v_fmac_f32 v99, v19, v125
    v_lshlrev_b32 v18, 16, v86
    v_and_b32 v19, 0xffff0000, v86
    v_fmac_f32 v100, v18, v125
    v_fmac_f32 v101, v19, v125
    v_lshlrev_b32 v18, 16, v87
    v_and_b32 v19, 0xffff0000, v87
    v_fmac_f32 v102, v18, v125
    v_fmac_f32 v103, v19, v125
    s_waitcnt vmcnt(1)
    v_lshlrev_b32 v18, 16, v88
    v_and_b32 v19, 0xffff0000, v88
    v_fmac_f32 v96, v18, v126
    v_fmac_f32 v97, v19, v126
    v_lshlrev_b32 v18, 16, v89
    v_and_b32 v19, 0xffff0000, v89
    v_fmac_f32 v98, v18, v126
    v_fmac_f32 v99, v19, v126
    v_lshlrev_b32 v18, 16, v90
    v_and_b32 v19, 0xffff0000, v90
    v_fmac_f32 v100, v18, v126
    v_fmac_f32 v101, v19, v126
    v_lshlrev_b32 v18, 16, v91
    v_and_b32 v19, 0xffff0000, v91
    v_fmac_f32 v102, v18, v126
    v_fmac_f32 v103, v19, v126
    s_waitcnt vmcnt(0)
    v_lshlrev_b32 v18, 16, v92
    v_and_b32 v19, 0xffff0000, v92
    v_fmac_f32 v96, v18, v127
    v_fmac_f32 v97, v19, v127
    v_lshlrev_b32 v18, 16, v93
    v_and_b32 v19, 0xffff0000, v93
    v_fmac_f32 v98, v18, v127
    v_fmac_f32 v99, v19, v127
    v_lshlrev_b32 v18, 16, v94
    v_and_b32 v19, 0xffff0000, v94
    v_fmac_f32 v100, v18, v127
    v_fmac_f32 v101, v19, v127
    v_lshlrev_b32 v18, 16, v95
    v_and_b32 v19, 0xffff0000, v95
    v_fmac_f32 v102, v18, v127
    v_fmac_f32 v103, v19, v127
    v_lshlrev_b32 v16, 5, v0
    ds_write_b128 v16, v[96:99]
    ds_write_b128 v16, v[100:103] offset:16
    s_waitcnt lgkmcnt(0)
    s_barrier
    s_cmp_lg_u32 s44, 0
    s_cbranch_scc1 L_mod_fin_112
    v_mov_b32 v18, 0
    ds_read_b32 v32, v12 offset:0
    ds_read_b32 v33, v12 offset:256
    ds_read_b32 v34, v12 offset:512
    ds_read_b32 v35, v12 offset:768
    ds_read_b32 v36, v12 offset:1024
    ds_read_b32 v37, v12 offset:1280
    ds_read_b32 v38, v12 offset:1536
    ds_read_b32 v39, v12 offset:1792
    ds_read_b32 v40, v12 offset:2048
    ds_read_b32 v41, v12 offset:2304
    ds_read_b32 v42, v12 offset:2560
    ds_read_b32 v43, v12 offset:2816
    ds_read_b32 v44, v12 offset:3072
    ds_read_b32 v45, v12 offset:3328
    ds_read_b32 v46, v12 offset:3584
    ds_read_b32 v47, v12 offset:3840
    s_waitcnt lgkmcnt(0)
    v_add_f32 v18, v18, v32
    v_add_f32 v18, v18, v33
    v_add_f32 v18, v18, v34
    v_add_f32 v18, v18, v35
    v_add_f32 v18, v18, v36
    v_add_f32 v18, v18, v37
    v_add_f32 v18, v18, v38
    v_add_f32 v18, v18, v39
    v_add_f32 v18, v18, v40
    v_add_f32 v18, v18, v41
    v_add_f32 v18, v18, v42
    v_add_f32 v18, v18, v43
    v_add_f32 v18, v18, v44
    v_add_f32 v18, v18, v45
    v_add_f32 v18, v18, v46
    v_add_f32 v18, v18, v47
    ds_read_b32 v32, v12 offset:4096
    ds_read_b32 v33, v12 offset:4352
    ds_read_b32 v34, v12 offset:4608
    ds_read_b32 v35, v12 offset:4864
    ds_read_b32 v36, v12 offset:5120
    ds_read_b32 v37, v12 offset:5376
    ds_read_b32 v38, v12 offset:5632
    ds_read_b32 v39, v12 offset:5888
    ds_read_b32 v40, v12 offset:6144
    ds_read_b32 v41, v12 offset:6400
    ds_read_b32 v42, v12 offset:6656
    ds_read_b32 v43, v12 offset:6912
    ds_read_b32 v44, v12 offset:7168
    ds_read_b32 v45, v12 offset:7424
    ds_read_b32 v46, v12 offset:7680
    ds_read_b32 v47, v12 offset:7936
    s_waitcnt lgkmcnt(0)
    v_add_f32 v18, v18, v32
    v_add_f32 v18, v18, v33
    v_add_f32 v18, v18, v34
    v_add_f32 v18, v18, v35
    v_add_f32 v18, v18, v36
    v_add_f32 v18, v18, v37
    v_add_f32 v18, v18, v38
    v_add_f32 v18, v18, v39
    v_add_f32 v18, v18, v40
    v_add_f32 v18, v18, v41
    v_add_f32 v18, v18, v42
    v_add_f32 v18, v18, v43
    v_add_f32 v18, v18, v44
    v_add_f32 v18, v18, v45
    v_add_f32 v18, v18, v46
    v_add_f32 v18, v18, v47
    s_lshr_b32 s45, s39, 1
    s_lshl_b32 s45, s45, 8
    s_mul_i32 s46, s47, 24576
    s_add_u32 s45, s45, s46
    buffer_store_dword v18, v12, s[12:15], s45 offen sc1
L_mod_fin_112:
    s_waitcnt vmcnt(0)
    s_barrier
    s_cmp_lg_u32 s44, 0
    s_cbranch_scc1 L_cnt_113
    v_mov_b32 v30, 1
    v_mov_b32 v31, 0
    s_mov_b64 exec, 1
    buffer_atomic_add v30, v31, s[16:19], 0 offen offset:132 sc1
    s_mov_b64 exec, -1
L_cnt_113:
    s_branch L_w_roles_104
L_w_kv_103:
    s_lshl_b32 s45, s43, 3
    s_add_u32 s45, s45, 16
    s_load_dwordx2 s[6:7], s[0:1], s45
    s_waitcnt lgkmcnt(0)
    s_mov_b32 s24, s6
    s_and_b32 s25, s7, 0xffff
    s_mov_b32 s26, 0x800000
    s_mov_b32 s27, 0x00020000
    s_lshl_b32 s46, s41, 8
    s_barrier
    v_lshrrev_b32 v20, 4, v1
    s_lshl_b32 s45, s44, 2
    v_add_u32 v21, s45, v20
    s_mov_b32 s45, 8192
    v_mul_lo_u32 v21, v21, s45
    v_lshlrev_b32 v22, 2, v20
    v_and_b32 v23, 15, v1
    v_xor_b32 v22, v22, v23
    v_lshlrev_b32 v22, 4, v22
    v_add_u32 v21, v21, v22
    v_bfe_u32 v22, v1, 2, 2
    v_lshlrev_b32 v23, 3, v20
    v_add_u32 v23, v23, v22
    v_lshlrev_b32 v23, 8, v23
    v_xor_b32 v22, s44, v22
    v_lshlrev_b32 v22, 6, v22
    v_add_u32 v23, v23, v22
    v_and_b32 v22, 3, v1
    v_lshlrev_b32 v22, 4, v22
    v_add_u32 v23, v23, v22
    v_add_u32 v24, 65536, v23
    v_add_u32 v25, 131072, v23
    s_lshl_b32 s47, s44, 10
    s_add_u32 s45, s46, 0x0
    s_add_u32 m0, s47, 0
    s_nop 0
    buffer_load_dwordx4 v21, s[24:27], s45 offen  lds
    s_add_u32 s45, s46, 0x20000
    s_add_u32 m0, s47, 4096
    s_nop 0
    buffer_load_dwordx4 v21, s[24:27], s45 offen  lds
    s_add_u32 s45, s46, 0x40000
    s_add_u32 m0, s47, 8192
    s_nop 0
    buffer_load_dwordx4 v21, s[24:27], s45 offen  lds
    s_add_u32 s45, s46, 0x60000
    s_add_u32 m0, s47, 12288
    s_nop 0
    buffer_load_dwordx4 v21, s[24:27], s45 offen  lds
    s_add_u32 s45, s46, 0x80000
    s_add_u32 m0, s47, 16384
    s_nop 0
    buffer_load_dwordx4 v21, s[24:27], s45 offen  lds
    s_add_u32 s45, s46, 0xa0000
    s_add_u32 m0, s47, 20480
    s_nop 0
    buffer_load_dwordx4 v21, s[24:27], s45 offen  lds
    s_add_u32 s45, s46, 0xc0000
    s_add_u32 m0, s47, 24576
    s_nop 0
    buffer_load_dwordx4 v21, s[24:27], s45 offen  lds
    s_add_u32 s45, s46, 0xe0000
    s_add_u32 m0, s47, 28672
    s_nop 0
    buffer_load_dwordx4 v21, s[24:27], s45 offen  lds
    s_add_u32 s45, s46, 0x100000
    s_add_u32 m0, s47, 32768
    s_nop 0
    buffer_load_dwordx4 v21, s[24:27], s45 offen  lds
    s_add_u32 s45, s46, 0x120000
    s_add_u32 m0, s47, 36864
    s_nop 0
    buffer_load_dwordx4 v21, s[24:27], s45 offen  lds
    s_add_u32 s45, s46, 0x140000
    s_add_u32 m0, s47, 40960
    s_nop 0
    buffer_load_dwordx4 v21, s[24:27], s45 offen  lds
    s_add_u32 s45, s46, 0x160000
    s_add_u32 m0, s47, 45056
    s_nop 0
    buffer_load_dwordx4 v21, s[24:27], s45 offen  lds
    s_add_u32 s45, s46, 0x180000
    s_add_u32 m0, s47, 49152
    s_nop 0
    buffer_load_dwordx4 v21, s[24:27], s45 offen  lds
    s_add_u32 s45, s46, 0x1a0000
    s_add_u32 m0, s47, 53248
    s_nop 0
    buffer_load_dwordx4 v21, s[24:27], s45 offen  lds
    s_add_u32 s45, s46, 0x1c0000
    s_add_u32 m0, s47, 57344
    s_nop 0
    buffer_load_dwordx4 v21, s[24:27], s45 offen  lds
    s_add_u32 s45, s46, 0x1e0000
    s_add_u32 m0, s47, 61440
    s_nop 0
    buffer_load_dwordx4 v21, s[24:27], s45 offen  lds
    s_add_u32 s45, s46, 0x200000
    s_add_u32 m0, s47, 65536
    s_nop 0
    buffer_load_dwordx4 v21, s[24:27], s45 offen  lds
    s_add_u32 s45, s46, 0x220000
    s_add_u32 m0, s47, 69632
    s_nop 0
    buffer_load_dwordx4 v21, s[24:27], s45 offen  lds
    s_add_u32 s45, s46, 0x240000
    s_add_u32 m0, s47, 73728
    s_nop 0
    buffer_load_dwordx4 v21, s[24:27], s45 offen  lds
    s_add_u32 s45, s46, 0x260000
    s_add_u32 m0, s47, 77824
    s_nop 0
    buffer_load_dwordx4 v21, s[24:27], s45 offen  lds
    s_add_u32 s45, s46, 0x280000
    s_add_u32 m0, s47, 81920
    s_nop 0
    buffer_load_dwordx4 v21, s[24:27], s45 offen  lds
    s_add_u32 s45, s46, 0x2a0000
    s_add_u32 m0, s47, 86016
    s_nop 0
    buffer_load_dwordx4 v21, s[24:27], s45 offen  lds
    s_add_u32 s45, s46, 0x2c0000
    s_add_u32 m0, s47, 90112
    s_nop 0
    buffer_load_dwordx4 v21, s[24:27], s45 offen  lds
    s_add_u32 s45, s46, 0x2e0000
    s_add_u32 m0, s47, 94208
    s_nop 0
    buffer_load_dwordx4 v21, s[24:27], s45 offen  lds
    s_add_u32 s45, s46, 0x300000
    s_add_u32 m0, s47, 98304
    s_nop 0
    buffer_load_dwordx4 v21, s[24:27], s45 offen  lds
    s_add_u32 s45, s46, 0x320000
    s_add_u32 m0, s47, 102400
    s_nop 0
    buffer_load_dwordx4 v21, s[24:27], s45 offen  lds
    s_add_u32 s45, s46, 0x340000
    s_add_u32 m0, s47, 106496
    s_nop 0
    buffer_load_dwordx4 v21, s[24:27], s45 offen  lds
    s_add_u32 s45, s46, 0x360000
    s_add_u32 m0, s47, 110592
    s_nop 0
    buffer_load_dwordx4 v21, s[24:27], s45 offen  lds
    s_add_u32 s45, s46, 0x380000
    s_add_u32 m0, s47, 114688
    s_nop 0
    buffer_load_dwordx4 v21, s[24:27], s45 offen  lds
    s_add_u32 s45, s46, 0x3a0000
    s_add_u32 m0, s47, 118784
    s_nop 0
    buffer_load_dwordx4 v21, s[24:27], s45 offen  lds
    s_add_u32 s45, s46, 0x3c0000
    s_add_u32 m0, s47, 122880
    s_nop 0
    buffer_load_dwordx4 v21, s[24:27], s45 offen  lds
    s_add_u32 s45, s46, 0x3e0000
    s_add_u32 m0, s47, 126976
    s_nop 0
    buffer_load_dwordx4 v21, s[24:27], s45 offen  lds
    s_waitcnt vmcnt(28)
    s_barrier
    s_add_u32 s45, s46, 0x400000
    s_add_u32 m0, s47, 131072
    s_nop 0
    buffer_load_dwordx4 v21, s[24:27], s45 offen  lds
    s_add_u32 s45, s46, 0x420000
    s_add_u32 m0, s47, 135168
    s_nop 0
    buffer_load_dwordx4 v21, s[24:27], s45 offen  lds
    s_add_u32 s45, s46, 0x440000
    s_add_u32 m0, s47, 139264
    s_nop 0
    buffer_load_dwordx4 v21, s[24:27], s45 offen  lds
    s_add_u32 s45, s46, 0x460000
    s_add_u32 m0, s47, 143360
    s_nop 0
    buffer_load_dwordx4 v21, s[24:27], s45 offen  lds
    ds_read_b64_tr_b16 a[0:1], v23 offset:0
    ds_read_b64_tr_b16 a[2:3], v23 offset:1024
    ds_read_b64_tr_b16 a[4:5], v23 offset:8
    ds_read_b64_tr_b16 a[6:7], v23 offset:1032
    ds_read_b64_tr_b16 a[8:9], v23 offset:8192
    ds_read_b64_tr_b16 a[10:11], v23 offset:9216
    ds_read_b64_tr_b16 a[12:13], v23 offset:8200
    ds_read_b64_tr_b16 a[14:15], v23 offset:9224
    s_waitcnt lgkmcnt(0)
    s_waitcnt vmcnt(28)
    s_barrier
    s_add_u32 s45, s46, 0x480000
    s_add_u32 m0, s47, 0
    s_nop 0
    buffer_load_dwordx4 v21, s[24:27], s45 offen  lds
    s_add_u32 s45, s46, 0x4a0000
    s_add_u32 m0, s47, 4096
    s_nop 0
    buffer_load_dwordx4 v21, s[24:27], s45 offen  lds
    s_add_u32 s45, s46, 0x4c0000
    s_add_u32 m0, s47, 8192
    s_nop 0
    buffer_load_dwordx4 v21, s[24:27], s45 offen  lds
    s_add_u32 s45, s46, 0x4e0000
    s_add_u32 m0, s47, 12288
    s_nop 0
    buffer_load_dwordx4 v21, s[24:27], s45 offen  lds
    ds_read_b64_tr_b16 a[16:17], v23 offset:16384
    ds_read_b64_tr_b16 a[18:19], v23 offset:17408
    ds_read_b64_tr_b16 a[20:21], v23 offset:16392
    ds_read_b64_tr_b16 a[22:23], v23 offset:17416
    ds_read_b64_tr_b16 a[24:25], v23 offset:24576
    ds_read_b64_tr_b16 a[26:27], v23 offset:25600
    ds_read_b64_tr_b16 a[28:29], v23 offset:24584
    ds_read_b64_tr_b16 a[30:31], v23 offset:25608
    s_waitcnt lgkmcnt(0)
    s_waitcnt vmcnt(28)
    s_barrier
    s_add_u32 s45, s46, 0x500000
    s_add_u32 m0, s47, 16384
    s_nop 0
    buffer_load_dwordx4 v21, s[24:27], s45 offen  lds
    s_add_u32 s45, s46, 0x520000
    s_add_u32 m0, s47, 20480
    s_nop 0
    buffer_load_dwordx4 v21, s[24:27], s45 offen  lds
    s_add_u32 s45, s46, 0x540000
    s_add_u32 m0, s47, 24576
    s_nop 0
    buffer_load_dwordx4 v21, s[24:27], s45 offen  lds
    s_add_u32 s45, s46, 0x560000
    s_add_u32 m0, s47, 28672
    s_nop 0
    buffer_load_dwordx4 v21, s[24:27], s45 offen  lds
    ds_read_b64_tr_b16 a[32:33], v23 offset:32768
    ds_read_b64_tr_b16 a[34:35], v23 offset:33792
    ds_read_b64_tr_b16 a[36:37], v23 offset:32776
    ds_read_b64_tr_b16 a[38:39], v23 offset:33800
    ds_read_b64_tr_b16 a[40:41], v23 offset:40960
    ds_read_b64_tr_b16 a[42:43], v23 offset:41984
    ds_read_b64_tr_b16 a[44:45], v23 offset:40968
    ds_read_b64_tr_b16 a[46:47], v23 offset:41992
    s_waitcnt lgkmcnt(0)
    s_waitcnt vmcnt(28)
    s_barrier
    s_add_u32 s45, s46, 0x580000
    s_add_u32 m0, s47, 32768
    s_nop 0
    buffer_load_dwordx4 v21, s[24:27], s45 offen  lds
    s_add_u32 s45, s46, 0x5a0000
    s_add_u32 m0, s47, 36864
    s_nop 0
    buffer_load_dwordx4 v21, s[24:27], s45 offen  lds
    s_add_u32 s45, s46, 0x5c0000
    s_add_u32 m0, s47, 40960
    s_nop 0
    buffer_load_dwordx4 v21, s[24:27], s45 offen  lds
    s_add_u32 s45, s46, 0x5e0000
    s_add_u32 m0, s47, 45056
    s_nop 0
    buffer_load_dwordx4 v21, s[24:27], s45 offen  lds
    ds_read_b64_tr_b16 a[48:49], v23 offset:49152
    ds_read_b64_tr_b16 a[50:51], v23 offset:50176
    ds_read_b64_tr_b16 a[52:53], v23 offset:49160
    ds_read_b64_tr_b16 a[54:55], v23 offset:50184
    ds_read_b64_tr_b16 a[56:57], v23 offset:57344
    ds_read_b64_tr_b16 a[58:59], v23 offset:58368
    ds_read_b64_tr_b16 a[60:61], v23 offset:57352
    ds_read_b64_tr_b16 a[62:63], v23 offset:58376
    s_waitcnt lgkmcnt(0)
    s_waitcnt vmcnt(28)
    s_barrier
    s_add_u32 s45, s46, 0x600000
    s_add_u32 m0, s47, 49152
    s_nop 0
    buffer_load_dwordx4 v21, s[24:27], s45 offen  lds
    s_add_u32 s45, s46, 0x620000
    s_add_u32 m0, s47, 53248
    s_nop 0
    buffer_load_dwordx4 v21, s[24:27], s45 offen  lds
    s_add_u32 s45, s46, 0x640000
    s_add_u32 m0, s47, 57344
    s_nop 0
    buffer_load_dwordx4 v21, s[24:27], s45 offen  lds
    s_add_u32 s45, s46, 0x660000
    s_add_u32 m0, s47, 61440
    s_nop 0
    buffer_load_dwordx4 v21, s[24:27], s45 offen  lds
    ds_read_b64_tr_b16 a[64:65], v24 offset:0
    ds_read_b64_tr_b16 a[66:67], v24 offset:1024
    ds_read_b64_tr_b16 a[68:69], v24 offset:8
    ds_read_b64_tr_b16 a[70:71], v24 offset:1032
    ds_read_b64_tr_b16 a[72:73], v24 offset:8192
    ds_read_b64_tr_b16 a[74:75], v24 offset:9216
    ds_read_b64_tr_b16 a[76:77], v24 offset:8200
    ds_read_b64_tr_b16 a[78:79], v24 offset:9224
    s_waitcnt lgkmcnt(0)
    s_waitcnt vmcnt(28)
    s_barrier
    s_add_u32 s45, s46, 0x680000
    s_add_u32 m0, s47, 65536
    s_nop 0
    buffer_load_dwordx4 v21, s[24:27], s45 offen  lds
    s_add_u32 s45, s46, 0x6a0000
    s_add_u32 m0, s47, 69632
    s_nop 0
    buffer_load_dwordx4 v21, s[24:27], s45 offen  lds
    s_add_u32 s45, s46, 0x6c0000
    s_add_u32 m0, s47, 73728
    s_nop 0
    buffer_load_dwordx4 v21, s[24:27], s45 offen  lds
    s_add_u32 s45, s46, 0x6e0000
    s_add_u32 m0, s47, 77824
    s_nop 0
    buffer_load_dwordx4 v21, s[24:27], s45 offen  lds
    ds_read_b64_tr_b16 a[80:81], v24 offset:16384
    ds_read_b64_tr_b16 a[82:83], v24 offset:17408
    ds_read_b64_tr_b16 a[84:85], v24 offset:16392
    ds_read_b64_tr_b16 a[86:87], v24 offset:17416
    ds_read_b64_tr_b16 a[88:89], v24 offset:24576
    ds_read_b64_tr_b16 a[90:91], v24 offset:25600
    ds_read_b64_tr_b16 a[92:93], v24 offset:24584
    ds_read_b64_tr_b16 a[94:95], v24 offset:25608
    s_waitcnt lgkmcnt(0)
    s_waitcnt vmcnt(28)
    s_barrier
    s_add_u32 s45, s46, 0x700000
    s_add_u32 m0, s47, 81920
    s_nop 0
    buffer_load_dwordx4 v21, s[24:27], s45 offen  lds
    s_add_u32 s45, s46, 0x720000
    s_add_u32 m0, s47, 86016
    s_nop 0
    buffer_load_dwordx4 v21, s[24:27], s45 offen  lds
    s_add_u32 s45, s46, 0x740000
    s_add_u32 m0, s47, 90112
    s_nop 0
    buffer_load_dwordx4 v21, s[24:27], s45 offen  lds
    s_add_u32 s45, s46, 0x760000
    s_add_u32 m0, s47, 94208
    s_nop 0
    buffer_load_dwordx4 v21, s[24:27], s45 offen  lds
    ds_read_b64_tr_b16 a[96:97], v24 offset:32768
    ds_read_b64_tr_b16 a[98:99], v24 offset:33792
    ds_read_b64_tr_b16 a[100:101], v24 offset:32776
    ds_read_b64_tr_b16 a[102:103], v24 offset:33800
    ds_read_b64_tr_b16 a[104:105], v24 offset:40960
    ds_read_b64_tr_b16 a[106:107], v24 offset:41984
    ds_read_b64_tr_b16 a[108:109], v24 offset:40968
    ds_read_b64_tr_b16 a[110:111], v24 offset:41992
    s_waitcnt lgkmcnt(0)
    s_waitcnt vmcnt(28)
    s_barrier
    s_add_u32 s45, s46, 0x780000
    s_add_u32 m0, s47, 98304
    s_nop 0
    buffer_load_dwordx4 v21, s[24:27], s45 offen  lds
    s_add_u32 s45, s46, 0x7a0000
    s_add_u32 m0, s47, 102400
    s_nop 0
    buffer_load_dwordx4 v21, s[24:27], s45 offen  lds
    s_add_u32 s45, s46, 0x7c0000
    s_add_u32 m0, s47, 106496
    s_nop 0
    buffer_load_dwordx4 v21, s[24:27], s45 offen  lds
    s_add_u32 s45, s46, 0x7e0000
    s_add_u32 m0, s47, 110592
    s_nop 0
    buffer_load_dwordx4 v21, s[24:27], s45 offen  lds
    ds_read_b64_tr_b16 a[112:113], v24 offset:49152
    ds_read_b64_tr_b16 a[114:115], v24 offset:50176
    ds_read_b64_tr_b16 a[116:117], v24 offset:49160
    ds_read_b64_tr_b16 a[118:119], v24 offset:50184
    ds_read_b64_tr_b16 a[120:121], v24 offset:57344
    ds_read_b64_tr_b16 a[122:123], v24 offset:58368
    ds_read_b64_tr_b16 a[124:125], v24 offset:57352
    ds_read_b64_tr_b16 a[126:127], v24 offset:58376
    s_waitcnt lgkmcnt(0)
    s_waitcnt vmcnt(28)
    s_barrier
    ds_read_b64_tr_b16 a[128:129], v25 offset:0
    ds_read_b64_tr_b16 a[130:131], v25 offset:1024
    ds_read_b64_tr_b16 a[132:133], v25 offset:8
    ds_read_b64_tr_b16 a[134:135], v25 offset:1032
    ds_read_b64_tr_b16 a[136:137], v25 offset:8192
    ds_read_b64_tr_b16 a[138:139], v25 offset:9216
    ds_read_b64_tr_b16 a[140:141], v25 offset:8200
    ds_read_b64_tr_b16 a[142:143], v25 offset:9224
    s_waitcnt lgkmcnt(0)
    s_waitcnt vmcnt(24)
    s_barrier
    ds_read_b64_tr_b16 a[144:145], v23 offset:0
    ds_read_b64_tr_b16 a[146:147], v23 offset:1024
    ds_read_b64_tr_b16 a[148:149], v23 offset:8
    ds_read_b64_tr_b16 a[150:151], v23 offset:1032
    ds_read_b64_tr_b16 a[152:153], v23 offset:8192
    ds_read_b64_tr_b16 a[154:155], v23 offset:9216
    ds_read_b64_tr_b16 a[156:157], v23 offset:8200
    ds_read_b64_tr_b16 a[158:159], v23 offset:9224
    s_waitcnt lgkmcnt(0)
    s_waitcnt vmcnt(20)
    s_barrier
    ds_read_b64_tr_b16 a[160:161], v23 offset:16384
    ds_read_b64_tr_b16 a[162:163], v23 offset:17408
    ds_read_b64_tr_b16 a[164:165], v23 offset:16392
    ds_read_b64_tr_b16 a[166:167], v23 offset:17416
    ds_read_b64_tr_b16 a[168:169], v23 offset:24576
    ds_read_b64_tr_b16 a[170:171], v23 offset:25600
    ds_read_b64_tr_b16 a[172:173], v23 offset:24584
    ds_read_b64_tr_b16 a[174:175], v23 offset:25608
    s_waitcnt lgkmcnt(0)
    s_waitcnt vmcnt(16)
    s_barrier
    ds_read_b64_tr_b16 a[176:177], v23 offset:32768
    ds_read_b64_tr_b16 a[178:179], v23 offset:33792
    ds_read_b64_tr_b16 a[180:181], v23 offset:32776
    ds_read_b64_tr_b16 a[182:183], v23 offset:33800
    ds_read_b64_tr_b16 a[184:185], v23 offset:40960
    ds_read_b64_tr_b16 a[186:187], v23 offset:41984
    ds_read_b64_tr_b16 a[188:189], v23 offset:40968
    ds_read_b64_tr_b16 a[190:191], v23 offset:41992
    s_waitcnt lgkmcnt(0)
    s_waitcnt vmcnt(12)
    s_barrier
    ds_read_b64_tr_b16 a[192:193], v23 offset:49152
    ds_read_b64_tr_b16 a[194:195], v23 offset:50176
    ds_read_b64_tr_b16 a[196:197], v23 offset:49160
    ds_read_b64_tr_b16 a[198:199], v23 offset:50184
    ds_read_b64_tr_b16 a[200:201], v23 offset:57344
    ds_read_b64_tr_b16 a[202:203], v23 offset:58368
    ds_read_b64_tr_b16 a[204:205], v23 offset:57352
    ds_read_b64_tr_b16 a[206:207], v23 offset:58376
    s_waitcnt lgkmcnt(0)
    s_waitcnt vmcnt(8)
    s_barrier
    ds_read_b64_tr_b16 a[208:209], v24 offset:0
    ds_read_b64_tr_b16 a[210:211], v24 offset:1024
    ds_read_b64_tr_b16 a[212:213], v24 offset:8
    ds_read_b64_tr_b16 a[214:215], v24 offset:1032
    ds_read_b64_tr_b16 a[216:217], v24 offset:8192
    ds_read_b64_tr_b16 a[218:219], v24 offset:9216
    ds_read_b64_tr_b16 a[220:221], v24 offset:8200
    ds_read_b64_tr_b16 a[222:223], v24 offset:9224
    s_waitcnt lgkmcnt(0)
    s_waitcnt vmcnt(4)
    s_barrier
    ds_read_b64_tr_b16 a[224:225], v24 offset:16384
    ds_read_b64_tr_b16 a[226:227], v24 offset:17408
    ds_read_b64_tr_b16 a[228:229], v24 offset:16392
    ds_read_b64_tr_b16 a[230:231], v24 offset:17416
    ds_read_b64_tr_b16 a[232:233], v24 offset:24576
    ds_read_b64_tr_b16 a[234:235], v24 offset:25600
    ds_read_b64_tr_b16 a[236:237], v24 offset:24584
    ds_read_b64_tr_b16 a[238:239], v24 offset:25608
    s_waitcnt lgkmcnt(0)
    s_waitcnt vmcnt(0)
    s_barrier
    ds_read_b64_tr_b16 a[240:241], v24 offset:32768
    ds_read_b64_tr_b16 a[242:243], v24 offset:33792
    ds_read_b64_tr_b16 a[244:245], v24 offset:32776
    ds_read_b64_tr_b16 a[246:247], v24 offset:33800
    ds_read_b64_tr_b16 a[248:249], v24 offset:40960
    ds_read_b64_tr_b16 a[250:251], v24 offset:41984
    ds_read_b64_tr_b16 a[252:253], v24 offset:40968
    ds_read_b64_tr_b16 a[254:255], v24 offset:41992
    s_waitcnt lgkmcnt(0)
    s_barrier
    s_mov_b32 s60, 0
    s_mov_b32 s51, 1
    s_mov_b32 s71, 64
    s_mov_b32 s52, 0x400000
    s_lshl_b32 s56, s39, 19
    s_add_u32 s56, s56, 0x2000000
L_w_qkv_114:
    s_cmp_lg_u32 s44, 0
    s_cbranch_scc1 L_pd_115
    v_mov_b32 v29, s71
    s_mov_b32 s46, 96
    s_mov_b64 exec, 1
    s_mov_b32 s70, 0
L_wp_116:
    buffer_load_dword v31, v29, s[16:19], 0 offen sc1
    s_add_u32 s70, s70, 1
    s_cmp_ge_u32 s70, 0x200000
    s_cbranch_scc1 L_w_done_102
    s_waitcnt vmcnt(0)
    v_cmp_gt_u32 vcc, s46, v31
    s_nop 1
    s_cbranch_vccz L_wp_116_ok
    s_sleep 3
    s_branch L_wp_116
L_wp_116_ok:
    s_mov_b64 exec, -1
L_pd_115:
    s_barrier
    s_mov_b32 s50, s60
    s_mul_i32 s53, s50, 65536
    s_add_u32 s53, s53, s52
    s_lshl_b32 s54, s44, 13
    s_add_u32 s53, s53, s54
    s_mul_i32 s57, s50, 8192
    s_add_u32 s57, s57, s56
    s_lshl_b32 s45, s44, 11
    s_add_u32 s57, s57, s45
    s_add_u32 s55, s54, 65536
    s_mov_b32 s58, 0
    v_mov_b32 v13, v3
    v_add_u32 v14, 65536, v13
    v_xor_b32 v15, 64, v13
    v_xor_b32 v16, 64, v14
    s_mov_b32 s76, 0x20000000
    s_add_u32 s48, s53, 0
    s_add_u32 s49, s48, 4096
    s_add_u32 m0, s54, 0
    s_nop 0
    buffer_load_dwordx4 v6, s[12:15], s48 offen offset:0 sc1 lds
    s_add_u32 m0, s54, 1024
    s_nop 0
    buffer_load_dwordx4 v9, s[12:15], s48 offen offset:0 sc1 lds
    s_add_u32 m0, s54, 2048
    s_nop 0
    buffer_load_dwordx4 v6, s[12:15], s49 offen offset:0 sc1 lds
    s_add_u32 m0, s54, 3072
    s_nop 0
    buffer_load_dwordx4 v9, s[12:15], s49 offen offset:0 sc1 lds
    s_add_u32 m0, s54, 3968
    s_nop 0
    buffer_load_dwordx4 v6, s[12:15], s48 offen offset:128 sc1 lds
    s_add_u32 m0, s54, 4992
    s_nop 0
    buffer_load_dwordx4 v9, s[12:15], s48 offen offset:128 sc1 lds
    s_add_u32 m0, s54, 6016
    s_nop 0
    buffer_load_dwordx4 v6, s[12:15], s49 offen offset:128 sc1 lds
    s_add_u32 m0, s54, 7040
    s_nop 0
    buffer_load_dwordx4 v9, s[12:15], s49 offen offset:128 sc1 lds
    s_add_u32 s48, s53, 32768
    s_add_u32 s49, s48, 4096
    s_add_u32 s46, s54, 32768
    s_add_u32 m0, s46, 0
    s_nop 0
    buffer_load_dwordx4 v6, s[12:15], s48 offen offset:0 sc1 lds
    s_add_u32 m0, s46, 1024
    s_nop 0
    buffer_load_dwordx4 v9, s[12:15], s48 offen offset:0 sc1 lds
    s_add_u32 m0, s46, 2048
    s_nop 0
    buffer_load_dwordx4 v6, s[12:15], s49 offen offset:0 sc1 lds
    s_add_u32 m0, s46, 3072
    s_nop 0
    buffer_load_dwordx4 v9, s[12:15], s49 offen offset:0 sc1 lds
    s_add_u32 m0, s46, 3968
    s_nop 0
    buffer_load_dwordx4 v6, s[12:15], s48 offen offset:128 sc1 lds
    s_add_u32 m0, s46, 4992
    s_nop 0
    buffer_load_dwordx4 v9, s[12:15], s48 offen offset:128 sc1 lds
    s_add_u32 m0, s46, 6016
    s_nop 0
    buffer_load_dwordx4 v6, s[12:15], s49 offen offset:128 sc1 lds
    s_add_u32 m0, s46, 7040
    s_nop 0
    buffer_load_dwordx4 v9, s[12:15], s49 offen offset:128 sc1 lds
    s_cmp_eq_u32 s51, 1
    s_cbranch_scc1 L_e_one_118
    s_add_u32 s48, s53, 65536
    s_add_u32 s49, s48, 4096
    s_add_u32 m0, s55, 0
    s_nop 0
    buffer_load_dwordx4 v6, s[12:15], s48 offen offset:0 sc1 lds
    s_add_u32 m0, s55, 1024
    s_nop 0
    buffer_load_dwordx4 v9, s[12:15], s48 offen offset:0 sc1 lds
    s_add_u32 m0, s55, 2048
    s_nop 0
    buffer_load_dwordx4 v6, s[12:15], s49 offen offset:0 sc1 lds
    s_add_u32 m0, s55, 3072
    s_nop 0
    buffer_load_dwordx4 v9, s[12:15], s49 offen offset:0 sc1 lds
    s_add_u32 m0, s55, 3968
    s_nop 0
    buffer_load_dwordx4 v6, s[12:15], s48 offen offset:128 sc1 lds
    s_add_u32 m0, s55, 4992
    s_nop 0
    buffer_load_dwordx4 v9, s[12:15], s48 offen offset:128 sc1 lds
    s_add_u32 m0, s55, 6016
    s_nop 0
    buffer_load_dwordx4 v6, s[12:15], s49 offen offset:128 sc1 lds
    s_add_u32 m0, s55, 7040
    s_nop 0
    buffer_load_dwordx4 v9, s[12:15], s49 offen offset:128 sc1 lds
    s_waitcnt vmcnt(16)
    s_barrier
    ds_read_b128 v[32:35], v13 offset:0
    ds_read_b128 v[36:39], v13 offset:2048
    ds_read_b128 v[40:43], v15 offset:0
    ds_read_b128 v[44:47], v15 offset:2048
L_e_loop_117:
    s_add_u32 s48, s53, 98304
    s_add_u32 s46, s58, 1
    s_cmp_lt_u32 s46, s51
    s_cselect_b32 s48, s48, 0x20000000
    s_add_u32 s49, s48, 4096
    s_add_u32 s59, s55, 32768
    s_waitcnt lgkmcnt(2)
    v_mfma_f32_16x16x32_bf16 v[80:83], a[0:3], v[32:35], 0
    ds_read_b128 v[48:51], v13 offset:4096
    ds_read_b128 v[52:55], v13 offset:6144
    v_mfma_f32_16x16x32_bf16 v[84:87], a[4:7], v[32:35], 0
    ds_read_b128 v[56:59], v15 offset:4096
    ds_read_b128 v[60:63], v15 offset:6144
    v_mfma_f32_16x16x32_bf16 v[88:91], a[0:3], v[36:39], 0
    s_add_u32 m0, s59, 0
    s_nop 0
    buffer_load_dwordx4 v6, s[12:15], s48 offen offset:0 sc1 lds
    v_mfma_f32_16x16x32_bf16 v[92:95], a[4:7], v[36:39], 0
    s_waitcnt lgkmcnt(4)
    v_mfma_f32_16x16x32_bf16 v[80:83], a[8:11], v[40:43], v[80:83]
    ds_read_b128 v[32:35], v13 offset:8192
    ds_read_b128 v[36:39], v13 offset:10240
    v_mfma_f32_16x16x32_bf16 v[84:87], a[12:15], v[40:43], v[84:87]
    v_mfma_f32_16x16x32_bf16 v[88:91], a[8:11], v[44:47], v[88:91]
    s_add_u32 m0, s59, 1024
    s_nop 0
    buffer_load_dwordx4 v9, s[12:15], s48 offen offset:0 sc1 lds
    v_mfma_f32_16x16x32_bf16 v[92:95], a[12:15], v[44:47], v[92:95]
    s_waitcnt lgkmcnt(4)
    v_mfma_f32_16x16x32_bf16 v[80:83], a[16:19], v[48:51], v[80:83]
    ds_read_b128 v[40:43], v15 offset:8192
    ds_read_b128 v[44:47], v15 offset:10240
    v_mfma_f32_16x16x32_bf16 v[84:87], a[20:23], v[48:51], v[84:87]
    v_mfma_f32_16x16x32_bf16 v[88:91], a[16:19], v[52:55], v[88:91]
    s_add_u32 m0, s59, 2048
    s_nop 0
    buffer_load_dwordx4 v6, s[12:15], s49 offen offset:0 sc1 lds
    v_mfma_f32_16x16x32_bf16 v[92:95], a[20:23], v[52:55], v[92:95]
    s_waitcnt lgkmcnt(4)
    v_mfma_f32_16x16x32_bf16 v[80:83], a[24:27], v[56:59], v[80:83]
    ds_read_b128 v[48:51], v13 offset:12288
    ds_read_b128 v[52:55], v13 offset:14336
    v_mfma_f32_16x16x32_bf16 v[84:87], a[28:31], v[56:59], v[84:87]
    v_mfma_f32_16x16x32_bf16 v[88:91], a[24:27], v[60:63], v[88:91]
    s_add_u32 m0, s59, 3072
    s_nop 0
    buffer_load_dwordx4 v9, s[12:15], s49 offen offset:0 sc1 lds
    v_mfma_f32_16x16x32_bf16 v[92:95], a[28:31], v[60:63], v[92:95]
    s_waitcnt lgkmcnt(4)
    v_mfma_f32_16x16x32_bf16 v[80:83], a[32:35], v[32:35], v[80:83]
    ds_read_b128 v[56:59], v15 offset:12288
    ds_read_b128 v[60:63], v15 offset:14336
    v_mfma_f32_16x16x32_bf16 v[84:87], a[36:39], v[32:35], v[84:87]
    v_mfma_f32_16x16x32_bf16 v[88:91], a[32:35], v[36:39], v[88:91]
    s_add_u32 m0, s59, 3968
    s_nop 0
    buffer_load_dwordx4 v6, s[12:15], s48 offen offset:128 sc1 lds
    v_mfma_f32_16x16x32_bf16 v[92:95], a[36:39], v[36:39], v[92:95]
    s_waitcnt lgkmcnt(4)
    v_mfma_f32_16x16x32_bf16 v[80:83], a[40:43], v[40:43], v[80:83]
    ds_read_b128 v[32:35], v13 offset:16384
    ds_read_b128 v[36:39], v13 offset:18432
    v_mfma_f32_16x16x32_bf16 v[84:87], a[44:47], v[40:43], v[84:87]
    v_mfma_f32_16x16x32_bf16 v[88:91], a[40:43], v[44:47], v[88:91]
    s_add_u32 m0, s59, 4992
    s_nop 0
    buffer_load_dwordx4 v9, s[12:15], s48 offen offset:128 sc1 lds
    v_mfma_f32_16x16x32_bf16 v[92:95], a[44:47], v[44:47], v[92:95]
    s_waitcnt lgkmcnt(4)
    v_mfma_f32_16x16x32_bf16 v[80:83], a[48:51], v[48:51], v[80:83]
    ds_read_b128 v[40:43], v15 offset:16384
    ds_read_b128 v[44:47], v15 offset:18432
    v_mfma_f32_16x16x32_bf16 v[84:87], a[52:55], v[48:51], v[84:87]
    v_mfma_f32_16x16x32_bf16 v[88:91], a[48:51], v[52:55], v[88:91]
    s_add_u32 m0, s59, 6016
    s_nop 0
    buffer_load_dwordx4 v6, s[12:15], s49 offen offset:128 sc1 lds
    v_mfma_f32_16x16x32_bf16 v[92:95], a[52:55], v[52:55], v[92:95]
    s_waitcnt lgkmcnt(4)
    v_mfma_f32_16x16x32_bf16 v[80:83], a[56:59], v[56:59], v[80:83]
    ds_read_b128 v[48:51], v13 offset:20480
    ds_read_b128 v[52:55], v13 offset:22528
    v_mfma_f32_16x16x32_bf16 v[84:87], a[60:63], v[56:59], v[84:87]
    v_mfma_f32_16x16x32_bf16 v[88:91], a[56:59], v[60:63], v[88:91]
    s_add_u32 m0, s59, 7040
    s_nop 0
    buffer_load_dwordx4 v9, s[12:15], s49 offen offset:128 sc1 lds
    v_mfma_f32_16x16x32_bf16 v[92:95], a[60:63], v[60:63], v[92:95]
    s_waitcnt lgkmcnt(4)
    v_mfma_f32_16x16x32_bf16 v[80:83], a[64:67], v[32:35], v[80:83]
    ds_read_b128 v[56:59], v15 offset:20480
    ds_read_b128 v[60:63], v15 offset:22528
    v_mfma_f32_16x16x32_bf16 v[84:87], a[68:71], v[32:35], v[84:87]
    v_mfma_f32_16x16x32_bf16 v[88:91], a[64:67], v[36:39], v[88:91]
    v_mfma_f32_16x16x32_bf16 v[92:95], a[68:71], v[36:39], v[92:95]
    s_waitcnt lgkmcnt(4)
    v_mfma_f32_16x16x32_bf16 v[80:83], a[72:75], v[40:43], v[80:83]
    ds_read_b128 v[32:35], v13 offset:24576
    ds_read_b128 v[36:39], v13 offset:26624
    v_mfma_f32_16x16x32_bf16 v[84:87], a[76:79], v[40:43], v[84:87]
    v_mfma_f32_16x16x32_bf16 v[88:91], a[72:75], v[44:47], v[88:91]
    v_mfma_f32_16x16x32_bf16 v[92:95], a[76:79], v[44:47], v[92:95]
    s_waitcnt lgkmcnt(4)
    v_mfma_f32_16x16x32_bf16 v[80:83], a[80:83], v[48:51], v[80:83]
    ds_read_b128 v[40:43], v15 offset:24576
    ds_read_b128 v[44:47], v15 offset:26624
    v_mfma_f32_16x16x32_bf16 v[84:87], a[84:87], v[48:51], v[84:87]
    v_mfma_f32_16x16x32_bf16 v[88:91], a[80:83], v[52:55], v[88:91]
    v_mfma_f32_16x16x32_bf16 v[92:95], a[84:87], v[52:55], v[92:95]
    s_waitcnt lgkmcnt(4)
    v_mfma_f32_16x16x32_bf16 v[80:83], a[88:91], v[56:59], v[80:83]
    ds_read_b128 v[48:51], v13 offset:28672
    ds_read_b128 v[52:55], v13 offset:30720
    v_mfma_f32_16x16x32_bf16 v[84:87], a[92:95], v[56:59], v[84:87]
    v_mfma_f32_16x16x32_bf16 v[88:91], a[88:91], v[60:63], v[88:91]
    v_mfma_f32_16x16x32_bf16 v[92:95], a[92:95], v[60:63], v[92:95]
    s_waitcnt lgkmcnt(4)
    v_mfma_f32_16x16x32_bf16 v[80:83], a[96:99], v[32:35], v[80:83]
    ds_read_b128 v[56:59], v15 offset:28672
    ds_read_b128 v[60:63], v15 offset:30720
    v_mfma_f32_16x16x32_bf16 v[84:87], a[100:103], v[32:35], v[84:87]
    v_mfma_f32_16x16x32_bf16 v[88:91], a[96:99], v[36:39], v[88:91]
    v_mfma_f32_16x16x32_bf16 v[92:95], a[100:103], v[36:39], v[92:95]
    s_waitcnt lgkmcnt(4)
    v_mfma_f32_16x16x32_bf16 v[80:83], a[104:107], v[40:43], v[80:83]
    v_mfma_f32_16x16x32_bf16 v[84:87], a[108:111], v[40:43], v[84:87]
    v_mfma_f32_16x16x32_bf16 v[88:91], a[104:107], v[44:47], v[88:91]
    v_mfma_f32_16x16x32_bf16 v[92:95], a[108:111], v[44:47], v[92:95]
    s_waitcnt vmcnt(16) lgkmcnt(0)
    s_barrier
    v_mfma_f32_16x16x32_bf16 v[80:83], a[112:115], v[48:51], v[80:83]
    ds_read_b128 v[32:35], v13 offset:32768
    ds_read_b128 v[36:39], v13 offset:34816
    v_mfma_f32_16x16x32_bf16 v[84:87], a[116:119], v[48:51], v[84:87]
    v_mfma_f32_16x16x32_bf16 v[88:91], a[112:115], v[52:55], v[88:91]
    v_mfma_f32_16x16x32_bf16 v[92:95], a[116:119], v[52:55], v[92:95]
    v_mfma_f32_16x16x32_bf16 v[80:83], a[120:123], v[56:59], v[80:83]
    ds_read_b128 v[40:43], v15 offset:32768
    ds_read_b128 v[44:47], v15 offset:34816
    v_mfma_f32_16x16x32_bf16 v[84:87], a[124:127], v[56:59], v[84:87]
    v_mfma_f32_16x16x32_bf16 v[88:91], a[120:123], v[60:63], v[88:91]
    v_mfma_f32_16x16x32_bf16 v[92:95], a[124:127], v[60:63], v[92:95]
    s_add_u32 s48, s53, 131072
    s_add_u32 s46, s58, 2
    s_cmp_lt_u32 s46, s51
    s_cselect_b32 s48, s48, 0x20000000
    s_add_u32 s49, s48, 4096
    s_mov_b32 s59, s54
    s_waitcnt lgkmcnt(2)
    v_mfma_f32_16x16x32_bf16 v[80:83], a[128:131], v[32:35], v[80:83]
    ds_read_b128 v[48:51], v13 offset:36864
    ds_read_b128 v[52:55], v13 offset:38912
    v_mfma_f32_16x16x32_bf16 v[84:87], a[132:135], v[32:35], v[84:87]
    ds_read_b128 v[56:59], v15 offset:36864
    ds_read_b128 v[60:63], v15 offset:38912
    v_mfma_f32_16x16x32_bf16 v[88:91], a[128:131], v[36:39], v[88:91]
    s_add_u32 m0, s59, 0
    s_nop 0
    buffer_load_dwordx4 v6, s[12:15], s48 offen offset:0 sc1 lds
    v_mfma_f32_16x16x32_bf16 v[92:95], a[132:135], v[36:39], v[92:95]
    s_waitcnt lgkmcnt(4)
    v_mfma_f32_16x16x32_bf16 v[80:83], a[136:139], v[40:43], v[80:83]
    ds_read_b128 v[32:35], v13 offset:40960
    ds_read_b128 v[36:39], v13 offset:43008
    v_mfma_f32_16x16x32_bf16 v[84:87], a[140:143], v[40:43], v[84:87]
    v_mfma_f32_16x16x32_bf16 v[88:91], a[136:139], v[44:47], v[88:91]
    s_add_u32 m0, s59, 1024
    s_nop 0
    buffer_load_dwordx4 v9, s[12:15], s48 offen offset:0 sc1 lds
    v_mfma_f32_16x16x32_bf16 v[92:95], a[140:143], v[44:47], v[92:95]
    s_waitcnt lgkmcnt(4)
    v_mfma_f32_16x16x32_bf16 v[80:83], a[144:147], v[48:51], v[80:83]
    ds_read_b128 v[40:43], v15 offset:40960
    ds_read_b128 v[44:47], v15 offset:43008
    v_mfma_f32_16x16x32_bf16 v[84:87], a[148:151], v[48:51], v[84:87]
    v_mfma_f32_16x16x32_bf16 v[88:91], a[144:147], v[52:55], v[88:91]
    s_add_u32 m0, s59, 2048
    s_nop 0
    buffer_load_dwordx4 v6, s[12:15], s49 offen offset:0 sc1 lds
    v_mfma_f32_16x16x32_bf16 v[92:95], a[148:151], v[52:55], v[92:95]
    s_waitcnt lgkmcnt(4)
    v_mfma_f32_16x16x32_bf16 v[80:83], a[152:155], v[56:59], v[80:83]
    ds_read_b128 v[48:51], v13 offset:45056
    ds_read_b128 v[52:55], v13 offset:47104
    v_mfma_f32_16x16x32_bf16 v[84:87], a[156:159], v[56:59], v[84:87]
    v_mfma_f32_16x16x32_bf16 v[88:91], a[152:155], v[60:63], v[88:91]
    s_add_u32 m0, s59, 3072
    s_nop 0
    buffer_load_dwordx4 v9, s[12:15], s49 offen offset:0 sc1 lds
    v_mfma_f32_16x16x32_bf16 v[92:95], a[156:159], v[60:63], v[92:95]
    s_waitcnt lgkmcnt(4)
    v_mfma_f32_16x16x32_bf16 v[80:83], a[160:163], v[32:35], v[80:83]
    ds_read_b128 v[56:59], v15 offset:45056
    ds_read_b128 v[60:63], v15 offset:47104
    v_mfma_f32_16x16x32_bf16 v[84:87], a[164:167], v[32:35], v[84:87]
    v_mfma_f32_16x16x32_bf16 v[88:91], a[160:163], v[36:39], v[88:91]
    s_add_u32 m0, s59, 3968
    s_nop 0
    buffer_load_dwordx4 v6, s[12:15], s48 offen offset:128 sc1 lds
    v_mfma_f32_16x16x32_bf16 v[92:95], a[164:167], v[36:39], v[92:95]
    s_waitcnt lgkmcnt(4)
    v_mfma_f32_16x16x32_bf16 v[80:83], a[168:171], v[40:43], v[80:83]
    ds_read_b128 v[32:35], v13 offset:49152
    ds_read_b128 v[36:39], v13 offset:51200
    v_mfma_f32_16x16x32_bf16 v[84:87], a[172:175], v[40:43], v[84:87]
    v_mfma_f32_16x16x32_bf16 v[88:91], a[168:171], v[44:47], v[88:91]
    s_add_u32 m0, s59, 4992
    s_nop 0
    buffer_load_dwordx4 v9, s[12:15], s48 offen offset:128 sc1 lds
    v_mfma_f32_16x16x32_bf16 v[92:95], a[172:175], v[44:47], v[92:95]
    s_waitcnt lgkmcnt(4)
    v_mfma_f32_16x16x32_bf16 v[80:83], a[176:179], v[48:51], v[80:83]
    ds_read_b128 v[40:43], v15 offset:49152
    ds_read_b128 v[44:47], v15 offset:51200
    v_mfma_f32_16x16x32_bf16 v[84:87], a[180:183], v[48:51], v[84:87]
    v_mfma_f32_16x16x32_bf16 v[88:91], a[176:179], v[52:55], v[88:91]
    s_add_u32 m0, s59, 6016
    s_nop 0
    buffer_load_dwordx4 v6, s[12:15], s49 offen offset:128 sc1 lds
    v_mfma_f32_16x16x32_bf16 v[92:95], a[180:183], v[52:55], v[92:95]
    s_waitcnt lgkmcnt(4)
    v_mfma_f32_16x16x32_bf16 v[80:83], a[184:187], v[56:59], v[80:83]
    ds_read_b128 v[48:51], v13 offset:53248
    ds_read_b128 v[52:55], v13 offset:55296
    v_mfma_f32_16x16x32_bf16 v[84:87], a[188:191], v[56:59], v[84:87]
    v_mfma_f32_16x16x32_bf16 v[88:91], a[184:187], v[60:63], v[88:91]
    s_add_u32 m0, s59, 7040
    s_nop 0
    buffer_load_dwordx4 v9, s[12:15], s49 offen offset:128 sc1 lds
    v_mfma_f32_16x16x32_bf16 v[92:95], a[188:191], v[60:63], v[92:95]
    s_waitcnt lgkmcnt(4)
    v_mfma_f32_16x16x32_bf16 v[80:83], a[192:195], v[32:35], v[80:83]
    ds_read_b128 v[56:59], v15 offset:53248
    ds_read_b128 v[60:63], v15 offset:55296
    v_mfma_f32_16x16x32_bf16 v[84:87], a[196:199], v[32:35], v[84:87]
    v_mfma_f32_16x16x32_bf16 v[88:91], a[192:195], v[36:39], v[88:91]
    v_mfma_f32_16x16x32_bf16 v[92:95], a[196:199], v[36:39], v[92:95]
    s_waitcnt lgkmcnt(4)
    v_mfma_f32_16x16x32_bf16 v[80:83], a[200:203], v[40:43], v[80:83]
    ds_read_b128 v[32:35], v13 offset:57344
    ds_read_b128 v[36:39], v13 offset:59392
    v_mfma_f32_16x16x32_bf16 v[84:87], a[204:207], v[40:43], v[84:87]
    v_mfma_f32_16x16x32_bf16 v[88:91], a[200:203], v[44:47], v[88:91]
    v_mfma_f32_16x16x32_bf16 v[92:95], a[204:207], v[44:47], v[92:95]
    s_waitcnt lgkmcnt(4)
    v_mfma_f32_16x16x32_bf16 v[80:83], a[208:211], v[48:51], v[80:83]
    ds_read_b128 v[40:43], v15 offset:57344
    ds_read_b128 v[44:47], v15 offset:59392
    v_mfma_f32_16x16x32_bf16 v[84:87], a[212:215], v[48:51], v[84:87]
    v_mfma_f32_16x16x32_bf16 v[88:91], a[208:211], v[52:55], v[88:91]
    v_mfma_f32_16x16x32_bf16 v[92:95], a[212:215], v[52:55], v[92:95]
    s_waitcnt lgkmcnt(4)
    v_mfma_f32_16x16x32_bf16 v[80:83], a[216:219], v[56:59], v[80:83]
    ds_read_b128 v[48:51], v13 offset:61440
    ds_read_b128 v[52:55], v13 offset:63488
    v_mfma_f32_16x16x32_bf16 v[84:87], a[220:223], v[56:59], v[84:87]
    v_mfma_f32_16x16x32_bf16 v[88:91], a[216:219], v[60:63], v[88:91]
    v_mfma_f32_16x16x32_bf16 v[92:95], a[220:223], v[60:63], v[92:95]
    s_waitcnt lgkmcnt(4)
    v_mfma_f32_16x16x32_bf16 v[80:83], a[224:227], v[32:35], v[80:83]
    ds_read_b128 v[56:59], v15 offset:61440
    ds_read_b128 v[60:63], v15 offset:63488
    v_mfma_f32_16x16x32_bf16 v[84:87], a[228:231], v[32:35], v[84:87]
    v_mfma_f32_16x16x32_bf16 v[88:91], a[224:227], v[36:39], v[88:91]
    v_mfma_f32_16x16x32_bf16 v[92:95], a[228:231], v[36:39], v[92:95]
    s_waitcnt lgkmcnt(4)
    v_mfma_f32_16x16x32_bf16 v[80:83], a[232:235], v[40:43], v[80:83]
    v_mfma_f32_16x16x32_bf16 v[84:87], a[236:239], v[40:43], v[84:87]
    v_mfma_f32_16x16x32_bf16 v[88:91], a[232:235], v[44:47], v[88:91]
    v_mfma_f32_16x16x32_bf16 v[92:95], a[236:239], v[44:47], v[92:95]
    s_waitcnt vmcnt(16) lgkmcnt(0)
    s_barrier
    s_cmp_lg_u32 s44, 0
    s_cbranch_scc1 L_e_pr_120
    s_add_u32 s45, s58, s60
    v_mov_b32 v30, s45
    v_mov_b32 v31, 0
    s_mov_b64 exec, 1
    buffer_store_dword v30, v31, s[12:15], s61 offen sc1
    s_mov_b64 exec, -1
L_e_pr_120:
    v_mfma_f32_16x16x32_bf16 v[80:83], a[240:243], v[48:51], v[80:83]
    ds_read_b128 v[32:35], v14 offset:0
    ds_read_b128 v[36:39], v14 offset:2048
    v_mfma_f32_16x16x32_bf16 v[84:87], a[244:247], v[48:51], v[84:87]
    v_mfma_f32_16x16x32_bf16 v[88:91], a[240:243], v[52:55], v[88:91]
    v_mfma_f32_16x16x32_bf16 v[92:95], a[244:247], v[52:55], v[92:95]
    v_mfma_f32_16x16x32_bf16 v[80:83], a[248:251], v[56:59], v[80:83]
    ds_read_b128 v[40:43], v16 offset:0
    ds_read_b128 v[44:47], v16 offset:2048
    v_mfma_f32_16x16x32_bf16 v[84:87], a[252:255], v[56:59], v[84:87]
    v_mfma_f32_16x16x32_bf16 v[88:91], a[248:251], v[60:63], v[88:91]
    v_mfma_f32_16x16x32_bf16 v[92:95], a[252:255], v[60:63], v[92:95]
    s_add_u32 s53, s53, 65536
    s_add_u32 s58, s58, 1
    v_swap_b32 v13, v14
    s_xor_b32 s54, s54, 65536
    s_xor_b32 s55, s55, 65536
    s_mov_b32 s76, s57
    v_swap_b32 v15, v16
    s_add_u32 s57, s57, 8192
    v_cvt_pk_bf16_f32 v216, v80, v81
    v_cvt_pk_bf16_f32 v217, v82, v83
    v_cvt_pk_bf16_f32 v218, v84, v85
    v_cvt_pk_bf16_f32 v219, v86, v87
    v_cvt_pk_bf16_f32 v220, v88, v89
    v_cvt_pk_bf16_f32 v221, v90, v91
    v_cvt_pk_bf16_f32 v222, v92, v93
    v_cvt_pk_bf16_f32 v223, v94, v95
    buffer_store_dwordx4 v[216:219], v10, s[12:15], s76 offen sc1
    buffer_store_dwordx4 v[220:223], v10, s[12:15], s76 offen offset:1024 sc1
    s_cmp_lt_u32 s58, s51
    s_cbranch_scc1 L_e_loop_117
    s_branch L_e_fin_119
L_e_one_118:
    s_waitcnt vmcnt(8)
    s_barrier
    ds_read_b128 v[32:35], v13 offset:0
    ds_read_b128 v[36:39], v13 offset:2048
    ds_read_b128 v[40:43], v15 offset:0
    ds_read_b128 v[44:47], v15 offset:2048
    s_waitcnt lgkmcnt(2)
    v_mfma_f32_16x16x32_bf16 v[80:83], a[0:3], v[32:35], 0
    ds_read_b128 v[48:51], v13 offset:4096
    ds_read_b128 v[52:55], v13 offset:6144
    v_mfma_f32_16x16x32_bf16 v[84:87], a[4:7], v[32:35], 0
    ds_read_b128 v[56:59], v15 offset:4096
    ds_read_b128 v[60:63], v15 offset:6144
    v_mfma_f32_16x16x32_bf16 v[88:91], a[0:3], v[36:39], 0
    v_mfma_f32_16x16x32_bf16 v[92:95], a[4:7], v[36:39], 0
    s_waitcnt lgkmcnt(4)
    v_mfma_f32_16x16x32_bf16 v[80:83], a[8:11], v[40:43], v[80:83]
    ds_read_b128 v[32:35], v13 offset:8192
    ds_read_b128 v[36:39], v13 offset:10240
    v_mfma_f32_16x16x32_bf16 v[84:87], a[12:15], v[40:43], v[84:87]
    v_mfma_f32_16x16x32_bf16 v[88:91], a[8:11], v[44:47], v[88:91]
    v_mfma_f32_16x16x32_bf16 v[92:95], a[12:15], v[44:47], v[92:95]
    s_waitcnt lgkmcnt(4)
    v_mfma_f32_16x16x32_bf16 v[80:83], a[16:19], v[48:51], v[80:83]
    ds_read_b128 v[40:43], v15 offset:8192
    ds_read_b128 v[44:47], v15 offset:10240
    v_mfma_f32_16x16x32_bf16 v[84:87], a[20:23], v[48:51], v[84:87]
    v_mfma_f32_16x16x32_bf16 v[88:91], a[16:19], v[52:55], v[88:91]
    v_mfma_f32_16x16x32_bf16 v[92:95], a[20:23], v[52:55], v[92:95]
    s_waitcnt lgkmcnt(4)
    v_mfma_f32_16x16x32_bf16 v[80:83], a[24:27], v[56:59], v[80:83]
    ds_read_b128 v[48:51], v13 offset:12288
    ds_read_b128 v[52:55], v13 offset:14336
    v_mfma_f32_16x16x32_bf16 v[84:87], a[28:31], v[56:59], v[84:87]
    v_mfma_f32_16x16x32_bf16 v[88:91], a[24:27], v[60:63], v[88:91]
    v_mfma_f32_16x16x32_bf16 v[92:95], a[28:31], v[60:63], v[92:95]
    s_waitcnt lgkmcnt(4)
    v_mfma_f32_16x16x32_bf16 v[80:83], a[32:35], v[32:35], v[80:83]
    ds_read_b128 v[56:59], v15 offset:12288
    ds_read_b128 v[60:63], v15 offset:14336
    v_mfma_f32_16x16x32_bf16 v[84:87], a[36:39], v[32:35], v[84:87]
    v_mfma_f32_16x16x32_bf16 v[88:91], a[32:35], v[36:39], v[88:91]
    v_mfma_f32_16x16x32_bf16 v[92:95], a[36:39], v[36:39], v[92:95]
    s_waitcnt lgkmcnt(4)
    v_mfma_f32_16x16x32_bf16 v[80:83], a[40:43], v[40:43], v[80:83]
    ds_read_b128 v[32:35], v13 offset:16384
    ds_read_b128 v[36:39], v13 offset:18432
    v_mfma_f32_16x16x32_bf16 v[84:87], a[44:47], v[40:43], v[84:87]
    v_mfma_f32_16x16x32_bf16 v[88:91], a[40:43], v[44:47], v[88:91]
    v_mfma_f32_16x16x32_bf16 v[92:95], a[44:47], v[44:47], v[92:95]
    s_waitcnt lgkmcnt(4)
    v_mfma_f32_16x16x32_bf16 v[80:83], a[48:51], v[48:51], v[80:83]
    ds_read_b128 v[40:43], v15 offset:16384
    ds_read_b128 v[44:47], v15 offset:18432
    v_mfma_f32_16x16x32_bf16 v[84:87], a[52:55], v[48:51], v[84:87]
    v_mfma_f32_16x16x32_bf16 v[88:91], a[48:51], v[52:55], v[88:91]
    v_mfma_f32_16x16x32_bf16 v[92:95], a[52:55], v[52:55], v[92:95]
    s_waitcnt lgkmcnt(4)
    v_mfma_f32_16x16x32_bf16 v[80:83], a[56:59], v[56:59], v[80:83]
    ds_read_b128 v[48:51], v13 offset:20480
    ds_read_b128 v[52:55], v13 offset:22528
    v_mfma_f32_16x16x32_bf16 v[84:87], a[60:63], v[56:59], v[84:87]
    v_mfma_f32_16x16x32_bf16 v[88:91], a[56:59], v[60:63], v[88:91]
    v_mfma_f32_16x16x32_bf16 v[92:95], a[60:63], v[60:63], v[92:95]
    s_waitcnt lgkmcnt(4)
    v_mfma_f32_16x16x32_bf16 v[80:83], a[64:67], v[32:35], v[80:83]
    ds_read_b128 v[56:59], v15 offset:20480
    ds_read_b128 v[60:63], v15 offset:22528
    v_mfma_f32_16x16x32_bf16 v[84:87], a[68:71], v[32:35], v[84:87]
    v_mfma_f32_16x16x32_bf16 v[88:91], a[64:67], v[36:39], v[88:91]
    v_mfma_f32_16x16x32_bf16 v[92:95], a[68:71], v[36:39], v[92:95]
    s_waitcnt lgkmcnt(4)
    v_mfma_f32_16x16x32_bf16 v[80:83], a[72:75], v[40:43], v[80:83]
    ds_read_b128 v[32:35], v13 offset:24576
    ds_read_b128 v[36:39], v13 offset:26624
    v_mfma_f32_16x16x32_bf16 v[84:87], a[76:79], v[40:43], v[84:87]
    v_mfma_f32_16x16x32_bf16 v[88:91], a[72:75], v[44:47], v[88:91]
    v_mfma_f32_16x16x32_bf16 v[92:95], a[76:79], v[44:47], v[92:95]
    s_waitcnt lgkmcnt(4)
    v_mfma_f32_16x16x32_bf16 v[80:83], a[80:83], v[48:51], v[80:83]
    ds_read_b128 v[40:43], v15 offset:24576
    ds_read_b128 v[44:47], v15 offset:26624
    v_mfma_f32_16x16x32_bf16 v[84:87], a[84:87], v[48:51], v[84:87]
    v_mfma_f32_16x16x32_bf16 v[88:91], a[80:83], v[52:55], v[88:91]
    v_mfma_f32_16x16x32_bf16 v[92:95], a[84:87], v[52:55], v[92:95]
    s_waitcnt lgkmcnt(4)
    v_mfma_f32_16x16x32_bf16 v[80:83], a[88:91], v[56:59], v[80:83]
    ds_read_b128 v[48:51], v13 offset:28672
    ds_read_b128 v[52:55], v13 offset:30720
    v_mfma_f32_16x16x32_bf16 v[84:87], a[92:95], v[56:59], v[84:87]
    v_mfma_f32_16x16x32_bf16 v[88:91], a[88:91], v[60:63], v[88:91]
    v_mfma_f32_16x16x32_bf16 v[92:95], a[92:95], v[60:63], v[92:95]
    s_waitcnt lgkmcnt(4)
    v_mfma_f32_16x16x32_bf16 v[80:83], a[96:99], v[32:35], v[80:83]
    ds_read_b128 v[56:59], v15 offset:28672
    ds_read_b128 v[60:63], v15 offset:30720
    v_mfma_f32_16x16x32_bf16 v[84:87], a[100:103], v[32:35], v[84:87]
    v_mfma_f32_16x16x32_bf16 v[88:91], a[96:99], v[36:39], v[88:91]
    v_mfma_f32_16x16x32_bf16 v[92:95], a[100:103], v[36:39], v[92:95]
    s_waitcnt lgkmcnt(4)
    v_mfma_f32_16x16x32_bf16 v[80:83], a[104:107], v[40:43], v[80:83]
    v_mfma_f32_16x16x32_bf16 v[84:87], a[108:111], v[40:43], v[84:87]
    v_mfma_f32_16x16x32_bf16 v[88:91], a[104:107], v[44:47], v[88:91]
    v_mfma_f32_16x16x32_bf16 v[92:95], a[108:111], v[44:47], v[92:95]
    s_waitcnt vmcnt(0) lgkmcnt(0)
    s_barrier
    v_mfma_f32_16x16x32_bf16 v[80:83], a[112:115], v[48:51], v[80:83]
    ds_read_b128 v[32:35], v13 offset:32768
    ds_read_b128 v[36:39], v13 offset:34816
    v_mfma_f32_16x16x32_bf16 v[84:87], a[116:119], v[48:51], v[84:87]
    v_mfma_f32_16x16x32_bf16 v[88:91], a[112:115], v[52:55], v[88:91]
    v_mfma_f32_16x16x32_bf16 v[92:95], a[116:119], v[52:55], v[92:95]
    v_mfma_f32_16x16x32_bf16 v[80:83], a[120:123], v[56:59], v[80:83]
    ds_read_b128 v[40:43], v15 offset:32768
    ds_read_b128 v[44:47], v15 offset:34816
    v_mfma_f32_16x16x32_bf16 v[84:87], a[124:127], v[56:59], v[84:87]
    v_mfma_f32_16x16x32_bf16 v[88:91], a[120:123], v[60:63], v[88:91]
    v_mfma_f32_16x16x32_bf16 v[92:95], a[124:127], v[60:63], v[92:95]
    s_waitcnt lgkmcnt(2)
    v_mfma_f32_16x16x32_bf16 v[80:83], a[128:131], v[32:35], v[80:83]
    ds_read_b128 v[48:51], v13 offset:36864
    ds_read_b128 v[52:55], v13 offset:38912
    v_mfma_f32_16x16x32_bf16 v[84:87], a[132:135], v[32:35], v[84:87]
    ds_read_b128 v[56:59], v15 offset:36864
    ds_read_b128 v[60:63], v15 offset:38912
    v_mfma_f32_16x16x32_bf16 v[88:91], a[128:131], v[36:39], v[88:91]
    v_mfma_f32_16x16x32_bf16 v[92:95], a[132:135], v[36:39], v[92:95]
    s_waitcnt lgkmcnt(4)
    v_mfma_f32_16x16x32_bf16 v[80:83], a[136:139], v[40:43], v[80:83]
    ds_read_b128 v[32:35], v13 offset:40960
    ds_read_b128 v[36:39], v13 offset:43008
    v_mfma_f32_16x16x32_bf16 v[84:87], a[140:143], v[40:43], v[84:87]
    v_mfma_f32_16x16x32_bf16 v[88:91], a[136:139], v[44:47], v[88:91]
    v_mfma_f32_16x16x32_bf16 v[92:95], a[140:143], v[44:47], v[92:95]
    s_waitcnt lgkmcnt(4)
    v_mfma_f32_16x16x32_bf16 v[80:83], a[144:147], v[48:51], v[80:83]
    ds_read_b128 v[40:43], v15 offset:40960
    ds_read_b128 v[44:47], v15 offset:43008
    v_mfma_f32_16x16x32_bf16 v[84:87], a[148:151], v[48:51], v[84:87]
    v_mfma_f32_16x16x32_bf16 v[88:91], a[144:147], v[52:55], v[88:91]
    v_mfma_f32_16x16x32_bf16 v[92:95], a[148:151], v[52:55], v[92:95]
    s_waitcnt lgkmcnt(4)
    v_mfma_f32_16x16x32_bf16 v[80:83], a[152:155], v[56:59], v[80:83]
    ds_read_b128 v[48:51], v13 offset:45056
    ds_read_b128 v[52:55], v13 offset:47104
    v_mfma_f32_16x16x32_bf16 v[84:87], a[156:159], v[56:59], v[84:87]
    v_mfma_f32_16x16x32_bf16 v[88:91], a[152:155], v[60:63], v[88:91]
    v_mfma_f32_16x16x32_bf16 v[92:95], a[156:159], v[60:63], v[92:95]
    s_waitcnt lgkmcnt(4)
    v_mfma_f32_16x16x32_bf16 v[80:83], a[160:163], v[32:35], v[80:83]
    ds_read_b128 v[56:59], v15 offset:45056
    ds_read_b128 v[60:63], v15 offset:47104
    v_mfma_f32_16x16x32_bf16 v[84:87], a[164:167], v[32:35], v[84:87]
    v_mfma_f32_16x16x32_bf16 v[88:91], a[160:163], v[36:39], v[88:91]
    v_mfma_f32_16x16x32_bf16 v[92:95], a[164:167], v[36:39], v[92:95]
    s_waitcnt lgkmcnt(4)
    v_mfma_f32_16x16x32_bf16 v[80:83], a[168:171], v[40:43], v[80:83]
    ds_read_b128 v[32:35], v13 offset:49152
    ds_read_b128 v[36:39], v13 offset:51200
    v_mfma_f32_16x16x32_bf16 v[84:87], a[172:175], v[40:43], v[84:87]
    v_mfma_f32_16x16x32_bf16 v[88:91], a[168:171], v[44:47], v[88:91]
    v_mfma_f32_16x16x32_bf16 v[92:95], a[172:175], v[44:47], v[92:95]
    s_waitcnt lgkmcnt(4)
    v_mfma_f32_16x16x32_bf16 v[80:83], a[176:179], v[48:51], v[80:83]
    ds_read_b128 v[40:43], v15 offset:49152
    ds_read_b128 v[44:47], v15 offset:51200
    v_mfma_f32_16x16x32_bf16 v[84:87], a[180:183], v[48:51], v[84:87]
    v_mfma_f32_16x16x32_bf16 v[88:91], a[176:179], v[52:55], v[88:91]
    v_mfma_f32_16x16x32_bf16 v[92:95], a[180:183], v[52:55], v[92:95]
    s_waitcnt lgkmcnt(4)
    v_mfma_f32_16x16x32_bf16 v[80:83], a[184:187], v[56:59], v[80:83]
    ds_read_b128 v[48:51], v13 offset:53248
    ds_read_b128 v[52:55], v13 offset:55296
    v_mfma_f32_16x16x32_bf16 v[84:87], a[188:191], v[56:59], v[84:87]
    v_mfma_f32_16x16x32_bf16 v[88:91], a[184:187], v[60:63], v[88:91]
    v_mfma_f32_16x16x32_bf16 v[92:95], a[188:191], v[60:63], v[92:95]
    s_waitcnt lgkmcnt(4)
    v_mfma_f32_16x16x32_bf16 v[80:83], a[192:195], v[32:35], v[80:83]
    ds_read_b128 v[56:59], v15 offset:53248
    ds_read_b128 v[60:63], v15 offset:55296
    v_mfma_f32_16x16x32_bf16 v[84:87], a[196:199], v[32:35], v[84:87]
    v_mfma_f32_16x16x32_bf16 v[88:91], a[192:195], v[36:39], v[88:91]
    v_mfma_f32_16x16x32_bf16 v[92:95], a[196:199], v[36:39], v[92:95]
    s_waitcnt lgkmcnt(4)
    v_mfma_f32_16x16x32_bf16 v[80:83], a[200:203], v[40:43], v[80:83]
    ds_read_b128 v[32:35], v13 offset:57344
    ds_read_b128 v[36:39], v13 offset:59392
    v_mfma_f32_16x16x32_bf16 v[84:87], a[204:207], v[40:43], v[84:87]
    v_mfma_f32_16x16x32_bf16 v[88:91], a[200:203], v[44:47], v[88:91]
    v_mfma_f32_16x16x32_bf16 v[92:95], a[204:207], v[44:47], v[92:95]
    s_waitcnt lgkmcnt(4)
    v_mfma_f32_16x16x32_bf16 v[80:83], a[208:211], v[48:51], v[80:83]
    ds_read_b128 v[40:43], v15 offset:57344
    ds_read_b128 v[44:47], v15 offset:59392
    v_mfma_f32_16x16x32_bf16 v[84:87], a[212:215], v[48:51], v[84:87]
    v_mfma_f32_16x16x32_bf16 v[88:91], a[208:211], v[52:55], v[88:91]
    v_mfma_f32_16x16x32_bf16 v[92:95], a[212:215], v[52:55], v[92:95]
    s_waitcnt lgkmcnt(4)
    v_mfma_f32_16x16x32_bf16 v[80:83], a[216:219], v[56:59], v[80:83]
    ds_read_b128 v[48:51], v13 offset:61440
    ds_read_b128 v[52:55], v13 offset:63488
    v_mfma_f32_16x16x32_bf16 v[84:87], a[220:223], v[56:59], v[84:87]
    v_mfma_f32_16x16x32_bf16 v[88:91], a[216:219], v[60:63], v[88:91]
    v_mfma_f32_16x16x32_bf16 v[92:95], a[220:223], v[60:63], v[92:95]
    s_waitcnt lgkmcnt(4)
    v_mfma_f32_16x16x32_bf16 v[80:83], a[224:227], v[32:35], v[80:83]
    ds_read_b128 v[56:59], v15 offset:61440
    ds_read_b128 v[60:63], v15 offset:63488
    v_mfma_f32_16x16x32_bf16 v[84:87], a[228:231], v[32:35], v[84:87]
    v_mfma_f32_16x16x32_bf16 v[88:91], a[224:227], v[36:39], v[88:91]
    v_mfma_f32_16x16x32_bf16 v[92:95], a[228:231], v[36:39], v[92:95]
    s_waitcnt lgkmcnt(4)
    v_mfma_f32_16x16x32_bf16 v[80:83], a[232:235], v[40:43], v[80:83]
    v_mfma_f32_16x16x32_bf16 v[84:87], a[236:239], v[40:43], v[84:87]
    v_mfma_f32_16x16x32_bf16 v[88:91], a[232:235], v[44:47], v[88:91]
    v_mfma_f32_16x16x32_bf16 v[92:95], a[236:239], v[44:47], v[92:95]
    s_waitcnt lgkmcnt(0)
    v_mfma_f32_16x16x32_bf16 v[80:83], a[240:243], v[48:51], v[80:83]
    v_mfma_f32_16x16x32_bf16 v[84:87], a[244:247], v[48:51], v[84:87]
    v_mfma_f32_16x16x32_bf16 v[88:91], a[240:243], v[52:55], v[88:91]
    v_mfma_f32_16x16x32_bf16 v[92:95], a[244:247], v[52:55], v[92:95]
    v_mfma_f32_16x16x32_bf16 v[80:83], a[248:251], v[56:59], v[80:83]
    v_mfma_f32_16x16x32_bf16 v[84:87], a[252:255], v[56:59], v[84:87]
    v_mfma_f32_16x16x32_bf16 v[88:91], a[248:251], v[60:63], v[88:91]
    v_mfma_f32_16x16x32_bf16 v[92:95], a[252:255], v[60:63], v[92:95]
    s_mov_b32 s76, s57
    s_nop 6
    v_cvt_pk_bf16_f32 v216, v80, v81
    v_cvt_pk_bf16_f32 v217, v82, v83
    v_cvt_pk_bf16_f32 v218, v84, v85
    v_cvt_pk_bf16_f32 v219, v86, v87
    v_cvt_pk_bf16_f32 v220, v88, v89
    v_cvt_pk_bf16_f32 v221, v90, v91
    v_cvt_pk_bf16_f32 v222, v92, v93
    v_cvt_pk_bf16_f32 v223, v94, v95
    buffer_store_dwordx4 v[216:219], v10, s[12:15], s76 offen sc1
    buffer_store_dwordx4 v[220:223], v10, s[12:15], s76 offen offset:1024 sc1
L_e_fin_119:
    s_waitcnt lgkmcnt(0)
    s_add_u32 s60, s60, s51
    s_waitcnt vmcnt(0)
    s_barrier
    s_cmp_lg_u32 s44, 0
    s_cbranch_scc1 L_pub_121
    v_mov_b32 v30, s60
    v_mov_b32 v31, 0
    s_mov_b64 exec, 1
    buffer_store_dword v30, v31, s[12:15], s61 offen sc1
    s_mov_b64 exec, -1
L_pub_121:
    s_cmp_eq_u32 s60, 1
    s_cselect_b32 s51, 11, 52
    s_cselect_b32 s71, s71, 196
    s_cmp_lt_u32 s60, 64
    s_cbranch_scc1 L_w_qkv_114
L_w_roles_104:
    s_cmp_lg_u32 s44, 0
    s_cbranch_scc1 L_gj_122
    s_getreg_b32 s45, hwreg(HW_REG_XCC_ID)
    s_and_b32 s45, s45, 15
    s_mul_i32 s46, s45, s45
    s_lshl_b32 s46, s46, 9
    s_add_u32 s45, s45, s46
    s_add_u32 s45, s45, 16777216
    v_mov_b32 v30, s45
    s_lshl_b32 s45, s40, 2
    v_mov_b32 v31, 0
    s_mov_b64 exec, 1
    buffer_atomic_add v30, v31, s[16:19], s45 offen offset:200 sc1
    s_mov_b64 exec, -1
L_gj_122:
    s_mov_b32 s36, 0x1111111
    s_mov_b32 s37, 0x54884101
    s_cmp_eq_u32 s42, 0
    s_cselect_b32 s36, s36, 0x10000000
    s_cselect_b32 s37, s37, 0xaa220810
    s_mov_b32 s72, 0x88888888
    s_mov_b32 s73, 0xff552488
    s_lshr_b32 s38, s41, 3
    s_and_b32 s68, s41, 7
    s_cmp_eq_u32 s43, 1
    s_cbranch_scc1 L_role_b_123
    s_cmp_eq_u32 s43, 2
    s_cbranch_scc1 L_role_c_124
    s_load_dwordx2 s[6:7], s[0:1], 40
    s_waitcnt lgkmcnt(0)
    s_mov_b32 s24, s6
    s_and_b32 s25, s7, 0xffff
    s_mov_b32 s26, 0x800000
    s_mov_b32 s27, 0x00020000
    s_lshl_b32 s46, s38, 21
    s_lshl_b32 s45, s68, 8
    s_add_u32 s46, s46, s45
    s_waitcnt vmcnt(0)
    s_barrier
    v_lshrrev_b32 v20, 4, v1
    s_lshl_b32 s45, s44, 2
    v_add_u32 v21, s45, v20
    s_mov_b32 s45, 2048
    v_mul_lo_u32 v21, v21, s45
    v_lshlrev_b32 v22, 2, v20
    v_and_b32 v23, 15, v1
    v_xor_b32 v22, v22, v23
    v_lshlrev_b32 v22, 4, v22
    v_add_u32 v21, v21, v22
    v_bfe_u32 v22, v1, 2, 2
    v_lshlrev_b32 v23, 2, v20
    v_add_u32 v23, v23, v22
    v_lshlrev_b32 v23, 8, v23
    v_xor_b32 v22, s44, v22
    v_lshlrev_b32 v22, 6, v22
    v_add_u32 v23, v23, v22
    v_and_b32 v22, 3, v1
    v_lshlrev_b32 v22, 3, v22
    v_add_u32 v23, v23, v22
    v_add_u32 v24, 65536, v23
    v_add_u32 v25, 131072, v23
    s_lshl_b32 s47, s44, 10
    s_add_u32 s45, s46, 0x0
    s_add_u32 m0, s47, 0
    s_nop 0
    buffer_load_dwordx4 v21, s[24:27], s45 offen  lds
    s_add_u32 s45, s46, 0x8000
    s_add_u32 m0, s47, 4096
    s_nop 0
    buffer_load_dwordx4 v21, s[24:27], s45 offen  lds
    s_add_u32 s45, s46, 0x10000
    s_add_u32 m0, s47, 8192
    s_nop 0
    buffer_load_dwordx4 v21, s[24:27], s45 offen  lds
    s_add_u32 s45, s46, 0x18000
    s_add_u32 m0, s47, 12288
    s_nop 0
    buffer_load_dwordx4 v21, s[24:27], s45 offen  lds
    s_add_u32 s45, s46, 0x20000
    s_add_u32 m0, s47, 16384
    s_nop 0
    buffer_load_dwordx4 v21, s[24:27], s45 offen  lds
    s_add_u32 s45, s46, 0x28000
    s_add_u32 m0, s47, 20480
    s_nop 0
    buffer_load_dwordx4 v21, s[24:27], s45 offen  lds
    s_add_u32 s45, s46, 0x30000
    s_add_u32 m0, s47, 24576
    s_nop 0
    buffer_load_dwordx4 v21, s[24:27], s45 offen  lds
    s_add_u32 s45, s46, 0x38000
    s_add_u32 m0, s47, 28672
    s_nop 0
    buffer_load_dwordx4 v21, s[24:27], s45 offen  lds
    s_add_u32 s45, s46, 0x40000
    s_add_u32 m0, s47, 32768
    s_nop 0
    buffer_load_dwordx4 v21, s[24:27], s45 offen  lds
    s_add_u32 s45, s46, 0x48000
    s_add_u32 m0, s47, 36864
    s_nop 0
    buffer_load_dwordx4 v21, s[24:27], s45 offen  lds
    s_add_u32 s45, s46, 0x50000
    s_add_u32 m0, s47, 40960
    s_nop 0
    buffer_load_dwordx4 v21, s[24:27], s45 offen  lds
    s_add_u32 s45, s46, 0x58000
    s_add_u32 m0, s47, 45056
    s_nop 0
    buffer_load_dwordx4 v21, s[24:27], s45 offen  lds
    s_add_u32 s45, s46, 0x60000
    s_add_u32 m0, s47, 49152
    s_nop 0
    buffer_load_dwordx4 v21, s[24:27], s45 offen  lds
    s_add_u32 s45, s46, 0x68000
    s_add_u32 m0, s47, 53248
    s_nop 0
    buffer_load_dwordx4 v21, s[24:27], s45 offen  lds
    s_add_u32 s45, s46, 0x70000
    s_add_u32 m0, s47, 57344
    s_nop 0
    buffer_load_dwordx4 v21, s[24:27], s45 offen  lds
    s_add_u32 s45, s46, 0x78000
    s_add_u32 m0, s47, 61440
    s_nop 0
    buffer_load_dwordx4 v21, s[24:27], s45 offen  lds
    s_add_u32 s45, s46, 0x80000
    s_add_u32 m0, s47, 65536
    s_nop 0
    buffer_load_dwordx4 v21, s[24:27], s45 offen  lds
    s_add_u32 s45, s46, 0x88000
    s_add_u32 m0, s47, 69632
    s_nop 0
    buffer_load_dwordx4 v21, s[24:27], s45 offen  lds
    s_add_u32 s45, s46, 0x90000
    s_add_u32 m0, s47, 73728
    s_nop 0
    buffer_load_dwordx4 v21, s[24:27], s45 offen  lds
    s_add_u32 s45, s46, 0x98000
    s_add_u32 m0, s47, 77824
    s_nop 0
    buffer_load_dwordx4 v21, s[24:27], s45 offen  lds
    s_add_u32 s45, s46, 0xa0000
    s_add_u32 m0, s47, 81920
    s_nop 0
    buffer_load_dwordx4 v21, s[24:27], s45 offen  lds
    s_add_u32 s45, s46, 0xa8000
    s_add_u32 m0, s47, 86016
    s_nop 0
    buffer_load_dwordx4 v21, s[24:27], s45 offen  lds
    s_add_u32 s45, s46, 0xb0000
    s_add_u32 m0, s47, 90112
    s_nop 0
    buffer_load_dwordx4 v21, s[24:27], s45 offen  lds
    s_add_u32 s45, s46, 0xb8000
    s_add_u32 m0, s47, 94208
    s_nop 0
    buffer_load_dwordx4 v21, s[24:27], s45 offen  lds
    s_add_u32 s45, s46, 0xc0000
    s_add_u32 m0, s47, 98304
    s_nop 0
    buffer_load_dwordx4 v21, s[24:27], s45 offen  lds
    s_add_u32 s45, s46, 0xc8000
    s_add_u32 m0, s47, 102400
    s_nop 0
    buffer_load_dwordx4 v21, s[24:27], s45 offen  lds
    s_add_u32 s45, s46, 0xd0000
    s_add_u32 m0, s47, 106496
    s_nop 0
    buffer_load_dwordx4 v21, s[24:27], s45 offen  lds
    s_add_u32 s45, s46, 0xd8000
    s_add_u32 m0, s47, 110592
    s_nop 0
    buffer_load_dwordx4 v21, s[24:27], s45 offen  lds
    s_add_u32 s45, s46, 0xe0000
    s_add_u32 m0, s47, 114688
    s_nop 0
    buffer_load_dwordx4 v21, s[24:27], s45 offen  lds
    s_add_u32 s45, s46, 0xe8000
    s_add_u32 m0, s47, 118784
    s_nop 0
    buffer_load_dwordx4 v21, s[24:27], s45 offen  lds
    s_add_u32 s45, s46, 0xf0000
    s_add_u32 m0, s47, 122880
    s_nop 0
    buffer_load_dwordx4 v21, s[24:27], s45 offen  lds
    s_add_u32 s45, s46, 0xf8000
    s_add_u32 m0, s47, 126976
    s_nop 0
    buffer_load_dwordx4 v21, s[24:27], s45 offen  lds
    s_waitcnt vmcnt(28)
    s_barrier
    s_add_u32 s45, s46, 0x100000
    s_add_u32 m0, s47, 131072
    s_nop 0
    buffer_load_dwordx4 v21, s[24:27], s45 offen  lds
    s_add_u32 s45, s46, 0x108000
    s_add_u32 m0, s47, 135168
    s_nop 0
    buffer_load_dwordx4 v21, s[24:27], s45 offen  lds
    s_add_u32 s45, s46, 0x110000
    s_add_u32 m0, s47, 139264
    s_nop 0
    buffer_load_dwordx4 v21, s[24:27], s45 offen  lds
    s_add_u32 s45, s46, 0x118000
    s_add_u32 m0, s47, 143360
    s_nop 0
    buffer_load_dwordx4 v21, s[24:27], s45 offen  lds
    ds_read_b64_tr_b16 a[0:1], v23 offset:0
    ds_read_b64_tr_b16 a[2:3], v23 offset:4096
    ds_read_b64_tr_b16 a[4:5], v23 offset:32
    ds_read_b64_tr_b16 a[6:7], v23 offset:4128
    ds_read_b64_tr_b16 a[8:9], v23 offset:8192
    ds_read_b64_tr_b16 a[10:11], v23 offset:12288
    ds_read_b64_tr_b16 a[12:13], v23 offset:8224
    ds_read_b64_tr_b16 a[14:15], v23 offset:12320
    s_waitcnt lgkmcnt(0)
    s_waitcnt vmcnt(28)
    s_barrier
    s_add_u32 s45, s46, 0x120000
    s_add_u32 m0, s47, 0
    s_nop 0
    buffer_load_dwordx4 v21, s[24:27], s45 offen  lds
    s_add_u32 s45, s46, 0x128000
    s_add_u32 m0, s47, 4096
    s_nop 0
    buffer_load_dwordx4 v21, s[24:27], s45 offen  lds
    s_add_u32 s45, s46, 0x130000
    s_add_u32 m0, s47, 8192
    s_nop 0
    buffer_load_dwordx4 v21, s[24:27], s45 offen  lds
    s_add_u32 s45, s46, 0x138000
    s_add_u32 m0, s47, 12288
    s_nop 0
    buffer_load_dwordx4 v21, s[24:27], s45 offen  lds
    ds_read_b64_tr_b16 a[16:17], v23 offset:16384
    ds_read_b64_tr_b16 a[18:19], v23 offset:20480
    ds_read_b64_tr_b16 a[20:21], v23 offset:16416
    ds_read_b64_tr_b16 a[22:23], v23 offset:20512
    ds_read_b64_tr_b16 a[24:25], v23 offset:24576
    ds_read_b64_tr_b16 a[26:27], v23 offset:28672
    ds_read_b64_tr_b16 a[28:29], v23 offset:24608
    ds_read_b64_tr_b16 a[30:31], v23 offset:28704
    s_waitcnt lgkmcnt(0)
    s_waitcnt vmcnt(28)
    s_barrier
    s_add_u32 s45, s46, 0x140000
    s_add_u32 m0, s47, 16384
    s_nop 0
    buffer_load_dwordx4 v21, s[24:27], s45 offen  lds
    s_add_u32 s45, s46, 0x148000
    s_add_u32 m0, s47, 20480
    s_nop 0
    buffer_load_dwordx4 v21, s[24:27], s45 offen  lds
    s_add_u32 s45, s46, 0x150000
    s_add_u32 m0, s47, 24576
    s_nop 0
    buffer_load_dwordx4 v21, s[24:27], s45 offen  lds
    s_add_u32 s45, s46, 0x158000
    s_add_u32 m0, s47, 28672
    s_nop 0
    buffer_load_dwordx4 v21, s[24:27], s45 offen  lds
    ds_read_b64_tr_b16 a[32:33], v23 offset:32768
    ds_read_b64_tr_b16 a[34:35], v23 offset:36864
    ds_read_b64_tr_b16 a[36:37], v23 offset:32800
    ds_read_b64_tr_b16 a[38:39], v23 offset:36896
    ds_read_b64_tr_b16 a[40:41], v23 offset:40960
    ds_read_b64_tr_b16 a[42:43], v23 offset:45056
    ds_read_b64_tr_b16 a[44:45], v23 offset:40992
    ds_read_b64_tr_b16 a[46:47], v23 offset:45088
    s_waitcnt lgkmcnt(0)
    s_waitcnt vmcnt(28)
    s_barrier
    s_add_u32 s45, s46, 0x160000
    s_add_u32 m0, s47, 32768
    s_nop 0
    buffer_load_dwordx4 v21, s[24:27], s45 offen  lds
    s_add_u32 s45, s46, 0x168000
    s_add_u32 m0, s47, 36864
    s_nop 0
    buffer_load_dwordx4 v21, s[24:27], s45 offen  lds
    s_add_u32 s45, s46, 0x170000
    s_add_u32 m0, s47, 40960
    s_nop 0
    buffer_load_dwordx4 v21, s[24:27], s45 offen  lds
    s_add_u32 s45, s46, 0x178000
    s_add_u32 m0, s47, 45056
    s_nop 0
    buffer_load_dwordx4 v21, s[24:27], s45 offen  lds
    ds_read_b64_tr_b16 a[48:49], v23 offset:49152
    ds_read_b64_tr_b16 a[50:51], v23 offset:53248
    ds_read_b64_tr_b16 a[52:53], v23 offset:49184
    ds_read_b64_tr_b16 a[54:55], v23 offset:53280
    ds_read_b64_tr_b16 a[56:57], v23 offset:57344
    ds_read_b64_tr_b16 a[58:59], v23 offset:61440
    ds_read_b64_tr_b16 a[60:61], v23 offset:57376
    ds_read_b64_tr_b16 a[62:63], v23 offset:61472
    s_waitcnt lgkmcnt(0)
    s_waitcnt vmcnt(28)
    s_barrier
    s_add_u32 s45, s46, 0x180000
    s_add_u32 m0, s47, 49152
    s_nop 0
    buffer_load_dwordx4 v21, s[24:27], s45 offen  lds
    s_add_u32 s45, s46, 0x188000
    s_add_u32 m0, s47, 53248
    s_nop 0
    buffer_load_dwordx4 v21, s[24:27], s45 offen  lds
    s_add_u32 s45, s46, 0x190000
    s_add_u32 m0, s47, 57344
    s_nop 0
    buffer_load_dwordx4 v21, s[24:27], s45 offen  lds
    s_add_u32 s45, s46, 0x198000
    s_add_u32 m0, s47, 61440
    s_nop 0
    buffer_load_dwordx4 v21, s[24:27], s45 offen  lds
    ds_read_b64_tr_b16 a[64:65], v24 offset:0
    ds_read_b64_tr_b16 a[66:67], v24 offset:4096
    ds_read_b64_tr_b16 a[68:69], v24 offset:32
    ds_read_b64_tr_b16 a[70:71], v24 offset:4128
    ds_read_b64_tr_b16 a[72:73], v24 offset:8192
    ds_read_b64_tr_b16 a[74:75], v24 offset:12288
    ds_read_b64_tr_b16 a[76:77], v24 offset:8224
    ds_read_b64_tr_b16 a[78:79], v24 offset:12320
    s_waitcnt lgkmcnt(0)
    s_waitcnt vmcnt(28)
    s_barrier
    s_add_u32 s45, s46, 0x1a0000
    s_add_u32 m0, s47, 65536
    s_nop 0
    buffer_load_dwordx4 v21, s[24:27], s45 offen  lds
    s_add_u32 s45, s46, 0x1a8000
    s_add_u32 m0, s47, 69632
    s_nop 0
    buffer_load_dwordx4 v21, s[24:27], s45 offen  lds
    s_add_u32 s45, s46, 0x1b0000
    s_add_u32 m0, s47, 73728
    s_nop 0
    buffer_load_dwordx4 v21, s[24:27], s45 offen  lds
    s_add_u32 s45, s46, 0x1b8000
    s_add_u32 m0, s47, 77824
    s_nop 0
    buffer_load_dwordx4 v21, s[24:27], s45 offen  lds
    ds_read_b64_tr_b16 a[80:81], v24 offset:16384
    ds_read_b64_tr_b16 a[82:83], v24 offset:20480
    ds_read_b64_tr_b16 a[84:85], v24 offset:16416
    ds_read_b64_tr_b16 a[86:87], v24 offset:20512
    ds_read_b64_tr_b16 a[88:89], v24 offset:24576
    ds_read_b64_tr_b16 a[90:91], v24 offset:28672
    ds_read_b64_tr_b16 a[92:93], v24 offset:24608
    ds_read_b64_tr_b16 a[94:95], v24 offset:28704
    s_waitcnt lgkmcnt(0)
    s_waitcnt vmcnt(28)
    s_barrier
    s_add_u32 s45, s46, 0x1c0000
    s_add_u32 m0, s47, 81920
    s_nop 0
    buffer_load_dwordx4 v21, s[24:27], s45 offen  lds
    s_add_u32 s45, s46, 0x1c8000
    s_add_u32 m0, s47, 86016
    s_nop 0
    buffer_load_dwordx4 v21, s[24:27], s45 offen  lds
    s_add_u32 s45, s46, 0x1d0000
    s_add_u32 m0, s47, 90112
    s_nop 0
    buffer_load_dwordx4 v21, s[24:27], s45 offen  lds
    s_add_u32 s45, s46, 0x1d8000
    s_add_u32 m0, s47, 94208
    s_nop 0
    buffer_load_dwordx4 v21, s[24:27], s45 offen  lds
    ds_read_b64_tr_b16 a[96:97], v24 offset:32768
    ds_read_b64_tr_b16 a[98:99], v24 offset:36864
    ds_read_b64_tr_b16 a[100:101], v24 offset:32800
    ds_read_b64_tr_b16 a[102:103], v24 offset:36896
    ds_read_b64_tr_b16 a[104:105], v24 offset:40960
    ds_read_b64_tr_b16 a[106:107], v24 offset:45056
    ds_read_b64_tr_b16 a[108:109], v24 offset:40992
    ds_read_b64_tr_b16 a[110:111], v24 offset:45088
    s_waitcnt lgkmcnt(0)
    s_waitcnt vmcnt(28)
    s_barrier
    s_add_u32 s45, s46, 0x1e0000
    s_add_u32 m0, s47, 98304
    s_nop 0
    buffer_load_dwordx4 v21, s[24:27], s45 offen  lds
    s_add_u32 s45, s46, 0x1e8000
    s_add_u32 m0, s47, 102400
    s_nop 0
    buffer_load_dwordx4 v21, s[24:27], s45 offen  lds
    s_add_u32 s45, s46, 0x1f0000
    s_add_u32 m0, s47, 106496
    s_nop 0
    buffer_load_dwordx4 v21, s[24:27], s45 offen  lds
    s_add_u32 s45, s46, 0x1f8000
    s_add_u32 m0, s47, 110592
    s_nop 0
    buffer_load_dwordx4 v21, s[24:27], s45 offen  lds
    ds_read_b64_tr_b16 a[112:113], v24 offset:49152
    ds_read_b64_tr_b16 a[114:115], v24 offset:53248
    ds_read_b64_tr_b16 a[116:117], v24 offset:49184
    ds_read_b64_tr_b16 a[118:119], v24 offset:53280
    ds_read_b64_tr_b16 a[120:121], v24 offset:57344
    ds_read_b64_tr_b16 a[122:123], v24 offset:61440
    ds_read_b64_tr_b16 a[124:125], v24 offset:57376
    ds_read_b64_tr_b16 a[126:127], v24 offset:61472
    s_waitcnt lgkmcnt(0)
    s_waitcnt vmcnt(28)
    s_barrier
    ds_read_b64_tr_b16 a[128:129], v25 offset:0
    ds_read_b64_tr_b16 a[130:131], v25 offset:4096
    ds_read_b64_tr_b16 a[132:133], v25 offset:32
    ds_read_b64_tr_b16 a[134:135], v25 offset:4128
    ds_read_b64_tr_b16 a[136:137], v25 offset:8192
    ds_read_b64_tr_b16 a[138:139], v25 offset:12288
    ds_read_b64_tr_b16 a[140:141], v25 offset:8224
    ds_read_b64_tr_b16 a[142:143], v25 offset:12320
    s_waitcnt lgkmcnt(0)
    s_waitcnt vmcnt(24)
    s_barrier
    ds_read_b64_tr_b16 a[144:145], v23 offset:0
    ds_read_b64_tr_b16 a[146:147], v23 offset:4096
    ds_read_b64_tr_b16 a[148:149], v23 offset:32
    ds_read_b64_tr_b16 a[150:151], v23 offset:4128
    ds_read_b64_tr_b16 a[152:153], v23 offset:8192
    ds_read_b64_tr_b16 a[154:155], v23 offset:12288
    ds_read_b64_tr_b16 a[156:157], v23 offset:8224
    ds_read_b64_tr_b16 a[158:159], v23 offset:12320
    s_waitcnt lgkmcnt(0)
    s_waitcnt vmcnt(20)
    s_barrier
    ds_read_b64_tr_b16 a[160:161], v23 offset:16384
    ds_read_b64_tr_b16 a[162:163], v23 offset:20480
    ds_read_b64_tr_b16 a[164:165], v23 offset:16416
    ds_read_b64_tr_b16 a[166:167], v23 offset:20512
    ds_read_b64_tr_b16 a[168:169], v23 offset:24576
    ds_read_b64_tr_b16 a[170:171], v23 offset:28672
    ds_read_b64_tr_b16 a[172:173], v23 offset:24608
    ds_read_b64_tr_b16 a[174:175], v23 offset:28704
    s_waitcnt lgkmcnt(0)
    s_waitcnt vmcnt(16)
    s_barrier
    ds_read_b64_tr_b16 a[176:177], v23 offset:32768
    ds_read_b64_tr_b16 a[178:179], v23 offset:36864
    ds_read_b64_tr_b16 a[180:181], v23 offset:32800
    ds_read_b64_tr_b16 a[182:183], v23 offset:36896
    ds_read_b64_tr_b16 a[184:185], v23 offset:40960
    ds_read_b64_tr_b16 a[186:187], v23 offset:45056
    ds_read_b64_tr_b16 a[188:189], v23 offset:40992
    ds_read_b64_tr_b16 a[190:191], v23 offset:45088
    s_waitcnt lgkmcnt(0)
    s_waitcnt vmcnt(12)
    s_barrier
    ds_read_b64_tr_b16 a[192:193], v23 offset:49152
    ds_read_b64_tr_b16 a[194:195], v23 offset:53248
    ds_read_b64_tr_b16 a[196:197], v23 offset:49184
    ds_read_b64_tr_b16 a[198:199], v23 offset:53280
    ds_read_b64_tr_b16 a[200:201], v23 offset:57344
    ds_read_b64_tr_b16 a[202:203], v23 offset:61440
    ds_read_b64_tr_b16 a[204:205], v23 offset:57376
    ds_read_b64_tr_b16 a[206:207], v23 offset:61472
    s_waitcnt lgkmcnt(0)
    s_waitcnt vmcnt(8)
    s_barrier
    ds_read_b64_tr_b16 a[208:209], v24 offset:0
    ds_read_b64_tr_b16 a[210:211], v24 offset:4096
    ds_read_b64_tr_b16 a[212:213], v24 offset:32
    ds_read_b64_tr_b16 a[214:215], v24 offset:4128
    ds_read_b64_tr_b16 a[216:217], v24 offset:8192
    ds_read_b64_tr_b16 a[218:219], v24 offset:12288
    ds_read_b64_tr_b16 a[220:221], v24 offset:8224
    ds_read_b64_tr_b16 a[222:223], v24 offset:12320
    s_waitcnt lgkmcnt(0)
    s_waitcnt vmcnt(4)
    s_barrier
    ds_read_b64_tr_b16 a[224:225], v24 offset:16384
    ds_read_b64_tr_b16 a[226:227], v24 offset:20480
    ds_read_b64_tr_b16 a[228:229], v24 offset:16416
    ds_read_b64_tr_b16 a[230:231], v24 offset:20512
    ds_read_b64_tr_b16 a[232:233], v24 offset:24576
    ds_read_b64_tr_b16 a[234:235], v24 offset:28672
    ds_read_b64_tr_b16 a[236:237], v24 offset:24608
    ds_read_b64_tr_b16 a[238:239], v24 offset:28704
    s_waitcnt lgkmcnt(0)
    s_waitcnt vmcnt(0)
    s_barrier
    ds_read_b64_tr_b16 a[240:241], v24 offset:32768
    ds_read_b64_tr_b16 a[242:243], v24 offset:36864
    ds_read_b64_tr_b16 a[244:245], v24 offset:32800
    ds_read_b64_tr_b16 a[246:247], v24 offset:36896
    ds_read_b64_tr_b16 a[248:249], v24 offset:40960
    ds_read_b64_tr_b16 a[250:251], v24 offset:45056
    ds_read_b64_tr_b16 a[252:253], v24 offset:40992
    ds_read_b64_tr_b16 a[254:255], v24 offset:45088
    s_waitcnt lgkmcnt(0)
    s_barrier
    s_lshl_b32 s52, s38, 16
    s_add_u32 s52, s52, 0x5000000
    s_lshl_b32 s56, s38, 23
    s_lshl_b32 s45, s68, 9
    s_add_u32 s56, s56, s45
    s_add_u32 s56, s56, 0x8000000
    s_cmp_lg_u32 s44, 0
    s_cbranch_scc1 L_pd_125
    v_mov_b32 v29, 4
    s_mov_b32 s46, 1073741824
    s_mov_b64 exec, 1
    s_mov_b32 s70, 0
L_wp_126:
    buffer_load_dword v31, v29, s[16:19], 0 offen sc1
    s_add_u32 s70, s70, 1
    s_cmp_ge_u32 s70, 0x200000
    s_cbranch_scc1 L_w_done_102
    s_waitcnt vmcnt(0)
    v_cmp_gt_u32 vcc, s46, v31
    s_nop 1
    s_cbranch_vccz L_wp_126_ok
    s_sleep 3
    s_branch L_wp_126
L_wp_126_ok:
    s_mov_b64 exec, -1
L_pd_125:
    s_barrier
    s_lshl_b32 s45, s40, 2
    s_add_u32 s45, s45, 200
    v_mov_b32 v29, s45
    s_mov_b32 s46, 536870912
    s_mov_b64 exec, 1
    s_mov_b32 s70, 0
L_wp_129:
    buffer_load_dword v31, v29, s[16:19], 0 offen sc1
    s_add_u32 s70, s70, 1
    s_cmp_ge_u32 s70, 0x200000
    s_cbranch_scc1 L_w_done_102
    s_waitcnt vmcnt(0)
    v_cmp_gt_u32 vcc, s46, v31
    s_nop 1
    s_cbranch_vccz L_wp_129_ok
    s_sleep 2
    s_branch L_wp_129
L_wp_129_ok:
    s_mov_b64 exec, -1
    v_readfirstlane_b32 s45, v31
    s_nop 3
    s_and_b32 s46, s45, 511
    s_mul_i32 s46, s46, s46
    s_bfe_u32 s45, s45, 0xf0009
    s_lshl_b32 s45, s45, 5
    s_mov_b32 s80, s12
    s_mov_b32 s81, s13
    s_mov_b32 s83, 0x00020000
    s_mov_b32 s84, s12
    s_mov_b32 s85, s13
    s_mov_b32 s87, 0x00020000
    s_cmp_eq_u32 s45, s46
    s_cselect_b32 s82, s14, 0
    s_cselect_b32 s86, 0, s14
    s_sub_u32 s79, 3, s44
    s_mov_b32 s78, 0
    s_cmp_eq_u64 s[36:37], 0
    s_cbranch_scc1 L_xl_130
    s_ff1_i32_b64 s47, s[36:37]
    s_lshr_b64 s[74:75], s[72:73], s47
    s_ff1_i32_b64 s48, s[74:75]
    s_cmp_gt_u32 s79, s48
    s_cbranch_scc1 L_xl_130
    s_add_u32 s47, s47, s79
    s_cmp_lt_u32 s47, s78
    s_cbranch_scc1 L_xl_130_go
    s_lshl_b32 s45, s41, 7
    s_add_u32 s45, s45, 0x10010
    s_add_u32 s46, s47, 1
    s_mov_b64 exec, 7
    s_mov_b32 s70, 0
L_wp_131:
    buffer_load_dword v31, v12, s[12:15], s45 offen sc1
    s_add_u32 s70, s70, 1
    s_cmp_ge_u32 s70, 0x200000
    s_cbranch_scc1 L_w_done_102
    s_waitcnt vmcnt(0)
    v_cmp_gt_u32 vcc, s46, v31
    s_nop 1
    s_cbranch_vccz L_wp_131_ok
    s_sleep 2
    s_branch L_wp_131
L_wp_131_ok:
    s_mov_b64 exec, -1
    v_readlane_b32 s78, v31, 0
    v_readlane_b32 s45, v31, 1
    v_readlane_b32 s46, v31, 2
    s_nop 3
    s_min_u32 s78, s78, s45
    s_min_u32 s78, s78, s46
L_xl_130_go:
    s_lshl_b32 s45, s41, 19
    s_lshl_b32 s46, s47, 13
    s_add_u32 s45, s45, s46
    s_add_u32 s45, s45, 0x2000000
    s_add_u32 s46, s45, 4096
    s_add_u32 s48, s45, 16777216
    s_add_u32 s49, s48, 4096
    s_add_u32 s76, s48, 16777216
    s_add_u32 s77, s76, 4096
    buffer_load_dwordx4 v[96:99], v10, s[12:15], s76 offen offset:0 sc1
    buffer_load_dwordx4 v[128:131], v10, s[12:15], s45 offen offset:0 sc1
    buffer_load_dwordx4 v[160:163], v10, s[12:15], s48 offen offset:0 sc1
    buffer_load_dwordx4 v[100:103], v10, s[12:15], s76 offen offset:1024 sc1
    buffer_load_dwordx4 v[144:147], v10, s[12:15], s45 offen offset:1024 sc1
    buffer_load_dwordx4 v[176:179], v10, s[12:15], s48 offen offset:1024 sc1
    buffer_load_dwordx4 v[104:107], v10, s[12:15], s76 offen offset:2048 sc1
    buffer_load_dwordx4 v[132:135], v10, s[12:15], s45 offen offset:2048 sc1
    buffer_load_dwordx4 v[164:167], v10, s[12:15], s48 offen offset:2048 sc1
    buffer_load_dwordx4 v[108:111], v10, s[12:15], s76 offen offset:3072 sc1
    buffer_load_dwordx4 v[148:151], v10, s[12:15], s45 offen offset:3072 sc1
    buffer_load_dwordx4 v[180:183], v10, s[12:15], s48 offen offset:3072 sc1
    buffer_load_dwordx4 v[112:115], v10, s[12:15], s77 offen offset:0 sc1
    buffer_load_dwordx4 v[136:139], v10, s[12:15], s46 offen offset:0 sc1
    buffer_load_dwordx4 v[168:171], v10, s[12:15], s49 offen offset:0 sc1
    buffer_load_dwordx4 v[116:119], v10, s[12:15], s77 offen offset:1024 sc1
    buffer_load_dwordx4 v[152:155], v10, s[12:15], s46 offen offset:1024 sc1
    buffer_load_dwordx4 v[184:187], v10, s[12:15], s49 offen offset:1024 sc1
    buffer_load_dwordx4 v[120:123], v10, s[12:15], s77 offen offset:2048 sc1
    buffer_load_dwordx4 v[140:143], v10, s[12:15], s46 offen offset:2048 sc1
    buffer_load_dwordx4 v[172:175], v10, s[12:15], s49 offen offset:2048 sc1
    buffer_load_dwordx4 v[124:127], v10, s[12:15], s77 offen offset:3072 sc1
    buffer_load_dwordx4 v[156:159], v10, s[12:15], s46 offen offset:3072 sc1
    buffer_load_dwordx4 v[188:191], v10, s[12:15], s49 offen offset:3072 sc1
L_xl_130:
L_a_loop_127:
    s_cmp_eq_u64 s[36:37], 0
    s_cbranch_scc1 L_w_done_102
    s_ff1_i32_b64 s50, s[36:37]
    s_bitset0_b64 s[36:37], s50
    s_lshr_b64 s[74:75], s[72:73], s50
    s_ff1_i32_b64 s51, s[74:75]
    s_add_u32 s51, s51, 1
    s_add_u32 s62, s50, s51
    s_add_u32 s63, s50, s79
    s_cmp_ge_u32 s79, s51
    s_cbranch_scc1 L_xs1_132
    s_lshl_b32 s47, s44, 13
    v_add_u32 v18, s47, v10
    v_and_b32 v14, 15, v1
    v_lshrrev_b32 v16, 4, v1
    s_waitcnt vmcnt(0)
    ds_write_b128 v18, v[96:99] offset:0
    ds_write_b128 v18, v[100:103] offset:1024
    ds_write_b128 v18, v[104:107] offset:2048
    ds_write_b128 v18, v[108:111] offset:3072
    ds_write_b128 v18, v[112:115] offset:4096
    ds_write_b128 v18, v[116:119] offset:5120
    ds_write_b128 v18, v[120:123] offset:6144
    ds_write_b128 v18, v[124:127] offset:7168
    v_mfma_f32_16x16x32_bf16 v[32:35], v[160:163], v[128:131], 0
    v_mfma_f32_16x16x32_bf16 v[36:39], v[160:163], v[144:147], 0
    v_mfma_f32_16x16x32_bf16 v[44:47], v[176:179], v[144:147], 0
    v_mfma_f32_16x16x32_bf16 v[32:35], v[164:167], v[132:135], v[32:35]
    v_mfma_f32_16x16x32_bf16 v[36:39], v[164:167], v[148:151], v[36:39]
    v_mfma_f32_16x16x32_bf16 v[44:47], v[180:183], v[148:151], v[44:47]
    v_mfma_f32_16x16x32_bf16 v[32:35], v[168:171], v[136:139], v[32:35]
    v_mfma_f32_16x16x32_bf16 v[36:39], v[168:171], v[152:155], v[36:39]
    v_mfma_f32_16x16x32_bf16 v[44:47], v[184:187], v[152:155], v[44:47]
    v_mfma_f32_16x16x32_bf16 v[32:35], v[172:175], v[140:143], v[32:35]
    v_mfma_f32_16x16x32_bf16 v[36:39], v[172:175], v[156:159], v[36:39]
    v_mfma_f32_16x16x32_bf16 v[44:47], v[188:191], v[156:159], v[44:47]
    v_lshlrev_b32 v19, 2, v16
    v_lshrrev_b32 v20, 2, v1
    v_lshlrev_b32 v20, 4, v20
    v_and_b32 v21, 1, v1
    v_lshlrev_b32 v21, 3, v21
    v_add3_u32 v20, v20, v21, s47
    v_and_b32 v21, 2, v1
    v_lshlrev_b32 v21, 7, v21
    v_add_u32 v20, v20, v21
    v_mov_b32 v22, 0xff800000
    s_waitcnt lgkmcnt(0)
    ds_read_b64_tr_b16 v[208:209], v20 offset:0
    ds_read_b64_tr_b16 v[210:211], v20 offset:1024
    ds_read_b64_tr_b16 v[212:213], v20 offset:512
    ds_read_b64_tr_b16 v[214:215], v20 offset:1536
    ds_read_b64_tr_b16 v[216:217], v20 offset:2048
    ds_read_b64_tr_b16 v[218:219], v20 offset:3072
    ds_read_b64_tr_b16 v[220:221], v20 offset:2560
    ds_read_b64_tr_b16 v[222:223], v20 offset:3584
    ds_read_b64_tr_b16 v[224:225], v20 offset:4096
    ds_read_b64_tr_b16 v[226:227], v20 offset:5120
    ds_read_b64_tr_b16 v[228:229], v20 offset:4608
    ds_read_b64_tr_b16 v[230:231], v20 offset:5632
    ds_read_b64_tr_b16 v[232:233], v20 offset:6144
    ds_read_b64_tr_b16 v[234:235], v20 offset:7168
    ds_read_b64_tr_b16 v[236:237], v20 offset:6656
    ds_read_b64_tr_b16 v[238:239], v20 offset:7680
    v_add_u32 v21, 0, v19
    v_cmp_gt_u32 vcc, v21, v14
    s_nop 1
    v_cndmask_b32 v32, v32, v22, vcc
    v_cndmask_b32 v44, v44, v22, vcc
    v_add_u32 v21, 1, v19
    v_cmp_gt_u32 vcc, v21, v14
    s_nop 1
    v_cndmask_b32 v33, v33, v22, vcc
    v_cndmask_b32 v45, v45, v22, vcc
    v_add_u32 v21, 2, v19
    v_cmp_gt_u32 vcc, v21, v14
    s_nop 1
    v_cndmask_b32 v34, v34, v22, vcc
    v_cndmask_b32 v46, v46, v22, vcc
    v_add_u32 v21, 3, v19
    v_cmp_gt_u32 vcc, v21, v14
    s_nop 1
    v_cndmask_b32 v35, v35, v22, vcc
    v_cndmask_b32 v47, v47, v22, vcc
L_xs1_132:
    s_lshl_b32 s45, s41, 7
    s_add_u32 s45, s45, 0x11000
    s_cmp_lg_u32 s44, 0
    s_cbranch_scc1 L_pw_134
    s_mov_b64 exec, 255
    s_mov_b32 s70, 0
L_wp_135:
    buffer_load_dword v31, v12, s[12:15], s45 offen sc1
    s_add_u32 s70, s70, 1
    s_cmp_ge_u32 s70, 0x200000
    s_cbranch_scc1 L_w_done_102
    s_waitcnt vmcnt(0)
    v_cmp_gt_u32 vcc, s62, v31
    s_nop 1
    s_cbranch_vccz L_wp_135_ok
    s_sleep 2
    s_branch L_wp_135
L_wp_135_ok:
    s_mov_b64 exec, -1
L_pw_134:
    s_barrier
    s_cmp_ge_u32 s79, s51
    s_cbranch_scc1 L_xs2_133
    s_lshl_b32 s45, s63, 17
    s_lshl_b32 s46, s41, 12
    s_add_u32 s45, s45, s46
    s_lshr_b32 s46, s45, 1
    s_add_u32 s45, s45, 0x1000000
    s_add_u32 s46, s46, 0x1800000
    v_lshlrev_b32 v21, 3, v1
    buffer_load_dwordx4 v[192:195], v10, s[12:15], s45 offen offset:0 sc1
    buffer_load_dwordx4 v[196:199], v10, s[12:15], s45 offen offset:1024 sc1
    buffer_load_dwordx4 v[200:203], v10, s[12:15], s45 offen offset:2048 sc1
    buffer_load_dwordx4 v[204:207], v10, s[12:15], s45 offen offset:3072 sc1
    buffer_load_dwordx2 v[240:241], v21, s[12:15], s46 offen offset:0 sc1
    buffer_load_dwordx2 v[242:243], v21, s[12:15], s46 offen offset:512 sc1
    buffer_load_dwordx2 v[244:245], v21, s[12:15], s46 offen offset:1024 sc1
    buffer_load_dwordx2 v[246:247], v21, s[12:15], s46 offen offset:1536 sc1
    s_waitcnt vmcnt(4)
    v_mfma_f32_16x16x32_bf16 v[48:51], v[192:195], v[128:131], 0
    v_mfma_f32_16x16x32_bf16 v[52:55], v[192:195], v[144:147], 0
    v_mfma_f32_16x16x32_bf16 v[48:51], v[196:199], v[132:135], v[48:51]
    v_mfma_f32_16x16x32_bf16 v[52:55], v[196:199], v[148:151], v[52:55]
    v_mfma_f32_16x16x32_bf16 v[48:51], v[200:203], v[136:139], v[48:51]
    v_mfma_f32_16x16x32_bf16 v[52:55], v[200:203], v[152:155], v[52:55]
    v_mfma_f32_16x16x32_bf16 v[48:51], v[204:207], v[140:143], v[48:51]
    v_mfma_f32_16x16x32_bf16 v[52:55], v[204:207], v[156:159], v[52:55]
    s_mov_b32 s45, 0x3e0293ee
    s_nop 6
    v_permlane32_swap_b32 v48, v50
    v_permlane32_swap_b32 v49, v51
    v_pk_add_f32 v[48:49], v[48:49], v[50:51]
    v_permlane32_swap_b32 v52, v54
    v_permlane32_swap_b32 v53, v55
    v_pk_add_f32 v[52:53], v[52:53], v[54:55]
    v_max_f32 v22, v32, v33
    v_max3_f32 v22, v22, v34, v35
    v_max3_f32 v22, v22, v48, v49
    v_max_f32 v23, v36, v37
    v_max3_f32 v23, v23, v38, v39
    v_max3_f32 v23, v23, v44, v45
    v_max3_f32 v23, v23, v46, v47
    v_max3_f32 v23, v23, v52, v53
    v_mov_b32 v24, v22
    v_mov_b32 v25, v23
    s_nop 0
    v_permlane32_swap_b32 v22, v24
    v_permlane32_swap_b32 v23, v25
    v_max_f32 v22, v22, v24
    v_max_f32 v23, v23, v25
    v_mov_b32 v24, v22
    v_mov_b32 v25, v23
    s_nop 0
    v_permlane16_swap_b32 v22, v24
    v_permlane16_swap_b32 v23, v25
    v_max_f32 v22, v22, v24
    v_max_f32 v23, v23, v25
    v_mul_f32 v22, s45, v22
    v_mul_f32 v23, s45, v23
    v_fma_f32 v32, v32, s45, -v22
    v_fma_f32 v33, v33, s45, -v22
    v_fma_f32 v34, v34, s45, -v22
    v_fma_f32 v35, v35, s45, -v22
    v_fma_f32 v48, v48, s45, -v22
    v_fma_f32 v49, v49, s45, -v22
    v_exp_f32 v32, v32
    v_exp_f32 v33, v33
    v_exp_f32 v34, v34
    v_exp_f32 v35, v35
    v_exp_f32 v48, v48
    v_exp_f32 v49, v49
    v_fma_f32 v36, v36, s45, -v23
    v_fma_f32 v37, v37, s45, -v23
    v_fma_f32 v38, v38, s45, -v23
    v_fma_f32 v39, v39, s45, -v23
    v_fma_f32 v44, v44, s45, -v23
    v_fma_f32 v45, v45, s45, -v23
    v_fma_f32 v46, v46, s45, -v23
    v_fma_f32 v47, v47, s45, -v23
    v_fma_f32 v52, v52, s45, -v23
    v_fma_f32 v53, v53, s45, -v23
    v_exp_f32 v36, v36
    v_exp_f32 v37, v37
    v_exp_f32 v38, v38
    v_exp_f32 v39, v39
    v_exp_f32 v44, v44
    v_exp_f32 v45, v45
    v_exp_f32 v46, v46
    v_exp_f32 v47, v47
    v_exp_f32 v52, v52
    v_exp_f32 v53, v53
    v_add_f32 v22, v32, v33
    v_add_f32 v22, v22, v34
    v_add_f32 v22, v22, v35
    v_add_f32 v22, v22, v48
    v_add_f32 v22, v22, v49
    v_add_f32 v23, v36, v37
    v_add_f32 v23, v23, v38
    v_add_f32 v23, v23, v39
    v_add_f32 v23, v23, v44
    v_add_f32 v23, v23, v45
    v_add_f32 v23, v23, v46
    v_add_f32 v23, v23, v47
    v_add_f32 v23, v23, v52
    v_add_f32 v23, v23, v53
    v_mov_b32 v24, v22
    v_mov_b32 v25, v23
    s_nop 0
    v_permlane32_swap_b32 v22, v24
    v_permlane32_swap_b32 v23, v25
    v_add_f32 v22, v22, v24
    v_add_f32 v23, v23, v25
    v_mov_b32 v24, v22
    v_mov_b32 v25, v23
    s_nop 0
    v_permlane16_swap_b32 v22, v24
    v_permlane16_swap_b32 v23, v25
    v_add_f32 v22, v22, v24
    v_add_f32 v23, v23, v25
    v_rcp_f32 v22, v22
    v_rcp_f32 v23, v23
    s_nop 0
    v_mul_f32 v32, v32, v22
    v_mul_f32 v33, v33, v22
    v_mul_f32 v34, v34, v22
    v_mul_f32 v35, v35, v22
    v_mul_f32 v48, v48, v22
    v_mul_f32 v49, v49, v22
    v_mul_f32 v36, v36, v23
    v_mul_f32 v37, v37, v23
    v_mul_f32 v38, v38, v23
    v_mul_f32 v39, v39, v23
    v_mul_f32 v44, v44, v23
    v_mul_f32 v45, v45, v23
    v_mul_f32 v46, v46, v23
    v_mul_f32 v47, v47, v23
    v_mul_f32 v52, v52, v23
    v_mul_f32 v53, v53, v23
    v_cvt_pk_bf16_f32 v128, v32, v33
    v_cvt_pk_bf16_f32 v129, v34, v35
    v_mov_b32 v130, 0
    v_mov_b32 v131, 0
    v_cvt_pk_bf16_f32 v132, v48, v49
    v_mov_b32 v133, 0
    v_mov_b32 v134, 0
    v_cvt_pk_bf16_f32 v135, v48, v49
    v_cvt_pk_bf16_f32 v136, v36, v37
    v_cvt_pk_bf16_f32 v137, v38, v39
    v_cvt_pk_bf16_f32 v138, v44, v45
    v_cvt_pk_bf16_f32 v139, v46, v47
    v_cvt_pk_bf16_f32 v140, v52, v53
    v_mov_b32 v141, 0
    v_mov_b32 v142, 0
    v_cvt_pk_bf16_f32 v143, v52, v53
    s_waitcnt vmcnt(0) lgkmcnt(0)
    s_nop 0
    v_mfma_f32_16x16x32_bf16 v[64:67], v[208:211], v[128:131], 0
    v_mfma_f32_16x16x32_bf16 v[68:71], v[212:215], v[128:131], 0
    v_mfma_f32_16x16x32_bf16 v[72:75], v[216:219], v[128:131], 0
    v_mfma_f32_16x16x32_bf16 v[76:79], v[220:223], v[128:131], 0
    v_mfma_f32_16x16x32_bf16 v[80:83], v[224:227], v[128:131], 0
    v_mfma_f32_16x16x32_bf16 v[84:87], v[228:231], v[128:131], 0
    v_mfma_f32_16x16x32_bf16 v[88:91], v[232:235], v[128:131], 0
    v_mfma_f32_16x16x32_bf16 v[92:95], v[236:239], v[128:131], 0
    v_mfma_f32_16x16x16_bf16 v[64:67], v[240:241], v[132:133], v[64:67]
    v_mfma_f32_16x16x16_bf16 v[68:71], v[240:241], v[134:135], v[68:71]
    v_mfma_f32_16x16x16_bf16 v[72:75], v[242:243], v[132:133], v[72:75]
    v_mfma_f32_16x16x16_bf16 v[76:79], v[242:243], v[134:135], v[76:79]
    v_mfma_f32_16x16x16_bf16 v[80:83], v[244:245], v[132:133], v[80:83]
    v_mfma_f32_16x16x16_bf16 v[84:87], v[244:245], v[134:135], v[84:87]
    v_mfma_f32_16x16x16_bf16 v[88:91], v[246:247], v[132:133], v[88:91]
    v_mfma_f32_16x16x16_bf16 v[92:95], v[246:247], v[134:135], v[92:95]
    v_mfma_f32_16x16x32_bf16 v[96:99], v[208:211], v[136:139], 0
    v_mfma_f32_16x16x32_bf16 v[100:103], v[212:215], v[136:139], 0
    v_mfma_f32_16x16x32_bf16 v[104:107], v[216:219], v[136:139], 0
    v_mfma_f32_16x16x32_bf16 v[108:111], v[220:223], v[136:139], 0
    v_mfma_f32_16x16x32_bf16 v[112:115], v[224:227], v[136:139], 0
    v_mfma_f32_16x16x32_bf16 v[116:119], v[228:231], v[136:139], 0
    v_mfma_f32_16x16x32_bf16 v[120:123], v[232:235], v[136:139], 0
    v_mfma_f32_16x16x32_bf16 v[124:127], v[236:239], v[136:139], 0
    v_mfma_f32_16x16x16_bf16 v[96:99], v[240:241], v[140:141], v[96:99]
    v_mfma_f32_16x16x16_bf16 v[100:103], v[240:241], v[142:143], v[100:103]
    v_mfma_f32_16x16x16_bf16 v[104:107], v[242:243], v[140:141], v[104:107]
    v_mfma_f32_16x16x16_bf16 v[108:111], v[242:243], v[142:143], v[108:111]
    v_mfma_f32_16x16x16_bf16 v[112:115], v[244:245], v[140:141], v[112:115]
    v_mfma_f32_16x16x16_bf16 v[116:119], v[244:245], v[142:143], v[116:119]
    v_mfma_f32_16x16x16_bf16 v[120:123], v[246:247], v[140:141], v[120:123]
    v_mfma_f32_16x16x16_bf16 v[124:127], v[246:247], v[142:143], v[124:127]
    s_lshl_b32 s45, s63, 18
    s_lshl_b32 s46, s41, 13
    s_add_u32 s45, s45, s46
    s_add_u32 s45, s45, 0x5000000
    s_add_u32 s46, s45, 4096
    v_cvt_pk_bf16_f32 v64, v64, v65
    v_cvt_pk_bf16_f32 v65, v66, v67
    v_cvt_pk_bf16_f32 v66, v68, v69
    v_cvt_pk_bf16_f32 v67, v70, v71
    buffer_store_dwordx4 v[64:67], v10, s[12:15], s45 offen offset:0 sc1
    v_cvt_pk_bf16_f32 v72, v72, v73
    v_cvt_pk_bf16_f32 v73, v74, v75
    v_cvt_pk_bf16_f32 v74, v76, v77
    v_cvt_pk_bf16_f32 v75, v78, v79
    buffer_store_dwordx4 v[72:75], v10, s[12:15], s45 offen offset:2048 sc1
    v_cvt_pk_bf16_f32 v80, v80, v81
    v_cvt_pk_bf16_f32 v81, v82, v83
    v_cvt_pk_bf16_f32 v82, v84, v85
    v_cvt_pk_bf16_f32 v83, v86, v87
    buffer_store_dwordx4 v[80:83], v10, s[12:15], s46 offen offset:0 sc1
    v_cvt_pk_bf16_f32 v88, v88, v89
    v_cvt_pk_bf16_f32 v89, v90, v91
    v_cvt_pk_bf16_f32 v90, v92, v93
    v_cvt_pk_bf16_f32 v91, v94, v95
    buffer_store_dwordx4 v[88:91], v10, s[12:15], s46 offen offset:2048 sc1
    v_cvt_pk_bf16_f32 v96, v96, v97
    v_cvt_pk_bf16_f32 v97, v98, v99
    v_cvt_pk_bf16_f32 v98, v100, v101
    v_cvt_pk_bf16_f32 v99, v102, v103
    buffer_store_dwordx4 v[96:99], v10, s[12:15], s45 offen offset:1024 sc1
    v_cvt_pk_bf16_f32 v104, v104, v105
    v_cvt_pk_bf16_f32 v105, v106, v107
    v_cvt_pk_bf16_f32 v106, v108, v109
    v_cvt_pk_bf16_f32 v107, v110, v111
    buffer_store_dwordx4 v[104:107], v10, s[12:15], s45 offen offset:3072 sc1
    v_cvt_pk_bf16_f32 v112, v112, v113
    v_cvt_pk_bf16_f32 v113, v114, v115
    v_cvt_pk_bf16_f32 v114, v116, v117
    v_cvt_pk_bf16_f32 v115, v118, v119
    buffer_store_dwordx4 v[112:115], v10, s[12:15], s46 offen offset:1024 sc1
    v_cvt_pk_bf16_f32 v120, v120, v121
    v_cvt_pk_bf16_f32 v121, v122, v123
    v_cvt_pk_bf16_f32 v122, v124, v125
    v_cvt_pk_bf16_f32 v123, v126, v127
    buffer_store_dwordx4 v[120:123], v10, s[12:15], s46 offen offset:3072 sc1
L_xs2_133:
    s_waitcnt vmcnt(0)
    s_barrier
    s_cmp_lg_u32 s44, 0
    s_cbranch_scc1 L_pub_136
    v_mov_b32 v30, s62
    v_mov_b32 v31, 0
    s_mov_b64 exec, 1
    buffer_store_dword v30, v31, s[80:83], s65 offen
    buffer_store_dword v30, v31, s[84:87], s65 offen sc1
    s_mov_b64 exec, -1
L_pub_136:
    s_cmp_eq_u64 s[36:37], 0
    s_cbranch_scc1 L_xl_137
    s_ff1_i32_b64 s47, s[36:37]
    s_lshr_b64 s[74:75], s[72:73], s47
    s_ff1_i32_b64 s48, s[74:75]
    s_cmp_gt_u32 s79, s48
    s_cbranch_scc1 L_xl_137
    s_add_u32 s47, s47, s79
    s_cmp_lt_u32 s47, s78
    s_cbranch_scc1 L_xl_137_go
    s_lshl_b32 s45, s41, 7
    s_add_u32 s45, s45, 0x10010
    s_add_u32 s46, s47, 1
    s_mov_b64 exec, 7
    s_mov_b32 s70, 0
L_wp_138:
    buffer_load_dword v31, v12, s[12:15], s45 offen sc1
    s_add_u32 s70, s70, 1
    s_cmp_ge_u32 s70, 0x200000
    s_cbranch_scc1 L_w_done_102
    s_waitcnt vmcnt(0)
    v_cmp_gt_u32 vcc, s46, v31
    s_nop 1
    s_cbranch_vccz L_wp_138_ok
    s_sleep 2
    s_branch L_wp_138
L_wp_138_ok:
    s_mov_b64 exec, -1
    v_readlane_b32 s78, v31, 0
    v_readlane_b32 s45, v31, 1
    v_readlane_b32 s46, v31, 2
    s_nop 3
    s_min_u32 s78, s78, s45
    s_min_u32 s78, s78, s46
L_xl_137_go:
    s_lshl_b32 s45, s41, 19
    s_lshl_b32 s46, s47, 13
    s_add_u32 s45, s45, s46
    s_add_u32 s45, s45, 0x2000000
    s_add_u32 s46, s45, 4096
    s_add_u32 s48, s45, 16777216
    s_add_u32 s49, s48, 4096
    s_add_u32 s76, s48, 16777216
    s_add_u32 s77, s76, 4096
    buffer_load_dwordx4 v[96:99], v10, s[12:15], s76 offen offset:0 sc1
    buffer_load_dwordx4 v[128:131], v10, s[12:15], s45 offen offset:0 sc1
    buffer_load_dwordx4 v[160:163], v10, s[12:15], s48 offen offset:0 sc1
    buffer_load_dwordx4 v[100:103], v10, s[12:15], s76 offen offset:1024 sc1
    buffer_load_dwordx4 v[144:147], v10, s[12:15], s45 offen offset:1024 sc1
    buffer_load_dwordx4 v[176:179], v10, s[12:15], s48 offen offset:1024 sc1
    buffer_load_dwordx4 v[104:107], v10, s[12:15], s76 offen offset:2048 sc1
    buffer_load_dwordx4 v[132:135], v10, s[12:15], s45 offen offset:2048 sc1
    buffer_load_dwordx4 v[164:167], v10, s[12:15], s48 offen offset:2048 sc1
    buffer_load_dwordx4 v[108:111], v10, s[12:15], s76 offen offset:3072 sc1
    buffer_load_dwordx4 v[148:151], v10, s[12:15], s45 offen offset:3072 sc1
    buffer_load_dwordx4 v[180:183], v10, s[12:15], s48 offen offset:3072 sc1
    buffer_load_dwordx4 v[112:115], v10, s[12:15], s77 offen offset:0 sc1
    buffer_load_dwordx4 v[136:139], v10, s[12:15], s46 offen offset:0 sc1
    buffer_load_dwordx4 v[168:171], v10, s[12:15], s49 offen offset:0 sc1
    buffer_load_dwordx4 v[116:119], v10, s[12:15], s77 offen offset:1024 sc1
    buffer_load_dwordx4 v[152:155], v10, s[12:15], s46 offen offset:1024 sc1
    buffer_load_dwordx4 v[184:187], v10, s[12:15], s49 offen offset:1024 sc1
    buffer_load_dwordx4 v[120:123], v10, s[12:15], s77 offen offset:2048 sc1
    buffer_load_dwordx4 v[140:143], v10, s[12:15], s46 offen offset:2048 sc1
    buffer_load_dwordx4 v[172:175], v10, s[12:15], s49 offen offset:2048 sc1
    buffer_load_dwordx4 v[124:127], v10, s[12:15], s77 offen offset:3072 sc1
    buffer_load_dwordx4 v[156:159], v10, s[12:15], s46 offen offset:3072 sc1
    buffer_load_dwordx4 v[188:191], v10, s[12:15], s49 offen offset:3072 sc1
L_xl_137:
    s_lshl_b32 s45, s38, 10
    s_add_u32 s45, s45, s64
    s_cmp_lg_u32 s44, 0
    s_cbranch_scc1 L_pw_139
    s_mov_b64 exec, 255
    s_mov_b32 s70, 0
L_wp_140:
    buffer_load_dword v31, v5, s[12:15], s45 offen sc1
    s_add_u32 s70, s70, 1
    s_cmp_ge_u32 s70, 0x200000
    s_cbranch_scc1 L_w_done_102
    s_waitcnt vmcnt(0)
    v_cmp_gt_u32 vcc, s62, v31
    s_nop 1
    s_cbranch_vccz L_wp_140_ok
    s_sleep 1
    s_branch L_wp_140
L_wp_140_ok:
    s_mov_b64 exec, -1
L_pw_139:
    s_barrier
    s_mul_i32 s53, s50, 262144
    s_add_u32 s53, s53, s52
    s_lshl_b32 s54, s44, 13
    s_add_u32 s53, s53, s54
    s_mul_i32 s57, s50, 131072
    s_add_u32 s57, s57, s56
    s_lshl_b32 s45, s44, 7
    s_add_u32 s57, s57, s45
    s_add_u32 s55, s54, 65536
    s_mov_b32 s58, 0
    v_mov_b32 v13, v10
    v_add_u32 v14, 65536, v13
    v_xor_b32 v15, 64, v13
    v_xor_b32 v16, 64, v14
    s_mov_b32 s76, 0x20000000
    s_add_u32 s48, s53, 0
    s_add_u32 s49, s48, 4096
    s_add_u32 m0, s54, 0
    s_nop 0
    buffer_load_dwordx4 v10, s[12:15], s48 offen offset:0 sc1 lds
    buffer_load_dwordx4 v10, s[12:15], s48 offen offset:1024 sc1 lds
    buffer_load_dwordx4 v10, s[12:15], s48 offen offset:2048 sc1 lds
    buffer_load_dwordx4 v10, s[12:15], s48 offen offset:3072 sc1 lds
    s_add_u32 m0, s54, 4096
    s_nop 0
    buffer_load_dwordx4 v10, s[12:15], s49 offen offset:0 sc1 lds
    buffer_load_dwordx4 v10, s[12:15], s49 offen offset:1024 sc1 lds
    buffer_load_dwordx4 v10, s[12:15], s49 offen offset:2048 sc1 lds
    buffer_load_dwordx4 v10, s[12:15], s49 offen offset:3072 sc1 lds
    s_add_u32 s48, s53, 32768
    s_add_u32 s49, s48, 4096
    s_add_u32 s46, s54, 32768
    s_add_u32 m0, s46, 0
    s_nop 0
    buffer_load_dwordx4 v10, s[12:15], s48 offen offset:0 sc1 lds
    buffer_load_dwordx4 v10, s[12:15], s48 offen offset:1024 sc1 lds
    buffer_load_dwordx4 v10, s[12:15], s48 offen offset:2048 sc1 lds
    buffer_load_dwordx4 v10, s[12:15], s48 offen offset:3072 sc1 lds
    s_add_u32 m0, s46, 4096
    s_nop 0
    buffer_load_dwordx4 v10, s[12:15], s49 offen offset:0 sc1 lds
    buffer_load_dwordx4 v10, s[12:15], s49 offen offset:1024 sc1 lds
    buffer_load_dwordx4 v10, s[12:15], s49 offen offset:2048 sc1 lds
    buffer_load_dwordx4 v10, s[12:15], s49 offen offset:3072 sc1 lds
    s_cmp_eq_u32 s51, 1
    s_cbranch_scc1 L_e_one_142
    s_add_u32 s48, s53, 262144
    s_add_u32 s49, s48, 4096
    s_add_u32 m0, s55, 0
    s_nop 0
    buffer_load_dwordx4 v10, s[12:15], s48 offen offset:0 sc1 lds
    buffer_load_dwordx4 v10, s[12:15], s48 offen offset:1024 sc1 lds
    buffer_load_dwordx4 v10, s[12:15], s48 offen offset:2048 sc1 lds
    buffer_load_dwordx4 v10, s[12:15], s48 offen offset:3072 sc1 lds
    s_add_u32 m0, s55, 4096
    s_nop 0
    buffer_load_dwordx4 v10, s[12:15], s49 offen offset:0 sc1 lds
    buffer_load_dwordx4 v10, s[12:15], s49 offen offset:1024 sc1 lds
    buffer_load_dwordx4 v10, s[12:15], s49 offen offset:2048 sc1 lds
    buffer_load_dwordx4 v10, s[12:15], s49 offen offset:3072 sc1 lds
    s_waitcnt vmcnt(16)
    s_barrier
    ds_read_b128 v[32:35], v13 offset:0
    ds_read_b128 v[36:39], v13 offset:1024
    ds_read_b128 v[40:43], v13 offset:2048
    ds_read_b128 v[44:47], v13 offset:3072
L_e_loop_141:
    s_add_u32 s48, s53, 294912
    s_add_u32 s46, s58, 1
    s_cmp_lt_u32 s46, s51
    s_cselect_b32 s48, s48, 0x20000000
    s_add_u32 s49, s48, 4096
    s_add_u32 s59, s55, 32768
    s_waitcnt lgkmcnt(2)
    v_mfma_f32_16x16x32_bf16 v[80:83], a[0:3], v[32:35], 0
    ds_read_b128 v[48:51], v13 offset:4096
    ds_read_b128 v[52:55], v13 offset:5120
    v_mfma_f32_16x16x32_bf16 v[84:87], a[4:7], v[32:35], 0
    ds_read_b128 v[56:59], v13 offset:6144
    ds_read_b128 v[60:63], v13 offset:7168
    v_mfma_f32_16x16x32_bf16 v[88:91], a[0:3], v[36:39], 0
    s_add_u32 m0, s59, 0
    s_nop 0
    buffer_load_dwordx4 v10, s[12:15], s48 offen offset:0 sc1 lds
    v_mfma_f32_16x16x32_bf16 v[92:95], a[4:7], v[36:39], 0
    s_waitcnt lgkmcnt(4)
    v_mfma_f32_16x16x32_bf16 v[80:83], a[8:11], v[40:43], v[80:83]
    ds_read_b128 v[32:35], v13 offset:8192
    ds_read_b128 v[36:39], v13 offset:9216
    v_mfma_f32_16x16x32_bf16 v[84:87], a[12:15], v[40:43], v[84:87]
    v_mfma_f32_16x16x32_bf16 v[88:91], a[8:11], v[44:47], v[88:91]
    buffer_load_dwordx4 v10, s[12:15], s48 offen offset:1024 sc1 lds
    v_mfma_f32_16x16x32_bf16 v[92:95], a[12:15], v[44:47], v[92:95]
    s_waitcnt lgkmcnt(4)
    v_mfma_f32_16x16x32_bf16 v[80:83], a[16:19], v[48:51], v[80:83]
    ds_read_b128 v[40:43], v13 offset:10240
    ds_read_b128 v[44:47], v13 offset:11264
    v_mfma_f32_16x16x32_bf16 v[84:87], a[20:23], v[48:51], v[84:87]
    v_mfma_f32_16x16x32_bf16 v[88:91], a[16:19], v[52:55], v[88:91]
    buffer_load_dwordx4 v10, s[12:15], s48 offen offset:2048 sc1 lds
    v_mfma_f32_16x16x32_bf16 v[92:95], a[20:23], v[52:55], v[92:95]
    s_waitcnt lgkmcnt(4)
    v_mfma_f32_16x16x32_bf16 v[80:83], a[24:27], v[56:59], v[80:83]
    ds_read_b128 v[48:51], v13 offset:12288
    ds_read_b128 v[52:55], v13 offset:13312
    v_mfma_f32_16x16x32_bf16 v[84:87], a[28:31], v[56:59], v[84:87]
    v_mfma_f32_16x16x32_bf16 v[88:91], a[24:27], v[60:63], v[88:91]
    buffer_load_dwordx4 v10, s[12:15], s48 offen offset:3072 sc1 lds
    v_mfma_f32_16x16x32_bf16 v[92:95], a[28:31], v[60:63], v[92:95]
    s_waitcnt lgkmcnt(4)
    v_mfma_f32_16x16x32_bf16 v[80:83], a[32:35], v[32:35], v[80:83]
    ds_read_b128 v[56:59], v13 offset:14336
    ds_read_b128 v[60:63], v13 offset:15360
    v_mfma_f32_16x16x32_bf16 v[84:87], a[36:39], v[32:35], v[84:87]
    v_mfma_f32_16x16x32_bf16 v[88:91], a[32:35], v[36:39], v[88:91]
    s_add_u32 m0, s59, 4096
    s_nop 0
    buffer_load_dwordx4 v10, s[12:15], s49 offen offset:0 sc1 lds
    v_mfma_f32_16x16x32_bf16 v[92:95], a[36:39], v[36:39], v[92:95]
    s_waitcnt lgkmcnt(4)
    v_mfma_f32_16x16x32_bf16 v[80:83], a[40:43], v[40:43], v[80:83]
    ds_read_b128 v[32:35], v13 offset:16384
    ds_read_b128 v[36:39], v13 offset:17408
    v_mfma_f32_16x16x32_bf16 v[84:87], a[44:47], v[40:43], v[84:87]
    v_mfma_f32_16x16x32_bf16 v[88:91], a[40:43], v[44:47], v[88:91]
    buffer_load_dwordx4 v10, s[12:15], s49 offen offset:1024 sc1 lds
    v_mfma_f32_16x16x32_bf16 v[92:95], a[44:47], v[44:47], v[92:95]
    s_waitcnt lgkmcnt(4)
    v_mfma_f32_16x16x32_bf16 v[80:83], a[48:51], v[48:51], v[80:83]
    ds_read_b128 v[40:43], v13 offset:18432
    ds_read_b128 v[44:47], v13 offset:19456
    v_mfma_f32_16x16x32_bf16 v[84:87], a[52:55], v[48:51], v[84:87]
    v_mfma_f32_16x16x32_bf16 v[88:91], a[48:51], v[52:55], v[88:91]
    buffer_load_dwordx4 v10, s[12:15], s49 offen offset:2048 sc1 lds
    v_mfma_f32_16x16x32_bf16 v[92:95], a[52:55], v[52:55], v[92:95]
    s_waitcnt lgkmcnt(4)
    v_mfma_f32_16x16x32_bf16 v[80:83], a[56:59], v[56:59], v[80:83]
    ds_read_b128 v[48:51], v13 offset:20480
    ds_read_b128 v[52:55], v13 offset:21504
    v_mfma_f32_16x16x32_bf16 v[84:87], a[60:63], v[56:59], v[84:87]
    v_mfma_f32_16x16x32_bf16 v[88:91], a[56:59], v[60:63], v[88:91]
    buffer_load_dwordx4 v10, s[12:15], s49 offen offset:3072 sc1 lds
    v_mfma_f32_16x16x32_bf16 v[92:95], a[60:63], v[60:63], v[92:95]
    s_waitcnt lgkmcnt(4)
    v_mfma_f32_16x16x32_bf16 v[80:83], a[64:67], v[32:35], v[80:83]
    ds_read_b128 v[56:59], v13 offset:22528
    ds_read_b128 v[60:63], v13 offset:23552
    v_mfma_f32_16x16x32_bf16 v[84:87], a[68:71], v[32:35], v[84:87]
    v_mfma_f32_16x16x32_bf16 v[88:91], a[64:67], v[36:39], v[88:91]
    v_mfma_f32_16x16x32_bf16 v[92:95], a[68:71], v[36:39], v[92:95]
    s_waitcnt lgkmcnt(4)
    v_mfma_f32_16x16x32_bf16 v[80:83], a[72:75], v[40:43], v[80:83]
    ds_read_b128 v[32:35], v13 offset:24576
    ds_read_b128 v[36:39], v13 offset:25600
    v_mfma_f32_16x16x32_bf16 v[84:87], a[76:79], v[40:43], v[84:87]
    v_mfma_f32_16x16x32_bf16 v[88:91], a[72:75], v[44:47], v[88:91]
    v_mfma_f32_16x16x32_bf16 v[92:95], a[76:79], v[44:47], v[92:95]
    s_waitcnt lgkmcnt(4)
    v_mfma_f32_16x16x32_bf16 v[80:83], a[80:83], v[48:51], v[80:83]
    ds_read_b128 v[40:43], v13 offset:26624
    ds_read_b128 v[44:47], v13 offset:27648
    v_mfma_f32_16x16x32_bf16 v[84:87], a[84:87], v[48:51], v[84:87]
    v_mfma_f32_16x16x32_bf16 v[88:91], a[80:83], v[52:55], v[88:91]
    v_mfma_f32_16x16x32_bf16 v[92:95], a[84:87], v[52:55], v[92:95]
    s_waitcnt lgkmcnt(4)
    v_mfma_f32_16x16x32_bf16 v[80:83], a[88:91], v[56:59], v[80:83]
    ds_read_b128 v[48:51], v13 offset:28672
    ds_read_b128 v[52:55], v13 offset:29696
    v_mfma_f32_16x16x32_bf16 v[84:87], a[92:95], v[56:59], v[84:87]
    v_mfma_f32_16x16x32_bf16 v[88:91], a[88:91], v[60:63], v[88:91]
    v_mfma_f32_16x16x32_bf16 v[92:95], a[92:95], v[60:63], v[92:95]
    s_waitcnt lgkmcnt(4)
    v_mfma_f32_16x16x32_bf16 v[80:83], a[96:99], v[32:35], v[80:83]
    ds_read_b128 v[56:59], v13 offset:30720
    ds_read_b128 v[60:63], v13 offset:31744
    v_mfma_f32_16x16x32_bf16 v[84:87], a[100:103], v[32:35], v[84:87]
    v_mfma_f32_16x16x32_bf16 v[88:91], a[96:99], v[36:39], v[88:91]
    v_mfma_f32_16x16x32_bf16 v[92:95], a[100:103], v[36:39], v[92:95]
    s_waitcnt lgkmcnt(4)
    v_mfma_f32_16x16x32_bf16 v[80:83], a[104:107], v[40:43], v[80:83]
    ds_read_b128 v[216:219], v8 offset:0
    ds_read_b128 v[220:223], v8 offset:1152
    v_mfma_f32_16x16x32_bf16 v[84:87], a[108:111], v[40:43], v[84:87]
    ds_read_b128 v[224:227], v8 offset:2304
    ds_read_b128 v[228:231], v8 offset:3456
    v_mfma_f32_16x16x32_bf16 v[88:91], a[104:107], v[44:47], v[88:91]
    v_mfma_f32_16x16x32_bf16 v[92:95], a[108:111], v[44:47], v[92:95]
    s_waitcnt vmcnt(16) lgkmcnt(0)
    s_barrier
    v_mfma_f32_16x16x32_bf16 v[80:83], a[112:115], v[48:51], v[80:83]
    ds_read_b128 v[32:35], v13 offset:32768
    ds_read_b128 v[36:39], v13 offset:33792
    v_mfma_f32_16x16x32_bf16 v[84:87], a[116:119], v[48:51], v[84:87]
    buffer_store_dwordx4 v[216:219], v11, s[12:15], s76 offen sc1
    v_mfma_f32_16x16x32_bf16 v[88:91], a[112:115], v[52:55], v[88:91]
    s_add_u32 s76, s76, 32768
    v_mfma_f32_16x16x32_bf16 v[92:95], a[116:119], v[52:55], v[92:95]
    buffer_store_dwordx4 v[220:223], v11, s[12:15], s76 offen sc1
    v_mfma_f32_16x16x32_bf16 v[80:83], a[120:123], v[56:59], v[80:83]
    ds_read_b128 v[40:43], v13 offset:34816
    ds_read_b128 v[44:47], v13 offset:35840
    v_mfma_f32_16x16x32_bf16 v[84:87], a[124:127], v[56:59], v[84:87]
    s_add_u32 s76, s76, 32768
    v_mfma_f32_16x16x32_bf16 v[88:91], a[120:123], v[60:63], v[88:91]
    buffer_store_dwordx4 v[224:227], v11, s[12:15], s76 offen sc1
    v_mfma_f32_16x16x32_bf16 v[92:95], a[124:127], v[60:63], v[92:95]
    s_add_u32 s76, s76, 32768
    s_add_u32 s48, s53, 524288
    s_add_u32 s46, s58, 2
    s_cmp_lt_u32 s46, s51
    s_cselect_b32 s48, s48, 0x20000000
    s_add_u32 s49, s48, 4096
    s_mov_b32 s59, s54
    s_waitcnt lgkmcnt(2)
    v_mfma_f32_16x16x32_bf16 v[80:83], a[128:131], v[32:35], v[80:83]
    ds_read_b128 v[48:51], v13 offset:36864
    ds_read_b128 v[52:55], v13 offset:37888
    v_mfma_f32_16x16x32_bf16 v[84:87], a[132:135], v[32:35], v[84:87]
    ds_read_b128 v[56:59], v13 offset:38912
    ds_read_b128 v[60:63], v13 offset:39936
    v_mfma_f32_16x16x32_bf16 v[88:91], a[128:131], v[36:39], v[88:91]
    s_add_u32 m0, s59, 0
    s_nop 0
    buffer_load_dwordx4 v10, s[12:15], s48 offen offset:0 sc1 lds
    v_mfma_f32_16x16x32_bf16 v[92:95], a[132:135], v[36:39], v[92:95]
    buffer_store_dwordx4 v[228:231], v11, s[12:15], s76 offen sc1
    s_waitcnt lgkmcnt(4)
    v_mfma_f32_16x16x32_bf16 v[80:83], a[136:139], v[40:43], v[80:83]
    ds_read_b128 v[32:35], v13 offset:40960
    ds_read_b128 v[36:39], v13 offset:41984
    v_mfma_f32_16x16x32_bf16 v[84:87], a[140:143], v[40:43], v[84:87]
    v_mfma_f32_16x16x32_bf16 v[88:91], a[136:139], v[44:47], v[88:91]
    buffer_load_dwordx4 v10, s[12:15], s48 offen offset:1024 sc1 lds
    v_mfma_f32_16x16x32_bf16 v[92:95], a[140:143], v[44:47], v[92:95]
    s_waitcnt lgkmcnt(4)
    v_mfma_f32_16x16x32_bf16 v[80:83], a[144:147], v[48:51], v[80:83]
    ds_read_b128 v[40:43], v13 offset:43008
    ds_read_b128 v[44:47], v13 offset:44032
    v_mfma_f32_16x16x32_bf16 v[84:87], a[148:151], v[48:51], v[84:87]
    v_mfma_f32_16x16x32_bf16 v[88:91], a[144:147], v[52:55], v[88:91]
    buffer_load_dwordx4 v10, s[12:15], s48 offen offset:2048 sc1 lds
    v_mfma_f32_16x16x32_bf16 v[92:95], a[148:151], v[52:55], v[92:95]
    s_waitcnt lgkmcnt(4)
    v_mfma_f32_16x16x32_bf16 v[80:83], a[152:155], v[56:59], v[80:83]
    ds_read_b128 v[48:51], v13 offset:45056
    ds_read_b128 v[52:55], v13 offset:46080
    v_mfma_f32_16x16x32_bf16 v[84:87], a[156:159], v[56:59], v[84:87]
    v_mfma_f32_16x16x32_bf16 v[88:91], a[152:155], v[60:63], v[88:91]
    buffer_load_dwordx4 v10, s[12:15], s48 offen offset:3072 sc1 lds
    v_mfma_f32_16x16x32_bf16 v[92:95], a[156:159], v[60:63], v[92:95]
    s_waitcnt lgkmcnt(4)
    v_mfma_f32_16x16x32_bf16 v[80:83], a[160:163], v[32:35], v[80:83]
    ds_read_b128 v[56:59], v13 offset:47104
    ds_read_b128 v[60:63], v13 offset:48128
    v_mfma_f32_16x16x32_bf16 v[84:87], a[164:167], v[32:35], v[84:87]
    v_mfma_f32_16x16x32_bf16 v[88:91], a[160:163], v[36:39], v[88:91]
    s_add_u32 m0, s59, 4096
    s_nop 0
    buffer_load_dwordx4 v10, s[12:15], s49 offen offset:0 sc1 lds
    v_mfma_f32_16x16x32_bf16 v[92:95], a[164:167], v[36:39], v[92:95]
    s_waitcnt lgkmcnt(4)
    v_mfma_f32_16x16x32_bf16 v[80:83], a[168:171], v[40:43], v[80:83]
    ds_read_b128 v[32:35], v13 offset:49152
    ds_read_b128 v[36:39], v13 offset:50176
    v_mfma_f32_16x16x32_bf16 v[84:87], a[172:175], v[40:43], v[84:87]
    v_mfma_f32_16x16x32_bf16 v[88:91], a[168:171], v[44:47], v[88:91]
    buffer_load_dwordx4 v10, s[12:15], s49 offen offset:1024 sc1 lds
    v_mfma_f32_16x16x32_bf16 v[92:95], a[172:175], v[44:47], v[92:95]
    s_waitcnt lgkmcnt(4)
    v_mfma_f32_16x16x32_bf16 v[80:83], a[176:179], v[48:51], v[80:83]
    ds_read_b128 v[40:43], v13 offset:51200
    ds_read_b128 v[44:47], v13 offset:52224
    v_mfma_f32_16x16x32_bf16 v[84:87], a[180:183], v[48:51], v[84:87]
    v_mfma_f32_16x16x32_bf16 v[88:91], a[176:179], v[52:55], v[88:91]
    buffer_load_dwordx4 v10, s[12:15], s49 offen offset:2048 sc1 lds
    v_mfma_f32_16x16x32_bf16 v[92:95], a[180:183], v[52:55], v[92:95]
    s_waitcnt lgkmcnt(4)
    v_mfma_f32_16x16x32_bf16 v[80:83], a[184:187], v[56:59], v[80:83]
    ds_read_b128 v[48:51], v13 offset:53248
    ds_read_b128 v[52:55], v13 offset:54272
    v_mfma_f32_16x16x32_bf16 v[84:87], a[188:191], v[56:59], v[84:87]
    v_mfma_f32_16x16x32_bf16 v[88:91], a[184:187], v[60:63], v[88:91]
    buffer_load_dwordx4 v10, s[12:15], s49 offen offset:3072 sc1 lds
    v_mfma_f32_16x16x32_bf16 v[92:95], a[188:191], v[60:63], v[92:95]
    s_waitcnt lgkmcnt(4)
    v_mfma_f32_16x16x32_bf16 v[80:83], a[192:195], v[32:35], v[80:83]
    ds_read_b128 v[56:59], v13 offset:55296
    ds_read_b128 v[60:63], v13 offset:56320
    v_mfma_f32_16x16x32_bf16 v[84:87], a[196:199], v[32:35], v[84:87]
    v_mfma_f32_16x16x32_bf16 v[88:91], a[192:195], v[36:39], v[88:91]
    v_mfma_f32_16x16x32_bf16 v[92:95], a[196:199], v[36:39], v[92:95]
    s_waitcnt lgkmcnt(4)
    v_mfma_f32_16x16x32_bf16 v[80:83], a[200:203], v[40:43], v[80:83]
    ds_read_b128 v[32:35], v13 offset:57344
    ds_read_b128 v[36:39], v13 offset:58368
    v_mfma_f32_16x16x32_bf16 v[84:87], a[204:207], v[40:43], v[84:87]
    v_mfma_f32_16x16x32_bf16 v[88:91], a[200:203], v[44:47], v[88:91]
    v_mfma_f32_16x16x32_bf16 v[92:95], a[204:207], v[44:47], v[92:95]
    s_waitcnt lgkmcnt(4)
    v_mfma_f32_16x16x32_bf16 v[80:83], a[208:211], v[48:51], v[80:83]
    ds_read_b128 v[40:43], v13 offset:59392
    ds_read_b128 v[44:47], v13 offset:60416
    v_mfma_f32_16x16x32_bf16 v[84:87], a[212:215], v[48:51], v[84:87]
    v_mfma_f32_16x16x32_bf16 v[88:91], a[208:211], v[52:55], v[88:91]
    v_mfma_f32_16x16x32_bf16 v[92:95], a[212:215], v[52:55], v[92:95]
    s_waitcnt lgkmcnt(4)
    v_mfma_f32_16x16x32_bf16 v[80:83], a[216:219], v[56:59], v[80:83]
    ds_read_b128 v[48:51], v13 offset:61440
    ds_read_b128 v[52:55], v13 offset:62464
    v_mfma_f32_16x16x32_bf16 v[84:87], a[220:223], v[56:59], v[84:87]
    v_mfma_f32_16x16x32_bf16 v[88:91], a[216:219], v[60:63], v[88:91]
    v_mfma_f32_16x16x32_bf16 v[92:95], a[220:223], v[60:63], v[92:95]
    s_waitcnt lgkmcnt(4)
    v_mfma_f32_16x16x32_bf16 v[80:83], a[224:227], v[32:35], v[80:83]
    ds_read_b128 v[56:59], v13 offset:63488
    ds_read_b128 v[60:63], v13 offset:64512
    v_mfma_f32_16x16x32_bf16 v[84:87], a[228:231], v[32:35], v[84:87]
    v_mfma_f32_16x16x32_bf16 v[88:91], a[224:227], v[36:39], v[88:91]
    v_mfma_f32_16x16x32_bf16 v[92:95], a[228:231], v[36:39], v[92:95]
    s_waitcnt lgkmcnt(4)
    v_mfma_f32_16x16x32_bf16 v[80:83], a[232:235], v[40:43], v[80:83]
    v_mfma_f32_16x16x32_bf16 v[84:87], a[236:239], v[40:43], v[84:87]
    v_mfma_f32_16x16x32_bf16 v[88:91], a[232:235], v[44:47], v[88:91]
    v_mfma_f32_16x16x32_bf16 v[92:95], a[236:239], v[44:47], v[92:95]
    s_waitcnt vmcnt(16) lgkmcnt(0)
    s_barrier
    v_mfma_f32_16x16x32_bf16 v[80:83], a[240:243], v[48:51], v[80:83]
    ds_read_b128 v[32:35], v14 offset:0
    ds_read_b128 v[36:39], v14 offset:1024
    v_mfma_f32_16x16x32_bf16 v[84:87], a[244:247], v[48:51], v[84:87]
    v_mfma_f32_16x16x32_bf16 v[88:91], a[240:243], v[52:55], v[88:91]
    v_mfma_f32_16x16x32_bf16 v[92:95], a[244:247], v[52:55], v[92:95]
    v_mfma_f32_16x16x32_bf16 v[80:83], a[248:251], v[56:59], v[80:83]
    ds_read_b128 v[40:43], v14 offset:2048
    ds_read_b128 v[44:47], v14 offset:3072
    v_mfma_f32_16x16x32_bf16 v[84:87], a[252:255], v[56:59], v[84:87]
    v_mfma_f32_16x16x32_bf16 v[88:91], a[248:251], v[60:63], v[88:91]
    v_mfma_f32_16x16x32_bf16 v[92:95], a[252:255], v[60:63], v[92:95]
    s_add_u32 s53, s53, 262144
    s_add_u32 s58, s58, 1
    v_swap_b32 v13, v14
    s_xor_b32 s54, s54, 65536
    s_xor_b32 s55, s55, 65536
    s_mov_b32 s76, s57
    v_swap_b32 v15, v16
    s_add_u32 s57, s57, 131072
    ds_write_b128 v7, v[80:83] offset:0
    ds_write_b128 v7, v[84:87] offset:64
    ds_write_b128 v7, v[88:91] offset:2304
    ds_write_b128 v7, v[92:95] offset:2368
    s_cmp_lt_u32 s58, s51
    s_cbranch_scc1 L_e_loop_141
    s_branch L_e_fin_143
L_e_one_142:
    s_waitcnt vmcnt(8)
    s_barrier
    ds_read_b128 v[32:35], v13 offset:0
    ds_read_b128 v[36:39], v13 offset:1024
    ds_read_b128 v[40:43], v13 offset:2048
    ds_read_b128 v[44:47], v13 offset:3072
    s_waitcnt lgkmcnt(2)
    v_mfma_f32_16x16x32_bf16 v[80:83], a[0:3], v[32:35], 0
    ds_read_b128 v[48:51], v13 offset:4096
    ds_read_b128 v[52:55], v13 offset:5120
    v_mfma_f32_16x16x32_bf16 v[84:87], a[4:7], v[32:35], 0
    ds_read_b128 v[56:59], v13 offset:6144
    ds_read_b128 v[60:63], v13 offset:7168
    v_mfma_f32_16x16x32_bf16 v[88:91], a[0:3], v[36:39], 0
    v_mfma_f32_16x16x32_bf16 v[92:95], a[4:7], v[36:39], 0
    s_waitcnt lgkmcnt(4)
    v_mfma_f32_16x16x32_bf16 v[80:83], a[8:11], v[40:43], v[80:83]
    ds_read_b128 v[32:35], v13 offset:8192
    ds_read_b128 v[36:39], v13 offset:9216
    v_mfma_f32_16x16x32_bf16 v[84:87], a[12:15], v[40:43], v[84:87]
    v_mfma_f32_16x16x32_bf16 v[88:91], a[8:11], v[44:47], v[88:91]
    v_mfma_f32_16x16x32_bf16 v[92:95], a[12:15], v[44:47], v[92:95]
    s_waitcnt lgkmcnt(4)
    v_mfma_f32_16x16x32_bf16 v[80:83], a[16:19], v[48:51], v[80:83]
    ds_read_b128 v[40:43], v13 offset:10240
    ds_read_b128 v[44:47], v13 offset:11264
    v_mfma_f32_16x16x32_bf16 v[84:87], a[20:23], v[48:51], v[84:87]
    v_mfma_f32_16x16x32_bf16 v[88:91], a[16:19], v[52:55], v[88:91]
    v_mfma_f32_16x16x32_bf16 v[92:95], a[20:23], v[52:55], v[92:95]
    s_waitcnt lgkmcnt(4)
    v_mfma_f32_16x16x32_bf16 v[80:83], a[24:27], v[56:59], v[80:83]
    ds_read_b128 v[48:51], v13 offset:12288
    ds_read_b128 v[52:55], v13 offset:13312
    v_mfma_f32_16x16x32_bf16 v[84:87], a[28:31], v[56:59], v[84:87]
    v_mfma_f32_16x16x32_bf16 v[88:91], a[24:27], v[60:63], v[88:91]
    v_mfma_f32_16x16x32_bf16 v[92:95], a[28:31], v[60:63], v[92:95]
    s_waitcnt lgkmcnt(4)
    v_mfma_f32_16x16x32_bf16 v[80:83], a[32:35], v[32:35], v[80:83]
    ds_read_b128 v[56:59], v13 offset:14336
    ds_read_b128 v[60:63], v13 offset:15360
    v_mfma_f32_16x16x32_bf16 v[84:87], a[36:39], v[32:35], v[84:87]
    v_mfma_f32_16x16x32_bf16 v[88:91], a[32:35], v[36:39], v[88:91]
    v_mfma_f32_16x16x32_bf16 v[92:95], a[36:39], v[36:39], v[92:95]
    s_waitcnt lgkmcnt(4)
    v_mfma_f32_16x16x32_bf16 v[80:83], a[40:43], v[40:43], v[80:83]
    ds_read_b128 v[32:35], v13 offset:16384
    ds_read_b128 v[36:39], v13 offset:17408
    v_mfma_f32_16x16x32_bf16 v[84:87], a[44:47], v[40:43], v[84:87]
    v_mfma_f32_16x16x32_bf16 v[88:91], a[40:43], v[44:47], v[88:91]
    v_mfma_f32_16x16x32_bf16 v[92:95], a[44:47], v[44:47], v[92:95]
    s_waitcnt lgkmcnt(4)
    v_mfma_f32_16x16x32_bf16 v[80:83], a[48:51], v[48:51], v[80:83]
    ds_read_b128 v[40:43], v13 offset:18432
    ds_read_b128 v[44:47], v13 offset:19456
    v_mfma_f32_16x16x32_bf16 v[84:87], a[52:55], v[48:51], v[84:87]
    v_mfma_f32_16x16x32_bf16 v[88:91], a[48:51], v[52:55], v[88:91]
    v_mfma_f32_16x16x32_bf16 v[92:95], a[52:55], v[52:55], v[92:95]
    s_waitcnt lgkmcnt(4)
    v_mfma_f32_16x16x32_bf16 v[80:83], a[56:59], v[56:59], v[80:83]
    ds_read_b128 v[48:51], v13 offset:20480
    ds_read_b128 v[52:55], v13 offset:21504
    v_mfma_f32_16x16x32_bf16 v[84:87], a[60:63], v[56:59], v[84:87]
    v_mfma_f32_16x16x32_bf16 v[88:91], a[56:59], v[60:63], v[88:91]
    v_mfma_f32_16x16x32_bf16 v[92:95], a[60:63], v[60:63], v[92:95]
    s_waitcnt lgkmcnt(4)
    v_mfma_f32_16x16x32_bf16 v[80:83], a[64:67], v[32:35], v[80:83]
    ds_read_b128 v[56:59], v13 offset:22528
    ds_read_b128 v[60:63], v13 offset:23552
    v_mfma_f32_16x16x32_bf16 v[84:87], a[68:71], v[32:35], v[84:87]
    v_mfma_f32_16x16x32_bf16 v[88:91], a[64:67], v[36:39], v[88:91]
    v_mfma_f32_16x16x32_bf16 v[92:95], a[68:71], v[36:39], v[92:95]
    s_waitcnt lgkmcnt(4)
    v_mfma_f32_16x16x32_bf16 v[80:83], a[72:75], v[40:43], v[80:83]
    ds_read_b128 v[32:35], v13 offset:24576
    ds_read_b128 v[36:39], v13 offset:25600
    v_mfma_f32_16x16x32_bf16 v[84:87], a[76:79], v[40:43], v[84:87]
    v_mfma_f32_16x16x32_bf16 v[88:91], a[72:75], v[44:47], v[88:91]
    v_mfma_f32_16x16x32_bf16 v[92:95], a[76:79], v[44:47], v[92:95]
    s_waitcnt lgkmcnt(4)
    v_mfma_f32_16x16x32_bf16 v[80:83], a[80:83], v[48:51], v[80:83]
    ds_read_b128 v[40:43], v13 offset:26624
    ds_read_b128 v[44:47], v13 offset:27648
    v_mfma_f32_16x16x32_bf16 v[84:87], a[84:87], v[48:51], v[84:87]
    v_mfma_f32_16x16x32_bf16 v[88:91], a[80:83], v[52:55], v[88:91]
    v_mfma_f32_16x16x32_bf16 v[92:95], a[84:87], v[52:55], v[92:95]
    s_waitcnt lgkmcnt(4)
    v_mfma_f32_16x16x32_bf16 v[80:83], a[88:91], v[56:59], v[80:83]
    ds_read_b128 v[48:51], v13 offset:28672
    ds_read_b128 v[52:55], v13 offset:29696
    v_mfma_f32_16x16x32_bf16 v[84:87], a[92:95], v[56:59], v[84:87]
    v_mfma_f32_16x16x32_bf16 v[88:91], a[88:91], v[60:63], v[88:91]
    v_mfma_f32_16x16x32_bf16 v[92:95], a[92:95], v[60:63], v[92:95]
    s_waitcnt lgkmcnt(4)
    v_mfma_f32_16x16x32_bf16 v[80:83], a[96:99], v[32:35], v[80:83]
    ds_read_b128 v[56:59], v13 offset:30720
    ds_read_b128 v[60:63], v13 offset:31744
    v_mfma_f32_16x16x32_bf16 v[84:87], a[100:103], v[32:35], v[84:87]
    v_mfma_f32_16x16x32_bf16 v[88:91], a[96:99], v[36:39], v[88:91]
    v_mfma_f32_16x16x32_bf16 v[92:95], a[100:103], v[36:39], v[92:95]
    s_waitcnt lgkmcnt(4)
    v_mfma_f32_16x16x32_bf16 v[80:83], a[104:107], v[40:43], v[80:83]
    v_mfma_f32_16x16x32_bf16 v[84:87], a[108:111], v[40:43], v[84:87]
    v_mfma_f32_16x16x32_bf16 v[88:91], a[104:107], v[44:47], v[88:91]
    v_mfma_f32_16x16x32_bf16 v[92:95], a[108:111], v[44:47], v[92:95]
    s_waitcnt vmcnt(0) lgkmcnt(0)
    s_barrier
    v_mfma_f32_16x16x32_bf16 v[80:83], a[112:115], v[48:51], v[80:83]
    ds_read_b128 v[32:35], v13 offset:32768
    ds_read_b128 v[36:39], v13 offset:33792
    v_mfma_f32_16x16x32_bf16 v[84:87], a[116:119], v[48:51], v[84:87]
    v_mfma_f32_16x16x32_bf16 v[88:91], a[112:115], v[52:55], v[88:91]
    v_mfma_f32_16x16x32_bf16 v[92:95], a[116:119], v[52:55], v[92:95]
    v_mfma_f32_16x16x32_bf16 v[80:83], a[120:123], v[56:59], v[80:83]
    ds_read_b128 v[40:43], v13 offset:34816
    ds_read_b128 v[44:47], v13 offset:35840
    v_mfma_f32_16x16x32_bf16 v[84:87], a[124:127], v[56:59], v[84:87]
    v_mfma_f32_16x16x32_bf16 v[88:91], a[120:123], v[60:63], v[88:91]
    v_mfma_f32_16x16x32_bf16 v[92:95], a[124:127], v[60:63], v[92:95]
    s_waitcnt lgkmcnt(2)
    v_mfma_f32_16x16x32_bf16 v[80:83], a[128:131], v[32:35], v[80:83]
    ds_read_b128 v[48:51], v13 offset:36864
    ds_read_b128 v[52:55], v13 offset:37888
    v_mfma_f32_16x16x32_bf16 v[84:87], a[132:135], v[32:35], v[84:87]
    ds_read_b128 v[56:59], v13 offset:38912
    ds_read_b128 v[60:63], v13 offset:39936
    v_mfma_f32_16x16x32_bf16 v[88:91], a[128:131], v[36:39], v[88:91]
    v_mfma_f32_16x16x32_bf16 v[92:95], a[132:135], v[36:39], v[92:95]
    s_waitcnt lgkmcnt(4)
    v_mfma_f32_16x16x32_bf16 v[80:83], a[136:139], v[40:43], v[80:83]
    ds_read_b128 v[32:35], v13 offset:40960
    ds_read_b128 v[36:39], v13 offset:41984
    v_mfma_f32_16x16x32_bf16 v[84:87], a[140:143], v[40:43], v[84:87]
    v_mfma_f32_16x16x32_bf16 v[88:91], a[136:139], v[44:47], v[88:91]
    v_mfma_f32_16x16x32_bf16 v[92:95], a[140:143], v[44:47], v[92:95]
    s_waitcnt lgkmcnt(4)
    v_mfma_f32_16x16x32_bf16 v[80:83], a[144:147], v[48:51], v[80:83]
    ds_read_b128 v[40:43], v13 offset:43008
    ds_read_b128 v[44:47], v13 offset:44032
    v_mfma_f32_16x16x32_bf16 v[84:87], a[148:151], v[48:51], v[84:87]
    v_mfma_f32_16x16x32_bf16 v[88:91], a[144:147], v[52:55], v[88:91]
    v_mfma_f32_16x16x32_bf16 v[92:95], a[148:151], v[52:55], v[92:95]
    s_waitcnt lgkmcnt(4)
    v_mfma_f32_16x16x32_bf16 v[80:83], a[152:155], v[56:59], v[80:83]
    ds_read_b128 v[48:51], v13 offset:45056
    ds_read_b128 v[52:55], v13 offset:46080
    v_mfma_f32_16x16x32_bf16 v[84:87], a[156:159], v[56:59], v[84:87]
    v_mfma_f32_16x16x32_bf16 v[88:91], a[152:155], v[60:63], v[88:91]
    v_mfma_f32_16x16x32_bf16 v[92:95], a[156:159], v[60:63], v[92:95]
    s_waitcnt lgkmcnt(4)
    v_mfma_f32_16x16x32_bf16 v[80:83], a[160:163], v[32:35], v[80:83]
    ds_read_b128 v[56:59], v13 offset:47104
    ds_read_b128 v[60:63], v13 offset:48128
    v_mfma_f32_16x16x32_bf16 v[84:87], a[164:167], v[32:35], v[84:87]
    v_mfma_f32_16x16x32_bf16 v[88:91], a[160:163], v[36:39], v[88:91]
    v_mfma_f32_16x16x32_bf16 v[92:95], a[164:167], v[36:39], v[92:95]
    s_waitcnt lgkmcnt(4)
    v_mfma_f32_16x16x32_bf16 v[80:83], a[168:171], v[40:43], v[80:83]
    ds_read_b128 v[32:35], v13 offset:49152
    ds_read_b128 v[36:39], v13 offset:50176
    v_mfma_f32_16x16x32_bf16 v[84:87], a[172:175], v[40:43], v[84:87]
    v_mfma_f32_16x16x32_bf16 v[88:91], a[168:171], v[44:47], v[88:91]
    v_mfma_f32_16x16x32_bf16 v[92:95], a[172:175], v[44:47], v[92:95]
    s_waitcnt lgkmcnt(4)
    v_mfma_f32_16x16x32_bf16 v[80:83], a[176:179], v[48:51], v[80:83]
    ds_read_b128 v[40:43], v13 offset:51200
    ds_read_b128 v[44:47], v13 offset:52224
    v_mfma_f32_16x16x32_bf16 v[84:87], a[180:183], v[48:51], v[84:87]
    v_mfma_f32_16x16x32_bf16 v[88:91], a[176:179], v[52:55], v[88:91]
    v_mfma_f32_16x16x32_bf16 v[92:95], a[180:183], v[52:55], v[92:95]
    s_waitcnt lgkmcnt(4)
    v_mfma_f32_16x16x32_bf16 v[80:83], a[184:187], v[56:59], v[80:83]
    ds_read_b128 v[48:51], v13 offset:53248
    ds_read_b128 v[52:55], v13 offset:54272
    v_mfma_f32_16x16x32_bf16 v[84:87], a[188:191], v[56:59], v[84:87]
    v_mfma_f32_16x16x32_bf16 v[88:91], a[184:187], v[60:63], v[88:91]
    v_mfma_f32_16x16x32_bf16 v[92:95], a[188:191], v[60:63], v[92:95]
    s_waitcnt lgkmcnt(4)
    v_mfma_f32_16x16x32_bf16 v[80:83], a[192:195], v[32:35], v[80:83]
    ds_read_b128 v[56:59], v13 offset:55296
    ds_read_b128 v[60:63], v13 offset:56320
    v_mfma_f32_16x16x32_bf16 v[84:87], a[196:199], v[32:35], v[84:87]
    v_mfma_f32_16x16x32_bf16 v[88:91], a[192:195], v[36:39], v[88:91]
    v_mfma_f32_16x16x32_bf16 v[92:95], a[196:199], v[36:39], v[92:95]
    s_waitcnt lgkmcnt(4)
    v_mfma_f32_16x16x32_bf16 v[80:83], a[200:203], v[40:43], v[80:83]
    ds_read_b128 v[32:35], v13 offset:57344
    ds_read_b128 v[36:39], v13 offset:58368
    v_mfma_f32_16x16x32_bf16 v[84:87], a[204:207], v[40:43], v[84:87]
    v_mfma_f32_16x16x32_bf16 v[88:91], a[200:203], v[44:47], v[88:91]
    v_mfma_f32_16x16x32_bf16 v[92:95], a[204:207], v[44:47], v[92:95]
    s_waitcnt lgkmcnt(4)
    v_mfma_f32_16x16x32_bf16 v[80:83], a[208:211], v[48:51], v[80:83]
    ds_read_b128 v[40:43], v13 offset:59392
    ds_read_b128 v[44:47], v13 offset:60416
    v_mfma_f32_16x16x32_bf16 v[84:87], a[212:215], v[48:51], v[84:87]
    v_mfma_f32_16x16x32_bf16 v[88:91], a[208:211], v[52:55], v[88:91]
    v_mfma_f32_16x16x32_bf16 v[92:95], a[212:215], v[52:55], v[92:95]
    s_waitcnt lgkmcnt(4)
    v_mfma_f32_16x16x32_bf16 v[80:83], a[216:219], v[56:59], v[80:83]
    ds_read_b128 v[48:51], v13 offset:61440
    ds_read_b128 v[52:55], v13 offset:62464
    v_mfma_f32_16x16x32_bf16 v[84:87], a[220:223], v[56:59], v[84:87]
    v_mfma_f32_16x16x32_bf16 v[88:91], a[216:219], v[60:63], v[88:91]
    v_mfma_f32_16x16x32_bf16 v[92:95], a[220:223], v[60:63], v[92:95]
    s_waitcnt lgkmcnt(4)
    v_mfma_f32_16x16x32_bf16 v[80:83], a[224:227], v[32:35], v[80:83]
    ds_read_b128 v[56:59], v13 offset:63488
    ds_read_b128 v[60:63], v13 offset:64512
    v_mfma_f32_16x16x32_bf16 v[84:87], a[228:231], v[32:35], v[84:87]
    v_mfma_f32_16x16x32_bf16 v[88:91], a[224:227], v[36:39], v[88:91]
    v_mfma_f32_16x16x32_bf16 v[92:95], a[228:231], v[36:39], v[92:95]
    s_waitcnt lgkmcnt(4)
    v_mfma_f32_16x16x32_bf16 v[80:83], a[232:235], v[40:43], v[80:83]
    v_mfma_f32_16x16x32_bf16 v[84:87], a[236:239], v[40:43], v[84:87]
    v_mfma_f32_16x16x32_bf16 v[88:91], a[232:235], v[44:47], v[88:91]
    v_mfma_f32_16x16x32_bf16 v[92:95], a[236:239], v[44:47], v[92:95]
    s_waitcnt lgkmcnt(0)
    v_mfma_f32_16x16x32_bf16 v[80:83], a[240:243], v[48:51], v[80:83]
    v_mfma_f32_16x16x32_bf16 v[84:87], a[244:247], v[48:51], v[84:87]
    v_mfma_f32_16x16x32_bf16 v[88:91], a[240:243], v[52:55], v[88:91]
    v_mfma_f32_16x16x32_bf16 v[92:95], a[244:247], v[52:55], v[92:95]
    v_mfma_f32_16x16x32_bf16 v[80:83], a[248:251], v[56:59], v[80:83]
    v_mfma_f32_16x16x32_bf16 v[84:87], a[252:255], v[56:59], v[84:87]
    v_mfma_f32_16x16x32_bf16 v[88:91], a[248:251], v[60:63], v[88:91]
    v_mfma_f32_16x16x32_bf16 v[92:95], a[252:255], v[60:63], v[92:95]
    s_mov_b32 s76, s57
    s_nop 6
    ds_write_b128 v7, v[80:83] offset:0
    ds_write_b128 v7, v[84:87] offset:64
    ds_write_b128 v7, v[88:91] offset:2304
    ds_write_b128 v7, v[92:95] offset:2368
L_e_fin_143:
    s_waitcnt lgkmcnt(0)
    ds_read_b128 v[216:219], v8 offset:0
    ds_read_b128 v[220:223], v8 offset:1152
    ds_read_b128 v[224:227], v8 offset:2304
    ds_read_b128 v[228:231], v8 offset:3456
    s_waitcnt lgkmcnt(0)
    buffer_store_dwordx4 v[216:219], v11, s[12:15], s76 offen sc1
    s_add_u32 s76, s76, 32768
    buffer_store_dwordx4 v[220:223], v11, s[12:15], s76 offen sc1
    s_add_u32 s76, s76, 32768
    buffer_store_dwordx4 v[224:227], v11, s[12:15], s76 offen sc1
    s_add_u32 s76, s76, 32768
    buffer_store_dwordx4 v[228:231], v11, s[12:15], s76 offen sc1
    s_waitcnt vmcnt(0)
    s_barrier
    s_cmp_lg_u32 s44, 0
    s_cbranch_scc1 L_pub_144
    v_mov_b32 v30, s62
    v_mov_b32 v31, 0
    s_mov_b64 exec, 1
    buffer_store_dword v30, v31, s[12:15], s67 offen sc1
    s_mov_b64 exec, -1
L_pub_144:
    s_branch L_a_loop_127
L_role_b_123:
    s_load_dwordx2 s[6:7], s[0:1], 64
    s_load_dwordx2 s[8:9], s[0:1], 72
    s_waitcnt lgkmcnt(0)
    s_mov_b32 s24, s6
    s_and_b32 s25, s7, 0xffff
    s_mov_b32 s26, 0x700000
    s_mov_b32 s27, 0x00020000
    s_mov_b32 s32, s8
    s_and_b32 s33, s9, 0xffff
    s_mov_b32 s34, 0x1c00
    s_mov_b32 s35, 0x00020000
    s_min_u32 s45, s41, 27
    s_lshl_b32 s46, s45, 8
    s_waitcnt vmcnt(0)
    s_barrier
    v_lshrrev_b32 v20, 4, v1
    s_lshl_b32 s45, s44, 2
    v_add_u32 v21, s45, v20
    s_mov_b32 s45, 7168
    v_mul_lo_u32 v21, v21, s45
    v_lshlrev_b32 v22, 2, v20
    v_and_b32 v23, 15, v1
    v_xor_b32 v22, v22, v23
    v_lshlrev_b32 v22, 4, v22
    v_add_u32 v21, v21, v22
    v_bfe_u32 v22, v1, 2, 2
    v_lshlrev_b32 v23, 3, v20
    v_add_u32 v23, v23, v22
    v_lshlrev_b32 v23, 8, v23
    v_xor_b32 v22, s44, v22
    v_lshlrev_b32 v22, 6, v22
    v_add_u32 v23, v23, v22
    v_and_b32 v22, 3, v1
    v_lshlrev_b32 v22, 4, v22
    v_add_u32 v23, v23, v22
    v_add_u32 v24, 65536, v23
    v_add_u32 v25, 131072, v23
    s_lshl_b32 s47, s44, 10
    s_add_u32 s45, s46, 0x0
    s_add_u32 m0, s47, 0
    s_nop 0
    buffer_load_dwordx4 v21, s[24:27], s45 offen  lds
    s_add_u32 s45, s46, 0x1c000
    s_add_u32 m0, s47, 4096
    s_nop 0
    buffer_load_dwordx4 v21, s[24:27], s45 offen  lds
    s_add_u32 s45, s46, 0x38000
    s_add_u32 m0, s47, 8192
    s_nop 0
    buffer_load_dwordx4 v21, s[24:27], s45 offen  lds
    s_add_u32 s45, s46, 0x54000
    s_add_u32 m0, s47, 12288
    s_nop 0
    buffer_load_dwordx4 v21, s[24:27], s45 offen  lds
    s_add_u32 s45, s46, 0x70000
    s_add_u32 m0, s47, 16384
    s_nop 0
    buffer_load_dwordx4 v21, s[24:27], s45 offen  lds
    s_add_u32 s45, s46, 0x8c000
    s_add_u32 m0, s47, 20480
    s_nop 0
    buffer_load_dwordx4 v21, s[24:27], s45 offen  lds
    s_add_u32 s45, s46, 0xa8000
    s_add_u32 m0, s47, 24576
    s_nop 0
    buffer_load_dwordx4 v21, s[24:27], s45 offen  lds
    s_add_u32 s45, s46, 0xc4000
    s_add_u32 m0, s47, 28672
    s_nop 0
    buffer_load_dwordx4 v21, s[24:27], s45 offen  lds
    s_add_u32 s45, s46, 0xe0000
    s_add_u32 m0, s47, 32768
    s_nop 0
    buffer_load_dwordx4 v21, s[24:27], s45 offen  lds
    s_add_u32 s45, s46, 0xfc000
    s_add_u32 m0, s47, 36864
    s_nop 0
    buffer_load_dwordx4 v21, s[24:27], s45 offen  lds
    s_add_u32 s45, s46, 0x118000
    s_add_u32 m0, s47, 40960
    s_nop 0
    buffer_load_dwordx4 v21, s[24:27], s45 offen  lds
    s_add_u32 s45, s46, 0x134000
    s_add_u32 m0, s47, 45056
    s_nop 0
    buffer_load_dwordx4 v21, s[24:27], s45 offen  lds
    s_add_u32 s45, s46, 0x150000
    s_add_u32 m0, s47, 49152
    s_nop 0
    buffer_load_dwordx4 v21, s[24:27], s45 offen  lds
    s_add_u32 s45, s46, 0x16c000
    s_add_u32 m0, s47, 53248
    s_nop 0
    buffer_load_dwordx4 v21, s[24:27], s45 offen  lds
    s_add_u32 s45, s46, 0x188000
    s_add_u32 m0, s47, 57344
    s_nop 0
    buffer_load_dwordx4 v21, s[24:27], s45 offen  lds
    s_add_u32 s45, s46, 0x1a4000
    s_add_u32 m0, s47, 61440
    s_nop 0
    buffer_load_dwordx4 v21, s[24:27], s45 offen  lds
    s_add_u32 s45, s46, 0x1c0000
    s_add_u32 m0, s47, 65536
    s_nop 0
    buffer_load_dwordx4 v21, s[24:27], s45 offen  lds
    s_add_u32 s45, s46, 0x1dc000
    s_add_u32 m0, s47, 69632
    s_nop 0
    buffer_load_dwordx4 v21, s[24:27], s45 offen  lds
    s_add_u32 s45, s46, 0x1f8000
    s_add_u32 m0, s47, 73728
    s_nop 0
    buffer_load_dwordx4 v21, s[24:27], s45 offen  lds
    s_add_u32 s45, s46, 0x214000
    s_add_u32 m0, s47, 77824
    s_nop 0
    buffer_load_dwordx4 v21, s[24:27], s45 offen  lds
    s_add_u32 s45, s46, 0x230000
    s_add_u32 m0, s47, 81920
    s_nop 0
    buffer_load_dwordx4 v21, s[24:27], s45 offen  lds
    s_add_u32 s45, s46, 0x24c000
    s_add_u32 m0, s47, 86016
    s_nop 0
    buffer_load_dwordx4 v21, s[24:27], s45 offen  lds
    s_add_u32 s45, s46, 0x268000
    s_add_u32 m0, s47, 90112
    s_nop 0
    buffer_load_dwordx4 v21, s[24:27], s45 offen  lds
    s_add_u32 s45, s46, 0x284000
    s_add_u32 m0, s47, 94208
    s_nop 0
    buffer_load_dwordx4 v21, s[24:27], s45 offen  lds
    s_add_u32 s45, s46, 0x2a0000
    s_add_u32 m0, s47, 98304
    s_nop 0
    buffer_load_dwordx4 v21, s[24:27], s45 offen  lds
    s_add_u32 s45, s46, 0x2bc000
    s_add_u32 m0, s47, 102400
    s_nop 0
    buffer_load_dwordx4 v21, s[24:27], s45 offen  lds
    s_add_u32 s45, s46, 0x2d8000
    s_add_u32 m0, s47, 106496
    s_nop 0
    buffer_load_dwordx4 v21, s[24:27], s45 offen  lds
    s_add_u32 s45, s46, 0x2f4000
    s_add_u32 m0, s47, 110592
    s_nop 0
    buffer_load_dwordx4 v21, s[24:27], s45 offen  lds
    s_add_u32 s45, s46, 0x310000
    s_add_u32 m0, s47, 114688
    s_nop 0
    buffer_load_dwordx4 v21, s[24:27], s45 offen  lds
    s_add_u32 s45, s46, 0x32c000
    s_add_u32 m0, s47, 118784
    s_nop 0
    buffer_load_dwordx4 v21, s[24:27], s45 offen  lds
    s_add_u32 s45, s46, 0x348000
    s_add_u32 m0, s47, 122880
    s_nop 0
    buffer_load_dwordx4 v21, s[24:27], s45 offen  lds
    s_add_u32 s45, s46, 0x364000
    s_add_u32 m0, s47, 126976
    s_nop 0
    buffer_load_dwordx4 v21, s[24:27], s45 offen  lds
    s_waitcnt vmcnt(28)
    s_barrier
    s_add_u32 s45, s46, 0x380000
    s_add_u32 m0, s47, 131072
    s_nop 0
    buffer_load_dwordx4 v21, s[24:27], s45 offen  lds
    s_add_u32 s45, s46, 0x39c000
    s_add_u32 m0, s47, 135168
    s_nop 0
    buffer_load_dwordx4 v21, s[24:27], s45 offen  lds
    s_add_u32 s45, s46, 0x3b8000
    s_add_u32 m0, s47, 139264
    s_nop 0
    buffer_load_dwordx4 v21, s[24:27], s45 offen  lds
    s_add_u32 s45, s46, 0x3d4000
    s_add_u32 m0, s47, 143360
    s_nop 0
    buffer_load_dwordx4 v21, s[24:27], s45 offen  lds
    ds_read_b64_tr_b16 a[0:1], v23 offset:0
    ds_read_b64_tr_b16 a[2:3], v23 offset:1024
    ds_read_b64_tr_b16 a[4:5], v23 offset:8
    ds_read_b64_tr_b16 a[6:7], v23 offset:1032
    ds_read_b64_tr_b16 a[8:9], v23 offset:8192
    ds_read_b64_tr_b16 a[10:11], v23 offset:9216
    ds_read_b64_tr_b16 a[12:13], v23 offset:8200
    ds_read_b64_tr_b16 a[14:15], v23 offset:9224
    s_waitcnt lgkmcnt(0)
    s_waitcnt vmcnt(28)
    s_barrier
    s_add_u32 s45, s46, 0x3f0000
    s_add_u32 m0, s47, 0
    s_nop 0
    buffer_load_dwordx4 v21, s[24:27], s45 offen  lds
    s_add_u32 s45, s46, 0x40c000
    s_add_u32 m0, s47, 4096
    s_nop 0
    buffer_load_dwordx4 v21, s[24:27], s45 offen  lds
    s_add_u32 s45, s46, 0x428000
    s_add_u32 m0, s47, 8192
    s_nop 0
    buffer_load_dwordx4 v21, s[24:27], s45 offen  lds
    s_add_u32 s45, s46, 0x444000
    s_add_u32 m0, s47, 12288
    s_nop 0
    buffer_load_dwordx4 v21, s[24:27], s45 offen  lds
    ds_read_b64_tr_b16 a[16:17], v23 offset:16384
    ds_read_b64_tr_b16 a[18:19], v23 offset:17408
    ds_read_b64_tr_b16 a[20:21], v23 offset:16392
    ds_read_b64_tr_b16 a[22:23], v23 offset:17416
    ds_read_b64_tr_b16 a[24:25], v23 offset:24576
    ds_read_b64_tr_b16 a[26:27], v23 offset:25600
    ds_read_b64_tr_b16 a[28:29], v23 offset:24584
    ds_read_b64_tr_b16 a[30:31], v23 offset:25608
    s_waitcnt lgkmcnt(0)
    s_waitcnt vmcnt(28)
    s_barrier
    s_add_u32 s45, s46, 0x460000
    s_add_u32 m0, s47, 16384
    s_nop 0
    buffer_load_dwordx4 v21, s[24:27], s45 offen  lds
    s_add_u32 s45, s46, 0x47c000
    s_add_u32 m0, s47, 20480
    s_nop 0
    buffer_load_dwordx4 v21, s[24:27], s45 offen  lds
    s_add_u32 s45, s46, 0x498000
    s_add_u32 m0, s47, 24576
    s_nop 0
    buffer_load_dwordx4 v21, s[24:27], s45 offen  lds
    s_add_u32 s45, s46, 0x4b4000
    s_add_u32 m0, s47, 28672
    s_nop 0
    buffer_load_dwordx4 v21, s[24:27], s45 offen  lds
    ds_read_b64_tr_b16 a[32:33], v23 offset:32768
    ds_read_b64_tr_b16 a[34:35], v23 offset:33792
    ds_read_b64_tr_b16 a[36:37], v23 offset:32776
    ds_read_b64_tr_b16 a[38:39], v23 offset:33800
    ds_read_b64_tr_b16 a[40:41], v23 offset:40960
    ds_read_b64_tr_b16 a[42:43], v23 offset:41984
    ds_read_b64_tr_b16 a[44:45], v23 offset:40968
    ds_read_b64_tr_b16 a[46:47], v23 offset:41992
    s_waitcnt lgkmcnt(0)
    s_waitcnt vmcnt(28)
    s_barrier
    s_add_u32 s45, s46, 0x4d0000
    s_add_u32 m0, s47, 32768
    s_nop 0
    buffer_load_dwordx4 v21, s[24:27], s45 offen  lds
    s_add_u32 s45, s46, 0x4ec000
    s_add_u32 m0, s47, 36864
    s_nop 0
    buffer_load_dwordx4 v21, s[24:27], s45 offen  lds
    s_add_u32 s45, s46, 0x508000
    s_add_u32 m0, s47, 40960
    s_nop 0
    buffer_load_dwordx4 v21, s[24:27], s45 offen  lds
    s_add_u32 s45, s46, 0x524000
    s_add_u32 m0, s47, 45056
    s_nop 0
    buffer_load_dwordx4 v21, s[24:27], s45 offen  lds
    ds_read_b64_tr_b16 a[48:49], v23 offset:49152
    ds_read_b64_tr_b16 a[50:51], v23 offset:50176
    ds_read_b64_tr_b16 a[52:53], v23 offset:49160
    ds_read_b64_tr_b16 a[54:55], v23 offset:50184
    ds_read_b64_tr_b16 a[56:57], v23 offset:57344
    ds_read_b64_tr_b16 a[58:59], v23 offset:58368
    ds_read_b64_tr_b16 a[60:61], v23 offset:57352
    ds_read_b64_tr_b16 a[62:63], v23 offset:58376
    s_waitcnt lgkmcnt(0)
    s_waitcnt vmcnt(28)
    s_barrier
    s_add_u32 s45, s46, 0x540000
    s_add_u32 m0, s47, 49152
    s_nop 0
    buffer_load_dwordx4 v21, s[24:27], s45 offen  lds
    s_add_u32 s45, s46, 0x55c000
    s_add_u32 m0, s47, 53248
    s_nop 0
    buffer_load_dwordx4 v21, s[24:27], s45 offen  lds
    s_add_u32 s45, s46, 0x578000
    s_add_u32 m0, s47, 57344
    s_nop 0
    buffer_load_dwordx4 v21, s[24:27], s45 offen  lds
    s_add_u32 s45, s46, 0x594000
    s_add_u32 m0, s47, 61440
    s_nop 0
    buffer_load_dwordx4 v21, s[24:27], s45 offen  lds
    ds_read_b64_tr_b16 a[64:65], v24 offset:0
    ds_read_b64_tr_b16 a[66:67], v24 offset:1024
    ds_read_b64_tr_b16 a[68:69], v24 offset:8
    ds_read_b64_tr_b16 a[70:71], v24 offset:1032
    ds_read_b64_tr_b16 a[72:73], v24 offset:8192
    ds_read_b64_tr_b16 a[74:75], v24 offset:9216
    ds_read_b64_tr_b16 a[76:77], v24 offset:8200
    ds_read_b64_tr_b16 a[78:79], v24 offset:9224
    s_waitcnt lgkmcnt(0)
    s_waitcnt vmcnt(28)
    s_barrier
    s_add_u32 s45, s46, 0x5b0000
    s_add_u32 m0, s47, 65536
    s_nop 0
    buffer_load_dwordx4 v21, s[24:27], s45 offen  lds
    s_add_u32 s45, s46, 0x5cc000
    s_add_u32 m0, s47, 69632
    s_nop 0
    buffer_load_dwordx4 v21, s[24:27], s45 offen  lds
    s_add_u32 s45, s46, 0x5e8000
    s_add_u32 m0, s47, 73728
    s_nop 0
    buffer_load_dwordx4 v21, s[24:27], s45 offen  lds
    s_add_u32 s45, s46, 0x604000
    s_add_u32 m0, s47, 77824
    s_nop 0
    buffer_load_dwordx4 v21, s[24:27], s45 offen  lds
    ds_read_b64_tr_b16 a[80:81], v24 offset:16384
    ds_read_b64_tr_b16 a[82:83], v24 offset:17408
    ds_read_b64_tr_b16 a[84:85], v24 offset:16392
    ds_read_b64_tr_b16 a[86:87], v24 offset:17416
    ds_read_b64_tr_b16 a[88:89], v24 offset:24576
    ds_read_b64_tr_b16 a[90:91], v24 offset:25600
    ds_read_b64_tr_b16 a[92:93], v24 offset:24584
    ds_read_b64_tr_b16 a[94:95], v24 offset:25608
    s_waitcnt lgkmcnt(0)
    s_waitcnt vmcnt(28)
    s_barrier
    s_add_u32 s45, s46, 0x620000
    s_add_u32 m0, s47, 81920
    s_nop 0
    buffer_load_dwordx4 v21, s[24:27], s45 offen  lds
    s_add_u32 s45, s46, 0x63c000
    s_add_u32 m0, s47, 86016
    s_nop 0
    buffer_load_dwordx4 v21, s[24:27], s45 offen  lds
    s_add_u32 s45, s46, 0x658000
    s_add_u32 m0, s47, 90112
    s_nop 0
    buffer_load_dwordx4 v21, s[24:27], s45 offen  lds
    s_add_u32 s45, s46, 0x674000
    s_add_u32 m0, s47, 94208
    s_nop 0
    buffer_load_dwordx4 v21, s[24:27], s45 offen  lds
    ds_read_b64_tr_b16 a[96:97], v24 offset:32768
    ds_read_b64_tr_b16 a[98:99], v24 offset:33792
    ds_read_b64_tr_b16 a[100:101], v24 offset:32776
    ds_read_b64_tr_b16 a[102:103], v24 offset:33800
    ds_read_b64_tr_b16 a[104:105], v24 offset:40960
    ds_read_b64_tr_b16 a[106:107], v24 offset:41984
    ds_read_b64_tr_b16 a[108:109], v24 offset:40968
    ds_read_b64_tr_b16 a[110:111], v24 offset:41992
    s_waitcnt lgkmcnt(0)
    s_waitcnt vmcnt(28)
    s_barrier
    s_add_u32 s45, s46, 0x690000
    s_add_u32 m0, s47, 98304
    s_nop 0
    buffer_load_dwordx4 v21, s[24:27], s45 offen  lds
    s_add_u32 s45, s46, 0x6ac000
    s_add_u32 m0, s47, 102400
    s_nop 0
    buffer_load_dwordx4 v21, s[24:27], s45 offen  lds
    s_add_u32 s45, s46, 0x6c8000
    s_add_u32 m0, s47, 106496
    s_nop 0
    buffer_load_dwordx4 v21, s[24:27], s45 offen  lds
    s_add_u32 s45, s46, 0x6e4000
    s_add_u32 m0, s47, 110592
    s_nop 0
    buffer_load_dwordx4 v21, s[24:27], s45 offen  lds
    ds_read_b64_tr_b16 a[112:113], v24 offset:49152
    ds_read_b64_tr_b16 a[114:115], v24 offset:50176
    ds_read_b64_tr_b16 a[116:117], v24 offset:49160
    ds_read_b64_tr_b16 a[118:119], v24 offset:50184
    ds_read_b64_tr_b16 a[120:121], v24 offset:57344
    ds_read_b64_tr_b16 a[122:123], v24 offset:58368
    ds_read_b64_tr_b16 a[124:125], v24 offset:57352
    ds_read_b64_tr_b16 a[126:127], v24 offset:58376
    s_waitcnt lgkmcnt(0)
    s_waitcnt vmcnt(28)
    s_barrier
    ds_read_b64_tr_b16 a[128:129], v25 offset:0
    ds_read_b64_tr_b16 a[130:131], v25 offset:1024
    ds_read_b64_tr_b16 a[132:133], v25 offset:8
    ds_read_b64_tr_b16 a[134:135], v25 offset:1032
    ds_read_b64_tr_b16 a[136:137], v25 offset:8192
    ds_read_b64_tr_b16 a[138:139], v25 offset:9216
    ds_read_b64_tr_b16 a[140:141], v25 offset:8200
    ds_read_b64_tr_b16 a[142:143], v25 offset:9224
    s_waitcnt lgkmcnt(0)
    s_waitcnt vmcnt(24)
    s_barrier
    ds_read_b64_tr_b16 a[144:145], v23 offset:0
    ds_read_b64_tr_b16 a[146:147], v23 offset:1024
    ds_read_b64_tr_b16 a[148:149], v23 offset:8
    ds_read_b64_tr_b16 a[150:151], v23 offset:1032
    ds_read_b64_tr_b16 a[152:153], v23 offset:8192
    ds_read_b64_tr_b16 a[154:155], v23 offset:9216
    ds_read_b64_tr_b16 a[156:157], v23 offset:8200
    ds_read_b64_tr_b16 a[158:159], v23 offset:9224
    s_waitcnt lgkmcnt(0)
    s_waitcnt vmcnt(20)
    s_barrier
    ds_read_b64_tr_b16 a[160:161], v23 offset:16384
    ds_read_b64_tr_b16 a[162:163], v23 offset:17408
    ds_read_b64_tr_b16 a[164:165], v23 offset:16392
    ds_read_b64_tr_b16 a[166:167], v23 offset:17416
    ds_read_b64_tr_b16 a[168:169], v23 offset:24576
    ds_read_b64_tr_b16 a[170:171], v23 offset:25600
    ds_read_b64_tr_b16 a[172:173], v23 offset:24584
    ds_read_b64_tr_b16 a[174:175], v23 offset:25608
    s_waitcnt lgkmcnt(0)
    s_waitcnt vmcnt(16)
    s_barrier
    ds_read_b64_tr_b16 a[176:177], v23 offset:32768
    ds_read_b64_tr_b16 a[178:179], v23 offset:33792
    ds_read_b64_tr_b16 a[180:181], v23 offset:32776
    ds_read_b64_tr_b16 a[182:183], v23 offset:33800
    ds_read_b64_tr_b16 a[184:185], v23 offset:40960
    ds_read_b64_tr_b16 a[186:187], v23 offset:41984
    ds_read_b64_tr_b16 a[188:189], v23 offset:40968
    ds_read_b64_tr_b16 a[190:191], v23 offset:41992
    s_waitcnt lgkmcnt(0)
    s_waitcnt vmcnt(12)
    s_barrier
    ds_read_b64_tr_b16 a[192:193], v23 offset:49152
    ds_read_b64_tr_b16 a[194:195], v23 offset:50176
    ds_read_b64_tr_b16 a[196:197], v23 offset:49160
    ds_read_b64_tr_b16 a[198:199], v23 offset:50184
    ds_read_b64_tr_b16 a[200:201], v23 offset:57344
    ds_read_b64_tr_b16 a[202:203], v23 offset:58368
    ds_read_b64_tr_b16 a[204:205], v23 offset:57352
    ds_read_b64_tr_b16 a[206:207], v23 offset:58376
    s_waitcnt lgkmcnt(0)
    s_waitcnt vmcnt(8)
    s_barrier
    ds_read_b64_tr_b16 a[208:209], v24 offset:0
    ds_read_b64_tr_b16 a[210:211], v24 offset:1024
    ds_read_b64_tr_b16 a[212:213], v24 offset:8
    ds_read_b64_tr_b16 a[214:215], v24 offset:1032
    ds_read_b64_tr_b16 a[216:217], v24 offset:8192
    ds_read_b64_tr_b16 a[218:219], v24 offset:9216
    ds_read_b64_tr_b16 a[220:221], v24 offset:8200
    ds_read_b64_tr_b16 a[222:223], v24 offset:9224
    s_waitcnt lgkmcnt(0)
    s_waitcnt vmcnt(4)
    s_barrier
    ds_read_b64_tr_b16 a[224:225], v24 offset:16384
    ds_read_b64_tr_b16 a[226:227], v24 offset:17408
    ds_read_b64_tr_b16 a[228:229], v24 offset:16392
    ds_read_b64_tr_b16 a[230:231], v24 offset:17416
    ds_read_b64_tr_b16 a[232:233], v24 offset:24576
    ds_read_b64_tr_b16 a[234:235], v24 offset:25600
    ds_read_b64_tr_b16 a[236:237], v24 offset:24584
    ds_read_b64_tr_b16 a[238:239], v24 offset:25608
    s_waitcnt lgkmcnt(0)
    s_waitcnt vmcnt(0)
    s_barrier
    ds_read_b64_tr_b16 a[240:241], v24 offset:32768
    ds_read_b64_tr_b16 a[242:243], v24 offset:33792
    ds_read_b64_tr_b16 a[244:245], v24 offset:32776
    ds_read_b64_tr_b16 a[246:247], v24 offset:33800
    ds_read_b64_tr_b16 a[248:249], v24 offset:40960
    ds_read_b64_tr_b16 a[250:251], v24 offset:41984
    ds_read_b64_tr_b16 a[252:253], v24 offset:40968
    ds_read_b64_tr_b16 a[254:255], v24 offset:41992
    s_waitcnt lgkmcnt(0)
    s_barrier
    s_min_u32 s45, s41, 27
    s_lshl_b32 s45, s45, 8
    s_lshl_b32 s46, s44, 6
    s_add_u32 s45, s45, s46
    v_lshrrev_b32 v29, 4, v1
    v_lshlrev_b32 v29, 4, v29
    buffer_load_dwordx4 v[80:83], v29, s[32:35], s45 offen
    s_waitcnt vmcnt(0)
    v_lshlrev_b32 v96, 16, v80
    v_and_b32 v97, 0xffff0000, v80
    v_lshlrev_b32 v98, 16, v81
    v_and_b32 v99, 0xffff0000, v81
    v_lshlrev_b32 v100, 16, v82
    v_and_b32 v101, 0xffff0000, v82
    v_lshlrev_b32 v102, 16, v83
    v_and_b32 v103, 0xffff0000, v83
    v_mov_b32 v104, 0xbdd2d3e8
    v_mov_b32 v105, v104
    v_mov_b32 v106, 0xc0135761
    v_mov_b32 v107, v106
    s_cmp_lg_u32 s44, 0
    s_cbranch_scc1 L_pd_145
    v_mov_b32 v29, 132
    s_mov_b32 s46, 96
    s_mov_b64 exec, 1
    s_mov_b32 s70, 0
L_wp_146:
    buffer_load_dword v31, v29, s[16:19], 0 offen sc1
    s_add_u32 s70, s70, 1
    s_cmp_ge_u32 s70, 0x200000
    s_cbranch_scc1 L_w_done_102
    s_waitcnt vmcnt(0)
    v_cmp_gt_u32 vcc, s46, v31
    s_nop 1
    s_cbranch_vccz L_wp_146_ok
    s_sleep 3
    s_branch L_wp_146
L_wp_146_ok:
    s_mov_b64 exec, -1
L_pd_145:
    s_barrier
    v_lshlrev_b32 v29, 5, v1
    s_mov_b32 s45, 8192
    buffer_load_dwordx4 v[112:115], v29, s[12:15], s45 offen offset:0 sc1
    buffer_load_dwordx4 v[116:119], v29, s[12:15], s45 offen offset:16 sc1
    buffer_load_dwordx4 v[120:123], v29, s[12:15], s45 offen offset:2048 sc1
    buffer_load_dwordx4 v[124:127], v29, s[12:15], s45 offen offset:2064 sc1
    s_mov_b32 s45, 32768
    buffer_load_dwordx4 v[32:35], v29, s[12:15], s45 offen offset:0 sc1
    buffer_load_dwordx4 v[36:39], v29, s[12:15], s45 offen offset:16 sc1
    buffer_load_dwordx4 v[40:43], v29, s[12:15], s45 offen offset:2048 sc1
    buffer_load_dwordx4 v[44:47], v29, s[12:15], s45 offen offset:2064 sc1
    s_mov_b32 s45, 12288
    buffer_load_dwordx4 v[128:131], v29, s[12:15], s45 offen offset:0 sc1
    buffer_load_dwordx4 v[132:135], v29, s[12:15], s45 offen offset:16 sc1
    buffer_load_dwordx4 v[136:139], v29, s[12:15], s45 offen offset:2048 sc1
    buffer_load_dwordx4 v[140:143], v29, s[12:15], s45 offen offset:2064 sc1
    s_mov_b32 s45, 36864
    buffer_load_dwordx4 v[48:51], v29, s[12:15], s45 offen offset:0 sc1
    buffer_load_dwordx4 v[52:55], v29, s[12:15], s45 offen offset:16 sc1
    buffer_load_dwordx4 v[56:59], v29, s[12:15], s45 offen offset:2048 sc1
    buffer_load_dwordx4 v[60:63], v29, s[12:15], s45 offen offset:2064 sc1
    s_mov_b32 s45, 16384
    buffer_load_dwordx4 v[144:147], v29, s[12:15], s45 offen offset:0 sc1
    buffer_load_dwordx4 v[148:151], v29, s[12:15], s45 offen offset:16 sc1
    buffer_load_dwordx4 v[152:155], v29, s[12:15], s45 offen offset:2048 sc1
    buffer_load_dwordx4 v[156:159], v29, s[12:15], s45 offen offset:2064 sc1
    s_mov_b32 s45, 40960
    buffer_load_dwordx4 v[64:67], v29, s[12:15], s45 offen offset:0 sc1
    buffer_load_dwordx4 v[68:71], v29, s[12:15], s45 offen offset:16 sc1
    buffer_load_dwordx4 v[72:75], v29, s[12:15], s45 offen offset:2048 sc1
    buffer_load_dwordx4 v[76:79], v29, s[12:15], s45 offen offset:2064 sc1
    s_waitcnt vmcnt(0)
    v_add_f32 v112, v112, v32
    v_cvt_pk_bf16_f32 v112, v112, v112
    v_lshlrev_b32 v112, 16, v112
    v_add_f32 v113, v113, v33
    v_cvt_pk_bf16_f32 v113, v113, v113
    v_lshlrev_b32 v113, 16, v113
    v_add_f32 v114, v114, v34
    v_cvt_pk_bf16_f32 v114, v114, v114
    v_lshlrev_b32 v114, 16, v114
    v_add_f32 v115, v115, v35
    v_cvt_pk_bf16_f32 v115, v115, v115
    v_lshlrev_b32 v115, 16, v115
    v_add_f32 v116, v116, v36
    v_cvt_pk_bf16_f32 v116, v116, v116
    v_lshlrev_b32 v116, 16, v116
    v_add_f32 v117, v117, v37
    v_cvt_pk_bf16_f32 v117, v117, v117
    v_lshlrev_b32 v117, 16, v117
    v_add_f32 v118, v118, v38
    v_cvt_pk_bf16_f32 v118, v118, v118
    v_lshlrev_b32 v118, 16, v118
    v_add_f32 v119, v119, v39
    v_cvt_pk_bf16_f32 v119, v119, v119
    v_lshlrev_b32 v119, 16, v119
    v_add_f32 v120, v120, v40
    v_cvt_pk_bf16_f32 v120, v120, v120
    v_lshlrev_b32 v120, 16, v120
    v_add_f32 v121, v121, v41
    v_cvt_pk_bf16_f32 v121, v121, v121
    v_lshlrev_b32 v121, 16, v121
    v_add_f32 v122, v122, v42
    v_cvt_pk_bf16_f32 v122, v122, v122
    v_lshlrev_b32 v122, 16, v122
    v_add_f32 v123, v123, v43
    v_cvt_pk_bf16_f32 v123, v123, v123
    v_lshlrev_b32 v123, 16, v123
    v_add_f32 v124, v124, v44
    v_cvt_pk_bf16_f32 v124, v124, v124
    v_lshlrev_b32 v124, 16, v124
    v_add_f32 v125, v125, v45
    v_cvt_pk_bf16_f32 v125, v125, v125
    v_lshlrev_b32 v125, 16, v125
    v_add_f32 v126, v126, v46
    v_cvt_pk_bf16_f32 v126, v126, v126
    v_lshlrev_b32 v126, 16, v126
    v_add_f32 v127, v127, v47
    v_cvt_pk_bf16_f32 v127, v127, v127
    v_lshlrev_b32 v127, 16, v127
    v_add_f32 v128, v128, v48
    v_cvt_pk_bf16_f32 v128, v128, v128
    v_lshlrev_b32 v128, 16, v128
    v_add_f32 v129, v129, v49
    v_cvt_pk_bf16_f32 v129, v129, v129
    v_lshlrev_b32 v129, 16, v129
    v_add_f32 v130, v130, v50
    v_cvt_pk_bf16_f32 v130, v130, v130
    v_lshlrev_b32 v130, 16, v130
    v_add_f32 v131, v131, v51
    v_cvt_pk_bf16_f32 v131, v131, v131
    v_lshlrev_b32 v131, 16, v131
    v_add_f32 v132, v132, v52
    v_cvt_pk_bf16_f32 v132, v132, v132
    v_lshlrev_b32 v132, 16, v132
    v_add_f32 v133, v133, v53
    v_cvt_pk_bf16_f32 v133, v133, v133
    v_lshlrev_b32 v133, 16, v133
    v_add_f32 v134, v134, v54
    v_cvt_pk_bf16_f32 v134, v134, v134
    v_lshlrev_b32 v134, 16, v134
    v_add_f32 v135, v135, v55
    v_cvt_pk_bf16_f32 v135, v135, v135
    v_lshlrev_b32 v135, 16, v135
    v_add_f32 v136, v136, v56
    v_cvt_pk_bf16_f32 v136, v136, v136
    v_lshlrev_b32 v136, 16, v136
    v_add_f32 v137, v137, v57
    v_cvt_pk_bf16_f32 v137, v137, v137
    v_lshlrev_b32 v137, 16, v137
    v_add_f32 v138, v138, v58
    v_cvt_pk_bf16_f32 v138, v138, v138
    v_lshlrev_b32 v138, 16, v138
    v_add_f32 v139, v139, v59
    v_cvt_pk_bf16_f32 v139, v139, v139
    v_lshlrev_b32 v139, 16, v139
    v_add_f32 v140, v140, v60
    v_cvt_pk_bf16_f32 v140, v140, v140
    v_lshlrev_b32 v140, 16, v140
    v_add_f32 v141, v141, v61
    v_cvt_pk_bf16_f32 v141, v141, v141
    v_lshlrev_b32 v141, 16, v141
    v_add_f32 v142, v142, v62
    v_cvt_pk_bf16_f32 v142, v142, v142
    v_lshlrev_b32 v142, 16, v142
    v_add_f32 v143, v143, v63
    v_cvt_pk_bf16_f32 v143, v143, v143
    v_lshlrev_b32 v143, 16, v143
    v_add_f32 v144, v144, v64
    v_cvt_pk_bf16_f32 v144, v144, v144
    v_lshlrev_b32 v144, 16, v144
    v_add_f32 v144, 1.0, v144
    v_cvt_pk_bf16_f32 v144, v144, v144
    v_lshlrev_b32 v144, 16, v144
    v_add_f32 v145, v145, v65
    v_cvt_pk_bf16_f32 v145, v145, v145
    v_lshlrev_b32 v145, 16, v145
    v_add_f32 v145, 1.0, v145
    v_cvt_pk_bf16_f32 v145, v145, v145
    v_lshlrev_b32 v145, 16, v145
    v_add_f32 v146, v146, v66
    v_cvt_pk_bf16_f32 v146, v146, v146
    v_lshlrev_b32 v146, 16, v146
    v_add_f32 v146, 1.0, v146
    v_cvt_pk_bf16_f32 v146, v146, v146
    v_lshlrev_b32 v146, 16, v146
    v_add_f32 v147, v147, v67
    v_cvt_pk_bf16_f32 v147, v147, v147
    v_lshlrev_b32 v147, 16, v147
    v_add_f32 v147, 1.0, v147
    v_cvt_pk_bf16_f32 v147, v147, v147
    v_lshlrev_b32 v147, 16, v147
    v_add_f32 v148, v148, v68
    v_cvt_pk_bf16_f32 v148, v148, v148
    v_lshlrev_b32 v148, 16, v148
    v_add_f32 v148, 1.0, v148
    v_cvt_pk_bf16_f32 v148, v148, v148
    v_lshlrev_b32 v148, 16, v148
    v_add_f32 v149, v149, v69
    v_cvt_pk_bf16_f32 v149, v149, v149
    v_lshlrev_b32 v149, 16, v149
    v_add_f32 v149, 1.0, v149
    v_cvt_pk_bf16_f32 v149, v149, v149
    v_lshlrev_b32 v149, 16, v149
    v_add_f32 v150, v150, v70
    v_cvt_pk_bf16_f32 v150, v150, v150
    v_lshlrev_b32 v150, 16, v150
    v_add_f32 v150, 1.0, v150
    v_cvt_pk_bf16_f32 v150, v150, v150
    v_lshlrev_b32 v150, 16, v150
    v_add_f32 v151, v151, v71
    v_cvt_pk_bf16_f32 v151, v151, v151
    v_lshlrev_b32 v151, 16, v151
    v_add_f32 v151, 1.0, v151
    v_cvt_pk_bf16_f32 v151, v151, v151
    v_lshlrev_b32 v151, 16, v151
    v_add_f32 v152, v152, v72
    v_cvt_pk_bf16_f32 v152, v152, v152
    v_lshlrev_b32 v152, 16, v152
    v_add_f32 v152, 1.0, v152
    v_cvt_pk_bf16_f32 v152, v152, v152
    v_lshlrev_b32 v152, 16, v152
    v_add_f32 v153, v153, v73
    v_cvt_pk_bf16_f32 v153, v153, v153
    v_lshlrev_b32 v153, 16, v153
    v_add_f32 v153, 1.0, v153
    v_cvt_pk_bf16_f32 v153, v153, v153
    v_lshlrev_b32 v153, 16, v153
    v_add_f32 v154, v154, v74
    v_cvt_pk_bf16_f32 v154, v154, v154
    v_lshlrev_b32 v154, 16, v154
    v_add_f32 v154, 1.0, v154
    v_cvt_pk_bf16_f32 v154, v154, v154
    v_lshlrev_b32 v154, 16, v154
    v_add_f32 v155, v155, v75
    v_cvt_pk_bf16_f32 v155, v155, v155
    v_lshlrev_b32 v155, 16, v155
    v_add_f32 v155, 1.0, v155
    v_cvt_pk_bf16_f32 v155, v155, v155
    v_lshlrev_b32 v155, 16, v155
    v_add_f32 v156, v156, v76
    v_cvt_pk_bf16_f32 v156, v156, v156
    v_lshlrev_b32 v156, 16, v156
    v_add_f32 v156, 1.0, v156
    v_cvt_pk_bf16_f32 v156, v156, v156
    v_lshlrev_b32 v156, 16, v156
    v_add_f32 v157, v157, v77
    v_cvt_pk_bf16_f32 v157, v157, v157
    v_lshlrev_b32 v157, 16, v157
    v_add_f32 v157, 1.0, v157
    v_cvt_pk_bf16_f32 v157, v157, v157
    v_lshlrev_b32 v157, 16, v157
    v_add_f32 v158, v158, v78
    v_cvt_pk_bf16_f32 v158, v158, v158
    v_lshlrev_b32 v158, 16, v158
    v_add_f32 v158, 1.0, v158
    v_cvt_pk_bf16_f32 v158, v158, v158
    v_lshlrev_b32 v158, 16, v158
    v_add_f32 v159, v159, v79
    v_cvt_pk_bf16_f32 v159, v159, v159
    v_lshlrev_b32 v159, 16, v159
    v_add_f32 v159, 1.0, v159
    v_cvt_pk_bf16_f32 v159, v159, v159
    v_lshlrev_b32 v159, 16, v159
    s_lshl_b32 s46, s44, 10
    s_add_u32 s45, s46, 8192
    buffer_load_dwordx4 v[18:21], v10, s[12:15], s45 offen sc1
    s_add_u32 s45, s46, 32768
    buffer_load_dwordx4 v[32:35], v10, s[12:15], s45 offen sc1
    s_add_u32 s45, s46, 12288
    buffer_load_dwordx4 v[22:25], v10, s[12:15], s45 offen sc1
    s_add_u32 s45, s46, 36864
    buffer_load_dwordx4 v[36:39], v10, s[12:15], s45 offen sc1
    s_add_u32 s45, s46, 16384
    buffer_load_dwordx4 v[108:111], v10, s[12:15], s45 offen sc1
    s_add_u32 s45, s46, 40960
    buffer_load_dwordx4 v[40:43], v10, s[12:15], s45 offen sc1
    s_waitcnt vmcnt(0)
    v_add_f32 v18, v18, v32
    v_cvt_pk_bf16_f32 v18, v18, v18
    v_lshlrev_b32 v18, 16, v18
    v_add_f32 v19, v19, v33
    v_cvt_pk_bf16_f32 v19, v19, v19
    v_lshlrev_b32 v19, 16, v19
    v_add_f32 v20, v20, v34
    v_cvt_pk_bf16_f32 v20, v20, v20
    v_lshlrev_b32 v20, 16, v20
    v_add_f32 v21, v21, v35
    v_cvt_pk_bf16_f32 v21, v21, v21
    v_lshlrev_b32 v21, 16, v21
    v_add_f32 v22, v22, v36
    v_cvt_pk_bf16_f32 v22, v22, v22
    v_lshlrev_b32 v22, 16, v22
    v_add_f32 v23, v23, v37
    v_cvt_pk_bf16_f32 v23, v23, v23
    v_lshlrev_b32 v23, 16, v23
    v_add_f32 v24, v24, v38
    v_cvt_pk_bf16_f32 v24, v24, v24
    v_lshlrev_b32 v24, 16, v24
    v_add_f32 v25, v25, v39
    v_cvt_pk_bf16_f32 v25, v25, v25
    v_lshlrev_b32 v25, 16, v25
    v_add_f32 v108, v108, v40
    v_cvt_pk_bf16_f32 v108, v108, v108
    v_lshlrev_b32 v108, 16, v108
    v_add_f32 v108, 1.0, v108
    v_cvt_pk_bf16_f32 v108, v108, v108
    v_lshlrev_b32 v108, 16, v108
    v_add_f32 v109, v109, v41
    v_cvt_pk_bf16_f32 v109, v109, v109
    v_lshlrev_b32 v109, 16, v109
    v_add_f32 v109, 1.0, v109
    v_cvt_pk_bf16_f32 v109, v109, v109
    v_lshlrev_b32 v109, 16, v109
    v_add_f32 v110, v110, v42
    v_cvt_pk_bf16_f32 v110, v110, v110
    v_lshlrev_b32 v110, 16, v110
    v_add_f32 v110, 1.0, v110
    v_cvt_pk_bf16_f32 v110, v110, v110
    v_lshlrev_b32 v110, 16, v110
    v_add_f32 v111, v111, v43
    v_cvt_pk_bf16_f32 v111, v111, v111
    v_lshlrev_b32 v111, 16, v111
    v_add_f32 v111, 1.0, v111
    v_cvt_pk_bf16_f32 v111, v111, v111
    v_lshlrev_b32 v111, 16, v111
    s_mov_b32 s52, 0xc00000
    s_lshl_b32 s56, s41, 13
    s_add_u32 s56, s56, 0x6000000
    s_lshl_b32 s45, s40, 2
    s_add_u32 s45, s45, 200
    v_mov_b32 v29, s45
    s_mov_b32 s46, 536870912
    s_mov_b64 exec, 1
    s_mov_b32 s70, 0
L_wp_150:
    buffer_load_dword v31, v29, s[16:19], 0 offen sc1
    s_add_u32 s70, s70, 1
    s_cmp_ge_u32 s70, 0x200000
    s_cbranch_scc1 L_w_done_102
    s_waitcnt vmcnt(0)
    v_cmp_gt_u32 vcc, s46, v31
    s_nop 1
    s_cbranch_vccz L_wp_150_ok
    s_sleep 2
    s_branch L_wp_150
L_wp_150_ok:
    s_mov_b64 exec, -1
    v_readfirstlane_b32 s45, v31
    s_nop 3
    s_and_b32 s46, s45, 511
    s_mul_i32 s46, s46, s46
    s_bfe_u32 s45, s45, 0xf0009
    s_lshl_b32 s45, s45, 5
    s_mov_b32 s80, s12
    s_mov_b32 s81, s13
    s_mov_b32 s83, 0x00020000
    s_mov_b32 s84, s12
    s_mov_b32 s85, s13
    s_mov_b32 s87, 0x00020000
    s_cmp_eq_u32 s45, s46
    s_cselect_b32 s82, s14, 0
    s_cselect_b32 s86, 0, s14
L_b_loop_147:
    s_cmp_eq_u64 s[36:37], 0
    s_cbranch_scc1 L_w_done_102
    s_ff1_i32_b64 s50, s[36:37]
    s_bitset0_b64 s[36:37], s50
    s_lshr_b64 s[74:75], s[72:73], s50
    s_ff1_i32_b64 s51, s[74:75]
    s_add_u32 s51, s51, 1
    s_add_u32 s62, s50, s51
    s_cmp_lg_u32 s51, 1
    s_cbranch_scc1 L_b_skip2_149
    s_lshl_b32 s63, s50, 5
    s_add_u32 s63, s63, s41
    s_lshl_b32 s47, s63, 11
    s_lshl_b32 s45, s44, 9
    s_add_u32 s47, s47, s45
    v_lshlrev_b32 v17, 3, v1
    buffer_load_dwordx2 v[208:209], v17, s[28:31], s47 offen
    s_add_u32 s45, s64, 4096
    s_waitcnt vmcnt(0)
    s_cmp_lg_u32 s44, 0
    s_cbranch_scc1 L_pw_151
    s_mov_b32 exec_hi, 0
    s_mov_b32 s70, 0
L_wp_152:
    buffer_load_dword v31, v5, s[12:15], s45 offen sc1
    s_add_u32 s70, s70, 1
    s_cmp_ge_u32 s70, 0x200000
    s_cbranch_scc1 L_w_done_102
    s_waitcnt vmcnt(0)
    v_cmp_gt_u32 vcc, s62, v31
    s_nop 1
    s_cbranch_vccz L_wp_152_ok
    s_sleep 1
    s_branch L_wp_152
L_wp_152_ok:
    s_mov_b64 exec, -1
L_pw_151:
    s_barrier
    s_lshl_b32 s45, s63, 12
    s_lshl_b32 s46, s44, 10
    s_add_u32 s45, s45, s46
    s_add_u32 s45, s45, 0x8000000
    buffer_load_dwordx4 v[64:67], v10, s[12:15], s45 offen sc1
    s_add_u32 s45, s45, 0x800000
    buffer_load_dwordx4 v[68:71], v10, s[12:15], s45 offen sc1
    s_add_u32 s45, s45, 0x800000
    buffer_load_dwordx4 v[72:75], v10, s[12:15], s45 offen sc1
    s_add_u32 s45, s45, 0x800000
    buffer_load_dwordx4 v[76:79], v10, s[12:15], s45 offen sc1
    v_lshlrev_b32 v160, 16, v208
    v_and_b32 v161, 0xffff0000, v208
    v_lshlrev_b32 v162, 16, v209
    v_and_b32 v163, 0xffff0000, v209
    s_waitcnt vmcnt(0)
    v_pk_add_f32 v[64:65], v[64:65], v[68:69]
    v_pk_add_f32 v[72:73], v[72:73], v[76:77]
    v_pk_add_f32 v[66:67], v[66:67], v[70:71]
    v_pk_add_f32 v[74:75], v[74:75], v[78:79]
    v_pk_add_f32 v[64:65], v[64:65], v[72:73]
    v_pk_add_f32 v[66:67], v[66:67], v[74:75]
    v_cvt_pk_bf16_f32 v64, v64, v64
    v_lshlrev_b32 v64, 16, v64
    v_cvt_pk_bf16_f32 v65, v65, v65
    v_lshlrev_b32 v65, 16, v65
    v_cvt_pk_bf16_f32 v66, v66, v66
    v_lshlrev_b32 v66, 16, v66
    v_cvt_pk_bf16_f32 v67, v67, v67
    v_lshlrev_b32 v67, 16, v67
    v_mul_f32 v64, v64, v18
    v_cvt_pk_bf16_f32 v64, v64, v64
    v_lshlrev_b32 v64, 16, v64
    v_add_f32 v64, v64, v160
    v_mul_f32 v65, v65, v19
    v_cvt_pk_bf16_f32 v65, v65, v65
    v_lshlrev_b32 v65, 16, v65
    v_add_f32 v65, v65, v161
    v_mul_f32 v66, v66, v20
    v_cvt_pk_bf16_f32 v66, v66, v66
    v_lshlrev_b32 v66, 16, v66
    v_add_f32 v66, v66, v162
    v_mul_f32 v67, v67, v21
    v_cvt_pk_bf16_f32 v67, v67, v67
    v_lshlrev_b32 v67, 16, v67
    v_add_f32 v67, v67, v163
    v_cvt_pk_bf16_f32 v208, v64, v65
    v_cvt_pk_bf16_f32 v209, v66, v67
    s_add_u32 s47, s47, 0x800000
    buffer_store_dwordx2 v[208:209], v17, s[12:15], s47 offen sc1
    v_lshlrev_b32 v64, 16, v208
    v_and_b32 v65, 0xffff0000, v208
    v_lshlrev_b32 v66, 16, v209
    v_and_b32 v67, 0xffff0000, v209
    v_add_f32 v26, v64, v65
    v_add_f32 v27, v66, v67
    v_add_f32 v26, v26, v27
    s_nop 1
    v_add_f32_dpp v26, v26, v26 row_shr:1 row_mask:0xf bank_mask:0xf bound_ctrl:0
    s_nop 1
    v_add_f32_dpp v26, v26, v26 row_shr:2 row_mask:0xf bank_mask:0xf bound_ctrl:0
    s_nop 1
    v_add_f32_dpp v26, v26, v26 row_shr:4 row_mask:0xf bank_mask:0xf bound_ctrl:0
    s_nop 1
    v_add_f32_dpp v26, v26, v26 row_shr:8 row_mask:0xf bank_mask:0xf bound_ctrl:0
    s_nop 1
    v_add_f32_dpp v26, v26, v26 row_bcast:15 row_mask:0xa bank_mask:0xf
    s_nop 1
    v_add_f32_dpp v26, v26, v26 row_bcast:31 row_mask:0xc bank_mask:0xf
    s_nop 1
    v_readlane_b32 s66, v26, 63
    s_nop 1
    v_mov_b32 v28, s66
    v_mul_f32 v28, 0x3b800000, v28
    v_mov_b32 v26, 0
    v_sub_f32 v27, v64, v28
    v_fmac_f32 v26, v27, v27
    v_sub_f32 v27, v65, v28
    v_fmac_f32 v26, v27, v27
    v_sub_f32 v27, v66, v28
    v_fmac_f32 v26, v27, v27
    v_sub_f32 v27, v67, v28
    v_fmac_f32 v26, v27, v27
    s_nop 1
    v_add_f32_dpp v26, v26, v26 row_shr:1 row_mask:0xf bank_mask:0xf bound_ctrl:0
    s_nop 1
    v_add_f32_dpp v26, v26, v26 row_shr:2 row_mask:0xf bank_mask:0xf bound_ctrl:0
    s_nop 1
    v_add_f32_dpp v26, v26, v26 row_shr:4 row_mask:0xf bank_mask:0xf bound_ctrl:0
    s_nop 1
    v_add_f32_dpp v26, v26, v26 row_shr:8 row_mask:0xf bank_mask:0xf bound_ctrl:0
    s_nop 1
    v_add_f32_dpp v26, v26, v26 row_bcast:15 row_mask:0xa bank_mask:0xf
    s_nop 1
    v_add_f32_dpp v26, v26, v26 row_bcast:31 row_mask:0xc bank_mask:0xf
    s_nop 1
    v_readlane_b32 s66, v26, 63
    s_lshl_b32 s45, s44, 3
    s_add_u32 s45, s45, 131072
    v_mov_b32 v29, s66
    v_mov_b32 v27, s45
    ds_write_b64 v27, v[28:29]
    v_mov_b32 v27, 131072
    s_waitcnt lgkmcnt(0)
    s_barrier
    ds_read_b128 v[68:71], v27
    ds_read_b128 v[72:75], v27 offset:16
    s_waitcnt lgkmcnt(0)
    v_add_f32 v27, v68, v70
    v_add_f32 v26, v72, v74
    v_add_f32 v27, v27, v26
    v_mul_f32 v27, 0x3e800000, v27
    v_add_f32 v26, v69, v71
    v_add_f32 v28, v73, v75
    v_add_f32 v26, v26, v28
    v_mov_b32 v28, 0
    v_sub_f32 v68, v68, v27
    v_fmac_f32 v28, v68, v68
    v_sub_f32 v70, v70, v27
    v_fmac_f32 v28, v70, v70
    v_sub_f32 v72, v72, v27
    v_fmac_f32 v28, v72, v72
    v_sub_f32 v74, v74, v27
    v_fmac_f32 v28, v74, v74
    v_mul_f32 v28, 0x43800000, v28
    v_add_f32 v26, v26, v28
    v_mul_f32 v26, 0x3a800000, v26
    v_cvt_pk_bf16_f32 v26, v26, v26
    v_lshlrev_b32 v26, 16, v26
    v_cvt_pk_bf16_f32 v27, v27, v27
    v_lshlrev_b32 v27, 16, v27
    v_add_f32 v26, 0x3727c5ac, v26
    v_cvt_pk_bf16_f32 v26, v26, v26
    v_lshlrev_b32 v26, 16, v26
    v_sqrt_f32 v26, v26
    s_nop 0
    v_cvt_pk_bf16_f32 v26, v26, v26
    v_lshlrev_b32 v26, 16, v26
    v_rcp_f32 v26, v26
    s_nop 0
    v_sub_f32 v64, v64, v27
    v_cvt_pk_bf16_f32 v64, v64, v64
    v_lshlrev_b32 v64, 16, v64
    v_mul_f32 v64, v64, v26
    v_cvt_pk_bf16_f32 v64, v64, v64
    v_lshlrev_b32 v64, 16, v64
    v_mul_f32 v64, v64, v108
    v_cvt_pk_bf16_f32 v64, v64, v64
    v_lshlrev_b32 v64, 16, v64
    v_add_f32 v64, v64, v22
    v_sub_f32 v65, v65, v27
    v_cvt_pk_bf16_f32 v65, v65, v65
    v_lshlrev_b32 v65, 16, v65
    v_mul_f32 v65, v65, v26
    v_cvt_pk_bf16_f32 v65, v65, v65
    v_lshlrev_b32 v65, 16, v65
    v_mul_f32 v65, v65, v109
    v_cvt_pk_bf16_f32 v65, v65, v65
    v_lshlrev_b32 v65, 16, v65
    v_add_f32 v65, v65, v23
    v_sub_f32 v66, v66, v27
    v_cvt_pk_bf16_f32 v66, v66, v66
    v_lshlrev_b32 v66, 16, v66
    v_mul_f32 v66, v66, v26
    v_cvt_pk_bf16_f32 v66, v66, v66
    v_lshlrev_b32 v66, 16, v66
    v_mul_f32 v66, v66, v110
    v_cvt_pk_bf16_f32 v66, v66, v66
    v_lshlrev_b32 v66, 16, v66
    v_add_f32 v66, v66, v24
    v_sub_f32 v67, v67, v27
    v_cvt_pk_bf16_f32 v67, v67, v67
    v_lshlrev_b32 v67, 16, v67
    v_mul_f32 v67, v67, v26
    v_cvt_pk_bf16_f32 v67, v67, v67
    v_lshlrev_b32 v67, 16, v67
    v_mul_f32 v67, v67, v111
    v_cvt_pk_bf16_f32 v67, v67, v67
    v_lshlrev_b32 v67, 16, v67
    v_add_f32 v67, v67, v25
    v_cvt_pk_bf16_f32 v64, v64, v65
    v_cvt_pk_bf16_f32 v65, v66, v67
    v_lshrrev_b32 v26, 5, v1
    v_lshlrev_b32 v26, 13, v26
    v_and_b32 v27, 255, v17
    v_add_u32 v26, v26, v27
    s_lshl_b32 s45, s50, 16
    s_lshl_b32 s46, s41, 8
    s_add_u32 s45, s45, s46
    s_lshl_b32 s46, s44, 14
    s_add_u32 s45, s45, s46
    s_add_u32 s45, s45, 0xc00000
    buffer_store_dwordx2 v[64:65], v26, s[12:15], s45 offen sc1
    s_branch L_b_skip_148
L_b_skip2_149:
    s_add_u32 s63, s50, s44
    s_lshl_b32 s63, s63, 5
    s_add_u32 s63, s63, s41
    s_lshl_b32 s47, s63, 11
    buffer_load_dwordx4 v[208:211], v10, s[28:31], s47 offen
    buffer_load_dwordx4 v[212:215], v10, s[28:31], s47 offen offset:1024
    s_add_u32 s45, s64, 4096
    s_cmp_lg_u32 s44, 0
    s_cbranch_scc1 L_pw_153
    s_mov_b32 exec_hi, 0
    s_mov_b32 s70, 0
L_wp_154:
    buffer_load_dword v31, v5, s[12:15], s45 offen sc1
    s_add_u32 s70, s70, 1
    s_cmp_ge_u32 s70, 0x200000
    s_cbranch_scc1 L_w_done_102
    s_waitcnt vmcnt(0)
    v_cmp_gt_u32 vcc, s62, v31
    s_nop 1
    s_cbranch_vccz L_wp_154_ok
    s_sleep 2
    s_branch L_wp_154
L_wp_154_ok:
    s_mov_b64 exec, -1
L_pw_153:
    s_barrier
    s_cmp_ge_u32 s44, s51
    s_cbranch_scc1 L_b_skip_148
    s_lshl_b32 s45, s63, 12
    s_add_u32 s45, s45, 0x8000000
    v_lshlrev_b32 v29, 5, v1
    buffer_load_dwordx4 v[64:67], v29, s[12:15], s45 offen offset:0 sc1
    buffer_load_dwordx4 v[68:71], v29, s[12:15], s45 offen offset:16 sc1
    buffer_load_dwordx4 v[72:75], v29, s[12:15], s45 offen offset:2048 sc1
    buffer_load_dwordx4 v[76:79], v29, s[12:15], s45 offen offset:2064 sc1
    s_add_u32 s45, s45, 0x800000
    buffer_load_dwordx4 v[160:163], v29, s[12:15], s45 offen offset:0 sc1
    buffer_load_dwordx4 v[164:167], v29, s[12:15], s45 offen offset:16 sc1
    buffer_load_dwordx4 v[168:171], v29, s[12:15], s45 offen offset:2048 sc1
    buffer_load_dwordx4 v[172:175], v29, s[12:15], s45 offen offset:2064 sc1
    s_add_u32 s45, s45, 0x800000
    buffer_load_dwordx4 v[176:179], v29, s[12:15], s45 offen offset:0 sc1
    buffer_load_dwordx4 v[180:183], v29, s[12:15], s45 offen offset:16 sc1
    buffer_load_dwordx4 v[184:187], v29, s[12:15], s45 offen offset:2048 sc1
    buffer_load_dwordx4 v[188:191], v29, s[12:15], s45 offen offset:2064 sc1
    s_add_u32 s45, s45, 0x800000
    buffer_load_dwordx4 v[192:195], v29, s[12:15], s45 offen offset:0 sc1
    buffer_load_dwordx4 v[196:199], v29, s[12:15], s45 offen offset:16 sc1
    buffer_load_dwordx4 v[200:203], v29, s[12:15], s45 offen offset:2048 sc1
    buffer_load_dwordx4 v[204:207], v29, s[12:15], s45 offen offset:2064 sc1
    s_waitcnt vmcnt(0)
    v_pk_add_f32 v[64:65], v[64:65], v[160:161]
    v_pk_add_f32 v[176:177], v[176:177], v[192:193]
    v_pk_add_f32 v[66:67], v[66:67], v[162:163]
    v_pk_add_f32 v[178:179], v[178:179], v[194:195]
    v_pk_add_f32 v[68:69], v[68:69], v[164:165]
    v_pk_add_f32 v[180:181], v[180:181], v[196:197]
    v_pk_add_f32 v[70:71], v[70:71], v[166:167]
    v_pk_add_f32 v[182:183], v[182:183], v[198:199]
    v_pk_add_f32 v[72:73], v[72:73], v[168:169]
    v_pk_add_f32 v[184:185], v[184:185], v[200:201]
    v_pk_add_f32 v[74:75], v[74:75], v[170:171]
    v_pk_add_f32 v[186:187], v[186:187], v[202:203]
    v_pk_add_f32 v[76:77], v[76:77], v[172:173]
    v_pk_add_f32 v[188:189], v[188:189], v[204:205]
    v_pk_add_f32 v[78:79], v[78:79], v[174:175]
    v_pk_add_f32 v[190:191], v[190:191], v[206:207]
    v_pk_add_f32 v[64:65], v[64:65], v[176:177]
    v_pk_add_f32 v[66:67], v[66:67], v[178:179]
    v_pk_add_f32 v[68:69], v[68:69], v[180:181]
    v_pk_add_f32 v[70:71], v[70:71], v[182:183]
    v_pk_add_f32 v[72:73], v[72:73], v[184:185]
    v_pk_add_f32 v[74:75], v[74:75], v[186:187]
    v_pk_add_f32 v[76:77], v[76:77], v[188:189]
    v_pk_add_f32 v[78:79], v[78:79], v[190:191]
    v_cvt_pk_bf16_f32 v64, v64, v64
    v_lshlrev_b32 v64, 16, v64
    v_cvt_pk_bf16_f32 v65, v65, v65
    v_lshlrev_b32 v65, 16, v65
    v_cvt_pk_bf16_f32 v66, v66, v66
    v_lshlrev_b32 v66, 16, v66
    v_cvt_pk_bf16_f32 v67, v67, v67
    v_lshlrev_b32 v67, 16, v67
    v_cvt_pk_bf16_f32 v68, v68, v68
    v_lshlrev_b32 v68, 16, v68
    v_cvt_pk_bf16_f32 v69, v69, v69
    v_lshlrev_b32 v69, 16, v69
    v_cvt_pk_bf16_f32 v70, v70, v70
    v_lshlrev_b32 v70, 16, v70
    v_cvt_pk_bf16_f32 v71, v71, v71
    v_lshlrev_b32 v71, 16, v71
    v_cvt_pk_bf16_f32 v72, v72, v72
    v_lshlrev_b32 v72, 16, v72
    v_cvt_pk_bf16_f32 v73, v73, v73
    v_lshlrev_b32 v73, 16, v73
    v_cvt_pk_bf16_f32 v74, v74, v74
    v_lshlrev_b32 v74, 16, v74
    v_cvt_pk_bf16_f32 v75, v75, v75
    v_lshlrev_b32 v75, 16, v75
    v_cvt_pk_bf16_f32 v76, v76, v76
    v_lshlrev_b32 v76, 16, v76
    v_cvt_pk_bf16_f32 v77, v77, v77
    v_lshlrev_b32 v77, 16, v77
    v_cvt_pk_bf16_f32 v78, v78, v78
    v_lshlrev_b32 v78, 16, v78
    v_cvt_pk_bf16_f32 v79, v79, v79
    v_lshlrev_b32 v79, 16, v79
    v_lshlrev_b32 v160, 16, v208
    v_and_b32 v161, 0xffff0000, v208
    v_lshlrev_b32 v162, 16, v209
    v_and_b32 v163, 0xffff0000, v209
    v_lshlrev_b32 v164, 16, v210
    v_and_b32 v165, 0xffff0000, v210
    v_lshlrev_b32 v166, 16, v211
    v_and_b32 v167, 0xffff0000, v211
    v_lshlrev_b32 v168, 16, v212
    v_and_b32 v169, 0xffff0000, v212
    v_lshlrev_b32 v170, 16, v213
    v_and_b32 v171, 0xffff0000, v213
    v_lshlrev_b32 v172, 16, v214
    v_and_b32 v173, 0xffff0000, v214
    v_lshlrev_b32 v174, 16, v215
    v_and_b32 v175, 0xffff0000, v215
    v_mul_f32 v64, v64, v112
    v_cvt_pk_bf16_f32 v64, v64, v64
    v_lshlrev_b32 v64, 16, v64
    v_add_f32 v64, v64, v160
    v_mul_f32 v65, v65, v113
    v_cvt_pk_bf16_f32 v65, v65, v65
    v_lshlrev_b32 v65, 16, v65
    v_add_f32 v65, v65, v161
    v_mul_f32 v66, v66, v114
    v_cvt_pk_bf16_f32 v66, v66, v66
    v_lshlrev_b32 v66, 16, v66
    v_add_f32 v66, v66, v162
    v_mul_f32 v67, v67, v115
    v_cvt_pk_bf16_f32 v67, v67, v67
    v_lshlrev_b32 v67, 16, v67
    v_add_f32 v67, v67, v163
    v_mul_f32 v68, v68, v116
    v_cvt_pk_bf16_f32 v68, v68, v68
    v_lshlrev_b32 v68, 16, v68
    v_add_f32 v68, v68, v164
    v_mul_f32 v69, v69, v117
    v_cvt_pk_bf16_f32 v69, v69, v69
    v_lshlrev_b32 v69, 16, v69
    v_add_f32 v69, v69, v165
    v_mul_f32 v70, v70, v118
    v_cvt_pk_bf16_f32 v70, v70, v70
    v_lshlrev_b32 v70, 16, v70
    v_add_f32 v70, v70, v166
    v_mul_f32 v71, v71, v119
    v_cvt_pk_bf16_f32 v71, v71, v71
    v_lshlrev_b32 v71, 16, v71
    v_add_f32 v71, v71, v167
    v_mul_f32 v72, v72, v120
    v_cvt_pk_bf16_f32 v72, v72, v72
    v_lshlrev_b32 v72, 16, v72
    v_add_f32 v72, v72, v168
    v_mul_f32 v73, v73, v121
    v_cvt_pk_bf16_f32 v73, v73, v73
    v_lshlrev_b32 v73, 16, v73
    v_add_f32 v73, v73, v169
    v_mul_f32 v74, v74, v122
    v_cvt_pk_bf16_f32 v74, v74, v74
    v_lshlrev_b32 v74, 16, v74
    v_add_f32 v74, v74, v170
    v_mul_f32 v75, v75, v123
    v_cvt_pk_bf16_f32 v75, v75, v75
    v_lshlrev_b32 v75, 16, v75
    v_add_f32 v75, v75, v171
    v_mul_f32 v76, v76, v124
    v_cvt_pk_bf16_f32 v76, v76, v76
    v_lshlrev_b32 v76, 16, v76
    v_add_f32 v76, v76, v172
    v_mul_f32 v77, v77, v125
    v_cvt_pk_bf16_f32 v77, v77, v77
    v_lshlrev_b32 v77, 16, v77
    v_add_f32 v77, v77, v173
    v_mul_f32 v78, v78, v126
    v_cvt_pk_bf16_f32 v78, v78, v78
    v_lshlrev_b32 v78, 16, v78
    v_add_f32 v78, v78, v174
    v_mul_f32 v79, v79, v127
    v_cvt_pk_bf16_f32 v79, v79, v79
    v_lshlrev_b32 v79, 16, v79
    v_add_f32 v79, v79, v175
    v_cvt_pk_bf16_f32 v208, v64, v65
    v_cvt_pk_bf16_f32 v209, v66, v67
    v_cvt_pk_bf16_f32 v210, v68, v69
    v_cvt_pk_bf16_f32 v211, v70, v71
    v_cvt_pk_bf16_f32 v212, v72, v73
    v_cvt_pk_bf16_f32 v213, v74, v75
    v_cvt_pk_bf16_f32 v214, v76, v77
    v_cvt_pk_bf16_f32 v215, v78, v79
    s_add_u32 s47, s47, 0x800000
    buffer_store_dwordx4 v[208:211], v10, s[12:15], s47 offen sc1
    buffer_store_dwordx4 v[212:215], v10, s[12:15], s47 offen offset:1024 sc1
    v_lshlrev_b32 v64, 16, v208
    v_and_b32 v65, 0xffff0000, v208
    v_lshlrev_b32 v66, 16, v209
    v_and_b32 v67, 0xffff0000, v209
    v_lshlrev_b32 v68, 16, v210
    v_and_b32 v69, 0xffff0000, v210
    v_lshlrev_b32 v70, 16, v211
    v_and_b32 v71, 0xffff0000, v211
    v_lshlrev_b32 v72, 16, v212
    v_and_b32 v73, 0xffff0000, v212
    v_lshlrev_b32 v74, 16, v213
    v_and_b32 v75, 0xffff0000, v213
    v_lshlrev_b32 v76, 16, v214
    v_and_b32 v77, 0xffff0000, v214
    v_lshlrev_b32 v78, 16, v215
    v_and_b32 v79, 0xffff0000, v215
    v_add_f32 v26, v64, v65
    v_add_f32 v26, v26, v66
    v_add_f32 v26, v26, v67
    v_add_f32 v26, v26, v68
    v_add_f32 v26, v26, v69
    v_add_f32 v26, v26, v70
    v_add_f32 v26, v26, v71
    v_add_f32 v26, v26, v72
    v_add_f32 v26, v26, v73
    v_add_f32 v26, v26, v74
    v_add_f32 v26, v26, v75
    v_add_f32 v26, v26, v76
    v_add_f32 v26, v26, v77
    v_add_f32 v26, v26, v78
    v_add_f32 v26, v26, v79
    s_nop 1
    v_add_f32_dpp v26, v26, v26 row_shr:1 row_mask:0xf bank_mask:0xf bound_ctrl:0
    s_nop 1
    v_add_f32_dpp v26, v26, v26 row_shr:2 row_mask:0xf bank_mask:0xf bound_ctrl:0
    s_nop 1
    v_add_f32_dpp v26, v26, v26 row_shr:4 row_mask:0xf bank_mask:0xf bound_ctrl:0
    s_nop 1
    v_add_f32_dpp v26, v26, v26 row_shr:8 row_mask:0xf bank_mask:0xf bound_ctrl:0
    s_nop 1
    v_add_f32_dpp v26, v26, v26 row_bcast:15 row_mask:0xa bank_mask:0xf
    s_nop 1
    v_add_f32_dpp v26, v26, v26 row_bcast:31 row_mask:0xc bank_mask:0xf
    s_nop 1
    v_readlane_b32 s66, v26, 63
    s_nop 1
    v_mov_b32 v27, s66
    v_mul_f32 v27, 0x3a800000, v27
    v_mov_b32 v26, 0
    v_sub_f32 v28, v64, v27
    v_fmac_f32 v26, v28, v28
    v_sub_f32 v28, v65, v27
    v_fmac_f32 v26, v28, v28
    v_sub_f32 v28, v66, v27
    v_fmac_f32 v26, v28, v28
    v_sub_f32 v28, v67, v27
    v_fmac_f32 v26, v28, v28
    v_sub_f32 v28, v68, v27
    v_fmac_f32 v26, v28, v28
    v_sub_f32 v28, v69, v27
    v_fmac_f32 v26, v28, v28
    v_sub_f32 v28, v70, v27
    v_fmac_f32 v26, v28, v28
    v_sub_f32 v28, v71, v27
    v_fmac_f32 v26, v28, v28
    v_sub_f32 v28, v72, v27
    v_fmac_f32 v26, v28, v28
    v_sub_f32 v28, v73, v27
    v_fmac_f32 v26, v28, v28
    v_sub_f32 v28, v74, v27
    v_fmac_f32 v26, v28, v28
    v_sub_f32 v28, v75, v27
    v_fmac_f32 v26, v28, v28
    v_sub_f32 v28, v76, v27
    v_fmac_f32 v26, v28, v28
    v_sub_f32 v28, v77, v27
    v_fmac_f32 v26, v28, v28
    v_sub_f32 v28, v78, v27
    v_fmac_f32 v26, v28, v28
    v_sub_f32 v28, v79, v27
    v_fmac_f32 v26, v28, v28
    s_nop 1
    v_add_f32_dpp v26, v26, v26 row_shr:1 row_mask:0xf bank_mask:0xf bound_ctrl:0
    s_nop 1
    v_add_f32_dpp v26, v26, v26 row_shr:2 row_mask:0xf bank_mask:0xf bound_ctrl:0
    s_nop 1
    v_add_f32_dpp v26, v26, v26 row_shr:4 row_mask:0xf bank_mask:0xf bound_ctrl:0
    s_nop 1
    v_add_f32_dpp v26, v26, v26 row_shr:8 row_mask:0xf bank_mask:0xf bound_ctrl:0
    s_nop 1
    v_add_f32_dpp v26, v26, v26 row_bcast:15 row_mask:0xa bank_mask:0xf
    s_nop 1
    v_add_f32_dpp v26, v26, v26 row_bcast:31 row_mask:0xc bank_mask:0xf
    s_nop 1
    v_readlane_b32 s66, v26, 63
    s_nop 1
    v_mov_b32 v26, s66
    v_mul_f32 v26, 0x3a800000, v26
    v_cvt_pk_bf16_f32 v26, v26, v26
    v_lshlrev_b32 v26, 16, v26
    v_cvt_pk_bf16_f32 v27, v27, v27
    v_lshlrev_b32 v27, 16, v27
    v_add_f32 v26, 0x3727c5ac, v26
    v_cvt_pk_bf16_f32 v26, v26, v26
    v_lshlrev_b32 v26, 16, v26
    v_sqrt_f32 v26, v26
    s_nop 0
    v_cvt_pk_bf16_f32 v26, v26, v26
    v_lshlrev_b32 v26, 16, v26
    v_rcp_f32 v26, v26
    s_nop 0
    v_sub_f32 v64, v64, v27
    v_cvt_pk_bf16_f32 v64, v64, v64
    v_lshlrev_b32 v64, 16, v64
    v_mul_f32 v64, v64, v26
    v_cvt_pk_bf16_f32 v64, v64, v64
    v_lshlrev_b32 v64, 16, v64
    v_sub_f32 v65, v65, v27
    v_cvt_pk_bf16_f32 v65, v65, v65
    v_lshlrev_b32 v65, 16, v65
    v_mul_f32 v65, v65, v26
    v_cvt_pk_bf16_f32 v65, v65, v65
    v_lshlrev_b32 v65, 16, v65
    v_sub_f32 v66, v66, v27
    v_cvt_pk_bf16_f32 v66, v66, v66
    v_lshlrev_b32 v66, 16, v66
    v_mul_f32 v66, v66, v26
    v_cvt_pk_bf16_f32 v66, v66, v66
    v_lshlrev_b32 v66, 16, v66
    v_sub_f32 v67, v67, v27
    v_cvt_pk_bf16_f32 v67, v67, v67
    v_lshlrev_b32 v67, 16, v67
    v_mul_f32 v67, v67, v26
    v_cvt_pk_bf16_f32 v67, v67, v67
    v_lshlrev_b32 v67, 16, v67
    v_sub_f32 v68, v68, v27
    v_cvt_pk_bf16_f32 v68, v68, v68
    v_lshlrev_b32 v68, 16, v68
    v_mul_f32 v68, v68, v26
    v_cvt_pk_bf16_f32 v68, v68, v68
    v_lshlrev_b32 v68, 16, v68
    v_sub_f32 v69, v69, v27
    v_cvt_pk_bf16_f32 v69, v69, v69
    v_lshlrev_b32 v69, 16, v69
    v_mul_f32 v69, v69, v26
    v_cvt_pk_bf16_f32 v69, v69, v69
    v_lshlrev_b32 v69, 16, v69
    v_sub_f32 v70, v70, v27
    v_cvt_pk_bf16_f32 v70, v70, v70
    v_lshlrev_b32 v70, 16, v70
    v_mul_f32 v70, v70, v26
    v_cvt_pk_bf16_f32 v70, v70, v70
    v_lshlrev_b32 v70, 16, v70
    v_sub_f32 v71, v71, v27
    v_cvt_pk_bf16_f32 v71, v71, v71
    v_lshlrev_b32 v71, 16, v71
    v_mul_f32 v71, v71, v26
    v_cvt_pk_bf16_f32 v71, v71, v71
    v_lshlrev_b32 v71, 16, v71
    v_sub_f32 v72, v72, v27
    v_cvt_pk_bf16_f32 v72, v72, v72
    v_lshlrev_b32 v72, 16, v72
    v_mul_f32 v72, v72, v26
    v_cvt_pk_bf16_f32 v72, v72, v72
    v_lshlrev_b32 v72, 16, v72
    v_sub_f32 v73, v73, v27
    v_cvt_pk_bf16_f32 v73, v73, v73
    v_lshlrev_b32 v73, 16, v73
    v_mul_f32 v73, v73, v26
    v_cvt_pk_bf16_f32 v73, v73, v73
    v_lshlrev_b32 v73, 16, v73
    v_sub_f32 v74, v74, v27
    v_cvt_pk_bf16_f32 v74, v74, v74
    v_lshlrev_b32 v74, 16, v74
    v_mul_f32 v74, v74, v26
    v_cvt_pk_bf16_f32 v74, v74, v74
    v_lshlrev_b32 v74, 16, v74
    v_sub_f32 v75, v75, v27
    v_cvt_pk_bf16_f32 v75, v75, v75
    v_lshlrev_b32 v75, 16, v75
    v_mul_f32 v75, v75, v26
    v_cvt_pk_bf16_f32 v75, v75, v75
    v_lshlrev_b32 v75, 16, v75
    v_sub_f32 v76, v76, v27
    v_cvt_pk_bf16_f32 v76, v76, v76
    v_lshlrev_b32 v76, 16, v76
    v_mul_f32 v76, v76, v26
    v_cvt_pk_bf16_f32 v76, v76, v76
    v_lshlrev_b32 v76, 16, v76
    v_sub_f32 v77, v77, v27
    v_cvt_pk_bf16_f32 v77, v77, v77
    v_lshlrev_b32 v77, 16, v77
    v_mul_f32 v77, v77, v26
    v_cvt_pk_bf16_f32 v77, v77, v77
    v_lshlrev_b32 v77, 16, v77
    v_sub_f32 v78, v78, v27
    v_cvt_pk_bf16_f32 v78, v78, v78
    v_lshlrev_b32 v78, 16, v78
    v_mul_f32 v78, v78, v26
    v_cvt_pk_bf16_f32 v78, v78, v78
    v_lshlrev_b32 v78, 16, v78
    v_sub_f32 v79, v79, v27
    v_cvt_pk_bf16_f32 v79, v79, v79
    v_lshlrev_b32 v79, 16, v79
    v_mul_f32 v79, v79, v26
    v_cvt_pk_bf16_f32 v79, v79, v79
    v_lshlrev_b32 v79, 16, v79
    v_mul_f32 v64, v64, v144
    v_cvt_pk_bf16_f32 v64, v64, v64
    v_lshlrev_b32 v64, 16, v64
    v_add_f32 v64, v64, v128
    v_mul_f32 v65, v65, v145
    v_cvt_pk_bf16_f32 v65, v65, v65
    v_lshlrev_b32 v65, 16, v65
    v_add_f32 v65, v65, v129
    v_mul_f32 v66, v66, v146
    v_cvt_pk_bf16_f32 v66, v66, v66
    v_lshlrev_b32 v66, 16, v66
    v_add_f32 v66, v66, v130
    v_mul_f32 v67, v67, v147
    v_cvt_pk_bf16_f32 v67, v67, v67
    v_lshlrev_b32 v67, 16, v67
    v_add_f32 v67, v67, v131
    v_mul_f32 v68, v68, v148
    v_cvt_pk_bf16_f32 v68, v68, v68
    v_lshlrev_b32 v68, 16, v68
    v_add_f32 v68, v68, v132
    v_mul_f32 v69, v69, v149
    v_cvt_pk_bf16_f32 v69, v69, v69
    v_lshlrev_b32 v69, 16, v69
    v_add_f32 v69, v69, v133
    v_mul_f32 v70, v70, v150
    v_cvt_pk_bf16_f32 v70, v70, v70
    v_lshlrev_b32 v70, 16, v70
    v_add_f32 v70, v70, v134
    v_mul_f32 v71, v71, v151
    v_cvt_pk_bf16_f32 v71, v71, v71
    v_lshlrev_b32 v71, 16, v71
    v_add_f32 v71, v71, v135
    v_mul_f32 v72, v72, v152
    v_cvt_pk_bf16_f32 v72, v72, v72
    v_lshlrev_b32 v72, 16, v72
    v_add_f32 v72, v72, v136
    v_mul_f32 v73, v73, v153
    v_cvt_pk_bf16_f32 v73, v73, v73
    v_lshlrev_b32 v73, 16, v73
    v_add_f32 v73, v73, v137
    v_mul_f32 v74, v74, v154
    v_cvt_pk_bf16_f32 v74, v74, v74
    v_lshlrev_b32 v74, 16, v74
    v_add_f32 v74, v74, v138
    v_mul_f32 v75, v75, v155
    v_cvt_pk_bf16_f32 v75, v75, v75
    v_lshlrev_b32 v75, 16, v75
    v_add_f32 v75, v75, v139
    v_mul_f32 v76, v76, v156
    v_cvt_pk_bf16_f32 v76, v76, v76
    v_lshlrev_b32 v76, 16, v76
    v_add_f32 v76, v76, v140
    v_mul_f32 v77, v77, v157
    v_cvt_pk_bf16_f32 v77, v77, v77
    v_lshlrev_b32 v77, 16, v77
    v_add_f32 v77, v77, v141
    v_mul_f32 v78, v78, v158
    v_cvt_pk_bf16_f32 v78, v78, v78
    v_lshlrev_b32 v78, 16, v78
    v_add_f32 v78, v78, v142
    v_mul_f32 v79, v79, v159
    v_cvt_pk_bf16_f32 v79, v79, v79
    v_lshlrev_b32 v79, 16, v79
    v_add_f32 v79, v79, v143
    v_cvt_pk_bf16_f32 v80, v64, v65
    v_cvt_pk_bf16_f32 v81, v66, v67
    v_cvt_pk_bf16_f32 v82, v68, v69
    v_cvt_pk_bf16_f32 v83, v70, v71
    v_cvt_pk_bf16_f32 v84, v72, v73
    v_cvt_pk_bf16_f32 v85, v74, v75
    v_cvt_pk_bf16_f32 v86, v76, v77
    v_cvt_pk_bf16_f32 v87, v78, v79
    s_lshr_b32 s45, s63, 5
    s_lshl_b32 s45, s45, 16
    s_and_b32 s46, s63, 31
    s_lshl_b32 s46, s46, 8
    s_add_u32 s45, s45, s46
    s_add_u32 s45, s45, 0xc00000
    s_add_u32 s46, s45, 32768
    buffer_store_dwordx4 v[80:83], v2, s[12:15], s45 offen sc1
    buffer_store_dwordx4 v[84:87], v2, s[12:15], s46 offen sc1
L_b_skip_148:
    s_waitcnt vmcnt(0)
    s_barrier
    s_cmp_lg_u32 s44, 0
    s_cbranch_scc1 L_pub_155
    v_mov_b32 v30, s62
    v_mov_b32 v31, 0
    s_mov_b64 exec, 1
    buffer_store_dword v30, v31, s[80:83], s65 offen
    buffer_store_dword v30, v31, s[84:87], s65 offen sc1
    s_mov_b64 exec, -1
L_pub_155:
    s_cmp_ge_u32 s41, 28
    s_cbranch_scc1 L_b_loop_147
    s_add_u32 s45, s64, 8192
    s_cmp_lg_u32 s44, 0
    s_cbranch_scc1 L_pw_156
    s_mov_b32 exec_hi, 0
    s_mov_b32 s70, 0
L_wp_157:
    buffer_load_dword v31, v5, s[12:15], s45 offen sc1
    s_add_u32 s70, s70, 1
    s_cmp_ge_u32 s70, 0x200000
    s_cbranch_scc1 L_w_done_102
    s_waitcnt vmcnt(0)
    v_cmp_gt_u32 vcc, s62, v31
    s_nop 1
    s_cbranch_vccz L_wp_157_ok
    s_sleep 1
    s_branch L_wp_157
L_wp_157_ok:
    s_mov_b64 exec, -1
L_pw_156:
    s_barrier
    s_mul_i32 s53, s50, 65536
    s_add_u32 s53, s53, s52
    s_lshl_b32 s54, s44, 13
    s_add_u32 s53, s53, s54
    s_mul_i32 s57, s50, 229376
    s_add_u32 s57, s57, s56
    s_lshl_b32 s45, s44, 11
    s_add_u32 s57, s57, s45
    s_add_u32 s55, s54, 65536
    s_mov_b32 s58, 0
    v_mov_b32 v13, v3
    v_add_u32 v14, 65536, v13
    v_xor_b32 v15, 64, v13
    v_xor_b32 v16, 64, v14
    s_mov_b32 s76, 0x20000000
    s_add_u32 s48, s53, 0
    s_add_u32 s49, s48, 4096
    s_add_u32 m0, s54, 0
    s_nop 0
    buffer_load_dwordx4 v6, s[12:15], s48 offen offset:0 sc1 lds
    s_add_u32 m0, s54, 1024
    s_nop 0
    buffer_load_dwordx4 v9, s[12:15], s48 offen offset:0 sc1 lds
    s_add_u32 m0, s54, 2048
    s_nop 0
    buffer_load_dwordx4 v6, s[12:15], s49 offen offset:0 sc1 lds
    s_add_u32 m0, s54, 3072
    s_nop 0
    buffer_load_dwordx4 v9, s[12:15], s49 offen offset:0 sc1 lds
    s_add_u32 m0, s54, 3968
    s_nop 0
    buffer_load_dwordx4 v6, s[12:15], s48 offen offset:128 sc1 lds
    s_add_u32 m0, s54, 4992
    s_nop 0
    buffer_load_dwordx4 v9, s[12:15], s48 offen offset:128 sc1 lds
    s_add_u32 m0, s54, 6016
    s_nop 0
    buffer_load_dwordx4 v6, s[12:15], s49 offen offset:128 sc1 lds
    s_add_u32 m0, s54, 7040
    s_nop 0
    buffer_load_dwordx4 v9, s[12:15], s49 offen offset:128 sc1 lds
    s_add_u32 s48, s53, 32768
    s_add_u32 s49, s48, 4096
    s_add_u32 s46, s54, 32768
    s_add_u32 m0, s46, 0
    s_nop 0
    buffer_load_dwordx4 v6, s[12:15], s48 offen offset:0 sc1 lds
    s_add_u32 m0, s46, 1024
    s_nop 0
    buffer_load_dwordx4 v9, s[12:15], s48 offen offset:0 sc1 lds
    s_add_u32 m0, s46, 2048
    s_nop 0
    buffer_load_dwordx4 v6, s[12:15], s49 offen offset:0 sc1 lds
    s_add_u32 m0, s46, 3072
    s_nop 0
    buffer_load_dwordx4 v9, s[12:15], s49 offen offset:0 sc1 lds
    s_add_u32 m0, s46, 3968
    s_nop 0
    buffer_load_dwordx4 v6, s[12:15], s48 offen offset:128 sc1 lds
    s_add_u32 m0, s46, 4992
    s_nop 0
    buffer_load_dwordx4 v9, s[12:15], s48 offen offset:128 sc1 lds
    s_add_u32 m0, s46, 6016
    s_nop 0
    buffer_load_dwordx4 v6, s[12:15], s49 offen offset:128 sc1 lds
    s_add_u32 m0, s46, 7040
    s_nop 0
    buffer_load_dwordx4 v9, s[12:15], s49 offen offset:128 sc1 lds
    s_cmp_eq_u32 s51, 1
    s_cbranch_scc1 L_e_one_159
    s_add_u32 s48, s53, 65536
    s_add_u32 s49, s48, 4096
    s_add_u32 m0, s55, 0
    s_nop 0
    buffer_load_dwordx4 v6, s[12:15], s48 offen offset:0 sc1 lds
    s_add_u32 m0, s55, 1024
    s_nop 0
    buffer_load_dwordx4 v9, s[12:15], s48 offen offset:0 sc1 lds
    s_add_u32 m0, s55, 2048
    s_nop 0
    buffer_load_dwordx4 v6, s[12:15], s49 offen offset:0 sc1 lds
    s_add_u32 m0, s55, 3072
    s_nop 0
    buffer_load_dwordx4 v9, s[12:15], s49 offen offset:0 sc1 lds
    s_add_u32 m0, s55, 3968
    s_nop 0
    buffer_load_dwordx4 v6, s[12:15], s48 offen offset:128 sc1 lds
    s_add_u32 m0, s55, 4992
    s_nop 0
    buffer_load_dwordx4 v9, s[12:15], s48 offen offset:128 sc1 lds
    s_add_u32 m0, s55, 6016
    s_nop 0
    buffer_load_dwordx4 v6, s[12:15], s49 offen offset:128 sc1 lds
    s_add_u32 m0, s55, 7040
    s_nop 0
    buffer_load_dwordx4 v9, s[12:15], s49 offen offset:128 sc1 lds
    s_waitcnt vmcnt(16)
    s_barrier
    ds_read_b128 v[32:35], v13 offset:0
    ds_read_b128 v[36:39], v13 offset:2048
    ds_read_b128 v[40:43], v15 offset:0
    ds_read_b128 v[44:47], v15 offset:2048
L_e_loop_158:
    s_add_u32 s48, s53, 98304
    s_add_u32 s46, s58, 1
    s_cmp_lt_u32 s46, s51
    s_cselect_b32 s48, s48, 0x20000000
    s_add_u32 s49, s48, 4096
    s_add_u32 s59, s55, 32768
    s_waitcnt lgkmcnt(2)
    v_mfma_f32_16x16x32_bf16 v[80:83], a[0:3], v[32:35], 0
    ds_read_b128 v[48:51], v13 offset:4096
    ds_read_b128 v[52:55], v13 offset:6144
    v_mfma_f32_16x16x32_bf16 v[84:87], a[4:7], v[32:35], 0
    ds_read_b128 v[56:59], v15 offset:4096
    ds_read_b128 v[60:63], v15 offset:6144
    v_mfma_f32_16x16x32_bf16 v[88:91], a[0:3], v[36:39], 0
    s_add_u32 m0, s59, 0
    s_nop 0
    buffer_load_dwordx4 v6, s[12:15], s48 offen offset:0 sc1 lds
    v_mfma_f32_16x16x32_bf16 v[92:95], a[4:7], v[36:39], 0
    v_lshlrev_b32 v224, 16, v216
    v_and_b32 v225, 0xffff0000, v216
    s_waitcnt lgkmcnt(4)
    v_mfma_f32_16x16x32_bf16 v[80:83], a[8:11], v[40:43], v[80:83]
    ds_read_b128 v[32:35], v13 offset:8192
    ds_read_b128 v[36:39], v13 offset:10240
    v_mfma_f32_16x16x32_bf16 v[84:87], a[12:15], v[40:43], v[84:87]
    v_lshlrev_b32 v226, 16, v217
    v_and_b32 v227, 0xffff0000, v217
    v_mfma_f32_16x16x32_bf16 v[88:91], a[8:11], v[44:47], v[88:91]
    s_add_u32 m0, s59, 1024
    s_nop 0
    buffer_load_dwordx4 v9, s[12:15], s48 offen offset:0 sc1 lds
    v_mfma_f32_16x16x32_bf16 v[92:95], a[12:15], v[44:47], v[92:95]
    v_lshlrev_b32 v228, 16, v218
    v_and_b32 v229, 0xffff0000, v218
    s_waitcnt lgkmcnt(4)
    v_mfma_f32_16x16x32_bf16 v[80:83], a[16:19], v[48:51], v[80:83]
    ds_read_b128 v[40:43], v15 offset:8192
    ds_read_b128 v[44:47], v15 offset:10240
    v_mfma_f32_16x16x32_bf16 v[84:87], a[20:23], v[48:51], v[84:87]
    v_lshlrev_b32 v230, 16, v219
    v_and_b32 v231, 0xffff0000, v219
    v_mfma_f32_16x16x32_bf16 v[88:91], a[16:19], v[52:55], v[88:91]
    s_add_u32 m0, s59, 2048
    s_nop 0
    buffer_load_dwordx4 v6, s[12:15], s49 offen offset:0 sc1 lds
    v_mfma_f32_16x16x32_bf16 v[92:95], a[20:23], v[52:55], v[92:95]
    v_lshlrev_b32 v232, 16, v220
    v_and_b32 v233, 0xffff0000, v220
    s_waitcnt lgkmcnt(4)
    v_mfma_f32_16x16x32_bf16 v[80:83], a[24:27], v[56:59], v[80:83]
    ds_read_b128 v[48:51], v13 offset:12288
    ds_read_b128 v[52:55], v13 offset:14336
    v_mfma_f32_16x16x32_bf16 v[84:87], a[28:31], v[56:59], v[84:87]
    v_lshlrev_b32 v234, 16, v221
    v_and_b32 v235, 0xffff0000, v221
    v_mfma_f32_16x16x32_bf16 v[88:91], a[24:27], v[60:63], v[88:91]
    s_add_u32 m0, s59, 3072
    s_nop 0
    buffer_load_dwordx4 v9, s[12:15], s49 offen offset:0 sc1 lds
    v_mfma_f32_16x16x32_bf16 v[92:95], a[28:31], v[60:63], v[92:95]
    v_lshlrev_b32 v236, 16, v222
    v_and_b32 v237, 0xffff0000, v222
    s_waitcnt lgkmcnt(4)
    v_mfma_f32_16x16x32_bf16 v[80:83], a[32:35], v[32:35], v[80:83]
    ds_read_b128 v[56:59], v15 offset:12288
    ds_read_b128 v[60:63], v15 offset:14336
    v_mfma_f32_16x16x32_bf16 v[84:87], a[36:39], v[32:35], v[84:87]
    v_lshlrev_b32 v238, 16, v223
    v_and_b32 v239, 0xffff0000, v223
    v_mfma_f32_16x16x32_bf16 v[88:91], a[32:35], v[36:39], v[88:91]
    s_add_u32 m0, s59, 3968
    s_nop 0
    buffer_load_dwordx4 v6, s[12:15], s48 offen offset:128 sc1 lds
    v_mfma_f32_16x16x32_bf16 v[92:95], a[36:39], v[36:39], v[92:95]
    v_pk_add_f32 v[224:225], v[224:225], v[96:97]
    v_pk_add_f32 v[226:227], v[226:227], v[98:99]
    s_waitcnt lgkmcnt(4)
    v_mfma_f32_16x16x32_bf16 v[80:83], a[40:43], v[40:43], v[80:83]
    ds_read_b128 v[32:35], v13 offset:16384
    ds_read_b128 v[36:39], v13 offset:18432
    v_mfma_f32_16x16x32_bf16 v[84:87], a[44:47], v[40:43], v[84:87]
    v_pk_add_f32 v[228:229], v[228:229], v[100:101]
    v_pk_add_f32 v[230:231], v[230:231], v[102:103]
    v_mfma_f32_16x16x32_bf16 v[88:91], a[40:43], v[44:47], v[88:91]
    s_add_u32 m0, s59, 4992
    s_nop 0
    buffer_load_dwordx4 v9, s[12:15], s48 offen offset:128 sc1 lds
    v_mfma_f32_16x16x32_bf16 v[92:95], a[44:47], v[44:47], v[92:95]
    v_pk_add_f32 v[232:233], v[232:233], v[96:97]
    v_pk_add_f32 v[234:235], v[234:235], v[98:99]
    s_waitcnt lgkmcnt(4)
    v_mfma_f32_16x16x32_bf16 v[80:83], a[48:51], v[48:51], v[80:83]
    ds_read_b128 v[40:43], v15 offset:16384
    ds_read_b128 v[44:47], v15 offset:18432
    v_mfma_f32_16x16x32_bf16 v[84:87], a[52:55], v[48:51], v[84:87]
    v_pk_add_f32 v[236:237], v[236:237], v[100:101]
    v_pk_add_f32 v[238:239], v[238:239], v[102:103]
    v_mfma_f32_16x16x32_bf16 v[88:91], a[48:51], v[52:55], v[88:91]
    s_add_u32 m0, s59, 6016
    s_nop 0
    buffer_load_dwordx4 v6, s[12:15], s49 offen offset:128 sc1 lds
    v_mfma_f32_16x16x32_bf16 v[92:95], a[52:55], v[52:55], v[92:95]
    v_cvt_pk_bf16_f32 v216, v224, v225
    v_cvt_pk_bf16_f32 v217, v226, v227
    s_waitcnt lgkmcnt(4)
    v_mfma_f32_16x16x32_bf16 v[80:83], a[56:59], v[56:59], v[80:83]
    ds_read_b128 v[48:51], v13 offset:20480
    ds_read_b128 v[52:55], v13 offset:22528
    v_mfma_f32_16x16x32_bf16 v[84:87], a[60:63], v[56:59], v[84:87]
    v_cvt_pk_bf16_f32 v218, v228, v229
    v_cvt_pk_bf16_f32 v219, v230, v231
    v_mfma_f32_16x16x32_bf16 v[88:91], a[56:59], v[60:63], v[88:91]
    s_add_u32 m0, s59, 7040
    s_nop 0
    buffer_load_dwordx4 v9, s[12:15], s49 offen offset:128 sc1 lds
    v_mfma_f32_16x16x32_bf16 v[92:95], a[60:63], v[60:63], v[92:95]
    v_cvt_pk_bf16_f32 v220, v232, v233
    v_cvt_pk_bf16_f32 v221, v234, v235
    s_waitcnt lgkmcnt(4)
    v_mfma_f32_16x16x32_bf16 v[80:83], a[64:67], v[32:35], v[80:83]
    ds_read_b128 v[56:59], v15 offset:20480
    ds_read_b128 v[60:63], v15 offset:22528
    v_mfma_f32_16x16x32_bf16 v[84:87], a[68:71], v[32:35], v[84:87]
    v_cvt_pk_bf16_f32 v222, v236, v237
    v_cvt_pk_bf16_f32 v223, v238, v239
    v_mfma_f32_16x16x32_bf16 v[88:91], a[64:67], v[36:39], v[88:91]
    v_lshlrev_b32 v224, 16, v216
    v_and_b32 v225, 0xffff0000, v216
    v_mfma_f32_16x16x32_bf16 v[92:95], a[68:71], v[36:39], v[92:95]
    v_lshlrev_b32 v226, 16, v217
    v_and_b32 v227, 0xffff0000, v217
    s_waitcnt lgkmcnt(4)
    v_mfma_f32_16x16x32_bf16 v[80:83], a[72:75], v[40:43], v[80:83]
    ds_read_b128 v[32:35], v13 offset:24576
    ds_read_b128 v[36:39], v13 offset:26624
    v_mfma_f32_16x16x32_bf16 v[84:87], a[76:79], v[40:43], v[84:87]
    v_lshlrev_b32 v228, 16, v218
    v_and_b32 v229, 0xffff0000, v218
    v_mfma_f32_16x16x32_bf16 v[88:91], a[72:75], v[44:47], v[88:91]
    v_lshlrev_b32 v230, 16, v219
    v_and_b32 v231, 0xffff0000, v219
    v_mfma_f32_16x16x32_bf16 v[92:95], a[76:79], v[44:47], v[92:95]
    v_lshlrev_b32 v232, 16, v220
    v_and_b32 v233, 0xffff0000, v220
    s_waitcnt lgkmcnt(4)
    v_mfma_f32_16x16x32_bf16 v[80:83], a[80:83], v[48:51], v[80:83]
    ds_read_b128 v[40:43], v15 offset:24576
    ds_read_b128 v[44:47], v15 offset:26624
    v_mfma_f32_16x16x32_bf16 v[84:87], a[84:87], v[48:51], v[84:87]
    v_lshlrev_b32 v234, 16, v221
    v_and_b32 v235, 0xffff0000, v221
    v_mfma_f32_16x16x32_bf16 v[88:91], a[80:83], v[52:55], v[88:91]
    v_lshlrev_b32 v236, 16, v222
    v_and_b32 v237, 0xffff0000, v222
    v_mfma_f32_16x16x32_bf16 v[92:95], a[84:87], v[52:55], v[92:95]
    v_lshlrev_b32 v238, 16, v223
    v_and_b32 v239, 0xffff0000, v223
    s_waitcnt lgkmcnt(4)
    v_mfma_f32_16x16x32_bf16 v[80:83], a[88:91], v[56:59], v[80:83]
    ds_read_b128 v[48:51], v13 offset:28672
    ds_read_b128 v[52:55], v13 offset:30720
    v_mfma_f32_16x16x32_bf16 v[84:87], a[92:95], v[56:59], v[84:87]
    v_pk_mul_f32 v[240:241], v[224:225], v[224:225]
    v_pk_mul_f32 v[242:243], v[226:227], v[226:227]
    v_mfma_f32_16x16x32_bf16 v[88:91], a[88:91], v[60:63], v[88:91]
    v_pk_mul_f32 v[244:245], v[228:229], v[228:229]
    v_pk_mul_f32 v[246:247], v[230:231], v[230:231]
    v_mfma_f32_16x16x32_bf16 v[92:95], a[92:95], v[60:63], v[92:95]
    v_pk_mul_f32 v[248:249], v[232:233], v[232:233]
    v_pk_mul_f32 v[250:251], v[234:235], v[234:235]
    s_waitcnt lgkmcnt(4)
    v_mfma_f32_16x16x32_bf16 v[80:83], a[96:99], v[32:35], v[80:83]
    ds_read_b128 v[56:59], v15 offset:28672
    ds_read_b128 v[60:63], v15 offset:30720
    v_mfma_f32_16x16x32_bf16 v[84:87], a[100:103], v[32:35], v[84:87]
    v_pk_mul_f32 v[252:253], v[236:237], v[236:237]
    v_pk_mul_f32 v[254:255], v[238:239], v[238:239]
    v_mfma_f32_16x16x32_bf16 v[88:91], a[96:99], v[36:39], v[88:91]
    v_pk_fma_f32 v[240:241], v[240:241], v[104:105], v[106:107]
    v_pk_fma_f32 v[242:243], v[242:243], v[104:105], v[106:107]
    v_mfma_f32_16x16x32_bf16 v[92:95], a[100:103], v[36:39], v[92:95]
    v_pk_fma_f32 v[244:245], v[244:245], v[104:105], v[106:107]
    v_pk_fma_f32 v[246:247], v[246:247], v[104:105], v[106:107]
    s_waitcnt lgkmcnt(4)
    v_mfma_f32_16x16x32_bf16 v[80:83], a[104:107], v[40:43], v[80:83]
    v_pk_fma_f32 v[248:249], v[248:249], v[104:105], v[106:107]
    v_pk_fma_f32 v[250:251], v[250:251], v[104:105], v[106:107]
    v_mfma_f32_16x16x32_bf16 v[84:87], a[108:111], v[40:43], v[84:87]
    v_pk_fma_f32 v[252:253], v[252:253], v[104:105], v[106:107]
    v_pk_fma_f32 v[254:255], v[254:255], v[104:105], v[106:107]
    v_mfma_f32_16x16x32_bf16 v[88:91], a[104:107], v[44:47], v[88:91]
    v_pk_mul_f32 v[240:241], v[240:241], v[224:225]
    v_pk_mul_f32 v[242:243], v[242:243], v[226:227]
    v_mfma_f32_16x16x32_bf16 v[92:95], a[108:111], v[44:47], v[92:95]
    v_pk_mul_f32 v[244:245], v[244:245], v[228:229]
    v_pk_mul_f32 v[246:247], v[246:247], v[230:231]
    s_waitcnt vmcnt(16) lgkmcnt(0)
    s_barrier
    v_mfma_f32_16x16x32_bf16 v[80:83], a[112:115], v[48:51], v[80:83]
    ds_read_b128 v[32:35], v13 offset:32768
    ds_read_b128 v[36:39], v13 offset:34816
    v_mfma_f32_16x16x32_bf16 v[84:87], a[116:119], v[48:51], v[84:87]
    v_pk_mul_f32 v[248:249], v[248:249], v[232:233]
    v_pk_mul_f32 v[250:251], v[250:251], v[234:235]
    v_mfma_f32_16x16x32_bf16 v[88:91], a[112:115], v[52:55], v[88:91]
    v_pk_mul_f32 v[252:253], v[252:253], v[236:237]
    v_pk_mul_f32 v[254:255], v[254:255], v[238:239]
    v_mfma_f32_16x16x32_bf16 v[92:95], a[116:119], v[52:55], v[92:95]
    v_exp_f32 v240, v240
    v_mfma_f32_16x16x32_bf16 v[80:83], a[120:123], v[56:59], v[80:83]
    ds_read_b128 v[40:43], v15 offset:32768
    ds_read_b128 v[44:47], v15 offset:34816
    v_mfma_f32_16x16x32_bf16 v[84:87], a[124:127], v[56:59], v[84:87]
    v_exp_f32 v241, v241
    v_exp_f32 v242, v242
    v_mfma_f32_16x16x32_bf16 v[88:91], a[120:123], v[60:63], v[88:91]
    v_exp_f32 v243, v243
    v_mfma_f32_16x16x32_bf16 v[92:95], a[124:127], v[60:63], v[92:95]
    v_exp_f32 v244, v244
    s_add_u32 s48, s53, 131072
    s_add_u32 s46, s58, 2
    s_cmp_lt_u32 s46, s51
    s_cselect_b32 s48, s48, 0x20000000
    s_add_u32 s49, s48, 4096
    s_mov_b32 s59, s54
    s_waitcnt lgkmcnt(2)
    v_mfma_f32_16x16x32_bf16 v[80:83], a[128:131], v[32:35], v[80:83]
    ds_read_b128 v[48:51], v13 offset:36864
    ds_read_b128 v[52:55], v13 offset:38912
    v_mfma_f32_16x16x32_bf16 v[84:87], a[132:135], v[32:35], v[84:87]
    ds_read_b128 v[56:59], v15 offset:36864
    ds_read_b128 v[60:63], v15 offset:38912
    v_mfma_f32_16x16x32_bf16 v[88:91], a[128:131], v[36:39], v[88:91]
    s_add_u32 m0, s59, 0
    s_nop 0
    buffer_load_dwordx4 v6, s[12:15], s48 offen offset:0 sc1 lds
    v_mfma_f32_16x16x32_bf16 v[92:95], a[132:135], v[36:39], v[92:95]
    v_exp_f32 v245, v245
    v_exp_f32 v246, v246
    s_waitcnt lgkmcnt(4)
    v_mfma_f32_16x16x32_bf16 v[80:83], a[136:139], v[40:43], v[80:83]
    ds_read_b128 v[32:35], v13 offset:40960
    ds_read_b128 v[36:39], v13 offset:43008
    v_mfma_f32_16x16x32_bf16 v[84:87], a[140:143], v[40:43], v[84:87]
    v_exp_f32 v247, v247
    v_exp_f32 v248, v248
    v_mfma_f32_16x16x32_bf16 v[88:91], a[136:139], v[44:47], v[88:91]
    s_add_u32 m0, s59, 1024
    s_nop 0
    buffer_load_dwordx4 v9, s[12:15], s48 offen offset:0 sc1 lds
    v_mfma_f32_16x16x32_bf16 v[92:95], a[140:143], v[44:47], v[92:95]
    v_exp_f32 v249, v249
    v_exp_f32 v250, v250
    s_waitcnt lgkmcnt(4)
    v_mfma_f32_16x16x32_bf16 v[80:83], a[144:147], v[48:51], v[80:83]
    ds_read_b128 v[40:43], v15 offset:40960
    ds_read_b128 v[44:47], v15 offset:43008
    v_mfma_f32_16x16x32_bf16 v[84:87], a[148:151], v[48:51], v[84:87]
    v_exp_f32 v251, v251
    v_exp_f32 v252, v252
    v_mfma_f32_16x16x32_bf16 v[88:91], a[144:147], v[52:55], v[88:91]
    s_add_u32 m0, s59, 2048
    s_nop 0
    buffer_load_dwordx4 v6, s[12:15], s49 offen offset:0 sc1 lds
    v_mfma_f32_16x16x32_bf16 v[92:95], a[148:151], v[52:55], v[92:95]
    v_exp_f32 v253, v253
    v_exp_f32 v254, v254
    s_waitcnt lgkmcnt(4)
    v_mfma_f32_16x16x32_bf16 v[80:83], a[152:155], v[56:59], v[80:83]
    ds_read_b128 v[48:51], v13 offset:45056
    ds_read_b128 v[52:55], v13 offset:47104
    v_mfma_f32_16x16x32_bf16 v[84:87], a[156:159], v[56:59], v[84:87]
    v_exp_f32 v255, v255
    v_add_f32 v240, 1.0, v240
    v_mfma_f32_16x16x32_bf16 v[88:91], a[152:155], v[60:63], v[88:91]
    s_add_u32 m0, s59, 3072
    s_nop 0
    buffer_load_dwordx4 v9, s[12:15], s49 offen offset:0 sc1 lds
    v_mfma_f32_16x16x32_bf16 v[92:95], a[156:159], v[60:63], v[92:95]
    v_add_f32 v241, 1.0, v241
    v_add_f32 v242, 1.0, v242
    s_waitcnt lgkmcnt(4)
    v_mfma_f32_16x16x32_bf16 v[80:83], a[160:163], v[32:35], v[80:83]
    ds_read_b128 v[56:59], v15 offset:45056
    ds_read_b128 v[60:63], v15 offset:47104
    v_mfma_f32_16x16x32_bf16 v[84:87], a[164:167], v[32:35], v[84:87]
    v_add_f32 v243, 1.0, v243
    v_add_f32 v244, 1.0, v244
    v_mfma_f32_16x16x32_bf16 v[88:91], a[160:163], v[36:39], v[88:91]
    s_add_u32 m0, s59, 3968
    s_nop 0
    buffer_load_dwordx4 v6, s[12:15], s48 offen offset:128 sc1 lds
    v_mfma_f32_16x16x32_bf16 v[92:95], a[164:167], v[36:39], v[92:95]
    v_add_f32 v245, 1.0, v245
    v_add_f32 v246, 1.0, v246
    s_waitcnt lgkmcnt(4)
    v_mfma_f32_16x16x32_bf16 v[80:83], a[168:171], v[40:43], v[80:83]
    ds_read_b128 v[32:35], v13 offset:49152
    ds_read_b128 v[36:39], v13 offset:51200
    v_mfma_f32_16x16x32_bf16 v[84:87], a[172:175], v[40:43], v[84:87]
    v_add_f32 v247, 1.0, v247
    v_add_f32 v248, 1.0, v248
    v_mfma_f32_16x16x32_bf16 v[88:91], a[168:171], v[44:47], v[88:91]
    s_add_u32 m0, s59, 4992
    s_nop 0
    buffer_load_dwordx4 v9, s[12:15], s48 offen offset:128 sc1 lds
    v_mfma_f32_16x16x32_bf16 v[92:95], a[172:175], v[44:47], v[92:95]
    v_add_f32 v249, 1.0, v249
    v_add_f32 v250, 1.0, v250
    s_waitcnt lgkmcnt(4)
    v_mfma_f32_16x16x32_bf16 v[80:83], a[176:179], v[48:51], v[80:83]
    ds_read_b128 v[40:43], v15 offset:49152
    ds_read_b128 v[44:47], v15 offset:51200
    v_mfma_f32_16x16x32_bf16 v[84:87], a[180:183], v[48:51], v[84:87]
    v_add_f32 v251, 1.0, v251
    v_add_f32 v252, 1.0, v252
    v_mfma_f32_16x16x32_bf16 v[88:91], a[176:179], v[52:55], v[88:91]
    s_add_u32 m0, s59, 6016
    s_nop 0
    buffer_load_dwordx4 v6, s[12:15], s49 offen offset:128 sc1 lds
    v_mfma_f32_16x16x32_bf16 v[92:95], a[180:183], v[52:55], v[92:95]
    v_add_f32 v253, 1.0, v253
    v_add_f32 v254, 1.0, v254
    s_waitcnt lgkmcnt(4)
    v_mfma_f32_16x16x32_bf16 v[80:83], a[184:187], v[56:59], v[80:83]
    ds_read_b128 v[48:51], v13 offset:53248
    ds_read_b128 v[52:55], v13 offset:55296
    v_mfma_f32_16x16x32_bf16 v[84:87], a[188:191], v[56:59], v[84:87]
    v_add_f32 v255, 1.0, v255
    v_rcp_f32 v240, v240
    v_mfma_f32_16x16x32_bf16 v[88:91], a[184:187], v[60:63], v[88:91]
    s_add_u32 m0, s59, 7040
    s_nop 0
    buffer_load_dwordx4 v9, s[12:15], s49 offen offset:128 sc1 lds
    v_mfma_f32_16x16x32_bf16 v[92:95], a[188:191], v[60:63], v[92:95]
    v_rcp_f32 v241, v241
    v_rcp_f32 v242, v242
    s_waitcnt lgkmcnt(4)
    v_mfma_f32_16x16x32_bf16 v[80:83], a[192:195], v[32:35], v[80:83]
    ds_read_b128 v[56:59], v15 offset:53248
    ds_read_b128 v[60:63], v15 offset:55296
    v_mfma_f32_16x16x32_bf16 v[84:87], a[196:199], v[32:35], v[84:87]
    v_rcp_f32 v243, v243
    v_rcp_f32 v244, v244
    v_mfma_f32_16x16x32_bf16 v[88:91], a[192:195], v[36:39], v[88:91]
    v_rcp_f32 v245, v245
    v_rcp_f32 v246, v246
    v_mfma_f32_16x16x32_bf16 v[92:95], a[196:199], v[36:39], v[92:95]
    v_rcp_f32 v247, v247
    v_rcp_f32 v248, v248
    s_waitcnt lgkmcnt(4)
    v_mfma_f32_16x16x32_bf16 v[80:83], a[200:203], v[40:43], v[80:83]
    ds_read_b128 v[32:35], v13 offset:57344
    ds_read_b128 v[36:39], v13 offset:59392
    v_mfma_f32_16x16x32_bf16 v[84:87], a[204:207], v[40:43], v[84:87]
    v_rcp_f32 v249, v249
    v_rcp_f32 v250, v250
    v_mfma_f32_16x16x32_bf16 v[88:91], a[200:203], v[44:47], v[88:91]
    v_rcp_f32 v251, v251
    v_mfma_f32_16x16x32_bf16 v[92:95], a[204:207], v[44:47], v[92:95]
    v_rcp_f32 v252, v252
    s_waitcnt lgkmcnt(4)
    v_mfma_f32_16x16x32_bf16 v[80:83], a[208:211], v[48:51], v[80:83]
    ds_read_b128 v[40:43], v15 offset:57344
    ds_read_b128 v[44:47], v15 offset:59392
    v_mfma_f32_16x16x32_bf16 v[84:87], a[212:215], v[48:51], v[84:87]
    v_rcp_f32 v253, v253
    v_rcp_f32 v254, v254
    v_mfma_f32_16x16x32_bf16 v[88:91], a[208:211], v[52:55], v[88:91]
    v_rcp_f32 v255, v255
    v_mfma_f32_16x16x32_bf16 v[92:95], a[212:215], v[52:55], v[92:95]
    v_pk_mul_f32 v[224:225], v[224:225], v[240:241]
    s_waitcnt lgkmcnt(4)
    v_mfma_f32_16x16x32_bf16 v[80:83], a[216:219], v[56:59], v[80:83]
    ds_read_b128 v[48:51], v13 offset:61440
    ds_read_b128 v[52:55], v13 offset:63488
    v_mfma_f32_16x16x32_bf16 v[84:87], a[220:223], v[56:59], v[84:87]
    v_pk_mul_f32 v[226:227], v[226:227], v[242:243]
    v_pk_mul_f32 v[228:229], v[228:229], v[244:245]
    v_mfma_f32_16x16x32_bf16 v[88:91], a[216:219], v[60:63], v[88:91]
    v_pk_mul_f32 v[230:231], v[230:231], v[246:247]
    v_mfma_f32_16x16x32_bf16 v[92:95], a[220:223], v[60:63], v[92:95]
    v_pk_mul_f32 v[232:233], v[232:233], v[248:249]
    s_waitcnt lgkmcnt(4)
    v_mfma_f32_16x16x32_bf16 v[80:83], a[224:227], v[32:35], v[80:83]
    ds_read_b128 v[56:59], v15 offset:61440
    ds_read_b128 v[60:63], v15 offset:63488
    v_mfma_f32_16x16x32_bf16 v[84:87], a[228:231], v[32:35], v[84:87]
    v_pk_mul_f32 v[234:235], v[234:235], v[250:251]
    v_pk_mul_f32 v[236:237], v[236:237], v[252:253]
    v_mfma_f32_16x16x32_bf16 v[88:91], a[224:227], v[36:39], v[88:91]
    v_pk_mul_f32 v[238:239], v[238:239], v[254:255]
    v_mfma_f32_16x16x32_bf16 v[92:95], a[228:231], v[36:39], v[92:95]
    v_cvt_pk_bf16_f32 v240, v224, v225
    s_waitcnt lgkmcnt(4)
    v_mfma_f32_16x16x32_bf16 v[80:83], a[232:235], v[40:43], v[80:83]
    v_cvt_pk_bf16_f32 v241, v226, v227
    v_mfma_f32_16x16x32_bf16 v[84:87], a[236:239], v[40:43], v[84:87]
    v_cvt_pk_bf16_f32 v242, v228, v229
    v_mfma_f32_16x16x32_bf16 v[88:91], a[232:235], v[44:47], v[88:91]
    v_cvt_pk_bf16_f32 v243, v230, v231
    v_mfma_f32_16x16x32_bf16 v[92:95], a[236:239], v[44:47], v[92:95]
    v_cvt_pk_bf16_f32 v244, v232, v233
    s_waitcnt vmcnt(16) lgkmcnt(0)
    s_barrier
    v_mfma_f32_16x16x32_bf16 v[80:83], a[240:243], v[48:51], v[80:83]
    ds_read_b128 v[32:35], v14 offset:0
    ds_read_b128 v[36:39], v14 offset:2048
    v_mfma_f32_16x16x32_bf16 v[84:87], a[244:247], v[48:51], v[84:87]
    v_cvt_pk_bf16_f32 v245, v234, v235
    v_cvt_pk_bf16_f32 v246, v236, v237
    v_mfma_f32_16x16x32_bf16 v[88:91], a[240:243], v[52:55], v[88:91]
    v_cvt_pk_bf16_f32 v247, v238, v239
    v_mfma_f32_16x16x32_bf16 v[92:95], a[244:247], v[52:55], v[92:95]
    buffer_store_dwordx4 v[240:243], v10, s[12:15], s76 offen sc1
    v_mfma_f32_16x16x32_bf16 v[80:83], a[248:251], v[56:59], v[80:83]
    ds_read_b128 v[40:43], v16 offset:0
    ds_read_b128 v[44:47], v16 offset:2048
    v_mfma_f32_16x16x32_bf16 v[84:87], a[252:255], v[56:59], v[84:87]
    buffer_store_dwordx4 v[244:247], v10, s[12:15], s76 offen offset:1024 sc1
    v_mfma_f32_16x16x32_bf16 v[88:91], a[248:251], v[60:63], v[88:91]
    v_mfma_f32_16x16x32_bf16 v[92:95], a[252:255], v[60:63], v[92:95]
    s_add_u32 s53, s53, 65536
    s_add_u32 s58, s58, 1
    v_swap_b32 v13, v14
    s_xor_b32 s54, s54, 65536
    s_xor_b32 s55, s55, 65536
    s_mov_b32 s76, s57
    v_swap_b32 v15, v16
    s_add_u32 s57, s57, 229376
    v_cvt_pk_bf16_f32 v216, v80, v81
    v_cvt_pk_bf16_f32 v217, v82, v83
    v_cvt_pk_bf16_f32 v218, v84, v85
    v_cvt_pk_bf16_f32 v219, v86, v87
    v_cvt_pk_bf16_f32 v220, v88, v89
    v_cvt_pk_bf16_f32 v221, v90, v91
    v_cvt_pk_bf16_f32 v222, v92, v93
    v_cvt_pk_bf16_f32 v223, v94, v95
    s_cmp_lt_u32 s58, s51
    s_cbranch_scc1 L_e_loop_158
    s_branch L_e_fin_160
L_e_one_159:
    s_waitcnt vmcnt(8)
    s_barrier
    ds_read_b128 v[32:35], v13 offset:0
    ds_read_b128 v[36:39], v13 offset:2048
    ds_read_b128 v[40:43], v15 offset:0
    ds_read_b128 v[44:47], v15 offset:2048
    s_waitcnt lgkmcnt(2)
    v_mfma_f32_16x16x32_bf16 v[80:83], a[0:3], v[32:35], 0
    ds_read_b128 v[48:51], v13 offset:4096
    ds_read_b128 v[52:55], v13 offset:6144
    v_mfma_f32_16x16x32_bf16 v[84:87], a[4:7], v[32:35], 0
    ds_read_b128 v[56:59], v15 offset:4096
    ds_read_b128 v[60:63], v15 offset:6144
    v_mfma_f32_16x16x32_bf16 v[88:91], a[0:3], v[36:39], 0
    v_mfma_f32_16x16x32_bf16 v[92:95], a[4:7], v[36:39], 0
    s_waitcnt lgkmcnt(4)
    v_mfma_f32_16x16x32_bf16 v[80:83], a[8:11], v[40:43], v[80:83]
    ds_read_b128 v[32:35], v13 offset:8192
    ds_read_b128 v[36:39], v13 offset:10240
    v_mfma_f32_16x16x32_bf16 v[84:87], a[12:15], v[40:43], v[84:87]
    v_mfma_f32_16x16x32_bf16 v[88:91], a[8:11], v[44:47], v[88:91]
    v_mfma_f32_16x16x32_bf16 v[92:95], a[12:15], v[44:47], v[92:95]
    s_waitcnt lgkmcnt(4)
    v_mfma_f32_16x16x32_bf16 v[80:83], a[16:19], v[48:51], v[80:83]
    ds_read_b128 v[40:43], v15 offset:8192
    ds_read_b128 v[44:47], v15 offset:10240
    v_mfma_f32_16x16x32_bf16 v[84:87], a[20:23], v[48:51], v[84:87]
    v_mfma_f32_16x16x32_bf16 v[88:91], a[16:19], v[52:55], v[88:91]
    v_mfma_f32_16x16x32_bf16 v[92:95], a[20:23], v[52:55], v[92:95]
    s_waitcnt lgkmcnt(4)
    v_mfma_f32_16x16x32_bf16 v[80:83], a[24:27], v[56:59], v[80:83]
    ds_read_b128 v[48:51], v13 offset:12288
    ds_read_b128 v[52:55], v13 offset:14336
    v_mfma_f32_16x16x32_bf16 v[84:87], a[28:31], v[56:59], v[84:87]
    v_mfma_f32_16x16x32_bf16 v[88:91], a[24:27], v[60:63], v[88:91]
    v_mfma_f32_16x16x32_bf16 v[92:95], a[28:31], v[60:63], v[92:95]
    s_waitcnt lgkmcnt(4)
    v_mfma_f32_16x16x32_bf16 v[80:83], a[32:35], v[32:35], v[80:83]
    ds_read_b128 v[56:59], v15 offset:12288
    ds_read_b128 v[60:63], v15 offset:14336
    v_mfma_f32_16x16x32_bf16 v[84:87], a[36:39], v[32:35], v[84:87]
    v_mfma_f32_16x16x32_bf16 v[88:91], a[32:35], v[36:39], v[88:91]
    v_mfma_f32_16x16x32_bf16 v[92:95], a[36:39], v[36:39], v[92:95]
    s_waitcnt lgkmcnt(4)
    v_mfma_f32_16x16x32_bf16 v[80:83], a[40:43], v[40:43], v[80:83]
    ds_read_b128 v[32:35], v13 offset:16384
    ds_read_b128 v[36:39], v13 offset:18432
    v_mfma_f32_16x16x32_bf16 v[84:87], a[44:47], v[40:43], v[84:87]
    v_mfma_f32_16x16x32_bf16 v[88:91], a[40:43], v[44:47], v[88:91]
    v_mfma_f32_16x16x32_bf16 v[92:95], a[44:47], v[44:47], v[92:95]
    s_waitcnt lgkmcnt(4)
    v_mfma_f32_16x16x32_bf16 v[80:83], a[48:51], v[48:51], v[80:83]
    ds_read_b128 v[40:43], v15 offset:16384
    ds_read_b128 v[44:47], v15 offset:18432
    v_mfma_f32_16x16x32_bf16 v[84:87], a[52:55], v[48:51], v[84:87]
    v_mfma_f32_16x16x32_bf16 v[88:91], a[48:51], v[52:55], v[88:91]
    v_mfma_f32_16x16x32_bf16 v[92:95], a[52:55], v[52:55], v[92:95]
    s_waitcnt lgkmcnt(4)
    v_mfma_f32_16x16x32_bf16 v[80:83], a[56:59], v[56:59], v[80:83]
    ds_read_b128 v[48:51], v13 offset:20480
    ds_read_b128 v[52:55], v13 offset:22528
    v_mfma_f32_16x16x32_bf16 v[84:87], a[60:63], v[56:59], v[84:87]
    v_mfma_f32_16x16x32_bf16 v[88:91], a[56:59], v[60:63], v[88:91]
    v_mfma_f32_16x16x32_bf16 v[92:95], a[60:63], v[60:63], v[92:95]
    s_waitcnt lgkmcnt(4)
    v_mfma_f32_16x16x32_bf16 v[80:83], a[64:67], v[32:35], v[80:83]
    ds_read_b128 v[56:59], v15 offset:20480
    ds_read_b128 v[60:63], v15 offset:22528
    v_mfma_f32_16x16x32_bf16 v[84:87], a[68:71], v[32:35], v[84:87]
    v_mfma_f32_16x16x32_bf16 v[88:91], a[64:67], v[36:39], v[88:91]
    v_mfma_f32_16x16x32_bf16 v[92:95], a[68:71], v[36:39], v[92:95]
    s_waitcnt lgkmcnt(4)
    v_mfma_f32_16x16x32_bf16 v[80:83], a[72:75], v[40:43], v[80:83]
    ds_read_b128 v[32:35], v13 offset:24576
    ds_read_b128 v[36:39], v13 offset:26624
    v_mfma_f32_16x16x32_bf16 v[84:87], a[76:79], v[40:43], v[84:87]
    v_mfma_f32_16x16x32_bf16 v[88:91], a[72:75], v[44:47], v[88:91]
    v_mfma_f32_16x16x32_bf16 v[92:95], a[76:79], v[44:47], v[92:95]
    s_waitcnt lgkmcnt(4)
    v_mfma_f32_16x16x32_bf16 v[80:83], a[80:83], v[48:51], v[80:83]
    ds_read_b128 v[40:43], v15 offset:24576
    ds_read_b128 v[44:47], v15 offset:26624
    v_mfma_f32_16x16x32_bf16 v[84:87], a[84:87], v[48:51], v[84:87]
    v_mfma_f32_16x16x32_bf16 v[88:91], a[80:83], v[52:55], v[88:91]
    v_mfma_f32_16x16x32_bf16 v[92:95], a[84:87], v[52:55], v[92:95]
    s_waitcnt lgkmcnt(4)
    v_mfma_f32_16x16x32_bf16 v[80:83], a[88:91], v[56:59], v[80:83]
    ds_read_b128 v[48:51], v13 offset:28672
    ds_read_b128 v[52:55], v13 offset:30720
    v_mfma_f32_16x16x32_bf16 v[84:87], a[92:95], v[56:59], v[84:87]
    v_mfma_f32_16x16x32_bf16 v[88:91], a[88:91], v[60:63], v[88:91]
    v_mfma_f32_16x16x32_bf16 v[92:95], a[92:95], v[60:63], v[92:95]
    s_waitcnt lgkmcnt(4)
    v_mfma_f32_16x16x32_bf16 v[80:83], a[96:99], v[32:35], v[80:83]
    ds_read_b128 v[56:59], v15 offset:28672
    ds_read_b128 v[60:63], v15 offset:30720
    v_mfma_f32_16x16x32_bf16 v[84:87], a[100:103], v[32:35], v[84:87]
    v_mfma_f32_16x16x32_bf16 v[88:91], a[96:99], v[36:39], v[88:91]
    v_mfma_f32_16x16x32_bf16 v[92:95], a[100:103], v[36:39], v[92:95]
    s_waitcnt lgkmcnt(4)
    v_mfma_f32_16x16x32_bf16 v[80:83], a[104:107], v[40:43], v[80:83]
    v_mfma_f32_16x16x32_bf16 v[84:87], a[108:111], v[40:43], v[84:87]
    v_mfma_f32_16x16x32_bf16 v[88:91], a[104:107], v[44:47], v[88:91]
    v_mfma_f32_16x16x32_bf16 v[92:95], a[108:111], v[44:47], v[92:95]
    s_waitcnt vmcnt(0) lgkmcnt(0)
    s_barrier
    v_mfma_f32_16x16x32_bf16 v[80:83], a[112:115], v[48:51], v[80:83]
    ds_read_b128 v[32:35], v13 offset:32768
    ds_read_b128 v[36:39], v13 offset:34816
    v_mfma_f32_16x16x32_bf16 v[84:87], a[116:119], v[48:51], v[84:87]
    v_mfma_f32_16x16x32_bf16 v[88:91], a[112:115], v[52:55], v[88:91]
    v_mfma_f32_16x16x32_bf16 v[92:95], a[116:119], v[52:55], v[92:95]
    v_mfma_f32_16x16x32_bf16 v[80:83], a[120:123], v[56:59], v[80:83]
    ds_read_b128 v[40:43], v15 offset:32768
    ds_read_b128 v[44:47], v15 offset:34816
    v_mfma_f32_16x16x32_bf16 v[84:87], a[124:127], v[56:59], v[84:87]
    v_mfma_f32_16x16x32_bf16 v[88:91], a[120:123], v[60:63], v[88:91]
    v_mfma_f32_16x16x32_bf16 v[92:95], a[124:127], v[60:63], v[92:95]
    s_waitcnt lgkmcnt(2)
    v_mfma_f32_16x16x32_bf16 v[80:83], a[128:131], v[32:35], v[80:83]
    ds_read_b128 v[48:51], v13 offset:36864
    ds_read_b128 v[52:55], v13 offset:38912
    v_mfma_f32_16x16x32_bf16 v[84:87], a[132:135], v[32:35], v[84:87]
    ds_read_b128 v[56:59], v15 offset:36864
    ds_read_b128 v[60:63], v15 offset:38912
    v_mfma_f32_16x16x32_bf16 v[88:91], a[128:131], v[36:39], v[88:91]
    v_mfma_f32_16x16x32_bf16 v[92:95], a[132:135], v[36:39], v[92:95]
    s_waitcnt lgkmcnt(4)
    v_mfma_f32_16x16x32_bf16 v[80:83], a[136:139], v[40:43], v[80:83]
    ds_read_b128 v[32:35], v13 offset:40960
    ds_read_b128 v[36:39], v13 offset:43008
    v_mfma_f32_16x16x32_bf16 v[84:87], a[140:143], v[40:43], v[84:87]
    v_mfma_f32_16x16x32_bf16 v[88:91], a[136:139], v[44:47], v[88:91]
    v_mfma_f32_16x16x32_bf16 v[92:95], a[140:143], v[44:47], v[92:95]
    s_waitcnt lgkmcnt(4)
    v_mfma_f32_16x16x32_bf16 v[80:83], a[144:147], v[48:51], v[80:83]
    ds_read_b128 v[40:43], v15 offset:40960
    ds_read_b128 v[44:47], v15 offset:43008
    v_mfma_f32_16x16x32_bf16 v[84:87], a[148:151], v[48:51], v[84:87]
    v_mfma_f32_16x16x32_bf16 v[88:91], a[144:147], v[52:55], v[88:91]
    v_mfma_f32_16x16x32_bf16 v[92:95], a[148:151], v[52:55], v[92:95]
    s_waitcnt lgkmcnt(4)
    v_mfma_f32_16x16x32_bf16 v[80:83], a[152:155], v[56:59], v[80:83]
    ds_read_b128 v[48:51], v13 offset:45056
    ds_read_b128 v[52:55], v13 offset:47104
    v_mfma_f32_16x16x32_bf16 v[84:87], a[156:159], v[56:59], v[84:87]
    v_mfma_f32_16x16x32_bf16 v[88:91], a[152:155], v[60:63], v[88:91]
    v_mfma_f32_16x16x32_bf16 v[92:95], a[156:159], v[60:63], v[92:95]
    s_waitcnt lgkmcnt(4)
    v_mfma_f32_16x16x32_bf16 v[80:83], a[160:163], v[32:35], v[80:83]
    ds_read_b128 v[56:59], v15 offset:45056
    ds_read_b128 v[60:63], v15 offset:47104
    v_mfma_f32_16x16x32_bf16 v[84:87], a[164:167], v[32:35], v[84:87]
    v_mfma_f32_16x16x32_bf16 v[88:91], a[160:163], v[36:39], v[88:91]
    v_mfma_f32_16x16x32_bf16 v[92:95], a[164:167], v[36:39], v[92:95]
    s_waitcnt lgkmcnt(4)
    v_mfma_f32_16x16x32_bf16 v[80:83], a[168:171], v[40:43], v[80:83]
    ds_read_b128 v[32:35], v13 offset:49152
    ds_read_b128 v[36:39], v13 offset:51200
    v_mfma_f32_16x16x32_bf16 v[84:87], a[172:175], v[40:43], v[84:87]
    v_mfma_f32_16x16x32_bf16 v[88:91], a[168:171], v[44:47], v[88:91]
    v_mfma_f32_16x16x32_bf16 v[92:95], a[172:175], v[44:47], v[92:95]
    s_waitcnt lgkmcnt(4)
    v_mfma_f32_16x16x32_bf16 v[80:83], a[176:179], v[48:51], v[80:83]
    ds_read_b128 v[40:43], v15 offset:49152
    ds_read_b128 v[44:47], v15 offset:51200
    v_mfma_f32_16x16x32_bf16 v[84:87], a[180:183], v[48:51], v[84:87]
    v_mfma_f32_16x16x32_bf16 v[88:91], a[176:179], v[52:55], v[88:91]
    v_mfma_f32_16x16x32_bf16 v[92:95], a[180:183], v[52:55], v[92:95]
    s_waitcnt lgkmcnt(4)
    v_mfma_f32_16x16x32_bf16 v[80:83], a[184:187], v[56:59], v[80:83]
    ds_read_b128 v[48:51], v13 offset:53248
    ds_read_b128 v[52:55], v13 offset:55296
    v_mfma_f32_16x16x32_bf16 v[84:87], a[188:191], v[56:59], v[84:87]
    v_mfma_f32_16x16x32_bf16 v[88:91], a[184:187], v[60:63], v[88:91]
    v_mfma_f32_16x16x32_bf16 v[92:95], a[188:191], v[60:63], v[92:95]
    s_waitcnt lgkmcnt(4)
    v_mfma_f32_16x16x32_bf16 v[80:83], a[192:195], v[32:35], v[80:83]
    ds_read_b128 v[56:59], v15 offset:53248
    ds_read_b128 v[60:63], v15 offset:55296
    v_mfma_f32_16x16x32_bf16 v[84:87], a[196:199], v[32:35], v[84:87]
    v_mfma_f32_16x16x32_bf16 v[88:91], a[192:195], v[36:39], v[88:91]
    v_mfma_f32_16x16x32_bf16 v[92:95], a[196:199], v[36:39], v[92:95]
    s_waitcnt lgkmcnt(4)
    v_mfma_f32_16x16x32_bf16 v[80:83], a[200:203], v[40:43], v[80:83]
    ds_read_b128 v[32:35], v13 offset:57344
    ds_read_b128 v[36:39], v13 offset:59392
    v_mfma_f32_16x16x32_bf16 v[84:87], a[204:207], v[40:43], v[84:87]
    v_mfma_f32_16x16x32_bf16 v[88:91], a[200:203], v[44:47], v[88:91]
    v_mfma_f32_16x16x32_bf16 v[92:95], a[204:207], v[44:47], v[92:95]
    s_waitcnt lgkmcnt(4)
    v_mfma_f32_16x16x32_bf16 v[80:83], a[208:211], v[48:51], v[80:83]
    ds_read_b128 v[40:43], v15 offset:57344
    ds_read_b128 v[44:47], v15 offset:59392
    v_mfma_f32_16x16x32_bf16 v[84:87], a[212:215], v[48:51], v[84:87]
    v_mfma_f32_16x16x32_bf16 v[88:91], a[208:211], v[52:55], v[88:91]
    v_mfma_f32_16x16x32_bf16 v[92:95], a[212:215], v[52:55], v[92:95]
    s_waitcnt lgkmcnt(4)
    v_mfma_f32_16x16x32_bf16 v[80:83], a[216:219], v[56:59], v[80:83]
    ds_read_b128 v[48:51], v13 offset:61440
    ds_read_b128 v[52:55], v13 offset:63488
    v_mfma_f32_16x16x32_bf16 v[84:87], a[220:223], v[56:59], v[84:87]
    v_mfma_f32_16x16x32_bf16 v[88:91], a[216:219], v[60:63], v[88:91]
    v_mfma_f32_16x16x32_bf16 v[92:95], a[220:223], v[60:63], v[92:95]
    s_waitcnt lgkmcnt(4)
    v_mfma_f32_16x16x32_bf16 v[80:83], a[224:227], v[32:35], v[80:83]
    ds_read_b128 v[56:59], v15 offset:61440
    ds_read_b128 v[60:63], v15 offset:63488
    v_mfma_f32_16x16x32_bf16 v[84:87], a[228:231], v[32:35], v[84:87]
    v_mfma_f32_16x16x32_bf16 v[88:91], a[224:227], v[36:39], v[88:91]
    v_mfma_f32_16x16x32_bf16 v[92:95], a[228:231], v[36:39], v[92:95]
    s_waitcnt lgkmcnt(4)
    v_mfma_f32_16x16x32_bf16 v[80:83], a[232:235], v[40:43], v[80:83]
    v_mfma_f32_16x16x32_bf16 v[84:87], a[236:239], v[40:43], v[84:87]
    v_mfma_f32_16x16x32_bf16 v[88:91], a[232:235], v[44:47], v[88:91]
    v_mfma_f32_16x16x32_bf16 v[92:95], a[236:239], v[44:47], v[92:95]
    s_waitcnt lgkmcnt(0)
    v_mfma_f32_16x16x32_bf16 v[80:83], a[240:243], v[48:51], v[80:83]
    v_mfma_f32_16x16x32_bf16 v[84:87], a[244:247], v[48:51], v[84:87]
    v_mfma_f32_16x16x32_bf16 v[88:91], a[240:243], v[52:55], v[88:91]
    v_mfma_f32_16x16x32_bf16 v[92:95], a[244:247], v[52:55], v[92:95]
    v_mfma_f32_16x16x32_bf16 v[80:83], a[248:251], v[56:59], v[80:83]
    v_mfma_f32_16x16x32_bf16 v[84:87], a[252:255], v[56:59], v[84:87]
    v_mfma_f32_16x16x32_bf16 v[88:91], a[248:251], v[60:63], v[88:91]
    v_mfma_f32_16x16x32_bf16 v[92:95], a[252:255], v[60:63], v[92:95]
    s_mov_b32 s76, s57
    s_nop 6
    v_cvt_pk_bf16_f32 v216, v80, v81
    v_cvt_pk_bf16_f32 v217, v82, v83
    v_cvt_pk_bf16_f32 v218, v84, v85
    v_cvt_pk_bf16_f32 v219, v86, v87
    v_cvt_pk_bf16_f32 v220, v88, v89
    v_cvt_pk_bf16_f32 v221, v90, v91
    v_cvt_pk_bf16_f32 v222, v92, v93
    v_cvt_pk_bf16_f32 v223, v94, v95
L_e_fin_160:
    v_lshlrev_b32 v224, 16, v216
    v_and_b32 v225, 0xffff0000, v216
    v_lshlrev_b32 v226, 16, v217
    v_and_b32 v227, 0xffff0000, v217
    v_lshlrev_b32 v228, 16, v218
    v_and_b32 v229, 0xffff0000, v218
    v_lshlrev_b32 v230, 16, v219
    v_and_b32 v231, 0xffff0000, v219
    v_lshlrev_b32 v232, 16, v220
    v_and_b32 v233, 0xffff0000, v220
    v_lshlrev_b32 v234, 16, v221
    v_and_b32 v235, 0xffff0000, v221
    v_lshlrev_b32 v236, 16, v222
    v_and_b32 v237, 0xffff0000, v222
    v_lshlrev_b32 v238, 16, v223
    v_and_b32 v239, 0xffff0000, v223
    v_pk_add_f32 v[224:225], v[224:225], v[96:97]
    v_pk_add_f32 v[226:227], v[226:227], v[98:99]
    v_pk_add_f32 v[228:229], v[228:229], v[100:101]
    v_pk_add_f32 v[230:231], v[230:231], v[102:103]
    v_pk_add_f32 v[232:233], v[232:233], v[96:97]
    v_pk_add_f32 v[234:235], v[234:235], v[98:99]
    v_pk_add_f32 v[236:237], v[236:237], v[100:101]
    v_pk_add_f32 v[238:239], v[238:239], v[102:103]
    v_cvt_pk_bf16_f32 v216, v224, v225
    v_cvt_pk_bf16_f32 v217, v226, v227
    v_cvt_pk_bf16_f32 v218, v228, v229
    v_cvt_pk_bf16_f32 v219, v230, v231
    v_cvt_pk_bf16_f32 v220, v232, v233
    v_cvt_pk_bf16_f32 v221, v234, v235
    v_cvt_pk_bf16_f32 v222, v236, v237
    v_cvt_pk_bf16_f32 v223, v238, v239
    v_lshlrev_b32 v224, 16, v216
    v_and_b32 v225, 0xffff0000, v216
    v_lshlrev_b32 v226, 16, v217
    v_and_b32 v227, 0xffff0000, v217
    v_lshlrev_b32 v228, 16, v218
    v_and_b32 v229, 0xffff0000, v218
    v_lshlrev_b32 v230, 16, v219
    v_and_b32 v231, 0xffff0000, v219
    v_lshlrev_b32 v232, 16, v220
    v_and_b32 v233, 0xffff0000, v220
    v_lshlrev_b32 v234, 16, v221
    v_and_b32 v235, 0xffff0000, v221
    v_lshlrev_b32 v236, 16, v222
    v_and_b32 v237, 0xffff0000, v222
    v_lshlrev_b32 v238, 16, v223
    v_and_b32 v239, 0xffff0000, v223
    v_pk_mul_f32 v[240:241], v[224:225], v[224:225]
    v_pk_mul_f32 v[242:243], v[226:227], v[226:227]
    v_pk_mul_f32 v[244:245], v[228:229], v[228:229]
    v_pk_mul_f32 v[246:247], v[230:231], v[230:231]
    v_pk_mul_f32 v[248:249], v[232:233], v[232:233]
    v_pk_mul_f32 v[250:251], v[234:235], v[234:235]
    v_pk_mul_f32 v[252:253], v[236:237], v[236:237]
    v_pk_mul_f32 v[254:255], v[238:239], v[238:239]
    v_pk_fma_f32 v[240:241], v[240:241], v[104:105], v[106:107]
    v_pk_fma_f32 v[242:243], v[242:243], v[104:105], v[106:107]
    v_pk_fma_f32 v[244:245], v[244:245], v[104:105], v[106:107]
    v_pk_fma_f32 v[246:247], v[246:247], v[104:105], v[106:107]
    v_pk_fma_f32 v[248:249], v[248:249], v[104:105], v[106:107]
    v_pk_fma_f32 v[250:251], v[250:251], v[104:105], v[106:107]
    v_pk_fma_f32 v[252:253], v[252:253], v[104:105], v[106:107]
    v_pk_fma_f32 v[254:255], v[254:255], v[104:105], v[106:107]
    v_pk_mul_f32 v[240:241], v[240:241], v[224:225]
    v_pk_mul_f32 v[242:243], v[242:243], v[226:227]
    v_pk_mul_f32 v[244:245], v[244:245], v[228:229]
    v_pk_mul_f32 v[246:247], v[246:247], v[230:231]
    v_pk_mul_f32 v[248:249], v[248:249], v[232:233]
    v_pk_mul_f32 v[250:251], v[250:251], v[234:235]
    v_pk_mul_f32 v[252:253], v[252:253], v[236:237]
    v_pk_mul_f32 v[254:255], v[254:255], v[238:239]
    v_exp_f32 v240, v240
    v_exp_f32 v241, v241
    v_exp_f32 v242, v242
    v_exp_f32 v243, v243
    v_exp_f32 v244, v244
    v_exp_f32 v245, v245
    v_exp_f32 v246, v246
    v_exp_f32 v247, v247
    v_exp_f32 v248, v248
    v_exp_f32 v249, v249
    v_exp_f32 v250, v250
    v_exp_f32 v251, v251
    v_exp_f32 v252, v252
    v_exp_f32 v253, v253
    v_exp_f32 v254, v254
    v_exp_f32 v255, v255
    v_add_f32 v240, 1.0, v240
    v_add_f32 v241, 1.0, v241
    v_add_f32 v242, 1.0, v242
    v_add_f32 v243, 1.0, v243
    v_add_f32 v244, 1.0, v244
    v_add_f32 v245, 1.0, v245
    v_add_f32 v246, 1.0, v246
    v_add_f32 v247, 1.0, v247
    v_add_f32 v248, 1.0, v248
    v_add_f32 v249, 1.0, v249
    v_add_f32 v250, 1.0, v250
    v_add_f32 v251, 1.0, v251
    v_add_f32 v252, 1.0, v252
    v_add_f32 v253, 1.0, v253
    v_add_f32 v254, 1.0, v254
    v_add_f32 v255, 1.0, v255
    v_rcp_f32 v240, v240
    v_rcp_f32 v241, v241
    v_rcp_f32 v242, v242
    v_rcp_f32 v243, v243
    v_rcp_f32 v244, v244
    v_rcp_f32 v245, v245
    v_rcp_f32 v246, v246
    v_rcp_f32 v247, v247
    v_rcp_f32 v248, v248
    v_rcp_f32 v249, v249
    v_rcp_f32 v250, v250
    v_rcp_f32 v251, v251
    v_rcp_f32 v252, v252
    v_rcp_f32 v253, v253
    v_rcp_f32 v254, v254
    v_rcp_f32 v255, v255
    v_pk_mul_f32 v[224:225], v[224:225], v[240:241]
    v_pk_mul_f32 v[226:227], v[226:227], v[242:243]
    v_pk_mul_f32 v[228:229], v[228:229], v[244:245]
    v_pk_mul_f32 v[230:231], v[230:231], v[246:247]
    v_pk_mul_f32 v[232:233], v[232:233], v[248:249]
    v_pk_mul_f32 v[234:235], v[234:235], v[250:251]
    v_pk_mul_f32 v[236:237], v[236:237], v[252:253]
    v_pk_mul_f32 v[238:239], v[238:239], v[254:255]
    v_cvt_pk_bf16_f32 v240, v224, v225
    v_cvt_pk_bf16_f32 v241, v226, v227
    v_cvt_pk_bf16_f32 v242, v228, v229
    v_cvt_pk_bf16_f32 v243, v230, v231
    v_cvt_pk_bf16_f32 v244, v232, v233
    v_cvt_pk_bf16_f32 v245, v234, v235
    v_cvt_pk_bf16_f32 v246, v236, v237
    v_cvt_pk_bf16_f32 v247, v238, v239
    buffer_store_dwordx4 v[240:243], v10, s[12:15], s76 offen sc1
    buffer_store_dwordx4 v[244:247], v10, s[12:15], s76 offen offset:1024 sc1
    s_waitcnt lgkmcnt(0)
    s_waitcnt vmcnt(0)
    s_barrier
    s_cmp_lg_u32 s44, 0
    s_cbranch_scc1 L_pub_161
    v_mov_b32 v30, s62
    v_mov_b32 v31, 0
    s_mov_b64 exec, 1
    buffer_store_dword v30, v31, s[12:15], s67 offen sc1
    s_mov_b64 exec, -1
L_pub_161:
    s_branch L_b_loop_147
L_role_c_124:
    s_load_dwordx2 s[6:7], s[0:1], 80
    s_load_dwordx2 s[8:9], s[0:1], 88
    s_load_dwordx2 s[10:11], s[0:1], 112
    s_waitcnt lgkmcnt(0)
    s_mov_b32 s24, s6
    s_and_b32 s25, s7, 0xffff
    s_mov_b32 s26, 0x700000
    s_mov_b32 s27, 0x00020000
    s_mov_b32 s28, s8
    s_and_b32 s29, s9, 0xffff
    s_mov_b32 s30, 0x800
    s_mov_b32 s31, 0x00020000
    s_mov_b32 s32, s10
    s_and_b32 s33, s11, 0xffff
    s_mov_b32 s34, 0x400000
    s_mov_b32 s35, 0x00020000
    s_mul_i32 s46, s38, 1835008
    s_lshl_b32 s45, s68, 8
    s_add_u32 s46, s46, s45
    s_waitcnt vmcnt(0)
    s_barrier
    v_lshrrev_b32 v20, 4, v1
    s_lshl_b32 s45, s44, 2
    v_add_u32 v21, s45, v20
    s_mov_b32 s45, 2048
    v_mul_lo_u32 v21, v21, s45
    v_lshlrev_b32 v22, 2, v20
    v_and_b32 v23, 15, v1
    v_xor_b32 v22, v22, v23
    v_lshlrev_b32 v22, 4, v22
    v_add_u32 v21, v21, v22
    v_bfe_u32 v22, v1, 2, 2
    v_lshlrev_b32 v23, 3, v20
    v_add_u32 v23, v23, v22
    v_lshlrev_b32 v23, 8, v23
    v_xor_b32 v22, s44, v22
    v_lshlrev_b32 v22, 6, v22
    v_add_u32 v23, v23, v22
    v_and_b32 v22, 3, v1
    v_lshlrev_b32 v22, 3, v22
    v_add_u32 v23, v23, v22
    v_add_u32 v24, 65536, v23
    v_add_u32 v25, 131072, v23
    s_lshl_b32 s47, s44, 10
    s_add_u32 s45, s46, 0x0
    s_add_u32 m0, s47, 0
    s_nop 0
    buffer_load_dwordx4 v21, s[24:27], s45 offen  lds
    s_add_u32 s45, s46, 0x8000
    s_add_u32 m0, s47, 4096
    s_nop 0
    buffer_load_dwordx4 v21, s[24:27], s45 offen  lds
    s_add_u32 s45, s46, 0x10000
    s_add_u32 m0, s47, 8192
    s_nop 0
    buffer_load_dwordx4 v21, s[24:27], s45 offen  lds
    s_add_u32 s45, s46, 0x18000
    s_add_u32 m0, s47, 12288
    s_nop 0
    buffer_load_dwordx4 v21, s[24:27], s45 offen  lds
    s_add_u32 s45, s46, 0x20000
    s_add_u32 m0, s47, 16384
    s_nop 0
    buffer_load_dwordx4 v21, s[24:27], s45 offen  lds
    s_add_u32 s45, s46, 0x28000
    s_add_u32 m0, s47, 20480
    s_nop 0
    buffer_load_dwordx4 v21, s[24:27], s45 offen  lds
    s_add_u32 s45, s46, 0x30000
    s_add_u32 m0, s47, 24576
    s_nop 0
    buffer_load_dwordx4 v21, s[24:27], s45 offen  lds
    s_add_u32 s45, s46, 0x38000
    s_add_u32 m0, s47, 28672
    s_nop 0
    buffer_load_dwordx4 v21, s[24:27], s45 offen  lds
    s_add_u32 s45, s46, 0x40000
    s_add_u32 m0, s47, 32768
    s_nop 0
    buffer_load_dwordx4 v21, s[24:27], s45 offen  lds
    s_add_u32 s45, s46, 0x48000
    s_add_u32 m0, s47, 36864
    s_nop 0
    buffer_load_dwordx4 v21, s[24:27], s45 offen  lds
    s_add_u32 s45, s46, 0x50000
    s_add_u32 m0, s47, 40960
    s_nop 0
    buffer_load_dwordx4 v21, s[24:27], s45 offen  lds
    s_add_u32 s45, s46, 0x58000
    s_add_u32 m0, s47, 45056
    s_nop 0
    buffer_load_dwordx4 v21, s[24:27], s45 offen  lds
    s_add_u32 s45, s46, 0x60000
    s_add_u32 m0, s47, 49152
    s_nop 0
    buffer_load_dwordx4 v21, s[24:27], s45 offen  lds
    s_add_u32 s45, s46, 0x68000
    s_add_u32 m0, s47, 53248
    s_nop 0
    buffer_load_dwordx4 v21, s[24:27], s45 offen  lds
    s_add_u32 s45, s46, 0x70000
    s_add_u32 m0, s47, 57344
    s_nop 0
    buffer_load_dwordx4 v21, s[24:27], s45 offen  lds
    s_add_u32 s45, s46, 0x78000
    s_add_u32 m0, s47, 61440
    s_nop 0
    buffer_load_dwordx4 v21, s[24:27], s45 offen  lds
    s_add_u32 s45, s46, 0x80000
    s_add_u32 m0, s47, 65536
    s_nop 0
    buffer_load_dwordx4 v21, s[24:27], s45 offen  lds
    s_add_u32 s45, s46, 0x88000
    s_add_u32 m0, s47, 69632
    s_nop 0
    buffer_load_dwordx4 v21, s[24:27], s45 offen  lds
    s_add_u32 s45, s46, 0x90000
    s_add_u32 m0, s47, 73728
    s_nop 0
    buffer_load_dwordx4 v21, s[24:27], s45 offen  lds
    s_add_u32 s45, s46, 0x98000
    s_add_u32 m0, s47, 77824
    s_nop 0
    buffer_load_dwordx4 v21, s[24:27], s45 offen  lds
    s_add_u32 s45, s46, 0xa0000
    s_add_u32 m0, s47, 81920
    s_nop 0
    buffer_load_dwordx4 v21, s[24:27], s45 offen  lds
    s_add_u32 s45, s46, 0xa8000
    s_add_u32 m0, s47, 86016
    s_nop 0
    buffer_load_dwordx4 v21, s[24:27], s45 offen  lds
    s_add_u32 s45, s46, 0xb0000
    s_add_u32 m0, s47, 90112
    s_nop 0
    buffer_load_dwordx4 v21, s[24:27], s45 offen  lds
    s_add_u32 s45, s46, 0xb8000
    s_add_u32 m0, s47, 94208
    s_nop 0
    buffer_load_dwordx4 v21, s[24:27], s45 offen  lds
    s_add_u32 s45, s46, 0xc0000
    s_add_u32 m0, s47, 98304
    s_nop 0
    buffer_load_dwordx4 v21, s[24:27], s45 offen  lds
    s_add_u32 s45, s46, 0xc8000
    s_add_u32 m0, s47, 102400
    s_nop 0
    buffer_load_dwordx4 v21, s[24:27], s45 offen  lds
    s_add_u32 s45, s46, 0xd0000
    s_add_u32 m0, s47, 106496
    s_nop 0
    buffer_load_dwordx4 v21, s[24:27], s45 offen  lds
    s_add_u32 s45, s46, 0xd8000
    s_add_u32 m0, s47, 110592
    s_nop 0
    buffer_load_dwordx4 v21, s[24:27], s45 offen  lds
    s_add_u32 s45, s46, 0xe0000
    s_add_u32 m0, s47, 114688
    s_nop 0
    buffer_load_dwordx4 v21, s[24:27], s45 offen  lds
    s_add_u32 s45, s46, 0xe8000
    s_add_u32 m0, s47, 118784
    s_nop 0
    buffer_load_dwordx4 v21, s[24:27], s45 offen  lds
    s_add_u32 s45, s46, 0xf0000
    s_add_u32 m0, s47, 122880
    s_nop 0
    buffer_load_dwordx4 v21, s[24:27], s45 offen  lds
    s_add_u32 s45, s46, 0xf8000
    s_add_u32 m0, s47, 126976
    s_nop 0
    buffer_load_dwordx4 v21, s[24:27], s45 offen  lds
    s_waitcnt vmcnt(28)
    s_barrier
    s_add_u32 s45, s46, 0x100000
    s_add_u32 m0, s47, 131072
    s_nop 0
    buffer_load_dwordx4 v21, s[24:27], s45 offen  lds
    s_add_u32 s45, s46, 0x108000
    s_add_u32 m0, s47, 135168
    s_nop 0
    buffer_load_dwordx4 v21, s[24:27], s45 offen  lds
    s_add_u32 s45, s46, 0x110000
    s_add_u32 m0, s47, 139264
    s_nop 0
    buffer_load_dwordx4 v21, s[24:27], s45 offen  lds
    s_add_u32 s45, s46, 0x118000
    s_add_u32 m0, s47, 143360
    s_nop 0
    buffer_load_dwordx4 v21, s[24:27], s45 offen  lds
    ds_read_b64_tr_b16 a[0:1], v23 offset:0
    ds_read_b64_tr_b16 a[2:3], v23 offset:1024
    ds_read_b64_tr_b16 a[4:5], v23 offset:32
    ds_read_b64_tr_b16 a[6:7], v23 offset:1056
    ds_read_b64_tr_b16 a[8:9], v23 offset:8192
    ds_read_b64_tr_b16 a[10:11], v23 offset:9216
    ds_read_b64_tr_b16 a[12:13], v23 offset:8224
    ds_read_b64_tr_b16 a[14:15], v23 offset:9248
    s_waitcnt lgkmcnt(0)
    s_waitcnt vmcnt(28)
    s_barrier
    s_add_u32 s45, s46, 0x120000
    s_add_u32 m0, s47, 0
    s_nop 0
    buffer_load_dwordx4 v21, s[24:27], s45 offen  lds
    s_add_u32 s45, s46, 0x128000
    s_add_u32 m0, s47, 4096
    s_nop 0
    buffer_load_dwordx4 v21, s[24:27], s45 offen  lds
    s_add_u32 s45, s46, 0x130000
    s_add_u32 m0, s47, 8192
    s_nop 0
    buffer_load_dwordx4 v21, s[24:27], s45 offen  lds
    s_add_u32 s45, s46, 0x138000
    s_add_u32 m0, s47, 12288
    s_nop 0
    buffer_load_dwordx4 v21, s[24:27], s45 offen  lds
    ds_read_b64_tr_b16 a[16:17], v23 offset:16384
    ds_read_b64_tr_b16 a[18:19], v23 offset:17408
    ds_read_b64_tr_b16 a[20:21], v23 offset:16416
    ds_read_b64_tr_b16 a[22:23], v23 offset:17440
    ds_read_b64_tr_b16 a[24:25], v23 offset:24576
    ds_read_b64_tr_b16 a[26:27], v23 offset:25600
    ds_read_b64_tr_b16 a[28:29], v23 offset:24608
    ds_read_b64_tr_b16 a[30:31], v23 offset:25632
    s_waitcnt lgkmcnt(0)
    s_waitcnt vmcnt(28)
    s_barrier
    s_add_u32 s45, s46, 0x140000
    s_add_u32 m0, s47, 16384
    s_nop 0
    buffer_load_dwordx4 v21, s[24:27], s45 offen  lds
    s_add_u32 s45, s46, 0x148000
    s_add_u32 m0, s47, 20480
    s_nop 0
    buffer_load_dwordx4 v21, s[24:27], s45 offen  lds
    s_add_u32 s45, s46, 0x150000
    s_add_u32 m0, s47, 24576
    s_nop 0
    buffer_load_dwordx4 v21, s[24:27], s45 offen  lds
    s_add_u32 s45, s46, 0x158000
    s_add_u32 m0, s47, 28672
    s_nop 0
    buffer_load_dwordx4 v21, s[24:27], s45 offen  lds
    ds_read_b64_tr_b16 a[32:33], v23 offset:32768
    ds_read_b64_tr_b16 a[34:35], v23 offset:33792
    ds_read_b64_tr_b16 a[36:37], v23 offset:32800
    ds_read_b64_tr_b16 a[38:39], v23 offset:33824
    ds_read_b64_tr_b16 a[40:41], v23 offset:40960
    ds_read_b64_tr_b16 a[42:43], v23 offset:41984
    ds_read_b64_tr_b16 a[44:45], v23 offset:40992
    ds_read_b64_tr_b16 a[46:47], v23 offset:42016
    s_waitcnt lgkmcnt(0)
    s_waitcnt vmcnt(28)
    s_barrier
    s_add_u32 s45, s46, 0x160000
    s_add_u32 m0, s47, 32768
    s_nop 0
    buffer_load_dwordx4 v21, s[24:27], s45 offen  lds
    s_add_u32 s45, s46, 0x168000
    s_add_u32 m0, s47, 36864
    s_nop 0
    buffer_load_dwordx4 v21, s[24:27], s45 offen  lds
    s_add_u32 s45, s46, 0x170000
    s_add_u32 m0, s47, 40960
    s_nop 0
    buffer_load_dwordx4 v21, s[24:27], s45 offen  lds
    s_add_u32 s45, s46, 0x178000
    s_add_u32 m0, s47, 45056
    s_nop 0
    buffer_load_dwordx4 v21, s[24:27], s45 offen  lds
    ds_read_b64_tr_b16 a[48:49], v23 offset:49152
    ds_read_b64_tr_b16 a[50:51], v23 offset:50176
    ds_read_b64_tr_b16 a[52:53], v23 offset:49184
    ds_read_b64_tr_b16 a[54:55], v23 offset:50208
    ds_read_b64_tr_b16 a[56:57], v23 offset:57344
    ds_read_b64_tr_b16 a[58:59], v23 offset:58368
    ds_read_b64_tr_b16 a[60:61], v23 offset:57376
    ds_read_b64_tr_b16 a[62:63], v23 offset:58400
    s_waitcnt lgkmcnt(0)
    s_waitcnt vmcnt(28)
    s_barrier
    s_add_u32 s45, s46, 0x180000
    s_add_u32 m0, s47, 49152
    s_nop 0
    buffer_load_dwordx4 v21, s[24:27], s45 offen  lds
    s_add_u32 s45, s46, 0x188000
    s_add_u32 m0, s47, 53248
    s_nop 0
    buffer_load_dwordx4 v21, s[24:27], s45 offen  lds
    s_add_u32 s45, s46, 0x190000
    s_add_u32 m0, s47, 57344
    s_nop 0
    buffer_load_dwordx4 v21, s[24:27], s45 offen  lds
    s_add_u32 s45, s46, 0x198000
    s_add_u32 m0, s47, 61440
    s_nop 0
    buffer_load_dwordx4 v21, s[24:27], s45 offen  lds
    ds_read_b64_tr_b16 a[64:65], v24 offset:0
    ds_read_b64_tr_b16 a[66:67], v24 offset:1024
    ds_read_b64_tr_b16 a[68:69], v24 offset:32
    ds_read_b64_tr_b16 a[70:71], v24 offset:1056
    ds_read_b64_tr_b16 a[72:73], v24 offset:8192
    ds_read_b64_tr_b16 a[74:75], v24 offset:9216
    ds_read_b64_tr_b16 a[76:77], v24 offset:8224
    ds_read_b64_tr_b16 a[78:79], v24 offset:9248
    s_waitcnt lgkmcnt(0)
    s_waitcnt vmcnt(28)
    s_barrier
    s_add_u32 s45, s46, 0x1a0000
    s_add_u32 m0, s47, 65536
    s_nop 0
    buffer_load_dwordx4 v21, s[24:27], s45 offen  lds
    s_add_u32 s45, s46, 0x1a8000
    s_add_u32 m0, s47, 69632
    s_nop 0
    buffer_load_dwordx4 v21, s[24:27], s45 offen  lds
    s_add_u32 s45, s46, 0x1b0000
    s_add_u32 m0, s47, 73728
    s_nop 0
    buffer_load_dwordx4 v21, s[24:27], s45 offen  lds
    s_add_u32 s45, s46, 0x1b8000
    s_add_u32 m0, s47, 77824
    s_nop 0
    buffer_load_dwordx4 v21, s[24:27], s45 offen  lds
    ds_read_b64_tr_b16 a[80:81], v24 offset:16384
    ds_read_b64_tr_b16 a[82:83], v24 offset:17408
    ds_read_b64_tr_b16 a[84:85], v24 offset:16416
    ds_read_b64_tr_b16 a[86:87], v24 offset:17440
    ds_read_b64_tr_b16 a[88:89], v24 offset:24576
    ds_read_b64_tr_b16 a[90:91], v24 offset:25600
    ds_read_b64_tr_b16 a[92:93], v24 offset:24608
    ds_read_b64_tr_b16 a[94:95], v24 offset:25632
    s_waitcnt lgkmcnt(0)
    s_waitcnt vmcnt(28)
    s_barrier
    ds_read_b64_tr_b16 a[96:97], v24 offset:32768
    ds_read_b64_tr_b16 a[98:99], v24 offset:33792
    ds_read_b64_tr_b16 a[100:101], v24 offset:32800
    ds_read_b64_tr_b16 a[102:103], v24 offset:33824
    ds_read_b64_tr_b16 a[104:105], v24 offset:40960
    ds_read_b64_tr_b16 a[106:107], v24 offset:41984
    ds_read_b64_tr_b16 a[108:109], v24 offset:40992
    ds_read_b64_tr_b16 a[110:111], v24 offset:42016
    s_waitcnt lgkmcnt(0)
    s_waitcnt vmcnt(24)
    s_barrier
    ds_read_b64_tr_b16 a[112:113], v24 offset:49152
    ds_read_b64_tr_b16 a[114:115], v24 offset:50176
    ds_read_b64_tr_b16 a[116:117], v24 offset:49184
    ds_read_b64_tr_b16 a[118:119], v24 offset:50208
    ds_read_b64_tr_b16 a[120:121], v24 offset:57344
    ds_read_b64_tr_b16 a[122:123], v24 offset:58368
    ds_read_b64_tr_b16 a[124:125], v24 offset:57376
    ds_read_b64_tr_b16 a[126:127], v24 offset:58400
    s_waitcnt lgkmcnt(0)
    s_waitcnt vmcnt(20)
    s_barrier
    ds_read_b64_tr_b16 a[128:129], v25 offset:0
    ds_read_b64_tr_b16 a[130:131], v25 offset:1024
    ds_read_b64_tr_b16 a[132:133], v25 offset:32
    ds_read_b64_tr_b16 a[134:135], v25 offset:1056
    ds_read_b64_tr_b16 a[136:137], v25 offset:8192
    ds_read_b64_tr_b16 a[138:139], v25 offset:9216
    ds_read_b64_tr_b16 a[140:141], v25 offset:8224
    ds_read_b64_tr_b16 a[142:143], v25 offset:9248
    s_waitcnt lgkmcnt(0)
    s_waitcnt vmcnt(16)
    s_barrier
    ds_read_b64_tr_b16 a[144:145], v23 offset:0
    ds_read_b64_tr_b16 a[146:147], v23 offset:1024
    ds_read_b64_tr_b16 a[148:149], v23 offset:32
    ds_read_b64_tr_b16 a[150:151], v23 offset:1056
    ds_read_b64_tr_b16 a[152:153], v23 offset:8192
    ds_read_b64_tr_b16 a[154:155], v23 offset:9216
    ds_read_b64_tr_b16 a[156:157], v23 offset:8224
    ds_read_b64_tr_b16 a[158:159], v23 offset:9248
    s_waitcnt lgkmcnt(0)
    s_waitcnt vmcnt(12)
    s_barrier
    ds_read_b64_tr_b16 a[160:161], v23 offset:16384
    ds_read_b64_tr_b16 a[162:163], v23 offset:17408
    ds_read_b64_tr_b16 a[164:165], v23 offset:16416
    ds_read_b64_tr_b16 a[166:167], v23 offset:17440
    ds_read_b64_tr_b16 a[168:169], v23 offset:24576
    ds_read_b64_tr_b16 a[170:171], v23 offset:25600
    ds_read_b64_tr_b16 a[172:173], v23 offset:24608
    ds_read_b64_tr_b16 a[174:175], v23 offset:25632
    s_waitcnt lgkmcnt(0)
    s_waitcnt vmcnt(8)
    s_barrier
    ds_read_b64_tr_b16 a[176:177], v23 offset:32768
    ds_read_b64_tr_b16 a[178:179], v23 offset:33792
    ds_read_b64_tr_b16 a[180:181], v23 offset:32800
    ds_read_b64_tr_b16 a[182:183], v23 offset:33824
    ds_read_b64_tr_b16 a[184:185], v23 offset:40960
    ds_read_b64_tr_b16 a[186:187], v23 offset:41984
    ds_read_b64_tr_b16 a[188:189], v23 offset:40992
    ds_read_b64_tr_b16 a[190:191], v23 offset:42016
    s_waitcnt lgkmcnt(0)
    s_waitcnt vmcnt(4)
    s_barrier
    ds_read_b64_tr_b16 a[192:193], v23 offset:49152
    ds_read_b64_tr_b16 a[194:195], v23 offset:50176
    ds_read_b64_tr_b16 a[196:197], v23 offset:49184
    ds_read_b64_tr_b16 a[198:199], v23 offset:50208
    ds_read_b64_tr_b16 a[200:201], v23 offset:57344
    ds_read_b64_tr_b16 a[202:203], v23 offset:58368
    ds_read_b64_tr_b16 a[204:205], v23 offset:57376
    ds_read_b64_tr_b16 a[206:207], v23 offset:58400
    s_waitcnt lgkmcnt(0)
    s_waitcnt vmcnt(0)
    s_barrier
    ds_read_b64_tr_b16 a[208:209], v24 offset:0
    ds_read_b64_tr_b16 a[210:211], v24 offset:1024
    ds_read_b64_tr_b16 a[212:213], v24 offset:32
    ds_read_b64_tr_b16 a[214:215], v24 offset:1056
    ds_read_b64_tr_b16 a[216:217], v24 offset:8192
    ds_read_b64_tr_b16 a[218:219], v24 offset:9216
    ds_read_b64_tr_b16 a[220:221], v24 offset:8224
    ds_read_b64_tr_b16 a[222:223], v24 offset:9248
    s_waitcnt lgkmcnt(0)
    s_barrier
    buffer_load_dwordx4 v[80:83], v10, s[28:31], 0 offen
    buffer_load_dwordx4 v[84:87], v10, s[28:31], 0 offen offset:1024
    s_waitcnt vmcnt(0)
    v_lshlrev_b32 v96, 16, v80
    v_and_b32 v97, 0xffff0000, v80
    v_lshlrev_b32 v98, 16, v81
    v_and_b32 v99, 0xffff0000, v81
    v_lshlrev_b32 v100, 16, v82
    v_and_b32 v101, 0xffff0000, v82
    v_lshlrev_b32 v102, 16, v83
    v_and_b32 v103, 0xffff0000, v83
    v_lshlrev_b32 v104, 16, v84
    v_and_b32 v105, 0xffff0000, v84
    v_lshlrev_b32 v106, 16, v85
    v_and_b32 v107, 0xffff0000, v85
    v_lshlrev_b32 v108, 16, v86
    v_and_b32 v109, 0xffff0000, v86
    v_lshlrev_b32 v110, 16, v87
    v_and_b32 v111, 0xffff0000, v87
    s_cmp_lg_u32 s44, 0
    s_cbranch_scc1 L_pd_162
    v_mov_b32 v29, 132
    s_mov_b32 s46, 96
    s_mov_b64 exec, 1
    s_mov_b32 s70, 0
L_wp_163:
    buffer_load_dword v31, v29, s[16:19], 0 offen sc1
    s_add_u32 s70, s70, 1
    s_cmp_ge_u32 s70, 0x200000
    s_cbranch_scc1 L_w_done_102
    s_waitcnt vmcnt(0)
    v_cmp_gt_u32 vcc, s46, v31
    s_nop 1
    s_cbranch_vccz L_wp_163_ok
    s_sleep 3
    s_branch L_wp_163
L_wp_163_ok:
    s_mov_b64 exec, -1
L_pd_162:
    s_barrier
    v_lshlrev_b32 v29, 5, v1
    s_mov_b32 s45, 20480
    buffer_load_dwordx4 v[112:115], v29, s[12:15], s45 offen offset:0 sc1
    buffer_load_dwordx4 v[116:119], v29, s[12:15], s45 offen offset:16 sc1
    buffer_load_dwordx4 v[120:123], v29, s[12:15], s45 offen offset:2048 sc1
    buffer_load_dwordx4 v[124:127], v29, s[12:15], s45 offen offset:2064 sc1
    s_mov_b32 s45, 45056
    buffer_load_dwordx4 v[32:35], v29, s[12:15], s45 offen offset:0 sc1
    buffer_load_dwordx4 v[36:39], v29, s[12:15], s45 offen offset:16 sc1
    buffer_load_dwordx4 v[40:43], v29, s[12:15], s45 offen offset:2048 sc1
    buffer_load_dwordx4 v[44:47], v29, s[12:15], s45 offen offset:2064 sc1
    s_waitcnt vmcnt(0)
    v_add_f32 v112, v112, v32
    v_cvt_pk_bf16_f32 v112, v112, v112
    v_lshlrev_b32 v112, 16, v112
    v_add_f32 v113, v113, v33
    v_cvt_pk_bf16_f32 v113, v113, v113
    v_lshlrev_b32 v113, 16, v113
    v_add_f32 v114, v114, v34
    v_cvt_pk_bf16_f32 v114, v114, v114
    v_lshlrev_b32 v114, 16, v114
    v_add_f32 v115, v115, v35
    v_cvt_pk_bf16_f32 v115, v115, v115
    v_lshlrev_b32 v115, 16, v115
    v_add_f32 v116, v116, v36
    v_cvt_pk_bf16_f32 v116, v116, v116
    v_lshlrev_b32 v116, 16, v116
    v_add_f32 v117, v117, v37
    v_cvt_pk_bf16_f32 v117, v117, v117
    v_lshlrev_b32 v117, 16, v117
    v_add_f32 v118, v118, v38
    v_cvt_pk_bf16_f32 v118, v118, v118
    v_lshlrev_b32 v118, 16, v118
    v_add_f32 v119, v119, v39
    v_cvt_pk_bf16_f32 v119, v119, v119
    v_lshlrev_b32 v119, 16, v119
    v_add_f32 v120, v120, v40
    v_cvt_pk_bf16_f32 v120, v120, v120
    v_lshlrev_b32 v120, 16, v120
    v_add_f32 v121, v121, v41
    v_cvt_pk_bf16_f32 v121, v121, v121
    v_lshlrev_b32 v121, 16, v121
    v_add_f32 v122, v122, v42
    v_cvt_pk_bf16_f32 v122, v122, v122
    v_lshlrev_b32 v122, 16, v122
    v_add_f32 v123, v123, v43
    v_cvt_pk_bf16_f32 v123, v123, v123
    v_lshlrev_b32 v123, 16, v123
    v_add_f32 v124, v124, v44
    v_cvt_pk_bf16_f32 v124, v124, v124
    v_lshlrev_b32 v124, 16, v124
    v_add_f32 v125, v125, v45
    v_cvt_pk_bf16_f32 v125, v125, v125
    v_lshlrev_b32 v125, 16, v125
    v_add_f32 v126, v126, v46
    v_cvt_pk_bf16_f32 v126, v126, v126
    v_lshlrev_b32 v126, 16, v126
    v_add_f32 v127, v127, v47
    v_cvt_pk_bf16_f32 v127, v127, v127
    v_lshlrev_b32 v127, 16, v127
    s_lshl_b32 s46, s44, 10
    s_add_u32 s45, s46, 20480
    buffer_load_dwordx4 v[22:25], v10, s[12:15], s45 offen sc1
    s_add_u32 s45, s46, 45056
    buffer_load_dwordx4 v[32:35], v10, s[12:15], s45 offen sc1
    s_waitcnt vmcnt(0)
    v_add_f32 v22, v22, v32
    v_cvt_pk_bf16_f32 v22, v22, v22
    v_lshlrev_b32 v22, 16, v22
    v_add_f32 v23, v23, v33
    v_cvt_pk_bf16_f32 v23, v23, v23
    v_lshlrev_b32 v23, 16, v23
    v_add_f32 v24, v24, v34
    v_cvt_pk_bf16_f32 v24, v24, v24
    v_lshlrev_b32 v24, 16, v24
    v_add_f32 v25, v25, v35
    v_cvt_pk_bf16_f32 v25, v25, v25
    v_lshlrev_b32 v25, 16, v25
    v_lshlrev_b32 v17, 3, v1
    s_lshl_b32 s45, s44, 9
    buffer_load_dwordx2 v[80:81], v17, s[28:31], s45 offen
    s_waitcnt vmcnt(0)
    v_lshlrev_b32 v18, 16, v80
    v_and_b32 v19, 0xffff0000, v80
    v_lshlrev_b32 v20, 16, v81
    v_and_b32 v21, 0xffff0000, v81
    s_mul_i32 s52, s38, 57344
    s_add_u32 s52, s52, 0x6000000
    s_lshl_b32 s56, s38, 23
    s_lshl_b32 s45, s68, 9
    s_add_u32 s56, s56, s45
    s_add_u32 s56, s56, 0xc000000
    s_lshl_b32 s45, s40, 2
    s_add_u32 s45, s45, 200
    v_mov_b32 v29, s45
    s_mov_b32 s46, 536870912
    s_mov_b64 exec, 1
    s_mov_b32 s70, 0
L_wp_166:
    buffer_load_dword v31, v29, s[16:19], 0 offen sc1
    s_add_u32 s70, s70, 1
    s_cmp_ge_u32 s70, 0x200000
    s_cbranch_scc1 L_w_done_102
    s_waitcnt vmcnt(0)
    v_cmp_gt_u32 vcc, s46, v31
    s_nop 1
    s_cbranch_vccz L_wp_166_ok
    s_sleep 2
    s_branch L_wp_166
L_wp_166_ok:
    s_mov_b64 exec, -1
    v_readfirstlane_b32 s45, v31
    s_nop 3
    s_and_b32 s46, s45, 511
    s_mul_i32 s46, s46, s46
    s_bfe_u32 s45, s45, 0xf0009
    s_lshl_b32 s45, s45, 5
    s_mov_b32 s80, s12
    s_mov_b32 s81, s13
    s_mov_b32 s83, 0x00020000
    s_mov_b32 s84, s12
    s_mov_b32 s85, s13
    s_mov_b32 s87, 0x00020000
    s_cmp_eq_u32 s45, s46
    s_cselect_b32 s82, s14, 0
    s_cselect_b32 s86, 0, s14
L_c_loop_164:
    s_cmp_eq_u64 s[36:37], 0
    s_cbranch_scc1 L_w_done_102
    s_ff1_i32_b64 s50, s[36:37]
    s_bitset0_b64 s[36:37], s50
    s_lshr_b64 s[74:75], s[72:73], s50
    s_ff1_i32_b64 s51, s[74:75]
    s_add_u32 s51, s51, 1
    s_add_u32 s62, s50, s51
    s_mul_i32 s45, s38, 896
    s_add_u32 s45, s45, s64
    s_add_u32 s45, s45, 12288
    s_cmp_lg_u32 s44, 0
    s_cbranch_scc1 L_pw_167
    s_mov_b64 exec, 127
    s_mov_b32 s70, 0
L_wp_168:
    buffer_load_dword v31, v5, s[12:15], s45 offen sc1
    s_add_u32 s70, s70, 1
    s_cmp_ge_u32 s70, 0x200000
    s_cbranch_scc1 L_w_done_102
    s_waitcnt vmcnt(0)
    v_cmp_gt_u32 vcc, s62, v31
    s_nop 1
    s_cbranch_vccz L_wp_168_ok
    s_sleep 2
    s_branch L_wp_168
L_wp_168_ok:
    s_mov_b64 exec, -1
L_pw_167:
    s_barrier
    s_mul_i32 s53, s50, 229376
    s_add_u32 s53, s53, s52
    s_lshl_b32 s54, s44, 13
    s_add_u32 s53, s53, s54
    s_mul_i32 s57, s50, 131072
    s_add_u32 s57, s57, s56
    s_lshl_b32 s45, s44, 7
    s_add_u32 s57, s57, s45
    s_add_u32 s55, s54, 65536
    s_mov_b32 s58, 0
    v_mov_b32 v13, v10
    v_add_u32 v14, 65536, v13
    v_xor_b32 v15, 64, v13
    v_xor_b32 v16, 64, v14
    s_mov_b32 s76, 0x20000000
    s_add_u32 s48, s53, 0
    s_add_u32 s49, s48, 4096
    s_add_u32 m0, s54, 0
    s_nop 0
    buffer_load_dwordx4 v10, s[12:15], s48 offen offset:0 sc1 lds
    buffer_load_dwordx4 v10, s[12:15], s48 offen offset:1024 sc1 lds
    buffer_load_dwordx4 v10, s[12:15], s48 offen offset:2048 sc1 lds
    buffer_load_dwordx4 v10, s[12:15], s48 offen offset:3072 sc1 lds
    s_add_u32 m0, s54, 4096
    s_nop 0
    buffer_load_dwordx4 v10, s[12:15], s49 offen offset:0 sc1 lds
    buffer_load_dwordx4 v10, s[12:15], s49 offen offset:1024 sc1 lds
    buffer_load_dwordx4 v10, s[12:15], s49 offen offset:2048 sc1 lds
    buffer_load_dwordx4 v10, s[12:15], s49 offen offset:3072 sc1 lds
    s_add_u32 s48, s53, 32768
    s_cmp_lt_u32 s44, 3
    s_cselect_b32 s48, s48, 0x20000000
    s_add_u32 s49, s48, 4096
    s_add_u32 s46, s54, 32768
    s_add_u32 m0, s46, 0
    s_nop 0
    buffer_load_dwordx4 v10, s[12:15], s48 offen offset:0 sc1 lds
    buffer_load_dwordx4 v10, s[12:15], s48 offen offset:1024 sc1 lds
    buffer_load_dwordx4 v10, s[12:15], s48 offen offset:2048 sc1 lds
    buffer_load_dwordx4 v10, s[12:15], s48 offen offset:3072 sc1 lds
    s_add_u32 m0, s46, 4096
    s_nop 0
    buffer_load_dwordx4 v10, s[12:15], s49 offen offset:0 sc1 lds
    buffer_load_dwordx4 v10, s[12:15], s49 offen offset:1024 sc1 lds
    buffer_load_dwordx4 v10, s[12:15], s49 offen offset:2048 sc1 lds
    buffer_load_dwordx4 v10, s[12:15], s49 offen offset:3072 sc1 lds
    s_cmp_eq_u32 s51, 1
    s_cbranch_scc1 L_e_one_170
    s_add_u32 s48, s53, 229376
    s_add_u32 s49, s48, 4096
    s_add_u32 m0, s55, 0
    s_nop 0
    buffer_load_dwordx4 v10, s[12:15], s48 offen offset:0 sc1 lds
    buffer_load_dwordx4 v10, s[12:15], s48 offen offset:1024 sc1 lds
    buffer_load_dwordx4 v10, s[12:15], s48 offen offset:2048 sc1 lds
    buffer_load_dwordx4 v10, s[12:15], s48 offen offset:3072 sc1 lds
    s_add_u32 m0, s55, 4096
    s_nop 0
    buffer_load_dwordx4 v10, s[12:15], s49 offen offset:0 sc1 lds
    buffer_load_dwordx4 v10, s[12:15], s49 offen offset:1024 sc1 lds
    buffer_load_dwordx4 v10, s[12:15], s49 offen offset:2048 sc1 lds
    buffer_load_dwordx4 v10, s[12:15], s49 offen offset:3072 sc1 lds
    s_waitcnt vmcnt(16)
    s_barrier
    ds_read_b128 v[32:35], v13 offset:0
    ds_read_b128 v[36:39], v13 offset:1024
    ds_read_b128 v[40:43], v13 offset:2048
    ds_read_b128 v[44:47], v13 offset:3072
L_e_loop_169:
    s_add_u32 s48, s53, 262144
    s_add_u32 s46, s58, 1
    s_cmp_lt_u32 s46, s51
    s_cselect_b32 s48, s48, 0x20000000
    s_cmp_lt_u32 s44, 3
    s_cselect_b32 s48, s48, 0x20000000
    s_add_u32 s49, s48, 4096
    s_add_u32 s59, s55, 32768
    s_waitcnt lgkmcnt(2)
    v_mfma_f32_16x16x32_bf16 v[80:83], a[0:3], v[32:35], 0
    ds_read_b128 v[48:51], v13 offset:4096
    ds_read_b128 v[52:55], v13 offset:5120
    v_mfma_f32_16x16x32_bf16 v[84:87], a[4:7], v[32:35], 0
    ds_read_b128 v[56:59], v13 offset:6144
    ds_read_b128 v[60:63], v13 offset:7168
    v_mfma_f32_16x16x32_bf16 v[88:91], a[0:3], v[36:39], 0
    s_add_u32 m0, s59, 0
    s_nop 0
    buffer_load_dwordx4 v10, s[12:15], s48 offen offset:0 sc1 lds
    v_mfma_f32_16x16x32_bf16 v[92:95], a[4:7], v[36:39], 0
    s_waitcnt lgkmcnt(4)
    v_mfma_f32_16x16x32_bf16 v[80:83], a[8:11], v[40:43], v[80:83]
    ds_read_b128 v[32:35], v13 offset:8192
    ds_read_b128 v[36:39], v13 offset:9216
    v_mfma_f32_16x16x32_bf16 v[84:87], a[12:15], v[40:43], v[84:87]
    v_mfma_f32_16x16x32_bf16 v[88:91], a[8:11], v[44:47], v[88:91]
    buffer_load_dwordx4 v10, s[12:15], s48 offen offset:1024 sc1 lds
    v_mfma_f32_16x16x32_bf16 v[92:95], a[12:15], v[44:47], v[92:95]
    s_waitcnt lgkmcnt(4)
    v_mfma_f32_16x16x32_bf16 v[80:83], a[16:19], v[48:51], v[80:83]
    ds_read_b128 v[40:43], v13 offset:10240
    ds_read_b128 v[44:47], v13 offset:11264
    v_mfma_f32_16x16x32_bf16 v[84:87], a[20:23], v[48:51], v[84:87]
    v_mfma_f32_16x16x32_bf16 v[88:91], a[16:19], v[52:55], v[88:91]
    buffer_load_dwordx4 v10, s[12:15], s48 offen offset:2048 sc1 lds
    v_mfma_f32_16x16x32_bf16 v[92:95], a[20:23], v[52:55], v[92:95]
    s_waitcnt lgkmcnt(4)
    v_mfma_f32_16x16x32_bf16 v[80:83], a[24:27], v[56:59], v[80:83]
    ds_read_b128 v[48:51], v13 offset:12288
    ds_read_b128 v[52:55], v13 offset:13312
    v_mfma_f32_16x16x32_bf16 v[84:87], a[28:31], v[56:59], v[84:87]
    v_mfma_f32_16x16x32_bf16 v[88:91], a[24:27], v[60:63], v[88:91]
    buffer_load_dwordx4 v10, s[12:15], s48 offen offset:3072 sc1 lds
    v_mfma_f32_16x16x32_bf16 v[92:95], a[28:31], v[60:63], v[92:95]
    s_waitcnt lgkmcnt(4)
    v_mfma_f32_16x16x32_bf16 v[80:83], a[32:35], v[32:35], v[80:83]
    ds_read_b128 v[56:59], v13 offset:14336
    ds_read_b128 v[60:63], v13 offset:15360
    v_mfma_f32_16x16x32_bf16 v[84:87], a[36:39], v[32:35], v[84:87]
    v_mfma_f32_16x16x32_bf16 v[88:91], a[32:35], v[36:39], v[88:91]
    s_add_u32 m0, s59, 4096
    s_nop 0
    buffer_load_dwordx4 v10, s[12:15], s49 offen offset:0 sc1 lds
    v_mfma_f32_16x16x32_bf16 v[92:95], a[36:39], v[36:39], v[92:95]
    s_waitcnt lgkmcnt(4)
    v_mfma_f32_16x16x32_bf16 v[80:83], a[40:43], v[40:43], v[80:83]
    ds_read_b128 v[32:35], v13 offset:16384
    ds_read_b128 v[36:39], v13 offset:17408
    v_mfma_f32_16x16x32_bf16 v[84:87], a[44:47], v[40:43], v[84:87]
    v_mfma_f32_16x16x32_bf16 v[88:91], a[40:43], v[44:47], v[88:91]
    buffer_load_dwordx4 v10, s[12:15], s49 offen offset:1024 sc1 lds
    v_mfma_f32_16x16x32_bf16 v[92:95], a[44:47], v[44:47], v[92:95]
    s_waitcnt lgkmcnt(4)
    v_mfma_f32_16x16x32_bf16 v[80:83], a[48:51], v[48:51], v[80:83]
    ds_read_b128 v[40:43], v13 offset:18432
    ds_read_b128 v[44:47], v13 offset:19456
    v_mfma_f32_16x16x32_bf16 v[84:87], a[52:55], v[48:51], v[84:87]
    v_mfma_f32_16x16x32_bf16 v[88:91], a[48:51], v[52:55], v[88:91]
    buffer_load_dwordx4 v10, s[12:15], s49 offen offset:2048 sc1 lds
    v_mfma_f32_16x16x32_bf16 v[92:95], a[52:55], v[52:55], v[92:95]
    s_waitcnt lgkmcnt(4)
    v_mfma_f32_16x16x32_bf16 v[80:83], a[56:59], v[56:59], v[80:83]
    ds_read_b128 v[48:51], v13 offset:20480
    ds_read_b128 v[52:55], v13 offset:21504
    v_mfma_f32_16x16x32_bf16 v[84:87], a[60:63], v[56:59], v[84:87]
    v_mfma_f32_16x16x32_bf16 v[88:91], a[56:59], v[60:63], v[88:91]
    buffer_load_dwordx4 v10, s[12:15], s49 offen offset:3072 sc1 lds
    v_mfma_f32_16x16x32_bf16 v[92:95], a[60:63], v[60:63], v[92:95]
    s_waitcnt lgkmcnt(4)
    v_mfma_f32_16x16x32_bf16 v[80:83], a[64:67], v[32:35], v[80:83]
    ds_read_b128 v[56:59], v13 offset:22528
    ds_read_b128 v[60:63], v13 offset:23552
    v_mfma_f32_16x16x32_bf16 v[84:87], a[68:71], v[32:35], v[84:87]
    v_mfma_f32_16x16x32_bf16 v[88:91], a[64:67], v[36:39], v[88:91]
    v_mfma_f32_16x16x32_bf16 v[92:95], a[68:71], v[36:39], v[92:95]
    s_waitcnt lgkmcnt(4)
    v_mfma_f32_16x16x32_bf16 v[80:83], a[72:75], v[40:43], v[80:83]
    ds_read_b128 v[32:35], v13 offset:24576
    ds_read_b128 v[36:39], v13 offset:25600
    v_mfma_f32_16x16x32_bf16 v[84:87], a[76:79], v[40:43], v[84:87]
    v_mfma_f32_16x16x32_bf16 v[88:91], a[72:75], v[44:47], v[88:91]
    v_mfma_f32_16x16x32_bf16 v[92:95], a[76:79], v[44:47], v[92:95]
    s_waitcnt lgkmcnt(4)
    v_mfma_f32_16x16x32_bf16 v[80:83], a[80:83], v[48:51], v[80:83]
    ds_read_b128 v[40:43], v13 offset:26624
    ds_read_b128 v[44:47], v13 offset:27648
    v_mfma_f32_16x16x32_bf16 v[84:87], a[84:87], v[48:51], v[84:87]
    v_mfma_f32_16x16x32_bf16 v[88:91], a[80:83], v[52:55], v[88:91]
    v_mfma_f32_16x16x32_bf16 v[92:95], a[84:87], v[52:55], v[92:95]
    s_waitcnt lgkmcnt(4)
    v_mfma_f32_16x16x32_bf16 v[80:83], a[88:91], v[56:59], v[80:83]
    ds_read_b128 v[48:51], v13 offset:28672
    ds_read_b128 v[52:55], v13 offset:29696
    v_mfma_f32_16x16x32_bf16 v[84:87], a[92:95], v[56:59], v[84:87]
    v_mfma_f32_16x16x32_bf16 v[88:91], a[88:91], v[60:63], v[88:91]
    v_mfma_f32_16x16x32_bf16 v[92:95], a[92:95], v[60:63], v[92:95]
    s_waitcnt lgkmcnt(4)
    v_mfma_f32_16x16x32_bf16 v[80:83], a[96:99], v[32:35], v[80:83]
    ds_read_b128 v[56:59], v13 offset:30720
    ds_read_b128 v[60:63], v13 offset:31744
    v_mfma_f32_16x16x32_bf16 v[84:87], a[100:103], v[32:35], v[84:87]
    v_mfma_f32_16x16x32_bf16 v[88:91], a[96:99], v[36:39], v[88:91]
    v_mfma_f32_16x16x32_bf16 v[92:95], a[100:103], v[36:39], v[92:95]
    s_waitcnt lgkmcnt(4)
    v_mfma_f32_16x16x32_bf16 v[80:83], a[104:107], v[40:43], v[80:83]
    ds_read_b128 v[216:219], v8 offset:0
    ds_read_b128 v[220:223], v8 offset:1152
    v_mfma_f32_16x16x32_bf16 v[84:87], a[108:111], v[40:43], v[84:87]
    ds_read_b128 v[224:227], v8 offset:2304
    ds_read_b128 v[228:231], v8 offset:3456
    v_mfma_f32_16x16x32_bf16 v[88:91], a[104:107], v[44:47], v[88:91]
    v_mfma_f32_16x16x32_bf16 v[92:95], a[108:111], v[44:47], v[92:95]
    s_waitcnt vmcnt(16) lgkmcnt(0)
    s_barrier
    v_mfma_f32_16x16x32_bf16 v[80:83], a[112:115], v[48:51], v[80:83]
    ds_read_b128 v[32:35], v13 offset:32768
    ds_read_b128 v[36:39], v13 offset:33792
    v_mfma_f32_16x16x32_bf16 v[84:87], a[116:119], v[48:51], v[84:87]
    buffer_store_dwordx4 v[216:219], v11, s[12:15], s76 offen sc1
    v_mfma_f32_16x16x32_bf16 v[88:91], a[112:115], v[52:55], v[88:91]
    s_add_u32 s76, s76, 32768
    v_mfma_f32_16x16x32_bf16 v[92:95], a[116:119], v[52:55], v[92:95]
    buffer_store_dwordx4 v[220:223], v11, s[12:15], s76 offen sc1
    v_mfma_f32_16x16x32_bf16 v[80:83], a[120:123], v[56:59], v[80:83]
    ds_read_b128 v[40:43], v13 offset:34816
    ds_read_b128 v[44:47], v13 offset:35840
    v_mfma_f32_16x16x32_bf16 v[84:87], a[124:127], v[56:59], v[84:87]
    s_add_u32 s76, s76, 32768
    v_mfma_f32_16x16x32_bf16 v[88:91], a[120:123], v[60:63], v[88:91]
    buffer_store_dwordx4 v[224:227], v11, s[12:15], s76 offen sc1
    v_mfma_f32_16x16x32_bf16 v[92:95], a[124:127], v[60:63], v[92:95]
    s_add_u32 s76, s76, 32768
    s_add_u32 s48, s53, 458752
    s_add_u32 s46, s58, 2
    s_cmp_lt_u32 s46, s51
    s_cselect_b32 s48, s48, 0x20000000
    s_add_u32 s49, s48, 4096
    s_mov_b32 s59, s54
    s_waitcnt lgkmcnt(2)
    v_mfma_f32_16x16x32_bf16 v[80:83], a[128:131], v[32:35], v[80:83]
    ds_read_b128 v[48:51], v13 offset:36864
    ds_read_b128 v[52:55], v13 offset:37888
    v_mfma_f32_16x16x32_bf16 v[84:87], a[132:135], v[32:35], v[84:87]
    ds_read_b128 v[56:59], v13 offset:38912
    ds_read_b128 v[60:63], v13 offset:39936
    v_mfma_f32_16x16x32_bf16 v[88:91], a[128:131], v[36:39], v[88:91]
    s_add_u32 m0, s59, 0
    s_nop 0
    buffer_load_dwordx4 v10, s[12:15], s48 offen offset:0 sc1 lds
    v_mfma_f32_16x16x32_bf16 v[92:95], a[132:135], v[36:39], v[92:95]
    buffer_store_dwordx4 v[228:231], v11, s[12:15], s76 offen sc1
    s_waitcnt lgkmcnt(4)
    v_mfma_f32_16x16x32_bf16 v[80:83], a[136:139], v[40:43], v[80:83]
    ds_read_b128 v[32:35], v13 offset:40960
    ds_read_b128 v[36:39], v13 offset:41984
    v_mfma_f32_16x16x32_bf16 v[84:87], a[140:143], v[40:43], v[84:87]
    v_mfma_f32_16x16x32_bf16 v[88:91], a[136:139], v[44:47], v[88:91]
    buffer_load_dwordx4 v10, s[12:15], s48 offen offset:1024 sc1 lds
    v_mfma_f32_16x16x32_bf16 v[92:95], a[140:143], v[44:47], v[92:95]
    s_waitcnt lgkmcnt(4)
    v_mfma_f32_16x16x32_bf16 v[80:83], a[144:147], v[48:51], v[80:83]
    ds_read_b128 v[40:43], v13 offset:43008
    ds_read_b128 v[44:47], v13 offset:44032
    v_mfma_f32_16x16x32_bf16 v[84:87], a[148:151], v[48:51], v[84:87]
    v_mfma_f32_16x16x32_bf16 v[88:91], a[144:147], v[52:55], v[88:91]
    buffer_load_dwordx4 v10, s[12:15], s48 offen offset:2048 sc1 lds
    v_mfma_f32_16x16x32_bf16 v[92:95], a[148:151], v[52:55], v[92:95]
    s_waitcnt lgkmcnt(4)
    v_mfma_f32_16x16x32_bf16 v[80:83], a[152:155], v[56:59], v[80:83]
    ds_read_b128 v[48:51], v13 offset:45056
    ds_read_b128 v[52:55], v13 offset:46080
    v_mfma_f32_16x16x32_bf16 v[84:87], a[156:159], v[56:59], v[84:87]
    v_mfma_f32_16x16x32_bf16 v[88:91], a[152:155], v[60:63], v[88:91]
    buffer_load_dwordx4 v10, s[12:15], s48 offen offset:3072 sc1 lds
    v_mfma_f32_16x16x32_bf16 v[92:95], a[156:159], v[60:63], v[92:95]
    s_waitcnt lgkmcnt(4)
    v_mfma_f32_16x16x32_bf16 v[80:83], a[160:163], v[32:35], v[80:83]
    ds_read_b128 v[56:59], v13 offset:47104
    ds_read_b128 v[60:63], v13 offset:48128
    v_mfma_f32_16x16x32_bf16 v[84:87], a[164:167], v[32:35], v[84:87]
    v_mfma_f32_16x16x32_bf16 v[88:91], a[160:163], v[36:39], v[88:91]
    s_add_u32 m0, s59, 4096
    s_nop 0
    buffer_load_dwordx4 v10, s[12:15], s49 offen offset:0 sc1 lds
    v_mfma_f32_16x16x32_bf16 v[92:95], a[164:167], v[36:39], v[92:95]
    s_waitcnt lgkmcnt(4)
    v_mfma_f32_16x16x32_bf16 v[80:83], a[168:171], v[40:43], v[80:83]
    ds_read_b128 v[32:35], v13 offset:49152
    ds_read_b128 v[36:39], v13 offset:50176
    v_mfma_f32_16x16x32_bf16 v[84:87], a[172:175], v[40:43], v[84:87]
    v_mfma_f32_16x16x32_bf16 v[88:91], a[168:171], v[44:47], v[88:91]
    buffer_load_dwordx4 v10, s[12:15], s49 offen offset:1024 sc1 lds
    v_mfma_f32_16x16x32_bf16 v[92:95], a[172:175], v[44:47], v[92:95]
    s_waitcnt lgkmcnt(4)
    v_mfma_f32_16x16x32_bf16 v[80:83], a[176:179], v[48:51], v[80:83]
    ds_read_b128 v[40:43], v13 offset:51200
    ds_read_b128 v[44:47], v13 offset:52224
    v_mfma_f32_16x16x32_bf16 v[84:87], a[180:183], v[48:51], v[84:87]
    v_mfma_f32_16x16x32_bf16 v[88:91], a[176:179], v[52:55], v[88:91]
    buffer_load_dwordx4 v10, s[12:15], s49 offen offset:2048 sc1 lds
    v_mfma_f32_16x16x32_bf16 v[92:95], a[180:183], v[52:55], v[92:95]
    s_waitcnt lgkmcnt(4)
    v_mfma_f32_16x16x32_bf16 v[80:83], a[184:187], v[56:59], v[80:83]
    ds_read_b128 v[48:51], v13 offset:53248
    ds_read_b128 v[52:55], v13 offset:54272
    v_mfma_f32_16x16x32_bf16 v[84:87], a[188:191], v[56:59], v[84:87]
    v_mfma_f32_16x16x32_bf16 v[88:91], a[184:187], v[60:63], v[88:91]
    buffer_load_dwordx4 v10, s[12:15], s49 offen offset:3072 sc1 lds
    v_mfma_f32_16x16x32_bf16 v[92:95], a[188:191], v[60:63], v[92:95]
    s_waitcnt lgkmcnt(4)
    v_mfma_f32_16x16x32_bf16 v[80:83], a[192:195], v[32:35], v[80:83]
    ds_read_b128 v[56:59], v13 offset:55296
    ds_read_b128 v[60:63], v13 offset:56320
    v_mfma_f32_16x16x32_bf16 v[84:87], a[196:199], v[32:35], v[84:87]
    v_mfma_f32_16x16x32_bf16 v[88:91], a[192:195], v[36:39], v[88:91]
    v_mfma_f32_16x16x32_bf16 v[92:95], a[196:199], v[36:39], v[92:95]
    s_waitcnt lgkmcnt(4)
    v_mfma_f32_16x16x32_bf16 v[80:83], a[200:203], v[40:43], v[80:83]
    v_mfma_f32_16x16x32_bf16 v[84:87], a[204:207], v[40:43], v[84:87]
    v_mfma_f32_16x16x32_bf16 v[88:91], a[200:203], v[44:47], v[88:91]
    v_mfma_f32_16x16x32_bf16 v[92:95], a[204:207], v[44:47], v[92:95]
    s_waitcnt vmcnt(16) lgkmcnt(0)
    s_barrier
    v_mfma_f32_16x16x32_bf16 v[80:83], a[208:211], v[48:51], v[80:83]
    ds_read_b128 v[32:35], v14 offset:0
    ds_read_b128 v[36:39], v14 offset:1024
    v_mfma_f32_16x16x32_bf16 v[84:87], a[212:215], v[48:51], v[84:87]
    v_mfma_f32_16x16x32_bf16 v[88:91], a[208:211], v[52:55], v[88:91]
    v_mfma_f32_16x16x32_bf16 v[92:95], a[212:215], v[52:55], v[92:95]
    v_mfma_f32_16x16x32_bf16 v[80:83], a[216:219], v[56:59], v[80:83]
    ds_read_b128 v[40:43], v14 offset:2048
    ds_read_b128 v[44:47], v14 offset:3072
    v_mfma_f32_16x16x32_bf16 v[84:87], a[220:223], v[56:59], v[84:87]
    v_mfma_f32_16x16x32_bf16 v[88:91], a[216:219], v[60:63], v[88:91]
    v_mfma_f32_16x16x32_bf16 v[92:95], a[220:223], v[60:63], v[92:95]
    s_add_u32 s53, s53, 229376
    s_add_u32 s58, s58, 1
    v_swap_b32 v13, v14
    s_xor_b32 s54, s54, 65536
    s_xor_b32 s55, s55, 65536
    s_mov_b32 s76, s57
    v_swap_b32 v15, v16
    s_add_u32 s57, s57, 131072
    ds_write_b128 v7, v[80:83] offset:0
    ds_write_b128 v7, v[84:87] offset:64
    ds_write_b128 v7, v[88:91] offset:2304
    ds_write_b128 v7, v[92:95] offset:2368
    s_cmp_lt_u32 s58, s51
    s_cbranch_scc1 L_e_loop_169
    s_branch L_e_fin_171
L_e_one_170:
    s_waitcnt vmcnt(8)
    s_barrier
    ds_read_b128 v[32:35], v13 offset:0
    ds_read_b128 v[36:39], v13 offset:1024
    ds_read_b128 v[40:43], v13 offset:2048
    ds_read_b128 v[44:47], v13 offset:3072
    s_waitcnt lgkmcnt(2)
    v_mfma_f32_16x16x32_bf16 v[80:83], a[0:3], v[32:35], 0
    ds_read_b128 v[48:51], v13 offset:4096
    ds_read_b128 v[52:55], v13 offset:5120
    v_mfma_f32_16x16x32_bf16 v[84:87], a[4:7], v[32:35], 0
    ds_read_b128 v[56:59], v13 offset:6144
    ds_read_b128 v[60:63], v13 offset:7168
    v_mfma_f32_16x16x32_bf16 v[88:91], a[0:3], v[36:39], 0
    v_mfma_f32_16x16x32_bf16 v[92:95], a[4:7], v[36:39], 0
    s_waitcnt lgkmcnt(4)
    v_mfma_f32_16x16x32_bf16 v[80:83], a[8:11], v[40:43], v[80:83]
    ds_read_b128 v[32:35], v13 offset:8192
    ds_read_b128 v[36:39], v13 offset:9216
    v_mfma_f32_16x16x32_bf16 v[84:87], a[12:15], v[40:43], v[84:87]
    v_mfma_f32_16x16x32_bf16 v[88:91], a[8:11], v[44:47], v[88:91]
    v_mfma_f32_16x16x32_bf16 v[92:95], a[12:15], v[44:47], v[92:95]
    s_waitcnt lgkmcnt(4)
    v_mfma_f32_16x16x32_bf16 v[80:83], a[16:19], v[48:51], v[80:83]
    ds_read_b128 v[40:43], v13 offset:10240
    ds_read_b128 v[44:47], v13 offset:11264
    v_mfma_f32_16x16x32_bf16 v[84:87], a[20:23], v[48:51], v[84:87]
    v_mfma_f32_16x16x32_bf16 v[88:91], a[16:19], v[52:55], v[88:91]
    v_mfma_f32_16x16x32_bf16 v[92:95], a[20:23], v[52:55], v[92:95]
    s_waitcnt lgkmcnt(4)
    v_mfma_f32_16x16x32_bf16 v[80:83], a[24:27], v[56:59], v[80:83]
    ds_read_b128 v[48:51], v13 offset:12288
    ds_read_b128 v[52:55], v13 offset:13312
    v_mfma_f32_16x16x32_bf16 v[84:87], a[28:31], v[56:59], v[84:87]
    v_mfma_f32_16x16x32_bf16 v[88:91], a[24:27], v[60:63], v[88:91]
    v_mfma_f32_16x16x32_bf16 v[92:95], a[28:31], v[60:63], v[92:95]
    s_waitcnt lgkmcnt(4)
    v_mfma_f32_16x16x32_bf16 v[80:83], a[32:35], v[32:35], v[80:83]
    ds_read_b128 v[56:59], v13 offset:14336
    ds_read_b128 v[60:63], v13 offset:15360
    v_mfma_f32_16x16x32_bf16 v[84:87], a[36:39], v[32:35], v[84:87]
    v_mfma_f32_16x16x32_bf16 v[88:91], a[32:35], v[36:39], v[88:91]
    v_mfma_f32_16x16x32_bf16 v[92:95], a[36:39], v[36:39], v[92:95]
    s_waitcnt lgkmcnt(4)
    v_mfma_f32_16x16x32_bf16 v[80:83], a[40:43], v[40:43], v[80:83]
    ds_read_b128 v[32:35], v13 offset:16384
    ds_read_b128 v[36:39], v13 offset:17408
    v_mfma_f32_16x16x32_bf16 v[84:87], a[44:47], v[40:43], v[84:87]
    v_mfma_f32_16x16x32_bf16 v[88:91], a[40:43], v[44:47], v[88:91]
    v_mfma_f32_16x16x32_bf16 v[92:95], a[44:47], v[44:47], v[92:95]
    s_waitcnt lgkmcnt(4)
    v_mfma_f32_16x16x32_bf16 v[80:83], a[48:51], v[48:51], v[80:83]
    ds_read_b128 v[40:43], v13 offset:18432
    ds_read_b128 v[44:47], v13 offset:19456
    v_mfma_f32_16x16x32_bf16 v[84:87], a[52:55], v[48:51], v[84:87]
    v_mfma_f32_16x16x32_bf16 v[88:91], a[48:51], v[52:55], v[88:91]
    v_mfma_f32_16x16x32_bf16 v[92:95], a[52:55], v[52:55], v[92:95]
    s_waitcnt lgkmcnt(4)
    v_mfma_f32_16x16x32_bf16 v[80:83], a[56:59], v[56:59], v[80:83]
    ds_read_b128 v[48:51], v13 offset:20480
    ds_read_b128 v[52:55], v13 offset:21504
    v_mfma_f32_16x16x32_bf16 v[84:87], a[60:63], v[56:59], v[84:87]
    v_mfma_f32_16x16x32_bf16 v[88:91], a[56:59], v[60:63], v[88:91]
    v_mfma_f32_16x16x32_bf16 v[92:95], a[60:63], v[60:63], v[92:95]
    s_waitcnt lgkmcnt(4)
    v_mfma_f32_16x16x32_bf16 v[80:83], a[64:67], v[32:35], v[80:83]
    ds_read_b128 v[56:59], v13 offset:22528
    ds_read_b128 v[60:63], v13 offset:23552
    v_mfma_f32_16x16x32_bf16 v[84:87], a[68:71], v[32:35], v[84:87]
    v_mfma_f32_16x16x32_bf16 v[88:91], a[64:67], v[36:39], v[88:91]
    v_mfma_f32_16x16x32_bf16 v[92:95], a[68:71], v[36:39], v[92:95]
    s_waitcnt lgkmcnt(4)
    v_mfma_f32_16x16x32_bf16 v[80:83], a[72:75], v[40:43], v[80:83]
    ds_read_b128 v[32:35], v13 offset:24576
    ds_read_b128 v[36:39], v13 offset:25600
    v_mfma_f32_16x16x32_bf16 v[84:87], a[76:79], v[40:43], v[84:87]
    v_mfma_f32_16x16x32_bf16 v[88:91], a[72:75], v[44:47], v[88:91]
    v_mfma_f32_16x16x32_bf16 v[92:95], a[76:79], v[44:47], v[92:95]
    s_waitcnt lgkmcnt(4)
    v_mfma_f32_16x16x32_bf16 v[80:83], a[80:83], v[48:51], v[80:83]
    ds_read_b128 v[40:43], v13 offset:26624
    ds_read_b128 v[44:47], v13 offset:27648
    v_mfma_f32_16x16x32_bf16 v[84:87], a[84:87], v[48:51], v[84:87]
    v_mfma_f32_16x16x32_bf16 v[88:91], a[80:83], v[52:55], v[88:91]
    v_mfma_f32_16x16x32_bf16 v[92:95], a[84:87], v[52:55], v[92:95]
    s_waitcnt lgkmcnt(4)
    v_mfma_f32_16x16x32_bf16 v[80:83], a[88:91], v[56:59], v[80:83]
    ds_read_b128 v[48:51], v13 offset:28672
    ds_read_b128 v[52:55], v13 offset:29696
    v_mfma_f32_16x16x32_bf16 v[84:87], a[92:95], v[56:59], v[84:87]
    v_mfma_f32_16x16x32_bf16 v[88:91], a[88:91], v[60:63], v[88:91]
    v_mfma_f32_16x16x32_bf16 v[92:95], a[92:95], v[60:63], v[92:95]
    s_waitcnt lgkmcnt(4)
    v_mfma_f32_16x16x32_bf16 v[80:83], a[96:99], v[32:35], v[80:83]
    ds_read_b128 v[56:59], v13 offset:30720
    ds_read_b128 v[60:63], v13 offset:31744
    v_mfma_f32_16x16x32_bf16 v[84:87], a[100:103], v[32:35], v[84:87]
    v_mfma_f32_16x16x32_bf16 v[88:91], a[96:99], v[36:39], v[88:91]
    v_mfma_f32_16x16x32_bf16 v[92:95], a[100:103], v[36:39], v[92:95]
    s_waitcnt lgkmcnt(4)
    v_mfma_f32_16x16x32_bf16 v[80:83], a[104:107], v[40:43], v[80:83]
    v_mfma_f32_16x16x32_bf16 v[84:87], a[108:111], v[40:43], v[84:87]
    v_mfma_f32_16x16x32_bf16 v[88:91], a[104:107], v[44:47], v[88:91]
    v_mfma_f32_16x16x32_bf16 v[92:95], a[108:111], v[44:47], v[92:95]
    s_waitcnt vmcnt(0) lgkmcnt(0)
    s_barrier
    v_mfma_f32_16x16x32_bf16 v[80:83], a[112:115], v[48:51], v[80:83]
    ds_read_b128 v[32:35], v13 offset:32768
    ds_read_b128 v[36:39], v13 offset:33792
    v_mfma_f32_16x16x32_bf16 v[84:87], a[116:119], v[48:51], v[84:87]
    v_mfma_f32_16x16x32_bf16 v[88:91], a[112:115], v[52:55], v[88:91]
    v_mfma_f32_16x16x32_bf16 v[92:95], a[116:119], v[52:55], v[92:95]
    v_mfma_f32_16x16x32_bf16 v[80:83], a[120:123], v[56:59], v[80:83]
    ds_read_b128 v[40:43], v13 offset:34816
    ds_read_b128 v[44:47], v13 offset:35840
    v_mfma_f32_16x16x32_bf16 v[84:87], a[124:127], v[56:59], v[84:87]
    v_mfma_f32_16x16x32_bf16 v[88:91], a[120:123], v[60:63], v[88:91]
    v_mfma_f32_16x16x32_bf16 v[92:95], a[124:127], v[60:63], v[92:95]
    s_waitcnt lgkmcnt(2)
    v_mfma_f32_16x16x32_bf16 v[80:83], a[128:131], v[32:35], v[80:83]
    ds_read_b128 v[48:51], v13 offset:36864
    ds_read_b128 v[52:55], v13 offset:37888
    v_mfma_f32_16x16x32_bf16 v[84:87], a[132:135], v[32:35], v[84:87]
    ds_read_b128 v[56:59], v13 offset:38912
    ds_read_b128 v[60:63], v13 offset:39936
    v_mfma_f32_16x16x32_bf16 v[88:91], a[128:131], v[36:39], v[88:91]
    v_mfma_f32_16x16x32_bf16 v[92:95], a[132:135], v[36:39], v[92:95]
    s_waitcnt lgkmcnt(4)
    v_mfma_f32_16x16x32_bf16 v[80:83], a[136:139], v[40:43], v[80:83]
    ds_read_b128 v[32:35], v13 offset:40960
    ds_read_b128 v[36:39], v13 offset:41984
    v_mfma_f32_16x16x32_bf16 v[84:87], a[140:143], v[40:43], v[84:87]
    v_mfma_f32_16x16x32_bf16 v[88:91], a[136:139], v[44:47], v[88:91]
    v_mfma_f32_16x16x32_bf16 v[92:95], a[140:143], v[44:47], v[92:95]
    s_waitcnt lgkmcnt(4)
    v_mfma_f32_16x16x32_bf16 v[80:83], a[144:147], v[48:51], v[80:83]
    ds_read_b128 v[40:43], v13 offset:43008
    ds_read_b128 v[44:47], v13 offset:44032
    v_mfma_f32_16x16x32_bf16 v[84:87], a[148:151], v[48:51], v[84:87]
    v_mfma_f32_16x16x32_bf16 v[88:91], a[144:147], v[52:55], v[88:91]
    v_mfma_f32_16x16x32_bf16 v[92:95], a[148:151], v[52:55], v[92:95]
    s_waitcnt lgkmcnt(4)
    v_mfma_f32_16x16x32_bf16 v[80:83], a[152:155], v[56:59], v[80:83]
    ds_read_b128 v[48:51], v13 offset:45056
    ds_read_b128 v[52:55], v13 offset:46080
    v_mfma_f32_16x16x32_bf16 v[84:87], a[156:159], v[56:59], v[84:87]
    v_mfma_f32_16x16x32_bf16 v[88:91], a[152:155], v[60:63], v[88:91]
    v_mfma_f32_16x16x32_bf16 v[92:95], a[156:159], v[60:63], v[92:95]
    s_waitcnt lgkmcnt(4)
    v_mfma_f32_16x16x32_bf16 v[80:83], a[160:163], v[32:35], v[80:83]
    ds_read_b128 v[56:59], v13 offset:47104
    ds_read_b128 v[60:63], v13 offset:48128
    v_mfma_f32_16x16x32_bf16 v[84:87], a[164:167], v[32:35], v[84:87]
    v_mfma_f32_16x16x32_bf16 v[88:91], a[160:163], v[36:39], v[88:91]
    v_mfma_f32_16x16x32_bf16 v[92:95], a[164:167], v[36:39], v[92:95]
    s_waitcnt lgkmcnt(4)
    v_mfma_f32_16x16x32_bf16 v[80:83], a[168:171], v[40:43], v[80:83]
    ds_read_b128 v[32:35], v13 offset:49152
    ds_read_b128 v[36:39], v13 offset:50176
    v_mfma_f32_16x16x32_bf16 v[84:87], a[172:175], v[40:43], v[84:87]
    v_mfma_f32_16x16x32_bf16 v[88:91], a[168:171], v[44:47], v[88:91]
    v_mfma_f32_16x16x32_bf16 v[92:95], a[172:175], v[44:47], v[92:95]
    s_waitcnt lgkmcnt(4)
    v_mfma_f32_16x16x32_bf16 v[80:83], a[176:179], v[48:51], v[80:83]
    ds_read_b128 v[40:43], v13 offset:51200
    ds_read_b128 v[44:47], v13 offset:52224
    v_mfma_f32_16x16x32_bf16 v[84:87], a[180:183], v[48:51], v[84:87]
    v_mfma_f32_16x16x32_bf16 v[88:91], a[176:179], v[52:55], v[88:91]
    v_mfma_f32_16x16x32_bf16 v[92:95], a[180:183], v[52:55], v[92:95]
    s_waitcnt lgkmcnt(4)
    v_mfma_f32_16x16x32_bf16 v[80:83], a[184:187], v[56:59], v[80:83]
    ds_read_b128 v[48:51], v13 offset:53248
    ds_read_b128 v[52:55], v13 offset:54272
    v_mfma_f32_16x16x32_bf16 v[84:87], a[188:191], v[56:59], v[84:87]
    v_mfma_f32_16x16x32_bf16 v[88:91], a[184:187], v[60:63], v[88:91]
    v_mfma_f32_16x16x32_bf16 v[92:95], a[188:191], v[60:63], v[92:95]
    s_waitcnt lgkmcnt(4)
    v_mfma_f32_16x16x32_bf16 v[80:83], a[192:195], v[32:35], v[80:83]
    ds_read_b128 v[56:59], v13 offset:55296
    ds_read_b128 v[60:63], v13 offset:56320
    v_mfma_f32_16x16x32_bf16 v[84:87], a[196:199], v[32:35], v[84:87]
    v_mfma_f32_16x16x32_bf16 v[88:91], a[192:195], v[36:39], v[88:91]
    v_mfma_f32_16x16x32_bf16 v[92:95], a[196:199], v[36:39], v[92:95]
    s_waitcnt lgkmcnt(4)
    v_mfma_f32_16x16x32_bf16 v[80:83], a[200:203], v[40:43], v[80:83]
    v_mfma_f32_16x16x32_bf16 v[84:87], a[204:207], v[40:43], v[84:87]
    v_mfma_f32_16x16x32_bf16 v[88:91], a[200:203], v[44:47], v[88:91]
    v_mfma_f32_16x16x32_bf16 v[92:95], a[204:207], v[44:47], v[92:95]
    s_waitcnt lgkmcnt(0)
    v_mfma_f32_16x16x32_bf16 v[80:83], a[208:211], v[48:51], v[80:83]
    v_mfma_f32_16x16x32_bf16 v[84:87], a[212:215], v[48:51], v[84:87]
    v_mfma_f32_16x16x32_bf16 v[88:91], a[208:211], v[52:55], v[88:91]
    v_mfma_f32_16x16x32_bf16 v[92:95], a[212:215], v[52:55], v[92:95]
    v_mfma_f32_16x16x32_bf16 v[80:83], a[216:219], v[56:59], v[80:83]
    v_mfma_f32_16x16x32_bf16 v[84:87], a[220:223], v[56:59], v[84:87]
    v_mfma_f32_16x16x32_bf16 v[88:91], a[216:219], v[60:63], v[88:91]
    v_mfma_f32_16x16x32_bf16 v[92:95], a[220:223], v[60:63], v[92:95]
    s_mov_b32 s76, s57
    s_nop 6
    ds_write_b128 v7, v[80:83] offset:0
    ds_write_b128 v7, v[84:87] offset:64
    ds_write_b128 v7, v[88:91] offset:2304
    ds_write_b128 v7, v[92:95] offset:2368
L_e_fin_171:
    s_waitcnt lgkmcnt(0)
    ds_read_b128 v[216:219], v8 offset:0
    ds_read_b128 v[220:223], v8 offset:1152
    ds_read_b128 v[224:227], v8 offset:2304
    ds_read_b128 v[228:231], v8 offset:3456
    s_waitcnt lgkmcnt(0)
    buffer_store_dwordx4 v[216:219], v11, s[12:15], s76 offen sc1
    s_add_u32 s76, s76, 32768
    buffer_store_dwordx4 v[220:223], v11, s[12:15], s76 offen sc1
    s_add_u32 s76, s76, 32768
    buffer_store_dwordx4 v[224:227], v11, s[12:15], s76 offen sc1
    s_add_u32 s76, s76, 32768
    buffer_store_dwordx4 v[228:231], v11, s[12:15], s76 offen sc1
    s_waitcnt vmcnt(0)
    s_barrier
    s_cmp_lg_u32 s44, 0
    s_cbranch_scc1 L_pub_172
    v_mov_b32 v30, s62
    v_mov_b32 v31, 0
    s_mov_b64 exec, 1
    buffer_store_dword v30, v31, s[80:83], s65 offen
    buffer_store_dword v30, v31, s[84:87], s65 offen sc1
    s_mov_b64 exec, -1
L_pub_172:
    s_cmp_lg_u32 s51, 1
    s_cbranch_scc1 L_c_skip_165
    s_lshl_b32 s63, s50, 5
    s_add_u32 s63, s63, s41
    s_lshl_b32 s47, s63, 11
    s_lshl_b32 s45, s44, 9
    s_add_u32 s47, s47, s45
    s_add_u32 s46, s47, 0x800000
    v_lshlrev_b32 v17, 3, v1
    buffer_load_dwordx2 v[208:209], v17, s[12:15], s46 offen sc1
    s_add_u32 s45, s64, 16384
    s_cmp_lg_u32 s44, 0
    s_cbranch_scc1 L_pw_173
    s_mov_b32 exec_hi, 0
    s_mov_b32 s70, 0
L_wp_174:
    buffer_load_dword v31, v5, s[12:15], s45 offen sc1
    s_add_u32 s70, s70, 1
    s_cmp_ge_u32 s70, 0x200000
    s_cbranch_scc1 L_w_done_102
    s_waitcnt vmcnt(0)
    v_cmp_gt_u32 vcc, s62, v31
    s_nop 1
    s_cbranch_vccz L_wp_174_ok
    s_sleep 1
    s_branch L_wp_174
L_wp_174_ok:
    s_mov_b64 exec, -1
L_pw_173:
    s_barrier
    s_waitcnt vmcnt(0)
    s_lshl_b32 s45, s63, 12
    s_lshl_b32 s46, s44, 10
    s_add_u32 s45, s45, s46
    s_add_u32 s45, s45, 0xc000000
    buffer_load_dwordx4 v[64:67], v10, s[12:15], s45 offen sc1
    s_add_u32 s45, s45, 0x800000
    buffer_load_dwordx4 v[68:71], v10, s[12:15], s45 offen sc1
    s_add_u32 s45, s45, 0x800000
    buffer_load_dwordx4 v[72:75], v10, s[12:15], s45 offen sc1
    s_add_u32 s45, s45, 0x800000
    buffer_load_dwordx4 v[76:79], v10, s[12:15], s45 offen sc1
    v_lshlrev_b32 v160, 16, v208
    v_and_b32 v161, 0xffff0000, v208
    v_lshlrev_b32 v162, 16, v209
    v_and_b32 v163, 0xffff0000, v209
    s_waitcnt vmcnt(0)
    v_pk_add_f32 v[64:65], v[64:65], v[68:69]
    v_pk_add_f32 v[72:73], v[72:73], v[76:77]
    v_pk_add_f32 v[66:67], v[66:67], v[70:71]
    v_pk_add_f32 v[74:75], v[74:75], v[78:79]
    v_pk_add_f32 v[64:65], v[64:65], v[72:73]
    v_pk_add_f32 v[66:67], v[66:67], v[74:75]
    v_cvt_pk_bf16_f32 v64, v64, v64
    v_lshlrev_b32 v64, 16, v64
    v_cvt_pk_bf16_f32 v65, v65, v65
    v_lshlrev_b32 v65, 16, v65
    v_cvt_pk_bf16_f32 v66, v66, v66
    v_lshlrev_b32 v66, 16, v66
    v_cvt_pk_bf16_f32 v67, v67, v67
    v_lshlrev_b32 v67, 16, v67
    v_add_f32 v64, v64, v18
    v_cvt_pk_bf16_f32 v64, v64, v64
    v_lshlrev_b32 v64, 16, v64
    v_mul_f32 v64, v64, v22
    v_cvt_pk_bf16_f32 v64, v64, v64
    v_lshlrev_b32 v64, 16, v64
    v_add_f32 v64, v64, v160
    v_add_f32 v65, v65, v19
    v_cvt_pk_bf16_f32 v65, v65, v65
    v_lshlrev_b32 v65, 16, v65
    v_mul_f32 v65, v65, v23
    v_cvt_pk_bf16_f32 v65, v65, v65
    v_lshlrev_b32 v65, 16, v65
    v_add_f32 v65, v65, v161
    v_add_f32 v66, v66, v20
    v_cvt_pk_bf16_f32 v66, v66, v66
    v_lshlrev_b32 v66, 16, v66
    v_mul_f32 v66, v66, v24
    v_cvt_pk_bf16_f32 v66, v66, v66
    v_lshlrev_b32 v66, 16, v66
    v_add_f32 v66, v66, v162
    v_add_f32 v67, v67, v21
    v_cvt_pk_bf16_f32 v67, v67, v67
    v_lshlrev_b32 v67, 16, v67
    v_mul_f32 v67, v67, v25
    v_cvt_pk_bf16_f32 v67, v67, v67
    v_lshlrev_b32 v67, 16, v67
    v_add_f32 v67, v67, v163
    v_cvt_pk_bf16_f32 v208, v64, v65
    v_cvt_pk_bf16_f32 v209, v66, v67
    buffer_store_dwordx2 v[208:209], v17, s[32:35], s47 offen
    s_branch L_c_loop_164
L_c_skip_165:
    s_add_u32 s63, s50, s44
    s_lshl_b32 s63, s63, 5
    s_add_u32 s63, s63, s41
    s_lshl_b32 s47, s63, 11
    s_add_u32 s46, s47, 0x800000
    s_cmp_lt_u32 s44, s51
    s_cselect_b32 s46, s46, 0x20000000
    buffer_load_dwordx4 v[208:211], v10, s[12:15], s46 offen sc1
    buffer_load_dwordx4 v[212:215], v10, s[12:15], s46 offen offset:1024 sc1
    s_add_u32 s45, s64, 16384
    s_cmp_lg_u32 s44, 0
    s_cbranch_scc1 L_pw_175
    s_mov_b32 exec_hi, 0
    s_mov_b32 s70, 0
L_wp_176:
    buffer_load_dword v31, v5, s[12:15], s45 offen sc1
    s_add_u32 s70, s70, 1
    s_cmp_ge_u32 s70, 0x200000
    s_cbranch_scc1 L_w_done_102
    s_waitcnt vmcnt(0)
    v_cmp_gt_u32 vcc, s62, v31
    s_nop 1
    s_cbranch_vccz L_wp_176_ok
    s_sleep 1
    s_branch L_wp_176
L_wp_176_ok:
    s_mov_b64 exec, -1
L_pw_175:
    s_barrier
    s_cmp_ge_u32 s44, s51
    s_cbranch_scc1 L_c_loop_164
    s_lshl_b32 s45, s63, 12
    s_add_u32 s45, s45, 0xc000000
    v_lshlrev_b32 v29, 5, v1
    buffer_load_dwordx4 v[64:67], v29, s[12:15], s45 offen offset:0 sc1
    buffer_load_dwordx4 v[68:71], v29, s[12:15], s45 offen offset:16 sc1
    buffer_load_dwordx4 v[72:75], v29, s[12:15], s45 offen offset:2048 sc1
    buffer_load_dwordx4 v[76:79], v29, s[12:15], s45 offen offset:2064 sc1
    s_add_u32 s45, s45, 0x800000
    buffer_load_dwordx4 v[160:163], v29, s[12:15], s45 offen offset:0 sc1
    buffer_load_dwordx4 v[164:167], v29, s[12:15], s45 offen offset:16 sc1
    buffer_load_dwordx4 v[168:171], v29, s[12:15], s45 offen offset:2048 sc1
    buffer_load_dwordx4 v[172:175], v29, s[12:15], s45 offen offset:2064 sc1
    s_add_u32 s45, s45, 0x800000
    buffer_load_dwordx4 v[176:179], v29, s[12:15], s45 offen offset:0 sc1
    buffer_load_dwordx4 v[180:183], v29, s[12:15], s45 offen offset:16 sc1
    buffer_load_dwordx4 v[184:187], v29, s[12:15], s45 offen offset:2048 sc1
    buffer_load_dwordx4 v[188:191], v29, s[12:15], s45 offen offset:2064 sc1
    s_add_u32 s45, s45, 0x800000
    buffer_load_dwordx4 v[192:195], v29, s[12:15], s45 offen offset:0 sc1
    buffer_load_dwordx4 v[196:199], v29, s[12:15], s45 offen offset:16 sc1
    buffer_load_dwordx4 v[200:203], v29, s[12:15], s45 offen offset:2048 sc1
    buffer_load_dwordx4 v[204:207], v29, s[12:15], s45 offen offset:2064 sc1
    s_waitcnt vmcnt(0)
    v_pk_add_f32 v[64:65], v[64:65], v[160:161]
    v_pk_add_f32 v[176:177], v[176:177], v[192:193]
    v_pk_add_f32 v[66:67], v[66:67], v[162:163]
    v_pk_add_f32 v[178:179], v[178:179], v[194:195]
    v_pk_add_f32 v[68:69], v[68:69], v[164:165]
    v_pk_add_f32 v[180:181], v[180:181], v[196:197]
    v_pk_add_f32 v[70:71], v[70:71], v[166:167]
    v_pk_add_f32 v[182:183], v[182:183], v[198:199]
    v_pk_add_f32 v[72:73], v[72:73], v[168:169]
    v_pk_add_f32 v[184:185], v[184:185], v[200:201]
    v_pk_add_f32 v[74:75], v[74:75], v[170:171]
    v_pk_add_f32 v[186:187], v[186:187], v[202:203]
    v_pk_add_f32 v[76:77], v[76:77], v[172:173]
    v_pk_add_f32 v[188:189], v[188:189], v[204:205]
    v_pk_add_f32 v[78:79], v[78:79], v[174:175]
    v_pk_add_f32 v[190:191], v[190:191], v[206:207]
    v_pk_add_f32 v[64:65], v[64:65], v[176:177]
    v_pk_add_f32 v[66:67], v[66:67], v[178:179]
    v_pk_add_f32 v[68:69], v[68:69], v[180:181]
    v_pk_add_f32 v[70:71], v[70:71], v[182:183]
    v_pk_add_f32 v[72:73], v[72:73], v[184:185]
    v_pk_add_f32 v[74:75], v[74:75], v[186:187]
    v_pk_add_f32 v[76:77], v[76:77], v[188:189]
    v_pk_add_f32 v[78:79], v[78:79], v[190:191]
    v_cvt_pk_bf16_f32 v64, v64, v64
    v_lshlrev_b32 v64, 16, v64
    v_cvt_pk_bf16_f32 v65, v65, v65
    v_lshlrev_b32 v65, 16, v65
    v_cvt_pk_bf16_f32 v66, v66, v66
    v_lshlrev_b32 v66, 16, v66
    v_cvt_pk_bf16_f32 v67, v67, v67
    v_lshlrev_b32 v67, 16, v67
    v_cvt_pk_bf16_f32 v68, v68, v68
    v_lshlrev_b32 v68, 16, v68
    v_cvt_pk_bf16_f32 v69, v69, v69
    v_lshlrev_b32 v69, 16, v69
    v_cvt_pk_bf16_f32 v70, v70, v70
    v_lshlrev_b32 v70, 16, v70
    v_cvt_pk_bf16_f32 v71, v71, v71
    v_lshlrev_b32 v71, 16, v71
    v_cvt_pk_bf16_f32 v72, v72, v72
    v_lshlrev_b32 v72, 16, v72
    v_cvt_pk_bf16_f32 v73, v73, v73
    v_lshlrev_b32 v73, 16, v73
    v_cvt_pk_bf16_f32 v74, v74, v74
    v_lshlrev_b32 v74, 16, v74
    v_cvt_pk_bf16_f32 v75, v75, v75
    v_lshlrev_b32 v75, 16, v75
    v_cvt_pk_bf16_f32 v76, v76, v76
    v_lshlrev_b32 v76, 16, v76
    v_cvt_pk_bf16_f32 v77, v77, v77
    v_lshlrev_b32 v77, 16, v77
    v_cvt_pk_bf16_f32 v78, v78, v78
    v_lshlrev_b32 v78, 16, v78
    v_cvt_pk_bf16_f32 v79, v79, v79
    v_lshlrev_b32 v79, 16, v79
    v_lshlrev_b32 v160, 16, v208
    v_and_b32 v161, 0xffff0000, v208
    v_lshlrev_b32 v162, 16, v209
    v_and_b32 v163, 0xffff0000, v209
    v_lshlrev_b32 v164, 16, v210
    v_and_b32 v165, 0xffff0000, v210
    v_lshlrev_b32 v166, 16, v211
    v_and_b32 v167, 0xffff0000, v211
    v_lshlrev_b32 v168, 16, v212
    v_and_b32 v169, 0xffff0000, v212
    v_lshlrev_b32 v170, 16, v213
    v_and_b32 v171, 0xffff0000, v213
    v_lshlrev_b32 v172, 16, v214
    v_and_b32 v173, 0xffff0000, v214
    v_lshlrev_b32 v174, 16, v215
    v_and_b32 v175, 0xffff0000, v215
    v_add_f32 v64, v64, v96
    v_cvt_pk_bf16_f32 v64, v64, v64
    v_lshlrev_b32 v64, 16, v64
    v_mul_f32 v64, v64, v112
    v_cvt_pk_bf16_f32 v64, v64, v64
    v_lshlrev_b32 v64, 16, v64
    v_add_f32 v64, v64, v160
    v_add_f32 v65, v65, v97
    v_cvt_pk_bf16_f32 v65, v65, v65
    v_lshlrev_b32 v65, 16, v65
    v_mul_f32 v65, v65, v113
    v_cvt_pk_bf16_f32 v65, v65, v65
    v_lshlrev_b32 v65, 16, v65
    v_add_f32 v65, v65, v161
    v_add_f32 v66, v66, v98
    v_cvt_pk_bf16_f32 v66, v66, v66
    v_lshlrev_b32 v66, 16, v66
    v_mul_f32 v66, v66, v114
    v_cvt_pk_bf16_f32 v66, v66, v66
    v_lshlrev_b32 v66, 16, v66
    v_add_f32 v66, v66, v162
    v_add_f32 v67, v67, v99
    v_cvt_pk_bf16_f32 v67, v67, v67
    v_lshlrev_b32 v67, 16, v67
    v_mul_f32 v67, v67, v115
    v_cvt_pk_bf16_f32 v67, v67, v67
    v_lshlrev_b32 v67, 16, v67
    v_add_f32 v67, v67, v163
    v_add_f32 v68, v68, v100
    v_cvt_pk_bf16_f32 v68, v68, v68
    v_lshlrev_b32 v68, 16, v68
    v_mul_f32 v68, v68, v116
    v_cvt_pk_bf16_f32 v68, v68, v68
    v_lshlrev_b32 v68, 16, v68
    v_add_f32 v68, v68, v164
    v_add_f32 v69, v69, v101
    v_cvt_pk_bf16_f32 v69, v69, v69
    v_lshlrev_b32 v69, 16, v69
    v_mul_f32 v69, v69, v117
    v_cvt_pk_bf16_f32 v69, v69, v69
    v_lshlrev_b32 v69, 16, v69
    v_add_f32 v69, v69, v165
    v_add_f32 v70, v70, v102
    v_cvt_pk_bf16_f32 v70, v70, v70
    v_lshlrev_b32 v70, 16, v70
    v_mul_f32 v70, v70, v118
    v_cvt_pk_bf16_f32 v70, v70, v70
    v_lshlrev_b32 v70, 16, v70
    v_add_f32 v70, v70, v166
    v_add_f32 v71, v71, v103
    v_cvt_pk_bf16_f32 v71, v71, v71
    v_lshlrev_b32 v71, 16, v71
    v_mul_f32 v71, v71, v119
    v_cvt_pk_bf16_f32 v71, v71, v71
    v_lshlrev_b32 v71, 16, v71
    v_add_f32 v71, v71, v167
    v_add_f32 v72, v72, v104
    v_cvt_pk_bf16_f32 v72, v72, v72
    v_lshlrev_b32 v72, 16, v72
    v_mul_f32 v72, v72, v120
    v_cvt_pk_bf16_f32 v72, v72, v72
    v_lshlrev_b32 v72, 16, v72
    v_add_f32 v72, v72, v168
    v_add_f32 v73, v73, v105
    v_cvt_pk_bf16_f32 v73, v73, v73
    v_lshlrev_b32 v73, 16, v73
    v_mul_f32 v73, v73, v121
    v_cvt_pk_bf16_f32 v73, v73, v73
    v_lshlrev_b32 v73, 16, v73
    v_add_f32 v73, v73, v169
    v_add_f32 v74, v74, v106
    v_cvt_pk_bf16_f32 v74, v74, v74
    v_lshlrev_b32 v74, 16, v74
    v_mul_f32 v74, v74, v122
    v_cvt_pk_bf16_f32 v74, v74, v74
    v_lshlrev_b32 v74, 16, v74
    v_add_f32 v74, v74, v170
    v_add_f32 v75, v75, v107
    v_cvt_pk_bf16_f32 v75, v75, v75
    v_lshlrev_b32 v75, 16, v75
    v_mul_f32 v75, v75, v123
    v_cvt_pk_bf16_f32 v75, v75, v75
    v_lshlrev_b32 v75, 16, v75
    v_add_f32 v75, v75, v171
    v_add_f32 v76, v76, v108
    v_cvt_pk_bf16_f32 v76, v76, v76
    v_lshlrev_b32 v76, 16, v76
    v_mul_f32 v76, v76, v124
    v_cvt_pk_bf16_f32 v76, v76, v76
    v_lshlrev_b32 v76, 16, v76
    v_add_f32 v76, v76, v172
    v_add_f32 v77, v77, v109
    v_cvt_pk_bf16_f32 v77, v77, v77
    v_lshlrev_b32 v77, 16, v77
    v_mul_f32 v77, v77, v125
    v_cvt_pk_bf16_f32 v77, v77, v77
    v_lshlrev_b32 v77, 16, v77
    v_add_f32 v77, v77, v173
    v_add_f32 v78, v78, v110
    v_cvt_pk_bf16_f32 v78, v78, v78
    v_lshlrev_b32 v78, 16, v78
    v_mul_f32 v78, v78, v126
    v_cvt_pk_bf16_f32 v78, v78, v78
    v_lshlrev_b32 v78, 16, v78
    v_add_f32 v78, v78, v174
    v_add_f32 v79, v79, v111
    v_cvt_pk_bf16_f32 v79, v79, v79
    v_lshlrev_b32 v79, 16, v79
    v_mul_f32 v79, v79, v127
    v_cvt_pk_bf16_f32 v79, v79, v79
    v_lshlrev_b32 v79, 16, v79
    v_add_f32 v79, v79, v175
    v_cvt_pk_bf16_f32 v208, v64, v65
    v_cvt_pk_bf16_f32 v209, v66, v67
    v_cvt_pk_bf16_f32 v210, v68, v69
    v_cvt_pk_bf16_f32 v211, v70, v71
    v_cvt_pk_bf16_f32 v212, v72, v73
    v_cvt_pk_bf16_f32 v213, v74, v75
    v_cvt_pk_bf16_f32 v214, v76, v77
    v_cvt_pk_bf16_f32 v215, v78, v79
    buffer_store_dwordx4 v[208:211], v10, s[32:35], s47 offen
    buffer_store_dwordx4 v[212:215], v10, s[32:35], s47 offen offset:1024
    s_branch L_c_loop_164
L_w_done_102:
    s_endpgm
.section .rodata,"a"
.p2align 6
.amdhsa_kernel adaLN_cond__memory_aug_recurrent_mem_tr__dense_activation_gelu__prompt_kernel
  .amdhsa_next_free_vgpr 512
  .amdhsa_next_free_sgpr 102
  .amdhsa_accum_offset 256
  .amdhsa_group_segment_fixed_size 0
  .amdhsa_kernarg_size 136
  .amdhsa_user_sgpr_count 2
  .amdhsa_user_sgpr_kernarg_segment_ptr 1
  .amdhsa_system_sgpr_workgroup_id_x 1
.end_amdhsa_kernel
```

```asm
; @launch kernel=adaLN_cond__memory_aug_recurrent_mem_tr__dense_activation_gelu__prompt_kernel grid=(256,1,1) block=(256,1,1) lds=163840
.amdgcn_target "amdgcn-amd-amdhsa--gfx950"
.text
.globl adaLN_cond__memory_aug_recurrent_mem_tr__dense_activation_gelu__prompt_kernel
.p2align 8
.type adaLN_cond__memory_aug_recurrent_mem_tr__dense_activation_gelu__prompt_kernel,@function
adaLN_cond__memory_aug_recurrent_mem_tr__dense_activation_gelu__prompt_kernel:
    s_cmp_lt_u32 s2, 256
    s_cbranch_scc1 L_c_done_1_go
    s_endpgm
L_c_done_1_go:
    s_and_b32 s40, s2, 7
    s_load_dwordx4 s[4:7], s[0:1], 16
    s_load_dwordx4 s[8:11], s[0:1], 32
    s_load_dwordx2 s[20:21], s[0:1], 128
    s_load_dwordx2 s[22:23], s[0:1], 120
    s_load_dwordx2 s[50:51], s[0:1], 8
    s_lshr_b32 s41, s2, 3
    s_and_b32 s42, s41, 15
    v_and_b32 v1, 63, v0
    v_lshrrev_b32 v2, 6, v0
    s_nop 0
    v_readfirstlane_b32 s44, v2
    s_waitcnt lgkmcnt(0)
    s_mov_b32 s24, s4
    s_and_b32 s25, s5, 0xffff
    s_mov_b32 s26, 0x800000
    s_mov_b32 s27, 0x00020000
    s_mov_b32 s28, s6
    s_and_b32 s29, s7, 0xffff
    s_mov_b32 s30, 0x800000
    s_mov_b32 s31, 0x00020000
    s_mov_b32 s32, s8
    s_and_b32 s33, s9, 0xffff
    s_mov_b32 s34, 0x800000
    s_mov_b32 s35, 0x00020000
    s_mov_b32 s36, s10
    s_and_b32 s37, s11, 0xffff
    s_mov_b32 s38, 0x800000
    s_mov_b32 s39, 0x00020000
    s_mov_b32 s12, s20
    s_and_b32 s13, s21, 0xffff
    s_mov_b32 s14, 0x10000000
    s_mov_b32 s15, 0x00020000
    s_mov_b32 s16, s22
    s_and_b32 s17, s23, 0xffff
    s_mov_b32 s18, 0x100
    s_mov_b32 s19, 0x00020000
    s_mov_b32 s52, s50
    s_and_b32 s53, s51, 0xffff
    s_mov_b32 s54, 0x4000
    s_mov_b32 s55, 0x00020000
    v_mov_b32 v41, 0
    s_cmp_lg_u32 s2, 1
    s_cbranch_scc1 L_worker_3_a
    s_getreg_b32 s45, hwreg(HW_REG_XCC_ID)
    s_and_b32 s45, s45, 1
    s_add_u32 s45, s45, 1
    v_mov_b32 v40, s45
    buffer_store_dword v40, v41, s[16:19], 0 offen offset:24 sc1
L_worker_3_a:
    s_cmp_eq_u32 s40, 1
    s_cbranch_scc1 L_worker_3_g0
    s_cmp_lt_u32 s40, 3
    s_cbranch_scc1 L_worker_3_q
    s_sub_u32 s40, s40, 2
    s_branch L_worker_3
L_worker_3_q:
    s_mov_b32 s70, 0
L_worker_3_p:
    buffer_load_dword v40, v41, s[16:19], 0 offen offset:24 sc1
    s_add_u32 s70, s70, 1
    s_cmp_ge_u32 s70, 0x200000
    s_cbranch_scc1 L_c_done_1
    s_waitcnt vmcnt(0)
    v_readfirstlane_b32 s45, v40
    s_nop 3
    s_cmp_eq_u32 s45, 0
    s_cbranch_scc1 L_worker_3_p
    s_and_b32 s45, s45, 2
    s_cmp_lg_u32 s45, s40
    s_mov_b32 s40, 1
    s_cbranch_scc1 L_worker_3_no
    s_mov_b32 s40, 0
    s_branch L_worker_3
L_worker_3_g0:
    s_mov_b32 s40, 0
L_worker_3_no:
    s_lshl_b32 s43, s40, 4
    s_add_u32 s43, s43, s42
    s_lshl_b32 s3, s43, 7
    s_lshr_b32 s45, s41, 4
    s_lshl_b32 s45, s45, 4
    s_add_u32 s3, s3, s45
    s_lshl_b32 s45, s44, 2
    s_add_u32 s3, s3, s45
    s_add_u32 s3, s3, 0x11000
    s_cmp_ge_u32 s41, 16
    s_cselect_b32 s45, 63, 0
    v_mov_b32 v40, s45
    v_mov_b32 v41, 0
    s_mov_b64 exec, 1
    buffer_store_dword v40, v41, s[12:15], s3 offen sc1
    s_mov_b64 exec, -1
    v_and_b32 v21, 8, v1
    v_cmp_eq_u32 s[56:57], 0, v21
    v_mov_b32 v2, 0xeeee
    v_mov_b32 v3, 0x4444
    v_cndmask_b32 v2, v2, v3, s[56:57]
    v_lshlrev_b32 v68, 4, v1
    s_lshl_b32 s45, s44, 12
    v_add_u32 v3, s45, v68
    v_add_u32 v4, 4096, v3
    v_and_b32 v4, 16383, v4
    v_add_u32 v21, 8192, v3
    v_and_b32 v21, 16383, v21
    v_add_u32 v23, 12288, v3
    v_and_b32 v23, 16383, v23
    s_mul_i32 s45, s44, 24576
    s_add_u32 s45, s45, 65536
    v_add_u32 v5, s45, v68
    v_lshrrev_b32 v63, 4, v1
    s_lshl_b32 s45, s44, 2
    v_add_u32 v64, s45, v63
    s_lshr_b32 s45, s44, 1
    s_lshl_b32 s45, s45, 2
    v_add_u32 v65, s45, v63
    v_bfe_u32 v66, v1, 1, 3
    v_xor_b32 v66, v66, v65
    v_lshlrev_b32 v66, 5, v66
    v_and_b32 v67, 1, v1
    v_lshlrev_b32 v67, 4, v67
    v_add_u32 v66, v66, v67
    v_lshlrev_b32 v64, 13, v64
    v_add_u32 v82, v64, v66
    s_lshl_b32 s47, s43, 8
    s_lshl_b32 s48, s44, 10
    v_bfe_u32 v64, v1, 2, 2
    v_bfe_u32 v65, v1, 4, 1
    v_lshlrev_b32 v65, 2, v65
    v_add_u32 v65, v65, v64
    v_lshlrev_b32 v66, 3, v63
    v_add_u32 v66, v66, v64
    v_lshlrev_b32 v66, 8, v66
    v_and_b32 v67, 3, v1
    v_lshlrev_b32 v67, 3, v67
    v_add_u32 v66, v66, v67
    s_lshl_b32 s45, s44, 1
    v_xor_b32 v65, s45, v65
    v_lshlrev_b32 v65, 5, v65
    v_add_u32 v80, v66, v65
    v_xor_b32 v81, 32, v80
    v_lshrrev_b32 v64, 5, v1
    v_mul_u32_u24 v64, 20480, v64
    v_add_u32 v64, 65536, v64
    v_add_u32 v84, v64, v80
    v_add_u32 v85, v64, v81
    v_add_u32 v86, 49152, v84
    v_add_u32 v87, 49152, v85
    v_mov_b32 v40, -1
    v_mov_b32 v41, -1
    v_mov_b32 v42, -1
    v_mov_b32 v43, -1
    v_mov_b32 v44, 0
    s_mov_b32 s68, 0
    s_cmp_ge_u32 s41, 16
    s_cbranch_scc1 L_c_vo_2
    s_lshl_b32 s45, s42, 11
    s_lshr_b32 s46, s44, 1
    s_lshl_b32 s46, s46, 10
    s_add_u32 s45, s45, s46
    s_and_b32 s46, s44, 1
    s_lshl_b32 s46, s46, 7
    s_add_u32 s45, s45, s46
    v_add_u32 v17, s45, v68
    v_mov_b32 v63, 0x20000000
    v_cndmask_b32 v17, v63, v17, s[56:57]
    s_lshl_b32 s62, s40, 17
    s_add_u32 s62, s62, 0x7040000
    s_add_u32 s63, s62, 0
    buffer_store_dwordx4 v[40:43], v17, s[12:15], s63 offen sc1
    s_add_u32 s63, s62, 32768
    buffer_store_dwordx4 v[40:43], v17, s[12:15], s63 offen sc1
    s_add_u32 s63, s62, 65536
    buffer_store_dwordx4 v[40:43], v17, s[12:15], s63 offen sc1
    s_add_u32 s63, s62, 98304
    buffer_store_dwordx4 v[40:43], v17, s[12:15], s63 offen sc1
    s_mov_b64 exec, -1
    s_lshl_b32 s45, s40, 12
    s_lshl_b32 s46, s42, 4
    s_add_u32 s45, s45, s46
    s_add_u32 s45, s45, 0x7080000
    s_lshl_b32 s46, s44, 2
    s_add_u32 s45, s45, s46
    v_lshlrev_b32 v20, 8, v1
    v_add_u32 v20, s45, v20
    v_cmp_gt_u32 vcc, 16, v1
    s_nop 1
    v_cndmask_b32 v20, v63, v20, vcc
    buffer_store_dword v44, v20, s[12:15], 0 offen sc1
    s_add_u32 s79, s41, 0
    s_and_b32 s79, s79, 3
    s_lshl_b32 s79, s79, 19
    s_add_u32 s79, s79, s47
    s_add_u32 s46, s79, 0x0
    s_add_u32 m0, s48, 69632
    s_nop 0
    buffer_load_dwordx4 v82, s[24:27], s46 offen  lds
    s_add_u32 s46, s79, 0x20000
    s_add_u32 m0, s48, 94208
    s_nop 0
    buffer_load_dwordx4 v82, s[24:27], s46 offen  lds
    s_add_u32 s46, s79, 0x40000
    s_add_u32 m0, s48, 118784
    s_nop 0
    buffer_load_dwordx4 v82, s[24:27], s46 offen  lds
    s_add_u32 s46, s79, 0x60000
    s_add_u32 m0, s48, 143360
    s_nop 0
    buffer_load_dwordx4 v82, s[24:27], s46 offen  lds
    s_add_u32 s79, s41, 1
    s_and_b32 s79, s79, 3
    s_lshl_b32 s79, s79, 19
    s_add_u32 s79, s79, s47
    s_add_u32 s46, s79, 0x0
    s_add_u32 m0, s48, 73728
    s_nop 0
    buffer_load_dwordx4 v82, s[24:27], s46 offen  lds
    s_add_u32 s46, s79, 0x20000
    s_add_u32 m0, s48, 98304
    s_nop 0
    buffer_load_dwordx4 v82, s[24:27], s46 offen  lds
    s_add_u32 s46, s79, 0x40000
    s_add_u32 m0, s48, 122880
    s_nop 0
    buffer_load_dwordx4 v82, s[24:27], s46 offen  lds
    s_add_u32 s46, s79, 0x60000
    s_add_u32 m0, s48, 147456
    s_nop 0
    buffer_load_dwordx4 v82, s[24:27], s46 offen  lds
    s_add_u32 s79, s41, 2
    s_and_b32 s79, s79, 3
    s_lshl_b32 s79, s79, 19
    s_add_u32 s79, s79, s47
    s_add_u32 s46, s79, 0x0
    s_add_u32 m0, s48, 81920
    s_nop 0
    buffer_load_dwordx4 v82, s[24:27], s46 offen  lds
    s_add_u32 s46, s79, 0x20000
    s_add_u32 m0, s48, 106496
    s_nop 0
    buffer_load_dwordx4 v82, s[24:27], s46 offen  lds
    s_add_u32 s46, s79, 0x40000
    s_add_u32 m0, s48, 131072
    s_nop 0
    buffer_load_dwordx4 v82, s[24:27], s46 offen  lds
    s_add_u32 s46, s79, 0x60000
    s_add_u32 m0, s48, 155648
    s_nop 0
    buffer_load_dwordx4 v82, s[24:27], s46 offen  lds
    s_add_u32 s79, s41, 3
    s_and_b32 s79, s79, 3
    s_lshl_b32 s79, s79, 19
    s_add_u32 s79, s79, s47
    s_add_u32 s46, s79, 0x0
    s_add_u32 m0, s48, 86016
    s_nop 0
    buffer_load_dwordx4 v82, s[24:27], s46 offen  lds
    s_add_u32 s46, s79, 0x20000
    s_add_u32 m0, s48, 110592
    s_nop 0
    buffer_load_dwordx4 v82, s[24:27], s46 offen  lds
    s_add_u32 s46, s79, 0x40000
    s_add_u32 m0, s48, 135168
    s_nop 0
    buffer_load_dwordx4 v82, s[24:27], s46 offen  lds
    s_add_u32 s46, s79, 0x60000
    s_add_u32 m0, s48, 159744
    s_nop 0
    buffer_load_dwordx4 v82, s[24:27], s46 offen  lds
    s_add_u32 s79, s41, 4
    s_and_b32 s79, s79, 3
    s_lshl_b32 s79, s79, 19
    s_add_u32 s79, s79, s47
    s_add_u32 s46, s79, 0x200000
    s_add_u32 m0, s48, 0
    s_nop 0
    buffer_load_dwordx4 v82, s[24:27], s46 offen  lds
    s_add_u32 s46, s79, 0x220000
    s_add_u32 m0, s48, 4096
    s_nop 0
    buffer_load_dwordx4 v82, s[24:27], s46 offen  lds
    s_add_u32 s46, s79, 0x240000
    s_add_u32 m0, s48, 8192
    s_nop 0
    buffer_load_dwordx4 v82, s[24:27], s46 offen  lds
    s_add_u32 s46, s79, 0x260000
    s_add_u32 m0, s48, 12288
    s_nop 0
    buffer_load_dwordx4 v82, s[24:27], s46 offen  lds
    s_add_u32 s79, s41, 5
    s_and_b32 s79, s79, 3
    s_lshl_b32 s79, s79, 19
    s_add_u32 s79, s79, s47
    s_add_u32 s46, s79, 0x200000
    s_add_u32 m0, s48, 16384
    s_nop 0
    buffer_load_dwordx4 v82, s[24:27], s46 offen  lds
    s_add_u32 s46, s79, 0x220000
    s_add_u32 m0, s48, 20480
    s_nop 0
    buffer_load_dwordx4 v82, s[24:27], s46 offen  lds
    s_add_u32 s46, s79, 0x240000
    s_add_u32 m0, s48, 24576
    s_nop 0
    buffer_load_dwordx4 v82, s[24:27], s46 offen  lds
    s_add_u32 s46, s79, 0x260000
    s_add_u32 m0, s48, 28672
    s_nop 0
    buffer_load_dwordx4 v82, s[24:27], s46 offen  lds
    s_add_u32 s79, s41, 6
    s_and_b32 s79, s79, 3
    s_lshl_b32 s79, s79, 19
    s_add_u32 s79, s79, s47
    s_add_u32 s46, s79, 0x200000
    s_add_u32 m0, s48, 32768
    s_nop 0
    buffer_load_dwordx4 v82, s[24:27], s46 offen  lds
    s_add_u32 s46, s79, 0x220000
    s_add_u32 m0, s48, 36864
    s_nop 0
    buffer_load_dwordx4 v82, s[24:27], s46 offen  lds
    s_add_u32 s46, s79, 0x240000
    s_add_u32 m0, s48, 40960
    s_nop 0
    buffer_load_dwordx4 v82, s[24:27], s46 offen  lds
    s_add_u32 s46, s79, 0x260000
    s_add_u32 m0, s48, 45056
    s_nop 0
    buffer_load_dwordx4 v82, s[24:27], s46 offen  lds
    s_add_u32 s79, s41, 7
    s_and_b32 s79, s79, 3
    s_lshl_b32 s79, s79, 19
    s_add_u32 s79, s79, s47
    s_add_u32 s46, s79, 0x200000
    s_add_u32 m0, s48, 49152
    s_nop 0
    buffer_load_dwordx4 v82, s[24:27], s46 offen  lds
    s_add_u32 s46, s79, 0x220000
    s_add_u32 m0, s48, 53248
    s_nop 0
    buffer_load_dwordx4 v82, s[24:27], s46 offen  lds
    s_add_u32 s46, s79, 0x240000
    s_add_u32 m0, s48, 57344
    s_nop 0
    buffer_load_dwordx4 v82, s[24:27], s46 offen  lds
    s_add_u32 s46, s79, 0x260000
    s_add_u32 m0, s48, 61440
    s_nop 0
    buffer_load_dwordx4 v82, s[24:27], s46 offen  lds
    s_waitcnt vmcnt(28)
    s_barrier
    s_cmp_lg_u32 s44, 0
    s_cbranch_scc1 L_lw_4_0
    ds_read_b64_tr_b16 a[0:1], v84 offset:4096
    ds_read_b64_tr_b16 a[2:3], v84 offset:5120
    ds_read_b64_tr_b16 a[4:5], v86 offset:4096
    ds_read_b64_tr_b16 a[6:7], v86 offset:5120
    ds_read_b64_tr_b16 a[8:9], v85 offset:4096
    ds_read_b64_tr_b16 a[10:11], v85 offset:5120
    ds_read_b64_tr_b16 a[12:13], v87 offset:4096
    ds_read_b64_tr_b16 a[14:15], v87 offset:5120
    s_branch L_lw_4
L_lw_4_0:
    s_cmp_lg_u32 s44, 1
    s_cbranch_scc1 L_lw_4_1
    ds_read_b64_tr_b16 v[128:129], v84 offset:4096
    ds_read_b64_tr_b16 v[130:131], v84 offset:5120
    ds_read_b64_tr_b16 v[132:133], v86 offset:4096
    ds_read_b64_tr_b16 v[134:135], v86 offset:5120
    ds_read_b64_tr_b16 v[136:137], v85 offset:4096
    ds_read_b64_tr_b16 v[138:139], v85 offset:5120
    ds_read_b64_tr_b16 v[140:141], v87 offset:4096
    ds_read_b64_tr_b16 v[142:143], v87 offset:5120
    s_branch L_lw_4
L_lw_4_1:
    s_cmp_lg_u32 s44, 2
    s_cbranch_scc1 L_lw_4_2
    ds_read_b64_tr_b16 a[192:193], v84 offset:4096
    ds_read_b64_tr_b16 a[194:195], v84 offset:5120
    ds_read_b64_tr_b16 a[196:197], v86 offset:4096
    ds_read_b64_tr_b16 a[198:199], v86 offset:5120
    ds_read_b64_tr_b16 v[56:57], v85 offset:4096
    ds_read_b64_tr_b16 v[58:59], v85 offset:5120
    ds_read_b64_tr_b16 v[60:61], v87 offset:4096
    ds_read_b64_tr_b16 v[62:63], v87 offset:5120
    s_waitcnt lgkmcnt(0)
    ds_write_b128 v5, v[56:59] offset:0
    ds_write_b128 v5, v[60:63] offset:1024
    s_branch L_lw_4
L_lw_4_2:
    ds_read_b64_tr_b16 a[96:97], v84 offset:4096
    ds_read_b64_tr_b16 a[98:99], v84 offset:5120
    ds_read_b64_tr_b16 a[100:101], v86 offset:4096
    ds_read_b64_tr_b16 a[102:103], v86 offset:5120
    ds_read_b64_tr_b16 v[56:57], v85 offset:4096
    ds_read_b64_tr_b16 v[58:59], v85 offset:5120
    ds_read_b64_tr_b16 v[60:61], v87 offset:4096
    ds_read_b64_tr_b16 v[62:63], v87 offset:5120
    s_waitcnt lgkmcnt(0)
    ds_write_b128 v5, v[56:59] offset:2048
    ds_write_b128 v5, v[60:63] offset:3072
L_lw_4:
    s_waitcnt lgkmcnt(0)
    s_waitcnt vmcnt(24)
    s_barrier
    s_cmp_lg_u32 s44, 0
    s_cbranch_scc1 L_hs_5
    s_getreg_b32 s45, hwreg(HW_REG_XCC_ID)
    s_and_b32 s45, s45, 15
    s_mul_i32 s46, s45, s45
    s_lshl_b32 s46, s46, 9
    s_add_u32 s45, s45, s46
    s_cmp_eq_u32 s40, 0
    s_cselect_b32 s46, s45, 0
    s_cselect_b32 s45, 0, s45
    s_lshl_b32 s68, s68, 24
    s_add_u32 s46, s46, s68
    s_add_u32 s45, s45, 16777216
    v_mov_b32 v40, s46
    v_mov_b32 v41, s45
    v_mov_b32 v42, 0
    s_mov_b64 exec, 1
    buffer_atomic_add_x2 v[40:41], v42, s[16:19], 0 offen sc1
    s_mov_b64 exec, -1
L_hs_5:
    s_cmp_lg_u32 s44, 0
    s_cbranch_scc1 L_lw_6_0
    ds_read_b64_tr_b16 a[32:33], v84 offset:8192
    ds_read_b64_tr_b16 a[34:35], v84 offset:9216
    ds_read_b64_tr_b16 a[36:37], v86 offset:8192
    ds_read_b64_tr_b16 a[38:39], v86 offset:9216
    ds_read_b64_tr_b16 a[40:41], v85 offset:8192
    ds_read_b64_tr_b16 a[42:43], v85 offset:9216
    ds_read_b64_tr_b16 a[44:45], v87 offset:8192
    ds_read_b64_tr_b16 a[46:47], v87 offset:9216
    s_branch L_lw_6
L_lw_6_0:
    s_cmp_lg_u32 s44, 1
    s_cbranch_scc1 L_lw_6_1
    ds_read_b64_tr_b16 v[160:161], v84 offset:8192
    ds_read_b64_tr_b16 v[162:163], v84 offset:9216
    ds_read_b64_tr_b16 v[164:165], v86 offset:8192
    ds_read_b64_tr_b16 v[166:167], v86 offset:9216
    ds_read_b64_tr_b16 v[168:169], v85 offset:8192
    ds_read_b64_tr_b16 v[170:171], v85 offset:9216
    ds_read_b64_tr_b16 v[172:173], v87 offset:8192
    ds_read_b64_tr_b16 v[174:175], v87 offset:9216
    s_branch L_lw_6
L_lw_6_1:
    s_cmp_lg_u32 s44, 2
    s_cbranch_scc1 L_lw_6_2
    ds_read_b64_tr_b16 a[216:217], v84 offset:8192
    ds_read_b64_tr_b16 a[218:219], v84 offset:9216
    ds_read_b64_tr_b16 a[220:221], v86 offset:8192
    ds_read_b64_tr_b16 a[222:223], v86 offset:9216
    ds_read_b64_tr_b16 v[56:57], v85 offset:8192
    ds_read_b64_tr_b16 v[58:59], v85 offset:9216
    ds_read_b64_tr_b16 v[60:61], v87 offset:8192
    ds_read_b64_tr_b16 v[62:63], v87 offset:9216
    s_waitcnt lgkmcnt(0)
    ds_write_b128 v5, v[56:59] offset:4096
    ds_write_b128 v5, v[60:63] offset:5120
    s_branch L_lw_6
L_lw_6_2:
    ds_read_b64_tr_b16 a[120:121], v84 offset:8192
    ds_read_b64_tr_b16 a[122:123], v84 offset:9216
    ds_read_b64_tr_b16 a[124:125], v86 offset:8192
    ds_read_b64_tr_b16 a[126:127], v86 offset:9216
    ds_read_b64_tr_b16 v[56:57], v85 offset:8192
    ds_read_b64_tr_b16 v[58:59], v85 offset:9216
    ds_read_b64_tr_b16 v[60:61], v87 offset:8192
    ds_read_b64_tr_b16 v[62:63], v87 offset:9216
    s_waitcnt lgkmcnt(0)
    ds_write_b128 v5, v[56:59] offset:6144
    ds_write_b128 v5, v[60:63] offset:7168
L_lw_6:
    s_waitcnt lgkmcnt(0)
    s_waitcnt vmcnt(20)
    s_barrier
    s_cmp_lg_u32 s44, 0
    s_cbranch_scc1 L_lw_7_0
    ds_read_b64_tr_b16 a[64:65], v84 offset:16384
    ds_read_b64_tr_b16 a[66:67], v84 offset:17408
    ds_read_b64_tr_b16 a[68:69], v86 offset:16384
    ds_read_b64_tr_b16 a[70:71], v86 offset:17408
    ds_read_b64_tr_b16 v[56:57], v85 offset:16384
    ds_read_b64_tr_b16 v[58:59], v85 offset:17408
    ds_read_b64_tr_b16 v[60:61], v87 offset:16384
    ds_read_b64_tr_b16 v[62:63], v87 offset:17408
    s_waitcnt lgkmcnt(0)
    ds_write_b128 v5, v[56:59] offset:8192
    ds_write_b128 v5, v[60:63] offset:9216
    s_branch L_lw_7
L_lw_7_0:
    s_cmp_lg_u32 s44, 1
    s_cbranch_scc1 L_lw_7_1
    ds_read_b64_tr_b16 v[192:193], v84 offset:16384
    ds_read_b64_tr_b16 v[194:195], v84 offset:17408
    ds_read_b64_tr_b16 v[196:197], v86 offset:16384
    ds_read_b64_tr_b16 v[198:199], v86 offset:17408
    ds_read_b64_tr_b16 v[200:201], v85 offset:16384
    ds_read_b64_tr_b16 v[202:203], v85 offset:17408
    ds_read_b64_tr_b16 v[204:205], v87 offset:16384
    ds_read_b64_tr_b16 v[206:207], v87 offset:17408
    s_branch L_lw_7
L_lw_7_1:
    s_cmp_lg_u32 s44, 2
    s_cbranch_scc1 L_lw_7_2
    ds_read_b64_tr_b16 a[240:241], v84 offset:16384
    ds_read_b64_tr_b16 a[242:243], v84 offset:17408
    ds_read_b64_tr_b16 a[244:245], v86 offset:16384
    ds_read_b64_tr_b16 a[246:247], v86 offset:17408
    ds_read_b64_tr_b16 v[56:57], v85 offset:16384
    ds_read_b64_tr_b16 v[58:59], v85 offset:17408
    ds_read_b64_tr_b16 v[60:61], v87 offset:16384
    ds_read_b64_tr_b16 v[62:63], v87 offset:17408
    s_waitcnt lgkmcnt(0)
    ds_write_b128 v5, v[56:59] offset:10240
    ds_write_b128 v5, v[60:63] offset:11264
    s_branch L_lw_7
L_lw_7_2:
    ds_read_b64_tr_b16 a[144:145], v84 offset:16384
    ds_read_b64_tr_b16 a[146:147], v84 offset:17408
    ds_read_b64_tr_b16 a[148:149], v86 offset:16384
    ds_read_b64_tr_b16 a[150:151], v86 offset:17408
    ds_read_b64_tr_b16 v[56:57], v85 offset:16384
    ds_read_b64_tr_b16 v[58:59], v85 offset:17408
    ds_read_b64_tr_b16 v[60:61], v87 offset:16384
    ds_read_b64_tr_b16 v[62:63], v87 offset:17408
    s_waitcnt lgkmcnt(0)
    ds_write_b128 v5, v[56:59] offset:12288
    ds_write_b128 v5, v[60:63] offset:13312
L_lw_7:
    s_waitcnt lgkmcnt(0)
    s_waitcnt vmcnt(16)
    s_barrier
    s_cmp_lg_u32 s44, 0
    s_cbranch_scc1 L_lw_8_0
    ds_read_b64_tr_b16 a[80:81], v84 offset:20480
    ds_read_b64_tr_b16 a[82:83], v84 offset:21504
    ds_read_b64_tr_b16 a[84:85], v86 offset:20480
    ds_read_b64_tr_b16 a[86:87], v86 offset:21504
    ds_read_b64_tr_b16 v[56:57], v85 offset:20480
    ds_read_b64_tr_b16 v[58:59], v85 offset:21504
    ds_read_b64_tr_b16 v[60:61], v87 offset:20480
    ds_read_b64_tr_b16 v[62:63], v87 offset:21504
    s_waitcnt lgkmcnt(0)
    ds_write_b128 v5, v[56:59] offset:14336
    ds_write_b128 v5, v[60:63] offset:15360
    s_branch L_lw_8
L_lw_8_0:
    s_cmp_lg_u32 s44, 1
    s_cbranch_scc1 L_lw_8_1
    ds_read_b64_tr_b16 v[224:225], v84 offset:20480
    ds_read_b64_tr_b16 v[226:227], v84 offset:21504
    ds_read_b64_tr_b16 v[228:229], v86 offset:20480
    ds_read_b64_tr_b16 v[230:231], v86 offset:21504
    ds_read_b64_tr_b16 v[232:233], v85 offset:20480
    ds_read_b64_tr_b16 v[234:235], v85 offset:21504
    ds_read_b64_tr_b16 v[236:237], v87 offset:20480
    ds_read_b64_tr_b16 v[238:239], v87 offset:21504
    s_branch L_lw_8
L_lw_8_1:
    s_cmp_lg_u32 s44, 2
    s_cbranch_scc1 L_lw_8_2
    ds_read_b64_tr_b16 v[104:105], v84 offset:20480
    ds_read_b64_tr_b16 v[106:107], v84 offset:21504
    ds_read_b64_tr_b16 v[108:109], v86 offset:20480
    ds_read_b64_tr_b16 v[110:111], v86 offset:21504
    ds_read_b64_tr_b16 v[56:57], v85 offset:20480
    ds_read_b64_tr_b16 v[58:59], v85 offset:21504
    ds_read_b64_tr_b16 v[60:61], v87 offset:20480
    ds_read_b64_tr_b16 v[62:63], v87 offset:21504
    s_waitcnt lgkmcnt(0)
    ds_write_b128 v5, v[56:59] offset:16384
    ds_write_b128 v5, v[60:63] offset:17408
    s_branch L_lw_8
L_lw_8_2:
    ds_read_b64_tr_b16 a[168:169], v84 offset:20480
    ds_read_b64_tr_b16 a[170:171], v84 offset:21504
    ds_read_b64_tr_b16 a[172:173], v86 offset:20480
    ds_read_b64_tr_b16 a[174:175], v86 offset:21504
    ds_read_b64_tr_b16 v[56:57], v85 offset:20480
    ds_read_b64_tr_b16 v[58:59], v85 offset:21504
    ds_read_b64_tr_b16 v[60:61], v87 offset:20480
    ds_read_b64_tr_b16 v[62:63], v87 offset:21504
    s_waitcnt lgkmcnt(0)
    ds_write_b128 v5, v[56:59] offset:18432
    ds_write_b128 v5, v[60:63] offset:19456
L_lw_8:
    s_waitcnt lgkmcnt(0)
    s_waitcnt vmcnt(12)
    s_barrier
    s_add_u32 s79, s41, 8
    s_and_b32 s79, s79, 3
    s_lshl_b32 s79, s79, 19
    s_add_u32 s79, s79, s47
    s_add_u32 s46, s79, 0x400000
    s_add_u32 m0, s48, 86016
    s_nop 0
    buffer_load_dwordx4 v82, s[24:27], s46 offen  lds
    s_add_u32 s46, s79, 0x420000
    s_add_u32 m0, s48, 110592
    s_nop 0
    buffer_load_dwordx4 v82, s[24:27], s46 offen  lds
    s_add_u32 s46, s79, 0x440000
    s_add_u32 m0, s48, 135168
    s_nop 0
    buffer_load_dwordx4 v82, s[24:27], s46 offen  lds
    s_add_u32 s46, s79, 0x460000
    s_add_u32 m0, s48, 159744
    s_nop 0
    buffer_load_dwordx4 v82, s[24:27], s46 offen  lds
    s_cmp_lg_u32 s44, 0
    s_cbranch_scc1 L_lw_9_0
    ds_read_b64_tr_b16 a[96:97], v80 offset:0
    ds_read_b64_tr_b16 a[98:99], v80 offset:1024
    ds_read_b64_tr_b16 a[100:101], v80 offset:8192
    ds_read_b64_tr_b16 a[102:103], v80 offset:9216
    ds_read_b64_tr_b16 v[56:57], v81 offset:0
    ds_read_b64_tr_b16 v[58:59], v81 offset:1024
    ds_read_b64_tr_b16 v[60:61], v81 offset:8192
    ds_read_b64_tr_b16 v[62:63], v81 offset:9216
    s_waitcnt lgkmcnt(0)
    ds_write_b128 v5, v[56:59] offset:2048
    ds_write_b128 v5, v[60:63] offset:3072
    s_branch L_lw_9
L_lw_9_0:
    s_cmp_lg_u32 s44, 1
    s_cbranch_scc1 L_lw_9_1
    ds_read_b64_tr_b16 a[0:1], v80 offset:0
    ds_read_b64_tr_b16 a[2:3], v80 offset:1024
    ds_read_b64_tr_b16 a[4:5], v80 offset:8192
    ds_read_b64_tr_b16 a[6:7], v80 offset:9216
    ds_read_b64_tr_b16 a[8:9], v81 offset:0
    ds_read_b64_tr_b16 a[10:11], v81 offset:1024
    ds_read_b64_tr_b16 a[12:13], v81 offset:8192
    ds_read_b64_tr_b16 a[14:15], v81 offset:9216
    s_branch L_lw_9
L_lw_9_1:
    s_cmp_lg_u32 s44, 2
    s_cbranch_scc1 L_lw_9_2
    ds_read_b64_tr_b16 v[128:129], v80 offset:0
    ds_read_b64_tr_b16 v[130:131], v80 offset:1024
    ds_read_b64_tr_b16 v[132:133], v80 offset:8192
    ds_read_b64_tr_b16 v[134:135], v80 offset:9216
    ds_read_b64_tr_b16 v[136:137], v81 offset:0
    ds_read_b64_tr_b16 v[138:139], v81 offset:1024
    ds_read_b64_tr_b16 v[140:141], v81 offset:8192
    ds_read_b64_tr_b16 v[142:143], v81 offset:9216
    s_branch L_lw_9
L_lw_9_2:
    ds_read_b64_tr_b16 a[192:193], v80 offset:0
    ds_read_b64_tr_b16 a[194:195], v80 offset:1024
    ds_read_b64_tr_b16 a[196:197], v80 offset:8192
    ds_read_b64_tr_b16 a[198:199], v80 offset:9216
    ds_read_b64_tr_b16 v[56:57], v81 offset:0
    ds_read_b64_tr_b16 v[58:59], v81 offset:1024
    ds_read_b64_tr_b16 v[60:61], v81 offset:8192
    ds_read_b64_tr_b16 v[62:63], v81 offset:9216
    s_waitcnt lgkmcnt(0)
    ds_write_b128 v5, v[56:59] offset:0
    ds_write_b128 v5, v[60:63] offset:1024
L_lw_9:
    s_waitcnt lgkmcnt(0)
    s_waitcnt vmcnt(12)
    s_barrier
    s_add_u32 s79, s41, 9
    s_and_b32 s79, s79, 3
    s_lshl_b32 s79, s79, 19
    s_add_u32 s79, s79, s47
    s_add_u32 s46, s79, 0x400000
    s_add_u32 m0, s48, 0
    s_nop 0
    buffer_load_dwordx4 v82, s[24:27], s46 offen  lds
    s_add_u32 s46, s79, 0x420000
    s_add_u32 m0, s48, 4096
    s_nop 0
    buffer_load_dwordx4 v82, s[24:27], s46 offen  lds
    s_add_u32 s46, s79, 0x440000
    s_add_u32 m0, s48, 8192
    s_nop 0
    buffer_load_dwordx4 v82, s[24:27], s46 offen  lds
    s_add_u32 s46, s79, 0x460000
    s_add_u32 m0, s48, 12288
    s_nop 0
    buffer_load_dwordx4 v82, s[24:27], s46 offen  lds
    s_cmp_lg_u32 s44, 0
    s_cbranch_scc1 L_lw_10_0
    ds_read_b64_tr_b16 a[120:121], v80 offset:16384
    ds_read_b64_tr_b16 a[122:123], v80 offset:17408
    ds_read_b64_tr_b16 a[124:125], v80 offset:24576
    ds_read_b64_tr_b16 a[126:127], v80 offset:25600
    ds_read_b64_tr_b16 v[56:57], v81 offset:16384
    ds_read_b64_tr_b16 v[58:59], v81 offset:17408
    ds_read_b64_tr_b16 v[60:61], v81 offset:24576
    ds_read_b64_tr_b16 v[62:63], v81 offset:25600
    s_waitcnt lgkmcnt(0)
    ds_write_b128 v5, v[56:59] offset:6144
    ds_write_b128 v5, v[60:63] offset:7168
    s_branch L_lw_10
L_lw_10_0:
    s_cmp_lg_u32 s44, 1
    s_cbranch_scc1 L_lw_10_1
    ds_read_b64_tr_b16 a[32:33], v80 offset:16384
    ds_read_b64_tr_b16 a[34:35], v80 offset:17408
    ds_read_b64_tr_b16 a[36:37], v80 offset:24576
    ds_read_b64_tr_b16 a[38:39], v80 offset:25600
    ds_read_b64_tr_b16 a[40:41], v81 offset:16384
    ds_read_b64_tr_b16 a[42:43], v81 offset:17408
    ds_read_b64_tr_b16 a[44:45], v81 offset:24576
    ds_read_b64_tr_b16 a[46:47], v81 offset:25600
    s_branch L_lw_10
L_lw_10_1:
    s_cmp_lg_u32 s44, 2
    s_cbranch_scc1 L_lw_10_2
    ds_read_b64_tr_b16 v[160:161], v80 offset:16384
    ds_read_b64_tr_b16 v[162:163], v80 offset:17408
    ds_read_b64_tr_b16 v[164:165], v80 offset:24576
    ds_read_b64_tr_b16 v[166:167], v80 offset:25600
    ds_read_b64_tr_b16 v[168:169], v81 offset:16384
    ds_read_b64_tr_b16 v[170:171], v81 offset:17408
    ds_read_b64_tr_b16 v[172:173], v81 offset:24576
    ds_read_b64_tr_b16 v[174:175], v81 offset:25600
    s_branch L_lw_10
L_lw_10_2:
    ds_read_b64_tr_b16 a[216:217], v80 offset:16384
    ds_read_b64_tr_b16 a[218:219], v80 offset:17408
    ds_read_b64_tr_b16 a[220:221], v80 offset:24576
    ds_read_b64_tr_b16 a[222:223], v80 offset:25600
    ds_read_b64_tr_b16 v[56:57], v81 offset:16384
    ds_read_b64_tr_b16 v[58:59], v81 offset:17408
    ds_read_b64_tr_b16 v[60:61], v81 offset:24576
    ds_read_b64_tr_b16 v[62:63], v81 offset:25600
    s_waitcnt lgkmcnt(0)
    ds_write_b128 v5, v[56:59] offset:4096
    ds_write_b128 v5, v[60:63] offset:5120
L_lw_10:
    s_waitcnt lgkmcnt(0)
    s_waitcnt vmcnt(12)
    s_barrier
    s_add_u32 s79, s41, 10
    s_and_b32 s79, s79, 3
    s_lshl_b32 s79, s79, 19
    s_add_u32 s79, s79, s47
    s_add_u32 s46, s79, 0x400000
    s_add_u32 m0, s48, 16384
    s_nop 0
    buffer_load_dwordx4 v82, s[24:27], s46 offen  lds
    s_add_u32 s46, s79, 0x420000
    s_add_u32 m0, s48, 20480
    s_nop 0
    buffer_load_dwordx4 v82, s[24:27], s46 offen  lds
    s_add_u32 s46, s79, 0x440000
    s_add_u32 m0, s48, 24576
    s_nop 0
    buffer_load_dwordx4 v82, s[24:27], s46 offen  lds
    s_add_u32 s46, s79, 0x460000
    s_add_u32 m0, s48, 28672
    s_nop 0
    buffer_load_dwordx4 v82, s[24:27], s46 offen  lds
    s_cmp_lg_u32 s44, 0
    s_cbranch_scc1 L_lw_11_0
    ds_read_b64_tr_b16 a[144:145], v80 offset:32768
    ds_read_b64_tr_b16 a[146:147], v80 offset:33792
    ds_read_b64_tr_b16 a[148:149], v80 offset:40960
    ds_read_b64_tr_b16 a[150:151], v80 offset:41984
    ds_read_b64_tr_b16 v[56:57], v81 offset:32768
    ds_read_b64_tr_b16 v[58:59], v81 offset:33792
    ds_read_b64_tr_b16 v[60:61], v81 offset:40960
    ds_read_b64_tr_b16 v[62:63], v81 offset:41984
    s_waitcnt lgkmcnt(0)
    ds_write_b128 v5, v[56:59] offset:12288
    ds_write_b128 v5, v[60:63] offset:13312
    s_branch L_lw_11
L_lw_11_0:
    s_cmp_lg_u32 s44, 1
    s_cbranch_scc1 L_lw_11_1
    ds_read_b64_tr_b16 a[64:65], v80 offset:32768
    ds_read_b64_tr_b16 a[66:67], v80 offset:33792
    ds_read_b64_tr_b16 a[68:69], v80 offset:40960
    ds_read_b64_tr_b16 a[70:71], v80 offset:41984
    ds_read_b64_tr_b16 v[56:57], v81 offset:32768
    ds_read_b64_tr_b16 v[58:59], v81 offset:33792
    ds_read_b64_tr_b16 v[60:61], v81 offset:40960
    ds_read_b64_tr_b16 v[62:63], v81 offset:41984
    s_waitcnt lgkmcnt(0)
    ds_write_b128 v5, v[56:59] offset:8192
    ds_write_b128 v5, v[60:63] offset:9216
    s_branch L_lw_11
L_lw_11_1:
    s_cmp_lg_u32 s44, 2
    s_cbranch_scc1 L_lw_11_2
    ds_read_b64_tr_b16 v[192:193], v80 offset:32768
    ds_read_b64_tr_b16 v[194:195], v80 offset:33792
    ds_read_b64_tr_b16 v[196:197], v80 offset:40960
    ds_read_b64_tr_b16 v[198:199], v80 offset:41984
    ds_read_b64_tr_b16 v[200:201], v81 offset:32768
    ds_read_b64_tr_b16 v[202:203], v81 offset:33792
    ds_read_b64_tr_b16 v[204:205], v81 offset:40960
    ds_read_b64_tr_b16 v[206:207], v81 offset:41984
    s_branch L_lw_11
L_lw_11_2:
    ds_read_b64_tr_b16 a[240:241], v80 offset:32768
    ds_read_b64_tr_b16 a[242:243], v80 offset:33792
    ds_read_b64_tr_b16 a[244:245], v80 offset:40960
    ds_read_b64_tr_b16 a[246:247], v80 offset:41984
    ds_read_b64_tr_b16 v[56:57], v81 offset:32768
    ds_read_b64_tr_b16 v[58:59], v81 offset:33792
    ds_read_b64_tr_b16 v[60:61], v81 offset:40960
    ds_read_b64_tr_b16 v[62:63], v81 offset:41984
    s_waitcnt lgkmcnt(0)
    ds_write_b128 v5, v[56:59] offset:10240
    ds_write_b128 v5, v[60:63] offset:11264
L_lw_11:
    s_waitcnt lgkmcnt(0)
    s_waitcnt vmcnt(12)
    s_barrier
    s_add_u32 s79, s41, 11
    s_and_b32 s79, s79, 3
    s_lshl_b32 s79, s79, 19
    s_add_u32 s79, s79, s47
    s_add_u32 s46, s79, 0x400000
    s_add_u32 m0, s48, 32768
    s_nop 0
    buffer_load_dwordx4 v82, s[24:27], s46 offen  lds
    s_add_u32 s46, s79, 0x420000
    s_add_u32 m0, s48, 36864
    s_nop 0
    buffer_load_dwordx4 v82, s[24:27], s46 offen  lds
    s_add_u32 s46, s79, 0x440000
    s_add_u32 m0, s48, 40960
    s_nop 0
    buffer_load_dwordx4 v82, s[24:27], s46 offen  lds
    s_add_u32 s46, s79, 0x460000
    s_add_u32 m0, s48, 45056
    s_nop 0
    buffer_load_dwordx4 v82, s[24:27], s46 offen  lds
    s_cmp_lg_u32 s44, 0
    s_cbranch_scc1 L_lw_12_0
    ds_read_b64_tr_b16 a[168:169], v80 offset:49152
    ds_read_b64_tr_b16 a[170:171], v80 offset:50176
    ds_read_b64_tr_b16 a[172:173], v80 offset:57344
    ds_read_b64_tr_b16 a[174:175], v80 offset:58368
    ds_read_b64_tr_b16 v[56:57], v81 offset:49152
    ds_read_b64_tr_b16 v[58:59], v81 offset:50176
    ds_read_b64_tr_b16 v[60:61], v81 offset:57344
    ds_read_b64_tr_b16 v[62:63], v81 offset:58368
    s_waitcnt lgkmcnt(0)
    ds_write_b128 v5, v[56:59] offset:18432
    ds_write_b128 v5, v[60:63] offset:19456
    s_branch L_lw_12
L_lw_12_0:
    s_cmp_lg_u32 s44, 1
    s_cbranch_scc1 L_lw_12_1
    ds_read_b64_tr_b16 a[80:81], v80 offset:49152
    ds_read_b64_tr_b16 a[82:83], v80 offset:50176
    ds_read_b64_tr_b16 a[84:85], v80 offset:57344
    ds_read_b64_tr_b16 a[86:87], v80 offset:58368
    ds_read_b64_tr_b16 v[56:57], v81 offset:49152
    ds_read_b64_tr_b16 v[58:59], v81 offset:50176
    ds_read_b64_tr_b16 v[60:61], v81 offset:57344
    ds_read_b64_tr_b16 v[62:63], v81 offset:58368
    s_waitcnt lgkmcnt(0)
    ds_write_b128 v5, v[56:59] offset:14336
    ds_write_b128 v5, v[60:63] offset:15360
    s_branch L_lw_12
L_lw_12_1:
    s_cmp_lg_u32 s44, 2
    s_cbranch_scc1 L_lw_12_2
    ds_read_b64_tr_b16 v[224:225], v80 offset:49152
    ds_read_b64_tr_b16 v[226:227], v80 offset:50176
    ds_read_b64_tr_b16 v[228:229], v80 offset:57344
    ds_read_b64_tr_b16 v[230:231], v80 offset:58368
    ds_read_b64_tr_b16 v[232:233], v81 offset:49152
    ds_read_b64_tr_b16 v[234:235], v81 offset:50176
    ds_read_b64_tr_b16 v[236:237], v81 offset:57344
    ds_read_b64_tr_b16 v[238:239], v81 offset:58368
    s_branch L_lw_12
L_lw_12_2:
    ds_read_b64_tr_b16 v[104:105], v80 offset:49152
    ds_read_b64_tr_b16 v[106:107], v80 offset:50176
    ds_read_b64_tr_b16 v[108:109], v80 offset:57344
    ds_read_b64_tr_b16 v[110:111], v80 offset:58368
    ds_read_b64_tr_b16 v[56:57], v81 offset:49152
    ds_read_b64_tr_b16 v[58:59], v81 offset:50176
    ds_read_b64_tr_b16 v[60:61], v81 offset:57344
    ds_read_b64_tr_b16 v[62:63], v81 offset:58368
    s_waitcnt lgkmcnt(0)
    ds_write_b128 v5, v[56:59] offset:16384
    ds_write_b128 v5, v[60:63] offset:17408
L_lw_12:
    s_waitcnt lgkmcnt(0)
    s_waitcnt vmcnt(12)
    s_barrier
    s_add_u32 s79, s41, 12
    s_and_b32 s79, s79, 3
    s_lshl_b32 s79, s79, 19
    s_add_u32 s79, s79, s47
    s_add_u32 s46, s79, 0x600000
    s_add_u32 m0, s48, 49152
    s_nop 0
    buffer_load_dwordx4 v82, s[24:27], s46 offen  lds
    s_add_u32 s46, s79, 0x620000
    s_add_u32 m0, s48, 53248
    s_nop 0
    buffer_load_dwordx4 v82, s[24:27], s46 offen  lds
    s_add_u32 s46, s79, 0x640000
    s_add_u32 m0, s48, 57344
    s_nop 0
    buffer_load_dwordx4 v82, s[24:27], s46 offen  lds
    s_add_u32 s46, s79, 0x660000
    s_add_u32 m0, s48, 61440
    s_nop 0
    buffer_load_dwordx4 v82, s[24:27], s46 offen  lds
    s_cmp_lg_u32 s44, 0
    s_cbranch_scc1 L_lw_13_0
    ds_read_b64_tr_b16 a[192:193], v84 offset:20480
    ds_read_b64_tr_b16 a[194:195], v84 offset:21504
    ds_read_b64_tr_b16 a[196:197], v86 offset:20480
    ds_read_b64_tr_b16 a[198:199], v86 offset:21504
    ds_read_b64_tr_b16 v[56:57], v85 offset:20480
    ds_read_b64_tr_b16 v[58:59], v85 offset:21504
    ds_read_b64_tr_b16 v[60:61], v87 offset:20480
    ds_read_b64_tr_b16 v[62:63], v87 offset:21504
    s_waitcnt lgkmcnt(0)
    ds_write_b128 v5, v[56:59] offset:0
    ds_write_b128 v5, v[60:63] offset:1024
    s_branch L_lw_13
L_lw_13_0:
    s_cmp_lg_u32 s44, 1
    s_cbranch_scc1 L_lw_13_1
    ds_read_b64_tr_b16 a[96:97], v84 offset:20480
    ds_read_b64_tr_b16 a[98:99], v84 offset:21504
    ds_read_b64_tr_b16 a[100:101], v86 offset:20480
    ds_read_b64_tr_b16 a[102:103], v86 offset:21504
    ds_read_b64_tr_b16 v[56:57], v85 offset:20480
    ds_read_b64_tr_b16 v[58:59], v85 offset:21504
    ds_read_b64_tr_b16 v[60:61], v87 offset:20480
    ds_read_b64_tr_b16 v[62:63], v87 offset:21504
    s_waitcnt lgkmcnt(0)
    ds_write_b128 v5, v[56:59] offset:2048
    ds_write_b128 v5, v[60:63] offset:3072
    s_branch L_lw_13
L_lw_13_1:
    s_cmp_lg_u32 s44, 2
    s_cbranch_scc1 L_lw_13_2
    ds_read_b64_tr_b16 a[0:1], v84 offset:20480
    ds_read_b64_tr_b16 a[2:3], v84 offset:21504
    ds_read_b64_tr_b16 a[4:5], v86 offset:20480
    ds_read_b64_tr_b16 a[6:7], v86 offset:21504
    ds_read_b64_tr_b16 a[8:9], v85 offset:20480
    ds_read_b64_tr_b16 a[10:11], v85 offset:21504
    ds_read_b64_tr_b16 a[12:13], v87 offset:20480
    ds_read_b64_tr_b16 a[14:15], v87 offset:21504
    s_branch L_lw_13
L_lw_13_2:
    ds_read_b64_tr_b16 v[128:129], v84 offset:20480
    ds_read_b64_tr_b16 v[130:131], v84 offset:21504
    ds_read_b64_tr_b16 v[132:133], v86 offset:20480
    ds_read_b64_tr_b16 v[134:135], v86 offset:21504
    ds_read_b64_tr_b16 v[136:137], v85 offset:20480
    ds_read_b64_tr_b16 v[138:139], v85 offset:21504
    ds_read_b64_tr_b16 v[140:141], v87 offset:20480
    ds_read_b64_tr_b16 v[142:143], v87 offset:21504
L_lw_13:
    s_waitcnt lgkmcnt(0)
    s_waitcnt vmcnt(12)
    s_barrier
    s_add_u32 s79, s41, 13
    s_and_b32 s79, s79, 3
    s_lshl_b32 s79, s79, 19
    s_add_u32 s79, s79, s47
    s_add_u32 s46, s79, 0x600000
    s_add_u32 m0, s48, 86016
    s_nop 0
    buffer_load_dwordx4 v82, s[24:27], s46 offen  lds
    s_add_u32 s46, s79, 0x620000
    s_add_u32 m0, s48, 110592
    s_nop 0
    buffer_load_dwordx4 v82, s[24:27], s46 offen  lds
    s_add_u32 s46, s79, 0x640000
    s_add_u32 m0, s48, 135168
    s_nop 0
    buffer_load_dwordx4 v82, s[24:27], s46 offen  lds
    s_add_u32 s46, s79, 0x660000
    s_add_u32 m0, s48, 159744
    s_nop 0
    buffer_load_dwordx4 v82, s[24:27], s46 offen  lds
    s_cmp_lg_u32 s44, 0
    s_cbranch_scc1 L_lw_14_0
    ds_read_b64_tr_b16 a[216:217], v80 offset:0
    ds_read_b64_tr_b16 a[218:219], v80 offset:1024
    ds_read_b64_tr_b16 a[220:221], v80 offset:8192
    ds_read_b64_tr_b16 a[222:223], v80 offset:9216
    ds_read_b64_tr_b16 v[56:57], v81 offset:0
    ds_read_b64_tr_b16 v[58:59], v81 offset:1024
    ds_read_b64_tr_b16 v[60:61], v81 offset:8192
    ds_read_b64_tr_b16 v[62:63], v81 offset:9216
    s_waitcnt lgkmcnt(0)
    ds_write_b128 v5, v[56:59] offset:4096
    ds_write_b128 v5, v[60:63] offset:5120
    s_branch L_lw_14
L_lw_14_0:
    s_cmp_lg_u32 s44, 1
    s_cbranch_scc1 L_lw_14_1
    ds_read_b64_tr_b16 a[120:121], v80 offset:0
    ds_read_b64_tr_b16 a[122:123], v80 offset:1024
    ds_read_b64_tr_b16 a[124:125], v80 offset:8192
    ds_read_b64_tr_b16 a[126:127], v80 offset:9216
    ds_read_b64_tr_b16 v[56:57], v81 offset:0
    ds_read_b64_tr_b16 v[58:59], v81 offset:1024
    ds_read_b64_tr_b16 v[60:61], v81 offset:8192
    ds_read_b64_tr_b16 v[62:63], v81 offset:9216
    s_waitcnt lgkmcnt(0)
    ds_write_b128 v5, v[56:59] offset:6144
    ds_write_b128 v5, v[60:63] offset:7168
    s_branch L_lw_14
L_lw_14_1:
    s_cmp_lg_u32 s44, 2
    s_cbranch_scc1 L_lw_14_2
    ds_read_b64_tr_b16 a[32:33], v80 offset:0
    ds_read_b64_tr_b16 a[34:35], v80 offset:1024
    ds_read_b64_tr_b16 a[36:37], v80 offset:8192
    ds_read_b64_tr_b16 a[38:39], v80 offset:9216
    ds_read_b64_tr_b16 a[40:41], v81 offset:0
    ds_read_b64_tr_b16 a[42:43], v81 offset:1024
    ds_read_b64_tr_b16 a[44:45], v81 offset:8192
    ds_read_b64_tr_b16 a[46:47], v81 offset:9216
    s_branch L_lw_14
L_lw_14_2:
    ds_read_b64_tr_b16 v[160:161], v80 offset:0
    ds_read_b64_tr_b16 v[162:163], v80 offset:1024
    ds_read_b64_tr_b16 v[164:165], v80 offset:8192
    ds_read_b64_tr_b16 v[166:167], v80 offset:9216
    ds_read_b64_tr_b16 v[168:169], v81 offset:0
    ds_read_b64_tr_b16 v[170:171], v81 offset:1024
    ds_read_b64_tr_b16 v[172:173], v81 offset:8192
    ds_read_b64_tr_b16 v[174:175], v81 offset:9216
L_lw_14:
    s_waitcnt lgkmcnt(0)
    s_waitcnt vmcnt(12)
    s_barrier
    s_add_u32 s79, s41, 14
    s_and_b32 s79, s79, 3
    s_lshl_b32 s79, s79, 19
    s_add_u32 s79, s79, s47
    s_add_u32 s46, s79, 0x600000
    s_add_u32 m0, s48, 0
    s_nop 0
    buffer_load_dwordx4 v82, s[24:27], s46 offen  lds
    s_add_u32 s46, s79, 0x620000
    s_add_u32 m0, s48, 4096
    s_nop 0
    buffer_load_dwordx4 v82, s[24:27], s46 offen  lds
    s_add_u32 s46, s79, 0x640000
    s_add_u32 m0, s48, 8192
    s_nop 0
    buffer_load_dwordx4 v82, s[24:27], s46 offen  lds
    s_add_u32 s46, s79, 0x660000
    s_add_u32 m0, s48, 12288
    s_nop 0
    buffer_load_dwordx4 v82, s[24:27], s46 offen  lds
    s_cmp_lg_u32 s44, 0
    s_cbranch_scc1 L_lw_15_0
    ds_read_b64_tr_b16 a[240:241], v80 offset:16384
    ds_read_b64_tr_b16 a[242:243], v80 offset:17408
    ds_read_b64_tr_b16 a[244:245], v80 offset:24576
    ds_read_b64_tr_b16 a[246:247], v80 offset:25600
    ds_read_b64_tr_b16 v[56:57], v81 offset:16384
    ds_read_b64_tr_b16 v[58:59], v81 offset:17408
    ds_read_b64_tr_b16 v[60:61], v81 offset:24576
    ds_read_b64_tr_b16 v[62:63], v81 offset:25600
    s_waitcnt lgkmcnt(0)
    ds_write_b128 v5, v[56:59] offset:10240
    ds_write_b128 v5, v[60:63] offset:11264
    s_branch L_lw_15
L_lw_15_0:
    s_cmp_lg_u32 s44, 1
    s_cbranch_scc1 L_lw_15_1
    ds_read_b64_tr_b16 a[144:145], v80 offset:16384
    ds_read_b64_tr_b16 a[146:147], v80 offset:17408
    ds_read_b64_tr_b16 a[148:149], v80 offset:24576
    ds_read_b64_tr_b16 a[150:151], v80 offset:25600
    ds_read_b64_tr_b16 v[56:57], v81 offset:16384
    ds_read_b64_tr_b16 v[58:59], v81 offset:17408
    ds_read_b64_tr_b16 v[60:61], v81 offset:24576
    ds_read_b64_tr_b16 v[62:63], v81 offset:25600
    s_waitcnt lgkmcnt(0)
    ds_write_b128 v5, v[56:59] offset:12288
    ds_write_b128 v5, v[60:63] offset:13312
    s_branch L_lw_15
L_lw_15_1:
    s_cmp_lg_u32 s44, 2
    s_cbranch_scc1 L_lw_15_2
    ds_read_b64_tr_b16 a[64:65], v80 offset:16384
    ds_read_b64_tr_b16 a[66:67], v80 offset:17408
    ds_read_b64_tr_b16 a[68:69], v80 offset:24576
    ds_read_b64_tr_b16 a[70:71], v80 offset:25600
    ds_read_b64_tr_b16 v[56:57], v81 offset:16384
    ds_read_b64_tr_b16 v[58:59], v81 offset:17408
    ds_read_b64_tr_b16 v[60:61], v81 offset:24576
    ds_read_b64_tr_b16 v[62:63], v81 offset:25600
    s_waitcnt lgkmcnt(0)
    ds_write_b128 v5, v[56:59] offset:8192
    ds_write_b128 v5, v[60:63] offset:9216
    s_branch L_lw_15
L_lw_15_2:
    ds_read_b64_tr_b16 v[192:193], v80 offset:16384
    ds_read_b64_tr_b16 v[194:195], v80 offset:17408
    ds_read_b64_tr_b16 v[196:197], v80 offset:24576
    ds_read_b64_tr_b16 v[198:199], v80 offset:25600
    ds_read_b64_tr_b16 v[200:201], v81 offset:16384
    ds_read_b64_tr_b16 v[202:203], v81 offset:17408
    ds_read_b64_tr_b16 v[204:205], v81 offset:24576
    ds_read_b64_tr_b16 v[206:207], v81 offset:25600
L_lw_15:
    s_waitcnt lgkmcnt(0)
    s_waitcnt vmcnt(12)
    s_barrier
    s_add_u32 s79, s41, 15
    s_and_b32 s79, s79, 3
    s_lshl_b32 s79, s79, 19
    s_add_u32 s79, s79, s47
    s_add_u32 s46, s79, 0x600000
    s_add_u32 m0, s48, 16384
    s_nop 0
    buffer_load_dwordx4 v82, s[24:27], s46 offen  lds
    s_add_u32 s46, s79, 0x620000
    s_add_u32 m0, s48, 20480
    s_nop 0
    buffer_load_dwordx4 v82, s[24:27], s46 offen  lds
    s_add_u32 s46, s79, 0x640000
    s_add_u32 m0, s48, 24576
    s_nop 0
    buffer_load_dwordx4 v82, s[24:27], s46 offen  lds
    s_add_u32 s46, s79, 0x660000
    s_add_u32 m0, s48, 28672
    s_nop 0
    buffer_load_dwordx4 v82, s[24:27], s46 offen  lds
    s_cmp_lg_u32 s44, 0
    s_cbranch_scc1 L_lw_16_0
    ds_read_b64_tr_b16 v[104:105], v80 offset:32768
    ds_read_b64_tr_b16 v[106:107], v80 offset:33792
    ds_read_b64_tr_b16 v[108:109], v80 offset:40960
    ds_read_b64_tr_b16 v[110:111], v80 offset:41984
    ds_read_b64_tr_b16 v[56:57], v81 offset:32768
    ds_read_b64_tr_b16 v[58:59], v81 offset:33792
    ds_read_b64_tr_b16 v[60:61], v81 offset:40960
    ds_read_b64_tr_b16 v[62:63], v81 offset:41984
    s_waitcnt lgkmcnt(0)
    ds_write_b128 v5, v[56:59] offset:16384
    ds_write_b128 v5, v[60:63] offset:17408
    s_branch L_lw_16
L_lw_16_0:
    s_cmp_lg_u32 s44, 1
    s_cbranch_scc1 L_lw_16_1
    ds_read_b64_tr_b16 a[168:169], v80 offset:32768
    ds_read_b64_tr_b16 a[170:171], v80 offset:33792
    ds_read_b64_tr_b16 a[172:173], v80 offset:40960
    ds_read_b64_tr_b16 a[174:175], v80 offset:41984
    ds_read_b64_tr_b16 v[56:57], v81 offset:32768
    ds_read_b64_tr_b16 v[58:59], v81 offset:33792
    ds_read_b64_tr_b16 v[60:61], v81 offset:40960
    ds_read_b64_tr_b16 v[62:63], v81 offset:41984
    s_waitcnt lgkmcnt(0)
    ds_write_b128 v5, v[56:59] offset:18432
    ds_write_b128 v5, v[60:63] offset:19456
    s_branch L_lw_16
L_lw_16_1:
    s_cmp_lg_u32 s44, 2
    s_cbranch_scc1 L_lw_16_2
    ds_read_b64_tr_b16 a[80:81], v80 offset:32768
    ds_read_b64_tr_b16 a[82:83], v80 offset:33792
    ds_read_b64_tr_b16 a[84:85], v80 offset:40960
    ds_read_b64_tr_b16 a[86:87], v80 offset:41984
    ds_read_b64_tr_b16 v[56:57], v81 offset:32768
    ds_read_b64_tr_b16 v[58:59], v81 offset:33792
    ds_read_b64_tr_b16 v[60:61], v81 offset:40960
    ds_read_b64_tr_b16 v[62:63], v81 offset:41984
    s_waitcnt lgkmcnt(0)
    ds_write_b128 v5, v[56:59] offset:14336
    ds_write_b128 v5, v[60:63] offset:15360
    s_branch L_lw_16
L_lw_16_2:
    ds_read_b64_tr_b16 v[224:225], v80 offset:32768
    ds_read_b64_tr_b16 v[226:227], v80 offset:33792
    ds_read_b64_tr_b16 v[228:229], v80 offset:40960
    ds_read_b64_tr_b16 v[230:231], v80 offset:41984
    ds_read_b64_tr_b16 v[232:233], v81 offset:32768
    ds_read_b64_tr_b16 v[234:235], v81 offset:33792
    ds_read_b64_tr_b16 v[236:237], v81 offset:40960
    ds_read_b64_tr_b16 v[238:239], v81 offset:41984
L_lw_16:
    s_waitcnt lgkmcnt(0)
    s_waitcnt vmcnt(12)
    s_barrier
    s_add_u32 s79, s41, 0
    s_and_b32 s79, s79, 3
    s_lshl_b32 s79, s79, 19
    s_add_u32 s79, s79, s47
    s_add_u32 s46, s79, 0x0
    s_add_u32 m0, s48, 32768
    s_nop 0
    buffer_load_dwordx4 v82, s[28:31], s46 offen  lds
    s_add_u32 s46, s79, 0x20000
    s_add_u32 m0, s48, 36864
    s_nop 0
    buffer_load_dwordx4 v82, s[28:31], s46 offen  lds
    s_add_u32 s46, s79, 0x40000
    s_add_u32 m0, s48, 40960
    s_nop 0
    buffer_load_dwordx4 v82, s[28:31], s46 offen  lds
    s_add_u32 s46, s79, 0x60000
    s_add_u32 m0, s48, 45056
    s_nop 0
    buffer_load_dwordx4 v82, s[28:31], s46 offen  lds
    s_cmp_lg_u32 s44, 0
    s_cbranch_scc1 L_lw_17_0
    ds_read_b64_tr_b16 v[128:129], v80 offset:49152
    ds_read_b64_tr_b16 v[130:131], v80 offset:50176
    ds_read_b64_tr_b16 v[132:133], v80 offset:57344
    ds_read_b64_tr_b16 v[134:135], v80 offset:58368
    ds_read_b64_tr_b16 v[136:137], v81 offset:49152
    ds_read_b64_tr_b16 v[138:139], v81 offset:50176
    ds_read_b64_tr_b16 v[140:141], v81 offset:57344
    ds_read_b64_tr_b16 v[142:143], v81 offset:58368
    s_branch L_lw_17
L_lw_17_0:
    s_cmp_lg_u32 s44, 1
    s_cbranch_scc1 L_lw_17_1
    ds_read_b64_tr_b16 a[192:193], v80 offset:49152
    ds_read_b64_tr_b16 a[194:195], v80 offset:50176
    ds_read_b64_tr_b16 a[196:197], v80 offset:57344
    ds_read_b64_tr_b16 a[198:199], v80 offset:58368
    ds_read_b64_tr_b16 v[56:57], v81 offset:49152
    ds_read_b64_tr_b16 v[58:59], v81 offset:50176
    ds_read_b64_tr_b16 v[60:61], v81 offset:57344
    ds_read_b64_tr_b16 v[62:63], v81 offset:58368
    s_waitcnt lgkmcnt(0)
    ds_write_b128 v5, v[56:59] offset:0
    ds_write_b128 v5, v[60:63] offset:1024
    s_branch L_lw_17
L_lw_17_1:
    s_cmp_lg_u32 s44, 2
    s_cbranch_scc1 L_lw_17_2
    ds_read_b64_tr_b16 a[96:97], v80 offset:49152
    ds_read_b64_tr_b16 a[98:99], v80 offset:50176
    ds_read_b64_tr_b16 a[100:101], v80 offset:57344
    ds_read_b64_tr_b16 a[102:103], v80 offset:58368
    ds_read_b64_tr_b16 v[56:57], v81 offset:49152
    ds_read_b64_tr_b16 v[58:59], v81 offset:50176
    ds_read_b64_tr_b16 v[60:61], v81 offset:57344
    ds_read_b64_tr_b16 v[62:63], v81 offset:58368
    s_waitcnt lgkmcnt(0)
    ds_write_b128 v5, v[56:59] offset:2048
    ds_write_b128 v5, v[60:63] offset:3072
    s_branch L_lw_17
L_lw_17_2:
    ds_read_b64_tr_b16 a[0:1], v80 offset:49152
    ds_read_b64_tr_b16 a[2:3], v80 offset:50176
    ds_read_b64_tr_b16 a[4:5], v80 offset:57344
    ds_read_b64_tr_b16 a[6:7], v80 offset:58368
    ds_read_b64_tr_b16 a[8:9], v81 offset:49152
    ds_read_b64_tr_b16 a[10:11], v81 offset:50176
    ds_read_b64_tr_b16 a[12:13], v81 offset:57344
    ds_read_b64_tr_b16 a[14:15], v81 offset:58368
L_lw_17:
    s_waitcnt lgkmcnt(0)
    s_waitcnt vmcnt(12)
    s_barrier
    s_add_u32 s79, s41, 1
    s_and_b32 s79, s79, 3
    s_lshl_b32 s79, s79, 19
    s_add_u32 s79, s79, s47
    s_add_u32 s46, s79, 0x0
    s_add_u32 m0, s48, 49152
    s_nop 0
    buffer_load_dwordx4 v82, s[28:31], s46 offen  lds
    s_add_u32 s46, s79, 0x20000
    s_add_u32 m0, s48, 53248
    s_nop 0
    buffer_load_dwordx4 v82, s[28:31], s46 offen  lds
    s_add_u32 s46, s79, 0x40000
    s_add_u32 m0, s48, 57344
    s_nop 0
    buffer_load_dwordx4 v82, s[28:31], s46 offen  lds
    s_add_u32 s46, s79, 0x60000
    s_add_u32 m0, s48, 61440
    s_nop 0
    buffer_load_dwordx4 v82, s[28:31], s46 offen  lds
    s_cmp_lg_u32 s44, 0
    s_cbranch_scc1 L_lw_18_0
    ds_read_b64_tr_b16 v[160:161], v84 offset:20480
    ds_read_b64_tr_b16 v[162:163], v84 offset:21504
    ds_read_b64_tr_b16 v[164:165], v86 offset:20480
    ds_read_b64_tr_b16 v[166:167], v86 offset:21504
    ds_read_b64_tr_b16 v[168:169], v85 offset:20480
    ds_read_b64_tr_b16 v[170:171], v85 offset:21504
    ds_read_b64_tr_b16 v[172:173], v87 offset:20480
    ds_read_b64_tr_b16 v[174:175], v87 offset:21504
    s_branch L_lw_18
L_lw_18_0:
    s_cmp_lg_u32 s44, 1
    s_cbranch_scc1 L_lw_18_1
    ds_read_b64_tr_b16 a[216:217], v84 offset:20480
    ds_read_b64_tr_b16 a[218:219], v84 offset:21504
    ds_read_b64_tr_b16 a[220:221], v86 offset:20480
    ds_read_b64_tr_b16 a[222:223], v86 offset:21504
    ds_read_b64_tr_b16 v[56:57], v85 offset:20480
    ds_read_b64_tr_b16 v[58:59], v85 offset:21504
    ds_read_b64_tr_b16 v[60:61], v87 offset:20480
    ds_read_b64_tr_b16 v[62:63], v87 offset:21504
    s_waitcnt lgkmcnt(0)
    ds_write_b128 v5, v[56:59] offset:4096
    ds_write_b128 v5, v[60:63] offset:5120
    s_branch L_lw_18
L_lw_18_1:
    s_cmp_lg_u32 s44, 2
    s_cbranch_scc1 L_lw_18_2
    ds_read_b64_tr_b16 a[120:121], v84 offset:20480
    ds_read_b64_tr_b16 a[122:123], v84 offset:21504
    ds_read_b64_tr_b16 a[124:125], v86 offset:20480
    ds_read_b64_tr_b16 a[126:127], v86 offset:21504
    ds_read_b64_tr_b16 v[56:57], v85 offset:20480
    ds_read_b64_tr_b16 v[58:59], v85 offset:21504
    ds_read_b64_tr_b16 v[60:61], v87 offset:20480
    ds_read_b64_tr_b16 v[62:63], v87 offset:21504
    s_waitcnt lgkmcnt(0)
    ds_write_b128 v5, v[56:59] offset:6144
    ds_write_b128 v5, v[60:63] offset:7168
    s_branch L_lw_18
L_lw_18_2:
    ds_read_b64_tr_b16 a[32:33], v84 offset:20480
    ds_read_b64_tr_b16 a[34:35], v84 offset:21504
    ds_read_b64_tr_b16 a[36:37], v86 offset:20480
    ds_read_b64_tr_b16 a[38:39], v86 offset:21504
    ds_read_b64_tr_b16 a[40:41], v85 offset:20480
    ds_read_b64_tr_b16 a[42:43], v85 offset:21504
    ds_read_b64_tr_b16 a[44:45], v87 offset:20480
    ds_read_b64_tr_b16 a[46:47], v87 offset:21504
L_lw_18:
    s_waitcnt lgkmcnt(0)
    s_waitcnt vmcnt(12)
    s_barrier
    s_cmp_lg_u32 s44, 0
    s_cbranch_scc1 L_lw_19_0
    ds_read_b64_tr_b16 v[192:193], v80 offset:0
    ds_read_b64_tr_b16 v[194:195], v80 offset:1024
    ds_read_b64_tr_b16 v[196:197], v80 offset:8192
    ds_read_b64_tr_b16 v[198:199], v80 offset:9216
    ds_read_b64_tr_b16 v[200:201], v81 offset:0
    ds_read_b64_tr_b16 v[202:203], v81 offset:1024
    ds_read_b64_tr_b16 v[204:205], v81 offset:8192
    ds_read_b64_tr_b16 v[206:207], v81 offset:9216
    s_branch L_lw_19
L_lw_19_0:
    s_cmp_lg_u32 s44, 1
    s_cbranch_scc1 L_lw_19_1
    ds_read_b64_tr_b16 a[240:241], v80 offset:0
    ds_read_b64_tr_b16 a[242:243], v80 offset:1024
    ds_read_b64_tr_b16 a[244:245], v80 offset:8192
    ds_read_b64_tr_b16 a[246:247], v80 offset:9216
    ds_read_b64_tr_b16 v[56:57], v81 offset:0
    ds_read_b64_tr_b16 v[58:59], v81 offset:1024
    ds_read_b64_tr_b16 v[60:61], v81 offset:8192
    ds_read_b64_tr_b16 v[62:63], v81 offset:9216
    s_waitcnt lgkmcnt(0)
    ds_write_b128 v5, v[56:59] offset:10240
    ds_write_b128 v5, v[60:63] offset:11264
    s_branch L_lw_19
L_lw_19_1:
    s_cmp_lg_u32 s44, 2
    s_cbranch_scc1 L_lw_19_2
    ds_read_b64_tr_b16 a[144:145], v80 offset:0
    ds_read_b64_tr_b16 a[146:147], v80 offset:1024
    ds_read_b64_tr_b16 a[148:149], v80 offset:8192
    ds_read_b64_tr_b16 a[150:151], v80 offset:9216
    ds_read_b64_tr_b16 v[56:57], v81 offset:0
    ds_read_b64_tr_b16 v[58:59], v81 offset:1024
    ds_read_b64_tr_b16 v[60:61], v81 offset:8192
    ds_read_b64_tr_b16 v[62:63], v81 offset:9216
    s_waitcnt lgkmcnt(0)
    ds_write_b128 v5, v[56:59] offset:12288
    ds_write_b128 v5, v[60:63] offset:13312
    s_branch L_lw_19
L_lw_19_2:
    ds_read_b64_tr_b16 a[64:65], v80 offset:0
    ds_read_b64_tr_b16 a[66:67], v80 offset:1024
    ds_read_b64_tr_b16 a[68:69], v80 offset:8192
    ds_read_b64_tr_b16 a[70:71], v80 offset:9216
    ds_read_b64_tr_b16 v[56:57], v81 offset:0
    ds_read_b64_tr_b16 v[58:59], v81 offset:1024
    ds_read_b64_tr_b16 v[60:61], v81 offset:8192
    ds_read_b64_tr_b16 v[62:63], v81 offset:9216
    s_waitcnt lgkmcnt(0)
    ds_write_b128 v5, v[56:59] offset:8192
    ds_write_b128 v5, v[60:63] offset:9216
L_lw_19:
    s_waitcnt lgkmcnt(0)
    s_waitcnt vmcnt(8)
    s_barrier
    s_add_u32 s79, s41, 2
    s_and_b32 s79, s79, 3
    s_lshl_b32 s79, s79, 19
    s_add_u32 s79, s79, s47
    s_add_u32 s46, s79, 0x0
    s_add_u32 m0, s48, 0
    s_nop 0
    buffer_load_dwordx4 v82, s[28:31], s46 offen  lds
    s_add_u32 s46, s79, 0x20000
    s_add_u32 m0, s48, 4096
    s_nop 0
    buffer_load_dwordx4 v82, s[28:31], s46 offen  lds
    s_add_u32 s46, s79, 0x40000
    s_add_u32 m0, s48, 8192
    s_nop 0
    buffer_load_dwordx4 v82, s[28:31], s46 offen  lds
    s_add_u32 s46, s79, 0x60000
    s_add_u32 m0, s48, 12288
    s_nop 0
    buffer_load_dwordx4 v82, s[28:31], s46 offen  lds
    s_cmp_lg_u32 s44, 0
    s_cbranch_scc1 L_lw_20_0
    ds_read_b64_tr_b16 v[224:225], v80 offset:16384
    ds_read_b64_tr_b16 v[226:227], v80 offset:17408
    ds_read_b64_tr_b16 v[228:229], v80 offset:24576
    ds_read_b64_tr_b16 v[230:231], v80 offset:25600
    ds_read_b64_tr_b16 v[232:233], v81 offset:16384
    ds_read_b64_tr_b16 v[234:235], v81 offset:17408
    ds_read_b64_tr_b16 v[236:237], v81 offset:24576
    ds_read_b64_tr_b16 v[238:239], v81 offset:25600
    s_branch L_lw_20
L_lw_20_0:
    s_cmp_lg_u32 s44, 1
    s_cbranch_scc1 L_lw_20_1
    ds_read_b64_tr_b16 v[104:105], v80 offset:16384
    ds_read_b64_tr_b16 v[106:107], v80 offset:17408
    ds_read_b64_tr_b16 v[108:109], v80 offset:24576
    ds_read_b64_tr_b16 v[110:111], v80 offset:25600
    ds_read_b64_tr_b16 v[56:57], v81 offset:16384
    ds_read_b64_tr_b16 v[58:59], v81 offset:17408
    ds_read_b64_tr_b16 v[60:61], v81 offset:24576
    ds_read_b64_tr_b16 v[62:63], v81 offset:25600
    s_waitcnt lgkmcnt(0)
    ds_write_b128 v5, v[56:59] offset:16384
    ds_write_b128 v5, v[60:63] offset:17408
    s_branch L_lw_20
L_lw_20_1:
    s_cmp_lg_u32 s44, 2
    s_cbranch_scc1 L_lw_20_2
    ds_read_b64_tr_b16 a[168:169], v80 offset:16384
    ds_read_b64_tr_b16 a[170:171], v80 offset:17408
    ds_read_b64_tr_b16 a[172:173], v80 offset:24576
    ds_read_b64_tr_b16 a[174:175], v80 offset:25600
    ds_read_b64_tr_b16 v[56:57], v81 offset:16384
    ds_read_b64_tr_b16 v[58:59], v81 offset:17408
    ds_read_b64_tr_b16 v[60:61], v81 offset:24576
    ds_read_b64_tr_b16 v[62:63], v81 offset:25600
    s_waitcnt lgkmcnt(0)
    ds_write_b128 v5, v[56:59] offset:18432
    ds_write_b128 v5, v[60:63] offset:19456
    s_branch L_lw_20
L_lw_20_2:
    ds_read_b64_tr_b16 a[80:81], v80 offset:16384
    ds_read_b64_tr_b16 a[82:83], v80 offset:17408
    ds_read_b64_tr_b16 a[84:85], v80 offset:24576
    ds_read_b64_tr_b16 a[86:87], v80 offset:25600
    ds_read_b64_tr_b16 v[56:57], v81 offset:16384
    ds_read_b64_tr_b16 v[58:59], v81 offset:17408
    ds_read_b64_tr_b16 v[60:61], v81 offset:24576
    ds_read_b64_tr_b16 v[62:63], v81 offset:25600
    s_waitcnt lgkmcnt(0)
    ds_write_b128 v5, v[56:59] offset:14336
    ds_write_b128 v5, v[60:63] offset:15360
L_lw_20:
    s_waitcnt lgkmcnt(0)
    s_waitcnt vmcnt(8)
    s_barrier
    s_add_u32 s79, s41, 3
    s_and_b32 s79, s79, 3
    s_lshl_b32 s79, s79, 19
    s_add_u32 s79, s79, s47
    s_add_u32 s46, s79, 0x0
    s_add_u32 m0, s48, 16384
    s_nop 0
    buffer_load_dwordx4 v82, s[28:31], s46 offen  lds
    s_add_u32 s46, s79, 0x20000
    s_add_u32 m0, s48, 20480
    s_nop 0
    buffer_load_dwordx4 v82, s[28:31], s46 offen  lds
    s_add_u32 s46, s79, 0x40000
    s_add_u32 m0, s48, 24576
    s_nop 0
    buffer_load_dwordx4 v82, s[28:31], s46 offen  lds
    s_add_u32 s46, s79, 0x60000
    s_add_u32 m0, s48, 28672
    s_nop 0
    buffer_load_dwordx4 v82, s[28:31], s46 offen  lds
    s_cmp_lg_u32 s44, 0
    s_cbranch_scc1 L_lw_21_0
    ds_read_b64_tr_b16 a[16:17], v80 offset:32768
    ds_read_b64_tr_b16 a[18:19], v80 offset:33792
    ds_read_b64_tr_b16 a[20:21], v80 offset:40960
    ds_read_b64_tr_b16 a[22:23], v80 offset:41984
    ds_read_b64_tr_b16 a[24:25], v81 offset:32768
    ds_read_b64_tr_b16 a[26:27], v81 offset:33792
    ds_read_b64_tr_b16 a[28:29], v81 offset:40960
    ds_read_b64_tr_b16 a[30:31], v81 offset:41984
    s_branch L_lw_21
L_lw_21_0:
    s_cmp_lg_u32 s44, 1
    s_cbranch_scc1 L_lw_21_1
    ds_read_b64_tr_b16 v[144:145], v80 offset:32768
    ds_read_b64_tr_b16 v[146:147], v80 offset:33792
    ds_read_b64_tr_b16 v[148:149], v80 offset:40960
    ds_read_b64_tr_b16 v[150:151], v80 offset:41984
    ds_read_b64_tr_b16 v[152:153], v81 offset:32768
    ds_read_b64_tr_b16 v[154:155], v81 offset:33792
    ds_read_b64_tr_b16 v[156:157], v81 offset:40960
    ds_read_b64_tr_b16 v[158:159], v81 offset:41984
    s_branch L_lw_21
L_lw_21_1:
    s_cmp_lg_u32 s44, 2
    s_cbranch_scc1 L_lw_21_2
    ds_read_b64_tr_b16 a[200:201], v80 offset:32768
    ds_read_b64_tr_b16 a[202:203], v80 offset:33792
    ds_read_b64_tr_b16 a[204:205], v80 offset:40960
    ds_read_b64_tr_b16 a[206:207], v80 offset:41984
    ds_read_b64_tr_b16 a[208:209], v81 offset:32768
    ds_read_b64_tr_b16 a[210:211], v81 offset:33792
    ds_read_b64_tr_b16 a[212:213], v81 offset:40960
    ds_read_b64_tr_b16 a[214:215], v81 offset:41984
    s_branch L_lw_21
L_lw_21_2:
    ds_read_b64_tr_b16 a[104:105], v80 offset:32768
    ds_read_b64_tr_b16 a[106:107], v80 offset:33792
    ds_read_b64_tr_b16 a[108:109], v80 offset:40960
    ds_read_b64_tr_b16 a[110:111], v80 offset:41984
    ds_read_b64_tr_b16 a[112:113], v81 offset:32768
    ds_read_b64_tr_b16 a[114:115], v81 offset:33792
    ds_read_b64_tr_b16 a[116:117], v81 offset:40960
    ds_read_b64_tr_b16 a[118:119], v81 offset:41984
L_lw_21:
    s_waitcnt lgkmcnt(0)
    s_waitcnt vmcnt(8)
    s_barrier
    s_add_u32 s79, s41, 4
    s_and_b32 s79, s79, 3
    s_lshl_b32 s79, s79, 19
    s_add_u32 s79, s79, s47
    s_add_u32 s46, s79, 0x200000
    s_add_u32 m0, s48, 32768
    s_nop 0
    buffer_load_dwordx4 v82, s[28:31], s46 offen  lds
    s_add_u32 s46, s79, 0x220000
    s_add_u32 m0, s48, 36864
    s_nop 0
    buffer_load_dwordx4 v82, s[28:31], s46 offen  lds
    s_add_u32 s46, s79, 0x240000
    s_add_u32 m0, s48, 40960
    s_nop 0
    buffer_load_dwordx4 v82, s[28:31], s46 offen  lds
    s_add_u32 s46, s79, 0x260000
    s_add_u32 m0, s48, 45056
    s_nop 0
    buffer_load_dwordx4 v82, s[28:31], s46 offen  lds
    s_cmp_lg_u32 s44, 0
    s_cbranch_scc1 L_lw_22_0
    ds_read_b64_tr_b16 a[48:49], v80 offset:49152
    ds_read_b64_tr_b16 a[50:51], v80 offset:50176
    ds_read_b64_tr_b16 a[52:53], v80 offset:57344
    ds_read_b64_tr_b16 a[54:55], v80 offset:58368
    ds_read_b64_tr_b16 a[56:57], v81 offset:49152
    ds_read_b64_tr_b16 a[58:59], v81 offset:50176
    ds_read_b64_tr_b16 a[60:61], v81 offset:57344
    ds_read_b64_tr_b16 a[62:63], v81 offset:58368
    s_branch L_lw_22
L_lw_22_0:
    s_cmp_lg_u32 s44, 1
    s_cbranch_scc1 L_lw_22_1
    ds_read_b64_tr_b16 v[176:177], v80 offset:49152
    ds_read_b64_tr_b16 v[178:179], v80 offset:50176
    ds_read_b64_tr_b16 v[180:181], v80 offset:57344
    ds_read_b64_tr_b16 v[182:183], v80 offset:58368
    ds_read_b64_tr_b16 v[184:185], v81 offset:49152
    ds_read_b64_tr_b16 v[186:187], v81 offset:50176
    ds_read_b64_tr_b16 v[188:189], v81 offset:57344
    ds_read_b64_tr_b16 v[190:191], v81 offset:58368
    s_branch L_lw_22
L_lw_22_1:
    s_cmp_lg_u32 s44, 2
    s_cbranch_scc1 L_lw_22_2
    ds_read_b64_tr_b16 a[224:225], v80 offset:49152
    ds_read_b64_tr_b16 a[226:227], v80 offset:50176
    ds_read_b64_tr_b16 a[228:229], v80 offset:57344
    ds_read_b64_tr_b16 a[230:231], v80 offset:58368
    ds_read_b64_tr_b16 a[232:233], v81 offset:49152
    ds_read_b64_tr_b16 a[234:235], v81 offset:50176
    ds_read_b64_tr_b16 a[236:237], v81 offset:57344
    ds_read_b64_tr_b16 a[238:239], v81 offset:58368
    s_branch L_lw_22
L_lw_22_2:
    ds_read_b64_tr_b16 a[128:129], v80 offset:49152
    ds_read_b64_tr_b16 a[130:131], v80 offset:50176
    ds_read_b64_tr_b16 a[132:133], v80 offset:57344
    ds_read_b64_tr_b16 a[134:135], v80 offset:58368
    ds_read_b64_tr_b16 a[136:137], v81 offset:49152
    ds_read_b64_tr_b16 a[138:139], v81 offset:50176
    ds_read_b64_tr_b16 a[140:141], v81 offset:57344
    ds_read_b64_tr_b16 a[142:143], v81 offset:58368
L_lw_22:
    s_waitcnt lgkmcnt(0)
    s_waitcnt vmcnt(8)
    s_barrier
    s_add_u32 s79, s41, 5
    s_and_b32 s79, s79, 3
    s_lshl_b32 s79, s79, 19
    s_add_u32 s79, s79, s47
    s_add_u32 s46, s79, 0x200000
    s_add_u32 m0, s48, 49152
    s_nop 0
    buffer_load_dwordx4 v82, s[28:31], s46 offen  lds
    s_add_u32 s46, s79, 0x220000
    s_add_u32 m0, s48, 53248
    s_nop 0
    buffer_load_dwordx4 v82, s[28:31], s46 offen  lds
    s_add_u32 s46, s79, 0x240000
    s_add_u32 m0, s48, 57344
    s_nop 0
    buffer_load_dwordx4 v82, s[28:31], s46 offen  lds
    s_add_u32 s46, s79, 0x260000
    s_add_u32 m0, s48, 61440
    s_nop 0
    buffer_load_dwordx4 v82, s[28:31], s46 offen  lds
    s_cmp_lg_u32 s44, 0
    s_cbranch_scc1 L_lw_23_0
    ds_read_b64_tr_b16 a[72:73], v80 offset:0
    ds_read_b64_tr_b16 a[74:75], v80 offset:1024
    ds_read_b64_tr_b16 a[76:77], v80 offset:8192
    ds_read_b64_tr_b16 a[78:79], v80 offset:9216
    ds_read_b64_tr_b16 v[56:57], v81 offset:0
    ds_read_b64_tr_b16 v[58:59], v81 offset:1024
    ds_read_b64_tr_b16 v[60:61], v81 offset:8192
    ds_read_b64_tr_b16 v[62:63], v81 offset:9216
    s_waitcnt lgkmcnt(0)
    ds_write_b128 v5, v[56:59] offset:20480
    ds_write_b128 v5, v[60:63] offset:21504
    s_branch L_lw_23
L_lw_23_0:
    s_cmp_lg_u32 s44, 1
    s_cbranch_scc1 L_lw_23_1
    ds_read_b64_tr_b16 v[208:209], v80 offset:0
    ds_read_b64_tr_b16 v[210:211], v80 offset:1024
    ds_read_b64_tr_b16 v[212:213], v80 offset:8192
    ds_read_b64_tr_b16 v[214:215], v80 offset:9216
    ds_read_b64_tr_b16 v[216:217], v81 offset:0
    ds_read_b64_tr_b16 v[218:219], v81 offset:1024
    ds_read_b64_tr_b16 v[220:221], v81 offset:8192
    ds_read_b64_tr_b16 v[222:223], v81 offset:9216
    s_branch L_lw_23
L_lw_23_1:
    s_cmp_lg_u32 s44, 2
    s_cbranch_scc1 L_lw_23_2
    ds_read_b64_tr_b16 a[248:249], v80 offset:0
    ds_read_b64_tr_b16 a[250:251], v80 offset:1024
    ds_read_b64_tr_b16 a[252:253], v80 offset:8192
    ds_read_b64_tr_b16 a[254:255], v80 offset:9216
    ds_read_b64_tr_b16 v[96:97], v81 offset:0
    ds_read_b64_tr_b16 v[98:99], v81 offset:1024
    ds_read_b64_tr_b16 v[100:101], v81 offset:8192
    ds_read_b64_tr_b16 v[102:103], v81 offset:9216
    s_branch L_lw_23
L_lw_23_2:
    ds_read_b64_tr_b16 a[152:153], v80 offset:0
    ds_read_b64_tr_b16 a[154:155], v80 offset:1024
    ds_read_b64_tr_b16 a[156:157], v80 offset:8192
    ds_read_b64_tr_b16 a[158:159], v80 offset:9216
    ds_read_b64_tr_b16 a[160:161], v81 offset:0
    ds_read_b64_tr_b16 a[162:163], v81 offset:1024
    ds_read_b64_tr_b16 a[164:165], v81 offset:8192
    ds_read_b64_tr_b16 a[166:167], v81 offset:9216
L_lw_23:
    s_waitcnt lgkmcnt(0)
    s_waitcnt vmcnt(8)
    s_barrier
    s_add_u32 s79, s41, 6
    s_and_b32 s79, s79, 3
    s_lshl_b32 s79, s79, 19
    s_add_u32 s79, s79, s47
    s_add_u32 s46, s79, 0x200000
    s_add_u32 m0, s48, 0
    s_nop 0
    buffer_load_dwordx4 v82, s[28:31], s46 offen  lds
    s_add_u32 s46, s79, 0x220000
    s_add_u32 m0, s48, 4096
    s_nop 0
    buffer_load_dwordx4 v82, s[28:31], s46 offen  lds
    s_add_u32 s46, s79, 0x240000
    s_add_u32 m0, s48, 8192
    s_nop 0
    buffer_load_dwordx4 v82, s[28:31], s46 offen  lds
    s_add_u32 s46, s79, 0x260000
    s_add_u32 m0, s48, 12288
    s_nop 0
    buffer_load_dwordx4 v82, s[28:31], s46 offen  lds
    s_cmp_lg_u32 s44, 0
    s_cbranch_scc1 L_lw_24_0
    ds_read_b64_tr_b16 a[88:89], v80 offset:16384
    ds_read_b64_tr_b16 a[90:91], v80 offset:17408
    ds_read_b64_tr_b16 a[92:93], v80 offset:24576
    ds_read_b64_tr_b16 a[94:95], v80 offset:25600
    ds_read_b64_tr_b16 v[56:57], v81 offset:16384
    ds_read_b64_tr_b16 v[58:59], v81 offset:17408
    ds_read_b64_tr_b16 v[60:61], v81 offset:24576
    ds_read_b64_tr_b16 v[62:63], v81 offset:25600
    s_waitcnt lgkmcnt(0)
    ds_write_b128 v5, v[56:59] offset:22528
    ds_write_b128 v5, v[60:63] offset:23552
    s_branch L_lw_24
L_lw_24_0:
    s_cmp_lg_u32 s44, 1
    s_cbranch_scc1 L_lw_24_1
    ds_read_b64_tr_b16 v[240:241], v80 offset:16384
    ds_read_b64_tr_b16 v[242:243], v80 offset:17408
    ds_read_b64_tr_b16 v[244:245], v80 offset:24576
    ds_read_b64_tr_b16 v[246:247], v80 offset:25600
    ds_read_b64_tr_b16 v[248:249], v81 offset:16384
    ds_read_b64_tr_b16 v[250:251], v81 offset:17408
    ds_read_b64_tr_b16 v[252:253], v81 offset:24576
    ds_read_b64_tr_b16 v[254:255], v81 offset:25600
    s_branch L_lw_24
L_lw_24_1:
    s_cmp_lg_u32 s44, 2
    s_cbranch_scc1 L_lw_24_2
    ds_read_b64_tr_b16 v[112:113], v80 offset:16384
    ds_read_b64_tr_b16 v[114:115], v80 offset:17408
    ds_read_b64_tr_b16 v[116:117], v80 offset:24576
    ds_read_b64_tr_b16 v[118:119], v80 offset:25600
    ds_read_b64_tr_b16 v[120:121], v81 offset:16384
    ds_read_b64_tr_b16 v[122:123], v81 offset:17408
    ds_read_b64_tr_b16 v[124:125], v81 offset:24576
    ds_read_b64_tr_b16 v[126:127], v81 offset:25600
    s_branch L_lw_24
L_lw_24_2:
    ds_read_b64_tr_b16 a[176:177], v80 offset:16384
    ds_read_b64_tr_b16 a[178:179], v80 offset:17408
    ds_read_b64_tr_b16 a[180:181], v80 offset:24576
    ds_read_b64_tr_b16 a[182:183], v80 offset:25600
    ds_read_b64_tr_b16 a[184:185], v81 offset:16384
    ds_read_b64_tr_b16 a[186:187], v81 offset:17408
    ds_read_b64_tr_b16 a[188:189], v81 offset:24576
    ds_read_b64_tr_b16 a[190:191], v81 offset:25600
L_lw_24:
    s_waitcnt lgkmcnt(0)
    s_waitcnt vmcnt(8)
    s_barrier
    s_add_u32 s79, s41, 7
    s_and_b32 s79, s79, 3
    s_lshl_b32 s79, s79, 19
    s_add_u32 s79, s79, s47
    s_add_u32 s46, s79, 0x200000
    s_add_u32 m0, s48, 16384
    s_nop 0
    buffer_load_dwordx4 v82, s[28:31], s46 offen  lds
    s_add_u32 s46, s79, 0x220000
    s_add_u32 m0, s48, 20480
    s_nop 0
    buffer_load_dwordx4 v82, s[28:31], s46 offen  lds
    s_add_u32 s46, s79, 0x240000
    s_add_u32 m0, s48, 24576
    s_nop 0
    buffer_load_dwordx4 v82, s[28:31], s46 offen  lds
    s_add_u32 s46, s79, 0x260000
    s_add_u32 m0, s48, 28672
    s_nop 0
    buffer_load_dwordx4 v82, s[28:31], s46 offen  lds
    s_cmp_lg_u32 s44, 0
    s_cbranch_scc1 L_lw_25_0
    ds_read_b64_tr_b16 a[104:105], v80 offset:32768
    ds_read_b64_tr_b16 a[106:107], v80 offset:33792
    ds_read_b64_tr_b16 a[108:109], v80 offset:40960
    ds_read_b64_tr_b16 a[110:111], v80 offset:41984
    ds_read_b64_tr_b16 a[112:113], v81 offset:32768
    ds_read_b64_tr_b16 a[114:115], v81 offset:33792
    ds_read_b64_tr_b16 a[116:117], v81 offset:40960
    ds_read_b64_tr_b16 a[118:119], v81 offset:41984
    s_branch L_lw_25
L_lw_25_0:
    s_cmp_lg_u32 s44, 1
    s_cbranch_scc1 L_lw_25_1
    ds_read_b64_tr_b16 a[16:17], v80 offset:32768
    ds_read_b64_tr_b16 a[18:19], v80 offset:33792
    ds_read_b64_tr_b16 a[20:21], v80 offset:40960
    ds_read_b64_tr_b16 a[22:23], v80 offset:41984
    ds_read_b64_tr_b16 a[24:25], v81 offset:32768
    ds_read_b64_tr_b16 a[26:27], v81 offset:33792
    ds_read_b64_tr_b16 a[28:29], v81 offset:40960
    ds_read_b64_tr_b16 a[30:31], v81 offset:41984
    s_branch L_lw_25
L_lw_25_1:
    s_cmp_lg_u32 s44, 2
    s_cbranch_scc1 L_lw_25_2
    ds_read_b64_tr_b16 v[144:145], v80 offset:32768
    ds_read_b64_tr_b16 v[146:147], v80 offset:33792
    ds_read_b64_tr_b16 v[148:149], v80 offset:40960
    ds_read_b64_tr_b16 v[150:151], v80 offset:41984
    ds_read_b64_tr_b16 v[152:153], v81 offset:32768
    ds_read_b64_tr_b16 v[154:155], v81 offset:33792
    ds_read_b64_tr_b16 v[156:157], v81 offset:40960
    ds_read_b64_tr_b16 v[158:159], v81 offset:41984
    s_branch L_lw_25
L_lw_25_2:
    ds_read_b64_tr_b16 a[200:201], v80 offset:32768
    ds_read_b64_tr_b16 a[202:203], v80 offset:33792
    ds_read_b64_tr_b16 a[204:205], v80 offset:40960
    ds_read_b64_tr_b16 a[206:207], v80 offset:41984
    ds_read_b64_tr_b16 a[208:209], v81 offset:32768
    ds_read_b64_tr_b16 a[210:211], v81 offset:33792
    ds_read_b64_tr_b16 a[212:213], v81 offset:40960
    ds_read_b64_tr_b16 a[214:215], v81 offset:41984
L_lw_25:
    s_waitcnt lgkmcnt(0)
    s_waitcnt vmcnt(8)
    s_barrier
    s_add_u32 s79, s41, 8
    s_and_b32 s79, s79, 3
    s_lshl_b32 s79, s79, 19
    s_add_u32 s79, s79, s47
    s_add_u32 s46, s79, 0x400000
    s_add_u32 m0, s48, 32768
    s_nop 0
    buffer_load_dwordx4 v82, s[28:31], s46 offen  lds
    s_add_u32 s46, s79, 0x420000
    s_add_u32 m0, s48, 36864
    s_nop 0
    buffer_load_dwordx4 v82, s[28:31], s46 offen  lds
    s_add_u32 s46, s79, 0x440000
    s_add_u32 m0, s48, 40960
    s_nop 0
    buffer_load_dwordx4 v82, s[28:31], s46 offen  lds
    s_add_u32 s46, s79, 0x460000
    s_add_u32 m0, s48, 45056
    s_nop 0
    buffer_load_dwordx4 v82, s[28:31], s46 offen  lds
    s_cmp_lg_u32 s44, 0
    s_cbranch_scc1 L_lw_26_0
    ds_read_b64_tr_b16 a[128:129], v80 offset:49152
    ds_read_b64_tr_b16 a[130:131], v80 offset:50176
    ds_read_b64_tr_b16 a[132:133], v80 offset:57344
    ds_read_b64_tr_b16 a[134:135], v80 offset:58368
    ds_read_b64_tr_b16 a[136:137], v81 offset:49152
    ds_read_b64_tr_b16 a[138:139], v81 offset:50176
    ds_read_b64_tr_b16 a[140:141], v81 offset:57344
    ds_read_b64_tr_b16 a[142:143], v81 offset:58368
    s_branch L_lw_26
L_lw_26_0:
    s_cmp_lg_u32 s44, 1
    s_cbranch_scc1 L_lw_26_1
    ds_read_b64_tr_b16 a[48:49], v80 offset:49152
    ds_read_b64_tr_b16 a[50:51], v80 offset:50176
    ds_read_b64_tr_b16 a[52:53], v80 offset:57344
    ds_read_b64_tr_b16 a[54:55], v80 offset:58368
    ds_read_b64_tr_b16 a[56:57], v81 offset:49152
    ds_read_b64_tr_b16 a[58:59], v81 offset:50176
    ds_read_b64_tr_b16 a[60:61], v81 offset:57344
    ds_read_b64_tr_b16 a[62:63], v81 offset:58368
    s_branch L_lw_26
L_lw_26_1:
    s_cmp_lg_u32 s44, 2
    s_cbranch_scc1 L_lw_26_2
    ds_read_b64_tr_b16 v[176:177], v80 offset:49152
    ds_read_b64_tr_b16 v[178:179], v80 offset:50176
    ds_read_b64_tr_b16 v[180:181], v80 offset:57344
    ds_read_b64_tr_b16 v[182:183], v80 offset:58368
    ds_read_b64_tr_b16 v[184:185], v81 offset:49152
    ds_read_b64_tr_b16 v[186:187], v81 offset:50176
    ds_read_b64_tr_b16 v[188:189], v81 offset:57344
    ds_read_b64_tr_b16 v[190:191], v81 offset:58368
    s_branch L_lw_26
L_lw_26_2:
    ds_read_b64_tr_b16 a[224:225], v80 offset:49152
    ds_read_b64_tr_b16 a[226:227], v80 offset:50176
    ds_read_b64_tr_b16 a[228:229], v80 offset:57344
    ds_read_b64_tr_b16 a[230:231], v80 offset:58368
    ds_read_b64_tr_b16 a[232:233], v81 offset:49152
    ds_read_b64_tr_b16 a[234:235], v81 offset:50176
    ds_read_b64_tr_b16 a[236:237], v81 offset:57344
    ds_read_b64_tr_b16 a[238:239], v81 offset:58368
L_lw_26:
    s_waitcnt lgkmcnt(0)
    s_waitcnt vmcnt(8)
    s_barrier
    s_add_u32 s79, s41, 9
    s_and_b32 s79, s79, 3
    s_lshl_b32 s79, s79, 19
    s_add_u32 s79, s79, s47
    s_add_u32 s46, s79, 0x400000
    s_add_u32 m0, s48, 49152
    s_nop 0
    buffer_load_dwordx4 v82, s[28:31], s46 offen  lds
    s_add_u32 s46, s79, 0x420000
    s_add_u32 m0, s48, 53248
    s_nop 0
    buffer_load_dwordx4 v82, s[28:31], s46 offen  lds
    s_add_u32 s46, s79, 0x440000
    s_add_u32 m0, s48, 57344
    s_nop 0
    buffer_load_dwordx4 v82, s[28:31], s46 offen  lds
    s_add_u32 s46, s79, 0x460000
    s_add_u32 m0, s48, 61440
    s_nop 0
    buffer_load_dwordx4 v82, s[28:31], s46 offen  lds
    s_cmp_lg_u32 s44, 0
    s_cbranch_scc1 L_lw_27_0
    ds_read_b64_tr_b16 a[152:153], v80 offset:0
    ds_read_b64_tr_b16 a[154:155], v80 offset:1024
    ds_read_b64_tr_b16 a[156:157], v80 offset:8192
    ds_read_b64_tr_b16 a[158:159], v80 offset:9216
    ds_read_b64_tr_b16 a[160:161], v81 offset:0
    ds_read_b64_tr_b16 a[162:163], v81 offset:1024
    ds_read_b64_tr_b16 a[164:165], v81 offset:8192
    ds_read_b64_tr_b16 a[166:167], v81 offset:9216
    s_branch L_lw_27
L_lw_27_0:
    s_cmp_lg_u32 s44, 1
    s_cbranch_scc1 L_lw_27_1
    ds_read_b64_tr_b16 a[72:73], v80 offset:0
    ds_read_b64_tr_b16 a[74:75], v80 offset:1024
    ds_read_b64_tr_b16 a[76:77], v80 offset:8192
    ds_read_b64_tr_b16 a[78:79], v80 offset:9216
    ds_read_b64_tr_b16 v[56:57], v81 offset:0
    ds_read_b64_tr_b16 v[58:59], v81 offset:1024
    ds_read_b64_tr_b16 v[60:61], v81 offset:8192
    ds_read_b64_tr_b16 v[62:63], v81 offset:9216
    s_waitcnt lgkmcnt(0)
    ds_write_b128 v5, v[56:59] offset:20480
    ds_write_b128 v5, v[60:63] offset:21504
    s_branch L_lw_27
L_lw_27_1:
    s_cmp_lg_u32 s44, 2
    s_cbranch_scc1 L_lw_27_2
    ds_read_b64_tr_b16 v[208:209], v80 offset:0
    ds_read_b64_tr_b16 v[210:211], v80 offset:1024
    ds_read_b64_tr_b16 v[212:213], v80 offset:8192
    ds_read_b64_tr_b16 v[214:215], v80 offset:9216
    ds_read_b64_tr_b16 v[216:217], v81 offset:0
    ds_read_b64_tr_b16 v[218:219], v81 offset:1024
    ds_read_b64_tr_b16 v[220:221], v81 offset:8192
    ds_read_b64_tr_b16 v[222:223], v81 offset:9216
    s_branch L_lw_27
L_lw_27_2:
    ds_read_b64_tr_b16 a[248:249], v80 offset:0
    ds_read_b64_tr_b16 a[250:251], v80 offset:1024
    ds_read_b64_tr_b16 a[252:253], v80 offset:8192
    ds_read_b64_tr_b16 a[254:255], v80 offset:9216
    ds_read_b64_tr_b16 v[96:97], v81 offset:0
    ds_read_b64_tr_b16 v[98:99], v81 offset:1024
    ds_read_b64_tr_b16 v[100:101], v81 offset:8192
    ds_read_b64_tr_b16 v[102:103], v81 offset:9216
L_lw_27:
    s_waitcnt lgkmcnt(0)
    s_waitcnt vmcnt(8)
    s_barrier
    s_add_u32 s79, s41, 10
    s_and_b32 s79, s79, 3
    s_lshl_b32 s79, s79, 19
    s_add_u32 s79, s79, s47
    s_add_u32 s46, s79, 0x400000
    s_add_u32 m0, s48, 0
    s_nop 0
    buffer_load_dwordx4 v82, s[28:31], s46 offen  lds
    s_add_u32 s46, s79, 0x420000
    s_add_u32 m0, s48, 4096
    s_nop 0
    buffer_load_dwordx4 v82, s[28:31], s46 offen  lds
    s_add_u32 s46, s79, 0x440000
    s_add_u32 m0, s48, 8192
    s_nop 0
    buffer_load_dwordx4 v82, s[28:31], s46 offen  lds
    s_add_u32 s46, s79, 0x460000
    s_add_u32 m0, s48, 12288
    s_nop 0
    buffer_load_dwordx4 v82, s[28:31], s46 offen  lds
    s_cmp_lg_u32 s44, 0
    s_cbranch_scc1 L_lw_28_0
    ds_read_b64_tr_b16 a[176:177], v80 offset:16384
    ds_read_b64_tr_b16 a[178:179], v80 offset:17408
    ds_read_b64_tr_b16 a[180:181], v80 offset:24576
    ds_read_b64_tr_b16 a[182:183], v80 offset:25600
    ds_read_b64_tr_b16 a[184:185], v81 offset:16384
    ds_read_b64_tr_b16 a[186:187], v81 offset:17408
    ds_read_b64_tr_b16 a[188:189], v81 offset:24576
    ds_read_b64_tr_b16 a[190:191], v81 offset:25600
    s_branch L_lw_28
L_lw_28_0:
    s_cmp_lg_u32 s44, 1
    s_cbranch_scc1 L_lw_28_1
    ds_read_b64_tr_b16 a[88:89], v80 offset:16384
    ds_read_b64_tr_b16 a[90:91], v80 offset:17408
    ds_read_b64_tr_b16 a[92:93], v80 offset:24576
    ds_read_b64_tr_b16 a[94:95], v80 offset:25600
    ds_read_b64_tr_b16 v[56:57], v81 offset:16384
    ds_read_b64_tr_b16 v[58:59], v81 offset:17408
    ds_read_b64_tr_b16 v[60:61], v81 offset:24576
    ds_read_b64_tr_b16 v[62:63], v81 offset:25600
    s_waitcnt lgkmcnt(0)
    ds_write_b128 v5, v[56:59] offset:22528
    ds_write_b128 v5, v[60:63] offset:23552
    s_branch L_lw_28
L_lw_28_1:
    s_cmp_lg_u32 s44, 2
    s_cbranch_scc1 L_lw_28_2
    ds_read_b64_tr_b16 v[240:241], v80 offset:16384
    ds_read_b64_tr_b16 v[242:243], v80 offset:17408
    ds_read_b64_tr_b16 v[244:245], v80 offset:24576
    ds_read_b64_tr_b16 v[246:247], v80 offset:25600
    ds_read_b64_tr_b16 v[248:249], v81 offset:16384
    ds_read_b64_tr_b16 v[250:251], v81 offset:17408
    ds_read_b64_tr_b16 v[252:253], v81 offset:24576
    ds_read_b64_tr_b16 v[254:255], v81 offset:25600
    s_branch L_lw_28
L_lw_28_2:
    ds_read_b64_tr_b16 v[112:113], v80 offset:16384
    ds_read_b64_tr_b16 v[114:115], v80 offset:17408
    ds_read_b64_tr_b16 v[116:117], v80 offset:24576
    ds_read_b64_tr_b16 v[118:119], v80 offset:25600
    ds_read_b64_tr_b16 v[120:121], v81 offset:16384
    ds_read_b64_tr_b16 v[122:123], v81 offset:17408
    ds_read_b64_tr_b16 v[124:125], v81 offset:24576
    ds_read_b64_tr_b16 v[126:127], v81 offset:25600
L_lw_28:
    s_waitcnt lgkmcnt(0)
    s_waitcnt vmcnt(8)
    s_barrier
    s_add_u32 s79, s41, 11
    s_and_b32 s79, s79, 3
    s_lshl_b32 s79, s79, 19
    s_add_u32 s79, s79, s47
    s_add_u32 s46, s79, 0x400000
    s_add_u32 m0, s48, 16384
    s_nop 0
    buffer_load_dwordx4 v82, s[28:31], s46 offen  lds
    s_add_u32 s46, s79, 0x420000
    s_add_u32 m0, s48, 20480
    s_nop 0
    buffer_load_dwordx4 v82, s[28:31], s46 offen  lds
    s_add_u32 s46, s79, 0x440000
    s_add_u32 m0, s48, 24576
    s_nop 0
    buffer_load_dwordx4 v82, s[28:31], s46 offen  lds
    s_add_u32 s46, s79, 0x460000
    s_add_u32 m0, s48, 28672
    s_nop 0
    buffer_load_dwordx4 v82, s[28:31], s46 offen  lds
    s_cmp_lg_u32 s44, 0
    s_cbranch_scc1 L_lw_29_0
    ds_read_b64_tr_b16 a[200:201], v80 offset:32768
    ds_read_b64_tr_b16 a[202:203], v80 offset:33792
    ds_read_b64_tr_b16 a[204:205], v80 offset:40960
    ds_read_b64_tr_b16 a[206:207], v80 offset:41984
    ds_read_b64_tr_b16 a[208:209], v81 offset:32768
    ds_read_b64_tr_b16 a[210:211], v81 offset:33792
    ds_read_b64_tr_b16 a[212:213], v81 offset:40960
    ds_read_b64_tr_b16 a[214:215], v81 offset:41984
    s_branch L_lw_29
L_lw_29_0:
    s_cmp_lg_u32 s44, 1
    s_cbranch_scc1 L_lw_29_1
    ds_read_b64_tr_b16 a[104:105], v80 offset:32768
    ds_read_b64_tr_b16 a[106:107], v80 offset:33792
    ds_read_b64_tr_b16 a[108:109], v80 offset:40960
    ds_read_b64_tr_b16 a[110:111], v80 offset:41984
    ds_read_b64_tr_b16 a[112:113], v81 offset:32768
    ds_read_b64_tr_b16 a[114:115], v81 offset:33792
    ds_read_b64_tr_b16 a[116:117], v81 offset:40960
    ds_read_b64_tr_b16 a[118:119], v81 offset:41984
    s_branch L_lw_29
L_lw_29_1:
    s_cmp_lg_u32 s44, 2
    s_cbranch_scc1 L_lw_29_2
    ds_read_b64_tr_b16 a[16:17], v80 offset:32768
    ds_read_b64_tr_b16 a[18:19], v80 offset:33792
    ds_read_b64_tr_b16 a[20:21], v80 offset:40960
    ds_read_b64_tr_b16 a[22:23], v80 offset:41984
    ds_read_b64_tr_b16 a[24:25], v81 offset:32768
    ds_read_b64_tr_b16 a[26:27], v81 offset:33792
    ds_read_b64_tr_b16 a[28:29], v81 offset:40960
    ds_read_b64_tr_b16 a[30:31], v81 offset:41984
    s_branch L_lw_29
L_lw_29_2:
    ds_read_b64_tr_b16 v[144:145], v80 offset:32768
    ds_read_b64_tr_b16 v[146:147], v80 offset:33792
    ds_read_b64_tr_b16 v[148:149], v80 offset:40960
    ds_read_b64_tr_b16 v[150:151], v80 offset:41984
    ds_read_b64_tr_b16 v[152:153], v81 offset:32768
    ds_read_b64_tr_b16 v[154:155], v81 offset:33792
    ds_read_b64_tr_b16 v[156:157], v81 offset:40960
    ds_read_b64_tr_b16 v[158:159], v81 offset:41984
L_lw_29:
    s_waitcnt lgkmcnt(0)
    s_waitcnt vmcnt(8)
    s_barrier
    s_add_u32 s79, s41, 12
    s_and_b32 s79, s79, 3
    s_lshl_b32 s79, s79, 19
    s_add_u32 s79, s79, s47
    s_add_u32 s46, s79, 0x600000
    s_add_u32 m0, s48, 32768
    s_nop 0
    buffer_load_dwordx4 v82, s[28:31], s46 offen  lds
    s_add_u32 s46, s79, 0x620000
    s_add_u32 m0, s48, 36864
    s_nop 0
    buffer_load_dwordx4 v82, s[28:31], s46 offen  lds
    s_add_u32 s46, s79, 0x640000
    s_add_u32 m0, s48, 40960
    s_nop 0
    buffer_load_dwordx4 v82, s[28:31], s46 offen  lds
    s_add_u32 s46, s79, 0x660000
    s_add_u32 m0, s48, 45056
    s_nop 0
    buffer_load_dwordx4 v82, s[28:31], s46 offen  lds
    s_cmp_lg_u32 s44, 0
    s_cbranch_scc1 L_lw_30_0
    ds_read_b64_tr_b16 a[224:225], v80 offset:49152
    ds_read_b64_tr_b16 a[226:227], v80 offset:50176
    ds_read_b64_tr_b16 a[228:229], v80 offset:57344
    ds_read_b64_tr_b16 a[230:231], v80 offset:58368
    ds_read_b64_tr_b16 a[232:233], v81 offset:49152
    ds_read_b64_tr_b16 a[234:235], v81 offset:50176
    ds_read_b64_tr_b16 a[236:237], v81 offset:57344
    ds_read_b64_tr_b16 a[238:239], v81 offset:58368
    s_branch L_lw_30
L_lw_30_0:
    s_cmp_lg_u32 s44, 1
    s_cbranch_scc1 L_lw_30_1
    ds_read_b64_tr_b16 a[128:129], v80 offset:49152
    ds_read_b64_tr_b16 a[130:131], v80 offset:50176
    ds_read_b64_tr_b16 a[132:133], v80 offset:57344
    ds_read_b64_tr_b16 a[134:135], v80 offset:58368
    ds_read_b64_tr_b16 a[136:137], v81 offset:49152
    ds_read_b64_tr_b16 a[138:139], v81 offset:50176
    ds_read_b64_tr_b16 a[140:141], v81 offset:57344
    ds_read_b64_tr_b16 a[142:143], v81 offset:58368
    s_branch L_lw_30
L_lw_30_1:
    s_cmp_lg_u32 s44, 2
    s_cbranch_scc1 L_lw_30_2
    ds_read_b64_tr_b16 a[48:49], v80 offset:49152
    ds_read_b64_tr_b16 a[50:51], v80 offset:50176
    ds_read_b64_tr_b16 a[52:53], v80 offset:57344
    ds_read_b64_tr_b16 a[54:55], v80 offset:58368
    ds_read_b64_tr_b16 a[56:57], v81 offset:49152
    ds_read_b64_tr_b16 a[58:59], v81 offset:50176
    ds_read_b64_tr_b16 a[60:61], v81 offset:57344
    ds_read_b64_tr_b16 a[62:63], v81 offset:58368
    s_branch L_lw_30
L_lw_30_2:
    ds_read_b64_tr_b16 v[176:177], v80 offset:49152
    ds_read_b64_tr_b16 v[178:179], v80 offset:50176
    ds_read_b64_tr_b16 v[180:181], v80 offset:57344
    ds_read_b64_tr_b16 v[182:183], v80 offset:58368
    ds_read_b64_tr_b16 v[184:185], v81 offset:49152
    ds_read_b64_tr_b16 v[186:187], v81 offset:50176
    ds_read_b64_tr_b16 v[188:189], v81 offset:57344
    ds_read_b64_tr_b16 v[190:191], v81 offset:58368
L_lw_30:
    s_waitcnt lgkmcnt(0)
    s_waitcnt vmcnt(8)
    s_barrier
    s_add_u32 s79, s41, 13
    s_and_b32 s79, s79, 3
    s_lshl_b32 s79, s79, 19
    s_add_u32 s79, s79, s47
    s_add_u32 s46, s79, 0x600000
    s_add_u32 m0, s48, 49152
    s_nop 0
    buffer_load_dwordx4 v82, s[28:31], s46 offen  lds
    s_add_u32 s46, s79, 0x620000
    s_add_u32 m0, s48, 53248
    s_nop 0
    buffer_load_dwordx4 v82, s[28:31], s46 offen  lds
    s_add_u32 s46, s79, 0x640000
    s_add_u32 m0, s48, 57344
    s_nop 0
    buffer_load_dwordx4 v82, s[28:31], s46 offen  lds
    s_add_u32 s46, s79, 0x660000
    s_add_u32 m0, s48, 61440
    s_nop 0
    buffer_load_dwordx4 v82, s[28:31], s46 offen  lds
    s_cmp_lg_u32 s44, 0
    s_cbranch_scc1 L_lw_31_0
    ds_read_b64_tr_b16 a[248:249], v80 offset:0
    ds_read_b64_tr_b16 a[250:251], v80 offset:1024
    ds_read_b64_tr_b16 a[252:253], v80 offset:8192
    ds_read_b64_tr_b16 a[254:255], v80 offset:9216
    ds_read_b64_tr_b16 v[96:97], v81 offset:0
    ds_read_b64_tr_b16 v[98:99], v81 offset:1024
    ds_read_b64_tr_b16 v[100:101], v81 offset:8192
    ds_read_b64_tr_b16 v[102:103], v81 offset:9216
    s_branch L_lw_31
L_lw_31_0:
    s_cmp_lg_u32 s44, 1
    s_cbranch_scc1 L_lw_31_1
    ds_read_b64_tr_b16 a[152:153], v80 offset:0
    ds_read_b64_tr_b16 a[154:155], v80 offset:1024
    ds_read_b64_tr_b16 a[156:157], v80 offset:8192
    ds_read_b64_tr_b16 a[158:159], v80 offset:9216
    ds_read_b64_tr_b16 a[160:161], v81 offset:0
    ds_read_b64_tr_b16 a[162:163], v81 offset:1024
    ds_read_b64_tr_b16 a[164:165], v81 offset:8192
    ds_read_b64_tr_b16 a[166:167], v81 offset:9216
    s_branch L_lw_31
L_lw_31_1:
    s_cmp_lg_u32 s44, 2
    s_cbranch_scc1 L_lw_31_2
    ds_read_b64_tr_b16 a[72:73], v80 offset:0
    ds_read_b64_tr_b16 a[74:75], v80 offset:1024
    ds_read_b64_tr_b16 a[76:77], v80 offset:8192
    ds_read_b64_tr_b16 a[78:79], v80 offset:9216
    ds_read_b64_tr_b16 v[56:57], v81 offset:0
    ds_read_b64_tr_b16 v[58:59], v81 offset:1024
    ds_read_b64_tr_b16 v[60:61], v81 offset:8192
    ds_read_b64_tr_b16 v[62:63], v81 offset:9216
    s_waitcnt lgkmcnt(0)
    ds_write_b128 v5, v[56:59] offset:20480
    ds_write_b128 v5, v[60:63] offset:21504
    s_branch L_lw_31
L_lw_31_2:
    ds_read_b64_tr_b16 v[208:209], v80 offset:0
    ds_read_b64_tr_b16 v[210:211], v80 offset:1024
    ds_read_b64_tr_b16 v[212:213], v80 offset:8192
    ds_read_b64_tr_b16 v[214:215], v80 offset:9216
    ds_read_b64_tr_b16 v[216:217], v81 offset:0
    ds_read_b64_tr_b16 v[218:219], v81 offset:1024
    ds_read_b64_tr_b16 v[220:221], v81 offset:8192
    ds_read_b64_tr_b16 v[222:223], v81 offset:9216
L_lw_31:
    s_waitcnt lgkmcnt(0)
    s_waitcnt vmcnt(8)
    s_barrier
    s_add_u32 s79, s41, 14
    s_and_b32 s79, s79, 3
    s_lshl_b32 s79, s79, 19
    s_add_u32 s79, s79, s47
    s_add_u32 s46, s79, 0x600000
    s_add_u32 m0, s48, 0
    s_nop 0
    buffer_load_dwordx4 v82, s[28:31], s46 offen  lds
    s_add_u32 s46, s79, 0x620000
    s_add_u32 m0, s48, 4096
    s_nop 0
    buffer_load_dwordx4 v82, s[28:31], s46 offen  lds
    s_add_u32 s46, s79, 0x640000
    s_add_u32 m0, s48, 8192
    s_nop 0
    buffer_load_dwordx4 v82, s[28:31], s46 offen  lds
    s_add_u32 s46, s79, 0x660000
    s_add_u32 m0, s48, 12288
    s_nop 0
    buffer_load_dwordx4 v82, s[28:31], s46 offen  lds
    s_cmp_lg_u32 s44, 0
    s_cbranch_scc1 L_lw_32_0
    ds_read_b64_tr_b16 v[112:113], v80 offset:16384
    ds_read_b64_tr_b16 v[114:115], v80 offset:17408
    ds_read_b64_tr_b16 v[116:117], v80 offset:24576
    ds_read_b64_tr_b16 v[118:119], v80 offset:25600
    ds_read_b64_tr_b16 v[120:121], v81 offset:16384
    ds_read_b64_tr_b16 v[122:123], v81 offset:17408
    ds_read_b64_tr_b16 v[124:125], v81 offset:24576
    ds_read_b64_tr_b16 v[126:127], v81 offset:25600
    s_branch L_lw_32
L_lw_32_0:
    s_cmp_lg_u32 s44, 1
    s_cbranch_scc1 L_lw_32_1
    ds_read_b64_tr_b16 a[176:177], v80 offset:16384
    ds_read_b64_tr_b16 a[178:179], v80 offset:17408
    ds_read_b64_tr_b16 a[180:181], v80 offset:24576
    ds_read_b64_tr_b16 a[182:183], v80 offset:25600
    ds_read_b64_tr_b16 a[184:185], v81 offset:16384
    ds_read_b64_tr_b16 a[186:187], v81 offset:17408
    ds_read_b64_tr_b16 a[188:189], v81 offset:24576
    ds_read_b64_tr_b16 a[190:191], v81 offset:25600
    s_branch L_lw_32
L_lw_32_1:
    s_cmp_lg_u32 s44, 2
    s_cbranch_scc1 L_lw_32_2
    ds_read_b64_tr_b16 a[88:89], v80 offset:16384
    ds_read_b64_tr_b16 a[90:91], v80 offset:17408
    ds_read_b64_tr_b16 a[92:93], v80 offset:24576
    ds_read_b64_tr_b16 a[94:95], v80 offset:25600
    ds_read_b64_tr_b16 v[56:57], v81 offset:16384
    ds_read_b64_tr_b16 v[58:59], v81 offset:17408
    ds_read_b64_tr_b16 v[60:61], v81 offset:24576
    ds_read_b64_tr_b16 v[62:63], v81 offset:25600
    s_waitcnt lgkmcnt(0)
    ds_write_b128 v5, v[56:59] offset:22528
    ds_write_b128 v5, v[60:63] offset:23552
    s_branch L_lw_32
L_lw_32_2:
    ds_read_b64_tr_b16 v[240:241], v80 offset:16384
    ds_read_b64_tr_b16 v[242:243], v80 offset:17408
    ds_read_b64_tr_b16 v[244:245], v80 offset:24576
    ds_read_b64_tr_b16 v[246:247], v80 offset:25600
    ds_read_b64_tr_b16 v[248:249], v81 offset:16384
    ds_read_b64_tr_b16 v[250:251], v81 offset:17408
    ds_read_b64_tr_b16 v[252:253], v81 offset:24576
    ds_read_b64_tr_b16 v[254:255], v81 offset:25600
L_lw_32:
    s_waitcnt lgkmcnt(0)
    s_waitcnt vmcnt(8)
    s_barrier
    s_add_u32 s79, s41, 15
    s_and_b32 s79, s79, 3
    s_lshl_b32 s79, s79, 19
    s_add_u32 s79, s79, s47
    s_add_u32 s46, s79, 0x600000
    s_add_u32 m0, s48, 16384
    s_nop 0
    buffer_load_dwordx4 v82, s[28:31], s46 offen  lds
    s_add_u32 s46, s79, 0x620000
    s_add_u32 m0, s48, 20480
    s_nop 0
    buffer_load_dwordx4 v82, s[28:31], s46 offen  lds
    s_add_u32 s46, s79, 0x640000
    s_add_u32 m0, s48, 24576
    s_nop 0
    buffer_load_dwordx4 v82, s[28:31], s46 offen  lds
    s_add_u32 s46, s79, 0x660000
    s_add_u32 m0, s48, 28672
    s_nop 0
    buffer_load_dwordx4 v82, s[28:31], s46 offen  lds
    s_cmp_lg_u32 s44, 0
    s_cbranch_scc1 L_lw_33_0
    ds_read_b64_tr_b16 v[144:145], v80 offset:32768
    ds_read_b64_tr_b16 v[146:147], v80 offset:33792
    ds_read_b64_tr_b16 v[148:149], v80 offset:40960
    ds_read_b64_tr_b16 v[150:151], v80 offset:41984
    ds_read_b64_tr_b16 v[152:153], v81 offset:32768
    ds_read_b64_tr_b16 v[154:155], v81 offset:33792
    ds_read_b64_tr_b16 v[156:157], v81 offset:40960
    ds_read_b64_tr_b16 v[158:159], v81 offset:41984
    s_branch L_lw_33
L_lw_33_0:
    s_cmp_lg_u32 s44, 1
    s_cbranch_scc1 L_lw_33_1
    ds_read_b64_tr_b16 a[200:201], v80 offset:32768
    ds_read_b64_tr_b16 a[202:203], v80 offset:33792
    ds_read_b64_tr_b16 a[204:205], v80 offset:40960
    ds_read_b64_tr_b16 a[206:207], v80 offset:41984
    ds_read_b64_tr_b16 a[208:209], v81 offset:32768
    ds_read_b64_tr_b16 a[210:211], v81 offset:33792
    ds_read_b64_tr_b16 a[212:213], v81 offset:40960
    ds_read_b64_tr_b16 a[214:215], v81 offset:41984
    s_branch L_lw_33
L_lw_33_1:
    s_cmp_lg_u32 s44, 2
    s_cbranch_scc1 L_lw_33_2
    ds_read_b64_tr_b16 a[104:105], v80 offset:32768
    ds_read_b64_tr_b16 a[106:107], v80 offset:33792
    ds_read_b64_tr_b16 a[108:109], v80 offset:40960
    ds_read_b64_tr_b16 a[110:111], v80 offset:41984
    ds_read_b64_tr_b16 a[112:113], v81 offset:32768
    ds_read_b64_tr_b16 a[114:115], v81 offset:33792
    ds_read_b64_tr_b16 a[116:117], v81 offset:40960
    ds_read_b64_tr_b16 a[118:119], v81 offset:41984
    s_branch L_lw_33
L_lw_33_2:
    ds_read_b64_tr_b16 a[16:17], v80 offset:32768
    ds_read_b64_tr_b16 a[18:19], v80 offset:33792
    ds_read_b64_tr_b16 a[20:21], v80 offset:40960
    ds_read_b64_tr_b16 a[22:23], v80 offset:41984
    ds_read_b64_tr_b16 a[24:25], v81 offset:32768
    ds_read_b64_tr_b16 a[26:27], v81 offset:33792
    ds_read_b64_tr_b16 a[28:29], v81 offset:40960
    ds_read_b64_tr_b16 a[30:31], v81 offset:41984
L_lw_33:
    s_waitcnt lgkmcnt(0)
    s_waitcnt vmcnt(8)
    s_barrier
    s_cmp_lg_u32 s44, 0
    s_cbranch_scc1 L_lw_34_0
    ds_read_b64_tr_b16 v[176:177], v80 offset:49152
    ds_read_b64_tr_b16 v[178:179], v80 offset:50176
    ds_read_b64_tr_b16 v[180:181], v80 offset:57344
    ds_read_b64_tr_b16 v[182:183], v80 offset:58368
    ds_read_b64_tr_b16 v[184:185], v81 offset:49152
    ds_read_b64_tr_b16 v[186:187], v81 offset:50176
    ds_read_b64_tr_b16 v[188:189], v81 offset:57344
    ds_read_b64_tr_b16 v[190:191], v81 offset:58368
    s_branch L_lw_34
L_lw_34_0:
    s_cmp_lg_u32 s44, 1
    s_cbranch_scc1 L_lw_34_1
    ds_read_b64_tr_b16 a[224:225], v80 offset:49152
    ds_read_b64_tr_b16 a[226:227], v80 offset:50176
    ds_read_b64_tr_b16 a[228:229], v80 offset:57344
    ds_read_b64_tr_b16 a[230:231], v80 offset:58368
    ds_read_b64_tr_b16 a[232:233], v81 offset:49152
    ds_read_b64_tr_b16 a[234:235], v81 offset:50176
    ds_read_b64_tr_b16 a[236:237], v81 offset:57344
    ds_read_b64_tr_b16 a[238:239], v81 offset:58368
    s_branch L_lw_34
L_lw_34_1:
    s_cmp_lg_u32 s44, 2
    s_cbranch_scc1 L_lw_34_2
    ds_read_b64_tr_b16 a[128:129], v80 offset:49152
    ds_read_b64_tr_b16 a[130:131], v80 offset:50176
    ds_read_b64_tr_b16 a[132:133], v80 offset:57344
    ds_read_b64_tr_b16 a[134:135], v80 offset:58368
    ds_read_b64_tr_b16 a[136:137], v81 offset:49152
    ds_read_b64_tr_b16 a[138:139], v81 offset:50176
    ds_read_b64_tr_b16 a[140:141], v81 offset:57344
    ds_read_b64_tr_b16 a[142:143], v81 offset:58368
    s_branch L_lw_34
L_lw_34_2:
    ds_read_b64_tr_b16 a[48:49], v80 offset:49152
    ds_read_b64_tr_b16 a[50:51], v80 offset:50176
    ds_read_b64_tr_b16 a[52:53], v80 offset:57344
    ds_read_b64_tr_b16 a[54:55], v80 offset:58368
    ds_read_b64_tr_b16 a[56:57], v81 offset:49152
    ds_read_b64_tr_b16 a[58:59], v81 offset:50176
    ds_read_b64_tr_b16 a[60:61], v81 offset:57344
    ds_read_b64_tr_b16 a[62:63], v81 offset:58368
L_lw_34:
    s_waitcnt lgkmcnt(0)
    s_waitcnt vmcnt(4)
    s_barrier
    s_cmp_lg_u32 s44, 0
    s_cbranch_scc1 L_lw_35_0
    ds_read_b64_tr_b16 v[208:209], v80 offset:0
    ds_read_b64_tr_b16 v[210:211], v80 offset:1024
    ds_read_b64_tr_b16 v[212:213], v80 offset:8192
    ds_read_b64_tr_b16 v[214:215], v80 offset:9216
    ds_read_b64_tr_b16 v[216:217], v81 offset:0
    ds_read_b64_tr_b16 v[218:219], v81 offset:1024
    ds_read_b64_tr_b16 v[220:221], v81 offset:8192
    ds_read_b64_tr_b16 v[222:223], v81 offset:9216
    s_branch L_lw_35
L_lw_35_0:
    s_cmp_lg_u32 s44, 1
    s_cbranch_scc1 L_lw_35_1
    ds_read_b64_tr_b16 a[248:249], v80 offset:0
    ds_read_b64_tr_b16 a[250:251], v80 offset:1024
    ds_read_b64_tr_b16 a[252:253], v80 offset:8192
    ds_read_b64_tr_b16 a[254:255], v80 offset:9216
    ds_read_b64_tr_b16 v[96:97], v81 offset:0
    ds_read_b64_tr_b16 v[98:99], v81 offset:1024
    ds_read_b64_tr_b16 v[100:101], v81 offset:8192
    ds_read_b64_tr_b16 v[102:103], v81 offset:9216
    s_branch L_lw_35
L_lw_35_1:
    s_cmp_lg_u32 s44, 2
    s_cbranch_scc1 L_lw_35_2
    ds_read_b64_tr_b16 a[152:153], v80 offset:0
    ds_read_b64_tr_b16 a[154:155], v80 offset:1024
    ds_read_b64_tr_b16 a[156:157], v80 offset:8192
    ds_read_b64_tr_b16 a[158:159], v80 offset:9216
    ds_read_b64_tr_b16 a[160:161], v81 offset:0
    ds_read_b64_tr_b16 a[162:163], v81 offset:1024
    ds_read_b64_tr_b16 a[164:165], v81 offset:8192
    ds_read_b64_tr_b16 a[166:167], v81 offset:9216
    s_branch L_lw_35
L_lw_35_2:
    ds_read_b64_tr_b16 a[72:73], v80 offset:0
    ds_read_b64_tr_b16 a[74:75], v80 offset:1024
    ds_read_b64_tr_b16 a[76:77], v80 offset:8192
    ds_read_b64_tr_b16 a[78:79], v80 offset:9216
    ds_read_b64_tr_b16 v[56:57], v81 offset:0
    ds_read_b64_tr_b16 v[58:59], v81 offset:1024
    ds_read_b64_tr_b16 v[60:61], v81 offset:8192
    ds_read_b64_tr_b16 v[62:63], v81 offset:9216
    s_waitcnt lgkmcnt(0)
    ds_write_b128 v5, v[56:59] offset:20480
    ds_write_b128 v5, v[60:63] offset:21504
L_lw_35:
    s_waitcnt lgkmcnt(0)
    s_waitcnt vmcnt(0)
    s_barrier
    s_cmp_lg_u32 s44, 0
    s_cbranch_scc1 L_lw_36_0
    ds_read_b64_tr_b16 v[240:241], v80 offset:16384
    ds_read_b64_tr_b16 v[242:243], v80 offset:17408
    ds_read_b64_tr_b16 v[244:245], v80 offset:24576
    ds_read_b64_tr_b16 v[246:247], v80 offset:25600
    ds_read_b64_tr_b16 v[248:249], v81 offset:16384
    ds_read_b64_tr_b16 v[250:251], v81 offset:17408
    ds_read_b64_tr_b16 v[252:253], v81 offset:24576
    ds_read_b64_tr_b16 v[254:255], v81 offset:25600
    s_branch L_lw_36
L_lw_36_0:
    s_cmp_lg_u32 s44, 1
    s_cbranch_scc1 L_lw_36_1
    ds_read_b64_tr_b16 v[112:113], v80 offset:16384
    ds_read_b64_tr_b16 v[114:115], v80 offset:17408
    ds_read_b64_tr_b16 v[116:117], v80 offset:24576
    ds_read_b64_tr_b16 v[118:119], v80 offset:25600
    ds_read_b64_tr_b16 v[120:121], v81 offset:16384
    ds_read_b64_tr_b16 v[122:123], v81 offset:17408
    ds_read_b64_tr_b16 v[124:125], v81 offset:24576
    ds_read_b64_tr_b16 v[126:127], v81 offset:25600
    s_branch L_lw_36
L_lw_36_1:
    s_cmp_lg_u32 s44, 2
    s_cbranch_scc1 L_lw_36_2
    ds_read_b64_tr_b16 a[176:177], v80 offset:16384
    ds_read_b64_tr_b16 a[178:179], v80 offset:17408
    ds_read_b64_tr_b16 a[180:181], v80 offset:24576
    ds_read_b64_tr_b16 a[182:183], v80 offset:25600
    ds_read_b64_tr_b16 a[184:185], v81 offset:16384
    ds_read_b64_tr_b16 a[186:187], v81 offset:17408
    ds_read_b64_tr_b16 a[188:189], v81 offset:24576
    ds_read_b64_tr_b16 a[190:191], v81 offset:25600
    s_branch L_lw_36
L_lw_36_2:
    ds_read_b64_tr_b16 a[88:89], v80 offset:16384
    ds_read_b64_tr_b16 a[90:91], v80 offset:17408
    ds_read_b64_tr_b16 a[92:93], v80 offset:24576
    ds_read_b64_tr_b16 a[94:95], v80 offset:25600
    ds_read_b64_tr_b16 v[56:57], v81 offset:16384
    ds_read_b64_tr_b16 v[58:59], v81 offset:17408
    ds_read_b64_tr_b16 v[60:61], v81 offset:24576
    ds_read_b64_tr_b16 v[62:63], v81 offset:25600
    s_waitcnt lgkmcnt(0)
    ds_write_b128 v5, v[56:59] offset:22528
    ds_write_b128 v5, v[60:63] offset:23552
L_lw_36:
    s_waitcnt lgkmcnt(0)
    s_barrier
    v_and_b32 v63, 15, v1
    v_lshrrev_b32 v64, 4, v1
    v_lshrrev_b32 v65, 5, v1
    v_lshlrev_b32 v65, 4, v65
    v_add_u32 v65, v65, v63
    v_lshlrev_b32 v65, 4, v65
    v_and_b32 v66, 1, v64
    v_lshlrev_b32 v66, 3, v66
    s_lshl_b32 s45, s44, 9
    s_add_u32 s45, s45, 53248
    v_add3_u32 v6, v65, v66, s45
    v_bfe_u32 v65, v1, 2, 2
    v_lshlrev_b32 v66, 3, v64
    v_add_u32 v65, v65, v66
    v_lshlrev_b32 v65, 4, v65
    v_and_b32 v66, 1, v1
    v_lshlrev_b32 v66, 3, v66
    v_add_u32 v65, v65, v66
    v_add_u32 v7, 53248, v65
    v_bfe_u32 v65, v1, 2, 1
    v_mul_u32_u24 v65, 520, v65
    v_bfe_u32 v66, v1, 3, 1
    v_lshlrev_b32 v14, 7, v66
    v_and_b32 v67, 3, v1
    v_lshlrev_b32 v67, 5, v67
    v_add3_u32 v65, v65, v14, v67
    v_lshlrev_b32 v66, 1, v66
    v_xor_b32 v66, v66, v64
    v_lshlrev_b32 v66, 3, v66
    s_mul_i32 s45, s44, 1040
    s_add_u32 s45, s45, 55296
    v_add3_u32 v18, v65, v66, s45
    v_lshlrev_b32 v14, 3, v1
    v_and_b32 v65, 16, v1
    v_xor_b32 v14, v14, v65
    v_lshlrev_b32 v16, 3, v1
    v_lshlrev_b32 v8, 4, v1
    v_lshrrev_b32 v65, 2, v1
    v_lshlrev_b32 v65, 4, v65
    v_and_b32 v66, 1, v1
    v_lshlrev_b32 v66, 3, v66
    s_lshl_b32 s45, s44, 11
    v_add3_u32 v65, v65, v66, s45
    v_and_b32 v66, 2, v1
    v_lshlrev_b32 v66, 7, v66
    v_add_u32 v9, v65, v66
    s_lshl_b32 s45, s43, 11
    s_lshl_b32 s46, s44, 9
    s_add_u32 s45, s45, s46
    s_add_u32 s51, s45, 0x7020000
    s_lshl_b32 s63, s43, 19
    s_add_u32 s63, s63, 0x3000000
    s_mov_b32 s50, 0
    s_lshl_b32 s64, s44, 11
    s_sub_u32 s63, s63, s64
    s_add_u32 s64, s64, 16384
    s_add_u32 s65, s64, 8192
    s_lshl_b32 s66, s43, 12
    s_add_u32 s66, s66, 0x1000000
    s_mov_b32 s69, 16384
    s_mov_b32 s52, 0x3e0293ee
    s_mov_b32 s53, 0x41800000
    s_lshl_b32 s45, s40, 4
    s_add_u32 s45, s45, s41
    s_lshl_b32 s45, s45, 8
    s_lshl_b32 s46, s44, 6
    s_add_u32 s45, s45, s46
    s_add_u32 s45, s45, 0x7082000
    v_and_b32 v19, 15, v1
    v_lshlrev_b32 v19, 2, v19
    v_add_u32 v19, s45, v19
    v_mov_b32 v29, 128
    s_mov_b32 s46, 96
    s_mov_b64 exec, 1
    s_mov_b32 s70, 0
L_wp_37:
    buffer_load_dword v31, v29, s[16:19], 0 offen sc1
    s_add_u32 s70, s70, 1
    s_cmp_ge_u32 s70, 0x200000
    s_cbranch_scc1 L_c_done_1
    s_waitcnt vmcnt(0)
    v_cmp_gt_u32 vcc, s46, v31
    s_nop 1
    s_cbranch_vccz L_wp_37_ok
    s_sleep 2
    s_branch L_wp_37
L_wp_37_ok:
    s_mov_b64 exec, -1
    s_mov_b32 s47, 0
    s_cmp_lt_u32 s47, s50
    s_cbranch_scc1 L_kv_rdy_38
    s_lshl_b32 s45, s43, 7
    s_add_u32 s45, s45, 0x10014
    v_mov_b32 v0, 0
    s_mov_b32 s70, 0
L_kv_rdy_38_p:
    buffer_load_dwordx2 v[10:11], v0, s[12:15], s45 offen sc1
    s_add_u32 s70, s70, 1
    s_cmp_ge_u32 s70, 0x200000
    s_cbranch_scc1 L_c_done_1
    s_waitcnt vmcnt(0)
    v_min_u32 v10, v10, v11
    s_nop 0
    v_readfirstlane_b32 s50, v10
    s_nop 3
    s_cmp_lt_u32 s47, s50
    s_cbranch_scc1 L_kv_rdy_38
    s_sleep 2
    s_branch L_kv_rdy_38_p
L_kv_rdy_38:
    s_mov_b32 m0, s64
    s_add_u32 s46, s63, 0x1000000
    buffer_load_dwordx4 v3, s[12:15], s63 offen sc1 lds
    buffer_load_dwordx4 v3, s[12:15], s63 offen offset:1024 sc1 lds
    s_mov_b32 m0, s65
    s_add_u32 s63, s63, 8192
    buffer_load_dwordx4 v3, s[12:15], s46 offen sc1 lds
    buffer_load_dwordx4 v3, s[12:15], s46 offen offset:1024 sc1 lds
    s_add_u32 s64, s64, 16384
    s_add_u32 s65, s65, 16384
    s_mov_b32 s70, 0
    v_mov_b32 v41, 0
L_hw_39:
    buffer_load_dwordx2 v[44:45], v41, s[16:19], 0 offen sc1
    s_add_u32 s70, s70, 1
    s_cmp_ge_u32 s70, 0x100000
    s_cbranch_scc1 L_c_done_1
    s_waitcnt vmcnt(0)
    v_readfirstlane_b32 s45, v44
    v_readfirstlane_b32 s46, v45
    s_nop 3
    s_lshr_b32 s47, s46, 24
    s_cmp_lg_u32 s47, 64
    s_cbranch_scc1 L_hw_39
    s_lshr_b32 s68, s45, 24
    s_and_b32 s47, s45, 511
    s_mul_i32 s47, s47, s47
    s_bfe_u32 s45, s45, 0xf0009
    s_lshl_b32 s45, s45, 5
    s_sub_u32 s45, s45, s47
    s_and_b32 s47, s46, 511
    s_mul_i32 s47, s47, s47
    s_bfe_u32 s46, s46, 0xf0009
    s_lshl_b32 s46, s46, 5
    s_sub_u32 s46, s46, s47
    s_or_b32 s45, s45, s46
    s_cmp_eq_u32 s45, 0
    s_cselect_b32 s67, 1, 0
    s_mov_b32 s24, s12
    s_mov_b32 s25, s13
    s_mov_b32 s28, s12
    s_mov_b32 s29, s13
    s_cmp_eq_u32 s67, 1
    s_cselect_b32 s26, s14, 0
    s_cselect_b32 s30, 0, s14
    s_cmp_ge_u32 s68, 16
    s_cselect_b32 s68, 8192, 0
    s_mov_b32 s6, 0x11111111
    s_mov_b32 s7, 0xffaaa491
    s_mov_b32 s60, 0
    s_lshl_b32 s58, s40, 16
    s_add_u32 s58, s58, 0x7000000
    s_mov_b32 s61, s58
    s_lshl_b32 s59, s40, 17
    s_add_u32 s59, s59, 0x7040000
    s_mov_b32 s62, s59
    s_add_u32 s32, s41, 0
    s_and_b32 s32, s32, 3
    s_lshl_b32 s32, s32, 10
    s_add_u32 s33, s41, 1
    s_and_b32 s33, s33, 3
    s_lshl_b32 s33, s33, 10
    s_add_u32 s34, s41, 2
    s_and_b32 s34, s34, 3
    s_lshl_b32 s34, s34, 10
    s_add_u32 s35, s41, 3
    s_and_b32 s35, s35, 3
    s_lshl_b32 s35, s35, 10
L_q_loop_40:
    ds_read_b128 v[56:59], v5 offset:8192
    ds_read_b128 v[60:63], v5 offset:9216
    ds_read_b128 v[64:67], v5 offset:20480
    ds_read_b128 v[68:71], v5 offset:21504
    ds_read_b128 v[72:75], v5 offset:14336
    ds_read_b128 v[76:79], v5 offset:15360
    ds_read_b128 v[80:83], v5 offset:22528
    ds_read_b128 v[84:87], v5 offset:23552
    ds_read_b128 v[88:91], v5 offset:2048
    ds_read_b128 v[92:95], v5 offset:3072
    s_add_u32 s46, s60, 1
    v_mov_b32 v15, s46
    v_mov_b32 v0, -1
    s_add_u32 s8, s61, s32
    s_add_u32 s9, s61, s33
    s_add_u32 s10, s61, s34
    s_add_u32 s11, s61, s35
    s_cmp_eq_u32 s60, 0
    s_cbranch_scc1 L_q_first_41
    s_sleep 16
    s_waitcnt vmcnt(0)
    s_mov_b64 exec, 65535
    buffer_load_dword v10, v19, s[12:15], 0 offen sc1
    s_nop 15
    buffer_load_dword v11, v19, s[12:15], 0 offen sc1
    s_nop 15
    buffer_load_dword v12, v19, s[12:15], 0 offen sc1
    s_nop 15
    buffer_load_dword v13, v19, s[12:15], 0 offen sc1
    s_mov_b32 s70, 0
L_pp_42:
    s_waitcnt vmcnt(3)
    v_cmp_gt_u32 vcc, s60, v10
    s_add_u32 s70, s70, 1
    s_nop 0
    s_cbranch_vccz L_ppd_43
    buffer_load_dword v10, v19, s[12:15], 0 offen sc1
    s_waitcnt vmcnt(3)
    v_cmp_gt_u32 vcc, s60, v11
    s_add_u32 s70, s70, 1
    s_nop 0
    s_cbranch_vccz L_ppd_43
    buffer_load_dword v11, v19, s[12:15], 0 offen sc1
    s_waitcnt vmcnt(3)
    v_cmp_gt_u32 vcc, s60, v12
    s_add_u32 s70, s70, 1
    s_nop 0
    s_cbranch_vccz L_ppd_43
    buffer_load_dword v12, v19, s[12:15], 0 offen sc1
    s_waitcnt vmcnt(3)
    v_cmp_gt_u32 vcc, s60, v13
    s_add_u32 s70, s70, 1
    s_nop 0
    s_cbranch_vccz L_ppd_43
    buffer_load_dword v13, v19, s[12:15], 0 offen sc1
    s_cmp_lt_u32 s70, 0x400000
    s_cbranch_scc1 L_pp_42
    s_branch L_c_done_1
L_ppd_43:
    s_mov_b64 exec, -1
L_q_first_41:
    s_waitcnt lgkmcnt(0)
    buffer_load_dwordx4 v[40:43], v3, s[12:15], s8 offen sc1
    v_mov_b32 v24, 0
    v_mov_b32 v25, 0
    v_mov_b32 v26, 0
    v_mov_b32 v27, 0
    v_mov_b32 v28, 0
    buffer_load_dwordx4 v[44:47], v3, s[12:15], s9 offen sc1
    v_mov_b32 v29, 0
    v_mov_b32 v30, 0
    v_mov_b32 v31, 0
    v_mov_b32 v32, 0
    v_mov_b32 v33, 0
    buffer_load_dwordx4 v[48:51], v3, s[12:15], s10 offen sc1
    v_mov_b32 v34, 0
    v_mov_b32 v35, 0
    v_mov_b32 v36, 0
    v_mov_b32 v37, 0
    v_mov_b32 v38, 0
    buffer_load_dwordx4 v[52:55], v3, s[12:15], s11 offen sc1
    s_mov_b32 s70, 0
    v_mov_b32 v39, 0
L_mg_44_p:
    s_waitcnt vmcnt(3)
    ds_write_b128 v3, v[40:43] offset:0
    v_smfmac_f32_16x16x64_bf16 v[24:27], v[40:43], a[0:7], v2
    s_waitcnt vmcnt(2)
    ds_write_b128 v3, v[44:47] offset:1024
    v_smfmac_f32_16x16x64_bf16 v[28:31], v[40:43], a[8:15], v2
    s_waitcnt vmcnt(1)
    ds_write_b128 v3, v[48:51] offset:2048
    v_smfmac_f32_16x16x64_bf16 v[32:35], v[40:43], a[16:23], v2
    s_waitcnt vmcnt(0)
    ds_write_b128 v3, v[52:55] offset:3072
    v_smfmac_f32_16x16x64_bf16 v[36:39], v[40:43], a[24:31], v2
    v_max3_u32 v22, v40, v41, v42
    v_max3_u32 v22, v22, v43, v44
    v_max3_u32 v22, v22, v45, v46
    v_smfmac_f32_16x16x64_bf16 v[24:27], v[44:47], a[32:39], v2
    v_max3_u32 v22, v22, v47, v48
    v_max3_u32 v22, v22, v49, v50
    v_smfmac_f32_16x16x64_bf16 v[28:31], v[44:47], a[40:47], v2
    v_max3_u32 v22, v22, v51, v52
    v_max3_u32 v22, v22, v53, v54
    v_smfmac_f32_16x16x64_bf16 v[32:35], v[44:47], a[48:55], v2
    v_max_u32 v22, v22, v55
    v_cmp_eq_u32 vcc, -1, v22
    v_smfmac_f32_16x16x64_bf16 v[36:39], v[44:47], a[56:63], v2
    s_waitcnt lgkmcnt(0)
    s_cbranch_vccnz L_mg_44_r
    s_barrier
    ds_read_b128 v[40:43], v4 offset:0
    ds_read_b128 v[44:47], v4 offset:1024
    v_smfmac_f32_16x16x64_bf16 v[24:27], v[48:51], a[64:71], v2
    v_smfmac_f32_16x16x64_bf16 v[28:31], v[48:51], v[56:63], v2
    ds_read_b128 v[56:59], v5 offset:6144
    v_smfmac_f32_16x16x64_bf16 v[32:35], v[48:51], a[72:79], v2
    ds_read_b128 v[60:63], v5 offset:7168
    v_smfmac_f32_16x16x64_bf16 v[36:39], v[48:51], v[64:71], v2
    ds_read_b128 v[48:51], v4 offset:2048
    v_smfmac_f32_16x16x64_bf16 v[24:27], v[52:55], a[80:87], v2
    ds_read_b128 v[64:67], v5 offset:12288
    v_smfmac_f32_16x16x64_bf16 v[28:31], v[52:55], v[72:79], v2
    ds_read_b128 v[68:71], v5 offset:13312
    v_smfmac_f32_16x16x64_bf16 v[32:35], v[52:55], a[88:95], v2
    ds_read_b128 v[72:75], v5 offset:18432
    v_smfmac_f32_16x16x64_bf16 v[36:39], v[52:55], v[80:87], v2
    ds_read_b128 v[52:55], v4 offset:3072
    ds_read_b128 v[76:79], v5 offset:19456
    s_waitcnt lgkmcnt(5)
    v_smfmac_f32_16x16x64_bf16 v[24:27], v[40:43], a[96:103], v2
    ds_read_b128 v[80:83], v5 offset:0
    v_smfmac_f32_16x16x64_bf16 v[28:31], v[40:43], v[88:95], v2
    ds_read_b128 v[84:87], v5 offset:1024
    v_smfmac_f32_16x16x64_bf16 v[32:35], v[40:43], a[104:111], v2
    ds_read_b128 v[88:91], v5 offset:4096
    v_smfmac_f32_16x16x64_bf16 v[36:39], v[40:43], a[112:119], v2
    ds_read_b128 v[40:43], v21 offset:0
    v_smfmac_f32_16x16x64_bf16 v[24:27], v[44:47], a[120:127], v2
    ds_read_b128 v[92:95], v5 offset:5120
    v_smfmac_f32_16x16x64_bf16 v[28:31], v[44:47], v[56:63], v2
    ds_read_b128 v[56:59], v5 offset:10240
    v_smfmac_f32_16x16x64_bf16 v[32:35], v[44:47], a[128:135], v2
    ds_read_b128 v[60:63], v5 offset:11264
    v_smfmac_f32_16x16x64_bf16 v[36:39], v[44:47], a[136:143], v2
    ds_read_b128 v[44:47], v21 offset:1024
    v_smfmac_f32_16x16x64_bf16 v[24:27], v[48:51], a[144:151], v2
    s_waitcnt lgkmcnt(3)
    v_smfmac_f32_16x16x64_bf16 v[28:31], v[48:51], v[64:71], v2
    ds_read_b128 v[48:51], v21 offset:2048
    v_smfmac_f32_16x16x64_bf16 v[24:27], v[52:55], a[168:175], v2
    ds_read_b128 v[64:67], v5 offset:16384
    v_smfmac_f32_16x16x64_bf16 v[28:31], v[52:55], v[72:79], v2
    ds_read_b128 v[52:55], v21 offset:3072
    v_smfmac_f32_16x16x64_bf16 v[24:27], v[40:43], a[192:199], v2
    ds_read_b128 v[68:71], v5 offset:17408
    v_smfmac_f32_16x16x64_bf16 v[28:31], v[40:43], v[80:87], v2
    ds_read_b128 v[40:43], v23 offset:0
    s_waitcnt lgkmcnt(4)
    v_smfmac_f32_16x16x64_bf16 v[24:27], v[44:47], a[216:223], v2
    v_smfmac_f32_16x16x64_bf16 v[28:31], v[44:47], v[88:95], v2
    ds_read_b128 v[44:47], v23 offset:1024
    v_smfmac_f32_16x16x64_bf16 v[24:27], v[48:51], a[240:247], v2
    v_smfmac_f32_16x16x64_bf16 v[28:31], v[48:51], v[56:63], v2
    ds_read_b128 v[48:51], v23 offset:2048
    s_waitcnt lgkmcnt(2)
    v_smfmac_f32_16x16x64_bf16 v[24:27], v[52:55], v[104:111], v2
    v_smfmac_f32_16x16x64_bf16 v[28:31], v[52:55], v[64:71], v2
    ds_read_b128 v[52:55], v23 offset:3072
    v_smfmac_f32_16x16x64_bf16 v[24:27], v[40:43], v[128:135], v2
    ds_read_b128 v[72:75], v8 offset:20480
    v_smfmac_f32_16x16x64_bf16 v[28:31], v[40:43], v[136:143], v2
    ds_read_b128 v[76:79], v8 offset:21504
    s_waitcnt lgkmcnt(3)
    v_smfmac_f32_16x16x64_bf16 v[24:27], v[44:47], v[160:167], v2
    ds_read_b128 v[56:59], v8 offset:16384
    v_smfmac_f32_16x16x64_bf16 v[28:31], v[44:47], v[168:175], v2
    ds_read_b128 v[60:63], v8 offset:17408
    v_smfmac_f32_16x16x64_bf16 v[24:27], v[48:51], v[192:199], v2
    ds_read_b128 v[64:67], v8 offset:18432
    v_smfmac_f32_16x16x64_bf16 v[28:31], v[48:51], v[200:207], v2
    ds_read_b128 v[68:71], v8 offset:19456
    s_waitcnt lgkmcnt(4)
    v_smfmac_f32_16x16x64_bf16 v[24:27], v[52:55], v[224:231], v2
    v_smfmac_f32_16x16x64_bf16 v[28:31], v[52:55], v[232:239], v2
    v_smfmac_f32_16x16x64_bf16 v[32:35], v[52:55], v[240:247], v2
    v_smfmac_f32_16x16x64_bf16 v[36:39], v[52:55], v[248:255], v2
    ds_read_b128 v[52:55], v21 offset:3072
    v_smfmac_f32_16x16x64_bf16 v[32:35], v[48:51], v[208:215], v2
    s_nop 3
    v_permlane32_swap_b32 v24, v28
    v_permlane32_swap_b32 v25, v29
    v_smfmac_f32_16x16x64_bf16 v[36:39], v[48:51], v[216:223], v2
    ds_read_b128 v[48:51], v21 offset:2048
    v_permlane32_swap_b32 v26, v30
    v_smfmac_f32_16x16x64_bf16 v[32:35], v[44:47], v[176:183], v2
    v_permlane32_swap_b32 v27, v31
    v_add_f32 v24, v24, v28
    v_smfmac_f32_16x16x64_bf16 v[36:39], v[44:47], v[184:191], v2
    ds_read_b128 v[44:47], v21 offset:1024
    v_add_f32 v25, v25, v29
    v_smfmac_f32_16x16x64_bf16 v[32:35], v[40:43], v[144:151], v2
    v_add_f32 v26, v26, v30
    v_add_f32 v27, v27, v31
    v_smfmac_f32_16x16x64_bf16 v[36:39], v[40:43], v[152:159], v2
    ds_read_b128 v[40:43], v21 offset:0
    v_cvt_pk_bf16_f32 v24, v24, v25
    s_waitcnt lgkmcnt(2)
    v_smfmac_f32_16x16x64_bf16 v[32:35], v[52:55], v[112:119], v2
    v_cvt_pk_bf16_f32 v25, v26, v27
    v_smfmac_f32_16x16x64_bf16 v[36:39], v[52:55], v[120:127], v2
    ds_read_b128 v[52:55], v4 offset:3072
    v_smfmac_f32_16x16x64_bf16 v[32:35], v[48:51], a[248:255], v2
    ds_write_b64 v6, v[24:25]
    v_smfmac_f32_16x16x64_bf16 v[36:39], v[48:51], v[96:103], v2
    ds_read_b128 v[48:51], v4 offset:2048
    s_waitcnt lgkmcnt(3)
    v_smfmac_f32_16x16x64_bf16 v[32:35], v[44:47], a[224:231], v2
    v_smfmac_f32_16x16x64_bf16 v[36:39], v[44:47], a[232:239], v2
    s_waitcnt lgkmcnt(1)
    s_barrier
    ds_read_b64_tr_b16 v[80:81], v7 offset:0
    v_smfmac_f32_16x16x64_bf16 v[32:35], v[40:43], a[200:207], v2
    ds_read_b64_tr_b16 v[82:83], v7 offset:64
    ds_read_b64_tr_b16 v[84:85], v7 offset:512
    v_smfmac_f32_16x16x64_bf16 v[36:39], v[40:43], a[208:215], v2
    ds_read_b64_tr_b16 v[86:87], v7 offset:576
    ds_read_b64_tr_b16 v[88:89], v7 offset:1024
    v_smfmac_f32_16x16x64_bf16 v[32:35], v[52:55], a[176:183], v2
    ds_read_b64_tr_b16 v[90:91], v7 offset:1088
    v_smfmac_f32_16x16x64_bf16 v[36:39], v[52:55], a[184:191], v2
    ds_read_b64_tr_b16 v[92:93], v7 offset:1536
    s_waitcnt lgkmcnt(6)
    v_smfmac_f32_16x16x64_bf16 v[32:35], v[48:51], a[152:159], v2
    ds_read_b64_tr_b16 v[94:95], v7 offset:1600
    v_smfmac_f32_16x16x64_bf16 v[36:39], v[48:51], a[160:167], v2
    s_waitcnt lgkmcnt(3)
    v_mfma_f32_16x16x32_bf16 v[24:27], v[56:59], v[80:83], 0
    ds_read_b128 v[56:59], v8 offset:22528
    v_mfma_f32_16x16x32_bf16 v[28:31], v[60:63], v[80:83], 0
    ds_read_b128 v[60:63], v8 offset:23552
    v_mfma_f32_16x16x32_bf16 v[24:27], v[64:67], v[84:87], v[24:27]
    s_nop 1
    v_cvt_pk_bf16_f32 v32, v32, v33
    v_cvt_pk_bf16_f32 v33, v34, v35
    v_cvt_pk_bf16_f32 v34, v36, v37
    v_cvt_pk_bf16_f32 v35, v38, v39
    ds_write2_b64 v18, v[32:33], v[34:35] offset1:32
    v_mfma_f32_16x16x32_bf16 v[28:31], v[68:71], v[84:87], v[28:31]
    s_waitcnt lgkmcnt(3)
    v_mfma_f32_16x16x32_bf16 v[24:27], v[72:75], v[88:91], v[24:27]
    ds_read_b64_tr_b16 v[64:65], v9 offset:24576
    v_mfma_f32_16x16x32_bf16 v[28:31], v[76:79], v[88:91], v[28:31]
    ds_read_b64_tr_b16 v[66:67], v9 offset:25600
    s_waitcnt lgkmcnt(3)
    v_mfma_f32_16x16x32_bf16 v[24:27], v[56:59], v[92:95], v[24:27]
    ds_read_b64_tr_b16 v[68:69], v9 offset:25088
    v_mfma_f32_16x16x32_bf16 v[28:31], v[60:63], v[92:95], v[28:31]
    ds_read_b64_tr_b16 v[70:71], v9 offset:26112
    v_mov_b32 v57, 0
    v_mov_b32 v58, 0
    s_cmp_eq_u32 s60, 63
    s_waitcnt lgkmcnt(4)
    s_barrier
    ds_read_b64_tr_b16 v[40:41], v14 offset:55296
    ds_read_b64_tr_b16 v[42:43], v14 offset:55816
    ds_read_b64_tr_b16 v[44:45], v14 offset:56336
    ds_read_b64_tr_b16 v[46:47], v14 offset:56856
    ds_read_b64_tr_b16 v[48:49], v14 offset:57376
    ds_read_b64_tr_b16 v[50:51], v14 offset:57896
    ds_read_b64_tr_b16 v[52:53], v14 offset:58416
    ds_read_b64_tr_b16 v[54:55], v14 offset:58936
    s_cbranch_scc1 L_q_last_45
    v_max3_f32 v11, v24, v25, v26
    v_max3_f32 v13, v27, v28, v29
    v_max3_f32 v11, v11, v30, v31
    v_max_f32 v12, v11, v13
    v_max_f32 v13, v11, v13
    v_mov_b32 v32, 0x3f803f80
    v_mov_b32 v33, 0x3f803f80
    v_mov_b32 v34, 0x3f803f80
    v_mov_b32 v35, 0x3f803f80
    buffer_load_dwordx2 v[0:1], v16, s[12:15], s51 offen sc1
    s_waitcnt lgkmcnt(4)
    v_mfma_f32_16x16x32_bf16 v[36:39], v[40:43], v[80:83], 0
    v_permlane32_swap_b32 v12, v13
    v_mfma_f32_16x16x32_bf16 v[36:39], v[44:47], v[84:87], v[36:39]
    v_max_f32 v22, v12, v13
    v_max_f32 v13, v12, v13
    s_waitcnt lgkmcnt(0)
    v_mfma_f32_16x16x32_bf16 v[36:39], v[48:51], v[88:91], v[36:39]
    v_permlane16_swap_b32 v22, v13
    v_mfma_f32_16x16x32_bf16 v[36:39], v[52:55], v[92:95], v[36:39]
    v_max_f32 v11, v22, v13
    v_mul_f32 v10, s52, v11
    v_fma_f32 v24, v24, s52, -v10
    v_fma_f32 v25, v25, s52, -v10
    v_fma_f32 v26, v26, s52, -v10
    v_fma_f32 v27, v27, s52, -v10
    v_fma_f32 v28, v28, s52, -v10
    v_fma_f32 v29, v29, s52, -v10
    v_fma_f32 v30, v30, s52, -v10
    v_fma_f32 v31, v31, s52, -v10
    v_exp_f32 v24, v24
    v_exp_f32 v25, v25
    v_exp_f32 v26, v26
    v_exp_f32 v27, v27
    v_exp_f32 v28, v28
    v_exp_f32 v29, v29
    v_exp_f32 v30, v30
    v_exp_f32 v31, v31
    v_cvt_pk_bf16_f32 v60, v24, v25
    v_cvt_pk_bf16_f32 v61, v26, v27
    v_cvt_pk_bf16_f32 v62, v28, v29
    v_cvt_pk_bf16_f32 v63, v30, v31
    v_permlane32_swap_b32 v36, v38
    v_permlane32_swap_b32 v37, v39
    v_mfma_f32_16x16x32_bf16 v[72:75], v[64:67], v[60:63], 0
    v_add_f32 v36, v36, v38
    v_add_f32 v37, v37, v39
    v_mfma_f32_16x16x32_bf16 v[76:79], v[68:71], v[60:63], 0
    v_fma_f32 v12, v36, s52, -v10
    v_fma_f32 v13, v37, s52, -v10
    v_mfma_f32_16x16x32_bf16 v[24:27], v[32:35], v[60:63], 0
    buffer_store_dword v15, v20, s[24:27], 0 offen
    v_exp_f32 v36, v12
    v_exp_f32 v37, v13
    v_max_f32 v11, v12, v13
    s_waitcnt vmcnt(1)
    v_max_u32 v22, v0, v1
    v_cmp_lt_f32 s[8:9], s53, v11
    v_cmp_eq_u32 vcc, -1, v22
    v_cvt_pk_bf16_f32 v56, v36, v37
    v_cvt_pk_bf16_f32 v59, v36, v37
    s_or_b64 s[10:11], vcc, s[8:9]
    s_cbranch_scc1 L_q_vm_46_s
L_q_vm_46_j:
    v_mfma_f32_16x16x16_bf16 v[24:27], v[32:33], v[56:57], v[24:27]
    v_mfma_f32_16x16x16_bf16 v[72:75], v[0:1], v[56:57], v[72:75]
    v_mfma_f32_16x16x16_bf16 v[76:79], v[0:1], v[58:59], v[76:79]
    s_nop 5
    v_rcp_f32 v12, v24
    s_nop 0
    v_pk_mul_f32 v[72:73], v[72:73], v[12:13] op_sel_hi:[1,0]
    v_pk_mul_f32 v[74:75], v[74:75], v[12:13] op_sel_hi:[1,0]
    v_pk_mul_f32 v[76:77], v[76:77], v[12:13] op_sel_hi:[1,0]
    v_pk_mul_f32 v[78:79], v[78:79], v[12:13] op_sel_hi:[1,0]
    v_cvt_pk_bf16_f32 v72, v72, v73
    v_cvt_pk_bf16_f32 v73, v74, v75
    v_cvt_pk_bf16_f32 v74, v76, v77
    v_cvt_pk_bf16_f32 v75, v78, v79
    buffer_store_dwordx4 v[72:75], v17, s[24:27], s62 offen
    buffer_store_dwordx4 v[72:75], v17, s[28:31], s62 offen sc1
    buffer_store_dword v15, v20, s[28:31], 0 offen sc1
    v_mov_b32 v60, -1
    v_mov_b32 v61, -1
    v_mov_b32 v62, -1
    v_mov_b32 v63, -1
    s_add_u32 s45, s60, 3
    s_and_b32 s45, s45, 3
    s_lshl_b32 s45, s45, 15
    s_add_u32 s45, s45, s59
    buffer_store_dwordx4 v[60:63], v17, s[24:27], s45 offen
    buffer_store_dwordx4 v[60:63], v17, s[28:31], s45 offen sc1
    s_barrier
    s_and_b32 s45, s51, 0xffff
    s_lshl_b32 s46, s60, 16
    s_add_u32 s45, s45, s46
    s_add_u32 s45, s45, 0x1800000
    buffer_store_dwordx2 v[0:1], v16, s[12:15], s45 offen sc1
L_q_last_45:
    s_waitcnt lgkmcnt(0)
    v_lshlrev_b32 v22, 1, v16
    s_cmp_lg_u32 s44, 0
    s_cbranch_scc1 L_q_km_47_0
    buffer_store_dwordx4 v[40:43], v22, s[12:15], s66 offen offset:0 sc1
L_q_km_47_0:
    s_cmp_lg_u32 s44, 1
    s_cbranch_scc1 L_q_km_47_1
    buffer_store_dwordx4 v[44:47], v22, s[12:15], s66 offen offset:1024 sc1
L_q_km_47_1:
    s_cmp_lg_u32 s44, 2
    s_cbranch_scc1 L_q_km_47_2
    buffer_store_dwordx4 v[48:51], v22, s[12:15], s66 offen offset:2048 sc1
L_q_km_47_2:
    s_cmp_lg_u32 s44, 3
    s_cbranch_scc1 L_q_km_47_3
    buffer_store_dwordx4 v[52:55], v22, s[12:15], s66 offen offset:3072 sc1
L_q_km_47_3:
    s_cmp_eq_u32 s60, 63
    s_cbranch_scc1 L_q_fin_48
    s_cmp_eq_u32 s60, 62
    s_cbranch_scc1 L_q_fin_48_n
    s_add_u32 s47, s60, 1
    s_cmp_lt_u32 s47, s50
    s_cbranch_scc1 L_kv_rdy_49
    s_lshl_b32 s45, s43, 7
    s_add_u32 s45, s45, 0x10014
    v_mov_b32 v0, 0
    s_mov_b32 s70, 0
L_kv_rdy_49_p:
    buffer_load_dwordx2 v[10:11], v0, s[12:15], s45 offen sc1
    s_add_u32 s70, s70, 1
    s_cmp_ge_u32 s70, 0x200000
    s_cbranch_scc1 L_c_done_1
    s_waitcnt vmcnt(0)
    v_min_u32 v10, v10, v11
    s_nop 0
    v_readfirstlane_b32 s50, v10
    s_nop 3
    s_cmp_lt_u32 s47, s50
    s_cbranch_scc1 L_kv_rdy_49
    s_sleep 2
    s_branch L_kv_rdy_49_p
L_kv_rdy_49:
    s_mov_b32 m0, s64
    s_add_u32 s46, s63, 0x1000000
    buffer_load_dwordx4 v3, s[12:15], s63 offen sc1 lds
    buffer_load_dwordx4 v3, s[12:15], s63 offen offset:1024 sc1 lds
    s_mov_b32 m0, s65
    s_add_u32 s63, s63, 8192
    buffer_load_dwordx4 v3, s[12:15], s46 offen sc1 lds
    buffer_load_dwordx4 v3, s[12:15], s46 offen offset:1024 sc1 lds
L_q_fin_48_n:
    s_add_u32 s47, s60, 1
    s_bitcmp1_b64 s[6:7], s47
    s_cselect_b32 s47, s47, s60
    s_cbranch_scc0 L_q_fin_48_m
    s_waitcnt vmcnt(0)
L_q_fin_48_m:
    v_mov_b32 v22, s47
    v_mov_b32 v0, 0
    s_mov_b64 exec, 1
    buffer_store_dword v22, v0, s[12:15], s3 offen sc1
    s_mov_b64 exec, -1
    s_mov_b64 exec, -1
    v_add_u32 v8, s69, v8
    v_add_u32 v9, s69, v9
    s_sub_u32 s64, s64, s69
    s_sub_u32 s65, s65, s69
    s_sub_u32 s69, 0, s69
    s_add_u32 s66, s66, 131072
    s_xor_b32 s51, s51, 65536
    s_add_u32 s60, s60, 1
    s_and_b32 s45, s60, 3
    s_lshl_b32 s46, s45, 14
    s_add_u32 s61, s58, s46
    s_lshl_b32 s46, s45, 15
    s_add_u32 s62, s59, s46
    s_branch L_q_loop_40
L_q_fin_48:
    s_waitcnt vmcnt(0)
    v_mov_b32 v22, 64
    v_mov_b32 v0, 0
    s_mov_b64 exec, 1
    buffer_store_dword v22, v0, s[12:15], s3 offen sc1
    s_mov_b64 exec, -1
    s_endpgm
L_mg_44_r:
    buffer_load_dwordx4 v[40:43], v3, s[12:15], s8 offen sc1
    buffer_load_dwordx4 v[44:47], v3, s[12:15], s9 offen sc1
    buffer_load_dwordx4 v[48:51], v3, s[12:15], s10 offen sc1
    buffer_load_dwordx4 v[52:55], v3, s[12:15], s11 offen sc1
    s_add_u32 s70, s70, 1
    s_cmp_ge_u32 s70, 0x100000
    s_cbranch_scc1 L_c_done_1
    s_nop 1
    v_mov_b32 v24, 0
    v_mov_b32 v25, 0
    v_mov_b32 v26, 0
    v_mov_b32 v27, 0
    v_mov_b32 v28, 0
    v_mov_b32 v29, 0
    v_mov_b32 v30, 0
    v_mov_b32 v31, 0
    v_mov_b32 v32, 0
    v_mov_b32 v33, 0
    v_mov_b32 v34, 0
    v_mov_b32 v35, 0
    v_mov_b32 v36, 0
    v_mov_b32 v37, 0
    v_mov_b32 v38, 0
    v_mov_b32 v39, 0
    s_branch L_mg_44_p
L_q_vm_46_s:
    s_cbranch_vccz L_q_vm_46_t
    buffer_load_dwordx2 v[0:1], v16, s[12:15], s51 offen sc1
    s_add_u32 s70, s70, 1
    s_nop 0
    s_cmp_ge_u32 s70, 0x100000
    s_cbranch_scc1 L_c_done_1
    s_waitcnt vmcnt(0)
    v_max_u32 v22, v0, v1
    v_cmp_eq_u32 vcc, -1, v22
    s_nop 1
    s_branch L_q_vm_46_s
L_q_vm_46_t:
    s_cmp_eq_u64 s[8:9], 0
    s_cbranch_scc1 L_q_vm_46_j
    v_max_f32 v11, 0, v11
    v_mov_b32 v22, v11
    s_nop 1
    v_permlane32_swap_b32 v11, v22
    v_max_f32 v11, v11, v22
    v_mov_b32 v22, v11
    s_nop 1
    v_permlane16_swap_b32 v11, v22
    v_max_f32 v11, v11, v22
    v_sub_f32 v12, v12, v11
    v_sub_f32 v13, v13, v11
    v_sub_f32 v11, 0, v11
    v_exp_f32 v36, v12
    v_exp_f32 v37, v13
    v_exp_f32 v11, v11
    s_nop 7
    v_mul_f32 v72, v72, v11
    v_mul_f32 v73, v73, v11
    v_mul_f32 v74, v74, v11
    v_mul_f32 v75, v75, v11
    v_mul_f32 v76, v76, v11
    v_mul_f32 v77, v77, v11
    v_mul_f32 v78, v78, v11
    v_mul_f32 v79, v79, v11
    v_mul_f32 v24, v24, v11
    v_cvt_pk_bf16_f32 v56, v36, v37
    v_cvt_pk_bf16_f32 v59, v36, v37
    s_nop 1
    s_branch L_q_vm_46_j
L_c_vo_2:
    s_lshl_b32 s45, s43, 11
    s_lshl_b32 s46, s44, 9
    s_add_u32 s45, s45, s46
    v_lshlrev_b32 v10, 3, v1
    v_add_u32 v10, s45, v10
    v_lshlrev_b32 v11, 3, v0
    v_bfe_u32 v69, v1, 4, 1
    v_lshlrev_b32 v69, 2, v69
    v_lshrrev_b32 v63, 5, v1
    v_lshlrev_b32 v63, 1, v63
    v_and_b32 v64, 1, v1
    v_add3_u32 v69, v69, v63, v64
    v_bfe_u32 v63, v1, 1, 1
    v_lshlrev_b32 v63, 3, v63
    v_add_u32 v63, v63, v69
    v_lshlrev_b32 v63, 4, v63
    v_bfe_u32 v64, v1, 2, 2
    v_lshlrev_b32 v64, 2, v64
    s_lshl_b32 s45, s42, 10
    s_lshl_b32 s46, s44, 8
    s_add_u32 s45, s45, s46
    v_add3_u32 v12, v63, v64, s45
    v_and_b32 v64, 1, v1
    v_cmp_eq_u32 vcc, 0, v64
    v_mov_b32 v9, 0x07060302
    v_mov_b32 v63, 0x01000504
    v_cndmask_b32 v9, v9, v63, vcc
    s_lshl_b32 s63, s40, 19
    s_lshl_b32 s45, s42, 15
    s_add_u32 s63, s63, s45
    s_add_u32 s63, s63, 0x7100000
    s_xor_b32 s64, s63, 524288
    s_lshl_b32 s45, s40, 12
    s_lshl_b32 s46, s44, 2
    s_add_u32 s45, s45, s46
    s_lshl_b32 s46, s42, 4
    s_add_u32 s45, s45, s46
    s_add_u32 s45, s45, 0x7082000
    v_lshlrev_b32 v20, 8, v1
    v_add_u32 v20, s45, v20
    v_mov_b32 v63, 0x20000000
    v_cmp_gt_u32 vcc, 16, v1
    s_nop 1
    v_cndmask_b32 v20, v63, v20, vcc
    buffer_store_dword v44, v20, s[12:15], 0 offen sc1
    s_mov_b32 s45, 0x7020000
    buffer_store_dwordx2 v[40:41], v10, s[12:15], s45 offen sc1
    s_mov_b32 s45, 0x7030000
    buffer_store_dwordx2 v[40:41], v10, s[12:15], s45 offen sc1
    s_add_u32 s45, s63, 0
    buffer_store_dwordx2 v[40:41], v11, s[12:15], s45 offen sc1
    s_add_u32 s45, s63, 4096
    buffer_store_dwordx2 v[40:41], v11, s[12:15], s45 offen sc1
    s_add_u32 s45, s63, 8192
    buffer_store_dwordx2 v[40:41], v11, s[12:15], s45 offen sc1
    s_add_u32 s45, s63, 12288
    buffer_store_dwordx2 v[40:41], v11, s[12:15], s45 offen sc1
    s_add_u32 s45, s63, 16384
    buffer_store_dwordx2 v[40:41], v11, s[12:15], s45 offen sc1
    s_add_u32 s45, s63, 20480
    buffer_store_dwordx2 v[40:41], v11, s[12:15], s45 offen sc1
    s_add_u32 s45, s63, 24576
    buffer_store_dwordx2 v[40:41], v11, s[12:15], s45 offen sc1
    s_add_u32 s45, s63, 28672
    buffer_store_dwordx2 v[40:41], v11, s[12:15], s45 offen sc1
    s_lshl_b32 s61, s40, 16
    s_add_u32 s61, s61, 0x7000000
    s_add_u32 s45, s61, 16384
    buffer_store_dword v40, v12, s[12:15], s45 offen sc1
    s_add_u32 s45, s61, 32768
    buffer_store_dword v40, v12, s[12:15], s45 offen sc1
    s_add_u32 s45, s61, 49152
    buffer_store_dword v40, v12, s[12:15], s45 offen sc1
    v_lshlrev_b32 v63, 11, v69
    v_and_b32 v64, 14, v1
    v_lshlrev_b32 v64, 1, v64
    v_add_u32 v63, v63, v64
    s_lshl_b32 s45, s42, 7
    s_lshl_b32 s46, s44, 5
    s_add_u32 s45, s45, s46
    buffer_load_dword v45, v63, s[52:55], s45 offen
    s_mov_b32 s76, -1
    s_mov_b32 s77, -1
    v_lshrrev_b32 v63, 3, v1
    v_lshlrev_b32 v63, 11, v63
    v_bfe_u32 v64, v1, 1, 2
    v_and_b32 v65, 1, v1
    v_lshlrev_b32 v65, 4, v65
    v_add_u32 v63, v63, v65
    v_xor_b32 v66, 0, v64
    v_lshlrev_b32 v66, 5, v66
    v_add_u32 v70, v63, v66
    v_xor_b32 v66, 1, v64
    v_lshlrev_b32 v66, 5, v66
    v_add_u32 v71, v63, v66
    v_xor_b32 v66, 2, v64
    v_lshlrev_b32 v66, 5, v66
    v_add_u32 v72, v63, v66
    v_xor_b32 v66, 3, v64
    v_lshlrev_b32 v66, 5, v66
    v_add_u32 v73, v63, v66
    v_bfe_u32 v63, v1, 3, 1
    v_lshlrev_b32 v63, 1, v63
    v_bfe_u32 v64, v1, 4, 1
    v_add_u32 v63, v63, v64
    v_lshlrev_b32 v64, 3, v63
    v_lshrrev_b32 v65, 5, v1
    v_lshlrev_b32 v65, 2, v65
    v_add_u32 v64, v64, v65
    v_bfe_u32 v65, v1, 2, 1
    v_add_u32 v64, v64, v65
    v_lshlrev_b32 v64, 7, v64
    v_and_b32 v65, 3, v1
    v_lshlrev_b32 v65, 3, v65
    v_add_u32 v64, v64, v65
    s_lshl_b32 s45, s44, 12
    v_add_u32 v64, s45, v64
    s_add_u32 s45, s44, 1
    s_and_b32 s45, s45, 3
    v_xor_b32 v65, s45, v63
    v_lshlrev_b32 v65, 5, v65
    v_add_u32 v74, v64, v65
    s_mul_i32 s45, s44, 20480
    s_add_u32 s45, s45, 65536
    v_add_u32 v88, s45, v74
    s_add_u32 s45, s44, 2
    s_and_b32 s45, s45, 3
    v_xor_b32 v65, s45, v63
    v_lshlrev_b32 v65, 5, v65
    v_add_u32 v75, v64, v65
    s_mul_i32 s45, s44, 20480
    s_add_u32 s45, s45, 65536
    v_add_u32 v89, s45, v75
    s_add_u32 s45, s44, 3
    s_and_b32 s45, s45, 3
    v_xor_b32 v65, s45, v63
    v_lshlrev_b32 v65, 5, v65
    v_add_u32 v76, v64, v65
    s_mul_i32 s45, s44, 20480
    s_add_u32 s45, s45, 65536
    v_add_u32 v90, s45, v76
    s_add_u32 s45, s44, 4
    s_and_b32 s45, s45, 3
    v_xor_b32 v65, s45, v63
    v_lshlrev_b32 v65, 5, v65
    v_add_u32 v77, v64, v65
    s_mul_i32 s45, s44, 20480
    s_add_u32 s45, s45, 65536
    v_add_u32 v91, s45, v77
    s_mul_i32 s65, s44, 24576
    s_lshl_b32 s49, s40, 22
    s_lshl_b32 s45, s44, 20
    s_add_u32 s49, s49, s45
    s_lshl_b32 s45, s42, 7
    s_add_u32 s49, s49, s45
    s_lshl_b32 s50, s44, 12
    s_mul_i32 s69, s42, 1
    s_add_u32 s51, s69, 0
    s_and_b32 s51, s51, 7
    s_lshl_b32 s51, s51, 17
    s_add_u32 s51, s51, s49
    s_add_u32 s46, s51, 0x0
    s_add_u32 m0, s65, 65536
    s_nop 0
    buffer_load_dwordx4 v70, s[36:39], s46 offen  lds
    s_add_u32 s46, s51, 0x8000
    s_add_u32 m0, s65, 66560
    s_nop 0
    buffer_load_dwordx4 v71, s[36:39], s46 offen  lds
    s_add_u32 s46, s51, 0x10000
    s_add_u32 m0, s65, 67584
    s_nop 0
    buffer_load_dwordx4 v72, s[36:39], s46 offen  lds
    s_add_u32 s46, s51, 0x18000
    s_add_u32 m0, s65, 68608
    s_nop 0
    buffer_load_dwordx4 v73, s[36:39], s46 offen  lds
    s_add_u32 s51, s69, 0
    s_and_b32 s51, s51, 7
    s_lshl_b32 s51, s51, 17
    s_add_u32 s51, s51, s49
    s_add_u32 s46, s51, 0x4000
    s_add_u32 m0, s65, 69632
    s_nop 0
    buffer_load_dwordx4 v70, s[36:39], s46 offen  lds
    s_add_u32 s46, s51, 0xc000
    s_add_u32 m0, s65, 70656
    s_nop 0
    buffer_load_dwordx4 v71, s[36:39], s46 offen  lds
    s_add_u32 s46, s51, 0x14000
    s_add_u32 m0, s65, 71680
    s_nop 0
    buffer_load_dwordx4 v72, s[36:39], s46 offen  lds
    s_add_u32 s46, s51, 0x1c000
    s_add_u32 m0, s65, 72704
    s_nop 0
    buffer_load_dwordx4 v73, s[36:39], s46 offen  lds
    s_add_u32 s51, s69, 1
    s_and_b32 s51, s51, 7
    s_lshl_b32 s51, s51, 17
    s_add_u32 s51, s51, s49
    s_add_u32 s46, s51, 0x0
    s_add_u32 m0, s65, 73728
    s_nop 0
    buffer_load_dwordx4 v70, s[36:39], s46 offen  lds
    s_add_u32 s46, s51, 0x8000
    s_add_u32 m0, s65, 74752
    s_nop 0
    buffer_load_dwordx4 v71, s[36:39], s46 offen  lds
    s_add_u32 s46, s51, 0x10000
    s_add_u32 m0, s65, 75776
    s_nop 0
    buffer_load_dwordx4 v72, s[36:39], s46 offen  lds
    s_add_u32 s46, s51, 0x18000
    s_add_u32 m0, s65, 76800
    s_nop 0
    buffer_load_dwordx4 v73, s[36:39], s46 offen  lds
    s_add_u32 s51, s69, 1
    s_and_b32 s51, s51, 7
    s_lshl_b32 s51, s51, 17
    s_add_u32 s51, s51, s49
    s_add_u32 s46, s51, 0x4000
    s_add_u32 m0, s65, 77824
    s_nop 0
    buffer_load_dwordx4 v70, s[36:39], s46 offen  lds
    s_add_u32 s46, s51, 0xc000
    s_add_u32 m0, s65, 78848
    s_nop 0
    buffer_load_dwordx4 v71, s[36:39], s46 offen  lds
    s_add_u32 s46, s51, 0x14000
    s_add_u32 m0, s65, 79872
    s_nop 0
    buffer_load_dwordx4 v72, s[36:39], s46 offen  lds
    s_add_u32 s46, s51, 0x1c000
    s_add_u32 m0, s65, 80896
    s_nop 0
    buffer_load_dwordx4 v73, s[36:39], s46 offen  lds
    s_add_u32 s51, s69, 2
    s_and_b32 s51, s51, 7
    s_lshl_b32 s51, s51, 17
    s_add_u32 s51, s51, s49
    s_add_u32 s46, s51, 0x0
    s_add_u32 m0, s65, 81920
    s_nop 0
    buffer_load_dwordx4 v70, s[36:39], s46 offen  lds
    s_add_u32 s46, s51, 0x8000
    s_add_u32 m0, s65, 82944
    s_nop 0
    buffer_load_dwordx4 v71, s[36:39], s46 offen  lds
    s_add_u32 s46, s51, 0x10000
    s_add_u32 m0, s65, 83968
    s_nop 0
    buffer_load_dwordx4 v72, s[36:39], s46 offen  lds
    s_add_u32 s46, s51, 0x18000
    s_add_u32 m0, s65, 84992
    s_nop 0
    buffer_load_dwordx4 v73, s[36:39], s46 offen  lds
    s_add_u32 s51, s69, 2
    s_and_b32 s51, s51, 7
    s_lshl_b32 s51, s51, 17
    s_add_u32 s51, s51, s49
    s_add_u32 s46, s51, 0x4000
    s_add_u32 m0, s65, 86016
    s_nop 0
    buffer_load_dwordx4 v70, s[36:39], s46 offen  lds
    s_add_u32 s46, s51, 0xc000
    s_add_u32 m0, s65, 87040
    s_nop 0
    buffer_load_dwordx4 v71, s[36:39], s46 offen  lds
    s_add_u32 s46, s51, 0x14000
    s_add_u32 m0, s65, 88064
    s_nop 0
    buffer_load_dwordx4 v72, s[36:39], s46 offen  lds
    s_add_u32 s46, s51, 0x1c000
    s_add_u32 m0, s65, 89088
    s_nop 0
    buffer_load_dwordx4 v73, s[36:39], s46 offen  lds
    s_add_u32 s51, s69, 3
    s_and_b32 s51, s51, 7
    s_lshl_b32 s51, s51, 17
    s_add_u32 s51, s51, s49
    s_add_u32 s46, s51, 0x0
    s_add_u32 m0, s50, 0
    s_nop 0
    buffer_load_dwordx4 v70, s[36:39], s46 offen  lds
    s_add_u32 s46, s51, 0x8000
    s_add_u32 m0, s50, 1024
    s_nop 0
    buffer_load_dwordx4 v71, s[36:39], s46 offen  lds
    s_add_u32 s46, s51, 0x10000
    s_add_u32 m0, s50, 2048
    s_nop 0
    buffer_load_dwordx4 v72, s[36:39], s46 offen  lds
    s_add_u32 s46, s51, 0x18000
    s_add_u32 m0, s50, 3072
    s_nop 0
    buffer_load_dwordx4 v73, s[36:39], s46 offen  lds
    s_add_u32 s51, s69, 3
    s_and_b32 s51, s51, 7
    s_lshl_b32 s51, s51, 17
    s_add_u32 s51, s51, s49
    s_add_u32 s46, s51, 0x4000
    s_add_u32 m0, s50, 16384
    s_nop 0
    buffer_load_dwordx4 v70, s[36:39], s46 offen  lds
    s_add_u32 s46, s51, 0xc000
    s_add_u32 m0, s50, 17408
    s_nop 0
    buffer_load_dwordx4 v71, s[36:39], s46 offen  lds
    s_add_u32 s46, s51, 0x14000
    s_add_u32 m0, s50, 18432
    s_nop 0
    buffer_load_dwordx4 v72, s[36:39], s46 offen  lds
    s_add_u32 s46, s51, 0x1c000
    s_add_u32 m0, s50, 19456
    s_nop 0
    buffer_load_dwordx4 v73, s[36:39], s46 offen  lds
    s_add_u32 s51, s69, 4
    s_and_b32 s51, s51, 7
    s_lshl_b32 s51, s51, 17
    s_add_u32 s51, s51, s49
    s_add_u32 s46, s51, 0x0
    s_add_u32 m0, s50, 32768
    s_nop 0
    buffer_load_dwordx4 v70, s[36:39], s46 offen  lds
    s_add_u32 s46, s51, 0x8000
    s_add_u32 m0, s50, 33792
    s_nop 0
    buffer_load_dwordx4 v71, s[36:39], s46 offen  lds
    s_add_u32 s46, s51, 0x10000
    s_add_u32 m0, s50, 34816
    s_nop 0
    buffer_load_dwordx4 v72, s[36:39], s46 offen  lds
    s_add_u32 s46, s51, 0x18000
    s_add_u32 m0, s50, 35840
    s_nop 0
    buffer_load_dwordx4 v73, s[36:39], s46 offen  lds
    s_add_u32 s51, s69, 4
    s_and_b32 s51, s51, 7
    s_lshl_b32 s51, s51, 17
    s_add_u32 s51, s51, s49
    s_add_u32 s46, s51, 0x4000
    s_add_u32 m0, s50, 49152
    s_nop 0
    buffer_load_dwordx4 v70, s[36:39], s46 offen  lds
    s_add_u32 s46, s51, 0xc000
    s_add_u32 m0, s50, 50176
    s_nop 0
    buffer_load_dwordx4 v71, s[36:39], s46 offen  lds
    s_add_u32 s46, s51, 0x14000
    s_add_u32 m0, s50, 51200
    s_nop 0
    buffer_load_dwordx4 v72, s[36:39], s46 offen  lds
    s_add_u32 s46, s51, 0x1c000
    s_add_u32 m0, s50, 52224
    s_nop 0
    buffer_load_dwordx4 v73, s[36:39], s46 offen  lds
    s_waitcnt vmcnt(40)
    v_min_u32 v45, -2, v45
    buffer_store_dword v45, v12, s[12:15], s61 offen sc1
    s_waitcnt vmcnt(36)
    s_barrier
    ds_read_b64_tr_b16 a[160:161], v88 offset:0
    ds_read_b64_tr_b16 a[162:163], v88 offset:256
    ds_read_b64_tr_b16 a[168:169], v89 offset:0
    ds_read_b64_tr_b16 a[170:171], v89 offset:256
    ds_read_b64_tr_b16 a[176:177], v90 offset:0
    ds_read_b64_tr_b16 a[178:179], v90 offset:256
    ds_read_b64_tr_b16 a[184:185], v91 offset:0
    ds_read_b64_tr_b16 a[186:187], v91 offset:256
L_lw_50:
    s_waitcnt lgkmcnt(0)
    s_cmp_lg_u32 s44, 0
    s_cbranch_scc1 L_v_probe_51
    s_add_u32 s45, s63, 0
    s_memtime s[72:73]
    s_waitcnt lgkmcnt(0)
    s_load_dword s78, s[20:21], s45
    s_waitcnt lgkmcnt(0)
    s_memtime s[74:75]
    s_waitcnt lgkmcnt(0)
    s_sub_u32 s45, s74, s72
    s_min_u32 s76, s76, s45
    s_cmp_lt_u32 s77, s76
    s_cselect_b32 s68, 1, 0
L_v_probe_51:
    s_waitcnt vmcnt(32)
    s_barrier
    s_add_u32 s51, s69, 5
    s_and_b32 s51, s51, 7
    s_lshl_b32 s51, s51, 17
    s_add_u32 s51, s51, s49
    s_add_u32 s46, s51, 0x0
    s_add_u32 m0, s65, 65536
    s_nop 0
    buffer_load_dwordx4 v70, s[36:39], s46 offen  lds
    s_add_u32 s46, s51, 0x8000
    s_add_u32 m0, s65, 66560
    s_nop 0
    buffer_load_dwordx4 v71, s[36:39], s46 offen  lds
    s_add_u32 s46, s51, 0x10000
    s_add_u32 m0, s65, 67584
    s_nop 0
    buffer_load_dwordx4 v72, s[36:39], s46 offen  lds
    s_add_u32 s46, s51, 0x18000
    s_add_u32 m0, s65, 68608
    s_nop 0
    buffer_load_dwordx4 v73, s[36:39], s46 offen  lds
    ds_read_b64_tr_b16 a[164:165], v88 offset:4096
    ds_read_b64_tr_b16 a[166:167], v88 offset:4352
    ds_read_b64_tr_b16 a[172:173], v89 offset:4096
    ds_read_b64_tr_b16 a[174:175], v89 offset:4352
    ds_read_b64_tr_b16 a[180:181], v90 offset:4096
    ds_read_b64_tr_b16 a[182:183], v90 offset:4352
    ds_read_b64_tr_b16 a[188:189], v91 offset:4096
    ds_read_b64_tr_b16 a[190:191], v91 offset:4352
L_lw_52:
    s_waitcnt lgkmcnt(0)
    s_cmp_lg_u32 s44, 0
    s_cbranch_scc1 L_v_probe_53
    s_add_u32 s45, s63, 8192
    s_memtime s[72:73]
    s_waitcnt lgkmcnt(0)
    s_load_dword s78, s[20:21], s45
    s_waitcnt lgkmcnt(0)
    s_memtime s[74:75]
    s_waitcnt lgkmcnt(0)
    s_sub_u32 s45, s74, s72
    s_min_u32 s77, s77, s45
    s_cmp_lt_u32 s77, s76
    s_cselect_b32 s68, 1, 0
L_v_probe_53:
    s_waitcnt vmcnt(32)
    s_barrier
    s_add_u32 s51, s69, 5
    s_and_b32 s51, s51, 7
    s_lshl_b32 s51, s51, 17
    s_add_u32 s51, s51, s49
    s_add_u32 s46, s51, 0x4000
    s_add_u32 m0, s65, 69632
    s_nop 0
    buffer_load_dwordx4 v70, s[36:39], s46 offen  lds
    s_add_u32 s46, s51, 0xc000
    s_add_u32 m0, s65, 70656
    s_nop 0
    buffer_load_dwordx4 v71, s[36:39], s46 offen  lds
    s_add_u32 s46, s51, 0x14000
    s_add_u32 m0, s65, 71680
    s_nop 0
    buffer_load_dwordx4 v72, s[36:39], s46 offen  lds
    s_add_u32 s46, s51, 0x1c000
    s_add_u32 m0, s65, 72704
    s_nop 0
    buffer_load_dwordx4 v73, s[36:39], s46 offen  lds
    ds_read_b64_tr_b16 a[192:193], v88 offset:8192
    ds_read_b64_tr_b16 a[194:195], v88 offset:8448
    ds_read_b64_tr_b16 a[200:201], v89 offset:8192
    ds_read_b64_tr_b16 a[202:203], v89 offset:8448
    ds_read_b64_tr_b16 a[208:209], v90 offset:8192
    ds_read_b64_tr_b16 a[210:211], v90 offset:8448
    ds_read_b64_tr_b16 a[216:217], v91 offset:8192
    ds_read_b64_tr_b16 a[218:219], v91 offset:8448
L_lw_54:
    s_waitcnt lgkmcnt(0)
    s_cmp_lg_u32 s44, 0
    s_cbranch_scc1 L_v_probe_55
    s_add_u32 s45, s63, 128
    s_memtime s[72:73]
    s_waitcnt lgkmcnt(0)
    s_load_dword s78, s[20:21], s45
    s_waitcnt lgkmcnt(0)
    s_memtime s[74:75]
    s_waitcnt lgkmcnt(0)
    s_sub_u32 s45, s74, s72
    s_min_u32 s76, s76, s45
    s_cmp_lt_u32 s77, s76
    s_cselect_b32 s68, 1, 0
L_v_probe_55:
    s_waitcnt vmcnt(32)
    s_barrier
    s_add_u32 s51, s69, 6
    s_and_b32 s51, s51, 7
    s_lshl_b32 s51, s51, 17
    s_add_u32 s51, s51, s49
    s_add_u32 s46, s51, 0x0
    s_add_u32 m0, s65, 73728
    s_nop 0
    buffer_load_dwordx4 v70, s[36:39], s46 offen  lds
    s_add_u32 s46, s51, 0x8000
    s_add_u32 m0, s65, 74752
    s_nop 0
    buffer_load_dwordx4 v71, s[36:39], s46 offen  lds
    s_add_u32 s46, s51, 0x10000
    s_add_u32 m0, s65, 75776
    s_nop 0
    buffer_load_dwordx4 v72, s[36:39], s46 offen  lds
    s_add_u32 s46, s51, 0x18000
    s_add_u32 m0, s65, 76800
    s_nop 0
    buffer_load_dwordx4 v73, s[36:39], s46 offen  lds
    ds_read_b64_tr_b16 a[196:197], v88 offset:12288
    ds_read_b64_tr_b16 a[198:199], v88 offset:12544
    ds_read_b64_tr_b16 a[204:205], v89 offset:12288
    ds_read_b64_tr_b16 a[206:207], v89 offset:12544
    ds_read_b64_tr_b16 a[212:213], v90 offset:12288
    ds_read_b64_tr_b16 a[214:215], v90 offset:12544
    ds_read_b64_tr_b16 a[220:221], v91 offset:12288
    ds_read_b64_tr_b16 a[222:223], v91 offset:12544
L_lw_56:
    s_waitcnt lgkmcnt(0)
    s_cmp_lg_u32 s44, 0
    s_cbranch_scc1 L_v_probe_57
    s_add_u32 s45, s63, 8320
    s_memtime s[72:73]
    s_waitcnt lgkmcnt(0)
    s_load_dword s78, s[20:21], s45
    s_waitcnt lgkmcnt(0)
    s_memtime s[74:75]
    s_waitcnt lgkmcnt(0)
    s_sub_u32 s45, s74, s72
    s_min_u32 s77, s77, s45
    s_cmp_lt_u32 s77, s76
    s_cselect_b32 s68, 1, 0
L_v_probe_57:
    s_waitcnt vmcnt(32)
    s_barrier
    s_add_u32 s51, s69, 6
    s_and_b32 s51, s51, 7
    s_lshl_b32 s51, s51, 17
    s_add_u32 s51, s51, s49
    s_add_u32 s46, s51, 0x4000
    s_add_u32 m0, s65, 77824
    s_nop 0
    buffer_load_dwordx4 v70, s[36:39], s46 offen  lds
    s_add_u32 s46, s51, 0xc000
    s_add_u32 m0, s65, 78848
    s_nop 0
    buffer_load_dwordx4 v71, s[36:39], s46 offen  lds
    s_add_u32 s46, s51, 0x14000
    s_add_u32 m0, s65, 79872
    s_nop 0
    buffer_load_dwordx4 v72, s[36:39], s46 offen  lds
    s_add_u32 s46, s51, 0x1c000
    s_add_u32 m0, s65, 80896
    s_nop 0
    buffer_load_dwordx4 v73, s[36:39], s46 offen  lds
    ds_read_b64_tr_b16 a[224:225], v88 offset:16384
    ds_read_b64_tr_b16 a[226:227], v88 offset:16640
    ds_read_b64_tr_b16 a[232:233], v89 offset:16384
    ds_read_b64_tr_b16 a[234:235], v89 offset:16640
    ds_read_b64_tr_b16 a[240:241], v90 offset:16384
    ds_read_b64_tr_b16 a[242:243], v90 offset:16640
    ds_read_b64_tr_b16 a[248:249], v91 offset:16384
    ds_read_b64_tr_b16 a[250:251], v91 offset:16640
L_lw_58:
    s_waitcnt lgkmcnt(0)
    s_cmp_lg_u32 s44, 0
    s_cbranch_scc1 L_v_probe_59
    s_add_u32 s45, s63, 256
    s_memtime s[72:73]
    s_waitcnt lgkmcnt(0)
    s_load_dword s78, s[20:21], s45
    s_waitcnt lgkmcnt(0)
    s_memtime s[74:75]
    s_waitcnt lgkmcnt(0)
    s_sub_u32 s45, s74, s72
    s_min_u32 s76, s76, s45
    s_cmp_lt_u32 s77, s76
    s_cselect_b32 s68, 1, 0
L_v_probe_59:
    s_waitcnt vmcnt(32)
    s_barrier
    s_add_u32 s51, s69, 7
    s_and_b32 s51, s51, 7
    s_lshl_b32 s51, s51, 17
    s_add_u32 s51, s51, s49
    s_add_u32 s46, s51, 0x0
    s_add_u32 m0, s65, 81920
    s_nop 0
    buffer_load_dwordx4 v70, s[36:39], s46 offen  lds
    s_add_u32 s46, s51, 0x8000
    s_add_u32 m0, s65, 82944
    s_nop 0
    buffer_load_dwordx4 v71, s[36:39], s46 offen  lds
    s_add_u32 s46, s51, 0x10000
    s_add_u32 m0, s65, 83968
    s_nop 0
    buffer_load_dwordx4 v72, s[36:39], s46 offen  lds
    s_add_u32 s46, s51, 0x18000
    s_add_u32 m0, s65, 84992
    s_nop 0
    buffer_load_dwordx4 v73, s[36:39], s46 offen  lds
    ds_read_b64_tr_b16 a[228:229], v88 offset:20480
    ds_read_b64_tr_b16 a[230:231], v88 offset:20736
    ds_read_b64_tr_b16 a[236:237], v89 offset:20480
    ds_read_b64_tr_b16 a[238:239], v89 offset:20736
    ds_read_b64_tr_b16 a[244:245], v90 offset:20480
    ds_read_b64_tr_b16 a[246:247], v90 offset:20736
    ds_read_b64_tr_b16 a[252:253], v91 offset:20480
    ds_read_b64_tr_b16 a[254:255], v91 offset:20736
L_lw_60:
    s_waitcnt lgkmcnt(0)
    s_cmp_lg_u32 s44, 0
    s_cbranch_scc1 L_v_probe_61
    s_add_u32 s45, s63, 8448
    s_memtime s[72:73]
    s_waitcnt lgkmcnt(0)
    s_load_dword s78, s[20:21], s45
    s_waitcnt lgkmcnt(0)
    s_memtime s[74:75]
    s_waitcnt lgkmcnt(0)
    s_sub_u32 s45, s74, s72
    s_min_u32 s77, s77, s45
    s_cmp_lt_u32 s77, s76
    s_cselect_b32 s68, 1, 0
L_v_probe_61:
    s_waitcnt vmcnt(32)
    s_barrier
    s_add_u32 s51, s69, 7
    s_and_b32 s51, s51, 7
    s_lshl_b32 s51, s51, 17
    s_add_u32 s51, s51, s49
    s_add_u32 s46, s51, 0x4000
    s_add_u32 m0, s65, 86016
    s_nop 0
    buffer_load_dwordx4 v70, s[36:39], s46 offen  lds
    s_add_u32 s46, s51, 0xc000
    s_add_u32 m0, s65, 87040
    s_nop 0
    buffer_load_dwordx4 v71, s[36:39], s46 offen  lds
    s_add_u32 s46, s51, 0x14000
    s_add_u32 m0, s65, 88064
    s_nop 0
    buffer_load_dwordx4 v72, s[36:39], s46 offen  lds
    s_add_u32 s46, s51, 0x1c000
    s_add_u32 m0, s65, 89088
    s_nop 0
    buffer_load_dwordx4 v73, s[36:39], s46 offen  lds
    ds_read_b64_tr_b16 v[96:97], v74 offset:0
    ds_read_b64_tr_b16 v[98:99], v74 offset:256
    ds_read_b64_tr_b16 v[104:105], v75 offset:0
    ds_read_b64_tr_b16 v[106:107], v75 offset:256
    ds_read_b64_tr_b16 v[112:113], v76 offset:0
    ds_read_b64_tr_b16 v[114:115], v76 offset:256
    ds_read_b64_tr_b16 v[120:121], v77 offset:0
    ds_read_b64_tr_b16 v[122:123], v77 offset:256
L_lw_62:
    s_waitcnt lgkmcnt(0)
    s_cmp_lg_u32 s44, 0
    s_cbranch_scc1 L_v_probe_63
    s_add_u32 s45, s63, 384
    s_memtime s[72:73]
    s_waitcnt lgkmcnt(0)
    s_load_dword s78, s[20:21], s45
    s_waitcnt lgkmcnt(0)
    s_memtime s[74:75]
    s_waitcnt lgkmcnt(0)
    s_sub_u32 s45, s74, s72
    s_min_u32 s76, s76, s45
    s_cmp_lt_u32 s77, s76
    s_cselect_b32 s68, 1, 0
L_v_probe_63:
    s_waitcnt vmcnt(32)
    s_barrier
    s_add_u32 s79, s41, 0
    s_and_b32 s79, s79, 3
    s_lshl_b32 s79, s79, 19
    s_add_u32 s79, s79, s47
    s_add_u32 s46, s79, 0x0
    s_add_u32 m0, s48, 0
    s_nop 0
    buffer_load_dwordx4 v82, s[32:35], s46 offen  lds
    s_add_u32 s46, s79, 0x20000
    s_add_u32 m0, s48, 4096
    s_nop 0
    buffer_load_dwordx4 v82, s[32:35], s46 offen  lds
    s_add_u32 s46, s79, 0x40000
    s_add_u32 m0, s48, 8192
    s_nop 0
    buffer_load_dwordx4 v82, s[32:35], s46 offen  lds
    s_add_u32 s46, s79, 0x60000
    s_add_u32 m0, s48, 12288
    s_nop 0
    buffer_load_dwordx4 v82, s[32:35], s46 offen  lds
    ds_read_b64_tr_b16 v[100:101], v74 offset:16384
    ds_read_b64_tr_b16 v[102:103], v74 offset:16640
    ds_read_b64_tr_b16 v[108:109], v75 offset:16384
    ds_read_b64_tr_b16 v[110:111], v75 offset:16640
    ds_read_b64_tr_b16 v[116:117], v76 offset:16384
    ds_read_b64_tr_b16 v[118:119], v76 offset:16640
    ds_read_b64_tr_b16 v[124:125], v77 offset:16384
    ds_read_b64_tr_b16 v[126:127], v77 offset:16640
L_lw_64:
    s_waitcnt lgkmcnt(0)
    s_cmp_lg_u32 s44, 0
    s_cbranch_scc1 L_v_probe_65
    s_add_u32 s45, s63, 8576
    s_memtime s[72:73]
    s_waitcnt lgkmcnt(0)
    s_load_dword s78, s[20:21], s45
    s_waitcnt lgkmcnt(0)
    s_memtime s[74:75]
    s_waitcnt lgkmcnt(0)
    s_sub_u32 s45, s74, s72
    s_min_u32 s77, s77, s45
    s_cmp_lt_u32 s77, s76
    s_cselect_b32 s68, 1, 0
L_v_probe_65:
    s_waitcnt vmcnt(32)
    s_barrier
    s_add_u32 s79, s41, 1
    s_and_b32 s79, s79, 3
    s_lshl_b32 s79, s79, 19
    s_add_u32 s79, s79, s47
    s_add_u32 s46, s79, 0x0
    s_add_u32 m0, s48, 16384
    s_nop 0
    buffer_load_dwordx4 v82, s[32:35], s46 offen  lds
    s_add_u32 s46, s79, 0x20000
    s_add_u32 m0, s48, 20480
    s_nop 0
    buffer_load_dwordx4 v82, s[32:35], s46 offen  lds
    s_add_u32 s46, s79, 0x40000
    s_add_u32 m0, s48, 24576
    s_nop 0
    buffer_load_dwordx4 v82, s[32:35], s46 offen  lds
    s_add_u32 s46, s79, 0x60000
    s_add_u32 m0, s48, 28672
    s_nop 0
    buffer_load_dwordx4 v82, s[32:35], s46 offen  lds
    ds_read_b64_tr_b16 v[128:129], v74 offset:32768
    ds_read_b64_tr_b16 v[130:131], v74 offset:33024
    ds_read_b64_tr_b16 v[136:137], v75 offset:32768
    ds_read_b64_tr_b16 v[138:139], v75 offset:33024
    ds_read_b64_tr_b16 v[144:145], v76 offset:32768
    ds_read_b64_tr_b16 v[146:147], v76 offset:33024
    ds_read_b64_tr_b16 v[152:153], v77 offset:32768
    ds_read_b64_tr_b16 v[154:155], v77 offset:33024
L_lw_66:
    s_waitcnt lgkmcnt(0)
    s_cmp_lg_u32 s44, 0
    s_cbranch_scc1 L_v_probe_67
    s_add_u32 s45, s63, 512
    s_memtime s[72:73]
    s_waitcnt lgkmcnt(0)
    s_load_dword s78, s[20:21], s45
    s_waitcnt lgkmcnt(0)
    s_memtime s[74:75]
    s_waitcnt lgkmcnt(0)
    s_sub_u32 s45, s74, s72
    s_min_u32 s76, s76, s45
    s_cmp_lt_u32 s77, s76
    s_cselect_b32 s68, 1, 0
L_v_probe_67:
    s_waitcnt vmcnt(32)
    s_barrier
    s_add_u32 s79, s41, 2
    s_and_b32 s79, s79, 3
    s_lshl_b32 s79, s79, 19
    s_add_u32 s79, s79, s47
    s_add_u32 s46, s79, 0x0
    s_add_u32 m0, s48, 32768
    s_nop 0
    buffer_load_dwordx4 v82, s[32:35], s46 offen  lds
    s_add_u32 s46, s79, 0x20000
    s_add_u32 m0, s48, 36864
    s_nop 0
    buffer_load_dwordx4 v82, s[32:35], s46 offen  lds
    s_add_u32 s46, s79, 0x40000
    s_add_u32 m0, s48, 40960
    s_nop 0
    buffer_load_dwordx4 v82, s[32:35], s46 offen  lds
    s_add_u32 s46, s79, 0x60000
    s_add_u32 m0, s48, 45056
    s_nop 0
    buffer_load_dwordx4 v82, s[32:35], s46 offen  lds
    ds_read_b64_tr_b16 v[132:133], v74 offset:49152
    ds_read_b64_tr_b16 v[134:135], v74 offset:49408
    ds_read_b64_tr_b16 v[140:141], v75 offset:49152
    ds_read_b64_tr_b16 v[142:143], v75 offset:49408
    ds_read_b64_tr_b16 v[148:149], v76 offset:49152
    ds_read_b64_tr_b16 v[150:151], v76 offset:49408
    ds_read_b64_tr_b16 v[156:157], v77 offset:49152
    ds_read_b64_tr_b16 v[158:159], v77 offset:49408
L_lw_68:
    s_waitcnt lgkmcnt(0)
    s_cmp_lg_u32 s44, 0
    s_cbranch_scc1 L_v_probe_69
    s_add_u32 s45, s63, 8704
    s_memtime s[72:73]
    s_waitcnt lgkmcnt(0)
    s_load_dword s78, s[20:21], s45
    s_waitcnt lgkmcnt(0)
    s_memtime s[74:75]
    s_waitcnt lgkmcnt(0)
    s_sub_u32 s45, s74, s72
    s_min_u32 s77, s77, s45
    s_cmp_lt_u32 s77, s76
    s_cselect_b32 s68, 1, 0
L_v_probe_69:
    s_waitcnt vmcnt(32)
    s_barrier
    s_add_u32 s79, s41, 3
    s_and_b32 s79, s79, 3
    s_lshl_b32 s79, s79, 19
    s_add_u32 s79, s79, s47
    s_add_u32 s46, s79, 0x0
    s_add_u32 m0, s48, 49152
    s_nop 0
    buffer_load_dwordx4 v82, s[32:35], s46 offen  lds
    s_add_u32 s46, s79, 0x20000
    s_add_u32 m0, s48, 53248
    s_nop 0
    buffer_load_dwordx4 v82, s[32:35], s46 offen  lds
    s_add_u32 s46, s79, 0x40000
    s_add_u32 m0, s48, 57344
    s_nop 0
    buffer_load_dwordx4 v82, s[32:35], s46 offen  lds
    s_add_u32 s46, s79, 0x60000
    s_add_u32 m0, s48, 61440
    s_nop 0
    buffer_load_dwordx4 v82, s[32:35], s46 offen  lds
    ds_read_b64_tr_b16 v[160:161], v88 offset:0
    ds_read_b64_tr_b16 v[162:163], v88 offset:256
    ds_read_b64_tr_b16 v[168:169], v89 offset:0
    ds_read_b64_tr_b16 v[170:171], v89 offset:256
    ds_read_b64_tr_b16 v[176:177], v90 offset:0
    ds_read_b64_tr_b16 v[178:179], v90 offset:256
    ds_read_b64_tr_b16 v[184:185], v91 offset:0
    ds_read_b64_tr_b16 v[186:187], v91 offset:256
L_lw_70:
    s_waitcnt lgkmcnt(0)
    s_waitcnt vmcnt(32)
    s_barrier
    s_cmp_lg_u32 s44, 0
    s_cbranch_scc1 L_hs_71
    s_getreg_b32 s45, hwreg(HW_REG_XCC_ID)
    s_and_b32 s45, s45, 15
    s_mul_i32 s46, s45, s45
    s_lshl_b32 s46, s46, 9
    s_add_u32 s45, s45, s46
    s_cmp_eq_u32 s40, 0
    s_cselect_b32 s46, s45, 0
    s_cselect_b32 s45, 0, s45
    s_lshl_b32 s68, s68, 24
    s_add_u32 s46, s46, s68
    s_add_u32 s45, s45, 16777216
    v_mov_b32 v40, s46
    v_mov_b32 v41, s45
    v_mov_b32 v42, 0
    s_mov_b64 exec, 1
    buffer_atomic_add_x2 v[40:41], v42, s[16:19], 0 offen sc1
    s_mov_b64 exec, -1
L_hs_71:
    ds_read_b64_tr_b16 v[164:165], v88 offset:4096
    ds_read_b64_tr_b16 v[166:167], v88 offset:4352
    ds_read_b64_tr_b16 v[172:173], v89 offset:4096
    ds_read_b64_tr_b16 v[174:175], v89 offset:4352
    ds_read_b64_tr_b16 v[180:181], v90 offset:4096
    ds_read_b64_tr_b16 v[182:183], v90 offset:4352
    ds_read_b64_tr_b16 v[188:189], v91 offset:4096
    ds_read_b64_tr_b16 v[190:191], v91 offset:4352
L_lw_72:
    s_waitcnt lgkmcnt(0)
    s_waitcnt vmcnt(28)
    s_barrier
    ds_read_b64_tr_b16 v[192:193], v88 offset:8192
    ds_read_b64_tr_b16 v[194:195], v88 offset:8448
    ds_read_b64_tr_b16 v[200:201], v89 offset:8192
    ds_read_b64_tr_b16 v[202:203], v89 offset:8448
    ds_read_b64_tr_b16 v[208:209], v90 offset:8192
    ds_read_b64_tr_b16 v[210:211], v90 offset:8448
    ds_read_b64_tr_b16 v[216:217], v91 offset:8192
    ds_read_b64_tr_b16 v[218:219], v91 offset:8448
L_lw_73:
    s_waitcnt lgkmcnt(0)
    s_waitcnt vmcnt(24)
    s_barrier
    ds_read_b64_tr_b16 v[196:197], v88 offset:12288
    ds_read_b64_tr_b16 v[198:199], v88 offset:12544
    ds_read_b64_tr_b16 v[204:205], v89 offset:12288
    ds_read_b64_tr_b16 v[206:207], v89 offset:12544
    ds_read_b64_tr_b16 v[212:213], v90 offset:12288
    ds_read_b64_tr_b16 v[214:215], v90 offset:12544
    ds_read_b64_tr_b16 v[220:221], v91 offset:12288
    ds_read_b64_tr_b16 v[222:223], v91 offset:12544
L_lw_74:
    s_waitcnt lgkmcnt(0)
    s_waitcnt vmcnt(20)
    s_barrier
    ds_read_b64_tr_b16 v[224:225], v88 offset:16384
    ds_read_b64_tr_b16 v[226:227], v88 offset:16640
    ds_read_b64_tr_b16 v[232:233], v89 offset:16384
    ds_read_b64_tr_b16 v[234:235], v89 offset:16640
    ds_read_b64_tr_b16 v[240:241], v90 offset:16384
    ds_read_b64_tr_b16 v[242:243], v90 offset:16640
    ds_read_b64_tr_b16 v[248:249], v91 offset:16384
    ds_read_b64_tr_b16 v[250:251], v91 offset:16640
L_lw_75:
    s_waitcnt lgkmcnt(0)
    s_waitcnt vmcnt(16)
    s_barrier
    ds_read_b64_tr_b16 v[228:229], v88 offset:20480
    ds_read_b64_tr_b16 v[230:231], v88 offset:20736
    ds_read_b64_tr_b16 v[236:237], v89 offset:20480
    ds_read_b64_tr_b16 v[238:239], v89 offset:20736
    ds_read_b64_tr_b16 v[244:245], v90 offset:20480
    ds_read_b64_tr_b16 v[246:247], v90 offset:20736
    ds_read_b64_tr_b16 v[252:253], v91 offset:20480
    ds_read_b64_tr_b16 v[254:255], v91 offset:20736
L_lw_76:
    s_waitcnt lgkmcnt(0)
    s_waitcnt vmcnt(12)
    s_barrier
    s_cmp_lg_u32 s44, 0
    s_cbranch_scc1 L_lw_77_0
    ds_read_b64_tr_b16 a[0:1], v80 offset:0
    ds_read_b64_tr_b16 a[2:3], v80 offset:1024
    ds_read_b64_tr_b16 a[4:5], v80 offset:8192
    ds_read_b64_tr_b16 a[6:7], v80 offset:9216
    ds_read_b64_tr_b16 a[8:9], v81 offset:0
    ds_read_b64_tr_b16 a[10:11], v81 offset:1024
    ds_read_b64_tr_b16 a[12:13], v81 offset:8192
    ds_read_b64_tr_b16 a[14:15], v81 offset:9216
    s_branch L_lw_77
L_lw_77_0:
    s_cmp_lg_u32 s44, 1
    s_cbranch_scc1 L_lw_77_1
    ds_read_b64_tr_b16 a[120:121], v80 offset:0
    ds_read_b64_tr_b16 a[122:123], v80 offset:1024
    ds_read_b64_tr_b16 a[124:125], v80 offset:8192
    ds_read_b64_tr_b16 a[126:127], v80 offset:9216
    ds_read_b64_tr_b16 v[56:57], v81 offset:0
    ds_read_b64_tr_b16 v[58:59], v81 offset:1024
    ds_read_b64_tr_b16 v[60:61], v81 offset:8192
    ds_read_b64_tr_b16 v[62:63], v81 offset:9216
    s_waitcnt lgkmcnt(0)
    ds_write_b128 v5, v[56:59] offset:0
    ds_write_b128 v5, v[60:63] offset:1024
    s_branch L_lw_77
L_lw_77_1:
    s_cmp_lg_u32 s44, 2
    s_cbranch_scc1 L_lw_77_2
    ds_read_b64_tr_b16 a[80:81], v80 offset:0
    ds_read_b64_tr_b16 a[82:83], v80 offset:1024
    ds_read_b64_tr_b16 a[84:85], v80 offset:8192
    ds_read_b64_tr_b16 a[86:87], v80 offset:9216
    ds_read_b64_tr_b16 v[56:57], v81 offset:0
    ds_read_b64_tr_b16 v[58:59], v81 offset:1024
    ds_read_b64_tr_b16 v[60:61], v81 offset:8192
    ds_read_b64_tr_b16 v[62:63], v81 offset:9216
    s_waitcnt lgkmcnt(0)
    ds_write_b128 v5, v[56:59] offset:2048
    ds_write_b128 v5, v[60:63] offset:3072
    s_branch L_lw_77
L_lw_77_2:
    ds_read_b64_tr_b16 a[48:49], v80 offset:0
    ds_read_b64_tr_b16 a[50:51], v80 offset:1024
    ds_read_b64_tr_b16 a[52:53], v80 offset:8192
    ds_read_b64_tr_b16 a[54:55], v80 offset:9216
    ds_read_b64_tr_b16 v[56:57], v81 offset:0
    ds_read_b64_tr_b16 v[58:59], v81 offset:1024
    ds_read_b64_tr_b16 v[60:61], v81 offset:8192
    ds_read_b64_tr_b16 v[62:63], v81 offset:9216
    s_waitcnt lgkmcnt(0)
    ds_write_b128 v5, v[56:59] offset:4096
    ds_write_b128 v5, v[60:63] offset:5120
L_lw_77:
    s_waitcnt lgkmcnt(0)
    s_waitcnt vmcnt(8)
    s_barrier
    s_add_u32 s79, s41, 4
    s_and_b32 s79, s79, 3
    s_lshl_b32 s79, s79, 19
    s_add_u32 s79, s79, s47
    s_add_u32 s46, s79, 0x200000
    s_add_u32 m0, s48, 0
    s_nop 0
    buffer_load_dwordx4 v82, s[32:35], s46 offen  lds
    s_add_u32 s46, s79, 0x220000
    s_add_u32 m0, s48, 4096
    s_nop 0
    buffer_load_dwordx4 v82, s[32:35], s46 offen  lds
    s_add_u32 s46, s79, 0x240000
    s_add_u32 m0, s48, 8192
    s_nop 0
    buffer_load_dwordx4 v82, s[32:35], s46 offen  lds
    s_add_u32 s46, s79, 0x260000
    s_add_u32 m0, s48, 12288
    s_nop 0
    buffer_load_dwordx4 v82, s[32:35], s46 offen  lds
    s_cmp_lg_u32 s44, 0
    s_cbranch_scc1 L_lw_78_0
    ds_read_b64_tr_b16 a[16:17], v80 offset:16384
    ds_read_b64_tr_b16 a[18:19], v80 offset:17408
    ds_read_b64_tr_b16 a[20:21], v80 offset:24576
    ds_read_b64_tr_b16 a[22:23], v80 offset:25600
    ds_read_b64_tr_b16 a[24:25], v81 offset:16384
    ds_read_b64_tr_b16 a[26:27], v81 offset:17408
    ds_read_b64_tr_b16 a[28:29], v81 offset:24576
    ds_read_b64_tr_b16 a[30:31], v81 offset:25600
    s_branch L_lw_78
L_lw_78_0:
    s_cmp_lg_u32 s44, 1
    s_cbranch_scc1 L_lw_78_1
    ds_read_b64_tr_b16 a[128:129], v80 offset:16384
    ds_read_b64_tr_b16 a[130:131], v80 offset:17408
    ds_read_b64_tr_b16 a[132:133], v80 offset:24576
    ds_read_b64_tr_b16 a[134:135], v80 offset:25600
    ds_read_b64_tr_b16 a[136:137], v81 offset:16384
    ds_read_b64_tr_b16 a[138:139], v81 offset:17408
    ds_read_b64_tr_b16 a[140:141], v81 offset:24576
    ds_read_b64_tr_b16 a[142:143], v81 offset:25600
    s_branch L_lw_78
L_lw_78_1:
    s_cmp_lg_u32 s44, 2
    s_cbranch_scc1 L_lw_78_2
    ds_read_b64_tr_b16 a[88:89], v80 offset:16384
    ds_read_b64_tr_b16 a[90:91], v80 offset:17408
    ds_read_b64_tr_b16 a[92:93], v80 offset:24576
    ds_read_b64_tr_b16 a[94:95], v80 offset:25600
    ds_read_b64_tr_b16 a[96:97], v81 offset:16384
    ds_read_b64_tr_b16 a[98:99], v81 offset:17408
    ds_read_b64_tr_b16 a[100:101], v81 offset:24576
    ds_read_b64_tr_b16 a[102:103], v81 offset:25600
    s_branch L_lw_78
L_lw_78_2:
    ds_read_b64_tr_b16 a[56:57], v80 offset:16384
    ds_read_b64_tr_b16 a[58:59], v80 offset:17408
    ds_read_b64_tr_b16 a[60:61], v80 offset:24576
    ds_read_b64_tr_b16 a[62:63], v80 offset:25600
    ds_read_b64_tr_b16 v[56:57], v81 offset:16384
    ds_read_b64_tr_b16 v[58:59], v81 offset:17408
    ds_read_b64_tr_b16 v[60:61], v81 offset:24576
    ds_read_b64_tr_b16 v[62:63], v81 offset:25600
    s_waitcnt lgkmcnt(0)
    ds_write_b128 v5, v[56:59] offset:6144
    ds_write_b128 v5, v[60:63] offset:7168
L_lw_78:
    s_waitcnt lgkmcnt(0)
    s_waitcnt vmcnt(8)
    s_barrier
    s_add_u32 s79, s41, 5
    s_and_b32 s79, s79, 3
    s_lshl_b32 s79, s79, 19
    s_add_u32 s79, s79, s47
    s_add_u32 s46, s79, 0x200000
    s_add_u32 m0, s48, 16384
    s_nop 0
    buffer_load_dwordx4 v82, s[32:35], s46 offen  lds
    s_add_u32 s46, s79, 0x220000
    s_add_u32 m0, s48, 20480
    s_nop 0
    buffer_load_dwordx4 v82, s[32:35], s46 offen  lds
    s_add_u32 s46, s79, 0x240000
    s_add_u32 m0, s48, 24576
    s_nop 0
    buffer_load_dwordx4 v82, s[32:35], s46 offen  lds
    s_add_u32 s46, s79, 0x260000
    s_add_u32 m0, s48, 28672
    s_nop 0
    buffer_load_dwordx4 v82, s[32:35], s46 offen  lds
    s_cmp_lg_u32 s44, 0
    s_cbranch_scc1 L_lw_79_0
    ds_read_b64_tr_b16 a[32:33], v80 offset:32768
    ds_read_b64_tr_b16 a[34:35], v80 offset:33792
    ds_read_b64_tr_b16 a[36:37], v80 offset:40960
    ds_read_b64_tr_b16 a[38:39], v80 offset:41984
    ds_read_b64_tr_b16 v[56:57], v81 offset:32768
    ds_read_b64_tr_b16 v[58:59], v81 offset:33792
    ds_read_b64_tr_b16 v[60:61], v81 offset:40960
    ds_read_b64_tr_b16 v[62:63], v81 offset:41984
    s_waitcnt lgkmcnt(0)
    ds_write_b128 v5, v[56:59] offset:8192
    ds_write_b128 v5, v[60:63] offset:9216
    s_branch L_lw_79
L_lw_79_0:
    s_cmp_lg_u32 s44, 1
    s_cbranch_scc1 L_lw_79_1
    ds_read_b64_tr_b16 a[144:145], v80 offset:32768
    ds_read_b64_tr_b16 a[146:147], v80 offset:33792
    ds_read_b64_tr_b16 a[148:149], v80 offset:40960
    ds_read_b64_tr_b16 a[150:151], v80 offset:41984
    ds_read_b64_tr_b16 v[56:57], v81 offset:32768
    ds_read_b64_tr_b16 v[58:59], v81 offset:33792
    ds_read_b64_tr_b16 v[60:61], v81 offset:40960
    ds_read_b64_tr_b16 v[62:63], v81 offset:41984
    s_waitcnt lgkmcnt(0)
    ds_write_b128 v5, v[56:59] offset:10240
    ds_write_b128 v5, v[60:63] offset:11264
    s_branch L_lw_79
L_lw_79_1:
    s_cmp_lg_u32 s44, 2
    s_cbranch_scc1 L_lw_79_2
    ds_read_b64_tr_b16 a[104:105], v80 offset:32768
    ds_read_b64_tr_b16 a[106:107], v80 offset:33792
    ds_read_b64_tr_b16 a[108:109], v80 offset:40960
    ds_read_b64_tr_b16 a[110:111], v80 offset:41984
    ds_read_b64_tr_b16 v[56:57], v81 offset:32768
    ds_read_b64_tr_b16 v[58:59], v81 offset:33792
    ds_read_b64_tr_b16 v[60:61], v81 offset:40960
    ds_read_b64_tr_b16 v[62:63], v81 offset:41984
    s_waitcnt lgkmcnt(0)
    ds_write_b128 v5, v[56:59] offset:12288
    ds_write_b128 v5, v[60:63] offset:13312
    s_branch L_lw_79
L_lw_79_2:
    ds_read_b64_tr_b16 a[64:65], v80 offset:32768
    ds_read_b64_tr_b16 a[66:67], v80 offset:33792
    ds_read_b64_tr_b16 a[68:69], v80 offset:40960
    ds_read_b64_tr_b16 a[70:71], v80 offset:41984
    ds_read_b64_tr_b16 v[56:57], v81 offset:32768
    ds_read_b64_tr_b16 v[58:59], v81 offset:33792
    ds_read_b64_tr_b16 v[60:61], v81 offset:40960
    ds_read_b64_tr_b16 v[62:63], v81 offset:41984
    s_waitcnt lgkmcnt(0)
    ds_write_b128 v5, v[56:59] offset:14336
    ds_write_b128 v5, v[60:63] offset:15360
L_lw_79:
    s_waitcnt lgkmcnt(0)
    s_waitcnt vmcnt(8)
    s_barrier
    s_add_u32 s79, s41, 6
    s_and_b32 s79, s79, 3
    s_lshl_b32 s79, s79, 19
    s_add_u32 s79, s79, s47
    s_add_u32 s46, s79, 0x200000
    s_add_u32 m0, s48, 32768
    s_nop 0
    buffer_load_dwordx4 v82, s[32:35], s46 offen  lds
    s_add_u32 s46, s79, 0x220000
    s_add_u32 m0, s48, 36864
    s_nop 0
    buffer_load_dwordx4 v82, s[32:35], s46 offen  lds
    s_add_u32 s46, s79, 0x240000
    s_add_u32 m0, s48, 40960
    s_nop 0
    buffer_load_dwordx4 v82, s[32:35], s46 offen  lds
    s_add_u32 s46, s79, 0x260000
    s_add_u32 m0, s48, 45056
    s_nop 0
    buffer_load_dwordx4 v82, s[32:35], s46 offen  lds
    s_cmp_lg_u32 s44, 0
    s_cbranch_scc1 L_lw_80_0
    ds_read_b64_tr_b16 a[40:41], v80 offset:49152
    ds_read_b64_tr_b16 a[42:43], v80 offset:50176
    ds_read_b64_tr_b16 a[44:45], v80 offset:57344
    ds_read_b64_tr_b16 a[46:47], v80 offset:58368
    ds_read_b64_tr_b16 v[56:57], v81 offset:49152
    ds_read_b64_tr_b16 v[58:59], v81 offset:50176
    ds_read_b64_tr_b16 v[60:61], v81 offset:57344
    ds_read_b64_tr_b16 v[62:63], v81 offset:58368
    s_waitcnt lgkmcnt(0)
    ds_write_b128 v5, v[56:59] offset:16384
    ds_write_b128 v5, v[60:63] offset:17408
    s_branch L_lw_80
L_lw_80_0:
    s_cmp_lg_u32 s44, 1
    s_cbranch_scc1 L_lw_80_1
    ds_read_b64_tr_b16 a[152:153], v80 offset:49152
    ds_read_b64_tr_b16 a[154:155], v80 offset:50176
    ds_read_b64_tr_b16 a[156:157], v80 offset:57344
    ds_read_b64_tr_b16 a[158:159], v80 offset:58368
    ds_read_b64_tr_b16 v[56:57], v81 offset:49152
    ds_read_b64_tr_b16 v[58:59], v81 offset:50176
    ds_read_b64_tr_b16 v[60:61], v81 offset:57344
    ds_read_b64_tr_b16 v[62:63], v81 offset:58368
    s_waitcnt lgkmcnt(0)
    ds_write_b128 v5, v[56:59] offset:18432
    ds_write_b128 v5, v[60:63] offset:19456
    s_branch L_lw_80
L_lw_80_1:
    s_cmp_lg_u32 s44, 2
    s_cbranch_scc1 L_lw_80_2
    ds_read_b64_tr_b16 a[112:113], v80 offset:49152
    ds_read_b64_tr_b16 a[114:115], v80 offset:50176
    ds_read_b64_tr_b16 a[116:117], v80 offset:57344
    ds_read_b64_tr_b16 a[118:119], v80 offset:58368
    ds_read_b64_tr_b16 v[56:57], v81 offset:49152
    ds_read_b64_tr_b16 v[58:59], v81 offset:50176
    ds_read_b64_tr_b16 v[60:61], v81 offset:57344
    ds_read_b64_tr_b16 v[62:63], v81 offset:58368
    s_waitcnt lgkmcnt(0)
    ds_write_b128 v5, v[56:59] offset:20480
    ds_write_b128 v5, v[60:63] offset:21504
    s_branch L_lw_80
L_lw_80_2:
    ds_read_b64_tr_b16 a[72:73], v80 offset:49152
    ds_read_b64_tr_b16 a[74:75], v80 offset:50176
    ds_read_b64_tr_b16 a[76:77], v80 offset:57344
    ds_read_b64_tr_b16 a[78:79], v80 offset:58368
    ds_read_b64_tr_b16 v[56:57], v81 offset:49152
    ds_read_b64_tr_b16 v[58:59], v81 offset:50176
    ds_read_b64_tr_b16 v[60:61], v81 offset:57344
    ds_read_b64_tr_b16 v[62:63], v81 offset:58368
    s_waitcnt lgkmcnt(0)
    ds_write_b128 v5, v[56:59] offset:22528
    ds_write_b128 v5, v[60:63] offset:23552
L_lw_80:
    s_waitcnt lgkmcnt(0)
    s_waitcnt vmcnt(8)
    s_barrier
    s_add_u32 s79, s41, 7
    s_and_b32 s79, s79, 3
    s_lshl_b32 s79, s79, 19
    s_add_u32 s79, s79, s47
    s_add_u32 s46, s79, 0x200000
    s_add_u32 m0, s48, 49152
    s_nop 0
    buffer_load_dwordx4 v82, s[32:35], s46 offen  lds
    s_add_u32 s46, s79, 0x220000
    s_add_u32 m0, s48, 53248
    s_nop 0
    buffer_load_dwordx4 v82, s[32:35], s46 offen  lds
    s_add_u32 s46, s79, 0x240000
    s_add_u32 m0, s48, 57344
    s_nop 0
    buffer_load_dwordx4 v82, s[32:35], s46 offen  lds
    s_add_u32 s46, s79, 0x260000
    s_add_u32 m0, s48, 61440
    s_nop 0
    buffer_load_dwordx4 v82, s[32:35], s46 offen  lds
    s_cmp_lg_u32 s44, 0
    s_cbranch_scc1 L_lw_81_0
    ds_read_b64_tr_b16 a[48:49], v80 offset:0
    ds_read_b64_tr_b16 a[50:51], v80 offset:1024
    ds_read_b64_tr_b16 a[52:53], v80 offset:8192
    ds_read_b64_tr_b16 a[54:55], v80 offset:9216
    ds_read_b64_tr_b16 v[56:57], v81 offset:0
    ds_read_b64_tr_b16 v[58:59], v81 offset:1024
    ds_read_b64_tr_b16 v[60:61], v81 offset:8192
    ds_read_b64_tr_b16 v[62:63], v81 offset:9216
    s_waitcnt lgkmcnt(0)
    ds_write_b128 v5, v[56:59] offset:4096
    ds_write_b128 v5, v[60:63] offset:5120
    s_branch L_lw_81
L_lw_81_0:
    s_cmp_lg_u32 s44, 1
    s_cbranch_scc1 L_lw_81_1
    ds_read_b64_tr_b16 a[0:1], v80 offset:0
    ds_read_b64_tr_b16 a[2:3], v80 offset:1024
    ds_read_b64_tr_b16 a[4:5], v80 offset:8192
    ds_read_b64_tr_b16 a[6:7], v80 offset:9216
    ds_read_b64_tr_b16 a[8:9], v81 offset:0
    ds_read_b64_tr_b16 a[10:11], v81 offset:1024
    ds_read_b64_tr_b16 a[12:13], v81 offset:8192
    ds_read_b64_tr_b16 a[14:15], v81 offset:9216
    s_branch L_lw_81
L_lw_81_1:
    s_cmp_lg_u32 s44, 2
    s_cbranch_scc1 L_lw_81_2
    ds_read_b64_tr_b16 a[120:121], v80 offset:0
    ds_read_b64_tr_b16 a[122:123], v80 offset:1024
    ds_read_b64_tr_b16 a[124:125], v80 offset:8192
    ds_read_b64_tr_b16 a[126:127], v80 offset:9216
    ds_read_b64_tr_b16 v[56:57], v81 offset:0
    ds_read_b64_tr_b16 v[58:59], v81 offset:1024
    ds_read_b64_tr_b16 v[60:61], v81 offset:8192
    ds_read_b64_tr_b16 v[62:63], v81 offset:9216
    s_waitcnt lgkmcnt(0)
    ds_write_b128 v5, v[56:59] offset:0
    ds_write_b128 v5, v[60:63] offset:1024
    s_branch L_lw_81
L_lw_81_2:
    ds_read_b64_tr_b16 a[80:81], v80 offset:0
    ds_read_b64_tr_b16 a[82:83], v80 offset:1024
    ds_read_b64_tr_b16 a[84:85], v80 offset:8192
    ds_read_b64_tr_b16 a[86:87], v80 offset:9216
    ds_read_b64_tr_b16 v[56:57], v81 offset:0
    ds_read_b64_tr_b16 v[58:59], v81 offset:1024
    ds_read_b64_tr_b16 v[60:61], v81 offset:8192
    ds_read_b64_tr_b16 v[62:63], v81 offset:9216
    s_waitcnt lgkmcnt(0)
    ds_write_b128 v5, v[56:59] offset:2048
    ds_write_b128 v5, v[60:63] offset:3072
L_lw_81:
    s_waitcnt lgkmcnt(0)
    s_waitcnt vmcnt(8)
    s_barrier
    s_add_u32 s79, s41, 8
    s_and_b32 s79, s79, 3
    s_lshl_b32 s79, s79, 19
    s_add_u32 s79, s79, s47
    s_add_u32 s46, s79, 0x400000
    s_add_u32 m0, s48, 0
    s_nop 0
    buffer_load_dwordx4 v82, s[32:35], s46 offen  lds
    s_add_u32 s46, s79, 0x420000
    s_add_u32 m0, s48, 4096
    s_nop 0
    buffer_load_dwordx4 v82, s[32:35], s46 offen  lds
    s_add_u32 s46, s79, 0x440000
    s_add_u32 m0, s48, 8192
    s_nop 0
    buffer_load_dwordx4 v82, s[32:35], s46 offen  lds
    s_add_u32 s46, s79, 0x460000
    s_add_u32 m0, s48, 12288
    s_nop 0
    buffer_load_dwordx4 v82, s[32:35], s46 offen  lds
    s_cmp_lg_u32 s44, 0
    s_cbranch_scc1 L_lw_82_0
    ds_read_b64_tr_b16 a[56:57], v80 offset:16384
    ds_read_b64_tr_b16 a[58:59], v80 offset:17408
    ds_read_b64_tr_b16 a[60:61], v80 offset:24576
    ds_read_b64_tr_b16 a[62:63], v80 offset:25600
    ds_read_b64_tr_b16 v[56:57], v81 offset:16384
    ds_read_b64_tr_b16 v[58:59], v81 offset:17408
    ds_read_b64_tr_b16 v[60:61], v81 offset:24576
    ds_read_b64_tr_b16 v[62:63], v81 offset:25600
    s_waitcnt lgkmcnt(0)
    ds_write_b128 v5, v[56:59] offset:6144
    ds_write_b128 v5, v[60:63] offset:7168
    s_branch L_lw_82
L_lw_82_0:
    s_cmp_lg_u32 s44, 1
    s_cbranch_scc1 L_lw_82_1
    ds_read_b64_tr_b16 a[16:17], v80 offset:16384
    ds_read_b64_tr_b16 a[18:19], v80 offset:17408
    ds_read_b64_tr_b16 a[20:21], v80 offset:24576
    ds_read_b64_tr_b16 a[22:23], v80 offset:25600
    ds_read_b64_tr_b16 a[24:25], v81 offset:16384
    ds_read_b64_tr_b16 a[26:27], v81 offset:17408
    ds_read_b64_tr_b16 a[28:29], v81 offset:24576
    ds_read_b64_tr_b16 a[30:31], v81 offset:25600
    s_branch L_lw_82
L_lw_82_1:
    s_cmp_lg_u32 s44, 2
    s_cbranch_scc1 L_lw_82_2
    ds_read_b64_tr_b16 a[128:129], v80 offset:16384
    ds_read_b64_tr_b16 a[130:131], v80 offset:17408
    ds_read_b64_tr_b16 a[132:133], v80 offset:24576
    ds_read_b64_tr_b16 a[134:135], v80 offset:25600
    ds_read_b64_tr_b16 a[136:137], v81 offset:16384
    ds_read_b64_tr_b16 a[138:139], v81 offset:17408
    ds_read_b64_tr_b16 a[140:141], v81 offset:24576
    ds_read_b64_tr_b16 a[142:143], v81 offset:25600
    s_branch L_lw_82
L_lw_82_2:
    ds_read_b64_tr_b16 a[88:89], v80 offset:16384
    ds_read_b64_tr_b16 a[90:91], v80 offset:17408
    ds_read_b64_tr_b16 a[92:93], v80 offset:24576
    ds_read_b64_tr_b16 a[94:95], v80 offset:25600
    ds_read_b64_tr_b16 a[96:97], v81 offset:16384
    ds_read_b64_tr_b16 a[98:99], v81 offset:17408
    ds_read_b64_tr_b16 a[100:101], v81 offset:24576
    ds_read_b64_tr_b16 a[102:103], v81 offset:25600
L_lw_82:
    s_waitcnt lgkmcnt(0)
    s_waitcnt vmcnt(8)
    s_barrier
    s_add_u32 s79, s41, 9
    s_and_b32 s79, s79, 3
    s_lshl_b32 s79, s79, 19
    s_add_u32 s79, s79, s47
    s_add_u32 s46, s79, 0x400000
    s_add_u32 m0, s48, 16384
    s_nop 0
    buffer_load_dwordx4 v82, s[32:35], s46 offen  lds
    s_add_u32 s46, s79, 0x420000
    s_add_u32 m0, s48, 20480
    s_nop 0
    buffer_load_dwordx4 v82, s[32:35], s46 offen  lds
    s_add_u32 s46, s79, 0x440000
    s_add_u32 m0, s48, 24576
    s_nop 0
    buffer_load_dwordx4 v82, s[32:35], s46 offen  lds
    s_add_u32 s46, s79, 0x460000
    s_add_u32 m0, s48, 28672
    s_nop 0
    buffer_load_dwordx4 v82, s[32:35], s46 offen  lds
    s_cmp_lg_u32 s44, 0
    s_cbranch_scc1 L_lw_83_0
    ds_read_b64_tr_b16 a[64:65], v80 offset:32768
    ds_read_b64_tr_b16 a[66:67], v80 offset:33792
    ds_read_b64_tr_b16 a[68:69], v80 offset:40960
    ds_read_b64_tr_b16 a[70:71], v80 offset:41984
    ds_read_b64_tr_b16 v[56:57], v81 offset:32768
    ds_read_b64_tr_b16 v[58:59], v81 offset:33792
    ds_read_b64_tr_b16 v[60:61], v81 offset:40960
    ds_read_b64_tr_b16 v[62:63], v81 offset:41984
    s_waitcnt lgkmcnt(0)
    ds_write_b128 v5, v[56:59] offset:14336
    ds_write_b128 v5, v[60:63] offset:15360
    s_branch L_lw_83
L_lw_83_0:
    s_cmp_lg_u32 s44, 1
    s_cbranch_scc1 L_lw_83_1
    ds_read_b64_tr_b16 a[32:33], v80 offset:32768
    ds_read_b64_tr_b16 a[34:35], v80 offset:33792
    ds_read_b64_tr_b16 a[36:37], v80 offset:40960
    ds_read_b64_tr_b16 a[38:39], v80 offset:41984
    ds_read_b64_tr_b16 v[56:57], v81 offset:32768
    ds_read_b64_tr_b16 v[58:59], v81 offset:33792
    ds_read_b64_tr_b16 v[60:61], v81 offset:40960
    ds_read_b64_tr_b16 v[62:63], v81 offset:41984
    s_waitcnt lgkmcnt(0)
    ds_write_b128 v5, v[56:59] offset:8192
    ds_write_b128 v5, v[60:63] offset:9216
    s_branch L_lw_83
L_lw_83_1:
    s_cmp_lg_u32 s44, 2
    s_cbranch_scc1 L_lw_83_2
    ds_read_b64_tr_b16 a[144:145], v80 offset:32768
    ds_read_b64_tr_b16 a[146:147], v80 offset:33792
    ds_read_b64_tr_b16 a[148:149], v80 offset:40960
    ds_read_b64_tr_b16 a[150:151], v80 offset:41984
    ds_read_b64_tr_b16 v[56:57], v81 offset:32768
    ds_read_b64_tr_b16 v[58:59], v81 offset:33792
    ds_read_b64_tr_b16 v[60:61], v81 offset:40960
    ds_read_b64_tr_b16 v[62:63], v81 offset:41984
    s_waitcnt lgkmcnt(0)
    ds_write_b128 v5, v[56:59] offset:10240
    ds_write_b128 v5, v[60:63] offset:11264
    s_branch L_lw_83
L_lw_83_2:
    ds_read_b64_tr_b16 a[104:105], v80 offset:32768
    ds_read_b64_tr_b16 a[106:107], v80 offset:33792
    ds_read_b64_tr_b16 a[108:109], v80 offset:40960
    ds_read_b64_tr_b16 a[110:111], v80 offset:41984
    ds_read_b64_tr_b16 v[56:57], v81 offset:32768
    ds_read_b64_tr_b16 v[58:59], v81 offset:33792
    ds_read_b64_tr_b16 v[60:61], v81 offset:40960
    ds_read_b64_tr_b16 v[62:63], v81 offset:41984
    s_waitcnt lgkmcnt(0)
    ds_write_b128 v5, v[56:59] offset:12288
    ds_write_b128 v5, v[60:63] offset:13312
L_lw_83:
    s_waitcnt lgkmcnt(0)
    s_waitcnt vmcnt(8)
    s_barrier
    s_add_u32 s79, s41, 10
    s_and_b32 s79, s79, 3
    s_lshl_b32 s79, s79, 19
    s_add_u32 s79, s79, s47
    s_add_u32 s46, s79, 0x400000
    s_add_u32 m0, s48, 32768
    s_nop 0
    buffer_load_dwordx4 v82, s[32:35], s46 offen  lds
    s_add_u32 s46, s79, 0x420000
    s_add_u32 m0, s48, 36864
    s_nop 0
    buffer_load_dwordx4 v82, s[32:35], s46 offen  lds
    s_add_u32 s46, s79, 0x440000
    s_add_u32 m0, s48, 40960
    s_nop 0
    buffer_load_dwordx4 v82, s[32:35], s46 offen  lds
    s_add_u32 s46, s79, 0x460000
    s_add_u32 m0, s48, 45056
    s_nop 0
    buffer_load_dwordx4 v82, s[32:35], s46 offen  lds
    s_cmp_lg_u32 s44, 0
    s_cbranch_scc1 L_lw_84_0
    ds_read_b64_tr_b16 a[72:73], v80 offset:49152
    ds_read_b64_tr_b16 a[74:75], v80 offset:50176
    ds_read_b64_tr_b16 a[76:77], v80 offset:57344
    ds_read_b64_tr_b16 a[78:79], v80 offset:58368
    ds_read_b64_tr_b16 v[56:57], v81 offset:49152
    ds_read_b64_tr_b16 v[58:59], v81 offset:50176
    ds_read_b64_tr_b16 v[60:61], v81 offset:57344
    ds_read_b64_tr_b16 v[62:63], v81 offset:58368
    s_waitcnt lgkmcnt(0)
    ds_write_b128 v5, v[56:59] offset:22528
    ds_write_b128 v5, v[60:63] offset:23552
    s_branch L_lw_84
L_lw_84_0:
    s_cmp_lg_u32 s44, 1
    s_cbranch_scc1 L_lw_84_1
    ds_read_b64_tr_b16 a[40:41], v80 offset:49152
    ds_read_b64_tr_b16 a[42:43], v80 offset:50176
    ds_read_b64_tr_b16 a[44:45], v80 offset:57344
    ds_read_b64_tr_b16 a[46:47], v80 offset:58368
    ds_read_b64_tr_b16 v[56:57], v81 offset:49152
    ds_read_b64_tr_b16 v[58:59], v81 offset:50176
    ds_read_b64_tr_b16 v[60:61], v81 offset:57344
    ds_read_b64_tr_b16 v[62:63], v81 offset:58368
    s_waitcnt lgkmcnt(0)
    ds_write_b128 v5, v[56:59] offset:16384
    ds_write_b128 v5, v[60:63] offset:17408
    s_branch L_lw_84
L_lw_84_1:
    s_cmp_lg_u32 s44, 2
    s_cbranch_scc1 L_lw_84_2
    ds_read_b64_tr_b16 a[152:153], v80 offset:49152
    ds_read_b64_tr_b16 a[154:155], v80 offset:50176
    ds_read_b64_tr_b16 a[156:157], v80 offset:57344
    ds_read_b64_tr_b16 a[158:159], v80 offset:58368
    ds_read_b64_tr_b16 v[56:57], v81 offset:49152
    ds_read_b64_tr_b16 v[58:59], v81 offset:50176
    ds_read_b64_tr_b16 v[60:61], v81 offset:57344
    ds_read_b64_tr_b16 v[62:63], v81 offset:58368
    s_waitcnt lgkmcnt(0)
    ds_write_b128 v5, v[56:59] offset:18432
    ds_write_b128 v5, v[60:63] offset:19456
    s_branch L_lw_84
L_lw_84_2:
    ds_read_b64_tr_b16 a[112:113], v80 offset:49152
    ds_read_b64_tr_b16 a[114:115], v80 offset:50176
    ds_read_b64_tr_b16 a[116:117], v80 offset:57344
    ds_read_b64_tr_b16 a[118:119], v80 offset:58368
    ds_read_b64_tr_b16 v[56:57], v81 offset:49152
    ds_read_b64_tr_b16 v[58:59], v81 offset:50176
    ds_read_b64_tr_b16 v[60:61], v81 offset:57344
    ds_read_b64_tr_b16 v[62:63], v81 offset:58368
    s_waitcnt lgkmcnt(0)
    ds_write_b128 v5, v[56:59] offset:20480
    ds_write_b128 v5, v[60:63] offset:21504
L_lw_84:
    s_waitcnt lgkmcnt(0)
    s_waitcnt vmcnt(8)
    s_barrier
    s_add_u32 s79, s41, 11
    s_and_b32 s79, s79, 3
    s_lshl_b32 s79, s79, 19
    s_add_u32 s79, s79, s47
    s_add_u32 s46, s79, 0x400000
    s_add_u32 m0, s48, 49152
    s_nop 0
    buffer_load_dwordx4 v82, s[32:35], s46 offen  lds
    s_add_u32 s46, s79, 0x420000
    s_add_u32 m0, s48, 53248
    s_nop 0
    buffer_load_dwordx4 v82, s[32:35], s46 offen  lds
    s_add_u32 s46, s79, 0x440000
    s_add_u32 m0, s48, 57344
    s_nop 0
    buffer_load_dwordx4 v82, s[32:35], s46 offen  lds
    s_add_u32 s46, s79, 0x460000
    s_add_u32 m0, s48, 61440
    s_nop 0
    buffer_load_dwordx4 v82, s[32:35], s46 offen  lds
    s_cmp_lg_u32 s44, 0
    s_cbranch_scc1 L_lw_85_0
    ds_read_b64_tr_b16 a[80:81], v80 offset:0
    ds_read_b64_tr_b16 a[82:83], v80 offset:1024
    ds_read_b64_tr_b16 a[84:85], v80 offset:8192
    ds_read_b64_tr_b16 a[86:87], v80 offset:9216
    ds_read_b64_tr_b16 v[56:57], v81 offset:0
    ds_read_b64_tr_b16 v[58:59], v81 offset:1024
    ds_read_b64_tr_b16 v[60:61], v81 offset:8192
    ds_read_b64_tr_b16 v[62:63], v81 offset:9216
    s_waitcnt lgkmcnt(0)
    ds_write_b128 v5, v[56:59] offset:2048
    ds_write_b128 v5, v[60:63] offset:3072
    s_branch L_lw_85
L_lw_85_0:
    s_cmp_lg_u32 s44, 1
    s_cbranch_scc1 L_lw_85_1
    ds_read_b64_tr_b16 a[48:49], v80 offset:0
    ds_read_b64_tr_b16 a[50:51], v80 offset:1024
    ds_read_b64_tr_b16 a[52:53], v80 offset:8192
    ds_read_b64_tr_b16 a[54:55], v80 offset:9216
    ds_read_b64_tr_b16 v[56:57], v81 offset:0
    ds_read_b64_tr_b16 v[58:59], v81 offset:1024
    ds_read_b64_tr_b16 v[60:61], v81 offset:8192
    ds_read_b64_tr_b16 v[62:63], v81 offset:9216
    s_waitcnt lgkmcnt(0)
    ds_write_b128 v5, v[56:59] offset:4096
    ds_write_b128 v5, v[60:63] offset:5120
    s_branch L_lw_85
L_lw_85_1:
    s_cmp_lg_u32 s44, 2
    s_cbranch_scc1 L_lw_85_2
    ds_read_b64_tr_b16 a[0:1], v80 offset:0
    ds_read_b64_tr_b16 a[2:3], v80 offset:1024
    ds_read_b64_tr_b16 a[4:5], v80 offset:8192
    ds_read_b64_tr_b16 a[6:7], v80 offset:9216
    ds_read_b64_tr_b16 a[8:9], v81 offset:0
    ds_read_b64_tr_b16 a[10:11], v81 offset:1024
    ds_read_b64_tr_b16 a[12:13], v81 offset:8192
    ds_read_b64_tr_b16 a[14:15], v81 offset:9216
    s_branch L_lw_85
L_lw_85_2:
    ds_read_b64_tr_b16 a[120:121], v80 offset:0
    ds_read_b64_tr_b16 a[122:123], v80 offset:1024
    ds_read_b64_tr_b16 a[124:125], v80 offset:8192
    ds_read_b64_tr_b16 a[126:127], v80 offset:9216
    ds_read_b64_tr_b16 v[56:57], v81 offset:0
    ds_read_b64_tr_b16 v[58:59], v81 offset:1024
    ds_read_b64_tr_b16 v[60:61], v81 offset:8192
    ds_read_b64_tr_b16 v[62:63], v81 offset:9216
    s_waitcnt lgkmcnt(0)
    ds_write_b128 v5, v[56:59] offset:0
    ds_write_b128 v5, v[60:63] offset:1024
L_lw_85:
    s_waitcnt lgkmcnt(0)
    s_waitcnt vmcnt(8)
    s_barrier
    s_add_u32 s79, s41, 12
    s_and_b32 s79, s79, 3
    s_lshl_b32 s79, s79, 19
    s_add_u32 s79, s79, s47
    s_add_u32 s46, s79, 0x600000
    s_add_u32 m0, s48, 0
    s_nop 0
    buffer_load_dwordx4 v82, s[32:35], s46 offen  lds
    s_add_u32 s46, s79, 0x620000
    s_add_u32 m0, s48, 4096
    s_nop 0
    buffer_load_dwordx4 v82, s[32:35], s46 offen  lds
    s_add_u32 s46, s79, 0x640000
    s_add_u32 m0, s48, 8192
    s_nop 0
    buffer_load_dwordx4 v82, s[32:35], s46 offen  lds
    s_add_u32 s46, s79, 0x660000
    s_add_u32 m0, s48, 12288
    s_nop 0
    buffer_load_dwordx4 v82, s[32:35], s46 offen  lds
    s_cmp_lg_u32 s44, 0
    s_cbranch_scc1 L_lw_86_0
    ds_read_b64_tr_b16 a[88:89], v80 offset:16384
    ds_read_b64_tr_b16 a[90:91], v80 offset:17408
    ds_read_b64_tr_b16 a[92:93], v80 offset:24576
    ds_read_b64_tr_b16 a[94:95], v80 offset:25600
    ds_read_b64_tr_b16 a[96:97], v81 offset:16384
    ds_read_b64_tr_b16 a[98:99], v81 offset:17408
    ds_read_b64_tr_b16 a[100:101], v81 offset:24576
    ds_read_b64_tr_b16 a[102:103], v81 offset:25600
    s_branch L_lw_86
L_lw_86_0:
    s_cmp_lg_u32 s44, 1
    s_cbranch_scc1 L_lw_86_1
    ds_read_b64_tr_b16 a[56:57], v80 offset:16384
    ds_read_b64_tr_b16 a[58:59], v80 offset:17408
    ds_read_b64_tr_b16 a[60:61], v80 offset:24576
    ds_read_b64_tr_b16 a[62:63], v80 offset:25600
    ds_read_b64_tr_b16 v[56:57], v81 offset:16384
    ds_read_b64_tr_b16 v[58:59], v81 offset:17408
    ds_read_b64_tr_b16 v[60:61], v81 offset:24576
    ds_read_b64_tr_b16 v[62:63], v81 offset:25600
    s_waitcnt lgkmcnt(0)
    ds_write_b128 v5, v[56:59] offset:6144
    ds_write_b128 v5, v[60:63] offset:7168
    s_branch L_lw_86
L_lw_86_1:
    s_cmp_lg_u32 s44, 2
    s_cbranch_scc1 L_lw_86_2
    ds_read_b64_tr_b16 a[16:17], v80 offset:16384
    ds_read_b64_tr_b16 a[18:19], v80 offset:17408
    ds_read_b64_tr_b16 a[20:21], v80 offset:24576
    ds_read_b64_tr_b16 a[22:23], v80 offset:25600
    ds_read_b64_tr_b16 a[24:25], v81 offset:16384
    ds_read_b64_tr_b16 a[26:27], v81 offset:17408
    ds_read_b64_tr_b16 a[28:29], v81 offset:24576
    ds_read_b64_tr_b16 a[30:31], v81 offset:25600
    s_branch L_lw_86
L_lw_86_2:
    ds_read_b64_tr_b16 a[128:129], v80 offset:16384
    ds_read_b64_tr_b16 a[130:131], v80 offset:17408
    ds_read_b64_tr_b16 a[132:133], v80 offset:24576
    ds_read_b64_tr_b16 a[134:135], v80 offset:25600
    ds_read_b64_tr_b16 a[136:137], v81 offset:16384
    ds_read_b64_tr_b16 a[138:139], v81 offset:17408
    ds_read_b64_tr_b16 a[140:141], v81 offset:24576
    ds_read_b64_tr_b16 a[142:143], v81 offset:25600
L_lw_86:
    s_waitcnt lgkmcnt(0)
    s_waitcnt vmcnt(8)
    s_barrier
    s_add_u32 s79, s41, 13
    s_and_b32 s79, s79, 3
    s_lshl_b32 s79, s79, 19
    s_add_u32 s79, s79, s47
    s_add_u32 s46, s79, 0x600000
    s_add_u32 m0, s48, 16384
    s_nop 0
    buffer_load_dwordx4 v82, s[32:35], s46 offen  lds
    s_add_u32 s46, s79, 0x620000
    s_add_u32 m0, s48, 20480
    s_nop 0
    buffer_load_dwordx4 v82, s[32:35], s46 offen  lds
    s_add_u32 s46, s79, 0x640000
    s_add_u32 m0, s48, 24576
    s_nop 0
    buffer_load_dwordx4 v82, s[32:35], s46 offen  lds
    s_add_u32 s46, s79, 0x660000
    s_add_u32 m0, s48, 28672
    s_nop 0
    buffer_load_dwordx4 v82, s[32:35], s46 offen  lds
    s_cmp_lg_u32 s44, 0
    s_cbranch_scc1 L_lw_87_0
    ds_read_b64_tr_b16 a[104:105], v80 offset:32768
    ds_read_b64_tr_b16 a[106:107], v80 offset:33792
    ds_read_b64_tr_b16 a[108:109], v80 offset:40960
    ds_read_b64_tr_b16 a[110:111], v80 offset:41984
    ds_read_b64_tr_b16 v[56:57], v81 offset:32768
    ds_read_b64_tr_b16 v[58:59], v81 offset:33792
    ds_read_b64_tr_b16 v[60:61], v81 offset:40960
    ds_read_b64_tr_b16 v[62:63], v81 offset:41984
    s_waitcnt lgkmcnt(0)
    ds_write_b128 v5, v[56:59] offset:12288
    ds_write_b128 v5, v[60:63] offset:13312
    s_branch L_lw_87
L_lw_87_0:
    s_cmp_lg_u32 s44, 1
    s_cbranch_scc1 L_lw_87_1
    ds_read_b64_tr_b16 a[64:65], v80 offset:32768
    ds_read_b64_tr_b16 a[66:67], v80 offset:33792
    ds_read_b64_tr_b16 a[68:69], v80 offset:40960
    ds_read_b64_tr_b16 a[70:71], v80 offset:41984
    ds_read_b64_tr_b16 v[56:57], v81 offset:32768
    ds_read_b64_tr_b16 v[58:59], v81 offset:33792
    ds_read_b64_tr_b16 v[60:61], v81 offset:40960
    ds_read_b64_tr_b16 v[62:63], v81 offset:41984
    s_waitcnt lgkmcnt(0)
    ds_write_b128 v5, v[56:59] offset:14336
    ds_write_b128 v5, v[60:63] offset:15360
    s_branch L_lw_87
L_lw_87_1:
    s_cmp_lg_u32 s44, 2
    s_cbranch_scc1 L_lw_87_2
    ds_read_b64_tr_b16 a[32:33], v80 offset:32768
    ds_read_b64_tr_b16 a[34:35], v80 offset:33792
    ds_read_b64_tr_b16 a[36:37], v80 offset:40960
    ds_read_b64_tr_b16 a[38:39], v80 offset:41984
    ds_read_b64_tr_b16 v[56:57], v81 offset:32768
    ds_read_b64_tr_b16 v[58:59], v81 offset:33792
    ds_read_b64_tr_b16 v[60:61], v81 offset:40960
    ds_read_b64_tr_b16 v[62:63], v81 offset:41984
    s_waitcnt lgkmcnt(0)
    ds_write_b128 v5, v[56:59] offset:8192
    ds_write_b128 v5, v[60:63] offset:9216
    s_branch L_lw_87
L_lw_87_2:
    ds_read_b64_tr_b16 a[144:145], v80 offset:32768
    ds_read_b64_tr_b16 a[146:147], v80 offset:33792
    ds_read_b64_tr_b16 a[148:149], v80 offset:40960
    ds_read_b64_tr_b16 a[150:151], v80 offset:41984
    ds_read_b64_tr_b16 v[56:57], v81 offset:32768
    ds_read_b64_tr_b16 v[58:59], v81 offset:33792
    ds_read_b64_tr_b16 v[60:61], v81 offset:40960
    ds_read_b64_tr_b16 v[62:63], v81 offset:41984
    s_waitcnt lgkmcnt(0)
    ds_write_b128 v5, v[56:59] offset:10240
    ds_write_b128 v5, v[60:63] offset:11264
L_lw_87:
    s_waitcnt lgkmcnt(0)
    s_waitcnt vmcnt(8)
    s_barrier
    s_add_u32 s79, s41, 14
    s_and_b32 s79, s79, 3
    s_lshl_b32 s79, s79, 19
    s_add_u32 s79, s79, s47
    s_add_u32 s46, s79, 0x600000
    s_add_u32 m0, s48, 32768
    s_nop 0
    buffer_load_dwordx4 v82, s[32:35], s46 offen  lds
    s_add_u32 s46, s79, 0x620000
    s_add_u32 m0, s48, 36864
    s_nop 0
    buffer_load_dwordx4 v82, s[32:35], s46 offen  lds
    s_add_u32 s46, s79, 0x640000
    s_add_u32 m0, s48, 40960
    s_nop 0
    buffer_load_dwordx4 v82, s[32:35], s46 offen  lds
    s_add_u32 s46, s79, 0x660000
    s_add_u32 m0, s48, 45056
    s_nop 0
    buffer_load_dwordx4 v82, s[32:35], s46 offen  lds
    s_cmp_lg_u32 s44, 0
    s_cbranch_scc1 L_lw_88_0
    ds_read_b64_tr_b16 a[112:113], v80 offset:49152
    ds_read_b64_tr_b16 a[114:115], v80 offset:50176
    ds_read_b64_tr_b16 a[116:117], v80 offset:57344
    ds_read_b64_tr_b16 a[118:119], v80 offset:58368
    ds_read_b64_tr_b16 v[56:57], v81 offset:49152
    ds_read_b64_tr_b16 v[58:59], v81 offset:50176
    ds_read_b64_tr_b16 v[60:61], v81 offset:57344
    ds_read_b64_tr_b16 v[62:63], v81 offset:58368
    s_waitcnt lgkmcnt(0)
    ds_write_b128 v5, v[56:59] offset:20480
    ds_write_b128 v5, v[60:63] offset:21504
    s_branch L_lw_88
L_lw_88_0:
    s_cmp_lg_u32 s44, 1
    s_cbranch_scc1 L_lw_88_1
    ds_read_b64_tr_b16 a[72:73], v80 offset:49152
    ds_read_b64_tr_b16 a[74:75], v80 offset:50176
    ds_read_b64_tr_b16 a[76:77], v80 offset:57344
    ds_read_b64_tr_b16 a[78:79], v80 offset:58368
    ds_read_b64_tr_b16 v[56:57], v81 offset:49152
    ds_read_b64_tr_b16 v[58:59], v81 offset:50176
    ds_read_b64_tr_b16 v[60:61], v81 offset:57344
    ds_read_b64_tr_b16 v[62:63], v81 offset:58368
    s_waitcnt lgkmcnt(0)
    ds_write_b128 v5, v[56:59] offset:22528
    ds_write_b128 v5, v[60:63] offset:23552
    s_branch L_lw_88
L_lw_88_1:
    s_cmp_lg_u32 s44, 2
    s_cbranch_scc1 L_lw_88_2
    ds_read_b64_tr_b16 a[40:41], v80 offset:49152
    ds_read_b64_tr_b16 a[42:43], v80 offset:50176
    ds_read_b64_tr_b16 a[44:45], v80 offset:57344
    ds_read_b64_tr_b16 a[46:47], v80 offset:58368
    ds_read_b64_tr_b16 v[56:57], v81 offset:49152
    ds_read_b64_tr_b16 v[58:59], v81 offset:50176
    ds_read_b64_tr_b16 v[60:61], v81 offset:57344
    ds_read_b64_tr_b16 v[62:63], v81 offset:58368
    s_waitcnt lgkmcnt(0)
    ds_write_b128 v5, v[56:59] offset:16384
    ds_write_b128 v5, v[60:63] offset:17408
    s_branch L_lw_88
L_lw_88_2:
    ds_read_b64_tr_b16 a[152:153], v80 offset:49152
    ds_read_b64_tr_b16 a[154:155], v80 offset:50176
    ds_read_b64_tr_b16 a[156:157], v80 offset:57344
    ds_read_b64_tr_b16 a[158:159], v80 offset:58368
    ds_read_b64_tr_b16 v[56:57], v81 offset:49152
    ds_read_b64_tr_b16 v[58:59], v81 offset:50176
    ds_read_b64_tr_b16 v[60:61], v81 offset:57344
    ds_read_b64_tr_b16 v[62:63], v81 offset:58368
    s_waitcnt lgkmcnt(0)
    ds_write_b128 v5, v[56:59] offset:18432
    ds_write_b128 v5, v[60:63] offset:19456
L_lw_88:
    s_waitcnt lgkmcnt(0)
    s_waitcnt vmcnt(8)
    s_barrier
    s_add_u32 s79, s41, 15
    s_and_b32 s79, s79, 3
    s_lshl_b32 s79, s79, 19
    s_add_u32 s79, s79, s47
    s_add_u32 s46, s79, 0x600000
    s_add_u32 m0, s48, 49152
    s_nop 0
    buffer_load_dwordx4 v82, s[32:35], s46 offen  lds
    s_add_u32 s46, s79, 0x620000
    s_add_u32 m0, s48, 53248
    s_nop 0
    buffer_load_dwordx4 v82, s[32:35], s46 offen  lds
    s_add_u32 s46, s79, 0x640000
    s_add_u32 m0, s48, 57344
    s_nop 0
    buffer_load_dwordx4 v82, s[32:35], s46 offen  lds
    s_add_u32 s46, s79, 0x660000
    s_add_u32 m0, s48, 61440
    s_nop 0
    buffer_load_dwordx4 v82, s[32:35], s46 offen  lds
    s_cmp_lg_u32 s44, 0
    s_cbranch_scc1 L_lw_89_0
    ds_read_b64_tr_b16 a[120:121], v80 offset:0
    ds_read_b64_tr_b16 a[122:123], v80 offset:1024
    ds_read_b64_tr_b16 a[124:125], v80 offset:8192
    ds_read_b64_tr_b16 a[126:127], v80 offset:9216
    ds_read_b64_tr_b16 v[56:57], v81 offset:0
    ds_read_b64_tr_b16 v[58:59], v81 offset:1024
    ds_read_b64_tr_b16 v[60:61], v81 offset:8192
    ds_read_b64_tr_b16 v[62:63], v81 offset:9216
    s_waitcnt lgkmcnt(0)
    ds_write_b128 v5, v[56:59] offset:0
    ds_write_b128 v5, v[60:63] offset:1024
    s_branch L_lw_89
L_lw_89_0:
    s_cmp_lg_u32 s44, 1
    s_cbranch_scc1 L_lw_89_1
    ds_read_b64_tr_b16 a[80:81], v80 offset:0
    ds_read_b64_tr_b16 a[82:83], v80 offset:1024
    ds_read_b64_tr_b16 a[84:85], v80 offset:8192
    ds_read_b64_tr_b16 a[86:87], v80 offset:9216
    ds_read_b64_tr_b16 v[56:57], v81 offset:0
    ds_read_b64_tr_b16 v[58:59], v81 offset:1024
    ds_read_b64_tr_b16 v[60:61], v81 offset:8192
    ds_read_b64_tr_b16 v[62:63], v81 offset:9216
    s_waitcnt lgkmcnt(0)
    ds_write_b128 v5, v[56:59] offset:2048
    ds_write_b128 v5, v[60:63] offset:3072
    s_branch L_lw_89
L_lw_89_1:
    s_cmp_lg_u32 s44, 2
    s_cbranch_scc1 L_lw_89_2
    ds_read_b64_tr_b16 a[48:49], v80 offset:0
    ds_read_b64_tr_b16 a[50:51], v80 offset:1024
    ds_read_b64_tr_b16 a[52:53], v80 offset:8192
    ds_read_b64_tr_b16 a[54:55], v80 offset:9216
    ds_read_b64_tr_b16 v[56:57], v81 offset:0
    ds_read_b64_tr_b16 v[58:59], v81 offset:1024
    ds_read_b64_tr_b16 v[60:61], v81 offset:8192
    ds_read_b64_tr_b16 v[62:63], v81 offset:9216
    s_waitcnt lgkmcnt(0)
    ds_write_b128 v5, v[56:59] offset:4096
    ds_write_b128 v5, v[60:63] offset:5120
    s_branch L_lw_89
L_lw_89_2:
    ds_read_b64_tr_b16 a[0:1], v80 offset:0
    ds_read_b64_tr_b16 a[2:3], v80 offset:1024
    ds_read_b64_tr_b16 a[4:5], v80 offset:8192
    ds_read_b64_tr_b16 a[6:7], v80 offset:9216
    ds_read_b64_tr_b16 a[8:9], v81 offset:0
    ds_read_b64_tr_b16 a[10:11], v81 offset:1024
    ds_read_b64_tr_b16 a[12:13], v81 offset:8192
    ds_read_b64_tr_b16 a[14:15], v81 offset:9216
L_lw_89:
    s_waitcnt lgkmcnt(0)
    s_waitcnt vmcnt(8)
    s_barrier
    s_cmp_lg_u32 s44, 0
    s_cbranch_scc1 L_lw_90_0
    ds_read_b64_tr_b16 a[128:129], v80 offset:16384
    ds_read_b64_tr_b16 a[130:131], v80 offset:17408
    ds_read_b64_tr_b16 a[132:133], v80 offset:24576
    ds_read_b64_tr_b16 a[134:135], v80 offset:25600
    ds_read_b64_tr_b16 a[136:137], v81 offset:16384
    ds_read_b64_tr_b16 a[138:139], v81 offset:17408
    ds_read_b64_tr_b16 a[140:141], v81 offset:24576
    ds_read_b64_tr_b16 a[142:143], v81 offset:25600
    s_branch L_lw_90
L_lw_90_0:
    s_cmp_lg_u32 s44, 1
    s_cbranch_scc1 L_lw_90_1
    ds_read_b64_tr_b16 a[88:89], v80 offset:16384
    ds_read_b64_tr_b16 a[90:91], v80 offset:17408
    ds_read_b64_tr_b16 a[92:93], v80 offset:24576
    ds_read_b64_tr_b16 a[94:95], v80 offset:25600
    ds_read_b64_tr_b16 a[96:97], v81 offset:16384
    ds_read_b64_tr_b16 a[98:99], v81 offset:17408
    ds_read_b64_tr_b16 a[100:101], v81 offset:24576
    ds_read_b64_tr_b16 a[102:103], v81 offset:25600
    s_branch L_lw_90
L_lw_90_1:
    s_cmp_lg_u32 s44, 2
    s_cbranch_scc1 L_lw_90_2
    ds_read_b64_tr_b16 a[56:57], v80 offset:16384
    ds_read_b64_tr_b16 a[58:59], v80 offset:17408
    ds_read_b64_tr_b16 a[60:61], v80 offset:24576
    ds_read_b64_tr_b16 a[62:63], v80 offset:25600
    ds_read_b64_tr_b16 v[56:57], v81 offset:16384
    ds_read_b64_tr_b16 v[58:59], v81 offset:17408
    ds_read_b64_tr_b16 v[60:61], v81 offset:24576
    ds_read_b64_tr_b16 v[62:63], v81 offset:25600
    s_waitcnt lgkmcnt(0)
    ds_write_b128 v5, v[56:59] offset:6144
    ds_write_b128 v5, v[60:63] offset:7168
    s_branch L_lw_90
L_lw_90_2:
    ds_read_b64_tr_b16 a[16:17], v80 offset:16384
    ds_read_b64_tr_b16 a[18:19], v80 offset:17408
    ds_read_b64_tr_b16 a[20:21], v80 offset:24576
    ds_read_b64_tr_b16 a[22:23], v80 offset:25600
    ds_read_b64_tr_b16 a[24:25], v81 offset:16384
    ds_read_b64_tr_b16 a[26:27], v81 offset:17408
    ds_read_b64_tr_b16 a[28:29], v81 offset:24576
    ds_read_b64_tr_b16 a[30:31], v81 offset:25600
L_lw_90:
    s_waitcnt lgkmcnt(0)
    s_waitcnt vmcnt(4)
    s_barrier
    s_cmp_lg_u32 s44, 0
    s_cbranch_scc1 L_lw_91_0
    ds_read_b64_tr_b16 a[144:145], v80 offset:32768
    ds_read_b64_tr_b16 a[146:147], v80 offset:33792
    ds_read_b64_tr_b16 a[148:149], v80 offset:40960
    ds_read_b64_tr_b16 a[150:151], v80 offset:41984
    ds_read_b64_tr_b16 v[56:57], v81 offset:32768
    ds_read_b64_tr_b16 v[58:59], v81 offset:33792
    ds_read_b64_tr_b16 v[60:61], v81 offset:40960
    ds_read_b64_tr_b16 v[62:63], v81 offset:41984
    s_waitcnt lgkmcnt(0)
    ds_write_b128 v5, v[56:59] offset:10240
    ds_write_b128 v5, v[60:63] offset:11264
    s_branch L_lw_91
L_lw_91_0:
    s_cmp_lg_u32 s44, 1
    s_cbranch_scc1 L_lw_91_1
    ds_read_b64_tr_b16 a[104:105], v80 offset:32768
    ds_read_b64_tr_b16 a[106:107], v80 offset:33792
    ds_read_b64_tr_b16 a[108:109], v80 offset:40960
    ds_read_b64_tr_b16 a[110:111], v80 offset:41984
    ds_read_b64_tr_b16 v[56:57], v81 offset:32768
    ds_read_b64_tr_b16 v[58:59], v81 offset:33792
    ds_read_b64_tr_b16 v[60:61], v81 offset:40960
    ds_read_b64_tr_b16 v[62:63], v81 offset:41984
    s_waitcnt lgkmcnt(0)
    ds_write_b128 v5, v[56:59] offset:12288
    ds_write_b128 v5, v[60:63] offset:13312
    s_branch L_lw_91
L_lw_91_1:
    s_cmp_lg_u32 s44, 2
    s_cbranch_scc1 L_lw_91_2
    ds_read_b64_tr_b16 a[64:65], v80 offset:32768
    ds_read_b64_tr_b16 a[66:67], v80 offset:33792
    ds_read_b64_tr_b16 a[68:69], v80 offset:40960
    ds_read_b64_tr_b16 a[70:71], v80 offset:41984
    ds_read_b64_tr_b16 v[56:57], v81 offset:32768
    ds_read_b64_tr_b16 v[58:59], v81 offset:33792
    ds_read_b64_tr_b16 v[60:61], v81 offset:40960
    ds_read_b64_tr_b16 v[62:63], v81 offset:41984
    s_waitcnt lgkmcnt(0)
    ds_write_b128 v5, v[56:59] offset:14336
    ds_write_b128 v5, v[60:63] offset:15360
    s_branch L_lw_91
L_lw_91_2:
    ds_read_b64_tr_b16 a[32:33], v80 offset:32768
    ds_read_b64_tr_b16 a[34:35], v80 offset:33792
    ds_read_b64_tr_b16 a[36:37], v80 offset:40960
    ds_read_b64_tr_b16 a[38:39], v80 offset:41984
    ds_read_b64_tr_b16 v[56:57], v81 offset:32768
    ds_read_b64_tr_b16 v[58:59], v81 offset:33792
    ds_read_b64_tr_b16 v[60:61], v81 offset:40960
    ds_read_b64_tr_b16 v[62:63], v81 offset:41984
    s_waitcnt lgkmcnt(0)
    ds_write_b128 v5, v[56:59] offset:8192
    ds_write_b128 v5, v[60:63] offset:9216
L_lw_91:
    s_waitcnt lgkmcnt(0)
    s_waitcnt vmcnt(0)
    s_barrier
    s_cmp_lg_u32 s44, 0
    s_cbranch_scc1 L_lw_92_0
    ds_read_b64_tr_b16 a[152:153], v80 offset:49152
    ds_read_b64_tr_b16 a[154:155], v80 offset:50176
    ds_read_b64_tr_b16 a[156:157], v80 offset:57344
    ds_read_b64_tr_b16 a[158:159], v80 offset:58368
    ds_read_b64_tr_b16 v[56:57], v81 offset:49152
    ds_read_b64_tr_b16 v[58:59], v81 offset:50176
    ds_read_b64_tr_b16 v[60:61], v81 offset:57344
    ds_read_b64_tr_b16 v[62:63], v81 offset:58368
    s_waitcnt lgkmcnt(0)
    ds_write_b128 v5, v[56:59] offset:18432
    ds_write_b128 v5, v[60:63] offset:19456
    s_branch L_lw_92
L_lw_92_0:
    s_cmp_lg_u32 s44, 1
    s_cbranch_scc1 L_lw_92_1
    ds_read_b64_tr_b16 a[112:113], v80 offset:49152
    ds_read_b64_tr_b16 a[114:115], v80 offset:50176
    ds_read_b64_tr_b16 a[116:117], v80 offset:57344
    ds_read_b64_tr_b16 a[118:119], v80 offset:58368
    ds_read_b64_tr_b16 v[56:57], v81 offset:49152
    ds_read_b64_tr_b16 v[58:59], v81 offset:50176
    ds_read_b64_tr_b16 v[60:61], v81 offset:57344
    ds_read_b64_tr_b16 v[62:63], v81 offset:58368
    s_waitcnt lgkmcnt(0)
    ds_write_b128 v5, v[56:59] offset:20480
    ds_write_b128 v5, v[60:63] offset:21504
    s_branch L_lw_92
L_lw_92_1:
    s_cmp_lg_u32 s44, 2
    s_cbranch_scc1 L_lw_92_2
    ds_read_b64_tr_b16 a[72:73], v80 offset:49152
    ds_read_b64_tr_b16 a[74:75], v80 offset:50176
    ds_read_b64_tr_b16 a[76:77], v80 offset:57344
    ds_read_b64_tr_b16 a[78:79], v80 offset:58368
    ds_read_b64_tr_b16 v[56:57], v81 offset:49152
    ds_read_b64_tr_b16 v[58:59], v81 offset:50176
    ds_read_b64_tr_b16 v[60:61], v81 offset:57344
    ds_read_b64_tr_b16 v[62:63], v81 offset:58368
    s_waitcnt lgkmcnt(0)
    ds_write_b128 v5, v[56:59] offset:22528
    ds_write_b128 v5, v[60:63] offset:23552
    s_branch L_lw_92
L_lw_92_2:
    ds_read_b64_tr_b16 a[40:41], v80 offset:49152
    ds_read_b64_tr_b16 a[42:43], v80 offset:50176
    ds_read_b64_tr_b16 a[44:45], v80 offset:57344
    ds_read_b64_tr_b16 a[46:47], v80 offset:58368
    ds_read_b64_tr_b16 v[56:57], v81 offset:49152
    ds_read_b64_tr_b16 v[58:59], v81 offset:50176
    ds_read_b64_tr_b16 v[60:61], v81 offset:57344
    ds_read_b64_tr_b16 v[62:63], v81 offset:58368
    s_waitcnt lgkmcnt(0)
    ds_write_b128 v5, v[56:59] offset:16384
    ds_write_b128 v5, v[60:63] offset:17408
L_lw_92:
    s_waitcnt lgkmcnt(0)
    s_barrier
    v_lshlrev_b32 v68, 4, v1
    s_mul_i32 s45, s44, 3072
    s_add_u32 s45, s45, 53248
    v_add_u32 v6, s45, v68
    s_sub_u32 s45, s44, 1
    s_and_b32 s45, s45, 3
    s_mul_i32 s45, s45, 3072
    s_add_u32 s45, s45, 53248
    v_add_u32 v7, s45, v68
    s_sub_u32 s45, s44, 2
    s_and_b32 s45, s45, 3
    s_mul_i32 s45, s45, 3072
    s_add_u32 s45, s45, 54272
    v_add_u32 v8, s45, v68
    s_sub_u32 s45, s44, 3
    s_and_b32 s45, s45, 3
    s_mul_i32 s45, s45, 3072
    s_add_u32 s45, s45, 55296
    v_add_u32 v18, s45, v68
    v_lshlrev_b32 v68, 4, v1
    s_add_u32 s45, s69, 0
    s_and_b32 s45, s45, 7
    s_lshl_b32 s45, s45, 10
    s_lshl_b32 s46, s44, 13
    s_add_u32 s45, s45, s46
    v_add_u32 v80, s45, v68
    s_add_u32 s45, s69, 1
    s_and_b32 s45, s45, 7
    s_lshl_b32 s45, s45, 10
    s_lshl_b32 s46, s44, 13
    s_add_u32 s45, s45, s46
    v_add_u32 v81, s45, v68
    s_add_u32 s45, s69, 2
    s_and_b32 s45, s45, 7
    s_lshl_b32 s45, s45, 10
    s_lshl_b32 s46, s44, 13
    s_add_u32 s45, s45, s46
    v_add_u32 v82, s45, v68
    s_add_u32 s45, s69, 3
    s_and_b32 s45, s45, 7
    s_lshl_b32 s45, s45, 10
    s_lshl_b32 s46, s44, 13
    s_add_u32 s45, s45, s46
    v_add_u32 v83, s45, v68
    s_add_u32 s45, s69, 4
    s_and_b32 s45, s45, 7
    s_lshl_b32 s45, s45, 10
    s_lshl_b32 s46, s44, 13
    s_add_u32 s45, s45, s46
    v_add_u32 v84, s45, v68
    s_add_u32 s45, s69, 5
    s_and_b32 s45, s45, 7
    s_lshl_b32 s45, s45, 10
    s_lshl_b32 s46, s44, 13
    s_add_u32 s45, s45, s46
    v_add_u32 v85, s45, v68
    s_add_u32 s45, s69, 6
    s_and_b32 s45, s45, 7
    s_lshl_b32 s45, s45, 10
    s_lshl_b32 s46, s44, 13
    s_add_u32 s45, s45, s46
    v_add_u32 v86, s45, v68
    s_add_u32 s45, s69, 7
    s_and_b32 s45, s45, 7
    s_lshl_b32 s45, s45, 10
    s_lshl_b32 s46, s44, 13
    s_add_u32 s45, s45, s46
    v_add_u32 v87, s45, v68
    s_lshl_b32 s45, s40, 4
    s_add_u32 s45, s45, s42
    s_lshl_b32 s45, s45, 8
    s_lshl_b32 s46, s44, 6
    s_add_u32 s45, s45, s46
    s_add_u32 s45, s45, 0x7080000
    v_and_b32 v13, 15, v1
    v_lshlrev_b32 v13, 2, v13
    v_add_u32 v13, s45, v13
    s_mov_b32 s66, 0x1800000
    v_mov_b32 v14, -1
    v_mov_b32 v15, -1
    s_mov_b32 s70, 0
    v_mov_b32 v41, 0
L_hw_93:
    buffer_load_dwordx2 v[44:45], v41, s[16:19], 0 offen sc1
    s_add_u32 s70, s70, 1
    s_cmp_ge_u32 s70, 0x100000
    s_cbranch_scc1 L_c_done_1
    s_waitcnt vmcnt(0)
    v_readfirstlane_b32 s45, v44
    v_readfirstlane_b32 s46, v45
    s_nop 3
    s_lshr_b32 s47, s46, 24
    s_cmp_lg_u32 s47, 64
    s_cbranch_scc1 L_hw_93
    s_lshr_b32 s68, s45, 24
    s_and_b32 s47, s45, 511
    s_mul_i32 s47, s47, s47
    s_bfe_u32 s45, s45, 0xf0009
    s_lshl_b32 s45, s45, 5
    s_sub_u32 s45, s45, s47
    s_and_b32 s47, s46, 511
    s_mul_i32 s47, s47, s47
    s_bfe_u32 s46, s46, 0xf0009
    s_lshl_b32 s46, s46, 5
    s_sub_u32 s46, s46, s47
    s_or_b32 s45, s45, s46
    s_cmp_eq_u32 s45, 0
    s_cselect_b32 s67, 1, 0
    s_mov_b32 s24, s12
    s_mov_b32 s25, s13
    s_mov_b32 s28, s12
    s_mov_b32 s29, s13
    s_cmp_eq_u32 s67, 1
    s_cselect_b32 s26, s14, 0
    s_cselect_b32 s30, 0, s14
    s_cmp_ge_u32 s68, 16
    s_cselect_b32 s68, 8192, 0
    s_mov_b32 s6, 0x11111111
    s_mov_b32 s7, 0xffaaa491
    s_mov_b32 s60, 0
    s_lshl_b32 s58, s40, 16
    s_add_u32 s58, s58, 0x7000000
    s_mov_b32 s61, s58
    s_lshl_b32 s59, s40, 17
    s_add_u32 s59, s59, 0x7040000
    s_mov_b32 s62, s59
    s_add_u32 s32, s41, 0
    s_and_b32 s32, s32, 3
    s_lshl_b32 s32, s32, 10
    s_add_u32 s33, s41, 1
    s_and_b32 s33, s33, 3
    s_lshl_b32 s33, s33, 10
    s_add_u32 s34, s41, 2
    s_and_b32 s34, s34, 3
    s_lshl_b32 s34, s34, 10
    s_add_u32 s35, s41, 3
    s_and_b32 s35, s35, 3
    s_lshl_b32 s35, s35, 10
    s_add_u32 s63, s63, s68
    s_add_u32 s64, s64, s68
    ds_read_b128 v[56:59], v5 offset:8192
    ds_read_b128 v[60:63], v5 offset:9216
    ds_read_b128 v[64:67], v5 offset:16384
    ds_read_b128 v[68:71], v5 offset:17408
    ds_read_b128 v[72:75], v5 offset:4096
    ds_read_b128 v[76:79], v5 offset:5120
    ds_read_b128 v[88:91], v5 offset:6144
    ds_read_b128 v[92:95], v5 offset:7168
    ds_read_b128 v[32:35], v5 offset:14336
    ds_read_b128 v[36:39], v5 offset:15360
L_v_loop_94:
    s_add_u32 s8, s61, s32
    s_add_u32 s9, s61, s33
    s_add_u32 s10, s61, s34
    s_add_u32 s11, s61, s35
    s_nop 15
    s_nop 15
    s_waitcnt lgkmcnt(0)
    buffer_load_dwordx4 v[40:43], v3, s[12:15], s8 offen sc1
    v_mov_b32 v24, 0
    v_mov_b32 v25, 0
    v_mov_b32 v26, 0
    v_mov_b32 v27, 0
    v_mov_b32 v28, 0
    buffer_load_dwordx4 v[44:47], v3, s[12:15], s9 offen sc1
    v_mov_b32 v29, 0
    v_mov_b32 v30, 0
    v_mov_b32 v31, 0
    s_nop 1
    buffer_load_dwordx4 v[48:51], v3, s[12:15], s10 offen sc1
    s_nop 4
    buffer_load_dwordx4 v[52:55], v3, s[12:15], s11 offen sc1
    s_mov_b32 s70, 0
    s_waitcnt vmcnt(3)
    v_max3_u32 v22, v40, v41, v42
    ds_write_b128 v3, v[40:43] offset:0
    v_max_u32 v22, v22, v43
    v_cmp_eq_u32 vcc, -1, v22
    s_nop 0
    s_nop 0
    s_cbranch_vccnz L_mg_95_r0
L_mg_95_c0:
    v_smfmac_f32_16x16x64_bf16 v[24:27], v[40:43], a[0:7], v2
    s_waitcnt vmcnt(2)
    v_max3_u32 v22, v44, v45, v46
    ds_write_b128 v3, v[44:47] offset:1024
    v_max_u32 v22, v22, v47
    v_cmp_eq_u32 vcc, -1, v22
    v_smfmac_f32_16x16x64_bf16 v[28:31], v[40:43], a[8:15], v2
    s_nop 0
    s_cbranch_vccnz L_mg_95_r1
L_mg_95_c1:
    v_smfmac_f32_16x16x64_bf16 v[24:27], v[44:47], a[16:23], v2
    s_waitcnt vmcnt(1)
    v_max3_u32 v22, v48, v49, v50
    ds_write_b128 v3, v[48:51] offset:2048
    v_max_u32 v22, v22, v51
    v_cmp_eq_u32 vcc, -1, v22
    v_smfmac_f32_16x16x64_bf16 v[28:31], v[44:47], a[24:31], v2
    s_nop 0
    s_cbranch_vccnz L_mg_95_r2
L_mg_95_c2:
    s_waitcnt vmcnt(0)
    v_max3_u32 v22, v52, v53, v54
    ds_write_b128 v3, v[52:55] offset:3072
    v_max_u32 v22, v22, v55
    v_cmp_eq_u32 vcc, -1, v22
    s_waitcnt lgkmcnt(0)
    s_nop 0
    s_cbranch_vccnz L_mg_95_r3
L_mg_95_c3:
    s_barrier
    ds_read_b128 v[40:43], v4 offset:0
    ds_read_b128 v[44:47], v4 offset:1024
    v_smfmac_f32_16x16x64_bf16 v[24:27], v[48:51], a[32:39], v2
    v_smfmac_f32_16x16x64_bf16 v[28:31], v[48:51], v[56:63], v2
    ds_read_b128 v[48:51], v4 offset:2048
    v_smfmac_f32_16x16x64_bf16 v[24:27], v[52:55], a[40:47], v2
    ds_read_b128 v[56:59], v5 offset:22528
    v_smfmac_f32_16x16x64_bf16 v[28:31], v[52:55], v[64:71], v2
    ds_read_b128 v[52:55], v4 offset:3072
    ds_read_b128 v[60:63], v5 offset:23552
    s_waitcnt lgkmcnt(4)
    v_smfmac_f32_16x16x64_bf16 v[24:27], v[40:43], a[48:55], v2
    ds_read_b128 v[64:67], v5 offset:2048
    v_smfmac_f32_16x16x64_bf16 v[28:31], v[40:43], v[72:79], v2
    ds_read_b128 v[40:43], v21 offset:0
    ds_read_b128 v[68:71], v5 offset:3072
    v_smfmac_f32_16x16x64_bf16 v[24:27], v[44:47], a[56:63], v2
    ds_read_b128 v[72:75], v5 offset:12288
    v_smfmac_f32_16x16x64_bf16 v[28:31], v[44:47], v[88:95], v2
    ds_read_b128 v[44:47], v21 offset:1024
    ds_read_b128 v[76:79], v5 offset:13312
    s_waitcnt lgkmcnt(6)
    v_smfmac_f32_16x16x64_bf16 v[24:27], v[48:51], a[64:71], v2
    ds_read_b128 v[88:91], v5 offset:20480
    v_smfmac_f32_16x16x64_bf16 v[28:31], v[48:51], v[32:39], v2
    ds_read_b128 v[48:51], v21 offset:2048
    ds_read_b128 v[92:95], v5 offset:21504
    v_smfmac_f32_16x16x64_bf16 v[24:27], v[52:55], a[72:79], v2
    ds_read_b128 v[32:35], v5 offset:0
    v_smfmac_f32_16x16x64_bf16 v[28:31], v[52:55], v[56:63], v2
    ds_read_b128 v[52:55], v21 offset:3072
    ds_read_b128 v[36:39], v5 offset:1024
    s_waitcnt lgkmcnt(6)
    v_smfmac_f32_16x16x64_bf16 v[24:27], v[40:43], a[80:87], v2
    ds_read_b128 v[56:59], v5 offset:10240
    v_smfmac_f32_16x16x64_bf16 v[28:31], v[40:43], v[64:71], v2
    ds_read_b128 v[40:43], v23 offset:0
    ds_read_b128 v[60:63], v5 offset:11264
    v_smfmac_f32_16x16x64_bf16 v[24:27], v[44:47], a[88:95], v2
    ds_read_b128 v[64:67], v5 offset:18432
    v_smfmac_f32_16x16x64_bf16 v[28:31], v[44:47], a[96:103], v2
    ds_read_b128 v[44:47], v23 offset:1024
    s_waitcnt lgkmcnt(5)
    v_smfmac_f32_16x16x64_bf16 v[24:27], v[48:51], a[104:111], v2
    ds_read_b128 v[68:71], v5 offset:19456
    v_smfmac_f32_16x16x64_bf16 v[28:31], v[48:51], v[72:79], v2
    ds_read_b128 v[48:51], v23 offset:2048
    v_smfmac_f32_16x16x64_bf16 v[24:27], v[52:55], a[112:119], v2
    v_smfmac_f32_16x16x64_bf16 v[28:31], v[52:55], v[88:95], v2
    ds_read_b128 v[52:55], v23 offset:3072
    s_waitcnt lgkmcnt(3)
    v_smfmac_f32_16x16x64_bf16 v[24:27], v[40:43], a[120:127], v2
    v_smfmac_f32_16x16x64_bf16 v[28:31], v[40:43], v[32:39], v2
    v_smfmac_f32_16x16x64_bf16 v[24:27], v[44:47], a[128:135], v2
    v_smfmac_f32_16x16x64_bf16 v[28:31], v[44:47], a[136:143], v2
    s_waitcnt lgkmcnt(0)
    v_smfmac_f32_16x16x64_bf16 v[24:27], v[48:51], a[144:151], v2
    v_smfmac_f32_16x16x64_bf16 v[28:31], v[48:51], v[56:63], v2
    v_smfmac_f32_16x16x64_bf16 v[24:27], v[52:55], a[152:159], v2
    v_smfmac_f32_16x16x64_bf16 v[28:31], v[52:55], v[64:71], v2
    s_and_b32 s45, s60, 1
    s_lshl_b32 s45, s45, 16
    s_add_u32 s45, s45, 0x7020000
    s_xor_b32 s46, s45, 65536
    s_nop 3
    v_permlane32_swap_b32 v24, v26
    v_permlane32_swap_b32 v25, v27
    v_permlane32_swap_b32 v28, v30
    v_permlane32_swap_b32 v29, v31
    v_pk_add_f32 v[24:25], v[24:25], v[26:27]
    v_pk_add_f32 v[28:29], v[28:29], v[30:31]
    v_cvt_pk_bf16_f32 v16, v24, v25
    v_cvt_pk_bf16_f32 v17, v28, v29
    s_add_u32 s47, s60, 3
    s_and_b32 s47, s47, 3
    s_lshl_b32 s47, s47, 14
    s_add_u32 s47, s47, s58
    buffer_store_dwordx2 v[16:17], v10, s[24:27], s45 offen
    buffer_store_dwordx2 v[14:15], v10, s[24:27], s46 offen
    buffer_store_dword v14, v12, s[24:27], s47 offen
    buffer_store_dwordx2 v[16:17], v10, s[28:31], s45 offen sc1
    buffer_store_dwordx2 v[14:15], v10, s[28:31], s46 offen sc1
    buffer_store_dword v14, v12, s[28:31], s47 offen sc1
    s_barrier
    s_cmp_eq_u32 s60, 63
    s_cbranch_scc1 L_v_fin_96
    s_and_b32 s65, s60, 1
    s_lshl_b32 s65, s65, 12
    s_and_b32 s45, s60, 2
    s_lshl_b32 s45, s45, 13
    s_add_u32 s65, s65, s45
    s_xor_b32 s45, s65, 16384
    s_add_u32 s45, s45, s63
    buffer_store_dwordx2 v[14:15], v11, s[12:15], s45 offen sc1
    s_add_u32 s48, s63, s65
    s_add_u32 s49, s64, s65
    s_sleep 8
    s_waitcnt vmcnt(0)
    s_mov_b64 exec, 65535
    buffer_load_dword v88, v13, s[12:15], 0 offen sc1
    s_nop 15
    buffer_load_dword v89, v13, s[12:15], 0 offen sc1
    s_nop 15
    buffer_load_dword v90, v13, s[12:15], 0 offen sc1
    s_nop 15
    buffer_load_dword v91, v13, s[12:15], 0 offen sc1
    s_mov_b32 s70, 0
L_pp_97:
    s_waitcnt vmcnt(3)
    v_cmp_ge_u32 vcc, s60, v88
    s_add_u32 s70, s70, 1
    s_nop 0
    s_cbranch_vccz L_ppd_98
    buffer_load_dword v88, v13, s[12:15], 0 offen sc1
    s_waitcnt vmcnt(3)
    v_cmp_ge_u32 vcc, s60, v89
    s_add_u32 s70, s70, 1
    s_nop 0
    s_cbranch_vccz L_ppd_98
    buffer_load_dword v89, v13, s[12:15], 0 offen sc1
    s_waitcnt vmcnt(3)
    v_cmp_ge_u32 vcc, s60, v90
    s_add_u32 s70, s70, 1
    s_nop 0
    s_cbranch_vccz L_ppd_98
    buffer_load_dword v90, v13, s[12:15], 0 offen sc1
    s_waitcnt vmcnt(3)
    v_cmp_ge_u32 vcc, s60, v91
    s_add_u32 s70, s70, 1
    s_nop 0
    s_cbranch_vccz L_ppd_98
    buffer_load_dword v91, v13, s[12:15], 0 offen sc1
    s_cmp_lt_u32 s70, 0x400000
    s_cbranch_scc1 L_pp_97
    s_branch L_c_done_1
L_ppd_98:
    s_mov_b64 exec, -1
    s_nop 3
    s_mov_b32 s70, 0
    buffer_load_dwordx4 v[40:43], v80, s[12:15], s62 offen sc1
    v_mov_b32 v24, 0
    v_mov_b32 v25, 0
    v_mov_b32 v26, 0
    v_mov_b32 v27, 0
    s_nop 3
    buffer_load_dwordx4 v[44:47], v81, s[12:15], s62 offen sc1
    v_mov_b32 v28, 0
    v_mov_b32 v29, 0
    v_mov_b32 v30, 0
    v_mov_b32 v31, 0
    s_nop 3
    buffer_load_dwordx4 v[48:51], v82, s[12:15], s62 offen sc1
    v_mov_b32 v32, 0
    v_mov_b32 v33, 0
    v_mov_b32 v34, 0
    v_mov_b32 v35, 0
    s_nop 3
    buffer_load_dwordx4 v[52:55], v83, s[12:15], s62 offen sc1
    v_mov_b32 v36, 0
    v_mov_b32 v37, 0
    v_mov_b32 v38, 0
    v_mov_b32 v39, 0
    s_nop 3
    buffer_load_dwordx4 v[56:59], v84, s[12:15], s62 offen sc1
    s_nop 7
    buffer_load_dwordx4 v[60:63], v85, s[12:15], s62 offen sc1
    s_waitcnt vmcnt(5)
    v_cmp_eq_u32 vcc, -1, v43
    s_nop 1
    s_cbranch_vccnz L_v_og_99_r0
L_v_og_99_c0:
    v_smfmac_f32_16x16x64_bf16 v[24:27], v[40:43], a[160:167], v2
    s_waitcnt vmcnt(4)
    v_smfmac_f32_16x16x64_bf16 v[28:31], v[40:43], a[168:175], v2
    v_cmp_eq_u32 vcc, -1, v47
    v_smfmac_f32_16x16x64_bf16 v[32:35], v[40:43], a[176:183], v2
    buffer_load_dwordx4 v[64:67], v86, s[12:15], s62 offen sc1
    v_smfmac_f32_16x16x64_bf16 v[36:39], v[40:43], a[184:191], v2
    s_cbranch_vccnz L_v_og_99_r1
L_v_og_99_c1:
    v_smfmac_f32_16x16x64_bf16 v[24:27], v[44:47], a[192:199], v2
    s_waitcnt vmcnt(4)
    v_smfmac_f32_16x16x64_bf16 v[28:31], v[44:47], a[200:207], v2
    v_cmp_eq_u32 vcc, -1, v51
    v_smfmac_f32_16x16x64_bf16 v[32:35], v[44:47], a[208:215], v2
    buffer_load_dwordx4 v[68:71], v87, s[12:15], s62 offen sc1
    v_smfmac_f32_16x16x64_bf16 v[36:39], v[44:47], a[216:223], v2
    s_cbranch_vccnz L_v_og_99_r2
L_v_og_99_c2:
    v_smfmac_f32_16x16x64_bf16 v[24:27], v[48:51], a[224:231], v2
    s_waitcnt vmcnt(4)
    v_smfmac_f32_16x16x64_bf16 v[28:31], v[48:51], a[232:239], v2
    v_cmp_eq_u32 vcc, -1, v55
    v_smfmac_f32_16x16x64_bf16 v[32:35], v[48:51], a[240:247], v2
    v_smfmac_f32_16x16x64_bf16 v[36:39], v[48:51], a[248:255], v2
    s_cbranch_vccnz L_v_og_99_r3
L_v_og_99_c3:
    v_smfmac_f32_16x16x64_bf16 v[24:27], v[52:55], v[96:103], v2
    s_waitcnt vmcnt(3)
    v_cmp_eq_u32 vcc, -1, v59
    v_smfmac_f32_16x16x64_bf16 v[28:31], v[52:55], v[104:111], v2
    v_smfmac_f32_16x16x64_bf16 v[32:35], v[52:55], v[112:119], v2
    s_cbranch_vccnz L_v_og_99_r4
L_v_og_99_c4:
    v_smfmac_f32_16x16x64_bf16 v[24:27], v[56:59], v[128:135], v2
    s_waitcnt vmcnt(2)
    v_cmp_eq_u32 vcc, -1, v63
    v_smfmac_f32_16x16x64_bf16 v[28:31], v[56:59], v[136:143], v2
    v_smfmac_f32_16x16x64_bf16 v[32:35], v[56:59], v[144:151], v2
    s_cbranch_vccnz L_v_og_99_r5
L_v_og_99_c5:
    v_smfmac_f32_16x16x64_bf16 v[24:27], v[60:63], v[160:167], v2
    s_waitcnt vmcnt(1)
    v_cmp_eq_u32 vcc, -1, v67
    v_smfmac_f32_16x16x64_bf16 v[28:31], v[60:63], v[168:175], v2
    v_smfmac_f32_16x16x64_bf16 v[32:35], v[60:63], v[176:183], v2
    s_cbranch_vccnz L_v_og_99_r6
L_v_og_99_c6:
    v_smfmac_f32_16x16x64_bf16 v[24:27], v[64:67], v[192:199], v2
    s_waitcnt vmcnt(0)
    v_cmp_eq_u32 vcc, -1, v71
    v_smfmac_f32_16x16x64_bf16 v[28:31], v[64:67], v[200:207], v2
    v_smfmac_f32_16x16x64_bf16 v[32:35], v[64:67], v[208:215], v2
    s_cbranch_vccnz L_v_og_99_r7
L_v_og_99_c7:
    v_smfmac_f32_16x16x64_bf16 v[24:27], v[68:71], v[224:231], v2
    v_smfmac_f32_16x16x64_bf16 v[28:31], v[68:71], v[232:239], v2
    v_smfmac_f32_16x16x64_bf16 v[32:35], v[68:71], v[240:247], v2
    v_smfmac_f32_16x16x64_bf16 v[36:39], v[52:55], v[120:127], v2
    s_add_u32 s46, s60, 1
    v_smfmac_f32_16x16x64_bf16 v[36:39], v[56:59], v[152:159], v2
    s_and_b32 s45, s46, 3
    v_smfmac_f32_16x16x64_bf16 v[36:39], v[60:63], v[184:191], v2
    s_mov_b32 s60, s46
    ds_write_b128 v6, v[24:27] offset:0
    v_smfmac_f32_16x16x64_bf16 v[36:39], v[64:67], v[216:223], v2
    ds_write_b128 v6, v[28:31] offset:1024
    v_smfmac_f32_16x16x64_bf16 v[36:39], v[68:71], v[248:255], v2
    ds_write_b128 v6, v[32:35] offset:2048
    s_lshl_b32 s46, s45, 14
    s_add_u32 s61, s58, s46
    s_lshl_b32 s46, s45, 15
    s_add_u32 s62, s59, s46
    s_waitcnt lgkmcnt(0)
    s_barrier
    ds_read_b128 v[40:43], v7
    ds_read_b128 v[44:47], v8
    ds_read_b128 v[48:51], v18
    v_mov_b32 v19, s60
    s_waitcnt lgkmcnt(2)
    v_pk_add_f32 v[36:37], v[36:37], v[40:41]
    v_pk_add_f32 v[38:39], v[38:39], v[42:43]
    s_waitcnt lgkmcnt(1)
    v_pk_add_f32 v[36:37], v[36:37], v[44:45]
    v_pk_add_f32 v[38:39], v[38:39], v[46:47]
    s_waitcnt lgkmcnt(0)
    v_pk_add_f32 v[36:37], v[36:37], v[48:49]
    v_pk_add_f32 v[38:39], v[38:39], v[50:51]
    s_nop 1
    v_permlane32_swap_b32 v36, v38
    v_permlane32_swap_b32 v37, v39
    v_pk_add_f32 v[24:25], v[36:37], v[38:39]
    buffer_store_dwordx2 v[24:25], v11, s[12:15], s48 offen sc1
    ds_read_b128 v[56:59], v5 offset:8192
    ds_read_b128 v[60:63], v5 offset:9216
    ds_read_b128 v[64:67], v5 offset:16384
    ds_read_b128 v[68:71], v5 offset:17408
    ds_read_b128 v[72:75], v5 offset:4096
    ds_read_b128 v[76:79], v5 offset:5120
    ds_read_b128 v[88:91], v5 offset:6144
    ds_read_b128 v[92:95], v5 offset:7168
    ds_read_b128 v[32:35], v5 offset:14336
    ds_read_b128 v[36:39], v5 offset:15360
    s_sleep 4
    buffer_load_dwordx2 v[40:41], v11, s[12:15], s49 offen sc1
    s_mov_b32 s70, 0
L_v_xp_100:
    s_waitcnt vmcnt(0)
    v_max_u32 v22, v40, v41
    v_cmp_eq_u32 vcc, -1, v22
    v_pk_add_f32 v[28:29], v[24:25], v[40:41]
    v_cvt_pk_bf16_f32 v28, v28, v29
    s_cbranch_vccnz L_v_xp_100_r
L_v_xp_100_ok:
    buffer_store_dword v19, v20, s[24:27], 0 offen
    v_mov_b32_dpp v29, v28 quad_perm:[1,0,3,2] row_mask:0xf bank_mask:0xf
    v_perm_b32 v28, v28, v29, v9
    buffer_store_dword v28, v12, s[24:27], s61 offen
    buffer_store_dword v28, v12, s[28:31], s61 offen sc1
    buffer_store_dword v19, v20, s[28:31], 0 offen sc1
    s_add_u32 s66, s66, 65536
    s_branch L_v_loop_94
L_v_fin_96:
    buffer_store_dwordx2 v[16:17], v10, s[12:15], s66 offen sc1
    s_waitcnt vmcnt(0)
    v_mov_b32 v22, 64
    v_mov_b32 v0, 0
    s_mov_b64 exec, 1
    buffer_store_dword v22, v0, s[12:15], s3 offen sc1
    s_mov_b64 exec, -1
L_c_done_1:
    s_endpgm
L_v_og_99_r0:
    buffer_load_dwordx4 v[40:43], v80, s[12:15], s62 offen sc1
    buffer_load_dwordx4 v[44:47], v81, s[12:15], s62 offen sc1
    buffer_load_dwordx4 v[48:51], v82, s[12:15], s62 offen sc1
    buffer_load_dwordx4 v[52:55], v83, s[12:15], s62 offen sc1
    buffer_load_dwordx4 v[56:59], v84, s[12:15], s62 offen sc1
    buffer_load_dwordx4 v[60:63], v85, s[12:15], s62 offen sc1
    s_add_u32 s70, s70, 1
    s_cmp_ge_u32 s70, 0x100000
    s_cbranch_scc1 L_c_done_1
    s_waitcnt vmcnt(5)
    v_cmp_eq_u32 vcc, -1, v43
    s_nop 1
    s_cbranch_vccnz L_v_og_99_r0
    s_branch L_v_og_99_c0
L_v_og_99_r1:
    buffer_load_dwordx4 v[44:47], v81, s[12:15], s62 offen sc1
    buffer_load_dwordx4 v[48:51], v82, s[12:15], s62 offen sc1
    buffer_load_dwordx4 v[52:55], v83, s[12:15], s62 offen sc1
    buffer_load_dwordx4 v[56:59], v84, s[12:15], s62 offen sc1
    buffer_load_dwordx4 v[60:63], v85, s[12:15], s62 offen sc1
    buffer_load_dwordx4 v[64:67], v86, s[12:15], s62 offen sc1
    s_add_u32 s70, s70, 1
    s_cmp_ge_u32 s70, 0x100000
    s_cbranch_scc1 L_c_done_1
    s_waitcnt vmcnt(5)
    v_cmp_eq_u32 vcc, -1, v47
    s_nop 1
    s_cbranch_vccnz L_v_og_99_r1
    s_branch L_v_og_99_c1
L_v_og_99_r2:
    buffer_load_dwordx4 v[48:51], v82, s[12:15], s62 offen sc1
    buffer_load_dwordx4 v[52:55], v83, s[12:15], s62 offen sc1
    buffer_load_dwordx4 v[56:59], v84, s[12:15], s62 offen sc1
    buffer_load_dwordx4 v[60:63], v85, s[12:15], s62 offen sc1
    buffer_load_dwordx4 v[64:67], v86, s[12:15], s62 offen sc1
    buffer_load_dwordx4 v[68:71], v87, s[12:15], s62 offen sc1
    s_add_u32 s70, s70, 1
    s_cmp_ge_u32 s70, 0x100000
    s_cbranch_scc1 L_c_done_1
    s_waitcnt vmcnt(5)
    v_cmp_eq_u32 vcc, -1, v51
    s_nop 1
    s_cbranch_vccnz L_v_og_99_r2
    s_branch L_v_og_99_c2
L_v_og_99_r3:
    buffer_load_dwordx4 v[52:55], v83, s[12:15], s62 offen sc1
    buffer_load_dwordx4 v[56:59], v84, s[12:15], s62 offen sc1
    buffer_load_dwordx4 v[60:63], v85, s[12:15], s62 offen sc1
    buffer_load_dwordx4 v[64:67], v86, s[12:15], s62 offen sc1
    buffer_load_dwordx4 v[68:71], v87, s[12:15], s62 offen sc1
    s_add_u32 s70, s70, 1
    s_cmp_ge_u32 s70, 0x100000
    s_cbranch_scc1 L_c_done_1
    s_waitcnt vmcnt(4)
    v_cmp_eq_u32 vcc, -1, v55
    s_nop 1
    s_cbranch_vccnz L_v_og_99_r3
    s_branch L_v_og_99_c3
L_v_og_99_r4:
    buffer_load_dwordx4 v[56:59], v84, s[12:15], s62 offen sc1
    buffer_load_dwordx4 v[60:63], v85, s[12:15], s62 offen sc1
    buffer_load_dwordx4 v[64:67], v86, s[12:15], s62 offen sc1
    buffer_load_dwordx4 v[68:71], v87, s[12:15], s62 offen sc1
    s_add_u32 s70, s70, 1
    s_cmp_ge_u32 s70, 0x100000
    s_cbranch_scc1 L_c_done_1
    s_waitcnt vmcnt(3)
    v_cmp_eq_u32 vcc, -1, v59
    s_nop 1
    s_cbranch_vccnz L_v_og_99_r4
    s_branch L_v_og_99_c4
L_v_og_99_r5:
    buffer_load_dwordx4 v[60:63], v85, s[12:15], s62 offen sc1
    buffer_load_dwordx4 v[64:67], v86, s[12:15], s62 offen sc1
    buffer_load_dwordx4 v[68:71], v87, s[12:15], s62 offen sc1
    s_add_u32 s70, s70, 1
    s_cmp_ge_u32 s70, 0x100000
    s_cbranch_scc1 L_c_done_1
    s_waitcnt vmcnt(2)
    v_cmp_eq_u32 vcc, -1, v63
    s_nop 1
    s_cbranch_vccnz L_v_og_99_r5
    s_branch L_v_og_99_c5
L_v_og_99_r6:
    buffer_load_dwordx4 v[64:67], v86, s[12:15], s62 offen sc1
    buffer_load_dwordx4 v[68:71], v87, s[12:15], s62 offen sc1
    s_add_u32 s70, s70, 1
    s_cmp_ge_u32 s70, 0x100000
    s_cbranch_scc1 L_c_done_1
    s_waitcnt vmcnt(1)
    v_cmp_eq_u32 vcc, -1, v67
    s_nop 1
    s_cbranch_vccnz L_v_og_99_r6
    s_branch L_v_og_99_c6
L_v_og_99_r7:
    buffer_load_dwordx4 v[68:71], v87, s[12:15], s62 offen sc1
    s_add_u32 s70, s70, 1
    s_cmp_ge_u32 s70, 0x100000
    s_cbranch_scc1 L_c_done_1
    s_waitcnt vmcnt(0)
    v_cmp_eq_u32 vcc, -1, v71
    s_nop 1
    s_cbranch_vccnz L_v_og_99_r7
    s_branch L_v_og_99_c7
L_mg_95_r0:
    buffer_load_dwordx4 v[40:43], v3, s[12:15], s8 offen sc1
    buffer_load_dwordx4 v[44:47], v3, s[12:15], s9 offen sc1
    buffer_load_dwordx4 v[48:51], v3, s[12:15], s10 offen sc1
    buffer_load_dwordx4 v[52:55], v3, s[12:15], s11 offen sc1
    s_add_u32 s70, s70, 1
    s_cmp_ge_u32 s70, 0x100000
    s_cbranch_scc1 L_c_done_1
    s_waitcnt vmcnt(3)
    ds_write_b128 v3, v[40:43] offset:0
    v_max3_u32 v22, v40, v41, v42
    v_max_u32 v22, v22, v43
    v_cmp_eq_u32 vcc, -1, v22
    s_waitcnt lgkmcnt(0)
    s_nop 0
    s_cbranch_vccnz L_mg_95_r0
    s_branch L_mg_95_c0
L_mg_95_r1:
    buffer_load_dwordx4 v[44:47], v3, s[12:15], s9 offen sc1
    buffer_load_dwordx4 v[48:51], v3, s[12:15], s10 offen sc1
    buffer_load_dwordx4 v[52:55], v3, s[12:15], s11 offen sc1
    s_add_u32 s70, s70, 1
    s_cmp_ge_u32 s70, 0x100000
    s_cbranch_scc1 L_c_done_1
    s_waitcnt vmcnt(2)
    ds_write_b128 v3, v[44:47] offset:1024
    v_max3_u32 v22, v44, v45, v46
    v_max_u32 v22, v22, v47
    v_cmp_eq_u32 vcc, -1, v22
    s_waitcnt lgkmcnt(0)
    s_nop 0
    s_cbranch_vccnz L_mg_95_r1
    s_branch L_mg_95_c1
L_mg_95_r2:
    buffer_load_dwordx4 v[48:51], v3, s[12:15], s10 offen sc1
    buffer_load_dwordx4 v[52:55], v3, s[12:15], s11 offen sc1
    s_add_u32 s70, s70, 1
    s_cmp_ge_u32 s70, 0x100000
    s_cbranch_scc1 L_c_done_1
    s_waitcnt vmcnt(1)
    ds_write_b128 v3, v[48:51] offset:2048
    v_max3_u32 v22, v48, v49, v50
    v_max_u32 v22, v22, v51
    v_cmp_eq_u32 vcc, -1, v22
    s_waitcnt lgkmcnt(0)
    s_nop 0
    s_cbranch_vccnz L_mg_95_r2
    s_branch L_mg_95_c2
L_mg_95_r3:
    buffer_load_dwordx4 v[52:55], v3, s[12:15], s11 offen sc1
    s_add_u32 s70, s70, 1
    s_cmp_ge_u32 s70, 0x100000
    s_cbranch_scc1 L_c_done_1
    s_waitcnt vmcnt(0)
    ds_write_b128 v3, v[52:55] offset:3072
    v_max3_u32 v22, v52, v53, v54
    v_max_u32 v22, v22, v55
    v_cmp_eq_u32 vcc, -1, v22
    s_waitcnt lgkmcnt(0)
    s_nop 0
    s_cbranch_vccnz L_mg_95_r3
    s_branch L_mg_95_c3
L_v_xp_100_r:
    buffer_load_dwordx2 v[40:41], v11, s[12:15], s49 offen sc1
    s_add_u32 s70, s70, 1
    s_cmp_lt_u32 s70, 0x100000
    s_cbranch_scc1 L_v_xp_100
    s_endpgm
L_worker_3:
    s_lshr_b32 s41, s2, 3
    s_and_b32 s42, s40, 1
    s_lshr_b32 s43, s40, 1
    s_lshl_b32 s39, s43, 5
    s_add_u32 s39, s39, s41
    s_load_dwordx2 s[4:5], s[0:1], 0
    s_waitcnt lgkmcnt(0)
    s_mov_b32 s28, s4
    s_and_b32 s29, s5, 0xffff
    s_mov_b32 s30, 0x400000
    s_mov_b32 s31, 0x00020000
    v_lshrrev_b32 v2, 4, v1
    v_and_b32 v4, 15, v1
    v_lshrrev_b32 v3, 1, v4
    v_xor_b32 v3, v3, v2
    v_lshlrev_b32 v3, 4, v3
    v_lshlrev_b32 v6, 7, v4
    v_add_u32 v3, v3, v6
    v_mul_u32_u24 v7, 144, v4
    v_lshlrev_b32 v6, 4, v2
    s_mul_i32 s45, s44, 4608
    s_add_u32 s45, s45, 131072
    v_add3_u32 v7, v7, v6, s45
    v_lshrrev_b32 v9, 3, v1
    v_mul_u32_u24 v8, 144, v9
    v_and_b32 v6, 7, v1
    v_lshlrev_b32 v6, 4, v6
    v_add3_u32 v8, v8, v6, s45
    v_lshlrev_b32 v11, 12, v9
    v_add_u32 v11, v11, v6
    v_lshlrev_b32 v2, 13, v2
    v_lshlrev_b32 v6, 4, v4
    v_add_u32 v2, v2, v6
    v_lshrrev_b32 v6, 3, v1
    v_lshrrev_b32 v9, 4, v1
    v_and_b32 v4, 7, v1
    v_xor_b32 v9, v9, v4
    v_lshlrev_b32 v9, 4, v9
    v_lshlrev_b32 v6, 8, v6
    v_add_u32 v6, v6, v9
    v_xor_b32 v9, 64, v6
    v_add_u32 v9, 2048, v9
    v_lshlrev_b32 v10, 4, v1
    v_lshlrev_b32 v12, 2, v1
    v_lshlrev_b32 v5, 7, v1
    s_lshl_b32 s61, s41, 7
    s_lshl_b32 s45, s43, 2
    s_add_u32 s61, s61, s45
    s_add_u32 s61, s61, 0x10010
    s_mul_i32 s64, s42, 24576
    s_add_u32 s64, s64, 0x12000
    s_lshl_b32 s45, s41, 7
    s_add_u32 s65, s64, s45
    s_lshl_b32 s45, s43, 13
    s_add_u32 s65, s65, s45
    s_add_u32 s67, s65, 4096
    s_cmp_lg_u32 s42, 0
    s_cbranch_scc1 L_w_kv_102
    v_mov_b32 v30, 0
    v_mov_b32 v31, 0
    v_mov_b32 v29, 24576
    s_mov_b64 exec, 1
    buffer_store_dword v30, v31, s[12:15], s61 offen sc1
    buffer_store_dword v30, v31, s[12:15], s65 offen sc1
    buffer_store_dword v30, v31, s[12:15], s67 offen sc1
    buffer_store_dword v30, v29, s[12:15], s65 offen sc1
    buffer_store_dword v30, v29, s[12:15], s67 offen sc1
    s_mov_b64 exec, -1
    s_lshl_b32 s63, s39, 2
    s_add_u32 s63, s63, s44
    s_load_dwordx2 s[4:5], s[0:1], 96
    s_load_dwordx2 s[6:7], s[0:1], 104
    v_and_b32 v14, 7, v0
    v_lshrrev_b32 v15, 3, v0
    s_waitcnt lgkmcnt(0)
    s_mov_b32 s32, s4
    s_and_b32 s33, s5, 0xffff
    s_mov_b32 s34, 0x800
    s_mov_b32 s35, 0x00020000
    s_mov_b32 s24, s6
    s_and_b32 s25, s7, 0xffff
    s_mov_b32 s26, 0xc00000
    s_mov_b32 s27, 0x00020000
    s_and_b32 s47, s39, 1
    s_lshl_b32 s45, s47, 10
    v_lshlrev_b32 v16, 5, v15
    buffer_load_dwordx4 v[104:107], v16, s[32:35], s45 offen
    buffer_load_dwordx4 v[108:111], v16, s[32:35], s45 offen offset:16
    s_mov_b32 s45, 196608
    v_mul_lo_u32 v17, v15, s45
    v_lshlrev_b32 v18, 4, v14
    v_add_u32 v17, v17, v18
    s_lshr_b32 s46, s39, 1
    s_lshl_b32 s46, s46, 7
    s_mul_i32 s45, s47, 6291456
    s_add_u32 s46, s46, s45
    buffer_load_dwordx4 v[32:35], v17, s[24:27], s46 offen
    v_add_u32 v17, 12288, v17
    buffer_load_dwordx4 v[36:39], v17, s[24:27], s46 offen
    v_add_u32 v17, 12288, v17
    buffer_load_dwordx4 v[40:43], v17, s[24:27], s46 offen
    v_add_u32 v17, 12288, v17
    buffer_load_dwordx4 v[44:47], v17, s[24:27], s46 offen
    v_add_u32 v17, 12288, v17
    buffer_load_dwordx4 v[48:51], v17, s[24:27], s46 offen
    v_add_u32 v17, 12288, v17
    buffer_load_dwordx4 v[52:55], v17, s[24:27], s46 offen
    v_add_u32 v17, 12288, v17
    buffer_load_dwordx4 v[56:59], v17, s[24:27], s46 offen
    v_add_u32 v17, 12288, v17
    buffer_load_dwordx4 v[60:63], v17, s[24:27], s46 offen
    v_add_u32 v17, 12288, v17
    buffer_load_dwordx4 v[64:67], v17, s[24:27], s46 offen
    v_add_u32 v17, 12288, v17
    buffer_load_dwordx4 v[68:71], v17, s[24:27], s46 offen
    v_add_u32 v17, 12288, v17
    buffer_load_dwordx4 v[72:75], v17, s[24:27], s46 offen
    v_add_u32 v17, 12288, v17
    buffer_load_dwordx4 v[76:79], v17, s[24:27], s46 offen
    v_add_u32 v17, 12288, v17
    buffer_load_dwordx4 v[80:83], v17, s[24:27], s46 offen
    v_add_u32 v17, 12288, v17
    buffer_load_dwordx4 v[84:87], v17, s[24:27], s46 offen
    v_add_u32 v17, 12288, v17
    buffer_load_dwordx4 v[88:91], v17, s[24:27], s46 offen
    v_add_u32 v17, 12288, v17
    buffer_load_dwordx4 v[92:95], v17, s[24:27], s46 offen
    s_add_u32 s45, s63, 0
    s_lshl_b32 s45, s45, 11
    buffer_load_dwordx4 v[128:131], v10, s[28:31], s45 offen
    buffer_load_dwordx4 v[132:135], v10, s[28:31], s45 offen offset:1024
    s_add_u32 s45, s63, 384
    s_lshl_b32 s45, s45, 11
    buffer_load_dwordx4 v[136:139], v10, s[28:31], s45 offen
    buffer_load_dwordx4 v[140:143], v10, s[28:31], s45 offen offset:1024
    s_add_u32 s45, s63, 768
    s_lshl_b32 s45, s45, 11
    buffer_load_dwordx4 v[144:147], v10, s[28:31], s45 offen
    buffer_load_dwordx4 v[148:151], v10, s[28:31], s45 offen offset:1024
    s_add_u32 s45, s63, 1152
    s_lshl_b32 s45, s45, 11
    buffer_load_dwordx4 v[152:155], v10, s[28:31], s45 offen
    buffer_load_dwordx4 v[156:159], v10, s[28:31], s45 offen offset:1024
    s_add_u32 s45, s63, 1536
    s_lshl_b32 s45, s45, 11
    buffer_load_dwordx4 v[160:163], v10, s[28:31], s45 offen
    buffer_load_dwordx4 v[164:167], v10, s[28:31], s45 offen offset:1024
    s_add_u32 s45, s63, 1920
    s_lshl_b32 s45, s45, 11
    buffer_load_dwordx4 v[168:171], v10, s[28:31], s45 offen
    buffer_load_dwordx4 v[172:175], v10, s[28:31], s45 offen offset:1024
    s_waitcnt vmcnt(28)
    v_lshlrev_b32 v112, 16, v104
    v_and_b32 v113, 0xffff0000, v104
    v_lshlrev_b32 v114, 16, v105
    v_and_b32 v115, 0xffff0000, v105
    v_lshlrev_b32 v116, 16, v106
    v_and_b32 v117, 0xffff0000, v106
    v_lshlrev_b32 v118, 16, v107
    v_and_b32 v119, 0xffff0000, v107
    v_lshlrev_b32 v120, 16, v108
    v_and_b32 v121, 0xffff0000, v108
    v_lshlrev_b32 v122, 16, v109
    v_and_b32 v123, 0xffff0000, v109
    v_lshlrev_b32 v124, 16, v110
    v_and_b32 v125, 0xffff0000, v110
    v_lshlrev_b32 v126, 16, v111
    v_and_b32 v127, 0xffff0000, v111
    v_mul_f32 v18, 0xbfb8aa3b, v112
    v_exp_f32 v18, v18
    s_nop 0
    v_add_f32 v18, 1.0, v18
    v_rcp_f32 v18, v18
    s_nop 0
    v_mul_f32 v112, v112, v18
    v_cvt_pk_bf16_f32 v112, v112, v112
    v_lshlrev_b32 v112, 16, v112
    v_mul_f32 v18, 0xbfb8aa3b, v113
    v_exp_f32 v18, v18
    s_nop 0
    v_add_f32 v18, 1.0, v18
    v_rcp_f32 v18, v18
    s_nop 0
    v_mul_f32 v113, v113, v18
    v_cvt_pk_bf16_f32 v113, v113, v113
    v_lshlrev_b32 v113, 16, v113
    v_mul_f32 v18, 0xbfb8aa3b, v114
    v_exp_f32 v18, v18
    s_nop 0
    v_add_f32 v18, 1.0, v18
    v_rcp_f32 v18, v18
    s_nop 0
    v_mul_f32 v114, v114, v18
    v_cvt_pk_bf16_f32 v114, v114, v114
    v_lshlrev_b32 v114, 16, v114
    v_mul_f32 v18, 0xbfb8aa3b, v115
    v_exp_f32 v18, v18
    s_nop 0
    v_add_f32 v18, 1.0, v18
    v_rcp_f32 v18, v18
    s_nop 0
    v_mul_f32 v115, v115, v18
    v_cvt_pk_bf16_f32 v115, v115, v115
    v_lshlrev_b32 v115, 16, v115
    v_mul_f32 v18, 0xbfb8aa3b, v116
    v_exp_f32 v18, v18
    s_nop 0
    v_add_f32 v18, 1.0, v18
    v_rcp_f32 v18, v18
    s_nop 0
    v_mul_f32 v116, v116, v18
    v_cvt_pk_bf16_f32 v116, v116, v116
    v_lshlrev_b32 v116, 16, v116
    v_mul_f32 v18, 0xbfb8aa3b, v117
    v_exp_f32 v18, v18
    s_nop 0
    v_add_f32 v18, 1.0, v18
    v_rcp_f32 v18, v18
    s_nop 0
    v_mul_f32 v117, v117, v18
    v_cvt_pk_bf16_f32 v117, v117, v117
    v_lshlrev_b32 v117, 16, v117
    v_mul_f32 v18, 0xbfb8aa3b, v118
    v_exp_f32 v18, v18
    s_nop 0
    v_add_f32 v18, 1.0, v18
    v_rcp_f32 v18, v18
    s_nop 0
    v_mul_f32 v118, v118, v18
    v_cvt_pk_bf16_f32 v118, v118, v118
    v_lshlrev_b32 v118, 16, v118
    v_mul_f32 v18, 0xbfb8aa3b, v119
    v_exp_f32 v18, v18
    s_nop 0
    v_add_f32 v18, 1.0, v18
    v_rcp_f32 v18, v18
    s_nop 0
    v_mul_f32 v119, v119, v18
    v_cvt_pk_bf16_f32 v119, v119, v119
    v_lshlrev_b32 v119, 16, v119
    v_mul_f32 v18, 0xbfb8aa3b, v120
    v_exp_f32 v18, v18
    s_nop 0
    v_add_f32 v18, 1.0, v18
    v_rcp_f32 v18, v18
    s_nop 0
    v_mul_f32 v120, v120, v18
    v_cvt_pk_bf16_f32 v120, v120, v120
    v_lshlrev_b32 v120, 16, v120
    v_mul_f32 v18, 0xbfb8aa3b, v121
    v_exp_f32 v18, v18
    s_nop 0
    v_add_f32 v18, 1.0, v18
    v_rcp_f32 v18, v18
    s_nop 0
    v_mul_f32 v121, v121, v18
    v_cvt_pk_bf16_f32 v121, v121, v121
    v_lshlrev_b32 v121, 16, v121
    v_mul_f32 v18, 0xbfb8aa3b, v122
    v_exp_f32 v18, v18
    s_nop 0
    v_add_f32 v18, 1.0, v18
    v_rcp_f32 v18, v18
    s_nop 0
    v_mul_f32 v122, v122, v18
    v_cvt_pk_bf16_f32 v122, v122, v122
    v_lshlrev_b32 v122, 16, v122
    v_mul_f32 v18, 0xbfb8aa3b, v123
    v_exp_f32 v18, v18
    s_nop 0
    v_add_f32 v18, 1.0, v18
    v_rcp_f32 v18, v18
    s_nop 0
    v_mul_f32 v123, v123, v18
    v_cvt_pk_bf16_f32 v123, v123, v123
    v_lshlrev_b32 v123, 16, v123
    v_mul_f32 v18, 0xbfb8aa3b, v124
    v_exp_f32 v18, v18
    s_nop 0
    v_add_f32 v18, 1.0, v18
    v_rcp_f32 v18, v18
    s_nop 0
    v_mul_f32 v124, v124, v18
    v_cvt_pk_bf16_f32 v124, v124, v124
    v_lshlrev_b32 v124, 16, v124
    v_mul_f32 v18, 0xbfb8aa3b, v125
    v_exp_f32 v18, v18
    s_nop 0
    v_add_f32 v18, 1.0, v18
    v_rcp_f32 v18, v18
    s_nop 0
    v_mul_f32 v125, v125, v18
    v_cvt_pk_bf16_f32 v125, v125, v125
    v_lshlrev_b32 v125, 16, v125
    v_mul_f32 v18, 0xbfb8aa3b, v126
    v_exp_f32 v18, v18
    s_nop 0
    v_add_f32 v18, 1.0, v18
    v_rcp_f32 v18, v18
    s_nop 0
    v_mul_f32 v126, v126, v18
    v_cvt_pk_bf16_f32 v126, v126, v126
    v_lshlrev_b32 v126, 16, v126
    v_mul_f32 v18, 0xbfb8aa3b, v127
    v_exp_f32 v18, v18
    s_nop 0
    v_add_f32 v18, 1.0, v18
    v_rcp_f32 v18, v18
    s_nop 0
    v_mul_f32 v127, v127, v18
    v_cvt_pk_bf16_f32 v127, v127, v127
    v_lshlrev_b32 v127, 16, v127
    v_mov_b32 v96, 0
    v_mov_b32 v97, 0
    v_mov_b32 v98, 0
    v_mov_b32 v99, 0
    v_mov_b32 v100, 0
    v_mov_b32 v101, 0
    v_mov_b32 v102, 0
    v_mov_b32 v103, 0
    s_waitcnt vmcnt(27)
    v_lshlrev_b32 v18, 16, v32
    v_and_b32 v19, 0xffff0000, v32
    v_fmac_f32 v96, v18, v112
    v_fmac_f32 v97, v19, v112
    v_lshlrev_b32 v18, 16, v33
    v_and_b32 v19, 0xffff0000, v33
    v_fmac_f32 v98, v18, v112
    v_fmac_f32 v99, v19, v112
    v_lshlrev_b32 v18, 16, v34
    v_and_b32 v19, 0xffff0000, v34
    v_fmac_f32 v100, v18, v112
    v_fmac_f32 v101, v19, v112
    v_lshlrev_b32 v18, 16, v35
    v_and_b32 v19, 0xffff0000, v35
    v_fmac_f32 v102, v18, v112
    v_fmac_f32 v103, v19, v112
    s_waitcnt vmcnt(26)
    v_lshlrev_b32 v18, 16, v36
    v_and_b32 v19, 0xffff0000, v36
    v_fmac_f32 v96, v18, v113
    v_fmac_f32 v97, v19, v113
    v_lshlrev_b32 v18, 16, v37
    v_and_b32 v19, 0xffff0000, v37
    v_fmac_f32 v98, v18, v113
    v_fmac_f32 v99, v19, v113
    v_lshlrev_b32 v18, 16, v38
    v_and_b32 v19, 0xffff0000, v38
    v_fmac_f32 v100, v18, v113
    v_fmac_f32 v101, v19, v113
    v_lshlrev_b32 v18, 16, v39
    v_and_b32 v19, 0xffff0000, v39
    v_fmac_f32 v102, v18, v113
    v_fmac_f32 v103, v19, v113
    s_waitcnt vmcnt(25)
    v_lshlrev_b32 v18, 16, v40
    v_and_b32 v19, 0xffff0000, v40
    v_fmac_f32 v96, v18, v114
    v_fmac_f32 v97, v19, v114
    v_lshlrev_b32 v18, 16, v41
    v_and_b32 v19, 0xffff0000, v41
    v_fmac_f32 v98, v18, v114
    v_fmac_f32 v99, v19, v114
    v_lshlrev_b32 v18, 16, v42
    v_and_b32 v19, 0xffff0000, v42
    v_fmac_f32 v100, v18, v114
    v_fmac_f32 v101, v19, v114
    v_lshlrev_b32 v18, 16, v43
    v_and_b32 v19, 0xffff0000, v43
    v_fmac_f32 v102, v18, v114
    v_fmac_f32 v103, v19, v114
    s_waitcnt vmcnt(24)
    v_lshlrev_b32 v18, 16, v44
    v_and_b32 v19, 0xffff0000, v44
    v_fmac_f32 v96, v18, v115
    v_fmac_f32 v97, v19, v115
    v_lshlrev_b32 v18, 16, v45
    v_and_b32 v19, 0xffff0000, v45
    v_fmac_f32 v98, v18, v115
    v_fmac_f32 v99, v19, v115
    v_lshlrev_b32 v18, 16, v46
    v_and_b32 v19, 0xffff0000, v46
    v_fmac_f32 v100, v18, v115
    v_fmac_f32 v101, v19, v115
    v_lshlrev_b32 v18, 16, v47
    v_and_b32 v19, 0xffff0000, v47
    v_fmac_f32 v102, v18, v115
    v_fmac_f32 v103, v19, v115
    s_waitcnt vmcnt(23)
    v_lshlrev_b32 v18, 16, v48
    v_and_b32 v19, 0xffff0000, v48
    v_fmac_f32 v96, v18, v116
    v_fmac_f32 v97, v19, v116
    v_lshlrev_b32 v18, 16, v49
    v_and_b32 v19, 0xffff0000, v49
    v_fmac_f32 v98, v18, v116
    v_fmac_f32 v99, v19, v116
    v_lshlrev_b32 v18, 16, v50
    v_and_b32 v19, 0xffff0000, v50
    v_fmac_f32 v100, v18, v116
    v_fmac_f32 v101, v19, v116
    v_lshlrev_b32 v18, 16, v51
    v_and_b32 v19, 0xffff0000, v51
    v_fmac_f32 v102, v18, v116
    v_fmac_f32 v103, v19, v116
    s_waitcnt vmcnt(22)
    v_lshlrev_b32 v18, 16, v52
    v_and_b32 v19, 0xffff0000, v52
    v_fmac_f32 v96, v18, v117
    v_fmac_f32 v97, v19, v117
    v_lshlrev_b32 v18, 16, v53
    v_and_b32 v19, 0xffff0000, v53
    v_fmac_f32 v98, v18, v117
    v_fmac_f32 v99, v19, v117
    v_lshlrev_b32 v18, 16, v54
    v_and_b32 v19, 0xffff0000, v54
    v_fmac_f32 v100, v18, v117
    v_fmac_f32 v101, v19, v117
    v_lshlrev_b32 v18, 16, v55
    v_and_b32 v19, 0xffff0000, v55
    v_fmac_f32 v102, v18, v117
    v_fmac_f32 v103, v19, v117
    s_waitcnt vmcnt(21)
    v_lshlrev_b32 v18, 16, v56
    v_and_b32 v19, 0xffff0000, v56
    v_fmac_f32 v96, v18, v118
    v_fmac_f32 v97, v19, v118
    v_lshlrev_b32 v18, 16, v57
    v_and_b32 v19, 0xffff0000, v57
    v_fmac_f32 v98, v18, v118
    v_fmac_f32 v99, v19, v118
    v_lshlrev_b32 v18, 16, v58
    v_and_b32 v19, 0xffff0000, v58
    v_fmac_f32 v100, v18, v118
    v_fmac_f32 v101, v19, v118
    v_lshlrev_b32 v18, 16, v59
    v_and_b32 v19, 0xffff0000, v59
    v_fmac_f32 v102, v18, v118
    v_fmac_f32 v103, v19, v118
    s_waitcnt vmcnt(20)
    v_lshlrev_b32 v18, 16, v60
    v_and_b32 v19, 0xffff0000, v60
    v_fmac_f32 v96, v18, v119
    v_fmac_f32 v97, v19, v119
    v_lshlrev_b32 v18, 16, v61
    v_and_b32 v19, 0xffff0000, v61
    v_fmac_f32 v98, v18, v119
    v_fmac_f32 v99, v19, v119
    v_lshlrev_b32 v18, 16, v62
    v_and_b32 v19, 0xffff0000, v62
    v_fmac_f32 v100, v18, v119
    v_fmac_f32 v101, v19, v119
    v_lshlrev_b32 v18, 16, v63
    v_and_b32 v19, 0xffff0000, v63
    v_fmac_f32 v102, v18, v119
    v_fmac_f32 v103, v19, v119
    s_waitcnt vmcnt(19)
    v_lshlrev_b32 v18, 16, v64
    v_and_b32 v19, 0xffff0000, v64
    v_fmac_f32 v96, v18, v120
    v_fmac_f32 v97, v19, v120
    v_lshlrev_b32 v18, 16, v65
    v_and_b32 v19, 0xffff0000, v65
    v_fmac_f32 v98, v18, v120
    v_fmac_f32 v99, v19, v120
    v_lshlrev_b32 v18, 16, v66
    v_and_b32 v19, 0xffff0000, v66
    v_fmac_f32 v100, v18, v120
    v_fmac_f32 v101, v19, v120
    v_lshlrev_b32 v18, 16, v67
    v_and_b32 v19, 0xffff0000, v67
    v_fmac_f32 v102, v18, v120
    v_fmac_f32 v103, v19, v120
    s_waitcnt vmcnt(18)
    v_lshlrev_b32 v18, 16, v68
    v_and_b32 v19, 0xffff0000, v68
    v_fmac_f32 v96, v18, v121
    v_fmac_f32 v97, v19, v121
    v_lshlrev_b32 v18, 16, v69
    v_and_b32 v19, 0xffff0000, v69
    v_fmac_f32 v98, v18, v121
    v_fmac_f32 v99, v19, v121
    v_lshlrev_b32 v18, 16, v70
    v_and_b32 v19, 0xffff0000, v70
    v_fmac_f32 v100, v18, v121
    v_fmac_f32 v101, v19, v121
    v_lshlrev_b32 v18, 16, v71
    v_and_b32 v19, 0xffff0000, v71
    v_fmac_f32 v102, v18, v121
    v_fmac_f32 v103, v19, v121
    s_waitcnt vmcnt(17)
    v_lshlrev_b32 v18, 16, v72
    v_and_b32 v19, 0xffff0000, v72
    v_fmac_f32 v96, v18, v122
    v_fmac_f32 v97, v19, v122
    v_lshlrev_b32 v18, 16, v73
    v_and_b32 v19, 0xffff0000, v73
    v_fmac_f32 v98, v18, v122
    v_fmac_f32 v99, v19, v122
    v_lshlrev_b32 v18, 16, v74
    v_and_b32 v19, 0xffff0000, v74
    v_fmac_f32 v100, v18, v122
    v_fmac_f32 v101, v19, v122
    v_lshlrev_b32 v18, 16, v75
    v_and_b32 v19, 0xffff0000, v75
    v_fmac_f32 v102, v18, v122
    v_fmac_f32 v103, v19, v122
    s_waitcnt vmcnt(16)
    v_lshlrev_b32 v18, 16, v76
    v_and_b32 v19, 0xffff0000, v76
    v_fmac_f32 v96, v18, v123
    v_fmac_f32 v97, v19, v123
    v_lshlrev_b32 v18, 16, v77
    v_and_b32 v19, 0xffff0000, v77
    v_fmac_f32 v98, v18, v123
    v_fmac_f32 v99, v19, v123
    v_lshlrev_b32 v18, 16, v78
    v_and_b32 v19, 0xffff0000, v78
    v_fmac_f32 v100, v18, v123
    v_fmac_f32 v101, v19, v123
    v_lshlrev_b32 v18, 16, v79
    v_and_b32 v19, 0xffff0000, v79
    v_fmac_f32 v102, v18, v123
    v_fmac_f32 v103, v19, v123
    s_waitcnt vmcnt(15)
    v_lshlrev_b32 v18, 16, v80
    v_and_b32 v19, 0xffff0000, v80
    v_fmac_f32 v96, v18, v124
    v_fmac_f32 v97, v19, v124
    v_lshlrev_b32 v18, 16, v81
    v_and_b32 v19, 0xffff0000, v81
    v_fmac_f32 v98, v18, v124
    v_fmac_f32 v99, v19, v124
    v_lshlrev_b32 v18, 16, v82
    v_and_b32 v19, 0xffff0000, v82
    v_fmac_f32 v100, v18, v124
    v_fmac_f32 v101, v19, v124
    v_lshlrev_b32 v18, 16, v83
    v_and_b32 v19, 0xffff0000, v83
    v_fmac_f32 v102, v18, v124
    v_fmac_f32 v103, v19, v124
    s_waitcnt vmcnt(14)
    v_lshlrev_b32 v18, 16, v84
    v_and_b32 v19, 0xffff0000, v84
    v_fmac_f32 v96, v18, v125
    v_fmac_f32 v97, v19, v125
    v_lshlrev_b32 v18, 16, v85
    v_and_b32 v19, 0xffff0000, v85
    v_fmac_f32 v98, v18, v125
    v_fmac_f32 v99, v19, v125
    v_lshlrev_b32 v18, 16, v86
    v_and_b32 v19, 0xffff0000, v86
    v_fmac_f32 v100, v18, v125
    v_fmac_f32 v101, v19, v125
    v_lshlrev_b32 v18, 16, v87
    v_and_b32 v19, 0xffff0000, v87
    v_fmac_f32 v102, v18, v125
    v_fmac_f32 v103, v19, v125
    s_waitcnt vmcnt(13)
    v_lshlrev_b32 v18, 16, v88
    v_and_b32 v19, 0xffff0000, v88
    v_fmac_f32 v96, v18, v126
    v_fmac_f32 v97, v19, v126
    v_lshlrev_b32 v18, 16, v89
    v_and_b32 v19, 0xffff0000, v89
    v_fmac_f32 v98, v18, v126
    v_fmac_f32 v99, v19, v126
    v_lshlrev_b32 v18, 16, v90
    v_and_b32 v19, 0xffff0000, v90
    v_fmac_f32 v100, v18, v126
    v_fmac_f32 v101, v19, v126
    v_lshlrev_b32 v18, 16, v91
    v_and_b32 v19, 0xffff0000, v91
    v_fmac_f32 v102, v18, v126
    v_fmac_f32 v103, v19, v126
    s_waitcnt vmcnt(12)
    v_lshlrev_b32 v18, 16, v92
    v_and_b32 v19, 0xffff0000, v92
    v_fmac_f32 v96, v18, v127
    v_fmac_f32 v97, v19, v127
    v_lshlrev_b32 v18, 16, v93
    v_and_b32 v19, 0xffff0000, v93
    v_fmac_f32 v98, v18, v127
    v_fmac_f32 v99, v19, v127
    v_lshlrev_b32 v18, 16, v94
    v_and_b32 v19, 0xffff0000, v94
    v_fmac_f32 v100, v18, v127
    v_fmac_f32 v101, v19, v127
    v_lshlrev_b32 v18, 16, v95
    v_and_b32 v19, 0xffff0000, v95
    v_fmac_f32 v102, v18, v127
    v_fmac_f32 v103, v19, v127
    v_lshlrev_b32 v16, 5, v0
    ds_write_b128 v16, v[96:99]
    ds_write_b128 v16, v[100:103] offset:16
    s_waitcnt lgkmcnt(0)
    s_barrier
    s_cmp_lg_u32 s44, 0
    s_cbranch_scc1 L_mod_fin_104
    v_mov_b32 v18, 0
    ds_read_b32 v32, v12 offset:0
    ds_read_b32 v33, v12 offset:256
    ds_read_b32 v34, v12 offset:512
    ds_read_b32 v35, v12 offset:768
    ds_read_b32 v36, v12 offset:1024
    ds_read_b32 v37, v12 offset:1280
    ds_read_b32 v38, v12 offset:1536
    ds_read_b32 v39, v12 offset:1792
    ds_read_b32 v40, v12 offset:2048
    ds_read_b32 v41, v12 offset:2304
    ds_read_b32 v42, v12 offset:2560
    ds_read_b32 v43, v12 offset:2816
    ds_read_b32 v44, v12 offset:3072
    ds_read_b32 v45, v12 offset:3328
    ds_read_b32 v46, v12 offset:3584
    ds_read_b32 v47, v12 offset:3840
    s_waitcnt lgkmcnt(0)
    v_add_f32 v18, v18, v32
    v_add_f32 v18, v18, v33
    v_add_f32 v18, v18, v34
    v_add_f32 v18, v18, v35
    v_add_f32 v18, v18, v36
    v_add_f32 v18, v18, v37
    v_add_f32 v18, v18, v38
    v_add_f32 v18, v18, v39
    v_add_f32 v18, v18, v40
    v_add_f32 v18, v18, v41
    v_add_f32 v18, v18, v42
    v_add_f32 v18, v18, v43
    v_add_f32 v18, v18, v44
    v_add_f32 v18, v18, v45
    v_add_f32 v18, v18, v46
    v_add_f32 v18, v18, v47
    ds_read_b32 v32, v12 offset:4096
    ds_read_b32 v33, v12 offset:4352
    ds_read_b32 v34, v12 offset:4608
    ds_read_b32 v35, v12 offset:4864
    ds_read_b32 v36, v12 offset:5120
    ds_read_b32 v37, v12 offset:5376
    ds_read_b32 v38, v12 offset:5632
    ds_read_b32 v39, v12 offset:5888
    ds_read_b32 v40, v12 offset:6144
    ds_read_b32 v41, v12 offset:6400
    ds_read_b32 v42, v12 offset:6656
    ds_read_b32 v43, v12 offset:6912
    ds_read_b32 v44, v12 offset:7168
    ds_read_b32 v45, v12 offset:7424
    ds_read_b32 v46, v12 offset:7680
    ds_read_b32 v47, v12 offset:7936
    s_waitcnt lgkmcnt(0)
    v_add_f32 v18, v18, v32
    v_add_f32 v18, v18, v33
    v_add_f32 v18, v18, v34
    v_add_f32 v18, v18, v35
    v_add_f32 v18, v18, v36
    v_add_f32 v18, v18, v37
    v_add_f32 v18, v18, v38
    v_add_f32 v18, v18, v39
    v_add_f32 v18, v18, v40
    v_add_f32 v18, v18, v41
    v_add_f32 v18, v18, v42
    v_add_f32 v18, v18, v43
    v_add_f32 v18, v18, v44
    v_add_f32 v18, v18, v45
    v_add_f32 v18, v18, v46
    v_add_f32 v18, v18, v47
    s_lshr_b32 s45, s39, 1
    s_lshl_b32 s45, s45, 8
    s_mul_i32 s46, s47, 24576
    s_add_u32 s45, s45, s46
    buffer_store_dword v18, v12, s[12:15], s45 offen sc1
L_mod_fin_104:
    s_waitcnt vmcnt(0)
    s_barrier
    s_cmp_lg_u32 s44, 0
    s_cbranch_scc1 L_cnt_105
    v_mov_b32 v30, 1
    v_mov_b32 v31, 0
    s_mov_b64 exec, 1
    buffer_atomic_add v30, v31, s[16:19], 0 offen offset:128 sc1
    s_mov_b64 exec, -1
L_cnt_105:
    v_lshlrev_b32 v192, 16, v128
    v_and_b32 v193, 0xffff0000, v128
    v_lshlrev_b32 v194, 16, v129
    v_and_b32 v195, 0xffff0000, v129
    v_lshlrev_b32 v196, 16, v130
    v_and_b32 v197, 0xffff0000, v130
    v_lshlrev_b32 v198, 16, v131
    v_and_b32 v199, 0xffff0000, v131
    v_lshlrev_b32 v200, 16, v132
    v_and_b32 v201, 0xffff0000, v132
    v_lshlrev_b32 v202, 16, v133
    v_and_b32 v203, 0xffff0000, v133
    v_lshlrev_b32 v204, 16, v134
    v_and_b32 v205, 0xffff0000, v134
    v_lshlrev_b32 v206, 16, v135
    v_and_b32 v207, 0xffff0000, v135
    v_add_f32 v26, v192, v193
    v_add_f32 v26, v26, v194
    v_add_f32 v26, v26, v195
    v_add_f32 v26, v26, v196
    v_add_f32 v26, v26, v197
    v_add_f32 v26, v26, v198
    v_add_f32 v26, v26, v199
    v_add_f32 v26, v26, v200
    v_add_f32 v26, v26, v201
    v_add_f32 v26, v26, v202
    v_add_f32 v26, v26, v203
    v_add_f32 v26, v26, v204
    v_add_f32 v26, v26, v205
    v_add_f32 v26, v26, v206
    v_add_f32 v26, v26, v207
    s_nop 1
    v_add_f32_dpp v26, v26, v26 row_shr:1 row_mask:0xf bank_mask:0xf bound_ctrl:0
    s_nop 1
    v_add_f32_dpp v26, v26, v26 row_shr:2 row_mask:0xf bank_mask:0xf bound_ctrl:0
    s_nop 1
    v_add_f32_dpp v26, v26, v26 row_shr:4 row_mask:0xf bank_mask:0xf bound_ctrl:0
    s_nop 1
    v_add_f32_dpp v26, v26, v26 row_shr:8 row_mask:0xf bank_mask:0xf bound_ctrl:0
    s_nop 1
    v_add_f32_dpp v26, v26, v26 row_bcast:15 row_mask:0xa bank_mask:0xf
    s_nop 1
    v_add_f32_dpp v26, v26, v26 row_bcast:31 row_mask:0xc bank_mask:0xf
    s_nop 1
    v_readlane_b32 s66, v26, 63
    s_nop 1
    v_mov_b32 v27, s66
    v_mul_f32 v27, 0x3a800000, v27
    v_mov_b32 v26, 0
    v_sub_f32 v28, v192, v27
    v_fmac_f32 v26, v28, v28
    v_sub_f32 v28, v193, v27
    v_fmac_f32 v26, v28, v28
    v_sub_f32 v28, v194, v27
    v_fmac_f32 v26, v28, v28
    v_sub_f32 v28, v195, v27
    v_fmac_f32 v26, v28, v28
    v_sub_f32 v28, v196, v27
    v_fmac_f32 v26, v28, v28
    v_sub_f32 v28, v197, v27
    v_fmac_f32 v26, v28, v28
    v_sub_f32 v28, v198, v27
    v_fmac_f32 v26, v28, v28
    v_sub_f32 v28, v199, v27
    v_fmac_f32 v26, v28, v28
    v_sub_f32 v28, v200, v27
    v_fmac_f32 v26, v28, v28
    v_sub_f32 v28, v201, v27
    v_fmac_f32 v26, v28, v28
    v_sub_f32 v28, v202, v27
    v_fmac_f32 v26, v28, v28
    v_sub_f32 v28, v203, v27
    v_fmac_f32 v26, v28, v28
    v_sub_f32 v28, v204, v27
    v_fmac_f32 v26, v28, v28
    v_sub_f32 v28, v205, v27
    v_fmac_f32 v26, v28, v28
    v_sub_f32 v28, v206, v27
    v_fmac_f32 v26, v28, v28
    v_sub_f32 v28, v207, v27
    v_fmac_f32 v26, v28, v28
    s_nop 1
    v_add_f32_dpp v26, v26, v26 row_shr:1 row_mask:0xf bank_mask:0xf bound_ctrl:0
    s_nop 1
    v_add_f32_dpp v26, v26, v26 row_shr:2 row_mask:0xf bank_mask:0xf bound_ctrl:0
    s_nop 1
    v_add_f32_dpp v26, v26, v26 row_shr:4 row_mask:0xf bank_mask:0xf bound_ctrl:0
    s_nop 1
    v_add_f32_dpp v26, v26, v26 row_shr:8 row_mask:0xf bank_mask:0xf bound_ctrl:0
    s_nop 1
    v_add_f32_dpp v26, v26, v26 row_bcast:15 row_mask:0xa bank_mask:0xf
    s_nop 1
    v_add_f32_dpp v26, v26, v26 row_bcast:31 row_mask:0xc bank_mask:0xf
    s_nop 1
    v_readlane_b32 s66, v26, 63
    s_nop 1
    v_mov_b32 v26, s66
    v_mul_f32 v26, 0x3a800000, v26
    v_cvt_pk_bf16_f32 v26, v26, v26
    v_lshlrev_b32 v26, 16, v26
    v_cvt_pk_bf16_f32 v27, v27, v27
    v_lshlrev_b32 v27, 16, v27
    v_add_f32 v26, 0x3727c5ac, v26
    v_cvt_pk_bf16_f32 v26, v26, v26
    v_lshlrev_b32 v26, 16, v26
    v_sqrt_f32 v26, v26
    s_nop 0
    v_cvt_pk_bf16_f32 v26, v26, v26
    v_lshlrev_b32 v26, 16, v26
    v_rcp_f32 v26, v26
    s_nop 0
    v_sub_f32 v192, v192, v27
    v_cvt_pk_bf16_f32 v192, v192, v192
    v_lshlrev_b32 v192, 16, v192
    v_mul_f32 v192, v192, v26
    v_cvt_pk_bf16_f32 v192, v192, v192
    v_lshlrev_b32 v192, 16, v192
    v_sub_f32 v193, v193, v27
    v_cvt_pk_bf16_f32 v193, v193, v193
    v_lshlrev_b32 v193, 16, v193
    v_mul_f32 v193, v193, v26
    v_cvt_pk_bf16_f32 v193, v193, v193
    v_lshlrev_b32 v193, 16, v193
    v_sub_f32 v194, v194, v27
    v_cvt_pk_bf16_f32 v194, v194, v194
    v_lshlrev_b32 v194, 16, v194
    v_mul_f32 v194, v194, v26
    v_cvt_pk_bf16_f32 v194, v194, v194
    v_lshlrev_b32 v194, 16, v194
    v_sub_f32 v195, v195, v27
    v_cvt_pk_bf16_f32 v195, v195, v195
    v_lshlrev_b32 v195, 16, v195
    v_mul_f32 v195, v195, v26
    v_cvt_pk_bf16_f32 v195, v195, v195
    v_lshlrev_b32 v195, 16, v195
    v_sub_f32 v196, v196, v27
    v_cvt_pk_bf16_f32 v196, v196, v196
    v_lshlrev_b32 v196, 16, v196
    v_mul_f32 v196, v196, v26
    v_cvt_pk_bf16_f32 v196, v196, v196
    v_lshlrev_b32 v196, 16, v196
    v_sub_f32 v197, v197, v27
    v_cvt_pk_bf16_f32 v197, v197, v197
    v_lshlrev_b32 v197, 16, v197
    v_mul_f32 v197, v197, v26
    v_cvt_pk_bf16_f32 v197, v197, v197
    v_lshlrev_b32 v197, 16, v197
    v_sub_f32 v198, v198, v27
    v_cvt_pk_bf16_f32 v198, v198, v198
    v_lshlrev_b32 v198, 16, v198
    v_mul_f32 v198, v198, v26
    v_cvt_pk_bf16_f32 v198, v198, v198
    v_lshlrev_b32 v198, 16, v198
    v_sub_f32 v199, v199, v27
    v_cvt_pk_bf16_f32 v199, v199, v199
    v_lshlrev_b32 v199, 16, v199
    v_mul_f32 v199, v199, v26
    v_cvt_pk_bf16_f32 v199, v199, v199
    v_lshlrev_b32 v199, 16, v199
    v_sub_f32 v200, v200, v27
    v_cvt_pk_bf16_f32 v200, v200, v200
    v_lshlrev_b32 v200, 16, v200
    v_mul_f32 v200, v200, v26
    v_cvt_pk_bf16_f32 v200, v200, v200
    v_lshlrev_b32 v200, 16, v200
    v_sub_f32 v201, v201, v27
    v_cvt_pk_bf16_f32 v201, v201, v201
    v_lshlrev_b32 v201, 16, v201
    v_mul_f32 v201, v201, v26
    v_cvt_pk_bf16_f32 v201, v201, v201
    v_lshlrev_b32 v201, 16, v201
    v_sub_f32 v202, v202, v27
    v_cvt_pk_bf16_f32 v202, v202, v202
    v_lshlrev_b32 v202, 16, v202
    v_mul_f32 v202, v202, v26
    v_cvt_pk_bf16_f32 v202, v202, v202
    v_lshlrev_b32 v202, 16, v202
    v_sub_f32 v203, v203, v27
    v_cvt_pk_bf16_f32 v203, v203, v203
    v_lshlrev_b32 v203, 16, v203
    v_mul_f32 v203, v203, v26
    v_cvt_pk_bf16_f32 v203, v203, v203
    v_lshlrev_b32 v203, 16, v203
    v_sub_f32 v204, v204, v27
    v_cvt_pk_bf16_f32 v204, v204, v204
    v_lshlrev_b32 v204, 16, v204
    v_mul_f32 v204, v204, v26
    v_cvt_pk_bf16_f32 v204, v204, v204
    v_lshlrev_b32 v204, 16, v204
    v_sub_f32 v205, v205, v27
    v_cvt_pk_bf16_f32 v205, v205, v205
    v_lshlrev_b32 v205, 16, v205
    v_mul_f32 v205, v205, v26
    v_cvt_pk_bf16_f32 v205, v205, v205
    v_lshlrev_b32 v205, 16, v205
    v_sub_f32 v206, v206, v27
    v_cvt_pk_bf16_f32 v206, v206, v206
    v_lshlrev_b32 v206, 16, v206
    v_mul_f32 v206, v206, v26
    v_cvt_pk_bf16_f32 v206, v206, v206
    v_lshlrev_b32 v206, 16, v206
    v_sub_f32 v207, v207, v27
    v_cvt_pk_bf16_f32 v207, v207, v207
    v_lshlrev_b32 v207, 16, v207
    v_mul_f32 v207, v207, v26
    v_cvt_pk_bf16_f32 v207, v207, v207
    v_lshlrev_b32 v207, 16, v207
    v_lshlrev_b32 v208, 16, v136
    v_and_b32 v209, 0xffff0000, v136
    v_lshlrev_b32 v210, 16, v137
    v_and_b32 v211, 0xffff0000, v137
    v_lshlrev_b32 v212, 16, v138
    v_and_b32 v213, 0xffff0000, v138
    v_lshlrev_b32 v214, 16, v139
    v_and_b32 v215, 0xffff0000, v139
    v_lshlrev_b32 v216, 16, v140
    v_and_b32 v217, 0xffff0000, v140
    v_lshlrev_b32 v218, 16, v141
    v_and_b32 v219, 0xffff0000, v141
    v_lshlrev_b32 v220, 16, v142
    v_and_b32 v221, 0xffff0000, v142
    v_lshlrev_b32 v222, 16, v143
    v_and_b32 v223, 0xffff0000, v143
    v_add_f32 v26, v208, v209
    v_add_f32 v26, v26, v210
    v_add_f32 v26, v26, v211
    v_add_f32 v26, v26, v212
    v_add_f32 v26, v26, v213
    v_add_f32 v26, v26, v214
    v_add_f32 v26, v26, v215
    v_add_f32 v26, v26, v216
    v_add_f32 v26, v26, v217
    v_add_f32 v26, v26, v218
    v_add_f32 v26, v26, v219
    v_add_f32 v26, v26, v220
    v_add_f32 v26, v26, v221
    v_add_f32 v26, v26, v222
    v_add_f32 v26, v26, v223
    s_nop 1
    v_add_f32_dpp v26, v26, v26 row_shr:1 row_mask:0xf bank_mask:0xf bound_ctrl:0
    s_nop 1
    v_add_f32_dpp v26, v26, v26 row_shr:2 row_mask:0xf bank_mask:0xf bound_ctrl:0
    s_nop 1
    v_add_f32_dpp v26, v26, v26 row_shr:4 row_mask:0xf bank_mask:0xf bound_ctrl:0
    s_nop 1
    v_add_f32_dpp v26, v26, v26 row_shr:8 row_mask:0xf bank_mask:0xf bound_ctrl:0
    s_nop 1
    v_add_f32_dpp v26, v26, v26 row_bcast:15 row_mask:0xa bank_mask:0xf
    s_nop 1
    v_add_f32_dpp v26, v26, v26 row_bcast:31 row_mask:0xc bank_mask:0xf
    s_nop 1
    v_readlane_b32 s66, v26, 63
    s_nop 1
    v_mov_b32 v27, s66
    v_mul_f32 v27, 0x3a800000, v27
    v_mov_b32 v26, 0
    v_sub_f32 v28, v208, v27
    v_fmac_f32 v26, v28, v28
    v_sub_f32 v28, v209, v27
    v_fmac_f32 v26, v28, v28
    v_sub_f32 v28, v210, v27
    v_fmac_f32 v26, v28, v28
    v_sub_f32 v28, v211, v27
    v_fmac_f32 v26, v28, v28
    v_sub_f32 v28, v212, v27
    v_fmac_f32 v26, v28, v28
    v_sub_f32 v28, v213, v27
    v_fmac_f32 v26, v28, v28
    v_sub_f32 v28, v214, v27
    v_fmac_f32 v26, v28, v28
    v_sub_f32 v28, v215, v27
    v_fmac_f32 v26, v28, v28
    v_sub_f32 v28, v216, v27
    v_fmac_f32 v26, v28, v28
    v_sub_f32 v28, v217, v27
    v_fmac_f32 v26, v28, v28
    v_sub_f32 v28, v218, v27
    v_fmac_f32 v26, v28, v28
    v_sub_f32 v28, v219, v27
    v_fmac_f32 v26, v28, v28
    v_sub_f32 v28, v220, v27
    v_fmac_f32 v26, v28, v28
    v_sub_f32 v28, v221, v27
    v_fmac_f32 v26, v28, v28
    v_sub_f32 v28, v222, v27
    v_fmac_f32 v26, v28, v28
    v_sub_f32 v28, v223, v27
    v_fmac_f32 v26, v28, v28
    s_nop 1
    v_add_f32_dpp v26, v26, v26 row_shr:1 row_mask:0xf bank_mask:0xf bound_ctrl:0
    s_nop 1
    v_add_f32_dpp v26, v26, v26 row_shr:2 row_mask:0xf bank_mask:0xf bound_ctrl:0
    s_nop 1
    v_add_f32_dpp v26, v26, v26 row_shr:4 row_mask:0xf bank_mask:0xf bound_ctrl:0
    s_nop 1
    v_add_f32_dpp v26, v26, v26 row_shr:8 row_mask:0xf bank_mask:0xf bound_ctrl:0
    s_nop 1
    v_add_f32_dpp v26, v26, v26 row_bcast:15 row_mask:0xa bank_mask:0xf
    s_nop 1
    v_add_f32_dpp v26, v26, v26 row_bcast:31 row_mask:0xc bank_mask:0xf
    s_nop 1
    v_readlane_b32 s66, v26, 63
    s_nop 1
    v_mov_b32 v26, s66
    v_mul_f32 v26, 0x3a800000, v26
    v_cvt_pk_bf16_f32 v26, v26, v26
    v_lshlrev_b32 v26, 16, v26
    v_cvt_pk_bf16_f32 v27, v27, v27
    v_lshlrev_b32 v27, 16, v27
    v_add_f32 v26, 0x3727c5ac, v26
    v_cvt_pk_bf16_f32 v26, v26, v26
    v_lshlrev_b32 v26, 16, v26
    v_sqrt_f32 v26, v26
    s_nop 0
    v_cvt_pk_bf16_f32 v26, v26, v26
    v_lshlrev_b32 v26, 16, v26
    v_rcp_f32 v26, v26
    s_nop 0
    v_sub_f32 v208, v208, v27
    v_cvt_pk_bf16_f32 v208, v208, v208
    v_lshlrev_b32 v208, 16, v208
    v_mul_f32 v208, v208, v26
    v_cvt_pk_bf16_f32 v208, v208, v208
    v_lshlrev_b32 v208, 16, v208
    v_sub_f32 v209, v209, v27
    v_cvt_pk_bf16_f32 v209, v209, v209
    v_lshlrev_b32 v209, 16, v209
    v_mul_f32 v209, v209, v26
    v_cvt_pk_bf16_f32 v209, v209, v209
    v_lshlrev_b32 v209, 16, v209
    v_sub_f32 v210, v210, v27
    v_cvt_pk_bf16_f32 v210, v210, v210
    v_lshlrev_b32 v210, 16, v210
    v_mul_f32 v210, v210, v26
    v_cvt_pk_bf16_f32 v210, v210, v210
    v_lshlrev_b32 v210, 16, v210
    v_sub_f32 v211, v211, v27
    v_cvt_pk_bf16_f32 v211, v211, v211
    v_lshlrev_b32 v211, 16, v211
    v_mul_f32 v211, v211, v26
    v_cvt_pk_bf16_f32 v211, v211, v211
    v_lshlrev_b32 v211, 16, v211
    v_sub_f32 v212, v212, v27
    v_cvt_pk_bf16_f32 v212, v212, v212
    v_lshlrev_b32 v212, 16, v212
    v_mul_f32 v212, v212, v26
    v_cvt_pk_bf16_f32 v212, v212, v212
    v_lshlrev_b32 v212, 16, v212
    v_sub_f32 v213, v213, v27
    v_cvt_pk_bf16_f32 v213, v213, v213
    v_lshlrev_b32 v213, 16, v213
    v_mul_f32 v213, v213, v26
    v_cvt_pk_bf16_f32 v213, v213, v213
    v_lshlrev_b32 v213, 16, v213
    v_sub_f32 v214, v214, v27
    v_cvt_pk_bf16_f32 v214, v214, v214
    v_lshlrev_b32 v214, 16, v214
    v_mul_f32 v214, v214, v26
    v_cvt_pk_bf16_f32 v214, v214, v214
    v_lshlrev_b32 v214, 16, v214
    v_sub_f32 v215, v215, v27
    v_cvt_pk_bf16_f32 v215, v215, v215
    v_lshlrev_b32 v215, 16, v215
    v_mul_f32 v215, v215, v26
    v_cvt_pk_bf16_f32 v215, v215, v215
    v_lshlrev_b32 v215, 16, v215
    v_sub_f32 v216, v216, v27
    v_cvt_pk_bf16_f32 v216, v216, v216
    v_lshlrev_b32 v216, 16, v216
    v_mul_f32 v216, v216, v26
    v_cvt_pk_bf16_f32 v216, v216, v216
    v_lshlrev_b32 v216, 16, v216
    v_sub_f32 v217, v217, v27
    v_cvt_pk_bf16_f32 v217, v217, v217
    v_lshlrev_b32 v217, 16, v217
    v_mul_f32 v217, v217, v26
    v_cvt_pk_bf16_f32 v217, v217, v217
    v_lshlrev_b32 v217, 16, v217
    v_sub_f32 v218, v218, v27
    v_cvt_pk_bf16_f32 v218, v218, v218
    v_lshlrev_b32 v218, 16, v218
    v_mul_f32 v218, v218, v26
    v_cvt_pk_bf16_f32 v218, v218, v218
    v_lshlrev_b32 v218, 16, v218
    v_sub_f32 v219, v219, v27
    v_cvt_pk_bf16_f32 v219, v219, v219
    v_lshlrev_b32 v219, 16, v219
    v_mul_f32 v219, v219, v26
    v_cvt_pk_bf16_f32 v219, v219, v219
    v_lshlrev_b32 v219, 16, v219
    v_sub_f32 v220, v220, v27
    v_cvt_pk_bf16_f32 v220, v220, v220
    v_lshlrev_b32 v220, 16, v220
    v_mul_f32 v220, v220, v26
    v_cvt_pk_bf16_f32 v220, v220, v220
    v_lshlrev_b32 v220, 16, v220
    v_sub_f32 v221, v221, v27
    v_cvt_pk_bf16_f32 v221, v221, v221
    v_lshlrev_b32 v221, 16, v221
    v_mul_f32 v221, v221, v26
    v_cvt_pk_bf16_f32 v221, v221, v221
    v_lshlrev_b32 v221, 16, v221
    v_sub_f32 v222, v222, v27
    v_cvt_pk_bf16_f32 v222, v222, v222
    v_lshlrev_b32 v222, 16, v222
    v_mul_f32 v222, v222, v26
    v_cvt_pk_bf16_f32 v222, v222, v222
    v_lshlrev_b32 v222, 16, v222
    v_sub_f32 v223, v223, v27
    v_cvt_pk_bf16_f32 v223, v223, v223
    v_lshlrev_b32 v223, 16, v223
    v_mul_f32 v223, v223, v26
    v_cvt_pk_bf16_f32 v223, v223, v223
    v_lshlrev_b32 v223, 16, v223
    s_cmp_lg_u32 s44, 0
    s_cbranch_scc1 L_pd_106
    v_mov_b32 v29, 128
    s_mov_b32 s46, 96
    s_mov_b64 exec, 1
    s_mov_b32 s70, 0
L_wp_107:
    buffer_load_dword v31, v29, s[16:19], 0 offen sc1
    s_add_u32 s70, s70, 1
    s_cmp_ge_u32 s70, 0x200000
    s_cbranch_scc1 L_w_done_101
    s_waitcnt vmcnt(0)
    v_cmp_gt_u32 vcc, s46, v31
    s_nop 1
    s_cbranch_vccz L_wp_107_ok
    s_sleep 1
    s_branch L_wp_107
L_wp_107_ok:
    s_mov_b64 exec, -1
L_pd_106:
    s_barrier
    v_lshlrev_b32 v29, 5, v1
    s_mov_b32 s45, 0
    buffer_load_dwordx4 v[96:99], v29, s[12:15], s45 offen offset:0 sc1
    buffer_load_dwordx4 v[100:103], v29, s[12:15], s45 offen offset:16 sc1
    buffer_load_dwordx4 v[104:107], v29, s[12:15], s45 offen offset:2048 sc1
    buffer_load_dwordx4 v[108:111], v29, s[12:15], s45 offen offset:2064 sc1
    s_mov_b32 s45, 24576
    buffer_load_dwordx4 v[32:35], v29, s[12:15], s45 offen offset:0 sc1
    buffer_load_dwordx4 v[36:39], v29, s[12:15], s45 offen offset:16 sc1
    buffer_load_dwordx4 v[40:43], v29, s[12:15], s45 offen offset:2048 sc1
    buffer_load_dwordx4 v[44:47], v29, s[12:15], s45 offen offset:2064 sc1
    s_mov_b32 s45, 4096
    buffer_load_dwordx4 v[112:115], v29, s[12:15], s45 offen offset:0 sc1
    buffer_load_dwordx4 v[116:119], v29, s[12:15], s45 offen offset:16 sc1
    buffer_load_dwordx4 v[120:123], v29, s[12:15], s45 offen offset:2048 sc1
    buffer_load_dwordx4 v[124:127], v29, s[12:15], s45 offen offset:2064 sc1
    s_mov_b32 s45, 28672
    buffer_load_dwordx4 v[48:51], v29, s[12:15], s45 offen offset:0 sc1
    buffer_load_dwordx4 v[52:55], v29, s[12:15], s45 offen offset:16 sc1
    buffer_load_dwordx4 v[56:59], v29, s[12:15], s45 offen offset:2048 sc1
    buffer_load_dwordx4 v[60:63], v29, s[12:15], s45 offen offset:2064 sc1
    s_waitcnt vmcnt(0)
    v_add_f32 v96, v96, v32
    v_cvt_pk_bf16_f32 v96, v96, v96
    v_lshlrev_b32 v96, 16, v96
    v_add_f32 v97, v97, v33
    v_cvt_pk_bf16_f32 v97, v97, v97
    v_lshlrev_b32 v97, 16, v97
    v_add_f32 v98, v98, v34
    v_cvt_pk_bf16_f32 v98, v98, v98
    v_lshlrev_b32 v98, 16, v98
    v_add_f32 v99, v99, v35
    v_cvt_pk_bf16_f32 v99, v99, v99
    v_lshlrev_b32 v99, 16, v99
    v_add_f32 v100, v100, v36
    v_cvt_pk_bf16_f32 v100, v100, v100
    v_lshlrev_b32 v100, 16, v100
    v_add_f32 v101, v101, v37
    v_cvt_pk_bf16_f32 v101, v101, v101
    v_lshlrev_b32 v101, 16, v101
    v_add_f32 v102, v102, v38
    v_cvt_pk_bf16_f32 v102, v102, v102
    v_lshlrev_b32 v102, 16, v102
    v_add_f32 v103, v103, v39
    v_cvt_pk_bf16_f32 v103, v103, v103
    v_lshlrev_b32 v103, 16, v103
    v_add_f32 v104, v104, v40
    v_cvt_pk_bf16_f32 v104, v104, v104
    v_lshlrev_b32 v104, 16, v104
    v_add_f32 v105, v105, v41
    v_cvt_pk_bf16_f32 v105, v105, v105
    v_lshlrev_b32 v105, 16, v105
    v_add_f32 v106, v106, v42
    v_cvt_pk_bf16_f32 v106, v106, v106
    v_lshlrev_b32 v106, 16, v106
    v_add_f32 v107, v107, v43
    v_cvt_pk_bf16_f32 v107, v107, v107
    v_lshlrev_b32 v107, 16, v107
    v_add_f32 v108, v108, v44
    v_cvt_pk_bf16_f32 v108, v108, v108
    v_lshlrev_b32 v108, 16, v108
    v_add_f32 v109, v109, v45
    v_cvt_pk_bf16_f32 v109, v109, v109
    v_lshlrev_b32 v109, 16, v109
    v_add_f32 v110, v110, v46
    v_cvt_pk_bf16_f32 v110, v110, v110
    v_lshlrev_b32 v110, 16, v110
    v_add_f32 v111, v111, v47
    v_cvt_pk_bf16_f32 v111, v111, v111
    v_lshlrev_b32 v111, 16, v111
    v_add_f32 v112, v112, v48
    v_cvt_pk_bf16_f32 v112, v112, v112
    v_lshlrev_b32 v112, 16, v112
    v_add_f32 v112, 1.0, v112
    v_cvt_pk_bf16_f32 v112, v112, v112
    v_lshlrev_b32 v112, 16, v112
    v_add_f32 v113, v113, v49
    v_cvt_pk_bf16_f32 v113, v113, v113
    v_lshlrev_b32 v113, 16, v113
    v_add_f32 v113, 1.0, v113
    v_cvt_pk_bf16_f32 v113, v113, v113
    v_lshlrev_b32 v113, 16, v113
    v_add_f32 v114, v114, v50
    v_cvt_pk_bf16_f32 v114, v114, v114
    v_lshlrev_b32 v114, 16, v114
    v_add_f32 v114, 1.0, v114
    v_cvt_pk_bf16_f32 v114, v114, v114
    v_lshlrev_b32 v114, 16, v114
    v_add_f32 v115, v115, v51
    v_cvt_pk_bf16_f32 v115, v115, v115
    v_lshlrev_b32 v115, 16, v115
    v_add_f32 v115, 1.0, v115
    v_cvt_pk_bf16_f32 v115, v115, v115
    v_lshlrev_b32 v115, 16, v115
    v_add_f32 v116, v116, v52
    v_cvt_pk_bf16_f32 v116, v116, v116
    v_lshlrev_b32 v116, 16, v116
    v_add_f32 v116, 1.0, v116
    v_cvt_pk_bf16_f32 v116, v116, v116
    v_lshlrev_b32 v116, 16, v116
    v_add_f32 v117, v117, v53
    v_cvt_pk_bf16_f32 v117, v117, v117
    v_lshlrev_b32 v117, 16, v117
    v_add_f32 v117, 1.0, v117
    v_cvt_pk_bf16_f32 v117, v117, v117
    v_lshlrev_b32 v117, 16, v117
    v_add_f32 v118, v118, v54
    v_cvt_pk_bf16_f32 v118, v118, v118
    v_lshlrev_b32 v118, 16, v118
    v_add_f32 v118, 1.0, v118
    v_cvt_pk_bf16_f32 v118, v118, v118
    v_lshlrev_b32 v118, 16, v118
    v_add_f32 v119, v119, v55
    v_cvt_pk_bf16_f32 v119, v119, v119
    v_lshlrev_b32 v119, 16, v119
    v_add_f32 v119, 1.0, v119
    v_cvt_pk_bf16_f32 v119, v119, v119
    v_lshlrev_b32 v119, 16, v119
    v_add_f32 v120, v120, v56
    v_cvt_pk_bf16_f32 v120, v120, v120
    v_lshlrev_b32 v120, 16, v120
    v_add_f32 v120, 1.0, v120
    v_cvt_pk_bf16_f32 v120, v120, v120
    v_lshlrev_b32 v120, 16, v120
    v_add_f32 v121, v121, v57
    v_cvt_pk_bf16_f32 v121, v121, v121
    v_lshlrev_b32 v121, 16, v121
    v_add_f32 v121, 1.0, v121
    v_cvt_pk_bf16_f32 v121, v121, v121
    v_lshlrev_b32 v121, 16, v121
    v_add_f32 v122, v122, v58
    v_cvt_pk_bf16_f32 v122, v122, v122
    v_lshlrev_b32 v122, 16, v122
    v_add_f32 v122, 1.0, v122
    v_cvt_pk_bf16_f32 v122, v122, v122
    v_lshlrev_b32 v122, 16, v122
    v_add_f32 v123, v123, v59
    v_cvt_pk_bf16_f32 v123, v123, v123
    v_lshlrev_b32 v123, 16, v123
    v_add_f32 v123, 1.0, v123
    v_cvt_pk_bf16_f32 v123, v123, v123
    v_lshlrev_b32 v123, 16, v123
    v_add_f32 v124, v124, v60
    v_cvt_pk_bf16_f32 v124, v124, v124
    v_lshlrev_b32 v124, 16, v124
    v_add_f32 v124, 1.0, v124
    v_cvt_pk_bf16_f32 v124, v124, v124
    v_lshlrev_b32 v124, 16, v124
    v_add_f32 v125, v125, v61
    v_cvt_pk_bf16_f32 v125, v125, v125
    v_lshlrev_b32 v125, 16, v125
    v_add_f32 v125, 1.0, v125
    v_cvt_pk_bf16_f32 v125, v125, v125
    v_lshlrev_b32 v125, 16, v125
    v_add_f32 v126, v126, v62
    v_cvt_pk_bf16_f32 v126, v126, v126
    v_lshlrev_b32 v126, 16, v126
    v_add_f32 v126, 1.0, v126
    v_cvt_pk_bf16_f32 v126, v126, v126
    v_lshlrev_b32 v126, 16, v126
    v_add_f32 v127, v127, v63
    v_cvt_pk_bf16_f32 v127, v127, v127
    v_lshlrev_b32 v127, 16, v127
    v_add_f32 v127, 1.0, v127
    v_cvt_pk_bf16_f32 v127, v127, v127
    v_lshlrev_b32 v127, 16, v127
    v_mul_f32 v192, v192, v112
    v_cvt_pk_bf16_f32 v192, v192, v192
    v_lshlrev_b32 v192, 16, v192
    v_add_f32 v192, v192, v96
    v_mul_f32 v193, v193, v113
    v_cvt_pk_bf16_f32 v193, v193, v193
    v_lshlrev_b32 v193, 16, v193
    v_add_f32 v193, v193, v97
    v_mul_f32 v194, v194, v114
    v_cvt_pk_bf16_f32 v194, v194, v194
    v_lshlrev_b32 v194, 16, v194
    v_add_f32 v194, v194, v98
    v_mul_f32 v195, v195, v115
    v_cvt_pk_bf16_f32 v195, v195, v195
    v_lshlrev_b32 v195, 16, v195
    v_add_f32 v195, v195, v99
    v_mul_f32 v196, v196, v116
    v_cvt_pk_bf16_f32 v196, v196, v196
    v_lshlrev_b32 v196, 16, v196
    v_add_f32 v196, v196, v100
    v_mul_f32 v197, v197, v117
    v_cvt_pk_bf16_f32 v197, v197, v197
    v_lshlrev_b32 v197, 16, v197
    v_add_f32 v197, v197, v101
    v_mul_f32 v198, v198, v118
    v_cvt_pk_bf16_f32 v198, v198, v198
    v_lshlrev_b32 v198, 16, v198
    v_add_f32 v198, v198, v102
    v_mul_f32 v199, v199, v119
    v_cvt_pk_bf16_f32 v199, v199, v199
    v_lshlrev_b32 v199, 16, v199
    v_add_f32 v199, v199, v103
    v_mul_f32 v200, v200, v120
    v_cvt_pk_bf16_f32 v200, v200, v200
    v_lshlrev_b32 v200, 16, v200
    v_add_f32 v200, v200, v104
    v_mul_f32 v201, v201, v121
    v_cvt_pk_bf16_f32 v201, v201, v201
    v_lshlrev_b32 v201, 16, v201
    v_add_f32 v201, v201, v105
    v_mul_f32 v202, v202, v122
    v_cvt_pk_bf16_f32 v202, v202, v202
    v_lshlrev_b32 v202, 16, v202
    v_add_f32 v202, v202, v106
    v_mul_f32 v203, v203, v123
    v_cvt_pk_bf16_f32 v203, v203, v203
    v_lshlrev_b32 v203, 16, v203
    v_add_f32 v203, v203, v107
    v_mul_f32 v204, v204, v124
    v_cvt_pk_bf16_f32 v204, v204, v204
    v_lshlrev_b32 v204, 16, v204
    v_add_f32 v204, v204, v108
    v_mul_f32 v205, v205, v125
    v_cvt_pk_bf16_f32 v205, v205, v205
    v_lshlrev_b32 v205, 16, v205
    v_add_f32 v205, v205, v109
    v_mul_f32 v206, v206, v126
    v_cvt_pk_bf16_f32 v206, v206, v206
    v_lshlrev_b32 v206, 16, v206
    v_add_f32 v206, v206, v110
    v_mul_f32 v207, v207, v127
    v_cvt_pk_bf16_f32 v207, v207, v207
    v_lshlrev_b32 v207, 16, v207
    v_add_f32 v207, v207, v111
    v_cvt_pk_bf16_f32 v80, v192, v193
    v_cvt_pk_bf16_f32 v81, v194, v195
    v_cvt_pk_bf16_f32 v82, v196, v197
    v_cvt_pk_bf16_f32 v83, v198, v199
    v_cvt_pk_bf16_f32 v84, v200, v201
    v_cvt_pk_bf16_f32 v85, v202, v203
    v_cvt_pk_bf16_f32 v86, v204, v205
    v_cvt_pk_bf16_f32 v87, v206, v207
    s_lshr_b32 s45, s63, 5
    s_lshl_b32 s45, s45, 16
    s_and_b32 s46, s63, 31
    s_lshl_b32 s46, s46, 8
    s_add_u32 s45, s45, s46
    s_add_u32 s45, s45, 0x400000
    s_add_u32 s46, s45, 32768
    buffer_store_dwordx4 v[80:83], v2, s[12:15], s45 offen sc1
    buffer_store_dwordx4 v[84:87], v2, s[12:15], s46 offen sc1
    s_add_u32 s63, s63, 384
    v_mul_f32 v208, v208, v112
    v_cvt_pk_bf16_f32 v208, v208, v208
    v_lshlrev_b32 v208, 16, v208
    v_add_f32 v208, v208, v96
    v_mul_f32 v209, v209, v113
    v_cvt_pk_bf16_f32 v209, v209, v209
    v_lshlrev_b32 v209, 16, v209
    v_add_f32 v209, v209, v97
    v_mul_f32 v210, v210, v114
    v_cvt_pk_bf16_f32 v210, v210, v210
    v_lshlrev_b32 v210, 16, v210
    v_add_f32 v210, v210, v98
    v_mul_f32 v211, v211, v115
    v_cvt_pk_bf16_f32 v211, v211, v211
    v_lshlrev_b32 v211, 16, v211
    v_add_f32 v211, v211, v99
    v_mul_f32 v212, v212, v116
    v_cvt_pk_bf16_f32 v212, v212, v212
    v_lshlrev_b32 v212, 16, v212
    v_add_f32 v212, v212, v100
    v_mul_f32 v213, v213, v117
    v_cvt_pk_bf16_f32 v213, v213, v213
    v_lshlrev_b32 v213, 16, v213
    v_add_f32 v213, v213, v101
    v_mul_f32 v214, v214, v118
    v_cvt_pk_bf16_f32 v214, v214, v214
    v_lshlrev_b32 v214, 16, v214
    v_add_f32 v214, v214, v102
    v_mul_f32 v215, v215, v119
    v_cvt_pk_bf16_f32 v215, v215, v215
    v_lshlrev_b32 v215, 16, v215
    v_add_f32 v215, v215, v103
    v_mul_f32 v216, v216, v120
    v_cvt_pk_bf16_f32 v216, v216, v216
    v_lshlrev_b32 v216, 16, v216
    v_add_f32 v216, v216, v104
    v_mul_f32 v217, v217, v121
    v_cvt_pk_bf16_f32 v217, v217, v217
    v_lshlrev_b32 v217, 16, v217
    v_add_f32 v217, v217, v105
    v_mul_f32 v218, v218, v122
    v_cvt_pk_bf16_f32 v218, v218, v218
    v_lshlrev_b32 v218, 16, v218
    v_add_f32 v218, v218, v106
    v_mul_f32 v219, v219, v123
    v_cvt_pk_bf16_f32 v219, v219, v219
    v_lshlrev_b32 v219, 16, v219
    v_add_f32 v219, v219, v107
    v_mul_f32 v220, v220, v124
    v_cvt_pk_bf16_f32 v220, v220, v220
    v_lshlrev_b32 v220, 16, v220
    v_add_f32 v220, v220, v108
    v_mul_f32 v221, v221, v125
    v_cvt_pk_bf16_f32 v221, v221, v221
    v_lshlrev_b32 v221, 16, v221
    v_add_f32 v221, v221, v109
    v_mul_f32 v222, v222, v126
    v_cvt_pk_bf16_f32 v222, v222, v222
    v_lshlrev_b32 v222, 16, v222
    v_add_f32 v222, v222, v110
    v_mul_f32 v223, v223, v127
    v_cvt_pk_bf16_f32 v223, v223, v223
    v_lshlrev_b32 v223, 16, v223
    v_add_f32 v223, v223, v111
    v_cvt_pk_bf16_f32 v88, v208, v209
    v_cvt_pk_bf16_f32 v89, v210, v211
    v_cvt_pk_bf16_f32 v90, v212, v213
    v_cvt_pk_bf16_f32 v91, v214, v215
    v_cvt_pk_bf16_f32 v92, v216, v217
    v_cvt_pk_bf16_f32 v93, v218, v219
    v_cvt_pk_bf16_f32 v94, v220, v221
    v_cvt_pk_bf16_f32 v95, v222, v223
    s_lshr_b32 s45, s63, 5
    s_lshl_b32 s45, s45, 16
    s_and_b32 s46, s63, 31
    s_lshl_b32 s46, s46, 8
    s_add_u32 s45, s45, s46
    s_add_u32 s45, s45, 0x400000
    s_add_u32 s46, s45, 32768
    buffer_store_dwordx4 v[88:91], v2, s[12:15], s45 offen sc1
    buffer_store_dwordx4 v[92:95], v2, s[12:15], s46 offen sc1
    s_waitcnt vmcnt(2)
    s_barrier
    s_cmp_lg_u32 s44, 0
    s_cbranch_scc1 L_cnt_109
    v_mov_b32 v30, 1
    v_mov_b32 v31, 0
    s_mov_b64 exec, 1
    buffer_atomic_add v30, v31, s[16:19], 0 offen offset:64 sc1
    s_mov_b64 exec, -1
L_cnt_109:
    s_add_u32 s63, s63, 384
    v_lshlrev_b32 v64, 16, v144
    v_and_b32 v65, 0xffff0000, v144
    v_lshlrev_b32 v66, 16, v145
    v_and_b32 v67, 0xffff0000, v145
    v_lshlrev_b32 v68, 16, v146
    v_and_b32 v69, 0xffff0000, v146
    v_lshlrev_b32 v70, 16, v147
    v_and_b32 v71, 0xffff0000, v147
    v_lshlrev_b32 v72, 16, v148
    v_and_b32 v73, 0xffff0000, v148
    v_lshlrev_b32 v74, 16, v149
    v_and_b32 v75, 0xffff0000, v149
    v_lshlrev_b32 v76, 16, v150
    v_and_b32 v77, 0xffff0000, v150
    v_lshlrev_b32 v78, 16, v151
    v_and_b32 v79, 0xffff0000, v151
    v_add_f32 v26, v64, v65
    v_add_f32 v26, v26, v66
    v_add_f32 v26, v26, v67
    v_add_f32 v26, v26, v68
    v_add_f32 v26, v26, v69
    v_add_f32 v26, v26, v70
    v_add_f32 v26, v26, v71
    v_add_f32 v26, v26, v72
    v_add_f32 v26, v26, v73
    v_add_f32 v26, v26, v74
    v_add_f32 v26, v26, v75
    v_add_f32 v26, v26, v76
    v_add_f32 v26, v26, v77
    v_add_f32 v26, v26, v78
    v_add_f32 v26, v26, v79
    s_nop 1
    v_add_f32_dpp v26, v26, v26 row_shr:1 row_mask:0xf bank_mask:0xf bound_ctrl:0
    s_nop 1
    v_add_f32_dpp v26, v26, v26 row_shr:2 row_mask:0xf bank_mask:0xf bound_ctrl:0
    s_nop 1
    v_add_f32_dpp v26, v26, v26 row_shr:4 row_mask:0xf bank_mask:0xf bound_ctrl:0
    s_nop 1
    v_add_f32_dpp v26, v26, v26 row_shr:8 row_mask:0xf bank_mask:0xf bound_ctrl:0
    s_nop 1
    v_add_f32_dpp v26, v26, v26 row_bcast:15 row_mask:0xa bank_mask:0xf
    s_nop 1
    v_add_f32_dpp v26, v26, v26 row_bcast:31 row_mask:0xc bank_mask:0xf
    s_nop 1
    v_readlane_b32 s66, v26, 63
    s_nop 1
    v_mov_b32 v27, s66
    v_mul_f32 v27, 0x3a800000, v27
    v_mov_b32 v26, 0
    v_sub_f32 v28, v64, v27
    v_fmac_f32 v26, v28, v28
    v_sub_f32 v28, v65, v27
    v_fmac_f32 v26, v28, v28
    v_sub_f32 v28, v66, v27
    v_fmac_f32 v26, v28, v28
    v_sub_f32 v28, v67, v27
    v_fmac_f32 v26, v28, v28
    v_sub_f32 v28, v68, v27
    v_fmac_f32 v26, v28, v28
    v_sub_f32 v28, v69, v27
    v_fmac_f32 v26, v28, v28
    v_sub_f32 v28, v70, v27
    v_fmac_f32 v26, v28, v28
    v_sub_f32 v28, v71, v27
    v_fmac_f32 v26, v28, v28
    v_sub_f32 v28, v72, v27
    v_fmac_f32 v26, v28, v28
    v_sub_f32 v28, v73, v27
    v_fmac_f32 v26, v28, v28
    v_sub_f32 v28, v74, v27
    v_fmac_f32 v26, v28, v28
    v_sub_f32 v28, v75, v27
    v_fmac_f32 v26, v28, v28
    v_sub_f32 v28, v76, v27
    v_fmac_f32 v26, v28, v28
    v_sub_f32 v28, v77, v27
    v_fmac_f32 v26, v28, v28
    v_sub_f32 v28, v78, v27
    v_fmac_f32 v26, v28, v28
    v_sub_f32 v28, v79, v27
    v_fmac_f32 v26, v28, v28
    s_nop 1
    v_add_f32_dpp v26, v26, v26 row_shr:1 row_mask:0xf bank_mask:0xf bound_ctrl:0
    s_nop 1
    v_add_f32_dpp v26, v26, v26 row_shr:2 row_mask:0xf bank_mask:0xf bound_ctrl:0
    s_nop 1
    v_add_f32_dpp v26, v26, v26 row_shr:4 row_mask:0xf bank_mask:0xf bound_ctrl:0
    s_nop 1
    v_add_f32_dpp v26, v26, v26 row_shr:8 row_mask:0xf bank_mask:0xf bound_ctrl:0
    s_nop 1
    v_add_f32_dpp v26, v26, v26 row_bcast:15 row_mask:0xa bank_mask:0xf
    s_nop 1
    v_add_f32_dpp v26, v26, v26 row_bcast:31 row_mask:0xc bank_mask:0xf
    s_nop 1
    v_readlane_b32 s66, v26, 63
    s_nop 1
    v_mov_b32 v26, s66
    v_mul_f32 v26, 0x3a800000, v26
    v_cvt_pk_bf16_f32 v26, v26, v26
    v_lshlrev_b32 v26, 16, v26
    v_cvt_pk_bf16_f32 v27, v27, v27
    v_lshlrev_b32 v27, 16, v27
    v_add_f32 v26, 0x3727c5ac, v26
    v_cvt_pk_bf16_f32 v26, v26, v26
    v_lshlrev_b32 v26, 16, v26
    v_sqrt_f32 v26, v26
    s_nop 0
    v_cvt_pk_bf16_f32 v26, v26, v26
    v_lshlrev_b32 v26, 16, v26
    v_rcp_f32 v26, v26
    s_nop 0
    v_sub_f32 v64, v64, v27
    v_cvt_pk_bf16_f32 v64, v64, v64
    v_lshlrev_b32 v64, 16, v64
    v_mul_f32 v64, v64, v26
    v_cvt_pk_bf16_f32 v64, v64, v64
    v_lshlrev_b32 v64, 16, v64
    v_sub_f32 v65, v65, v27
    v_cvt_pk_bf16_f32 v65, v65, v65
    v_lshlrev_b32 v65, 16, v65
    v_mul_f32 v65, v65, v26
    v_cvt_pk_bf16_f32 v65, v65, v65
    v_lshlrev_b32 v65, 16, v65
    v_sub_f32 v66, v66, v27
    v_cvt_pk_bf16_f32 v66, v66, v66
    v_lshlrev_b32 v66, 16, v66
    v_mul_f32 v66, v66, v26
    v_cvt_pk_bf16_f32 v66, v66, v66
    v_lshlrev_b32 v66, 16, v66
    v_sub_f32 v67, v67, v27
    v_cvt_pk_bf16_f32 v67, v67, v67
    v_lshlrev_b32 v67, 16, v67
    v_mul_f32 v67, v67, v26
    v_cvt_pk_bf16_f32 v67, v67, v67
    v_lshlrev_b32 v67, 16, v67
    v_sub_f32 v68, v68, v27
    v_cvt_pk_bf16_f32 v68, v68, v68
    v_lshlrev_b32 v68, 16, v68
    v_mul_f32 v68, v68, v26
    v_cvt_pk_bf16_f32 v68, v68, v68
    v_lshlrev_b32 v68, 16, v68
    v_sub_f32 v69, v69, v27
    v_cvt_pk_bf16_f32 v69, v69, v69
    v_lshlrev_b32 v69, 16, v69
    v_mul_f32 v69, v69, v26
    v_cvt_pk_bf16_f32 v69, v69, v69
    v_lshlrev_b32 v69, 16, v69
    v_sub_f32 v70, v70, v27
    v_cvt_pk_bf16_f32 v70, v70, v70
    v_lshlrev_b32 v70, 16, v70
    v_mul_f32 v70, v70, v26
    v_cvt_pk_bf16_f32 v70, v70, v70
    v_lshlrev_b32 v70, 16, v70
    v_sub_f32 v71, v71, v27
    v_cvt_pk_bf16_f32 v71, v71, v71
    v_lshlrev_b32 v71, 16, v71
    v_mul_f32 v71, v71, v26
    v_cvt_pk_bf16_f32 v71, v71, v71
    v_lshlrev_b32 v71, 16, v71
    v_sub_f32 v72, v72, v27
    v_cvt_pk_bf16_f32 v72, v72, v72
    v_lshlrev_b32 v72, 16, v72
    v_mul_f32 v72, v72, v26
    v_cvt_pk_bf16_f32 v72, v72, v72
    v_lshlrev_b32 v72, 16, v72
    v_sub_f32 v73, v73, v27
    v_cvt_pk_bf16_f32 v73, v73, v73
    v_lshlrev_b32 v73, 16, v73
    v_mul_f32 v73, v73, v26
    v_cvt_pk_bf16_f32 v73, v73, v73
    v_lshlrev_b32 v73, 16, v73
    v_sub_f32 v74, v74, v27
    v_cvt_pk_bf16_f32 v74, v74, v74
    v_lshlrev_b32 v74, 16, v74
    v_mul_f32 v74, v74, v26
    v_cvt_pk_bf16_f32 v74, v74, v74
    v_lshlrev_b32 v74, 16, v74
    v_sub_f32 v75, v75, v27
    v_cvt_pk_bf16_f32 v75, v75, v75
    v_lshlrev_b32 v75, 16, v75
    v_mul_f32 v75, v75, v26
    v_cvt_pk_bf16_f32 v75, v75, v75
    v_lshlrev_b32 v75, 16, v75
    v_sub_f32 v76, v76, v27
    v_cvt_pk_bf16_f32 v76, v76, v76
    v_lshlrev_b32 v76, 16, v76
    v_mul_f32 v76, v76, v26
    v_cvt_pk_bf16_f32 v76, v76, v76
    v_lshlrev_b32 v76, 16, v76
    v_sub_f32 v77, v77, v27
    v_cvt_pk_bf16_f32 v77, v77, v77
    v_lshlrev_b32 v77, 16, v77
    v_mul_f32 v77, v77, v26
    v_cvt_pk_bf16_f32 v77, v77, v77
    v_lshlrev_b32 v77, 16, v77
    v_sub_f32 v78, v78, v27
    v_cvt_pk_bf16_f32 v78, v78, v78
    v_lshlrev_b32 v78, 16, v78
    v_mul_f32 v78, v78, v26
    v_cvt_pk_bf16_f32 v78, v78, v78
    v_lshlrev_b32 v78, 16, v78
    v_sub_f32 v79, v79, v27
    v_cvt_pk_bf16_f32 v79, v79, v79
    v_lshlrev_b32 v79, 16, v79
    v_mul_f32 v79, v79, v26
    v_cvt_pk_bf16_f32 v79, v79, v79
    v_lshlrev_b32 v79, 16, v79
    v_mul_f32 v64, v64, v112
    v_cvt_pk_bf16_f32 v64, v64, v64
    v_lshlrev_b32 v64, 16, v64
    v_add_f32 v64, v64, v96
    v_mul_f32 v65, v65, v113
    v_cvt_pk_bf16_f32 v65, v65, v65
    v_lshlrev_b32 v65, 16, v65
    v_add_f32 v65, v65, v97
    v_mul_f32 v66, v66, v114
    v_cvt_pk_bf16_f32 v66, v66, v66
    v_lshlrev_b32 v66, 16, v66
    v_add_f32 v66, v66, v98
    v_mul_f32 v67, v67, v115
    v_cvt_pk_bf16_f32 v67, v67, v67
    v_lshlrev_b32 v67, 16, v67
    v_add_f32 v67, v67, v99
    v_mul_f32 v68, v68, v116
    v_cvt_pk_bf16_f32 v68, v68, v68
    v_lshlrev_b32 v68, 16, v68
    v_add_f32 v68, v68, v100
    v_mul_f32 v69, v69, v117
    v_cvt_pk_bf16_f32 v69, v69, v69
    v_lshlrev_b32 v69, 16, v69
    v_add_f32 v69, v69, v101
    v_mul_f32 v70, v70, v118
    v_cvt_pk_bf16_f32 v70, v70, v70
    v_lshlrev_b32 v70, 16, v70
    v_add_f32 v70, v70, v102
    v_mul_f32 v71, v71, v119
    v_cvt_pk_bf16_f32 v71, v71, v71
    v_lshlrev_b32 v71, 16, v71
    v_add_f32 v71, v71, v103
    v_mul_f32 v72, v72, v120
    v_cvt_pk_bf16_f32 v72, v72, v72
    v_lshlrev_b32 v72, 16, v72
    v_add_f32 v72, v72, v104
    v_mul_f32 v73, v73, v121
    v_cvt_pk_bf16_f32 v73, v73, v73
    v_lshlrev_b32 v73, 16, v73
    v_add_f32 v73, v73, v105
    v_mul_f32 v74, v74, v122
    v_cvt_pk_bf16_f32 v74, v74, v74
    v_lshlrev_b32 v74, 16, v74
    v_add_f32 v74, v74, v106
    v_mul_f32 v75, v75, v123
    v_cvt_pk_bf16_f32 v75, v75, v75
    v_lshlrev_b32 v75, 16, v75
    v_add_f32 v75, v75, v107
    v_mul_f32 v76, v76, v124
    v_cvt_pk_bf16_f32 v76, v76, v76
    v_lshlrev_b32 v76, 16, v76
    v_add_f32 v76, v76, v108
    v_mul_f32 v77, v77, v125
    v_cvt_pk_bf16_f32 v77, v77, v77
    v_lshlrev_b32 v77, 16, v77
    v_add_f32 v77, v77, v109
    v_mul_f32 v78, v78, v126
    v_cvt_pk_bf16_f32 v78, v78, v78
    v_lshlrev_b32 v78, 16, v78
    v_add_f32 v78, v78, v110
    v_mul_f32 v79, v79, v127
    v_cvt_pk_bf16_f32 v79, v79, v79
    v_lshlrev_b32 v79, 16, v79
    v_add_f32 v79, v79, v111
    v_cvt_pk_bf16_f32 v80, v64, v65
    v_cvt_pk_bf16_f32 v81, v66, v67
    v_cvt_pk_bf16_f32 v82, v68, v69
    v_cvt_pk_bf16_f32 v83, v70, v71
    v_cvt_pk_bf16_f32 v84, v72, v73
    v_cvt_pk_bf16_f32 v85, v74, v75
    v_cvt_pk_bf16_f32 v86, v76, v77
    v_cvt_pk_bf16_f32 v87, v78, v79
    s_lshr_b32 s45, s63, 5
    s_lshl_b32 s45, s45, 16
    s_and_b32 s46, s63, 31
    s_lshl_b32 s46, s46, 8
    s_add_u32 s45, s45, s46
    s_add_u32 s45, s45, 0x400000
    s_add_u32 s46, s45, 32768
    buffer_store_dwordx4 v[80:83], v2, s[12:15], s45 offen sc1
    buffer_store_dwordx4 v[84:87], v2, s[12:15], s46 offen sc1
    s_add_u32 s63, s63, 384
    v_lshlrev_b32 v64, 16, v152
    v_and_b32 v65, 0xffff0000, v152
    v_lshlrev_b32 v66, 16, v153
    v_and_b32 v67, 0xffff0000, v153
    v_lshlrev_b32 v68, 16, v154
    v_and_b32 v69, 0xffff0000, v154
    v_lshlrev_b32 v70, 16, v155
    v_and_b32 v71, 0xffff0000, v155
    v_lshlrev_b32 v72, 16, v156
    v_and_b32 v73, 0xffff0000, v156
    v_lshlrev_b32 v74, 16, v157
    v_and_b32 v75, 0xffff0000, v157
    v_lshlrev_b32 v76, 16, v158
    v_and_b32 v77, 0xffff0000, v158
    v_lshlrev_b32 v78, 16, v159
    v_and_b32 v79, 0xffff0000, v159
    v_add_f32 v26, v64, v65
    v_add_f32 v26, v26, v66
    v_add_f32 v26, v26, v67
    v_add_f32 v26, v26, v68
    v_add_f32 v26, v26, v69
    v_add_f32 v26, v26, v70
    v_add_f32 v26, v26, v71
    v_add_f32 v26, v26, v72
    v_add_f32 v26, v26, v73
    v_add_f32 v26, v26, v74
    v_add_f32 v26, v26, v75
    v_add_f32 v26, v26, v76
    v_add_f32 v26, v26, v77
    v_add_f32 v26, v26, v78
    v_add_f32 v26, v26, v79
    s_nop 1
    v_add_f32_dpp v26, v26, v26 row_shr:1 row_mask:0xf bank_mask:0xf bound_ctrl:0
    s_nop 1
    v_add_f32_dpp v26, v26, v26 row_shr:2 row_mask:0xf bank_mask:0xf bound_ctrl:0
    s_nop 1
    v_add_f32_dpp v26, v26, v26 row_shr:4 row_mask:0xf bank_mask:0xf bound_ctrl:0
    s_nop 1
    v_add_f32_dpp v26, v26, v26 row_shr:8 row_mask:0xf bank_mask:0xf bound_ctrl:0
    s_nop 1
    v_add_f32_dpp v26, v26, v26 row_bcast:15 row_mask:0xa bank_mask:0xf
    s_nop 1
    v_add_f32_dpp v26, v26, v26 row_bcast:31 row_mask:0xc bank_mask:0xf
    s_nop 1
    v_readlane_b32 s66, v26, 63
    s_nop 1
    v_mov_b32 v27, s66
    v_mul_f32 v27, 0x3a800000, v27
    v_mov_b32 v26, 0
    v_sub_f32 v28, v64, v27
    v_fmac_f32 v26, v28, v28
    v_sub_f32 v28, v65, v27
    v_fmac_f32 v26, v28, v28
    v_sub_f32 v28, v66, v27
    v_fmac_f32 v26, v28, v28
    v_sub_f32 v28, v67, v27
    v_fmac_f32 v26, v28, v28
    v_sub_f32 v28, v68, v27
    v_fmac_f32 v26, v28, v28
    v_sub_f32 v28, v69, v27
    v_fmac_f32 v26, v28, v28
    v_sub_f32 v28, v70, v27
    v_fmac_f32 v26, v28, v28
    v_sub_f32 v28, v71, v27
    v_fmac_f32 v26, v28, v28
    v_sub_f32 v28, v72, v27
    v_fmac_f32 v26, v28, v28
    v_sub_f32 v28, v73, v27
    v_fmac_f32 v26, v28, v28
    v_sub_f32 v28, v74, v27
    v_fmac_f32 v26, v28, v28
    v_sub_f32 v28, v75, v27
    v_fmac_f32 v26, v28, v28
    v_sub_f32 v28, v76, v27
    v_fmac_f32 v26, v28, v28
    v_sub_f32 v28, v77, v27
    v_fmac_f32 v26, v28, v28
    v_sub_f32 v28, v78, v27
    v_fmac_f32 v26, v28, v28
    v_sub_f32 v28, v79, v27
    v_fmac_f32 v26, v28, v28
    s_nop 1
    v_add_f32_dpp v26, v26, v26 row_shr:1 row_mask:0xf bank_mask:0xf bound_ctrl:0
    s_nop 1
    v_add_f32_dpp v26, v26, v26 row_shr:2 row_mask:0xf bank_mask:0xf bound_ctrl:0
    s_nop 1
    v_add_f32_dpp v26, v26, v26 row_shr:4 row_mask:0xf bank_mask:0xf bound_ctrl:0
    s_nop 1
    v_add_f32_dpp v26, v26, v26 row_shr:8 row_mask:0xf bank_mask:0xf bound_ctrl:0
    s_nop 1
    v_add_f32_dpp v26, v26, v26 row_bcast:15 row_mask:0xa bank_mask:0xf
    s_nop 1
    v_add_f32_dpp v26, v26, v26 row_bcast:31 row_mask:0xc bank_mask:0xf
    s_nop 1
    v_readlane_b32 s66, v26, 63
    s_nop 1
    v_mov_b32 v26, s66
    v_mul_f32 v26, 0x3a800000, v26
    v_cvt_pk_bf16_f32 v26, v26, v26
    v_lshlrev_b32 v26, 16, v26
    v_cvt_pk_bf16_f32 v27, v27, v27
    v_lshlrev_b32 v27, 16, v27
    v_add_f32 v26, 0x3727c5ac, v26
    v_cvt_pk_bf16_f32 v26, v26, v26
    v_lshlrev_b32 v26, 16, v26
    v_sqrt_f32 v26, v26
    s_nop 0
    v_cvt_pk_bf16_f32 v26, v26, v26
    v_lshlrev_b32 v26, 16, v26
    v_rcp_f32 v26, v26
    s_nop 0
    v_sub_f32 v64, v64, v27
    v_cvt_pk_bf16_f32 v64, v64, v64
    v_lshlrev_b32 v64, 16, v64
    v_mul_f32 v64, v64, v26
    v_cvt_pk_bf16_f32 v64, v64, v64
    v_lshlrev_b32 v64, 16, v64
    v_sub_f32 v65, v65, v27
    v_cvt_pk_bf16_f32 v65, v65, v65
    v_lshlrev_b32 v65, 16, v65
    v_mul_f32 v65, v65, v26
    v_cvt_pk_bf16_f32 v65, v65, v65
    v_lshlrev_b32 v65, 16, v65
    v_sub_f32 v66, v66, v27
    v_cvt_pk_bf16_f32 v66, v66, v66
    v_lshlrev_b32 v66, 16, v66
    v_mul_f32 v66, v66, v26
    v_cvt_pk_bf16_f32 v66, v66, v66
    v_lshlrev_b32 v66, 16, v66
    v_sub_f32 v67, v67, v27
    v_cvt_pk_bf16_f32 v67, v67, v67
    v_lshlrev_b32 v67, 16, v67
    v_mul_f32 v67, v67, v26
    v_cvt_pk_bf16_f32 v67, v67, v67
    v_lshlrev_b32 v67, 16, v67
    v_sub_f32 v68, v68, v27
    v_cvt_pk_bf16_f32 v68, v68, v68
    v_lshlrev_b32 v68, 16, v68
    v_mul_f32 v68, v68, v26
    v_cvt_pk_bf16_f32 v68, v68, v68
    v_lshlrev_b32 v68, 16, v68
    v_sub_f32 v69, v69, v27
    v_cvt_pk_bf16_f32 v69, v69, v69
    v_lshlrev_b32 v69, 16, v69
    v_mul_f32 v69, v69, v26
    v_cvt_pk_bf16_f32 v69, v69, v69
    v_lshlrev_b32 v69, 16, v69
    v_sub_f32 v70, v70, v27
    v_cvt_pk_bf16_f32 v70, v70, v70
    v_lshlrev_b32 v70, 16, v70
    v_mul_f32 v70, v70, v26
    v_cvt_pk_bf16_f32 v70, v70, v70
    v_lshlrev_b32 v70, 16, v70
    v_sub_f32 v71, v71, v27
    v_cvt_pk_bf16_f32 v71, v71, v71
    v_lshlrev_b32 v71, 16, v71
    v_mul_f32 v71, v71, v26
    v_cvt_pk_bf16_f32 v71, v71, v71
    v_lshlrev_b32 v71, 16, v71
    v_sub_f32 v72, v72, v27
    v_cvt_pk_bf16_f32 v72, v72, v72
    v_lshlrev_b32 v72, 16, v72
    v_mul_f32 v72, v72, v26
    v_cvt_pk_bf16_f32 v72, v72, v72
    v_lshlrev_b32 v72, 16, v72
    v_sub_f32 v73, v73, v27
    v_cvt_pk_bf16_f32 v73, v73, v73
    v_lshlrev_b32 v73, 16, v73
    v_mul_f32 v73, v73, v26
    v_cvt_pk_bf16_f32 v73, v73, v73
    v_lshlrev_b32 v73, 16, v73
    v_sub_f32 v74, v74, v27
    v_cvt_pk_bf16_f32 v74, v74, v74
    v_lshlrev_b32 v74, 16, v74
    v_mul_f32 v74, v74, v26
    v_cvt_pk_bf16_f32 v74, v74, v74
    v_lshlrev_b32 v74, 16, v74
    v_sub_f32 v75, v75, v27
    v_cvt_pk_bf16_f32 v75, v75, v75
    v_lshlrev_b32 v75, 16, v75
    v_mul_f32 v75, v75, v26
    v_cvt_pk_bf16_f32 v75, v75, v75
    v_lshlrev_b32 v75, 16, v75
    v_sub_f32 v76, v76, v27
    v_cvt_pk_bf16_f32 v76, v76, v76
    v_lshlrev_b32 v76, 16, v76
    v_mul_f32 v76, v76, v26
    v_cvt_pk_bf16_f32 v76, v76, v76
    v_lshlrev_b32 v76, 16, v76
    v_sub_f32 v77, v77, v27
    v_cvt_pk_bf16_f32 v77, v77, v77
    v_lshlrev_b32 v77, 16, v77
    v_mul_f32 v77, v77, v26
    v_cvt_pk_bf16_f32 v77, v77, v77
    v_lshlrev_b32 v77, 16, v77
    v_sub_f32 v78, v78, v27
    v_cvt_pk_bf16_f32 v78, v78, v78
    v_lshlrev_b32 v78, 16, v78
    v_mul_f32 v78, v78, v26
    v_cvt_pk_bf16_f32 v78, v78, v78
    v_lshlrev_b32 v78, 16, v78
    v_sub_f32 v79, v79, v27
    v_cvt_pk_bf16_f32 v79, v79, v79
    v_lshlrev_b32 v79, 16, v79
    v_mul_f32 v79, v79, v26
    v_cvt_pk_bf16_f32 v79, v79, v79
    v_lshlrev_b32 v79, 16, v79
    v_mul_f32 v64, v64, v112
    v_cvt_pk_bf16_f32 v64, v64, v64
    v_lshlrev_b32 v64, 16, v64
    v_add_f32 v64, v64, v96
    v_mul_f32 v65, v65, v113
    v_cvt_pk_bf16_f32 v65, v65, v65
    v_lshlrev_b32 v65, 16, v65
    v_add_f32 v65, v65, v97
    v_mul_f32 v66, v66, v114
    v_cvt_pk_bf16_f32 v66, v66, v66
    v_lshlrev_b32 v66, 16, v66
    v_add_f32 v66, v66, v98
    v_mul_f32 v67, v67, v115
    v_cvt_pk_bf16_f32 v67, v67, v67
    v_lshlrev_b32 v67, 16, v67
    v_add_f32 v67, v67, v99
    v_mul_f32 v68, v68, v116
    v_cvt_pk_bf16_f32 v68, v68, v68
    v_lshlrev_b32 v68, 16, v68
    v_add_f32 v68, v68, v100
    v_mul_f32 v69, v69, v117
    v_cvt_pk_bf16_f32 v69, v69, v69
    v_lshlrev_b32 v69, 16, v69
    v_add_f32 v69, v69, v101
    v_mul_f32 v70, v70, v118
    v_cvt_pk_bf16_f32 v70, v70, v70
    v_lshlrev_b32 v70, 16, v70
    v_add_f32 v70, v70, v102
    v_mul_f32 v71, v71, v119
    v_cvt_pk_bf16_f32 v71, v71, v71
    v_lshlrev_b32 v71, 16, v71
    v_add_f32 v71, v71, v103
    v_mul_f32 v72, v72, v120
    v_cvt_pk_bf16_f32 v72, v72, v72
    v_lshlrev_b32 v72, 16, v72
    v_add_f32 v72, v72, v104
    v_mul_f32 v73, v73, v121
    v_cvt_pk_bf16_f32 v73, v73, v73
    v_lshlrev_b32 v73, 16, v73
    v_add_f32 v73, v73, v105
    v_mul_f32 v74, v74, v122
    v_cvt_pk_bf16_f32 v74, v74, v74
    v_lshlrev_b32 v74, 16, v74
    v_add_f32 v74, v74, v106
    v_mul_f32 v75, v75, v123
    v_cvt_pk_bf16_f32 v75, v75, v75
    v_lshlrev_b32 v75, 16, v75
    v_add_f32 v75, v75, v107
    v_mul_f32 v76, v76, v124
    v_cvt_pk_bf16_f32 v76, v76, v76
    v_lshlrev_b32 v76, 16, v76
    v_add_f32 v76, v76, v108
    v_mul_f32 v77, v77, v125
    v_cvt_pk_bf16_f32 v77, v77, v77
    v_lshlrev_b32 v77, 16, v77
    v_add_f32 v77, v77, v109
    v_mul_f32 v78, v78, v126
    v_cvt_pk_bf16_f32 v78, v78, v78
    v_lshlrev_b32 v78, 16, v78
    v_add_f32 v78, v78, v110
    v_mul_f32 v79, v79, v127
    v_cvt_pk_bf16_f32 v79, v79, v79
    v_lshlrev_b32 v79, 16, v79
    v_add_f32 v79, v79, v111
    v_cvt_pk_bf16_f32 v80, v64, v65
    v_cvt_pk_bf16_f32 v81, v66, v67
    v_cvt_pk_bf16_f32 v82, v68, v69
    v_cvt_pk_bf16_f32 v83, v70, v71
    v_cvt_pk_bf16_f32 v84, v72, v73
    v_cvt_pk_bf16_f32 v85, v74, v75
    v_cvt_pk_bf16_f32 v86, v76, v77
    v_cvt_pk_bf16_f32 v87, v78, v79
    s_lshr_b32 s45, s63, 5
    s_lshl_b32 s45, s45, 16
    s_and_b32 s46, s63, 31
    s_lshl_b32 s46, s46, 8
    s_add_u32 s45, s45, s46
    s_add_u32 s45, s45, 0x400000
    s_add_u32 s46, s45, 32768
    buffer_store_dwordx4 v[80:83], v2, s[12:15], s45 offen sc1
    buffer_store_dwordx4 v[84:87], v2, s[12:15], s46 offen sc1
    s_add_u32 s63, s63, 384
    v_lshlrev_b32 v64, 16, v160
    v_and_b32 v65, 0xffff0000, v160
    v_lshlrev_b32 v66, 16, v161
    v_and_b32 v67, 0xffff0000, v161
    v_lshlrev_b32 v68, 16, v162
    v_and_b32 v69, 0xffff0000, v162
    v_lshlrev_b32 v70, 16, v163
    v_and_b32 v71, 0xffff0000, v163
    v_lshlrev_b32 v72, 16, v164
    v_and_b32 v73, 0xffff0000, v164
    v_lshlrev_b32 v74, 16, v165
    v_and_b32 v75, 0xffff0000, v165
    v_lshlrev_b32 v76, 16, v166
    v_and_b32 v77, 0xffff0000, v166
    v_lshlrev_b32 v78, 16, v167
    v_and_b32 v79, 0xffff0000, v167
    v_add_f32 v26, v64, v65
    v_add_f32 v26, v26, v66
    v_add_f32 v26, v26, v67
    v_add_f32 v26, v26, v68
    v_add_f32 v26, v26, v69
    v_add_f32 v26, v26, v70
    v_add_f32 v26, v26, v71
    v_add_f32 v26, v26, v72
    v_add_f32 v26, v26, v73
    v_add_f32 v26, v26, v74
    v_add_f32 v26, v26, v75
    v_add_f32 v26, v26, v76
    v_add_f32 v26, v26, v77
    v_add_f32 v26, v26, v78
    v_add_f32 v26, v26, v79
    s_nop 1
    v_add_f32_dpp v26, v26, v26 row_shr:1 row_mask:0xf bank_mask:0xf bound_ctrl:0
    s_nop 1
    v_add_f32_dpp v26, v26, v26 row_shr:2 row_mask:0xf bank_mask:0xf bound_ctrl:0
    s_nop 1
    v_add_f32_dpp v26, v26, v26 row_shr:4 row_mask:0xf bank_mask:0xf bound_ctrl:0
    s_nop 1
    v_add_f32_dpp v26, v26, v26 row_shr:8 row_mask:0xf bank_mask:0xf bound_ctrl:0
    s_nop 1
    v_add_f32_dpp v26, v26, v26 row_bcast:15 row_mask:0xa bank_mask:0xf
    s_nop 1
    v_add_f32_dpp v26, v26, v26 row_bcast:31 row_mask:0xc bank_mask:0xf
    s_nop 1
    v_readlane_b32 s66, v26, 63
    s_nop 1
    v_mov_b32 v27, s66
    v_mul_f32 v27, 0x3a800000, v27
    v_mov_b32 v26, 0
    v_sub_f32 v28, v64, v27
    v_fmac_f32 v26, v28, v28
    v_sub_f32 v28, v65, v27
    v_fmac_f32 v26, v28, v28
    v_sub_f32 v28, v66, v27
    v_fmac_f32 v26, v28, v28
    v_sub_f32 v28, v67, v27
    v_fmac_f32 v26, v28, v28
    v_sub_f32 v28, v68, v27
    v_fmac_f32 v26, v28, v28
    v_sub_f32 v28, v69, v27
    v_fmac_f32 v26, v28, v28
    v_sub_f32 v28, v70, v27
    v_fmac_f32 v26, v28, v28
    v_sub_f32 v28, v71, v27
    v_fmac_f32 v26, v28, v28
    v_sub_f32 v28, v72, v27
    v_fmac_f32 v26, v28, v28
    v_sub_f32 v28, v73, v27
    v_fmac_f32 v26, v28, v28
    v_sub_f32 v28, v74, v27
    v_fmac_f32 v26, v28, v28
    v_sub_f32 v28, v75, v27
    v_fmac_f32 v26, v28, v28
    v_sub_f32 v28, v76, v27
    v_fmac_f32 v26, v28, v28
    v_sub_f32 v28, v77, v27
    v_fmac_f32 v26, v28, v28
    v_sub_f32 v28, v78, v27
    v_fmac_f32 v26, v28, v28
    v_sub_f32 v28, v79, v27
    v_fmac_f32 v26, v28, v28
    s_nop 1
    v_add_f32_dpp v26, v26, v26 row_shr:1 row_mask:0xf bank_mask:0xf bound_ctrl:0
    s_nop 1
    v_add_f32_dpp v26, v26, v26 row_shr:2 row_mask:0xf bank_mask:0xf bound_ctrl:0
    s_nop 1
    v_add_f32_dpp v26, v26, v26 row_shr:4 row_mask:0xf bank_mask:0xf bound_ctrl:0
    s_nop 1
    v_add_f32_dpp v26, v26, v26 row_shr:8 row_mask:0xf bank_mask:0xf bound_ctrl:0
    s_nop 1
    v_add_f32_dpp v26, v26, v26 row_bcast:15 row_mask:0xa bank_mask:0xf
    s_nop 1
    v_add_f32_dpp v26, v26, v26 row_bcast:31 row_mask:0xc bank_mask:0xf
    s_nop 1
    v_readlane_b32 s66, v26, 63
    s_nop 1
    v_mov_b32 v26, s66
    v_mul_f32 v26, 0x3a800000, v26
    v_cvt_pk_bf16_f32 v26, v26, v26
    v_lshlrev_b32 v26, 16, v26
    v_cvt_pk_bf16_f32 v27, v27, v27
    v_lshlrev_b32 v27, 16, v27
    v_add_f32 v26, 0x3727c5ac, v26
    v_cvt_pk_bf16_f32 v26, v26, v26
    v_lshlrev_b32 v26, 16, v26
    v_sqrt_f32 v26, v26
    s_nop 0
    v_cvt_pk_bf16_f32 v26, v26, v26
    v_lshlrev_b32 v26, 16, v26
    v_rcp_f32 v26, v26
    s_nop 0
    v_sub_f32 v64, v64, v27
    v_cvt_pk_bf16_f32 v64, v64, v64
    v_lshlrev_b32 v64, 16, v64
    v_mul_f32 v64, v64, v26
    v_cvt_pk_bf16_f32 v64, v64, v64
    v_lshlrev_b32 v64, 16, v64
    v_sub_f32 v65, v65, v27
    v_cvt_pk_bf16_f32 v65, v65, v65
    v_lshlrev_b32 v65, 16, v65
    v_mul_f32 v65, v65, v26
    v_cvt_pk_bf16_f32 v65, v65, v65
    v_lshlrev_b32 v65, 16, v65
    v_sub_f32 v66, v66, v27
    v_cvt_pk_bf16_f32 v66, v66, v66
    v_lshlrev_b32 v66, 16, v66
    v_mul_f32 v66, v66, v26
    v_cvt_pk_bf16_f32 v66, v66, v66
    v_lshlrev_b32 v66, 16, v66
    v_sub_f32 v67, v67, v27
    v_cvt_pk_bf16_f32 v67, v67, v67
    v_lshlrev_b32 v67, 16, v67
    v_mul_f32 v67, v67, v26
    v_cvt_pk_bf16_f32 v67, v67, v67
    v_lshlrev_b32 v67, 16, v67
    v_sub_f32 v68, v68, v27
    v_cvt_pk_bf16_f32 v68, v68, v68
    v_lshlrev_b32 v68, 16, v68
    v_mul_f32 v68, v68, v26
    v_cvt_pk_bf16_f32 v68, v68, v68
    v_lshlrev_b32 v68, 16, v68
    v_sub_f32 v69, v69, v27
    v_cvt_pk_bf16_f32 v69, v69, v69
    v_lshlrev_b32 v69, 16, v69
    v_mul_f32 v69, v69, v26
    v_cvt_pk_bf16_f32 v69, v69, v69
    v_lshlrev_b32 v69, 16, v69
    v_sub_f32 v70, v70, v27
    v_cvt_pk_bf16_f32 v70, v70, v70
    v_lshlrev_b32 v70, 16, v70
    v_mul_f32 v70, v70, v26
    v_cvt_pk_bf16_f32 v70, v70, v70
    v_lshlrev_b32 v70, 16, v70
    v_sub_f32 v71, v71, v27
    v_cvt_pk_bf16_f32 v71, v71, v71
    v_lshlrev_b32 v71, 16, v71
    v_mul_f32 v71, v71, v26
    v_cvt_pk_bf16_f32 v71, v71, v71
    v_lshlrev_b32 v71, 16, v71
    v_sub_f32 v72, v72, v27
    v_cvt_pk_bf16_f32 v72, v72, v72
    v_lshlrev_b32 v72, 16, v72
    v_mul_f32 v72, v72, v26
    v_cvt_pk_bf16_f32 v72, v72, v72
    v_lshlrev_b32 v72, 16, v72
    v_sub_f32 v73, v73, v27
    v_cvt_pk_bf16_f32 v73, v73, v73
    v_lshlrev_b32 v73, 16, v73
    v_mul_f32 v73, v73, v26
    v_cvt_pk_bf16_f32 v73, v73, v73
    v_lshlrev_b32 v73, 16, v73
    v_sub_f32 v74, v74, v27
    v_cvt_pk_bf16_f32 v74, v74, v74
    v_lshlrev_b32 v74, 16, v74
    v_mul_f32 v74, v74, v26
    v_cvt_pk_bf16_f32 v74, v74, v74
    v_lshlrev_b32 v74, 16, v74
    v_sub_f32 v75, v75, v27
    v_cvt_pk_bf16_f32 v75, v75, v75
    v_lshlrev_b32 v75, 16, v75
    v_mul_f32 v75, v75, v26
    v_cvt_pk_bf16_f32 v75, v75, v75
    v_lshlrev_b32 v75, 16, v75
    v_sub_f32 v76, v76, v27
    v_cvt_pk_bf16_f32 v76, v76, v76
    v_lshlrev_b32 v76, 16, v76
    v_mul_f32 v76, v76, v26
    v_cvt_pk_bf16_f32 v76, v76, v76
    v_lshlrev_b32 v76, 16, v76
    v_sub_f32 v77, v77, v27
    v_cvt_pk_bf16_f32 v77, v77, v77
    v_lshlrev_b32 v77, 16, v77
    v_mul_f32 v77, v77, v26
    v_cvt_pk_bf16_f32 v77, v77, v77
    v_lshlrev_b32 v77, 16, v77
    v_sub_f32 v78, v78, v27
    v_cvt_pk_bf16_f32 v78, v78, v78
    v_lshlrev_b32 v78, 16, v78
    v_mul_f32 v78, v78, v26
    v_cvt_pk_bf16_f32 v78, v78, v78
    v_lshlrev_b32 v78, 16, v78
    v_sub_f32 v79, v79, v27
    v_cvt_pk_bf16_f32 v79, v79, v79
    v_lshlrev_b32 v79, 16, v79
    v_mul_f32 v79, v79, v26
    v_cvt_pk_bf16_f32 v79, v79, v79
    v_lshlrev_b32 v79, 16, v79
    v_mul_f32 v64, v64, v112
    v_cvt_pk_bf16_f32 v64, v64, v64
    v_lshlrev_b32 v64, 16, v64
    v_add_f32 v64, v64, v96
    v_mul_f32 v65, v65, v113
    v_cvt_pk_bf16_f32 v65, v65, v65
    v_lshlrev_b32 v65, 16, v65
    v_add_f32 v65, v65, v97
    v_mul_f32 v66, v66, v114
    v_cvt_pk_bf16_f32 v66, v66, v66
    v_lshlrev_b32 v66, 16, v66
    v_add_f32 v66, v66, v98
    v_mul_f32 v67, v67, v115
    v_cvt_pk_bf16_f32 v67, v67, v67
    v_lshlrev_b32 v67, 16, v67
    v_add_f32 v67, v67, v99
    v_mul_f32 v68, v68, v116
    v_cvt_pk_bf16_f32 v68, v68, v68
    v_lshlrev_b32 v68, 16, v68
    v_add_f32 v68, v68, v100
    v_mul_f32 v69, v69, v117
    v_cvt_pk_bf16_f32 v69, v69, v69
    v_lshlrev_b32 v69, 16, v69
    v_add_f32 v69, v69, v101
    v_mul_f32 v70, v70, v118
    v_cvt_pk_bf16_f32 v70, v70, v70
    v_lshlrev_b32 v70, 16, v70
    v_add_f32 v70, v70, v102
    v_mul_f32 v71, v71, v119
    v_cvt_pk_bf16_f32 v71, v71, v71
    v_lshlrev_b32 v71, 16, v71
    v_add_f32 v71, v71, v103
    v_mul_f32 v72, v72, v120
    v_cvt_pk_bf16_f32 v72, v72, v72
    v_lshlrev_b32 v72, 16, v72
    v_add_f32 v72, v72, v104
    v_mul_f32 v73, v73, v121
    v_cvt_pk_bf16_f32 v73, v73, v73
    v_lshlrev_b32 v73, 16, v73
    v_add_f32 v73, v73, v105
    v_mul_f32 v74, v74, v122
    v_cvt_pk_bf16_f32 v74, v74, v74
    v_lshlrev_b32 v74, 16, v74
    v_add_f32 v74, v74, v106
    v_mul_f32 v75, v75, v123
    v_cvt_pk_bf16_f32 v75, v75, v75
    v_lshlrev_b32 v75, 16, v75
    v_add_f32 v75, v75, v107
    v_mul_f32 v76, v76, v124
    v_cvt_pk_bf16_f32 v76, v76, v76
    v_lshlrev_b32 v76, 16, v76
    v_add_f32 v76, v76, v108
    v_mul_f32 v77, v77, v125
    v_cvt_pk_bf16_f32 v77, v77, v77
    v_lshlrev_b32 v77, 16, v77
    v_add_f32 v77, v77, v109
    v_mul_f32 v78, v78, v126
    v_cvt_pk_bf16_f32 v78, v78, v78
    v_lshlrev_b32 v78, 16, v78
    v_add_f32 v78, v78, v110
    v_mul_f32 v79, v79, v127
    v_cvt_pk_bf16_f32 v79, v79, v79
    v_lshlrev_b32 v79, 16, v79
    v_add_f32 v79, v79, v111
    v_cvt_pk_bf16_f32 v80, v64, v65
    v_cvt_pk_bf16_f32 v81, v66, v67
    v_cvt_pk_bf16_f32 v82, v68, v69
    v_cvt_pk_bf16_f32 v83, v70, v71
    v_cvt_pk_bf16_f32 v84, v72, v73
    v_cvt_pk_bf16_f32 v85, v74, v75
    v_cvt_pk_bf16_f32 v86, v76, v77
    v_cvt_pk_bf16_f32 v87, v78, v79
    s_lshr_b32 s45, s63, 5
    s_lshl_b32 s45, s45, 16
    s_and_b32 s46, s63, 31
    s_lshl_b32 s46, s46, 8
    s_add_u32 s45, s45, s46
    s_add_u32 s45, s45, 0x400000
    s_add_u32 s46, s45, 32768
    buffer_store_dwordx4 v[80:83], v2, s[12:15], s45 offen sc1
    buffer_store_dwordx4 v[84:87], v2, s[12:15], s46 offen sc1
    s_add_u32 s63, s63, 384
    s_cmp_ge_u32 s63, 2048
    s_cbranch_scc1 L_ln_done_108
    v_lshlrev_b32 v64, 16, v168
    v_and_b32 v65, 0xffff0000, v168
    v_lshlrev_b32 v66, 16, v169
    v_and_b32 v67, 0xffff0000, v169
    v_lshlrev_b32 v68, 16, v170
    v_and_b32 v69, 0xffff0000, v170
    v_lshlrev_b32 v70, 16, v171
    v_and_b32 v71, 0xffff0000, v171
    v_lshlrev_b32 v72, 16, v172
    v_and_b32 v73, 0xffff0000, v172
    v_lshlrev_b32 v74, 16, v173
    v_and_b32 v75, 0xffff0000, v173
    v_lshlrev_b32 v76, 16, v174
    v_and_b32 v77, 0xffff0000, v174
    v_lshlrev_b32 v78, 16, v175
    v_and_b32 v79, 0xffff0000, v175
    v_add_f32 v26, v64, v65
    v_add_f32 v26, v26, v66
    v_add_f32 v26, v26, v67
    v_add_f32 v26, v26, v68
    v_add_f32 v26, v26, v69
    v_add_f32 v26, v26, v70
    v_add_f32 v26, v26, v71
    v_add_f32 v26, v26, v72
    v_add_f32 v26, v26, v73
    v_add_f32 v26, v26, v74
    v_add_f32 v26, v26, v75
    v_add_f32 v26, v26, v76
    v_add_f32 v26, v26, v77
    v_add_f32 v26, v26, v78
    v_add_f32 v26, v26, v79
    s_nop 1
    v_add_f32_dpp v26, v26, v26 row_shr:1 row_mask:0xf bank_mask:0xf bound_ctrl:0
    s_nop 1
    v_add_f32_dpp v26, v26, v26 row_shr:2 row_mask:0xf bank_mask:0xf bound_ctrl:0
    s_nop 1
    v_add_f32_dpp v26, v26, v26 row_shr:4 row_mask:0xf bank_mask:0xf bound_ctrl:0
    s_nop 1
    v_add_f32_dpp v26, v26, v26 row_shr:8 row_mask:0xf bank_mask:0xf bound_ctrl:0
    s_nop 1
    v_add_f32_dpp v26, v26, v26 row_bcast:15 row_mask:0xa bank_mask:0xf
    s_nop 1
    v_add_f32_dpp v26, v26, v26 row_bcast:31 row_mask:0xc bank_mask:0xf
    s_nop 1
    v_readlane_b32 s66, v26, 63
    s_nop 1
    v_mov_b32 v27, s66
    v_mul_f32 v27, 0x3a800000, v27
    v_mov_b32 v26, 0
    v_sub_f32 v28, v64, v27
    v_fmac_f32 v26, v28, v28
    v_sub_f32 v28, v65, v27
    v_fmac_f32 v26, v28, v28
    v_sub_f32 v28, v66, v27
    v_fmac_f32 v26, v28, v28
    v_sub_f32 v28, v67, v27
    v_fmac_f32 v26, v28, v28
    v_sub_f32 v28, v68, v27
    v_fmac_f32 v26, v28, v28
    v_sub_f32 v28, v69, v27
    v_fmac_f32 v26, v28, v28
    v_sub_f32 v28, v70, v27
    v_fmac_f32 v26, v28, v28
    v_sub_f32 v28, v71, v27
    v_fmac_f32 v26, v28, v28
    v_sub_f32 v28, v72, v27
    v_fmac_f32 v26, v28, v28
    v_sub_f32 v28, v73, v27
    v_fmac_f32 v26, v28, v28
    v_sub_f32 v28, v74, v27
    v_fmac_f32 v26, v28, v28
    v_sub_f32 v28, v75, v27
    v_fmac_f32 v26, v28, v28
    v_sub_f32 v28, v76, v27
    v_fmac_f32 v26, v28, v28
    v_sub_f32 v28, v77, v27
    v_fmac_f32 v26, v28, v28
    v_sub_f32 v28, v78, v27
    v_fmac_f32 v26, v28, v28
    v_sub_f32 v28, v79, v27
    v_fmac_f32 v26, v28, v28
    s_nop 1
    v_add_f32_dpp v26, v26, v26 row_shr:1 row_mask:0xf bank_mask:0xf bound_ctrl:0
    s_nop 1
    v_add_f32_dpp v26, v26, v26 row_shr:2 row_mask:0xf bank_mask:0xf bound_ctrl:0
    s_nop 1
    v_add_f32_dpp v26, v26, v26 row_shr:4 row_mask:0xf bank_mask:0xf bound_ctrl:0
    s_nop 1
    v_add_f32_dpp v26, v26, v26 row_shr:8 row_mask:0xf bank_mask:0xf bound_ctrl:0
    s_nop 1
    v_add_f32_dpp v26, v26, v26 row_bcast:15 row_mask:0xa bank_mask:0xf
    s_nop 1
    v_add_f32_dpp v26, v26, v26 row_bcast:31 row_mask:0xc bank_mask:0xf
    s_nop 1
    v_readlane_b32 s66, v26, 63
    s_nop 1
    v_mov_b32 v26, s66
    v_mul_f32 v26, 0x3a800000, v26
    v_cvt_pk_bf16_f32 v26, v26, v26
    v_lshlrev_b32 v26, 16, v26
    v_cvt_pk_bf16_f32 v27, v27, v27
    v_lshlrev_b32 v27, 16, v27
    v_add_f32 v26, 0x3727c5ac, v26
    v_cvt_pk_bf16_f32 v26, v26, v26
    v_lshlrev_b32 v26, 16, v26
    v_sqrt_f32 v26, v26
    s_nop 0
    v_cvt_pk_bf16_f32 v26, v26, v26
    v_lshlrev_b32 v26, 16, v26
    v_rcp_f32 v26, v26
    s_nop 0
    v_sub_f32 v64, v64, v27
    v_cvt_pk_bf16_f32 v64, v64, v64
    v_lshlrev_b32 v64, 16, v64
    v_mul_f32 v64, v64, v26
    v_cvt_pk_bf16_f32 v64, v64, v64
    v_lshlrev_b32 v64, 16, v64
    v_sub_f32 v65, v65, v27
    v_cvt_pk_bf16_f32 v65, v65, v65
    v_lshlrev_b32 v65, 16, v65
    v_mul_f32 v65, v65, v26
    v_cvt_pk_bf16_f32 v65, v65, v65
    v_lshlrev_b32 v65, 16, v65
    v_sub_f32 v66, v66, v27
    v_cvt_pk_bf16_f32 v66, v66, v66
    v_lshlrev_b32 v66, 16, v66
    v_mul_f32 v66, v66, v26
    v_cvt_pk_bf16_f32 v66, v66, v66
    v_lshlrev_b32 v66, 16, v66
    v_sub_f32 v67, v67, v27
    v_cvt_pk_bf16_f32 v67, v67, v67
    v_lshlrev_b32 v67, 16, v67
    v_mul_f32 v67, v67, v26
    v_cvt_pk_bf16_f32 v67, v67, v67
    v_lshlrev_b32 v67, 16, v67
    v_sub_f32 v68, v68, v27
    v_cvt_pk_bf16_f32 v68, v68, v68
    v_lshlrev_b32 v68, 16, v68
    v_mul_f32 v68, v68, v26
    v_cvt_pk_bf16_f32 v68, v68, v68
    v_lshlrev_b32 v68, 16, v68
    v_sub_f32 v69, v69, v27
    v_cvt_pk_bf16_f32 v69, v69, v69
    v_lshlrev_b32 v69, 16, v69
    v_mul_f32 v69, v69, v26
    v_cvt_pk_bf16_f32 v69, v69, v69
    v_lshlrev_b32 v69, 16, v69
    v_sub_f32 v70, v70, v27
    v_cvt_pk_bf16_f32 v70, v70, v70
    v_lshlrev_b32 v70, 16, v70
    v_mul_f32 v70, v70, v26
    v_cvt_pk_bf16_f32 v70, v70, v70
    v_lshlrev_b32 v70, 16, v70
    v_sub_f32 v71, v71, v27
    v_cvt_pk_bf16_f32 v71, v71, v71
    v_lshlrev_b32 v71, 16, v71
    v_mul_f32 v71, v71, v26
    v_cvt_pk_bf16_f32 v71, v71, v71
    v_lshlrev_b32 v71, 16, v71
    v_sub_f32 v72, v72, v27
    v_cvt_pk_bf16_f32 v72, v72, v72
    v_lshlrev_b32 v72, 16, v72
    v_mul_f32 v72, v72, v26
    v_cvt_pk_bf16_f32 v72, v72, v72
    v_lshlrev_b32 v72, 16, v72
    v_sub_f32 v73, v73, v27
    v_cvt_pk_bf16_f32 v73, v73, v73
    v_lshlrev_b32 v73, 16, v73
    v_mul_f32 v73, v73, v26
    v_cvt_pk_bf16_f32 v73, v73, v73
    v_lshlrev_b32 v73, 16, v73
    v_sub_f32 v74, v74, v27
    v_cvt_pk_bf16_f32 v74, v74, v74
    v_lshlrev_b32 v74, 16, v74
    v_mul_f32 v74, v74, v26
    v_cvt_pk_bf16_f32 v74, v74, v74
    v_lshlrev_b32 v74, 16, v74
    v_sub_f32 v75, v75, v27
    v_cvt_pk_bf16_f32 v75, v75, v75
    v_lshlrev_b32 v75, 16, v75
    v_mul_f32 v75, v75, v26
    v_cvt_pk_bf16_f32 v75, v75, v75
    v_lshlrev_b32 v75, 16, v75
    v_sub_f32 v76, v76, v27
    v_cvt_pk_bf16_f32 v76, v76, v76
    v_lshlrev_b32 v76, 16, v76
    v_mul_f32 v76, v76, v26
    v_cvt_pk_bf16_f32 v76, v76, v76
    v_lshlrev_b32 v76, 16, v76
    v_sub_f32 v77, v77, v27
    v_cvt_pk_bf16_f32 v77, v77, v77
    v_lshlrev_b32 v77, 16, v77
    v_mul_f32 v77, v77, v26
    v_cvt_pk_bf16_f32 v77, v77, v77
    v_lshlrev_b32 v77, 16, v77
    v_sub_f32 v78, v78, v27
    v_cvt_pk_bf16_f32 v78, v78, v78
    v_lshlrev_b32 v78, 16, v78
    v_mul_f32 v78, v78, v26
    v_cvt_pk_bf16_f32 v78, v78, v78
    v_lshlrev_b32 v78, 16, v78
    v_sub_f32 v79, v79, v27
    v_cvt_pk_bf16_f32 v79, v79, v79
    v_lshlrev_b32 v79, 16, v79
    v_mul_f32 v79, v79, v26
    v_cvt_pk_bf16_f32 v79, v79, v79
    v_lshlrev_b32 v79, 16, v79
    v_mul_f32 v64, v64, v112
    v_cvt_pk_bf16_f32 v64, v64, v64
    v_lshlrev_b32 v64, 16, v64
    v_add_f32 v64, v64, v96
    v_mul_f32 v65, v65, v113
    v_cvt_pk_bf16_f32 v65, v65, v65
    v_lshlrev_b32 v65, 16, v65
    v_add_f32 v65, v65, v97
    v_mul_f32 v66, v66, v114
    v_cvt_pk_bf16_f32 v66, v66, v66
    v_lshlrev_b32 v66, 16, v66
    v_add_f32 v66, v66, v98
    v_mul_f32 v67, v67, v115
    v_cvt_pk_bf16_f32 v67, v67, v67
    v_lshlrev_b32 v67, 16, v67
    v_add_f32 v67, v67, v99
    v_mul_f32 v68, v68, v116
    v_cvt_pk_bf16_f32 v68, v68, v68
    v_lshlrev_b32 v68, 16, v68
    v_add_f32 v68, v68, v100
    v_mul_f32 v69, v69, v117
    v_cvt_pk_bf16_f32 v69, v69, v69
    v_lshlrev_b32 v69, 16, v69
    v_add_f32 v69, v69, v101
    v_mul_f32 v70, v70, v118
    v_cvt_pk_bf16_f32 v70, v70, v70
    v_lshlrev_b32 v70, 16, v70
    v_add_f32 v70, v70, v102
    v_mul_f32 v71, v71, v119
    v_cvt_pk_bf16_f32 v71, v71, v71
    v_lshlrev_b32 v71, 16, v71
    v_add_f32 v71, v71, v103
    v_mul_f32 v72, v72, v120
    v_cvt_pk_bf16_f32 v72, v72, v72
    v_lshlrev_b32 v72, 16, v72
    v_add_f32 v72, v72, v104
    v_mul_f32 v73, v73, v121
    v_cvt_pk_bf16_f32 v73, v73, v73
    v_lshlrev_b32 v73, 16, v73
    v_add_f32 v73, v73, v105
    v_mul_f32 v74, v74, v122
    v_cvt_pk_bf16_f32 v74, v74, v74
    v_lshlrev_b32 v74, 16, v74
    v_add_f32 v74, v74, v106
    v_mul_f32 v75, v75, v123
    v_cvt_pk_bf16_f32 v75, v75, v75
    v_lshlrev_b32 v75, 16, v75
    v_add_f32 v75, v75, v107
    v_mul_f32 v76, v76, v124
    v_cvt_pk_bf16_f32 v76, v76, v76
    v_lshlrev_b32 v76, 16, v76
    v_add_f32 v76, v76, v108
    v_mul_f32 v77, v77, v125
    v_cvt_pk_bf16_f32 v77, v77, v77
    v_lshlrev_b32 v77, 16, v77
    v_add_f32 v77, v77, v109
    v_mul_f32 v78, v78, v126
    v_cvt_pk_bf16_f32 v78, v78, v78
    v_lshlrev_b32 v78, 16, v78
    v_add_f32 v78, v78, v110
    v_mul_f32 v79, v79, v127
    v_cvt_pk_bf16_f32 v79, v79, v79
    v_lshlrev_b32 v79, 16, v79
    v_add_f32 v79, v79, v111
    v_cvt_pk_bf16_f32 v80, v64, v65
    v_cvt_pk_bf16_f32 v81, v66, v67
    v_cvt_pk_bf16_f32 v82, v68, v69
    v_cvt_pk_bf16_f32 v83, v70, v71
    v_cvt_pk_bf16_f32 v84, v72, v73
    v_cvt_pk_bf16_f32 v85, v74, v75
    v_cvt_pk_bf16_f32 v86, v76, v77
    v_cvt_pk_bf16_f32 v87, v78, v79
    s_lshr_b32 s45, s63, 5
    s_lshl_b32 s45, s45, 16
    s_and_b32 s46, s63, 31
    s_lshl_b32 s46, s46, 8
    s_add_u32 s45, s45, s46
    s_add_u32 s45, s45, 0x400000
    s_add_u32 s46, s45, 32768
    buffer_store_dwordx4 v[80:83], v2, s[12:15], s45 offen sc1
    buffer_store_dwordx4 v[84:87], v2, s[12:15], s46 offen sc1
    s_add_u32 s63, s63, 384
L_ln_done_108:
    s_waitcnt vmcnt(0)
    s_barrier
    s_cmp_lg_u32 s44, 0
    s_cbranch_scc1 L_cnt_110
    v_mov_b32 v30, 1
    v_mov_b32 v31, 0
    s_mov_b64 exec, 1
    buffer_atomic_add v30, v31, s[16:19], 0 offen offset:196 sc1
    s_mov_b64 exec, -1
L_cnt_110:
    s_add_u32 s39, s39, 96
    s_load_dwordx2 s[4:5], s[0:1], 96
    s_load_dwordx2 s[6:7], s[0:1], 104
    v_and_b32 v14, 7, v0
    v_lshrrev_b32 v15, 3, v0
    s_waitcnt lgkmcnt(0)
    s_mov_b32 s32, s4
    s_and_b32 s33, s5, 0xffff
    s_mov_b32 s34, 0x800
    s_mov_b32 s35, 0x00020000
    s_mov_b32 s24, s6
    s_and_b32 s25, s7, 0xffff
    s_mov_b32 s26, 0xc00000
    s_mov_b32 s27, 0x00020000
    s_and_b32 s47, s39, 1
    s_lshl_b32 s45, s47, 10
    v_lshlrev_b32 v16, 5, v15
    buffer_load_dwordx4 v[104:107], v16, s[32:35], s45 offen
    buffer_load_dwordx4 v[108:111], v16, s[32:35], s45 offen offset:16
    s_mov_b32 s45, 196608
    v_mul_lo_u32 v17, v15, s45
    v_lshlrev_b32 v18, 4, v14
    v_add_u32 v17, v17, v18
    s_lshr_b32 s46, s39, 1
    s_lshl_b32 s46, s46, 7
    s_mul_i32 s45, s47, 6291456
    s_add_u32 s46, s46, s45
    buffer_load_dwordx4 v[32:35], v17, s[24:27], s46 offen
    v_add_u32 v17, 12288, v17
    buffer_load_dwordx4 v[36:39], v17, s[24:27], s46 offen
    v_add_u32 v17, 12288, v17
    buffer_load_dwordx4 v[40:43], v17, s[24:27], s46 offen
    v_add_u32 v17, 12288, v17
    buffer_load_dwordx4 v[44:47], v17, s[24:27], s46 offen
    v_add_u32 v17, 12288, v17
    buffer_load_dwordx4 v[48:51], v17, s[24:27], s46 offen
    v_add_u32 v17, 12288, v17
    buffer_load_dwordx4 v[52:55], v17, s[24:27], s46 offen
    v_add_u32 v17, 12288, v17
    buffer_load_dwordx4 v[56:59], v17, s[24:27], s46 offen
    v_add_u32 v17, 12288, v17
    buffer_load_dwordx4 v[60:63], v17, s[24:27], s46 offen
    v_add_u32 v17, 12288, v17
    buffer_load_dwordx4 v[64:67], v17, s[24:27], s46 offen
    v_add_u32 v17, 12288, v17
    buffer_load_dwordx4 v[68:71], v17, s[24:27], s46 offen
    v_add_u32 v17, 12288, v17
    buffer_load_dwordx4 v[72:75], v17, s[24:27], s46 offen
    v_add_u32 v17, 12288, v17
    buffer_load_dwordx4 v[76:79], v17, s[24:27], s46 offen
    v_add_u32 v17, 12288, v17
    buffer_load_dwordx4 v[80:83], v17, s[24:27], s46 offen
    v_add_u32 v17, 12288, v17
    buffer_load_dwordx4 v[84:87], v17, s[24:27], s46 offen
    v_add_u32 v17, 12288, v17
    buffer_load_dwordx4 v[88:91], v17, s[24:27], s46 offen
    v_add_u32 v17, 12288, v17
    buffer_load_dwordx4 v[92:95], v17, s[24:27], s46 offen
    s_waitcnt vmcnt(16)
    v_lshlrev_b32 v112, 16, v104
    v_and_b32 v113, 0xffff0000, v104
    v_lshlrev_b32 v114, 16, v105
    v_and_b32 v115, 0xffff0000, v105
    v_lshlrev_b32 v116, 16, v106
    v_and_b32 v117, 0xffff0000, v106
    v_lshlrev_b32 v118, 16, v107
    v_and_b32 v119, 0xffff0000, v107
    v_lshlrev_b32 v120, 16, v108
    v_and_b32 v121, 0xffff0000, v108
    v_lshlrev_b32 v122, 16, v109
    v_and_b32 v123, 0xffff0000, v109
    v_lshlrev_b32 v124, 16, v110
    v_and_b32 v125, 0xffff0000, v110
    v_lshlrev_b32 v126, 16, v111
    v_and_b32 v127, 0xffff0000, v111
    v_mul_f32 v18, 0xbfb8aa3b, v112
    v_exp_f32 v18, v18
    s_nop 0
    v_add_f32 v18, 1.0, v18
    v_rcp_f32 v18, v18
    s_nop 0
    v_mul_f32 v112, v112, v18
    v_cvt_pk_bf16_f32 v112, v112, v112
    v_lshlrev_b32 v112, 16, v112
    v_mul_f32 v18, 0xbfb8aa3b, v113
    v_exp_f32 v18, v18
    s_nop 0
    v_add_f32 v18, 1.0, v18
    v_rcp_f32 v18, v18
    s_nop 0
    v_mul_f32 v113, v113, v18
    v_cvt_pk_bf16_f32 v113, v113, v113
    v_lshlrev_b32 v113, 16, v113
    v_mul_f32 v18, 0xbfb8aa3b, v114
    v_exp_f32 v18, v18
    s_nop 0
    v_add_f32 v18, 1.0, v18
    v_rcp_f32 v18, v18
    s_nop 0
    v_mul_f32 v114, v114, v18
    v_cvt_pk_bf16_f32 v114, v114, v114
    v_lshlrev_b32 v114, 16, v114
    v_mul_f32 v18, 0xbfb8aa3b, v115
    v_exp_f32 v18, v18
    s_nop 0
    v_add_f32 v18, 1.0, v18
    v_rcp_f32 v18, v18
    s_nop 0
    v_mul_f32 v115, v115, v18
    v_cvt_pk_bf16_f32 v115, v115, v115
    v_lshlrev_b32 v115, 16, v115
    v_mul_f32 v18, 0xbfb8aa3b, v116
    v_exp_f32 v18, v18
    s_nop 0
    v_add_f32 v18, 1.0, v18
    v_rcp_f32 v18, v18
    s_nop 0
    v_mul_f32 v116, v116, v18
    v_cvt_pk_bf16_f32 v116, v116, v116
    v_lshlrev_b32 v116, 16, v116
    v_mul_f32 v18, 0xbfb8aa3b, v117
    v_exp_f32 v18, v18
    s_nop 0
    v_add_f32 v18, 1.0, v18
    v_rcp_f32 v18, v18
    s_nop 0
    v_mul_f32 v117, v117, v18
    v_cvt_pk_bf16_f32 v117, v117, v117
    v_lshlrev_b32 v117, 16, v117
    v_mul_f32 v18, 0xbfb8aa3b, v118
    v_exp_f32 v18, v18
    s_nop 0
    v_add_f32 v18, 1.0, v18
    v_rcp_f32 v18, v18
    s_nop 0
    v_mul_f32 v118, v118, v18
    v_cvt_pk_bf16_f32 v118, v118, v118
    v_lshlrev_b32 v118, 16, v118
    v_mul_f32 v18, 0xbfb8aa3b, v119
    v_exp_f32 v18, v18
    s_nop 0
    v_add_f32 v18, 1.0, v18
    v_rcp_f32 v18, v18
    s_nop 0
    v_mul_f32 v119, v119, v18
    v_cvt_pk_bf16_f32 v119, v119, v119
    v_lshlrev_b32 v119, 16, v119
    v_mul_f32 v18, 0xbfb8aa3b, v120
    v_exp_f32 v18, v18
    s_nop 0
    v_add_f32 v18, 1.0, v18
    v_rcp_f32 v18, v18
    s_nop 0
    v_mul_f32 v120, v120, v18
    v_cvt_pk_bf16_f32 v120, v120, v120
    v_lshlrev_b32 v120, 16, v120
    v_mul_f32 v18, 0xbfb8aa3b, v121
    v_exp_f32 v18, v18
    s_nop 0
    v_add_f32 v18, 1.0, v18
    v_rcp_f32 v18, v18
    s_nop 0
    v_mul_f32 v121, v121, v18
    v_cvt_pk_bf16_f32 v121, v121, v121
    v_lshlrev_b32 v121, 16, v121
    v_mul_f32 v18, 0xbfb8aa3b, v122
    v_exp_f32 v18, v18
    s_nop 0
    v_add_f32 v18, 1.0, v18
    v_rcp_f32 v18, v18
    s_nop 0
    v_mul_f32 v122, v122, v18
    v_cvt_pk_bf16_f32 v122, v122, v122
    v_lshlrev_b32 v122, 16, v122
    v_mul_f32 v18, 0xbfb8aa3b, v123
    v_exp_f32 v18, v18
    s_nop 0
    v_add_f32 v18, 1.0, v18
    v_rcp_f32 v18, v18
    s_nop 0
    v_mul_f32 v123, v123, v18
    v_cvt_pk_bf16_f32 v123, v123, v123
    v_lshlrev_b32 v123, 16, v123
    v_mul_f32 v18, 0xbfb8aa3b, v124
    v_exp_f32 v18, v18
    s_nop 0
    v_add_f32 v18, 1.0, v18
    v_rcp_f32 v18, v18
    s_nop 0
    v_mul_f32 v124, v124, v18
    v_cvt_pk_bf16_f32 v124, v124, v124
    v_lshlrev_b32 v124, 16, v124
    v_mul_f32 v18, 0xbfb8aa3b, v125
    v_exp_f32 v18, v18
    s_nop 0
    v_add_f32 v18, 1.0, v18
    v_rcp_f32 v18, v18
    s_nop 0
    v_mul_f32 v125, v125, v18
    v_cvt_pk_bf16_f32 v125, v125, v125
    v_lshlrev_b32 v125, 16, v125
    v_mul_f32 v18, 0xbfb8aa3b, v126
    v_exp_f32 v18, v18
    s_nop 0
    v_add_f32 v18, 1.0, v18
    v_rcp_f32 v18, v18
    s_nop 0
    v_mul_f32 v126, v126, v18
    v_cvt_pk_bf16_f32 v126, v126, v126
    v_lshlrev_b32 v126, 16, v126
    v_mul_f32 v18, 0xbfb8aa3b, v127
    v_exp_f32 v18, v18
    s_nop 0
    v_add_f32 v18, 1.0, v18
    v_rcp_f32 v18, v18
    s_nop 0
    v_mul_f32 v127, v127, v18
    v_cvt_pk_bf16_f32 v127, v127, v127
    v_lshlrev_b32 v127, 16, v127
    v_mov_b32 v96, 0
    v_mov_b32 v97, 0
    v_mov_b32 v98, 0
    v_mov_b32 v99, 0
    v_mov_b32 v100, 0
    v_mov_b32 v101, 0
    v_mov_b32 v102, 0
    v_mov_b32 v103, 0
    s_waitcnt vmcnt(15)
    v_lshlrev_b32 v18, 16, v32
    v_and_b32 v19, 0xffff0000, v32
    v_fmac_f32 v96, v18, v112
    v_fmac_f32 v97, v19, v112
    v_lshlrev_b32 v18, 16, v33
    v_and_b32 v19, 0xffff0000, v33
    v_fmac_f32 v98, v18, v112
    v_fmac_f32 v99, v19, v112
    v_lshlrev_b32 v18, 16, v34
    v_and_b32 v19, 0xffff0000, v34
    v_fmac_f32 v100, v18, v112
    v_fmac_f32 v101, v19, v112
    v_lshlrev_b32 v18, 16, v35
    v_and_b32 v19, 0xffff0000, v35
    v_fmac_f32 v102, v18, v112
    v_fmac_f32 v103, v19, v112
    s_waitcnt vmcnt(14)
    v_lshlrev_b32 v18, 16, v36
    v_and_b32 v19, 0xffff0000, v36
    v_fmac_f32 v96, v18, v113
    v_fmac_f32 v97, v19, v113
    v_lshlrev_b32 v18, 16, v37
    v_and_b32 v19, 0xffff0000, v37
    v_fmac_f32 v98, v18, v113
    v_fmac_f32 v99, v19, v113
    v_lshlrev_b32 v18, 16, v38
    v_and_b32 v19, 0xffff0000, v38
    v_fmac_f32 v100, v18, v113
    v_fmac_f32 v101, v19, v113
    v_lshlrev_b32 v18, 16, v39
    v_and_b32 v19, 0xffff0000, v39
    v_fmac_f32 v102, v18, v113
    v_fmac_f32 v103, v19, v113
    s_waitcnt vmcnt(13)
    v_lshlrev_b32 v18, 16, v40
    v_and_b32 v19, 0xffff0000, v40
    v_fmac_f32 v96, v18, v114
    v_fmac_f32 v97, v19, v114
    v_lshlrev_b32 v18, 16, v41
    v_and_b32 v19, 0xffff0000, v41
    v_fmac_f32 v98, v18, v114
    v_fmac_f32 v99, v19, v114
    v_lshlrev_b32 v18, 16, v42
    v_and_b32 v19, 0xffff0000, v42
    v_fmac_f32 v100, v18, v114
    v_fmac_f32 v101, v19, v114
    v_lshlrev_b32 v18, 16, v43
    v_and_b32 v19, 0xffff0000, v43
    v_fmac_f32 v102, v18, v114
    v_fmac_f32 v103, v19, v114
    s_waitcnt vmcnt(12)
    v_lshlrev_b32 v18, 16, v44
    v_and_b32 v19, 0xffff0000, v44
    v_fmac_f32 v96, v18, v115
    v_fmac_f32 v97, v19, v115
    v_lshlrev_b32 v18, 16, v45
    v_and_b32 v19, 0xffff0000, v45
    v_fmac_f32 v98, v18, v115
    v_fmac_f32 v99, v19, v115
    v_lshlrev_b32 v18, 16, v46
    v_and_b32 v19, 0xffff0000, v46
    v_fmac_f32 v100, v18, v115
    v_fmac_f32 v101, v19, v115
    v_lshlrev_b32 v18, 16, v47
    v_and_b32 v19, 0xffff0000, v47
    v_fmac_f32 v102, v18, v115
    v_fmac_f32 v103, v19, v115
    s_waitcnt vmcnt(11)
    v_lshlrev_b32 v18, 16, v48
    v_and_b32 v19, 0xffff0000, v48
    v_fmac_f32 v96, v18, v116
    v_fmac_f32 v97, v19, v116
    v_lshlrev_b32 v18, 16, v49
    v_and_b32 v19, 0xffff0000, v49
    v_fmac_f32 v98, v18, v116
    v_fmac_f32 v99, v19, v116
    v_lshlrev_b32 v18, 16, v50
    v_and_b32 v19, 0xffff0000, v50
    v_fmac_f32 v100, v18, v116
    v_fmac_f32 v101, v19, v116
    v_lshlrev_b32 v18, 16, v51
    v_and_b32 v19, 0xffff0000, v51
    v_fmac_f32 v102, v18, v116
    v_fmac_f32 v103, v19, v116
    s_waitcnt vmcnt(10)
    v_lshlrev_b32 v18, 16, v52
    v_and_b32 v19, 0xffff0000, v52
    v_fmac_f32 v96, v18, v117
    v_fmac_f32 v97, v19, v117
    v_lshlrev_b32 v18, 16, v53
    v_and_b32 v19, 0xffff0000, v53
    v_fmac_f32 v98, v18, v117
    v_fmac_f32 v99, v19, v117
    v_lshlrev_b32 v18, 16, v54
    v_and_b32 v19, 0xffff0000, v54
    v_fmac_f32 v100, v18, v117
    v_fmac_f32 v101, v19, v117
    v_lshlrev_b32 v18, 16, v55
    v_and_b32 v19, 0xffff0000, v55
    v_fmac_f32 v102, v18, v117
    v_fmac_f32 v103, v19, v117
    s_waitcnt vmcnt(9)
    v_lshlrev_b32 v18, 16, v56
    v_and_b32 v19, 0xffff0000, v56
    v_fmac_f32 v96, v18, v118
    v_fmac_f32 v97, v19, v118
    v_lshlrev_b32 v18, 16, v57
    v_and_b32 v19, 0xffff0000, v57
    v_fmac_f32 v98, v18, v118
    v_fmac_f32 v99, v19, v118
    v_lshlrev_b32 v18, 16, v58
    v_and_b32 v19, 0xffff0000, v58
    v_fmac_f32 v100, v18, v118
    v_fmac_f32 v101, v19, v118
    v_lshlrev_b32 v18, 16, v59
    v_and_b32 v19, 0xffff0000, v59
    v_fmac_f32 v102, v18, v118
    v_fmac_f32 v103, v19, v118
    s_waitcnt vmcnt(8)
    v_lshlrev_b32 v18, 16, v60
    v_and_b32 v19, 0xffff0000, v60
    v_fmac_f32 v96, v18, v119
    v_fmac_f32 v97, v19, v119
    v_lshlrev_b32 v18, 16, v61
    v_and_b32 v19, 0xffff0000, v61
    v_fmac_f32 v98, v18, v119
    v_fmac_f32 v99, v19, v119
    v_lshlrev_b32 v18, 16, v62
    v_and_b32 v19, 0xffff0000, v62
    v_fmac_f32 v100, v18, v119
    v_fmac_f32 v101, v19, v119
    v_lshlrev_b32 v18, 16, v63
    v_and_b32 v19, 0xffff0000, v63
    v_fmac_f32 v102, v18, v119
    v_fmac_f32 v103, v19, v119
    s_waitcnt vmcnt(7)
    v_lshlrev_b32 v18, 16, v64
    v_and_b32 v19, 0xffff0000, v64
    v_fmac_f32 v96, v18, v120
    v_fmac_f32 v97, v19, v120
    v_lshlrev_b32 v18, 16, v65
    v_and_b32 v19, 0xffff0000, v65
    v_fmac_f32 v98, v18, v120
    v_fmac_f32 v99, v19, v120
    v_lshlrev_b32 v18, 16, v66
    v_and_b32 v19, 0xffff0000, v66
    v_fmac_f32 v100, v18, v120
    v_fmac_f32 v101, v19, v120
    v_lshlrev_b32 v18, 16, v67
    v_and_b32 v19, 0xffff0000, v67
    v_fmac_f32 v102, v18, v120
    v_fmac_f32 v103, v19, v120
    s_waitcnt vmcnt(6)
    v_lshlrev_b32 v18, 16, v68
    v_and_b32 v19, 0xffff0000, v68
    v_fmac_f32 v96, v18, v121
    v_fmac_f32 v97, v19, v121
    v_lshlrev_b32 v18, 16, v69
    v_and_b32 v19, 0xffff0000, v69
    v_fmac_f32 v98, v18, v121
    v_fmac_f32 v99, v19, v121
    v_lshlrev_b32 v18, 16, v70
    v_and_b32 v19, 0xffff0000, v70
    v_fmac_f32 v100, v18, v121
    v_fmac_f32 v101, v19, v121
    v_lshlrev_b32 v18, 16, v71
    v_and_b32 v19, 0xffff0000, v71
    v_fmac_f32 v102, v18, v121
    v_fmac_f32 v103, v19, v121
    s_waitcnt vmcnt(5)
    v_lshlrev_b32 v18, 16, v72
    v_and_b32 v19, 0xffff0000, v72
    v_fmac_f32 v96, v18, v122
    v_fmac_f32 v97, v19, v122
    v_lshlrev_b32 v18, 16, v73
    v_and_b32 v19, 0xffff0000, v73
    v_fmac_f32 v98, v18, v122
    v_fmac_f32 v99, v19, v122
    v_lshlrev_b32 v18, 16, v74
    v_and_b32 v19, 0xffff0000, v74
    v_fmac_f32 v100, v18, v122
    v_fmac_f32 v101, v19, v122
    v_lshlrev_b32 v18, 16, v75
    v_and_b32 v19, 0xffff0000, v75
    v_fmac_f32 v102, v18, v122
    v_fmac_f32 v103, v19, v122
    s_waitcnt vmcnt(4)
    v_lshlrev_b32 v18, 16, v76
    v_and_b32 v19, 0xffff0000, v76
    v_fmac_f32 v96, v18, v123
    v_fmac_f32 v97, v19, v123
    v_lshlrev_b32 v18, 16, v77
    v_and_b32 v19, 0xffff0000, v77
    v_fmac_f32 v98, v18, v123
    v_fmac_f32 v99, v19, v123
    v_lshlrev_b32 v18, 16, v78
    v_and_b32 v19, 0xffff0000, v78
    v_fmac_f32 v100, v18, v123
    v_fmac_f32 v101, v19, v123
    v_lshlrev_b32 v18, 16, v79
    v_and_b32 v19, 0xffff0000, v79
    v_fmac_f32 v102, v18, v123
    v_fmac_f32 v103, v19, v123
    s_waitcnt vmcnt(3)
    v_lshlrev_b32 v18, 16, v80
    v_and_b32 v19, 0xffff0000, v80
    v_fmac_f32 v96, v18, v124
    v_fmac_f32 v97, v19, v124
    v_lshlrev_b32 v18, 16, v81
    v_and_b32 v19, 0xffff0000, v81
    v_fmac_f32 v98, v18, v124
    v_fmac_f32 v99, v19, v124
    v_lshlrev_b32 v18, 16, v82
    v_and_b32 v19, 0xffff0000, v82
    v_fmac_f32 v100, v18, v124
    v_fmac_f32 v101, v19, v124
    v_lshlrev_b32 v18, 16, v83
    v_and_b32 v19, 0xffff0000, v83
    v_fmac_f32 v102, v18, v124
    v_fmac_f32 v103, v19, v124
    s_waitcnt vmcnt(2)
    v_lshlrev_b32 v18, 16, v84
    v_and_b32 v19, 0xffff0000, v84
    v_fmac_f32 v96, v18, v125
    v_fmac_f32 v97, v19, v125
    v_lshlrev_b32 v18, 16, v85
    v_and_b32 v19, 0xffff0000, v85
    v_fmac_f32 v98, v18, v125
    v_fmac_f32 v99, v19, v125
    v_lshlrev_b32 v18, 16, v86
    v_and_b32 v19, 0xffff0000, v86
    v_fmac_f32 v100, v18, v125
    v_fmac_f32 v101, v19, v125
    v_lshlrev_b32 v18, 16, v87
    v_and_b32 v19, 0xffff0000, v87
    v_fmac_f32 v102, v18, v125
    v_fmac_f32 v103, v19, v125
    s_waitcnt vmcnt(1)
    v_lshlrev_b32 v18, 16, v88
    v_and_b32 v19, 0xffff0000, v88
    v_fmac_f32 v96, v18, v126
    v_fmac_f32 v97, v19, v126
    v_lshlrev_b32 v18, 16, v89
    v_and_b32 v19, 0xffff0000, v89
    v_fmac_f32 v98, v18, v126
    v_fmac_f32 v99, v19, v126
    v_lshlrev_b32 v18, 16, v90
    v_and_b32 v19, 0xffff0000, v90
    v_fmac_f32 v100, v18, v126
    v_fmac_f32 v101, v19, v126
    v_lshlrev_b32 v18, 16, v91
    v_and_b32 v19, 0xffff0000, v91
    v_fmac_f32 v102, v18, v126
    v_fmac_f32 v103, v19, v126
    s_waitcnt vmcnt(0)
    v_lshlrev_b32 v18, 16, v92
    v_and_b32 v19, 0xffff0000, v92
    v_fmac_f32 v96, v18, v127
    v_fmac_f32 v97, v19, v127
    v_lshlrev_b32 v18, 16, v93
    v_and_b32 v19, 0xffff0000, v93
    v_fmac_f32 v98, v18, v127
    v_fmac_f32 v99, v19, v127
    v_lshlrev_b32 v18, 16, v94
    v_and_b32 v19, 0xffff0000, v94
    v_fmac_f32 v100, v18, v127
    v_fmac_f32 v101, v19, v127
    v_lshlrev_b32 v18, 16, v95
    v_and_b32 v19, 0xffff0000, v95
    v_fmac_f32 v102, v18, v127
    v_fmac_f32 v103, v19, v127
    v_lshlrev_b32 v16, 5, v0
    ds_write_b128 v16, v[96:99]
    ds_write_b128 v16, v[100:103] offset:16
    s_waitcnt lgkmcnt(0)
    s_barrier
    s_cmp_lg_u32 s44, 0
    s_cbranch_scc1 L_mod_fin_111
    v_mov_b32 v18, 0
    ds_read_b32 v32, v12 offset:0
    ds_read_b32 v33, v12 offset:256
    ds_read_b32 v34, v12 offset:512
    ds_read_b32 v35, v12 offset:768
    ds_read_b32 v36, v12 offset:1024
    ds_read_b32 v37, v12 offset:1280
    ds_read_b32 v38, v12 offset:1536
    ds_read_b32 v39, v12 offset:1792
    ds_read_b32 v40, v12 offset:2048
    ds_read_b32 v41, v12 offset:2304
    ds_read_b32 v42, v12 offset:2560
    ds_read_b32 v43, v12 offset:2816
    ds_read_b32 v44, v12 offset:3072
    ds_read_b32 v45, v12 offset:3328
    ds_read_b32 v46, v12 offset:3584
    ds_read_b32 v47, v12 offset:3840
    s_waitcnt lgkmcnt(0)
    v_add_f32 v18, v18, v32
    v_add_f32 v18, v18, v33
    v_add_f32 v18, v18, v34
    v_add_f32 v18, v18, v35
    v_add_f32 v18, v18, v36
    v_add_f32 v18, v18, v37
    v_add_f32 v18, v18, v38
    v_add_f32 v18, v18, v39
    v_add_f32 v18, v18, v40
    v_add_f32 v18, v18, v41
    v_add_f32 v18, v18, v42
    v_add_f32 v18, v18, v43
    v_add_f32 v18, v18, v44
    v_add_f32 v18, v18, v45
    v_add_f32 v18, v18, v46
    v_add_f32 v18, v18, v47
    ds_read_b32 v32, v12 offset:4096
    ds_read_b32 v33, v12 offset:4352
    ds_read_b32 v34, v12 offset:4608
    ds_read_b32 v35, v12 offset:4864
    ds_read_b32 v36, v12 offset:5120
    ds_read_b32 v37, v12 offset:5376
    ds_read_b32 v38, v12 offset:5632
    ds_read_b32 v39, v12 offset:5888
    ds_read_b32 v40, v12 offset:6144
    ds_read_b32 v41, v12 offset:6400
    ds_read_b32 v42, v12 offset:6656
    ds_read_b32 v43, v12 offset:6912
    ds_read_b32 v44, v12 offset:7168
    ds_read_b32 v45, v12 offset:7424
    ds_read_b32 v46, v12 offset:7680
    ds_read_b32 v47, v12 offset:7936
    s_waitcnt lgkmcnt(0)
    v_add_f32 v18, v18, v32
    v_add_f32 v18, v18, v33
    v_add_f32 v18, v18, v34
    v_add_f32 v18, v18, v35
    v_add_f32 v18, v18, v36
    v_add_f32 v18, v18, v37
    v_add_f32 v18, v18, v38
    v_add_f32 v18, v18, v39
    v_add_f32 v18, v18, v40
    v_add_f32 v18, v18, v41
    v_add_f32 v18, v18, v42
    v_add_f32 v18, v18, v43
    v_add_f32 v18, v18, v44
    v_add_f32 v18, v18, v45
    v_add_f32 v18, v18, v46
    v_add_f32 v18, v18, v47
    s_lshr_b32 s45, s39, 1
    s_lshl_b32 s45, s45, 8
    s_mul_i32 s46, s47, 24576
    s_add_u32 s45, s45, s46
    buffer_store_dword v18, v12, s[12:15], s45 offen sc1
L_mod_fin_111:
    s_waitcnt vmcnt(0)
    s_barrier
    s_cmp_lg_u32 s44, 0
    s_cbranch_scc1 L_cnt_112
    v_mov_b32 v30, 1
    v_mov_b32 v31, 0
    s_mov_b64 exec, 1
    buffer_atomic_add v30, v31, s[16:19], 0 offen offset:132 sc1
    s_mov_b64 exec, -1
L_cnt_112:
    s_branch L_w_roles_103
L_w_kv_102:
    s_lshl_b32 s45, s43, 3
    s_add_u32 s45, s45, 16
    s_load_dwordx2 s[6:7], s[0:1], s45
    s_waitcnt lgkmcnt(0)
    s_mov_b32 s24, s6
    s_and_b32 s25, s7, 0xffff
    s_mov_b32 s26, 0x800000
    s_mov_b32 s27, 0x00020000
    s_lshl_b32 s46, s41, 8
    s_barrier
    v_lshrrev_b32 v20, 4, v1
    s_lshl_b32 s45, s44, 2
    v_add_u32 v21, s45, v20
    s_mov_b32 s45, 8192
    v_mul_lo_u32 v21, v21, s45
    v_lshlrev_b32 v22, 2, v20
    v_and_b32 v23, 15, v1
    v_xor_b32 v22, v22, v23
    v_lshlrev_b32 v22, 4, v22
    v_add_u32 v21, v21, v22
    v_bfe_u32 v22, v1, 2, 2
    v_lshlrev_b32 v23, 3, v20
    v_add_u32 v23, v23, v22
    v_lshlrev_b32 v23, 8, v23
    v_xor_b32 v22, s44, v22
    v_lshlrev_b32 v22, 6, v22
    v_add_u32 v23, v23, v22
    v_and_b32 v22, 3, v1
    v_lshlrev_b32 v22, 4, v22
    v_add_u32 v23, v23, v22
    v_add_u32 v24, 65536, v23
    v_add_u32 v25, 131072, v23
    s_lshl_b32 s47, s44, 10
    s_add_u32 s45, s46, 0x0
    s_add_u32 m0, s47, 0
    s_nop 0
    buffer_load_dwordx4 v21, s[24:27], s45 offen  lds
    s_add_u32 s45, s46, 0x20000
    s_add_u32 m0, s47, 4096
    s_nop 0
    buffer_load_dwordx4 v21, s[24:27], s45 offen  lds
    s_add_u32 s45, s46, 0x40000
    s_add_u32 m0, s47, 8192
    s_nop 0
    buffer_load_dwordx4 v21, s[24:27], s45 offen  lds
    s_add_u32 s45, s46, 0x60000
    s_add_u32 m0, s47, 12288
    s_nop 0
    buffer_load_dwordx4 v21, s[24:27], s45 offen  lds
    s_add_u32 s45, s46, 0x80000
    s_add_u32 m0, s47, 16384
    s_nop 0
    buffer_load_dwordx4 v21, s[24:27], s45 offen  lds
    s_add_u32 s45, s46, 0xa0000
    s_add_u32 m0, s47, 20480
    s_nop 0
    buffer_load_dwordx4 v21, s[24:27], s45 offen  lds
    s_add_u32 s45, s46, 0xc0000
    s_add_u32 m0, s47, 24576
    s_nop 0
    buffer_load_dwordx4 v21, s[24:27], s45 offen  lds
    s_add_u32 s45, s46, 0xe0000
    s_add_u32 m0, s47, 28672
    s_nop 0
    buffer_load_dwordx4 v21, s[24:27], s45 offen  lds
    s_add_u32 s45, s46, 0x100000
    s_add_u32 m0, s47, 32768
    s_nop 0
    buffer_load_dwordx4 v21, s[24:27], s45 offen  lds
    s_add_u32 s45, s46, 0x120000
    s_add_u32 m0, s47, 36864
    s_nop 0
    buffer_load_dwordx4 v21, s[24:27], s45 offen  lds
    s_add_u32 s45, s46, 0x140000
    s_add_u32 m0, s47, 40960
    s_nop 0
    buffer_load_dwordx4 v21, s[24:27], s45 offen  lds
    s_add_u32 s45, s46, 0x160000
    s_add_u32 m0, s47, 45056
    s_nop 0
    buffer_load_dwordx4 v21, s[24:27], s45 offen  lds
    s_add_u32 s45, s46, 0x180000
    s_add_u32 m0, s47, 49152
    s_nop 0
    buffer_load_dwordx4 v21, s[24:27], s45 offen  lds
    s_add_u32 s45, s46, 0x1a0000
    s_add_u32 m0, s47, 53248
    s_nop 0
    buffer_load_dwordx4 v21, s[24:27], s45 offen  lds
    s_add_u32 s45, s46, 0x1c0000
    s_add_u32 m0, s47, 57344
    s_nop 0
    buffer_load_dwordx4 v21, s[24:27], s45 offen  lds
    s_add_u32 s45, s46, 0x1e0000
    s_add_u32 m0, s47, 61440
    s_nop 0
    buffer_load_dwordx4 v21, s[24:27], s45 offen  lds
    s_add_u32 s45, s46, 0x200000
    s_add_u32 m0, s47, 65536
    s_nop 0
    buffer_load_dwordx4 v21, s[24:27], s45 offen  lds
    s_add_u32 s45, s46, 0x220000
    s_add_u32 m0, s47, 69632
    s_nop 0
    buffer_load_dwordx4 v21, s[24:27], s45 offen  lds
    s_add_u32 s45, s46, 0x240000
    s_add_u32 m0, s47, 73728
    s_nop 0
    buffer_load_dwordx4 v21, s[24:27], s45 offen  lds
    s_add_u32 s45, s46, 0x260000
    s_add_u32 m0, s47, 77824
    s_nop 0
    buffer_load_dwordx4 v21, s[24:27], s45 offen  lds
    s_add_u32 s45, s46, 0x280000
    s_add_u32 m0, s47, 81920
    s_nop 0
    buffer_load_dwordx4 v21, s[24:27], s45 offen  lds
    s_add_u32 s45, s46, 0x2a0000
    s_add_u32 m0, s47, 86016
    s_nop 0
    buffer_load_dwordx4 v21, s[24:27], s45 offen  lds
    s_add_u32 s45, s46, 0x2c0000
    s_add_u32 m0, s47, 90112
    s_nop 0
    buffer_load_dwordx4 v21, s[24:27], s45 offen  lds
    s_add_u32 s45, s46, 0x2e0000
    s_add_u32 m0, s47, 94208
    s_nop 0
    buffer_load_dwordx4 v21, s[24:27], s45 offen  lds
    s_add_u32 s45, s46, 0x300000
    s_add_u32 m0, s47, 98304
    s_nop 0
    buffer_load_dwordx4 v21, s[24:27], s45 offen  lds
    s_add_u32 s45, s46, 0x320000
    s_add_u32 m0, s47, 102400
    s_nop 0
    buffer_load_dwordx4 v21, s[24:27], s45 offen  lds
    s_add_u32 s45, s46, 0x340000
    s_add_u32 m0, s47, 106496
    s_nop 0
    buffer_load_dwordx4 v21, s[24:27], s45 offen  lds
    s_add_u32 s45, s46, 0x360000
    s_add_u32 m0, s47, 110592
    s_nop 0
    buffer_load_dwordx4 v21, s[24:27], s45 offen  lds
    s_add_u32 s45, s46, 0x380000
    s_add_u32 m0, s47, 114688
    s_nop 0
    buffer_load_dwordx4 v21, s[24:27], s45 offen  lds
    s_add_u32 s45, s46, 0x3a0000
    s_add_u32 m0, s47, 118784
    s_nop 0
    buffer_load_dwordx4 v21, s[24:27], s45 offen  lds
    s_add_u32 s45, s46, 0x3c0000
    s_add_u32 m0, s47, 122880
    s_nop 0
    buffer_load_dwordx4 v21, s[24:27], s45 offen  lds
    s_add_u32 s45, s46, 0x3e0000
    s_add_u32 m0, s47, 126976
    s_nop 0
    buffer_load_dwordx4 v21, s[24:27], s45 offen  lds
    s_waitcnt vmcnt(28)
    s_barrier
    s_add_u32 s45, s46, 0x400000
    s_add_u32 m0, s47, 131072
    s_nop 0
    buffer_load_dwordx4 v21, s[24:27], s45 offen  lds
    s_add_u32 s45, s46, 0x420000
    s_add_u32 m0, s47, 135168
    s_nop 0
    buffer_load_dwordx4 v21, s[24:27], s45 offen  lds
    s_add_u32 s45, s46, 0x440000
    s_add_u32 m0, s47, 139264
    s_nop 0
    buffer_load_dwordx4 v21, s[24:27], s45 offen  lds
    s_add_u32 s45, s46, 0x460000
    s_add_u32 m0, s47, 143360
    s_nop 0
    buffer_load_dwordx4 v21, s[24:27], s45 offen  lds
    ds_read_b64_tr_b16 a[0:1], v23 offset:0
    ds_read_b64_tr_b16 a[2:3], v23 offset:1024
    ds_read_b64_tr_b16 a[4:5], v23 offset:8
    ds_read_b64_tr_b16 a[6:7], v23 offset:1032
    ds_read_b64_tr_b16 a[8:9], v23 offset:8192
    ds_read_b64_tr_b16 a[10:11], v23 offset:9216
    ds_read_b64_tr_b16 a[12:13], v23 offset:8200
    ds_read_b64_tr_b16 a[14:15], v23 offset:9224
    s_waitcnt lgkmcnt(0)
    s_waitcnt vmcnt(28)
    s_barrier
    s_add_u32 s45, s46, 0x480000
    s_add_u32 m0, s47, 0
    s_nop 0
    buffer_load_dwordx4 v21, s[24:27], s45 offen  lds
    s_add_u32 s45, s46, 0x4a0000
    s_add_u32 m0, s47, 4096
    s_nop 0
    buffer_load_dwordx4 v21, s[24:27], s45 offen  lds
    s_add_u32 s45, s46, 0x4c0000
    s_add_u32 m0, s47, 8192
    s_nop 0
    buffer_load_dwordx4 v21, s[24:27], s45 offen  lds
    s_add_u32 s45, s46, 0x4e0000
    s_add_u32 m0, s47, 12288
    s_nop 0
    buffer_load_dwordx4 v21, s[24:27], s45 offen  lds
    ds_read_b64_tr_b16 a[16:17], v23 offset:16384
    ds_read_b64_tr_b16 a[18:19], v23 offset:17408
    ds_read_b64_tr_b16 a[20:21], v23 offset:16392
    ds_read_b64_tr_b16 a[22:23], v23 offset:17416
    ds_read_b64_tr_b16 a[24:25], v23 offset:24576
    ds_read_b64_tr_b16 a[26:27], v23 offset:25600
    ds_read_b64_tr_b16 a[28:29], v23 offset:24584
    ds_read_b64_tr_b16 a[30:31], v23 offset:25608
    s_waitcnt lgkmcnt(0)
    s_waitcnt vmcnt(28)
    s_barrier
    s_add_u32 s45, s46, 0x500000
    s_add_u32 m0, s47, 16384
    s_nop 0
    buffer_load_dwordx4 v21, s[24:27], s45 offen  lds
    s_add_u32 s45, s46, 0x520000
    s_add_u32 m0, s47, 20480
    s_nop 0
    buffer_load_dwordx4 v21, s[24:27], s45 offen  lds
    s_add_u32 s45, s46, 0x540000
    s_add_u32 m0, s47, 24576
    s_nop 0
    buffer_load_dwordx4 v21, s[24:27], s45 offen  lds
    s_add_u32 s45, s46, 0x560000
    s_add_u32 m0, s47, 28672
    s_nop 0
    buffer_load_dwordx4 v21, s[24:27], s45 offen  lds
    ds_read_b64_tr_b16 a[32:33], v23 offset:32768
    ds_read_b64_tr_b16 a[34:35], v23 offset:33792
    ds_read_b64_tr_b16 a[36:37], v23 offset:32776
    ds_read_b64_tr_b16 a[38:39], v23 offset:33800
    ds_read_b64_tr_b16 a[40:41], v23 offset:40960
    ds_read_b64_tr_b16 a[42:43], v23 offset:41984
    ds_read_b64_tr_b16 a[44:45], v23 offset:40968
    ds_read_b64_tr_b16 a[46:47], v23 offset:41992
    s_waitcnt lgkmcnt(0)
    s_waitcnt vmcnt(28)
    s_barrier
    s_add_u32 s45, s46, 0x580000
    s_add_u32 m0, s47, 32768
    s_nop 0
    buffer_load_dwordx4 v21, s[24:27], s45 offen  lds
    s_add_u32 s45, s46, 0x5a0000
    s_add_u32 m0, s47, 36864
    s_nop 0
    buffer_load_dwordx4 v21, s[24:27], s45 offen  lds
    s_add_u32 s45, s46, 0x5c0000
    s_add_u32 m0, s47, 40960
    s_nop 0
    buffer_load_dwordx4 v21, s[24:27], s45 offen  lds
    s_add_u32 s45, s46, 0x5e0000
    s_add_u32 m0, s47, 45056
    s_nop 0
    buffer_load_dwordx4 v21, s[24:27], s45 offen  lds
    ds_read_b64_tr_b16 a[48:49], v23 offset:49152
    ds_read_b64_tr_b16 a[50:51], v23 offset:50176
    ds_read_b64_tr_b16 a[52:53], v23 offset:49160
    ds_read_b64_tr_b16 a[54:55], v23 offset:50184
    ds_read_b64_tr_b16 a[56:57], v23 offset:57344
    ds_read_b64_tr_b16 a[58:59], v23 offset:58368
    ds_read_b64_tr_b16 a[60:61], v23 offset:57352
    ds_read_b64_tr_b16 a[62:63], v23 offset:58376
    s_waitcnt lgkmcnt(0)
    s_waitcnt vmcnt(28)
    s_barrier
    s_add_u32 s45, s46, 0x600000
    s_add_u32 m0, s47, 49152
    s_nop 0
    buffer_load_dwordx4 v21, s[24:27], s45 offen  lds
    s_add_u32 s45, s46, 0x620000
    s_add_u32 m0, s47, 53248
    s_nop 0
    buffer_load_dwordx4 v21, s[24:27], s45 offen  lds
    s_add_u32 s45, s46, 0x640000
    s_add_u32 m0, s47, 57344
    s_nop 0
    buffer_load_dwordx4 v21, s[24:27], s45 offen  lds
    s_add_u32 s45, s46, 0x660000
    s_add_u32 m0, s47, 61440
    s_nop 0
    buffer_load_dwordx4 v21, s[24:27], s45 offen  lds
    ds_read_b64_tr_b16 a[64:65], v24 offset:0
    ds_read_b64_tr_b16 a[66:67], v24 offset:1024
    ds_read_b64_tr_b16 a[68:69], v24 offset:8
    ds_read_b64_tr_b16 a[70:71], v24 offset:1032
    ds_read_b64_tr_b16 a[72:73], v24 offset:8192
    ds_read_b64_tr_b16 a[74:75], v24 offset:9216
    ds_read_b64_tr_b16 a[76:77], v24 offset:8200
    ds_read_b64_tr_b16 a[78:79], v24 offset:9224
    s_waitcnt lgkmcnt(0)
    s_waitcnt vmcnt(28)
    s_barrier
    s_add_u32 s45, s46, 0x680000
    s_add_u32 m0, s47, 65536
    s_nop 0
    buffer_load_dwordx4 v21, s[24:27], s45 offen  lds
    s_add_u32 s45, s46, 0x6a0000
    s_add_u32 m0, s47, 69632
    s_nop 0
    buffer_load_dwordx4 v21, s[24:27], s45 offen  lds
    s_add_u32 s45, s46, 0x6c0000
    s_add_u32 m0, s47, 73728
    s_nop 0
    buffer_load_dwordx4 v21, s[24:27], s45 offen  lds
    s_add_u32 s45, s46, 0x6e0000
    s_add_u32 m0, s47, 77824
    s_nop 0
    buffer_load_dwordx4 v21, s[24:27], s45 offen  lds
    ds_read_b64_tr_b16 a[80:81], v24 offset:16384
    ds_read_b64_tr_b16 a[82:83], v24 offset:17408
    ds_read_b64_tr_b16 a[84:85], v24 offset:16392
    ds_read_b64_tr_b16 a[86:87], v24 offset:17416
    ds_read_b64_tr_b16 a[88:89], v24 offset:24576
    ds_read_b64_tr_b16 a[90:91], v24 offset:25600
    ds_read_b64_tr_b16 a[92:93], v24 offset:24584
    ds_read_b64_tr_b16 a[94:95], v24 offset:25608
    s_waitcnt lgkmcnt(0)
    s_waitcnt vmcnt(28)
    s_barrier
    s_add_u32 s45, s46, 0x700000
    s_add_u32 m0, s47, 81920
    s_nop 0
    buffer_load_dwordx4 v21, s[24:27], s45 offen  lds
    s_add_u32 s45, s46, 0x720000
    s_add_u32 m0, s47, 86016
    s_nop 0
    buffer_load_dwordx4 v21, s[24:27], s45 offen  lds
    s_add_u32 s45, s46, 0x740000
    s_add_u32 m0, s47, 90112
    s_nop 0
    buffer_load_dwordx4 v21, s[24:27], s45 offen  lds
    s_add_u32 s45, s46, 0x760000
    s_add_u32 m0, s47, 94208
    s_nop 0
    buffer_load_dwordx4 v21, s[24:27], s45 offen  lds
    ds_read_b64_tr_b16 a[96:97], v24 offset:32768
    ds_read_b64_tr_b16 a[98:99], v24 offset:33792
    ds_read_b64_tr_b16 a[100:101], v24 offset:32776
    ds_read_b64_tr_b16 a[102:103], v24 offset:33800
    ds_read_b64_tr_b16 a[104:105], v24 offset:40960
    ds_read_b64_tr_b16 a[106:107], v24 offset:41984
    ds_read_b64_tr_b16 a[108:109], v24 offset:40968
    ds_read_b64_tr_b16 a[110:111], v24 offset:41992
    s_waitcnt lgkmcnt(0)
    s_waitcnt vmcnt(28)
    s_barrier
    s_add_u32 s45, s46, 0x780000
    s_add_u32 m0, s47, 98304
    s_nop 0
    buffer_load_dwordx4 v21, s[24:27], s45 offen  lds
    s_add_u32 s45, s46, 0x7a0000
    s_add_u32 m0, s47, 102400
    s_nop 0
    buffer_load_dwordx4 v21, s[24:27], s45 offen  lds
    s_add_u32 s45, s46, 0x7c0000
    s_add_u32 m0, s47, 106496
    s_nop 0
    buffer_load_dwordx4 v21, s[24:27], s45 offen  lds
    s_add_u32 s45, s46, 0x7e0000
    s_add_u32 m0, s47, 110592
    s_nop 0
    buffer_load_dwordx4 v21, s[24:27], s45 offen  lds
    ds_read_b64_tr_b16 a[112:113], v24 offset:49152
    ds_read_b64_tr_b16 a[114:115], v24 offset:50176
    ds_read_b64_tr_b16 a[116:117], v24 offset:49160
    ds_read_b64_tr_b16 a[118:119], v24 offset:50184
    ds_read_b64_tr_b16 a[120:121], v24 offset:57344
    ds_read_b64_tr_b16 a[122:123], v24 offset:58368
    ds_read_b64_tr_b16 a[124:125], v24 offset:57352
    ds_read_b64_tr_b16 a[126:127], v24 offset:58376
    s_waitcnt lgkmcnt(0)
    s_waitcnt vmcnt(28)
    s_barrier
    ds_read_b64_tr_b16 a[128:129], v25 offset:0
    ds_read_b64_tr_b16 a[130:131], v25 offset:1024
    ds_read_b64_tr_b16 a[132:133], v25 offset:8
    ds_read_b64_tr_b16 a[134:135], v25 offset:1032
    ds_read_b64_tr_b16 a[136:137], v25 offset:8192
    ds_read_b64_tr_b16 a[138:139], v25 offset:9216
    ds_read_b64_tr_b16 a[140:141], v25 offset:8200
    ds_read_b64_tr_b16 a[142:143], v25 offset:9224
    s_waitcnt lgkmcnt(0)
    s_waitcnt vmcnt(24)
    s_barrier
    ds_read_b64_tr_b16 a[144:145], v23 offset:0
    ds_read_b64_tr_b16 a[146:147], v23 offset:1024
    ds_read_b64_tr_b16 a[148:149], v23 offset:8
    ds_read_b64_tr_b16 a[150:151], v23 offset:1032
    ds_read_b64_tr_b16 a[152:153], v23 offset:8192
    ds_read_b64_tr_b16 a[154:155], v23 offset:9216
    ds_read_b64_tr_b16 a[156:157], v23 offset:8200
    ds_read_b64_tr_b16 a[158:159], v23 offset:9224
    s_waitcnt lgkmcnt(0)
    s_waitcnt vmcnt(20)
    s_barrier
    ds_read_b64_tr_b16 a[160:161], v23 offset:16384
    ds_read_b64_tr_b16 a[162:163], v23 offset:17408
    ds_read_b64_tr_b16 a[164:165], v23 offset:16392
    ds_read_b64_tr_b16 a[166:167], v23 offset:17416
    ds_read_b64_tr_b16 a[168:169], v23 offset:24576
    ds_read_b64_tr_b16 a[170:171], v23 offset:25600
    ds_read_b64_tr_b16 a[172:173], v23 offset:24584
    ds_read_b64_tr_b16 a[174:175], v23 offset:25608
    s_waitcnt lgkmcnt(0)
    s_waitcnt vmcnt(16)
    s_barrier
    ds_read_b64_tr_b16 a[176:177], v23 offset:32768
    ds_read_b64_tr_b16 a[178:179], v23 offset:33792
    ds_read_b64_tr_b16 a[180:181], v23 offset:32776
    ds_read_b64_tr_b16 a[182:183], v23 offset:33800
    ds_read_b64_tr_b16 a[184:185], v23 offset:40960
    ds_read_b64_tr_b16 a[186:187], v23 offset:41984
    ds_read_b64_tr_b16 a[188:189], v23 offset:40968
    ds_read_b64_tr_b16 a[190:191], v23 offset:41992
    s_waitcnt lgkmcnt(0)
    s_waitcnt vmcnt(12)
    s_barrier
    ds_read_b64_tr_b16 a[192:193], v23 offset:49152
    ds_read_b64_tr_b16 a[194:195], v23 offset:50176
    ds_read_b64_tr_b16 a[196:197], v23 offset:49160
    ds_read_b64_tr_b16 a[198:199], v23 offset:50184
    ds_read_b64_tr_b16 a[200:201], v23 offset:57344
    ds_read_b64_tr_b16 a[202:203], v23 offset:58368
    ds_read_b64_tr_b16 a[204:205], v23 offset:57352
    ds_read_b64_tr_b16 a[206:207], v23 offset:58376
    s_waitcnt lgkmcnt(0)
    s_waitcnt vmcnt(8)
    s_barrier
    ds_read_b64_tr_b16 a[208:209], v24 offset:0
    ds_read_b64_tr_b16 a[210:211], v24 offset:1024
    ds_read_b64_tr_b16 a[212:213], v24 offset:8
    ds_read_b64_tr_b16 a[214:215], v24 offset:1032
    ds_read_b64_tr_b16 a[216:217], v24 offset:8192
    ds_read_b64_tr_b16 a[218:219], v24 offset:9216
    ds_read_b64_tr_b16 a[220:221], v24 offset:8200
    ds_read_b64_tr_b16 a[222:223], v24 offset:9224
    s_waitcnt lgkmcnt(0)
    s_waitcnt vmcnt(4)
    s_barrier
    ds_read_b64_tr_b16 a[224:225], v24 offset:16384
    ds_read_b64_tr_b16 a[226:227], v24 offset:17408
    ds_read_b64_tr_b16 a[228:229], v24 offset:16392
    ds_read_b64_tr_b16 a[230:231], v24 offset:17416
    ds_read_b64_tr_b16 a[232:233], v24 offset:24576
    ds_read_b64_tr_b16 a[234:235], v24 offset:25600
    ds_read_b64_tr_b16 a[236:237], v24 offset:24584
    ds_read_b64_tr_b16 a[238:239], v24 offset:25608
    s_waitcnt lgkmcnt(0)
    s_waitcnt vmcnt(0)
    s_barrier
    ds_read_b64_tr_b16 a[240:241], v24 offset:32768
    ds_read_b64_tr_b16 a[242:243], v24 offset:33792
    ds_read_b64_tr_b16 a[244:245], v24 offset:32776
    ds_read_b64_tr_b16 a[246:247], v24 offset:33800
    ds_read_b64_tr_b16 a[248:249], v24 offset:40960
    ds_read_b64_tr_b16 a[250:251], v24 offset:41984
    ds_read_b64_tr_b16 a[252:253], v24 offset:40968
    ds_read_b64_tr_b16 a[254:255], v24 offset:41992
    s_waitcnt lgkmcnt(0)
    s_barrier
    s_mov_b32 s60, 0
    s_mov_b32 s51, 1
    s_mov_b32 s71, 64
    s_mov_b32 s52, 0x400000
    s_lshl_b32 s56, s39, 19
    s_add_u32 s56, s56, 0x2000000
L_w_qkv_113:
    s_cmp_lg_u32 s44, 0
    s_cbranch_scc1 L_pd_114
    v_mov_b32 v29, s71
    s_mov_b32 s46, 96
    s_mov_b64 exec, 1
    s_mov_b32 s70, 0
L_wp_115:
    buffer_load_dword v31, v29, s[16:19], 0 offen sc1
    s_add_u32 s70, s70, 1
    s_cmp_ge_u32 s70, 0x200000
    s_cbranch_scc1 L_w_done_101
    s_waitcnt vmcnt(0)
    v_cmp_gt_u32 vcc, s46, v31
    s_nop 1
    s_cbranch_vccz L_wp_115_ok
    s_sleep 3
    s_branch L_wp_115
L_wp_115_ok:
    s_mov_b64 exec, -1
L_pd_114:
    s_barrier
    s_mov_b32 s50, s60
    s_mul_i32 s53, s50, 65536
    s_add_u32 s53, s53, s52
    s_lshl_b32 s54, s44, 13
    s_add_u32 s53, s53, s54
    s_mul_i32 s57, s50, 8192
    s_add_u32 s57, s57, s56
    s_lshl_b32 s45, s44, 11
    s_add_u32 s57, s57, s45
    s_add_u32 s55, s54, 65536
    s_mov_b32 s58, 0
    v_mov_b32 v13, v3
    v_add_u32 v14, 65536, v13
    v_xor_b32 v15, 64, v13
    v_xor_b32 v16, 64, v14
    s_mov_b32 s76, 0x20000000
    s_add_u32 s48, s53, 0
    s_add_u32 s49, s48, 4096
    s_add_u32 m0, s54, 0
    s_nop 0
    buffer_load_dwordx4 v6, s[12:15], s48 offen offset:0 sc1 lds
    s_add_u32 m0, s54, 1024
    s_nop 0
    buffer_load_dwordx4 v9, s[12:15], s48 offen offset:0 sc1 lds
    s_add_u32 m0, s54, 2048
    s_nop 0
    buffer_load_dwordx4 v6, s[12:15], s49 offen offset:0 sc1 lds
    s_add_u32 m0, s54, 3072
    s_nop 0
    buffer_load_dwordx4 v9, s[12:15], s49 offen offset:0 sc1 lds
    s_add_u32 m0, s54, 3968
    s_nop 0
    buffer_load_dwordx4 v6, s[12:15], s48 offen offset:128 sc1 lds
    s_add_u32 m0, s54, 4992
    s_nop 0
    buffer_load_dwordx4 v9, s[12:15], s48 offen offset:128 sc1 lds
    s_add_u32 m0, s54, 6016
    s_nop 0
    buffer_load_dwordx4 v6, s[12:15], s49 offen offset:128 sc1 lds
    s_add_u32 m0, s54, 7040
    s_nop 0
    buffer_load_dwordx4 v9, s[12:15], s49 offen offset:128 sc1 lds
    s_add_u32 s48, s53, 32768
    s_add_u32 s49, s48, 4096
    s_add_u32 s46, s54, 32768
    s_add_u32 m0, s46, 0
    s_nop 0
    buffer_load_dwordx4 v6, s[12:15], s48 offen offset:0 sc1 lds
    s_add_u32 m0, s46, 1024
    s_nop 0
    buffer_load_dwordx4 v9, s[12:15], s48 offen offset:0 sc1 lds
    s_add_u32 m0, s46, 2048
    s_nop 0
    buffer_load_dwordx4 v6, s[12:15], s49 offen offset:0 sc1 lds
    s_add_u32 m0, s46, 3072
    s_nop 0
    buffer_load_dwordx4 v9, s[12:15], s49 offen offset:0 sc1 lds
    s_add_u32 m0, s46, 3968
    s_nop 0
    buffer_load_dwordx4 v6, s[12:15], s48 offen offset:128 sc1 lds
    s_add_u32 m0, s46, 4992
    s_nop 0
    buffer_load_dwordx4 v9, s[12:15], s48 offen offset:128 sc1 lds
    s_add_u32 m0, s46, 6016
    s_nop 0
    buffer_load_dwordx4 v6, s[12:15], s49 offen offset:128 sc1 lds
    s_add_u32 m0, s46, 7040
    s_nop 0
    buffer_load_dwordx4 v9, s[12:15], s49 offen offset:128 sc1 lds
    s_cmp_eq_u32 s51, 1
    s_cbranch_scc1 L_e_one_117
    s_add_u32 s48, s53, 65536
    s_add_u32 s49, s48, 4096
    s_add_u32 m0, s55, 0
    s_nop 0
    buffer_load_dwordx4 v6, s[12:15], s48 offen offset:0 sc1 lds
    s_add_u32 m0, s55, 1024
    s_nop 0
    buffer_load_dwordx4 v9, s[12:15], s48 offen offset:0 sc1 lds
    s_add_u32 m0, s55, 2048
    s_nop 0
    buffer_load_dwordx4 v6, s[12:15], s49 offen offset:0 sc1 lds
    s_add_u32 m0, s55, 3072
    s_nop 0
    buffer_load_dwordx4 v9, s[12:15], s49 offen offset:0 sc1 lds
    s_add_u32 m0, s55, 3968
    s_nop 0
    buffer_load_dwordx4 v6, s[12:15], s48 offen offset:128 sc1 lds
    s_add_u32 m0, s55, 4992
    s_nop 0
    buffer_load_dwordx4 v9, s[12:15], s48 offen offset:128 sc1 lds
    s_add_u32 m0, s55, 6016
    s_nop 0
    buffer_load_dwordx4 v6, s[12:15], s49 offen offset:128 sc1 lds
    s_add_u32 m0, s55, 7040
    s_nop 0
    buffer_load_dwordx4 v9, s[12:15], s49 offen offset:128 sc1 lds
    s_waitcnt vmcnt(16)
    s_barrier
    ds_read_b128 v[32:35], v13 offset:0
    ds_read_b128 v[36:39], v13 offset:2048
    ds_read_b128 v[40:43], v15 offset:0
    ds_read_b128 v[44:47], v15 offset:2048
L_e_loop_116:
    s_add_u32 s48, s53, 98304
    s_add_u32 s46, s58, 1
    s_cmp_lt_u32 s46, s51
    s_cselect_b32 s48, s48, 0x20000000
    s_add_u32 s49, s48, 4096
    s_add_u32 s59, s55, 32768
    s_waitcnt lgkmcnt(2)
    v_mfma_f32_16x16x32_bf16 v[80:83], a[0:3], v[32:35], 0
    ds_read_b128 v[48:51], v13 offset:4096
    ds_read_b128 v[52:55], v13 offset:6144
    v_mfma_f32_16x16x32_bf16 v[84:87], a[4:7], v[32:35], 0
    ds_read_b128 v[56:59], v15 offset:4096
    ds_read_b128 v[60:63], v15 offset:6144
    v_mfma_f32_16x16x32_bf16 v[88:91], a[0:3], v[36:39], 0
    s_add_u32 m0, s59, 0
    s_nop 0
    buffer_load_dwordx4 v6, s[12:15], s48 offen offset:0 sc1 lds
    v_mfma_f32_16x16x32_bf16 v[92:95], a[4:7], v[36:39], 0
    s_waitcnt lgkmcnt(4)
    v_mfma_f32_16x16x32_bf16 v[80:83], a[8:11], v[40:43], v[80:83]
    ds_read_b128 v[32:35], v13 offset:8192
    ds_read_b128 v[36:39], v13 offset:10240
    v_mfma_f32_16x16x32_bf16 v[84:87], a[12:15], v[40:43], v[84:87]
    v_mfma_f32_16x16x32_bf16 v[88:91], a[8:11], v[44:47], v[88:91]
    s_add_u32 m0, s59, 1024
    s_nop 0
    buffer_load_dwordx4 v9, s[12:15], s48 offen offset:0 sc1 lds
    v_mfma_f32_16x16x32_bf16 v[92:95], a[12:15], v[44:47], v[92:95]
    s_waitcnt lgkmcnt(4)
    v_mfma_f32_16x16x32_bf16 v[80:83], a[16:19], v[48:51], v[80:83]
    ds_read_b128 v[40:43], v15 offset:8192
    ds_read_b128 v[44:47], v15 offset:10240
    v_mfma_f32_16x16x32_bf16 v[84:87], a[20:23], v[48:51], v[84:87]
    v_mfma_f32_16x16x32_bf16 v[88:91], a[16:19], v[52:55], v[88:91]
    s_add_u32 m0, s59, 2048
    s_nop 0
    buffer_load_dwordx4 v6, s[12:15], s49 offen offset:0 sc1 lds
    v_mfma_f32_16x16x32_bf16 v[92:95], a[20:23], v[52:55], v[92:95]
    s_waitcnt lgkmcnt(4)
    v_mfma_f32_16x16x32_bf16 v[80:83], a[24:27], v[56:59], v[80:83]
    ds_read_b128 v[48:51], v13 offset:12288
    ds_read_b128 v[52:55], v13 offset:14336
    v_mfma_f32_16x16x32_bf16 v[84:87], a[28:31], v[56:59], v[84:87]
    v_mfma_f32_16x16x32_bf16 v[88:91], a[24:27], v[60:63], v[88:91]
    s_add_u32 m0, s59, 3072
    s_nop 0
    buffer_load_dwordx4 v9, s[12:15], s49 offen offset:0 sc1 lds
    v_mfma_f32_16x16x32_bf16 v[92:95], a[28:31], v[60:63], v[92:95]
    s_waitcnt lgkmcnt(4)
    v_mfma_f32_16x16x32_bf16 v[80:83], a[32:35], v[32:35], v[80:83]
    ds_read_b128 v[56:59], v15 offset:12288
    ds_read_b128 v[60:63], v15 offset:14336
    v_mfma_f32_16x16x32_bf16 v[84:87], a[36:39], v[32:35], v[84:87]
    v_mfma_f32_16x16x32_bf16 v[88:91], a[32:35], v[36:39], v[88:91]
    s_add_u32 m0, s59, 3968
    s_nop 0
    buffer_load_dwordx4 v6, s[12:15], s48 offen offset:128 sc1 lds
    v_mfma_f32_16x16x32_bf16 v[92:95], a[36:39], v[36:39], v[92:95]
    s_waitcnt lgkmcnt(4)
    v_mfma_f32_16x16x32_bf16 v[80:83], a[40:43], v[40:43], v[80:83]
    ds_read_b128 v[32:35], v13 offset:16384
    ds_read_b128 v[36:39], v13 offset:18432
    v_mfma_f32_16x16x32_bf16 v[84:87], a[44:47], v[40:43], v[84:87]
    v_mfma_f32_16x16x32_bf16 v[88:91], a[40:43], v[44:47], v[88:91]
    s_add_u32 m0, s59, 4992
    s_nop 0
    buffer_load_dwordx4 v9, s[12:15], s48 offen offset:128 sc1 lds
    v_mfma_f32_16x16x32_bf16 v[92:95], a[44:47], v[44:47], v[92:95]
    s_waitcnt lgkmcnt(4)
    v_mfma_f32_16x16x32_bf16 v[80:83], a[48:51], v[48:51], v[80:83]
    ds_read_b128 v[40:43], v15 offset:16384
    ds_read_b128 v[44:47], v15 offset:18432
    v_mfma_f32_16x16x32_bf16 v[84:87], a[52:55], v[48:51], v[84:87]
    v_mfma_f32_16x16x32_bf16 v[88:91], a[48:51], v[52:55], v[88:91]
    s_add_u32 m0, s59, 6016
    s_nop 0
    buffer_load_dwordx4 v6, s[12:15], s49 offen offset:128 sc1 lds
    v_mfma_f32_16x16x32_bf16 v[92:95], a[52:55], v[52:55], v[92:95]
    s_waitcnt lgkmcnt(4)
    v_mfma_f32_16x16x32_bf16 v[80:83], a[56:59], v[56:59], v[80:83]
    ds_read_b128 v[48:51], v13 offset:20480
    ds_read_b128 v[52:55], v13 offset:22528
    v_mfma_f32_16x16x32_bf16 v[84:87], a[60:63], v[56:59], v[84:87]
    v_mfma_f32_16x16x32_bf16 v[88:91], a[56:59], v[60:63], v[88:91]
    s_add_u32 m0, s59, 7040
    s_nop 0
    buffer_load_dwordx4 v9, s[12:15], s49 offen offset:128 sc1 lds
    v_mfma_f32_16x16x32_bf16 v[92:95], a[60:63], v[60:63], v[92:95]
    s_waitcnt lgkmcnt(4)
    v_mfma_f32_16x16x32_bf16 v[80:83], a[64:67], v[32:35], v[80:83]
    ds_read_b128 v[56:59], v15 offset:20480
    ds_read_b128 v[60:63], v15 offset:22528
    v_mfma_f32_16x16x32_bf16 v[84:87], a[68:71], v[32:35], v[84:87]
    v_mfma_f32_16x16x32_bf16 v[88:91], a[64:67], v[36:39], v[88:91]
    v_mfma_f32_16x16x32_bf16 v[92:95], a[68:71], v[36:39], v[92:95]
    s_waitcnt lgkmcnt(4)
    v_mfma_f32_16x16x32_bf16 v[80:83], a[72:75], v[40:43], v[80:83]
    ds_read_b128 v[32:35], v13 offset:24576
    ds_read_b128 v[36:39], v13 offset:26624
    v_mfma_f32_16x16x32_bf16 v[84:87], a[76:79], v[40:43], v[84:87]
    v_mfma_f32_16x16x32_bf16 v[88:91], a[72:75], v[44:47], v[88:91]
    v_mfma_f32_16x16x32_bf16 v[92:95], a[76:79], v[44:47], v[92:95]
    s_waitcnt lgkmcnt(4)
    v_mfma_f32_16x16x32_bf16 v[80:83], a[80:83], v[48:51], v[80:83]
    ds_read_b128 v[40:43], v15 offset:24576
    ds_read_b128 v[44:47], v15 offset:26624
    v_mfma_f32_16x16x32_bf16 v[84:87], a[84:87], v[48:51], v[84:87]
    v_mfma_f32_16x16x32_bf16 v[88:91], a[80:83], v[52:55], v[88:91]
    v_mfma_f32_16x16x32_bf16 v[92:95], a[84:87], v[52:55], v[92:95]
    s_waitcnt lgkmcnt(4)
    v_mfma_f32_16x16x32_bf16 v[80:83], a[88:91], v[56:59], v[80:83]
    ds_read_b128 v[48:51], v13 offset:28672
    ds_read_b128 v[52:55], v13 offset:30720
    v_mfma_f32_16x16x32_bf16 v[84:87], a[92:95], v[56:59], v[84:87]
    v_mfma_f32_16x16x32_bf16 v[88:91], a[88:91], v[60:63], v[88:91]
    v_mfma_f32_16x16x32_bf16 v[92:95], a[92:95], v[60:63], v[92:95]
    s_waitcnt lgkmcnt(4)
    v_mfma_f32_16x16x32_bf16 v[80:83], a[96:99], v[32:35], v[80:83]
    ds_read_b128 v[56:59], v15 offset:28672
    ds_read_b128 v[60:63], v15 offset:30720
    v_mfma_f32_16x16x32_bf16 v[84:87], a[100:103], v[32:35], v[84:87]
    v_mfma_f32_16x16x32_bf16 v[88:91], a[96:99], v[36:39], v[88:91]
    v_mfma_f32_16x16x32_bf16 v[92:95], a[100:103], v[36:39], v[92:95]
    s_waitcnt lgkmcnt(4)
    v_mfma_f32_16x16x32_bf16 v[80:83], a[104:107], v[40:43], v[80:83]
    v_mfma_f32_16x16x32_bf16 v[84:87], a[108:111], v[40:43], v[84:87]
    v_mfma_f32_16x16x32_bf16 v[88:91], a[104:107], v[44:47], v[88:91]
    v_mfma_f32_16x16x32_bf16 v[92:95], a[108:111], v[44:47], v[92:95]
    s_waitcnt vmcnt(16) lgkmcnt(0)
    s_barrier
    v_mfma_f32_16x16x32_bf16 v[80:83], a[112:115], v[48:51], v[80:83]
    ds_read_b128 v[32:35], v13 offset:32768
    ds_read_b128 v[36:39], v13 offset:34816
    v_mfma_f32_16x16x32_bf16 v[84:87], a[116:119], v[48:51], v[84:87]
    v_mfma_f32_16x16x32_bf16 v[88:91], a[112:115], v[52:55], v[88:91]
    v_mfma_f32_16x16x32_bf16 v[92:95], a[116:119], v[52:55], v[92:95]
    v_mfma_f32_16x16x32_bf16 v[80:83], a[120:123], v[56:59], v[80:83]
    ds_read_b128 v[40:43], v15 offset:32768
    ds_read_b128 v[44:47], v15 offset:34816
    v_mfma_f32_16x16x32_bf16 v[84:87], a[124:127], v[56:59], v[84:87]
    v_mfma_f32_16x16x32_bf16 v[88:91], a[120:123], v[60:63], v[88:91]
    v_mfma_f32_16x16x32_bf16 v[92:95], a[124:127], v[60:63], v[92:95]
    s_add_u32 s48, s53, 131072
    s_add_u32 s46, s58, 2
    s_cmp_lt_u32 s46, s51
    s_cselect_b32 s48, s48, 0x20000000
    s_add_u32 s49, s48, 4096
    s_mov_b32 s59, s54
    s_waitcnt lgkmcnt(2)
    v_mfma_f32_16x16x32_bf16 v[80:83], a[128:131], v[32:35], v[80:83]
    ds_read_b128 v[48:51], v13 offset:36864
    ds_read_b128 v[52:55], v13 offset:38912
    v_mfma_f32_16x16x32_bf16 v[84:87], a[132:135], v[32:35], v[84:87]
    ds_read_b128 v[56:59], v15 offset:36864
    ds_read_b128 v[60:63], v15 offset:38912
    v_mfma_f32_16x16x32_bf16 v[88:91], a[128:131], v[36:39], v[88:91]
    s_add_u32 m0, s59, 0
    s_nop 0
    buffer_load_dwordx4 v6, s[12:15], s48 offen offset:0 sc1 lds
    v_mfma_f32_16x16x32_bf16 v[92:95], a[132:135], v[36:39], v[92:95]
    s_waitcnt lgkmcnt(4)
    v_mfma_f32_16x16x32_bf16 v[80:83], a[136:139], v[40:43], v[80:83]
    ds_read_b128 v[32:35], v13 offset:40960
    ds_read_b128 v[36:39], v13 offset:43008
    v_mfma_f32_16x16x32_bf16 v[84:87], a[140:143], v[40:43], v[84:87]
    v_mfma_f32_16x16x32_bf16 v[88:91], a[136:139], v[44:47], v[88:91]
    s_add_u32 m0, s59, 1024
    s_nop 0
    buffer_load_dwordx4 v9, s[12:15], s48 offen offset:0 sc1 lds
    v_mfma_f32_16x16x32_bf16 v[92:95], a[140:143], v[44:47], v[92:95]
    s_waitcnt lgkmcnt(4)
    v_mfma_f32_16x16x32_bf16 v[80:83], a[144:147], v[48:51], v[80:83]
    ds_read_b128 v[40:43], v15 offset:40960
    ds_read_b128 v[44:47], v15 offset:43008
    v_mfma_f32_16x16x32_bf16 v[84:87], a[148:151], v[48:51], v[84:87]
    v_mfma_f32_16x16x32_bf16 v[88:91], a[144:147], v[52:55], v[88:91]
    s_add_u32 m0, s59, 2048
    s_nop 0
    buffer_load_dwordx4 v6, s[12:15], s49 offen offset:0 sc1 lds
    v_mfma_f32_16x16x32_bf16 v[92:95], a[148:151], v[52:55], v[92:95]
    s_waitcnt lgkmcnt(4)
    v_mfma_f32_16x16x32_bf16 v[80:83], a[152:155], v[56:59], v[80:83]
    ds_read_b128 v[48:51], v13 offset:45056
    ds_read_b128 v[52:55], v13 offset:47104
    v_mfma_f32_16x16x32_bf16 v[84:87], a[156:159], v[56:59], v[84:87]
    v_mfma_f32_16x16x32_bf16 v[88:91], a[152:155], v[60:63], v[88:91]
    s_add_u32 m0, s59, 3072
    s_nop 0
    buffer_load_dwordx4 v9, s[12:15], s49 offen offset:0 sc1 lds
    v_mfma_f32_16x16x32_bf16 v[92:95], a[156:159], v[60:63], v[92:95]
    s_waitcnt lgkmcnt(4)
    v_mfma_f32_16x16x32_bf16 v[80:83], a[160:163], v[32:35], v[80:83]
    ds_read_b128 v[56:59], v15 offset:45056
    ds_read_b128 v[60:63], v15 offset:47104
    v_mfma_f32_16x16x32_bf16 v[84:87], a[164:167], v[32:35], v[84:87]
    v_mfma_f32_16x16x32_bf16 v[88:91], a[160:163], v[36:39], v[88:91]
    s_add_u32 m0, s59, 3968
    s_nop 0
    buffer_load_dwordx4 v6, s[12:15], s48 offen offset:128 sc1 lds
    v_mfma_f32_16x16x32_bf16 v[92:95], a[164:167], v[36:39], v[92:95]
    s_waitcnt lgkmcnt(4)
    v_mfma_f32_16x16x32_bf16 v[80:83], a[168:171], v[40:43], v[80:83]
    ds_read_b128 v[32:35], v13 offset:49152
    ds_read_b128 v[36:39], v13 offset:51200
    v_mfma_f32_16x16x32_bf16 v[84:87], a[172:175], v[40:43], v[84:87]
    v_mfma_f32_16x16x32_bf16 v[88:91], a[168:171], v[44:47], v[88:91]
    s_add_u32 m0, s59, 4992
    s_nop 0
    buffer_load_dwordx4 v9, s[12:15], s48 offen offset:128 sc1 lds
    v_mfma_f32_16x16x32_bf16 v[92:95], a[172:175], v[44:47], v[92:95]
    s_waitcnt lgkmcnt(4)
    v_mfma_f32_16x16x32_bf16 v[80:83], a[176:179], v[48:51], v[80:83]
    ds_read_b128 v[40:43], v15 offset:49152
    ds_read_b128 v[44:47], v15 offset:51200
    v_mfma_f32_16x16x32_bf16 v[84:87], a[180:183], v[48:51], v[84:87]
    v_mfma_f32_16x16x32_bf16 v[88:91], a[176:179], v[52:55], v[88:91]
    s_add_u32 m0, s59, 6016
    s_nop 0
    buffer_load_dwordx4 v6, s[12:15], s49 offen offset:128 sc1 lds
    v_mfma_f32_16x16x32_bf16 v[92:95], a[180:183], v[52:55], v[92:95]
    s_waitcnt lgkmcnt(4)
    v_mfma_f32_16x16x32_bf16 v[80:83], a[184:187], v[56:59], v[80:83]
    ds_read_b128 v[48:51], v13 offset:53248
    ds_read_b128 v[52:55], v13 offset:55296
    v_mfma_f32_16x16x32_bf16 v[84:87], a[188:191], v[56:59], v[84:87]
    v_mfma_f32_16x16x32_bf16 v[88:91], a[184:187], v[60:63], v[88:91]
    s_add_u32 m0, s59, 7040
    s_nop 0
    buffer_load_dwordx4 v9, s[12:15], s49 offen offset:128 sc1 lds
    v_mfma_f32_16x16x32_bf16 v[92:95], a[188:191], v[60:63], v[92:95]
    s_waitcnt lgkmcnt(4)
    v_mfma_f32_16x16x32_bf16 v[80:83], a[192:195], v[32:35], v[80:83]
    ds_read_b128 v[56:59], v15 offset:53248
    ds_read_b128 v[60:63], v15 offset:55296
    v_mfma_f32_16x16x32_bf16 v[84:87], a[196:199], v[32:35], v[84:87]
    v_mfma_f32_16x16x32_bf16 v[88:91], a[192:195], v[36:39], v[88:91]
    v_mfma_f32_16x16x32_bf16 v[92:95], a[196:199], v[36:39], v[92:95]
    s_waitcnt lgkmcnt(4)
    v_mfma_f32_16x16x32_bf16 v[80:83], a[200:203], v[40:43], v[80:83]
    ds_read_b128 v[32:35], v13 offset:57344
    ds_read_b128 v[36:39], v13 offset:59392
    v_mfma_f32_16x16x32_bf16 v[84:87], a[204:207], v[40:43], v[84:87]
    v_mfma_f32_16x16x32_bf16 v[88:91], a[200:203], v[44:47], v[88:91]
    v_mfma_f32_16x16x32_bf16 v[92:95], a[204:207], v[44:47], v[92:95]
    s_waitcnt lgkmcnt(4)
    v_mfma_f32_16x16x32_bf16 v[80:83], a[208:211], v[48:51], v[80:83]
    ds_read_b128 v[40:43], v15 offset:57344
    ds_read_b128 v[44:47], v15 offset:59392
    v_mfma_f32_16x16x32_bf16 v[84:87], a[212:215], v[48:51], v[84:87]
    v_mfma_f32_16x16x32_bf16 v[88:91], a[208:211], v[52:55], v[88:91]
    v_mfma_f32_16x16x32_bf16 v[92:95], a[212:215], v[52:55], v[92:95]
    s_waitcnt lgkmcnt(4)
    v_mfma_f32_16x16x32_bf16 v[80:83], a[216:219], v[56:59], v[80:83]
    ds_read_b128 v[48:51], v13 offset:61440
    ds_read_b128 v[52:55], v13 offset:63488
    v_mfma_f32_16x16x32_bf16 v[84:87], a[220:223], v[56:59], v[84:87]
    v_mfma_f32_16x16x32_bf16 v[88:91], a[216:219], v[60:63], v[88:91]
    v_mfma_f32_16x16x32_bf16 v[92:95], a[220:223], v[60:63], v[92:95]
    s_waitcnt lgkmcnt(4)
    v_mfma_f32_16x16x32_bf16 v[80:83], a[224:227], v[32:35], v[80:83]
    ds_read_b128 v[56:59], v15 offset:61440
    ds_read_b128 v[60:63], v15 offset:63488
    v_mfma_f32_16x16x32_bf16 v[84:87], a[228:231], v[32:35], v[84:87]
    v_mfma_f32_16x16x32_bf16 v[88:91], a[224:227], v[36:39], v[88:91]
    v_mfma_f32_16x16x32_bf16 v[92:95], a[228:231], v[36:39], v[92:95]
    s_waitcnt lgkmcnt(4)
    v_mfma_f32_16x16x32_bf16 v[80:83], a[232:235], v[40:43], v[80:83]
    v_mfma_f32_16x16x32_bf16 v[84:87], a[236:239], v[40:43], v[84:87]
    v_mfma_f32_16x16x32_bf16 v[88:91], a[232:235], v[44:47], v[88:91]
    v_mfma_f32_16x16x32_bf16 v[92:95], a[236:239], v[44:47], v[92:95]
    s_waitcnt vmcnt(16) lgkmcnt(0)
    s_barrier
    s_cmp_lg_u32 s44, 0
    s_cbranch_scc1 L_e_pr_119
    s_add_u32 s45, s58, s60
    v_mov_b32 v30, s45
    v_mov_b32 v31, 0
    s_mov_b64 exec, 1
    buffer_store_dword v30, v31, s[12:15], s61 offen sc1
    s_mov_b64 exec, -1
L_e_pr_119:
    v_mfma_f32_16x16x32_bf16 v[80:83], a[240:243], v[48:51], v[80:83]
    ds_read_b128 v[32:35], v14 offset:0
    ds_read_b128 v[36:39], v14 offset:2048
    v_mfma_f32_16x16x32_bf16 v[84:87], a[244:247], v[48:51], v[84:87]
    v_mfma_f32_16x16x32_bf16 v[88:91], a[240:243], v[52:55], v[88:91]
    v_mfma_f32_16x16x32_bf16 v[92:95], a[244:247], v[52:55], v[92:95]
    v_mfma_f32_16x16x32_bf16 v[80:83], a[248:251], v[56:59], v[80:83]
    ds_read_b128 v[40:43], v16 offset:0
    ds_read_b128 v[44:47], v16 offset:2048
    v_mfma_f32_16x16x32_bf16 v[84:87], a[252:255], v[56:59], v[84:87]
    v_mfma_f32_16x16x32_bf16 v[88:91], a[248:251], v[60:63], v[88:91]
    v_mfma_f32_16x16x32_bf16 v[92:95], a[252:255], v[60:63], v[92:95]
    s_add_u32 s53, s53, 65536
    s_add_u32 s58, s58, 1
    v_swap_b32 v13, v14
    s_xor_b32 s54, s54, 65536
    s_xor_b32 s55, s55, 65536
    s_mov_b32 s76, s57
    v_swap_b32 v15, v16
    s_add_u32 s57, s57, 8192
    v_cvt_pk_bf16_f32 v216, v80, v81
    v_cvt_pk_bf16_f32 v217, v82, v83
    v_cvt_pk_bf16_f32 v218, v84, v85
    v_cvt_pk_bf16_f32 v219, v86, v87
    v_cvt_pk_bf16_f32 v220, v88, v89
    v_cvt_pk_bf16_f32 v221, v90, v91
    v_cvt_pk_bf16_f32 v222, v92, v93
    v_cvt_pk_bf16_f32 v223, v94, v95
    buffer_store_dwordx4 v[216:219], v10, s[12:15], s76 offen sc1
    buffer_store_dwordx4 v[220:223], v10, s[12:15], s76 offen offset:1024 sc1
    s_cmp_lt_u32 s58, s51
    s_cbranch_scc1 L_e_loop_116
    s_branch L_e_fin_118
L_e_one_117:
    s_waitcnt vmcnt(8)
    s_barrier
    ds_read_b128 v[32:35], v13 offset:0
    ds_read_b128 v[36:39], v13 offset:2048
    ds_read_b128 v[40:43], v15 offset:0
    ds_read_b128 v[44:47], v15 offset:2048
    s_waitcnt lgkmcnt(2)
    v_mfma_f32_16x16x32_bf16 v[80:83], a[0:3], v[32:35], 0
    ds_read_b128 v[48:51], v13 offset:4096
    ds_read_b128 v[52:55], v13 offset:6144
    v_mfma_f32_16x16x32_bf16 v[84:87], a[4:7], v[32:35], 0
    ds_read_b128 v[56:59], v15 offset:4096
    ds_read_b128 v[60:63], v15 offset:6144
    v_mfma_f32_16x16x32_bf16 v[88:91], a[0:3], v[36:39], 0
    v_mfma_f32_16x16x32_bf16 v[92:95], a[4:7], v[36:39], 0
    s_waitcnt lgkmcnt(4)
    v_mfma_f32_16x16x32_bf16 v[80:83], a[8:11], v[40:43], v[80:83]
    ds_read_b128 v[32:35], v13 offset:8192
    ds_read_b128 v[36:39], v13 offset:10240
    v_mfma_f32_16x16x32_bf16 v[84:87], a[12:15], v[40:43], v[84:87]
    v_mfma_f32_16x16x32_bf16 v[88:91], a[8:11], v[44:47], v[88:91]
    v_mfma_f32_16x16x32_bf16 v[92:95], a[12:15], v[44:47], v[92:95]
    s_waitcnt lgkmcnt(4)
    v_mfma_f32_16x16x32_bf16 v[80:83], a[16:19], v[48:51], v[80:83]
    ds_read_b128 v[40:43], v15 offset:8192
    ds_read_b128 v[44:47], v15 offset:10240
    v_mfma_f32_16x16x32_bf16 v[84:87], a[20:23], v[48:51], v[84:87]
    v_mfma_f32_16x16x32_bf16 v[88:91], a[16:19], v[52:55], v[88:91]
    v_mfma_f32_16x16x32_bf16 v[92:95], a[20:23], v[52:55], v[92:95]
    s_waitcnt lgkmcnt(4)
    v_mfma_f32_16x16x32_bf16 v[80:83], a[24:27], v[56:59], v[80:83]
    ds_read_b128 v[48:51], v13 offset:12288
    ds_read_b128 v[52:55], v13 offset:14336
    v_mfma_f32_16x16x32_bf16 v[84:87], a[28:31], v[56:59], v[84:87]
    v_mfma_f32_16x16x32_bf16 v[88:91], a[24:27], v[60:63], v[88:91]
    v_mfma_f32_16x16x32_bf16 v[92:95], a[28:31], v[60:63], v[92:95]
    s_waitcnt lgkmcnt(4)
    v_mfma_f32_16x16x32_bf16 v[80:83], a[32:35], v[32:35], v[80:83]
    ds_read_b128 v[56:59], v15 offset:12288
    ds_read_b128 v[60:63], v15 offset:14336
    v_mfma_f32_16x16x32_bf16 v[84:87], a[36:39], v[32:35], v[84:87]
    v_mfma_f32_16x16x32_bf16 v[88:91], a[32:35], v[36:39], v[88:91]
    v_mfma_f32_16x16x32_bf16 v[92:95], a[36:39], v[36:39], v[92:95]
    s_waitcnt lgkmcnt(4)
    v_mfma_f32_16x16x32_bf16 v[80:83], a[40:43], v[40:43], v[80:83]
    ds_read_b128 v[32:35], v13 offset:16384
    ds_read_b128 v[36:39], v13 offset:18432
    v_mfma_f32_16x16x32_bf16 v[84:87], a[44:47], v[40:43], v[84:87]
    v_mfma_f32_16x16x32_bf16 v[88:91], a[40:43], v[44:47], v[88:91]
    v_mfma_f32_16x16x32_bf16 v[92:95], a[44:47], v[44:47], v[92:95]
    s_waitcnt lgkmcnt(4)
    v_mfma_f32_16x16x32_bf16 v[80:83], a[48:51], v[48:51], v[80:83]
    ds_read_b128 v[40:43], v15 offset:16384
    ds_read_b128 v[44:47], v15 offset:18432
    v_mfma_f32_16x16x32_bf16 v[84:87], a[52:55], v[48:51], v[84:87]
    v_mfma_f32_16x16x32_bf16 v[88:91], a[48:51], v[52:55], v[88:91]
    v_mfma_f32_16x16x32_bf16 v[92:95], a[52:55], v[52:55], v[92:95]
    s_waitcnt lgkmcnt(4)
    v_mfma_f32_16x16x32_bf16 v[80:83], a[56:59], v[56:59], v[80:83]
    ds_read_b128 v[48:51], v13 offset:20480
    ds_read_b128 v[52:55], v13 offset:22528
    v_mfma_f32_16x16x32_bf16 v[84:87], a[60:63], v[56:59], v[84:87]
    v_mfma_f32_16x16x32_bf16 v[88:91], a[56:59], v[60:63], v[88:91]
    v_mfma_f32_16x16x32_bf16 v[92:95], a[60:63], v[60:63], v[92:95]
    s_waitcnt lgkmcnt(4)
    v_mfma_f32_16x16x32_bf16 v[80:83], a[64:67], v[32:35], v[80:83]
    ds_read_b128 v[56:59], v15 offset:20480
    ds_read_b128 v[60:63], v15 offset:22528
    v_mfma_f32_16x16x32_bf16 v[84:87], a[68:71], v[32:35], v[84:87]
    v_mfma_f32_16x16x32_bf16 v[88:91], a[64:67], v[36:39], v[88:91]
    v_mfma_f32_16x16x32_bf16 v[92:95], a[68:71], v[36:39], v[92:95]
    s_waitcnt lgkmcnt(4)
    v_mfma_f32_16x16x32_bf16 v[80:83], a[72:75], v[40:43], v[80:83]
    ds_read_b128 v[32:35], v13 offset:24576
    ds_read_b128 v[36:39], v13 offset:26624
    v_mfma_f32_16x16x32_bf16 v[84:87], a[76:79], v[40:43], v[84:87]
    v_mfma_f32_16x16x32_bf16 v[88:91], a[72:75], v[44:47], v[88:91]
    v_mfma_f32_16x16x32_bf16 v[92:95], a[76:79], v[44:47], v[92:95]
    s_waitcnt lgkmcnt(4)
    v_mfma_f32_16x16x32_bf16 v[80:83], a[80:83], v[48:51], v[80:83]
    ds_read_b128 v[40:43], v15 offset:24576
    ds_read_b128 v[44:47], v15 offset:26624
    v_mfma_f32_16x16x32_bf16 v[84:87], a[84:87], v[48:51], v[84:87]
    v_mfma_f32_16x16x32_bf16 v[88:91], a[80:83], v[52:55], v[88:91]
    v_mfma_f32_16x16x32_bf16 v[92:95], a[84:87], v[52:55], v[92:95]
    s_waitcnt lgkmcnt(4)
    v_mfma_f32_16x16x32_bf16 v[80:83], a[88:91], v[56:59], v[80:83]
    ds_read_b128 v[48:51], v13 offset:28672
    ds_read_b128 v[52:55], v13 offset:30720
    v_mfma_f32_16x16x32_bf16 v[84:87], a[92:95], v[56:59], v[84:87]
    v_mfma_f32_16x16x32_bf16 v[88:91], a[88:91], v[60:63], v[88:91]
    v_mfma_f32_16x16x32_bf16 v[92:95], a[92:95], v[60:63], v[92:95]
    s_waitcnt lgkmcnt(4)
    v_mfma_f32_16x16x32_bf16 v[80:83], a[96:99], v[32:35], v[80:83]
    ds_read_b128 v[56:59], v15 offset:28672
    ds_read_b128 v[60:63], v15 offset:30720
    v_mfma_f32_16x16x32_bf16 v[84:87], a[100:103], v[32:35], v[84:87]
    v_mfma_f32_16x16x32_bf16 v[88:91], a[96:99], v[36:39], v[88:91]
    v_mfma_f32_16x16x32_bf16 v[92:95], a[100:103], v[36:39], v[92:95]
    s_waitcnt lgkmcnt(4)
    v_mfma_f32_16x16x32_bf16 v[80:83], a[104:107], v[40:43], v[80:83]
    v_mfma_f32_16x16x32_bf16 v[84:87], a[108:111], v[40:43], v[84:87]
    v_mfma_f32_16x16x32_bf16 v[88:91], a[104:107], v[44:47], v[88:91]
    v_mfma_f32_16x16x32_bf16 v[92:95], a[108:111], v[44:47], v[92:95]
    s_waitcnt vmcnt(0) lgkmcnt(0)
    s_barrier
    v_mfma_f32_16x16x32_bf16 v[80:83], a[112:115], v[48:51], v[80:83]
    ds_read_b128 v[32:35], v13 offset:32768
    ds_read_b128 v[36:39], v13 offset:34816
    v_mfma_f32_16x16x32_bf16 v[84:87], a[116:119], v[48:51], v[84:87]
    v_mfma_f32_16x16x32_bf16 v[88:91], a[112:115], v[52:55], v[88:91]
    v_mfma_f32_16x16x32_bf16 v[92:95], a[116:119], v[52:55], v[92:95]
    v_mfma_f32_16x16x32_bf16 v[80:83], a[120:123], v[56:59], v[80:83]
    ds_read_b128 v[40:43], v15 offset:32768
    ds_read_b128 v[44:47], v15 offset:34816
    v_mfma_f32_16x16x32_bf16 v[84:87], a[124:127], v[56:59], v[84:87]
    v_mfma_f32_16x16x32_bf16 v[88:91], a[120:123], v[60:63], v[88:91]
    v_mfma_f32_16x16x32_bf16 v[92:95], a[124:127], v[60:63], v[92:95]
    s_waitcnt lgkmcnt(2)
    v_mfma_f32_16x16x32_bf16 v[80:83], a[128:131], v[32:35], v[80:83]
    ds_read_b128 v[48:51], v13 offset:36864
    ds_read_b128 v[52:55], v13 offset:38912
    v_mfma_f32_16x16x32_bf16 v[84:87], a[132:135], v[32:35], v[84:87]
    ds_read_b128 v[56:59], v15 offset:36864
    ds_read_b128 v[60:63], v15 offset:38912
    v_mfma_f32_16x16x32_bf16 v[88:91], a[128:131], v[36:39], v[88:91]
    v_mfma_f32_16x16x32_bf16 v[92:95], a[132:135], v[36:39], v[92:95]
    s_waitcnt lgkmcnt(4)
    v_mfma_f32_16x16x32_bf16 v[80:83], a[136:139], v[40:43], v[80:83]
    ds_read_b128 v[32:35], v13 offset:40960
    ds_read_b128 v[36:39], v13 offset:43008
    v_mfma_f32_16x16x32_bf16 v[84:87], a[140:143], v[40:43], v[84:87]
    v_mfma_f32_16x16x32_bf16 v[88:91], a[136:139], v[44:47], v[88:91]
    v_mfma_f32_16x16x32_bf16 v[92:95], a[140:143], v[44:47], v[92:95]
    s_waitcnt lgkmcnt(4)
    v_mfma_f32_16x16x32_bf16 v[80:83], a[144:147], v[48:51], v[80:83]
    ds_read_b128 v[40:43], v15 offset:40960
    ds_read_b128 v[44:47], v15 offset:43008
    v_mfma_f32_16x16x32_bf16 v[84:87], a[148:151], v[48:51], v[84:87]
    v_mfma_f32_16x16x32_bf16 v[88:91], a[144:147], v[52:55], v[88:91]
    v_mfma_f32_16x16x32_bf16 v[92:95], a[148:151], v[52:55], v[92:95]
    s_waitcnt lgkmcnt(4)
    v_mfma_f32_16x16x32_bf16 v[80:83], a[152:155], v[56:59], v[80:83]
    ds_read_b128 v[48:51], v13 offset:45056
    ds_read_b128 v[52:55], v13 offset:47104
    v_mfma_f32_16x16x32_bf16 v[84:87], a[156:159], v[56:59], v[84:87]
    v_mfma_f32_16x16x32_bf16 v[88:91], a[152:155], v[60:63], v[88:91]
    v_mfma_f32_16x16x32_bf16 v[92:95], a[156:159], v[60:63], v[92:95]
    s_waitcnt lgkmcnt(4)
    v_mfma_f32_16x16x32_bf16 v[80:83], a[160:163], v[32:35], v[80:83]
    ds_read_b128 v[56:59], v15 offset:45056
    ds_read_b128 v[60:63], v15 offset:47104
    v_mfma_f32_16x16x32_bf16 v[84:87], a[164:167], v[32:35], v[84:87]
    v_mfma_f32_16x16x32_bf16 v[88:91], a[160:163], v[36:39], v[88:91]
    v_mfma_f32_16x16x32_bf16 v[92:95], a[164:167], v[36:39], v[92:95]
    s_waitcnt lgkmcnt(4)
    v_mfma_f32_16x16x32_bf16 v[80:83], a[168:171], v[40:43], v[80:83]
    ds_read_b128 v[32:35], v13 offset:49152
    ds_read_b128 v[36:39], v13 offset:51200
    v_mfma_f32_16x16x32_bf16 v[84:87], a[172:175], v[40:43], v[84:87]
    v_mfma_f32_16x16x32_bf16 v[88:91], a[168:171], v[44:47], v[88:91]
    v_mfma_f32_16x16x32_bf16 v[92:95], a[172:175], v[44:47], v[92:95]
    s_waitcnt lgkmcnt(4)
    v_mfma_f32_16x16x32_bf16 v[80:83], a[176:179], v[48:51], v[80:83]
    ds_read_b128 v[40:43], v15 offset:49152
    ds_read_b128 v[44:47], v15 offset:51200
    v_mfma_f32_16x16x32_bf16 v[84:87], a[180:183], v[48:51], v[84:87]
    v_mfma_f32_16x16x32_bf16 v[88:91], a[176:179], v[52:55], v[88:91]
    v_mfma_f32_16x16x32_bf16 v[92:95], a[180:183], v[52:55], v[92:95]
    s_waitcnt lgkmcnt(4)
    v_mfma_f32_16x16x32_bf16 v[80:83], a[184:187], v[56:59], v[80:83]
    ds_read_b128 v[48:51], v13 offset:53248
    ds_read_b128 v[52:55], v13 offset:55296
    v_mfma_f32_16x16x32_bf16 v[84:87], a[188:191], v[56:59], v[84:87]
    v_mfma_f32_16x16x32_bf16 v[88:91], a[184:187], v[60:63], v[88:91]
    v_mfma_f32_16x16x32_bf16 v[92:95], a[188:191], v[60:63], v[92:95]
    s_waitcnt lgkmcnt(4)
    v_mfma_f32_16x16x32_bf16 v[80:83], a[192:195], v[32:35], v[80:83]
    ds_read_b128 v[56:59], v15 offset:53248
    ds_read_b128 v[60:63], v15 offset:55296
    v_mfma_f32_16x16x32_bf16 v[84:87], a[196:199], v[32:35], v[84:87]
    v_mfma_f32_16x16x32_bf16 v[88:91], a[192:195], v[36:39], v[88:91]
    v_mfma_f32_16x16x32_bf16 v[92:95], a[196:199], v[36:39], v[92:95]
    s_waitcnt lgkmcnt(4)
    v_mfma_f32_16x16x32_bf16 v[80:83], a[200:203], v[40:43], v[80:83]
    ds_read_b128 v[32:35], v13 offset:57344
    ds_read_b128 v[36:39], v13 offset:59392
    v_mfma_f32_16x16x32_bf16 v[84:87], a[204:207], v[40:43], v[84:87]
    v_mfma_f32_16x16x32_bf16 v[88:91], a[200:203], v[44:47], v[88:91]
    v_mfma_f32_16x16x32_bf16 v[92:95], a[204:207], v[44:47], v[92:95]
    s_waitcnt lgkmcnt(4)
    v_mfma_f32_16x16x32_bf16 v[80:83], a[208:211], v[48:51], v[80:83]
    ds_read_b128 v[40:43], v15 offset:57344
    ds_read_b128 v[44:47], v15 offset:59392
    v_mfma_f32_16x16x32_bf16 v[84:87], a[212:215], v[48:51], v[84:87]
    v_mfma_f32_16x16x32_bf16 v[88:91], a[208:211], v[52:55], v[88:91]
    v_mfma_f32_16x16x32_bf16 v[92:95], a[212:215], v[52:55], v[92:95]
    s_waitcnt lgkmcnt(4)
    v_mfma_f32_16x16x32_bf16 v[80:83], a[216:219], v[56:59], v[80:83]
    ds_read_b128 v[48:51], v13 offset:61440
    ds_read_b128 v[52:55], v13 offset:63488
    v_mfma_f32_16x16x32_bf16 v[84:87], a[220:223], v[56:59], v[84:87]
    v_mfma_f32_16x16x32_bf16 v[88:91], a[216:219], v[60:63], v[88:91]
    v_mfma_f32_16x16x32_bf16 v[92:95], a[220:223], v[60:63], v[92:95]
    s_waitcnt lgkmcnt(4)
    v_mfma_f32_16x16x32_bf16 v[80:83], a[224:227], v[32:35], v[80:83]
    ds_read_b128 v[56:59], v15 offset:61440
    ds_read_b128 v[60:63], v15 offset:63488
    v_mfma_f32_16x16x32_bf16 v[84:87], a[228:231], v[32:35], v[84:87]
    v_mfma_f32_16x16x32_bf16 v[88:91], a[224:227], v[36:39], v[88:91]
    v_mfma_f32_16x16x32_bf16 v[92:95], a[228:231], v[36:39], v[92:95]
    s_waitcnt lgkmcnt(4)
    v_mfma_f32_16x16x32_bf16 v[80:83], a[232:235], v[40:43], v[80:83]
    v_mfma_f32_16x16x32_bf16 v[84:87], a[236:239], v[40:43], v[84:87]
    v_mfma_f32_16x16x32_bf16 v[88:91], a[232:235], v[44:47], v[88:91]
    v_mfma_f32_16x16x32_bf16 v[92:95], a[236:239], v[44:47], v[92:95]
    s_waitcnt lgkmcnt(0)
    v_mfma_f32_16x16x32_bf16 v[80:83], a[240:243], v[48:51], v[80:83]
    v_mfma_f32_16x16x32_bf16 v[84:87], a[244:247], v[48:51], v[84:87]
    v_mfma_f32_16x16x32_bf16 v[88:91], a[240:243], v[52:55], v[88:91]
    v_mfma_f32_16x16x32_bf16 v[92:95], a[244:247], v[52:55], v[92:95]
    v_mfma_f32_16x16x32_bf16 v[80:83], a[248:251], v[56:59], v[80:83]
    v_mfma_f32_16x16x32_bf16 v[84:87], a[252:255], v[56:59], v[84:87]
    v_mfma_f32_16x16x32_bf16 v[88:91], a[248:251], v[60:63], v[88:91]
    v_mfma_f32_16x16x32_bf16 v[92:95], a[252:255], v[60:63], v[92:95]
    s_mov_b32 s76, s57
    s_nop 6
    v_cvt_pk_bf16_f32 v216, v80, v81
    v_cvt_pk_bf16_f32 v217, v82, v83
    v_cvt_pk_bf16_f32 v218, v84, v85
    v_cvt_pk_bf16_f32 v219, v86, v87
    v_cvt_pk_bf16_f32 v220, v88, v89
    v_cvt_pk_bf16_f32 v221, v90, v91
    v_cvt_pk_bf16_f32 v222, v92, v93
    v_cvt_pk_bf16_f32 v223, v94, v95
    buffer_store_dwordx4 v[216:219], v10, s[12:15], s76 offen sc1
    buffer_store_dwordx4 v[220:223], v10, s[12:15], s76 offen offset:1024 sc1
L_e_fin_118:
    s_waitcnt lgkmcnt(0)
    s_add_u32 s60, s60, s51
    s_waitcnt vmcnt(0)
    s_barrier
    s_cmp_lg_u32 s44, 0
    s_cbranch_scc1 L_pub_120
    v_mov_b32 v30, s60
    v_mov_b32 v31, 0
    s_mov_b64 exec, 1
    buffer_store_dword v30, v31, s[12:15], s61 offen sc1
    s_mov_b64 exec, -1
L_pub_120:
    s_cmp_eq_u32 s60, 1
    s_cselect_b32 s51, 11, 52
    s_cselect_b32 s71, s71, 196
    s_cmp_lt_u32 s60, 64
    s_cbranch_scc1 L_w_qkv_113
L_w_roles_103:
    s_cmp_lg_u32 s44, 0
    s_cbranch_scc1 L_gj_121
    s_getreg_b32 s45, hwreg(HW_REG_XCC_ID)
    s_and_b32 s45, s45, 15
    s_mul_i32 s46, s45, s45
    s_lshl_b32 s46, s46, 9
    s_add_u32 s45, s45, s46
    s_add_u32 s45, s45, 16777216
    v_mov_b32 v30, s45
    s_lshl_b32 s45, s40, 2
    v_mov_b32 v31, 0
    s_mov_b64 exec, 1
    buffer_atomic_add v30, v31, s[16:19], s45 offen offset:200 sc1
    s_mov_b64 exec, -1
L_gj_121:
    s_mov_b32 s36, 0x1111111
    s_mov_b32 s37, 0x55222081
    s_cmp_eq_u32 s42, 0
    s_cselect_b32 s36, s36, 0x10000000
    s_cselect_b32 s37, s37, 0xaa888410
    s_mov_b32 s72, 0x88888888
    s_mov_b32 s73, 0xffd55248
    s_lshr_b32 s38, s41, 3
    s_and_b32 s68, s41, 7
    s_cmp_eq_u32 s43, 1
    s_cbranch_scc1 L_role_b_122
    s_cmp_eq_u32 s43, 2
    s_cbranch_scc1 L_role_c_123
    s_load_dwordx2 s[6:7], s[0:1], 40
    s_waitcnt lgkmcnt(0)
    s_mov_b32 s24, s6
    s_and_b32 s25, s7, 0xffff
    s_mov_b32 s26, 0x800000
    s_mov_b32 s27, 0x00020000
    s_lshl_b32 s46, s38, 21
    s_lshl_b32 s45, s68, 8
    s_add_u32 s46, s46, s45
    s_waitcnt vmcnt(0)
    s_barrier
    v_lshrrev_b32 v20, 4, v1
    s_lshl_b32 s45, s44, 2
    v_add_u32 v21, s45, v20
    s_mov_b32 s45, 2048
    v_mul_lo_u32 v21, v21, s45
    v_lshlrev_b32 v22, 2, v20
    v_and_b32 v23, 15, v1
    v_xor_b32 v22, v22, v23
    v_lshlrev_b32 v22, 4, v22
    v_add_u32 v21, v21, v22
    v_bfe_u32 v22, v1, 2, 2
    v_lshlrev_b32 v23, 2, v20
    v_add_u32 v23, v23, v22
    v_lshlrev_b32 v23, 8, v23
    v_xor_b32 v22, s44, v22
    v_lshlrev_b32 v22, 6, v22
    v_add_u32 v23, v23, v22
    v_and_b32 v22, 3, v1
    v_lshlrev_b32 v22, 3, v22
    v_add_u32 v23, v23, v22
    v_add_u32 v24, 65536, v23
    v_add_u32 v25, 131072, v23
    s_lshl_b32 s47, s44, 10
    s_add_u32 s45, s46, 0x0
    s_add_u32 m0, s47, 0
    s_nop 0
    buffer_load_dwordx4 v21, s[24:27], s45 offen  lds
    s_add_u32 s45, s46, 0x8000
    s_add_u32 m0, s47, 4096
    s_nop 0
    buffer_load_dwordx4 v21, s[24:27], s45 offen  lds
    s_add_u32 s45, s46, 0x10000
    s_add_u32 m0, s47, 8192
    s_nop 0
    buffer_load_dwordx4 v21, s[24:27], s45 offen  lds
    s_add_u32 s45, s46, 0x18000
    s_add_u32 m0, s47, 12288
    s_nop 0
    buffer_load_dwordx4 v21, s[24:27], s45 offen  lds
    s_add_u32 s45, s46, 0x20000
    s_add_u32 m0, s47, 16384
    s_nop 0
    buffer_load_dwordx4 v21, s[24:27], s45 offen  lds
    s_add_u32 s45, s46, 0x28000
    s_add_u32 m0, s47, 20480
    s_nop 0
    buffer_load_dwordx4 v21, s[24:27], s45 offen  lds
    s_add_u32 s45, s46, 0x30000
    s_add_u32 m0, s47, 24576
    s_nop 0
    buffer_load_dwordx4 v21, s[24:27], s45 offen  lds
    s_add_u32 s45, s46, 0x38000
    s_add_u32 m0, s47, 28672
    s_nop 0
    buffer_load_dwordx4 v21, s[24:27], s45 offen  lds
    s_add_u32 s45, s46, 0x40000
    s_add_u32 m0, s47, 32768
    s_nop 0
    buffer_load_dwordx4 v21, s[24:27], s45 offen  lds
    s_add_u32 s45, s46, 0x48000
    s_add_u32 m0, s47, 36864
    s_nop 0
    buffer_load_dwordx4 v21, s[24:27], s45 offen  lds
    s_add_u32 s45, s46, 0x50000
    s_add_u32 m0, s47, 40960
    s_nop 0
    buffer_load_dwordx4 v21, s[24:27], s45 offen  lds
    s_add_u32 s45, s46, 0x58000
    s_add_u32 m0, s47, 45056
    s_nop 0
    buffer_load_dwordx4 v21, s[24:27], s45 offen  lds
    s_add_u32 s45, s46, 0x60000
    s_add_u32 m0, s47, 49152
    s_nop 0
    buffer_load_dwordx4 v21, s[24:27], s45 offen  lds
    s_add_u32 s45, s46, 0x68000
    s_add_u32 m0, s47, 53248
    s_nop 0
    buffer_load_dwordx4 v21, s[24:27], s45 offen  lds
    s_add_u32 s45, s46, 0x70000
    s_add_u32 m0, s47, 57344
    s_nop 0
    buffer_load_dwordx4 v21, s[24:27], s45 offen  lds
    s_add_u32 s45, s46, 0x78000
    s_add_u32 m0, s47, 61440
    s_nop 0
    buffer_load_dwordx4 v21, s[24:27], s45 offen  lds
    s_add_u32 s45, s46, 0x80000
    s_add_u32 m0, s47, 65536
    s_nop 0
    buffer_load_dwordx4 v21, s[24:27], s45 offen  lds
    s_add_u32 s45, s46, 0x88000
    s_add_u32 m0, s47, 69632
    s_nop 0
    buffer_load_dwordx4 v21, s[24:27], s45 offen  lds
    s_add_u32 s45, s46, 0x90000
    s_add_u32 m0, s47, 73728
    s_nop 0
    buffer_load_dwordx4 v21, s[24:27], s45 offen  lds
    s_add_u32 s45, s46, 0x98000
    s_add_u32 m0, s47, 77824
    s_nop 0
    buffer_load_dwordx4 v21, s[24:27], s45 offen  lds
    s_add_u32 s45, s46, 0xa0000
    s_add_u32 m0, s47, 81920
    s_nop 0
    buffer_load_dwordx4 v21, s[24:27], s45 offen  lds
    s_add_u32 s45, s46, 0xa8000
    s_add_u32 m0, s47, 86016
    s_nop 0
    buffer_load_dwordx4 v21, s[24:27], s45 offen  lds
    s_add_u32 s45, s46, 0xb0000
    s_add_u32 m0, s47, 90112
    s_nop 0
    buffer_load_dwordx4 v21, s[24:27], s45 offen  lds
    s_add_u32 s45, s46, 0xb8000
    s_add_u32 m0, s47, 94208
    s_nop 0
    buffer_load_dwordx4 v21, s[24:27], s45 offen  lds
    s_add_u32 s45, s46, 0xc0000
    s_add_u32 m0, s47, 98304
    s_nop 0
    buffer_load_dwordx4 v21, s[24:27], s45 offen  lds
    s_add_u32 s45, s46, 0xc8000
    s_add_u32 m0, s47, 102400
    s_nop 0
    buffer_load_dwordx4 v21, s[24:27], s45 offen  lds
    s_add_u32 s45, s46, 0xd0000
    s_add_u32 m0, s47, 106496
    s_nop 0
    buffer_load_dwordx4 v21, s[24:27], s45 offen  lds
    s_add_u32 s45, s46, 0xd8000
    s_add_u32 m0, s47, 110592
    s_nop 0
    buffer_load_dwordx4 v21, s[24:27], s45 offen  lds
    s_add_u32 s45, s46, 0xe0000
    s_add_u32 m0, s47, 114688
    s_nop 0
    buffer_load_dwordx4 v21, s[24:27], s45 offen  lds
    s_add_u32 s45, s46, 0xe8000
    s_add_u32 m0, s47, 118784
    s_nop 0
    buffer_load_dwordx4 v21, s[24:27], s45 offen  lds
    s_add_u32 s45, s46, 0xf0000
    s_add_u32 m0, s47, 122880
    s_nop 0
    buffer_load_dwordx4 v21, s[24:27], s45 offen  lds
    s_add_u32 s45, s46, 0xf8000
    s_add_u32 m0, s47, 126976
    s_nop 0
    buffer_load_dwordx4 v21, s[24:27], s45 offen  lds
    s_waitcnt vmcnt(28)
    s_barrier
    s_add_u32 s45, s46, 0x100000
    s_add_u32 m0, s47, 131072
    s_nop 0
    buffer_load_dwordx4 v21, s[24:27], s45 offen  lds
    s_add_u32 s45, s46, 0x108000
    s_add_u32 m0, s47, 135168
    s_nop 0
    buffer_load_dwordx4 v21, s[24:27], s45 offen  lds
    s_add_u32 s45, s46, 0x110000
    s_add_u32 m0, s47, 139264
    s_nop 0
    buffer_load_dwordx4 v21, s[24:27], s45 offen  lds
    s_add_u32 s45, s46, 0x118000
    s_add_u32 m0, s47, 143360
    s_nop 0
    buffer_load_dwordx4 v21, s[24:27], s45 offen  lds
    ds_read_b64_tr_b16 a[0:1], v23 offset:0
    ds_read_b64_tr_b16 a[2:3], v23 offset:4096
    ds_read_b64_tr_b16 a[4:5], v23 offset:32
    ds_read_b64_tr_b16 a[6:7], v23 offset:4128
    ds_read_b64_tr_b16 a[8:9], v23 offset:8192
    ds_read_b64_tr_b16 a[10:11], v23 offset:12288
    ds_read_b64_tr_b16 a[12:13], v23 offset:8224
    ds_read_b64_tr_b16 a[14:15], v23 offset:12320
    s_waitcnt lgkmcnt(0)
    s_waitcnt vmcnt(28)
    s_barrier
    s_add_u32 s45, s46, 0x120000
    s_add_u32 m0, s47, 0
    s_nop 0
    buffer_load_dwordx4 v21, s[24:27], s45 offen  lds
    s_add_u32 s45, s46, 0x128000
    s_add_u32 m0, s47, 4096
    s_nop 0
    buffer_load_dwordx4 v21, s[24:27], s45 offen  lds
    s_add_u32 s45, s46, 0x130000
    s_add_u32 m0, s47, 8192
    s_nop 0
    buffer_load_dwordx4 v21, s[24:27], s45 offen  lds
    s_add_u32 s45, s46, 0x138000
    s_add_u32 m0, s47, 12288
    s_nop 0
    buffer_load_dwordx4 v21, s[24:27], s45 offen  lds
    ds_read_b64_tr_b16 a[16:17], v23 offset:16384
    ds_read_b64_tr_b16 a[18:19], v23 offset:20480
    ds_read_b64_tr_b16 a[20:21], v23 offset:16416
    ds_read_b64_tr_b16 a[22:23], v23 offset:20512
    ds_read_b64_tr_b16 a[24:25], v23 offset:24576
    ds_read_b64_tr_b16 a[26:27], v23 offset:28672
    ds_read_b64_tr_b16 a[28:29], v23 offset:24608
    ds_read_b64_tr_b16 a[30:31], v23 offset:28704
    s_waitcnt lgkmcnt(0)
    s_waitcnt vmcnt(28)
    s_barrier
    s_add_u32 s45, s46, 0x140000
    s_add_u32 m0, s47, 16384
    s_nop 0
    buffer_load_dwordx4 v21, s[24:27], s45 offen  lds
    s_add_u32 s45, s46, 0x148000
    s_add_u32 m0, s47, 20480
    s_nop 0
    buffer_load_dwordx4 v21, s[24:27], s45 offen  lds
    s_add_u32 s45, s46, 0x150000
    s_add_u32 m0, s47, 24576
    s_nop 0
    buffer_load_dwordx4 v21, s[24:27], s45 offen  lds
    s_add_u32 s45, s46, 0x158000
    s_add_u32 m0, s47, 28672
    s_nop 0
    buffer_load_dwordx4 v21, s[24:27], s45 offen  lds
    ds_read_b64_tr_b16 a[32:33], v23 offset:32768
    ds_read_b64_tr_b16 a[34:35], v23 offset:36864
    ds_read_b64_tr_b16 a[36:37], v23 offset:32800
    ds_read_b64_tr_b16 a[38:39], v23 offset:36896
    ds_read_b64_tr_b16 a[40:41], v23 offset:40960
    ds_read_b64_tr_b16 a[42:43], v23 offset:45056
    ds_read_b64_tr_b16 a[44:45], v23 offset:40992
    ds_read_b64_tr_b16 a[46:47], v23 offset:45088
    s_waitcnt lgkmcnt(0)
    s_waitcnt vmcnt(28)
    s_barrier
    s_add_u32 s45, s46, 0x160000
    s_add_u32 m0, s47, 32768
    s_nop 0
    buffer_load_dwordx4 v21, s[24:27], s45 offen  lds
    s_add_u32 s45, s46, 0x168000
    s_add_u32 m0, s47, 36864
    s_nop 0
    buffer_load_dwordx4 v21, s[24:27], s45 offen  lds
    s_add_u32 s45, s46, 0x170000
    s_add_u32 m0, s47, 40960
    s_nop 0
    buffer_load_dwordx4 v21, s[24:27], s45 offen  lds
    s_add_u32 s45, s46, 0x178000
    s_add_u32 m0, s47, 45056
    s_nop 0
    buffer_load_dwordx4 v21, s[24:27], s45 offen  lds
    ds_read_b64_tr_b16 a[48:49], v23 offset:49152
    ds_read_b64_tr_b16 a[50:51], v23 offset:53248
    ds_read_b64_tr_b16 a[52:53], v23 offset:49184
    ds_read_b64_tr_b16 a[54:55], v23 offset:53280
    ds_read_b64_tr_b16 a[56:57], v23 offset:57344
    ds_read_b64_tr_b16 a[58:59], v23 offset:61440
    ds_read_b64_tr_b16 a[60:61], v23 offset:57376
    ds_read_b64_tr_b16 a[62:63], v23 offset:61472
    s_waitcnt lgkmcnt(0)
    s_waitcnt vmcnt(28)
    s_barrier
    s_add_u32 s45, s46, 0x180000
    s_add_u32 m0, s47, 49152
    s_nop 0
    buffer_load_dwordx4 v21, s[24:27], s45 offen  lds
    s_add_u32 s45, s46, 0x188000
    s_add_u32 m0, s47, 53248
    s_nop 0
    buffer_load_dwordx4 v21, s[24:27], s45 offen  lds
    s_add_u32 s45, s46, 0x190000
    s_add_u32 m0, s47, 57344
    s_nop 0
    buffer_load_dwordx4 v21, s[24:27], s45 offen  lds
    s_add_u32 s45, s46, 0x198000
    s_add_u32 m0, s47, 61440
    s_nop 0
    buffer_load_dwordx4 v21, s[24:27], s45 offen  lds
    ds_read_b64_tr_b16 a[64:65], v24 offset:0
    ds_read_b64_tr_b16 a[66:67], v24 offset:4096
    ds_read_b64_tr_b16 a[68:69], v24 offset:32
    ds_read_b64_tr_b16 a[70:71], v24 offset:4128
    ds_read_b64_tr_b16 a[72:73], v24 offset:8192
    ds_read_b64_tr_b16 a[74:75], v24 offset:12288
    ds_read_b64_tr_b16 a[76:77], v24 offset:8224
    ds_read_b64_tr_b16 a[78:79], v24 offset:12320
    s_waitcnt lgkmcnt(0)
    s_waitcnt vmcnt(28)
    s_barrier
    s_add_u32 s45, s46, 0x1a0000
    s_add_u32 m0, s47, 65536
    s_nop 0
    buffer_load_dwordx4 v21, s[24:27], s45 offen  lds
    s_add_u32 s45, s46, 0x1a8000
    s_add_u32 m0, s47, 69632
    s_nop 0
    buffer_load_dwordx4 v21, s[24:27], s45 offen  lds
    s_add_u32 s45, s46, 0x1b0000
    s_add_u32 m0, s47, 73728
    s_nop 0
    buffer_load_dwordx4 v21, s[24:27], s45 offen  lds
    s_add_u32 s45, s46, 0x1b8000
    s_add_u32 m0, s47, 77824
    s_nop 0
    buffer_load_dwordx4 v21, s[24:27], s45 offen  lds
    ds_read_b64_tr_b16 a[80:81], v24 offset:16384
    ds_read_b64_tr_b16 a[82:83], v24 offset:20480
    ds_read_b64_tr_b16 a[84:85], v24 offset:16416
    ds_read_b64_tr_b16 a[86:87], v24 offset:20512
    ds_read_b64_tr_b16 a[88:89], v24 offset:24576
    ds_read_b64_tr_b16 a[90:91], v24 offset:28672
    ds_read_b64_tr_b16 a[92:93], v24 offset:24608
    ds_read_b64_tr_b16 a[94:95], v24 offset:28704
    s_waitcnt lgkmcnt(0)
    s_waitcnt vmcnt(28)
    s_barrier
    s_add_u32 s45, s46, 0x1c0000
    s_add_u32 m0, s47, 81920
    s_nop 0
    buffer_load_dwordx4 v21, s[24:27], s45 offen  lds
    s_add_u32 s45, s46, 0x1c8000
    s_add_u32 m0, s47, 86016
    s_nop 0
    buffer_load_dwordx4 v21, s[24:27], s45 offen  lds
    s_add_u32 s45, s46, 0x1d0000
    s_add_u32 m0, s47, 90112
    s_nop 0
    buffer_load_dwordx4 v21, s[24:27], s45 offen  lds
    s_add_u32 s45, s46, 0x1d8000
    s_add_u32 m0, s47, 94208
    s_nop 0
    buffer_load_dwordx4 v21, s[24:27], s45 offen  lds
    ds_read_b64_tr_b16 a[96:97], v24 offset:32768
    ds_read_b64_tr_b16 a[98:99], v24 offset:36864
    ds_read_b64_tr_b16 a[100:101], v24 offset:32800
    ds_read_b64_tr_b16 a[102:103], v24 offset:36896
    ds_read_b64_tr_b16 a[104:105], v24 offset:40960
    ds_read_b64_tr_b16 a[106:107], v24 offset:45056
    ds_read_b64_tr_b16 a[108:109], v24 offset:40992
    ds_read_b64_tr_b16 a[110:111], v24 offset:45088
    s_waitcnt lgkmcnt(0)
    s_waitcnt vmcnt(28)
    s_barrier
    s_add_u32 s45, s46, 0x1e0000
    s_add_u32 m0, s47, 98304
    s_nop 0
    buffer_load_dwordx4 v21, s[24:27], s45 offen  lds
    s_add_u32 s45, s46, 0x1e8000
    s_add_u32 m0, s47, 102400
    s_nop 0
    buffer_load_dwordx4 v21, s[24:27], s45 offen  lds
    s_add_u32 s45, s46, 0x1f0000
    s_add_u32 m0, s47, 106496
    s_nop 0
    buffer_load_dwordx4 v21, s[24:27], s45 offen  lds
    s_add_u32 s45, s46, 0x1f8000
    s_add_u32 m0, s47, 110592
    s_nop 0
    buffer_load_dwordx4 v21, s[24:27], s45 offen  lds
    ds_read_b64_tr_b16 a[112:113], v24 offset:49152
    ds_read_b64_tr_b16 a[114:115], v24 offset:53248
    ds_read_b64_tr_b16 a[116:117], v24 offset:49184
    ds_read_b64_tr_b16 a[118:119], v24 offset:53280
    ds_read_b64_tr_b16 a[120:121], v24 offset:57344
    ds_read_b64_tr_b16 a[122:123], v24 offset:61440
    ds_read_b64_tr_b16 a[124:125], v24 offset:57376
    ds_read_b64_tr_b16 a[126:127], v24 offset:61472
    s_waitcnt lgkmcnt(0)
    s_waitcnt vmcnt(28)
    s_barrier
    ds_read_b64_tr_b16 a[128:129], v25 offset:0
    ds_read_b64_tr_b16 a[130:131], v25 offset:4096
    ds_read_b64_tr_b16 a[132:133], v25 offset:32
    ds_read_b64_tr_b16 a[134:135], v25 offset:4128
    ds_read_b64_tr_b16 a[136:137], v25 offset:8192
    ds_read_b64_tr_b16 a[138:139], v25 offset:12288
    ds_read_b64_tr_b16 a[140:141], v25 offset:8224
    ds_read_b64_tr_b16 a[142:143], v25 offset:12320
    s_waitcnt lgkmcnt(0)
    s_waitcnt vmcnt(24)
    s_barrier
    ds_read_b64_tr_b16 a[144:145], v23 offset:0
    ds_read_b64_tr_b16 a[146:147], v23 offset:4096
    ds_read_b64_tr_b16 a[148:149], v23 offset:32
    ds_read_b64_tr_b16 a[150:151], v23 offset:4128
    ds_read_b64_tr_b16 a[152:153], v23 offset:8192
    ds_read_b64_tr_b16 a[154:155], v23 offset:12288
    ds_read_b64_tr_b16 a[156:157], v23 offset:8224
    ds_read_b64_tr_b16 a[158:159], v23 offset:12320
    s_waitcnt lgkmcnt(0)
    s_waitcnt vmcnt(20)
    s_barrier
    ds_read_b64_tr_b16 a[160:161], v23 offset:16384
    ds_read_b64_tr_b16 a[162:163], v23 offset:20480
    ds_read_b64_tr_b16 a[164:165], v23 offset:16416
    ds_read_b64_tr_b16 a[166:167], v23 offset:20512
    ds_read_b64_tr_b16 a[168:169], v23 offset:24576
    ds_read_b64_tr_b16 a[170:171], v23 offset:28672
    ds_read_b64_tr_b16 a[172:173], v23 offset:24608
    ds_read_b64_tr_b16 a[174:175], v23 offset:28704
    s_waitcnt lgkmcnt(0)
    s_waitcnt vmcnt(16)
    s_barrier
    ds_read_b64_tr_b16 a[176:177], v23 offset:32768
    ds_read_b64_tr_b16 a[178:179], v23 offset:36864
    ds_read_b64_tr_b16 a[180:181], v23 offset:32800
    ds_read_b64_tr_b16 a[182:183], v23 offset:36896
    ds_read_b64_tr_b16 a[184:185], v23 offset:40960
    ds_read_b64_tr_b16 a[186:187], v23 offset:45056
    ds_read_b64_tr_b16 a[188:189], v23 offset:40992
    ds_read_b64_tr_b16 a[190:191], v23 offset:45088
    s_waitcnt lgkmcnt(0)
    s_waitcnt vmcnt(12)
    s_barrier
    ds_read_b64_tr_b16 a[192:193], v23 offset:49152
    ds_read_b64_tr_b16 a[194:195], v23 offset:53248
    ds_read_b64_tr_b16 a[196:197], v23 offset:49184
    ds_read_b64_tr_b16 a[198:199], v23 offset:53280
    ds_read_b64_tr_b16 a[200:201], v23 offset:57344
    ds_read_b64_tr_b16 a[202:203], v23 offset:61440
    ds_read_b64_tr_b16 a[204:205], v23 offset:57376
    ds_read_b64_tr_b16 a[206:207], v23 offset:61472
    s_waitcnt lgkmcnt(0)
    s_waitcnt vmcnt(8)
    s_barrier
    ds_read_b64_tr_b16 a[208:209], v24 offset:0
    ds_read_b64_tr_b16 a[210:211], v24 offset:4096
    ds_read_b64_tr_b16 a[212:213], v24 offset:32
    ds_read_b64_tr_b16 a[214:215], v24 offset:4128
    ds_read_b64_tr_b16 a[216:217], v24 offset:8192
    ds_read_b64_tr_b16 a[218:219], v24 offset:12288
    ds_read_b64_tr_b16 a[220:221], v24 offset:8224
    ds_read_b64_tr_b16 a[222:223], v24 offset:12320
    s_waitcnt lgkmcnt(0)
    s_waitcnt vmcnt(4)
    s_barrier
    ds_read_b64_tr_b16 a[224:225], v24 offset:16384
    ds_read_b64_tr_b16 a[226:227], v24 offset:20480
    ds_read_b64_tr_b16 a[228:229], v24 offset:16416
    ds_read_b64_tr_b16 a[230:231], v24 offset:20512
    ds_read_b64_tr_b16 a[232:233], v24 offset:24576
    ds_read_b64_tr_b16 a[234:235], v24 offset:28672
    ds_read_b64_tr_b16 a[236:237], v24 offset:24608
    ds_read_b64_tr_b16 a[238:239], v24 offset:28704
    s_waitcnt lgkmcnt(0)
    s_waitcnt vmcnt(0)
    s_barrier
    ds_read_b64_tr_b16 a[240:241], v24 offset:32768
    ds_read_b64_tr_b16 a[242:243], v24 offset:36864
    ds_read_b64_tr_b16 a[244:245], v24 offset:32800
    ds_read_b64_tr_b16 a[246:247], v24 offset:36896
    ds_read_b64_tr_b16 a[248:249], v24 offset:40960
    ds_read_b64_tr_b16 a[250:251], v24 offset:45056
    ds_read_b64_tr_b16 a[252:253], v24 offset:40992
    ds_read_b64_tr_b16 a[254:255], v24 offset:45088
    s_waitcnt lgkmcnt(0)
    s_barrier
    s_lshl_b32 s52, s38, 16
    s_add_u32 s52, s52, 0x5000000
    s_lshl_b32 s56, s38, 23
    s_lshl_b32 s45, s68, 9
    s_add_u32 s56, s56, s45
    s_add_u32 s56, s56, 0x8000000
    s_cmp_lg_u32 s44, 0
    s_cbranch_scc1 L_pd_124
    v_mov_b32 v29, 4
    s_mov_b32 s46, 1073741824
    s_mov_b64 exec, 1
    s_mov_b32 s70, 0
L_wp_125:
    buffer_load_dword v31, v29, s[16:19], 0 offen sc1
    s_add_u32 s70, s70, 1
    s_cmp_ge_u32 s70, 0x200000
    s_cbranch_scc1 L_w_done_101
    s_waitcnt vmcnt(0)
    v_cmp_gt_u32 vcc, s46, v31
    s_nop 1
    s_cbranch_vccz L_wp_125_ok
    s_sleep 3
    s_branch L_wp_125
L_wp_125_ok:
    s_mov_b64 exec, -1
L_pd_124:
    s_barrier
    s_lshl_b32 s45, s40, 2
    s_add_u32 s45, s45, 200
    v_mov_b32 v29, s45
    s_mov_b32 s46, 536870912
    s_mov_b64 exec, 1
    s_mov_b32 s70, 0
L_wp_128:
    buffer_load_dword v31, v29, s[16:19], 0 offen sc1
    s_add_u32 s70, s70, 1
    s_cmp_ge_u32 s70, 0x200000
    s_cbranch_scc1 L_w_done_101
    s_waitcnt vmcnt(0)
    v_cmp_gt_u32 vcc, s46, v31
    s_nop 1
    s_cbranch_vccz L_wp_128_ok
    s_sleep 2
    s_branch L_wp_128
L_wp_128_ok:
    s_mov_b64 exec, -1
    v_readfirstlane_b32 s45, v31
    s_nop 3
    s_and_b32 s46, s45, 511
    s_mul_i32 s46, s46, s46
    s_bfe_u32 s45, s45, 0xf0009
    s_lshl_b32 s45, s45, 5
    s_mov_b32 s80, s12
    s_mov_b32 s81, s13
    s_mov_b32 s83, 0x00020000
    s_mov_b32 s84, s12
    s_mov_b32 s85, s13
    s_mov_b32 s87, 0x00020000
    s_cmp_eq_u32 s45, s46
    s_cselect_b32 s82, s14, 0
    s_cselect_b32 s86, 0, s14
    s_sub_u32 s79, 3, s44
    s_mov_b32 s78, 0
    s_cmp_eq_u64 s[36:37], 0
    s_cbranch_scc1 L_xl_129
    s_ff1_i32_b64 s47, s[36:37]
    s_lshr_b64 s[74:75], s[72:73], s47
    s_ff1_i32_b64 s48, s[74:75]
    s_cmp_gt_u32 s79, s48
    s_cbranch_scc1 L_xl_129
    s_add_u32 s47, s47, s79
    s_cmp_lt_u32 s47, s78
    s_cbranch_scc1 L_xl_129_go
    s_lshl_b32 s45, s41, 7
    s_add_u32 s45, s45, 0x10010
    s_add_u32 s46, s47, 1
    s_mov_b64 exec, 7
    s_mov_b32 s70, 0
L_wp_130:
    buffer_load_dword v31, v12, s[12:15], s45 offen sc1
    s_add_u32 s70, s70, 1
    s_cmp_ge_u32 s70, 0x200000
    s_cbranch_scc1 L_w_done_101
    s_waitcnt vmcnt(0)
    v_cmp_gt_u32 vcc, s46, v31
    s_nop 1
    s_cbranch_vccz L_wp_130_ok
    s_sleep 2
    s_branch L_wp_130
L_wp_130_ok:
    s_mov_b64 exec, -1
    v_readlane_b32 s78, v31, 0
    v_readlane_b32 s45, v31, 1
    v_readlane_b32 s46, v31, 2
    s_nop 3
    s_min_u32 s78, s78, s45
    s_min_u32 s78, s78, s46
L_xl_129_go:
    s_lshl_b32 s45, s41, 19
    s_lshl_b32 s46, s47, 13
    s_add_u32 s45, s45, s46
    s_add_u32 s45, s45, 0x2000000
    s_add_u32 s46, s45, 4096
    s_add_u32 s48, s45, 16777216
    s_add_u32 s49, s48, 4096
    s_add_u32 s76, s48, 16777216
    s_add_u32 s77, s76, 4096
    buffer_load_dwordx4 v[96:99], v10, s[12:15], s76 offen offset:0 sc1
    buffer_load_dwordx4 v[128:131], v10, s[12:15], s45 offen offset:0 sc1
    buffer_load_dwordx4 v[160:163], v10, s[12:15], s48 offen offset:0 sc1
    buffer_load_dwordx4 v[100:103], v10, s[12:15], s76 offen offset:1024 sc1
    buffer_load_dwordx4 v[144:147], v10, s[12:15], s45 offen offset:1024 sc1
    buffer_load_dwordx4 v[176:179], v10, s[12:15], s48 offen offset:1024 sc1
    buffer_load_dwordx4 v[104:107], v10, s[12:15], s76 offen offset:2048 sc1
    buffer_load_dwordx4 v[132:135], v10, s[12:15], s45 offen offset:2048 sc1
    buffer_load_dwordx4 v[164:167], v10, s[12:15], s48 offen offset:2048 sc1
    buffer_load_dwordx4 v[108:111], v10, s[12:15], s76 offen offset:3072 sc1
    buffer_load_dwordx4 v[148:151], v10, s[12:15], s45 offen offset:3072 sc1
    buffer_load_dwordx4 v[180:183], v10, s[12:15], s48 offen offset:3072 sc1
    buffer_load_dwordx4 v[112:115], v10, s[12:15], s77 offen offset:0 sc1
    buffer_load_dwordx4 v[136:139], v10, s[12:15], s46 offen offset:0 sc1
    buffer_load_dwordx4 v[168:171], v10, s[12:15], s49 offen offset:0 sc1
    buffer_load_dwordx4 v[116:119], v10, s[12:15], s77 offen offset:1024 sc1
    buffer_load_dwordx4 v[152:155], v10, s[12:15], s46 offen offset:1024 sc1
    buffer_load_dwordx4 v[184:187], v10, s[12:15], s49 offen offset:1024 sc1
    buffer_load_dwordx4 v[120:123], v10, s[12:15], s77 offen offset:2048 sc1
    buffer_load_dwordx4 v[140:143], v10, s[12:15], s46 offen offset:2048 sc1
    buffer_load_dwordx4 v[172:175], v10, s[12:15], s49 offen offset:2048 sc1
    buffer_load_dwordx4 v[124:127], v10, s[12:15], s77 offen offset:3072 sc1
    buffer_load_dwordx4 v[156:159], v10, s[12:15], s46 offen offset:3072 sc1
    buffer_load_dwordx4 v[188:191], v10, s[12:15], s49 offen offset:3072 sc1
L_xl_129:
L_a_loop_126:
    s_cmp_eq_u64 s[36:37], 0
    s_cbranch_scc1 L_w_done_101
    s_ff1_i32_b64 s50, s[36:37]
    s_bitset0_b64 s[36:37], s50
    s_lshr_b64 s[74:75], s[72:73], s50
    s_ff1_i32_b64 s51, s[74:75]
    s_add_u32 s51, s51, 1
    s_add_u32 s62, s50, s51
    s_add_u32 s63, s50, s79
    s_cmp_ge_u32 s79, s51
    s_cbranch_scc1 L_xs1_131
    s_lshl_b32 s47, s44, 13
    v_add_u32 v18, s47, v10
    v_and_b32 v14, 15, v1
    v_lshrrev_b32 v16, 4, v1
    s_waitcnt vmcnt(0)
    ds_write_b128 v18, v[96:99] offset:0
    ds_write_b128 v18, v[100:103] offset:1024
    ds_write_b128 v18, v[104:107] offset:2048
    ds_write_b128 v18, v[108:111] offset:3072
    ds_write_b128 v18, v[112:115] offset:4096
    ds_write_b128 v18, v[116:119] offset:5120
    ds_write_b128 v18, v[120:123] offset:6144
    ds_write_b128 v18, v[124:127] offset:7168
    v_mfma_f32_16x16x32_bf16 v[32:35], v[160:163], v[128:131], 0
    v_mfma_f32_16x16x32_bf16 v[36:39], v[160:163], v[144:147], 0
    v_mfma_f32_16x16x32_bf16 v[44:47], v[176:179], v[144:147], 0
    v_mfma_f32_16x16x32_bf16 v[32:35], v[164:167], v[132:135], v[32:35]
    v_mfma_f32_16x16x32_bf16 v[36:39], v[164:167], v[148:151], v[36:39]
    v_mfma_f32_16x16x32_bf16 v[44:47], v[180:183], v[148:151], v[44:47]
    v_mfma_f32_16x16x32_bf16 v[32:35], v[168:171], v[136:139], v[32:35]
    v_mfma_f32_16x16x32_bf16 v[36:39], v[168:171], v[152:155], v[36:39]
    v_mfma_f32_16x16x32_bf16 v[44:47], v[184:187], v[152:155], v[44:47]
    v_mfma_f32_16x16x32_bf16 v[32:35], v[172:175], v[140:143], v[32:35]
    v_mfma_f32_16x16x32_bf16 v[36:39], v[172:175], v[156:159], v[36:39]
    v_mfma_f32_16x16x32_bf16 v[44:47], v[188:191], v[156:159], v[44:47]
    v_lshlrev_b32 v19, 2, v16
    v_lshrrev_b32 v20, 2, v1
    v_lshlrev_b32 v20, 4, v20
    v_and_b32 v21, 1, v1
    v_lshlrev_b32 v21, 3, v21
    v_add3_u32 v20, v20, v21, s47
    v_and_b32 v21, 2, v1
    v_lshlrev_b32 v21, 7, v21
    v_add_u32 v20, v20, v21
    v_mov_b32 v22, 0xff800000
    s_waitcnt lgkmcnt(0)
    ds_read_b64_tr_b16 v[208:209], v20 offset:0
    ds_read_b64_tr_b16 v[210:211], v20 offset:1024
    ds_read_b64_tr_b16 v[212:213], v20 offset:512
    ds_read_b64_tr_b16 v[214:215], v20 offset:1536
    ds_read_b64_tr_b16 v[216:217], v20 offset:2048
    ds_read_b64_tr_b16 v[218:219], v20 offset:3072
    ds_read_b64_tr_b16 v[220:221], v20 offset:2560
    ds_read_b64_tr_b16 v[222:223], v20 offset:3584
    ds_read_b64_tr_b16 v[224:225], v20 offset:4096
    ds_read_b64_tr_b16 v[226:227], v20 offset:5120
    ds_read_b64_tr_b16 v[228:229], v20 offset:4608
    ds_read_b64_tr_b16 v[230:231], v20 offset:5632
    ds_read_b64_tr_b16 v[232:233], v20 offset:6144
    ds_read_b64_tr_b16 v[234:235], v20 offset:7168
    ds_read_b64_tr_b16 v[236:237], v20 offset:6656
    ds_read_b64_tr_b16 v[238:239], v20 offset:7680
    v_add_u32 v21, 0, v19
    v_cmp_gt_u32 vcc, v21, v14
    s_nop 1
    v_cndmask_b32 v32, v32, v22, vcc
    v_cndmask_b32 v44, v44, v22, vcc
    v_add_u32 v21, 1, v19
    v_cmp_gt_u32 vcc, v21, v14
    s_nop 1
    v_cndmask_b32 v33, v33, v22, vcc
    v_cndmask_b32 v45, v45, v22, vcc
    v_add_u32 v21, 2, v19
    v_cmp_gt_u32 vcc, v21, v14
    s_nop 1
    v_cndmask_b32 v34, v34, v22, vcc
    v_cndmask_b32 v46, v46, v22, vcc
    v_add_u32 v21, 3, v19
    v_cmp_gt_u32 vcc, v21, v14
    s_nop 1
    v_cndmask_b32 v35, v35, v22, vcc
    v_cndmask_b32 v47, v47, v22, vcc
L_xs1_131:
    s_lshl_b32 s45, s41, 7
    s_add_u32 s45, s45, 0x11000
    s_cmp_lg_u32 s44, 0
    s_cbranch_scc1 L_pw_133
    s_mov_b64 exec, 255
    s_mov_b32 s70, 0
L_wp_134:
    buffer_load_dword v31, v12, s[12:15], s45 offen sc1
    s_add_u32 s70, s70, 1
    s_cmp_ge_u32 s70, 0x200000
    s_cbranch_scc1 L_w_done_101
    s_waitcnt vmcnt(0)
    v_cmp_gt_u32 vcc, s62, v31
    s_nop 1
    s_cbranch_vccz L_wp_134_ok
    s_sleep 2
    s_branch L_wp_134
L_wp_134_ok:
    s_mov_b64 exec, -1
L_pw_133:
    s_barrier
    s_cmp_ge_u32 s79, s51
    s_cbranch_scc1 L_xs2_132
    s_lshl_b32 s45, s63, 17
    s_lshl_b32 s46, s41, 12
    s_add_u32 s45, s45, s46
    s_lshr_b32 s46, s45, 1
    s_add_u32 s45, s45, 0x1000000
    s_add_u32 s46, s46, 0x1800000
    v_lshlrev_b32 v21, 3, v1
    buffer_load_dwordx4 v[192:195], v10, s[12:15], s45 offen offset:0 sc1
    buffer_load_dwordx4 v[196:199], v10, s[12:15], s45 offen offset:1024 sc1
    buffer_load_dwordx4 v[200:203], v10, s[12:15], s45 offen offset:2048 sc1
    buffer_load_dwordx4 v[204:207], v10, s[12:15], s45 offen offset:3072 sc1
    buffer_load_dwordx2 v[240:241], v21, s[12:15], s46 offen offset:0 sc1
    buffer_load_dwordx2 v[242:243], v21, s[12:15], s46 offen offset:512 sc1
    buffer_load_dwordx2 v[244:245], v21, s[12:15], s46 offen offset:1024 sc1
    buffer_load_dwordx2 v[246:247], v21, s[12:15], s46 offen offset:1536 sc1
    s_waitcnt vmcnt(4)
    v_mfma_f32_16x16x32_bf16 v[48:51], v[192:195], v[128:131], 0
    v_mfma_f32_16x16x32_bf16 v[52:55], v[192:195], v[144:147], 0
    v_mfma_f32_16x16x32_bf16 v[48:51], v[196:199], v[132:135], v[48:51]
    v_mfma_f32_16x16x32_bf16 v[52:55], v[196:199], v[148:151], v[52:55]
    v_mfma_f32_16x16x32_bf16 v[48:51], v[200:203], v[136:139], v[48:51]
    v_mfma_f32_16x16x32_bf16 v[52:55], v[200:203], v[152:155], v[52:55]
    v_mfma_f32_16x16x32_bf16 v[48:51], v[204:207], v[140:143], v[48:51]
    v_mfma_f32_16x16x32_bf16 v[52:55], v[204:207], v[156:159], v[52:55]
    s_mov_b32 s45, 0x3e0293ee
    s_nop 6
    v_permlane32_swap_b32 v48, v50
    v_permlane32_swap_b32 v49, v51
    v_pk_add_f32 v[48:49], v[48:49], v[50:51]
    v_permlane32_swap_b32 v52, v54
    v_permlane32_swap_b32 v53, v55
    v_pk_add_f32 v[52:53], v[52:53], v[54:55]
    v_max_f32 v22, v32, v33
    v_max3_f32 v22, v22, v34, v35
    v_max3_f32 v22, v22, v48, v49
    v_max_f32 v23, v36, v37
    v_max3_f32 v23, v23, v38, v39
    v_max3_f32 v23, v23, v44, v45
    v_max3_f32 v23, v23, v46, v47
    v_max3_f32 v23, v23, v52, v53
    v_mov_b32 v24, v22
    v_mov_b32 v25, v23
    s_nop 0
    v_permlane32_swap_b32 v22, v24
    v_permlane32_swap_b32 v23, v25
    v_max_f32 v22, v22, v24
    v_max_f32 v23, v23, v25
    v_mov_b32 v24, v22
    v_mov_b32 v25, v23
    s_nop 0
    v_permlane16_swap_b32 v22, v24
    v_permlane16_swap_b32 v23, v25
    v_max_f32 v22, v22, v24
    v_max_f32 v23, v23, v25
    v_mul_f32 v22, s45, v22
    v_mul_f32 v23, s45, v23
    v_fma_f32 v32, v32, s45, -v22
    v_fma_f32 v33, v33, s45, -v22
    v_fma_f32 v34, v34, s45, -v22
    v_fma_f32 v35, v35, s45, -v22
    v_fma_f32 v48, v48, s45, -v22
    v_fma_f32 v49, v49, s45, -v22
    v_exp_f32 v32, v32
    v_exp_f32 v33, v33
    v_exp_f32 v34, v34
    v_exp_f32 v35, v35
    v_exp_f32 v48, v48
    v_exp_f32 v49, v49
    v_fma_f32 v36, v36, s45, -v23
    v_fma_f32 v37, v37, s45, -v23
    v_fma_f32 v38, v38, s45, -v23
    v_fma_f32 v39, v39, s45, -v23
    v_fma_f32 v44, v44, s45, -v23
    v_fma_f32 v45, v45, s45, -v23
    v_fma_f32 v46, v46, s45, -v23
    v_fma_f32 v47, v47, s45, -v23
    v_fma_f32 v52, v52, s45, -v23
    v_fma_f32 v53, v53, s45, -v23
    v_exp_f32 v36, v36
    v_exp_f32 v37, v37
    v_exp_f32 v38, v38
    v_exp_f32 v39, v39
    v_exp_f32 v44, v44
    v_exp_f32 v45, v45
    v_exp_f32 v46, v46
    v_exp_f32 v47, v47
    v_exp_f32 v52, v52
    v_exp_f32 v53, v53
    v_add_f32 v22, v32, v33
    v_add_f32 v22, v22, v34
    v_add_f32 v22, v22, v35
    v_add_f32 v22, v22, v48
    v_add_f32 v22, v22, v49
    v_add_f32 v23, v36, v37
    v_add_f32 v23, v23, v38
    v_add_f32 v23, v23, v39
    v_add_f32 v23, v23, v44
    v_add_f32 v23, v23, v45
    v_add_f32 v23, v23, v46
    v_add_f32 v23, v23, v47
    v_add_f32 v23, v23, v52
    v_add_f32 v23, v23, v53
    v_mov_b32 v24, v22
    v_mov_b32 v25, v23
    s_nop 0
    v_permlane32_swap_b32 v22, v24
    v_permlane32_swap_b32 v23, v25
    v_add_f32 v22, v22, v24
    v_add_f32 v23, v23, v25
    v_mov_b32 v24, v22
    v_mov_b32 v25, v23
    s_nop 0
    v_permlane16_swap_b32 v22, v24
    v_permlane16_swap_b32 v23, v25
    v_add_f32 v22, v22, v24
    v_add_f32 v23, v23, v25
    v_rcp_f32 v22, v22
    v_rcp_f32 v23, v23
    s_nop 0
    v_mul_f32 v32, v32, v22
    v_mul_f32 v33, v33, v22
    v_mul_f32 v34, v34, v22
    v_mul_f32 v35, v35, v22
    v_mul_f32 v48, v48, v22
    v_mul_f32 v49, v49, v22
    v_mul_f32 v36, v36, v23
    v_mul_f32 v37, v37, v23
    v_mul_f32 v38, v38, v23
    v_mul_f32 v39, v39, v23
    v_mul_f32 v44, v44, v23
    v_mul_f32 v45, v45, v23
    v_mul_f32 v46, v46, v23
    v_mul_f32 v47, v47, v23
    v_mul_f32 v52, v52, v23
    v_mul_f32 v53, v53, v23
    v_cvt_pk_bf16_f32 v128, v32, v33
    v_cvt_pk_bf16_f32 v129, v34, v35
    v_mov_b32 v130, 0
    v_mov_b32 v131, 0
    v_cvt_pk_bf16_f32 v132, v48, v49
    v_mov_b32 v133, 0
    v_mov_b32 v134, 0
    v_cvt_pk_bf16_f32 v135, v48, v49
    v_cvt_pk_bf16_f32 v136, v36, v37
    v_cvt_pk_bf16_f32 v137, v38, v39
    v_cvt_pk_bf16_f32 v138, v44, v45
    v_cvt_pk_bf16_f32 v139, v46, v47
    v_cvt_pk_bf16_f32 v140, v52, v53
    v_mov_b32 v141, 0
    v_mov_b32 v142, 0
    v_cvt_pk_bf16_f32 v143, v52, v53
    s_waitcnt vmcnt(0) lgkmcnt(0)
    s_nop 0
    v_mfma_f32_16x16x32_bf16 v[64:67], v[208:211], v[128:131], 0
    v_mfma_f32_16x16x32_bf16 v[68:71], v[212:215], v[128:131], 0
    v_mfma_f32_16x16x32_bf16 v[72:75], v[216:219], v[128:131], 0
    v_mfma_f32_16x16x32_bf16 v[76:79], v[220:223], v[128:131], 0
    v_mfma_f32_16x16x32_bf16 v[80:83], v[224:227], v[128:131], 0
    v_mfma_f32_16x16x32_bf16 v[84:87], v[228:231], v[128:131], 0
    v_mfma_f32_16x16x32_bf16 v[88:91], v[232:235], v[128:131], 0
    v_mfma_f32_16x16x32_bf16 v[92:95], v[236:239], v[128:131], 0
    v_mfma_f32_16x16x16_bf16 v[64:67], v[240:241], v[132:133], v[64:67]
    v_mfma_f32_16x16x16_bf16 v[68:71], v[240:241], v[134:135], v[68:71]
    v_mfma_f32_16x16x16_bf16 v[72:75], v[242:243], v[132:133], v[72:75]
    v_mfma_f32_16x16x16_bf16 v[76:79], v[242:243], v[134:135], v[76:79]
    v_mfma_f32_16x16x16_bf16 v[80:83], v[244:245], v[132:133], v[80:83]
    v_mfma_f32_16x16x16_bf16 v[84:87], v[244:245], v[134:135], v[84:87]
    v_mfma_f32_16x16x16_bf16 v[88:91], v[246:247], v[132:133], v[88:91]
    v_mfma_f32_16x16x16_bf16 v[92:95], v[246:247], v[134:135], v[92:95]
    v_mfma_f32_16x16x32_bf16 v[96:99], v[208:211], v[136:139], 0
    v_mfma_f32_16x16x32_bf16 v[100:103], v[212:215], v[136:139], 0
    v_mfma_f32_16x16x32_bf16 v[104:107], v[216:219], v[136:139], 0
    v_mfma_f32_16x16x32_bf16 v[108:111], v[220:223], v[136:139], 0
    v_mfma_f32_16x16x32_bf16 v[112:115], v[224:227], v[136:139], 0
    v_mfma_f32_16x16x32_bf16 v[116:119], v[228:231], v[136:139], 0
    v_mfma_f32_16x16x32_bf16 v[120:123], v[232:235], v[136:139], 0
    v_mfma_f32_16x16x32_bf16 v[124:127], v[236:239], v[136:139], 0
    v_mfma_f32_16x16x16_bf16 v[96:99], v[240:241], v[140:141], v[96:99]
    v_mfma_f32_16x16x16_bf16 v[100:103], v[240:241], v[142:143], v[100:103]
    v_mfma_f32_16x16x16_bf16 v[104:107], v[242:243], v[140:141], v[104:107]
    v_mfma_f32_16x16x16_bf16 v[108:111], v[242:243], v[142:143], v[108:111]
    v_mfma_f32_16x16x16_bf16 v[112:115], v[244:245], v[140:141], v[112:115]
    v_mfma_f32_16x16x16_bf16 v[116:119], v[244:245], v[142:143], v[116:119]
    v_mfma_f32_16x16x16_bf16 v[120:123], v[246:247], v[140:141], v[120:123]
    v_mfma_f32_16x16x16_bf16 v[124:127], v[246:247], v[142:143], v[124:127]
    s_lshl_b32 s45, s63, 18
    s_lshl_b32 s46, s41, 13
    s_add_u32 s45, s45, s46
    s_add_u32 s45, s45, 0x5000000
    s_add_u32 s46, s45, 4096
    v_cvt_pk_bf16_f32 v64, v64, v65
    v_cvt_pk_bf16_f32 v65, v66, v67
    v_cvt_pk_bf16_f32 v66, v68, v69
    v_cvt_pk_bf16_f32 v67, v70, v71
    buffer_store_dwordx4 v[64:67], v10, s[12:15], s45 offen offset:0 sc1
    v_cvt_pk_bf16_f32 v72, v72, v73
    v_cvt_pk_bf16_f32 v73, v74, v75
    v_cvt_pk_bf16_f32 v74, v76, v77
    v_cvt_pk_bf16_f32 v75, v78, v79
    buffer_store_dwordx4 v[72:75], v10, s[12:15], s45 offen offset:2048 sc1
    v_cvt_pk_bf16_f32 v80, v80, v81
    v_cvt_pk_bf16_f32 v81, v82, v83
    v_cvt_pk_bf16_f32 v82, v84, v85
    v_cvt_pk_bf16_f32 v83, v86, v87
    buffer_store_dwordx4 v[80:83], v10, s[12:15], s46 offen offset:0 sc1
    v_cvt_pk_bf16_f32 v88, v88, v89
    v_cvt_pk_bf16_f32 v89, v90, v91
    v_cvt_pk_bf16_f32 v90, v92, v93
    v_cvt_pk_bf16_f32 v91, v94, v95
    buffer_store_dwordx4 v[88:91], v10, s[12:15], s46 offen offset:2048 sc1
    v_cvt_pk_bf16_f32 v96, v96, v97
    v_cvt_pk_bf16_f32 v97, v98, v99
    v_cvt_pk_bf16_f32 v98, v100, v101
    v_cvt_pk_bf16_f32 v99, v102, v103
    buffer_store_dwordx4 v[96:99], v10, s[12:15], s45 offen offset:1024 sc1
    v_cvt_pk_bf16_f32 v104, v104, v105
    v_cvt_pk_bf16_f32 v105, v106, v107
    v_cvt_pk_bf16_f32 v106, v108, v109
    v_cvt_pk_bf16_f32 v107, v110, v111
    buffer_store_dwordx4 v[104:107], v10, s[12:15], s45 offen offset:3072 sc1
    v_cvt_pk_bf16_f32 v112, v112, v113
    v_cvt_pk_bf16_f32 v113, v114, v115
    v_cvt_pk_bf16_f32 v114, v116, v117
    v_cvt_pk_bf16_f32 v115, v118, v119
    buffer_store_dwordx4 v[112:115], v10, s[12:15], s46 offen offset:1024 sc1
    v_cvt_pk_bf16_f32 v120, v120, v121
    v_cvt_pk_bf16_f32 v121, v122, v123
    v_cvt_pk_bf16_f32 v122, v124, v125
    v_cvt_pk_bf16_f32 v123, v126, v127
    buffer_store_dwordx4 v[120:123], v10, s[12:15], s46 offen offset:3072 sc1
L_xs2_132:
    s_waitcnt vmcnt(0)
    s_barrier
    s_cmp_lg_u32 s44, 0
    s_cbranch_scc1 L_pub_135
    v_mov_b32 v30, s62
    v_mov_b32 v31, 0
    s_mov_b64 exec, 1
    buffer_store_dword v30, v31, s[80:83], s65 offen
    buffer_store_dword v30, v31, s[84:87], s65 offen sc1
    s_mov_b64 exec, -1
L_pub_135:
    s_cmp_eq_u64 s[36:37], 0
    s_cbranch_scc1 L_xl_136
    s_ff1_i32_b64 s47, s[36:37]
    s_lshr_b64 s[74:75], s[72:73], s47
    s_ff1_i32_b64 s48, s[74:75]
    s_cmp_gt_u32 s79, s48
    s_cbranch_scc1 L_xl_136
    s_add_u32 s47, s47, s79
    s_cmp_lt_u32 s47, s78
    s_cbranch_scc1 L_xl_136_go
    s_lshl_b32 s45, s41, 7
    s_add_u32 s45, s45, 0x10010
    s_add_u32 s46, s47, 1
    s_mov_b64 exec, 7
    s_mov_b32 s70, 0
L_wp_137:
    buffer_load_dword v31, v12, s[12:15], s45 offen sc1
    s_add_u32 s70, s70, 1
    s_cmp_ge_u32 s70, 0x200000
    s_cbranch_scc1 L_w_done_101
    s_waitcnt vmcnt(0)
    v_cmp_gt_u32 vcc, s46, v31
    s_nop 1
    s_cbranch_vccz L_wp_137_ok
    s_sleep 2
    s_branch L_wp_137
L_wp_137_ok:
    s_mov_b64 exec, -1
    v_readlane_b32 s78, v31, 0
    v_readlane_b32 s45, v31, 1
    v_readlane_b32 s46, v31, 2
    s_nop 3
    s_min_u32 s78, s78, s45
    s_min_u32 s78, s78, s46
L_xl_136_go:
    s_lshl_b32 s45, s41, 19
    s_lshl_b32 s46, s47, 13
    s_add_u32 s45, s45, s46
    s_add_u32 s45, s45, 0x2000000
    s_add_u32 s46, s45, 4096
    s_add_u32 s48, s45, 16777216
    s_add_u32 s49, s48, 4096
    s_add_u32 s76, s48, 16777216
    s_add_u32 s77, s76, 4096
    buffer_load_dwordx4 v[96:99], v10, s[12:15], s76 offen offset:0 sc1
    buffer_load_dwordx4 v[128:131], v10, s[12:15], s45 offen offset:0 sc1
    buffer_load_dwordx4 v[160:163], v10, s[12:15], s48 offen offset:0 sc1
    buffer_load_dwordx4 v[100:103], v10, s[12:15], s76 offen offset:1024 sc1
    buffer_load_dwordx4 v[144:147], v10, s[12:15], s45 offen offset:1024 sc1
    buffer_load_dwordx4 v[176:179], v10, s[12:15], s48 offen offset:1024 sc1
    buffer_load_dwordx4 v[104:107], v10, s[12:15], s76 offen offset:2048 sc1
    buffer_load_dwordx4 v[132:135], v10, s[12:15], s45 offen offset:2048 sc1
    buffer_load_dwordx4 v[164:167], v10, s[12:15], s48 offen offset:2048 sc1
    buffer_load_dwordx4 v[108:111], v10, s[12:15], s76 offen offset:3072 sc1
    buffer_load_dwordx4 v[148:151], v10, s[12:15], s45 offen offset:3072 sc1
    buffer_load_dwordx4 v[180:183], v10, s[12:15], s48 offen offset:3072 sc1
    buffer_load_dwordx4 v[112:115], v10, s[12:15], s77 offen offset:0 sc1
    buffer_load_dwordx4 v[136:139], v10, s[12:15], s46 offen offset:0 sc1
    buffer_load_dwordx4 v[168:171], v10, s[12:15], s49 offen offset:0 sc1
    buffer_load_dwordx4 v[116:119], v10, s[12:15], s77 offen offset:1024 sc1
    buffer_load_dwordx4 v[152:155], v10, s[12:15], s46 offen offset:1024 sc1
    buffer_load_dwordx4 v[184:187], v10, s[12:15], s49 offen offset:1024 sc1
    buffer_load_dwordx4 v[120:123], v10, s[12:15], s77 offen offset:2048 sc1
    buffer_load_dwordx4 v[140:143], v10, s[12:15], s46 offen offset:2048 sc1
    buffer_load_dwordx4 v[172:175], v10, s[12:15], s49 offen offset:2048 sc1
    buffer_load_dwordx4 v[124:127], v10, s[12:15], s77 offen offset:3072 sc1
    buffer_load_dwordx4 v[156:159], v10, s[12:15], s46 offen offset:3072 sc1
    buffer_load_dwordx4 v[188:191], v10, s[12:15], s49 offen offset:3072 sc1
L_xl_136:
    s_lshl_b32 s45, s38, 10
    s_add_u32 s45, s45, s64
    s_cmp_lg_u32 s44, 0
    s_cbranch_scc1 L_pw_138
    s_mov_b64 exec, 255
    s_mov_b32 s70, 0
L_wp_139:
    buffer_load_dword v31, v5, s[12:15], s45 offen sc1
    s_add_u32 s70, s70, 1
    s_cmp_ge_u32 s70, 0x200000
    s_cbranch_scc1 L_w_done_101
    s_waitcnt vmcnt(0)
    v_cmp_gt_u32 vcc, s62, v31
    s_nop 1
    s_cbranch_vccz L_wp_139_ok
    s_sleep 1
    s_branch L_wp_139
L_wp_139_ok:
    s_mov_b64 exec, -1
L_pw_138:
    s_barrier
    s_mul_i32 s53, s50, 262144
    s_add_u32 s53, s53, s52
    s_lshl_b32 s54, s44, 13
    s_add_u32 s53, s53, s54
    s_mul_i32 s57, s50, 131072
    s_add_u32 s57, s57, s56
    s_lshl_b32 s45, s44, 7
    s_add_u32 s57, s57, s45
    s_add_u32 s55, s54, 65536
    s_mov_b32 s58, 0
    v_mov_b32 v13, v10
    v_add_u32 v14, 65536, v13
    v_xor_b32 v15, 64, v13
    v_xor_b32 v16, 64, v14
    s_mov_b32 s76, 0x20000000
    s_add_u32 s48, s53, 0
    s_add_u32 s49, s48, 4096
    s_add_u32 m0, s54, 0
    s_nop 0
    buffer_load_dwordx4 v10, s[12:15], s48 offen offset:0 sc1 lds
    buffer_load_dwordx4 v10, s[12:15], s48 offen offset:1024 sc1 lds
    buffer_load_dwordx4 v10, s[12:15], s48 offen offset:2048 sc1 lds
    buffer_load_dwordx4 v10, s[12:15], s48 offen offset:3072 sc1 lds
    s_add_u32 m0, s54, 4096
    s_nop 0
    buffer_load_dwordx4 v10, s[12:15], s49 offen offset:0 sc1 lds
    buffer_load_dwordx4 v10, s[12:15], s49 offen offset:1024 sc1 lds
    buffer_load_dwordx4 v10, s[12:15], s49 offen offset:2048 sc1 lds
    buffer_load_dwordx4 v10, s[12:15], s49 offen offset:3072 sc1 lds
    s_add_u32 s48, s53, 32768
    s_add_u32 s49, s48, 4096
    s_add_u32 s46, s54, 32768
    s_add_u32 m0, s46, 0
    s_nop 0
    buffer_load_dwordx4 v10, s[12:15], s48 offen offset:0 sc1 lds
    buffer_load_dwordx4 v10, s[12:15], s48 offen offset:1024 sc1 lds
    buffer_load_dwordx4 v10, s[12:15], s48 offen offset:2048 sc1 lds
    buffer_load_dwordx4 v10, s[12:15], s48 offen offset:3072 sc1 lds
    s_add_u32 m0, s46, 4096
    s_nop 0
    buffer_load_dwordx4 v10, s[12:15], s49 offen offset:0 sc1 lds
    buffer_load_dwordx4 v10, s[12:15], s49 offen offset:1024 sc1 lds
    buffer_load_dwordx4 v10, s[12:15], s49 offen offset:2048 sc1 lds
    buffer_load_dwordx4 v10, s[12:15], s49 offen offset:3072 sc1 lds
    s_cmp_eq_u32 s51, 1
    s_cbranch_scc1 L_e_one_141
    s_add_u32 s48, s53, 262144
    s_add_u32 s49, s48, 4096
    s_add_u32 m0, s55, 0
    s_nop 0
    buffer_load_dwordx4 v10, s[12:15], s48 offen offset:0 sc1 lds
    buffer_load_dwordx4 v10, s[12:15], s48 offen offset:1024 sc1 lds
    buffer_load_dwordx4 v10, s[12:15], s48 offen offset:2048 sc1 lds
    buffer_load_dwordx4 v10, s[12:15], s48 offen offset:3072 sc1 lds
    s_add_u32 m0, s55, 4096
    s_nop 0
    buffer_load_dwordx4 v10, s[12:15], s49 offen offset:0 sc1 lds
    buffer_load_dwordx4 v10, s[12:15], s49 offen offset:1024 sc1 lds
    buffer_load_dwordx4 v10, s[12:15], s49 offen offset:2048 sc1 lds
    buffer_load_dwordx4 v10, s[12:15], s49 offen offset:3072 sc1 lds
    s_waitcnt vmcnt(16)
    s_barrier
    ds_read_b128 v[32:35], v13 offset:0
    ds_read_b128 v[36:39], v13 offset:1024
    ds_read_b128 v[40:43], v13 offset:2048
    ds_read_b128 v[44:47], v13 offset:3072
L_e_loop_140:
    s_add_u32 s48, s53, 294912
    s_add_u32 s46, s58, 1
    s_cmp_lt_u32 s46, s51
    s_cselect_b32 s48, s48, 0x20000000
    s_add_u32 s49, s48, 4096
    s_add_u32 s59, s55, 32768
    s_waitcnt lgkmcnt(2)
    v_mfma_f32_16x16x32_bf16 v[80:83], a[0:3], v[32:35], 0
    ds_read_b128 v[48:51], v13 offset:4096
    ds_read_b128 v[52:55], v13 offset:5120
    v_mfma_f32_16x16x32_bf16 v[84:87], a[4:7], v[32:35], 0
    ds_read_b128 v[56:59], v13 offset:6144
    ds_read_b128 v[60:63], v13 offset:7168
    v_mfma_f32_16x16x32_bf16 v[88:91], a[0:3], v[36:39], 0
    s_add_u32 m0, s59, 0
    s_nop 0
    buffer_load_dwordx4 v10, s[12:15], s48 offen offset:0 sc1 lds
    v_mfma_f32_16x16x32_bf16 v[92:95], a[4:7], v[36:39], 0
    s_waitcnt lgkmcnt(4)
    v_mfma_f32_16x16x32_bf16 v[80:83], a[8:11], v[40:43], v[80:83]
    ds_read_b128 v[32:35], v13 offset:8192
    ds_read_b128 v[36:39], v13 offset:9216
    v_mfma_f32_16x16x32_bf16 v[84:87], a[12:15], v[40:43], v[84:87]
    v_mfma_f32_16x16x32_bf16 v[88:91], a[8:11], v[44:47], v[88:91]
    buffer_load_dwordx4 v10, s[12:15], s48 offen offset:1024 sc1 lds
    v_mfma_f32_16x16x32_bf16 v[92:95], a[12:15], v[44:47], v[92:95]
    s_waitcnt lgkmcnt(4)
    v_mfma_f32_16x16x32_bf16 v[80:83], a[16:19], v[48:51], v[80:83]
    ds_read_b128 v[40:43], v13 offset:10240
    ds_read_b128 v[44:47], v13 offset:11264
    v_mfma_f32_16x16x32_bf16 v[84:87], a[20:23], v[48:51], v[84:87]
    v_mfma_f32_16x16x32_bf16 v[88:91], a[16:19], v[52:55], v[88:91]
    buffer_load_dwordx4 v10, s[12:15], s48 offen offset:2048 sc1 lds
    v_mfma_f32_16x16x32_bf16 v[92:95], a[20:23], v[52:55], v[92:95]
    s_waitcnt lgkmcnt(4)
    v_mfma_f32_16x16x32_bf16 v[80:83], a[24:27], v[56:59], v[80:83]
    ds_read_b128 v[48:51], v13 offset:12288
    ds_read_b128 v[52:55], v13 offset:13312
    v_mfma_f32_16x16x32_bf16 v[84:87], a[28:31], v[56:59], v[84:87]
    v_mfma_f32_16x16x32_bf16 v[88:91], a[24:27], v[60:63], v[88:91]
    buffer_load_dwordx4 v10, s[12:15], s48 offen offset:3072 sc1 lds
    v_mfma_f32_16x16x32_bf16 v[92:95], a[28:31], v[60:63], v[92:95]
    s_waitcnt lgkmcnt(4)
    v_mfma_f32_16x16x32_bf16 v[80:83], a[32:35], v[32:35], v[80:83]
    ds_read_b128 v[56:59], v13 offset:14336
    ds_read_b128 v[60:63], v13 offset:15360
    v_mfma_f32_16x16x32_bf16 v[84:87], a[36:39], v[32:35], v[84:87]
    v_mfma_f32_16x16x32_bf16 v[88:91], a[32:35], v[36:39], v[88:91]
    s_add_u32 m0, s59, 4096
    s_nop 0
    buffer_load_dwordx4 v10, s[12:15], s49 offen offset:0 sc1 lds
    v_mfma_f32_16x16x32_bf16 v[92:95], a[36:39], v[36:39], v[92:95]
    s_waitcnt lgkmcnt(4)
    v_mfma_f32_16x16x32_bf16 v[80:83], a[40:43], v[40:43], v[80:83]
    ds_read_b128 v[32:35], v13 offset:16384
    ds_read_b128 v[36:39], v13 offset:17408
    v_mfma_f32_16x16x32_bf16 v[84:87], a[44:47], v[40:43], v[84:87]
    v_mfma_f32_16x16x32_bf16 v[88:91], a[40:43], v[44:47], v[88:91]
    buffer_load_dwordx4 v10, s[12:15], s49 offen offset:1024 sc1 lds
    v_mfma_f32_16x16x32_bf16 v[92:95], a[44:47], v[44:47], v[92:95]
    s_waitcnt lgkmcnt(4)
    v_mfma_f32_16x16x32_bf16 v[80:83], a[48:51], v[48:51], v[80:83]
    ds_read_b128 v[40:43], v13 offset:18432
    ds_read_b128 v[44:47], v13 offset:19456
    v_mfma_f32_16x16x32_bf16 v[84:87], a[52:55], v[48:51], v[84:87]
    v_mfma_f32_16x16x32_bf16 v[88:91], a[48:51], v[52:55], v[88:91]
    buffer_load_dwordx4 v10, s[12:15], s49 offen offset:2048 sc1 lds
    v_mfma_f32_16x16x32_bf16 v[92:95], a[52:55], v[52:55], v[92:95]
    s_waitcnt lgkmcnt(4)
    v_mfma_f32_16x16x32_bf16 v[80:83], a[56:59], v[56:59], v[80:83]
    ds_read_b128 v[48:51], v13 offset:20480
    ds_read_b128 v[52:55], v13 offset:21504
    v_mfma_f32_16x16x32_bf16 v[84:87], a[60:63], v[56:59], v[84:87]
    v_mfma_f32_16x16x32_bf16 v[88:91], a[56:59], v[60:63], v[88:91]
    buffer_load_dwordx4 v10, s[12:15], s49 offen offset:3072 sc1 lds
    v_mfma_f32_16x16x32_bf16 v[92:95], a[60:63], v[60:63], v[92:95]
    s_waitcnt lgkmcnt(4)
    v_mfma_f32_16x16x32_bf16 v[80:83], a[64:67], v[32:35], v[80:83]
    ds_read_b128 v[56:59], v13 offset:22528
    ds_read_b128 v[60:63], v13 offset:23552
    v_mfma_f32_16x16x32_bf16 v[84:87], a[68:71], v[32:35], v[84:87]
    v_mfma_f32_16x16x32_bf16 v[88:91], a[64:67], v[36:39], v[88:91]
    v_mfma_f32_16x16x32_bf16 v[92:95], a[68:71], v[36:39], v[92:95]
    s_waitcnt lgkmcnt(4)
    v_mfma_f32_16x16x32_bf16 v[80:83], a[72:75], v[40:43], v[80:83]
    ds_read_b128 v[32:35], v13 offset:24576
    ds_read_b128 v[36:39], v13 offset:25600
    v_mfma_f32_16x16x32_bf16 v[84:87], a[76:79], v[40:43], v[84:87]
    v_mfma_f32_16x16x32_bf16 v[88:91], a[72:75], v[44:47], v[88:91]
    v_mfma_f32_16x16x32_bf16 v[92:95], a[76:79], v[44:47], v[92:95]
    s_waitcnt lgkmcnt(4)
    v_mfma_f32_16x16x32_bf16 v[80:83], a[80:83], v[48:51], v[80:83]
    ds_read_b128 v[40:43], v13 offset:26624
    ds_read_b128 v[44:47], v13 offset:27648
    v_mfma_f32_16x16x32_bf16 v[84:87], a[84:87], v[48:51], v[84:87]
    v_mfma_f32_16x16x32_bf16 v[88:91], a[80:83], v[52:55], v[88:91]
    v_mfma_f32_16x16x32_bf16 v[92:95], a[84:87], v[52:55], v[92:95]
    s_waitcnt lgkmcnt(4)
    v_mfma_f32_16x16x32_bf16 v[80:83], a[88:91], v[56:59], v[80:83]
    ds_read_b128 v[48:51], v13 offset:28672
    ds_read_b128 v[52:55], v13 offset:29696
    v_mfma_f32_16x16x32_bf16 v[84:87], a[92:95], v[56:59], v[84:87]
    v_mfma_f32_16x16x32_bf16 v[88:91], a[88:91], v[60:63], v[88:91]
    v_mfma_f32_16x16x32_bf16 v[92:95], a[92:95], v[60:63], v[92:95]
    s_waitcnt lgkmcnt(4)
    v_mfma_f32_16x16x32_bf16 v[80:83], a[96:99], v[32:35], v[80:83]
    ds_read_b128 v[56:59], v13 offset:30720
    ds_read_b128 v[60:63], v13 offset:31744
    v_mfma_f32_16x16x32_bf16 v[84:87], a[100:103], v[32:35], v[84:87]
    v_mfma_f32_16x16x32_bf16 v[88:91], a[96:99], v[36:39], v[88:91]
    v_mfma_f32_16x16x32_bf16 v[92:95], a[100:103], v[36:39], v[92:95]
    s_waitcnt lgkmcnt(4)
    v_mfma_f32_16x16x32_bf16 v[80:83], a[104:107], v[40:43], v[80:83]
    ds_read_b128 v[216:219], v8 offset:0
    ds_read_b128 v[220:223], v8 offset:1152
    v_mfma_f32_16x16x32_bf16 v[84:87], a[108:111], v[40:43], v[84:87]
    ds_read_b128 v[224:227], v8 offset:2304
    ds_read_b128 v[228:231], v8 offset:3456
    v_mfma_f32_16x16x32_bf16 v[88:91], a[104:107], v[44:47], v[88:91]
    v_mfma_f32_16x16x32_bf16 v[92:95], a[108:111], v[44:47], v[92:95]
    s_waitcnt vmcnt(16) lgkmcnt(0)
    s_barrier
    v_mfma_f32_16x16x32_bf16 v[80:83], a[112:115], v[48:51], v[80:83]
    ds_read_b128 v[32:35], v13 offset:32768
    ds_read_b128 v[36:39], v13 offset:33792
    v_mfma_f32_16x16x32_bf16 v[84:87], a[116:119], v[48:51], v[84:87]
    buffer_store_dwordx4 v[216:219], v11, s[12:15], s76 offen sc1
    v_mfma_f32_16x16x32_bf16 v[88:91], a[112:115], v[52:55], v[88:91]
    s_add_u32 s76, s76, 32768
    v_mfma_f32_16x16x32_bf16 v[92:95], a[116:119], v[52:55], v[92:95]
    buffer_store_dwordx4 v[220:223], v11, s[12:15], s76 offen sc1
    v_mfma_f32_16x16x32_bf16 v[80:83], a[120:123], v[56:59], v[80:83]
    ds_read_b128 v[40:43], v13 offset:34816
    ds_read_b128 v[44:47], v13 offset:35840
    v_mfma_f32_16x16x32_bf16 v[84:87], a[124:127], v[56:59], v[84:87]
    s_add_u32 s76, s76, 32768
    v_mfma_f32_16x16x32_bf16 v[88:91], a[120:123], v[60:63], v[88:91]
    buffer_store_dwordx4 v[224:227], v11, s[12:15], s76 offen sc1
    v_mfma_f32_16x16x32_bf16 v[92:95], a[124:127], v[60:63], v[92:95]
    s_add_u32 s76, s76, 32768
    s_add_u32 s48, s53, 524288
    s_add_u32 s46, s58, 2
    s_cmp_lt_u32 s46, s51
    s_cselect_b32 s48, s48, 0x20000000
    s_add_u32 s49, s48, 4096
    s_mov_b32 s59, s54
    s_waitcnt lgkmcnt(2)
    v_mfma_f32_16x16x32_bf16 v[80:83], a[128:131], v[32:35], v[80:83]
    ds_read_b128 v[48:51], v13 offset:36864
    ds_read_b128 v[52:55], v13 offset:37888
    v_mfma_f32_16x16x32_bf16 v[84:87], a[132:135], v[32:35], v[84:87]
    ds_read_b128 v[56:59], v13 offset:38912
    ds_read_b128 v[60:63], v13 offset:39936
    v_mfma_f32_16x16x32_bf16 v[88:91], a[128:131], v[36:39], v[88:91]
    s_add_u32 m0, s59, 0
    s_nop 0
    buffer_load_dwordx4 v10, s[12:15], s48 offen offset:0 sc1 lds
    v_mfma_f32_16x16x32_bf16 v[92:95], a[132:135], v[36:39], v[92:95]
    buffer_store_dwordx4 v[228:231], v11, s[12:15], s76 offen sc1
    s_waitcnt lgkmcnt(4)
    v_mfma_f32_16x16x32_bf16 v[80:83], a[136:139], v[40:43], v[80:83]
    ds_read_b128 v[32:35], v13 offset:40960
    ds_read_b128 v[36:39], v13 offset:41984
    v_mfma_f32_16x16x32_bf16 v[84:87], a[140:143], v[40:43], v[84:87]
    v_mfma_f32_16x16x32_bf16 v[88:91], a[136:139], v[44:47], v[88:91]
    buffer_load_dwordx4 v10, s[12:15], s48 offen offset:1024 sc1 lds
    v_mfma_f32_16x16x32_bf16 v[92:95], a[140:143], v[44:47], v[92:95]
    s_waitcnt lgkmcnt(4)
    v_mfma_f32_16x16x32_bf16 v[80:83], a[144:147], v[48:51], v[80:83]
    ds_read_b128 v[40:43], v13 offset:43008
    ds_read_b128 v[44:47], v13 offset:44032
    v_mfma_f32_16x16x32_bf16 v[84:87], a[148:151], v[48:51], v[84:87]
    v_mfma_f32_16x16x32_bf16 v[88:91], a[144:147], v[52:55], v[88:91]
    buffer_load_dwordx4 v10, s[12:15], s48 offen offset:2048 sc1 lds
    v_mfma_f32_16x16x32_bf16 v[92:95], a[148:151], v[52:55], v[92:95]
    s_waitcnt lgkmcnt(4)
    v_mfma_f32_16x16x32_bf16 v[80:83], a[152:155], v[56:59], v[80:83]
    ds_read_b128 v[48:51], v13 offset:45056
    ds_read_b128 v[52:55], v13 offset:46080
    v_mfma_f32_16x16x32_bf16 v[84:87], a[156:159], v[56:59], v[84:87]
    v_mfma_f32_16x16x32_bf16 v[88:91], a[152:155], v[60:63], v[88:91]
    buffer_load_dwordx4 v10, s[12:15], s48 offen offset:3072 sc1 lds
    v_mfma_f32_16x16x32_bf16 v[92:95], a[156:159], v[60:63], v[92:95]
    s_waitcnt lgkmcnt(4)
    v_mfma_f32_16x16x32_bf16 v[80:83], a[160:163], v[32:35], v[80:83]
    ds_read_b128 v[56:59], v13 offset:47104
    ds_read_b128 v[60:63], v13 offset:48128
    v_mfma_f32_16x16x32_bf16 v[84:87], a[164:167], v[32:35], v[84:87]
    v_mfma_f32_16x16x32_bf16 v[88:91], a[160:163], v[36:39], v[88:91]
    s_add_u32 m0, s59, 4096
    s_nop 0
    buffer_load_dwordx4 v10, s[12:15], s49 offen offset:0 sc1 lds
    v_mfma_f32_16x16x32_bf16 v[92:95], a[164:167], v[36:39], v[92:95]
    s_waitcnt lgkmcnt(4)
    v_mfma_f32_16x16x32_bf16 v[80:83], a[168:171], v[40:43], v[80:83]
    ds_read_b128 v[32:35], v13 offset:49152
    ds_read_b128 v[36:39], v13 offset:50176
    v_mfma_f32_16x16x32_bf16 v[84:87], a[172:175], v[40:43], v[84:87]
    v_mfma_f32_16x16x32_bf16 v[88:91], a[168:171], v[44:47], v[88:91]
    buffer_load_dwordx4 v10, s[12:15], s49 offen offset:1024 sc1 lds
    v_mfma_f32_16x16x32_bf16 v[92:95], a[172:175], v[44:47], v[92:95]
    s_waitcnt lgkmcnt(4)
    v_mfma_f32_16x16x32_bf16 v[80:83], a[176:179], v[48:51], v[80:83]
    ds_read_b128 v[40:43], v13 offset:51200
    ds_read_b128 v[44:47], v13 offset:52224
    v_mfma_f32_16x16x32_bf16 v[84:87], a[180:183], v[48:51], v[84:87]
    v_mfma_f32_16x16x32_bf16 v[88:91], a[176:179], v[52:55], v[88:91]
    buffer_load_dwordx4 v10, s[12:15], s49 offen offset:2048 sc1 lds
    v_mfma_f32_16x16x32_bf16 v[92:95], a[180:183], v[52:55], v[92:95]
    s_waitcnt lgkmcnt(4)
    v_mfma_f32_16x16x32_bf16 v[80:83], a[184:187], v[56:59], v[80:83]
    ds_read_b128 v[48:51], v13 offset:53248
    ds_read_b128 v[52:55], v13 offset:54272
    v_mfma_f32_16x16x32_bf16 v[84:87], a[188:191], v[56:59], v[84:87]
    v_mfma_f32_16x16x32_bf16 v[88:91], a[184:187], v[60:63], v[88:91]
    buffer_load_dwordx4 v10, s[12:15], s49 offen offset:3072 sc1 lds
    v_mfma_f32_16x16x32_bf16 v[92:95], a[188:191], v[60:63], v[92:95]
    s_waitcnt lgkmcnt(4)
    v_mfma_f32_16x16x32_bf16 v[80:83], a[192:195], v[32:35], v[80:83]
    ds_read_b128 v[56:59], v13 offset:55296
    ds_read_b128 v[60:63], v13 offset:56320
    v_mfma_f32_16x16x32_bf16 v[84:87], a[196:199], v[32:35], v[84:87]
    v_mfma_f32_16x16x32_bf16 v[88:91], a[192:195], v[36:39], v[88:91]
    v_mfma_f32_16x16x32_bf16 v[92:95], a[196:199], v[36:39], v[92:95]
    s_waitcnt lgkmcnt(4)
    v_mfma_f32_16x16x32_bf16 v[80:83], a[200:203], v[40:43], v[80:83]
    ds_read_b128 v[32:35], v13 offset:57344
    ds_read_b128 v[36:39], v13 offset:58368
    v_mfma_f32_16x16x32_bf16 v[84:87], a[204:207], v[40:43], v[84:87]
    v_mfma_f32_16x16x32_bf16 v[88:91], a[200:203], v[44:47], v[88:91]
    v_mfma_f32_16x16x32_bf16 v[92:95], a[204:207], v[44:47], v[92:95]
    s_waitcnt lgkmcnt(4)
    v_mfma_f32_16x16x32_bf16 v[80:83], a[208:211], v[48:51], v[80:83]
    ds_read_b128 v[40:43], v13 offset:59392
    ds_read_b128 v[44:47], v13 offset:60416
    v_mfma_f32_16x16x32_bf16 v[84:87], a[212:215], v[48:51], v[84:87]
    v_mfma_f32_16x16x32_bf16 v[88:91], a[208:211], v[52:55], v[88:91]
    v_mfma_f32_16x16x32_bf16 v[92:95], a[212:215], v[52:55], v[92:95]
    s_waitcnt lgkmcnt(4)
    v_mfma_f32_16x16x32_bf16 v[80:83], a[216:219], v[56:59], v[80:83]
    ds_read_b128 v[48:51], v13 offset:61440
    ds_read_b128 v[52:55], v13 offset:62464
    v_mfma_f32_16x16x32_bf16 v[84:87], a[220:223], v[56:59], v[84:87]
    v_mfma_f32_16x16x32_bf16 v[88:91], a[216:219], v[60:63], v[88:91]
    v_mfma_f32_16x16x32_bf16 v[92:95], a[220:223], v[60:63], v[92:95]
    s_waitcnt lgkmcnt(4)
    v_mfma_f32_16x16x32_bf16 v[80:83], a[224:227], v[32:35], v[80:83]
    ds_read_b128 v[56:59], v13 offset:63488
    ds_read_b128 v[60:63], v13 offset:64512
    v_mfma_f32_16x16x32_bf16 v[84:87], a[228:231], v[32:35], v[84:87]
    v_mfma_f32_16x16x32_bf16 v[88:91], a[224:227], v[36:39], v[88:91]
    v_mfma_f32_16x16x32_bf16 v[92:95], a[228:231], v[36:39], v[92:95]
    s_waitcnt lgkmcnt(4)
    v_mfma_f32_16x16x32_bf16 v[80:83], a[232:235], v[40:43], v[80:83]
    v_mfma_f32_16x16x32_bf16 v[84:87], a[236:239], v[40:43], v[84:87]
    v_mfma_f32_16x16x32_bf16 v[88:91], a[232:235], v[44:47], v[88:91]
    v_mfma_f32_16x16x32_bf16 v[92:95], a[236:239], v[44:47], v[92:95]
    s_waitcnt vmcnt(16) lgkmcnt(0)
    s_barrier
    v_mfma_f32_16x16x32_bf16 v[80:83], a[240:243], v[48:51], v[80:83]
    ds_read_b128 v[32:35], v14 offset:0
    ds_read_b128 v[36:39], v14 offset:1024
    v_mfma_f32_16x16x32_bf16 v[84:87], a[244:247], v[48:51], v[84:87]
    v_mfma_f32_16x16x32_bf16 v[88:91], a[240:243], v[52:55], v[88:91]
    v_mfma_f32_16x16x32_bf16 v[92:95], a[244:247], v[52:55], v[92:95]
    v_mfma_f32_16x16x32_bf16 v[80:83], a[248:251], v[56:59], v[80:83]
    ds_read_b128 v[40:43], v14 offset:2048
    ds_read_b128 v[44:47], v14 offset:3072
    v_mfma_f32_16x16x32_bf16 v[84:87], a[252:255], v[56:59], v[84:87]
    v_mfma_f32_16x16x32_bf16 v[88:91], a[248:251], v[60:63], v[88:91]
    v_mfma_f32_16x16x32_bf16 v[92:95], a[252:255], v[60:63], v[92:95]
    s_add_u32 s53, s53, 262144
    s_add_u32 s58, s58, 1
    v_swap_b32 v13, v14
    s_xor_b32 s54, s54, 65536
    s_xor_b32 s55, s55, 65536
    s_mov_b32 s76, s57
    v_swap_b32 v15, v16
    s_add_u32 s57, s57, 131072
    ds_write_b128 v7, v[80:83] offset:0
    ds_write_b128 v7, v[84:87] offset:64
    ds_write_b128 v7, v[88:91] offset:2304
    ds_write_b128 v7, v[92:95] offset:2368
    s_cmp_lt_u32 s58, s51
    s_cbranch_scc1 L_e_loop_140
    s_branch L_e_fin_142
L_e_one_141:
    s_waitcnt vmcnt(8)
    s_barrier
    ds_read_b128 v[32:35], v13 offset:0
    ds_read_b128 v[36:39], v13 offset:1024
    ds_read_b128 v[40:43], v13 offset:2048
    ds_read_b128 v[44:47], v13 offset:3072
    s_waitcnt lgkmcnt(2)
    v_mfma_f32_16x16x32_bf16 v[80:83], a[0:3], v[32:35], 0
    ds_read_b128 v[48:51], v13 offset:4096
    ds_read_b128 v[52:55], v13 offset:5120
    v_mfma_f32_16x16x32_bf16 v[84:87], a[4:7], v[32:35], 0
    ds_read_b128 v[56:59], v13 offset:6144
    ds_read_b128 v[60:63], v13 offset:7168
    v_mfma_f32_16x16x32_bf16 v[88:91], a[0:3], v[36:39], 0
    v_mfma_f32_16x16x32_bf16 v[92:95], a[4:7], v[36:39], 0
    s_waitcnt lgkmcnt(4)
    v_mfma_f32_16x16x32_bf16 v[80:83], a[8:11], v[40:43], v[80:83]
    ds_read_b128 v[32:35], v13 offset:8192
    ds_read_b128 v[36:39], v13 offset:9216
    v_mfma_f32_16x16x32_bf16 v[84:87], a[12:15], v[40:43], v[84:87]
    v_mfma_f32_16x16x32_bf16 v[88:91], a[8:11], v[44:47], v[88:91]
    v_mfma_f32_16x16x32_bf16 v[92:95], a[12:15], v[44:47], v[92:95]
    s_waitcnt lgkmcnt(4)
    v_mfma_f32_16x16x32_bf16 v[80:83], a[16:19], v[48:51], v[80:83]
    ds_read_b128 v[40:43], v13 offset:10240
    ds_read_b128 v[44:47], v13 offset:11264
    v_mfma_f32_16x16x32_bf16 v[84:87], a[20:23], v[48:51], v[84:87]
    v_mfma_f32_16x16x32_bf16 v[88:91], a[16:19], v[52:55], v[88:91]
    v_mfma_f32_16x16x32_bf16 v[92:95], a[20:23], v[52:55], v[92:95]
    s_waitcnt lgkmcnt(4)
    v_mfma_f32_16x16x32_bf16 v[80:83], a[24:27], v[56:59], v[80:83]
    ds_read_b128 v[48:51], v13 offset:12288
    ds_read_b128 v[52:55], v13 offset:13312
    v_mfma_f32_16x16x32_bf16 v[84:87], a[28:31], v[56:59], v[84:87]
    v_mfma_f32_16x16x32_bf16 v[88:91], a[24:27], v[60:63], v[88:91]
    v_mfma_f32_16x16x32_bf16 v[92:95], a[28:31], v[60:63], v[92:95]
    s_waitcnt lgkmcnt(4)
    v_mfma_f32_16x16x32_bf16 v[80:83], a[32:35], v[32:35], v[80:83]
    ds_read_b128 v[56:59], v13 offset:14336
    ds_read_b128 v[60:63], v13 offset:15360
    v_mfma_f32_16x16x32_bf16 v[84:87], a[36:39], v[32:35], v[84:87]
    v_mfma_f32_16x16x32_bf16 v[88:91], a[32:35], v[36:39], v[88:91]
    v_mfma_f32_16x16x32_bf16 v[92:95], a[36:39], v[36:39], v[92:95]
    s_waitcnt lgkmcnt(4)
    v_mfma_f32_16x16x32_bf16 v[80:83], a[40:43], v[40:43], v[80:83]
    ds_read_b128 v[32:35], v13 offset:16384
    ds_read_b128 v[36:39], v13 offset:17408
    v_mfma_f32_16x16x32_bf16 v[84:87], a[44:47], v[40:43], v[84:87]
    v_mfma_f32_16x16x32_bf16 v[88:91], a[40:43], v[44:47], v[88:91]
    v_mfma_f32_16x16x32_bf16 v[92:95], a[44:47], v[44:47], v[92:95]
    s_waitcnt lgkmcnt(4)
    v_mfma_f32_16x16x32_bf16 v[80:83], a[48:51], v[48:51], v[80:83]
    ds_read_b128 v[40:43], v13 offset:18432
    ds_read_b128 v[44:47], v13 offset:19456
    v_mfma_f32_16x16x32_bf16 v[84:87], a[52:55], v[48:51], v[84:87]
    v_mfma_f32_16x16x32_bf16 v[88:91], a[48:51], v[52:55], v[88:91]
    v_mfma_f32_16x16x32_bf16 v[92:95], a[52:55], v[52:55], v[92:95]
    s_waitcnt lgkmcnt(4)
    v_mfma_f32_16x16x32_bf16 v[80:83], a[56:59], v[56:59], v[80:83]
    ds_read_b128 v[48:51], v13 offset:20480
    ds_read_b128 v[52:55], v13 offset:21504
    v_mfma_f32_16x16x32_bf16 v[84:87], a[60:63], v[56:59], v[84:87]
    v_mfma_f32_16x16x32_bf16 v[88:91], a[56:59], v[60:63], v[88:91]
    v_mfma_f32_16x16x32_bf16 v[92:95], a[60:63], v[60:63], v[92:95]
    s_waitcnt lgkmcnt(4)
    v_mfma_f32_16x16x32_bf16 v[80:83], a[64:67], v[32:35], v[80:83]
    ds_read_b128 v[56:59], v13 offset:22528
    ds_read_b128 v[60:63], v13 offset:23552
    v_mfma_f32_16x16x32_bf16 v[84:87], a[68:71], v[32:35], v[84:87]
    v_mfma_f32_16x16x32_bf16 v[88:91], a[64:67], v[36:39], v[88:91]
    v_mfma_f32_16x16x32_bf16 v[92:95], a[68:71], v[36:39], v[92:95]
    s_waitcnt lgkmcnt(4)
    v_mfma_f32_16x16x32_bf16 v[80:83], a[72:75], v[40:43], v[80:83]
    ds_read_b128 v[32:35], v13 offset:24576
    ds_read_b128 v[36:39], v13 offset:25600
    v_mfma_f32_16x16x32_bf16 v[84:87], a[76:79], v[40:43], v[84:87]
    v_mfma_f32_16x16x32_bf16 v[88:91], a[72:75], v[44:47], v[88:91]
    v_mfma_f32_16x16x32_bf16 v[92:95], a[76:79], v[44:47], v[92:95]
    s_waitcnt lgkmcnt(4)
    v_mfma_f32_16x16x32_bf16 v[80:83], a[80:83], v[48:51], v[80:83]
    ds_read_b128 v[40:43], v13 offset:26624
    ds_read_b128 v[44:47], v13 offset:27648
    v_mfma_f32_16x16x32_bf16 v[84:87], a[84:87], v[48:51], v[84:87]
    v_mfma_f32_16x16x32_bf16 v[88:91], a[80:83], v[52:55], v[88:91]
    v_mfma_f32_16x16x32_bf16 v[92:95], a[84:87], v[52:55], v[92:95]
    s_waitcnt lgkmcnt(4)
    v_mfma_f32_16x16x32_bf16 v[80:83], a[88:91], v[56:59], v[80:83]
    ds_read_b128 v[48:51], v13 offset:28672
    ds_read_b128 v[52:55], v13 offset:29696
    v_mfma_f32_16x16x32_bf16 v[84:87], a[92:95], v[56:59], v[84:87]
    v_mfma_f32_16x16x32_bf16 v[88:91], a[88:91], v[60:63], v[88:91]
    v_mfma_f32_16x16x32_bf16 v[92:95], a[92:95], v[60:63], v[92:95]
    s_waitcnt lgkmcnt(4)
    v_mfma_f32_16x16x32_bf16 v[80:83], a[96:99], v[32:35], v[80:83]
    ds_read_b128 v[56:59], v13 offset:30720
    ds_read_b128 v[60:63], v13 offset:31744
    v_mfma_f32_16x16x32_bf16 v[84:87], a[100:103], v[32:35], v[84:87]
    v_mfma_f32_16x16x32_bf16 v[88:91], a[96:99], v[36:39], v[88:91]
    v_mfma_f32_16x16x32_bf16 v[92:95], a[100:103], v[36:39], v[92:95]
    s_waitcnt lgkmcnt(4)
    v_mfma_f32_16x16x32_bf16 v[80:83], a[104:107], v[40:43], v[80:83]
    v_mfma_f32_16x16x32_bf16 v[84:87], a[108:111], v[40:43], v[84:87]
    v_mfma_f32_16x16x32_bf16 v[88:91], a[104:107], v[44:47], v[88:91]
    v_mfma_f32_16x16x32_bf16 v[92:95], a[108:111], v[44:47], v[92:95]
    s_waitcnt vmcnt(0) lgkmcnt(0)
    s_barrier
    v_mfma_f32_16x16x32_bf16 v[80:83], a[112:115], v[48:51], v[80:83]
    ds_read_b128 v[32:35], v13 offset:32768
    ds_read_b128 v[36:39], v13 offset:33792
    v_mfma_f32_16x16x32_bf16 v[84:87], a[116:119], v[48:51], v[84:87]
    v_mfma_f32_16x16x32_bf16 v[88:91], a[112:115], v[52:55], v[88:91]
    v_mfma_f32_16x16x32_bf16 v[92:95], a[116:119], v[52:55], v[92:95]
    v_mfma_f32_16x16x32_bf16 v[80:83], a[120:123], v[56:59], v[80:83]
    ds_read_b128 v[40:43], v13 offset:34816
    ds_read_b128 v[44:47], v13 offset:35840
    v_mfma_f32_16x16x32_bf16 v[84:87], a[124:127], v[56:59], v[84:87]
    v_mfma_f32_16x16x32_bf16 v[88:91], a[120:123], v[60:63], v[88:91]
    v_mfma_f32_16x16x32_bf16 v[92:95], a[124:127], v[60:63], v[92:95]
    s_waitcnt lgkmcnt(2)
    v_mfma_f32_16x16x32_bf16 v[80:83], a[128:131], v[32:35], v[80:83]
    ds_read_b128 v[48:51], v13 offset:36864
    ds_read_b128 v[52:55], v13 offset:37888
    v_mfma_f32_16x16x32_bf16 v[84:87], a[132:135], v[32:35], v[84:87]
    ds_read_b128 v[56:59], v13 offset:38912
    ds_read_b128 v[60:63], v13 offset:39936
    v_mfma_f32_16x16x32_bf16 v[88:91], a[128:131], v[36:39], v[88:91]
    v_mfma_f32_16x16x32_bf16 v[92:95], a[132:135], v[36:39], v[92:95]
    s_waitcnt lgkmcnt(4)
    v_mfma_f32_16x16x32_bf16 v[80:83], a[136:139], v[40:43], v[80:83]
    ds_read_b128 v[32:35], v13 offset:40960
    ds_read_b128 v[36:39], v13 offset:41984
    v_mfma_f32_16x16x32_bf16 v[84:87], a[140:143], v[40:43], v[84:87]
    v_mfma_f32_16x16x32_bf16 v[88:91], a[136:139], v[44:47], v[88:91]
    v_mfma_f32_16x16x32_bf16 v[92:95], a[140:143], v[44:47], v[92:95]
    s_waitcnt lgkmcnt(4)
    v_mfma_f32_16x16x32_bf16 v[80:83], a[144:147], v[48:51], v[80:83]
    ds_read_b128 v[40:43], v13 offset:43008
    ds_read_b128 v[44:47], v13 offset:44032
    v_mfma_f32_16x16x32_bf16 v[84:87], a[148:151], v[48:51], v[84:87]
    v_mfma_f32_16x16x32_bf16 v[88:91], a[144:147], v[52:55], v[88:91]
    v_mfma_f32_16x16x32_bf16 v[92:95], a[148:151], v[52:55], v[92:95]
    s_waitcnt lgkmcnt(4)
    v_mfma_f32_16x16x32_bf16 v[80:83], a[152:155], v[56:59], v[80:83]
    ds_read_b128 v[48:51], v13 offset:45056
    ds_read_b128 v[52:55], v13 offset:46080
    v_mfma_f32_16x16x32_bf16 v[84:87], a[156:159], v[56:59], v[84:87]
    v_mfma_f32_16x16x32_bf16 v[88:91], a[152:155], v[60:63], v[88:91]
    v_mfma_f32_16x16x32_bf16 v[92:95], a[156:159], v[60:63], v[92:95]
    s_waitcnt lgkmcnt(4)
    v_mfma_f32_16x16x32_bf16 v[80:83], a[160:163], v[32:35], v[80:83]
    ds_read_b128 v[56:59], v13 offset:47104
    ds_read_b128 v[60:63], v13 offset:48128
    v_mfma_f32_16x16x32_bf16 v[84:87], a[164:167], v[32:35], v[84:87]
    v_mfma_f32_16x16x32_bf16 v[88:91], a[160:163], v[36:39], v[88:91]
    v_mfma_f32_16x16x32_bf16 v[92:95], a[164:167], v[36:39], v[92:95]
    s_waitcnt lgkmcnt(4)
    v_mfma_f32_16x16x32_bf16 v[80:83], a[168:171], v[40:43], v[80:83]
    ds_read_b128 v[32:35], v13 offset:49152
    ds_read_b128 v[36:39], v13 offset:50176
    v_mfma_f32_16x16x32_bf16 v[84:87], a[172:175], v[40:43], v[84:87]
    v_mfma_f32_16x16x32_bf16 v[88:91], a[168:171], v[44:47], v[88:91]
    v_mfma_f32_16x16x32_bf16 v[92:95], a[172:175], v[44:47], v[92:95]
    s_waitcnt lgkmcnt(4)
    v_mfma_f32_16x16x32_bf16 v[80:83], a[176:179], v[48:51], v[80:83]
    ds_read_b128 v[40:43], v13 offset:51200
    ds_read_b128 v[44:47], v13 offset:52224
    v_mfma_f32_16x16x32_bf16 v[84:87], a[180:183], v[48:51], v[84:87]
    v_mfma_f32_16x16x32_bf16 v[88:91], a[176:179], v[52:55], v[88:91]
    v_mfma_f32_16x16x32_bf16 v[92:95], a[180:183], v[52:55], v[92:95]
    s_waitcnt lgkmcnt(4)
    v_mfma_f32_16x16x32_bf16 v[80:83], a[184:187], v[56:59], v[80:83]
    ds_read_b128 v[48:51], v13 offset:53248
    ds_read_b128 v[52:55], v13 offset:54272
    v_mfma_f32_16x16x32_bf16 v[84:87], a[188:191], v[56:59], v[84:87]
    v_mfma_f32_16x16x32_bf16 v[88:91], a[184:187], v[60:63], v[88:91]
    v_mfma_f32_16x16x32_bf16 v[92:95], a[188:191], v[60:63], v[92:95]
    s_waitcnt lgkmcnt(4)
    v_mfma_f32_16x16x32_bf16 v[80:83], a[192:195], v[32:35], v[80:83]
    ds_read_b128 v[56:59], v13 offset:55296
    ds_read_b128 v[60:63], v13 offset:56320
    v_mfma_f32_16x16x32_bf16 v[84:87], a[196:199], v[32:35], v[84:87]
    v_mfma_f32_16x16x32_bf16 v[88:91], a[192:195], v[36:39], v[88:91]
    v_mfma_f32_16x16x32_bf16 v[92:95], a[196:199], v[36:39], v[92:95]
    s_waitcnt lgkmcnt(4)
    v_mfma_f32_16x16x32_bf16 v[80:83], a[200:203], v[40:43], v[80:83]
    ds_read_b128 v[32:35], v13 offset:57344
    ds_read_b128 v[36:39], v13 offset:58368
    v_mfma_f32_16x16x32_bf16 v[84:87], a[204:207], v[40:43], v[84:87]
    v_mfma_f32_16x16x32_bf16 v[88:91], a[200:203], v[44:47], v[88:91]
    v_mfma_f32_16x16x32_bf16 v[92:95], a[204:207], v[44:47], v[92:95]
    s_waitcnt lgkmcnt(4)
    v_mfma_f32_16x16x32_bf16 v[80:83], a[208:211], v[48:51], v[80:83]
    ds_read_b128 v[40:43], v13 offset:59392
    ds_read_b128 v[44:47], v13 offset:60416
    v_mfma_f32_16x16x32_bf16 v[84:87], a[212:215], v[48:51], v[84:87]
    v_mfma_f32_16x16x32_bf16 v[88:91], a[208:211], v[52:55], v[88:91]
    v_mfma_f32_16x16x32_bf16 v[92:95], a[212:215], v[52:55], v[92:95]
    s_waitcnt lgkmcnt(4)
    v_mfma_f32_16x16x32_bf16 v[80:83], a[216:219], v[56:59], v[80:83]
    ds_read_b128 v[48:51], v13 offset:61440
    ds_read_b128 v[52:55], v13 offset:62464
    v_mfma_f32_16x16x32_bf16 v[84:87], a[220:223], v[56:59], v[84:87]
    v_mfma_f32_16x16x32_bf16 v[88:91], a[216:219], v[60:63], v[88:91]
    v_mfma_f32_16x16x32_bf16 v[92:95], a[220:223], v[60:63], v[92:95]
    s_waitcnt lgkmcnt(4)
    v_mfma_f32_16x16x32_bf16 v[80:83], a[224:227], v[32:35], v[80:83]
    ds_read_b128 v[56:59], v13 offset:63488
    ds_read_b128 v[60:63], v13 offset:64512
    v_mfma_f32_16x16x32_bf16 v[84:87], a[228:231], v[32:35], v[84:87]
    v_mfma_f32_16x16x32_bf16 v[88:91], a[224:227], v[36:39], v[88:91]
    v_mfma_f32_16x16x32_bf16 v[92:95], a[228:231], v[36:39], v[92:95]
    s_waitcnt lgkmcnt(4)
    v_mfma_f32_16x16x32_bf16 v[80:83], a[232:235], v[40:43], v[80:83]
    v_mfma_f32_16x16x32_bf16 v[84:87], a[236:239], v[40:43], v[84:87]
    v_mfma_f32_16x16x32_bf16 v[88:91], a[232:235], v[44:47], v[88:91]
    v_mfma_f32_16x16x32_bf16 v[92:95], a[236:239], v[44:47], v[92:95]
    s_waitcnt lgkmcnt(0)
    v_mfma_f32_16x16x32_bf16 v[80:83], a[240:243], v[48:51], v[80:83]
    v_mfma_f32_16x16x32_bf16 v[84:87], a[244:247], v[48:51], v[84:87]
    v_mfma_f32_16x16x32_bf16 v[88:91], a[240:243], v[52:55], v[88:91]
    v_mfma_f32_16x16x32_bf16 v[92:95], a[244:247], v[52:55], v[92:95]
    v_mfma_f32_16x16x32_bf16 v[80:83], a[248:251], v[56:59], v[80:83]
    v_mfma_f32_16x16x32_bf16 v[84:87], a[252:255], v[56:59], v[84:87]
    v_mfma_f32_16x16x32_bf16 v[88:91], a[248:251], v[60:63], v[88:91]
    v_mfma_f32_16x16x32_bf16 v[92:95], a[252:255], v[60:63], v[92:95]
    s_mov_b32 s76, s57
    s_nop 6
    ds_write_b128 v7, v[80:83] offset:0
    ds_write_b128 v7, v[84:87] offset:64
    ds_write_b128 v7, v[88:91] offset:2304
    ds_write_b128 v7, v[92:95] offset:2368
L_e_fin_142:
    s_waitcnt lgkmcnt(0)
    ds_read_b128 v[216:219], v8 offset:0
    ds_read_b128 v[220:223], v8 offset:1152
    ds_read_b128 v[224:227], v8 offset:2304
    ds_read_b128 v[228:231], v8 offset:3456
    s_waitcnt lgkmcnt(0)
    buffer_store_dwordx4 v[216:219], v11, s[12:15], s76 offen sc1
    s_add_u32 s76, s76, 32768
    buffer_store_dwordx4 v[220:223], v11, s[12:15], s76 offen sc1
    s_add_u32 s76, s76, 32768
    buffer_store_dwordx4 v[224:227], v11, s[12:15], s76 offen sc1
    s_add_u32 s76, s76, 32768
    buffer_store_dwordx4 v[228:231], v11, s[12:15], s76 offen sc1
    s_waitcnt vmcnt(0)
    s_barrier
    s_cmp_lg_u32 s44, 0
    s_cbranch_scc1 L_pub_143
    v_mov_b32 v30, s62
    v_mov_b32 v31, 0
    s_mov_b64 exec, 1
    buffer_store_dword v30, v31, s[12:15], s67 offen sc1
    s_mov_b64 exec, -1
L_pub_143:
    s_branch L_a_loop_126
L_role_b_122:
    s_load_dwordx2 s[6:7], s[0:1], 64
    s_load_dwordx2 s[8:9], s[0:1], 72
    s_waitcnt lgkmcnt(0)
    s_mov_b32 s24, s6
    s_and_b32 s25, s7, 0xffff
    s_mov_b32 s26, 0x700000
    s_mov_b32 s27, 0x00020000
    s_mov_b32 s32, s8
    s_and_b32 s33, s9, 0xffff
    s_mov_b32 s34, 0x1c00
    s_mov_b32 s35, 0x00020000
    s_min_u32 s45, s41, 27
    s_lshl_b32 s46, s45, 8
    s_waitcnt vmcnt(0)
    s_barrier
    v_lshrrev_b32 v20, 4, v1
    s_lshl_b32 s45, s44, 2
    v_add_u32 v21, s45, v20
    s_mov_b32 s45, 7168
    v_mul_lo_u32 v21, v21, s45
    v_lshlrev_b32 v22, 2, v20
    v_and_b32 v23, 15, v1
    v_xor_b32 v22, v22, v23
    v_lshlrev_b32 v22, 4, v22
    v_add_u32 v21, v21, v22
    v_bfe_u32 v22, v1, 2, 2
    v_lshlrev_b32 v23, 3, v20
    v_add_u32 v23, v23, v22
    v_lshlrev_b32 v23, 8, v23
    v_xor_b32 v22, s44, v22
    v_lshlrev_b32 v22, 6, v22
    v_add_u32 v23, v23, v22
    v_and_b32 v22, 3, v1
    v_lshlrev_b32 v22, 4, v22
    v_add_u32 v23, v23, v22
    v_add_u32 v24, 65536, v23
    v_add_u32 v25, 131072, v23
    s_lshl_b32 s47, s44, 10
    s_add_u32 s45, s46, 0x0
    s_add_u32 m0, s47, 0
    s_nop 0
    buffer_load_dwordx4 v21, s[24:27], s45 offen  lds
    s_add_u32 s45, s46, 0x1c000
    s_add_u32 m0, s47, 4096
    s_nop 0
    buffer_load_dwordx4 v21, s[24:27], s45 offen  lds
    s_add_u32 s45, s46, 0x38000
    s_add_u32 m0, s47, 8192
    s_nop 0
    buffer_load_dwordx4 v21, s[24:27], s45 offen  lds
    s_add_u32 s45, s46, 0x54000
    s_add_u32 m0, s47, 12288
    s_nop 0
    buffer_load_dwordx4 v21, s[24:27], s45 offen  lds
    s_add_u32 s45, s46, 0x70000
    s_add_u32 m0, s47, 16384
    s_nop 0
    buffer_load_dwordx4 v21, s[24:27], s45 offen  lds
    s_add_u32 s45, s46, 0x8c000
    s_add_u32 m0, s47, 20480
    s_nop 0
    buffer_load_dwordx4 v21, s[24:27], s45 offen  lds
    s_add_u32 s45, s46, 0xa8000
    s_add_u32 m0, s47, 24576
    s_nop 0
    buffer_load_dwordx4 v21, s[24:27], s45 offen  lds
    s_add_u32 s45, s46, 0xc4000
    s_add_u32 m0, s47, 28672
    s_nop 0
    buffer_load_dwordx4 v21, s[24:27], s45 offen  lds
    s_add_u32 s45, s46, 0xe0000
    s_add_u32 m0, s47, 32768
    s_nop 0
    buffer_load_dwordx4 v21, s[24:27], s45 offen  lds
    s_add_u32 s45, s46, 0xfc000
    s_add_u32 m0, s47, 36864
    s_nop 0
    buffer_load_dwordx4 v21, s[24:27], s45 offen  lds
    s_add_u32 s45, s46, 0x118000
    s_add_u32 m0, s47, 40960
    s_nop 0
    buffer_load_dwordx4 v21, s[24:27], s45 offen  lds
    s_add_u32 s45, s46, 0x134000
    s_add_u32 m0, s47, 45056
    s_nop 0
    buffer_load_dwordx4 v21, s[24:27], s45 offen  lds
    s_add_u32 s45, s46, 0x150000
    s_add_u32 m0, s47, 49152
    s_nop 0
    buffer_load_dwordx4 v21, s[24:27], s45 offen  lds
    s_add_u32 s45, s46, 0x16c000
    s_add_u32 m0, s47, 53248
    s_nop 0
    buffer_load_dwordx4 v21, s[24:27], s45 offen  lds
    s_add_u32 s45, s46, 0x188000
    s_add_u32 m0, s47, 57344
    s_nop 0
    buffer_load_dwordx4 v21, s[24:27], s45 offen  lds
    s_add_u32 s45, s46, 0x1a4000
    s_add_u32 m0, s47, 61440
    s_nop 0
    buffer_load_dwordx4 v21, s[24:27], s45 offen  lds
    s_add_u32 s45, s46, 0x1c0000
    s_add_u32 m0, s47, 65536
    s_nop 0
    buffer_load_dwordx4 v21, s[24:27], s45 offen  lds
    s_add_u32 s45, s46, 0x1dc000
    s_add_u32 m0, s47, 69632
    s_nop 0
    buffer_load_dwordx4 v21, s[24:27], s45 offen  lds
    s_add_u32 s45, s46, 0x1f8000
    s_add_u32 m0, s47, 73728
    s_nop 0
    buffer_load_dwordx4 v21, s[24:27], s45 offen  lds
    s_add_u32 s45, s46, 0x214000
    s_add_u32 m0, s47, 77824
    s_nop 0
    buffer_load_dwordx4 v21, s[24:27], s45 offen  lds
    s_add_u32 s45, s46, 0x230000
    s_add_u32 m0, s47, 81920
    s_nop 0
    buffer_load_dwordx4 v21, s[24:27], s45 offen  lds
    s_add_u32 s45, s46, 0x24c000
    s_add_u32 m0, s47, 86016
    s_nop 0
    buffer_load_dwordx4 v21, s[24:27], s45 offen  lds
    s_add_u32 s45, s46, 0x268000
    s_add_u32 m0, s47, 90112
    s_nop 0
    buffer_load_dwordx4 v21, s[24:27], s45 offen  lds
    s_add_u32 s45, s46, 0x284000
    s_add_u32 m0, s47, 94208
    s_nop 0
    buffer_load_dwordx4 v21, s[24:27], s45 offen  lds
    s_add_u32 s45, s46, 0x2a0000
    s_add_u32 m0, s47, 98304
    s_nop 0
    buffer_load_dwordx4 v21, s[24:27], s45 offen  lds
    s_add_u32 s45, s46, 0x2bc000
    s_add_u32 m0, s47, 102400
    s_nop 0
    buffer_load_dwordx4 v21, s[24:27], s45 offen  lds
    s_add_u32 s45, s46, 0x2d8000
    s_add_u32 m0, s47, 106496
    s_nop 0
    buffer_load_dwordx4 v21, s[24:27], s45 offen  lds
    s_add_u32 s45, s46, 0x2f4000
    s_add_u32 m0, s47, 110592
    s_nop 0
    buffer_load_dwordx4 v21, s[24:27], s45 offen  lds
    s_add_u32 s45, s46, 0x310000
    s_add_u32 m0, s47, 114688
    s_nop 0
    buffer_load_dwordx4 v21, s[24:27], s45 offen  lds
    s_add_u32 s45, s46, 0x32c000
    s_add_u32 m0, s47, 118784
    s_nop 0
    buffer_load_dwordx4 v21, s[24:27], s45 offen  lds
    s_add_u32 s45, s46, 0x348000
    s_add_u32 m0, s47, 122880
    s_nop 0
    buffer_load_dwordx4 v21, s[24:27], s45 offen  lds
    s_add_u32 s45, s46, 0x364000
    s_add_u32 m0, s47, 126976
    s_nop 0
    buffer_load_dwordx4 v21, s[24:27], s45 offen  lds
    s_waitcnt vmcnt(28)
    s_barrier
    s_add_u32 s45, s46, 0x380000
    s_add_u32 m0, s47, 131072
    s_nop 0
    buffer_load_dwordx4 v21, s[24:27], s45 offen  lds
    s_add_u32 s45, s46, 0x39c000
    s_add_u32 m0, s47, 135168
    s_nop 0
    buffer_load_dwordx4 v21, s[24:27], s45 offen  lds
    s_add_u32 s45, s46, 0x3b8000
    s_add_u32 m0, s47, 139264
    s_nop 0
    buffer_load_dwordx4 v21, s[24:27], s45 offen  lds
    s_add_u32 s45, s46, 0x3d4000
    s_add_u32 m0, s47, 143360
    s_nop 0
    buffer_load_dwordx4 v21, s[24:27], s45 offen  lds
    ds_read_b64_tr_b16 a[0:1], v23 offset:0
    ds_read_b64_tr_b16 a[2:3], v23 offset:1024
    ds_read_b64_tr_b16 a[4:5], v23 offset:8
    ds_read_b64_tr_b16 a[6:7], v23 offset:1032
    ds_read_b64_tr_b16 a[8:9], v23 offset:8192
    ds_read_b64_tr_b16 a[10:11], v23 offset:9216
    ds_read_b64_tr_b16 a[12:13], v23 offset:8200
    ds_read_b64_tr_b16 a[14:15], v23 offset:9224
    s_waitcnt lgkmcnt(0)
    s_waitcnt vmcnt(28)
    s_barrier
    s_add_u32 s45, s46, 0x3f0000
    s_add_u32 m0, s47, 0
    s_nop 0
    buffer_load_dwordx4 v21, s[24:27], s45 offen  lds
    s_add_u32 s45, s46, 0x40c000
    s_add_u32 m0, s47, 4096
    s_nop 0
    buffer_load_dwordx4 v21, s[24:27], s45 offen  lds
    s_add_u32 s45, s46, 0x428000
    s_add_u32 m0, s47, 8192
    s_nop 0
    buffer_load_dwordx4 v21, s[24:27], s45 offen  lds
    s_add_u32 s45, s46, 0x444000
    s_add_u32 m0, s47, 12288
    s_nop 0
    buffer_load_dwordx4 v21, s[24:27], s45 offen  lds
    ds_read_b64_tr_b16 a[16:17], v23 offset:16384
    ds_read_b64_tr_b16 a[18:19], v23 offset:17408
    ds_read_b64_tr_b16 a[20:21], v23 offset:16392
    ds_read_b64_tr_b16 a[22:23], v23 offset:17416
    ds_read_b64_tr_b16 a[24:25], v23 offset:24576
    ds_read_b64_tr_b16 a[26:27], v23 offset:25600
    ds_read_b64_tr_b16 a[28:29], v23 offset:24584
    ds_read_b64_tr_b16 a[30:31], v23 offset:25608
    s_waitcnt lgkmcnt(0)
    s_waitcnt vmcnt(28)
    s_barrier
    s_add_u32 s45, s46, 0x460000
    s_add_u32 m0, s47, 16384
    s_nop 0
    buffer_load_dwordx4 v21, s[24:27], s45 offen  lds
    s_add_u32 s45, s46, 0x47c000
    s_add_u32 m0, s47, 20480
    s_nop 0
    buffer_load_dwordx4 v21, s[24:27], s45 offen  lds
    s_add_u32 s45, s46, 0x498000
    s_add_u32 m0, s47, 24576
    s_nop 0
    buffer_load_dwordx4 v21, s[24:27], s45 offen  lds
    s_add_u32 s45, s46, 0x4b4000
    s_add_u32 m0, s47, 28672
    s_nop 0
    buffer_load_dwordx4 v21, s[24:27], s45 offen  lds
    ds_read_b64_tr_b16 a[32:33], v23 offset:32768
    ds_read_b64_tr_b16 a[34:35], v23 offset:33792
    ds_read_b64_tr_b16 a[36:37], v23 offset:32776
    ds_read_b64_tr_b16 a[38:39], v23 offset:33800
    ds_read_b64_tr_b16 a[40:41], v23 offset:40960
    ds_read_b64_tr_b16 a[42:43], v23 offset:41984
    ds_read_b64_tr_b16 a[44:45], v23 offset:40968
    ds_read_b64_tr_b16 a[46:47], v23 offset:41992
    s_waitcnt lgkmcnt(0)
    s_waitcnt vmcnt(28)
    s_barrier
    s_add_u32 s45, s46, 0x4d0000
    s_add_u32 m0, s47, 32768
    s_nop 0
    buffer_load_dwordx4 v21, s[24:27], s45 offen  lds
    s_add_u32 s45, s46, 0x4ec000
    s_add_u32 m0, s47, 36864
    s_nop 0
    buffer_load_dwordx4 v21, s[24:27], s45 offen  lds
    s_add_u32 s45, s46, 0x508000
    s_add_u32 m0, s47, 40960
    s_nop 0
    buffer_load_dwordx4 v21, s[24:27], s45 offen  lds
    s_add_u32 s45, s46, 0x524000
    s_add_u32 m0, s47, 45056
    s_nop 0
    buffer_load_dwordx4 v21, s[24:27], s45 offen  lds
    ds_read_b64_tr_b16 a[48:49], v23 offset:49152
    ds_read_b64_tr_b16 a[50:51], v23 offset:50176
    ds_read_b64_tr_b16 a[52:53], v23 offset:49160
    ds_read_b64_tr_b16 a[54:55], v23 offset:50184
    ds_read_b64_tr_b16 a[56:57], v23 offset:57344
    ds_read_b64_tr_b16 a[58:59], v23 offset:58368
    ds_read_b64_tr_b16 a[60:61], v23 offset:57352
    ds_read_b64_tr_b16 a[62:63], v23 offset:58376
    s_waitcnt lgkmcnt(0)
    s_waitcnt vmcnt(28)
    s_barrier
    s_add_u32 s45, s46, 0x540000
    s_add_u32 m0, s47, 49152
    s_nop 0
    buffer_load_dwordx4 v21, s[24:27], s45 offen  lds
    s_add_u32 s45, s46, 0x55c000
    s_add_u32 m0, s47, 53248
    s_nop 0
    buffer_load_dwordx4 v21, s[24:27], s45 offen  lds
    s_add_u32 s45, s46, 0x578000
    s_add_u32 m0, s47, 57344
    s_nop 0
    buffer_load_dwordx4 v21, s[24:27], s45 offen  lds
    s_add_u32 s45, s46, 0x594000
    s_add_u32 m0, s47, 61440
    s_nop 0
    buffer_load_dwordx4 v21, s[24:27], s45 offen  lds
    ds_read_b64_tr_b16 a[64:65], v24 offset:0
    ds_read_b64_tr_b16 a[66:67], v24 offset:1024
    ds_read_b64_tr_b16 a[68:69], v24 offset:8
    ds_read_b64_tr_b16 a[70:71], v24 offset:1032
    ds_read_b64_tr_b16 a[72:73], v24 offset:8192
    ds_read_b64_tr_b16 a[74:75], v24 offset:9216
    ds_read_b64_tr_b16 a[76:77], v24 offset:8200
    ds_read_b64_tr_b16 a[78:79], v24 offset:9224
    s_waitcnt lgkmcnt(0)
    s_waitcnt vmcnt(28)
    s_barrier
    s_add_u32 s45, s46, 0x5b0000
    s_add_u32 m0, s47, 65536
    s_nop 0
    buffer_load_dwordx4 v21, s[24:27], s45 offen  lds
    s_add_u32 s45, s46, 0x5cc000
    s_add_u32 m0, s47, 69632
    s_nop 0
    buffer_load_dwordx4 v21, s[24:27], s45 offen  lds
    s_add_u32 s45, s46, 0x5e8000
    s_add_u32 m0, s47, 73728
    s_nop 0
    buffer_load_dwordx4 v21, s[24:27], s45 offen  lds
    s_add_u32 s45, s46, 0x604000
    s_add_u32 m0, s47, 77824
    s_nop 0
    buffer_load_dwordx4 v21, s[24:27], s45 offen  lds
    ds_read_b64_tr_b16 a[80:81], v24 offset:16384
    ds_read_b64_tr_b16 a[82:83], v24 offset:17408
    ds_read_b64_tr_b16 a[84:85], v24 offset:16392
    ds_read_b64_tr_b16 a[86:87], v24 offset:17416
    ds_read_b64_tr_b16 a[88:89], v24 offset:24576
    ds_read_b64_tr_b16 a[90:91], v24 offset:25600
    ds_read_b64_tr_b16 a[92:93], v24 offset:24584
    ds_read_b64_tr_b16 a[94:95], v24 offset:25608
    s_waitcnt lgkmcnt(0)
    s_waitcnt vmcnt(28)
    s_barrier
    s_add_u32 s45, s46, 0x620000
    s_add_u32 m0, s47, 81920
    s_nop 0
    buffer_load_dwordx4 v21, s[24:27], s45 offen  lds
    s_add_u32 s45, s46, 0x63c000
    s_add_u32 m0, s47, 86016
    s_nop 0
    buffer_load_dwordx4 v21, s[24:27], s45 offen  lds
    s_add_u32 s45, s46, 0x658000
    s_add_u32 m0, s47, 90112
    s_nop 0
    buffer_load_dwordx4 v21, s[24:27], s45 offen  lds
    s_add_u32 s45, s46, 0x674000
    s_add_u32 m0, s47, 94208
    s_nop 0
    buffer_load_dwordx4 v21, s[24:27], s45 offen  lds
    ds_read_b64_tr_b16 a[96:97], v24 offset:32768
    ds_read_b64_tr_b16 a[98:99], v24 offset:33792
    ds_read_b64_tr_b16 a[100:101], v24 offset:32776
    ds_read_b64_tr_b16 a[102:103], v24 offset:33800
    ds_read_b64_tr_b16 a[104:105], v24 offset:40960
    ds_read_b64_tr_b16 a[106:107], v24 offset:41984
    ds_read_b64_tr_b16 a[108:109], v24 offset:40968
    ds_read_b64_tr_b16 a[110:111], v24 offset:41992
    s_waitcnt lgkmcnt(0)
    s_waitcnt vmcnt(28)
    s_barrier
    s_add_u32 s45, s46, 0x690000
    s_add_u32 m0, s47, 98304
    s_nop 0
    buffer_load_dwordx4 v21, s[24:27], s45 offen  lds
    s_add_u32 s45, s46, 0x6ac000
    s_add_u32 m0, s47, 102400
    s_nop 0
    buffer_load_dwordx4 v21, s[24:27], s45 offen  lds
    s_add_u32 s45, s46, 0x6c8000
    s_add_u32 m0, s47, 106496
    s_nop 0
    buffer_load_dwordx4 v21, s[24:27], s45 offen  lds
    s_add_u32 s45, s46, 0x6e4000
    s_add_u32 m0, s47, 110592
    s_nop 0
    buffer_load_dwordx4 v21, s[24:27], s45 offen  lds
    ds_read_b64_tr_b16 a[112:113], v24 offset:49152
    ds_read_b64_tr_b16 a[114:115], v24 offset:50176
    ds_read_b64_tr_b16 a[116:117], v24 offset:49160
    ds_read_b64_tr_b16 a[118:119], v24 offset:50184
    ds_read_b64_tr_b16 a[120:121], v24 offset:57344
    ds_read_b64_tr_b16 a[122:123], v24 offset:58368
    ds_read_b64_tr_b16 a[124:125], v24 offset:57352
    ds_read_b64_tr_b16 a[126:127], v24 offset:58376
    s_waitcnt lgkmcnt(0)
    s_waitcnt vmcnt(28)
    s_barrier
    ds_read_b64_tr_b16 a[128:129], v25 offset:0
    ds_read_b64_tr_b16 a[130:131], v25 offset:1024
    ds_read_b64_tr_b16 a[132:133], v25 offset:8
    ds_read_b64_tr_b16 a[134:135], v25 offset:1032
    ds_read_b64_tr_b16 a[136:137], v25 offset:8192
    ds_read_b64_tr_b16 a[138:139], v25 offset:9216
    ds_read_b64_tr_b16 a[140:141], v25 offset:8200
    ds_read_b64_tr_b16 a[142:143], v25 offset:9224
    s_waitcnt lgkmcnt(0)
    s_waitcnt vmcnt(24)
    s_barrier
    ds_read_b64_tr_b16 a[144:145], v23 offset:0
    ds_read_b64_tr_b16 a[146:147], v23 offset:1024
    ds_read_b64_tr_b16 a[148:149], v23 offset:8
    ds_read_b64_tr_b16 a[150:151], v23 offset:1032
    ds_read_b64_tr_b16 a[152:153], v23 offset:8192
    ds_read_b64_tr_b16 a[154:155], v23 offset:9216
    ds_read_b64_tr_b16 a[156:157], v23 offset:8200
    ds_read_b64_tr_b16 a[158:159], v23 offset:9224
    s_waitcnt lgkmcnt(0)
    s_waitcnt vmcnt(20)
    s_barrier
    ds_read_b64_tr_b16 a[160:161], v23 offset:16384
    ds_read_b64_tr_b16 a[162:163], v23 offset:17408
    ds_read_b64_tr_b16 a[164:165], v23 offset:16392
    ds_read_b64_tr_b16 a[166:167], v23 offset:17416
    ds_read_b64_tr_b16 a[168:169], v23 offset:24576
    ds_read_b64_tr_b16 a[170:171], v23 offset:25600
    ds_read_b64_tr_b16 a[172:173], v23 offset:24584
    ds_read_b64_tr_b16 a[174:175], v23 offset:25608
    s_waitcnt lgkmcnt(0)
    s_waitcnt vmcnt(16)
    s_barrier
    ds_read_b64_tr_b16 a[176:177], v23 offset:32768
    ds_read_b64_tr_b16 a[178:179], v23 offset:33792
    ds_read_b64_tr_b16 a[180:181], v23 offset:32776
    ds_read_b64_tr_b16 a[182:183], v23 offset:33800
    ds_read_b64_tr_b16 a[184:185], v23 offset:40960
    ds_read_b64_tr_b16 a[186:187], v23 offset:41984
    ds_read_b64_tr_b16 a[188:189], v23 offset:40968
    ds_read_b64_tr_b16 a[190:191], v23 offset:41992
    s_waitcnt lgkmcnt(0)
    s_waitcnt vmcnt(12)
    s_barrier
    ds_read_b64_tr_b16 a[192:193], v23 offset:49152
    ds_read_b64_tr_b16 a[194:195], v23 offset:50176
    ds_read_b64_tr_b16 a[196:197], v23 offset:49160
    ds_read_b64_tr_b16 a[198:199], v23 offset:50184
    ds_read_b64_tr_b16 a[200:201], v23 offset:57344
    ds_read_b64_tr_b16 a[202:203], v23 offset:58368
    ds_read_b64_tr_b16 a[204:205], v23 offset:57352
    ds_read_b64_tr_b16 a[206:207], v23 offset:58376
    s_waitcnt lgkmcnt(0)
    s_waitcnt vmcnt(8)
    s_barrier
    ds_read_b64_tr_b16 a[208:209], v24 offset:0
    ds_read_b64_tr_b16 a[210:211], v24 offset:1024
    ds_read_b64_tr_b16 a[212:213], v24 offset:8
    ds_read_b64_tr_b16 a[214:215], v24 offset:1032
    ds_read_b64_tr_b16 a[216:217], v24 offset:8192
    ds_read_b64_tr_b16 a[218:219], v24 offset:9216
    ds_read_b64_tr_b16 a[220:221], v24 offset:8200
    ds_read_b64_tr_b16 a[222:223], v24 offset:9224
    s_waitcnt lgkmcnt(0)
    s_waitcnt vmcnt(4)
    s_barrier
    ds_read_b64_tr_b16 a[224:225], v24 offset:16384
    ds_read_b64_tr_b16 a[226:227], v24 offset:17408
    ds_read_b64_tr_b16 a[228:229], v24 offset:16392
    ds_read_b64_tr_b16 a[230:231], v24 offset:17416
    ds_read_b64_tr_b16 a[232:233], v24 offset:24576
    ds_read_b64_tr_b16 a[234:235], v24 offset:25600
    ds_read_b64_tr_b16 a[236:237], v24 offset:24584
    ds_read_b64_tr_b16 a[238:239], v24 offset:25608
    s_waitcnt lgkmcnt(0)
    s_waitcnt vmcnt(0)
    s_barrier
    ds_read_b64_tr_b16 a[240:241], v24 offset:32768
    ds_read_b64_tr_b16 a[242:243], v24 offset:33792
    ds_read_b64_tr_b16 a[244:245], v24 offset:32776
    ds_read_b64_tr_b16 a[246:247], v24 offset:33800
    ds_read_b64_tr_b16 a[248:249], v24 offset:40960
    ds_read_b64_tr_b16 a[250:251], v24 offset:41984
    ds_read_b64_tr_b16 a[252:253], v24 offset:40968
    ds_read_b64_tr_b16 a[254:255], v24 offset:41992
    s_waitcnt lgkmcnt(0)
    s_barrier
    s_min_u32 s45, s41, 27
    s_lshl_b32 s45, s45, 8
    s_lshl_b32 s46, s44, 6
    s_add_u32 s45, s45, s46
    v_lshrrev_b32 v29, 4, v1
    v_lshlrev_b32 v29, 4, v29
    buffer_load_dwordx4 v[80:83], v29, s[32:35], s45 offen
    s_waitcnt vmcnt(0)
    v_lshlrev_b32 v96, 16, v80
    v_and_b32 v97, 0xffff0000, v80
    v_lshlrev_b32 v98, 16, v81
    v_and_b32 v99, 0xffff0000, v81
    v_lshlrev_b32 v100, 16, v82
    v_and_b32 v101, 0xffff0000, v82
    v_lshlrev_b32 v102, 16, v83
    v_and_b32 v103, 0xffff0000, v83
    v_mov_b32 v104, 0xbdd2d3e8
    v_mov_b32 v105, v104
    v_mov_b32 v106, 0xc0135761
    v_mov_b32 v107, v106
    s_cmp_lg_u32 s44, 0
    s_cbranch_scc1 L_pd_144
    v_mov_b32 v29, 132
    s_mov_b32 s46, 96
    s_mov_b64 exec, 1
    s_mov_b32 s70, 0
L_wp_145:
    buffer_load_dword v31, v29, s[16:19], 0 offen sc1
    s_add_u32 s70, s70, 1
    s_cmp_ge_u32 s70, 0x200000
    s_cbranch_scc1 L_w_done_101
    s_waitcnt vmcnt(0)
    v_cmp_gt_u32 vcc, s46, v31
    s_nop 1
    s_cbranch_vccz L_wp_145_ok
    s_sleep 3
    s_branch L_wp_145
L_wp_145_ok:
    s_mov_b64 exec, -1
L_pd_144:
    s_barrier
    v_lshlrev_b32 v29, 5, v1
    s_mov_b32 s45, 8192
    buffer_load_dwordx4 v[112:115], v29, s[12:15], s45 offen offset:0 sc1
    buffer_load_dwordx4 v[116:119], v29, s[12:15], s45 offen offset:16 sc1
    buffer_load_dwordx4 v[120:123], v29, s[12:15], s45 offen offset:2048 sc1
    buffer_load_dwordx4 v[124:127], v29, s[12:15], s45 offen offset:2064 sc1
    s_mov_b32 s45, 32768
    buffer_load_dwordx4 v[32:35], v29, s[12:15], s45 offen offset:0 sc1
    buffer_load_dwordx4 v[36:39], v29, s[12:15], s45 offen offset:16 sc1
    buffer_load_dwordx4 v[40:43], v29, s[12:15], s45 offen offset:2048 sc1
    buffer_load_dwordx4 v[44:47], v29, s[12:15], s45 offen offset:2064 sc1
    s_mov_b32 s45, 12288
    buffer_load_dwordx4 v[128:131], v29, s[12:15], s45 offen offset:0 sc1
    buffer_load_dwordx4 v[132:135], v29, s[12:15], s45 offen offset:16 sc1
    buffer_load_dwordx4 v[136:139], v29, s[12:15], s45 offen offset:2048 sc1
    buffer_load_dwordx4 v[140:143], v29, s[12:15], s45 offen offset:2064 sc1
    s_mov_b32 s45, 36864
    buffer_load_dwordx4 v[48:51], v29, s[12:15], s45 offen offset:0 sc1
    buffer_load_dwordx4 v[52:55], v29, s[12:15], s45 offen offset:16 sc1
    buffer_load_dwordx4 v[56:59], v29, s[12:15], s45 offen offset:2048 sc1
    buffer_load_dwordx4 v[60:63], v29, s[12:15], s45 offen offset:2064 sc1
    s_mov_b32 s45, 16384
    buffer_load_dwordx4 v[144:147], v29, s[12:15], s45 offen offset:0 sc1
    buffer_load_dwordx4 v[148:151], v29, s[12:15], s45 offen offset:16 sc1
    buffer_load_dwordx4 v[152:155], v29, s[12:15], s45 offen offset:2048 sc1
    buffer_load_dwordx4 v[156:159], v29, s[12:15], s45 offen offset:2064 sc1
    s_mov_b32 s45, 40960
    buffer_load_dwordx4 v[64:67], v29, s[12:15], s45 offen offset:0 sc1
    buffer_load_dwordx4 v[68:71], v29, s[12:15], s45 offen offset:16 sc1
    buffer_load_dwordx4 v[72:75], v29, s[12:15], s45 offen offset:2048 sc1
    buffer_load_dwordx4 v[76:79], v29, s[12:15], s45 offen offset:2064 sc1
    s_waitcnt vmcnt(0)
    v_add_f32 v112, v112, v32
    v_cvt_pk_bf16_f32 v112, v112, v112
    v_lshlrev_b32 v112, 16, v112
    v_add_f32 v113, v113, v33
    v_cvt_pk_bf16_f32 v113, v113, v113
    v_lshlrev_b32 v113, 16, v113
    v_add_f32 v114, v114, v34
    v_cvt_pk_bf16_f32 v114, v114, v114
    v_lshlrev_b32 v114, 16, v114
    v_add_f32 v115, v115, v35
    v_cvt_pk_bf16_f32 v115, v115, v115
    v_lshlrev_b32 v115, 16, v115
    v_add_f32 v116, v116, v36
    v_cvt_pk_bf16_f32 v116, v116, v116
    v_lshlrev_b32 v116, 16, v116
    v_add_f32 v117, v117, v37
    v_cvt_pk_bf16_f32 v117, v117, v117
    v_lshlrev_b32 v117, 16, v117
    v_add_f32 v118, v118, v38
    v_cvt_pk_bf16_f32 v118, v118, v118
    v_lshlrev_b32 v118, 16, v118
    v_add_f32 v119, v119, v39
    v_cvt_pk_bf16_f32 v119, v119, v119
    v_lshlrev_b32 v119, 16, v119
    v_add_f32 v120, v120, v40
    v_cvt_pk_bf16_f32 v120, v120, v120
    v_lshlrev_b32 v120, 16, v120
    v_add_f32 v121, v121, v41
    v_cvt_pk_bf16_f32 v121, v121, v121
    v_lshlrev_b32 v121, 16, v121
    v_add_f32 v122, v122, v42
    v_cvt_pk_bf16_f32 v122, v122, v122
    v_lshlrev_b32 v122, 16, v122
    v_add_f32 v123, v123, v43
    v_cvt_pk_bf16_f32 v123, v123, v123
    v_lshlrev_b32 v123, 16, v123
    v_add_f32 v124, v124, v44
    v_cvt_pk_bf16_f32 v124, v124, v124
    v_lshlrev_b32 v124, 16, v124
    v_add_f32 v125, v125, v45
    v_cvt_pk_bf16_f32 v125, v125, v125
    v_lshlrev_b32 v125, 16, v125
    v_add_f32 v126, v126, v46
    v_cvt_pk_bf16_f32 v126, v126, v126
    v_lshlrev_b32 v126, 16, v126
    v_add_f32 v127, v127, v47
    v_cvt_pk_bf16_f32 v127, v127, v127
    v_lshlrev_b32 v127, 16, v127
    v_add_f32 v128, v128, v48
    v_cvt_pk_bf16_f32 v128, v128, v128
    v_lshlrev_b32 v128, 16, v128
    v_add_f32 v129, v129, v49
    v_cvt_pk_bf16_f32 v129, v129, v129
    v_lshlrev_b32 v129, 16, v129
    v_add_f32 v130, v130, v50
    v_cvt_pk_bf16_f32 v130, v130, v130
    v_lshlrev_b32 v130, 16, v130
    v_add_f32 v131, v131, v51
    v_cvt_pk_bf16_f32 v131, v131, v131
    v_lshlrev_b32 v131, 16, v131
    v_add_f32 v132, v132, v52
    v_cvt_pk_bf16_f32 v132, v132, v132
    v_lshlrev_b32 v132, 16, v132
    v_add_f32 v133, v133, v53
    v_cvt_pk_bf16_f32 v133, v133, v133
    v_lshlrev_b32 v133, 16, v133
    v_add_f32 v134, v134, v54
    v_cvt_pk_bf16_f32 v134, v134, v134
    v_lshlrev_b32 v134, 16, v134
    v_add_f32 v135, v135, v55
    v_cvt_pk_bf16_f32 v135, v135, v135
    v_lshlrev_b32 v135, 16, v135
    v_add_f32 v136, v136, v56
    v_cvt_pk_bf16_f32 v136, v136, v136
    v_lshlrev_b32 v136, 16, v136
    v_add_f32 v137, v137, v57
    v_cvt_pk_bf16_f32 v137, v137, v137
    v_lshlrev_b32 v137, 16, v137
    v_add_f32 v138, v138, v58
    v_cvt_pk_bf16_f32 v138, v138, v138
    v_lshlrev_b32 v138, 16, v138
    v_add_f32 v139, v139, v59
    v_cvt_pk_bf16_f32 v139, v139, v139
    v_lshlrev_b32 v139, 16, v139
    v_add_f32 v140, v140, v60
    v_cvt_pk_bf16_f32 v140, v140, v140
    v_lshlrev_b32 v140, 16, v140
    v_add_f32 v141, v141, v61
    v_cvt_pk_bf16_f32 v141, v141, v141
    v_lshlrev_b32 v141, 16, v141
    v_add_f32 v142, v142, v62
    v_cvt_pk_bf16_f32 v142, v142, v142
    v_lshlrev_b32 v142, 16, v142
    v_add_f32 v143, v143, v63
    v_cvt_pk_bf16_f32 v143, v143, v143
    v_lshlrev_b32 v143, 16, v143
    v_add_f32 v144, v144, v64
    v_cvt_pk_bf16_f32 v144, v144, v144
    v_lshlrev_b32 v144, 16, v144
    v_add_f32 v144, 1.0, v144
    v_cvt_pk_bf16_f32 v144, v144, v144
    v_lshlrev_b32 v144, 16, v144
    v_add_f32 v145, v145, v65
    v_cvt_pk_bf16_f32 v145, v145, v145
    v_lshlrev_b32 v145, 16, v145
    v_add_f32 v145, 1.0, v145
    v_cvt_pk_bf16_f32 v145, v145, v145
    v_lshlrev_b32 v145, 16, v145
    v_add_f32 v146, v146, v66
    v_cvt_pk_bf16_f32 v146, v146, v146
    v_lshlrev_b32 v146, 16, v146
    v_add_f32 v146, 1.0, v146
    v_cvt_pk_bf16_f32 v146, v146, v146
    v_lshlrev_b32 v146, 16, v146
    v_add_f32 v147, v147, v67
    v_cvt_pk_bf16_f32 v147, v147, v147
    v_lshlrev_b32 v147, 16, v147
    v_add_f32 v147, 1.0, v147
    v_cvt_pk_bf16_f32 v147, v147, v147
    v_lshlrev_b32 v147, 16, v147
    v_add_f32 v148, v148, v68
    v_cvt_pk_bf16_f32 v148, v148, v148
    v_lshlrev_b32 v148, 16, v148
    v_add_f32 v148, 1.0, v148
    v_cvt_pk_bf16_f32 v148, v148, v148
    v_lshlrev_b32 v148, 16, v148
    v_add_f32 v149, v149, v69
    v_cvt_pk_bf16_f32 v149, v149, v149
    v_lshlrev_b32 v149, 16, v149
    v_add_f32 v149, 1.0, v149
    v_cvt_pk_bf16_f32 v149, v149, v149
    v_lshlrev_b32 v149, 16, v149
    v_add_f32 v150, v150, v70
    v_cvt_pk_bf16_f32 v150, v150, v150
    v_lshlrev_b32 v150, 16, v150
    v_add_f32 v150, 1.0, v150
    v_cvt_pk_bf16_f32 v150, v150, v150
    v_lshlrev_b32 v150, 16, v150
    v_add_f32 v151, v151, v71
    v_cvt_pk_bf16_f32 v151, v151, v151
    v_lshlrev_b32 v151, 16, v151
    v_add_f32 v151, 1.0, v151
    v_cvt_pk_bf16_f32 v151, v151, v151
    v_lshlrev_b32 v151, 16, v151
    v_add_f32 v152, v152, v72
    v_cvt_pk_bf16_f32 v152, v152, v152
    v_lshlrev_b32 v152, 16, v152
    v_add_f32 v152, 1.0, v152
    v_cvt_pk_bf16_f32 v152, v152, v152
    v_lshlrev_b32 v152, 16, v152
    v_add_f32 v153, v153, v73
    v_cvt_pk_bf16_f32 v153, v153, v153
    v_lshlrev_b32 v153, 16, v153
    v_add_f32 v153, 1.0, v153
    v_cvt_pk_bf16_f32 v153, v153, v153
    v_lshlrev_b32 v153, 16, v153
    v_add_f32 v154, v154, v74
    v_cvt_pk_bf16_f32 v154, v154, v154
    v_lshlrev_b32 v154, 16, v154
    v_add_f32 v154, 1.0, v154
    v_cvt_pk_bf16_f32 v154, v154, v154
    v_lshlrev_b32 v154, 16, v154
    v_add_f32 v155, v155, v75
    v_cvt_pk_bf16_f32 v155, v155, v155
    v_lshlrev_b32 v155, 16, v155
    v_add_f32 v155, 1.0, v155
    v_cvt_pk_bf16_f32 v155, v155, v155
    v_lshlrev_b32 v155, 16, v155
    v_add_f32 v156, v156, v76
    v_cvt_pk_bf16_f32 v156, v156, v156
    v_lshlrev_b32 v156, 16, v156
    v_add_f32 v156, 1.0, v156
    v_cvt_pk_bf16_f32 v156, v156, v156
    v_lshlrev_b32 v156, 16, v156
    v_add_f32 v157, v157, v77
    v_cvt_pk_bf16_f32 v157, v157, v157
    v_lshlrev_b32 v157, 16, v157
    v_add_f32 v157, 1.0, v157
    v_cvt_pk_bf16_f32 v157, v157, v157
    v_lshlrev_b32 v157, 16, v157
    v_add_f32 v158, v158, v78
    v_cvt_pk_bf16_f32 v158, v158, v158
    v_lshlrev_b32 v158, 16, v158
    v_add_f32 v158, 1.0, v158
    v_cvt_pk_bf16_f32 v158, v158, v158
    v_lshlrev_b32 v158, 16, v158
    v_add_f32 v159, v159, v79
    v_cvt_pk_bf16_f32 v159, v159, v159
    v_lshlrev_b32 v159, 16, v159
    v_add_f32 v159, 1.0, v159
    v_cvt_pk_bf16_f32 v159, v159, v159
    v_lshlrev_b32 v159, 16, v159
    s_lshl_b32 s46, s44, 10
    s_add_u32 s45, s46, 8192
    buffer_load_dwordx4 v[18:21], v10, s[12:15], s45 offen sc1
    s_add_u32 s45, s46, 32768
    buffer_load_dwordx4 v[32:35], v10, s[12:15], s45 offen sc1
    s_add_u32 s45, s46, 12288
    buffer_load_dwordx4 v[22:25], v10, s[12:15], s45 offen sc1
    s_add_u32 s45, s46, 36864
    buffer_load_dwordx4 v[36:39], v10, s[12:15], s45 offen sc1
    s_add_u32 s45, s46, 16384
    buffer_load_dwordx4 v[108:111], v10, s[12:15], s45 offen sc1
    s_add_u32 s45, s46, 40960
    buffer_load_dwordx4 v[40:43], v10, s[12:15], s45 offen sc1
    s_waitcnt vmcnt(0)
    v_add_f32 v18, v18, v32
    v_cvt_pk_bf16_f32 v18, v18, v18
    v_lshlrev_b32 v18, 16, v18
    v_add_f32 v19, v19, v33
    v_cvt_pk_bf16_f32 v19, v19, v19
    v_lshlrev_b32 v19, 16, v19
    v_add_f32 v20, v20, v34
    v_cvt_pk_bf16_f32 v20, v20, v20
    v_lshlrev_b32 v20, 16, v20
    v_add_f32 v21, v21, v35
    v_cvt_pk_bf16_f32 v21, v21, v21
    v_lshlrev_b32 v21, 16, v21
    v_add_f32 v22, v22, v36
    v_cvt_pk_bf16_f32 v22, v22, v22
    v_lshlrev_b32 v22, 16, v22
    v_add_f32 v23, v23, v37
    v_cvt_pk_bf16_f32 v23, v23, v23
    v_lshlrev_b32 v23, 16, v23
    v_add_f32 v24, v24, v38
    v_cvt_pk_bf16_f32 v24, v24, v24
    v_lshlrev_b32 v24, 16, v24
    v_add_f32 v25, v25, v39
    v_cvt_pk_bf16_f32 v25, v25, v25
    v_lshlrev_b32 v25, 16, v25
    v_add_f32 v108, v108, v40
    v_cvt_pk_bf16_f32 v108, v108, v108
    v_lshlrev_b32 v108, 16, v108
    v_add_f32 v108, 1.0, v108
    v_cvt_pk_bf16_f32 v108, v108, v108
    v_lshlrev_b32 v108, 16, v108
    v_add_f32 v109, v109, v41
    v_cvt_pk_bf16_f32 v109, v109, v109
    v_lshlrev_b32 v109, 16, v109
    v_add_f32 v109, 1.0, v109
    v_cvt_pk_bf16_f32 v109, v109, v109
    v_lshlrev_b32 v109, 16, v109
    v_add_f32 v110, v110, v42
    v_cvt_pk_bf16_f32 v110, v110, v110
    v_lshlrev_b32 v110, 16, v110
    v_add_f32 v110, 1.0, v110
    v_cvt_pk_bf16_f32 v110, v110, v110
    v_lshlrev_b32 v110, 16, v110
    v_add_f32 v111, v111, v43
    v_cvt_pk_bf16_f32 v111, v111, v111
    v_lshlrev_b32 v111, 16, v111
    v_add_f32 v111, 1.0, v111
    v_cvt_pk_bf16_f32 v111, v111, v111
    v_lshlrev_b32 v111, 16, v111
    s_mov_b32 s52, 0xc00000
    s_lshl_b32 s56, s41, 13
    s_add_u32 s56, s56, 0x6000000
    s_lshl_b32 s45, s40, 2
    s_add_u32 s45, s45, 200
    v_mov_b32 v29, s45
    s_mov_b32 s46, 536870912
    s_mov_b64 exec, 1
    s_mov_b32 s70, 0
L_wp_149:
    buffer_load_dword v31, v29, s[16:19], 0 offen sc1
    s_add_u32 s70, s70, 1
    s_cmp_ge_u32 s70, 0x200000
    s_cbranch_scc1 L_w_done_101
    s_waitcnt vmcnt(0)
    v_cmp_gt_u32 vcc, s46, v31
    s_nop 1
    s_cbranch_vccz L_wp_149_ok
    s_sleep 2
    s_branch L_wp_149
L_wp_149_ok:
    s_mov_b64 exec, -1
    v_readfirstlane_b32 s45, v31
    s_nop 3
    s_and_b32 s46, s45, 511
    s_mul_i32 s46, s46, s46
    s_bfe_u32 s45, s45, 0xf0009
    s_lshl_b32 s45, s45, 5
    s_mov_b32 s80, s12
    s_mov_b32 s81, s13
    s_mov_b32 s83, 0x00020000
    s_mov_b32 s84, s12
    s_mov_b32 s85, s13
    s_mov_b32 s87, 0x00020000
    s_cmp_eq_u32 s45, s46
    s_cselect_b32 s82, s14, 0
    s_cselect_b32 s86, 0, s14
L_b_loop_146:
    s_cmp_eq_u64 s[36:37], 0
    s_cbranch_scc1 L_w_done_101
    s_ff1_i32_b64 s50, s[36:37]
    s_bitset0_b64 s[36:37], s50
    s_lshr_b64 s[74:75], s[72:73], s50
    s_ff1_i32_b64 s51, s[74:75]
    s_add_u32 s51, s51, 1
    s_add_u32 s62, s50, s51
    s_cmp_lg_u32 s51, 1
    s_cbranch_scc1 L_b_skip2_148
    s_lshl_b32 s63, s50, 5
    s_add_u32 s63, s63, s41
    s_lshl_b32 s47, s63, 11
    s_lshl_b32 s45, s44, 9
    s_add_u32 s47, s47, s45
    v_lshlrev_b32 v17, 3, v1
    buffer_load_dwordx2 v[208:209], v17, s[28:31], s47 offen
    s_add_u32 s45, s64, 4096
    s_waitcnt vmcnt(0)
    s_cmp_lg_u32 s44, 0
    s_cbranch_scc1 L_pw_150
    s_mov_b32 exec_hi, 0
    s_mov_b32 s70, 0
L_wp_151:
    buffer_load_dword v31, v5, s[12:15], s45 offen sc1
    s_add_u32 s70, s70, 1
    s_cmp_ge_u32 s70, 0x200000
    s_cbranch_scc1 L_w_done_101
    s_waitcnt vmcnt(0)
    v_cmp_gt_u32 vcc, s62, v31
    s_nop 1
    s_cbranch_vccz L_wp_151_ok
    s_sleep 1
    s_branch L_wp_151
L_wp_151_ok:
    s_mov_b64 exec, -1
L_pw_150:
    s_barrier
    s_lshl_b32 s45, s63, 12
    s_lshl_b32 s46, s44, 10
    s_add_u32 s45, s45, s46
    s_add_u32 s45, s45, 0x8000000
    buffer_load_dwordx4 v[64:67], v10, s[12:15], s45 offen sc1
    s_add_u32 s45, s45, 0x800000
    buffer_load_dwordx4 v[68:71], v10, s[12:15], s45 offen sc1
    s_add_u32 s45, s45, 0x800000
    buffer_load_dwordx4 v[72:75], v10, s[12:15], s45 offen sc1
    s_add_u32 s45, s45, 0x800000
    buffer_load_dwordx4 v[76:79], v10, s[12:15], s45 offen sc1
    v_lshlrev_b32 v160, 16, v208
    v_and_b32 v161, 0xffff0000, v208
    v_lshlrev_b32 v162, 16, v209
    v_and_b32 v163, 0xffff0000, v209
    s_waitcnt vmcnt(0)
    v_pk_add_f32 v[64:65], v[64:65], v[68:69]
    v_pk_add_f32 v[72:73], v[72:73], v[76:77]
    v_pk_add_f32 v[66:67], v[66:67], v[70:71]
    v_pk_add_f32 v[74:75], v[74:75], v[78:79]
    v_pk_add_f32 v[64:65], v[64:65], v[72:73]
    v_pk_add_f32 v[66:67], v[66:67], v[74:75]
    v_cvt_pk_bf16_f32 v64, v64, v64
    v_lshlrev_b32 v64, 16, v64
    v_cvt_pk_bf16_f32 v65, v65, v65
    v_lshlrev_b32 v65, 16, v65
    v_cvt_pk_bf16_f32 v66, v66, v66
    v_lshlrev_b32 v66, 16, v66
    v_cvt_pk_bf16_f32 v67, v67, v67
    v_lshlrev_b32 v67, 16, v67
    v_mul_f32 v64, v64, v18
    v_cvt_pk_bf16_f32 v64, v64, v64
    v_lshlrev_b32 v64, 16, v64
    v_add_f32 v64, v64, v160
    v_mul_f32 v65, v65, v19
    v_cvt_pk_bf16_f32 v65, v65, v65
    v_lshlrev_b32 v65, 16, v65
    v_add_f32 v65, v65, v161
    v_mul_f32 v66, v66, v20
    v_cvt_pk_bf16_f32 v66, v66, v66
    v_lshlrev_b32 v66, 16, v66
    v_add_f32 v66, v66, v162
    v_mul_f32 v67, v67, v21
    v_cvt_pk_bf16_f32 v67, v67, v67
    v_lshlrev_b32 v67, 16, v67
    v_add_f32 v67, v67, v163
    v_cvt_pk_bf16_f32 v208, v64, v65
    v_cvt_pk_bf16_f32 v209, v66, v67
    s_add_u32 s47, s47, 0x800000
    buffer_store_dwordx2 v[208:209], v17, s[12:15], s47 offen sc1
    v_lshlrev_b32 v64, 16, v208
    v_and_b32 v65, 0xffff0000, v208
    v_lshlrev_b32 v66, 16, v209
    v_and_b32 v67, 0xffff0000, v209
    v_add_f32 v26, v64, v65
    v_add_f32 v27, v66, v67
    v_add_f32 v26, v26, v27
    s_nop 1
    v_add_f32_dpp v26, v26, v26 row_shr:1 row_mask:0xf bank_mask:0xf bound_ctrl:0
    s_nop 1
    v_add_f32_dpp v26, v26, v26 row_shr:2 row_mask:0xf bank_mask:0xf bound_ctrl:0
    s_nop 1
    v_add_f32_dpp v26, v26, v26 row_shr:4 row_mask:0xf bank_mask:0xf bound_ctrl:0
    s_nop 1
    v_add_f32_dpp v26, v26, v26 row_shr:8 row_mask:0xf bank_mask:0xf bound_ctrl:0
    s_nop 1
    v_add_f32_dpp v26, v26, v26 row_bcast:15 row_mask:0xa bank_mask:0xf
    s_nop 1
    v_add_f32_dpp v26, v26, v26 row_bcast:31 row_mask:0xc bank_mask:0xf
    s_nop 1
    v_readlane_b32 s66, v26, 63
    s_nop 1
    v_mov_b32 v28, s66
    v_mul_f32 v28, 0x3b800000, v28
    v_mov_b32 v26, 0
    v_sub_f32 v27, v64, v28
    v_fmac_f32 v26, v27, v27
    v_sub_f32 v27, v65, v28
    v_fmac_f32 v26, v27, v27
    v_sub_f32 v27, v66, v28
    v_fmac_f32 v26, v27, v27
    v_sub_f32 v27, v67, v28
    v_fmac_f32 v26, v27, v27
    s_nop 1
    v_add_f32_dpp v26, v26, v26 row_shr:1 row_mask:0xf bank_mask:0xf bound_ctrl:0
    s_nop 1
    v_add_f32_dpp v26, v26, v26 row_shr:2 row_mask:0xf bank_mask:0xf bound_ctrl:0
    s_nop 1
    v_add_f32_dpp v26, v26, v26 row_shr:4 row_mask:0xf bank_mask:0xf bound_ctrl:0
    s_nop 1
    v_add_f32_dpp v26, v26, v26 row_shr:8 row_mask:0xf bank_mask:0xf bound_ctrl:0
    s_nop 1
    v_add_f32_dpp v26, v26, v26 row_bcast:15 row_mask:0xa bank_mask:0xf
    s_nop 1
    v_add_f32_dpp v26, v26, v26 row_bcast:31 row_mask:0xc bank_mask:0xf
    s_nop 1
    v_readlane_b32 s66, v26, 63
    s_lshl_b32 s45, s44, 3
    s_add_u32 s45, s45, 131072
    v_mov_b32 v29, s66
    v_mov_b32 v27, s45
    ds_write_b64 v27, v[28:29]
    v_mov_b32 v27, 131072
    s_waitcnt lgkmcnt(0)
    s_barrier
    ds_read_b128 v[68:71], v27
    ds_read_b128 v[72:75], v27 offset:16
    s_waitcnt lgkmcnt(0)
    v_add_f32 v27, v68, v70
    v_add_f32 v26, v72, v74
    v_add_f32 v27, v27, v26
    v_mul_f32 v27, 0x3e800000, v27
    v_add_f32 v26, v69, v71
    v_add_f32 v28, v73, v75
    v_add_f32 v26, v26, v28
    v_mov_b32 v28, 0
    v_sub_f32 v68, v68, v27
    v_fmac_f32 v28, v68, v68
    v_sub_f32 v70, v70, v27
    v_fmac_f32 v28, v70, v70
    v_sub_f32 v72, v72, v27
    v_fmac_f32 v28, v72, v72
    v_sub_f32 v74, v74, v27
    v_fmac_f32 v28, v74, v74
    v_mul_f32 v28, 0x43800000, v28
    v_add_f32 v26, v26, v28
    v_mul_f32 v26, 0x3a800000, v26
    v_cvt_pk_bf16_f32 v26, v26, v26
    v_lshlrev_b32 v26, 16, v26
    v_cvt_pk_bf16_f32 v27, v27, v27
    v_lshlrev_b32 v27, 16, v27
    v_add_f32 v26, 0x3727c5ac, v26
    v_cvt_pk_bf16_f32 v26, v26, v26
    v_lshlrev_b32 v26, 16, v26
    v_sqrt_f32 v26, v26
    s_nop 0
    v_cvt_pk_bf16_f32 v26, v26, v26
    v_lshlrev_b32 v26, 16, v26
    v_rcp_f32 v26, v26
    s_nop 0
    v_sub_f32 v64, v64, v27
    v_cvt_pk_bf16_f32 v64, v64, v64
    v_lshlrev_b32 v64, 16, v64
    v_mul_f32 v64, v64, v26
    v_cvt_pk_bf16_f32 v64, v64, v64
    v_lshlrev_b32 v64, 16, v64
    v_mul_f32 v64, v64, v108
    v_cvt_pk_bf16_f32 v64, v64, v64
    v_lshlrev_b32 v64, 16, v64
    v_add_f32 v64, v64, v22
    v_sub_f32 v65, v65, v27
    v_cvt_pk_bf16_f32 v65, v65, v65
    v_lshlrev_b32 v65, 16, v65
    v_mul_f32 v65, v65, v26
    v_cvt_pk_bf16_f32 v65, v65, v65
    v_lshlrev_b32 v65, 16, v65
    v_mul_f32 v65, v65, v109
    v_cvt_pk_bf16_f32 v65, v65, v65
    v_lshlrev_b32 v65, 16, v65
    v_add_f32 v65, v65, v23
    v_sub_f32 v66, v66, v27
    v_cvt_pk_bf16_f32 v66, v66, v66
    v_lshlrev_b32 v66, 16, v66
    v_mul_f32 v66, v66, v26
    v_cvt_pk_bf16_f32 v66, v66, v66
    v_lshlrev_b32 v66, 16, v66
    v_mul_f32 v66, v66, v110
    v_cvt_pk_bf16_f32 v66, v66, v66
    v_lshlrev_b32 v66, 16, v66
    v_add_f32 v66, v66, v24
    v_sub_f32 v67, v67, v27
    v_cvt_pk_bf16_f32 v67, v67, v67
    v_lshlrev_b32 v67, 16, v67
    v_mul_f32 v67, v67, v26
    v_cvt_pk_bf16_f32 v67, v67, v67
    v_lshlrev_b32 v67, 16, v67
    v_mul_f32 v67, v67, v111
    v_cvt_pk_bf16_f32 v67, v67, v67
    v_lshlrev_b32 v67, 16, v67
    v_add_f32 v67, v67, v25
    v_cvt_pk_bf16_f32 v64, v64, v65
    v_cvt_pk_bf16_f32 v65, v66, v67
    v_lshrrev_b32 v26, 5, v1
    v_lshlrev_b32 v26, 13, v26
    v_and_b32 v27, 255, v17
    v_add_u32 v26, v26, v27
    s_lshl_b32 s45, s50, 16
    s_lshl_b32 s46, s41, 8
    s_add_u32 s45, s45, s46
    s_lshl_b32 s46, s44, 14
    s_add_u32 s45, s45, s46
    s_add_u32 s45, s45, 0xc00000
    buffer_store_dwordx2 v[64:65], v26, s[12:15], s45 offen sc1
    s_branch L_b_skip_147
L_b_skip2_148:
    s_add_u32 s63, s50, s44
    s_lshl_b32 s63, s63, 5
    s_add_u32 s63, s63, s41
    s_lshl_b32 s47, s63, 11
    buffer_load_dwordx4 v[208:211], v10, s[28:31], s47 offen
    buffer_load_dwordx4 v[212:215], v10, s[28:31], s47 offen offset:1024
    s_add_u32 s45, s64, 4096
    s_cmp_lg_u32 s44, 0
    s_cbranch_scc1 L_pw_152
    s_mov_b32 exec_hi, 0
    s_mov_b32 s70, 0
L_wp_153:
    buffer_load_dword v31, v5, s[12:15], s45 offen sc1
    s_add_u32 s70, s70, 1
    s_cmp_ge_u32 s70, 0x200000
    s_cbranch_scc1 L_w_done_101
    s_waitcnt vmcnt(0)
    v_cmp_gt_u32 vcc, s62, v31
    s_nop 1
    s_cbranch_vccz L_wp_153_ok
    s_sleep 2
    s_branch L_wp_153
L_wp_153_ok:
    s_mov_b64 exec, -1
L_pw_152:
    s_barrier
    s_cmp_ge_u32 s44, s51
    s_cbranch_scc1 L_b_skip_147
    s_lshl_b32 s45, s63, 12
    s_add_u32 s45, s45, 0x8000000
    v_lshlrev_b32 v29, 5, v1
    buffer_load_dwordx4 v[64:67], v29, s[12:15], s45 offen offset:0 sc1
    buffer_load_dwordx4 v[68:71], v29, s[12:15], s45 offen offset:16 sc1
    buffer_load_dwordx4 v[72:75], v29, s[12:15], s45 offen offset:2048 sc1
    buffer_load_dwordx4 v[76:79], v29, s[12:15], s45 offen offset:2064 sc1
    s_add_u32 s45, s45, 0x800000
    buffer_load_dwordx4 v[160:163], v29, s[12:15], s45 offen offset:0 sc1
    buffer_load_dwordx4 v[164:167], v29, s[12:15], s45 offen offset:16 sc1
    buffer_load_dwordx4 v[168:171], v29, s[12:15], s45 offen offset:2048 sc1
    buffer_load_dwordx4 v[172:175], v29, s[12:15], s45 offen offset:2064 sc1
    s_add_u32 s45, s45, 0x800000
    buffer_load_dwordx4 v[176:179], v29, s[12:15], s45 offen offset:0 sc1
    buffer_load_dwordx4 v[180:183], v29, s[12:15], s45 offen offset:16 sc1
    buffer_load_dwordx4 v[184:187], v29, s[12:15], s45 offen offset:2048 sc1
    buffer_load_dwordx4 v[188:191], v29, s[12:15], s45 offen offset:2064 sc1
    s_add_u32 s45, s45, 0x800000
    buffer_load_dwordx4 v[192:195], v29, s[12:15], s45 offen offset:0 sc1
    buffer_load_dwordx4 v[196:199], v29, s[12:15], s45 offen offset:16 sc1
    buffer_load_dwordx4 v[200:203], v29, s[12:15], s45 offen offset:2048 sc1
    buffer_load_dwordx4 v[204:207], v29, s[12:15], s45 offen offset:2064 sc1
    s_waitcnt vmcnt(0)
    v_pk_add_f32 v[64:65], v[64:65], v[160:161]
    v_pk_add_f32 v[176:177], v[176:177], v[192:193]
    v_pk_add_f32 v[66:67], v[66:67], v[162:163]
    v_pk_add_f32 v[178:179], v[178:179], v[194:195]
    v_pk_add_f32 v[68:69], v[68:69], v[164:165]
    v_pk_add_f32 v[180:181], v[180:181], v[196:197]
    v_pk_add_f32 v[70:71], v[70:71], v[166:167]
    v_pk_add_f32 v[182:183], v[182:183], v[198:199]
    v_pk_add_f32 v[72:73], v[72:73], v[168:169]
    v_pk_add_f32 v[184:185], v[184:185], v[200:201]
    v_pk_add_f32 v[74:75], v[74:75], v[170:171]
    v_pk_add_f32 v[186:187], v[186:187], v[202:203]
    v_pk_add_f32 v[76:77], v[76:77], v[172:173]
    v_pk_add_f32 v[188:189], v[188:189], v[204:205]
    v_pk_add_f32 v[78:79], v[78:79], v[174:175]
    v_pk_add_f32 v[190:191], v[190:191], v[206:207]
    v_pk_add_f32 v[64:65], v[64:65], v[176:177]
    v_pk_add_f32 v[66:67], v[66:67], v[178:179]
    v_pk_add_f32 v[68:69], v[68:69], v[180:181]
    v_pk_add_f32 v[70:71], v[70:71], v[182:183]
    v_pk_add_f32 v[72:73], v[72:73], v[184:185]
    v_pk_add_f32 v[74:75], v[74:75], v[186:187]
    v_pk_add_f32 v[76:77], v[76:77], v[188:189]
    v_pk_add_f32 v[78:79], v[78:79], v[190:191]
    v_cvt_pk_bf16_f32 v64, v64, v64
    v_lshlrev_b32 v64, 16, v64
    v_cvt_pk_bf16_f32 v65, v65, v65
    v_lshlrev_b32 v65, 16, v65
    v_cvt_pk_bf16_f32 v66, v66, v66
    v_lshlrev_b32 v66, 16, v66
    v_cvt_pk_bf16_f32 v67, v67, v67
    v_lshlrev_b32 v67, 16, v67
    v_cvt_pk_bf16_f32 v68, v68, v68
    v_lshlrev_b32 v68, 16, v68
    v_cvt_pk_bf16_f32 v69, v69, v69
    v_lshlrev_b32 v69, 16, v69
    v_cvt_pk_bf16_f32 v70, v70, v70
    v_lshlrev_b32 v70, 16, v70
    v_cvt_pk_bf16_f32 v71, v71, v71
    v_lshlrev_b32 v71, 16, v71
    v_cvt_pk_bf16_f32 v72, v72, v72
    v_lshlrev_b32 v72, 16, v72
    v_cvt_pk_bf16_f32 v73, v73, v73
    v_lshlrev_b32 v73, 16, v73
    v_cvt_pk_bf16_f32 v74, v74, v74
    v_lshlrev_b32 v74, 16, v74
    v_cvt_pk_bf16_f32 v75, v75, v75
    v_lshlrev_b32 v75, 16, v75
    v_cvt_pk_bf16_f32 v76, v76, v76
    v_lshlrev_b32 v76, 16, v76
    v_cvt_pk_bf16_f32 v77, v77, v77
    v_lshlrev_b32 v77, 16, v77
    v_cvt_pk_bf16_f32 v78, v78, v78
    v_lshlrev_b32 v78, 16, v78
    v_cvt_pk_bf16_f32 v79, v79, v79
    v_lshlrev_b32 v79, 16, v79
    v_lshlrev_b32 v160, 16, v208
    v_and_b32 v161, 0xffff0000, v208
    v_lshlrev_b32 v162, 16, v209
    v_and_b32 v163, 0xffff0000, v209
    v_lshlrev_b32 v164, 16, v210
    v_and_b32 v165, 0xffff0000, v210
    v_lshlrev_b32 v166, 16, v211
    v_and_b32 v167, 0xffff0000, v211
    v_lshlrev_b32 v168, 16, v212
    v_and_b32 v169, 0xffff0000, v212
    v_lshlrev_b32 v170, 16, v213
    v_and_b32 v171, 0xffff0000, v213
    v_lshlrev_b32 v172, 16, v214
    v_and_b32 v173, 0xffff0000, v214
    v_lshlrev_b32 v174, 16, v215
    v_and_b32 v175, 0xffff0000, v215
    v_mul_f32 v64, v64, v112
    v_cvt_pk_bf16_f32 v64, v64, v64
    v_lshlrev_b32 v64, 16, v64
    v_add_f32 v64, v64, v160
    v_mul_f32 v65, v65, v113
    v_cvt_pk_bf16_f32 v65, v65, v65
    v_lshlrev_b32 v65, 16, v65
    v_add_f32 v65, v65, v161
    v_mul_f32 v66, v66, v114
    v_cvt_pk_bf16_f32 v66, v66, v66
    v_lshlrev_b32 v66, 16, v66
    v_add_f32 v66, v66, v162
    v_mul_f32 v67, v67, v115
    v_cvt_pk_bf16_f32 v67, v67, v67
    v_lshlrev_b32 v67, 16, v67
    v_add_f32 v67, v67, v163
    v_mul_f32 v68, v68, v116
    v_cvt_pk_bf16_f32 v68, v68, v68
    v_lshlrev_b32 v68, 16, v68
    v_add_f32 v68, v68, v164
    v_mul_f32 v69, v69, v117
    v_cvt_pk_bf16_f32 v69, v69, v69
    v_lshlrev_b32 v69, 16, v69
    v_add_f32 v69, v69, v165
    v_mul_f32 v70, v70, v118
    v_cvt_pk_bf16_f32 v70, v70, v70
    v_lshlrev_b32 v70, 16, v70
    v_add_f32 v70, v70, v166
    v_mul_f32 v71, v71, v119
    v_cvt_pk_bf16_f32 v71, v71, v71
    v_lshlrev_b32 v71, 16, v71
    v_add_f32 v71, v71, v167
    v_mul_f32 v72, v72, v120
    v_cvt_pk_bf16_f32 v72, v72, v72
    v_lshlrev_b32 v72, 16, v72
    v_add_f32 v72, v72, v168
    v_mul_f32 v73, v73, v121
    v_cvt_pk_bf16_f32 v73, v73, v73
    v_lshlrev_b32 v73, 16, v73
    v_add_f32 v73, v73, v169
    v_mul_f32 v74, v74, v122
    v_cvt_pk_bf16_f32 v74, v74, v74
    v_lshlrev_b32 v74, 16, v74
    v_add_f32 v74, v74, v170
    v_mul_f32 v75, v75, v123
    v_cvt_pk_bf16_f32 v75, v75, v75
    v_lshlrev_b32 v75, 16, v75
    v_add_f32 v75, v75, v171
    v_mul_f32 v76, v76, v124
    v_cvt_pk_bf16_f32 v76, v76, v76
    v_lshlrev_b32 v76, 16, v76
    v_add_f32 v76, v76, v172
    v_mul_f32 v77, v77, v125
    v_cvt_pk_bf16_f32 v77, v77, v77
    v_lshlrev_b32 v77, 16, v77
    v_add_f32 v77, v77, v173
    v_mul_f32 v78, v78, v126
    v_cvt_pk_bf16_f32 v78, v78, v78
    v_lshlrev_b32 v78, 16, v78
    v_add_f32 v78, v78, v174
    v_mul_f32 v79, v79, v127
    v_cvt_pk_bf16_f32 v79, v79, v79
    v_lshlrev_b32 v79, 16, v79
    v_add_f32 v79, v79, v175
    v_cvt_pk_bf16_f32 v208, v64, v65
    v_cvt_pk_bf16_f32 v209, v66, v67
    v_cvt_pk_bf16_f32 v210, v68, v69
    v_cvt_pk_bf16_f32 v211, v70, v71
    v_cvt_pk_bf16_f32 v212, v72, v73
    v_cvt_pk_bf16_f32 v213, v74, v75
    v_cvt_pk_bf16_f32 v214, v76, v77
    v_cvt_pk_bf16_f32 v215, v78, v79
    s_add_u32 s47, s47, 0x800000
    buffer_store_dwordx4 v[208:211], v10, s[12:15], s47 offen sc1
    buffer_store_dwordx4 v[212:215], v10, s[12:15], s47 offen offset:1024 sc1
    v_lshlrev_b32 v64, 16, v208
    v_and_b32 v65, 0xffff0000, v208
    v_lshlrev_b32 v66, 16, v209
    v_and_b32 v67, 0xffff0000, v209
    v_lshlrev_b32 v68, 16, v210
    v_and_b32 v69, 0xffff0000, v210
    v_lshlrev_b32 v70, 16, v211
    v_and_b32 v71, 0xffff0000, v211
    v_lshlrev_b32 v72, 16, v212
    v_and_b32 v73, 0xffff0000, v212
    v_lshlrev_b32 v74, 16, v213
    v_and_b32 v75, 0xffff0000, v213
    v_lshlrev_b32 v76, 16, v214
    v_and_b32 v77, 0xffff0000, v214
    v_lshlrev_b32 v78, 16, v215
    v_and_b32 v79, 0xffff0000, v215
    v_add_f32 v26, v64, v65
    v_add_f32 v26, v26, v66
    v_add_f32 v26, v26, v67
    v_add_f32 v26, v26, v68
    v_add_f32 v26, v26, v69
    v_add_f32 v26, v26, v70
    v_add_f32 v26, v26, v71
    v_add_f32 v26, v26, v72
    v_add_f32 v26, v26, v73
    v_add_f32 v26, v26, v74
    v_add_f32 v26, v26, v75
    v_add_f32 v26, v26, v76
    v_add_f32 v26, v26, v77
    v_add_f32 v26, v26, v78
    v_add_f32 v26, v26, v79
    s_nop 1
    v_add_f32_dpp v26, v26, v26 row_shr:1 row_mask:0xf bank_mask:0xf bound_ctrl:0
    s_nop 1
    v_add_f32_dpp v26, v26, v26 row_shr:2 row_mask:0xf bank_mask:0xf bound_ctrl:0
    s_nop 1
    v_add_f32_dpp v26, v26, v26 row_shr:4 row_mask:0xf bank_mask:0xf bound_ctrl:0
    s_nop 1
    v_add_f32_dpp v26, v26, v26 row_shr:8 row_mask:0xf bank_mask:0xf bound_ctrl:0
    s_nop 1
    v_add_f32_dpp v26, v26, v26 row_bcast:15 row_mask:0xa bank_mask:0xf
    s_nop 1
    v_add_f32_dpp v26, v26, v26 row_bcast:31 row_mask:0xc bank_mask:0xf
    s_nop 1
    v_readlane_b32 s66, v26, 63
    s_nop 1
    v_mov_b32 v27, s66
    v_mul_f32 v27, 0x3a800000, v27
    v_mov_b32 v26, 0
    v_sub_f32 v28, v64, v27
    v_fmac_f32 v26, v28, v28
    v_sub_f32 v28, v65, v27
    v_fmac_f32 v26, v28, v28
    v_sub_f32 v28, v66, v27
    v_fmac_f32 v26, v28, v28
    v_sub_f32 v28, v67, v27
    v_fmac_f32 v26, v28, v28
    v_sub_f32 v28, v68, v27
    v_fmac_f32 v26, v28, v28
    v_sub_f32 v28, v69, v27
    v_fmac_f32 v26, v28, v28
    v_sub_f32 v28, v70, v27
    v_fmac_f32 v26, v28, v28
    v_sub_f32 v28, v71, v27
    v_fmac_f32 v26, v28, v28
    v_sub_f32 v28, v72, v27
    v_fmac_f32 v26, v28, v28
    v_sub_f32 v28, v73, v27
    v_fmac_f32 v26, v28, v28
    v_sub_f32 v28, v74, v27
    v_fmac_f32 v26, v28, v28
    v_sub_f32 v28, v75, v27
    v_fmac_f32 v26, v28, v28
    v_sub_f32 v28, v76, v27
    v_fmac_f32 v26, v28, v28
    v_sub_f32 v28, v77, v27
    v_fmac_f32 v26, v28, v28
    v_sub_f32 v28, v78, v27
    v_fmac_f32 v26, v28, v28
    v_sub_f32 v28, v79, v27
    v_fmac_f32 v26, v28, v28
    s_nop 1
    v_add_f32_dpp v26, v26, v26 row_shr:1 row_mask:0xf bank_mask:0xf bound_ctrl:0
    s_nop 1
    v_add_f32_dpp v26, v26, v26 row_shr:2 row_mask:0xf bank_mask:0xf bound_ctrl:0
    s_nop 1
    v_add_f32_dpp v26, v26, v26 row_shr:4 row_mask:0xf bank_mask:0xf bound_ctrl:0
    s_nop 1
    v_add_f32_dpp v26, v26, v26 row_shr:8 row_mask:0xf bank_mask:0xf bound_ctrl:0
    s_nop 1
    v_add_f32_dpp v26, v26, v26 row_bcast:15 row_mask:0xa bank_mask:0xf
    s_nop 1
    v_add_f32_dpp v26, v26, v26 row_bcast:31 row_mask:0xc bank_mask:0xf
    s_nop 1
    v_readlane_b32 s66, v26, 63
    s_nop 1
    v_mov_b32 v26, s66
    v_mul_f32 v26, 0x3a800000, v26
    v_cvt_pk_bf16_f32 v26, v26, v26
    v_lshlrev_b32 v26, 16, v26
    v_cvt_pk_bf16_f32 v27, v27, v27
    v_lshlrev_b32 v27, 16, v27
    v_add_f32 v26, 0x3727c5ac, v26
    v_cvt_pk_bf16_f32 v26, v26, v26
    v_lshlrev_b32 v26, 16, v26
    v_sqrt_f32 v26, v26
    s_nop 0
    v_cvt_pk_bf16_f32 v26, v26, v26
    v_lshlrev_b32 v26, 16, v26
    v_rcp_f32 v26, v26
    s_nop 0
    v_sub_f32 v64, v64, v27
    v_cvt_pk_bf16_f32 v64, v64, v64
    v_lshlrev_b32 v64, 16, v64
    v_mul_f32 v64, v64, v26
    v_cvt_pk_bf16_f32 v64, v64, v64
    v_lshlrev_b32 v64, 16, v64
    v_sub_f32 v65, v65, v27
    v_cvt_pk_bf16_f32 v65, v65, v65
    v_lshlrev_b32 v65, 16, v65
    v_mul_f32 v65, v65, v26
    v_cvt_pk_bf16_f32 v65, v65, v65
    v_lshlrev_b32 v65, 16, v65
    v_sub_f32 v66, v66, v27
    v_cvt_pk_bf16_f32 v66, v66, v66
    v_lshlrev_b32 v66, 16, v66
    v_mul_f32 v66, v66, v26
    v_cvt_pk_bf16_f32 v66, v66, v66
    v_lshlrev_b32 v66, 16, v66
    v_sub_f32 v67, v67, v27
    v_cvt_pk_bf16_f32 v67, v67, v67
    v_lshlrev_b32 v67, 16, v67
    v_mul_f32 v67, v67, v26
    v_cvt_pk_bf16_f32 v67, v67, v67
    v_lshlrev_b32 v67, 16, v67
    v_sub_f32 v68, v68, v27
    v_cvt_pk_bf16_f32 v68, v68, v68
    v_lshlrev_b32 v68, 16, v68
    v_mul_f32 v68, v68, v26
    v_cvt_pk_bf16_f32 v68, v68, v68
    v_lshlrev_b32 v68, 16, v68
    v_sub_f32 v69, v69, v27
    v_cvt_pk_bf16_f32 v69, v69, v69
    v_lshlrev_b32 v69, 16, v69
    v_mul_f32 v69, v69, v26
    v_cvt_pk_bf16_f32 v69, v69, v69
    v_lshlrev_b32 v69, 16, v69
    v_sub_f32 v70, v70, v27
    v_cvt_pk_bf16_f32 v70, v70, v70
    v_lshlrev_b32 v70, 16, v70
    v_mul_f32 v70, v70, v26
    v_cvt_pk_bf16_f32 v70, v70, v70
    v_lshlrev_b32 v70, 16, v70
    v_sub_f32 v71, v71, v27
    v_cvt_pk_bf16_f32 v71, v71, v71
    v_lshlrev_b32 v71, 16, v71
    v_mul_f32 v71, v71, v26
    v_cvt_pk_bf16_f32 v71, v71, v71
    v_lshlrev_b32 v71, 16, v71
    v_sub_f32 v72, v72, v27
    v_cvt_pk_bf16_f32 v72, v72, v72
    v_lshlrev_b32 v72, 16, v72
    v_mul_f32 v72, v72, v26
    v_cvt_pk_bf16_f32 v72, v72, v72
    v_lshlrev_b32 v72, 16, v72
    v_sub_f32 v73, v73, v27
    v_cvt_pk_bf16_f32 v73, v73, v73
    v_lshlrev_b32 v73, 16, v73
    v_mul_f32 v73, v73, v26
    v_cvt_pk_bf16_f32 v73, v73, v73
    v_lshlrev_b32 v73, 16, v73
    v_sub_f32 v74, v74, v27
    v_cvt_pk_bf16_f32 v74, v74, v74
    v_lshlrev_b32 v74, 16, v74
    v_mul_f32 v74, v74, v26
    v_cvt_pk_bf16_f32 v74, v74, v74
    v_lshlrev_b32 v74, 16, v74
    v_sub_f32 v75, v75, v27
    v_cvt_pk_bf16_f32 v75, v75, v75
    v_lshlrev_b32 v75, 16, v75
    v_mul_f32 v75, v75, v26
    v_cvt_pk_bf16_f32 v75, v75, v75
    v_lshlrev_b32 v75, 16, v75
    v_sub_f32 v76, v76, v27
    v_cvt_pk_bf16_f32 v76, v76, v76
    v_lshlrev_b32 v76, 16, v76
    v_mul_f32 v76, v76, v26
    v_cvt_pk_bf16_f32 v76, v76, v76
    v_lshlrev_b32 v76, 16, v76
    v_sub_f32 v77, v77, v27
    v_cvt_pk_bf16_f32 v77, v77, v77
    v_lshlrev_b32 v77, 16, v77
    v_mul_f32 v77, v77, v26
    v_cvt_pk_bf16_f32 v77, v77, v77
    v_lshlrev_b32 v77, 16, v77
    v_sub_f32 v78, v78, v27
    v_cvt_pk_bf16_f32 v78, v78, v78
    v_lshlrev_b32 v78, 16, v78
    v_mul_f32 v78, v78, v26
    v_cvt_pk_bf16_f32 v78, v78, v78
    v_lshlrev_b32 v78, 16, v78
    v_sub_f32 v79, v79, v27
    v_cvt_pk_bf16_f32 v79, v79, v79
    v_lshlrev_b32 v79, 16, v79
    v_mul_f32 v79, v79, v26
    v_cvt_pk_bf16_f32 v79, v79, v79
    v_lshlrev_b32 v79, 16, v79
    v_mul_f32 v64, v64, v144
    v_cvt_pk_bf16_f32 v64, v64, v64
    v_lshlrev_b32 v64, 16, v64
    v_add_f32 v64, v64, v128
    v_mul_f32 v65, v65, v145
    v_cvt_pk_bf16_f32 v65, v65, v65
    v_lshlrev_b32 v65, 16, v65
    v_add_f32 v65, v65, v129
    v_mul_f32 v66, v66, v146
    v_cvt_pk_bf16_f32 v66, v66, v66
    v_lshlrev_b32 v66, 16, v66
    v_add_f32 v66, v66, v130
    v_mul_f32 v67, v67, v147
    v_cvt_pk_bf16_f32 v67, v67, v67
    v_lshlrev_b32 v67, 16, v67
    v_add_f32 v67, v67, v131
    v_mul_f32 v68, v68, v148
    v_cvt_pk_bf16_f32 v68, v68, v68
    v_lshlrev_b32 v68, 16, v68
    v_add_f32 v68, v68, v132
    v_mul_f32 v69, v69, v149
    v_cvt_pk_bf16_f32 v69, v69, v69
    v_lshlrev_b32 v69, 16, v69
    v_add_f32 v69, v69, v133
    v_mul_f32 v70, v70, v150
    v_cvt_pk_bf16_f32 v70, v70, v70
    v_lshlrev_b32 v70, 16, v70
    v_add_f32 v70, v70, v134
    v_mul_f32 v71, v71, v151
    v_cvt_pk_bf16_f32 v71, v71, v71
    v_lshlrev_b32 v71, 16, v71
    v_add_f32 v71, v71, v135
    v_mul_f32 v72, v72, v152
    v_cvt_pk_bf16_f32 v72, v72, v72
    v_lshlrev_b32 v72, 16, v72
    v_add_f32 v72, v72, v136
    v_mul_f32 v73, v73, v153
    v_cvt_pk_bf16_f32 v73, v73, v73
    v_lshlrev_b32 v73, 16, v73
    v_add_f32 v73, v73, v137
    v_mul_f32 v74, v74, v154
    v_cvt_pk_bf16_f32 v74, v74, v74
    v_lshlrev_b32 v74, 16, v74
    v_add_f32 v74, v74, v138
    v_mul_f32 v75, v75, v155
    v_cvt_pk_bf16_f32 v75, v75, v75
    v_lshlrev_b32 v75, 16, v75
    v_add_f32 v75, v75, v139
    v_mul_f32 v76, v76, v156
    v_cvt_pk_bf16_f32 v76, v76, v76
    v_lshlrev_b32 v76, 16, v76
    v_add_f32 v76, v76, v140
    v_mul_f32 v77, v77, v157
    v_cvt_pk_bf16_f32 v77, v77, v77
    v_lshlrev_b32 v77, 16, v77
    v_add_f32 v77, v77, v141
    v_mul_f32 v78, v78, v158
    v_cvt_pk_bf16_f32 v78, v78, v78
    v_lshlrev_b32 v78, 16, v78
    v_add_f32 v78, v78, v142
    v_mul_f32 v79, v79, v159
    v_cvt_pk_bf16_f32 v79, v79, v79
    v_lshlrev_b32 v79, 16, v79
    v_add_f32 v79, v79, v143
    v_cvt_pk_bf16_f32 v80, v64, v65
    v_cvt_pk_bf16_f32 v81, v66, v67
    v_cvt_pk_bf16_f32 v82, v68, v69
    v_cvt_pk_bf16_f32 v83, v70, v71
    v_cvt_pk_bf16_f32 v84, v72, v73
    v_cvt_pk_bf16_f32 v85, v74, v75
    v_cvt_pk_bf16_f32 v86, v76, v77
    v_cvt_pk_bf16_f32 v87, v78, v79
    s_lshr_b32 s45, s63, 5
    s_lshl_b32 s45, s45, 16
    s_and_b32 s46, s63, 31
    s_lshl_b32 s46, s46, 8
    s_add_u32 s45, s45, s46
    s_add_u32 s45, s45, 0xc00000
    s_add_u32 s46, s45, 32768
    buffer_store_dwordx4 v[80:83], v2, s[12:15], s45 offen sc1
    buffer_store_dwordx4 v[84:87], v2, s[12:15], s46 offen sc1
L_b_skip_147:
    s_waitcnt vmcnt(0)
    s_barrier
    s_cmp_lg_u32 s44, 0
    s_cbranch_scc1 L_pub_154
    v_mov_b32 v30, s62
    v_mov_b32 v31, 0
    s_mov_b64 exec, 1
    buffer_store_dword v30, v31, s[80:83], s65 offen
    buffer_store_dword v30, v31, s[84:87], s65 offen sc1
    s_mov_b64 exec, -1
L_pub_154:
    s_cmp_ge_u32 s41, 28
    s_cbranch_scc1 L_b_loop_146
    s_add_u32 s45, s64, 8192
    s_cmp_lg_u32 s44, 0
    s_cbranch_scc1 L_pw_155
    s_mov_b32 exec_hi, 0
    s_mov_b32 s70, 0
L_wp_156:
    buffer_load_dword v31, v5, s[12:15], s45 offen sc1
    s_add_u32 s70, s70, 1
    s_cmp_ge_u32 s70, 0x200000
    s_cbranch_scc1 L_w_done_101
    s_waitcnt vmcnt(0)
    v_cmp_gt_u32 vcc, s62, v31
    s_nop 1
    s_cbranch_vccz L_wp_156_ok
    s_sleep 1
    s_branch L_wp_156
L_wp_156_ok:
    s_mov_b64 exec, -1
L_pw_155:
    s_barrier
    s_mul_i32 s53, s50, 65536
    s_add_u32 s53, s53, s52
    s_lshl_b32 s54, s44, 13
    s_add_u32 s53, s53, s54
    s_mul_i32 s57, s50, 229376
    s_add_u32 s57, s57, s56
    s_lshl_b32 s45, s44, 11
    s_add_u32 s57, s57, s45
    s_add_u32 s55, s54, 65536
    s_mov_b32 s58, 0
    v_mov_b32 v13, v3
    v_add_u32 v14, 65536, v13
    v_xor_b32 v15, 64, v13
    v_xor_b32 v16, 64, v14
    s_mov_b32 s76, 0x20000000
    s_add_u32 s48, s53, 0
    s_add_u32 s49, s48, 4096
    s_add_u32 m0, s54, 0
    s_nop 0
    buffer_load_dwordx4 v6, s[12:15], s48 offen offset:0 sc1 lds
    s_add_u32 m0, s54, 1024
    s_nop 0
    buffer_load_dwordx4 v9, s[12:15], s48 offen offset:0 sc1 lds
    s_add_u32 m0, s54, 2048
    s_nop 0
    buffer_load_dwordx4 v6, s[12:15], s49 offen offset:0 sc1 lds
    s_add_u32 m0, s54, 3072
    s_nop 0
    buffer_load_dwordx4 v9, s[12:15], s49 offen offset:0 sc1 lds
    s_add_u32 m0, s54, 3968
    s_nop 0
    buffer_load_dwordx4 v6, s[12:15], s48 offen offset:128 sc1 lds
    s_add_u32 m0, s54, 4992
    s_nop 0
    buffer_load_dwordx4 v9, s[12:15], s48 offen offset:128 sc1 lds
    s_add_u32 m0, s54, 6016
    s_nop 0
    buffer_load_dwordx4 v6, s[12:15], s49 offen offset:128 sc1 lds
    s_add_u32 m0, s54, 7040
    s_nop 0
    buffer_load_dwordx4 v9, s[12:15], s49 offen offset:128 sc1 lds
    s_add_u32 s48, s53, 32768
    s_add_u32 s49, s48, 4096
    s_add_u32 s46, s54, 32768
    s_add_u32 m0, s46, 0
    s_nop 0
    buffer_load_dwordx4 v6, s[12:15], s48 offen offset:0 sc1 lds
    s_add_u32 m0, s46, 1024
    s_nop 0
    buffer_load_dwordx4 v9, s[12:15], s48 offen offset:0 sc1 lds
    s_add_u32 m0, s46, 2048
    s_nop 0
    buffer_load_dwordx4 v6, s[12:15], s49 offen offset:0 sc1 lds
    s_add_u32 m0, s46, 3072
    s_nop 0
    buffer_load_dwordx4 v9, s[12:15], s49 offen offset:0 sc1 lds
    s_add_u32 m0, s46, 3968
    s_nop 0
    buffer_load_dwordx4 v6, s[12:15], s48 offen offset:128 sc1 lds
    s_add_u32 m0, s46, 4992
    s_nop 0
    buffer_load_dwordx4 v9, s[12:15], s48 offen offset:128 sc1 lds
    s_add_u32 m0, s46, 6016
    s_nop 0
    buffer_load_dwordx4 v6, s[12:15], s49 offen offset:128 sc1 lds
    s_add_u32 m0, s46, 7040
    s_nop 0
    buffer_load_dwordx4 v9, s[12:15], s49 offen offset:128 sc1 lds
    s_cmp_eq_u32 s51, 1
    s_cbranch_scc1 L_e_one_158
    s_add_u32 s48, s53, 65536
    s_add_u32 s49, s48, 4096
    s_add_u32 m0, s55, 0
    s_nop 0
    buffer_load_dwordx4 v6, s[12:15], s48 offen offset:0 sc1 lds
    s_add_u32 m0, s55, 1024
    s_nop 0
    buffer_load_dwordx4 v9, s[12:15], s48 offen offset:0 sc1 lds
    s_add_u32 m0, s55, 2048
    s_nop 0
    buffer_load_dwordx4 v6, s[12:15], s49 offen offset:0 sc1 lds
    s_add_u32 m0, s55, 3072
    s_nop 0
    buffer_load_dwordx4 v9, s[12:15], s49 offen offset:0 sc1 lds
    s_add_u32 m0, s55, 3968
    s_nop 0
    buffer_load_dwordx4 v6, s[12:15], s48 offen offset:128 sc1 lds
    s_add_u32 m0, s55, 4992
    s_nop 0
    buffer_load_dwordx4 v9, s[12:15], s48 offen offset:128 sc1 lds
    s_add_u32 m0, s55, 6016
    s_nop 0
    buffer_load_dwordx4 v6, s[12:15], s49 offen offset:128 sc1 lds
    s_add_u32 m0, s55, 7040
    s_nop 0
    buffer_load_dwordx4 v9, s[12:15], s49 offen offset:128 sc1 lds
    s_waitcnt vmcnt(16)
    s_barrier
    ds_read_b128 v[32:35], v13 offset:0
    ds_read_b128 v[36:39], v13 offset:2048
    ds_read_b128 v[40:43], v15 offset:0
    ds_read_b128 v[44:47], v15 offset:2048
L_e_loop_157:
    s_add_u32 s48, s53, 98304
    s_add_u32 s46, s58, 1
    s_cmp_lt_u32 s46, s51
    s_cselect_b32 s48, s48, 0x20000000
    s_add_u32 s49, s48, 4096
    s_add_u32 s59, s55, 32768
    s_waitcnt lgkmcnt(2)
    v_mfma_f32_16x16x32_bf16 v[80:83], a[0:3], v[32:35], 0
    ds_read_b128 v[48:51], v13 offset:4096
    ds_read_b128 v[52:55], v13 offset:6144
    v_mfma_f32_16x16x32_bf16 v[84:87], a[4:7], v[32:35], 0
    ds_read_b128 v[56:59], v15 offset:4096
    ds_read_b128 v[60:63], v15 offset:6144
    v_mfma_f32_16x16x32_bf16 v[88:91], a[0:3], v[36:39], 0
    s_add_u32 m0, s59, 0
    s_nop 0
    buffer_load_dwordx4 v6, s[12:15], s48 offen offset:0 sc1 lds
    v_mfma_f32_16x16x32_bf16 v[92:95], a[4:7], v[36:39], 0
    v_lshlrev_b32 v224, 16, v216
    v_and_b32 v225, 0xffff0000, v216
    s_waitcnt lgkmcnt(4)
    v_mfma_f32_16x16x32_bf16 v[80:83], a[8:11], v[40:43], v[80:83]
    ds_read_b128 v[32:35], v13 offset:8192
    ds_read_b128 v[36:39], v13 offset:10240
    v_mfma_f32_16x16x32_bf16 v[84:87], a[12:15], v[40:43], v[84:87]
    v_lshlrev_b32 v226, 16, v217
    v_and_b32 v227, 0xffff0000, v217
    v_mfma_f32_16x16x32_bf16 v[88:91], a[8:11], v[44:47], v[88:91]
    s_add_u32 m0, s59, 1024
    s_nop 0
    buffer_load_dwordx4 v9, s[12:15], s48 offen offset:0 sc1 lds
    v_mfma_f32_16x16x32_bf16 v[92:95], a[12:15], v[44:47], v[92:95]
    v_lshlrev_b32 v228, 16, v218
    v_and_b32 v229, 0xffff0000, v218
    s_waitcnt lgkmcnt(4)
    v_mfma_f32_16x16x32_bf16 v[80:83], a[16:19], v[48:51], v[80:83]
    ds_read_b128 v[40:43], v15 offset:8192
    ds_read_b128 v[44:47], v15 offset:10240
    v_mfma_f32_16x16x32_bf16 v[84:87], a[20:23], v[48:51], v[84:87]
    v_lshlrev_b32 v230, 16, v219
    v_and_b32 v231, 0xffff0000, v219
    v_mfma_f32_16x16x32_bf16 v[88:91], a[16:19], v[52:55], v[88:91]
    s_add_u32 m0, s59, 2048
    s_nop 0
    buffer_load_dwordx4 v6, s[12:15], s49 offen offset:0 sc1 lds
    v_mfma_f32_16x16x32_bf16 v[92:95], a[20:23], v[52:55], v[92:95]
    v_lshlrev_b32 v232, 16, v220
    v_and_b32 v233, 0xffff0000, v220
    s_waitcnt lgkmcnt(4)
    v_mfma_f32_16x16x32_bf16 v[80:83], a[24:27], v[56:59], v[80:83]
    ds_read_b128 v[48:51], v13 offset:12288
    ds_read_b128 v[52:55], v13 offset:14336
    v_mfma_f32_16x16x32_bf16 v[84:87], a[28:31], v[56:59], v[84:87]
    v_lshlrev_b32 v234, 16, v221
    v_and_b32 v235, 0xffff0000, v221
    v_mfma_f32_16x16x32_bf16 v[88:91], a[24:27], v[60:63], v[88:91]
    s_add_u32 m0, s59, 3072
    s_nop 0
    buffer_load_dwordx4 v9, s[12:15], s49 offen offset:0 sc1 lds
    v_mfma_f32_16x16x32_bf16 v[92:95], a[28:31], v[60:63], v[92:95]
    v_lshlrev_b32 v236, 16, v222
    v_and_b32 v237, 0xffff0000, v222
    s_waitcnt lgkmcnt(4)
    v_mfma_f32_16x16x32_bf16 v[80:83], a[32:35], v[32:35], v[80:83]
    ds_read_b128 v[56:59], v15 offset:12288
    ds_read_b128 v[60:63], v15 offset:14336
    v_mfma_f32_16x16x32_bf16 v[84:87], a[36:39], v[32:35], v[84:87]
    v_lshlrev_b32 v238, 16, v223
    v_and_b32 v239, 0xffff0000, v223
    v_mfma_f32_16x16x32_bf16 v[88:91], a[32:35], v[36:39], v[88:91]
    s_add_u32 m0, s59, 3968
    s_nop 0
    buffer_load_dwordx4 v6, s[12:15], s48 offen offset:128 sc1 lds
    v_mfma_f32_16x16x32_bf16 v[92:95], a[36:39], v[36:39], v[92:95]
    v_pk_add_f32 v[224:225], v[224:225], v[96:97]
    v_pk_add_f32 v[226:227], v[226:227], v[98:99]
    s_waitcnt lgkmcnt(4)
    v_mfma_f32_16x16x32_bf16 v[80:83], a[40:43], v[40:43], v[80:83]
    ds_read_b128 v[32:35], v13 offset:16384
    ds_read_b128 v[36:39], v13 offset:18432
    v_mfma_f32_16x16x32_bf16 v[84:87], a[44:47], v[40:43], v[84:87]
    v_pk_add_f32 v[228:229], v[228:229], v[100:101]
    v_pk_add_f32 v[230:231], v[230:231], v[102:103]
    v_mfma_f32_16x16x32_bf16 v[88:91], a[40:43], v[44:47], v[88:91]
    s_add_u32 m0, s59, 4992
    s_nop 0
    buffer_load_dwordx4 v9, s[12:15], s48 offen offset:128 sc1 lds
    v_mfma_f32_16x16x32_bf16 v[92:95], a[44:47], v[44:47], v[92:95]
    v_pk_add_f32 v[232:233], v[232:233], v[96:97]
    v_pk_add_f32 v[234:235], v[234:235], v[98:99]
    s_waitcnt lgkmcnt(4)
    v_mfma_f32_16x16x32_bf16 v[80:83], a[48:51], v[48:51], v[80:83]
    ds_read_b128 v[40:43], v15 offset:16384
    ds_read_b128 v[44:47], v15 offset:18432
    v_mfma_f32_16x16x32_bf16 v[84:87], a[52:55], v[48:51], v[84:87]
    v_pk_add_f32 v[236:237], v[236:237], v[100:101]
    v_pk_add_f32 v[238:239], v[238:239], v[102:103]
    v_mfma_f32_16x16x32_bf16 v[88:91], a[48:51], v[52:55], v[88:91]
    s_add_u32 m0, s59, 6016
    s_nop 0
    buffer_load_dwordx4 v6, s[12:15], s49 offen offset:128 sc1 lds
    v_mfma_f32_16x16x32_bf16 v[92:95], a[52:55], v[52:55], v[92:95]
    v_cvt_pk_bf16_f32 v216, v224, v225
    v_cvt_pk_bf16_f32 v217, v226, v227
    s_waitcnt lgkmcnt(4)
    v_mfma_f32_16x16x32_bf16 v[80:83], a[56:59], v[56:59], v[80:83]
    ds_read_b128 v[48:51], v13 offset:20480
    ds_read_b128 v[52:55], v13 offset:22528
    v_mfma_f32_16x16x32_bf16 v[84:87], a[60:63], v[56:59], v[84:87]
    v_cvt_pk_bf16_f32 v218, v228, v229
    v_cvt_pk_bf16_f32 v219, v230, v231
    v_mfma_f32_16x16x32_bf16 v[88:91], a[56:59], v[60:63], v[88:91]
    s_add_u32 m0, s59, 7040
    s_nop 0
    buffer_load_dwordx4 v9, s[12:15], s49 offen offset:128 sc1 lds
    v_mfma_f32_16x16x32_bf16 v[92:95], a[60:63], v[60:63], v[92:95]
    v_cvt_pk_bf16_f32 v220, v232, v233
    v_cvt_pk_bf16_f32 v221, v234, v235
    s_waitcnt lgkmcnt(4)
    v_mfma_f32_16x16x32_bf16 v[80:83], a[64:67], v[32:35], v[80:83]
    ds_read_b128 v[56:59], v15 offset:20480
    ds_read_b128 v[60:63], v15 offset:22528
    v_mfma_f32_16x16x32_bf16 v[84:87], a[68:71], v[32:35], v[84:87]
    v_cvt_pk_bf16_f32 v222, v236, v237
    v_cvt_pk_bf16_f32 v223, v238, v239
    v_mfma_f32_16x16x32_bf16 v[88:91], a[64:67], v[36:39], v[88:91]
    v_lshlrev_b32 v224, 16, v216
    v_and_b32 v225, 0xffff0000, v216
    v_mfma_f32_16x16x32_bf16 v[92:95], a[68:71], v[36:39], v[92:95]
    v_lshlrev_b32 v226, 16, v217
    v_and_b32 v227, 0xffff0000, v217
    s_waitcnt lgkmcnt(4)
    v_mfma_f32_16x16x32_bf16 v[80:83], a[72:75], v[40:43], v[80:83]
    ds_read_b128 v[32:35], v13 offset:24576
    ds_read_b128 v[36:39], v13 offset:26624
    v_mfma_f32_16x16x32_bf16 v[84:87], a[76:79], v[40:43], v[84:87]
    v_lshlrev_b32 v228, 16, v218
    v_and_b32 v229, 0xffff0000, v218
    v_mfma_f32_16x16x32_bf16 v[88:91], a[72:75], v[44:47], v[88:91]
    v_lshlrev_b32 v230, 16, v219
    v_and_b32 v231, 0xffff0000, v219
    v_mfma_f32_16x16x32_bf16 v[92:95], a[76:79], v[44:47], v[92:95]
    v_lshlrev_b32 v232, 16, v220
    v_and_b32 v233, 0xffff0000, v220
    s_waitcnt lgkmcnt(4)
    v_mfma_f32_16x16x32_bf16 v[80:83], a[80:83], v[48:51], v[80:83]
    ds_read_b128 v[40:43], v15 offset:24576
    ds_read_b128 v[44:47], v15 offset:26624
    v_mfma_f32_16x16x32_bf16 v[84:87], a[84:87], v[48:51], v[84:87]
    v_lshlrev_b32 v234, 16, v221
    v_and_b32 v235, 0xffff0000, v221
    v_mfma_f32_16x16x32_bf16 v[88:91], a[80:83], v[52:55], v[88:91]
    v_lshlrev_b32 v236, 16, v222
    v_and_b32 v237, 0xffff0000, v222
    v_mfma_f32_16x16x32_bf16 v[92:95], a[84:87], v[52:55], v[92:95]
    v_lshlrev_b32 v238, 16, v223
    v_and_b32 v239, 0xffff0000, v223
    s_waitcnt lgkmcnt(4)
    v_mfma_f32_16x16x32_bf16 v[80:83], a[88:91], v[56:59], v[80:83]
    ds_read_b128 v[48:51], v13 offset:28672
    ds_read_b128 v[52:55], v13 offset:30720
    v_mfma_f32_16x16x32_bf16 v[84:87], a[92:95], v[56:59], v[84:87]
    v_pk_mul_f32 v[240:241], v[224:225], v[224:225]
    v_pk_mul_f32 v[242:243], v[226:227], v[226:227]
    v_mfma_f32_16x16x32_bf16 v[88:91], a[88:91], v[60:63], v[88:91]
    v_pk_mul_f32 v[244:245], v[228:229], v[228:229]
    v_pk_mul_f32 v[246:247], v[230:231], v[230:231]
    v_mfma_f32_16x16x32_bf16 v[92:95], a[92:95], v[60:63], v[92:95]
    v_pk_mul_f32 v[248:249], v[232:233], v[232:233]
    v_pk_mul_f32 v[250:251], v[234:235], v[234:235]
    s_waitcnt lgkmcnt(4)
    v_mfma_f32_16x16x32_bf16 v[80:83], a[96:99], v[32:35], v[80:83]
    ds_read_b128 v[56:59], v15 offset:28672
    ds_read_b128 v[60:63], v15 offset:30720
    v_mfma_f32_16x16x32_bf16 v[84:87], a[100:103], v[32:35], v[84:87]
    v_pk_mul_f32 v[252:253], v[236:237], v[236:237]
    v_pk_mul_f32 v[254:255], v[238:239], v[238:239]
    v_mfma_f32_16x16x32_bf16 v[88:91], a[96:99], v[36:39], v[88:91]
    v_pk_fma_f32 v[240:241], v[240:241], v[104:105], v[106:107]
    v_pk_fma_f32 v[242:243], v[242:243], v[104:105], v[106:107]
    v_mfma_f32_16x16x32_bf16 v[92:95], a[100:103], v[36:39], v[92:95]
    v_pk_fma_f32 v[244:245], v[244:245], v[104:105], v[106:107]
    v_pk_fma_f32 v[246:247], v[246:247], v[104:105], v[106:107]
    s_waitcnt lgkmcnt(4)
    v_mfma_f32_16x16x32_bf16 v[80:83], a[104:107], v[40:43], v[80:83]
    v_pk_fma_f32 v[248:249], v[248:249], v[104:105], v[106:107]
    v_pk_fma_f32 v[250:251], v[250:251], v[104:105], v[106:107]
    v_mfma_f32_16x16x32_bf16 v[84:87], a[108:111], v[40:43], v[84:87]
    v_pk_fma_f32 v[252:253], v[252:253], v[104:105], v[106:107]
    v_pk_fma_f32 v[254:255], v[254:255], v[104:105], v[106:107]
    v_mfma_f32_16x16x32_bf16 v[88:91], a[104:107], v[44:47], v[88:91]
    v_pk_mul_f32 v[240:241], v[240:241], v[224:225]
    v_pk_mul_f32 v[242:243], v[242:243], v[226:227]
    v_mfma_f32_16x16x32_bf16 v[92:95], a[108:111], v[44:47], v[92:95]
    v_pk_mul_f32 v[244:245], v[244:245], v[228:229]
    v_pk_mul_f32 v[246:247], v[246:247], v[230:231]
    s_waitcnt vmcnt(16) lgkmcnt(0)
    s_barrier
    v_mfma_f32_16x16x32_bf16 v[80:83], a[112:115], v[48:51], v[80:83]
    ds_read_b128 v[32:35], v13 offset:32768
    ds_read_b128 v[36:39], v13 offset:34816
    v_mfma_f32_16x16x32_bf16 v[84:87], a[116:119], v[48:51], v[84:87]
    v_pk_mul_f32 v[248:249], v[248:249], v[232:233]
    v_pk_mul_f32 v[250:251], v[250:251], v[234:235]
    v_mfma_f32_16x16x32_bf16 v[88:91], a[112:115], v[52:55], v[88:91]
    v_pk_mul_f32 v[252:253], v[252:253], v[236:237]
    v_pk_mul_f32 v[254:255], v[254:255], v[238:239]
    v_mfma_f32_16x16x32_bf16 v[92:95], a[116:119], v[52:55], v[92:95]
    v_exp_f32 v240, v240
    v_mfma_f32_16x16x32_bf16 v[80:83], a[120:123], v[56:59], v[80:83]
    ds_read_b128 v[40:43], v15 offset:32768
    ds_read_b128 v[44:47], v15 offset:34816
    v_mfma_f32_16x16x32_bf16 v[84:87], a[124:127], v[56:59], v[84:87]
    v_exp_f32 v241, v241
    v_exp_f32 v242, v242
    v_mfma_f32_16x16x32_bf16 v[88:91], a[120:123], v[60:63], v[88:91]
    v_exp_f32 v243, v243
    v_mfma_f32_16x16x32_bf16 v[92:95], a[124:127], v[60:63], v[92:95]
    v_exp_f32 v244, v244
    s_add_u32 s48, s53, 131072
    s_add_u32 s46, s58, 2
    s_cmp_lt_u32 s46, s51
    s_cselect_b32 s48, s48, 0x20000000
    s_add_u32 s49, s48, 4096
    s_mov_b32 s59, s54
    s_waitcnt lgkmcnt(2)
    v_mfma_f32_16x16x32_bf16 v[80:83], a[128:131], v[32:35], v[80:83]
    ds_read_b128 v[48:51], v13 offset:36864
    ds_read_b128 v[52:55], v13 offset:38912
    v_mfma_f32_16x16x32_bf16 v[84:87], a[132:135], v[32:35], v[84:87]
    ds_read_b128 v[56:59], v15 offset:36864
    ds_read_b128 v[60:63], v15 offset:38912
    v_mfma_f32_16x16x32_bf16 v[88:91], a[128:131], v[36:39], v[88:91]
    s_add_u32 m0, s59, 0
    s_nop 0
    buffer_load_dwordx4 v6, s[12:15], s48 offen offset:0 sc1 lds
    v_mfma_f32_16x16x32_bf16 v[92:95], a[132:135], v[36:39], v[92:95]
    v_exp_f32 v245, v245
    v_exp_f32 v246, v246
    s_waitcnt lgkmcnt(4)
    v_mfma_f32_16x16x32_bf16 v[80:83], a[136:139], v[40:43], v[80:83]
    ds_read_b128 v[32:35], v13 offset:40960
    ds_read_b128 v[36:39], v13 offset:43008
    v_mfma_f32_16x16x32_bf16 v[84:87], a[140:143], v[40:43], v[84:87]
    v_exp_f32 v247, v247
    v_exp_f32 v248, v248
    v_mfma_f32_16x16x32_bf16 v[88:91], a[136:139], v[44:47], v[88:91]
    s_add_u32 m0, s59, 1024
    s_nop 0
    buffer_load_dwordx4 v9, s[12:15], s48 offen offset:0 sc1 lds
    v_mfma_f32_16x16x32_bf16 v[92:95], a[140:143], v[44:47], v[92:95]
    v_exp_f32 v249, v249
    v_exp_f32 v250, v250
    s_waitcnt lgkmcnt(4)
    v_mfma_f32_16x16x32_bf16 v[80:83], a[144:147], v[48:51], v[80:83]
    ds_read_b128 v[40:43], v15 offset:40960
    ds_read_b128 v[44:47], v15 offset:43008
    v_mfma_f32_16x16x32_bf16 v[84:87], a[148:151], v[48:51], v[84:87]
    v_exp_f32 v251, v251
    v_exp_f32 v252, v252
    v_mfma_f32_16x16x32_bf16 v[88:91], a[144:147], v[52:55], v[88:91]
    s_add_u32 m0, s59, 2048
    s_nop 0
    buffer_load_dwordx4 v6, s[12:15], s49 offen offset:0 sc1 lds
    v_mfma_f32_16x16x32_bf16 v[92:95], a[148:151], v[52:55], v[92:95]
    v_exp_f32 v253, v253
    v_exp_f32 v254, v254
    s_waitcnt lgkmcnt(4)
    v_mfma_f32_16x16x32_bf16 v[80:83], a[152:155], v[56:59], v[80:83]
    ds_read_b128 v[48:51], v13 offset:45056
    ds_read_b128 v[52:55], v13 offset:47104
    v_mfma_f32_16x16x32_bf16 v[84:87], a[156:159], v[56:59], v[84:87]
    v_exp_f32 v255, v255
    v_add_f32 v240, 1.0, v240
    v_mfma_f32_16x16x32_bf16 v[88:91], a[152:155], v[60:63], v[88:91]
    s_add_u32 m0, s59, 3072
    s_nop 0
    buffer_load_dwordx4 v9, s[12:15], s49 offen offset:0 sc1 lds
    v_mfma_f32_16x16x32_bf16 v[92:95], a[156:159], v[60:63], v[92:95]
    v_add_f32 v241, 1.0, v241
    v_add_f32 v242, 1.0, v242
    s_waitcnt lgkmcnt(4)
    v_mfma_f32_16x16x32_bf16 v[80:83], a[160:163], v[32:35], v[80:83]
    ds_read_b128 v[56:59], v15 offset:45056
    ds_read_b128 v[60:63], v15 offset:47104
    v_mfma_f32_16x16x32_bf16 v[84:87], a[164:167], v[32:35], v[84:87]
    v_add_f32 v243, 1.0, v243
    v_add_f32 v244, 1.0, v244
    v_mfma_f32_16x16x32_bf16 v[88:91], a[160:163], v[36:39], v[88:91]
    s_add_u32 m0, s59, 3968
    s_nop 0
    buffer_load_dwordx4 v6, s[12:15], s48 offen offset:128 sc1 lds
    v_mfma_f32_16x16x32_bf16 v[92:95], a[164:167], v[36:39], v[92:95]
    v_add_f32 v245, 1.0, v245
    v_add_f32 v246, 1.0, v246
    s_waitcnt lgkmcnt(4)
    v_mfma_f32_16x16x32_bf16 v[80:83], a[168:171], v[40:43], v[80:83]
    ds_read_b128 v[32:35], v13 offset:49152
    ds_read_b128 v[36:39], v13 offset:51200
    v_mfma_f32_16x16x32_bf16 v[84:87], a[172:175], v[40:43], v[84:87]
    v_add_f32 v247, 1.0, v247
    v_add_f32 v248, 1.0, v248
    v_mfma_f32_16x16x32_bf16 v[88:91], a[168:171], v[44:47], v[88:91]
    s_add_u32 m0, s59, 4992
    s_nop 0
    buffer_load_dwordx4 v9, s[12:15], s48 offen offset:128 sc1 lds
    v_mfma_f32_16x16x32_bf16 v[92:95], a[172:175], v[44:47], v[92:95]
    v_add_f32 v249, 1.0, v249
    v_add_f32 v250, 1.0, v250
    s_waitcnt lgkmcnt(4)
    v_mfma_f32_16x16x32_bf16 v[80:83], a[176:179], v[48:51], v[80:83]
    ds_read_b128 v[40:43], v15 offset:49152
    ds_read_b128 v[44:47], v15 offset:51200
    v_mfma_f32_16x16x32_bf16 v[84:87], a[180:183], v[48:51], v[84:87]
    v_add_f32 v251, 1.0, v251
    v_add_f32 v252, 1.0, v252
    v_mfma_f32_16x16x32_bf16 v[88:91], a[176:179], v[52:55], v[88:91]
    s_add_u32 m0, s59, 6016
    s_nop 0
    buffer_load_dwordx4 v6, s[12:15], s49 offen offset:128 sc1 lds
    v_mfma_f32_16x16x32_bf16 v[92:95], a[180:183], v[52:55], v[92:95]
    v_add_f32 v253, 1.0, v253
    v_add_f32 v254, 1.0, v254
    s_waitcnt lgkmcnt(4)
    v_mfma_f32_16x16x32_bf16 v[80:83], a[184:187], v[56:59], v[80:83]
    ds_read_b128 v[48:51], v13 offset:53248
    ds_read_b128 v[52:55], v13 offset:55296
    v_mfma_f32_16x16x32_bf16 v[84:87], a[188:191], v[56:59], v[84:87]
    v_add_f32 v255, 1.0, v255
    v_rcp_f32 v240, v240
    v_mfma_f32_16x16x32_bf16 v[88:91], a[184:187], v[60:63], v[88:91]
    s_add_u32 m0, s59, 7040
    s_nop 0
    buffer_load_dwordx4 v9, s[12:15], s49 offen offset:128 sc1 lds
    v_mfma_f32_16x16x32_bf16 v[92:95], a[188:191], v[60:63], v[92:95]
    v_rcp_f32 v241, v241
    v_rcp_f32 v242, v242
    s_waitcnt lgkmcnt(4)
    v_mfma_f32_16x16x32_bf16 v[80:83], a[192:195], v[32:35], v[80:83]
    ds_read_b128 v[56:59], v15 offset:53248
    ds_read_b128 v[60:63], v15 offset:55296
    v_mfma_f32_16x16x32_bf16 v[84:87], a[196:199], v[32:35], v[84:87]
    v_rcp_f32 v243, v243
    v_rcp_f32 v244, v244
    v_mfma_f32_16x16x32_bf16 v[88:91], a[192:195], v[36:39], v[88:91]
    v_rcp_f32 v245, v245
    v_rcp_f32 v246, v246
    v_mfma_f32_16x16x32_bf16 v[92:95], a[196:199], v[36:39], v[92:95]
    v_rcp_f32 v247, v247
    v_rcp_f32 v248, v248
    s_waitcnt lgkmcnt(4)
    v_mfma_f32_16x16x32_bf16 v[80:83], a[200:203], v[40:43], v[80:83]
    ds_read_b128 v[32:35], v13 offset:57344
    ds_read_b128 v[36:39], v13 offset:59392
    v_mfma_f32_16x16x32_bf16 v[84:87], a[204:207], v[40:43], v[84:87]
    v_rcp_f32 v249, v249
    v_rcp_f32 v250, v250
    v_mfma_f32_16x16x32_bf16 v[88:91], a[200:203], v[44:47], v[88:91]
    v_rcp_f32 v251, v251
    v_mfma_f32_16x16x32_bf16 v[92:95], a[204:207], v[44:47], v[92:95]
    v_rcp_f32 v252, v252
    s_waitcnt lgkmcnt(4)
    v_mfma_f32_16x16x32_bf16 v[80:83], a[208:211], v[48:51], v[80:83]
    ds_read_b128 v[40:43], v15 offset:57344
    ds_read_b128 v[44:47], v15 offset:59392
    v_mfma_f32_16x16x32_bf16 v[84:87], a[212:215], v[48:51], v[84:87]
    v_rcp_f32 v253, v253
    v_rcp_f32 v254, v254
    v_mfma_f32_16x16x32_bf16 v[88:91], a[208:211], v[52:55], v[88:91]
    v_rcp_f32 v255, v255
    v_mfma_f32_16x16x32_bf16 v[92:95], a[212:215], v[52:55], v[92:95]
    v_pk_mul_f32 v[224:225], v[224:225], v[240:241]
    s_waitcnt lgkmcnt(4)
    v_mfma_f32_16x16x32_bf16 v[80:83], a[216:219], v[56:59], v[80:83]
    ds_read_b128 v[48:51], v13 offset:61440
    ds_read_b128 v[52:55], v13 offset:63488
    v_mfma_f32_16x16x32_bf16 v[84:87], a[220:223], v[56:59], v[84:87]
    v_pk_mul_f32 v[226:227], v[226:227], v[242:243]
    v_pk_mul_f32 v[228:229], v[228:229], v[244:245]
    v_mfma_f32_16x16x32_bf16 v[88:91], a[216:219], v[60:63], v[88:91]
    v_pk_mul_f32 v[230:231], v[230:231], v[246:247]
    v_mfma_f32_16x16x32_bf16 v[92:95], a[220:223], v[60:63], v[92:95]
    v_pk_mul_f32 v[232:233], v[232:233], v[248:249]
    s_waitcnt lgkmcnt(4)
    v_mfma_f32_16x16x32_bf16 v[80:83], a[224:227], v[32:35], v[80:83]
    ds_read_b128 v[56:59], v15 offset:61440
    ds_read_b128 v[60:63], v15 offset:63488
    v_mfma_f32_16x16x32_bf16 v[84:87], a[228:231], v[32:35], v[84:87]
    v_pk_mul_f32 v[234:235], v[234:235], v[250:251]
    v_pk_mul_f32 v[236:237], v[236:237], v[252:253]
    v_mfma_f32_16x16x32_bf16 v[88:91], a[224:227], v[36:39], v[88:91]
    v_pk_mul_f32 v[238:239], v[238:239], v[254:255]
    v_mfma_f32_16x16x32_bf16 v[92:95], a[228:231], v[36:39], v[92:95]
    v_cvt_pk_bf16_f32 v240, v224, v225
    s_waitcnt lgkmcnt(4)
    v_mfma_f32_16x16x32_bf16 v[80:83], a[232:235], v[40:43], v[80:83]
    v_cvt_pk_bf16_f32 v241, v226, v227
    v_mfma_f32_16x16x32_bf16 v[84:87], a[236:239], v[40:43], v[84:87]
    v_cvt_pk_bf16_f32 v242, v228, v229
    v_mfma_f32_16x16x32_bf16 v[88:91], a[232:235], v[44:47], v[88:91]
    v_cvt_pk_bf16_f32 v243, v230, v231
    v_mfma_f32_16x16x32_bf16 v[92:95], a[236:239], v[44:47], v[92:95]
    v_cvt_pk_bf16_f32 v244, v232, v233
    s_waitcnt vmcnt(16) lgkmcnt(0)
    s_barrier
    v_mfma_f32_16x16x32_bf16 v[80:83], a[240:243], v[48:51], v[80:83]
    ds_read_b128 v[32:35], v14 offset:0
    ds_read_b128 v[36:39], v14 offset:2048
    v_mfma_f32_16x16x32_bf16 v[84:87], a[244:247], v[48:51], v[84:87]
    v_cvt_pk_bf16_f32 v245, v234, v235
    v_cvt_pk_bf16_f32 v246, v236, v237
    v_mfma_f32_16x16x32_bf16 v[88:91], a[240:243], v[52:55], v[88:91]
    v_cvt_pk_bf16_f32 v247, v238, v239
    v_mfma_f32_16x16x32_bf16 v[92:95], a[244:247], v[52:55], v[92:95]
    buffer_store_dwordx4 v[240:243], v10, s[12:15], s76 offen sc1
    v_mfma_f32_16x16x32_bf16 v[80:83], a[248:251], v[56:59], v[80:83]
    ds_read_b128 v[40:43], v16 offset:0
    ds_read_b128 v[44:47], v16 offset:2048
    v_mfma_f32_16x16x32_bf16 v[84:87], a[252:255], v[56:59], v[84:87]
    buffer_store_dwordx4 v[244:247], v10, s[12:15], s76 offen offset:1024 sc1
    v_mfma_f32_16x16x32_bf16 v[88:91], a[248:251], v[60:63], v[88:91]
    v_mfma_f32_16x16x32_bf16 v[92:95], a[252:255], v[60:63], v[92:95]
    s_add_u32 s53, s53, 65536
    s_add_u32 s58, s58, 1
    v_swap_b32 v13, v14
    s_xor_b32 s54, s54, 65536
    s_xor_b32 s55, s55, 65536
    s_mov_b32 s76, s57
    v_swap_b32 v15, v16
    s_add_u32 s57, s57, 229376
    v_cvt_pk_bf16_f32 v216, v80, v81
    v_cvt_pk_bf16_f32 v217, v82, v83
    v_cvt_pk_bf16_f32 v218, v84, v85
    v_cvt_pk_bf16_f32 v219, v86, v87
    v_cvt_pk_bf16_f32 v220, v88, v89
    v_cvt_pk_bf16_f32 v221, v90, v91
    v_cvt_pk_bf16_f32 v222, v92, v93
    v_cvt_pk_bf16_f32 v223, v94, v95
    s_cmp_lt_u32 s58, s51
    s_cbranch_scc1 L_e_loop_157
    s_branch L_e_fin_159
L_e_one_158:
    s_waitcnt vmcnt(8)
    s_barrier
    ds_read_b128 v[32:35], v13 offset:0
    ds_read_b128 v[36:39], v13 offset:2048
    ds_read_b128 v[40:43], v15 offset:0
    ds_read_b128 v[44:47], v15 offset:2048
    s_waitcnt lgkmcnt(2)
    v_mfma_f32_16x16x32_bf16 v[80:83], a[0:3], v[32:35], 0
    ds_read_b128 v[48:51], v13 offset:4096
    ds_read_b128 v[52:55], v13 offset:6144
    v_mfma_f32_16x16x32_bf16 v[84:87], a[4:7], v[32:35], 0
    ds_read_b128 v[56:59], v15 offset:4096
    ds_read_b128 v[60:63], v15 offset:6144
    v_mfma_f32_16x16x32_bf16 v[88:91], a[0:3], v[36:39], 0
    v_mfma_f32_16x16x32_bf16 v[92:95], a[4:7], v[36:39], 0
    s_waitcnt lgkmcnt(4)
    v_mfma_f32_16x16x32_bf16 v[80:83], a[8:11], v[40:43], v[80:83]
    ds_read_b128 v[32:35], v13 offset:8192
    ds_read_b128 v[36:39], v13 offset:10240
    v_mfma_f32_16x16x32_bf16 v[84:87], a[12:15], v[40:43], v[84:87]
    v_mfma_f32_16x16x32_bf16 v[88:91], a[8:11], v[44:47], v[88:91]
    v_mfma_f32_16x16x32_bf16 v[92:95], a[12:15], v[44:47], v[92:95]
    s_waitcnt lgkmcnt(4)
    v_mfma_f32_16x16x32_bf16 v[80:83], a[16:19], v[48:51], v[80:83]
    ds_read_b128 v[40:43], v15 offset:8192
    ds_read_b128 v[44:47], v15 offset:10240
    v_mfma_f32_16x16x32_bf16 v[84:87], a[20:23], v[48:51], v[84:87]
    v_mfma_f32_16x16x32_bf16 v[88:91], a[16:19], v[52:55], v[88:91]
    v_mfma_f32_16x16x32_bf16 v[92:95], a[20:23], v[52:55], v[92:95]
    s_waitcnt lgkmcnt(4)
    v_mfma_f32_16x16x32_bf16 v[80:83], a[24:27], v[56:59], v[80:83]
    ds_read_b128 v[48:51], v13 offset:12288
    ds_read_b128 v[52:55], v13 offset:14336
    v_mfma_f32_16x16x32_bf16 v[84:87], a[28:31], v[56:59], v[84:87]
    v_mfma_f32_16x16x32_bf16 v[88:91], a[24:27], v[60:63], v[88:91]
    v_mfma_f32_16x16x32_bf16 v[92:95], a[28:31], v[60:63], v[92:95]
    s_waitcnt lgkmcnt(4)
    v_mfma_f32_16x16x32_bf16 v[80:83], a[32:35], v[32:35], v[80:83]
    ds_read_b128 v[56:59], v15 offset:12288
    ds_read_b128 v[60:63], v15 offset:14336
    v_mfma_f32_16x16x32_bf16 v[84:87], a[36:39], v[32:35], v[84:87]
    v_mfma_f32_16x16x32_bf16 v[88:91], a[32:35], v[36:39], v[88:91]
    v_mfma_f32_16x16x32_bf16 v[92:95], a[36:39], v[36:39], v[92:95]
    s_waitcnt lgkmcnt(4)
    v_mfma_f32_16x16x32_bf16 v[80:83], a[40:43], v[40:43], v[80:83]
    ds_read_b128 v[32:35], v13 offset:16384
    ds_read_b128 v[36:39], v13 offset:18432
    v_mfma_f32_16x16x32_bf16 v[84:87], a[44:47], v[40:43], v[84:87]
    v_mfma_f32_16x16x32_bf16 v[88:91], a[40:43], v[44:47], v[88:91]
    v_mfma_f32_16x16x32_bf16 v[92:95], a[44:47], v[44:47], v[92:95]
    s_waitcnt lgkmcnt(4)
    v_mfma_f32_16x16x32_bf16 v[80:83], a[48:51], v[48:51], v[80:83]
    ds_read_b128 v[40:43], v15 offset:16384
    ds_read_b128 v[44:47], v15 offset:18432
    v_mfma_f32_16x16x32_bf16 v[84:87], a[52:55], v[48:51], v[84:87]
    v_mfma_f32_16x16x32_bf16 v[88:91], a[48:51], v[52:55], v[88:91]
    v_mfma_f32_16x16x32_bf16 v[92:95], a[52:55], v[52:55], v[92:95]
    s_waitcnt lgkmcnt(4)
    v_mfma_f32_16x16x32_bf16 v[80:83], a[56:59], v[56:59], v[80:83]
    ds_read_b128 v[48:51], v13 offset:20480
    ds_read_b128 v[52:55], v13 offset:22528
    v_mfma_f32_16x16x32_bf16 v[84:87], a[60:63], v[56:59], v[84:87]
    v_mfma_f32_16x16x32_bf16 v[88:91], a[56:59], v[60:63], v[88:91]
    v_mfma_f32_16x16x32_bf16 v[92:95], a[60:63], v[60:63], v[92:95]
    s_waitcnt lgkmcnt(4)
    v_mfma_f32_16x16x32_bf16 v[80:83], a[64:67], v[32:35], v[80:83]
    ds_read_b128 v[56:59], v15 offset:20480
    ds_read_b128 v[60:63], v15 offset:22528
    v_mfma_f32_16x16x32_bf16 v[84:87], a[68:71], v[32:35], v[84:87]
    v_mfma_f32_16x16x32_bf16 v[88:91], a[64:67], v[36:39], v[88:91]
    v_mfma_f32_16x16x32_bf16 v[92:95], a[68:71], v[36:39], v[92:95]
    s_waitcnt lgkmcnt(4)
    v_mfma_f32_16x16x32_bf16 v[80:83], a[72:75], v[40:43], v[80:83]
    ds_read_b128 v[32:35], v13 offset:24576
    ds_read_b128 v[36:39], v13 offset:26624
    v_mfma_f32_16x16x32_bf16 v[84:87], a[76:79], v[40:43], v[84:87]
    v_mfma_f32_16x16x32_bf16 v[88:91], a[72:75], v[44:47], v[88:91]
    v_mfma_f32_16x16x32_bf16 v[92:95], a[76:79], v[44:47], v[92:95]
    s_waitcnt lgkmcnt(4)
    v_mfma_f32_16x16x32_bf16 v[80:83], a[80:83], v[48:51], v[80:83]
    ds_read_b128 v[40:43], v15 offset:24576
    ds_read_b128 v[44:47], v15 offset:26624
    v_mfma_f32_16x16x32_bf16 v[84:87], a[84:87], v[48:51], v[84:87]
    v_mfma_f32_16x16x32_bf16 v[88:91], a[80:83], v[52:55], v[88:91]
    v_mfma_f32_16x16x32_bf16 v[92:95], a[84:87], v[52:55], v[92:95]
    s_waitcnt lgkmcnt(4)
    v_mfma_f32_16x16x32_bf16 v[80:83], a[88:91], v[56:59], v[80:83]
    ds_read_b128 v[48:51], v13 offset:28672
    ds_read_b128 v[52:55], v13 offset:30720
    v_mfma_f32_16x16x32_bf16 v[84:87], a[92:95], v[56:59], v[84:87]
    v_mfma_f32_16x16x32_bf16 v[88:91], a[88:91], v[60:63], v[88:91]
    v_mfma_f32_16x16x32_bf16 v[92:95], a[92:95], v[60:63], v[92:95]
    s_waitcnt lgkmcnt(4)
    v_mfma_f32_16x16x32_bf16 v[80:83], a[96:99], v[32:35], v[80:83]
    ds_read_b128 v[56:59], v15 offset:28672
    ds_read_b128 v[60:63], v15 offset:30720
    v_mfma_f32_16x16x32_bf16 v[84:87], a[100:103], v[32:35], v[84:87]
    v_mfma_f32_16x16x32_bf16 v[88:91], a[96:99], v[36:39], v[88:91]
    v_mfma_f32_16x16x32_bf16 v[92:95], a[100:103], v[36:39], v[92:95]
    s_waitcnt lgkmcnt(4)
    v_mfma_f32_16x16x32_bf16 v[80:83], a[104:107], v[40:43], v[80:83]
    v_mfma_f32_16x16x32_bf16 v[84:87], a[108:111], v[40:43], v[84:87]
    v_mfma_f32_16x16x32_bf16 v[88:91], a[104:107], v[44:47], v[88:91]
    v_mfma_f32_16x16x32_bf16 v[92:95], a[108:111], v[44:47], v[92:95]
    s_waitcnt vmcnt(0) lgkmcnt(0)
    s_barrier
    v_mfma_f32_16x16x32_bf16 v[80:83], a[112:115], v[48:51], v[80:83]
    ds_read_b128 v[32:35], v13 offset:32768
    ds_read_b128 v[36:39], v13 offset:34816
    v_mfma_f32_16x16x32_bf16 v[84:87], a[116:119], v[48:51], v[84:87]
    v_mfma_f32_16x16x32_bf16 v[88:91], a[112:115], v[52:55], v[88:91]
    v_mfma_f32_16x16x32_bf16 v[92:95], a[116:119], v[52:55], v[92:95]
    v_mfma_f32_16x16x32_bf16 v[80:83], a[120:123], v[56:59], v[80:83]
    ds_read_b128 v[40:43], v15 offset:32768
    ds_read_b128 v[44:47], v15 offset:34816
    v_mfma_f32_16x16x32_bf16 v[84:87], a[124:127], v[56:59], v[84:87]
    v_mfma_f32_16x16x32_bf16 v[88:91], a[120:123], v[60:63], v[88:91]
    v_mfma_f32_16x16x32_bf16 v[92:95], a[124:127], v[60:63], v[92:95]
    s_waitcnt lgkmcnt(2)
    v_mfma_f32_16x16x32_bf16 v[80:83], a[128:131], v[32:35], v[80:83]
    ds_read_b128 v[48:51], v13 offset:36864
    ds_read_b128 v[52:55], v13 offset:38912
    v_mfma_f32_16x16x32_bf16 v[84:87], a[132:135], v[32:35], v[84:87]
    ds_read_b128 v[56:59], v15 offset:36864
    ds_read_b128 v[60:63], v15 offset:38912
    v_mfma_f32_16x16x32_bf16 v[88:91], a[128:131], v[36:39], v[88:91]
    v_mfma_f32_16x16x32_bf16 v[92:95], a[132:135], v[36:39], v[92:95]
    s_waitcnt lgkmcnt(4)
    v_mfma_f32_16x16x32_bf16 v[80:83], a[136:139], v[40:43], v[80:83]
    ds_read_b128 v[32:35], v13 offset:40960
    ds_read_b128 v[36:39], v13 offset:43008
    v_mfma_f32_16x16x32_bf16 v[84:87], a[140:143], v[40:43], v[84:87]
    v_mfma_f32_16x16x32_bf16 v[88:91], a[136:139], v[44:47], v[88:91]
    v_mfma_f32_16x16x32_bf16 v[92:95], a[140:143], v[44:47], v[92:95]
    s_waitcnt lgkmcnt(4)
    v_mfma_f32_16x16x32_bf16 v[80:83], a[144:147], v[48:51], v[80:83]
    ds_read_b128 v[40:43], v15 offset:40960
    ds_read_b128 v[44:47], v15 offset:43008
    v_mfma_f32_16x16x32_bf16 v[84:87], a[148:151], v[48:51], v[84:87]
    v_mfma_f32_16x16x32_bf16 v[88:91], a[144:147], v[52:55], v[88:91]
    v_mfma_f32_16x16x32_bf16 v[92:95], a[148:151], v[52:55], v[92:95]
    s_waitcnt lgkmcnt(4)
    v_mfma_f32_16x16x32_bf16 v[80:83], a[152:155], v[56:59], v[80:83]
    ds_read_b128 v[48:51], v13 offset:45056
    ds_read_b128 v[52:55], v13 offset:47104
    v_mfma_f32_16x16x32_bf16 v[84:87], a[156:159], v[56:59], v[84:87]
    v_mfma_f32_16x16x32_bf16 v[88:91], a[152:155], v[60:63], v[88:91]
    v_mfma_f32_16x16x32_bf16 v[92:95], a[156:159], v[60:63], v[92:95]
    s_waitcnt lgkmcnt(4)
    v_mfma_f32_16x16x32_bf16 v[80:83], a[160:163], v[32:35], v[80:83]
    ds_read_b128 v[56:59], v15 offset:45056
    ds_read_b128 v[60:63], v15 offset:47104
    v_mfma_f32_16x16x32_bf16 v[84:87], a[164:167], v[32:35], v[84:87]
    v_mfma_f32_16x16x32_bf16 v[88:91], a[160:163], v[36:39], v[88:91]
    v_mfma_f32_16x16x32_bf16 v[92:95], a[164:167], v[36:39], v[92:95]
    s_waitcnt lgkmcnt(4)
    v_mfma_f32_16x16x32_bf16 v[80:83], a[168:171], v[40:43], v[80:83]
    ds_read_b128 v[32:35], v13 offset:49152
    ds_read_b128 v[36:39], v13 offset:51200
    v_mfma_f32_16x16x32_bf16 v[84:87], a[172:175], v[40:43], v[84:87]
    v_mfma_f32_16x16x32_bf16 v[88:91], a[168:171], v[44:47], v[88:91]
    v_mfma_f32_16x16x32_bf16 v[92:95], a[172:175], v[44:47], v[92:95]
    s_waitcnt lgkmcnt(4)
    v_mfma_f32_16x16x32_bf16 v[80:83], a[176:179], v[48:51], v[80:83]
    ds_read_b128 v[40:43], v15 offset:49152
    ds_read_b128 v[44:47], v15 offset:51200
    v_mfma_f32_16x16x32_bf16 v[84:87], a[180:183], v[48:51], v[84:87]
    v_mfma_f32_16x16x32_bf16 v[88:91], a[176:179], v[52:55], v[88:91]
    v_mfma_f32_16x16x32_bf16 v[92:95], a[180:183], v[52:55], v[92:95]
    s_waitcnt lgkmcnt(4)
    v_mfma_f32_16x16x32_bf16 v[80:83], a[184:187], v[56:59], v[80:83]
    ds_read_b128 v[48:51], v13 offset:53248
    ds_read_b128 v[52:55], v13 offset:55296
    v_mfma_f32_16x16x32_bf16 v[84:87], a[188:191], v[56:59], v[84:87]
    v_mfma_f32_16x16x32_bf16 v[88:91], a[184:187], v[60:63], v[88:91]
    v_mfma_f32_16x16x32_bf16 v[92:95], a[188:191], v[60:63], v[92:95]
    s_waitcnt lgkmcnt(4)
    v_mfma_f32_16x16x32_bf16 v[80:83], a[192:195], v[32:35], v[80:83]
    ds_read_b128 v[56:59], v15 offset:53248
    ds_read_b128 v[60:63], v15 offset:55296
    v_mfma_f32_16x16x32_bf16 v[84:87], a[196:199], v[32:35], v[84:87]
    v_mfma_f32_16x16x32_bf16 v[88:91], a[192:195], v[36:39], v[88:91]
    v_mfma_f32_16x16x32_bf16 v[92:95], a[196:199], v[36:39], v[92:95]
    s_waitcnt lgkmcnt(4)
    v_mfma_f32_16x16x32_bf16 v[80:83], a[200:203], v[40:43], v[80:83]
    ds_read_b128 v[32:35], v13 offset:57344
    ds_read_b128 v[36:39], v13 offset:59392
    v_mfma_f32_16x16x32_bf16 v[84:87], a[204:207], v[40:43], v[84:87]
    v_mfma_f32_16x16x32_bf16 v[88:91], a[200:203], v[44:47], v[88:91]
    v_mfma_f32_16x16x32_bf16 v[92:95], a[204:207], v[44:47], v[92:95]
    s_waitcnt lgkmcnt(4)
    v_mfma_f32_16x16x32_bf16 v[80:83], a[208:211], v[48:51], v[80:83]
    ds_read_b128 v[40:43], v15 offset:57344
    ds_read_b128 v[44:47], v15 offset:59392
    v_mfma_f32_16x16x32_bf16 v[84:87], a[212:215], v[48:51], v[84:87]
    v_mfma_f32_16x16x32_bf16 v[88:91], a[208:211], v[52:55], v[88:91]
    v_mfma_f32_16x16x32_bf16 v[92:95], a[212:215], v[52:55], v[92:95]
    s_waitcnt lgkmcnt(4)
    v_mfma_f32_16x16x32_bf16 v[80:83], a[216:219], v[56:59], v[80:83]
    ds_read_b128 v[48:51], v13 offset:61440
    ds_read_b128 v[52:55], v13 offset:63488
    v_mfma_f32_16x16x32_bf16 v[84:87], a[220:223], v[56:59], v[84:87]
    v_mfma_f32_16x16x32_bf16 v[88:91], a[216:219], v[60:63], v[88:91]
    v_mfma_f32_16x16x32_bf16 v[92:95], a[220:223], v[60:63], v[92:95]
    s_waitcnt lgkmcnt(4)
    v_mfma_f32_16x16x32_bf16 v[80:83], a[224:227], v[32:35], v[80:83]
    ds_read_b128 v[56:59], v15 offset:61440
    ds_read_b128 v[60:63], v15 offset:63488
    v_mfma_f32_16x16x32_bf16 v[84:87], a[228:231], v[32:35], v[84:87]
    v_mfma_f32_16x16x32_bf16 v[88:91], a[224:227], v[36:39], v[88:91]
    v_mfma_f32_16x16x32_bf16 v[92:95], a[228:231], v[36:39], v[92:95]
    s_waitcnt lgkmcnt(4)
    v_mfma_f32_16x16x32_bf16 v[80:83], a[232:235], v[40:43], v[80:83]
    v_mfma_f32_16x16x32_bf16 v[84:87], a[236:239], v[40:43], v[84:87]
    v_mfma_f32_16x16x32_bf16 v[88:91], a[232:235], v[44:47], v[88:91]
    v_mfma_f32_16x16x32_bf16 v[92:95], a[236:239], v[44:47], v[92:95]
    s_waitcnt lgkmcnt(0)
    v_mfma_f32_16x16x32_bf16 v[80:83], a[240:243], v[48:51], v[80:83]
    v_mfma_f32_16x16x32_bf16 v[84:87], a[244:247], v[48:51], v[84:87]
    v_mfma_f32_16x16x32_bf16 v[88:91], a[240:243], v[52:55], v[88:91]
    v_mfma_f32_16x16x32_bf16 v[92:95], a[244:247], v[52:55], v[92:95]
    v_mfma_f32_16x16x32_bf16 v[80:83], a[248:251], v[56:59], v[80:83]
    v_mfma_f32_16x16x32_bf16 v[84:87], a[252:255], v[56:59], v[84:87]
    v_mfma_f32_16x16x32_bf16 v[88:91], a[248:251], v[60:63], v[88:91]
    v_mfma_f32_16x16x32_bf16 v[92:95], a[252:255], v[60:63], v[92:95]
    s_mov_b32 s76, s57
    s_nop 6
    v_cvt_pk_bf16_f32 v216, v80, v81
    v_cvt_pk_bf16_f32 v217, v82, v83
    v_cvt_pk_bf16_f32 v218, v84, v85
    v_cvt_pk_bf16_f32 v219, v86, v87
    v_cvt_pk_bf16_f32 v220, v88, v89
    v_cvt_pk_bf16_f32 v221, v90, v91
    v_cvt_pk_bf16_f32 v222, v92, v93
    v_cvt_pk_bf16_f32 v223, v94, v95
L_e_fin_159:
    v_lshlrev_b32 v224, 16, v216
    v_and_b32 v225, 0xffff0000, v216
    v_lshlrev_b32 v226, 16, v217
    v_and_b32 v227, 0xffff0000, v217
    v_lshlrev_b32 v228, 16, v218
    v_and_b32 v229, 0xffff0000, v218
    v_lshlrev_b32 v230, 16, v219
    v_and_b32 v231, 0xffff0000, v219
    v_lshlrev_b32 v232, 16, v220
    v_and_b32 v233, 0xffff0000, v220
    v_lshlrev_b32 v234, 16, v221
    v_and_b32 v235, 0xffff0000, v221
    v_lshlrev_b32 v236, 16, v222
    v_and_b32 v237, 0xffff0000, v222
    v_lshlrev_b32 v238, 16, v223
    v_and_b32 v239, 0xffff0000, v223
    v_pk_add_f32 v[224:225], v[224:225], v[96:97]
    v_pk_add_f32 v[226:227], v[226:227], v[98:99]
    v_pk_add_f32 v[228:229], v[228:229], v[100:101]
    v_pk_add_f32 v[230:231], v[230:231], v[102:103]
    v_pk_add_f32 v[232:233], v[232:233], v[96:97]
    v_pk_add_f32 v[234:235], v[234:235], v[98:99]
    v_pk_add_f32 v[236:237], v[236:237], v[100:101]
    v_pk_add_f32 v[238:239], v[238:239], v[102:103]
    v_cvt_pk_bf16_f32 v216, v224, v225
    v_cvt_pk_bf16_f32 v217, v226, v227
    v_cvt_pk_bf16_f32 v218, v228, v229
    v_cvt_pk_bf16_f32 v219, v230, v231
    v_cvt_pk_bf16_f32 v220, v232, v233
    v_cvt_pk_bf16_f32 v221, v234, v235
    v_cvt_pk_bf16_f32 v222, v236, v237
    v_cvt_pk_bf16_f32 v223, v238, v239
    v_lshlrev_b32 v224, 16, v216
    v_and_b32 v225, 0xffff0000, v216
    v_lshlrev_b32 v226, 16, v217
    v_and_b32 v227, 0xffff0000, v217
    v_lshlrev_b32 v228, 16, v218
    v_and_b32 v229, 0xffff0000, v218
    v_lshlrev_b32 v230, 16, v219
    v_and_b32 v231, 0xffff0000, v219
    v_lshlrev_b32 v232, 16, v220
    v_and_b32 v233, 0xffff0000, v220
    v_lshlrev_b32 v234, 16, v221
    v_and_b32 v235, 0xffff0000, v221
    v_lshlrev_b32 v236, 16, v222
    v_and_b32 v237, 0xffff0000, v222
    v_lshlrev_b32 v238, 16, v223
    v_and_b32 v239, 0xffff0000, v223
    v_pk_mul_f32 v[240:241], v[224:225], v[224:225]
    v_pk_mul_f32 v[242:243], v[226:227], v[226:227]
    v_pk_mul_f32 v[244:245], v[228:229], v[228:229]
    v_pk_mul_f32 v[246:247], v[230:231], v[230:231]
    v_pk_mul_f32 v[248:249], v[232:233], v[232:233]
    v_pk_mul_f32 v[250:251], v[234:235], v[234:235]
    v_pk_mul_f32 v[252:253], v[236:237], v[236:237]
    v_pk_mul_f32 v[254:255], v[238:239], v[238:239]
    v_pk_fma_f32 v[240:241], v[240:241], v[104:105], v[106:107]
    v_pk_fma_f32 v[242:243], v[242:243], v[104:105], v[106:107]
    v_pk_fma_f32 v[244:245], v[244:245], v[104:105], v[106:107]
    v_pk_fma_f32 v[246:247], v[246:247], v[104:105], v[106:107]
    v_pk_fma_f32 v[248:249], v[248:249], v[104:105], v[106:107]
    v_pk_fma_f32 v[250:251], v[250:251], v[104:105], v[106:107]
    v_pk_fma_f32 v[252:253], v[252:253], v[104:105], v[106:107]
    v_pk_fma_f32 v[254:255], v[254:255], v[104:105], v[106:107]
    v_pk_mul_f32 v[240:241], v[240:241], v[224:225]
    v_pk_mul_f32 v[242:243], v[242:243], v[226:227]
    v_pk_mul_f32 v[244:245], v[244:245], v[228:229]
    v_pk_mul_f32 v[246:247], v[246:247], v[230:231]
    v_pk_mul_f32 v[248:249], v[248:249], v[232:233]
    v_pk_mul_f32 v[250:251], v[250:251], v[234:235]
    v_pk_mul_f32 v[252:253], v[252:253], v[236:237]
    v_pk_mul_f32 v[254:255], v[254:255], v[238:239]
    v_exp_f32 v240, v240
    v_exp_f32 v241, v241
    v_exp_f32 v242, v242
    v_exp_f32 v243, v243
    v_exp_f32 v244, v244
    v_exp_f32 v245, v245
    v_exp_f32 v246, v246
    v_exp_f32 v247, v247
    v_exp_f32 v248, v248
    v_exp_f32 v249, v249
    v_exp_f32 v250, v250
    v_exp_f32 v251, v251
    v_exp_f32 v252, v252
    v_exp_f32 v253, v253
    v_exp_f32 v254, v254
    v_exp_f32 v255, v255
    v_add_f32 v240, 1.0, v240
    v_add_f32 v241, 1.0, v241
    v_add_f32 v242, 1.0, v242
    v_add_f32 v243, 1.0, v243
    v_add_f32 v244, 1.0, v244
    v_add_f32 v245, 1.0, v245
    v_add_f32 v246, 1.0, v246
    v_add_f32 v247, 1.0, v247
    v_add_f32 v248, 1.0, v248
    v_add_f32 v249, 1.0, v249
    v_add_f32 v250, 1.0, v250
    v_add_f32 v251, 1.0, v251
    v_add_f32 v252, 1.0, v252
    v_add_f32 v253, 1.0, v253
    v_add_f32 v254, 1.0, v254
    v_add_f32 v255, 1.0, v255
    v_rcp_f32 v240, v240
    v_rcp_f32 v241, v241
    v_rcp_f32 v242, v242
    v_rcp_f32 v243, v243
    v_rcp_f32 v244, v244
    v_rcp_f32 v245, v245
    v_rcp_f32 v246, v246
    v_rcp_f32 v247, v247
    v_rcp_f32 v248, v248
    v_rcp_f32 v249, v249
    v_rcp_f32 v250, v250
    v_rcp_f32 v251, v251
    v_rcp_f32 v252, v252
    v_rcp_f32 v253, v253
    v_rcp_f32 v254, v254
    v_rcp_f32 v255, v255
    v_pk_mul_f32 v[224:225], v[224:225], v[240:241]
    v_pk_mul_f32 v[226:227], v[226:227], v[242:243]
    v_pk_mul_f32 v[228:229], v[228:229], v[244:245]
    v_pk_mul_f32 v[230:231], v[230:231], v[246:247]
    v_pk_mul_f32 v[232:233], v[232:233], v[248:249]
    v_pk_mul_f32 v[234:235], v[234:235], v[250:251]
    v_pk_mul_f32 v[236:237], v[236:237], v[252:253]
    v_pk_mul_f32 v[238:239], v[238:239], v[254:255]
    v_cvt_pk_bf16_f32 v240, v224, v225
    v_cvt_pk_bf16_f32 v241, v226, v227
    v_cvt_pk_bf16_f32 v242, v228, v229
    v_cvt_pk_bf16_f32 v243, v230, v231
    v_cvt_pk_bf16_f32 v244, v232, v233
    v_cvt_pk_bf16_f32 v245, v234, v235
    v_cvt_pk_bf16_f32 v246, v236, v237
    v_cvt_pk_bf16_f32 v247, v238, v239
    buffer_store_dwordx4 v[240:243], v10, s[12:15], s76 offen sc1
    buffer_store_dwordx4 v[244:247], v10, s[12:15], s76 offen offset:1024 sc1
    s_waitcnt lgkmcnt(0)
    s_waitcnt vmcnt(0)
    s_barrier
    s_cmp_lg_u32 s44, 0
    s_cbranch_scc1 L_pub_160
    v_mov_b32 v30, s62
    v_mov_b32 v31, 0
    s_mov_b64 exec, 1
    buffer_store_dword v30, v31, s[12:15], s67 offen sc1
    s_mov_b64 exec, -1
L_pub_160:
    s_branch L_b_loop_146
L_role_c_123:
    s_load_dwordx2 s[6:7], s[0:1], 80
    s_load_dwordx2 s[8:9], s[0:1], 88
    s_load_dwordx2 s[10:11], s[0:1], 112
    s_waitcnt lgkmcnt(0)
    s_mov_b32 s24, s6
    s_and_b32 s25, s7, 0xffff
    s_mov_b32 s26, 0x700000
    s_mov_b32 s27, 0x00020000
    s_mov_b32 s28, s8
    s_and_b32 s29, s9, 0xffff
    s_mov_b32 s30, 0x800
    s_mov_b32 s31, 0x00020000
    s_mov_b32 s32, s10
    s_and_b32 s33, s11, 0xffff
    s_mov_b32 s34, 0x400000
    s_mov_b32 s35, 0x00020000
    s_mul_i32 s46, s38, 1835008
    s_lshl_b32 s45, s68, 8
    s_add_u32 s46, s46, s45
    s_waitcnt vmcnt(0)
    s_barrier
    v_lshrrev_b32 v20, 4, v1
    s_lshl_b32 s45, s44, 2
    v_add_u32 v21, s45, v20
    s_mov_b32 s45, 2048
    v_mul_lo_u32 v21, v21, s45
    v_lshlrev_b32 v22, 2, v20
    v_and_b32 v23, 15, v1
    v_xor_b32 v22, v22, v23
    v_lshlrev_b32 v22, 4, v22
    v_add_u32 v21, v21, v22
    v_bfe_u32 v22, v1, 2, 2
    v_lshlrev_b32 v23, 3, v20
    v_add_u32 v23, v23, v22
    v_lshlrev_b32 v23, 8, v23
    v_xor_b32 v22, s44, v22
    v_lshlrev_b32 v22, 6, v22
    v_add_u32 v23, v23, v22
    v_and_b32 v22, 3, v1
    v_lshlrev_b32 v22, 3, v22
    v_add_u32 v23, v23, v22
    v_add_u32 v24, 65536, v23
    v_add_u32 v25, 131072, v23
    s_lshl_b32 s47, s44, 10
    s_add_u32 s45, s46, 0x0
    s_add_u32 m0, s47, 0
    s_nop 0
    buffer_load_dwordx4 v21, s[24:27], s45 offen  lds
    s_add_u32 s45, s46, 0x8000
    s_add_u32 m0, s47, 4096
    s_nop 0
    buffer_load_dwordx4 v21, s[24:27], s45 offen  lds
    s_add_u32 s45, s46, 0x10000
    s_add_u32 m0, s47, 8192
    s_nop 0
    buffer_load_dwordx4 v21, s[24:27], s45 offen  lds
    s_add_u32 s45, s46, 0x18000
    s_add_u32 m0, s47, 12288
    s_nop 0
    buffer_load_dwordx4 v21, s[24:27], s45 offen  lds
    s_add_u32 s45, s46, 0x20000
    s_add_u32 m0, s47, 16384
    s_nop 0
    buffer_load_dwordx4 v21, s[24:27], s45 offen  lds
    s_add_u32 s45, s46, 0x28000
    s_add_u32 m0, s47, 20480
    s_nop 0
    buffer_load_dwordx4 v21, s[24:27], s45 offen  lds
    s_add_u32 s45, s46, 0x30000
    s_add_u32 m0, s47, 24576
    s_nop 0
    buffer_load_dwordx4 v21, s[24:27], s45 offen  lds
    s_add_u32 s45, s46, 0x38000
    s_add_u32 m0, s47, 28672
    s_nop 0
    buffer_load_dwordx4 v21, s[24:27], s45 offen  lds
    s_add_u32 s45, s46, 0x40000
    s_add_u32 m0, s47, 32768
    s_nop 0
    buffer_load_dwordx4 v21, s[24:27], s45 offen  lds
    s_add_u32 s45, s46, 0x48000
    s_add_u32 m0, s47, 36864
    s_nop 0
    buffer_load_dwordx4 v21, s[24:27], s45 offen  lds
    s_add_u32 s45, s46, 0x50000
    s_add_u32 m0, s47, 40960
    s_nop 0
    buffer_load_dwordx4 v21, s[24:27], s45 offen  lds
    s_add_u32 s45, s46, 0x58000
    s_add_u32 m0, s47, 45056
    s_nop 0
    buffer_load_dwordx4 v21, s[24:27], s45 offen  lds
    s_add_u32 s45, s46, 0x60000
    s_add_u32 m0, s47, 49152
    s_nop 0
    buffer_load_dwordx4 v21, s[24:27], s45 offen  lds
    s_add_u32 s45, s46, 0x68000
    s_add_u32 m0, s47, 53248
    s_nop 0
    buffer_load_dwordx4 v21, s[24:27], s45 offen  lds
    s_add_u32 s45, s46, 0x70000
    s_add_u32 m0, s47, 57344
    s_nop 0
    buffer_load_dwordx4 v21, s[24:27], s45 offen  lds
    s_add_u32 s45, s46, 0x78000
    s_add_u32 m0, s47, 61440
    s_nop 0
    buffer_load_dwordx4 v21, s[24:27], s45 offen  lds
    s_add_u32 s45, s46, 0x80000
    s_add_u32 m0, s47, 65536
    s_nop 0
    buffer_load_dwordx4 v21, s[24:27], s45 offen  lds
    s_add_u32 s45, s46, 0x88000
    s_add_u32 m0, s47, 69632
    s_nop 0
    buffer_load_dwordx4 v21, s[24:27], s45 offen  lds
    s_add_u32 s45, s46, 0x90000
    s_add_u32 m0, s47, 73728
    s_nop 0
    buffer_load_dwordx4 v21, s[24:27], s45 offen  lds
    s_add_u32 s45, s46, 0x98000
    s_add_u32 m0, s47, 77824
    s_nop 0
    buffer_load_dwordx4 v21, s[24:27], s45 offen  lds
    s_add_u32 s45, s46, 0xa0000
    s_add_u32 m0, s47, 81920
    s_nop 0
    buffer_load_dwordx4 v21, s[24:27], s45 offen  lds
    s_add_u32 s45, s46, 0xa8000
    s_add_u32 m0, s47, 86016
    s_nop 0
    buffer_load_dwordx4 v21, s[24:27], s45 offen  lds
    s_add_u32 s45, s46, 0xb0000
    s_add_u32 m0, s47, 90112
    s_nop 0
    buffer_load_dwordx4 v21, s[24:27], s45 offen  lds
    s_add_u32 s45, s46, 0xb8000
    s_add_u32 m0, s47, 94208
    s_nop 0
    buffer_load_dwordx4 v21, s[24:27], s45 offen  lds
    s_add_u32 s45, s46, 0xc0000
    s_add_u32 m0, s47, 98304
    s_nop 0
    buffer_load_dwordx4 v21, s[24:27], s45 offen  lds
    s_add_u32 s45, s46, 0xc8000
    s_add_u32 m0, s47, 102400
    s_nop 0
    buffer_load_dwordx4 v21, s[24:27], s45 offen  lds
    s_add_u32 s45, s46, 0xd0000
    s_add_u32 m0, s47, 106496
    s_nop 0
    buffer_load_dwordx4 v21, s[24:27], s45 offen  lds
    s_add_u32 s45, s46, 0xd8000
    s_add_u32 m0, s47, 110592
    s_nop 0
    buffer_load_dwordx4 v21, s[24:27], s45 offen  lds
    s_add_u32 s45, s46, 0xe0000
    s_add_u32 m0, s47, 114688
    s_nop 0
    buffer_load_dwordx4 v21, s[24:27], s45 offen  lds
    s_add_u32 s45, s46, 0xe8000
    s_add_u32 m0, s47, 118784
    s_nop 0
    buffer_load_dwordx4 v21, s[24:27], s45 offen  lds
    s_add_u32 s45, s46, 0xf0000
    s_add_u32 m0, s47, 122880
    s_nop 0
    buffer_load_dwordx4 v21, s[24:27], s45 offen  lds
    s_add_u32 s45, s46, 0xf8000
    s_add_u32 m0, s47, 126976
    s_nop 0
    buffer_load_dwordx4 v21, s[24:27], s45 offen  lds
    s_waitcnt vmcnt(28)
    s_barrier
    s_add_u32 s45, s46, 0x100000
    s_add_u32 m0, s47, 131072
    s_nop 0
    buffer_load_dwordx4 v21, s[24:27], s45 offen  lds
    s_add_u32 s45, s46, 0x108000
    s_add_u32 m0, s47, 135168
    s_nop 0
    buffer_load_dwordx4 v21, s[24:27], s45 offen  lds
    s_add_u32 s45, s46, 0x110000
    s_add_u32 m0, s47, 139264
    s_nop 0
    buffer_load_dwordx4 v21, s[24:27], s45 offen  lds
    s_add_u32 s45, s46, 0x118000
    s_add_u32 m0, s47, 143360
    s_nop 0
    buffer_load_dwordx4 v21, s[24:27], s45 offen  lds
    ds_read_b64_tr_b16 a[0:1], v23 offset:0
    ds_read_b64_tr_b16 a[2:3], v23 offset:1024
    ds_read_b64_tr_b16 a[4:5], v23 offset:32
    ds_read_b64_tr_b16 a[6:7], v23 offset:1056
    ds_read_b64_tr_b16 a[8:9], v23 offset:8192
    ds_read_b64_tr_b16 a[10:11], v23 offset:9216
    ds_read_b64_tr_b16 a[12:13], v23 offset:8224
    ds_read_b64_tr_b16 a[14:15], v23 offset:9248
    s_waitcnt lgkmcnt(0)
    s_waitcnt vmcnt(28)
    s_barrier
    s_add_u32 s45, s46, 0x120000
    s_add_u32 m0, s47, 0
    s_nop 0
    buffer_load_dwordx4 v21, s[24:27], s45 offen  lds
    s_add_u32 s45, s46, 0x128000
    s_add_u32 m0, s47, 4096
    s_nop 0
    buffer_load_dwordx4 v21, s[24:27], s45 offen  lds
    s_add_u32 s45, s46, 0x130000
    s_add_u32 m0, s47, 8192
    s_nop 0
    buffer_load_dwordx4 v21, s[24:27], s45 offen  lds
    s_add_u32 s45, s46, 0x138000
    s_add_u32 m0, s47, 12288
    s_nop 0
    buffer_load_dwordx4 v21, s[24:27], s45 offen  lds
    ds_read_b64_tr_b16 a[16:17], v23 offset:16384
    ds_read_b64_tr_b16 a[18:19], v23 offset:17408
    ds_read_b64_tr_b16 a[20:21], v23 offset:16416
    ds_read_b64_tr_b16 a[22:23], v23 offset:17440
    ds_read_b64_tr_b16 a[24:25], v23 offset:24576
    ds_read_b64_tr_b16 a[26:27], v23 offset:25600
    ds_read_b64_tr_b16 a[28:29], v23 offset:24608
    ds_read_b64_tr_b16 a[30:31], v23 offset:25632
    s_waitcnt lgkmcnt(0)
    s_waitcnt vmcnt(28)
    s_barrier
    s_add_u32 s45, s46, 0x140000
    s_add_u32 m0, s47, 16384
    s_nop 0
    buffer_load_dwordx4 v21, s[24:27], s45 offen  lds
    s_add_u32 s45, s46, 0x148000
    s_add_u32 m0, s47, 20480
    s_nop 0
    buffer_load_dwordx4 v21, s[24:27], s45 offen  lds
    s_add_u32 s45, s46, 0x150000
    s_add_u32 m0, s47, 24576
    s_nop 0
    buffer_load_dwordx4 v21, s[24:27], s45 offen  lds
    s_add_u32 s45, s46, 0x158000
    s_add_u32 m0, s47, 28672
    s_nop 0
    buffer_load_dwordx4 v21, s[24:27], s45 offen  lds
    ds_read_b64_tr_b16 a[32:33], v23 offset:32768
    ds_read_b64_tr_b16 a[34:35], v23 offset:33792
    ds_read_b64_tr_b16 a[36:37], v23 offset:32800
    ds_read_b64_tr_b16 a[38:39], v23 offset:33824
    ds_read_b64_tr_b16 a[40:41], v23 offset:40960
    ds_read_b64_tr_b16 a[42:43], v23 offset:41984
    ds_read_b64_tr_b16 a[44:45], v23 offset:40992
    ds_read_b64_tr_b16 a[46:47], v23 offset:42016
    s_waitcnt lgkmcnt(0)
    s_waitcnt vmcnt(28)
    s_barrier
    s_add_u32 s45, s46, 0x160000
    s_add_u32 m0, s47, 32768
    s_nop 0
    buffer_load_dwordx4 v21, s[24:27], s45 offen  lds
    s_add_u32 s45, s46, 0x168000
    s_add_u32 m0, s47, 36864
    s_nop 0
    buffer_load_dwordx4 v21, s[24:27], s45 offen  lds
    s_add_u32 s45, s46, 0x170000
    s_add_u32 m0, s47, 40960
    s_nop 0
    buffer_load_dwordx4 v21, s[24:27], s45 offen  lds
    s_add_u32 s45, s46, 0x178000
    s_add_u32 m0, s47, 45056
    s_nop 0
    buffer_load_dwordx4 v21, s[24:27], s45 offen  lds
    ds_read_b64_tr_b16 a[48:49], v23 offset:49152
    ds_read_b64_tr_b16 a[50:51], v23 offset:50176
    ds_read_b64_tr_b16 a[52:53], v23 offset:49184
    ds_read_b64_tr_b16 a[54:55], v23 offset:50208
    ds_read_b64_tr_b16 a[56:57], v23 offset:57344
    ds_read_b64_tr_b16 a[58:59], v23 offset:58368
    ds_read_b64_tr_b16 a[60:61], v23 offset:57376
    ds_read_b64_tr_b16 a[62:63], v23 offset:58400
    s_waitcnt lgkmcnt(0)
    s_waitcnt vmcnt(28)
    s_barrier
    s_add_u32 s45, s46, 0x180000
    s_add_u32 m0, s47, 49152
    s_nop 0
    buffer_load_dwordx4 v21, s[24:27], s45 offen  lds
    s_add_u32 s45, s46, 0x188000
    s_add_u32 m0, s47, 53248
    s_nop 0
    buffer_load_dwordx4 v21, s[24:27], s45 offen  lds
    s_add_u32 s45, s46, 0x190000
    s_add_u32 m0, s47, 57344
    s_nop 0
    buffer_load_dwordx4 v21, s[24:27], s45 offen  lds
    s_add_u32 s45, s46, 0x198000
    s_add_u32 m0, s47, 61440
    s_nop 0
    buffer_load_dwordx4 v21, s[24:27], s45 offen  lds
    ds_read_b64_tr_b16 a[64:65], v24 offset:0
    ds_read_b64_tr_b16 a[66:67], v24 offset:1024
    ds_read_b64_tr_b16 a[68:69], v24 offset:32
    ds_read_b64_tr_b16 a[70:71], v24 offset:1056
    ds_read_b64_tr_b16 a[72:73], v24 offset:8192
    ds_read_b64_tr_b16 a[74:75], v24 offset:9216
    ds_read_b64_tr_b16 a[76:77], v24 offset:8224
    ds_read_b64_tr_b16 a[78:79], v24 offset:9248
    s_waitcnt lgkmcnt(0)
    s_waitcnt vmcnt(28)
    s_barrier
    s_add_u32 s45, s46, 0x1a0000
    s_add_u32 m0, s47, 65536
    s_nop 0
    buffer_load_dwordx4 v21, s[24:27], s45 offen  lds
    s_add_u32 s45, s46, 0x1a8000
    s_add_u32 m0, s47, 69632
    s_nop 0
    buffer_load_dwordx4 v21, s[24:27], s45 offen  lds
    s_add_u32 s45, s46, 0x1b0000
    s_add_u32 m0, s47, 73728
    s_nop 0
    buffer_load_dwordx4 v21, s[24:27], s45 offen  lds
    s_add_u32 s45, s46, 0x1b8000
    s_add_u32 m0, s47, 77824
    s_nop 0
    buffer_load_dwordx4 v21, s[24:27], s45 offen  lds
    ds_read_b64_tr_b16 a[80:81], v24 offset:16384
    ds_read_b64_tr_b16 a[82:83], v24 offset:17408
    ds_read_b64_tr_b16 a[84:85], v24 offset:16416
    ds_read_b64_tr_b16 a[86:87], v24 offset:17440
    ds_read_b64_tr_b16 a[88:89], v24 offset:24576
    ds_read_b64_tr_b16 a[90:91], v24 offset:25600
    ds_read_b64_tr_b16 a[92:93], v24 offset:24608
    ds_read_b64_tr_b16 a[94:95], v24 offset:25632
    s_waitcnt lgkmcnt(0)
    s_waitcnt vmcnt(28)
    s_barrier
    ds_read_b64_tr_b16 a[96:97], v24 offset:32768
    ds_read_b64_tr_b16 a[98:99], v24 offset:33792
    ds_read_b64_tr_b16 a[100:101], v24 offset:32800
    ds_read_b64_tr_b16 a[102:103], v24 offset:33824
    ds_read_b64_tr_b16 a[104:105], v24 offset:40960
    ds_read_b64_tr_b16 a[106:107], v24 offset:41984
    ds_read_b64_tr_b16 a[108:109], v24 offset:40992
    ds_read_b64_tr_b16 a[110:111], v24 offset:42016
    s_waitcnt lgkmcnt(0)
    s_waitcnt vmcnt(24)
    s_barrier
    ds_read_b64_tr_b16 a[112:113], v24 offset:49152
    ds_read_b64_tr_b16 a[114:115], v24 offset:50176
    ds_read_b64_tr_b16 a[116:117], v24 offset:49184
    ds_read_b64_tr_b16 a[118:119], v24 offset:50208
    ds_read_b64_tr_b16 a[120:121], v24 offset:57344
    ds_read_b64_tr_b16 a[122:123], v24 offset:58368
    ds_read_b64_tr_b16 a[124:125], v24 offset:57376
    ds_read_b64_tr_b16 a[126:127], v24 offset:58400
    s_waitcnt lgkmcnt(0)
    s_waitcnt vmcnt(20)
    s_barrier
    ds_read_b64_tr_b16 a[128:129], v25 offset:0
    ds_read_b64_tr_b16 a[130:131], v25 offset:1024
    ds_read_b64_tr_b16 a[132:133], v25 offset:32
    ds_read_b64_tr_b16 a[134:135], v25 offset:1056
    ds_read_b64_tr_b16 a[136:137], v25 offset:8192
    ds_read_b64_tr_b16 a[138:139], v25 offset:9216
    ds_read_b64_tr_b16 a[140:141], v25 offset:8224
    ds_read_b64_tr_b16 a[142:143], v25 offset:9248
    s_waitcnt lgkmcnt(0)
    s_waitcnt vmcnt(16)
    s_barrier
    ds_read_b64_tr_b16 a[144:145], v23 offset:0
    ds_read_b64_tr_b16 a[146:147], v23 offset:1024
    ds_read_b64_tr_b16 a[148:149], v23 offset:32
    ds_read_b64_tr_b16 a[150:151], v23 offset:1056
    ds_read_b64_tr_b16 a[152:153], v23 offset:8192
    ds_read_b64_tr_b16 a[154:155], v23 offset:9216
    ds_read_b64_tr_b16 a[156:157], v23 offset:8224
    ds_read_b64_tr_b16 a[158:159], v23 offset:9248
    s_waitcnt lgkmcnt(0)
    s_waitcnt vmcnt(12)
    s_barrier
    ds_read_b64_tr_b16 a[160:161], v23 offset:16384
    ds_read_b64_tr_b16 a[162:163], v23 offset:17408
    ds_read_b64_tr_b16 a[164:165], v23 offset:16416
    ds_read_b64_tr_b16 a[166:167], v23 offset:17440
    ds_read_b64_tr_b16 a[168:169], v23 offset:24576
    ds_read_b64_tr_b16 a[170:171], v23 offset:25600
    ds_read_b64_tr_b16 a[172:173], v23 offset:24608
    ds_read_b64_tr_b16 a[174:175], v23 offset:25632
    s_waitcnt lgkmcnt(0)
    s_waitcnt vmcnt(8)
    s_barrier
    ds_read_b64_tr_b16 a[176:177], v23 offset:32768
    ds_read_b64_tr_b16 a[178:179], v23 offset:33792
    ds_read_b64_tr_b16 a[180:181], v23 offset:32800
    ds_read_b64_tr_b16 a[182:183], v23 offset:33824
    ds_read_b64_tr_b16 a[184:185], v23 offset:40960
    ds_read_b64_tr_b16 a[186:187], v23 offset:41984
    ds_read_b64_tr_b16 a[188:189], v23 offset:40992
    ds_read_b64_tr_b16 a[190:191], v23 offset:42016
    s_waitcnt lgkmcnt(0)
    s_waitcnt vmcnt(4)
    s_barrier
    ds_read_b64_tr_b16 a[192:193], v23 offset:49152
    ds_read_b64_tr_b16 a[194:195], v23 offset:50176
    ds_read_b64_tr_b16 a[196:197], v23 offset:49184
    ds_read_b64_tr_b16 a[198:199], v23 offset:50208
    ds_read_b64_tr_b16 a[200:201], v23 offset:57344
    ds_read_b64_tr_b16 a[202:203], v23 offset:58368
    ds_read_b64_tr_b16 a[204:205], v23 offset:57376
    ds_read_b64_tr_b16 a[206:207], v23 offset:58400
    s_waitcnt lgkmcnt(0)
    s_waitcnt vmcnt(0)
    s_barrier
    ds_read_b64_tr_b16 a[208:209], v24 offset:0
    ds_read_b64_tr_b16 a[210:211], v24 offset:1024
    ds_read_b64_tr_b16 a[212:213], v24 offset:32
    ds_read_b64_tr_b16 a[214:215], v24 offset:1056
    ds_read_b64_tr_b16 a[216:217], v24 offset:8192
    ds_read_b64_tr_b16 a[218:219], v24 offset:9216
    ds_read_b64_tr_b16 a[220:221], v24 offset:8224
    ds_read_b64_tr_b16 a[222:223], v24 offset:9248
    s_waitcnt lgkmcnt(0)
    s_barrier
    buffer_load_dwordx4 v[80:83], v10, s[28:31], 0 offen
    buffer_load_dwordx4 v[84:87], v10, s[28:31], 0 offen offset:1024
    s_waitcnt vmcnt(0)
    v_lshlrev_b32 v96, 16, v80
    v_and_b32 v97, 0xffff0000, v80
    v_lshlrev_b32 v98, 16, v81
    v_and_b32 v99, 0xffff0000, v81
    v_lshlrev_b32 v100, 16, v82
    v_and_b32 v101, 0xffff0000, v82
    v_lshlrev_b32 v102, 16, v83
    v_and_b32 v103, 0xffff0000, v83
    v_lshlrev_b32 v104, 16, v84
    v_and_b32 v105, 0xffff0000, v84
    v_lshlrev_b32 v106, 16, v85
    v_and_b32 v107, 0xffff0000, v85
    v_lshlrev_b32 v108, 16, v86
    v_and_b32 v109, 0xffff0000, v86
    v_lshlrev_b32 v110, 16, v87
    v_and_b32 v111, 0xffff0000, v87
    s_cmp_lg_u32 s44, 0
    s_cbranch_scc1 L_pd_161
    v_mov_b32 v29, 132
    s_mov_b32 s46, 96
    s_mov_b64 exec, 1
    s_mov_b32 s70, 0
L_wp_162:
    buffer_load_dword v31, v29, s[16:19], 0 offen sc1
    s_add_u32 s70, s70, 1
    s_cmp_ge_u32 s70, 0x200000
    s_cbranch_scc1 L_w_done_101
    s_waitcnt vmcnt(0)
    v_cmp_gt_u32 vcc, s46, v31
    s_nop 1
    s_cbranch_vccz L_wp_162_ok
    s_sleep 3
    s_branch L_wp_162
L_wp_162_ok:
    s_mov_b64 exec, -1
L_pd_161:
    s_barrier
    v_lshlrev_b32 v29, 5, v1
    s_mov_b32 s45, 20480
    buffer_load_dwordx4 v[112:115], v29, s[12:15], s45 offen offset:0 sc1
    buffer_load_dwordx4 v[116:119], v29, s[12:15], s45 offen offset:16 sc1
    buffer_load_dwordx4 v[120:123], v29, s[12:15], s45 offen offset:2048 sc1
    buffer_load_dwordx4 v[124:127], v29, s[12:15], s45 offen offset:2064 sc1
    s_mov_b32 s45, 45056
    buffer_load_dwordx4 v[32:35], v29, s[12:15], s45 offen offset:0 sc1
    buffer_load_dwordx4 v[36:39], v29, s[12:15], s45 offen offset:16 sc1
    buffer_load_dwordx4 v[40:43], v29, s[12:15], s45 offen offset:2048 sc1
    buffer_load_dwordx4 v[44:47], v29, s[12:15], s45 offen offset:2064 sc1
    s_waitcnt vmcnt(0)
    v_add_f32 v112, v112, v32
    v_cvt_pk_bf16_f32 v112, v112, v112
    v_lshlrev_b32 v112, 16, v112
    v_add_f32 v113, v113, v33
    v_cvt_pk_bf16_f32 v113, v113, v113
    v_lshlrev_b32 v113, 16, v113
    v_add_f32 v114, v114, v34
    v_cvt_pk_bf16_f32 v114, v114, v114
    v_lshlrev_b32 v114, 16, v114
    v_add_f32 v115, v115, v35
    v_cvt_pk_bf16_f32 v115, v115, v115
    v_lshlrev_b32 v115, 16, v115
    v_add_f32 v116, v116, v36
    v_cvt_pk_bf16_f32 v116, v116, v116
    v_lshlrev_b32 v116, 16, v116
    v_add_f32 v117, v117, v37
    v_cvt_pk_bf16_f32 v117, v117, v117
    v_lshlrev_b32 v117, 16, v117
    v_add_f32 v118, v118, v38
    v_cvt_pk_bf16_f32 v118, v118, v118
    v_lshlrev_b32 v118, 16, v118
    v_add_f32 v119, v119, v39
    v_cvt_pk_bf16_f32 v119, v119, v119
    v_lshlrev_b32 v119, 16, v119
    v_add_f32 v120, v120, v40
    v_cvt_pk_bf16_f32 v120, v120, v120
    v_lshlrev_b32 v120, 16, v120
    v_add_f32 v121, v121, v41
    v_cvt_pk_bf16_f32 v121, v121, v121
    v_lshlrev_b32 v121, 16, v121
    v_add_f32 v122, v122, v42
    v_cvt_pk_bf16_f32 v122, v122, v122
    v_lshlrev_b32 v122, 16, v122
    v_add_f32 v123, v123, v43
    v_cvt_pk_bf16_f32 v123, v123, v123
    v_lshlrev_b32 v123, 16, v123
    v_add_f32 v124, v124, v44
    v_cvt_pk_bf16_f32 v124, v124, v124
    v_lshlrev_b32 v124, 16, v124
    v_add_f32 v125, v125, v45
    v_cvt_pk_bf16_f32 v125, v125, v125
    v_lshlrev_b32 v125, 16, v125
    v_add_f32 v126, v126, v46
    v_cvt_pk_bf16_f32 v126, v126, v126
    v_lshlrev_b32 v126, 16, v126
    v_add_f32 v127, v127, v47
    v_cvt_pk_bf16_f32 v127, v127, v127
    v_lshlrev_b32 v127, 16, v127
    s_lshl_b32 s46, s44, 10
    s_add_u32 s45, s46, 20480
    buffer_load_dwordx4 v[22:25], v10, s[12:15], s45 offen sc1
    s_add_u32 s45, s46, 45056
    buffer_load_dwordx4 v[32:35], v10, s[12:15], s45 offen sc1
    s_waitcnt vmcnt(0)
    v_add_f32 v22, v22, v32
    v_cvt_pk_bf16_f32 v22, v22, v22
    v_lshlrev_b32 v22, 16, v22
    v_add_f32 v23, v23, v33
    v_cvt_pk_bf16_f32 v23, v23, v23
    v_lshlrev_b32 v23, 16, v23
    v_add_f32 v24, v24, v34
    v_cvt_pk_bf16_f32 v24, v24, v24
    v_lshlrev_b32 v24, 16, v24
    v_add_f32 v25, v25, v35
    v_cvt_pk_bf16_f32 v25, v25, v25
    v_lshlrev_b32 v25, 16, v25
    v_lshlrev_b32 v17, 3, v1
    s_lshl_b32 s45, s44, 9
    buffer_load_dwordx2 v[80:81], v17, s[28:31], s45 offen
    s_waitcnt vmcnt(0)
    v_lshlrev_b32 v18, 16, v80
    v_and_b32 v19, 0xffff0000, v80
    v_lshlrev_b32 v20, 16, v81
    v_and_b32 v21, 0xffff0000, v81
    s_mul_i32 s52, s38, 57344
    s_add_u32 s52, s52, 0x6000000
    s_lshl_b32 s56, s38, 23
    s_lshl_b32 s45, s68, 9
    s_add_u32 s56, s56, s45
    s_add_u32 s56, s56, 0xc000000
    s_lshl_b32 s45, s40, 2
    s_add_u32 s45, s45, 200
    v_mov_b32 v29, s45
    s_mov_b32 s46, 536870912
    s_mov_b64 exec, 1
    s_mov_b32 s70, 0
L_wp_165:
    buffer_load_dword v31, v29, s[16:19], 0 offen sc1
    s_add_u32 s70, s70, 1
    s_cmp_ge_u32 s70, 0x200000
    s_cbranch_scc1 L_w_done_101
    s_waitcnt vmcnt(0)
    v_cmp_gt_u32 vcc, s46, v31
    s_nop 1
    s_cbranch_vccz L_wp_165_ok
    s_sleep 2
    s_branch L_wp_165
L_wp_165_ok:
    s_mov_b64 exec, -1
    v_readfirstlane_b32 s45, v31
    s_nop 3
    s_and_b32 s46, s45, 511
    s_mul_i32 s46, s46, s46
    s_bfe_u32 s45, s45, 0xf0009
    s_lshl_b32 s45, s45, 5
    s_mov_b32 s80, s12
    s_mov_b32 s81, s13
    s_mov_b32 s83, 0x00020000
    s_mov_b32 s84, s12
    s_mov_b32 s85, s13
    s_mov_b32 s87, 0x00020000
    s_cmp_eq_u32 s45, s46
    s_cselect_b32 s82, s14, 0
    s_cselect_b32 s86, 0, s14
L_c_loop_163:
    s_cmp_eq_u64 s[36:37], 0
    s_cbranch_scc1 L_w_done_101
    s_ff1_i32_b64 s50, s[36:37]
    s_bitset0_b64 s[36:37], s50
    s_lshr_b64 s[74:75], s[72:73], s50
    s_ff1_i32_b64 s51, s[74:75]
    s_add_u32 s51, s51, 1
    s_add_u32 s62, s50, s51
    s_mul_i32 s45, s38, 896
    s_add_u32 s45, s45, s64
    s_add_u32 s45, s45, 12288
    s_cmp_lg_u32 s44, 0
    s_cbranch_scc1 L_pw_166
    s_mov_b64 exec, 127
    s_mov_b32 s70, 0
L_wp_167:
    buffer_load_dword v31, v5, s[12:15], s45 offen sc1
    s_add_u32 s70, s70, 1
    s_cmp_ge_u32 s70, 0x200000
    s_cbranch_scc1 L_w_done_101
    s_waitcnt vmcnt(0)
    v_cmp_gt_u32 vcc, s62, v31
    s_nop 1
    s_cbranch_vccz L_wp_167_ok
    s_sleep 2
    s_branch L_wp_167
L_wp_167_ok:
    s_mov_b64 exec, -1
L_pw_166:
    s_barrier
    s_mul_i32 s53, s50, 229376
    s_add_u32 s53, s53, s52
    s_lshl_b32 s54, s44, 13
    s_add_u32 s53, s53, s54
    s_mul_i32 s57, s50, 131072
    s_add_u32 s57, s57, s56
    s_lshl_b32 s45, s44, 7
    s_add_u32 s57, s57, s45
    s_add_u32 s55, s54, 65536
    s_mov_b32 s58, 0
    v_mov_b32 v13, v10
    v_add_u32 v14, 65536, v13
    v_xor_b32 v15, 64, v13
    v_xor_b32 v16, 64, v14
    s_mov_b32 s76, 0x20000000
    s_add_u32 s48, s53, 0
    s_add_u32 s49, s48, 4096
    s_add_u32 m0, s54, 0
    s_nop 0
    buffer_load_dwordx4 v10, s[12:15], s48 offen offset:0 sc1 lds
    buffer_load_dwordx4 v10, s[12:15], s48 offen offset:1024 sc1 lds
    buffer_load_dwordx4 v10, s[12:15], s48 offen offset:2048 sc1 lds
    buffer_load_dwordx4 v10, s[12:15], s48 offen offset:3072 sc1 lds
    s_add_u32 m0, s54, 4096
    s_nop 0
    buffer_load_dwordx4 v10, s[12:15], s49 offen offset:0 sc1 lds
    buffer_load_dwordx4 v10, s[12:15], s49 offen offset:1024 sc1 lds
    buffer_load_dwordx4 v10, s[12:15], s49 offen offset:2048 sc1 lds
    buffer_load_dwordx4 v10, s[12:15], s49 offen offset:3072 sc1 lds
    s_add_u32 s48, s53, 32768
    s_cmp_lt_u32 s44, 3
    s_cselect_b32 s48, s48, 0x20000000
    s_add_u32 s49, s48, 4096
    s_add_u32 s46, s54, 32768
    s_add_u32 m0, s46, 0
    s_nop 0
    buffer_load_dwordx4 v10, s[12:15], s48 offen offset:0 sc1 lds
    buffer_load_dwordx4 v10, s[12:15], s48 offen offset:1024 sc1 lds
    buffer_load_dwordx4 v10, s[12:15], s48 offen offset:2048 sc1 lds
    buffer_load_dwordx4 v10, s[12:15], s48 offen offset:3072 sc1 lds
    s_add_u32 m0, s46, 4096
    s_nop 0
    buffer_load_dwordx4 v10, s[12:15], s49 offen offset:0 sc1 lds
    buffer_load_dwordx4 v10, s[12:15], s49 offen offset:1024 sc1 lds
    buffer_load_dwordx4 v10, s[12:15], s49 offen offset:2048 sc1 lds
    buffer_load_dwordx4 v10, s[12:15], s49 offen offset:3072 sc1 lds
    s_cmp_eq_u32 s51, 1
    s_cbranch_scc1 L_e_one_169
    s_add_u32 s48, s53, 229376
    s_add_u32 s49, s48, 4096
    s_add_u32 m0, s55, 0
    s_nop 0
    buffer_load_dwordx4 v10, s[12:15], s48 offen offset:0 sc1 lds
    buffer_load_dwordx4 v10, s[12:15], s48 offen offset:1024 sc1 lds
    buffer_load_dwordx4 v10, s[12:15], s48 offen offset:2048 sc1 lds
    buffer_load_dwordx4 v10, s[12:15], s48 offen offset:3072 sc1 lds
    s_add_u32 m0, s55, 4096
    s_nop 0
    buffer_load_dwordx4 v10, s[12:15], s49 offen offset:0 sc1 lds
    buffer_load_dwordx4 v10, s[12:15], s49 offen offset:1024 sc1 lds
    buffer_load_dwordx4 v10, s[12:15], s49 offen offset:2048 sc1 lds
    buffer_load_dwordx4 v10, s[12:15], s49 offen offset:3072 sc1 lds
    s_waitcnt vmcnt(16)
    s_barrier
    ds_read_b128 v[32:35], v13 offset:0
    ds_read_b128 v[36:39], v13 offset:1024
    ds_read_b128 v[40:43], v13 offset:2048
    ds_read_b128 v[44:47], v13 offset:3072
L_e_loop_168:
    s_add_u32 s48, s53, 262144
    s_add_u32 s46, s58, 1
    s_cmp_lt_u32 s46, s51
    s_cselect_b32 s48, s48, 0x20000000
    s_cmp_lt_u32 s44, 3
    s_cselect_b32 s48, s48, 0x20000000
    s_add_u32 s49, s48, 4096
    s_add_u32 s59, s55, 32768
    s_waitcnt lgkmcnt(2)
    v_mfma_f32_16x16x32_bf16 v[80:83], a[0:3], v[32:35], 0
    ds_read_b128 v[48:51], v13 offset:4096
    ds_read_b128 v[52:55], v13 offset:5120
    v_mfma_f32_16x16x32_bf16 v[84:87], a[4:7], v[32:35], 0
    ds_read_b128 v[56:59], v13 offset:6144
    ds_read_b128 v[60:63], v13 offset:7168
    v_mfma_f32_16x16x32_bf16 v[88:91], a[0:3], v[36:39], 0
    s_add_u32 m0, s59, 0
    s_nop 0
    buffer_load_dwordx4 v10, s[12:15], s48 offen offset:0 sc1 lds
    v_mfma_f32_16x16x32_bf16 v[92:95], a[4:7], v[36:39], 0
    s_waitcnt lgkmcnt(4)
    v_mfma_f32_16x16x32_bf16 v[80:83], a[8:11], v[40:43], v[80:83]
    ds_read_b128 v[32:35], v13 offset:8192
    ds_read_b128 v[36:39], v13 offset:9216
    v_mfma_f32_16x16x32_bf16 v[84:87], a[12:15], v[40:43], v[84:87]
    v_mfma_f32_16x16x32_bf16 v[88:91], a[8:11], v[44:47], v[88:91]
    buffer_load_dwordx4 v10, s[12:15], s48 offen offset:1024 sc1 lds
    v_mfma_f32_16x16x32_bf16 v[92:95], a[12:15], v[44:47], v[92:95]
    s_waitcnt lgkmcnt(4)
    v_mfma_f32_16x16x32_bf16 v[80:83], a[16:19], v[48:51], v[80:83]
    ds_read_b128 v[40:43], v13 offset:10240
    ds_read_b128 v[44:47], v13 offset:11264
    v_mfma_f32_16x16x32_bf16 v[84:87], a[20:23], v[48:51], v[84:87]
    v_mfma_f32_16x16x32_bf16 v[88:91], a[16:19], v[52:55], v[88:91]
    buffer_load_dwordx4 v10, s[12:15], s48 offen offset:2048 sc1 lds
    v_mfma_f32_16x16x32_bf16 v[92:95], a[20:23], v[52:55], v[92:95]
    s_waitcnt lgkmcnt(4)
    v_mfma_f32_16x16x32_bf16 v[80:83], a[24:27], v[56:59], v[80:83]
    ds_read_b128 v[48:51], v13 offset:12288
    ds_read_b128 v[52:55], v13 offset:13312
    v_mfma_f32_16x16x32_bf16 v[84:87], a[28:31], v[56:59], v[84:87]
    v_mfma_f32_16x16x32_bf16 v[88:91], a[24:27], v[60:63], v[88:91]
    buffer_load_dwordx4 v10, s[12:15], s48 offen offset:3072 sc1 lds
    v_mfma_f32_16x16x32_bf16 v[92:95], a[28:31], v[60:63], v[92:95]
    s_waitcnt lgkmcnt(4)
    v_mfma_f32_16x16x32_bf16 v[80:83], a[32:35], v[32:35], v[80:83]
    ds_read_b128 v[56:59], v13 offset:14336
    ds_read_b128 v[60:63], v13 offset:15360
    v_mfma_f32_16x16x32_bf16 v[84:87], a[36:39], v[32:35], v[84:87]
    v_mfma_f32_16x16x32_bf16 v[88:91], a[32:35], v[36:39], v[88:91]
    s_add_u32 m0, s59, 4096
    s_nop 0
    buffer_load_dwordx4 v10, s[12:15], s49 offen offset:0 sc1 lds
    v_mfma_f32_16x16x32_bf16 v[92:95], a[36:39], v[36:39], v[92:95]
    s_waitcnt lgkmcnt(4)
    v_mfma_f32_16x16x32_bf16 v[80:83], a[40:43], v[40:43], v[80:83]
    ds_read_b128 v[32:35], v13 offset:16384
    ds_read_b128 v[36:39], v13 offset:17408
    v_mfma_f32_16x16x32_bf16 v[84:87], a[44:47], v[40:43], v[84:87]
    v_mfma_f32_16x16x32_bf16 v[88:91], a[40:43], v[44:47], v[88:91]
    buffer_load_dwordx4 v10, s[12:15], s49 offen offset:1024 sc1 lds
    v_mfma_f32_16x16x32_bf16 v[92:95], a[44:47], v[44:47], v[92:95]
    s_waitcnt lgkmcnt(4)
    v_mfma_f32_16x16x32_bf16 v[80:83], a[48:51], v[48:51], v[80:83]
    ds_read_b128 v[40:43], v13 offset:18432
    ds_read_b128 v[44:47], v13 offset:19456
    v_mfma_f32_16x16x32_bf16 v[84:87], a[52:55], v[48:51], v[84:87]
    v_mfma_f32_16x16x32_bf16 v[88:91], a[48:51], v[52:55], v[88:91]
    buffer_load_dwordx4 v10, s[12:15], s49 offen offset:2048 sc1 lds
    v_mfma_f32_16x16x32_bf16 v[92:95], a[52:55], v[52:55], v[92:95]
    s_waitcnt lgkmcnt(4)
    v_mfma_f32_16x16x32_bf16 v[80:83], a[56:59], v[56:59], v[80:83]
    ds_read_b128 v[48:51], v13 offset:20480
    ds_read_b128 v[52:55], v13 offset:21504
    v_mfma_f32_16x16x32_bf16 v[84:87], a[60:63], v[56:59], v[84:87]
    v_mfma_f32_16x16x32_bf16 v[88:91], a[56:59], v[60:63], v[88:91]
    buffer_load_dwordx4 v10, s[12:15], s49 offen offset:3072 sc1 lds
    v_mfma_f32_16x16x32_bf16 v[92:95], a[60:63], v[60:63], v[92:95]
    s_waitcnt lgkmcnt(4)
    v_mfma_f32_16x16x32_bf16 v[80:83], a[64:67], v[32:35], v[80:83]
    ds_read_b128 v[56:59], v13 offset:22528
    ds_read_b128 v[60:63], v13 offset:23552
    v_mfma_f32_16x16x32_bf16 v[84:87], a[68:71], v[32:35], v[84:87]
    v_mfma_f32_16x16x32_bf16 v[88:91], a[64:67], v[36:39], v[88:91]
    v_mfma_f32_16x16x32_bf16 v[92:95], a[68:71], v[36:39], v[92:95]
    s_waitcnt lgkmcnt(4)
    v_mfma_f32_16x16x32_bf16 v[80:83], a[72:75], v[40:43], v[80:83]
    ds_read_b128 v[32:35], v13 offset:24576
    ds_read_b128 v[36:39], v13 offset:25600
    v_mfma_f32_16x16x32_bf16 v[84:87], a[76:79], v[40:43], v[84:87]
    v_mfma_f32_16x16x32_bf16 v[88:91], a[72:75], v[44:47], v[88:91]
    v_mfma_f32_16x16x32_bf16 v[92:95], a[76:79], v[44:47], v[92:95]
    s_waitcnt lgkmcnt(4)
    v_mfma_f32_16x16x32_bf16 v[80:83], a[80:83], v[48:51], v[80:83]
    ds_read_b128 v[40:43], v13 offset:26624
    ds_read_b128 v[44:47], v13 offset:27648
    v_mfma_f32_16x16x32_bf16 v[84:87], a[84:87], v[48:51], v[84:87]
    v_mfma_f32_16x16x32_bf16 v[88:91], a[80:83], v[52:55], v[88:91]
    v_mfma_f32_16x16x32_bf16 v[92:95], a[84:87], v[52:55], v[92:95]
    s_waitcnt lgkmcnt(4)
    v_mfma_f32_16x16x32_bf16 v[80:83], a[88:91], v[56:59], v[80:83]
    ds_read_b128 v[48:51], v13 offset:28672
    ds_read_b128 v[52:55], v13 offset:29696
    v_mfma_f32_16x16x32_bf16 v[84:87], a[92:95], v[56:59], v[84:87]
    v_mfma_f32_16x16x32_bf16 v[88:91], a[88:91], v[60:63], v[88:91]
    v_mfma_f32_16x16x32_bf16 v[92:95], a[92:95], v[60:63], v[92:95]
    s_waitcnt lgkmcnt(4)
    v_mfma_f32_16x16x32_bf16 v[80:83], a[96:99], v[32:35], v[80:83]
    ds_read_b128 v[56:59], v13 offset:30720
    ds_read_b128 v[60:63], v13 offset:31744
    v_mfma_f32_16x16x32_bf16 v[84:87], a[100:103], v[32:35], v[84:87]
    v_mfma_f32_16x16x32_bf16 v[88:91], a[96:99], v[36:39], v[88:91]
    v_mfma_f32_16x16x32_bf16 v[92:95], a[100:103], v[36:39], v[92:95]
    s_waitcnt lgkmcnt(4)
    v_mfma_f32_16x16x32_bf16 v[80:83], a[104:107], v[40:43], v[80:83]
    ds_read_b128 v[216:219], v8 offset:0
    ds_read_b128 v[220:223], v8 offset:1152
    v_mfma_f32_16x16x32_bf16 v[84:87], a[108:111], v[40:43], v[84:87]
    ds_read_b128 v[224:227], v8 offset:2304
    ds_read_b128 v[228:231], v8 offset:3456
    v_mfma_f32_16x16x32_bf16 v[88:91], a[104:107], v[44:47], v[88:91]
    v_mfma_f32_16x16x32_bf16 v[92:95], a[108:111], v[44:47], v[92:95]
    s_waitcnt vmcnt(16) lgkmcnt(0)
    s_barrier
    v_mfma_f32_16x16x32_bf16 v[80:83], a[112:115], v[48:51], v[80:83]
    ds_read_b128 v[32:35], v13 offset:32768
    ds_read_b128 v[36:39], v13 offset:33792
    v_mfma_f32_16x16x32_bf16 v[84:87], a[116:119], v[48:51], v[84:87]
    buffer_store_dwordx4 v[216:219], v11, s[12:15], s76 offen sc1
    v_mfma_f32_16x16x32_bf16 v[88:91], a[112:115], v[52:55], v[88:91]
    s_add_u32 s76, s76, 32768
    v_mfma_f32_16x16x32_bf16 v[92:95], a[116:119], v[52:55], v[92:95]
    buffer_store_dwordx4 v[220:223], v11, s[12:15], s76 offen sc1
    v_mfma_f32_16x16x32_bf16 v[80:83], a[120:123], v[56:59], v[80:83]
    ds_read_b128 v[40:43], v13 offset:34816
    ds_read_b128 v[44:47], v13 offset:35840
    v_mfma_f32_16x16x32_bf16 v[84:87], a[124:127], v[56:59], v[84:87]
    s_add_u32 s76, s76, 32768
    v_mfma_f32_16x16x32_bf16 v[88:91], a[120:123], v[60:63], v[88:91]
    buffer_store_dwordx4 v[224:227], v11, s[12:15], s76 offen sc1
    v_mfma_f32_16x16x32_bf16 v[92:95], a[124:127], v[60:63], v[92:95]
    s_add_u32 s76, s76, 32768
    s_add_u32 s48, s53, 458752
    s_add_u32 s46, s58, 2
    s_cmp_lt_u32 s46, s51
    s_cselect_b32 s48, s48, 0x20000000
    s_add_u32 s49, s48, 4096
    s_mov_b32 s59, s54
    s_waitcnt lgkmcnt(2)
    v_mfma_f32_16x16x32_bf16 v[80:83], a[128:131], v[32:35], v[80:83]
    ds_read_b128 v[48:51], v13 offset:36864
    ds_read_b128 v[52:55], v13 offset:37888
    v_mfma_f32_16x16x32_bf16 v[84:87], a[132:135], v[32:35], v[84:87]
    ds_read_b128 v[56:59], v13 offset:38912
    ds_read_b128 v[60:63], v13 offset:39936
    v_mfma_f32_16x16x32_bf16 v[88:91], a[128:131], v[36:39], v[88:91]
    s_add_u32 m0, s59, 0
    s_nop 0
    buffer_load_dwordx4 v10, s[12:15], s48 offen offset:0 sc1 lds
    v_mfma_f32_16x16x32_bf16 v[92:95], a[132:135], v[36:39], v[92:95]
    buffer_store_dwordx4 v[228:231], v11, s[12:15], s76 offen sc1
    s_waitcnt lgkmcnt(4)
    v_mfma_f32_16x16x32_bf16 v[80:83], a[136:139], v[40:43], v[80:83]
    ds_read_b128 v[32:35], v13 offset:40960
    ds_read_b128 v[36:39], v13 offset:41984
    v_mfma_f32_16x16x32_bf16 v[84:87], a[140:143], v[40:43], v[84:87]
    v_mfma_f32_16x16x32_bf16 v[88:91], a[136:139], v[44:47], v[88:91]
    buffer_load_dwordx4 v10, s[12:15], s48 offen offset:1024 sc1 lds
    v_mfma_f32_16x16x32_bf16 v[92:95], a[140:143], v[44:47], v[92:95]
    s_waitcnt lgkmcnt(4)
    v_mfma_f32_16x16x32_bf16 v[80:83], a[144:147], v[48:51], v[80:83]
    ds_read_b128 v[40:43], v13 offset:43008
    ds_read_b128 v[44:47], v13 offset:44032
    v_mfma_f32_16x16x32_bf16 v[84:87], a[148:151], v[48:51], v[84:87]
    v_mfma_f32_16x16x32_bf16 v[88:91], a[144:147], v[52:55], v[88:91]
    buffer_load_dwordx4 v10, s[12:15], s48 offen offset:2048 sc1 lds
    v_mfma_f32_16x16x32_bf16 v[92:95], a[148:151], v[52:55], v[92:95]
    s_waitcnt lgkmcnt(4)
    v_mfma_f32_16x16x32_bf16 v[80:83], a[152:155], v[56:59], v[80:83]
    ds_read_b128 v[48:51], v13 offset:45056
    ds_read_b128 v[52:55], v13 offset:46080
    v_mfma_f32_16x16x32_bf16 v[84:87], a[156:159], v[56:59], v[84:87]
    v_mfma_f32_16x16x32_bf16 v[88:91], a[152:155], v[60:63], v[88:91]
    buffer_load_dwordx4 v10, s[12:15], s48 offen offset:3072 sc1 lds
    v_mfma_f32_16x16x32_bf16 v[92:95], a[156:159], v[60:63], v[92:95]
    s_waitcnt lgkmcnt(4)
    v_mfma_f32_16x16x32_bf16 v[80:83], a[160:163], v[32:35], v[80:83]
    ds_read_b128 v[56:59], v13 offset:47104
    ds_read_b128 v[60:63], v13 offset:48128
    v_mfma_f32_16x16x32_bf16 v[84:87], a[164:167], v[32:35], v[84:87]
    v_mfma_f32_16x16x32_bf16 v[88:91], a[160:163], v[36:39], v[88:91]
    s_add_u32 m0, s59, 4096
    s_nop 0
    buffer_load_dwordx4 v10, s[12:15], s49 offen offset:0 sc1 lds
    v_mfma_f32_16x16x32_bf16 v[92:95], a[164:167], v[36:39], v[92:95]
    s_waitcnt lgkmcnt(4)
    v_mfma_f32_16x16x32_bf16 v[80:83], a[168:171], v[40:43], v[80:83]
    ds_read_b128 v[32:35], v13 offset:49152
    ds_read_b128 v[36:39], v13 offset:50176
    v_mfma_f32_16x16x32_bf16 v[84:87], a[172:175], v[40:43], v[84:87]
    v_mfma_f32_16x16x32_bf16 v[88:91], a[168:171], v[44:47], v[88:91]
    buffer_load_dwordx4 v10, s[12:15], s49 offen offset:1024 sc1 lds
    v_mfma_f32_16x16x32_bf16 v[92:95], a[172:175], v[44:47], v[92:95]
    s_waitcnt lgkmcnt(4)
    v_mfma_f32_16x16x32_bf16 v[80:83], a[176:179], v[48:51], v[80:83]
    ds_read_b128 v[40:43], v13 offset:51200
    ds_read_b128 v[44:47], v13 offset:52224
    v_mfma_f32_16x16x32_bf16 v[84:87], a[180:183], v[48:51], v[84:87]
    v_mfma_f32_16x16x32_bf16 v[88:91], a[176:179], v[52:55], v[88:91]
    buffer_load_dwordx4 v10, s[12:15], s49 offen offset:2048 sc1 lds
    v_mfma_f32_16x16x32_bf16 v[92:95], a[180:183], v[52:55], v[92:95]
    s_waitcnt lgkmcnt(4)
    v_mfma_f32_16x16x32_bf16 v[80:83], a[184:187], v[56:59], v[80:83]
    ds_read_b128 v[48:51], v13 offset:53248
    ds_read_b128 v[52:55], v13 offset:54272
    v_mfma_f32_16x16x32_bf16 v[84:87], a[188:191], v[56:59], v[84:87]
    v_mfma_f32_16x16x32_bf16 v[88:91], a[184:187], v[60:63], v[88:91]
    buffer_load_dwordx4 v10, s[12:15], s49 offen offset:3072 sc1 lds
    v_mfma_f32_16x16x32_bf16 v[92:95], a[188:191], v[60:63], v[92:95]
    s_waitcnt lgkmcnt(4)
    v_mfma_f32_16x16x32_bf16 v[80:83], a[192:195], v[32:35], v[80:83]
    ds_read_b128 v[56:59], v13 offset:55296
    ds_read_b128 v[60:63], v13 offset:56320
    v_mfma_f32_16x16x32_bf16 v[84:87], a[196:199], v[32:35], v[84:87]
    v_mfma_f32_16x16x32_bf16 v[88:91], a[192:195], v[36:39], v[88:91]
    v_mfma_f32_16x16x32_bf16 v[92:95], a[196:199], v[36:39], v[92:95]
    s_waitcnt lgkmcnt(4)
    v_mfma_f32_16x16x32_bf16 v[80:83], a[200:203], v[40:43], v[80:83]
    v_mfma_f32_16x16x32_bf16 v[84:87], a[204:207], v[40:43], v[84:87]
    v_mfma_f32_16x16x32_bf16 v[88:91], a[200:203], v[44:47], v[88:91]
    v_mfma_f32_16x16x32_bf16 v[92:95], a[204:207], v[44:47], v[92:95]
    s_waitcnt vmcnt(16) lgkmcnt(0)
    s_barrier
    v_mfma_f32_16x16x32_bf16 v[80:83], a[208:211], v[48:51], v[80:83]
    ds_read_b128 v[32:35], v14 offset:0
    ds_read_b128 v[36:39], v14 offset:1024
    v_mfma_f32_16x16x32_bf16 v[84:87], a[212:215], v[48:51], v[84:87]
    v_mfma_f32_16x16x32_bf16 v[88:91], a[208:211], v[52:55], v[88:91]
    v_mfma_f32_16x16x32_bf16 v[92:95], a[212:215], v[52:55], v[92:95]
    v_mfma_f32_16x16x32_bf16 v[80:83], a[216:219], v[56:59], v[80:83]
    ds_read_b128 v[40:43], v14 offset:2048
    ds_read_b128 v[44:47], v14 offset:3072
    v_mfma_f32_16x16x32_bf16 v[84:87], a[220:223], v[56:59], v[84:87]
    v_mfma_f32_16x16x32_bf16 v[88:91], a[216:219], v[60:63], v[88:91]
    v_mfma_f32_16x16x32_bf16 v[92:95], a[220:223], v[60:63], v[92:95]
    s_add_u32 s53, s53, 229376
    s_add_u32 s58, s58, 1
    v_swap_b32 v13, v14
    s_xor_b32 s54, s54, 65536
    s_xor_b32 s55, s55, 65536
    s_mov_b32 s76, s57
    v_swap_b32 v15, v16
    s_add_u32 s57, s57, 131072
    ds_write_b128 v7, v[80:83] offset:0
    ds_write_b128 v7, v[84:87] offset:64
    ds_write_b128 v7, v[88:91] offset:2304
    ds_write_b128 v7, v[92:95] offset:2368
    s_cmp_lt_u32 s58, s51
    s_cbranch_scc1 L_e_loop_168
    s_branch L_e_fin_170
L_e_one_169:
    s_waitcnt vmcnt(8)
    s_barrier
    ds_read_b128 v[32:35], v13 offset:0
    ds_read_b128 v[36:39], v13 offset:1024
    ds_read_b128 v[40:43], v13 offset:2048
    ds_read_b128 v[44:47], v13 offset:3072
    s_waitcnt lgkmcnt(2)
    v_mfma_f32_16x16x32_bf16 v[80:83], a[0:3], v[32:35], 0
    ds_read_b128 v[48:51], v13 offset:4096
    ds_read_b128 v[52:55], v13 offset:5120
    v_mfma_f32_16x16x32_bf16 v[84:87], a[4:7], v[32:35], 0
    ds_read_b128 v[56:59], v13 offset:6144
    ds_read_b128 v[60:63], v13 offset:7168
    v_mfma_f32_16x16x32_bf16 v[88:91], a[0:3], v[36:39], 0
    v_mfma_f32_16x16x32_bf16 v[92:95], a[4:7], v[36:39], 0
    s_waitcnt lgkmcnt(4)
    v_mfma_f32_16x16x32_bf16 v[80:83], a[8:11], v[40:43], v[80:83]
    ds_read_b128 v[32:35], v13 offset:8192
    ds_read_b128 v[36:39], v13 offset:9216
    v_mfma_f32_16x16x32_bf16 v[84:87], a[12:15], v[40:43], v[84:87]
    v_mfma_f32_16x16x32_bf16 v[88:91], a[8:11], v[44:47], v[88:91]
    v_mfma_f32_16x16x32_bf16 v[92:95], a[12:15], v[44:47], v[92:95]
    s_waitcnt lgkmcnt(4)
    v_mfma_f32_16x16x32_bf16 v[80:83], a[16:19], v[48:51], v[80:83]
    ds_read_b128 v[40:43], v13 offset:10240
    ds_read_b128 v[44:47], v13 offset:11264
    v_mfma_f32_16x16x32_bf16 v[84:87], a[20:23], v[48:51], v[84:87]
    v_mfma_f32_16x16x32_bf16 v[88:91], a[16:19], v[52:55], v[88:91]
    v_mfma_f32_16x16x32_bf16 v[92:95], a[20:23], v[52:55], v[92:95]
    s_waitcnt lgkmcnt(4)
    v_mfma_f32_16x16x32_bf16 v[80:83], a[24:27], v[56:59], v[80:83]
    ds_read_b128 v[48:51], v13 offset:12288
    ds_read_b128 v[52:55], v13 offset:13312
    v_mfma_f32_16x16x32_bf16 v[84:87], a[28:31], v[56:59], v[84:87]
    v_mfma_f32_16x16x32_bf16 v[88:91], a[24:27], v[60:63], v[88:91]
    v_mfma_f32_16x16x32_bf16 v[92:95], a[28:31], v[60:63], v[92:95]
    s_waitcnt lgkmcnt(4)
    v_mfma_f32_16x16x32_bf16 v[80:83], a[32:35], v[32:35], v[80:83]
    ds_read_b128 v[56:59], v13 offset:14336
    ds_read_b128 v[60:63], v13 offset:15360
    v_mfma_f32_16x16x32_bf16 v[84:87], a[36:39], v[32:35], v[84:87]
    v_mfma_f32_16x16x32_bf16 v[88:91], a[32:35], v[36:39], v[88:91]
    v_mfma_f32_16x16x32_bf16 v[92:95], a[36:39], v[36:39], v[92:95]
    s_waitcnt lgkmcnt(4)
    v_mfma_f32_16x16x32_bf16 v[80:83], a[40:43], v[40:43], v[80:83]
    ds_read_b128 v[32:35], v13 offset:16384
    ds_read_b128 v[36:39], v13 offset:17408
    v_mfma_f32_16x16x32_bf16 v[84:87], a[44:47], v[40:43], v[84:87]
    v_mfma_f32_16x16x32_bf16 v[88:91], a[40:43], v[44:47], v[88:91]
    v_mfma_f32_16x16x32_bf16 v[92:95], a[44:47], v[44:47], v[92:95]
    s_waitcnt lgkmcnt(4)
    v_mfma_f32_16x16x32_bf16 v[80:83], a[48:51], v[48:51], v[80:83]
    ds_read_b128 v[40:43], v13 offset:18432
    ds_read_b128 v[44:47], v13 offset:19456
    v_mfma_f32_16x16x32_bf16 v[84:87], a[52:55], v[48:51], v[84:87]
    v_mfma_f32_16x16x32_bf16 v[88:91], a[48:51], v[52:55], v[88:91]
    v_mfma_f32_16x16x32_bf16 v[92:95], a[52:55], v[52:55], v[92:95]
    s_waitcnt lgkmcnt(4)
    v_mfma_f32_16x16x32_bf16 v[80:83], a[56:59], v[56:59], v[80:83]
    ds_read_b128 v[48:51], v13 offset:20480
    ds_read_b128 v[52:55], v13 offset:21504
    v_mfma_f32_16x16x32_bf16 v[84:87], a[60:63], v[56:59], v[84:87]
    v_mfma_f32_16x16x32_bf16 v[88:91], a[56:59], v[60:63], v[88:91]
    v_mfma_f32_16x16x32_bf16 v[92:95], a[60:63], v[60:63], v[92:95]
    s_waitcnt lgkmcnt(4)
    v_mfma_f32_16x16x32_bf16 v[80:83], a[64:67], v[32:35], v[80:83]
    ds_read_b128 v[56:59], v13 offset:22528
    ds_read_b128 v[60:63], v13 offset:23552
    v_mfma_f32_16x16x32_bf16 v[84:87], a[68:71], v[32:35], v[84:87]
    v_mfma_f32_16x16x32_bf16 v[88:91], a[64:67], v[36:39], v[88:91]
    v_mfma_f32_16x16x32_bf16 v[92:95], a[68:71], v[36:39], v[92:95]
    s_waitcnt lgkmcnt(4)
    v_mfma_f32_16x16x32_bf16 v[80:83], a[72:75], v[40:43], v[80:83]
    ds_read_b128 v[32:35], v13 offset:24576
    ds_read_b128 v[36:39], v13 offset:25600
    v_mfma_f32_16x16x32_bf16 v[84:87], a[76:79], v[40:43], v[84:87]
    v_mfma_f32_16x16x32_bf16 v[88:91], a[72:75], v[44:47], v[88:91]
    v_mfma_f32_16x16x32_bf16 v[92:95], a[76:79], v[44:47], v[92:95]
    s_waitcnt lgkmcnt(4)
    v_mfma_f32_16x16x32_bf16 v[80:83], a[80:83], v[48:51], v[80:83]
    ds_read_b128 v[40:43], v13 offset:26624
    ds_read_b128 v[44:47], v13 offset:27648
    v_mfma_f32_16x16x32_bf16 v[84:87], a[84:87], v[48:51], v[84:87]
    v_mfma_f32_16x16x32_bf16 v[88:91], a[80:83], v[52:55], v[88:91]
    v_mfma_f32_16x16x32_bf16 v[92:95], a[84:87], v[52:55], v[92:95]
    s_waitcnt lgkmcnt(4)
    v_mfma_f32_16x16x32_bf16 v[80:83], a[88:91], v[56:59], v[80:83]
    ds_read_b128 v[48:51], v13 offset:28672
    ds_read_b128 v[52:55], v13 offset:29696
    v_mfma_f32_16x16x32_bf16 v[84:87], a[92:95], v[56:59], v[84:87]
    v_mfma_f32_16x16x32_bf16 v[88:91], a[88:91], v[60:63], v[88:91]
    v_mfma_f32_16x16x32_bf16 v[92:95], a[92:95], v[60:63], v[92:95]
    s_waitcnt lgkmcnt(4)
    v_mfma_f32_16x16x32_bf16 v[80:83], a[96:99], v[32:35], v[80:83]
    ds_read_b128 v[56:59], v13 offset:30720
    ds_read_b128 v[60:63], v13 offset:31744
    v_mfma_f32_16x16x32_bf16 v[84:87], a[100:103], v[32:35], v[84:87]
    v_mfma_f32_16x16x32_bf16 v[88:91], a[96:99], v[36:39], v[88:91]
    v_mfma_f32_16x16x32_bf16 v[92:95], a[100:103], v[36:39], v[92:95]
    s_waitcnt lgkmcnt(4)
    v_mfma_f32_16x16x32_bf16 v[80:83], a[104:107], v[40:43], v[80:83]
    v_mfma_f32_16x16x32_bf16 v[84:87], a[108:111], v[40:43], v[84:87]
    v_mfma_f32_16x16x32_bf16 v[88:91], a[104:107], v[44:47], v[88:91]
    v_mfma_f32_16x16x32_bf16 v[92:95], a[108:111], v[44:47], v[92:95]
    s_waitcnt vmcnt(0) lgkmcnt(0)
    s_barrier
    v_mfma_f32_16x16x32_bf16 v[80:83], a[112:115], v[48:51], v[80:83]
    ds_read_b128 v[32:35], v13 offset:32768
    ds_read_b128 v[36:39], v13 offset:33792
    v_mfma_f32_16x16x32_bf16 v[84:87], a[116:119], v[48:51], v[84:87]
    v_mfma_f32_16x16x32_bf16 v[88:91], a[112:115], v[52:55], v[88:91]
    v_mfma_f32_16x16x32_bf16 v[92:95], a[116:119], v[52:55], v[92:95]
    v_mfma_f32_16x16x32_bf16 v[80:83], a[120:123], v[56:59], v[80:83]
    ds_read_b128 v[40:43], v13 offset:34816
    ds_read_b128 v[44:47], v13 offset:35840
    v_mfma_f32_16x16x32_bf16 v[84:87], a[124:127], v[56:59], v[84:87]
    v_mfma_f32_16x16x32_bf16 v[88:91], a[120:123], v[60:63], v[88:91]
    v_mfma_f32_16x16x32_bf16 v[92:95], a[124:127], v[60:63], v[92:95]
    s_waitcnt lgkmcnt(2)
    v_mfma_f32_16x16x32_bf16 v[80:83], a[128:131], v[32:35], v[80:83]
    ds_read_b128 v[48:51], v13 offset:36864
    ds_read_b128 v[52:55], v13 offset:37888
    v_mfma_f32_16x16x32_bf16 v[84:87], a[132:135], v[32:35], v[84:87]
    ds_read_b128 v[56:59], v13 offset:38912
    ds_read_b128 v[60:63], v13 offset:39936
    v_mfma_f32_16x16x32_bf16 v[88:91], a[128:131], v[36:39], v[88:91]
    v_mfma_f32_16x16x32_bf16 v[92:95], a[132:135], v[36:39], v[92:95]
    s_waitcnt lgkmcnt(4)
    v_mfma_f32_16x16x32_bf16 v[80:83], a[136:139], v[40:43], v[80:83]
    ds_read_b128 v[32:35], v13 offset:40960
    ds_read_b128 v[36:39], v13 offset:41984
    v_mfma_f32_16x16x32_bf16 v[84:87], a[140:143], v[40:43], v[84:87]
    v_mfma_f32_16x16x32_bf16 v[88:91], a[136:139], v[44:47], v[88:91]
    v_mfma_f32_16x16x32_bf16 v[92:95], a[140:143], v[44:47], v[92:95]
    s_waitcnt lgkmcnt(4)
    v_mfma_f32_16x16x32_bf16 v[80:83], a[144:147], v[48:51], v[80:83]
    ds_read_b128 v[40:43], v13 offset:43008
    ds_read_b128 v[44:47], v13 offset:44032
    v_mfma_f32_16x16x32_bf16 v[84:87], a[148:151], v[48:51], v[84:87]
    v_mfma_f32_16x16x32_bf16 v[88:91], a[144:147], v[52:55], v[88:91]
    v_mfma_f32_16x16x32_bf16 v[92:95], a[148:151], v[52:55], v[92:95]
    s_waitcnt lgkmcnt(4)
    v_mfma_f32_16x16x32_bf16 v[80:83], a[152:155], v[56:59], v[80:83]
    ds_read_b128 v[48:51], v13 offset:45056
    ds_read_b128 v[52:55], v13 offset:46080
    v_mfma_f32_16x16x32_bf16 v[84:87], a[156:159], v[56:59], v[84:87]
    v_mfma_f32_16x16x32_bf16 v[88:91], a[152:155], v[60:63], v[88:91]
    v_mfma_f32_16x16x32_bf16 v[92:95], a[156:159], v[60:63], v[92:95]
    s_waitcnt lgkmcnt(4)
    v_mfma_f32_16x16x32_bf16 v[80:83], a[160:163], v[32:35], v[80:83]
    ds_read_b128 v[56:59], v13 offset:47104
    ds_read_b128 v[60:63], v13 offset:48128
    v_mfma_f32_16x16x32_bf16 v[84:87], a[164:167], v[32:35], v[84:87]
    v_mfma_f32_16x16x32_bf16 v[88:91], a[160:163], v[36:39], v[88:91]
    v_mfma_f32_16x16x32_bf16 v[92:95], a[164:167], v[36:39], v[92:95]
    s_waitcnt lgkmcnt(4)
    v_mfma_f32_16x16x32_bf16 v[80:83], a[168:171], v[40:43], v[80:83]
    ds_read_b128 v[32:35], v13 offset:49152
    ds_read_b128 v[36:39], v13 offset:50176
    v_mfma_f32_16x16x32_bf16 v[84:87], a[172:175], v[40:43], v[84:87]
    v_mfma_f32_16x16x32_bf16 v[88:91], a[168:171], v[44:47], v[88:91]
    v_mfma_f32_16x16x32_bf16 v[92:95], a[172:175], v[44:47], v[92:95]
    s_waitcnt lgkmcnt(4)
    v_mfma_f32_16x16x32_bf16 v[80:83], a[176:179], v[48:51], v[80:83]
    ds_read_b128 v[40:43], v13 offset:51200
    ds_read_b128 v[44:47], v13 offset:52224
    v_mfma_f32_16x16x32_bf16 v[84:87], a[180:183], v[48:51], v[84:87]
    v_mfma_f32_16x16x32_bf16 v[88:91], a[176:179], v[52:55], v[88:91]
    v_mfma_f32_16x16x32_bf16 v[92:95], a[180:183], v[52:55], v[92:95]
    s_waitcnt lgkmcnt(4)
    v_mfma_f32_16x16x32_bf16 v[80:83], a[184:187], v[56:59], v[80:83]
    ds_read_b128 v[48:51], v13 offset:53248
    ds_read_b128 v[52:55], v13 offset:54272
    v_mfma_f32_16x16x32_bf16 v[84:87], a[188:191], v[56:59], v[84:87]
    v_mfma_f32_16x16x32_bf16 v[88:91], a[184:187], v[60:63], v[88:91]
    v_mfma_f32_16x16x32_bf16 v[92:95], a[188:191], v[60:63], v[92:95]
    s_waitcnt lgkmcnt(4)
    v_mfma_f32_16x16x32_bf16 v[80:83], a[192:195], v[32:35], v[80:83]
    ds_read_b128 v[56:59], v13 offset:55296
    ds_read_b128 v[60:63], v13 offset:56320
    v_mfma_f32_16x16x32_bf16 v[84:87], a[196:199], v[32:35], v[84:87]
    v_mfma_f32_16x16x32_bf16 v[88:91], a[192:195], v[36:39], v[88:91]
    v_mfma_f32_16x16x32_bf16 v[92:95], a[196:199], v[36:39], v[92:95]
    s_waitcnt lgkmcnt(4)
    v_mfma_f32_16x16x32_bf16 v[80:83], a[200:203], v[40:43], v[80:83]
    v_mfma_f32_16x16x32_bf16 v[84:87], a[204:207], v[40:43], v[84:87]
    v_mfma_f32_16x16x32_bf16 v[88:91], a[200:203], v[44:47], v[88:91]
    v_mfma_f32_16x16x32_bf16 v[92:95], a[204:207], v[44:47], v[92:95]
    s_waitcnt lgkmcnt(0)
    v_mfma_f32_16x16x32_bf16 v[80:83], a[208:211], v[48:51], v[80:83]
    v_mfma_f32_16x16x32_bf16 v[84:87], a[212:215], v[48:51], v[84:87]
    v_mfma_f32_16x16x32_bf16 v[88:91], a[208:211], v[52:55], v[88:91]
    v_mfma_f32_16x16x32_bf16 v[92:95], a[212:215], v[52:55], v[92:95]
    v_mfma_f32_16x16x32_bf16 v[80:83], a[216:219], v[56:59], v[80:83]
    v_mfma_f32_16x16x32_bf16 v[84:87], a[220:223], v[56:59], v[84:87]
    v_mfma_f32_16x16x32_bf16 v[88:91], a[216:219], v[60:63], v[88:91]
    v_mfma_f32_16x16x32_bf16 v[92:95], a[220:223], v[60:63], v[92:95]
    s_mov_b32 s76, s57
    s_nop 6
    ds_write_b128 v7, v[80:83] offset:0
    ds_write_b128 v7, v[84:87] offset:64
    ds_write_b128 v7, v[88:91] offset:2304
    ds_write_b128 v7, v[92:95] offset:2368
L_e_fin_170:
    s_waitcnt lgkmcnt(0)
    ds_read_b128 v[216:219], v8 offset:0
    ds_read_b128 v[220:223], v8 offset:1152
    ds_read_b128 v[224:227], v8 offset:2304
    ds_read_b128 v[228:231], v8 offset:3456
    s_waitcnt lgkmcnt(0)
    buffer_store_dwordx4 v[216:219], v11, s[12:15], s76 offen sc1
    s_add_u32 s76, s76, 32768
    buffer_store_dwordx4 v[220:223], v11, s[12:15], s76 offen sc1
    s_add_u32 s76, s76, 32768
    buffer_store_dwordx4 v[224:227], v11, s[12:15], s76 offen sc1
    s_add_u32 s76, s76, 32768
    buffer_store_dwordx4 v[228:231], v11, s[12:15], s76 offen sc1
    s_waitcnt vmcnt(0)
    s_barrier
    s_cmp_lg_u32 s44, 0
    s_cbranch_scc1 L_pub_171
    v_mov_b32 v30, s62
    v_mov_b32 v31, 0
    s_mov_b64 exec, 1
    buffer_store_dword v30, v31, s[80:83], s65 offen
    buffer_store_dword v30, v31, s[84:87], s65 offen sc1
    s_mov_b64 exec, -1
L_pub_171:
    s_cmp_lg_u32 s51, 1
    s_cbranch_scc1 L_c_skip_164
    s_lshl_b32 s63, s50, 5
    s_add_u32 s63, s63, s41
    s_lshl_b32 s47, s63, 11
    s_lshl_b32 s45, s44, 9
    s_add_u32 s47, s47, s45
    s_add_u32 s46, s47, 0x800000
    v_lshlrev_b32 v17, 3, v1
    buffer_load_dwordx2 v[208:209], v17, s[12:15], s46 offen sc1
    s_add_u32 s45, s64, 16384
    s_cmp_lg_u32 s44, 0
    s_cbranch_scc1 L_pw_172
    s_mov_b32 exec_hi, 0
    s_mov_b32 s70, 0
L_wp_173:
    buffer_load_dword v31, v5, s[12:15], s45 offen sc1
    s_add_u32 s70, s70, 1
    s_cmp_ge_u32 s70, 0x200000
    s_cbranch_scc1 L_w_done_101
    s_waitcnt vmcnt(0)
    v_cmp_gt_u32 vcc, s62, v31
    s_nop 1
    s_cbranch_vccz L_wp_173_ok
    s_sleep 1
    s_branch L_wp_173
L_wp_173_ok:
    s_mov_b64 exec, -1
L_pw_172:
    s_barrier
    s_waitcnt vmcnt(0)
    s_lshl_b32 s45, s63, 12
    s_lshl_b32 s46, s44, 10
    s_add_u32 s45, s45, s46
    s_add_u32 s45, s45, 0xc000000
    buffer_load_dwordx4 v[64:67], v10, s[12:15], s45 offen sc1
    s_add_u32 s45, s45, 0x800000
    buffer_load_dwordx4 v[68:71], v10, s[12:15], s45 offen sc1
    s_add_u32 s45, s45, 0x800000
    buffer_load_dwordx4 v[72:75], v10, s[12:15], s45 offen sc1
    s_add_u32 s45, s45, 0x800000
    buffer_load_dwordx4 v[76:79], v10, s[12:15], s45 offen sc1
    v_lshlrev_b32 v160, 16, v208
    v_and_b32 v161, 0xffff0000, v208
    v_lshlrev_b32 v162, 16, v209
    v_and_b32 v163, 0xffff0000, v209
    s_waitcnt vmcnt(0)
    v_pk_add_f32 v[64:65], v[64:65], v[68:69]
    v_pk_add_f32 v[72:73], v[72:73], v[76:77]
    v_pk_add_f32 v[66:67], v[66:67], v[70:71]
    v_pk_add_f32 v[74:75], v[74:75], v[78:79]
    v_pk_add_f32 v[64:65], v[64:65], v[72:73]
    v_pk_add_f32 v[66:67], v[66:67], v[74:75]
    v_cvt_pk_bf16_f32 v64, v64, v64
    v_lshlrev_b32 v64, 16, v64
    v_cvt_pk_bf16_f32 v65, v65, v65
    v_lshlrev_b32 v65, 16, v65
    v_cvt_pk_bf16_f32 v66, v66, v66
    v_lshlrev_b32 v66, 16, v66
    v_cvt_pk_bf16_f32 v67, v67, v67
    v_lshlrev_b32 v67, 16, v67
    v_add_f32 v64, v64, v18
    v_cvt_pk_bf16_f32 v64, v64, v64
    v_lshlrev_b32 v64, 16, v64
    v_mul_f32 v64, v64, v22
    v_cvt_pk_bf16_f32 v64, v64, v64
    v_lshlrev_b32 v64, 16, v64
    v_add_f32 v64, v64, v160
    v_add_f32 v65, v65, v19
    v_cvt_pk_bf16_f32 v65, v65, v65
    v_lshlrev_b32 v65, 16, v65
    v_mul_f32 v65, v65, v23
    v_cvt_pk_bf16_f32 v65, v65, v65
    v_lshlrev_b32 v65, 16, v65
    v_add_f32 v65, v65, v161
    v_add_f32 v66, v66, v20
    v_cvt_pk_bf16_f32 v66, v66, v66
    v_lshlrev_b32 v66, 16, v66
    v_mul_f32 v66, v66, v24
    v_cvt_pk_bf16_f32 v66, v66, v66
    v_lshlrev_b32 v66, 16, v66
    v_add_f32 v66, v66, v162
    v_add_f32 v67, v67, v21
    v_cvt_pk_bf16_f32 v67, v67, v67
    v_lshlrev_b32 v67, 16, v67
    v_mul_f32 v67, v67, v25
    v_cvt_pk_bf16_f32 v67, v67, v67
    v_lshlrev_b32 v67, 16, v67
    v_add_f32 v67, v67, v163
    v_cvt_pk_bf16_f32 v208, v64, v65
    v_cvt_pk_bf16_f32 v209, v66, v67
    buffer_store_dwordx2 v[208:209], v17, s[32:35], s47 offen
    s_branch L_c_loop_163
L_c_skip_164:
    s_add_u32 s63, s50, s44
    s_lshl_b32 s63, s63, 5
    s_add_u32 s63, s63, s41
    s_lshl_b32 s47, s63, 11
    s_add_u32 s46, s47, 0x800000
    s_cmp_lt_u32 s44, s51
    s_cselect_b32 s46, s46, 0x20000000
    buffer_load_dwordx4 v[208:211], v10, s[12:15], s46 offen sc1
    buffer_load_dwordx4 v[212:215], v10, s[12:15], s46 offen offset:1024 sc1
    s_add_u32 s45, s64, 16384
    s_cmp_lg_u32 s44, 0
    s_cbranch_scc1 L_pw_174
    s_mov_b32 exec_hi, 0
    s_mov_b32 s70, 0
L_wp_175:
    buffer_load_dword v31, v5, s[12:15], s45 offen sc1
    s_add_u32 s70, s70, 1
    s_cmp_ge_u32 s70, 0x200000
    s_cbranch_scc1 L_w_done_101
    s_waitcnt vmcnt(0)
    v_cmp_gt_u32 vcc, s62, v31
    s_nop 1
    s_cbranch_vccz L_wp_175_ok
    s_sleep 1
    s_branch L_wp_175
L_wp_175_ok:
    s_mov_b64 exec, -1
L_pw_174:
    s_barrier
    s_cmp_ge_u32 s44, s51
    s_cbranch_scc1 L_c_loop_163
    s_lshl_b32 s45, s63, 12
    s_add_u32 s45, s45, 0xc000000
    v_lshlrev_b32 v29, 5, v1
    buffer_load_dwordx4 v[64:67], v29, s[12:15], s45 offen offset:0 sc1
    buffer_load_dwordx4 v[68:71], v29, s[12:15], s45 offen offset:16 sc1
    buffer_load_dwordx4 v[72:75], v29, s[12:15], s45 offen offset:2048 sc1
    buffer_load_dwordx4 v[76:79], v29, s[12:15], s45 offen offset:2064 sc1
    s_add_u32 s45, s45, 0x800000
    buffer_load_dwordx4 v[160:163], v29, s[12:15], s45 offen offset:0 sc1
    buffer_load_dwordx4 v[164:167], v29, s[12:15], s45 offen offset:16 sc1
    buffer_load_dwordx4 v[168:171], v29, s[12:15], s45 offen offset:2048 sc1
    buffer_load_dwordx4 v[172:175], v29, s[12:15], s45 offen offset:2064 sc1
    s_add_u32 s45, s45, 0x800000
    buffer_load_dwordx4 v[176:179], v29, s[12:15], s45 offen offset:0 sc1
    buffer_load_dwordx4 v[180:183], v29, s[12:15], s45 offen offset:16 sc1
    buffer_load_dwordx4 v[184:187], v29, s[12:15], s45 offen offset:2048 sc1
    buffer_load_dwordx4 v[188:191], v29, s[12:15], s45 offen offset:2064 sc1
    s_add_u32 s45, s45, 0x800000
    buffer_load_dwordx4 v[192:195], v29, s[12:15], s45 offen offset:0 sc1
    buffer_load_dwordx4 v[196:199], v29, s[12:15], s45 offen offset:16 sc1
    buffer_load_dwordx4 v[200:203], v29, s[12:15], s45 offen offset:2048 sc1
    buffer_load_dwordx4 v[204:207], v29, s[12:15], s45 offen offset:2064 sc1
    s_waitcnt vmcnt(0)
    v_pk_add_f32 v[64:65], v[64:65], v[160:161]
    v_pk_add_f32 v[176:177], v[176:177], v[192:193]
    v_pk_add_f32 v[66:67], v[66:67], v[162:163]
    v_pk_add_f32 v[178:179], v[178:179], v[194:195]
    v_pk_add_f32 v[68:69], v[68:69], v[164:165]
    v_pk_add_f32 v[180:181], v[180:181], v[196:197]
    v_pk_add_f32 v[70:71], v[70:71], v[166:167]
    v_pk_add_f32 v[182:183], v[182:183], v[198:199]
    v_pk_add_f32 v[72:73], v[72:73], v[168:169]
    v_pk_add_f32 v[184:185], v[184:185], v[200:201]
    v_pk_add_f32 v[74:75], v[74:75], v[170:171]
    v_pk_add_f32 v[186:187], v[186:187], v[202:203]
    v_pk_add_f32 v[76:77], v[76:77], v[172:173]
    v_pk_add_f32 v[188:189], v[188:189], v[204:205]
    v_pk_add_f32 v[78:79], v[78:79], v[174:175]
    v_pk_add_f32 v[190:191], v[190:191], v[206:207]
    v_pk_add_f32 v[64:65], v[64:65], v[176:177]
    v_pk_add_f32 v[66:67], v[66:67], v[178:179]
    v_pk_add_f32 v[68:69], v[68:69], v[180:181]
    v_pk_add_f32 v[70:71], v[70:71], v[182:183]
    v_pk_add_f32 v[72:73], v[72:73], v[184:185]
    v_pk_add_f32 v[74:75], v[74:75], v[186:187]
    v_pk_add_f32 v[76:77], v[76:77], v[188:189]
    v_pk_add_f32 v[78:79], v[78:79], v[190:191]
    v_cvt_pk_bf16_f32 v64, v64, v64
    v_lshlrev_b32 v64, 16, v64
    v_cvt_pk_bf16_f32 v65, v65, v65
    v_lshlrev_b32 v65, 16, v65
    v_cvt_pk_bf16_f32 v66, v66, v66
    v_lshlrev_b32 v66, 16, v66
    v_cvt_pk_bf16_f32 v67, v67, v67
    v_lshlrev_b32 v67, 16, v67
    v_cvt_pk_bf16_f32 v68, v68, v68
    v_lshlrev_b32 v68, 16, v68
    v_cvt_pk_bf16_f32 v69, v69, v69
    v_lshlrev_b32 v69, 16, v69
    v_cvt_pk_bf16_f32 v70, v70, v70
    v_lshlrev_b32 v70, 16, v70
    v_cvt_pk_bf16_f32 v71, v71, v71
    v_lshlrev_b32 v71, 16, v71
    v_cvt_pk_bf16_f32 v72, v72, v72
    v_lshlrev_b32 v72, 16, v72
    v_cvt_pk_bf16_f32 v73, v73, v73
    v_lshlrev_b32 v73, 16, v73
    v_cvt_pk_bf16_f32 v74, v74, v74
    v_lshlrev_b32 v74, 16, v74
    v_cvt_pk_bf16_f32 v75, v75, v75
    v_lshlrev_b32 v75, 16, v75
    v_cvt_pk_bf16_f32 v76, v76, v76
    v_lshlrev_b32 v76, 16, v76
    v_cvt_pk_bf16_f32 v77, v77, v77
    v_lshlrev_b32 v77, 16, v77
    v_cvt_pk_bf16_f32 v78, v78, v78
    v_lshlrev_b32 v78, 16, v78
    v_cvt_pk_bf16_f32 v79, v79, v79
    v_lshlrev_b32 v79, 16, v79
    v_lshlrev_b32 v160, 16, v208
    v_and_b32 v161, 0xffff0000, v208
    v_lshlrev_b32 v162, 16, v209
    v_and_b32 v163, 0xffff0000, v209
    v_lshlrev_b32 v164, 16, v210
    v_and_b32 v165, 0xffff0000, v210
    v_lshlrev_b32 v166, 16, v211
    v_and_b32 v167, 0xffff0000, v211
    v_lshlrev_b32 v168, 16, v212
    v_and_b32 v169, 0xffff0000, v212
    v_lshlrev_b32 v170, 16, v213
    v_and_b32 v171, 0xffff0000, v213
    v_lshlrev_b32 v172, 16, v214
    v_and_b32 v173, 0xffff0000, v214
    v_lshlrev_b32 v174, 16, v215
    v_and_b32 v175, 0xffff0000, v215
    v_add_f32 v64, v64, v96
    v_cvt_pk_bf16_f32 v64, v64, v64
    v_lshlrev_b32 v64, 16, v64
    v_mul_f32 v64, v64, v112
    v_cvt_pk_bf16_f32 v64, v64, v64
    v_lshlrev_b32 v64, 16, v64
    v_add_f32 v64, v64, v160
    v_add_f32 v65, v65, v97
    v_cvt_pk_bf16_f32 v65, v65, v65
    v_lshlrev_b32 v65, 16, v65
    v_mul_f32 v65, v65, v113
    v_cvt_pk_bf16_f32 v65, v65, v65
    v_lshlrev_b32 v65, 16, v65
    v_add_f32 v65, v65, v161
    v_add_f32 v66, v66, v98
    v_cvt_pk_bf16_f32 v66, v66, v66
    v_lshlrev_b32 v66, 16, v66
    v_mul_f32 v66, v66, v114
    v_cvt_pk_bf16_f32 v66, v66, v66
    v_lshlrev_b32 v66, 16, v66
    v_add_f32 v66, v66, v162
    v_add_f32 v67, v67, v99
    v_cvt_pk_bf16_f32 v67, v67, v67
    v_lshlrev_b32 v67, 16, v67
    v_mul_f32 v67, v67, v115
    v_cvt_pk_bf16_f32 v67, v67, v67
    v_lshlrev_b32 v67, 16, v67
    v_add_f32 v67, v67, v163
    v_add_f32 v68, v68, v100
    v_cvt_pk_bf16_f32 v68, v68, v68
    v_lshlrev_b32 v68, 16, v68
    v_mul_f32 v68, v68, v116
    v_cvt_pk_bf16_f32 v68, v68, v68
    v_lshlrev_b32 v68, 16, v68
    v_add_f32 v68, v68, v164
    v_add_f32 v69, v69, v101
    v_cvt_pk_bf16_f32 v69, v69, v69
    v_lshlrev_b32 v69, 16, v69
    v_mul_f32 v69, v69, v117
    v_cvt_pk_bf16_f32 v69, v69, v69
    v_lshlrev_b32 v69, 16, v69
    v_add_f32 v69, v69, v165
    v_add_f32 v70, v70, v102
    v_cvt_pk_bf16_f32 v70, v70, v70
    v_lshlrev_b32 v70, 16, v70
    v_mul_f32 v70, v70, v118
    v_cvt_pk_bf16_f32 v70, v70, v70
    v_lshlrev_b32 v70, 16, v70
    v_add_f32 v70, v70, v166
    v_add_f32 v71, v71, v103
    v_cvt_pk_bf16_f32 v71, v71, v71
    v_lshlrev_b32 v71, 16, v71
    v_mul_f32 v71, v71, v119
    v_cvt_pk_bf16_f32 v71, v71, v71
    v_lshlrev_b32 v71, 16, v71
    v_add_f32 v71, v71, v167
    v_add_f32 v72, v72, v104
    v_cvt_pk_bf16_f32 v72, v72, v72
    v_lshlrev_b32 v72, 16, v72
    v_mul_f32 v72, v72, v120
    v_cvt_pk_bf16_f32 v72, v72, v72
    v_lshlrev_b32 v72, 16, v72
    v_add_f32 v72, v72, v168
    v_add_f32 v73, v73, v105
    v_cvt_pk_bf16_f32 v73, v73, v73
    v_lshlrev_b32 v73, 16, v73
    v_mul_f32 v73, v73, v121
    v_cvt_pk_bf16_f32 v73, v73, v73
    v_lshlrev_b32 v73, 16, v73
    v_add_f32 v73, v73, v169
    v_add_f32 v74, v74, v106
    v_cvt_pk_bf16_f32 v74, v74, v74
    v_lshlrev_b32 v74, 16, v74
    v_mul_f32 v74, v74, v122
    v_cvt_pk_bf16_f32 v74, v74, v74
    v_lshlrev_b32 v74, 16, v74
    v_add_f32 v74, v74, v170
    v_add_f32 v75, v75, v107
    v_cvt_pk_bf16_f32 v75, v75, v75
    v_lshlrev_b32 v75, 16, v75
    v_mul_f32 v75, v75, v123
    v_cvt_pk_bf16_f32 v75, v75, v75
    v_lshlrev_b32 v75, 16, v75
    v_add_f32 v75, v75, v171
    v_add_f32 v76, v76, v108
    v_cvt_pk_bf16_f32 v76, v76, v76
    v_lshlrev_b32 v76, 16, v76
    v_mul_f32 v76, v76, v124
    v_cvt_pk_bf16_f32 v76, v76, v76
    v_lshlrev_b32 v76, 16, v76
    v_add_f32 v76, v76, v172
    v_add_f32 v77, v77, v109
    v_cvt_pk_bf16_f32 v77, v77, v77
    v_lshlrev_b32 v77, 16, v77
    v_mul_f32 v77, v77, v125
    v_cvt_pk_bf16_f32 v77, v77, v77
    v_lshlrev_b32 v77, 16, v77
    v_add_f32 v77, v77, v173
    v_add_f32 v78, v78, v110
    v_cvt_pk_bf16_f32 v78, v78, v78
    v_lshlrev_b32 v78, 16, v78
    v_mul_f32 v78, v78, v126
    v_cvt_pk_bf16_f32 v78, v78, v78
    v_lshlrev_b32 v78, 16, v78
    v_add_f32 v78, v78, v174
    v_add_f32 v79, v79, v111
    v_cvt_pk_bf16_f32 v79, v79, v79
    v_lshlrev_b32 v79, 16, v79
    v_mul_f32 v79, v79, v127
    v_cvt_pk_bf16_f32 v79, v79, v79
    v_lshlrev_b32 v79, 16, v79
    v_add_f32 v79, v79, v175
    v_cvt_pk_bf16_f32 v208, v64, v65
    v_cvt_pk_bf16_f32 v209, v66, v67
    v_cvt_pk_bf16_f32 v210, v68, v69
    v_cvt_pk_bf16_f32 v211, v70, v71
    v_cvt_pk_bf16_f32 v212, v72, v73
    v_cvt_pk_bf16_f32 v213, v74, v75
    v_cvt_pk_bf16_f32 v214, v76, v77
    v_cvt_pk_bf16_f32 v215, v78, v79
    buffer_store_dwordx4 v[208:211], v10, s[32:35], s47 offen
    buffer_store_dwordx4 v[212:215], v10, s[32:35], s47 offen offset:1024
    s_branch L_c_loop_163
L_w_done_101:
    s_endpgm
.section .rodata,"a"
.p2align 6
.amdhsa_kernel adaLN_cond__memory_aug_recurrent_mem_tr__dense_activation_gelu__prompt_kernel
  .amdhsa_next_free_vgpr 512
  .amdhsa_next_free_sgpr 102
  .amdhsa_accum_offset 256
  .amdhsa_group_segment_fixed_size 0
  .amdhsa_kernarg_size 136
  .amdhsa_user_sgpr_count 2
  .amdhsa_user_sgpr_kernarg_segment_ptr 1
  .amdhsa_system_sgpr_workgroup_id_x 1
.end_amdhsa_kernel
```

```asm
; @launch kernel=adaLN_cond__memory_aug_recurrent_mem_tr__dense_activation_gelu__prompt_kernel grid=(256,1,1) block=(256,1,1) lds=163840
.amdgcn_target "amdgcn-amd-amdhsa--gfx950"
.text
.globl adaLN_cond__memory_aug_recurrent_mem_tr__dense_activation_gelu__prompt_kernel
.p2align 8
.type adaLN_cond__memory_aug_recurrent_mem_tr__dense_activation_gelu__prompt_kernel,@function
adaLN_cond__memory_aug_recurrent_mem_tr__dense_activation_gelu__prompt_kernel:
    s_cmp_lt_u32 s2, 256
    s_cbranch_scc1 L_c_done_1_go
    s_endpgm
L_c_done_1_go:
    s_and_b32 s40, s2, 7
    s_load_dwordx4 s[4:7], s[0:1], 16
    s_load_dwordx4 s[8:11], s[0:1], 32
    s_load_dwordx2 s[20:21], s[0:1], 128
    s_load_dwordx2 s[22:23], s[0:1], 120
    s_load_dwordx2 s[50:51], s[0:1], 8
    s_lshr_b32 s41, s2, 3
    s_and_b32 s42, s41, 15
    v_and_b32 v1, 63, v0
    v_lshrrev_b32 v2, 6, v0
    s_nop 0
    v_readfirstlane_b32 s44, v2
    s_waitcnt lgkmcnt(0)
    s_mov_b32 s24, s4
    s_and_b32 s25, s5, 0xffff
    s_mov_b32 s26, 0x800000
    s_mov_b32 s27, 0x00020000
    s_mov_b32 s28, s6
    s_and_b32 s29, s7, 0xffff
    s_mov_b32 s30, 0x800000
    s_mov_b32 s31, 0x00020000
    s_mov_b32 s32, s8
    s_and_b32 s33, s9, 0xffff
    s_mov_b32 s34, 0x800000
    s_mov_b32 s35, 0x00020000
    s_mov_b32 s36, s10
    s_and_b32 s37, s11, 0xffff
    s_mov_b32 s38, 0x800000
    s_mov_b32 s39, 0x00020000
    s_mov_b32 s12, s20
    s_and_b32 s13, s21, 0xffff
    s_mov_b32 s14, 0x10000000
    s_mov_b32 s15, 0x00020000
    s_mov_b32 s16, s22
    s_and_b32 s17, s23, 0xffff
    s_mov_b32 s18, 0x100
    s_mov_b32 s19, 0x00020000
    s_mov_b32 s52, s50
    s_and_b32 s53, s51, 0xffff
    s_mov_b32 s54, 0x4000
    s_mov_b32 s55, 0x00020000
    v_mov_b32 v41, 0
    s_cmp_lg_u32 s2, 1
    s_cbranch_scc1 L_worker_3_a
    s_getreg_b32 s45, hwreg(HW_REG_XCC_ID)
    s_and_b32 s45, s45, 1
    s_add_u32 s45, s45, 1
    v_mov_b32 v40, s45
    buffer_store_dword v40, v41, s[16:19], 0 offen offset:24 sc1
L_worker_3_a:
    s_cmp_eq_u32 s40, 1
    s_cbranch_scc1 L_worker_3_g0
    s_cmp_lt_u32 s40, 3
    s_cbranch_scc1 L_worker_3_q
    s_sub_u32 s40, s40, 2
    s_branch L_worker_3
L_worker_3_q:
    s_mov_b32 s70, 0
L_worker_3_p:
    buffer_load_dword v40, v41, s[16:19], 0 offen offset:24 sc1
    s_add_u32 s70, s70, 1
    s_cmp_ge_u32 s70, 0x200000
    s_cbranch_scc1 L_c_done_1
    s_waitcnt vmcnt(0)
    v_readfirstlane_b32 s45, v40
    s_nop 3
    s_cmp_eq_u32 s45, 0
    s_cbranch_scc1 L_worker_3_p
    s_and_b32 s45, s45, 2
    s_cmp_lg_u32 s45, s40
    s_mov_b32 s40, 1
    s_cbranch_scc1 L_worker_3_no
    s_mov_b32 s40, 0
    s_branch L_worker_3
L_worker_3_g0:
    s_mov_b32 s40, 0
L_worker_3_no:
    s_lshl_b32 s43, s40, 4
    s_add_u32 s43, s43, s42
    s_lshl_b32 s3, s43, 7
    s_lshr_b32 s45, s41, 4
    s_lshl_b32 s45, s45, 4
    s_add_u32 s3, s3, s45
    s_lshl_b32 s45, s44, 2
    s_add_u32 s3, s3, s45
    s_add_u32 s3, s3, 0x11000
    v_and_b32 v21, 8, v1
    v_cmp_eq_u32 s[56:57], 0, v21
    v_mov_b32 v2, 0xeeee
    v_mov_b32 v3, 0x4444
    v_cndmask_b32 v2, v2, v3, s[56:57]
    v_lshlrev_b32 v68, 4, v1
    s_lshl_b32 s45, s44, 12
    v_add_u32 v3, s45, v68
    v_add_u32 v4, 4096, v3
    v_and_b32 v4, 16383, v4
    v_add_u32 v21, 8192, v3
    v_and_b32 v21, 16383, v21
    v_add_u32 v23, 12288, v3
    v_and_b32 v23, 16383, v23
    s_mul_i32 s45, s44, 24576
    s_add_u32 s45, s45, 65536
    v_add_u32 v5, s45, v68
    v_lshrrev_b32 v63, 4, v1
    s_lshl_b32 s45, s44, 2
    v_add_u32 v64, s45, v63
    s_lshr_b32 s45, s44, 1
    s_lshl_b32 s45, s45, 2
    v_add_u32 v65, s45, v63
    v_bfe_u32 v66, v1, 1, 3
    v_xor_b32 v66, v66, v65
    v_lshlrev_b32 v66, 5, v66
    v_and_b32 v67, 1, v1
    v_lshlrev_b32 v67, 4, v67
    v_add_u32 v66, v66, v67
    v_lshlrev_b32 v64, 13, v64
    v_add_u32 v82, v64, v66
    s_lshl_b32 s47, s43, 8
    s_lshl_b32 s48, s44, 10
    v_bfe_u32 v64, v1, 2, 2
    v_bfe_u32 v65, v1, 4, 1
    v_lshlrev_b32 v65, 2, v65
    v_add_u32 v65, v65, v64
    v_lshlrev_b32 v66, 3, v63
    v_add_u32 v66, v66, v64
    v_lshlrev_b32 v66, 8, v66
    v_and_b32 v67, 3, v1
    v_lshlrev_b32 v67, 3, v67
    v_add_u32 v66, v66, v67
    s_lshl_b32 s45, s44, 1
    v_xor_b32 v65, s45, v65
    v_lshlrev_b32 v65, 5, v65
    v_add_u32 v80, v66, v65
    v_xor_b32 v81, 32, v80
    v_lshrrev_b32 v64, 5, v1
    v_mul_u32_u24 v64, 20480, v64
    v_add_u32 v64, 65536, v64
    v_add_u32 v84, v64, v80
    v_add_u32 v85, v64, v81
    v_add_u32 v86, 49152, v84
    v_add_u32 v87, 49152, v85
    v_mov_b32 v40, -1
    v_mov_b32 v41, -1
    v_mov_b32 v42, -1
    v_mov_b32 v43, -1
    v_mov_b32 v44, 0
    s_mov_b32 s68, 0
    s_cmp_ge_u32 s41, 16
    s_cbranch_scc1 L_c_vo_2
    s_lshl_b32 s45, s42, 11
    s_lshr_b32 s46, s44, 1
    s_lshl_b32 s46, s46, 10
    s_add_u32 s45, s45, s46
    s_and_b32 s46, s44, 1
    s_lshl_b32 s46, s46, 7
    s_add_u32 s45, s45, s46
    v_add_u32 v17, s45, v68
    v_mov_b32 v63, 0x20000000
    v_cndmask_b32 v17, v63, v17, s[56:57]
    s_lshl_b32 s62, s40, 17
    s_add_u32 s62, s62, 0x7040000
    s_add_u32 s63, s62, 0
    buffer_store_dwordx4 v[40:43], v17, s[12:15], s63 offen sc1
    s_add_u32 s63, s62, 32768
    buffer_store_dwordx4 v[40:43], v17, s[12:15], s63 offen sc1
    s_add_u32 s63, s62, 65536
    buffer_store_dwordx4 v[40:43], v17, s[12:15], s63 offen sc1
    s_add_u32 s63, s62, 98304
    buffer_store_dwordx4 v[40:43], v17, s[12:15], s63 offen sc1
    s_mov_b64 exec, -1
    s_lshl_b32 s45, s40, 12
    s_lshl_b32 s46, s42, 4
    s_add_u32 s45, s45, s46
    s_add_u32 s45, s45, 0x7080000
    s_lshl_b32 s46, s44, 2
    s_add_u32 s45, s45, s46
    v_lshlrev_b32 v20, 8, v1
    v_add_u32 v20, s45, v20
    v_cmp_gt_u32 vcc, 16, v1
    s_nop 1
    v_cndmask_b32 v20, v63, v20, vcc
    buffer_store_dword v44, v20, s[12:15], 0 offen sc1
    s_lshl_b32 s45, s43, 7
    s_add_u32 s45, s45, 0x10010
    v_lshlrev_b32 v64, 2, v1
    s_mov_b64 exec, 7
    buffer_store_dword v44, v64, s[12:15], s45 offen sc1
    s_mov_b64 exec, 1
    v_mov_b32 v65, 63
    buffer_store_dword v44, v64, s[12:15], s3 offen sc1
    buffer_store_dword v65, v64, s[12:15], s3 offen offset:16 sc1
    s_mov_b64 exec, 0xffff
    v_lshlrev_b32 v64, 7, v1
    s_cmp_eq_u32 s2, 1
    s_mov_b32 s45, 0x1f000
    s_cselect_b32 s45, s45, 0x20000000
    buffer_store_dword v44, v64, s[12:15], s45 offen sc1
    s_mov_b64 exec, -1
    s_add_u32 s79, s41, 0
    s_and_b32 s79, s79, 3
    s_lshl_b32 s79, s79, 19
    s_add_u32 s79, s79, s47
    s_add_u32 s46, s79, 0x0
    s_add_u32 m0, s48, 69632
    s_nop 0
    buffer_load_dwordx4 v82, s[24:27], s46 offen  lds
    s_add_u32 s46, s79, 0x20000
    s_add_u32 m0, s48, 94208
    s_nop 0
    buffer_load_dwordx4 v82, s[24:27], s46 offen  lds
    s_add_u32 s46, s79, 0x40000
    s_add_u32 m0, s48, 118784
    s_nop 0
    buffer_load_dwordx4 v82, s[24:27], s46 offen  lds
    s_add_u32 s46, s79, 0x60000
    s_add_u32 m0, s48, 143360
    s_nop 0
    buffer_load_dwordx4 v82, s[24:27], s46 offen  lds
    s_add_u32 s79, s41, 1
    s_and_b32 s79, s79, 3
    s_lshl_b32 s79, s79, 19
    s_add_u32 s79, s79, s47
    s_add_u32 s46, s79, 0x0
    s_add_u32 m0, s48, 73728
    s_nop 0
    buffer_load_dwordx4 v82, s[24:27], s46 offen  lds
    s_add_u32 s46, s79, 0x20000
    s_add_u32 m0, s48, 98304
    s_nop 0
    buffer_load_dwordx4 v82, s[24:27], s46 offen  lds
    s_add_u32 s46, s79, 0x40000
    s_add_u32 m0, s48, 122880
    s_nop 0
    buffer_load_dwordx4 v82, s[24:27], s46 offen  lds
    s_add_u32 s46, s79, 0x60000
    s_add_u32 m0, s48, 147456
    s_nop 0
    buffer_load_dwordx4 v82, s[24:27], s46 offen  lds
    s_add_u32 s79, s41, 2
    s_and_b32 s79, s79, 3
    s_lshl_b32 s79, s79, 19
    s_add_u32 s79, s79, s47
    s_add_u32 s46, s79, 0x0
    s_add_u32 m0, s48, 81920
    s_nop 0
    buffer_load_dwordx4 v82, s[24:27], s46 offen  lds
    s_add_u32 s46, s79, 0x20000
    s_add_u32 m0, s48, 106496
    s_nop 0
    buffer_load_dwordx4 v82, s[24:27], s46 offen  lds
    s_add_u32 s46, s79, 0x40000
    s_add_u32 m0, s48, 131072
    s_nop 0
    buffer_load_dwordx4 v82, s[24:27], s46 offen  lds
    s_add_u32 s46, s79, 0x60000
    s_add_u32 m0, s48, 155648
    s_nop 0
    buffer_load_dwordx4 v82, s[24:27], s46 offen  lds
    s_add_u32 s79, s41, 3
    s_and_b32 s79, s79, 3
    s_lshl_b32 s79, s79, 19
    s_add_u32 s79, s79, s47
    s_add_u32 s46, s79, 0x0
    s_add_u32 m0, s48, 86016
    s_nop 0
    buffer_load_dwordx4 v82, s[24:27], s46 offen  lds
    s_add_u32 s46, s79, 0x20000
    s_add_u32 m0, s48, 110592
    s_nop 0
    buffer_load_dwordx4 v82, s[24:27], s46 offen  lds
    s_add_u32 s46, s79, 0x40000
    s_add_u32 m0, s48, 135168
    s_nop 0
    buffer_load_dwordx4 v82, s[24:27], s46 offen  lds
    s_add_u32 s46, s79, 0x60000
    s_add_u32 m0, s48, 159744
    s_nop 0
    buffer_load_dwordx4 v82, s[24:27], s46 offen  lds
    s_add_u32 s79, s41, 4
    s_and_b32 s79, s79, 3
    s_lshl_b32 s79, s79, 19
    s_add_u32 s79, s79, s47
    s_add_u32 s46, s79, 0x200000
    s_add_u32 m0, s48, 0
    s_nop 0
    buffer_load_dwordx4 v82, s[24:27], s46 offen  lds
    s_add_u32 s46, s79, 0x220000
    s_add_u32 m0, s48, 4096
    s_nop 0
    buffer_load_dwordx4 v82, s[24:27], s46 offen  lds
    s_add_u32 s46, s79, 0x240000
    s_add_u32 m0, s48, 8192
    s_nop 0
    buffer_load_dwordx4 v82, s[24:27], s46 offen  lds
    s_add_u32 s46, s79, 0x260000
    s_add_u32 m0, s48, 12288
    s_nop 0
    buffer_load_dwordx4 v82, s[24:27], s46 offen  lds
    s_add_u32 s79, s41, 5
    s_and_b32 s79, s79, 3
    s_lshl_b32 s79, s79, 19
    s_add_u32 s79, s79, s47
    s_add_u32 s46, s79, 0x200000
    s_add_u32 m0, s48, 16384
    s_nop 0
    buffer_load_dwordx4 v82, s[24:27], s46 offen  lds
    s_add_u32 s46, s79, 0x220000
    s_add_u32 m0, s48, 20480
    s_nop 0
    buffer_load_dwordx4 v82, s[24:27], s46 offen  lds
    s_add_u32 s46, s79, 0x240000
    s_add_u32 m0, s48, 24576
    s_nop 0
    buffer_load_dwordx4 v82, s[24:27], s46 offen  lds
    s_add_u32 s46, s79, 0x260000
    s_add_u32 m0, s48, 28672
    s_nop 0
    buffer_load_dwordx4 v82, s[24:27], s46 offen  lds
    s_add_u32 s79, s41, 6
    s_and_b32 s79, s79, 3
    s_lshl_b32 s79, s79, 19
    s_add_u32 s79, s79, s47
    s_add_u32 s46, s79, 0x200000
    s_add_u32 m0, s48, 32768
    s_nop 0
    buffer_load_dwordx4 v82, s[24:27], s46 offen  lds
    s_add_u32 s46, s79, 0x220000
    s_add_u32 m0, s48, 36864
    s_nop 0
    buffer_load_dwordx4 v82, s[24:27], s46 offen  lds
    s_add_u32 s46, s79, 0x240000
    s_add_u32 m0, s48, 40960
    s_nop 0
    buffer_load_dwordx4 v82, s[24:27], s46 offen  lds
    s_add_u32 s46, s79, 0x260000
    s_add_u32 m0, s48, 45056
    s_nop 0
    buffer_load_dwordx4 v82, s[24:27], s46 offen  lds
    s_add_u32 s79, s41, 7
    s_and_b32 s79, s79, 3
    s_lshl_b32 s79, s79, 19
    s_add_u32 s79, s79, s47
    s_add_u32 s46, s79, 0x200000
    s_add_u32 m0, s48, 49152
    s_nop 0
    buffer_load_dwordx4 v82, s[24:27], s46 offen  lds
    s_add_u32 s46, s79, 0x220000
    s_add_u32 m0, s48, 53248
    s_nop 0
    buffer_load_dwordx4 v82, s[24:27], s46 offen  lds
    s_add_u32 s46, s79, 0x240000
    s_add_u32 m0, s48, 57344
    s_nop 0
    buffer_load_dwordx4 v82, s[24:27], s46 offen  lds
    s_add_u32 s46, s79, 0x260000
    s_add_u32 m0, s48, 61440
    s_nop 0
    buffer_load_dwordx4 v82, s[24:27], s46 offen  lds
    s_waitcnt vmcnt(28)
    s_barrier
    s_cmp_lg_u32 s44, 0
    s_cbranch_scc1 L_lw_4_0
    ds_read_b64_tr_b16 a[0:1], v84 offset:4096
    ds_read_b64_tr_b16 a[2:3], v84 offset:5120
    ds_read_b64_tr_b16 a[4:5], v86 offset:4096
    ds_read_b64_tr_b16 a[6:7], v86 offset:5120
    ds_read_b64_tr_b16 a[8:9], v85 offset:4096
    ds_read_b64_tr_b16 a[10:11], v85 offset:5120
    ds_read_b64_tr_b16 a[12:13], v87 offset:4096
    ds_read_b64_tr_b16 a[14:15], v87 offset:5120
    s_branch L_lw_4
L_lw_4_0:
    s_cmp_lg_u32 s44, 1
    s_cbranch_scc1 L_lw_4_1
    ds_read_b64_tr_b16 v[128:129], v84 offset:4096
    ds_read_b64_tr_b16 v[130:131], v84 offset:5120
    ds_read_b64_tr_b16 v[132:133], v86 offset:4096
    ds_read_b64_tr_b16 v[134:135], v86 offset:5120
    ds_read_b64_tr_b16 v[136:137], v85 offset:4096
    ds_read_b64_tr_b16 v[138:139], v85 offset:5120
    ds_read_b64_tr_b16 v[140:141], v87 offset:4096
    ds_read_b64_tr_b16 v[142:143], v87 offset:5120
    s_branch L_lw_4
L_lw_4_1:
    s_cmp_lg_u32 s44, 2
    s_cbranch_scc1 L_lw_4_2
    ds_read_b64_tr_b16 a[192:193], v84 offset:4096
    ds_read_b64_tr_b16 a[194:195], v84 offset:5120
    ds_read_b64_tr_b16 a[196:197], v86 offset:4096
    ds_read_b64_tr_b16 a[198:199], v86 offset:5120
    ds_read_b64_tr_b16 v[56:57], v85 offset:4096
    ds_read_b64_tr_b16 v[58:59], v85 offset:5120
    ds_read_b64_tr_b16 v[60:61], v87 offset:4096
    ds_read_b64_tr_b16 v[62:63], v87 offset:5120
    s_waitcnt lgkmcnt(0)
    ds_write_b128 v5, v[56:59] offset:0
    ds_write_b128 v5, v[60:63] offset:1024
    s_branch L_lw_4
L_lw_4_2:
    ds_read_b64_tr_b16 a[96:97], v84 offset:4096
    ds_read_b64_tr_b16 a[98:99], v84 offset:5120
    ds_read_b64_tr_b16 a[100:101], v86 offset:4096
    ds_read_b64_tr_b16 a[102:103], v86 offset:5120
    ds_read_b64_tr_b16 v[56:57], v85 offset:4096
    ds_read_b64_tr_b16 v[58:59], v85 offset:5120
    ds_read_b64_tr_b16 v[60:61], v87 offset:4096
    ds_read_b64_tr_b16 v[62:63], v87 offset:5120
    s_waitcnt lgkmcnt(0)
    ds_write_b128 v5, v[56:59] offset:2048
    ds_write_b128 v5, v[60:63] offset:3072
L_lw_4:
    s_waitcnt lgkmcnt(0)
    s_waitcnt vmcnt(24)
    s_barrier
    s_cmp_lg_u32 s44, 0
    s_cbranch_scc1 L_hs_5
    s_getreg_b32 s45, hwreg(HW_REG_XCC_ID)
    s_and_b32 s45, s45, 15
    s_mul_i32 s46, s45, s45
    s_lshl_b32 s46, s46, 9
    s_add_u32 s45, s45, s46
    s_cmp_eq_u32 s40, 0
    s_cselect_b32 s46, s45, 0
    s_cselect_b32 s45, 0, s45
    s_lshl_b32 s68, s68, 24
    s_add_u32 s46, s46, s68
    s_add_u32 s45, s45, 16777216
    v_mov_b32 v40, s46
    v_mov_b32 v41, s45
    v_mov_b32 v42, 0
    s_mov_b64 exec, 1
    buffer_atomic_add_x2 v[40:41], v42, s[16:19], 0 offen sc1
    v_mov_b32 v43, 1
    buffer_atomic_add v43, v42, s[16:19], 0 offen offset:8 sc1
    s_mov_b64 exec, -1
L_hs_5:
    s_cmp_lg_u32 s44, 0
    s_cbranch_scc1 L_lw_6_0
    ds_read_b64_tr_b16 a[32:33], v84 offset:8192
    ds_read_b64_tr_b16 a[34:35], v84 offset:9216
    ds_read_b64_tr_b16 a[36:37], v86 offset:8192
    ds_read_b64_tr_b16 a[38:39], v86 offset:9216
    ds_read_b64_tr_b16 a[40:41], v85 offset:8192
    ds_read_b64_tr_b16 a[42:43], v85 offset:9216
    ds_read_b64_tr_b16 a[44:45], v87 offset:8192
    ds_read_b64_tr_b16 a[46:47], v87 offset:9216
    s_branch L_lw_6
L_lw_6_0:
    s_cmp_lg_u32 s44, 1
    s_cbranch_scc1 L_lw_6_1
    ds_read_b64_tr_b16 v[160:161], v84 offset:8192
    ds_read_b64_tr_b16 v[162:163], v84 offset:9216
    ds_read_b64_tr_b16 v[164:165], v86 offset:8192
    ds_read_b64_tr_b16 v[166:167], v86 offset:9216
    ds_read_b64_tr_b16 v[168:169], v85 offset:8192
    ds_read_b64_tr_b16 v[170:171], v85 offset:9216
    ds_read_b64_tr_b16 v[172:173], v87 offset:8192
    ds_read_b64_tr_b16 v[174:175], v87 offset:9216
    s_branch L_lw_6
L_lw_6_1:
    s_cmp_lg_u32 s44, 2
    s_cbranch_scc1 L_lw_6_2
    ds_read_b64_tr_b16 a[216:217], v84 offset:8192
    ds_read_b64_tr_b16 a[218:219], v84 offset:9216
    ds_read_b64_tr_b16 a[220:221], v86 offset:8192
    ds_read_b64_tr_b16 a[222:223], v86 offset:9216
    ds_read_b64_tr_b16 v[56:57], v85 offset:8192
    ds_read_b64_tr_b16 v[58:59], v85 offset:9216
    ds_read_b64_tr_b16 v[60:61], v87 offset:8192
    ds_read_b64_tr_b16 v[62:63], v87 offset:9216
    s_waitcnt lgkmcnt(0)
    ds_write_b128 v5, v[56:59] offset:4096
    ds_write_b128 v5, v[60:63] offset:5120
    s_branch L_lw_6
L_lw_6_2:
    ds_read_b64_tr_b16 a[120:121], v84 offset:8192
    ds_read_b64_tr_b16 a[122:123], v84 offset:9216
    ds_read_b64_tr_b16 a[124:125], v86 offset:8192
    ds_read_b64_tr_b16 a[126:127], v86 offset:9216
    ds_read_b64_tr_b16 v[56:57], v85 offset:8192
    ds_read_b64_tr_b16 v[58:59], v85 offset:9216
    ds_read_b64_tr_b16 v[60:61], v87 offset:8192
    ds_read_b64_tr_b16 v[62:63], v87 offset:9216
    s_waitcnt lgkmcnt(0)
    ds_write_b128 v5, v[56:59] offset:6144
    ds_write_b128 v5, v[60:63] offset:7168
L_lw_6:
    s_waitcnt lgkmcnt(0)
    s_waitcnt vmcnt(20)
    s_barrier
    s_cmp_lg_u32 s44, 0
    s_cbranch_scc1 L_lw_7_0
    ds_read_b64_tr_b16 a[64:65], v84 offset:16384
    ds_read_b64_tr_b16 a[66:67], v84 offset:17408
    ds_read_b64_tr_b16 a[68:69], v86 offset:16384
    ds_read_b64_tr_b16 a[70:71], v86 offset:17408
    ds_read_b64_tr_b16 v[56:57], v85 offset:16384
    ds_read_b64_tr_b16 v[58:59], v85 offset:17408
    ds_read_b64_tr_b16 v[60:61], v87 offset:16384
    ds_read_b64_tr_b16 v[62:63], v87 offset:17408
    s_waitcnt lgkmcnt(0)
    ds_write_b128 v5, v[56:59] offset:8192
    ds_write_b128 v5, v[60:63] offset:9216
    s_branch L_lw_7
L_lw_7_0:
    s_cmp_lg_u32 s44, 1
    s_cbranch_scc1 L_lw_7_1
    ds_read_b64_tr_b16 v[192:193], v84 offset:16384
    ds_read_b64_tr_b16 v[194:195], v84 offset:17408
    ds_read_b64_tr_b16 v[196:197], v86 offset:16384
    ds_read_b64_tr_b16 v[198:199], v86 offset:17408
    ds_read_b64_tr_b16 v[200:201], v85 offset:16384
    ds_read_b64_tr_b16 v[202:203], v85 offset:17408
    ds_read_b64_tr_b16 v[204:205], v87 offset:16384
    ds_read_b64_tr_b16 v[206:207], v87 offset:17408
    s_branch L_lw_7
L_lw_7_1:
    s_cmp_lg_u32 s44, 2
    s_cbranch_scc1 L_lw_7_2
    ds_read_b64_tr_b16 a[240:241], v84 offset:16384
    ds_read_b64_tr_b16 a[242:243], v84 offset:17408
    ds_read_b64_tr_b16 a[244:245], v86 offset:16384
    ds_read_b64_tr_b16 a[246:247], v86 offset:17408
    ds_read_b64_tr_b16 v[56:57], v85 offset:16384
    ds_read_b64_tr_b16 v[58:59], v85 offset:17408
    ds_read_b64_tr_b16 v[60:61], v87 offset:16384
    ds_read_b64_tr_b16 v[62:63], v87 offset:17408
    s_waitcnt lgkmcnt(0)
    ds_write_b128 v5, v[56:59] offset:10240
    ds_write_b128 v5, v[60:63] offset:11264
    s_branch L_lw_7
L_lw_7_2:
    ds_read_b64_tr_b16 a[144:145], v84 offset:16384
    ds_read_b64_tr_b16 a[146:147], v84 offset:17408
    ds_read_b64_tr_b16 a[148:149], v86 offset:16384
    ds_read_b64_tr_b16 a[150:151], v86 offset:17408
    ds_read_b64_tr_b16 v[56:57], v85 offset:16384
    ds_read_b64_tr_b16 v[58:59], v85 offset:17408
    ds_read_b64_tr_b16 v[60:61], v87 offset:16384
    ds_read_b64_tr_b16 v[62:63], v87 offset:17408
    s_waitcnt lgkmcnt(0)
    ds_write_b128 v5, v[56:59] offset:12288
    ds_write_b128 v5, v[60:63] offset:13312
L_lw_7:
    s_waitcnt lgkmcnt(0)
    s_waitcnt vmcnt(16)
    s_barrier
    s_cmp_lg_u32 s44, 0
    s_cbranch_scc1 L_lw_8_0
    ds_read_b64_tr_b16 a[80:81], v84 offset:20480
    ds_read_b64_tr_b16 a[82:83], v84 offset:21504
    ds_read_b64_tr_b16 a[84:85], v86 offset:20480
    ds_read_b64_tr_b16 a[86:87], v86 offset:21504
    ds_read_b64_tr_b16 v[56:57], v85 offset:20480
    ds_read_b64_tr_b16 v[58:59], v85 offset:21504
    ds_read_b64_tr_b16 v[60:61], v87 offset:20480
    ds_read_b64_tr_b16 v[62:63], v87 offset:21504
    s_waitcnt lgkmcnt(0)
    ds_write_b128 v5, v[56:59] offset:14336
    ds_write_b128 v5, v[60:63] offset:15360
    s_branch L_lw_8
L_lw_8_0:
    s_cmp_lg_u32 s44, 1
    s_cbranch_scc1 L_lw_8_1
    ds_read_b64_tr_b16 v[224:225], v84 offset:20480
    ds_read_b64_tr_b16 v[226:227], v84 offset:21504
    ds_read_b64_tr_b16 v[228:229], v86 offset:20480
    ds_read_b64_tr_b16 v[230:231], v86 offset:21504
    ds_read_b64_tr_b16 v[232:233], v85 offset:20480
    ds_read_b64_tr_b16 v[234:235], v85 offset:21504
    ds_read_b64_tr_b16 v[236:237], v87 offset:20480
    ds_read_b64_tr_b16 v[238:239], v87 offset:21504
    s_branch L_lw_8
L_lw_8_1:
    s_cmp_lg_u32 s44, 2
    s_cbranch_scc1 L_lw_8_2
    ds_read_b64_tr_b16 v[104:105], v84 offset:20480
    ds_read_b64_tr_b16 v[106:107], v84 offset:21504
    ds_read_b64_tr_b16 v[108:109], v86 offset:20480
    ds_read_b64_tr_b16 v[110:111], v86 offset:21504
    ds_read_b64_tr_b16 v[56:57], v85 offset:20480
    ds_read_b64_tr_b16 v[58:59], v85 offset:21504
    ds_read_b64_tr_b16 v[60:61], v87 offset:20480
    ds_read_b64_tr_b16 v[62:63], v87 offset:21504
    s_waitcnt lgkmcnt(0)
    ds_write_b128 v5, v[56:59] offset:16384
    ds_write_b128 v5, v[60:63] offset:17408
    s_branch L_lw_8
L_lw_8_2:
    ds_read_b64_tr_b16 a[168:169], v84 offset:20480
    ds_read_b64_tr_b16 a[170:171], v84 offset:21504
    ds_read_b64_tr_b16 a[172:173], v86 offset:20480
    ds_read_b64_tr_b16 a[174:175], v86 offset:21504
    ds_read_b64_tr_b16 v[56:57], v85 offset:20480
    ds_read_b64_tr_b16 v[58:59], v85 offset:21504
    ds_read_b64_tr_b16 v[60:61], v87 offset:20480
    ds_read_b64_tr_b16 v[62:63], v87 offset:21504
    s_waitcnt lgkmcnt(0)
    ds_write_b128 v5, v[56:59] offset:18432
    ds_write_b128 v5, v[60:63] offset:19456
L_lw_8:
    s_waitcnt lgkmcnt(0)
    s_waitcnt vmcnt(12)
    s_barrier
    s_add_u32 s79, s41, 8
    s_and_b32 s79, s79, 3
    s_lshl_b32 s79, s79, 19
    s_add_u32 s79, s79, s47
    s_add_u32 s46, s79, 0x400000
    s_add_u32 m0, s48, 86016
    s_nop 0
    buffer_load_dwordx4 v82, s[24:27], s46 offen  lds
    s_add_u32 s46, s79, 0x420000
    s_add_u32 m0, s48, 110592
    s_nop 0
    buffer_load_dwordx4 v82, s[24:27], s46 offen  lds
    s_add_u32 s46, s79, 0x440000
    s_add_u32 m0, s48, 135168
    s_nop 0
    buffer_load_dwordx4 v82, s[24:27], s46 offen  lds
    s_add_u32 s46, s79, 0x460000
    s_add_u32 m0, s48, 159744
    s_nop 0
    buffer_load_dwordx4 v82, s[24:27], s46 offen  lds
    s_cmp_lg_u32 s44, 0
    s_cbranch_scc1 L_lw_9_0
    ds_read_b64_tr_b16 a[96:97], v80 offset:0
    ds_read_b64_tr_b16 a[98:99], v80 offset:1024
    ds_read_b64_tr_b16 a[100:101], v80 offset:8192
    ds_read_b64_tr_b16 a[102:103], v80 offset:9216
    ds_read_b64_tr_b16 v[56:57], v81 offset:0
    ds_read_b64_tr_b16 v[58:59], v81 offset:1024
    ds_read_b64_tr_b16 v[60:61], v81 offset:8192
    ds_read_b64_tr_b16 v[62:63], v81 offset:9216
    s_waitcnt lgkmcnt(0)
    ds_write_b128 v5, v[56:59] offset:2048
    ds_write_b128 v5, v[60:63] offset:3072
    s_branch L_lw_9
L_lw_9_0:
    s_cmp_lg_u32 s44, 1
    s_cbranch_scc1 L_lw_9_1
    ds_read_b64_tr_b16 a[0:1], v80 offset:0
    ds_read_b64_tr_b16 a[2:3], v80 offset:1024
    ds_read_b64_tr_b16 a[4:5], v80 offset:8192
    ds_read_b64_tr_b16 a[6:7], v80 offset:9216
    ds_read_b64_tr_b16 a[8:9], v81 offset:0
    ds_read_b64_tr_b16 a[10:11], v81 offset:1024
    ds_read_b64_tr_b16 a[12:13], v81 offset:8192
    ds_read_b64_tr_b16 a[14:15], v81 offset:9216
    s_branch L_lw_9
L_lw_9_1:
    s_cmp_lg_u32 s44, 2
    s_cbranch_scc1 L_lw_9_2
    ds_read_b64_tr_b16 v[128:129], v80 offset:0
    ds_read_b64_tr_b16 v[130:131], v80 offset:1024
    ds_read_b64_tr_b16 v[132:133], v80 offset:8192
    ds_read_b64_tr_b16 v[134:135], v80 offset:9216
    ds_read_b64_tr_b16 v[136:137], v81 offset:0
    ds_read_b64_tr_b16 v[138:139], v81 offset:1024
    ds_read_b64_tr_b16 v[140:141], v81 offset:8192
    ds_read_b64_tr_b16 v[142:143], v81 offset:9216
    s_branch L_lw_9
L_lw_9_2:
    ds_read_b64_tr_b16 a[192:193], v80 offset:0
    ds_read_b64_tr_b16 a[194:195], v80 offset:1024
    ds_read_b64_tr_b16 a[196:197], v80 offset:8192
    ds_read_b64_tr_b16 a[198:199], v80 offset:9216
    ds_read_b64_tr_b16 v[56:57], v81 offset:0
    ds_read_b64_tr_b16 v[58:59], v81 offset:1024
    ds_read_b64_tr_b16 v[60:61], v81 offset:8192
    ds_read_b64_tr_b16 v[62:63], v81 offset:9216
    s_waitcnt lgkmcnt(0)
    ds_write_b128 v5, v[56:59] offset:0
    ds_write_b128 v5, v[60:63] offset:1024
L_lw_9:
    s_waitcnt lgkmcnt(0)
    s_waitcnt vmcnt(12)
    s_barrier
    s_add_u32 s79, s41, 9
    s_and_b32 s79, s79, 3
    s_lshl_b32 s79, s79, 19
    s_add_u32 s79, s79, s47
    s_add_u32 s46, s79, 0x400000
    s_add_u32 m0, s48, 0
    s_nop 0
    buffer_load_dwordx4 v82, s[24:27], s46 offen  lds
    s_add_u32 s46, s79, 0x420000
    s_add_u32 m0, s48, 4096
    s_nop 0
    buffer_load_dwordx4 v82, s[24:27], s46 offen  lds
    s_add_u32 s46, s79, 0x440000
    s_add_u32 m0, s48, 8192
    s_nop 0
    buffer_load_dwordx4 v82, s[24:27], s46 offen  lds
    s_add_u32 s46, s79, 0x460000
    s_add_u32 m0, s48, 12288
    s_nop 0
    buffer_load_dwordx4 v82, s[24:27], s46 offen  lds
    s_cmp_lg_u32 s44, 0
    s_cbranch_scc1 L_lw_10_0
    ds_read_b64_tr_b16 a[120:121], v80 offset:16384
    ds_read_b64_tr_b16 a[122:123], v80 offset:17408
    ds_read_b64_tr_b16 a[124:125], v80 offset:24576
    ds_read_b64_tr_b16 a[126:127], v80 offset:25600
    ds_read_b64_tr_b16 v[56:57], v81 offset:16384
    ds_read_b64_tr_b16 v[58:59], v81 offset:17408
    ds_read_b64_tr_b16 v[60:61], v81 offset:24576
    ds_read_b64_tr_b16 v[62:63], v81 offset:25600
    s_waitcnt lgkmcnt(0)
    ds_write_b128 v5, v[56:59] offset:6144
    ds_write_b128 v5, v[60:63] offset:7168
    s_branch L_lw_10
L_lw_10_0:
    s_cmp_lg_u32 s44, 1
    s_cbranch_scc1 L_lw_10_1
    ds_read_b64_tr_b16 a[32:33], v80 offset:16384
    ds_read_b64_tr_b16 a[34:35], v80 offset:17408
    ds_read_b64_tr_b16 a[36:37], v80 offset:24576
    ds_read_b64_tr_b16 a[38:39], v80 offset:25600
    ds_read_b64_tr_b16 a[40:41], v81 offset:16384
    ds_read_b64_tr_b16 a[42:43], v81 offset:17408
    ds_read_b64_tr_b16 a[44:45], v81 offset:24576
    ds_read_b64_tr_b16 a[46:47], v81 offset:25600
    s_branch L_lw_10
L_lw_10_1:
    s_cmp_lg_u32 s44, 2
    s_cbranch_scc1 L_lw_10_2
    ds_read_b64_tr_b16 v[160:161], v80 offset:16384
    ds_read_b64_tr_b16 v[162:163], v80 offset:17408
    ds_read_b64_tr_b16 v[164:165], v80 offset:24576
    ds_read_b64_tr_b16 v[166:167], v80 offset:25600
    ds_read_b64_tr_b16 v[168:169], v81 offset:16384
    ds_read_b64_tr_b16 v[170:171], v81 offset:17408
    ds_read_b64_tr_b16 v[172:173], v81 offset:24576
    ds_read_b64_tr_b16 v[174:175], v81 offset:25600
    s_branch L_lw_10
L_lw_10_2:
    ds_read_b64_tr_b16 a[216:217], v80 offset:16384
    ds_read_b64_tr_b16 a[218:219], v80 offset:17408
    ds_read_b64_tr_b16 a[220:221], v80 offset:24576
    ds_read_b64_tr_b16 a[222:223], v80 offset:25600
    ds_read_b64_tr_b16 v[56:57], v81 offset:16384
    ds_read_b64_tr_b16 v[58:59], v81 offset:17408
    ds_read_b64_tr_b16 v[60:61], v81 offset:24576
    ds_read_b64_tr_b16 v[62:63], v81 offset:25600
    s_waitcnt lgkmcnt(0)
    ds_write_b128 v5, v[56:59] offset:4096
    ds_write_b128 v5, v[60:63] offset:5120
L_lw_10:
    s_waitcnt lgkmcnt(0)
    s_waitcnt vmcnt(12)
    s_barrier
    s_add_u32 s79, s41, 10
    s_and_b32 s79, s79, 3
    s_lshl_b32 s79, s79, 19
    s_add_u32 s79, s79, s47
    s_add_u32 s46, s79, 0x400000
    s_add_u32 m0, s48, 16384
    s_nop 0
    buffer_load_dwordx4 v82, s[24:27], s46 offen  lds
    s_add_u32 s46, s79, 0x420000
    s_add_u32 m0, s48, 20480
    s_nop 0
    buffer_load_dwordx4 v82, s[24:27], s46 offen  lds
    s_add_u32 s46, s79, 0x440000
    s_add_u32 m0, s48, 24576
    s_nop 0
    buffer_load_dwordx4 v82, s[24:27], s46 offen  lds
    s_add_u32 s46, s79, 0x460000
    s_add_u32 m0, s48, 28672
    s_nop 0
    buffer_load_dwordx4 v82, s[24:27], s46 offen  lds
    s_cmp_lg_u32 s44, 0
    s_cbranch_scc1 L_lw_11_0
    ds_read_b64_tr_b16 a[144:145], v80 offset:32768
    ds_read_b64_tr_b16 a[146:147], v80 offset:33792
    ds_read_b64_tr_b16 a[148:149], v80 offset:40960
    ds_read_b64_tr_b16 a[150:151], v80 offset:41984
    ds_read_b64_tr_b16 v[56:57], v81 offset:32768
    ds_read_b64_tr_b16 v[58:59], v81 offset:33792
    ds_read_b64_tr_b16 v[60:61], v81 offset:40960
    ds_read_b64_tr_b16 v[62:63], v81 offset:41984
    s_waitcnt lgkmcnt(0)
    ds_write_b128 v5, v[56:59] offset:12288
    ds_write_b128 v5, v[60:63] offset:13312
    s_branch L_lw_11
L_lw_11_0:
    s_cmp_lg_u32 s44, 1
    s_cbranch_scc1 L_lw_11_1
    ds_read_b64_tr_b16 a[64:65], v80 offset:32768
    ds_read_b64_tr_b16 a[66:67], v80 offset:33792
    ds_read_b64_tr_b16 a[68:69], v80 offset:40960
    ds_read_b64_tr_b16 a[70:71], v80 offset:41984
    ds_read_b64_tr_b16 v[56:57], v81 offset:32768
    ds_read_b64_tr_b16 v[58:59], v81 offset:33792
    ds_read_b64_tr_b16 v[60:61], v81 offset:40960
    ds_read_b64_tr_b16 v[62:63], v81 offset:41984
    s_waitcnt lgkmcnt(0)
    ds_write_b128 v5, v[56:59] offset:8192
    ds_write_b128 v5, v[60:63] offset:9216
    s_branch L_lw_11
L_lw_11_1:
    s_cmp_lg_u32 s44, 2
    s_cbranch_scc1 L_lw_11_2
    ds_read_b64_tr_b16 v[192:193], v80 offset:32768
    ds_read_b64_tr_b16 v[194:195], v80 offset:33792
    ds_read_b64_tr_b16 v[196:197], v80 offset:40960
    ds_read_b64_tr_b16 v[198:199], v80 offset:41984
    ds_read_b64_tr_b16 v[200:201], v81 offset:32768
    ds_read_b64_tr_b16 v[202:203], v81 offset:33792
    ds_read_b64_tr_b16 v[204:205], v81 offset:40960
    ds_read_b64_tr_b16 v[206:207], v81 offset:41984
    s_branch L_lw_11
L_lw_11_2:
    ds_read_b64_tr_b16 a[240:241], v80 offset:32768
    ds_read_b64_tr_b16 a[242:243], v80 offset:33792
    ds_read_b64_tr_b16 a[244:245], v80 offset:40960
    ds_read_b64_tr_b16 a[246:247], v80 offset:41984
    ds_read_b64_tr_b16 v[56:57], v81 offset:32768
    ds_read_b64_tr_b16 v[58:59], v81 offset:33792
    ds_read_b64_tr_b16 v[60:61], v81 offset:40960
    ds_read_b64_tr_b16 v[62:63], v81 offset:41984
    s_waitcnt lgkmcnt(0)
    ds_write_b128 v5, v[56:59] offset:10240
    ds_write_b128 v5, v[60:63] offset:11264
L_lw_11:
    s_waitcnt lgkmcnt(0)
    s_waitcnt vmcnt(12)
    s_barrier
    s_add_u32 s79, s41, 11
    s_and_b32 s79, s79, 3
    s_lshl_b32 s79, s79, 19
    s_add_u32 s79, s79, s47
    s_add_u32 s46, s79, 0x400000
    s_add_u32 m0, s48, 32768
    s_nop 0
    buffer_load_dwordx4 v82, s[24:27], s46 offen  lds
    s_add_u32 s46, s79, 0x420000
    s_add_u32 m0, s48, 36864
    s_nop 0
    buffer_load_dwordx4 v82, s[24:27], s46 offen  lds
    s_add_u32 s46, s79, 0x440000
    s_add_u32 m0, s48, 40960
    s_nop 0
    buffer_load_dwordx4 v82, s[24:27], s46 offen  lds
    s_add_u32 s46, s79, 0x460000
    s_add_u32 m0, s48, 45056
    s_nop 0
    buffer_load_dwordx4 v82, s[24:27], s46 offen  lds
    s_cmp_lg_u32 s44, 0
    s_cbranch_scc1 L_lw_12_0
    ds_read_b64_tr_b16 a[168:169], v80 offset:49152
    ds_read_b64_tr_b16 a[170:171], v80 offset:50176
    ds_read_b64_tr_b16 a[172:173], v80 offset:57344
    ds_read_b64_tr_b16 a[174:175], v80 offset:58368
    ds_read_b64_tr_b16 v[56:57], v81 offset:49152
    ds_read_b64_tr_b16 v[58:59], v81 offset:50176
    ds_read_b64_tr_b16 v[60:61], v81 offset:57344
    ds_read_b64_tr_b16 v[62:63], v81 offset:58368
    s_waitcnt lgkmcnt(0)
    ds_write_b128 v5, v[56:59] offset:18432
    ds_write_b128 v5, v[60:63] offset:19456
    s_branch L_lw_12
L_lw_12_0:
    s_cmp_lg_u32 s44, 1
    s_cbranch_scc1 L_lw_12_1
    ds_read_b64_tr_b16 a[80:81], v80 offset:49152
    ds_read_b64_tr_b16 a[82:83], v80 offset:50176
    ds_read_b64_tr_b16 a[84:85], v80 offset:57344
    ds_read_b64_tr_b16 a[86:87], v80 offset:58368
    ds_read_b64_tr_b16 v[56:57], v81 offset:49152
    ds_read_b64_tr_b16 v[58:59], v81 offset:50176
    ds_read_b64_tr_b16 v[60:61], v81 offset:57344
    ds_read_b64_tr_b16 v[62:63], v81 offset:58368
    s_waitcnt lgkmcnt(0)
    ds_write_b128 v5, v[56:59] offset:14336
    ds_write_b128 v5, v[60:63] offset:15360
    s_branch L_lw_12
L_lw_12_1:
    s_cmp_lg_u32 s44, 2
    s_cbranch_scc1 L_lw_12_2
    ds_read_b64_tr_b16 v[224:225], v80 offset:49152
    ds_read_b64_tr_b16 v[226:227], v80 offset:50176
    ds_read_b64_tr_b16 v[228:229], v80 offset:57344
    ds_read_b64_tr_b16 v[230:231], v80 offset:58368
    ds_read_b64_tr_b16 v[232:233], v81 offset:49152
    ds_read_b64_tr_b16 v[234:235], v81 offset:50176
    ds_read_b64_tr_b16 v[236:237], v81 offset:57344
    ds_read_b64_tr_b16 v[238:239], v81 offset:58368
    s_branch L_lw_12
L_lw_12_2:
    ds_read_b64_tr_b16 v[104:105], v80 offset:49152
    ds_read_b64_tr_b16 v[106:107], v80 offset:50176
    ds_read_b64_tr_b16 v[108:109], v80 offset:57344
    ds_read_b64_tr_b16 v[110:111], v80 offset:58368
    ds_read_b64_tr_b16 v[56:57], v81 offset:49152
    ds_read_b64_tr_b16 v[58:59], v81 offset:50176
    ds_read_b64_tr_b16 v[60:61], v81 offset:57344
    ds_read_b64_tr_b16 v[62:63], v81 offset:58368
    s_waitcnt lgkmcnt(0)
    ds_write_b128 v5, v[56:59] offset:16384
    ds_write_b128 v5, v[60:63] offset:17408
L_lw_12:
    s_waitcnt lgkmcnt(0)
    s_waitcnt vmcnt(12)
    s_barrier
    s_add_u32 s79, s41, 12
    s_and_b32 s79, s79, 3
    s_lshl_b32 s79, s79, 19
    s_add_u32 s79, s79, s47
    s_add_u32 s46, s79, 0x600000
    s_add_u32 m0, s48, 49152
    s_nop 0
    buffer_load_dwordx4 v82, s[24:27], s46 offen  lds
    s_add_u32 s46, s79, 0x620000
    s_add_u32 m0, s48, 53248
    s_nop 0
    buffer_load_dwordx4 v82, s[24:27], s46 offen  lds
    s_add_u32 s46, s79, 0x640000
    s_add_u32 m0, s48, 57344
    s_nop 0
    buffer_load_dwordx4 v82, s[24:27], s46 offen  lds
    s_add_u32 s46, s79, 0x660000
    s_add_u32 m0, s48, 61440
    s_nop 0
    buffer_load_dwordx4 v82, s[24:27], s46 offen  lds
    s_cmp_lg_u32 s44, 0
    s_cbranch_scc1 L_lw_13_0
    ds_read_b64_tr_b16 a[192:193], v84 offset:20480
    ds_read_b64_tr_b16 a[194:195], v84 offset:21504
    ds_read_b64_tr_b16 a[196:197], v86 offset:20480
    ds_read_b64_tr_b16 a[198:199], v86 offset:21504
    ds_read_b64_tr_b16 v[56:57], v85 offset:20480
    ds_read_b64_tr_b16 v[58:59], v85 offset:21504
    ds_read_b64_tr_b16 v[60:61], v87 offset:20480
    ds_read_b64_tr_b16 v[62:63], v87 offset:21504
    s_waitcnt lgkmcnt(0)
    ds_write_b128 v5, v[56:59] offset:0
    ds_write_b128 v5, v[60:63] offset:1024
    s_branch L_lw_13
L_lw_13_0:
    s_cmp_lg_u32 s44, 1
    s_cbranch_scc1 L_lw_13_1
    ds_read_b64_tr_b16 a[96:97], v84 offset:20480
    ds_read_b64_tr_b16 a[98:99], v84 offset:21504
    ds_read_b64_tr_b16 a[100:101], v86 offset:20480
    ds_read_b64_tr_b16 a[102:103], v86 offset:21504
    ds_read_b64_tr_b16 v[56:57], v85 offset:20480
    ds_read_b64_tr_b16 v[58:59], v85 offset:21504
    ds_read_b64_tr_b16 v[60:61], v87 offset:20480
    ds_read_b64_tr_b16 v[62:63], v87 offset:21504
    s_waitcnt lgkmcnt(0)
    ds_write_b128 v5, v[56:59] offset:2048
    ds_write_b128 v5, v[60:63] offset:3072
    s_branch L_lw_13
L_lw_13_1:
    s_cmp_lg_u32 s44, 2
    s_cbranch_scc1 L_lw_13_2
    ds_read_b64_tr_b16 a[0:1], v84 offset:20480
    ds_read_b64_tr_b16 a[2:3], v84 offset:21504
    ds_read_b64_tr_b16 a[4:5], v86 offset:20480
    ds_read_b64_tr_b16 a[6:7], v86 offset:21504
    ds_read_b64_tr_b16 a[8:9], v85 offset:20480
    ds_read_b64_tr_b16 a[10:11], v85 offset:21504
    ds_read_b64_tr_b16 a[12:13], v87 offset:20480
    ds_read_b64_tr_b16 a[14:15], v87 offset:21504
    s_branch L_lw_13
L_lw_13_2:
    ds_read_b64_tr_b16 v[128:129], v84 offset:20480
    ds_read_b64_tr_b16 v[130:131], v84 offset:21504
    ds_read_b64_tr_b16 v[132:133], v86 offset:20480
    ds_read_b64_tr_b16 v[134:135], v86 offset:21504
    ds_read_b64_tr_b16 v[136:137], v85 offset:20480
    ds_read_b64_tr_b16 v[138:139], v85 offset:21504
    ds_read_b64_tr_b16 v[140:141], v87 offset:20480
    ds_read_b64_tr_b16 v[142:143], v87 offset:21504
L_lw_13:
    s_waitcnt lgkmcnt(0)
    s_waitcnt vmcnt(12)
    s_barrier
    s_add_u32 s79, s41, 13
    s_and_b32 s79, s79, 3
    s_lshl_b32 s79, s79, 19
    s_add_u32 s79, s79, s47
    s_add_u32 s46, s79, 0x600000
    s_add_u32 m0, s48, 86016
    s_nop 0
    buffer_load_dwordx4 v82, s[24:27], s46 offen  lds
    s_add_u32 s46, s79, 0x620000
    s_add_u32 m0, s48, 110592
    s_nop 0
    buffer_load_dwordx4 v82, s[24:27], s46 offen  lds
    s_add_u32 s46, s79, 0x640000
    s_add_u32 m0, s48, 135168
    s_nop 0
    buffer_load_dwordx4 v82, s[24:27], s46 offen  lds
    s_add_u32 s46, s79, 0x660000
    s_add_u32 m0, s48, 159744
    s_nop 0
    buffer_load_dwordx4 v82, s[24:27], s46 offen  lds
    s_cmp_lg_u32 s44, 0
    s_cbranch_scc1 L_lw_14_0
    ds_read_b64_tr_b16 a[216:217], v80 offset:0
    ds_read_b64_tr_b16 a[218:219], v80 offset:1024
    ds_read_b64_tr_b16 a[220:221], v80 offset:8192
    ds_read_b64_tr_b16 a[222:223], v80 offset:9216
    ds_read_b64_tr_b16 v[56:57], v81 offset:0
    ds_read_b64_tr_b16 v[58:59], v81 offset:1024
    ds_read_b64_tr_b16 v[60:61], v81 offset:8192
    ds_read_b64_tr_b16 v[62:63], v81 offset:9216
    s_waitcnt lgkmcnt(0)
    ds_write_b128 v5, v[56:59] offset:4096
    ds_write_b128 v5, v[60:63] offset:5120
    s_branch L_lw_14
L_lw_14_0:
    s_cmp_lg_u32 s44, 1
    s_cbranch_scc1 L_lw_14_1
    ds_read_b64_tr_b16 a[120:121], v80 offset:0
    ds_read_b64_tr_b16 a[122:123], v80 offset:1024
    ds_read_b64_tr_b16 a[124:125], v80 offset:8192
    ds_read_b64_tr_b16 a[126:127], v80 offset:9216
    ds_read_b64_tr_b16 v[56:57], v81 offset:0
    ds_read_b64_tr_b16 v[58:59], v81 offset:1024
    ds_read_b64_tr_b16 v[60:61], v81 offset:8192
    ds_read_b64_tr_b16 v[62:63], v81 offset:9216
    s_waitcnt lgkmcnt(0)
    ds_write_b128 v5, v[56:59] offset:6144
    ds_write_b128 v5, v[60:63] offset:7168
    s_branch L_lw_14
L_lw_14_1:
    s_cmp_lg_u32 s44, 2
    s_cbranch_scc1 L_lw_14_2
    ds_read_b64_tr_b16 a[32:33], v80 offset:0
    ds_read_b64_tr_b16 a[34:35], v80 offset:1024
    ds_read_b64_tr_b16 a[36:37], v80 offset:8192
    ds_read_b64_tr_b16 a[38:39], v80 offset:9216
    ds_read_b64_tr_b16 a[40:41], v81 offset:0
    ds_read_b64_tr_b16 a[42:43], v81 offset:1024
    ds_read_b64_tr_b16 a[44:45], v81 offset:8192
    ds_read_b64_tr_b16 a[46:47], v81 offset:9216
    s_branch L_lw_14
L_lw_14_2:
    ds_read_b64_tr_b16 v[160:161], v80 offset:0
    ds_read_b64_tr_b16 v[162:163], v80 offset:1024
    ds_read_b64_tr_b16 v[164:165], v80 offset:8192
    ds_read_b64_tr_b16 v[166:167], v80 offset:9216
    ds_read_b64_tr_b16 v[168:169], v81 offset:0
    ds_read_b64_tr_b16 v[170:171], v81 offset:1024
    ds_read_b64_tr_b16 v[172:173], v81 offset:8192
    ds_read_b64_tr_b16 v[174:175], v81 offset:9216
L_lw_14:
    s_waitcnt lgkmcnt(0)
    s_waitcnt vmcnt(12)
    s_barrier
    s_add_u32 s79, s41, 14
    s_and_b32 s79, s79, 3
    s_lshl_b32 s79, s79, 19
    s_add_u32 s79, s79, s47
    s_add_u32 s46, s79, 0x600000
    s_add_u32 m0, s48, 0
    s_nop 0
    buffer_load_dwordx4 v82, s[24:27], s46 offen  lds
    s_add_u32 s46, s79, 0x620000
    s_add_u32 m0, s48, 4096
    s_nop 0
    buffer_load_dwordx4 v82, s[24:27], s46 offen  lds
    s_add_u32 s46, s79, 0x640000
    s_add_u32 m0, s48, 8192
    s_nop 0
    buffer_load_dwordx4 v82, s[24:27], s46 offen  lds
    s_add_u32 s46, s79, 0x660000
    s_add_u32 m0, s48, 12288
    s_nop 0
    buffer_load_dwordx4 v82, s[24:27], s46 offen  lds
    s_cmp_lg_u32 s44, 0
    s_cbranch_scc1 L_lw_15_0
    ds_read_b64_tr_b16 a[240:241], v80 offset:16384
    ds_read_b64_tr_b16 a[242:243], v80 offset:17408
    ds_read_b64_tr_b16 a[244:245], v80 offset:24576
    ds_read_b64_tr_b16 a[246:247], v80 offset:25600
    ds_read_b64_tr_b16 v[56:57], v81 offset:16384
    ds_read_b64_tr_b16 v[58:59], v81 offset:17408
    ds_read_b64_tr_b16 v[60:61], v81 offset:24576
    ds_read_b64_tr_b16 v[62:63], v81 offset:25600
    s_waitcnt lgkmcnt(0)
    ds_write_b128 v5, v[56:59] offset:10240
    ds_write_b128 v5, v[60:63] offset:11264
    s_branch L_lw_15
L_lw_15_0:
    s_cmp_lg_u32 s44, 1
    s_cbranch_scc1 L_lw_15_1
    ds_read_b64_tr_b16 a[144:145], v80 offset:16384
    ds_read_b64_tr_b16 a[146:147], v80 offset:17408
    ds_read_b64_tr_b16 a[148:149], v80 offset:24576
    ds_read_b64_tr_b16 a[150:151], v80 offset:25600
    ds_read_b64_tr_b16 v[56:57], v81 offset:16384
    ds_read_b64_tr_b16 v[58:59], v81 offset:17408
    ds_read_b64_tr_b16 v[60:61], v81 offset:24576
    ds_read_b64_tr_b16 v[62:63], v81 offset:25600
    s_waitcnt lgkmcnt(0)
    ds_write_b128 v5, v[56:59] offset:12288
    ds_write_b128 v5, v[60:63] offset:13312
    s_branch L_lw_15
L_lw_15_1:
    s_cmp_lg_u32 s44, 2
    s_cbranch_scc1 L_lw_15_2
    ds_read_b64_tr_b16 a[64:65], v80 offset:16384
    ds_read_b64_tr_b16 a[66:67], v80 offset:17408
    ds_read_b64_tr_b16 a[68:69], v80 offset:24576
    ds_read_b64_tr_b16 a[70:71], v80 offset:25600
    ds_read_b64_tr_b16 v[56:57], v81 offset:16384
    ds_read_b64_tr_b16 v[58:59], v81 offset:17408
    ds_read_b64_tr_b16 v[60:61], v81 offset:24576
    ds_read_b64_tr_b16 v[62:63], v81 offset:25600
    s_waitcnt lgkmcnt(0)
    ds_write_b128 v5, v[56:59] offset:8192
    ds_write_b128 v5, v[60:63] offset:9216
    s_branch L_lw_15
L_lw_15_2:
    ds_read_b64_tr_b16 v[192:193], v80 offset:16384
    ds_read_b64_tr_b16 v[194:195], v80 offset:17408
    ds_read_b64_tr_b16 v[196:197], v80 offset:24576
    ds_read_b64_tr_b16 v[198:199], v80 offset:25600
    ds_read_b64_tr_b16 v[200:201], v81 offset:16384
    ds_read_b64_tr_b16 v[202:203], v81 offset:17408
    ds_read_b64_tr_b16 v[204:205], v81 offset:24576
    ds_read_b64_tr_b16 v[206:207], v81 offset:25600
L_lw_15:
    s_waitcnt lgkmcnt(0)
    s_waitcnt vmcnt(12)
    s_barrier
    s_add_u32 s79, s41, 15
    s_and_b32 s79, s79, 3
    s_lshl_b32 s79, s79, 19
    s_add_u32 s79, s79, s47
    s_add_u32 s46, s79, 0x600000
    s_add_u32 m0, s48, 16384
    s_nop 0
    buffer_load_dwordx4 v82, s[24:27], s46 offen  lds
    s_add_u32 s46, s79, 0x620000
    s_add_u32 m0, s48, 20480
    s_nop 0
    buffer_load_dwordx4 v82, s[24:27], s46 offen  lds
    s_add_u32 s46, s79, 0x640000
    s_add_u32 m0, s48, 24576
    s_nop 0
    buffer_load_dwordx4 v82, s[24:27], s46 offen  lds
    s_add_u32 s46, s79, 0x660000
    s_add_u32 m0, s48, 28672
    s_nop 0
    buffer_load_dwordx4 v82, s[24:27], s46 offen  lds
    s_cmp_lg_u32 s44, 0
    s_cbranch_scc1 L_lw_16_0
    ds_read_b64_tr_b16 v[104:105], v80 offset:32768
    ds_read_b64_tr_b16 v[106:107], v80 offset:33792
    ds_read_b64_tr_b16 v[108:109], v80 offset:40960
    ds_read_b64_tr_b16 v[110:111], v80 offset:41984
    ds_read_b64_tr_b16 v[56:57], v81 offset:32768
    ds_read_b64_tr_b16 v[58:59], v81 offset:33792
    ds_read_b64_tr_b16 v[60:61], v81 offset:40960
    ds_read_b64_tr_b16 v[62:63], v81 offset:41984
    s_waitcnt lgkmcnt(0)
    ds_write_b128 v5, v[56:59] offset:16384
    ds_write_b128 v5, v[60:63] offset:17408
    s_branch L_lw_16
L_lw_16_0:
    s_cmp_lg_u32 s44, 1
    s_cbranch_scc1 L_lw_16_1
    ds_read_b64_tr_b16 a[168:169], v80 offset:32768
    ds_read_b64_tr_b16 a[170:171], v80 offset:33792
    ds_read_b64_tr_b16 a[172:173], v80 offset:40960
    ds_read_b64_tr_b16 a[174:175], v80 offset:41984
    ds_read_b64_tr_b16 v[56:57], v81 offset:32768
    ds_read_b64_tr_b16 v[58:59], v81 offset:33792
    ds_read_b64_tr_b16 v[60:61], v81 offset:40960
    ds_read_b64_tr_b16 v[62:63], v81 offset:41984
    s_waitcnt lgkmcnt(0)
    ds_write_b128 v5, v[56:59] offset:18432
    ds_write_b128 v5, v[60:63] offset:19456
    s_branch L_lw_16
L_lw_16_1:
    s_cmp_lg_u32 s44, 2
    s_cbranch_scc1 L_lw_16_2
    ds_read_b64_tr_b16 a[80:81], v80 offset:32768
    ds_read_b64_tr_b16 a[82:83], v80 offset:33792
    ds_read_b64_tr_b16 a[84:85], v80 offset:40960
    ds_read_b64_tr_b16 a[86:87], v80 offset:41984
    ds_read_b64_tr_b16 v[56:57], v81 offset:32768
    ds_read_b64_tr_b16 v[58:59], v81 offset:33792
    ds_read_b64_tr_b16 v[60:61], v81 offset:40960
    ds_read_b64_tr_b16 v[62:63], v81 offset:41984
    s_waitcnt lgkmcnt(0)
    ds_write_b128 v5, v[56:59] offset:14336
    ds_write_b128 v5, v[60:63] offset:15360
    s_branch L_lw_16
L_lw_16_2:
    ds_read_b64_tr_b16 v[224:225], v80 offset:32768
    ds_read_b64_tr_b16 v[226:227], v80 offset:33792
    ds_read_b64_tr_b16 v[228:229], v80 offset:40960
    ds_read_b64_tr_b16 v[230:231], v80 offset:41984
    ds_read_b64_tr_b16 v[232:233], v81 offset:32768
    ds_read_b64_tr_b16 v[234:235], v81 offset:33792
    ds_read_b64_tr_b16 v[236:237], v81 offset:40960
    ds_read_b64_tr_b16 v[238:239], v81 offset:41984
L_lw_16:
    s_waitcnt lgkmcnt(0)
    s_waitcnt vmcnt(12)
    s_barrier
    s_add_u32 s79, s41, 0
    s_and_b32 s79, s79, 3
    s_lshl_b32 s79, s79, 19
    s_add_u32 s79, s79, s47
    s_add_u32 s46, s79, 0x0
    s_add_u32 m0, s48, 32768
    s_nop 0
    buffer_load_dwordx4 v82, s[28:31], s46 offen  lds
    s_add_u32 s46, s79, 0x20000
    s_add_u32 m0, s48, 36864
    s_nop 0
    buffer_load_dwordx4 v82, s[28:31], s46 offen  lds
    s_add_u32 s46, s79, 0x40000
    s_add_u32 m0, s48, 40960
    s_nop 0
    buffer_load_dwordx4 v82, s[28:31], s46 offen  lds
    s_add_u32 s46, s79, 0x60000
    s_add_u32 m0, s48, 45056
    s_nop 0
    buffer_load_dwordx4 v82, s[28:31], s46 offen  lds
    s_cmp_lg_u32 s44, 0
    s_cbranch_scc1 L_lw_17_0
    ds_read_b64_tr_b16 v[128:129], v80 offset:49152
    ds_read_b64_tr_b16 v[130:131], v80 offset:50176
    ds_read_b64_tr_b16 v[132:133], v80 offset:57344
    ds_read_b64_tr_b16 v[134:135], v80 offset:58368
    ds_read_b64_tr_b16 v[136:137], v81 offset:49152
    ds_read_b64_tr_b16 v[138:139], v81 offset:50176
    ds_read_b64_tr_b16 v[140:141], v81 offset:57344
    ds_read_b64_tr_b16 v[142:143], v81 offset:58368
    s_branch L_lw_17
L_lw_17_0:
    s_cmp_lg_u32 s44, 1
    s_cbranch_scc1 L_lw_17_1
    ds_read_b64_tr_b16 a[192:193], v80 offset:49152
    ds_read_b64_tr_b16 a[194:195], v80 offset:50176
    ds_read_b64_tr_b16 a[196:197], v80 offset:57344
    ds_read_b64_tr_b16 a[198:199], v80 offset:58368
    ds_read_b64_tr_b16 v[56:57], v81 offset:49152
    ds_read_b64_tr_b16 v[58:59], v81 offset:50176
    ds_read_b64_tr_b16 v[60:61], v81 offset:57344
    ds_read_b64_tr_b16 v[62:63], v81 offset:58368
    s_waitcnt lgkmcnt(0)
    ds_write_b128 v5, v[56:59] offset:0
    ds_write_b128 v5, v[60:63] offset:1024
    s_branch L_lw_17
L_lw_17_1:
    s_cmp_lg_u32 s44, 2
    s_cbranch_scc1 L_lw_17_2
    ds_read_b64_tr_b16 a[96:97], v80 offset:49152
    ds_read_b64_tr_b16 a[98:99], v80 offset:50176
    ds_read_b64_tr_b16 a[100:101], v80 offset:57344
    ds_read_b64_tr_b16 a[102:103], v80 offset:58368
    ds_read_b64_tr_b16 v[56:57], v81 offset:49152
    ds_read_b64_tr_b16 v[58:59], v81 offset:50176
    ds_read_b64_tr_b16 v[60:61], v81 offset:57344
    ds_read_b64_tr_b16 v[62:63], v81 offset:58368
    s_waitcnt lgkmcnt(0)
    ds_write_b128 v5, v[56:59] offset:2048
    ds_write_b128 v5, v[60:63] offset:3072
    s_branch L_lw_17
L_lw_17_2:
    ds_read_b64_tr_b16 a[0:1], v80 offset:49152
    ds_read_b64_tr_b16 a[2:3], v80 offset:50176
    ds_read_b64_tr_b16 a[4:5], v80 offset:57344
    ds_read_b64_tr_b16 a[6:7], v80 offset:58368
    ds_read_b64_tr_b16 a[8:9], v81 offset:49152
    ds_read_b64_tr_b16 a[10:11], v81 offset:50176
    ds_read_b64_tr_b16 a[12:13], v81 offset:57344
    ds_read_b64_tr_b16 a[14:15], v81 offset:58368
L_lw_17:
    s_waitcnt lgkmcnt(0)
    s_waitcnt vmcnt(12)
    s_barrier
    s_add_u32 s79, s41, 1
    s_and_b32 s79, s79, 3
    s_lshl_b32 s79, s79, 19
    s_add_u32 s79, s79, s47
    s_add_u32 s46, s79, 0x0
    s_add_u32 m0, s48, 49152
    s_nop 0
    buffer_load_dwordx4 v82, s[28:31], s46 offen  lds
    s_add_u32 s46, s79, 0x20000
    s_add_u32 m0, s48, 53248
    s_nop 0
    buffer_load_dwordx4 v82, s[28:31], s46 offen  lds
    s_add_u32 s46, s79, 0x40000
    s_add_u32 m0, s48, 57344
    s_nop 0
    buffer_load_dwordx4 v82, s[28:31], s46 offen  lds
    s_add_u32 s46, s79, 0x60000
    s_add_u32 m0, s48, 61440
    s_nop 0
    buffer_load_dwordx4 v82, s[28:31], s46 offen  lds
    s_cmp_lg_u32 s44, 0
    s_cbranch_scc1 L_lw_18_0
    ds_read_b64_tr_b16 v[160:161], v84 offset:20480
    ds_read_b64_tr_b16 v[162:163], v84 offset:21504
    ds_read_b64_tr_b16 v[164:165], v86 offset:20480
    ds_read_b64_tr_b16 v[166:167], v86 offset:21504
    ds_read_b64_tr_b16 v[168:169], v85 offset:20480
    ds_read_b64_tr_b16 v[170:171], v85 offset:21504
    ds_read_b64_tr_b16 v[172:173], v87 offset:20480
    ds_read_b64_tr_b16 v[174:175], v87 offset:21504
    s_branch L_lw_18
L_lw_18_0:
    s_cmp_lg_u32 s44, 1
    s_cbranch_scc1 L_lw_18_1
    ds_read_b64_tr_b16 a[216:217], v84 offset:20480
    ds_read_b64_tr_b16 a[218:219], v84 offset:21504
    ds_read_b64_tr_b16 a[220:221], v86 offset:20480
    ds_read_b64_tr_b16 a[222:223], v86 offset:21504
    ds_read_b64_tr_b16 v[56:57], v85 offset:20480
    ds_read_b64_tr_b16 v[58:59], v85 offset:21504
    ds_read_b64_tr_b16 v[60:61], v87 offset:20480
    ds_read_b64_tr_b16 v[62:63], v87 offset:21504
    s_waitcnt lgkmcnt(0)
    ds_write_b128 v5, v[56:59] offset:4096
    ds_write_b128 v5, v[60:63] offset:5120
    s_branch L_lw_18
L_lw_18_1:
    s_cmp_lg_u32 s44, 2
    s_cbranch_scc1 L_lw_18_2
    ds_read_b64_tr_b16 a[120:121], v84 offset:20480
    ds_read_b64_tr_b16 a[122:123], v84 offset:21504
    ds_read_b64_tr_b16 a[124:125], v86 offset:20480
    ds_read_b64_tr_b16 a[126:127], v86 offset:21504
    ds_read_b64_tr_b16 v[56:57], v85 offset:20480
    ds_read_b64_tr_b16 v[58:59], v85 offset:21504
    ds_read_b64_tr_b16 v[60:61], v87 offset:20480
    ds_read_b64_tr_b16 v[62:63], v87 offset:21504
    s_waitcnt lgkmcnt(0)
    ds_write_b128 v5, v[56:59] offset:6144
    ds_write_b128 v5, v[60:63] offset:7168
    s_branch L_lw_18
L_lw_18_2:
    ds_read_b64_tr_b16 a[32:33], v84 offset:20480
    ds_read_b64_tr_b16 a[34:35], v84 offset:21504
    ds_read_b64_tr_b16 a[36:37], v86 offset:20480
    ds_read_b64_tr_b16 a[38:39], v86 offset:21504
    ds_read_b64_tr_b16 a[40:41], v85 offset:20480
    ds_read_b64_tr_b16 a[42:43], v85 offset:21504
    ds_read_b64_tr_b16 a[44:45], v87 offset:20480
    ds_read_b64_tr_b16 a[46:47], v87 offset:21504
L_lw_18:
    s_waitcnt lgkmcnt(0)
    s_waitcnt vmcnt(12)
    s_barrier
    s_cmp_lg_u32 s44, 0
    s_cbranch_scc1 L_lw_19_0
    ds_read_b64_tr_b16 v[192:193], v80 offset:0
    ds_read_b64_tr_b16 v[194:195], v80 offset:1024
    ds_read_b64_tr_b16 v[196:197], v80 offset:8192
    ds_read_b64_tr_b16 v[198:199], v80 offset:9216
    ds_read_b64_tr_b16 v[200:201], v81 offset:0
    ds_read_b64_tr_b16 v[202:203], v81 offset:1024
    ds_read_b64_tr_b16 v[204:205], v81 offset:8192
    ds_read_b64_tr_b16 v[206:207], v81 offset:9216
    s_branch L_lw_19
L_lw_19_0:
    s_cmp_lg_u32 s44, 1
    s_cbranch_scc1 L_lw_19_1
    ds_read_b64_tr_b16 a[240:241], v80 offset:0
    ds_read_b64_tr_b16 a[242:243], v80 offset:1024
    ds_read_b64_tr_b16 a[244:245], v80 offset:8192
    ds_read_b64_tr_b16 a[246:247], v80 offset:9216
    ds_read_b64_tr_b16 v[56:57], v81 offset:0
    ds_read_b64_tr_b16 v[58:59], v81 offset:1024
    ds_read_b64_tr_b16 v[60:61], v81 offset:8192
    ds_read_b64_tr_b16 v[62:63], v81 offset:9216
    s_waitcnt lgkmcnt(0)
    ds_write_b128 v5, v[56:59] offset:10240
    ds_write_b128 v5, v[60:63] offset:11264
    s_branch L_lw_19
L_lw_19_1:
    s_cmp_lg_u32 s44, 2
    s_cbranch_scc1 L_lw_19_2
    ds_read_b64_tr_b16 a[144:145], v80 offset:0
    ds_read_b64_tr_b16 a[146:147], v80 offset:1024
    ds_read_b64_tr_b16 a[148:149], v80 offset:8192
    ds_read_b64_tr_b16 a[150:151], v80 offset:9216
    ds_read_b64_tr_b16 v[56:57], v81 offset:0
    ds_read_b64_tr_b16 v[58:59], v81 offset:1024
    ds_read_b64_tr_b16 v[60:61], v81 offset:8192
    ds_read_b64_tr_b16 v[62:63], v81 offset:9216
    s_waitcnt lgkmcnt(0)
    ds_write_b128 v5, v[56:59] offset:12288
    ds_write_b128 v5, v[60:63] offset:13312
    s_branch L_lw_19
L_lw_19_2:
    ds_read_b64_tr_b16 a[64:65], v80 offset:0
    ds_read_b64_tr_b16 a[66:67], v80 offset:1024
    ds_read_b64_tr_b16 a[68:69], v80 offset:8192
    ds_read_b64_tr_b16 a[70:71], v80 offset:9216
    ds_read_b64_tr_b16 v[56:57], v81 offset:0
    ds_read_b64_tr_b16 v[58:59], v81 offset:1024
    ds_read_b64_tr_b16 v[60:61], v81 offset:8192
    ds_read_b64_tr_b16 v[62:63], v81 offset:9216
    s_waitcnt lgkmcnt(0)
    ds_write_b128 v5, v[56:59] offset:8192
    ds_write_b128 v5, v[60:63] offset:9216
L_lw_19:
    s_waitcnt lgkmcnt(0)
    s_waitcnt vmcnt(8)
    s_barrier
    s_add_u32 s79, s41, 2
    s_and_b32 s79, s79, 3
    s_lshl_b32 s79, s79, 19
    s_add_u32 s79, s79, s47
    s_add_u32 s46, s79, 0x0
    s_add_u32 m0, s48, 0
    s_nop 0
    buffer_load_dwordx4 v82, s[28:31], s46 offen  lds
    s_add_u32 s46, s79, 0x20000
    s_add_u32 m0, s48, 4096
    s_nop 0
    buffer_load_dwordx4 v82, s[28:31], s46 offen  lds
    s_add_u32 s46, s79, 0x40000
    s_add_u32 m0, s48, 8192
    s_nop 0
    buffer_load_dwordx4 v82, s[28:31], s46 offen  lds
    s_add_u32 s46, s79, 0x60000
    s_add_u32 m0, s48, 12288
    s_nop 0
    buffer_load_dwordx4 v82, s[28:31], s46 offen  lds
    s_cmp_lg_u32 s44, 0
    s_cbranch_scc1 L_lw_20_0
    ds_read_b64_tr_b16 v[224:225], v80 offset:16384
    ds_read_b64_tr_b16 v[226:227], v80 offset:17408
    ds_read_b64_tr_b16 v[228:229], v80 offset:24576
    ds_read_b64_tr_b16 v[230:231], v80 offset:25600
    ds_read_b64_tr_b16 v[232:233], v81 offset:16384
    ds_read_b64_tr_b16 v[234:235], v81 offset:17408
    ds_read_b64_tr_b16 v[236:237], v81 offset:24576
    ds_read_b64_tr_b16 v[238:239], v81 offset:25600
    s_branch L_lw_20
L_lw_20_0:
    s_cmp_lg_u32 s44, 1
    s_cbranch_scc1 L_lw_20_1
    ds_read_b64_tr_b16 v[104:105], v80 offset:16384
    ds_read_b64_tr_b16 v[106:107], v80 offset:17408
    ds_read_b64_tr_b16 v[108:109], v80 offset:24576
    ds_read_b64_tr_b16 v[110:111], v80 offset:25600
    ds_read_b64_tr_b16 v[56:57], v81 offset:16384
    ds_read_b64_tr_b16 v[58:59], v81 offset:17408
    ds_read_b64_tr_b16 v[60:61], v81 offset:24576
    ds_read_b64_tr_b16 v[62:63], v81 offset:25600
    s_waitcnt lgkmcnt(0)
    ds_write_b128 v5, v[56:59] offset:16384
    ds_write_b128 v5, v[60:63] offset:17408
    s_branch L_lw_20
L_lw_20_1:
    s_cmp_lg_u32 s44, 2
    s_cbranch_scc1 L_lw_20_2
    ds_read_b64_tr_b16 a[168:169], v80 offset:16384
    ds_read_b64_tr_b16 a[170:171], v80 offset:17408
    ds_read_b64_tr_b16 a[172:173], v80 offset:24576
    ds_read_b64_tr_b16 a[174:175], v80 offset:25600
    ds_read_b64_tr_b16 v[56:57], v81 offset:16384
    ds_read_b64_tr_b16 v[58:59], v81 offset:17408
    ds_read_b64_tr_b16 v[60:61], v81 offset:24576
    ds_read_b64_tr_b16 v[62:63], v81 offset:25600
    s_waitcnt lgkmcnt(0)
    ds_write_b128 v5, v[56:59] offset:18432
    ds_write_b128 v5, v[60:63] offset:19456
    s_branch L_lw_20
L_lw_20_2:
    ds_read_b64_tr_b16 a[80:81], v80 offset:16384
    ds_read_b64_tr_b16 a[82:83], v80 offset:17408
    ds_read_b64_tr_b16 a[84:85], v80 offset:24576
    ds_read_b64_tr_b16 a[86:87], v80 offset:25600
    ds_read_b64_tr_b16 v[56:57], v81 offset:16384
    ds_read_b64_tr_b16 v[58:59], v81 offset:17408
    ds_read_b64_tr_b16 v[60:61], v81 offset:24576
    ds_read_b64_tr_b16 v[62:63], v81 offset:25600
    s_waitcnt lgkmcnt(0)
    ds_write_b128 v5, v[56:59] offset:14336
    ds_write_b128 v5, v[60:63] offset:15360
L_lw_20:
    s_waitcnt lgkmcnt(0)
    s_waitcnt vmcnt(8)
    s_barrier
    s_add_u32 s79, s41, 3
    s_and_b32 s79, s79, 3
    s_lshl_b32 s79, s79, 19
    s_add_u32 s79, s79, s47
    s_add_u32 s46, s79, 0x0
    s_add_u32 m0, s48, 16384
    s_nop 0
    buffer_load_dwordx4 v82, s[28:31], s46 offen  lds
    s_add_u32 s46, s79, 0x20000
    s_add_u32 m0, s48, 20480
    s_nop 0
    buffer_load_dwordx4 v82, s[28:31], s46 offen  lds
    s_add_u32 s46, s79, 0x40000
    s_add_u32 m0, s48, 24576
    s_nop 0
    buffer_load_dwordx4 v82, s[28:31], s46 offen  lds
    s_add_u32 s46, s79, 0x60000
    s_add_u32 m0, s48, 28672
    s_nop 0
    buffer_load_dwordx4 v82, s[28:31], s46 offen  lds
    s_cmp_lg_u32 s44, 0
    s_cbranch_scc1 L_lw_21_0
    ds_read_b64_tr_b16 a[16:17], v80 offset:32768
    ds_read_b64_tr_b16 a[18:19], v80 offset:33792
    ds_read_b64_tr_b16 a[20:21], v80 offset:40960
    ds_read_b64_tr_b16 a[22:23], v80 offset:41984
    ds_read_b64_tr_b16 a[24:25], v81 offset:32768
    ds_read_b64_tr_b16 a[26:27], v81 offset:33792
    ds_read_b64_tr_b16 a[28:29], v81 offset:40960
    ds_read_b64_tr_b16 a[30:31], v81 offset:41984
    s_branch L_lw_21
L_lw_21_0:
    s_cmp_lg_u32 s44, 1
    s_cbranch_scc1 L_lw_21_1
    ds_read_b64_tr_b16 v[144:145], v80 offset:32768
    ds_read_b64_tr_b16 v[146:147], v80 offset:33792
    ds_read_b64_tr_b16 v[148:149], v80 offset:40960
    ds_read_b64_tr_b16 v[150:151], v80 offset:41984
    ds_read_b64_tr_b16 v[152:153], v81 offset:32768
    ds_read_b64_tr_b16 v[154:155], v81 offset:33792
    ds_read_b64_tr_b16 v[156:157], v81 offset:40960
    ds_read_b64_tr_b16 v[158:159], v81 offset:41984
    s_branch L_lw_21
L_lw_21_1:
    s_cmp_lg_u32 s44, 2
    s_cbranch_scc1 L_lw_21_2
    ds_read_b64_tr_b16 a[200:201], v80 offset:32768
    ds_read_b64_tr_b16 a[202:203], v80 offset:33792
    ds_read_b64_tr_b16 a[204:205], v80 offset:40960
    ds_read_b64_tr_b16 a[206:207], v80 offset:41984
    ds_read_b64_tr_b16 a[208:209], v81 offset:32768
    ds_read_b64_tr_b16 a[210:211], v81 offset:33792
    ds_read_b64_tr_b16 a[212:213], v81 offset:40960
    ds_read_b64_tr_b16 a[214:215], v81 offset:41984
    s_branch L_lw_21
L_lw_21_2:
    ds_read_b64_tr_b16 a[104:105], v80 offset:32768
    ds_read_b64_tr_b16 a[106:107], v80 offset:33792
    ds_read_b64_tr_b16 a[108:109], v80 offset:40960
    ds_read_b64_tr_b16 a[110:111], v80 offset:41984
    ds_read_b64_tr_b16 a[112:113], v81 offset:32768
    ds_read_b64_tr_b16 a[114:115], v81 offset:33792
    ds_read_b64_tr_b16 a[116:117], v81 offset:40960
    ds_read_b64_tr_b16 a[118:119], v81 offset:41984
L_lw_21:
    s_waitcnt lgkmcnt(0)
    s_waitcnt vmcnt(8)
    s_barrier
    s_add_u32 s79, s41, 4
    s_and_b32 s79, s79, 3
    s_lshl_b32 s79, s79, 19
    s_add_u32 s79, s79, s47
    s_add_u32 s46, s79, 0x200000
    s_add_u32 m0, s48, 32768
    s_nop 0
    buffer_load_dwordx4 v82, s[28:31], s46 offen  lds
    s_add_u32 s46, s79, 0x220000
    s_add_u32 m0, s48, 36864
    s_nop 0
    buffer_load_dwordx4 v82, s[28:31], s46 offen  lds
    s_add_u32 s46, s79, 0x240000
    s_add_u32 m0, s48, 40960
    s_nop 0
    buffer_load_dwordx4 v82, s[28:31], s46 offen  lds
    s_add_u32 s46, s79, 0x260000
    s_add_u32 m0, s48, 45056
    s_nop 0
    buffer_load_dwordx4 v82, s[28:31], s46 offen  lds
    s_cmp_lg_u32 s44, 0
    s_cbranch_scc1 L_lw_22_0
    ds_read_b64_tr_b16 a[48:49], v80 offset:49152
    ds_read_b64_tr_b16 a[50:51], v80 offset:50176
    ds_read_b64_tr_b16 a[52:53], v80 offset:57344
    ds_read_b64_tr_b16 a[54:55], v80 offset:58368
    ds_read_b64_tr_b16 a[56:57], v81 offset:49152
    ds_read_b64_tr_b16 a[58:59], v81 offset:50176
    ds_read_b64_tr_b16 a[60:61], v81 offset:57344
    ds_read_b64_tr_b16 a[62:63], v81 offset:58368
    s_branch L_lw_22
L_lw_22_0:
    s_cmp_lg_u32 s44, 1
    s_cbranch_scc1 L_lw_22_1
    ds_read_b64_tr_b16 v[176:177], v80 offset:49152
    ds_read_b64_tr_b16 v[178:179], v80 offset:50176
    ds_read_b64_tr_b16 v[180:181], v80 offset:57344
    ds_read_b64_tr_b16 v[182:183], v80 offset:58368
    ds_read_b64_tr_b16 v[184:185], v81 offset:49152
    ds_read_b64_tr_b16 v[186:187], v81 offset:50176
    ds_read_b64_tr_b16 v[188:189], v81 offset:57344
    ds_read_b64_tr_b16 v[190:191], v81 offset:58368
    s_branch L_lw_22
L_lw_22_1:
    s_cmp_lg_u32 s44, 2
    s_cbranch_scc1 L_lw_22_2
    ds_read_b64_tr_b16 a[224:225], v80 offset:49152
    ds_read_b64_tr_b16 a[226:227], v80 offset:50176
    ds_read_b64_tr_b16 a[228:229], v80 offset:57344
    ds_read_b64_tr_b16 a[230:231], v80 offset:58368
    ds_read_b64_tr_b16 a[232:233], v81 offset:49152
    ds_read_b64_tr_b16 a[234:235], v81 offset:50176
    ds_read_b64_tr_b16 a[236:237], v81 offset:57344
    ds_read_b64_tr_b16 a[238:239], v81 offset:58368
    s_branch L_lw_22
L_lw_22_2:
    ds_read_b64_tr_b16 a[128:129], v80 offset:49152
    ds_read_b64_tr_b16 a[130:131], v80 offset:50176
    ds_read_b64_tr_b16 a[132:133], v80 offset:57344
    ds_read_b64_tr_b16 a[134:135], v80 offset:58368
    ds_read_b64_tr_b16 a[136:137], v81 offset:49152
    ds_read_b64_tr_b16 a[138:139], v81 offset:50176
    ds_read_b64_tr_b16 a[140:141], v81 offset:57344
    ds_read_b64_tr_b16 a[142:143], v81 offset:58368
L_lw_22:
    s_waitcnt lgkmcnt(0)
    s_waitcnt vmcnt(8)
    s_barrier
    s_add_u32 s79, s41, 5
    s_and_b32 s79, s79, 3
    s_lshl_b32 s79, s79, 19
    s_add_u32 s79, s79, s47
    s_add_u32 s46, s79, 0x200000
    s_add_u32 m0, s48, 49152
    s_nop 0
    buffer_load_dwordx4 v82, s[28:31], s46 offen  lds
    s_add_u32 s46, s79, 0x220000
    s_add_u32 m0, s48, 53248
    s_nop 0
    buffer_load_dwordx4 v82, s[28:31], s46 offen  lds
    s_add_u32 s46, s79, 0x240000
    s_add_u32 m0, s48, 57344
    s_nop 0
    buffer_load_dwordx4 v82, s[28:31], s46 offen  lds
    s_add_u32 s46, s79, 0x260000
    s_add_u32 m0, s48, 61440
    s_nop 0
    buffer_load_dwordx4 v82, s[28:31], s46 offen  lds
    s_cmp_lg_u32 s44, 0
    s_cbranch_scc1 L_lw_23_0
    ds_read_b64_tr_b16 a[72:73], v80 offset:0
    ds_read_b64_tr_b16 a[74:75], v80 offset:1024
    ds_read_b64_tr_b16 a[76:77], v80 offset:8192
    ds_read_b64_tr_b16 a[78:79], v80 offset:9216
    ds_read_b64_tr_b16 v[56:57], v81 offset:0
    ds_read_b64_tr_b16 v[58:59], v81 offset:1024
    ds_read_b64_tr_b16 v[60:61], v81 offset:8192
    ds_read_b64_tr_b16 v[62:63], v81 offset:9216
    s_waitcnt lgkmcnt(0)
    ds_write_b128 v5, v[56:59] offset:20480
    ds_write_b128 v5, v[60:63] offset:21504
    s_branch L_lw_23
L_lw_23_0:
    s_cmp_lg_u32 s44, 1
    s_cbranch_scc1 L_lw_23_1
    ds_read_b64_tr_b16 v[208:209], v80 offset:0
    ds_read_b64_tr_b16 v[210:211], v80 offset:1024
    ds_read_b64_tr_b16 v[212:213], v80 offset:8192
    ds_read_b64_tr_b16 v[214:215], v80 offset:9216
    ds_read_b64_tr_b16 v[216:217], v81 offset:0
    ds_read_b64_tr_b16 v[218:219], v81 offset:1024
    ds_read_b64_tr_b16 v[220:221], v81 offset:8192
    ds_read_b64_tr_b16 v[222:223], v81 offset:9216
    s_branch L_lw_23
L_lw_23_1:
    s_cmp_lg_u32 s44, 2
    s_cbranch_scc1 L_lw_23_2
    ds_read_b64_tr_b16 a[248:249], v80 offset:0
    ds_read_b64_tr_b16 a[250:251], v80 offset:1024
    ds_read_b64_tr_b16 a[252:253], v80 offset:8192
    ds_read_b64_tr_b16 a[254:255], v80 offset:9216
    ds_read_b64_tr_b16 v[96:97], v81 offset:0
    ds_read_b64_tr_b16 v[98:99], v81 offset:1024
    ds_read_b64_tr_b16 v[100:101], v81 offset:8192
    ds_read_b64_tr_b16 v[102:103], v81 offset:9216
    s_branch L_lw_23
L_lw_23_2:
    ds_read_b64_tr_b16 a[152:153], v80 offset:0
    ds_read_b64_tr_b16 a[154:155], v80 offset:1024
    ds_read_b64_tr_b16 a[156:157], v80 offset:8192
    ds_read_b64_tr_b16 a[158:159], v80 offset:9216
    ds_read_b64_tr_b16 a[160:161], v81 offset:0
    ds_read_b64_tr_b16 a[162:163], v81 offset:1024
    ds_read_b64_tr_b16 a[164:165], v81 offset:8192
    ds_read_b64_tr_b16 a[166:167], v81 offset:9216
L_lw_23:
    s_waitcnt lgkmcnt(0)
    s_waitcnt vmcnt(8)
    s_barrier
    s_add_u32 s79, s41, 6
    s_and_b32 s79, s79, 3
    s_lshl_b32 s79, s79, 19
    s_add_u32 s79, s79, s47
    s_add_u32 s46, s79, 0x200000
    s_add_u32 m0, s48, 0
    s_nop 0
    buffer_load_dwordx4 v82, s[28:31], s46 offen  lds
    s_add_u32 s46, s79, 0x220000
    s_add_u32 m0, s48, 4096
    s_nop 0
    buffer_load_dwordx4 v82, s[28:31], s46 offen  lds
    s_add_u32 s46, s79, 0x240000
    s_add_u32 m0, s48, 8192
    s_nop 0
    buffer_load_dwordx4 v82, s[28:31], s46 offen  lds
    s_add_u32 s46, s79, 0x260000
    s_add_u32 m0, s48, 12288
    s_nop 0
    buffer_load_dwordx4 v82, s[28:31], s46 offen  lds
    s_cmp_lg_u32 s44, 0
    s_cbranch_scc1 L_lw_24_0
    ds_read_b64_tr_b16 a[88:89], v80 offset:16384
    ds_read_b64_tr_b16 a[90:91], v80 offset:17408
    ds_read_b64_tr_b16 a[92:93], v80 offset:24576
    ds_read_b64_tr_b16 a[94:95], v80 offset:25600
    ds_read_b64_tr_b16 v[56:57], v81 offset:16384
    ds_read_b64_tr_b16 v[58:59], v81 offset:17408
    ds_read_b64_tr_b16 v[60:61], v81 offset:24576
    ds_read_b64_tr_b16 v[62:63], v81 offset:25600
    s_waitcnt lgkmcnt(0)
    ds_write_b128 v5, v[56:59] offset:22528
    ds_write_b128 v5, v[60:63] offset:23552
    s_branch L_lw_24
L_lw_24_0:
    s_cmp_lg_u32 s44, 1
    s_cbranch_scc1 L_lw_24_1
    ds_read_b64_tr_b16 v[240:241], v80 offset:16384
    ds_read_b64_tr_b16 v[242:243], v80 offset:17408
    ds_read_b64_tr_b16 v[244:245], v80 offset:24576
    ds_read_b64_tr_b16 v[246:247], v80 offset:25600
    ds_read_b64_tr_b16 v[248:249], v81 offset:16384
    ds_read_b64_tr_b16 v[250:251], v81 offset:17408
    ds_read_b64_tr_b16 v[252:253], v81 offset:24576
    ds_read_b64_tr_b16 v[254:255], v81 offset:25600
    s_branch L_lw_24
L_lw_24_1:
    s_cmp_lg_u32 s44, 2
    s_cbranch_scc1 L_lw_24_2
    ds_read_b64_tr_b16 v[112:113], v80 offset:16384
    ds_read_b64_tr_b16 v[114:115], v80 offset:17408
    ds_read_b64_tr_b16 v[116:117], v80 offset:24576
    ds_read_b64_tr_b16 v[118:119], v80 offset:25600
    ds_read_b64_tr_b16 v[120:121], v81 offset:16384
    ds_read_b64_tr_b16 v[122:123], v81 offset:17408
    ds_read_b64_tr_b16 v[124:125], v81 offset:24576
    ds_read_b64_tr_b16 v[126:127], v81 offset:25600
    s_branch L_lw_24
L_lw_24_2:
    ds_read_b64_tr_b16 a[176:177], v80 offset:16384
    ds_read_b64_tr_b16 a[178:179], v80 offset:17408
    ds_read_b64_tr_b16 a[180:181], v80 offset:24576
    ds_read_b64_tr_b16 a[182:183], v80 offset:25600
    ds_read_b64_tr_b16 a[184:185], v81 offset:16384
    ds_read_b64_tr_b16 a[186:187], v81 offset:17408
    ds_read_b64_tr_b16 a[188:189], v81 offset:24576
    ds_read_b64_tr_b16 a[190:191], v81 offset:25600
L_lw_24:
    s_waitcnt lgkmcnt(0)
    s_waitcnt vmcnt(8)
    s_barrier
    s_add_u32 s79, s41, 7
    s_and_b32 s79, s79, 3
    s_lshl_b32 s79, s79, 19
    s_add_u32 s79, s79, s47
    s_add_u32 s46, s79, 0x200000
    s_add_u32 m0, s48, 16384
    s_nop 0
    buffer_load_dwordx4 v82, s[28:31], s46 offen  lds
    s_add_u32 s46, s79, 0x220000
    s_add_u32 m0, s48, 20480
    s_nop 0
    buffer_load_dwordx4 v82, s[28:31], s46 offen  lds
    s_add_u32 s46, s79, 0x240000
    s_add_u32 m0, s48, 24576
    s_nop 0
    buffer_load_dwordx4 v82, s[28:31], s46 offen  lds
    s_add_u32 s46, s79, 0x260000
    s_add_u32 m0, s48, 28672
    s_nop 0
    buffer_load_dwordx4 v82, s[28:31], s46 offen  lds
    s_cmp_lg_u32 s44, 0
    s_cbranch_scc1 L_lw_25_0
    ds_read_b64_tr_b16 a[104:105], v80 offset:32768
    ds_read_b64_tr_b16 a[106:107], v80 offset:33792
    ds_read_b64_tr_b16 a[108:109], v80 offset:40960
    ds_read_b64_tr_b16 a[110:111], v80 offset:41984
    ds_read_b64_tr_b16 a[112:113], v81 offset:32768
    ds_read_b64_tr_b16 a[114:115], v81 offset:33792
    ds_read_b64_tr_b16 a[116:117], v81 offset:40960
    ds_read_b64_tr_b16 a[118:119], v81 offset:41984
    s_branch L_lw_25
L_lw_25_0:
    s_cmp_lg_u32 s44, 1
    s_cbranch_scc1 L_lw_25_1
    ds_read_b64_tr_b16 a[16:17], v80 offset:32768
    ds_read_b64_tr_b16 a[18:19], v80 offset:33792
    ds_read_b64_tr_b16 a[20:21], v80 offset:40960
    ds_read_b64_tr_b16 a[22:23], v80 offset:41984
    ds_read_b64_tr_b16 a[24:25], v81 offset:32768
    ds_read_b64_tr_b16 a[26:27], v81 offset:33792
    ds_read_b64_tr_b16 a[28:29], v81 offset:40960
    ds_read_b64_tr_b16 a[30:31], v81 offset:41984
    s_branch L_lw_25
L_lw_25_1:
    s_cmp_lg_u32 s44, 2
    s_cbranch_scc1 L_lw_25_2
    ds_read_b64_tr_b16 v[144:145], v80 offset:32768
    ds_read_b64_tr_b16 v[146:147], v80 offset:33792
    ds_read_b64_tr_b16 v[148:149], v80 offset:40960
    ds_read_b64_tr_b16 v[150:151], v80 offset:41984
    ds_read_b64_tr_b16 v[152:153], v81 offset:32768
    ds_read_b64_tr_b16 v[154:155], v81 offset:33792
    ds_read_b64_tr_b16 v[156:157], v81 offset:40960
    ds_read_b64_tr_b16 v[158:159], v81 offset:41984
    s_branch L_lw_25
L_lw_25_2:
    ds_read_b64_tr_b16 a[200:201], v80 offset:32768
    ds_read_b64_tr_b16 a[202:203], v80 offset:33792
    ds_read_b64_tr_b16 a[204:205], v80 offset:40960
    ds_read_b64_tr_b16 a[206:207], v80 offset:41984
    ds_read_b64_tr_b16 a[208:209], v81 offset:32768
    ds_read_b64_tr_b16 a[210:211], v81 offset:33792
    ds_read_b64_tr_b16 a[212:213], v81 offset:40960
    ds_read_b64_tr_b16 a[214:215], v81 offset:41984
L_lw_25:
    s_waitcnt lgkmcnt(0)
    s_waitcnt vmcnt(8)
    s_barrier
    s_add_u32 s79, s41, 8
    s_and_b32 s79, s79, 3
    s_lshl_b32 s79, s79, 19
    s_add_u32 s79, s79, s47
    s_add_u32 s46, s79, 0x400000
    s_add_u32 m0, s48, 32768
    s_nop 0
    buffer_load_dwordx4 v82, s[28:31], s46 offen  lds
    s_add_u32 s46, s79, 0x420000
    s_add_u32 m0, s48, 36864
    s_nop 0
    buffer_load_dwordx4 v82, s[28:31], s46 offen  lds
    s_add_u32 s46, s79, 0x440000
    s_add_u32 m0, s48, 40960
    s_nop 0
    buffer_load_dwordx4 v82, s[28:31], s46 offen  lds
    s_add_u32 s46, s79, 0x460000
    s_add_u32 m0, s48, 45056
    s_nop 0
    buffer_load_dwordx4 v82, s[28:31], s46 offen  lds
    s_cmp_lg_u32 s44, 0
    s_cbranch_scc1 L_lw_26_0
    ds_read_b64_tr_b16 a[128:129], v80 offset:49152
    ds_read_b64_tr_b16 a[130:131], v80 offset:50176
    ds_read_b64_tr_b16 a[132:133], v80 offset:57344
    ds_read_b64_tr_b16 a[134:135], v80 offset:58368
    ds_read_b64_tr_b16 a[136:137], v81 offset:49152
    ds_read_b64_tr_b16 a[138:139], v81 offset:50176
    ds_read_b64_tr_b16 a[140:141], v81 offset:57344
    ds_read_b64_tr_b16 a[142:143], v81 offset:58368
    s_branch L_lw_26
L_lw_26_0:
    s_cmp_lg_u32 s44, 1
    s_cbranch_scc1 L_lw_26_1
    ds_read_b64_tr_b16 a[48:49], v80 offset:49152
    ds_read_b64_tr_b16 a[50:51], v80 offset:50176
    ds_read_b64_tr_b16 a[52:53], v80 offset:57344
    ds_read_b64_tr_b16 a[54:55], v80 offset:58368
    ds_read_b64_tr_b16 a[56:57], v81 offset:49152
    ds_read_b64_tr_b16 a[58:59], v81 offset:50176
    ds_read_b64_tr_b16 a[60:61], v81 offset:57344
    ds_read_b64_tr_b16 a[62:63], v81 offset:58368
    s_branch L_lw_26
L_lw_26_1:
    s_cmp_lg_u32 s44, 2
    s_cbranch_scc1 L_lw_26_2
    ds_read_b64_tr_b16 v[176:177], v80 offset:49152
    ds_read_b64_tr_b16 v[178:179], v80 offset:50176
    ds_read_b64_tr_b16 v[180:181], v80 offset:57344
    ds_read_b64_tr_b16 v[182:183], v80 offset:58368
    ds_read_b64_tr_b16 v[184:185], v81 offset:49152
    ds_read_b64_tr_b16 v[186:187], v81 offset:50176
    ds_read_b64_tr_b16 v[188:189], v81 offset:57344
    ds_read_b64_tr_b16 v[190:191], v81 offset:58368
    s_branch L_lw_26
L_lw_26_2:
    ds_read_b64_tr_b16 a[224:225], v80 offset:49152
    ds_read_b64_tr_b16 a[226:227], v80 offset:50176
    ds_read_b64_tr_b16 a[228:229], v80 offset:57344
    ds_read_b64_tr_b16 a[230:231], v80 offset:58368
    ds_read_b64_tr_b16 a[232:233], v81 offset:49152
    ds_read_b64_tr_b16 a[234:235], v81 offset:50176
    ds_read_b64_tr_b16 a[236:237], v81 offset:57344
    ds_read_b64_tr_b16 a[238:239], v81 offset:58368
L_lw_26:
    s_waitcnt lgkmcnt(0)
    s_waitcnt vmcnt(8)
    s_barrier
    s_add_u32 s79, s41, 9
    s_and_b32 s79, s79, 3
    s_lshl_b32 s79, s79, 19
    s_add_u32 s79, s79, s47
    s_add_u32 s46, s79, 0x400000
    s_add_u32 m0, s48, 49152
    s_nop 0
    buffer_load_dwordx4 v82, s[28:31], s46 offen  lds
    s_add_u32 s46, s79, 0x420000
    s_add_u32 m0, s48, 53248
    s_nop 0
    buffer_load_dwordx4 v82, s[28:31], s46 offen  lds
    s_add_u32 s46, s79, 0x440000
    s_add_u32 m0, s48, 57344
    s_nop 0
    buffer_load_dwordx4 v82, s[28:31], s46 offen  lds
    s_add_u32 s46, s79, 0x460000
    s_add_u32 m0, s48, 61440
    s_nop 0
    buffer_load_dwordx4 v82, s[28:31], s46 offen  lds
    s_cmp_lg_u32 s44, 0
    s_cbranch_scc1 L_lw_27_0
    ds_read_b64_tr_b16 a[152:153], v80 offset:0
    ds_read_b64_tr_b16 a[154:155], v80 offset:1024
    ds_read_b64_tr_b16 a[156:157], v80 offset:8192
    ds_read_b64_tr_b16 a[158:159], v80 offset:9216
    ds_read_b64_tr_b16 a[160:161], v81 offset:0
    ds_read_b64_tr_b16 a[162:163], v81 offset:1024
    ds_read_b64_tr_b16 a[164:165], v81 offset:8192
    ds_read_b64_tr_b16 a[166:167], v81 offset:9216
    s_branch L_lw_27
L_lw_27_0:
    s_cmp_lg_u32 s44, 1
    s_cbranch_scc1 L_lw_27_1
    ds_read_b64_tr_b16 a[72:73], v80 offset:0
    ds_read_b64_tr_b16 a[74:75], v80 offset:1024
    ds_read_b64_tr_b16 a[76:77], v80 offset:8192
    ds_read_b64_tr_b16 a[78:79], v80 offset:9216
    ds_read_b64_tr_b16 v[56:57], v81 offset:0
    ds_read_b64_tr_b16 v[58:59], v81 offset:1024
    ds_read_b64_tr_b16 v[60:61], v81 offset:8192
    ds_read_b64_tr_b16 v[62:63], v81 offset:9216
    s_waitcnt lgkmcnt(0)
    ds_write_b128 v5, v[56:59] offset:20480
    ds_write_b128 v5, v[60:63] offset:21504
    s_branch L_lw_27
L_lw_27_1:
    s_cmp_lg_u32 s44, 2
    s_cbranch_scc1 L_lw_27_2
    ds_read_b64_tr_b16 v[208:209], v80 offset:0
    ds_read_b64_tr_b16 v[210:211], v80 offset:1024
    ds_read_b64_tr_b16 v[212:213], v80 offset:8192
    ds_read_b64_tr_b16 v[214:215], v80 offset:9216
    ds_read_b64_tr_b16 v[216:217], v81 offset:0
    ds_read_b64_tr_b16 v[218:219], v81 offset:1024
    ds_read_b64_tr_b16 v[220:221], v81 offset:8192
    ds_read_b64_tr_b16 v[222:223], v81 offset:9216
    s_branch L_lw_27
L_lw_27_2:
    ds_read_b64_tr_b16 a[248:249], v80 offset:0
    ds_read_b64_tr_b16 a[250:251], v80 offset:1024
    ds_read_b64_tr_b16 a[252:253], v80 offset:8192
    ds_read_b64_tr_b16 a[254:255], v80 offset:9216
    ds_read_b64_tr_b16 v[96:97], v81 offset:0
    ds_read_b64_tr_b16 v[98:99], v81 offset:1024
    ds_read_b64_tr_b16 v[100:101], v81 offset:8192
    ds_read_b64_tr_b16 v[102:103], v81 offset:9216
L_lw_27:
    s_waitcnt lgkmcnt(0)
    s_waitcnt vmcnt(8)
    s_barrier
    s_add_u32 s79, s41, 10
    s_and_b32 s79, s79, 3
    s_lshl_b32 s79, s79, 19
    s_add_u32 s79, s79, s47
    s_add_u32 s46, s79, 0x400000
    s_add_u32 m0, s48, 0
    s_nop 0
    buffer_load_dwordx4 v82, s[28:31], s46 offen  lds
    s_add_u32 s46, s79, 0x420000
    s_add_u32 m0, s48, 4096
    s_nop 0
    buffer_load_dwordx4 v82, s[28:31], s46 offen  lds
    s_add_u32 s46, s79, 0x440000
    s_add_u32 m0, s48, 8192
    s_nop 0
    buffer_load_dwordx4 v82, s[28:31], s46 offen  lds
    s_add_u32 s46, s79, 0x460000
    s_add_u32 m0, s48, 12288
    s_nop 0
    buffer_load_dwordx4 v82, s[28:31], s46 offen  lds
    s_cmp_lg_u32 s44, 0
    s_cbranch_scc1 L_lw_28_0
    ds_read_b64_tr_b16 a[176:177], v80 offset:16384
    ds_read_b64_tr_b16 a[178:179], v80 offset:17408
    ds_read_b64_tr_b16 a[180:181], v80 offset:24576
    ds_read_b64_tr_b16 a[182:183], v80 offset:25600
    ds_read_b64_tr_b16 a[184:185], v81 offset:16384
    ds_read_b64_tr_b16 a[186:187], v81 offset:17408
    ds_read_b64_tr_b16 a[188:189], v81 offset:24576
    ds_read_b64_tr_b16 a[190:191], v81 offset:25600
    s_branch L_lw_28
L_lw_28_0:
    s_cmp_lg_u32 s44, 1
    s_cbranch_scc1 L_lw_28_1
    ds_read_b64_tr_b16 a[88:89], v80 offset:16384
    ds_read_b64_tr_b16 a[90:91], v80 offset:17408
    ds_read_b64_tr_b16 a[92:93], v80 offset:24576
    ds_read_b64_tr_b16 a[94:95], v80 offset:25600
    ds_read_b64_tr_b16 v[56:57], v81 offset:16384
    ds_read_b64_tr_b16 v[58:59], v81 offset:17408
    ds_read_b64_tr_b16 v[60:61], v81 offset:24576
    ds_read_b64_tr_b16 v[62:63], v81 offset:25600
    s_waitcnt lgkmcnt(0)
    ds_write_b128 v5, v[56:59] offset:22528
    ds_write_b128 v5, v[60:63] offset:23552
    s_branch L_lw_28
L_lw_28_1:
    s_cmp_lg_u32 s44, 2
    s_cbranch_scc1 L_lw_28_2
    ds_read_b64_tr_b16 v[240:241], v80 offset:16384
    ds_read_b64_tr_b16 v[242:243], v80 offset:17408
    ds_read_b64_tr_b16 v[244:245], v80 offset:24576
    ds_read_b64_tr_b16 v[246:247], v80 offset:25600
    ds_read_b64_tr_b16 v[248:249], v81 offset:16384
    ds_read_b64_tr_b16 v[250:251], v81 offset:17408
    ds_read_b64_tr_b16 v[252:253], v81 offset:24576
    ds_read_b64_tr_b16 v[254:255], v81 offset:25600
    s_branch L_lw_28
L_lw_28_2:
    ds_read_b64_tr_b16 v[112:113], v80 offset:16384
    ds_read_b64_tr_b16 v[114:115], v80 offset:17408
    ds_read_b64_tr_b16 v[116:117], v80 offset:24576
    ds_read_b64_tr_b16 v[118:119], v80 offset:25600
    ds_read_b64_tr_b16 v[120:121], v81 offset:16384
    ds_read_b64_tr_b16 v[122:123], v81 offset:17408
    ds_read_b64_tr_b16 v[124:125], v81 offset:24576
    ds_read_b64_tr_b16 v[126:127], v81 offset:25600
L_lw_28:
    s_waitcnt lgkmcnt(0)
    s_waitcnt vmcnt(8)
    s_barrier
    s_add_u32 s79, s41, 11
    s_and_b32 s79, s79, 3
    s_lshl_b32 s79, s79, 19
    s_add_u32 s79, s79, s47
    s_add_u32 s46, s79, 0x400000
    s_add_u32 m0, s48, 16384
    s_nop 0
    buffer_load_dwordx4 v82, s[28:31], s46 offen  lds
    s_add_u32 s46, s79, 0x420000
    s_add_u32 m0, s48, 20480
    s_nop 0
    buffer_load_dwordx4 v82, s[28:31], s46 offen  lds
    s_add_u32 s46, s79, 0x440000
    s_add_u32 m0, s48, 24576
    s_nop 0
    buffer_load_dwordx4 v82, s[28:31], s46 offen  lds
    s_add_u32 s46, s79, 0x460000
    s_add_u32 m0, s48, 28672
    s_nop 0
    buffer_load_dwordx4 v82, s[28:31], s46 offen  lds
    s_cmp_lg_u32 s44, 0
    s_cbranch_scc1 L_lw_29_0
    ds_read_b64_tr_b16 a[200:201], v80 offset:32768
    ds_read_b64_tr_b16 a[202:203], v80 offset:33792
    ds_read_b64_tr_b16 a[204:205], v80 offset:40960
    ds_read_b64_tr_b16 a[206:207], v80 offset:41984
    ds_read_b64_tr_b16 a[208:209], v81 offset:32768
    ds_read_b64_tr_b16 a[210:211], v81 offset:33792
    ds_read_b64_tr_b16 a[212:213], v81 offset:40960
    ds_read_b64_tr_b16 a[214:215], v81 offset:41984
    s_branch L_lw_29
L_lw_29_0:
    s_cmp_lg_u32 s44, 1
    s_cbranch_scc1 L_lw_29_1
    ds_read_b64_tr_b16 a[104:105], v80 offset:32768
    ds_read_b64_tr_b16 a[106:107], v80 offset:33792
    ds_read_b64_tr_b16 a[108:109], v80 offset:40960
    ds_read_b64_tr_b16 a[110:111], v80 offset:41984
    ds_read_b64_tr_b16 a[112:113], v81 offset:32768
    ds_read_b64_tr_b16 a[114:115], v81 offset:33792
    ds_read_b64_tr_b16 a[116:117], v81 offset:40960
    ds_read_b64_tr_b16 a[118:119], v81 offset:41984
    s_branch L_lw_29
L_lw_29_1:
    s_cmp_lg_u32 s44, 2
    s_cbranch_scc1 L_lw_29_2
    ds_read_b64_tr_b16 a[16:17], v80 offset:32768
    ds_read_b64_tr_b16 a[18:19], v80 offset:33792
    ds_read_b64_tr_b16 a[20:21], v80 offset:40960
    ds_read_b64_tr_b16 a[22:23], v80 offset:41984
    ds_read_b64_tr_b16 a[24:25], v81 offset:32768
    ds_read_b64_tr_b16 a[26:27], v81 offset:33792
    ds_read_b64_tr_b16 a[28:29], v81 offset:40960
    ds_read_b64_tr_b16 a[30:31], v81 offset:41984
    s_branch L_lw_29
L_lw_29_2:
    ds_read_b64_tr_b16 v[144:145], v80 offset:32768
    ds_read_b64_tr_b16 v[146:147], v80 offset:33792
    ds_read_b64_tr_b16 v[148:149], v80 offset:40960
    ds_read_b64_tr_b16 v[150:151], v80 offset:41984
    ds_read_b64_tr_b16 v[152:153], v81 offset:32768
    ds_read_b64_tr_b16 v[154:155], v81 offset:33792
    ds_read_b64_tr_b16 v[156:157], v81 offset:40960
    ds_read_b64_tr_b16 v[158:159], v81 offset:41984
L_lw_29:
    s_waitcnt lgkmcnt(0)
    s_waitcnt vmcnt(8)
    s_barrier
    s_add_u32 s79, s41, 12
    s_and_b32 s79, s79, 3
    s_lshl_b32 s79, s79, 19
    s_add_u32 s79, s79, s47
    s_add_u32 s46, s79, 0x600000
    s_add_u32 m0, s48, 32768
    s_nop 0
    buffer_load_dwordx4 v82, s[28:31], s46 offen  lds
    s_add_u32 s46, s79, 0x620000
    s_add_u32 m0, s48, 36864
    s_nop 0
    buffer_load_dwordx4 v82, s[28:31], s46 offen  lds
    s_add_u32 s46, s79, 0x640000
    s_add_u32 m0, s48, 40960
    s_nop 0
    buffer_load_dwordx4 v82, s[28:31], s46 offen  lds
    s_add_u32 s46, s79, 0x660000
    s_add_u32 m0, s48, 45056
    s_nop 0
    buffer_load_dwordx4 v82, s[28:31], s46 offen  lds
    s_cmp_lg_u32 s44, 0
    s_cbranch_scc1 L_lw_30_0
    ds_read_b64_tr_b16 a[224:225], v80 offset:49152
    ds_read_b64_tr_b16 a[226:227], v80 offset:50176
    ds_read_b64_tr_b16 a[228:229], v80 offset:57344
    ds_read_b64_tr_b16 a[230:231], v80 offset:58368
    ds_read_b64_tr_b16 a[232:233], v81 offset:49152
    ds_read_b64_tr_b16 a[234:235], v81 offset:50176
    ds_read_b64_tr_b16 a[236:237], v81 offset:57344
    ds_read_b64_tr_b16 a[238:239], v81 offset:58368
    s_branch L_lw_30
L_lw_30_0:
    s_cmp_lg_u32 s44, 1
    s_cbranch_scc1 L_lw_30_1
    ds_read_b64_tr_b16 a[128:129], v80 offset:49152
    ds_read_b64_tr_b16 a[130:131], v80 offset:50176
    ds_read_b64_tr_b16 a[132:133], v80 offset:57344
    ds_read_b64_tr_b16 a[134:135], v80 offset:58368
    ds_read_b64_tr_b16 a[136:137], v81 offset:49152
    ds_read_b64_tr_b16 a[138:139], v81 offset:50176
    ds_read_b64_tr_b16 a[140:141], v81 offset:57344
    ds_read_b64_tr_b16 a[142:143], v81 offset:58368
    s_branch L_lw_30
L_lw_30_1:
    s_cmp_lg_u32 s44, 2
    s_cbranch_scc1 L_lw_30_2
    ds_read_b64_tr_b16 a[48:49], v80 offset:49152
    ds_read_b64_tr_b16 a[50:51], v80 offset:50176
    ds_read_b64_tr_b16 a[52:53], v80 offset:57344
    ds_read_b64_tr_b16 a[54:55], v80 offset:58368
    ds_read_b64_tr_b16 a[56:57], v81 offset:49152
    ds_read_b64_tr_b16 a[58:59], v81 offset:50176
    ds_read_b64_tr_b16 a[60:61], v81 offset:57344
    ds_read_b64_tr_b16 a[62:63], v81 offset:58368
    s_branch L_lw_30
L_lw_30_2:
    ds_read_b64_tr_b16 v[176:177], v80 offset:49152
    ds_read_b64_tr_b16 v[178:179], v80 offset:50176
    ds_read_b64_tr_b16 v[180:181], v80 offset:57344
    ds_read_b64_tr_b16 v[182:183], v80 offset:58368
    ds_read_b64_tr_b16 v[184:185], v81 offset:49152
    ds_read_b64_tr_b16 v[186:187], v81 offset:50176
    ds_read_b64_tr_b16 v[188:189], v81 offset:57344
    ds_read_b64_tr_b16 v[190:191], v81 offset:58368
L_lw_30:
    s_waitcnt lgkmcnt(0)
    s_waitcnt vmcnt(8)
    s_barrier
    s_add_u32 s79, s41, 13
    s_and_b32 s79, s79, 3
    s_lshl_b32 s79, s79, 19
    s_add_u32 s79, s79, s47
    s_add_u32 s46, s79, 0x600000
    s_add_u32 m0, s48, 49152
    s_nop 0
    buffer_load_dwordx4 v82, s[28:31], s46 offen  lds
    s_add_u32 s46, s79, 0x620000
    s_add_u32 m0, s48, 53248
    s_nop 0
    buffer_load_dwordx4 v82, s[28:31], s46 offen  lds
    s_add_u32 s46, s79, 0x640000
    s_add_u32 m0, s48, 57344
    s_nop 0
    buffer_load_dwordx4 v82, s[28:31], s46 offen  lds
    s_add_u32 s46, s79, 0x660000
    s_add_u32 m0, s48, 61440
    s_nop 0
    buffer_load_dwordx4 v82, s[28:31], s46 offen  lds
    s_cmp_lg_u32 s44, 0
    s_cbranch_scc1 L_lw_31_0
    ds_read_b64_tr_b16 a[248:249], v80 offset:0
    ds_read_b64_tr_b16 a[250:251], v80 offset:1024
    ds_read_b64_tr_b16 a[252:253], v80 offset:8192
    ds_read_b64_tr_b16 a[254:255], v80 offset:9216
    ds_read_b64_tr_b16 v[96:97], v81 offset:0
    ds_read_b64_tr_b16 v[98:99], v81 offset:1024
    ds_read_b64_tr_b16 v[100:101], v81 offset:8192
    ds_read_b64_tr_b16 v[102:103], v81 offset:9216
    s_branch L_lw_31
L_lw_31_0:
    s_cmp_lg_u32 s44, 1
    s_cbranch_scc1 L_lw_31_1
    ds_read_b64_tr_b16 a[152:153], v80 offset:0
    ds_read_b64_tr_b16 a[154:155], v80 offset:1024
    ds_read_b64_tr_b16 a[156:157], v80 offset:8192
    ds_read_b64_tr_b16 a[158:159], v80 offset:9216
    ds_read_b64_tr_b16 a[160:161], v81 offset:0
    ds_read_b64_tr_b16 a[162:163], v81 offset:1024
    ds_read_b64_tr_b16 a[164:165], v81 offset:8192
    ds_read_b64_tr_b16 a[166:167], v81 offset:9216
    s_branch L_lw_31
L_lw_31_1:
    s_cmp_lg_u32 s44, 2
    s_cbranch_scc1 L_lw_31_2
    ds_read_b64_tr_b16 a[72:73], v80 offset:0
    ds_read_b64_tr_b16 a[74:75], v80 offset:1024
    ds_read_b64_tr_b16 a[76:77], v80 offset:8192
    ds_read_b64_tr_b16 a[78:79], v80 offset:9216
    ds_read_b64_tr_b16 v[56:57], v81 offset:0
    ds_read_b64_tr_b16 v[58:59], v81 offset:1024
    ds_read_b64_tr_b16 v[60:61], v81 offset:8192
    ds_read_b64_tr_b16 v[62:63], v81 offset:9216
    s_waitcnt lgkmcnt(0)
    ds_write_b128 v5, v[56:59] offset:20480
    ds_write_b128 v5, v[60:63] offset:21504
    s_branch L_lw_31
L_lw_31_2:
    ds_read_b64_tr_b16 v[208:209], v80 offset:0
    ds_read_b64_tr_b16 v[210:211], v80 offset:1024
    ds_read_b64_tr_b16 v[212:213], v80 offset:8192
    ds_read_b64_tr_b16 v[214:215], v80 offset:9216
    ds_read_b64_tr_b16 v[216:217], v81 offset:0
    ds_read_b64_tr_b16 v[218:219], v81 offset:1024
    ds_read_b64_tr_b16 v[220:221], v81 offset:8192
    ds_read_b64_tr_b16 v[222:223], v81 offset:9216
L_lw_31:
    s_waitcnt lgkmcnt(0)
    s_waitcnt vmcnt(8)
    s_barrier
    s_add_u32 s79, s41, 14
    s_and_b32 s79, s79, 3
    s_lshl_b32 s79, s79, 19
    s_add_u32 s79, s79, s47
    s_add_u32 s46, s79, 0x600000
    s_add_u32 m0, s48, 0
    s_nop 0
    buffer_load_dwordx4 v82, s[28:31], s46 offen  lds
    s_add_u32 s46, s79, 0x620000
    s_add_u32 m0, s48, 4096
    s_nop 0
    buffer_load_dwordx4 v82, s[28:31], s46 offen  lds
    s_add_u32 s46, s79, 0x640000
    s_add_u32 m0, s48, 8192
    s_nop 0
    buffer_load_dwordx4 v82, s[28:31], s46 offen  lds
    s_add_u32 s46, s79, 0x660000
    s_add_u32 m0, s48, 12288
    s_nop 0
    buffer_load_dwordx4 v82, s[28:31], s46 offen  lds
    s_cmp_lg_u32 s44, 0
    s_cbranch_scc1 L_lw_32_0
    ds_read_b64_tr_b16 v[112:113], v80 offset:16384
    ds_read_b64_tr_b16 v[114:115], v80 offset:17408
    ds_read_b64_tr_b16 v[116:117], v80 offset:24576
    ds_read_b64_tr_b16 v[118:119], v80 offset:25600
    ds_read_b64_tr_b16 v[120:121], v81 offset:16384
    ds_read_b64_tr_b16 v[122:123], v81 offset:17408
    ds_read_b64_tr_b16 v[124:125], v81 offset:24576
    ds_read_b64_tr_b16 v[126:127], v81 offset:25600
    s_branch L_lw_32
L_lw_32_0:
    s_cmp_lg_u32 s44, 1
    s_cbranch_scc1 L_lw_32_1
    ds_read_b64_tr_b16 a[176:177], v80 offset:16384
    ds_read_b64_tr_b16 a[178:179], v80 offset:17408
    ds_read_b64_tr_b16 a[180:181], v80 offset:24576
    ds_read_b64_tr_b16 a[182:183], v80 offset:25600
    ds_read_b64_tr_b16 a[184:185], v81 offset:16384
    ds_read_b64_tr_b16 a[186:187], v81 offset:17408
    ds_read_b64_tr_b16 a[188:189], v81 offset:24576
    ds_read_b64_tr_b16 a[190:191], v81 offset:25600
    s_branch L_lw_32
L_lw_32_1:
    s_cmp_lg_u32 s44, 2
    s_cbranch_scc1 L_lw_32_2
    ds_read_b64_tr_b16 a[88:89], v80 offset:16384
    ds_read_b64_tr_b16 a[90:91], v80 offset:17408
    ds_read_b64_tr_b16 a[92:93], v80 offset:24576
    ds_read_b64_tr_b16 a[94:95], v80 offset:25600
    ds_read_b64_tr_b16 v[56:57], v81 offset:16384
    ds_read_b64_tr_b16 v[58:59], v81 offset:17408
    ds_read_b64_tr_b16 v[60:61], v81 offset:24576
    ds_read_b64_tr_b16 v[62:63], v81 offset:25600
    s_waitcnt lgkmcnt(0)
    ds_write_b128 v5, v[56:59] offset:22528
    ds_write_b128 v5, v[60:63] offset:23552
    s_branch L_lw_32
L_lw_32_2:
    ds_read_b64_tr_b16 v[240:241], v80 offset:16384
    ds_read_b64_tr_b16 v[242:243], v80 offset:17408
    ds_read_b64_tr_b16 v[244:245], v80 offset:24576
    ds_read_b64_tr_b16 v[246:247], v80 offset:25600
    ds_read_b64_tr_b16 v[248:249], v81 offset:16384
    ds_read_b64_tr_b16 v[250:251], v81 offset:17408
    ds_read_b64_tr_b16 v[252:253], v81 offset:24576
    ds_read_b64_tr_b16 v[254:255], v81 offset:25600
L_lw_32:
    s_waitcnt lgkmcnt(0)
    s_waitcnt vmcnt(8)
    s_barrier
    s_add_u32 s79, s41, 15
    s_and_b32 s79, s79, 3
    s_lshl_b32 s79, s79, 19
    s_add_u32 s79, s79, s47
    s_add_u32 s46, s79, 0x600000
    s_add_u32 m0, s48, 16384
    s_nop 0
    buffer_load_dwordx4 v82, s[28:31], s46 offen  lds
    s_add_u32 s46, s79, 0x620000
    s_add_u32 m0, s48, 20480
    s_nop 0
    buffer_load_dwordx4 v82, s[28:31], s46 offen  lds
    s_add_u32 s46, s79, 0x640000
    s_add_u32 m0, s48, 24576
    s_nop 0
    buffer_load_dwordx4 v82, s[28:31], s46 offen  lds
    s_add_u32 s46, s79, 0x660000
    s_add_u32 m0, s48, 28672
    s_nop 0
    buffer_load_dwordx4 v82, s[28:31], s46 offen  lds
    v_mov_b32 v46, 0
    buffer_load_dwordx2 v[44:45], v46, s[16:19], 0 offen sc1
    s_cmp_lg_u32 s44, 0
    s_cbranch_scc1 L_lw_33_0
    ds_read_b64_tr_b16 v[144:145], v80 offset:32768
    ds_read_b64_tr_b16 v[146:147], v80 offset:33792
    ds_read_b64_tr_b16 v[148:149], v80 offset:40960
    ds_read_b64_tr_b16 v[150:151], v80 offset:41984
    ds_read_b64_tr_b16 v[152:153], v81 offset:32768
    ds_read_b64_tr_b16 v[154:155], v81 offset:33792
    ds_read_b64_tr_b16 v[156:157], v81 offset:40960
    ds_read_b64_tr_b16 v[158:159], v81 offset:41984
    s_branch L_lw_33
L_lw_33_0:
    s_cmp_lg_u32 s44, 1
    s_cbranch_scc1 L_lw_33_1
    ds_read_b64_tr_b16 a[200:201], v80 offset:32768
    ds_read_b64_tr_b16 a[202:203], v80 offset:33792
    ds_read_b64_tr_b16 a[204:205], v80 offset:40960
    ds_read_b64_tr_b16 a[206:207], v80 offset:41984
    ds_read_b64_tr_b16 a[208:209], v81 offset:32768
    ds_read_b64_tr_b16 a[210:211], v81 offset:33792
    ds_read_b64_tr_b16 a[212:213], v81 offset:40960
    ds_read_b64_tr_b16 a[214:215], v81 offset:41984
    s_branch L_lw_33
L_lw_33_1:
    s_cmp_lg_u32 s44, 2
    s_cbranch_scc1 L_lw_33_2
    ds_read_b64_tr_b16 a[104:105], v80 offset:32768
    ds_read_b64_tr_b16 a[106:107], v80 offset:33792
    ds_read_b64_tr_b16 a[108:109], v80 offset:40960
    ds_read_b64_tr_b16 a[110:111], v80 offset:41984
    ds_read_b64_tr_b16 a[112:113], v81 offset:32768
    ds_read_b64_tr_b16 a[114:115], v81 offset:33792
    ds_read_b64_tr_b16 a[116:117], v81 offset:40960
    ds_read_b64_tr_b16 a[118:119], v81 offset:41984
    s_branch L_lw_33
L_lw_33_2:
    ds_read_b64_tr_b16 a[16:17], v80 offset:32768
    ds_read_b64_tr_b16 a[18:19], v80 offset:33792
    ds_read_b64_tr_b16 a[20:21], v80 offset:40960
    ds_read_b64_tr_b16 a[22:23], v80 offset:41984
    ds_read_b64_tr_b16 a[24:25], v81 offset:32768
    ds_read_b64_tr_b16 a[26:27], v81 offset:33792
    ds_read_b64_tr_b16 a[28:29], v81 offset:40960
    ds_read_b64_tr_b16 a[30:31], v81 offset:41984
L_lw_33:
    s_waitcnt lgkmcnt(0)
    s_waitcnt vmcnt(8)
    s_barrier
    s_cmp_lg_u32 s44, 0
    s_cbranch_scc1 L_lw_34_0
    ds_read_b64_tr_b16 v[176:177], v80 offset:49152
    ds_read_b64_tr_b16 v[178:179], v80 offset:50176
    ds_read_b64_tr_b16 v[180:181], v80 offset:57344
    ds_read_b64_tr_b16 v[182:183], v80 offset:58368
    ds_read_b64_tr_b16 v[184:185], v81 offset:49152
    ds_read_b64_tr_b16 v[186:187], v81 offset:50176
    ds_read_b64_tr_b16 v[188:189], v81 offset:57344
    ds_read_b64_tr_b16 v[190:191], v81 offset:58368
    s_branch L_lw_34
L_lw_34_0:
    s_cmp_lg_u32 s44, 1
    s_cbranch_scc1 L_lw_34_1
    ds_read_b64_tr_b16 a[224:225], v80 offset:49152
    ds_read_b64_tr_b16 a[226:227], v80 offset:50176
    ds_read_b64_tr_b16 a[228:229], v80 offset:57344
    ds_read_b64_tr_b16 a[230:231], v80 offset:58368
    ds_read_b64_tr_b16 a[232:233], v81 offset:49152
    ds_read_b64_tr_b16 a[234:235], v81 offset:50176
    ds_read_b64_tr_b16 a[236:237], v81 offset:57344
    ds_read_b64_tr_b16 a[238:239], v81 offset:58368
    s_branch L_lw_34
L_lw_34_1:
    s_cmp_lg_u32 s44, 2
    s_cbranch_scc1 L_lw_34_2
    ds_read_b64_tr_b16 a[128:129], v80 offset:49152
    ds_read_b64_tr_b16 a[130:131], v80 offset:50176
    ds_read_b64_tr_b16 a[132:133], v80 offset:57344
    ds_read_b64_tr_b16 a[134:135], v80 offset:58368
    ds_read_b64_tr_b16 a[136:137], v81 offset:49152
    ds_read_b64_tr_b16 a[138:139], v81 offset:50176
    ds_read_b64_tr_b16 a[140:141], v81 offset:57344
    ds_read_b64_tr_b16 a[142:143], v81 offset:58368
    s_branch L_lw_34
L_lw_34_2:
    ds_read_b64_tr_b16 a[48:49], v80 offset:49152
    ds_read_b64_tr_b16 a[50:51], v80 offset:50176
    ds_read_b64_tr_b16 a[52:53], v80 offset:57344
    ds_read_b64_tr_b16 a[54:55], v80 offset:58368
    ds_read_b64_tr_b16 a[56:57], v81 offset:49152
    ds_read_b64_tr_b16 a[58:59], v81 offset:50176
    ds_read_b64_tr_b16 a[60:61], v81 offset:57344
    ds_read_b64_tr_b16 a[62:63], v81 offset:58368
L_lw_34:
    s_waitcnt lgkmcnt(0)
    s_waitcnt vmcnt(4)
    s_barrier
    s_cmp_lg_u32 s44, 0
    s_cbranch_scc1 L_lw_35_0
    ds_read_b64_tr_b16 v[208:209], v80 offset:0
    ds_read_b64_tr_b16 v[210:211], v80 offset:1024
    ds_read_b64_tr_b16 v[212:213], v80 offset:8192
    ds_read_b64_tr_b16 v[214:215], v80 offset:9216
    ds_read_b64_tr_b16 v[216:217], v81 offset:0
    ds_read_b64_tr_b16 v[218:219], v81 offset:1024
    ds_read_b64_tr_b16 v[220:221], v81 offset:8192
    ds_read_b64_tr_b16 v[222:223], v81 offset:9216
    s_branch L_lw_35
L_lw_35_0:
    s_cmp_lg_u32 s44, 1
    s_cbranch_scc1 L_lw_35_1
    ds_read_b64_tr_b16 a[248:249], v80 offset:0
    ds_read_b64_tr_b16 a[250:251], v80 offset:1024
    ds_read_b64_tr_b16 a[252:253], v80 offset:8192
    ds_read_b64_tr_b16 a[254:255], v80 offset:9216
    ds_read_b64_tr_b16 v[96:97], v81 offset:0
    ds_read_b64_tr_b16 v[98:99], v81 offset:1024
    ds_read_b64_tr_b16 v[100:101], v81 offset:8192
    ds_read_b64_tr_b16 v[102:103], v81 offset:9216
    s_branch L_lw_35
L_lw_35_1:
    s_cmp_lg_u32 s44, 2
    s_cbranch_scc1 L_lw_35_2
    ds_read_b64_tr_b16 a[152:153], v80 offset:0
    ds_read_b64_tr_b16 a[154:155], v80 offset:1024
    ds_read_b64_tr_b16 a[156:157], v80 offset:8192
    ds_read_b64_tr_b16 a[158:159], v80 offset:9216
    ds_read_b64_tr_b16 a[160:161], v81 offset:0
    ds_read_b64_tr_b16 a[162:163], v81 offset:1024
    ds_read_b64_tr_b16 a[164:165], v81 offset:8192
    ds_read_b64_tr_b16 a[166:167], v81 offset:9216
    s_branch L_lw_35
L_lw_35_2:
    ds_read_b64_tr_b16 a[72:73], v80 offset:0
    ds_read_b64_tr_b16 a[74:75], v80 offset:1024
    ds_read_b64_tr_b16 a[76:77], v80 offset:8192
    ds_read_b64_tr_b16 a[78:79], v80 offset:9216
    ds_read_b64_tr_b16 v[56:57], v81 offset:0
    ds_read_b64_tr_b16 v[58:59], v81 offset:1024
    ds_read_b64_tr_b16 v[60:61], v81 offset:8192
    ds_read_b64_tr_b16 v[62:63], v81 offset:9216
    s_waitcnt lgkmcnt(0)
    ds_write_b128 v5, v[56:59] offset:20480
    ds_write_b128 v5, v[60:63] offset:21504
L_lw_35:
    s_waitcnt lgkmcnt(0)
    s_waitcnt vmcnt(0)
    s_barrier
    s_cmp_lg_u32 s44, 0
    s_cbranch_scc1 L_lw_36_0
    ds_read_b64_tr_b16 v[240:241], v80 offset:16384
    ds_read_b64_tr_b16 v[242:243], v80 offset:17408
    ds_read_b64_tr_b16 v[244:245], v80 offset:24576
    ds_read_b64_tr_b16 v[246:247], v80 offset:25600
    ds_read_b64_tr_b16 v[248:249], v81 offset:16384
    ds_read_b64_tr_b16 v[250:251], v81 offset:17408
    ds_read_b64_tr_b16 v[252:253], v81 offset:24576
    ds_read_b64_tr_b16 v[254:255], v81 offset:25600
    s_branch L_lw_36
L_lw_36_0:
    s_cmp_lg_u32 s44, 1
    s_cbranch_scc1 L_lw_36_1
    ds_read_b64_tr_b16 v[112:113], v80 offset:16384
    ds_read_b64_tr_b16 v[114:115], v80 offset:17408
    ds_read_b64_tr_b16 v[116:117], v80 offset:24576
    ds_read_b64_tr_b16 v[118:119], v80 offset:25600
    ds_read_b64_tr_b16 v[120:121], v81 offset:16384
    ds_read_b64_tr_b16 v[122:123], v81 offset:17408
    ds_read_b64_tr_b16 v[124:125], v81 offset:24576
    ds_read_b64_tr_b16 v[126:127], v81 offset:25600
    s_branch L_lw_36
L_lw_36_1:
    s_cmp_lg_u32 s44, 2
    s_cbranch_scc1 L_lw_36_2
    ds_read_b64_tr_b16 a[176:177], v80 offset:16384
    ds_read_b64_tr_b16 a[178:179], v80 offset:17408
    ds_read_b64_tr_b16 a[180:181], v80 offset:24576
    ds_read_b64_tr_b16 a[182:183], v80 offset:25600
    ds_read_b64_tr_b16 a[184:185], v81 offset:16384
    ds_read_b64_tr_b16 a[186:187], v81 offset:17408
    ds_read_b64_tr_b16 a[188:189], v81 offset:24576
    ds_read_b64_tr_b16 a[190:191], v81 offset:25600
    s_branch L_lw_36
L_lw_36_2:
    ds_read_b64_tr_b16 a[88:89], v80 offset:16384
    ds_read_b64_tr_b16 a[90:91], v80 offset:17408
    ds_read_b64_tr_b16 a[92:93], v80 offset:24576
    ds_read_b64_tr_b16 a[94:95], v80 offset:25600
    ds_read_b64_tr_b16 v[56:57], v81 offset:16384
    ds_read_b64_tr_b16 v[58:59], v81 offset:17408
    ds_read_b64_tr_b16 v[60:61], v81 offset:24576
    ds_read_b64_tr_b16 v[62:63], v81 offset:25600
    s_waitcnt lgkmcnt(0)
    ds_write_b128 v5, v[56:59] offset:22528
    ds_write_b128 v5, v[60:63] offset:23552
L_lw_36:
    s_waitcnt lgkmcnt(0)
    s_barrier
    v_and_b32 v63, 15, v1
    v_lshrrev_b32 v64, 4, v1
    v_lshrrev_b32 v65, 5, v1
    v_lshlrev_b32 v65, 4, v65
    v_add_u32 v65, v65, v63
    v_lshlrev_b32 v65, 4, v65
    v_and_b32 v66, 1, v64
    v_lshlrev_b32 v66, 3, v66
    s_lshl_b32 s45, s44, 9
    s_add_u32 s45, s45, 53248
    v_add3_u32 v6, v65, v66, s45
    v_bfe_u32 v65, v1, 2, 2
    v_lshlrev_b32 v66, 3, v64
    v_add_u32 v65, v65, v66
    v_lshlrev_b32 v65, 4, v65
    v_and_b32 v66, 1, v1
    v_lshlrev_b32 v66, 3, v66
    v_add_u32 v65, v65, v66
    v_add_u32 v7, 53248, v65
    v_bfe_u32 v65, v1, 2, 1
    v_mul_u32_u24 v65, 520, v65
    v_bfe_u32 v66, v1, 3, 1
    v_lshlrev_b32 v14, 7, v66
    v_and_b32 v67, 3, v1
    v_lshlrev_b32 v67, 5, v67
    v_add3_u32 v65, v65, v14, v67
    v_lshlrev_b32 v66, 1, v66
    v_xor_b32 v66, v66, v64
    v_lshlrev_b32 v66, 3, v66
    s_mul_i32 s45, s44, 1040
    s_add_u32 s45, s45, 55296
    v_add3_u32 v18, v65, v66, s45
    v_lshlrev_b32 v14, 3, v1
    v_and_b32 v65, 16, v1
    v_xor_b32 v14, v14, v65
    v_lshlrev_b32 v16, 3, v1
    v_lshlrev_b32 v8, 4, v1
    v_lshrrev_b32 v65, 2, v1
    v_lshlrev_b32 v65, 4, v65
    v_and_b32 v66, 1, v1
    v_lshlrev_b32 v66, 3, v66
    s_lshl_b32 s45, s44, 11
    v_add3_u32 v65, v65, v66, s45
    v_and_b32 v66, 2, v1
    v_lshlrev_b32 v66, 7, v66
    v_add_u32 v9, v65, v66
    s_lshl_b32 s45, s43, 11
    s_lshl_b32 s46, s44, 9
    s_add_u32 s45, s45, s46
    s_add_u32 s51, s45, 0x7020000
    s_lshl_b32 s63, s43, 19
    s_add_u32 s63, s63, 0x3000000
    s_mov_b32 s50, 0
    s_lshl_b32 s64, s44, 11
    s_sub_u32 s63, s63, s64
    s_add_u32 s64, s64, 16384
    s_add_u32 s65, s64, 8192
    s_lshl_b32 s66, s43, 12
    s_add_u32 s66, s66, 0x1000000
    s_mov_b32 s69, 16384
    s_mov_b32 s52, 0x3e0293ee
    s_mov_b32 s53, 0x41800000
    s_lshl_b32 s45, s40, 4
    s_add_u32 s45, s45, s41
    s_lshl_b32 s45, s45, 8
    s_lshl_b32 s46, s44, 6
    s_add_u32 s45, s45, s46
    s_add_u32 s45, s45, 0x7082000
    v_and_b32 v19, 15, v1
    v_lshlrev_b32 v19, 2, v19
    v_add_u32 v19, s45, v19
    s_mov_b32 s70, 0
    v_mov_b32 v41, 0
    s_branch L_hw_37_c
L_hw_37:
    buffer_load_dwordx2 v[44:45], v41, s[16:19], 0 offen sc1
    s_add_u32 s70, s70, 1
    s_cmp_ge_u32 s70, 0x100000
    s_cbranch_scc1 L_c_done_1
L_hw_37_c:
    s_waitcnt vmcnt(0)
    v_readfirstlane_b32 s45, v44
    v_readfirstlane_b32 s46, v45
    s_nop 3
    s_lshr_b32 s47, s46, 24
    s_cmp_lg_u32 s47, 64
    s_cbranch_scc1 L_hw_37
    s_lshr_b32 s68, s45, 24
    s_and_b32 s47, s45, 511
    s_mul_i32 s47, s47, s47
    s_bfe_u32 s45, s45, 0xf0009
    s_lshl_b32 s45, s45, 5
    s_sub_u32 s45, s45, s47
    s_and_b32 s47, s46, 511
    s_mul_i32 s47, s47, s47
    s_bfe_u32 s46, s46, 0xf0009
    s_lshl_b32 s46, s46, 5
    s_sub_u32 s46, s46, s47
    s_or_b32 s45, s45, s46
    s_cmp_eq_u32 s45, 0
    s_cselect_b32 s67, 1, 0
    s_mov_b32 s24, s12
    s_mov_b32 s25, s13
    s_mov_b32 s28, s12
    s_mov_b32 s29, s13
    s_cmp_eq_u32 s67, 1
    s_cselect_b32 s26, s14, 0
    s_cselect_b32 s30, 0, s14
    s_cmp_ge_u32 s68, 16
    s_cselect_b32 s68, 8192, 0
    s_mov_b32 s6, 0x11111111
    s_mov_b32 s7, 0xffaaa491
    s_mov_b32 s60, 0
    s_lshl_b32 s58, s40, 16
    s_add_u32 s58, s58, 0x7000000
    s_mov_b32 s61, s58
    s_lshl_b32 s59, s40, 17
    s_add_u32 s59, s59, 0x7040000
    s_mov_b32 s62, s59
    s_add_u32 s32, s41, 0
    s_and_b32 s32, s32, 3
    s_lshl_b32 s32, s32, 10
    s_add_u32 s33, s41, 1
    s_and_b32 s33, s33, 3
    s_lshl_b32 s33, s33, 10
    s_add_u32 s34, s41, 2
    s_and_b32 s34, s34, 3
    s_lshl_b32 s34, s34, 10
    s_add_u32 s35, s41, 3
    s_and_b32 s35, s35, 3
    s_lshl_b32 s35, s35, 10
    s_mov_b32 s47, 0
    s_cmp_lt_u32 s47, s50
    s_cbranch_scc1 L_kv_rdy_38
    s_lshl_b32 s45, s43, 7
    s_add_u32 s45, s45, 0x10014
    v_mov_b32 v0, 0
    s_mov_b32 s70, 0
L_kv_rdy_38_p:
    buffer_load_dwordx2 v[10:11], v0, s[12:15], s45 offen sc1
    s_add_u32 s70, s70, 1
    s_cmp_ge_u32 s70, 0x200000
    s_cbranch_scc1 L_c_done_1
    s_waitcnt vmcnt(0)
    v_min_u32 v10, v10, v11
    s_nop 0
    v_readfirstlane_b32 s50, v10
    s_nop 3
    s_cmp_lt_u32 s47, s50
    s_cbranch_scc1 L_kv_rdy_38
    s_sleep 2
    s_branch L_kv_rdy_38_p
L_kv_rdy_38:
    s_mov_b32 m0, s64
    s_add_u32 s46, s63, 0x1000000
    buffer_load_dwordx4 v3, s[12:15], s63 offen sc1 lds
    buffer_load_dwordx4 v3, s[12:15], s63 offen offset:1024 sc1 lds
    s_mov_b32 m0, s65
    s_add_u32 s63, s63, 8192
    buffer_load_dwordx4 v3, s[12:15], s46 offen sc1 lds
    buffer_load_dwordx4 v3, s[12:15], s46 offen offset:1024 sc1 lds
    s_add_u32 s64, s64, 16384
    s_add_u32 s65, s65, 16384
    s_cmp_lg_u32 s44, 0
    s_cbranch_scc1 L_ld_39
    v_mov_b32 v40, 1
    v_mov_b32 v41, 127360
    s_mov_b64 exec, 1
    buffer_atomic_add v40, v41, s[12:15], 0 offen sc1
    s_mov_b64 exec, -1
L_ld_39:
L_q_loop_40:
    ds_read_b128 v[56:59], v5 offset:8192
    ds_read_b128 v[60:63], v5 offset:9216
    ds_read_b128 v[64:67], v5 offset:20480
    ds_read_b128 v[68:71], v5 offset:21504
    ds_read_b128 v[72:75], v5 offset:14336
    ds_read_b128 v[76:79], v5 offset:15360
    ds_read_b128 v[80:83], v5 offset:22528
    ds_read_b128 v[84:87], v5 offset:23552
    ds_read_b128 v[88:91], v5 offset:2048
    ds_read_b128 v[92:95], v5 offset:3072
    s_add_u32 s46, s60, 1
    v_mov_b32 v15, s46
    v_mov_b32 v0, -1
    s_add_u32 s8, s61, s32
    s_add_u32 s9, s61, s33
    s_add_u32 s10, s61, s34
    s_add_u32 s11, s61, s35
    s_cmp_eq_u32 s60, 0
    s_cbranch_scc1 L_q_first_41
    s_sleep 16
    s_waitcnt vmcnt(0)
    s_mov_b64 exec, 65535
    buffer_load_dword v10, v19, s[12:15], 0 offen sc1
    s_nop 15
    buffer_load_dword v11, v19, s[12:15], 0 offen sc1
    s_nop 15
    buffer_load_dword v12, v19, s[12:15], 0 offen sc1
    s_nop 15
    buffer_load_dword v13, v19, s[12:15], 0 offen sc1
    s_mov_b32 s70, 0
L_pp_42:
    s_waitcnt vmcnt(3)
    v_cmp_gt_u32 vcc, s60, v10
    s_add_u32 s70, s70, 1
    s_nop 0
    s_cbranch_vccz L_ppd_43
    buffer_load_dword v10, v19, s[12:15], 0 offen sc1
    s_waitcnt vmcnt(3)
    v_cmp_gt_u32 vcc, s60, v11
    s_add_u32 s70, s70, 1
    s_nop 0
    s_cbranch_vccz L_ppd_43
    buffer_load_dword v11, v19, s[12:15], 0 offen sc1
    s_waitcnt vmcnt(3)
    v_cmp_gt_u32 vcc, s60, v12
    s_add_u32 s70, s70, 1
    s_nop 0
    s_cbranch_vccz L_ppd_43
    buffer_load_dword v12, v19, s[12:15], 0 offen sc1
    s_waitcnt vmcnt(3)
    v_cmp_gt_u32 vcc, s60, v13
    s_add_u32 s70, s70, 1
    s_nop 0
    s_cbranch_vccz L_ppd_43
    buffer_load_dword v13, v19, s[12:15], 0 offen sc1
    s_cmp_lt_u32 s70, 0x400000
    s_cbranch_scc1 L_pp_42
    s_branch L_c_done_1
L_ppd_43:
    s_mov_b64 exec, -1
L_q_first_41:
    s_waitcnt lgkmcnt(0)
    buffer_load_dwordx4 v[40:43], v3, s[12:15], s8 offen sc1
    v_mov_b32 v24, 0
    v_mov_b32 v25, 0
    v_mov_b32 v26, 0
    v_mov_b32 v27, 0
    v_mov_b32 v28, 0
    buffer_load_dwordx4 v[44:47], v3, s[12:15], s9 offen sc1
    v_mov_b32 v29, 0
    v_mov_b32 v30, 0
    v_mov_b32 v31, 0
    v_mov_b32 v32, 0
    v_mov_b32 v33, 0
    buffer_load_dwordx4 v[48:51], v3, s[12:15], s10 offen sc1
    v_mov_b32 v34, 0
    v_mov_b32 v35, 0
    v_mov_b32 v36, 0
    v_mov_b32 v37, 0
    v_mov_b32 v38, 0
    buffer_load_dwordx4 v[52:55], v3, s[12:15], s11 offen sc1
    s_mov_b32 s70, 0
    v_mov_b32 v39, 0
L_mg_44_p:
    s_waitcnt vmcnt(3)
    ds_write_b128 v3, v[40:43] offset:0
    v_smfmac_f32_16x16x64_bf16 v[24:27], v[40:43], a[0:7], v2
    s_waitcnt vmcnt(2)
    ds_write_b128 v3, v[44:47] offset:1024
    v_smfmac_f32_16x16x64_bf16 v[28:31], v[40:43], a[8:15], v2
    s_waitcnt vmcnt(1)
    ds_write_b128 v3, v[48:51] offset:2048
    v_smfmac_f32_16x16x64_bf16 v[32:35], v[40:43], a[16:23], v2
    s_waitcnt vmcnt(0)
    ds_write_b128 v3, v[52:55] offset:3072
    v_smfmac_f32_16x16x64_bf16 v[36:39], v[40:43], a[24:31], v2
    v_max3_u32 v22, v40, v41, v42
    v_max3_u32 v22, v22, v43, v44
    v_max3_u32 v22, v22, v45, v46
    v_smfmac_f32_16x16x64_bf16 v[24:27], v[44:47], a[32:39], v2
    v_max3_u32 v22, v22, v47, v48
    v_max3_u32 v22, v22, v49, v50
    v_smfmac_f32_16x16x64_bf16 v[28:31], v[44:47], a[40:47], v2
    v_max3_u32 v22, v22, v51, v52
    v_max3_u32 v22, v22, v53, v54
    v_smfmac_f32_16x16x64_bf16 v[32:35], v[44:47], a[48:55], v2
    v_max_u32 v22, v22, v55
    v_cmp_eq_u32 vcc, -1, v22
    v_smfmac_f32_16x16x64_bf16 v[36:39], v[44:47], a[56:63], v2
    s_waitcnt lgkmcnt(0)
    s_cbranch_vccnz L_mg_44_r
    s_barrier
    ds_read_b128 v[40:43], v4 offset:0
    ds_read_b128 v[44:47], v4 offset:1024
    v_smfmac_f32_16x16x64_bf16 v[24:27], v[48:51], a[64:71], v2
    v_smfmac_f32_16x16x64_bf16 v[28:31], v[48:51], v[56:63], v2
    ds_read_b128 v[56:59], v5 offset:6144
    v_smfmac_f32_16x16x64_bf16 v[32:35], v[48:51], a[72:79], v2
    ds_read_b128 v[60:63], v5 offset:7168
    v_smfmac_f32_16x16x64_bf16 v[36:39], v[48:51], v[64:71], v2
    ds_read_b128 v[48:51], v4 offset:2048
    v_smfmac_f32_16x16x64_bf16 v[24:27], v[52:55], a[80:87], v2
    ds_read_b128 v[64:67], v5 offset:12288
    v_smfmac_f32_16x16x64_bf16 v[28:31], v[52:55], v[72:79], v2
    ds_read_b128 v[68:71], v5 offset:13312
    v_smfmac_f32_16x16x64_bf16 v[32:35], v[52:55], a[88:95], v2
    ds_read_b128 v[72:75], v5 offset:18432
    v_smfmac_f32_16x16x64_bf16 v[36:39], v[52:55], v[80:87], v2
    ds_read_b128 v[52:55], v4 offset:3072
    ds_read_b128 v[76:79], v5 offset:19456
    s_waitcnt lgkmcnt(5)
    v_smfmac_f32_16x16x64_bf16 v[24:27], v[40:43], a[96:103], v2
    ds_read_b128 v[80:83], v5 offset:0
    v_smfmac_f32_16x16x64_bf16 v[28:31], v[40:43], v[88:95], v2
    ds_read_b128 v[84:87], v5 offset:1024
    v_smfmac_f32_16x16x64_bf16 v[32:35], v[40:43], a[104:111], v2
    ds_read_b128 v[88:91], v5 offset:4096
    v_smfmac_f32_16x16x64_bf16 v[36:39], v[40:43], a[112:119], v2
    ds_read_b128 v[40:43], v21 offset:0
    v_smfmac_f32_16x16x64_bf16 v[24:27], v[44:47], a[120:127], v2
    ds_read_b128 v[92:95], v5 offset:5120
    v_smfmac_f32_16x16x64_bf16 v[28:31], v[44:47], v[56:63], v2
    ds_read_b128 v[56:59], v5 offset:10240
    v_smfmac_f32_16x16x64_bf16 v[32:35], v[44:47], a[128:135], v2
    ds_read_b128 v[60:63], v5 offset:11264
    v_smfmac_f32_16x16x64_bf16 v[36:39], v[44:47], a[136:143], v2
    ds_read_b128 v[44:47], v21 offset:1024
    v_smfmac_f32_16x16x64_bf16 v[24:27], v[48:51], a[144:151], v2
    s_waitcnt lgkmcnt(3)
    v_smfmac_f32_16x16x64_bf16 v[28:31], v[48:51], v[64:71], v2
    ds_read_b128 v[48:51], v21 offset:2048
    v_smfmac_f32_16x16x64_bf16 v[24:27], v[52:55], a[168:175], v2
    ds_read_b128 v[64:67], v5 offset:16384
    v_smfmac_f32_16x16x64_bf16 v[28:31], v[52:55], v[72:79], v2
    ds_read_b128 v[52:55], v21 offset:3072
    v_smfmac_f32_16x16x64_bf16 v[24:27], v[40:43], a[192:199], v2
    ds_read_b128 v[68:71], v5 offset:17408
    v_smfmac_f32_16x16x64_bf16 v[28:31], v[40:43], v[80:87], v2
    ds_read_b128 v[40:43], v23 offset:0
    s_waitcnt lgkmcnt(4)
    v_smfmac_f32_16x16x64_bf16 v[24:27], v[44:47], a[216:223], v2
    v_smfmac_f32_16x16x64_bf16 v[28:31], v[44:47], v[88:95], v2
    ds_read_b128 v[44:47], v23 offset:1024
    v_smfmac_f32_16x16x64_bf16 v[24:27], v[48:51], a[240:247], v2
    v_smfmac_f32_16x16x64_bf16 v[28:31], v[48:51], v[56:63], v2
    ds_read_b128 v[48:51], v23 offset:2048
    s_waitcnt lgkmcnt(2)
    v_smfmac_f32_16x16x64_bf16 v[24:27], v[52:55], v[104:111], v2
    v_smfmac_f32_16x16x64_bf16 v[28:31], v[52:55], v[64:71], v2
    ds_read_b128 v[52:55], v23 offset:3072
    v_smfmac_f32_16x16x64_bf16 v[24:27], v[40:43], v[128:135], v2
    ds_read_b128 v[72:75], v8 offset:20480
    v_smfmac_f32_16x16x64_bf16 v[28:31], v[40:43], v[136:143], v2
    ds_read_b128 v[76:79], v8 offset:21504
    s_waitcnt lgkmcnt(3)
    v_smfmac_f32_16x16x64_bf16 v[24:27], v[44:47], v[160:167], v2
    ds_read_b128 v[56:59], v8 offset:16384
    v_smfmac_f32_16x16x64_bf16 v[28:31], v[44:47], v[168:175], v2
    ds_read_b128 v[60:63], v8 offset:17408
    v_smfmac_f32_16x16x64_bf16 v[24:27], v[48:51], v[192:199], v2
    ds_read_b128 v[64:67], v8 offset:18432
    v_smfmac_f32_16x16x64_bf16 v[28:31], v[48:51], v[200:207], v2
    ds_read_b128 v[68:71], v8 offset:19456
    s_waitcnt lgkmcnt(4)
    v_smfmac_f32_16x16x64_bf16 v[24:27], v[52:55], v[224:231], v2
    v_smfmac_f32_16x16x64_bf16 v[28:31], v[52:55], v[232:239], v2
    v_smfmac_f32_16x16x64_bf16 v[32:35], v[52:55], v[240:247], v2
    v_smfmac_f32_16x16x64_bf16 v[36:39], v[52:55], v[248:255], v2
    ds_read_b128 v[52:55], v21 offset:3072
    v_smfmac_f32_16x16x64_bf16 v[32:35], v[48:51], v[208:215], v2
    s_nop 3
    v_permlane32_swap_b32 v24, v28
    v_permlane32_swap_b32 v25, v29
    v_smfmac_f32_16x16x64_bf16 v[36:39], v[48:51], v[216:223], v2
    ds_read_b128 v[48:51], v21 offset:2048
    v_permlane32_swap_b32 v26, v30
    v_smfmac_f32_16x16x64_bf16 v[32:35], v[44:47], v[176:183], v2
    v_permlane32_swap_b32 v27, v31
    v_add_f32 v24, v24, v28
    v_smfmac_f32_16x16x64_bf16 v[36:39], v[44:47], v[184:191], v2
    ds_read_b128 v[44:47], v21 offset:1024
    v_add_f32 v25, v25, v29
    v_smfmac_f32_16x16x64_bf16 v[32:35], v[40:43], v[144:151], v2
    v_add_f32 v26, v26, v30
    v_add_f32 v27, v27, v31
    v_smfmac_f32_16x16x64_bf16 v[36:39], v[40:43], v[152:159], v2
    ds_read_b128 v[40:43], v21 offset:0
    v_cvt_pk_bf16_f32 v24, v24, v25
    s_waitcnt lgkmcnt(2)
    v_smfmac_f32_16x16x64_bf16 v[32:35], v[52:55], v[112:119], v2
    v_cvt_pk_bf16_f32 v25, v26, v27
    v_smfmac_f32_16x16x64_bf16 v[36:39], v[52:55], v[120:127], v2
    ds_read_b128 v[52:55], v4 offset:3072
    v_smfmac_f32_16x16x64_bf16 v[32:35], v[48:51], a[248:255], v2
    ds_write_b64 v6, v[24:25]
    v_smfmac_f32_16x16x64_bf16 v[36:39], v[48:51], v[96:103], v2
    ds_read_b128 v[48:51], v4 offset:2048
    s_waitcnt lgkmcnt(3)
    v_smfmac_f32_16x16x64_bf16 v[32:35], v[44:47], a[224:231], v2
    v_smfmac_f32_16x16x64_bf16 v[36:39], v[44:47], a[232:239], v2
    s_waitcnt lgkmcnt(1)
    s_barrier
    ds_read_b64_tr_b16 v[80:81], v7 offset:0
    v_smfmac_f32_16x16x64_bf16 v[32:35], v[40:43], a[200:207], v2
    ds_read_b64_tr_b16 v[82:83], v7 offset:64
    ds_read_b64_tr_b16 v[84:85], v7 offset:512
    v_smfmac_f32_16x16x64_bf16 v[36:39], v[40:43], a[208:215], v2
    ds_read_b64_tr_b16 v[86:87], v7 offset:576
    ds_read_b64_tr_b16 v[88:89], v7 offset:1024
    v_smfmac_f32_16x16x64_bf16 v[32:35], v[52:55], a[176:183], v2
    ds_read_b64_tr_b16 v[90:91], v7 offset:1088
    v_smfmac_f32_16x16x64_bf16 v[36:39], v[52:55], a[184:191], v2
    ds_read_b64_tr_b16 v[92:93], v7 offset:1536
    s_waitcnt lgkmcnt(6)
    v_smfmac_f32_16x16x64_bf16 v[32:35], v[48:51], a[152:159], v2
    ds_read_b64_tr_b16 v[94:95], v7 offset:1600
    v_smfmac_f32_16x16x64_bf16 v[36:39], v[48:51], a[160:167], v2
    s_waitcnt lgkmcnt(3)
    v_mfma_f32_16x16x32_bf16 v[24:27], v[56:59], v[80:83], 0
    ds_read_b128 v[56:59], v8 offset:22528
    v_mfma_f32_16x16x32_bf16 v[28:31], v[60:63], v[80:83], 0
    ds_read_b128 v[60:63], v8 offset:23552
    v_mfma_f32_16x16x32_bf16 v[24:27], v[64:67], v[84:87], v[24:27]
    s_nop 1
    v_cvt_pk_bf16_f32 v32, v32, v33
    v_cvt_pk_bf16_f32 v33, v34, v35
    v_cvt_pk_bf16_f32 v34, v36, v37
    v_cvt_pk_bf16_f32 v35, v38, v39
    ds_write2_b64 v18, v[32:33], v[34:35] offset1:32
    v_mfma_f32_16x16x32_bf16 v[28:31], v[68:71], v[84:87], v[28:31]
    s_waitcnt lgkmcnt(3)
    v_mfma_f32_16x16x32_bf16 v[24:27], v[72:75], v[88:91], v[24:27]
    ds_read_b64_tr_b16 v[64:65], v9 offset:24576
    v_mfma_f32_16x16x32_bf16 v[28:31], v[76:79], v[88:91], v[28:31]
    ds_read_b64_tr_b16 v[66:67], v9 offset:25600
    s_waitcnt lgkmcnt(3)
    v_mfma_f32_16x16x32_bf16 v[24:27], v[56:59], v[92:95], v[24:27]
    ds_read_b64_tr_b16 v[68:69], v9 offset:25088
    v_mfma_f32_16x16x32_bf16 v[28:31], v[60:63], v[92:95], v[28:31]
    ds_read_b64_tr_b16 v[70:71], v9 offset:26112
    v_mov_b32 v57, 0
    v_mov_b32 v58, 0
    s_cmp_eq_u32 s60, 63
    s_waitcnt lgkmcnt(4)
    s_barrier
    ds_read_b64_tr_b16 v[40:41], v14 offset:55296
    ds_read_b64_tr_b16 v[42:43], v14 offset:55816
    ds_read_b64_tr_b16 v[44:45], v14 offset:56336
    ds_read_b64_tr_b16 v[46:47], v14 offset:56856
    ds_read_b64_tr_b16 v[48:49], v14 offset:57376
    ds_read_b64_tr_b16 v[50:51], v14 offset:57896
    ds_read_b64_tr_b16 v[52:53], v14 offset:58416
    ds_read_b64_tr_b16 v[54:55], v14 offset:58936
    s_cbranch_scc1 L_q_last_45
    v_max3_f32 v11, v24, v25, v26
    v_max3_f32 v13, v27, v28, v29
    v_max3_f32 v11, v11, v30, v31
    v_max_f32 v12, v11, v13
    v_max_f32 v13, v11, v13
    v_mov_b32 v32, 0x3f803f80
    v_mov_b32 v33, 0x3f803f80
    v_mov_b32 v34, 0x3f803f80
    v_mov_b32 v35, 0x3f803f80
    buffer_load_dwordx2 v[0:1], v16, s[12:15], s51 offen sc1
    s_waitcnt lgkmcnt(4)
    v_mfma_f32_16x16x32_bf16 v[36:39], v[40:43], v[80:83], 0
    v_permlane32_swap_b32 v12, v13
    v_mfma_f32_16x16x32_bf16 v[36:39], v[44:47], v[84:87], v[36:39]
    v_max_f32 v22, v12, v13
    v_max_f32 v13, v12, v13
    s_waitcnt lgkmcnt(0)
    v_mfma_f32_16x16x32_bf16 v[36:39], v[48:51], v[88:91], v[36:39]
    v_permlane16_swap_b32 v22, v13
    v_mfma_f32_16x16x32_bf16 v[36:39], v[52:55], v[92:95], v[36:39]
    v_max_f32 v11, v22, v13
    v_mul_f32 v10, s52, v11
    v_fma_f32 v24, v24, s52, -v10
    v_fma_f32 v25, v25, s52, -v10
    v_fma_f32 v26, v26, s52, -v10
    v_fma_f32 v27, v27, s52, -v10
    v_fma_f32 v28, v28, s52, -v10
    v_fma_f32 v29, v29, s52, -v10
    v_fma_f32 v30, v30, s52, -v10
    v_fma_f32 v31, v31, s52, -v10
    v_exp_f32 v24, v24
    v_exp_f32 v25, v25
    v_exp_f32 v26, v26
    v_exp_f32 v27, v27
    v_exp_f32 v28, v28
    v_exp_f32 v29, v29
    v_exp_f32 v30, v30
    v_exp_f32 v31, v31
    v_cvt_pk_bf16_f32 v60, v24, v25
    v_cvt_pk_bf16_f32 v61, v26, v27
    v_cvt_pk_bf16_f32 v62, v28, v29
    v_cvt_pk_bf16_f32 v63, v30, v31
    v_permlane32_swap_b32 v36, v38
    v_permlane32_swap_b32 v37, v39
    v_mfma_f32_16x16x32_bf16 v[72:75], v[64:67], v[60:63], 0
    v_add_f32 v36, v36, v38
    v_add_f32 v37, v37, v39
    v_mfma_f32_16x16x32_bf16 v[76:79], v[68:71], v[60:63], 0
    v_fma_f32 v12, v36, s52, -v10
    v_fma_f32 v13, v37, s52, -v10
    v_mfma_f32_16x16x32_bf16 v[24:27], v[32:35], v[60:63], 0
    buffer_store_dword v15, v20, s[24:27], 0 offen
    v_exp_f32 v36, v12
    v_exp_f32 v37, v13
    v_max_f32 v11, v12, v13
    s_waitcnt vmcnt(1)
    v_max_u32 v22, v0, v1
    v_cmp_lt_f32 s[8:9], s53, v11
    v_cmp_eq_u32 vcc, -1, v22
    v_cvt_pk_bf16_f32 v56, v36, v37
    v_cvt_pk_bf16_f32 v59, v36, v37
    s_or_b64 s[10:11], vcc, s[8:9]
    s_cbranch_scc1 L_q_vm_46_s
L_q_vm_46_j:
    v_mfma_f32_16x16x16_bf16 v[24:27], v[32:33], v[56:57], v[24:27]
    v_mfma_f32_16x16x16_bf16 v[72:75], v[0:1], v[56:57], v[72:75]
    v_mfma_f32_16x16x16_bf16 v[76:79], v[0:1], v[58:59], v[76:79]
    s_nop 5
    v_rcp_f32 v12, v24
    s_nop 0
    v_pk_mul_f32 v[72:73], v[72:73], v[12:13] op_sel_hi:[1,0]
    v_pk_mul_f32 v[74:75], v[74:75], v[12:13] op_sel_hi:[1,0]
    v_pk_mul_f32 v[76:77], v[76:77], v[12:13] op_sel_hi:[1,0]
    v_pk_mul_f32 v[78:79], v[78:79], v[12:13] op_sel_hi:[1,0]
    v_cvt_pk_bf16_f32 v72, v72, v73
    v_cvt_pk_bf16_f32 v73, v74, v75
    v_cvt_pk_bf16_f32 v74, v76, v77
    v_cvt_pk_bf16_f32 v75, v78, v79
    buffer_store_dwordx4 v[72:75], v17, s[24:27], s62 offen
    buffer_store_dwordx4 v[72:75], v17, s[28:31], s62 offen sc1
    buffer_store_dword v15, v20, s[28:31], 0 offen sc1
    v_mov_b32 v60, -1
    v_mov_b32 v61, -1
    v_mov_b32 v62, -1
    v_mov_b32 v63, -1
    s_add_u32 s45, s60, 3
    s_and_b32 s45, s45, 3
    s_lshl_b32 s45, s45, 15
    s_add_u32 s45, s45, s59
    buffer_store_dwordx4 v[60:63], v17, s[24:27], s45 offen
    buffer_store_dwordx4 v[60:63], v17, s[28:31], s45 offen sc1
    s_barrier
    s_and_b32 s45, s51, 0xffff
    s_lshl_b32 s46, s60, 16
    s_add_u32 s45, s45, s46
    s_add_u32 s45, s45, 0x1800000
    buffer_store_dwordx2 v[0:1], v16, s[12:15], s45 offen sc1
L_q_last_45:
    s_waitcnt lgkmcnt(0)
    v_lshlrev_b32 v22, 1, v16
    s_cmp_lg_u32 s44, 0
    s_cbranch_scc1 L_q_km_47_0
    buffer_store_dwordx4 v[40:43], v22, s[12:15], s66 offen offset:0 sc1
L_q_km_47_0:
    s_cmp_lg_u32 s44, 1
    s_cbranch_scc1 L_q_km_47_1
    buffer_store_dwordx4 v[44:47], v22, s[12:15], s66 offen offset:1024 sc1
L_q_km_47_1:
    s_cmp_lg_u32 s44, 2
    s_cbranch_scc1 L_q_km_47_2
    buffer_store_dwordx4 v[48:51], v22, s[12:15], s66 offen offset:2048 sc1
L_q_km_47_2:
    s_cmp_lg_u32 s44, 3
    s_cbranch_scc1 L_q_km_47_3
    buffer_store_dwordx4 v[52:55], v22, s[12:15], s66 offen offset:3072 sc1
L_q_km_47_3:
    s_cmp_eq_u32 s60, 63
    s_cbranch_scc1 L_q_fin_48
    s_cmp_eq_u32 s60, 62
    s_cbranch_scc1 L_q_fin_48_n
    s_add_u32 s47, s60, 1
    s_cmp_lt_u32 s47, s50
    s_cbranch_scc1 L_kv_rdy_49
    s_lshl_b32 s45, s43, 7
    s_add_u32 s45, s45, 0x10014
    v_mov_b32 v0, 0
    s_mov_b32 s70, 0
L_kv_rdy_49_p:
    buffer_load_dwordx2 v[10:11], v0, s[12:15], s45 offen sc1
    s_add_u32 s70, s70, 1
    s_cmp_ge_u32 s70, 0x200000
    s_cbranch_scc1 L_c_done_1
    s_waitcnt vmcnt(0)
    v_min_u32 v10, v10, v11
    s_nop 0
    v_readfirstlane_b32 s50, v10
    s_nop 3
    s_cmp_lt_u32 s47, s50
    s_cbranch_scc1 L_kv_rdy_49
    s_sleep 2
    s_branch L_kv_rdy_49_p
L_kv_rdy_49:
    s_mov_b32 m0, s64
    s_add_u32 s46, s63, 0x1000000
    buffer_load_dwordx4 v3, s[12:15], s63 offen sc1 lds
    buffer_load_dwordx4 v3, s[12:15], s63 offen offset:1024 sc1 lds
    s_mov_b32 m0, s65
    s_add_u32 s63, s63, 8192
    buffer_load_dwordx4 v3, s[12:15], s46 offen sc1 lds
    buffer_load_dwordx4 v3, s[12:15], s46 offen offset:1024 sc1 lds
    s_branch L_q_fin_48_k
L_q_fin_48_n:
    s_waitcnt vmcnt(0)
L_q_fin_48_k:
    s_add_u32 s47, s60, 1
    s_bitcmp1_b64 s[6:7], s47
    s_cselect_b32 s47, s47, s60
    s_cbranch_scc0 L_q_fin_48_m
    s_waitcnt vmcnt(4)
L_q_fin_48_m:
    v_mov_b32 v22, s47
    v_mov_b32 v0, 0
    s_mov_b64 exec, 1
    buffer_store_dword v22, v0, s[12:15], s3 offen sc1
    s_mov_b64 exec, -1
    s_mov_b64 exec, -1
    v_add_u32 v8, s69, v8
    v_add_u32 v9, s69, v9
    s_sub_u32 s64, s64, s69
    s_sub_u32 s65, s65, s69
    s_sub_u32 s69, 0, s69
    s_add_u32 s66, s66, 131072
    s_xor_b32 s51, s51, 65536
    s_add_u32 s60, s60, 1
    s_and_b32 s45, s60, 3
    s_lshl_b32 s46, s45, 14
    s_add_u32 s61, s58, s46
    s_lshl_b32 s46, s45, 15
    s_add_u32 s62, s59, s46
    s_branch L_q_loop_40
L_q_fin_48:
    s_waitcnt vmcnt(0)
    v_mov_b32 v22, 64
    v_mov_b32 v0, 0
    s_mov_b64 exec, 1
    buffer_store_dword v22, v0, s[12:15], s3 offen sc1
    s_mov_b64 exec, -1
    s_endpgm
L_mg_44_r:
    buffer_load_dwordx4 v[40:43], v3, s[12:15], s8 offen sc1
    buffer_load_dwordx4 v[44:47], v3, s[12:15], s9 offen sc1
    buffer_load_dwordx4 v[48:51], v3, s[12:15], s10 offen sc1
    buffer_load_dwordx4 v[52:55], v3, s[12:15], s11 offen sc1
    s_add_u32 s70, s70, 1
    s_cmp_ge_u32 s70, 0x100000
    s_cbranch_scc1 L_c_done_1
    s_nop 1
    v_mov_b32 v24, 0
    v_mov_b32 v25, 0
    v_mov_b32 v26, 0
    v_mov_b32 v27, 0
    v_mov_b32 v28, 0
    v_mov_b32 v29, 0
    v_mov_b32 v30, 0
    v_mov_b32 v31, 0
    v_mov_b32 v32, 0
    v_mov_b32 v33, 0
    v_mov_b32 v34, 0
    v_mov_b32 v35, 0
    v_mov_b32 v36, 0
    v_mov_b32 v37, 0
    v_mov_b32 v38, 0
    v_mov_b32 v39, 0
    s_branch L_mg_44_p
L_q_vm_46_s:
    s_cbranch_vccz L_q_vm_46_t
    buffer_load_dwordx2 v[0:1], v16, s[12:15], s51 offen sc1
    s_add_u32 s70, s70, 1
    s_nop 0
    s_cmp_ge_u32 s70, 0x100000
    s_cbranch_scc1 L_c_done_1
    s_waitcnt vmcnt(0)
    v_max_u32 v22, v0, v1
    v_cmp_eq_u32 vcc, -1, v22
    s_nop 1
    s_branch L_q_vm_46_s
L_q_vm_46_t:
    s_cmp_eq_u64 s[8:9], 0
    s_cbranch_scc1 L_q_vm_46_j
    v_max_f32 v11, 0, v11
    v_mov_b32 v22, v11
    s_nop 1
    v_permlane32_swap_b32 v11, v22
    v_max_f32 v11, v11, v22
    v_mov_b32 v22, v11
    s_nop 1
    v_permlane16_swap_b32 v11, v22
    v_max_f32 v11, v11, v22
    v_sub_f32 v12, v12, v11
    v_sub_f32 v13, v13, v11
    v_sub_f32 v11, 0, v11
    v_exp_f32 v36, v12
    v_exp_f32 v37, v13
    v_exp_f32 v11, v11
    s_nop 7
    v_mul_f32 v72, v72, v11
    v_mul_f32 v73, v73, v11
    v_mul_f32 v74, v74, v11
    v_mul_f32 v75, v75, v11
    v_mul_f32 v76, v76, v11
    v_mul_f32 v77, v77, v11
    v_mul_f32 v78, v78, v11
    v_mul_f32 v79, v79, v11
    v_mul_f32 v24, v24, v11
    v_cvt_pk_bf16_f32 v56, v36, v37
    v_cvt_pk_bf16_f32 v59, v36, v37
    s_nop 1
    s_branch L_q_vm_46_j
L_c_vo_2:
    s_lshl_b32 s45, s43, 11
    s_lshl_b32 s46, s44, 9
    s_add_u32 s45, s45, s46
    v_lshlrev_b32 v10, 3, v1
    v_add_u32 v10, s45, v10
    v_lshlrev_b32 v11, 3, v0
    v_bfe_u32 v69, v1, 4, 1
    v_lshlrev_b32 v69, 2, v69
    v_lshrrev_b32 v63, 5, v1
    v_lshlrev_b32 v63, 1, v63
    v_and_b32 v64, 1, v1
    v_add3_u32 v69, v69, v63, v64
    v_bfe_u32 v63, v1, 1, 1
    v_lshlrev_b32 v63, 3, v63
    v_add_u32 v63, v63, v69
    v_lshlrev_b32 v63, 4, v63
    v_bfe_u32 v64, v1, 2, 2
    v_lshlrev_b32 v64, 2, v64
    s_lshl_b32 s45, s42, 10
    s_lshl_b32 s46, s44, 8
    s_add_u32 s45, s45, s46
    v_add3_u32 v12, v63, v64, s45
    v_and_b32 v64, 1, v1
    v_cmp_eq_u32 vcc, 0, v64
    v_mov_b32 v9, 0x07060302
    v_mov_b32 v63, 0x01000504
    v_cndmask_b32 v9, v9, v63, vcc
    s_lshl_b32 s63, s40, 19
    s_lshl_b32 s45, s42, 15
    s_add_u32 s63, s63, s45
    s_add_u32 s63, s63, 0x7100000
    s_xor_b32 s64, s63, 524288
    s_lshl_b32 s45, s40, 12
    s_lshl_b32 s46, s44, 2
    s_add_u32 s45, s45, s46
    s_lshl_b32 s46, s42, 4
    s_add_u32 s45, s45, s46
    s_add_u32 s45, s45, 0x7082000
    v_lshlrev_b32 v20, 8, v1
    v_add_u32 v20, s45, v20
    v_mov_b32 v63, 0x20000000
    v_cmp_gt_u32 vcc, 16, v1
    s_nop 1
    v_cndmask_b32 v20, v63, v20, vcc
    buffer_store_dword v44, v20, s[12:15], 0 offen sc1
    s_mov_b32 s45, 0x7020000
    buffer_store_dwordx2 v[40:41], v10, s[12:15], s45 offen sc1
    s_mov_b32 s45, 0x7030000
    buffer_store_dwordx2 v[40:41], v10, s[12:15], s45 offen sc1
    s_add_u32 s45, s63, 0
    buffer_store_dwordx2 v[40:41], v11, s[12:15], s45 offen sc1
    s_add_u32 s45, s63, 4096
    buffer_store_dwordx2 v[40:41], v11, s[12:15], s45 offen sc1
    s_add_u32 s45, s63, 8192
    buffer_store_dwordx2 v[40:41], v11, s[12:15], s45 offen sc1
    s_add_u32 s45, s63, 12288
    buffer_store_dwordx2 v[40:41], v11, s[12:15], s45 offen sc1
    s_add_u32 s45, s63, 16384
    buffer_store_dwordx2 v[40:41], v11, s[12:15], s45 offen sc1
    s_add_u32 s45, s63, 20480
    buffer_store_dwordx2 v[40:41], v11, s[12:15], s45 offen sc1
    s_add_u32 s45, s63, 24576
    buffer_store_dwordx2 v[40:41], v11, s[12:15], s45 offen sc1
    s_add_u32 s45, s63, 28672
    buffer_store_dwordx2 v[40:41], v11, s[12:15], s45 offen sc1
    s_lshl_b32 s61, s40, 16
    s_add_u32 s61, s61, 0x7000000
    s_add_u32 s45, s61, 16384
    buffer_store_dword v40, v12, s[12:15], s45 offen sc1
    s_add_u32 s45, s61, 32768
    buffer_store_dword v40, v12, s[12:15], s45 offen sc1
    s_add_u32 s45, s61, 49152
    buffer_store_dword v40, v12, s[12:15], s45 offen sc1
    v_lshlrev_b32 v63, 11, v69
    v_and_b32 v64, 14, v1
    v_lshlrev_b32 v64, 1, v64
    v_add_u32 v63, v63, v64
    s_lshl_b32 s45, s42, 7
    s_lshl_b32 s46, s44, 5
    s_add_u32 s45, s45, s46
    buffer_load_dword v45, v63, s[52:55], s45 offen
    s_mov_b32 s76, -1
    s_mov_b32 s77, -1
    v_lshrrev_b32 v63, 3, v1
    v_lshlrev_b32 v63, 11, v63
    v_bfe_u32 v64, v1, 1, 2
    v_and_b32 v65, 1, v1
    v_lshlrev_b32 v65, 4, v65
    v_add_u32 v63, v63, v65
    v_xor_b32 v66, 0, v64
    v_lshlrev_b32 v66, 5, v66
    v_add_u32 v70, v63, v66
    v_xor_b32 v66, 1, v64
    v_lshlrev_b32 v66, 5, v66
    v_add_u32 v71, v63, v66
    v_xor_b32 v66, 2, v64
    v_lshlrev_b32 v66, 5, v66
    v_add_u32 v72, v63, v66
    v_xor_b32 v66, 3, v64
    v_lshlrev_b32 v66, 5, v66
    v_add_u32 v73, v63, v66
    v_bfe_u32 v63, v1, 3, 1
    v_lshlrev_b32 v63, 1, v63
    v_bfe_u32 v64, v1, 4, 1
    v_add_u32 v63, v63, v64
    v_lshlrev_b32 v64, 3, v63
    v_lshrrev_b32 v65, 5, v1
    v_lshlrev_b32 v65, 2, v65
    v_add_u32 v64, v64, v65
    v_bfe_u32 v65, v1, 2, 1
    v_add_u32 v64, v64, v65
    v_lshlrev_b32 v64, 7, v64
    v_and_b32 v65, 3, v1
    v_lshlrev_b32 v65, 3, v65
    v_add_u32 v64, v64, v65
    s_lshl_b32 s45, s44, 12
    v_add_u32 v64, s45, v64
    s_add_u32 s45, s44, 1
    s_and_b32 s45, s45, 3
    v_xor_b32 v65, s45, v63
    v_lshlrev_b32 v65, 5, v65
    v_add_u32 v74, v64, v65
    s_mul_i32 s45, s44, 20480
    s_add_u32 s45, s45, 65536
    v_add_u32 v88, s45, v74
    s_add_u32 s45, s44, 2
    s_and_b32 s45, s45, 3
    v_xor_b32 v65, s45, v63
    v_lshlrev_b32 v65, 5, v65
    v_add_u32 v75, v64, v65
    s_mul_i32 s45, s44, 20480
    s_add_u32 s45, s45, 65536
    v_add_u32 v89, s45, v75
    s_add_u32 s45, s44, 3
    s_and_b32 s45, s45, 3
    v_xor_b32 v65, s45, v63
    v_lshlrev_b32 v65, 5, v65
    v_add_u32 v76, v64, v65
    s_mul_i32 s45, s44, 20480
    s_add_u32 s45, s45, 65536
    v_add_u32 v90, s45, v76
    s_add_u32 s45, s44, 4
    s_and_b32 s45, s45, 3
    v_xor_b32 v65, s45, v63
    v_lshlrev_b32 v65, 5, v65
    v_add_u32 v77, v64, v65
    s_mul_i32 s45, s44, 20480
    s_add_u32 s45, s45, 65536
    v_add_u32 v91, s45, v77
    s_mul_i32 s65, s44, 24576
    s_lshl_b32 s49, s40, 22
    s_lshl_b32 s45, s44, 20
    s_add_u32 s49, s49, s45
    s_lshl_b32 s45, s42, 7
    s_add_u32 s49, s49, s45
    s_lshl_b32 s50, s44, 12
    s_mul_i32 s69, s42, 1
    s_add_u32 s51, s69, 0
    s_and_b32 s51, s51, 7
    s_lshl_b32 s51, s51, 17
    s_add_u32 s51, s51, s49
    s_add_u32 s46, s51, 0x0
    s_add_u32 m0, s65, 65536
    s_nop 0
    buffer_load_dwordx4 v70, s[36:39], s46 offen  lds
    s_add_u32 s46, s51, 0x8000
    s_add_u32 m0, s65, 66560
    s_nop 0
    buffer_load_dwordx4 v71, s[36:39], s46 offen  lds
    s_add_u32 s46, s51, 0x10000
    s_add_u32 m0, s65, 67584
    s_nop 0
    buffer_load_dwordx4 v72, s[36:39], s46 offen  lds
    s_add_u32 s46, s51, 0x18000
    s_add_u32 m0, s65, 68608
    s_nop 0
    buffer_load_dwordx4 v73, s[36:39], s46 offen  lds
    s_add_u32 s51, s69, 0
    s_and_b32 s51, s51, 7
    s_lshl_b32 s51, s51, 17
    s_add_u32 s51, s51, s49
    s_add_u32 s46, s51, 0x4000
    s_add_u32 m0, s65, 69632
    s_nop 0
    buffer_load_dwordx4 v70, s[36:39], s46 offen  lds
    s_add_u32 s46, s51, 0xc000
    s_add_u32 m0, s65, 70656
    s_nop 0
    buffer_load_dwordx4 v71, s[36:39], s46 offen  lds
    s_add_u32 s46, s51, 0x14000
    s_add_u32 m0, s65, 71680
    s_nop 0
    buffer_load_dwordx4 v72, s[36:39], s46 offen  lds
    s_add_u32 s46, s51, 0x1c000
    s_add_u32 m0, s65, 72704
    s_nop 0
    buffer_load_dwordx4 v73, s[36:39], s46 offen  lds
    s_add_u32 s51, s69, 1
    s_and_b32 s51, s51, 7
    s_lshl_b32 s51, s51, 17
    s_add_u32 s51, s51, s49
    s_add_u32 s46, s51, 0x0
    s_add_u32 m0, s65, 73728
    s_nop 0
    buffer_load_dwordx4 v70, s[36:39], s46 offen  lds
    s_add_u32 s46, s51, 0x8000
    s_add_u32 m0, s65, 74752
    s_nop 0
    buffer_load_dwordx4 v71, s[36:39], s46 offen  lds
    s_add_u32 s46, s51, 0x10000
    s_add_u32 m0, s65, 75776
    s_nop 0
    buffer_load_dwordx4 v72, s[36:39], s46 offen  lds
    s_add_u32 s46, s51, 0x18000
    s_add_u32 m0, s65, 76800
    s_nop 0
    buffer_load_dwordx4 v73, s[36:39], s46 offen  lds
    s_add_u32 s51, s69, 1
    s_and_b32 s51, s51, 7
    s_lshl_b32 s51, s51, 17
    s_add_u32 s51, s51, s49
    s_add_u32 s46, s51, 0x4000
    s_add_u32 m0, s65, 77824
    s_nop 0
    buffer_load_dwordx4 v70, s[36:39], s46 offen  lds
    s_add_u32 s46, s51, 0xc000
    s_add_u32 m0, s65, 78848
    s_nop 0
    buffer_load_dwordx4 v71, s[36:39], s46 offen  lds
    s_add_u32 s46, s51, 0x14000
    s_add_u32 m0, s65, 79872
    s_nop 0
    buffer_load_dwordx4 v72, s[36:39], s46 offen  lds
    s_add_u32 s46, s51, 0x1c000
    s_add_u32 m0, s65, 80896
    s_nop 0
    buffer_load_dwordx4 v73, s[36:39], s46 offen  lds
    s_add_u32 s51, s69, 2
    s_and_b32 s51, s51, 7
    s_lshl_b32 s51, s51, 17
    s_add_u32 s51, s51, s49
    s_add_u32 s46, s51, 0x0
    s_add_u32 m0, s65, 81920
    s_nop 0
    buffer_load_dwordx4 v70, s[36:39], s46 offen  lds
    s_add_u32 s46, s51, 0x8000
    s_add_u32 m0, s65, 82944
    s_nop 0
    buffer_load_dwordx4 v71, s[36:39], s46 offen  lds
    s_add_u32 s46, s51, 0x10000
    s_add_u32 m0, s65, 83968
    s_nop 0
    buffer_load_dwordx4 v72, s[36:39], s46 offen  lds
    s_add_u32 s46, s51, 0x18000
    s_add_u32 m0, s65, 84992
    s_nop 0
    buffer_load_dwordx4 v73, s[36:39], s46 offen  lds
    s_add_u32 s51, s69, 2
    s_and_b32 s51, s51, 7
    s_lshl_b32 s51, s51, 17
    s_add_u32 s51, s51, s49
    s_add_u32 s46, s51, 0x4000
    s_add_u32 m0, s65, 86016
    s_nop 0
    buffer_load_dwordx4 v70, s[36:39], s46 offen  lds
    s_add_u32 s46, s51, 0xc000
    s_add_u32 m0, s65, 87040
    s_nop 0
    buffer_load_dwordx4 v71, s[36:39], s46 offen  lds
    s_add_u32 s46, s51, 0x14000
    s_add_u32 m0, s65, 88064
    s_nop 0
    buffer_load_dwordx4 v72, s[36:39], s46 offen  lds
    s_add_u32 s46, s51, 0x1c000
    s_add_u32 m0, s65, 89088
    s_nop 0
    buffer_load_dwordx4 v73, s[36:39], s46 offen  lds
    s_add_u32 s51, s69, 3
    s_and_b32 s51, s51, 7
    s_lshl_b32 s51, s51, 17
    s_add_u32 s51, s51, s49
    s_add_u32 s46, s51, 0x0
    s_add_u32 m0, s50, 0
    s_nop 0
    buffer_load_dwordx4 v70, s[36:39], s46 offen  lds
    s_add_u32 s46, s51, 0x8000
    s_add_u32 m0, s50, 1024
    s_nop 0
    buffer_load_dwordx4 v71, s[36:39], s46 offen  lds
    s_add_u32 s46, s51, 0x10000
    s_add_u32 m0, s50, 2048
    s_nop 0
    buffer_load_dwordx4 v72, s[36:39], s46 offen  lds
    s_add_u32 s46, s51, 0x18000
    s_add_u32 m0, s50, 3072
    s_nop 0
    buffer_load_dwordx4 v73, s[36:39], s46 offen  lds
    s_add_u32 s51, s69, 3
    s_and_b32 s51, s51, 7
    s_lshl_b32 s51, s51, 17
    s_add_u32 s51, s51, s49
    s_add_u32 s46, s51, 0x4000
    s_add_u32 m0, s50, 16384
    s_nop 0
    buffer_load_dwordx4 v70, s[36:39], s46 offen  lds
    s_add_u32 s46, s51, 0xc000
    s_add_u32 m0, s50, 17408
    s_nop 0
    buffer_load_dwordx4 v71, s[36:39], s46 offen  lds
    s_add_u32 s46, s51, 0x14000
    s_add_u32 m0, s50, 18432
    s_nop 0
    buffer_load_dwordx4 v72, s[36:39], s46 offen  lds
    s_add_u32 s46, s51, 0x1c000
    s_add_u32 m0, s50, 19456
    s_nop 0
    buffer_load_dwordx4 v73, s[36:39], s46 offen  lds
    s_add_u32 s51, s69, 4
    s_and_b32 s51, s51, 7
    s_lshl_b32 s51, s51, 17
    s_add_u32 s51, s51, s49
    s_add_u32 s46, s51, 0x0
    s_add_u32 m0, s50, 32768
    s_nop 0
    buffer_load_dwordx4 v70, s[36:39], s46 offen  lds
    s_add_u32 s46, s51, 0x8000
    s_add_u32 m0, s50, 33792
    s_nop 0
    buffer_load_dwordx4 v71, s[36:39], s46 offen  lds
    s_add_u32 s46, s51, 0x10000
    s_add_u32 m0, s50, 34816
    s_nop 0
    buffer_load_dwordx4 v72, s[36:39], s46 offen  lds
    s_add_u32 s46, s51, 0x18000
    s_add_u32 m0, s50, 35840
    s_nop 0
    buffer_load_dwordx4 v73, s[36:39], s46 offen  lds
    s_add_u32 s51, s69, 4
    s_and_b32 s51, s51, 7
    s_lshl_b32 s51, s51, 17
    s_add_u32 s51, s51, s49
    s_add_u32 s46, s51, 0x4000
    s_add_u32 m0, s50, 49152
    s_nop 0
    buffer_load_dwordx4 v70, s[36:39], s46 offen  lds
    s_add_u32 s46, s51, 0xc000
    s_add_u32 m0, s50, 50176
    s_nop 0
    buffer_load_dwordx4 v71, s[36:39], s46 offen  lds
    s_add_u32 s46, s51, 0x14000
    s_add_u32 m0, s50, 51200
    s_nop 0
    buffer_load_dwordx4 v72, s[36:39], s46 offen  lds
    s_add_u32 s46, s51, 0x1c000
    s_add_u32 m0, s50, 52224
    s_nop 0
    buffer_load_dwordx4 v73, s[36:39], s46 offen  lds
    s_waitcnt vmcnt(40)
    v_min_u32 v45, -2, v45
    buffer_store_dword v45, v12, s[12:15], s61 offen sc1
    s_waitcnt vmcnt(36)
    s_barrier
    ds_read_b64_tr_b16 a[160:161], v88 offset:0
    ds_read_b64_tr_b16 a[162:163], v88 offset:256
    ds_read_b64_tr_b16 a[168:169], v89 offset:0
    ds_read_b64_tr_b16 a[170:171], v89 offset:256
    ds_read_b64_tr_b16 a[176:177], v90 offset:0
    ds_read_b64_tr_b16 a[178:179], v90 offset:256
    ds_read_b64_tr_b16 a[184:185], v91 offset:0
    ds_read_b64_tr_b16 a[186:187], v91 offset:256
L_lw_50:
    s_waitcnt lgkmcnt(0)
    s_cmp_lg_u32 s44, 0
    s_cbranch_scc1 L_v_probe_51
    s_add_u32 s45, s63, 0
    s_memtime s[72:73]
    s_waitcnt lgkmcnt(0)
    s_load_dword s78, s[20:21], s45
    s_waitcnt lgkmcnt(0)
    s_memtime s[74:75]
    s_waitcnt lgkmcnt(0)
    s_sub_u32 s45, s74, s72
    s_min_u32 s76, s76, s45
    s_cmp_lt_u32 s77, s76
    s_cselect_b32 s68, 1, 0
L_v_probe_51:
    s_waitcnt vmcnt(32)
    s_barrier
    s_add_u32 s51, s69, 5
    s_and_b32 s51, s51, 7
    s_lshl_b32 s51, s51, 17
    s_add_u32 s51, s51, s49
    s_add_u32 s46, s51, 0x0
    s_add_u32 m0, s65, 65536
    s_nop 0
    buffer_load_dwordx4 v70, s[36:39], s46 offen  lds
    s_add_u32 s46, s51, 0x8000
    s_add_u32 m0, s65, 66560
    s_nop 0
    buffer_load_dwordx4 v71, s[36:39], s46 offen  lds
    s_add_u32 s46, s51, 0x10000
    s_add_u32 m0, s65, 67584
    s_nop 0
    buffer_load_dwordx4 v72, s[36:39], s46 offen  lds
    s_add_u32 s46, s51, 0x18000
    s_add_u32 m0, s65, 68608
    s_nop 0
    buffer_load_dwordx4 v73, s[36:39], s46 offen  lds
    ds_read_b64_tr_b16 a[164:165], v88 offset:4096
    ds_read_b64_tr_b16 a[166:167], v88 offset:4352
    ds_read_b64_tr_b16 a[172:173], v89 offset:4096
    ds_read_b64_tr_b16 a[174:175], v89 offset:4352
    ds_read_b64_tr_b16 a[180:181], v90 offset:4096
    ds_read_b64_tr_b16 a[182:183], v90 offset:4352
    ds_read_b64_tr_b16 a[188:189], v91 offset:4096
    ds_read_b64_tr_b16 a[190:191], v91 offset:4352
L_lw_52:
    s_waitcnt lgkmcnt(0)
    s_cmp_lg_u32 s44, 0
    s_cbranch_scc1 L_v_probe_53
    s_add_u32 s45, s63, 8192
    s_memtime s[72:73]
    s_waitcnt lgkmcnt(0)
    s_load_dword s78, s[20:21], s45
    s_waitcnt lgkmcnt(0)
    s_memtime s[74:75]
    s_waitcnt lgkmcnt(0)
    s_sub_u32 s45, s74, s72
    s_min_u32 s77, s77, s45
    s_cmp_lt_u32 s77, s76
    s_cselect_b32 s68, 1, 0
L_v_probe_53:
    s_waitcnt vmcnt(32)
    s_barrier
    s_add_u32 s51, s69, 5
    s_and_b32 s51, s51, 7
    s_lshl_b32 s51, s51, 17
    s_add_u32 s51, s51, s49
    s_add_u32 s46, s51, 0x4000
    s_add_u32 m0, s65, 69632
    s_nop 0
    buffer_load_dwordx4 v70, s[36:39], s46 offen  lds
    s_add_u32 s46, s51, 0xc000
    s_add_u32 m0, s65, 70656
    s_nop 0
    buffer_load_dwordx4 v71, s[36:39], s46 offen  lds
    s_add_u32 s46, s51, 0x14000
    s_add_u32 m0, s65, 71680
    s_nop 0
    buffer_load_dwordx4 v72, s[36:39], s46 offen  lds
    s_add_u32 s46, s51, 0x1c000
    s_add_u32 m0, s65, 72704
    s_nop 0
    buffer_load_dwordx4 v73, s[36:39], s46 offen  lds
    ds_read_b64_tr_b16 a[192:193], v88 offset:8192
    ds_read_b64_tr_b16 a[194:195], v88 offset:8448
    ds_read_b64_tr_b16 a[200:201], v89 offset:8192
    ds_read_b64_tr_b16 a[202:203], v89 offset:8448
    ds_read_b64_tr_b16 a[208:209], v90 offset:8192
    ds_read_b64_tr_b16 a[210:211], v90 offset:8448
    ds_read_b64_tr_b16 a[216:217], v91 offset:8192
    ds_read_b64_tr_b16 a[218:219], v91 offset:8448
L_lw_54:
    s_waitcnt lgkmcnt(0)
    s_cmp_lg_u32 s44, 0
    s_cbranch_scc1 L_v_probe_55
    s_add_u32 s45, s63, 128
    s_memtime s[72:73]
    s_waitcnt lgkmcnt(0)
    s_load_dword s78, s[20:21], s45
    s_waitcnt lgkmcnt(0)
    s_memtime s[74:75]
    s_waitcnt lgkmcnt(0)
    s_sub_u32 s45, s74, s72
    s_min_u32 s76, s76, s45
    s_cmp_lt_u32 s77, s76
    s_cselect_b32 s68, 1, 0
L_v_probe_55:
    s_waitcnt vmcnt(32)
    s_barrier
    s_add_u32 s51, s69, 6
    s_and_b32 s51, s51, 7
    s_lshl_b32 s51, s51, 17
    s_add_u32 s51, s51, s49
    s_add_u32 s46, s51, 0x0
    s_add_u32 m0, s65, 73728
    s_nop 0
    buffer_load_dwordx4 v70, s[36:39], s46 offen  lds
    s_add_u32 s46, s51, 0x8000
    s_add_u32 m0, s65, 74752
    s_nop 0
    buffer_load_dwordx4 v71, s[36:39], s46 offen  lds
    s_add_u32 s46, s51, 0x10000
    s_add_u32 m0, s65, 75776
    s_nop 0
    buffer_load_dwordx4 v72, s[36:39], s46 offen  lds
    s_add_u32 s46, s51, 0x18000
    s_add_u32 m0, s65, 76800
    s_nop 0
    buffer_load_dwordx4 v73, s[36:39], s46 offen  lds
    ds_read_b64_tr_b16 a[196:197], v88 offset:12288
    ds_read_b64_tr_b16 a[198:199], v88 offset:12544
    ds_read_b64_tr_b16 a[204:205], v89 offset:12288
    ds_read_b64_tr_b16 a[206:207], v89 offset:12544
    ds_read_b64_tr_b16 a[212:213], v90 offset:12288
    ds_read_b64_tr_b16 a[214:215], v90 offset:12544
    ds_read_b64_tr_b16 a[220:221], v91 offset:12288
    ds_read_b64_tr_b16 a[222:223], v91 offset:12544
L_lw_56:
    s_waitcnt lgkmcnt(0)
    s_cmp_lg_u32 s44, 0
    s_cbranch_scc1 L_v_probe_57
    s_add_u32 s45, s63, 8320
    s_memtime s[72:73]
    s_waitcnt lgkmcnt(0)
    s_load_dword s78, s[20:21], s45
    s_waitcnt lgkmcnt(0)
    s_memtime s[74:75]
    s_waitcnt lgkmcnt(0)
    s_sub_u32 s45, s74, s72
    s_min_u32 s77, s77, s45
    s_cmp_lt_u32 s77, s76
    s_cselect_b32 s68, 1, 0
L_v_probe_57:
    s_waitcnt vmcnt(32)
    s_barrier
    s_add_u32 s51, s69, 6
    s_and_b32 s51, s51, 7
    s_lshl_b32 s51, s51, 17
    s_add_u32 s51, s51, s49
    s_add_u32 s46, s51, 0x4000
    s_add_u32 m0, s65, 77824
    s_nop 0
    buffer_load_dwordx4 v70, s[36:39], s46 offen  lds
    s_add_u32 s46, s51, 0xc000
    s_add_u32 m0, s65, 78848
    s_nop 0
    buffer_load_dwordx4 v71, s[36:39], s46 offen  lds
    s_add_u32 s46, s51, 0x14000
    s_add_u32 m0, s65, 79872
    s_nop 0
    buffer_load_dwordx4 v72, s[36:39], s46 offen  lds
    s_add_u32 s46, s51, 0x1c000
    s_add_u32 m0, s65, 80896
    s_nop 0
    buffer_load_dwordx4 v73, s[36:39], s46 offen  lds
    ds_read_b64_tr_b16 a[224:225], v88 offset:16384
    ds_read_b64_tr_b16 a[226:227], v88 offset:16640
    ds_read_b64_tr_b16 a[232:233], v89 offset:16384
    ds_read_b64_tr_b16 a[234:235], v89 offset:16640
    ds_read_b64_tr_b16 a[240:241], v90 offset:16384
    ds_read_b64_tr_b16 a[242:243], v90 offset:16640
    ds_read_b64_tr_b16 a[248:249], v91 offset:16384
    ds_read_b64_tr_b16 a[250:251], v91 offset:16640
L_lw_58:
    s_waitcnt lgkmcnt(0)
    s_waitcnt vmcnt(32)
    s_barrier
    s_add_u32 s51, s69, 7
    s_and_b32 s51, s51, 7
    s_lshl_b32 s51, s51, 17
    s_add_u32 s51, s51, s49
    s_add_u32 s46, s51, 0x0
    s_add_u32 m0, s65, 81920
    s_nop 0
    buffer_load_dwordx4 v70, s[36:39], s46 offen  lds
    s_add_u32 s46, s51, 0x8000
    s_add_u32 m0, s65, 82944
    s_nop 0
    buffer_load_dwordx4 v71, s[36:39], s46 offen  lds
    s_add_u32 s46, s51, 0x10000
    s_add_u32 m0, s65, 83968
    s_nop 0
    buffer_load_dwordx4 v72, s[36:39], s46 offen  lds
    s_add_u32 s46, s51, 0x18000
    s_add_u32 m0, s65, 84992
    s_nop 0
    buffer_load_dwordx4 v73, s[36:39], s46 offen  lds
    ds_read_b64_tr_b16 a[228:229], v88 offset:20480
    ds_read_b64_tr_b16 a[230:231], v88 offset:20736
    ds_read_b64_tr_b16 a[236:237], v89 offset:20480
    ds_read_b64_tr_b16 a[238:239], v89 offset:20736
    ds_read_b64_tr_b16 a[244:245], v90 offset:20480
    ds_read_b64_tr_b16 a[246:247], v90 offset:20736
    ds_read_b64_tr_b16 a[252:253], v91 offset:20480
    ds_read_b64_tr_b16 a[254:255], v91 offset:20736
L_lw_59:
    s_waitcnt lgkmcnt(0)
    s_waitcnt vmcnt(32)
    s_barrier
    s_add_u32 s51, s69, 7
    s_and_b32 s51, s51, 7
    s_lshl_b32 s51, s51, 17
    s_add_u32 s51, s51, s49
    s_add_u32 s46, s51, 0x4000
    s_add_u32 m0, s65, 86016
    s_nop 0
    buffer_load_dwordx4 v70, s[36:39], s46 offen  lds
    s_add_u32 s46, s51, 0xc000
    s_add_u32 m0, s65, 87040
    s_nop 0
    buffer_load_dwordx4 v71, s[36:39], s46 offen  lds
    s_add_u32 s46, s51, 0x14000
    s_add_u32 m0, s65, 88064
    s_nop 0
    buffer_load_dwordx4 v72, s[36:39], s46 offen  lds
    s_add_u32 s46, s51, 0x1c000
    s_add_u32 m0, s65, 89088
    s_nop 0
    buffer_load_dwordx4 v73, s[36:39], s46 offen  lds
    ds_read_b64_tr_b16 v[96:97], v74 offset:0
    ds_read_b64_tr_b16 v[98:99], v74 offset:256
    ds_read_b64_tr_b16 v[104:105], v75 offset:0
    ds_read_b64_tr_b16 v[106:107], v75 offset:256
    ds_read_b64_tr_b16 v[112:113], v76 offset:0
    ds_read_b64_tr_b16 v[114:115], v76 offset:256
    ds_read_b64_tr_b16 v[120:121], v77 offset:0
    ds_read_b64_tr_b16 v[122:123], v77 offset:256
L_lw_60:
    s_waitcnt lgkmcnt(0)
    s_waitcnt vmcnt(32)
    s_barrier
    s_add_u32 s79, s41, 0
    s_and_b32 s79, s79, 3
    s_lshl_b32 s79, s79, 19
    s_add_u32 s79, s79, s47
    s_add_u32 s46, s79, 0x0
    s_add_u32 m0, s48, 0
    s_nop 0
    buffer_load_dwordx4 v82, s[32:35], s46 offen  lds
    s_add_u32 s46, s79, 0x20000
    s_add_u32 m0, s48, 4096
    s_nop 0
    buffer_load_dwordx4 v82, s[32:35], s46 offen  lds
    s_add_u32 s46, s79, 0x40000
    s_add_u32 m0, s48, 8192
    s_nop 0
    buffer_load_dwordx4 v82, s[32:35], s46 offen  lds
    s_add_u32 s46, s79, 0x60000
    s_add_u32 m0, s48, 12288
    s_nop 0
    buffer_load_dwordx4 v82, s[32:35], s46 offen  lds
    ds_read_b64_tr_b16 v[100:101], v74 offset:16384
    ds_read_b64_tr_b16 v[102:103], v74 offset:16640
    ds_read_b64_tr_b16 v[108:109], v75 offset:16384
    ds_read_b64_tr_b16 v[110:111], v75 offset:16640
    ds_read_b64_tr_b16 v[116:117], v76 offset:16384
    ds_read_b64_tr_b16 v[118:119], v76 offset:16640
    ds_read_b64_tr_b16 v[124:125], v77 offset:16384
    ds_read_b64_tr_b16 v[126:127], v77 offset:16640
L_lw_61:
    s_waitcnt lgkmcnt(0)
    s_waitcnt vmcnt(32)
    s_barrier
    s_add_u32 s79, s41, 1
    s_and_b32 s79, s79, 3
    s_lshl_b32 s79, s79, 19
    s_add_u32 s79, s79, s47
    s_add_u32 s46, s79, 0x0
    s_add_u32 m0, s48, 16384
    s_nop 0
    buffer_load_dwordx4 v82, s[32:35], s46 offen  lds
    s_add_u32 s46, s79, 0x20000
    s_add_u32 m0, s48, 20480
    s_nop 0
    buffer_load_dwordx4 v82, s[32:35], s46 offen  lds
    s_add_u32 s46, s79, 0x40000
    s_add_u32 m0, s48, 24576
    s_nop 0
    buffer_load_dwordx4 v82, s[32:35], s46 offen  lds
    s_add_u32 s46, s79, 0x60000
    s_add_u32 m0, s48, 28672
    s_nop 0
    buffer_load_dwordx4 v82, s[32:35], s46 offen  lds
    ds_read_b64_tr_b16 v[128:129], v74 offset:32768
    ds_read_b64_tr_b16 v[130:131], v74 offset:33024
    ds_read_b64_tr_b16 v[136:137], v75 offset:32768
    ds_read_b64_tr_b16 v[138:139], v75 offset:33024
    ds_read_b64_tr_b16 v[144:145], v76 offset:32768
    ds_read_b64_tr_b16 v[146:147], v76 offset:33024
    ds_read_b64_tr_b16 v[152:153], v77 offset:32768
    ds_read_b64_tr_b16 v[154:155], v77 offset:33024
L_lw_62:
    s_waitcnt lgkmcnt(0)
    s_waitcnt vmcnt(32)
    s_barrier
    s_add_u32 s79, s41, 2
    s_and_b32 s79, s79, 3
    s_lshl_b32 s79, s79, 19
    s_add_u32 s79, s79, s47
    s_add_u32 s46, s79, 0x0
    s_add_u32 m0, s48, 32768
    s_nop 0
    buffer_load_dwordx4 v82, s[32:35], s46 offen  lds
    s_add_u32 s46, s79, 0x20000
    s_add_u32 m0, s48, 36864
    s_nop 0
    buffer_load_dwordx4 v82, s[32:35], s46 offen  lds
    s_add_u32 s46, s79, 0x40000
    s_add_u32 m0, s48, 40960
    s_nop 0
    buffer_load_dwordx4 v82, s[32:35], s46 offen  lds
    s_add_u32 s46, s79, 0x60000
    s_add_u32 m0, s48, 45056
    s_nop 0
    buffer_load_dwordx4 v82, s[32:35], s46 offen  lds
    ds_read_b64_tr_b16 v[132:133], v74 offset:49152
    ds_read_b64_tr_b16 v[134:135], v74 offset:49408
    ds_read_b64_tr_b16 v[140:141], v75 offset:49152
    ds_read_b64_tr_b16 v[142:143], v75 offset:49408
    ds_read_b64_tr_b16 v[148:149], v76 offset:49152
    ds_read_b64_tr_b16 v[150:151], v76 offset:49408
    ds_read_b64_tr_b16 v[156:157], v77 offset:49152
    ds_read_b64_tr_b16 v[158:159], v77 offset:49408
L_lw_63:
    s_waitcnt lgkmcnt(0)
    s_waitcnt vmcnt(32)
    s_barrier
    s_add_u32 s79, s41, 3
    s_and_b32 s79, s79, 3
    s_lshl_b32 s79, s79, 19
    s_add_u32 s79, s79, s47
    s_add_u32 s46, s79, 0x0
    s_add_u32 m0, s48, 49152
    s_nop 0
    buffer_load_dwordx4 v82, s[32:35], s46 offen  lds
    s_add_u32 s46, s79, 0x20000
    s_add_u32 m0, s48, 53248
    s_nop 0
    buffer_load_dwordx4 v82, s[32:35], s46 offen  lds
    s_add_u32 s46, s79, 0x40000
    s_add_u32 m0, s48, 57344
    s_nop 0
    buffer_load_dwordx4 v82, s[32:35], s46 offen  lds
    s_add_u32 s46, s79, 0x60000
    s_add_u32 m0, s48, 61440
    s_nop 0
    buffer_load_dwordx4 v82, s[32:35], s46 offen  lds
    ds_read_b64_tr_b16 v[160:161], v88 offset:0
    ds_read_b64_tr_b16 v[162:163], v88 offset:256
    ds_read_b64_tr_b16 v[168:169], v89 offset:0
    ds_read_b64_tr_b16 v[170:171], v89 offset:256
    ds_read_b64_tr_b16 v[176:177], v90 offset:0
    ds_read_b64_tr_b16 v[178:179], v90 offset:256
    ds_read_b64_tr_b16 v[184:185], v91 offset:0
    ds_read_b64_tr_b16 v[186:187], v91 offset:256
L_lw_64:
    s_waitcnt lgkmcnt(0)
    s_waitcnt vmcnt(32)
    s_barrier
    s_cmp_lg_u32 s44, 0
    s_cbranch_scc1 L_hs_65
    s_getreg_b32 s45, hwreg(HW_REG_XCC_ID)
    s_and_b32 s45, s45, 15
    s_mul_i32 s46, s45, s45
    s_lshl_b32 s46, s46, 9
    s_add_u32 s45, s45, s46
    s_cmp_eq_u32 s40, 0
    s_cselect_b32 s46, s45, 0
    s_cselect_b32 s45, 0, s45
    s_lshl_b32 s68, s68, 24
    s_add_u32 s46, s46, s68
    s_add_u32 s45, s45, 16777216
    v_mov_b32 v40, s46
    v_mov_b32 v41, s45
    v_mov_b32 v42, 0
    s_mov_b64 exec, 1
    buffer_atomic_add_x2 v[40:41], v42, s[16:19], 0 offen sc1
    s_mov_b64 exec, -1
L_hs_65:
    ds_read_b64_tr_b16 v[164:165], v88 offset:4096
    ds_read_b64_tr_b16 v[166:167], v88 offset:4352
    ds_read_b64_tr_b16 v[172:173], v89 offset:4096
    ds_read_b64_tr_b16 v[174:175], v89 offset:4352
    ds_read_b64_tr_b16 v[180:181], v90 offset:4096
    ds_read_b64_tr_b16 v[182:183], v90 offset:4352
    ds_read_b64_tr_b16 v[188:189], v91 offset:4096
    ds_read_b64_tr_b16 v[190:191], v91 offset:4352
L_lw_66:
    s_waitcnt lgkmcnt(0)
    s_waitcnt vmcnt(28)
    s_barrier
    ds_read_b64_tr_b16 v[192:193], v88 offset:8192
    ds_read_b64_tr_b16 v[194:195], v88 offset:8448
    ds_read_b64_tr_b16 v[200:201], v89 offset:8192
    ds_read_b64_tr_b16 v[202:203], v89 offset:8448
    ds_read_b64_tr_b16 v[208:209], v90 offset:8192
    ds_read_b64_tr_b16 v[210:211], v90 offset:8448
    ds_read_b64_tr_b16 v[216:217], v91 offset:8192
    ds_read_b64_tr_b16 v[218:219], v91 offset:8448
L_lw_67:
    s_waitcnt lgkmcnt(0)
    s_waitcnt vmcnt(24)
    s_barrier
    ds_read_b64_tr_b16 v[196:197], v88 offset:12288
    ds_read_b64_tr_b16 v[198:199], v88 offset:12544
    ds_read_b64_tr_b16 v[204:205], v89 offset:12288
    ds_read_b64_tr_b16 v[206:207], v89 offset:12544
    ds_read_b64_tr_b16 v[212:213], v90 offset:12288
    ds_read_b64_tr_b16 v[214:215], v90 offset:12544
    ds_read_b64_tr_b16 v[220:221], v91 offset:12288
    ds_read_b64_tr_b16 v[222:223], v91 offset:12544
L_lw_68:
    s_waitcnt lgkmcnt(0)
    s_waitcnt vmcnt(20)
    s_barrier
    ds_read_b64_tr_b16 v[224:225], v88 offset:16384
    ds_read_b64_tr_b16 v[226:227], v88 offset:16640
    ds_read_b64_tr_b16 v[232:233], v89 offset:16384
    ds_read_b64_tr_b16 v[234:235], v89 offset:16640
    ds_read_b64_tr_b16 v[240:241], v90 offset:16384
    ds_read_b64_tr_b16 v[242:243], v90 offset:16640
    ds_read_b64_tr_b16 v[248:249], v91 offset:16384
    ds_read_b64_tr_b16 v[250:251], v91 offset:16640
L_lw_69:
    s_waitcnt lgkmcnt(0)
    s_waitcnt vmcnt(16)
    s_barrier
    ds_read_b64_tr_b16 v[228:229], v88 offset:20480
    ds_read_b64_tr_b16 v[230:231], v88 offset:20736
    ds_read_b64_tr_b16 v[236:237], v89 offset:20480
    ds_read_b64_tr_b16 v[238:239], v89 offset:20736
    ds_read_b64_tr_b16 v[244:245], v90 offset:20480
    ds_read_b64_tr_b16 v[246:247], v90 offset:20736
    ds_read_b64_tr_b16 v[252:253], v91 offset:20480
    ds_read_b64_tr_b16 v[254:255], v91 offset:20736
L_lw_70:
    s_waitcnt lgkmcnt(0)
    s_waitcnt vmcnt(12)
    s_barrier
    s_cmp_lg_u32 s44, 0
    s_cbranch_scc1 L_lw_71_0
    ds_read_b64_tr_b16 a[0:1], v80 offset:0
    ds_read_b64_tr_b16 a[2:3], v80 offset:1024
    ds_read_b64_tr_b16 a[4:5], v80 offset:8192
    ds_read_b64_tr_b16 a[6:7], v80 offset:9216
    ds_read_b64_tr_b16 a[8:9], v81 offset:0
    ds_read_b64_tr_b16 a[10:11], v81 offset:1024
    ds_read_b64_tr_b16 a[12:13], v81 offset:8192
    ds_read_b64_tr_b16 a[14:15], v81 offset:9216
    s_branch L_lw_71
L_lw_71_0:
    s_cmp_lg_u32 s44, 1
    s_cbranch_scc1 L_lw_71_1
    ds_read_b64_tr_b16 a[120:121], v80 offset:0
    ds_read_b64_tr_b16 a[122:123], v80 offset:1024
    ds_read_b64_tr_b16 a[124:125], v80 offset:8192
    ds_read_b64_tr_b16 a[126:127], v80 offset:9216
    ds_read_b64_tr_b16 v[56:57], v81 offset:0
    ds_read_b64_tr_b16 v[58:59], v81 offset:1024
    ds_read_b64_tr_b16 v[60:61], v81 offset:8192
    ds_read_b64_tr_b16 v[62:63], v81 offset:9216
    s_waitcnt lgkmcnt(0)
    ds_write_b128 v5, v[56:59] offset:0
    ds_write_b128 v5, v[60:63] offset:1024
    s_branch L_lw_71
L_lw_71_1:
    s_cmp_lg_u32 s44, 2
    s_cbranch_scc1 L_lw_71_2
    ds_read_b64_tr_b16 a[80:81], v80 offset:0
    ds_read_b64_tr_b16 a[82:83], v80 offset:1024
    ds_read_b64_tr_b16 a[84:85], v80 offset:8192
    ds_read_b64_tr_b16 a[86:87], v80 offset:9216
    ds_read_b64_tr_b16 v[56:57], v81 offset:0
    ds_read_b64_tr_b16 v[58:59], v81 offset:1024
    ds_read_b64_tr_b16 v[60:61], v81 offset:8192
    ds_read_b64_tr_b16 v[62:63], v81 offset:9216
    s_waitcnt lgkmcnt(0)
    ds_write_b128 v5, v[56:59] offset:2048
    ds_write_b128 v5, v[60:63] offset:3072
    s_branch L_lw_71
L_lw_71_2:
    ds_read_b64_tr_b16 a[48:49], v80 offset:0
    ds_read_b64_tr_b16 a[50:51], v80 offset:1024
    ds_read_b64_tr_b16 a[52:53], v80 offset:8192
    ds_read_b64_tr_b16 a[54:55], v80 offset:9216
    ds_read_b64_tr_b16 v[56:57], v81 offset:0
    ds_read_b64_tr_b16 v[58:59], v81 offset:1024
    ds_read_b64_tr_b16 v[60:61], v81 offset:8192
    ds_read_b64_tr_b16 v[62:63], v81 offset:9216
    s_waitcnt lgkmcnt(0)
    ds_write_b128 v5, v[56:59] offset:4096
    ds_write_b128 v5, v[60:63] offset:5120
L_lw_71:
    s_waitcnt lgkmcnt(0)
    s_waitcnt vmcnt(8)
    s_barrier
    s_add_u32 s79, s41, 4
    s_and_b32 s79, s79, 3
    s_lshl_b32 s79, s79, 19
    s_add_u32 s79, s79, s47
    s_add_u32 s46, s79, 0x200000
    s_add_u32 m0, s48, 0
    s_nop 0
    buffer_load_dwordx4 v82, s[32:35], s46 offen  lds
    s_add_u32 s46, s79, 0x220000
    s_add_u32 m0, s48, 4096
    s_nop 0
    buffer_load_dwordx4 v82, s[32:35], s46 offen  lds
    s_add_u32 s46, s79, 0x240000
    s_add_u32 m0, s48, 8192
    s_nop 0
    buffer_load_dwordx4 v82, s[32:35], s46 offen  lds
    s_add_u32 s46, s79, 0x260000
    s_add_u32 m0, s48, 12288
    s_nop 0
    buffer_load_dwordx4 v82, s[32:35], s46 offen  lds
    s_cmp_lg_u32 s44, 0
    s_cbranch_scc1 L_lw_72_0
    ds_read_b64_tr_b16 a[16:17], v80 offset:16384
    ds_read_b64_tr_b16 a[18:19], v80 offset:17408
    ds_read_b64_tr_b16 a[20:21], v80 offset:24576
    ds_read_b64_tr_b16 a[22:23], v80 offset:25600
    ds_read_b64_tr_b16 a[24:25], v81 offset:16384
    ds_read_b64_tr_b16 a[26:27], v81 offset:17408
    ds_read_b64_tr_b16 a[28:29], v81 offset:24576
    ds_read_b64_tr_b16 a[30:31], v81 offset:25600
    s_branch L_lw_72
L_lw_72_0:
    s_cmp_lg_u32 s44, 1
    s_cbranch_scc1 L_lw_72_1
    ds_read_b64_tr_b16 a[128:129], v80 offset:16384
    ds_read_b64_tr_b16 a[130:131], v80 offset:17408
    ds_read_b64_tr_b16 a[132:133], v80 offset:24576
    ds_read_b64_tr_b16 a[134:135], v80 offset:25600
    ds_read_b64_tr_b16 a[136:137], v81 offset:16384
    ds_read_b64_tr_b16 a[138:139], v81 offset:17408
    ds_read_b64_tr_b16 a[140:141], v81 offset:24576
    ds_read_b64_tr_b16 a[142:143], v81 offset:25600
    s_branch L_lw_72
L_lw_72_1:
    s_cmp_lg_u32 s44, 2
    s_cbranch_scc1 L_lw_72_2
    ds_read_b64_tr_b16 a[88:89], v80 offset:16384
    ds_read_b64_tr_b16 a[90:91], v80 offset:17408
    ds_read_b64_tr_b16 a[92:93], v80 offset:24576
    ds_read_b64_tr_b16 a[94:95], v80 offset:25600
    ds_read_b64_tr_b16 a[96:97], v81 offset:16384
    ds_read_b64_tr_b16 a[98:99], v81 offset:17408
    ds_read_b64_tr_b16 a[100:101], v81 offset:24576
    ds_read_b64_tr_b16 a[102:103], v81 offset:25600
    s_branch L_lw_72
L_lw_72_2:
    ds_read_b64_tr_b16 a[56:57], v80 offset:16384
    ds_read_b64_tr_b16 a[58:59], v80 offset:17408
    ds_read_b64_tr_b16 a[60:61], v80 offset:24576
    ds_read_b64_tr_b16 a[62:63], v80 offset:25600
    ds_read_b64_tr_b16 v[56:57], v81 offset:16384
    ds_read_b64_tr_b16 v[58:59], v81 offset:17408
    ds_read_b64_tr_b16 v[60:61], v81 offset:24576
    ds_read_b64_tr_b16 v[62:63], v81 offset:25600
    s_waitcnt lgkmcnt(0)
    ds_write_b128 v5, v[56:59] offset:6144
    ds_write_b128 v5, v[60:63] offset:7168
L_lw_72:
    s_waitcnt lgkmcnt(0)
    s_waitcnt vmcnt(8)
    s_barrier
    s_add_u32 s79, s41, 5
    s_and_b32 s79, s79, 3
    s_lshl_b32 s79, s79, 19
    s_add_u32 s79, s79, s47
    s_add_u32 s46, s79, 0x200000
    s_add_u32 m0, s48, 16384
    s_nop 0
    buffer_load_dwordx4 v82, s[32:35], s46 offen  lds
    s_add_u32 s46, s79, 0x220000
    s_add_u32 m0, s48, 20480
    s_nop 0
    buffer_load_dwordx4 v82, s[32:35], s46 offen  lds
    s_add_u32 s46, s79, 0x240000
    s_add_u32 m0, s48, 24576
    s_nop 0
    buffer_load_dwordx4 v82, s[32:35], s46 offen  lds
    s_add_u32 s46, s79, 0x260000
    s_add_u32 m0, s48, 28672
    s_nop 0
    buffer_load_dwordx4 v82, s[32:35], s46 offen  lds
    s_cmp_lg_u32 s44, 0
    s_cbranch_scc1 L_lw_73_0
    ds_read_b64_tr_b16 a[32:33], v80 offset:32768
    ds_read_b64_tr_b16 a[34:35], v80 offset:33792
    ds_read_b64_tr_b16 a[36:37], v80 offset:40960
    ds_read_b64_tr_b16 a[38:39], v80 offset:41984
    ds_read_b64_tr_b16 v[56:57], v81 offset:32768
    ds_read_b64_tr_b16 v[58:59], v81 offset:33792
    ds_read_b64_tr_b16 v[60:61], v81 offset:40960
    ds_read_b64_tr_b16 v[62:63], v81 offset:41984
    s_waitcnt lgkmcnt(0)
    ds_write_b128 v5, v[56:59] offset:8192
    ds_write_b128 v5, v[60:63] offset:9216
    s_branch L_lw_73
L_lw_73_0:
    s_cmp_lg_u32 s44, 1
    s_cbranch_scc1 L_lw_73_1
    ds_read_b64_tr_b16 a[144:145], v80 offset:32768
    ds_read_b64_tr_b16 a[146:147], v80 offset:33792
    ds_read_b64_tr_b16 a[148:149], v80 offset:40960
    ds_read_b64_tr_b16 a[150:151], v80 offset:41984
    ds_read_b64_tr_b16 v[56:57], v81 offset:32768
    ds_read_b64_tr_b16 v[58:59], v81 offset:33792
    ds_read_b64_tr_b16 v[60:61], v81 offset:40960
    ds_read_b64_tr_b16 v[62:63], v81 offset:41984
    s_waitcnt lgkmcnt(0)
    ds_write_b128 v5, v[56:59] offset:10240
    ds_write_b128 v5, v[60:63] offset:11264
    s_branch L_lw_73
L_lw_73_1:
    s_cmp_lg_u32 s44, 2
    s_cbranch_scc1 L_lw_73_2
    ds_read_b64_tr_b16 a[104:105], v80 offset:32768
    ds_read_b64_tr_b16 a[106:107], v80 offset:33792
    ds_read_b64_tr_b16 a[108:109], v80 offset:40960
    ds_read_b64_tr_b16 a[110:111], v80 offset:41984
    ds_read_b64_tr_b16 v[56:57], v81 offset:32768
    ds_read_b64_tr_b16 v[58:59], v81 offset:33792
    ds_read_b64_tr_b16 v[60:61], v81 offset:40960
    ds_read_b64_tr_b16 v[62:63], v81 offset:41984
    s_waitcnt lgkmcnt(0)
    ds_write_b128 v5, v[56:59] offset:12288
    ds_write_b128 v5, v[60:63] offset:13312
    s_branch L_lw_73
L_lw_73_2:
    ds_read_b64_tr_b16 a[64:65], v80 offset:32768
    ds_read_b64_tr_b16 a[66:67], v80 offset:33792
    ds_read_b64_tr_b16 a[68:69], v80 offset:40960
    ds_read_b64_tr_b16 a[70:71], v80 offset:41984
    ds_read_b64_tr_b16 v[56:57], v81 offset:32768
    ds_read_b64_tr_b16 v[58:59], v81 offset:33792
    ds_read_b64_tr_b16 v[60:61], v81 offset:40960
    ds_read_b64_tr_b16 v[62:63], v81 offset:41984
    s_waitcnt lgkmcnt(0)
    ds_write_b128 v5, v[56:59] offset:14336
    ds_write_b128 v5, v[60:63] offset:15360
L_lw_73:
    s_waitcnt lgkmcnt(0)
    s_waitcnt vmcnt(8)
    s_barrier
    s_add_u32 s79, s41, 6
    s_and_b32 s79, s79, 3
    s_lshl_b32 s79, s79, 19
    s_add_u32 s79, s79, s47
    s_add_u32 s46, s79, 0x200000
    s_add_u32 m0, s48, 32768
    s_nop 0
    buffer_load_dwordx4 v82, s[32:35], s46 offen  lds
    s_add_u32 s46, s79, 0x220000
    s_add_u32 m0, s48, 36864
    s_nop 0
    buffer_load_dwordx4 v82, s[32:35], s46 offen  lds
    s_add_u32 s46, s79, 0x240000
    s_add_u32 m0, s48, 40960
    s_nop 0
    buffer_load_dwordx4 v82, s[32:35], s46 offen  lds
    s_add_u32 s46, s79, 0x260000
    s_add_u32 m0, s48, 45056
    s_nop 0
    buffer_load_dwordx4 v82, s[32:35], s46 offen  lds
    s_cmp_lg_u32 s44, 0
    s_cbranch_scc1 L_lw_74_0
    ds_read_b64_tr_b16 a[40:41], v80 offset:49152
    ds_read_b64_tr_b16 a[42:43], v80 offset:50176
    ds_read_b64_tr_b16 a[44:45], v80 offset:57344
    ds_read_b64_tr_b16 a[46:47], v80 offset:58368
    ds_read_b64_tr_b16 v[56:57], v81 offset:49152
    ds_read_b64_tr_b16 v[58:59], v81 offset:50176
    ds_read_b64_tr_b16 v[60:61], v81 offset:57344
    ds_read_b64_tr_b16 v[62:63], v81 offset:58368
    s_waitcnt lgkmcnt(0)
    ds_write_b128 v5, v[56:59] offset:16384
    ds_write_b128 v5, v[60:63] offset:17408
    s_branch L_lw_74
L_lw_74_0:
    s_cmp_lg_u32 s44, 1
    s_cbranch_scc1 L_lw_74_1
    ds_read_b64_tr_b16 a[152:153], v80 offset:49152
    ds_read_b64_tr_b16 a[154:155], v80 offset:50176
    ds_read_b64_tr_b16 a[156:157], v80 offset:57344
    ds_read_b64_tr_b16 a[158:159], v80 offset:58368
    ds_read_b64_tr_b16 v[56:57], v81 offset:49152
    ds_read_b64_tr_b16 v[58:59], v81 offset:50176
    ds_read_b64_tr_b16 v[60:61], v81 offset:57344
    ds_read_b64_tr_b16 v[62:63], v81 offset:58368
    s_waitcnt lgkmcnt(0)
    ds_write_b128 v5, v[56:59] offset:18432
    ds_write_b128 v5, v[60:63] offset:19456
    s_branch L_lw_74
L_lw_74_1:
    s_cmp_lg_u32 s44, 2
    s_cbranch_scc1 L_lw_74_2
    ds_read_b64_tr_b16 a[112:113], v80 offset:49152
    ds_read_b64_tr_b16 a[114:115], v80 offset:50176
    ds_read_b64_tr_b16 a[116:117], v80 offset:57344
    ds_read_b64_tr_b16 a[118:119], v80 offset:58368
    ds_read_b64_tr_b16 v[56:57], v81 offset:49152
    ds_read_b64_tr_b16 v[58:59], v81 offset:50176
    ds_read_b64_tr_b16 v[60:61], v81 offset:57344
    ds_read_b64_tr_b16 v[62:63], v81 offset:58368
    s_waitcnt lgkmcnt(0)
    ds_write_b128 v5, v[56:59] offset:20480
    ds_write_b128 v5, v[60:63] offset:21504
    s_branch L_lw_74
L_lw_74_2:
    ds_read_b64_tr_b16 a[72:73], v80 offset:49152
    ds_read_b64_tr_b16 a[74:75], v80 offset:50176
    ds_read_b64_tr_b16 a[76:77], v80 offset:57344
    ds_read_b64_tr_b16 a[78:79], v80 offset:58368
    ds_read_b64_tr_b16 v[56:57], v81 offset:49152
    ds_read_b64_tr_b16 v[58:59], v81 offset:50176
    ds_read_b64_tr_b16 v[60:61], v81 offset:57344
    ds_read_b64_tr_b16 v[62:63], v81 offset:58368
    s_waitcnt lgkmcnt(0)
    ds_write_b128 v5, v[56:59] offset:22528
    ds_write_b128 v5, v[60:63] offset:23552
L_lw_74:
    s_waitcnt lgkmcnt(0)
    s_waitcnt vmcnt(8)
    s_barrier
    s_add_u32 s79, s41, 7
    s_and_b32 s79, s79, 3
    s_lshl_b32 s79, s79, 19
    s_add_u32 s79, s79, s47
    s_add_u32 s46, s79, 0x200000
    s_add_u32 m0, s48, 49152
    s_nop 0
    buffer_load_dwordx4 v82, s[32:35], s46 offen  lds
    s_add_u32 s46, s79, 0x220000
    s_add_u32 m0, s48, 53248
    s_nop 0
    buffer_load_dwordx4 v82, s[32:35], s46 offen  lds
    s_add_u32 s46, s79, 0x240000
    s_add_u32 m0, s48, 57344
    s_nop 0
    buffer_load_dwordx4 v82, s[32:35], s46 offen  lds
    s_add_u32 s46, s79, 0x260000
    s_add_u32 m0, s48, 61440
    s_nop 0
    buffer_load_dwordx4 v82, s[32:35], s46 offen  lds
    s_cmp_lg_u32 s44, 0
    s_cbranch_scc1 L_lw_75_0
    ds_read_b64_tr_b16 a[48:49], v80 offset:0
    ds_read_b64_tr_b16 a[50:51], v80 offset:1024
    ds_read_b64_tr_b16 a[52:53], v80 offset:8192
    ds_read_b64_tr_b16 a[54:55], v80 offset:9216
    ds_read_b64_tr_b16 v[56:57], v81 offset:0
    ds_read_b64_tr_b16 v[58:59], v81 offset:1024
    ds_read_b64_tr_b16 v[60:61], v81 offset:8192
    ds_read_b64_tr_b16 v[62:63], v81 offset:9216
    s_waitcnt lgkmcnt(0)
    ds_write_b128 v5, v[56:59] offset:4096
    ds_write_b128 v5, v[60:63] offset:5120
    s_branch L_lw_75
L_lw_75_0:
    s_cmp_lg_u32 s44, 1
    s_cbranch_scc1 L_lw_75_1
    ds_read_b64_tr_b16 a[0:1], v80 offset:0
    ds_read_b64_tr_b16 a[2:3], v80 offset:1024
    ds_read_b64_tr_b16 a[4:5], v80 offset:8192
    ds_read_b64_tr_b16 a[6:7], v80 offset:9216
    ds_read_b64_tr_b16 a[8:9], v81 offset:0
    ds_read_b64_tr_b16 a[10:11], v81 offset:1024
    ds_read_b64_tr_b16 a[12:13], v81 offset:8192
    ds_read_b64_tr_b16 a[14:15], v81 offset:9216
    s_branch L_lw_75
L_lw_75_1:
    s_cmp_lg_u32 s44, 2
    s_cbranch_scc1 L_lw_75_2
    ds_read_b64_tr_b16 a[120:121], v80 offset:0
    ds_read_b64_tr_b16 a[122:123], v80 offset:1024
    ds_read_b64_tr_b16 a[124:125], v80 offset:8192
    ds_read_b64_tr_b16 a[126:127], v80 offset:9216
    ds_read_b64_tr_b16 v[56:57], v81 offset:0
    ds_read_b64_tr_b16 v[58:59], v81 offset:1024
    ds_read_b64_tr_b16 v[60:61], v81 offset:8192
    ds_read_b64_tr_b16 v[62:63], v81 offset:9216
    s_waitcnt lgkmcnt(0)
    ds_write_b128 v5, v[56:59] offset:0
    ds_write_b128 v5, v[60:63] offset:1024
    s_branch L_lw_75
L_lw_75_2:
    ds_read_b64_tr_b16 a[80:81], v80 offset:0
    ds_read_b64_tr_b16 a[82:83], v80 offset:1024
    ds_read_b64_tr_b16 a[84:85], v80 offset:8192
    ds_read_b64_tr_b16 a[86:87], v80 offset:9216
    ds_read_b64_tr_b16 v[56:57], v81 offset:0
    ds_read_b64_tr_b16 v[58:59], v81 offset:1024
    ds_read_b64_tr_b16 v[60:61], v81 offset:8192
    ds_read_b64_tr_b16 v[62:63], v81 offset:9216
    s_waitcnt lgkmcnt(0)
    ds_write_b128 v5, v[56:59] offset:2048
    ds_write_b128 v5, v[60:63] offset:3072
L_lw_75:
    s_waitcnt lgkmcnt(0)
    s_waitcnt vmcnt(8)
    s_barrier
    s_add_u32 s79, s41, 8
    s_and_b32 s79, s79, 3
    s_lshl_b32 s79, s79, 19
    s_add_u32 s79, s79, s47
    s_add_u32 s46, s79, 0x400000
    s_add_u32 m0, s48, 0
    s_nop 0
    buffer_load_dwordx4 v82, s[32:35], s46 offen  lds
    s_add_u32 s46, s79, 0x420000
    s_add_u32 m0, s48, 4096
    s_nop 0
    buffer_load_dwordx4 v82, s[32:35], s46 offen  lds
    s_add_u32 s46, s79, 0x440000
    s_add_u32 m0, s48, 8192
    s_nop 0
    buffer_load_dwordx4 v82, s[32:35], s46 offen  lds
    s_add_u32 s46, s79, 0x460000
    s_add_u32 m0, s48, 12288
    s_nop 0
    buffer_load_dwordx4 v82, s[32:35], s46 offen  lds
    s_cmp_lg_u32 s44, 0
    s_cbranch_scc1 L_lw_76_0
    ds_read_b64_tr_b16 a[56:57], v80 offset:16384
    ds_read_b64_tr_b16 a[58:59], v80 offset:17408
    ds_read_b64_tr_b16 a[60:61], v80 offset:24576
    ds_read_b64_tr_b16 a[62:63], v80 offset:25600
    ds_read_b64_tr_b16 v[56:57], v81 offset:16384
    ds_read_b64_tr_b16 v[58:59], v81 offset:17408
    ds_read_b64_tr_b16 v[60:61], v81 offset:24576
    ds_read_b64_tr_b16 v[62:63], v81 offset:25600
    s_waitcnt lgkmcnt(0)
    ds_write_b128 v5, v[56:59] offset:6144
    ds_write_b128 v5, v[60:63] offset:7168
    s_branch L_lw_76
L_lw_76_0:
    s_cmp_lg_u32 s44, 1
    s_cbranch_scc1 L_lw_76_1
    ds_read_b64_tr_b16 a[16:17], v80 offset:16384
    ds_read_b64_tr_b16 a[18:19], v80 offset:17408
    ds_read_b64_tr_b16 a[20:21], v80 offset:24576
    ds_read_b64_tr_b16 a[22:23], v80 offset:25600
    ds_read_b64_tr_b16 a[24:25], v81 offset:16384
    ds_read_b64_tr_b16 a[26:27], v81 offset:17408
    ds_read_b64_tr_b16 a[28:29], v81 offset:24576
    ds_read_b64_tr_b16 a[30:31], v81 offset:25600
    s_branch L_lw_76
L_lw_76_1:
    s_cmp_lg_u32 s44, 2
    s_cbranch_scc1 L_lw_76_2
    ds_read_b64_tr_b16 a[128:129], v80 offset:16384
    ds_read_b64_tr_b16 a[130:131], v80 offset:17408
    ds_read_b64_tr_b16 a[132:133], v80 offset:24576
    ds_read_b64_tr_b16 a[134:135], v80 offset:25600
    ds_read_b64_tr_b16 a[136:137], v81 offset:16384
    ds_read_b64_tr_b16 a[138:139], v81 offset:17408
    ds_read_b64_tr_b16 a[140:141], v81 offset:24576
    ds_read_b64_tr_b16 a[142:143], v81 offset:25600
    s_branch L_lw_76
L_lw_76_2:
    ds_read_b64_tr_b16 a[88:89], v80 offset:16384
    ds_read_b64_tr_b16 a[90:91], v80 offset:17408
    ds_read_b64_tr_b16 a[92:93], v80 offset:24576
    ds_read_b64_tr_b16 a[94:95], v80 offset:25600
    ds_read_b64_tr_b16 a[96:97], v81 offset:16384
    ds_read_b64_tr_b16 a[98:99], v81 offset:17408
    ds_read_b64_tr_b16 a[100:101], v81 offset:24576
    ds_read_b64_tr_b16 a[102:103], v81 offset:25600
L_lw_76:
    s_waitcnt lgkmcnt(0)
    s_waitcnt vmcnt(8)
    s_barrier
    s_add_u32 s79, s41, 9
    s_and_b32 s79, s79, 3
    s_lshl_b32 s79, s79, 19
    s_add_u32 s79, s79, s47
    s_add_u32 s46, s79, 0x400000
    s_add_u32 m0, s48, 16384
    s_nop 0
    buffer_load_dwordx4 v82, s[32:35], s46 offen  lds
    s_add_u32 s46, s79, 0x420000
    s_add_u32 m0, s48, 20480
    s_nop 0
    buffer_load_dwordx4 v82, s[32:35], s46 offen  lds
    s_add_u32 s46, s79, 0x440000
    s_add_u32 m0, s48, 24576
    s_nop 0
    buffer_load_dwordx4 v82, s[32:35], s46 offen  lds
    s_add_u32 s46, s79, 0x460000
    s_add_u32 m0, s48, 28672
    s_nop 0
    buffer_load_dwordx4 v82, s[32:35], s46 offen  lds
    s_cmp_lg_u32 s44, 0
    s_cbranch_scc1 L_lw_77_0
    ds_read_b64_tr_b16 a[64:65], v80 offset:32768
    ds_read_b64_tr_b16 a[66:67], v80 offset:33792
    ds_read_b64_tr_b16 a[68:69], v80 offset:40960
    ds_read_b64_tr_b16 a[70:71], v80 offset:41984
    ds_read_b64_tr_b16 v[56:57], v81 offset:32768
    ds_read_b64_tr_b16 v[58:59], v81 offset:33792
    ds_read_b64_tr_b16 v[60:61], v81 offset:40960
    ds_read_b64_tr_b16 v[62:63], v81 offset:41984
    s_waitcnt lgkmcnt(0)
    ds_write_b128 v5, v[56:59] offset:14336
    ds_write_b128 v5, v[60:63] offset:15360
    s_branch L_lw_77
L_lw_77_0:
    s_cmp_lg_u32 s44, 1
    s_cbranch_scc1 L_lw_77_1
    ds_read_b64_tr_b16 a[32:33], v80 offset:32768
    ds_read_b64_tr_b16 a[34:35], v80 offset:33792
    ds_read_b64_tr_b16 a[36:37], v80 offset:40960
    ds_read_b64_tr_b16 a[38:39], v80 offset:41984
    ds_read_b64_tr_b16 v[56:57], v81 offset:32768
    ds_read_b64_tr_b16 v[58:59], v81 offset:33792
    ds_read_b64_tr_b16 v[60:61], v81 offset:40960
    ds_read_b64_tr_b16 v[62:63], v81 offset:41984
    s_waitcnt lgkmcnt(0)
    ds_write_b128 v5, v[56:59] offset:8192
    ds_write_b128 v5, v[60:63] offset:9216
    s_branch L_lw_77
L_lw_77_1:
    s_cmp_lg_u32 s44, 2
    s_cbranch_scc1 L_lw_77_2
    ds_read_b64_tr_b16 a[144:145], v80 offset:32768
    ds_read_b64_tr_b16 a[146:147], v80 offset:33792
    ds_read_b64_tr_b16 a[148:149], v80 offset:40960
    ds_read_b64_tr_b16 a[150:151], v80 offset:41984
    ds_read_b64_tr_b16 v[56:57], v81 offset:32768
    ds_read_b64_tr_b16 v[58:59], v81 offset:33792
    ds_read_b64_tr_b16 v[60:61], v81 offset:40960
    ds_read_b64_tr_b16 v[62:63], v81 offset:41984
    s_waitcnt lgkmcnt(0)
    ds_write_b128 v5, v[56:59] offset:10240
    ds_write_b128 v5, v[60:63] offset:11264
    s_branch L_lw_77
L_lw_77_2:
    ds_read_b64_tr_b16 a[104:105], v80 offset:32768
    ds_read_b64_tr_b16 a[106:107], v80 offset:33792
    ds_read_b64_tr_b16 a[108:109], v80 offset:40960
    ds_read_b64_tr_b16 a[110:111], v80 offset:41984
    ds_read_b64_tr_b16 v[56:57], v81 offset:32768
    ds_read_b64_tr_b16 v[58:59], v81 offset:33792
    ds_read_b64_tr_b16 v[60:61], v81 offset:40960
    ds_read_b64_tr_b16 v[62:63], v81 offset:41984
    s_waitcnt lgkmcnt(0)
    ds_write_b128 v5, v[56:59] offset:12288
    ds_write_b128 v5, v[60:63] offset:13312
L_lw_77:
    s_waitcnt lgkmcnt(0)
    s_waitcnt vmcnt(8)
    s_barrier
    s_add_u32 s79, s41, 10
    s_and_b32 s79, s79, 3
    s_lshl_b32 s79, s79, 19
    s_add_u32 s79, s79, s47
    s_add_u32 s46, s79, 0x400000
    s_add_u32 m0, s48, 32768
    s_nop 0
    buffer_load_dwordx4 v82, s[32:35], s46 offen  lds
    s_add_u32 s46, s79, 0x420000
    s_add_u32 m0, s48, 36864
    s_nop 0
    buffer_load_dwordx4 v82, s[32:35], s46 offen  lds
    s_add_u32 s46, s79, 0x440000
    s_add_u32 m0, s48, 40960
    s_nop 0
    buffer_load_dwordx4 v82, s[32:35], s46 offen  lds
    s_add_u32 s46, s79, 0x460000
    s_add_u32 m0, s48, 45056
    s_nop 0
    buffer_load_dwordx4 v82, s[32:35], s46 offen  lds
    s_cmp_lg_u32 s44, 0
    s_cbranch_scc1 L_lw_78_0
    ds_read_b64_tr_b16 a[72:73], v80 offset:49152
    ds_read_b64_tr_b16 a[74:75], v80 offset:50176
    ds_read_b64_tr_b16 a[76:77], v80 offset:57344
    ds_read_b64_tr_b16 a[78:79], v80 offset:58368
    ds_read_b64_tr_b16 v[56:57], v81 offset:49152
    ds_read_b64_tr_b16 v[58:59], v81 offset:50176
    ds_read_b64_tr_b16 v[60:61], v81 offset:57344
    ds_read_b64_tr_b16 v[62:63], v81 offset:58368
    s_waitcnt lgkmcnt(0)
    ds_write_b128 v5, v[56:59] offset:22528
    ds_write_b128 v5, v[60:63] offset:23552
    s_branch L_lw_78
L_lw_78_0:
    s_cmp_lg_u32 s44, 1
    s_cbranch_scc1 L_lw_78_1
    ds_read_b64_tr_b16 a[40:41], v80 offset:49152
    ds_read_b64_tr_b16 a[42:43], v80 offset:50176
    ds_read_b64_tr_b16 a[44:45], v80 offset:57344
    ds_read_b64_tr_b16 a[46:47], v80 offset:58368
    ds_read_b64_tr_b16 v[56:57], v81 offset:49152
    ds_read_b64_tr_b16 v[58:59], v81 offset:50176
    ds_read_b64_tr_b16 v[60:61], v81 offset:57344
    ds_read_b64_tr_b16 v[62:63], v81 offset:58368
    s_waitcnt lgkmcnt(0)
    ds_write_b128 v5, v[56:59] offset:16384
    ds_write_b128 v5, v[60:63] offset:17408
    s_branch L_lw_78
L_lw_78_1:
    s_cmp_lg_u32 s44, 2
    s_cbranch_scc1 L_lw_78_2
    ds_read_b64_tr_b16 a[152:153], v80 offset:49152
    ds_read_b64_tr_b16 a[154:155], v80 offset:50176
    ds_read_b64_tr_b16 a[156:157], v80 offset:57344
    ds_read_b64_tr_b16 a[158:159], v80 offset:58368
    ds_read_b64_tr_b16 v[56:57], v81 offset:49152
    ds_read_b64_tr_b16 v[58:59], v81 offset:50176
    ds_read_b64_tr_b16 v[60:61], v81 offset:57344
    ds_read_b64_tr_b16 v[62:63], v81 offset:58368
    s_waitcnt lgkmcnt(0)
    ds_write_b128 v5, v[56:59] offset:18432
    ds_write_b128 v5, v[60:63] offset:19456
    s_branch L_lw_78
L_lw_78_2:
    ds_read_b64_tr_b16 a[112:113], v80 offset:49152
    ds_read_b64_tr_b16 a[114:115], v80 offset:50176
    ds_read_b64_tr_b16 a[116:117], v80 offset:57344
    ds_read_b64_tr_b16 a[118:119], v80 offset:58368
    ds_read_b64_tr_b16 v[56:57], v81 offset:49152
    ds_read_b64_tr_b16 v[58:59], v81 offset:50176
    ds_read_b64_tr_b16 v[60:61], v81 offset:57344
    ds_read_b64_tr_b16 v[62:63], v81 offset:58368
    s_waitcnt lgkmcnt(0)
    ds_write_b128 v5, v[56:59] offset:20480
    ds_write_b128 v5, v[60:63] offset:21504
L_lw_78:
    s_waitcnt lgkmcnt(0)
    s_waitcnt vmcnt(8)
    s_barrier
    s_add_u32 s79, s41, 11
    s_and_b32 s79, s79, 3
    s_lshl_b32 s79, s79, 19
    s_add_u32 s79, s79, s47
    s_add_u32 s46, s79, 0x400000
    s_add_u32 m0, s48, 49152
    s_nop 0
    buffer_load_dwordx4 v82, s[32:35], s46 offen  lds
    s_add_u32 s46, s79, 0x420000
    s_add_u32 m0, s48, 53248
    s_nop 0
    buffer_load_dwordx4 v82, s[32:35], s46 offen  lds
    s_add_u32 s46, s79, 0x440000
    s_add_u32 m0, s48, 57344
    s_nop 0
    buffer_load_dwordx4 v82, s[32:35], s46 offen  lds
    s_add_u32 s46, s79, 0x460000
    s_add_u32 m0, s48, 61440
    s_nop 0
    buffer_load_dwordx4 v82, s[32:35], s46 offen  lds
    s_cmp_lg_u32 s44, 0
    s_cbranch_scc1 L_lw_79_0
    ds_read_b64_tr_b16 a[80:81], v80 offset:0
    ds_read_b64_tr_b16 a[82:83], v80 offset:1024
    ds_read_b64_tr_b16 a[84:85], v80 offset:8192
    ds_read_b64_tr_b16 a[86:87], v80 offset:9216
    ds_read_b64_tr_b16 v[56:57], v81 offset:0
    ds_read_b64_tr_b16 v[58:59], v81 offset:1024
    ds_read_b64_tr_b16 v[60:61], v81 offset:8192
    ds_read_b64_tr_b16 v[62:63], v81 offset:9216
    s_waitcnt lgkmcnt(0)
    ds_write_b128 v5, v[56:59] offset:2048
    ds_write_b128 v5, v[60:63] offset:3072
    s_branch L_lw_79
L_lw_79_0:
    s_cmp_lg_u32 s44, 1
    s_cbranch_scc1 L_lw_79_1
    ds_read_b64_tr_b16 a[48:49], v80 offset:0
    ds_read_b64_tr_b16 a[50:51], v80 offset:1024
    ds_read_b64_tr_b16 a[52:53], v80 offset:8192
    ds_read_b64_tr_b16 a[54:55], v80 offset:9216
    ds_read_b64_tr_b16 v[56:57], v81 offset:0
    ds_read_b64_tr_b16 v[58:59], v81 offset:1024
    ds_read_b64_tr_b16 v[60:61], v81 offset:8192
    ds_read_b64_tr_b16 v[62:63], v81 offset:9216
    s_waitcnt lgkmcnt(0)
    ds_write_b128 v5, v[56:59] offset:4096
    ds_write_b128 v5, v[60:63] offset:5120
    s_branch L_lw_79
L_lw_79_1:
    s_cmp_lg_u32 s44, 2
    s_cbranch_scc1 L_lw_79_2
    ds_read_b64_tr_b16 a[0:1], v80 offset:0
    ds_read_b64_tr_b16 a[2:3], v80 offset:1024
    ds_read_b64_tr_b16 a[4:5], v80 offset:8192
    ds_read_b64_tr_b16 a[6:7], v80 offset:9216
    ds_read_b64_tr_b16 a[8:9], v81 offset:0
    ds_read_b64_tr_b16 a[10:11], v81 offset:1024
    ds_read_b64_tr_b16 a[12:13], v81 offset:8192
    ds_read_b64_tr_b16 a[14:15], v81 offset:9216
    s_branch L_lw_79
L_lw_79_2:
    ds_read_b64_tr_b16 a[120:121], v80 offset:0
    ds_read_b64_tr_b16 a[122:123], v80 offset:1024
    ds_read_b64_tr_b16 a[124:125], v80 offset:8192
    ds_read_b64_tr_b16 a[126:127], v80 offset:9216
    ds_read_b64_tr_b16 v[56:57], v81 offset:0
    ds_read_b64_tr_b16 v[58:59], v81 offset:1024
    ds_read_b64_tr_b16 v[60:61], v81 offset:8192
    ds_read_b64_tr_b16 v[62:63], v81 offset:9216
    s_waitcnt lgkmcnt(0)
    ds_write_b128 v5, v[56:59] offset:0
    ds_write_b128 v5, v[60:63] offset:1024
L_lw_79:
    s_waitcnt lgkmcnt(0)
    s_waitcnt vmcnt(8)
    s_barrier
    s_add_u32 s79, s41, 12
    s_and_b32 s79, s79, 3
    s_lshl_b32 s79, s79, 19
    s_add_u32 s79, s79, s47
    s_add_u32 s46, s79, 0x600000
    s_add_u32 m0, s48, 0
    s_nop 0
    buffer_load_dwordx4 v82, s[32:35], s46 offen  lds
    s_add_u32 s46, s79, 0x620000
    s_add_u32 m0, s48, 4096
    s_nop 0
    buffer_load_dwordx4 v82, s[32:35], s46 offen  lds
    s_add_u32 s46, s79, 0x640000
    s_add_u32 m0, s48, 8192
    s_nop 0
    buffer_load_dwordx4 v82, s[32:35], s46 offen  lds
    s_add_u32 s46, s79, 0x660000
    s_add_u32 m0, s48, 12288
    s_nop 0
    buffer_load_dwordx4 v82, s[32:35], s46 offen  lds
    s_cmp_lg_u32 s44, 0
    s_cbranch_scc1 L_lw_80_0
    ds_read_b64_tr_b16 a[88:89], v80 offset:16384
    ds_read_b64_tr_b16 a[90:91], v80 offset:17408
    ds_read_b64_tr_b16 a[92:93], v80 offset:24576
    ds_read_b64_tr_b16 a[94:95], v80 offset:25600
    ds_read_b64_tr_b16 a[96:97], v81 offset:16384
    ds_read_b64_tr_b16 a[98:99], v81 offset:17408
    ds_read_b64_tr_b16 a[100:101], v81 offset:24576
    ds_read_b64_tr_b16 a[102:103], v81 offset:25600
    s_branch L_lw_80
L_lw_80_0:
    s_cmp_lg_u32 s44, 1
    s_cbranch_scc1 L_lw_80_1
    ds_read_b64_tr_b16 a[56:57], v80 offset:16384
    ds_read_b64_tr_b16 a[58:59], v80 offset:17408
    ds_read_b64_tr_b16 a[60:61], v80 offset:24576
    ds_read_b64_tr_b16 a[62:63], v80 offset:25600
    ds_read_b64_tr_b16 v[56:57], v81 offset:16384
    ds_read_b64_tr_b16 v[58:59], v81 offset:17408
    ds_read_b64_tr_b16 v[60:61], v81 offset:24576
    ds_read_b64_tr_b16 v[62:63], v81 offset:25600
    s_waitcnt lgkmcnt(0)
    ds_write_b128 v5, v[56:59] offset:6144
    ds_write_b128 v5, v[60:63] offset:7168
    s_branch L_lw_80
L_lw_80_1:
    s_cmp_lg_u32 s44, 2
    s_cbranch_scc1 L_lw_80_2
    ds_read_b64_tr_b16 a[16:17], v80 offset:16384
    ds_read_b64_tr_b16 a[18:19], v80 offset:17408
    ds_read_b64_tr_b16 a[20:21], v80 offset:24576
    ds_read_b64_tr_b16 a[22:23], v80 offset:25600
    ds_read_b64_tr_b16 a[24:25], v81 offset:16384
    ds_read_b64_tr_b16 a[26:27], v81 offset:17408
    ds_read_b64_tr_b16 a[28:29], v81 offset:24576
    ds_read_b64_tr_b16 a[30:31], v81 offset:25600
    s_branch L_lw_80
L_lw_80_2:
    ds_read_b64_tr_b16 a[128:129], v80 offset:16384
    ds_read_b64_tr_b16 a[130:131], v80 offset:17408
    ds_read_b64_tr_b16 a[132:133], v80 offset:24576
    ds_read_b64_tr_b16 a[134:135], v80 offset:25600
    ds_read_b64_tr_b16 a[136:137], v81 offset:16384
    ds_read_b64_tr_b16 a[138:139], v81 offset:17408
    ds_read_b64_tr_b16 a[140:141], v81 offset:24576
    ds_read_b64_tr_b16 a[142:143], v81 offset:25600
L_lw_80:
    s_waitcnt lgkmcnt(0)
    s_waitcnt vmcnt(8)
    s_barrier
    s_add_u32 s79, s41, 13
    s_and_b32 s79, s79, 3
    s_lshl_b32 s79, s79, 19
    s_add_u32 s79, s79, s47
    s_add_u32 s46, s79, 0x600000
    s_add_u32 m0, s48, 16384
    s_nop 0
    buffer_load_dwordx4 v82, s[32:35], s46 offen  lds
    s_add_u32 s46, s79, 0x620000
    s_add_u32 m0, s48, 20480
    s_nop 0
    buffer_load_dwordx4 v82, s[32:35], s46 offen  lds
    s_add_u32 s46, s79, 0x640000
    s_add_u32 m0, s48, 24576
    s_nop 0
    buffer_load_dwordx4 v82, s[32:35], s46 offen  lds
    s_add_u32 s46, s79, 0x660000
    s_add_u32 m0, s48, 28672
    s_nop 0
    buffer_load_dwordx4 v82, s[32:35], s46 offen  lds
    s_cmp_lg_u32 s44, 0
    s_cbranch_scc1 L_lw_81_0
    ds_read_b64_tr_b16 a[104:105], v80 offset:32768
    ds_read_b64_tr_b16 a[106:107], v80 offset:33792
    ds_read_b64_tr_b16 a[108:109], v80 offset:40960
    ds_read_b64_tr_b16 a[110:111], v80 offset:41984
    ds_read_b64_tr_b16 v[56:57], v81 offset:32768
    ds_read_b64_tr_b16 v[58:59], v81 offset:33792
    ds_read_b64_tr_b16 v[60:61], v81 offset:40960
    ds_read_b64_tr_b16 v[62:63], v81 offset:41984
    s_waitcnt lgkmcnt(0)
    ds_write_b128 v5, v[56:59] offset:12288
    ds_write_b128 v5, v[60:63] offset:13312
    s_branch L_lw_81
L_lw_81_0:
    s_cmp_lg_u32 s44, 1
    s_cbranch_scc1 L_lw_81_1
    ds_read_b64_tr_b16 a[64:65], v80 offset:32768
    ds_read_b64_tr_b16 a[66:67], v80 offset:33792
    ds_read_b64_tr_b16 a[68:69], v80 offset:40960
    ds_read_b64_tr_b16 a[70:71], v80 offset:41984
    ds_read_b64_tr_b16 v[56:57], v81 offset:32768
    ds_read_b64_tr_b16 v[58:59], v81 offset:33792
    ds_read_b64_tr_b16 v[60:61], v81 offset:40960
    ds_read_b64_tr_b16 v[62:63], v81 offset:41984
    s_waitcnt lgkmcnt(0)
    ds_write_b128 v5, v[56:59] offset:14336
    ds_write_b128 v5, v[60:63] offset:15360
    s_branch L_lw_81
L_lw_81_1:
    s_cmp_lg_u32 s44, 2
    s_cbranch_scc1 L_lw_81_2
    ds_read_b64_tr_b16 a[32:33], v80 offset:32768
    ds_read_b64_tr_b16 a[34:35], v80 offset:33792
    ds_read_b64_tr_b16 a[36:37], v80 offset:40960
    ds_read_b64_tr_b16 a[38:39], v80 offset:41984
    ds_read_b64_tr_b16 v[56:57], v81 offset:32768
    ds_read_b64_tr_b16 v[58:59], v81 offset:33792
    ds_read_b64_tr_b16 v[60:61], v81 offset:40960
    ds_read_b64_tr_b16 v[62:63], v81 offset:41984
    s_waitcnt lgkmcnt(0)
    ds_write_b128 v5, v[56:59] offset:8192
    ds_write_b128 v5, v[60:63] offset:9216
    s_branch L_lw_81
L_lw_81_2:
    ds_read_b64_tr_b16 a[144:145], v80 offset:32768
    ds_read_b64_tr_b16 a[146:147], v80 offset:33792
    ds_read_b64_tr_b16 a[148:149], v80 offset:40960
    ds_read_b64_tr_b16 a[150:151], v80 offset:41984
    ds_read_b64_tr_b16 v[56:57], v81 offset:32768
    ds_read_b64_tr_b16 v[58:59], v81 offset:33792
    ds_read_b64_tr_b16 v[60:61], v81 offset:40960
    ds_read_b64_tr_b16 v[62:63], v81 offset:41984
    s_waitcnt lgkmcnt(0)
    ds_write_b128 v5, v[56:59] offset:10240
    ds_write_b128 v5, v[60:63] offset:11264
L_lw_81:
    s_waitcnt lgkmcnt(0)
    s_waitcnt vmcnt(8)
    s_barrier
    s_add_u32 s79, s41, 14
    s_and_b32 s79, s79, 3
    s_lshl_b32 s79, s79, 19
    s_add_u32 s79, s79, s47
    s_add_u32 s46, s79, 0x600000
    s_add_u32 m0, s48, 32768
    s_nop 0
    buffer_load_dwordx4 v82, s[32:35], s46 offen  lds
    s_add_u32 s46, s79, 0x620000
    s_add_u32 m0, s48, 36864
    s_nop 0
    buffer_load_dwordx4 v82, s[32:35], s46 offen  lds
    s_add_u32 s46, s79, 0x640000
    s_add_u32 m0, s48, 40960
    s_nop 0
    buffer_load_dwordx4 v82, s[32:35], s46 offen  lds
    s_add_u32 s46, s79, 0x660000
    s_add_u32 m0, s48, 45056
    s_nop 0
    buffer_load_dwordx4 v82, s[32:35], s46 offen  lds
    s_cmp_lg_u32 s44, 0
    s_cbranch_scc1 L_lw_82_0
    ds_read_b64_tr_b16 a[112:113], v80 offset:49152
    ds_read_b64_tr_b16 a[114:115], v80 offset:50176
    ds_read_b64_tr_b16 a[116:117], v80 offset:57344
    ds_read_b64_tr_b16 a[118:119], v80 offset:58368
    ds_read_b64_tr_b16 v[56:57], v81 offset:49152
    ds_read_b64_tr_b16 v[58:59], v81 offset:50176
    ds_read_b64_tr_b16 v[60:61], v81 offset:57344
    ds_read_b64_tr_b16 v[62:63], v81 offset:58368
    s_waitcnt lgkmcnt(0)
    ds_write_b128 v5, v[56:59] offset:20480
    ds_write_b128 v5, v[60:63] offset:21504
    s_branch L_lw_82
L_lw_82_0:
    s_cmp_lg_u32 s44, 1
    s_cbranch_scc1 L_lw_82_1
    ds_read_b64_tr_b16 a[72:73], v80 offset:49152
    ds_read_b64_tr_b16 a[74:75], v80 offset:50176
    ds_read_b64_tr_b16 a[76:77], v80 offset:57344
    ds_read_b64_tr_b16 a[78:79], v80 offset:58368
    ds_read_b64_tr_b16 v[56:57], v81 offset:49152
    ds_read_b64_tr_b16 v[58:59], v81 offset:50176
    ds_read_b64_tr_b16 v[60:61], v81 offset:57344
    ds_read_b64_tr_b16 v[62:63], v81 offset:58368
    s_waitcnt lgkmcnt(0)
    ds_write_b128 v5, v[56:59] offset:22528
    ds_write_b128 v5, v[60:63] offset:23552
    s_branch L_lw_82
L_lw_82_1:
    s_cmp_lg_u32 s44, 2
    s_cbranch_scc1 L_lw_82_2
    ds_read_b64_tr_b16 a[40:41], v80 offset:49152
    ds_read_b64_tr_b16 a[42:43], v80 offset:50176
    ds_read_b64_tr_b16 a[44:45], v80 offset:57344
    ds_read_b64_tr_b16 a[46:47], v80 offset:58368
    ds_read_b64_tr_b16 v[56:57], v81 offset:49152
    ds_read_b64_tr_b16 v[58:59], v81 offset:50176
    ds_read_b64_tr_b16 v[60:61], v81 offset:57344
    ds_read_b64_tr_b16 v[62:63], v81 offset:58368
    s_waitcnt lgkmcnt(0)
    ds_write_b128 v5, v[56:59] offset:16384
    ds_write_b128 v5, v[60:63] offset:17408
    s_branch L_lw_82
L_lw_82_2:
    ds_read_b64_tr_b16 a[152:153], v80 offset:49152
    ds_read_b64_tr_b16 a[154:155], v80 offset:50176
    ds_read_b64_tr_b16 a[156:157], v80 offset:57344
    ds_read_b64_tr_b16 a[158:159], v80 offset:58368
    ds_read_b64_tr_b16 v[56:57], v81 offset:49152
    ds_read_b64_tr_b16 v[58:59], v81 offset:50176
    ds_read_b64_tr_b16 v[60:61], v81 offset:57344
    ds_read_b64_tr_b16 v[62:63], v81 offset:58368
    s_waitcnt lgkmcnt(0)
    ds_write_b128 v5, v[56:59] offset:18432
    ds_write_b128 v5, v[60:63] offset:19456
L_lw_82:
    s_waitcnt lgkmcnt(0)
    s_waitcnt vmcnt(8)
    s_barrier
    s_add_u32 s79, s41, 15
    s_and_b32 s79, s79, 3
    s_lshl_b32 s79, s79, 19
    s_add_u32 s79, s79, s47
    s_add_u32 s46, s79, 0x600000
    s_add_u32 m0, s48, 49152
    s_nop 0
    buffer_load_dwordx4 v82, s[32:35], s46 offen  lds
    s_add_u32 s46, s79, 0x620000
    s_add_u32 m0, s48, 53248
    s_nop 0
    buffer_load_dwordx4 v82, s[32:35], s46 offen  lds
    s_add_u32 s46, s79, 0x640000
    s_add_u32 m0, s48, 57344
    s_nop 0
    buffer_load_dwordx4 v82, s[32:35], s46 offen  lds
    s_add_u32 s46, s79, 0x660000
    s_add_u32 m0, s48, 61440
    s_nop 0
    buffer_load_dwordx4 v82, s[32:35], s46 offen  lds
    v_mov_b32 v46, 0
    buffer_load_dwordx2 v[44:45], v46, s[16:19], 0 offen sc1
    s_cmp_lg_u32 s44, 0
    s_cbranch_scc1 L_lw_83_0
    ds_read_b64_tr_b16 a[120:121], v80 offset:0
    ds_read_b64_tr_b16 a[122:123], v80 offset:1024
    ds_read_b64_tr_b16 a[124:125], v80 offset:8192
    ds_read_b64_tr_b16 a[126:127], v80 offset:9216
    ds_read_b64_tr_b16 v[56:57], v81 offset:0
    ds_read_b64_tr_b16 v[58:59], v81 offset:1024
    ds_read_b64_tr_b16 v[60:61], v81 offset:8192
    ds_read_b64_tr_b16 v[62:63], v81 offset:9216
    s_waitcnt lgkmcnt(0)
    ds_write_b128 v5, v[56:59] offset:0
    ds_write_b128 v5, v[60:63] offset:1024
    s_branch L_lw_83
L_lw_83_0:
    s_cmp_lg_u32 s44, 1
    s_cbranch_scc1 L_lw_83_1
    ds_read_b64_tr_b16 a[80:81], v80 offset:0
    ds_read_b64_tr_b16 a[82:83], v80 offset:1024
    ds_read_b64_tr_b16 a[84:85], v80 offset:8192
    ds_read_b64_tr_b16 a[86:87], v80 offset:9216
    ds_read_b64_tr_b16 v[56:57], v81 offset:0
    ds_read_b64_tr_b16 v[58:59], v81 offset:1024
    ds_read_b64_tr_b16 v[60:61], v81 offset:8192
    ds_read_b64_tr_b16 v[62:63], v81 offset:9216
    s_waitcnt lgkmcnt(0)
    ds_write_b128 v5, v[56:59] offset:2048
    ds_write_b128 v5, v[60:63] offset:3072
    s_branch L_lw_83
L_lw_83_1:
    s_cmp_lg_u32 s44, 2
    s_cbranch_scc1 L_lw_83_2
    ds_read_b64_tr_b16 a[48:49], v80 offset:0
    ds_read_b64_tr_b16 a[50:51], v80 offset:1024
    ds_read_b64_tr_b16 a[52:53], v80 offset:8192
    ds_read_b64_tr_b16 a[54:55], v80 offset:9216
    ds_read_b64_tr_b16 v[56:57], v81 offset:0
    ds_read_b64_tr_b16 v[58:59], v81 offset:1024
    ds_read_b64_tr_b16 v[60:61], v81 offset:8192
    ds_read_b64_tr_b16 v[62:63], v81 offset:9216
    s_waitcnt lgkmcnt(0)
    ds_write_b128 v5, v[56:59] offset:4096
    ds_write_b128 v5, v[60:63] offset:5120
    s_branch L_lw_83
L_lw_83_2:
    ds_read_b64_tr_b16 a[0:1], v80 offset:0
    ds_read_b64_tr_b16 a[2:3], v80 offset:1024
    ds_read_b64_tr_b16 a[4:5], v80 offset:8192
    ds_read_b64_tr_b16 a[6:7], v80 offset:9216
    ds_read_b64_tr_b16 a[8:9], v81 offset:0
    ds_read_b64_tr_b16 a[10:11], v81 offset:1024
    ds_read_b64_tr_b16 a[12:13], v81 offset:8192
    ds_read_b64_tr_b16 a[14:15], v81 offset:9216
L_lw_83:
    s_waitcnt lgkmcnt(0)
    s_waitcnt vmcnt(8)
    s_barrier
    s_cmp_lg_u32 s44, 0
    s_cbranch_scc1 L_lw_84_0
    ds_read_b64_tr_b16 a[128:129], v80 offset:16384
    ds_read_b64_tr_b16 a[130:131], v80 offset:17408
    ds_read_b64_tr_b16 a[132:133], v80 offset:24576
    ds_read_b64_tr_b16 a[134:135], v80 offset:25600
    ds_read_b64_tr_b16 a[136:137], v81 offset:16384
    ds_read_b64_tr_b16 a[138:139], v81 offset:17408
    ds_read_b64_tr_b16 a[140:141], v81 offset:24576
    ds_read_b64_tr_b16 a[142:143], v81 offset:25600
    s_branch L_lw_84
L_lw_84_0:
    s_cmp_lg_u32 s44, 1
    s_cbranch_scc1 L_lw_84_1
    ds_read_b64_tr_b16 a[88:89], v80 offset:16384
    ds_read_b64_tr_b16 a[90:91], v80 offset:17408
    ds_read_b64_tr_b16 a[92:93], v80 offset:24576
    ds_read_b64_tr_b16 a[94:95], v80 offset:25600
    ds_read_b64_tr_b16 a[96:97], v81 offset:16384
    ds_read_b64_tr_b16 a[98:99], v81 offset:17408
    ds_read_b64_tr_b16 a[100:101], v81 offset:24576
    ds_read_b64_tr_b16 a[102:103], v81 offset:25600
    s_branch L_lw_84
L_lw_84_1:
    s_cmp_lg_u32 s44, 2
    s_cbranch_scc1 L_lw_84_2
    ds_read_b64_tr_b16 a[56:57], v80 offset:16384
    ds_read_b64_tr_b16 a[58:59], v80 offset:17408
    ds_read_b64_tr_b16 a[60:61], v80 offset:24576
    ds_read_b64_tr_b16 a[62:63], v80 offset:25600
    ds_read_b64_tr_b16 v[56:57], v81 offset:16384
    ds_read_b64_tr_b16 v[58:59], v81 offset:17408
    ds_read_b64_tr_b16 v[60:61], v81 offset:24576
    ds_read_b64_tr_b16 v[62:63], v81 offset:25600
    s_waitcnt lgkmcnt(0)
    ds_write_b128 v5, v[56:59] offset:6144
    ds_write_b128 v5, v[60:63] offset:7168
    s_branch L_lw_84
L_lw_84_2:
    ds_read_b64_tr_b16 a[16:17], v80 offset:16384
    ds_read_b64_tr_b16 a[18:19], v80 offset:17408
    ds_read_b64_tr_b16 a[20:21], v80 offset:24576
    ds_read_b64_tr_b16 a[22:23], v80 offset:25600
    ds_read_b64_tr_b16 a[24:25], v81 offset:16384
    ds_read_b64_tr_b16 a[26:27], v81 offset:17408
    ds_read_b64_tr_b16 a[28:29], v81 offset:24576
    ds_read_b64_tr_b16 a[30:31], v81 offset:25600
L_lw_84:
    s_waitcnt lgkmcnt(0)
    s_waitcnt vmcnt(4)
    s_barrier
    s_cmp_lg_u32 s44, 0
    s_cbranch_scc1 L_lw_85_0
    ds_read_b64_tr_b16 a[144:145], v80 offset:32768
    ds_read_b64_tr_b16 a[146:147], v80 offset:33792
    ds_read_b64_tr_b16 a[148:149], v80 offset:40960
    ds_read_b64_tr_b16 a[150:151], v80 offset:41984
    ds_read_b64_tr_b16 v[56:57], v81 offset:32768
    ds_read_b64_tr_b16 v[58:59], v81 offset:33792
    ds_read_b64_tr_b16 v[60:61], v81 offset:40960
    ds_read_b64_tr_b16 v[62:63], v81 offset:41984
    s_waitcnt lgkmcnt(0)
    ds_write_b128 v5, v[56:59] offset:10240
    ds_write_b128 v5, v[60:63] offset:11264
    s_branch L_lw_85
L_lw_85_0:
    s_cmp_lg_u32 s44, 1
    s_cbranch_scc1 L_lw_85_1
    ds_read_b64_tr_b16 a[104:105], v80 offset:32768
    ds_read_b64_tr_b16 a[106:107], v80 offset:33792
    ds_read_b64_tr_b16 a[108:109], v80 offset:40960
    ds_read_b64_tr_b16 a[110:111], v80 offset:41984
    ds_read_b64_tr_b16 v[56:57], v81 offset:32768
    ds_read_b64_tr_b16 v[58:59], v81 offset:33792
    ds_read_b64_tr_b16 v[60:61], v81 offset:40960
    ds_read_b64_tr_b16 v[62:63], v81 offset:41984
    s_waitcnt lgkmcnt(0)
    ds_write_b128 v5, v[56:59] offset:12288
    ds_write_b128 v5, v[60:63] offset:13312
    s_branch L_lw_85
L_lw_85_1:
    s_cmp_lg_u32 s44, 2
    s_cbranch_scc1 L_lw_85_2
    ds_read_b64_tr_b16 a[64:65], v80 offset:32768
    ds_read_b64_tr_b16 a[66:67], v80 offset:33792
    ds_read_b64_tr_b16 a[68:69], v80 offset:40960
    ds_read_b64_tr_b16 a[70:71], v80 offset:41984
    ds_read_b64_tr_b16 v[56:57], v81 offset:32768
    ds_read_b64_tr_b16 v[58:59], v81 offset:33792
    ds_read_b64_tr_b16 v[60:61], v81 offset:40960
    ds_read_b64_tr_b16 v[62:63], v81 offset:41984
    s_waitcnt lgkmcnt(0)
    ds_write_b128 v5, v[56:59] offset:14336
    ds_write_b128 v5, v[60:63] offset:15360
    s_branch L_lw_85
L_lw_85_2:
    ds_read_b64_tr_b16 a[32:33], v80 offset:32768
    ds_read_b64_tr_b16 a[34:35], v80 offset:33792
    ds_read_b64_tr_b16 a[36:37], v80 offset:40960
    ds_read_b64_tr_b16 a[38:39], v80 offset:41984
    ds_read_b64_tr_b16 v[56:57], v81 offset:32768
    ds_read_b64_tr_b16 v[58:59], v81 offset:33792
    ds_read_b64_tr_b16 v[60:61], v81 offset:40960
    ds_read_b64_tr_b16 v[62:63], v81 offset:41984
    s_waitcnt lgkmcnt(0)
    ds_write_b128 v5, v[56:59] offset:8192
    ds_write_b128 v5, v[60:63] offset:9216
L_lw_85:
    s_waitcnt lgkmcnt(0)
    s_waitcnt vmcnt(0)
    s_barrier
    s_cmp_lg_u32 s44, 0
    s_cbranch_scc1 L_lw_86_0
    ds_read_b64_tr_b16 a[152:153], v80 offset:49152
    ds_read_b64_tr_b16 a[154:155], v80 offset:50176
    ds_read_b64_tr_b16 a[156:157], v80 offset:57344
    ds_read_b64_tr_b16 a[158:159], v80 offset:58368
    ds_read_b64_tr_b16 v[56:57], v81 offset:49152
    ds_read_b64_tr_b16 v[58:59], v81 offset:50176
    ds_read_b64_tr_b16 v[60:61], v81 offset:57344
    ds_read_b64_tr_b16 v[62:63], v81 offset:58368
    s_waitcnt lgkmcnt(0)
    ds_write_b128 v5, v[56:59] offset:18432
    ds_write_b128 v5, v[60:63] offset:19456
    s_branch L_lw_86
L_lw_86_0:
    s_cmp_lg_u32 s44, 1
    s_cbranch_scc1 L_lw_86_1
    ds_read_b64_tr_b16 a[112:113], v80 offset:49152
    ds_read_b64_tr_b16 a[114:115], v80 offset:50176
    ds_read_b64_tr_b16 a[116:117], v80 offset:57344
    ds_read_b64_tr_b16 a[118:119], v80 offset:58368
    ds_read_b64_tr_b16 v[56:57], v81 offset:49152
    ds_read_b64_tr_b16 v[58:59], v81 offset:50176
    ds_read_b64_tr_b16 v[60:61], v81 offset:57344
    ds_read_b64_tr_b16 v[62:63], v81 offset:58368
    s_waitcnt lgkmcnt(0)
    ds_write_b128 v5, v[56:59] offset:20480
    ds_write_b128 v5, v[60:63] offset:21504
    s_branch L_lw_86
L_lw_86_1:
    s_cmp_lg_u32 s44, 2
    s_cbranch_scc1 L_lw_86_2
    ds_read_b64_tr_b16 a[72:73], v80 offset:49152
    ds_read_b64_tr_b16 a[74:75], v80 offset:50176
    ds_read_b64_tr_b16 a[76:77], v80 offset:57344
    ds_read_b64_tr_b16 a[78:79], v80 offset:58368
    ds_read_b64_tr_b16 v[56:57], v81 offset:49152
    ds_read_b64_tr_b16 v[58:59], v81 offset:50176
    ds_read_b64_tr_b16 v[60:61], v81 offset:57344
    ds_read_b64_tr_b16 v[62:63], v81 offset:58368
    s_waitcnt lgkmcnt(0)
    ds_write_b128 v5, v[56:59] offset:22528
    ds_write_b128 v5, v[60:63] offset:23552
    s_branch L_lw_86
L_lw_86_2:
    ds_read_b64_tr_b16 a[40:41], v80 offset:49152
    ds_read_b64_tr_b16 a[42:43], v80 offset:50176
    ds_read_b64_tr_b16 a[44:45], v80 offset:57344
    ds_read_b64_tr_b16 a[46:47], v80 offset:58368
    ds_read_b64_tr_b16 v[56:57], v81 offset:49152
    ds_read_b64_tr_b16 v[58:59], v81 offset:50176
    ds_read_b64_tr_b16 v[60:61], v81 offset:57344
    ds_read_b64_tr_b16 v[62:63], v81 offset:58368
    s_waitcnt lgkmcnt(0)
    ds_write_b128 v5, v[56:59] offset:16384
    ds_write_b128 v5, v[60:63] offset:17408
L_lw_86:
    s_waitcnt lgkmcnt(0)
    s_barrier
    v_lshlrev_b32 v68, 4, v1
    s_mul_i32 s45, s44, 3072
    s_add_u32 s45, s45, 53248
    v_add_u32 v6, s45, v68
    s_sub_u32 s45, s44, 1
    s_and_b32 s45, s45, 3
    s_mul_i32 s45, s45, 3072
    s_add_u32 s45, s45, 53248
    v_add_u32 v7, s45, v68
    s_sub_u32 s45, s44, 2
    s_and_b32 s45, s45, 3
    s_mul_i32 s45, s45, 3072
    s_add_u32 s45, s45, 54272
    v_add_u32 v8, s45, v68
    s_sub_u32 s45, s44, 3
    s_and_b32 s45, s45, 3
    s_mul_i32 s45, s45, 3072
    s_add_u32 s45, s45, 55296
    v_add_u32 v18, s45, v68
    v_lshlrev_b32 v68, 4, v1
    s_add_u32 s45, s69, 0
    s_and_b32 s45, s45, 7
    s_lshl_b32 s45, s45, 10
    s_lshl_b32 s46, s44, 13
    s_add_u32 s45, s45, s46
    v_add_u32 v80, s45, v68
    s_add_u32 s45, s69, 1
    s_and_b32 s45, s45, 7
    s_lshl_b32 s45, s45, 10
    s_lshl_b32 s46, s44, 13
    s_add_u32 s45, s45, s46
    v_add_u32 v81, s45, v68
    s_add_u32 s45, s69, 2
    s_and_b32 s45, s45, 7
    s_lshl_b32 s45, s45, 10
    s_lshl_b32 s46, s44, 13
    s_add_u32 s45, s45, s46
    v_add_u32 v82, s45, v68
    s_add_u32 s45, s69, 3
    s_and_b32 s45, s45, 7
    s_lshl_b32 s45, s45, 10
    s_lshl_b32 s46, s44, 13
    s_add_u32 s45, s45, s46
    v_add_u32 v83, s45, v68
    s_add_u32 s45, s69, 4
    s_and_b32 s45, s45, 7
    s_lshl_b32 s45, s45, 10
    s_lshl_b32 s46, s44, 13
    s_add_u32 s45, s45, s46
    v_add_u32 v84, s45, v68
    s_add_u32 s45, s69, 5
    s_and_b32 s45, s45, 7
    s_lshl_b32 s45, s45, 10
    s_lshl_b32 s46, s44, 13
    s_add_u32 s45, s45, s46
    v_add_u32 v85, s45, v68
    s_add_u32 s45, s69, 6
    s_and_b32 s45, s45, 7
    s_lshl_b32 s45, s45, 10
    s_lshl_b32 s46, s44, 13
    s_add_u32 s45, s45, s46
    v_add_u32 v86, s45, v68
    s_add_u32 s45, s69, 7
    s_and_b32 s45, s45, 7
    s_lshl_b32 s45, s45, 10
    s_lshl_b32 s46, s44, 13
    s_add_u32 s45, s45, s46
    v_add_u32 v87, s45, v68
    s_lshl_b32 s45, s40, 4
    s_add_u32 s45, s45, s42
    s_lshl_b32 s45, s45, 8
    s_lshl_b32 s46, s44, 6
    s_add_u32 s45, s45, s46
    s_add_u32 s45, s45, 0x7080000
    v_and_b32 v13, 15, v1
    v_lshlrev_b32 v13, 2, v13
    v_add_u32 v13, s45, v13
    s_mov_b32 s66, 0x1800000
    v_mov_b32 v14, -1
    v_mov_b32 v15, -1
    s_mov_b32 s70, 0
    v_mov_b32 v41, 0
    s_branch L_hw_87_c
L_hw_87:
    buffer_load_dwordx2 v[44:45], v41, s[16:19], 0 offen sc1
    s_add_u32 s70, s70, 1
    s_cmp_ge_u32 s70, 0x100000
    s_cbranch_scc1 L_c_done_1
L_hw_87_c:
    s_waitcnt vmcnt(0)
    v_readfirstlane_b32 s45, v44
    v_readfirstlane_b32 s46, v45
    s_nop 3
    s_lshr_b32 s47, s46, 24
    s_cmp_lg_u32 s47, 64
    s_cbranch_scc1 L_hw_87
    s_lshr_b32 s68, s45, 24
    s_and_b32 s47, s45, 511
    s_mul_i32 s47, s47, s47
    s_bfe_u32 s45, s45, 0xf0009
    s_lshl_b32 s45, s45, 5
    s_sub_u32 s45, s45, s47
    s_and_b32 s47, s46, 511
    s_mul_i32 s47, s47, s47
    s_bfe_u32 s46, s46, 0xf0009
    s_lshl_b32 s46, s46, 5
    s_sub_u32 s46, s46, s47
    s_or_b32 s45, s45, s46
    s_cmp_eq_u32 s45, 0
    s_cselect_b32 s67, 1, 0
    s_mov_b32 s24, s12
    s_mov_b32 s25, s13
    s_mov_b32 s28, s12
    s_mov_b32 s29, s13
    s_cmp_eq_u32 s67, 1
    s_cselect_b32 s26, s14, 0
    s_cselect_b32 s30, 0, s14
    s_cmp_ge_u32 s68, 16
    s_cselect_b32 s68, 8192, 0
    s_mov_b32 s6, 0x11111111
    s_mov_b32 s7, 0xffaaa491
    s_mov_b32 s60, 0
    s_lshl_b32 s58, s40, 16
    s_add_u32 s58, s58, 0x7000000
    s_mov_b32 s61, s58
    s_lshl_b32 s59, s40, 17
    s_add_u32 s59, s59, 0x7040000
    s_mov_b32 s62, s59
    s_add_u32 s32, s41, 0
    s_and_b32 s32, s32, 3
    s_lshl_b32 s32, s32, 10
    s_add_u32 s33, s41, 1
    s_and_b32 s33, s33, 3
    s_lshl_b32 s33, s33, 10
    s_add_u32 s34, s41, 2
    s_and_b32 s34, s34, 3
    s_lshl_b32 s34, s34, 10
    s_add_u32 s35, s41, 3
    s_and_b32 s35, s35, 3
    s_lshl_b32 s35, s35, 10
    s_cmp_lg_u32 s44, 0
    s_cbranch_scc1 L_ld_88
    v_mov_b32 v40, 1
    v_mov_b32 v41, 127360
    s_mov_b64 exec, 1
    buffer_atomic_add v40, v41, s[12:15], 0 offen sc1
    s_mov_b64 exec, -1
L_ld_88:
    s_add_u32 s63, s63, s68
    s_add_u32 s64, s64, s68
    ds_read_b128 v[56:59], v5 offset:8192
    ds_read_b128 v[60:63], v5 offset:9216
    ds_read_b128 v[64:67], v5 offset:16384
    ds_read_b128 v[68:71], v5 offset:17408
    ds_read_b128 v[72:75], v5 offset:4096
    ds_read_b128 v[76:79], v5 offset:5120
    ds_read_b128 v[88:91], v5 offset:6144
    ds_read_b128 v[92:95], v5 offset:7168
    ds_read_b128 v[32:35], v5 offset:14336
    ds_read_b128 v[36:39], v5 offset:15360
L_v_loop_89:
    s_add_u32 s8, s61, s32
    s_add_u32 s9, s61, s33
    s_add_u32 s10, s61, s34
    s_add_u32 s11, s61, s35
    s_nop 15
    s_nop 15
    s_waitcnt lgkmcnt(0)
    buffer_load_dwordx4 v[40:43], v3, s[12:15], s8 offen sc1
    v_mov_b32 v24, 0
    v_mov_b32 v25, 0
    v_mov_b32 v26, 0
    v_mov_b32 v27, 0
    v_mov_b32 v28, 0
    buffer_load_dwordx4 v[44:47], v3, s[12:15], s9 offen sc1
    v_mov_b32 v29, 0
    v_mov_b32 v30, 0
    v_mov_b32 v31, 0
    s_nop 1
    buffer_load_dwordx4 v[48:51], v3, s[12:15], s10 offen sc1
    s_nop 4
    buffer_load_dwordx4 v[52:55], v3, s[12:15], s11 offen sc1
    s_mov_b32 s70, 0
    s_waitcnt vmcnt(3)
    v_max3_u32 v22, v40, v41, v42
    ds_write_b128 v3, v[40:43] offset:0
    v_max_u32 v22, v22, v43
    v_cmp_eq_u32 vcc, -1, v22
    s_nop 0
    s_nop 0
    s_cbranch_vccnz L_mg_90_r0
L_mg_90_c0:
    v_smfmac_f32_16x16x64_bf16 v[24:27], v[40:43], a[0:7], v2
    s_waitcnt vmcnt(2)
    v_max3_u32 v22, v44, v45, v46
    ds_write_b128 v3, v[44:47] offset:1024
    v_max_u32 v22, v22, v47
    v_cmp_eq_u32 vcc, -1, v22
    v_smfmac_f32_16x16x64_bf16 v[28:31], v[40:43], a[8:15], v2
    s_nop 0
    s_cbranch_vccnz L_mg_90_r1
L_mg_90_c1:
    v_smfmac_f32_16x16x64_bf16 v[24:27], v[44:47], a[16:23], v2
    s_waitcnt vmcnt(1)
    v_max3_u32 v22, v48, v49, v50
    ds_write_b128 v3, v[48:51] offset:2048
    v_max_u32 v22, v22, v51
    v_cmp_eq_u32 vcc, -1, v22
    v_smfmac_f32_16x16x64_bf16 v[28:31], v[44:47], a[24:31], v2
    s_nop 0
    s_cbranch_vccnz L_mg_90_r2
L_mg_90_c2:
    s_waitcnt vmcnt(0)
    v_max3_u32 v22, v52, v53, v54
    ds_write_b128 v3, v[52:55] offset:3072
    v_max_u32 v22, v22, v55
    v_cmp_eq_u32 vcc, -1, v22
    s_waitcnt lgkmcnt(0)
    s_nop 0
    s_cbranch_vccnz L_mg_90_r3
L_mg_90_c3:
    s_barrier
    ds_read_b128 v[40:43], v4 offset:0
    ds_read_b128 v[44:47], v4 offset:1024
    v_smfmac_f32_16x16x64_bf16 v[24:27], v[48:51], a[32:39], v2
    v_smfmac_f32_16x16x64_bf16 v[28:31], v[48:51], v[56:63], v2
    ds_read_b128 v[48:51], v4 offset:2048
    v_smfmac_f32_16x16x64_bf16 v[24:27], v[52:55], a[40:47], v2
    ds_read_b128 v[56:59], v5 offset:22528
    v_smfmac_f32_16x16x64_bf16 v[28:31], v[52:55], v[64:71], v2
    ds_read_b128 v[52:55], v4 offset:3072
    ds_read_b128 v[60:63], v5 offset:23552
    s_waitcnt lgkmcnt(4)
    v_smfmac_f32_16x16x64_bf16 v[24:27], v[40:43], a[48:55], v2
    ds_read_b128 v[64:67], v5 offset:2048
    v_smfmac_f32_16x16x64_bf16 v[28:31], v[40:43], v[72:79], v2
    ds_read_b128 v[40:43], v21 offset:0
    ds_read_b128 v[68:71], v5 offset:3072
    v_smfmac_f32_16x16x64_bf16 v[24:27], v[44:47], a[56:63], v2
    ds_read_b128 v[72:75], v5 offset:12288
    v_smfmac_f32_16x16x64_bf16 v[28:31], v[44:47], v[88:95], v2
    ds_read_b128 v[44:47], v21 offset:1024
    ds_read_b128 v[76:79], v5 offset:13312
    s_waitcnt lgkmcnt(6)
    v_smfmac_f32_16x16x64_bf16 v[24:27], v[48:51], a[64:71], v2
    ds_read_b128 v[88:91], v5 offset:20480
    v_smfmac_f32_16x16x64_bf16 v[28:31], v[48:51], v[32:39], v2
    ds_read_b128 v[48:51], v21 offset:2048
    ds_read_b128 v[92:95], v5 offset:21504
    v_smfmac_f32_16x16x64_bf16 v[24:27], v[52:55], a[72:79], v2
    ds_read_b128 v[32:35], v5 offset:0
    v_smfmac_f32_16x16x64_bf16 v[28:31], v[52:55], v[56:63], v2
    ds_read_b128 v[52:55], v21 offset:3072
    ds_read_b128 v[36:39], v5 offset:1024
    s_waitcnt lgkmcnt(6)
    v_smfmac_f32_16x16x64_bf16 v[24:27], v[40:43], a[80:87], v2
    ds_read_b128 v[56:59], v5 offset:10240
    v_smfmac_f32_16x16x64_bf16 v[28:31], v[40:43], v[64:71], v2
    ds_read_b128 v[40:43], v23 offset:0
    ds_read_b128 v[60:63], v5 offset:11264
    v_smfmac_f32_16x16x64_bf16 v[24:27], v[44:47], a[88:95], v2
    ds_read_b128 v[64:67], v5 offset:18432
    v_smfmac_f32_16x16x64_bf16 v[28:31], v[44:47], a[96:103], v2
    ds_read_b128 v[44:47], v23 offset:1024
    s_waitcnt lgkmcnt(5)
    v_smfmac_f32_16x16x64_bf16 v[24:27], v[48:51], a[104:111], v2
    ds_read_b128 v[68:71], v5 offset:19456
    v_smfmac_f32_16x16x64_bf16 v[28:31], v[48:51], v[72:79], v2
    ds_read_b128 v[48:51], v23 offset:2048
    v_smfmac_f32_16x16x64_bf16 v[24:27], v[52:55], a[112:119], v2
    v_smfmac_f32_16x16x64_bf16 v[28:31], v[52:55], v[88:95], v2
    ds_read_b128 v[52:55], v23 offset:3072
    s_waitcnt lgkmcnt(3)
    v_smfmac_f32_16x16x64_bf16 v[24:27], v[40:43], a[120:127], v2
    v_smfmac_f32_16x16x64_bf16 v[28:31], v[40:43], v[32:39], v2
    v_smfmac_f32_16x16x64_bf16 v[24:27], v[44:47], a[128:135], v2
    v_smfmac_f32_16x16x64_bf16 v[28:31], v[44:47], a[136:143], v2
    s_waitcnt lgkmcnt(0)
    v_smfmac_f32_16x16x64_bf16 v[24:27], v[48:51], a[144:151], v2
    v_smfmac_f32_16x16x64_bf16 v[28:31], v[48:51], v[56:63], v2
    v_smfmac_f32_16x16x64_bf16 v[24:27], v[52:55], a[152:159], v2
    v_smfmac_f32_16x16x64_bf16 v[28:31], v[52:55], v[64:71], v2
    s_and_b32 s45, s60, 1
    s_lshl_b32 s45, s45, 16
    s_add_u32 s45, s45, 0x7020000
    s_xor_b32 s46, s45, 65536
    s_nop 3
    v_permlane32_swap_b32 v24, v26
    v_permlane32_swap_b32 v25, v27
    v_permlane32_swap_b32 v28, v30
    v_permlane32_swap_b32 v29, v31
    v_pk_add_f32 v[24:25], v[24:25], v[26:27]
    v_pk_add_f32 v[28:29], v[28:29], v[30:31]
    v_cvt_pk_bf16_f32 v16, v24, v25
    v_cvt_pk_bf16_f32 v17, v28, v29
    s_add_u32 s47, s60, 3
    s_and_b32 s47, s47, 3
    s_lshl_b32 s47, s47, 14
    s_add_u32 s47, s47, s58
    buffer_store_dwordx2 v[16:17], v10, s[24:27], s45 offen
    buffer_store_dwordx2 v[14:15], v10, s[24:27], s46 offen
    buffer_store_dword v14, v12, s[24:27], s47 offen
    buffer_store_dwordx2 v[16:17], v10, s[28:31], s45 offen sc1
    buffer_store_dwordx2 v[14:15], v10, s[28:31], s46 offen sc1
    buffer_store_dword v14, v12, s[28:31], s47 offen sc1
    s_barrier
    s_cmp_eq_u32 s60, 63
    s_cbranch_scc1 L_v_fin_91
    s_and_b32 s65, s60, 1
    s_lshl_b32 s65, s65, 12
    s_and_b32 s45, s60, 2
    s_lshl_b32 s45, s45, 13
    s_add_u32 s65, s65, s45
    s_xor_b32 s45, s65, 16384
    s_add_u32 s45, s45, s63
    buffer_store_dwordx2 v[14:15], v11, s[12:15], s45 offen sc1
    s_add_u32 s48, s63, s65
    s_add_u32 s49, s64, s65
    s_sleep 8
    s_waitcnt vmcnt(0)
    s_mov_b64 exec, 65535
    buffer_load_dword v88, v13, s[12:15], 0 offen sc1
    s_nop 15
    buffer_load_dword v89, v13, s[12:15], 0 offen sc1
    s_nop 15
    buffer_load_dword v90, v13, s[12:15], 0 offen sc1
    s_nop 15
    buffer_load_dword v91, v13, s[12:15], 0 offen sc1
    s_mov_b32 s70, 0
L_pp_92:
    s_waitcnt vmcnt(3)
    v_cmp_ge_u32 vcc, s60, v88
    s_add_u32 s70, s70, 1
    s_nop 0
    s_cbranch_vccz L_ppd_93
    buffer_load_dword v88, v13, s[12:15], 0 offen sc1
    s_waitcnt vmcnt(3)
    v_cmp_ge_u32 vcc, s60, v89
    s_add_u32 s70, s70, 1
    s_nop 0
    s_cbranch_vccz L_ppd_93
    buffer_load_dword v89, v13, s[12:15], 0 offen sc1
    s_waitcnt vmcnt(3)
    v_cmp_ge_u32 vcc, s60, v90
    s_add_u32 s70, s70, 1
    s_nop 0
    s_cbranch_vccz L_ppd_93
    buffer_load_dword v90, v13, s[12:15], 0 offen sc1
    s_waitcnt vmcnt(3)
    v_cmp_ge_u32 vcc, s60, v91
    s_add_u32 s70, s70, 1
    s_nop 0
    s_cbranch_vccz L_ppd_93
    buffer_load_dword v91, v13, s[12:15], 0 offen sc1
    s_cmp_lt_u32 s70, 0x400000
    s_cbranch_scc1 L_pp_92
    s_branch L_c_done_1
L_ppd_93:
    s_mov_b64 exec, -1
    s_nop 3
    s_mov_b32 s70, 0
    buffer_load_dwordx4 v[40:43], v80, s[12:15], s62 offen sc1
    v_mov_b32 v24, 0
    v_mov_b32 v25, 0
    v_mov_b32 v26, 0
    v_mov_b32 v27, 0
    s_nop 3
    buffer_load_dwordx4 v[44:47], v81, s[12:15], s62 offen sc1
    v_mov_b32 v28, 0
    v_mov_b32 v29, 0
    v_mov_b32 v30, 0
    v_mov_b32 v31, 0
    s_nop 3
    buffer_load_dwordx4 v[48:51], v82, s[12:15], s62 offen sc1
    v_mov_b32 v32, 0
    v_mov_b32 v33, 0
    v_mov_b32 v34, 0
    v_mov_b32 v35, 0
    s_nop 3
    buffer_load_dwordx4 v[52:55], v83, s[12:15], s62 offen sc1
    v_mov_b32 v36, 0
    v_mov_b32 v37, 0
    v_mov_b32 v38, 0
    v_mov_b32 v39, 0
    s_nop 3
    buffer_load_dwordx4 v[56:59], v84, s[12:15], s62 offen sc1
    s_nop 7
    buffer_load_dwordx4 v[60:63], v85, s[12:15], s62 offen sc1
    s_waitcnt vmcnt(5)
    v_cmp_eq_u32 vcc, -1, v43
    s_nop 1
    s_cbranch_vccnz L_v_og_94_r0
L_v_og_94_c0:
    v_smfmac_f32_16x16x64_bf16 v[24:27], v[40:43], a[160:167], v2
    s_waitcnt vmcnt(4)
    v_smfmac_f32_16x16x64_bf16 v[28:31], v[40:43], a[168:175], v2
    v_cmp_eq_u32 vcc, -1, v47
    v_smfmac_f32_16x16x64_bf16 v[32:35], v[40:43], a[176:183], v2
    buffer_load_dwordx4 v[64:67], v86, s[12:15], s62 offen sc1
    v_smfmac_f32_16x16x64_bf16 v[36:39], v[40:43], a[184:191], v2
    s_cbranch_vccnz L_v_og_94_r1
L_v_og_94_c1:
    v_smfmac_f32_16x16x64_bf16 v[24:27], v[44:47], a[192:199], v2
    s_waitcnt vmcnt(4)
    v_smfmac_f32_16x16x64_bf16 v[28:31], v[44:47], a[200:207], v2
    v_cmp_eq_u32 vcc, -1, v51
    v_smfmac_f32_16x16x64_bf16 v[32:35], v[44:47], a[208:215], v2
    buffer_load_dwordx4 v[68:71], v87, s[12:15], s62 offen sc1
    v_smfmac_f32_16x16x64_bf16 v[36:39], v[44:47], a[216:223], v2
    s_cbranch_vccnz L_v_og_94_r2
L_v_og_94_c2:
    v_smfmac_f32_16x16x64_bf16 v[24:27], v[48:51], a[224:231], v2
    s_waitcnt vmcnt(4)
    v_smfmac_f32_16x16x64_bf16 v[28:31], v[48:51], a[232:239], v2
    v_cmp_eq_u32 vcc, -1, v55
    v_smfmac_f32_16x16x64_bf16 v[32:35], v[48:51], a[240:247], v2
    v_smfmac_f32_16x16x64_bf16 v[36:39], v[48:51], a[248:255], v2
    s_cbranch_vccnz L_v_og_94_r3
L_v_og_94_c3:
    v_smfmac_f32_16x16x64_bf16 v[24:27], v[52:55], v[96:103], v2
    s_waitcnt vmcnt(3)
    v_cmp_eq_u32 vcc, -1, v59
    v_smfmac_f32_16x16x64_bf16 v[28:31], v[52:55], v[104:111], v2
    v_smfmac_f32_16x16x64_bf16 v[32:35], v[52:55], v[112:119], v2
    s_cbranch_vccnz L_v_og_94_r4
L_v_og_94_c4:
    v_smfmac_f32_16x16x64_bf16 v[24:27], v[56:59], v[128:135], v2
    s_waitcnt vmcnt(2)
    v_cmp_eq_u32 vcc, -1, v63
    v_smfmac_f32_16x16x64_bf16 v[28:31], v[56:59], v[136:143], v2
    v_smfmac_f32_16x16x64_bf16 v[32:35], v[56:59], v[144:151], v2
    s_cbranch_vccnz L_v_og_94_r5
L_v_og_94_c5:
    v_smfmac_f32_16x16x64_bf16 v[24:27], v[60:63], v[160:167], v2
    s_waitcnt vmcnt(1)
    v_cmp_eq_u32 vcc, -1, v67
    v_smfmac_f32_16x16x64_bf16 v[28:31], v[60:63], v[168:175], v2
    v_smfmac_f32_16x16x64_bf16 v[32:35], v[60:63], v[176:183], v2
    s_cbranch_vccnz L_v_og_94_r6
L_v_og_94_c6:
    v_smfmac_f32_16x16x64_bf16 v[24:27], v[64:67], v[192:199], v2
    s_waitcnt vmcnt(0)
    v_cmp_eq_u32 vcc, -1, v71
    v_smfmac_f32_16x16x64_bf16 v[28:31], v[64:67], v[200:207], v2
    v_smfmac_f32_16x16x64_bf16 v[32:35], v[64:67], v[208:215], v2
    s_cbranch_vccnz L_v_og_94_r7
L_v_og_94_c7:
    v_smfmac_f32_16x16x64_bf16 v[24:27], v[68:71], v[224:231], v2
    v_smfmac_f32_16x16x64_bf16 v[28:31], v[68:71], v[232:239], v2
    v_smfmac_f32_16x16x64_bf16 v[32:35], v[68:71], v[240:247], v2
    v_smfmac_f32_16x16x64_bf16 v[36:39], v[52:55], v[120:127], v2
    s_add_u32 s46, s60, 1
    v_smfmac_f32_16x16x64_bf16 v[36:39], v[56:59], v[152:159], v2
    s_and_b32 s45, s46, 3
    v_smfmac_f32_16x16x64_bf16 v[36:39], v[60:63], v[184:191], v2
    s_mov_b32 s60, s46
    ds_write_b128 v6, v[24:27] offset:0
    v_smfmac_f32_16x16x64_bf16 v[36:39], v[64:67], v[216:223], v2
    ds_write_b128 v6, v[28:31] offset:1024
    v_smfmac_f32_16x16x64_bf16 v[36:39], v[68:71], v[248:255], v2
    ds_write_b128 v6, v[32:35] offset:2048
    s_lshl_b32 s46, s45, 14
    s_add_u32 s61, s58, s46
    s_lshl_b32 s46, s45, 15
    s_add_u32 s62, s59, s46
    s_waitcnt lgkmcnt(0)
    s_barrier
    ds_read_b128 v[40:43], v7
    ds_read_b128 v[44:47], v8
    ds_read_b128 v[48:51], v18
    v_mov_b32 v19, s60
    s_waitcnt lgkmcnt(2)
    v_pk_add_f32 v[36:37], v[36:37], v[40:41]
    v_pk_add_f32 v[38:39], v[38:39], v[42:43]
    s_waitcnt lgkmcnt(1)
    v_pk_add_f32 v[36:37], v[36:37], v[44:45]
    v_pk_add_f32 v[38:39], v[38:39], v[46:47]
    s_waitcnt lgkmcnt(0)
    v_pk_add_f32 v[36:37], v[36:37], v[48:49]
    v_pk_add_f32 v[38:39], v[38:39], v[50:51]
    s_nop 1
    v_permlane32_swap_b32 v36, v38
    v_permlane32_swap_b32 v37, v39
    v_pk_add_f32 v[24:25], v[36:37], v[38:39]
    buffer_store_dwordx2 v[24:25], v11, s[12:15], s48 offen sc1
    ds_read_b128 v[56:59], v5 offset:8192
    ds_read_b128 v[60:63], v5 offset:9216
    ds_read_b128 v[64:67], v5 offset:16384
    ds_read_b128 v[68:71], v5 offset:17408
    ds_read_b128 v[72:75], v5 offset:4096
    ds_read_b128 v[76:79], v5 offset:5120
    ds_read_b128 v[88:91], v5 offset:6144
    ds_read_b128 v[92:95], v5 offset:7168
    ds_read_b128 v[32:35], v5 offset:14336
    ds_read_b128 v[36:39], v5 offset:15360
    s_sleep 4
    buffer_load_dwordx2 v[40:41], v11, s[12:15], s49 offen sc1
    s_mov_b32 s70, 0
L_v_xp_95:
    s_waitcnt vmcnt(0)
    v_max_u32 v22, v40, v41
    v_cmp_eq_u32 vcc, -1, v22
    v_pk_add_f32 v[28:29], v[24:25], v[40:41]
    v_cvt_pk_bf16_f32 v28, v28, v29
    s_cbranch_vccnz L_v_xp_95_r
L_v_xp_95_ok:
    buffer_store_dword v19, v20, s[24:27], 0 offen
    v_mov_b32_dpp v29, v28 quad_perm:[1,0,3,2] row_mask:0xf bank_mask:0xf
    v_perm_b32 v28, v28, v29, v9
    buffer_store_dword v28, v12, s[24:27], s61 offen
    buffer_store_dword v28, v12, s[28:31], s61 offen sc1
    buffer_store_dword v19, v20, s[28:31], 0 offen sc1
    s_add_u32 s66, s66, 65536
    s_branch L_v_loop_89
L_v_fin_91:
    buffer_store_dwordx2 v[16:17], v10, s[12:15], s66 offen sc1
    s_waitcnt vmcnt(0)
    v_mov_b32 v22, 64
    v_mov_b32 v0, 0
    s_mov_b64 exec, 1
    buffer_store_dword v22, v0, s[12:15], s3 offen sc1
    s_mov_b64 exec, -1
L_c_done_1:
    s_endpgm
L_v_og_94_r0:
    buffer_load_dwordx4 v[40:43], v80, s[12:15], s62 offen sc1
    buffer_load_dwordx4 v[44:47], v81, s[12:15], s62 offen sc1
    buffer_load_dwordx4 v[48:51], v82, s[12:15], s62 offen sc1
    buffer_load_dwordx4 v[52:55], v83, s[12:15], s62 offen sc1
    buffer_load_dwordx4 v[56:59], v84, s[12:15], s62 offen sc1
    buffer_load_dwordx4 v[60:63], v85, s[12:15], s62 offen sc1
    s_add_u32 s70, s70, 1
    s_cmp_ge_u32 s70, 0x100000
    s_cbranch_scc1 L_c_done_1
    s_waitcnt vmcnt(5)
    v_cmp_eq_u32 vcc, -1, v43
    s_nop 1
    s_cbranch_vccnz L_v_og_94_r0
    s_branch L_v_og_94_c0
L_v_og_94_r1:
    buffer_load_dwordx4 v[44:47], v81, s[12:15], s62 offen sc1
    buffer_load_dwordx4 v[48:51], v82, s[12:15], s62 offen sc1
    buffer_load_dwordx4 v[52:55], v83, s[12:15], s62 offen sc1
    buffer_load_dwordx4 v[56:59], v84, s[12:15], s62 offen sc1
    buffer_load_dwordx4 v[60:63], v85, s[12:15], s62 offen sc1
    buffer_load_dwordx4 v[64:67], v86, s[12:15], s62 offen sc1
    s_add_u32 s70, s70, 1
    s_cmp_ge_u32 s70, 0x100000
    s_cbranch_scc1 L_c_done_1
    s_waitcnt vmcnt(5)
    v_cmp_eq_u32 vcc, -1, v47
    s_nop 1
    s_cbranch_vccnz L_v_og_94_r1
    s_branch L_v_og_94_c1
L_v_og_94_r2:
    buffer_load_dwordx4 v[48:51], v82, s[12:15], s62 offen sc1
    buffer_load_dwordx4 v[52:55], v83, s[12:15], s62 offen sc1
    buffer_load_dwordx4 v[56:59], v84, s[12:15], s62 offen sc1
    buffer_load_dwordx4 v[60:63], v85, s[12:15], s62 offen sc1
    buffer_load_dwordx4 v[64:67], v86, s[12:15], s62 offen sc1
    buffer_load_dwordx4 v[68:71], v87, s[12:15], s62 offen sc1
    s_add_u32 s70, s70, 1
    s_cmp_ge_u32 s70, 0x100000
    s_cbranch_scc1 L_c_done_1
    s_waitcnt vmcnt(5)
    v_cmp_eq_u32 vcc, -1, v51
    s_nop 1
    s_cbranch_vccnz L_v_og_94_r2
    s_branch L_v_og_94_c2
L_v_og_94_r3:
    buffer_load_dwordx4 v[52:55], v83, s[12:15], s62 offen sc1
    buffer_load_dwordx4 v[56:59], v84, s[12:15], s62 offen sc1
    buffer_load_dwordx4 v[60:63], v85, s[12:15], s62 offen sc1
    buffer_load_dwordx4 v[64:67], v86, s[12:15], s62 offen sc1
    buffer_load_dwordx4 v[68:71], v87, s[12:15], s62 offen sc1
    s_add_u32 s70, s70, 1
    s_cmp_ge_u32 s70, 0x100000
    s_cbranch_scc1 L_c_done_1
    s_waitcnt vmcnt(4)
    v_cmp_eq_u32 vcc, -1, v55
    s_nop 1
    s_cbranch_vccnz L_v_og_94_r3
    s_branch L_v_og_94_c3
L_v_og_94_r4:
    buffer_load_dwordx4 v[56:59], v84, s[12:15], s62 offen sc1
    buffer_load_dwordx4 v[60:63], v85, s[12:15], s62 offen sc1
    buffer_load_dwordx4 v[64:67], v86, s[12:15], s62 offen sc1
    buffer_load_dwordx4 v[68:71], v87, s[12:15], s62 offen sc1
    s_add_u32 s70, s70, 1
    s_cmp_ge_u32 s70, 0x100000
    s_cbranch_scc1 L_c_done_1
    s_waitcnt vmcnt(3)
    v_cmp_eq_u32 vcc, -1, v59
    s_nop 1
    s_cbranch_vccnz L_v_og_94_r4
    s_branch L_v_og_94_c4
L_v_og_94_r5:
    buffer_load_dwordx4 v[60:63], v85, s[12:15], s62 offen sc1
    buffer_load_dwordx4 v[64:67], v86, s[12:15], s62 offen sc1
    buffer_load_dwordx4 v[68:71], v87, s[12:15], s62 offen sc1
    s_add_u32 s70, s70, 1
    s_cmp_ge_u32 s70, 0x100000
    s_cbranch_scc1 L_c_done_1
    s_waitcnt vmcnt(2)
    v_cmp_eq_u32 vcc, -1, v63
    s_nop 1
    s_cbranch_vccnz L_v_og_94_r5
    s_branch L_v_og_94_c5
L_v_og_94_r6:
    buffer_load_dwordx4 v[64:67], v86, s[12:15], s62 offen sc1
    buffer_load_dwordx4 v[68:71], v87, s[12:15], s62 offen sc1
    s_add_u32 s70, s70, 1
    s_cmp_ge_u32 s70, 0x100000
    s_cbranch_scc1 L_c_done_1
    s_waitcnt vmcnt(1)
    v_cmp_eq_u32 vcc, -1, v67
    s_nop 1
    s_cbranch_vccnz L_v_og_94_r6
    s_branch L_v_og_94_c6
L_v_og_94_r7:
    buffer_load_dwordx4 v[68:71], v87, s[12:15], s62 offen sc1
    s_add_u32 s70, s70, 1
    s_cmp_ge_u32 s70, 0x100000
    s_cbranch_scc1 L_c_done_1
    s_waitcnt vmcnt(0)
    v_cmp_eq_u32 vcc, -1, v71
    s_nop 1
    s_cbranch_vccnz L_v_og_94_r7
    s_branch L_v_og_94_c7
L_mg_90_r0:
    buffer_load_dwordx4 v[40:43], v3, s[12:15], s8 offen sc1
    buffer_load_dwordx4 v[44:47], v3, s[12:15], s9 offen sc1
    buffer_load_dwordx4 v[48:51], v3, s[12:15], s10 offen sc1
    buffer_load_dwordx4 v[52:55], v3, s[12:15], s11 offen sc1
    s_add_u32 s70, s70, 1
    s_cmp_ge_u32 s70, 0x100000
    s_cbranch_scc1 L_c_done_1
    s_waitcnt vmcnt(3)
    ds_write_b128 v3, v[40:43] offset:0
    v_max3_u32 v22, v40, v41, v42
    v_max_u32 v22, v22, v43
    v_cmp_eq_u32 vcc, -1, v22
    s_waitcnt lgkmcnt(0)
    s_nop 0
    s_cbranch_vccnz L_mg_90_r0
    s_branch L_mg_90_c0
L_mg_90_r1:
    buffer_load_dwordx4 v[44:47], v3, s[12:15], s9 offen sc1
    buffer_load_dwordx4 v[48:51], v3, s[12:15], s10 offen sc1
    buffer_load_dwordx4 v[52:55], v3, s[12:15], s11 offen sc1
    s_add_u32 s70, s70, 1
    s_cmp_ge_u32 s70, 0x100000
    s_cbranch_scc1 L_c_done_1
    s_waitcnt vmcnt(2)
    ds_write_b128 v3, v[44:47] offset:1024
    v_max3_u32 v22, v44, v45, v46
    v_max_u32 v22, v22, v47
    v_cmp_eq_u32 vcc, -1, v22
    s_waitcnt lgkmcnt(0)
    s_nop 0
    s_cbranch_vccnz L_mg_90_r1
    s_branch L_mg_90_c1
L_mg_90_r2:
    buffer_load_dwordx4 v[48:51], v3, s[12:15], s10 offen sc1
    buffer_load_dwordx4 v[52:55], v3, s[12:15], s11 offen sc1
    s_add_u32 s70, s70, 1
    s_cmp_ge_u32 s70, 0x100000
    s_cbranch_scc1 L_c_done_1
    s_waitcnt vmcnt(1)
    ds_write_b128 v3, v[48:51] offset:2048
    v_max3_u32 v22, v48, v49, v50
    v_max_u32 v22, v22, v51
    v_cmp_eq_u32 vcc, -1, v22
    s_waitcnt lgkmcnt(0)
    s_nop 0
    s_cbranch_vccnz L_mg_90_r2
    s_branch L_mg_90_c2
L_mg_90_r3:
    buffer_load_dwordx4 v[52:55], v3, s[12:15], s11 offen sc1
    s_add_u32 s70, s70, 1
    s_cmp_ge_u32 s70, 0x100000
    s_cbranch_scc1 L_c_done_1
    s_waitcnt vmcnt(0)
    ds_write_b128 v3, v[52:55] offset:3072
    v_max3_u32 v22, v52, v53, v54
    v_max_u32 v22, v22, v55
    v_cmp_eq_u32 vcc, -1, v22
    s_waitcnt lgkmcnt(0)
    s_nop 0
    s_cbranch_vccnz L_mg_90_r3
    s_branch L_mg_90_c3
L_v_xp_95_r:
    buffer_load_dwordx2 v[40:41], v11, s[12:15], s49 offen sc1
    s_add_u32 s70, s70, 1
    s_cmp_lt_u32 s70, 0x100000
    s_cbranch_scc1 L_v_xp_95
    s_endpgm
L_worker_3:
    s_lshr_b32 s41, s2, 3
    s_and_b32 s42, s40, 1
    s_lshr_b32 s43, s40, 1
    s_lshl_b32 s39, s43, 5
    s_add_u32 s39, s39, s41
    s_load_dwordx2 s[4:5], s[0:1], 0
    s_waitcnt lgkmcnt(0)
    s_mov_b32 s28, s4
    s_and_b32 s29, s5, 0xffff
    s_mov_b32 s30, 0x400000
    s_mov_b32 s31, 0x00020000
    v_lshrrev_b32 v2, 4, v1
    v_and_b32 v4, 15, v1
    v_lshrrev_b32 v3, 1, v4
    v_xor_b32 v3, v3, v2
    v_lshlrev_b32 v3, 4, v3
    v_lshlrev_b32 v6, 7, v4
    v_add_u32 v3, v3, v6
    v_mul_u32_u24 v7, 144, v4
    v_lshlrev_b32 v6, 4, v2
    s_mul_i32 s45, s44, 4608
    s_add_u32 s45, s45, 131072
    v_add3_u32 v7, v7, v6, s45
    v_lshrrev_b32 v9, 3, v1
    v_mul_u32_u24 v8, 144, v9
    v_and_b32 v6, 7, v1
    v_lshlrev_b32 v6, 4, v6
    v_add3_u32 v8, v8, v6, s45
    v_lshlrev_b32 v11, 12, v9
    v_add_u32 v11, v11, v6
    v_lshlrev_b32 v2, 13, v2
    v_lshlrev_b32 v6, 4, v4
    v_add_u32 v2, v2, v6
    v_lshrrev_b32 v6, 3, v1
    v_lshrrev_b32 v9, 4, v1
    v_and_b32 v4, 7, v1
    v_xor_b32 v9, v9, v4
    v_lshlrev_b32 v9, 4, v9
    v_lshlrev_b32 v6, 8, v6
    v_add_u32 v6, v6, v9
    v_xor_b32 v9, 64, v6
    v_add_u32 v9, 2048, v9
    v_lshlrev_b32 v10, 4, v1
    v_lshlrev_b32 v12, 2, v1
    v_lshlrev_b32 v5, 7, v1
    s_lshl_b32 s61, s41, 7
    s_lshl_b32 s45, s43, 2
    s_add_u32 s61, s61, s45
    s_add_u32 s61, s61, 0x10010
    s_mul_i32 s64, s42, 24576
    s_add_u32 s64, s64, 0x12000
    s_lshl_b32 s45, s41, 7
    s_add_u32 s65, s64, s45
    s_lshl_b32 s45, s43, 13
    s_add_u32 s65, s65, s45
    s_add_u32 s67, s65, 4096
    s_cmp_lg_u32 s42, 0
    s_cbranch_scc1 L_w_kv_97
    v_mov_b32 v30, 0
    v_mov_b32 v31, 0
    v_mov_b32 v29, 24576
    s_mov_b64 exec, 1
    buffer_store_dword v30, v31, s[12:15], s65 offen sc1
    buffer_store_dword v30, v31, s[12:15], s67 offen sc1
    buffer_store_dword v30, v29, s[12:15], s65 offen sc1
    buffer_store_dword v30, v29, s[12:15], s67 offen sc1
    s_mov_b64 exec, -1
    s_lshl_b32 s63, s39, 2
    s_add_u32 s63, s63, s44
    s_load_dwordx2 s[4:5], s[0:1], 96
    s_load_dwordx2 s[6:7], s[0:1], 104
    v_and_b32 v14, 7, v0
    v_lshrrev_b32 v15, 3, v0
    s_waitcnt lgkmcnt(0)
    s_mov_b32 s32, s4
    s_and_b32 s33, s5, 0xffff
    s_mov_b32 s34, 0x800
    s_mov_b32 s35, 0x00020000
    s_mov_b32 s24, s6
    s_and_b32 s25, s7, 0xffff
    s_mov_b32 s26, 0xc00000
    s_mov_b32 s27, 0x00020000
    s_and_b32 s47, s39, 1
    s_lshl_b32 s45, s47, 10
    v_lshlrev_b32 v16, 5, v15
    buffer_load_dwordx4 v[104:107], v16, s[32:35], s45 offen
    buffer_load_dwordx4 v[108:111], v16, s[32:35], s45 offen offset:16
    s_mov_b32 s45, 196608
    v_mul_lo_u32 v17, v15, s45
    v_lshlrev_b32 v18, 4, v14
    v_add_u32 v17, v17, v18
    s_lshr_b32 s46, s39, 1
    s_lshl_b32 s46, s46, 7
    s_mul_i32 s45, s47, 6291456
    s_add_u32 s46, s46, s45
    buffer_load_dwordx4 v[32:35], v17, s[24:27], s46 offen
    v_add_u32 v17, 12288, v17
    buffer_load_dwordx4 v[36:39], v17, s[24:27], s46 offen
    v_add_u32 v17, 12288, v17
    buffer_load_dwordx4 v[40:43], v17, s[24:27], s46 offen
    v_add_u32 v17, 12288, v17
    buffer_load_dwordx4 v[44:47], v17, s[24:27], s46 offen
    v_add_u32 v17, 12288, v17
    buffer_load_dwordx4 v[48:51], v17, s[24:27], s46 offen
    v_add_u32 v17, 12288, v17
    buffer_load_dwordx4 v[52:55], v17, s[24:27], s46 offen
    v_add_u32 v17, 12288, v17
    buffer_load_dwordx4 v[56:59], v17, s[24:27], s46 offen
    v_add_u32 v17, 12288, v17
    buffer_load_dwordx4 v[60:63], v17, s[24:27], s46 offen
    v_add_u32 v17, 12288, v17
    buffer_load_dwordx4 v[64:67], v17, s[24:27], s46 offen
    v_add_u32 v17, 12288, v17
    buffer_load_dwordx4 v[68:71], v17, s[24:27], s46 offen
    v_add_u32 v17, 12288, v17
    buffer_load_dwordx4 v[72:75], v17, s[24:27], s46 offen
    v_add_u32 v17, 12288, v17
    buffer_load_dwordx4 v[76:79], v17, s[24:27], s46 offen
    v_add_u32 v17, 12288, v17
    buffer_load_dwordx4 v[80:83], v17, s[24:27], s46 offen
    v_add_u32 v17, 12288, v17
    buffer_load_dwordx4 v[84:87], v17, s[24:27], s46 offen
    v_add_u32 v17, 12288, v17
    buffer_load_dwordx4 v[88:91], v17, s[24:27], s46 offen
    v_add_u32 v17, 12288, v17
    buffer_load_dwordx4 v[92:95], v17, s[24:27], s46 offen
    s_add_u32 s45, s63, 0
    s_lshl_b32 s45, s45, 11
    buffer_load_dwordx4 v[128:131], v10, s[28:31], s45 offen
    buffer_load_dwordx4 v[132:135], v10, s[28:31], s45 offen offset:1024
    s_add_u32 s45, s63, 384
    s_lshl_b32 s45, s45, 11
    buffer_load_dwordx4 v[136:139], v10, s[28:31], s45 offen
    buffer_load_dwordx4 v[140:143], v10, s[28:31], s45 offen offset:1024
    s_add_u32 s45, s63, 768
    s_lshl_b32 s45, s45, 11
    buffer_load_dwordx4 v[144:147], v10, s[28:31], s45 offen
    buffer_load_dwordx4 v[148:151], v10, s[28:31], s45 offen offset:1024
    s_add_u32 s45, s63, 1152
    s_lshl_b32 s45, s45, 11
    buffer_load_dwordx4 v[152:155], v10, s[28:31], s45 offen
    buffer_load_dwordx4 v[156:159], v10, s[28:31], s45 offen offset:1024
    s_add_u32 s45, s63, 1536
    s_lshl_b32 s45, s45, 11
    buffer_load_dwordx4 v[160:163], v10, s[28:31], s45 offen
    buffer_load_dwordx4 v[164:167], v10, s[28:31], s45 offen offset:1024
    s_add_u32 s45, s63, 1920
    s_lshl_b32 s45, s45, 11
    buffer_load_dwordx4 v[168:171], v10, s[28:31], s45 offen
    buffer_load_dwordx4 v[172:175], v10, s[28:31], s45 offen offset:1024
    s_waitcnt vmcnt(28)
    v_lshlrev_b32 v112, 16, v104
    v_and_b32 v113, 0xffff0000, v104
    v_lshlrev_b32 v114, 16, v105
    v_and_b32 v115, 0xffff0000, v105
    v_lshlrev_b32 v116, 16, v106
    v_and_b32 v117, 0xffff0000, v106
    v_lshlrev_b32 v118, 16, v107
    v_and_b32 v119, 0xffff0000, v107
    v_lshlrev_b32 v120, 16, v108
    v_and_b32 v121, 0xffff0000, v108
    v_lshlrev_b32 v122, 16, v109
    v_and_b32 v123, 0xffff0000, v109
    v_lshlrev_b32 v124, 16, v110
    v_and_b32 v125, 0xffff0000, v110
    v_lshlrev_b32 v126, 16, v111
    v_and_b32 v127, 0xffff0000, v111
    v_mul_f32 v18, 0xbfb8aa3b, v112
    v_exp_f32 v18, v18
    s_nop 0
    v_add_f32 v18, 1.0, v18
    v_rcp_f32 v18, v18
    s_nop 0
    v_mul_f32 v112, v112, v18
    v_cvt_pk_bf16_f32 v112, v112, v112
    v_lshlrev_b32 v112, 16, v112
    v_mul_f32 v18, 0xbfb8aa3b, v113
    v_exp_f32 v18, v18
    s_nop 0
    v_add_f32 v18, 1.0, v18
    v_rcp_f32 v18, v18
    s_nop 0
    v_mul_f32 v113, v113, v18
    v_cvt_pk_bf16_f32 v113, v113, v113
    v_lshlrev_b32 v113, 16, v113
    v_mul_f32 v18, 0xbfb8aa3b, v114
    v_exp_f32 v18, v18
    s_nop 0
    v_add_f32 v18, 1.0, v18
    v_rcp_f32 v18, v18
    s_nop 0
    v_mul_f32 v114, v114, v18
    v_cvt_pk_bf16_f32 v114, v114, v114
    v_lshlrev_b32 v114, 16, v114
    v_mul_f32 v18, 0xbfb8aa3b, v115
    v_exp_f32 v18, v18
    s_nop 0
    v_add_f32 v18, 1.0, v18
    v_rcp_f32 v18, v18
    s_nop 0
    v_mul_f32 v115, v115, v18
    v_cvt_pk_bf16_f32 v115, v115, v115
    v_lshlrev_b32 v115, 16, v115
    v_mul_f32 v18, 0xbfb8aa3b, v116
    v_exp_f32 v18, v18
    s_nop 0
    v_add_f32 v18, 1.0, v18
    v_rcp_f32 v18, v18
    s_nop 0
    v_mul_f32 v116, v116, v18
    v_cvt_pk_bf16_f32 v116, v116, v116
    v_lshlrev_b32 v116, 16, v116
    v_mul_f32 v18, 0xbfb8aa3b, v117
    v_exp_f32 v18, v18
    s_nop 0
    v_add_f32 v18, 1.0, v18
    v_rcp_f32 v18, v18
    s_nop 0
    v_mul_f32 v117, v117, v18
    v_cvt_pk_bf16_f32 v117, v117, v117
    v_lshlrev_b32 v117, 16, v117
    v_mul_f32 v18, 0xbfb8aa3b, v118
    v_exp_f32 v18, v18
    s_nop 0
    v_add_f32 v18, 1.0, v18
    v_rcp_f32 v18, v18
    s_nop 0
    v_mul_f32 v118, v118, v18
    v_cvt_pk_bf16_f32 v118, v118, v118
    v_lshlrev_b32 v118, 16, v118
    v_mul_f32 v18, 0xbfb8aa3b, v119
    v_exp_f32 v18, v18
    s_nop 0
    v_add_f32 v18, 1.0, v18
    v_rcp_f32 v18, v18
    s_nop 0
    v_mul_f32 v119, v119, v18
    v_cvt_pk_bf16_f32 v119, v119, v119
    v_lshlrev_b32 v119, 16, v119
    v_mul_f32 v18, 0xbfb8aa3b, v120
    v_exp_f32 v18, v18
    s_nop 0
    v_add_f32 v18, 1.0, v18
    v_rcp_f32 v18, v18
    s_nop 0
    v_mul_f32 v120, v120, v18
    v_cvt_pk_bf16_f32 v120, v120, v120
    v_lshlrev_b32 v120, 16, v120
    v_mul_f32 v18, 0xbfb8aa3b, v121
    v_exp_f32 v18, v18
    s_nop 0
    v_add_f32 v18, 1.0, v18
    v_rcp_f32 v18, v18
    s_nop 0
    v_mul_f32 v121, v121, v18
    v_cvt_pk_bf16_f32 v121, v121, v121
    v_lshlrev_b32 v121, 16, v121
    v_mul_f32 v18, 0xbfb8aa3b, v122
    v_exp_f32 v18, v18
    s_nop 0
    v_add_f32 v18, 1.0, v18
    v_rcp_f32 v18, v18
    s_nop 0
    v_mul_f32 v122, v122, v18
    v_cvt_pk_bf16_f32 v122, v122, v122
    v_lshlrev_b32 v122, 16, v122
    v_mul_f32 v18, 0xbfb8aa3b, v123
    v_exp_f32 v18, v18
    s_nop 0
    v_add_f32 v18, 1.0, v18
    v_rcp_f32 v18, v18
    s_nop 0
    v_mul_f32 v123, v123, v18
    v_cvt_pk_bf16_f32 v123, v123, v123
    v_lshlrev_b32 v123, 16, v123
    v_mul_f32 v18, 0xbfb8aa3b, v124
    v_exp_f32 v18, v18
    s_nop 0
    v_add_f32 v18, 1.0, v18
    v_rcp_f32 v18, v18
    s_nop 0
    v_mul_f32 v124, v124, v18
    v_cvt_pk_bf16_f32 v124, v124, v124
    v_lshlrev_b32 v124, 16, v124
    v_mul_f32 v18, 0xbfb8aa3b, v125
    v_exp_f32 v18, v18
    s_nop 0
    v_add_f32 v18, 1.0, v18
    v_rcp_f32 v18, v18
    s_nop 0
    v_mul_f32 v125, v125, v18
    v_cvt_pk_bf16_f32 v125, v125, v125
    v_lshlrev_b32 v125, 16, v125
    v_mul_f32 v18, 0xbfb8aa3b, v126
    v_exp_f32 v18, v18
    s_nop 0
    v_add_f32 v18, 1.0, v18
    v_rcp_f32 v18, v18
    s_nop 0
    v_mul_f32 v126, v126, v18
    v_cvt_pk_bf16_f32 v126, v126, v126
    v_lshlrev_b32 v126, 16, v126
    v_mul_f32 v18, 0xbfb8aa3b, v127
    v_exp_f32 v18, v18
    s_nop 0
    v_add_f32 v18, 1.0, v18
    v_rcp_f32 v18, v18
    s_nop 0
    v_mul_f32 v127, v127, v18
    v_cvt_pk_bf16_f32 v127, v127, v127
    v_lshlrev_b32 v127, 16, v127
    v_mov_b32 v96, 0
    v_mov_b32 v97, 0
    v_mov_b32 v98, 0
    v_mov_b32 v99, 0
    v_mov_b32 v100, 0
    v_mov_b32 v101, 0
    v_mov_b32 v102, 0
    v_mov_b32 v103, 0
    s_waitcnt vmcnt(27)
    v_lshlrev_b32 v18, 16, v32
    v_and_b32 v19, 0xffff0000, v32
    v_fmac_f32 v96, v18, v112
    v_fmac_f32 v97, v19, v112
    v_lshlrev_b32 v18, 16, v33
    v_and_b32 v19, 0xffff0000, v33
    v_fmac_f32 v98, v18, v112
    v_fmac_f32 v99, v19, v112
    v_lshlrev_b32 v18, 16, v34
    v_and_b32 v19, 0xffff0000, v34
    v_fmac_f32 v100, v18, v112
    v_fmac_f32 v101, v19, v112
    v_lshlrev_b32 v18, 16, v35
    v_and_b32 v19, 0xffff0000, v35
    v_fmac_f32 v102, v18, v112
    v_fmac_f32 v103, v19, v112
    s_waitcnt vmcnt(26)
    v_lshlrev_b32 v18, 16, v36
    v_and_b32 v19, 0xffff0000, v36
    v_fmac_f32 v96, v18, v113
    v_fmac_f32 v97, v19, v113
    v_lshlrev_b32 v18, 16, v37
    v_and_b32 v19, 0xffff0000, v37
    v_fmac_f32 v98, v18, v113
    v_fmac_f32 v99, v19, v113
    v_lshlrev_b32 v18, 16, v38
    v_and_b32 v19, 0xffff0000, v38
    v_fmac_f32 v100, v18, v113
    v_fmac_f32 v101, v19, v113
    v_lshlrev_b32 v18, 16, v39
    v_and_b32 v19, 0xffff0000, v39
    v_fmac_f32 v102, v18, v113
    v_fmac_f32 v103, v19, v113
    s_waitcnt vmcnt(25)
    v_lshlrev_b32 v18, 16, v40
    v_and_b32 v19, 0xffff0000, v40
    v_fmac_f32 v96, v18, v114
    v_fmac_f32 v97, v19, v114
    v_lshlrev_b32 v18, 16, v41
    v_and_b32 v19, 0xffff0000, v41
    v_fmac_f32 v98, v18, v114
    v_fmac_f32 v99, v19, v114
    v_lshlrev_b32 v18, 16, v42
    v_and_b32 v19, 0xffff0000, v42
    v_fmac_f32 v100, v18, v114
    v_fmac_f32 v101, v19, v114
    v_lshlrev_b32 v18, 16, v43
    v_and_b32 v19, 0xffff0000, v43
    v_fmac_f32 v102, v18, v114
    v_fmac_f32 v103, v19, v114
    s_waitcnt vmcnt(24)
    v_lshlrev_b32 v18, 16, v44
    v_and_b32 v19, 0xffff0000, v44
    v_fmac_f32 v96, v18, v115
    v_fmac_f32 v97, v19, v115
    v_lshlrev_b32 v18, 16, v45
    v_and_b32 v19, 0xffff0000, v45
    v_fmac_f32 v98, v18, v115
    v_fmac_f32 v99, v19, v115
    v_lshlrev_b32 v18, 16, v46
    v_and_b32 v19, 0xffff0000, v46
    v_fmac_f32 v100, v18, v115
    v_fmac_f32 v101, v19, v115
    v_lshlrev_b32 v18, 16, v47
    v_and_b32 v19, 0xffff0000, v47
    v_fmac_f32 v102, v18, v115
    v_fmac_f32 v103, v19, v115
    s_waitcnt vmcnt(23)
    v_lshlrev_b32 v18, 16, v48
    v_and_b32 v19, 0xffff0000, v48
    v_fmac_f32 v96, v18, v116
    v_fmac_f32 v97, v19, v116
    v_lshlrev_b32 v18, 16, v49
    v_and_b32 v19, 0xffff0000, v49
    v_fmac_f32 v98, v18, v116
    v_fmac_f32 v99, v19, v116
    v_lshlrev_b32 v18, 16, v50
    v_and_b32 v19, 0xffff0000, v50
    v_fmac_f32 v100, v18, v116
    v_fmac_f32 v101, v19, v116
    v_lshlrev_b32 v18, 16, v51
    v_and_b32 v19, 0xffff0000, v51
    v_fmac_f32 v102, v18, v116
    v_fmac_f32 v103, v19, v116
    s_waitcnt vmcnt(22)
    v_lshlrev_b32 v18, 16, v52
    v_and_b32 v19, 0xffff0000, v52
    v_fmac_f32 v96, v18, v117
    v_fmac_f32 v97, v19, v117
    v_lshlrev_b32 v18, 16, v53
    v_and_b32 v19, 0xffff0000, v53
    v_fmac_f32 v98, v18, v117
    v_fmac_f32 v99, v19, v117
    v_lshlrev_b32 v18, 16, v54
    v_and_b32 v19, 0xffff0000, v54
    v_fmac_f32 v100, v18, v117
    v_fmac_f32 v101, v19, v117
    v_lshlrev_b32 v18, 16, v55
    v_and_b32 v19, 0xffff0000, v55
    v_fmac_f32 v102, v18, v117
    v_fmac_f32 v103, v19, v117
    s_waitcnt vmcnt(21)
    v_lshlrev_b32 v18, 16, v56
    v_and_b32 v19, 0xffff0000, v56
    v_fmac_f32 v96, v18, v118
    v_fmac_f32 v97, v19, v118
    v_lshlrev_b32 v18, 16, v57
    v_and_b32 v19, 0xffff0000, v57
    v_fmac_f32 v98, v18, v118
    v_fmac_f32 v99, v19, v118
    v_lshlrev_b32 v18, 16, v58
    v_and_b32 v19, 0xffff0000, v58
    v_fmac_f32 v100, v18, v118
    v_fmac_f32 v101, v19, v118
    v_lshlrev_b32 v18, 16, v59
    v_and_b32 v19, 0xffff0000, v59
    v_fmac_f32 v102, v18, v118
    v_fmac_f32 v103, v19, v118
    s_waitcnt vmcnt(20)
    v_lshlrev_b32 v18, 16, v60
    v_and_b32 v19, 0xffff0000, v60
    v_fmac_f32 v96, v18, v119
    v_fmac_f32 v97, v19, v119
    v_lshlrev_b32 v18, 16, v61
    v_and_b32 v19, 0xffff0000, v61
    v_fmac_f32 v98, v18, v119
    v_fmac_f32 v99, v19, v119
    v_lshlrev_b32 v18, 16, v62
    v_and_b32 v19, 0xffff0000, v62
    v_fmac_f32 v100, v18, v119
    v_fmac_f32 v101, v19, v119
    v_lshlrev_b32 v18, 16, v63
    v_and_b32 v19, 0xffff0000, v63
    v_fmac_f32 v102, v18, v119
    v_fmac_f32 v103, v19, v119
    s_waitcnt vmcnt(19)
    v_lshlrev_b32 v18, 16, v64
    v_and_b32 v19, 0xffff0000, v64
    v_fmac_f32 v96, v18, v120
    v_fmac_f32 v97, v19, v120
    v_lshlrev_b32 v18, 16, v65
    v_and_b32 v19, 0xffff0000, v65
    v_fmac_f32 v98, v18, v120
    v_fmac_f32 v99, v19, v120
    v_lshlrev_b32 v18, 16, v66
    v_and_b32 v19, 0xffff0000, v66
    v_fmac_f32 v100, v18, v120
    v_fmac_f32 v101, v19, v120
    v_lshlrev_b32 v18, 16, v67
    v_and_b32 v19, 0xffff0000, v67
    v_fmac_f32 v102, v18, v120
    v_fmac_f32 v103, v19, v120
    s_waitcnt vmcnt(18)
    v_lshlrev_b32 v18, 16, v68
    v_and_b32 v19, 0xffff0000, v68
    v_fmac_f32 v96, v18, v121
    v_fmac_f32 v97, v19, v121
    v_lshlrev_b32 v18, 16, v69
    v_and_b32 v19, 0xffff0000, v69
    v_fmac_f32 v98, v18, v121
    v_fmac_f32 v99, v19, v121
    v_lshlrev_b32 v18, 16, v70
    v_and_b32 v19, 0xffff0000, v70
    v_fmac_f32 v100, v18, v121
    v_fmac_f32 v101, v19, v121
    v_lshlrev_b32 v18, 16, v71
    v_and_b32 v19, 0xffff0000, v71
    v_fmac_f32 v102, v18, v121
    v_fmac_f32 v103, v19, v121
    s_waitcnt vmcnt(17)
    v_lshlrev_b32 v18, 16, v72
    v_and_b32 v19, 0xffff0000, v72
    v_fmac_f32 v96, v18, v122
    v_fmac_f32 v97, v19, v122
    v_lshlrev_b32 v18, 16, v73
    v_and_b32 v19, 0xffff0000, v73
    v_fmac_f32 v98, v18, v122
    v_fmac_f32 v99, v19, v122
    v_lshlrev_b32 v18, 16, v74
    v_and_b32 v19, 0xffff0000, v74
    v_fmac_f32 v100, v18, v122
    v_fmac_f32 v101, v19, v122
    v_lshlrev_b32 v18, 16, v75
    v_and_b32 v19, 0xffff0000, v75
    v_fmac_f32 v102, v18, v122
    v_fmac_f32 v103, v19, v122
    s_waitcnt vmcnt(16)
    v_lshlrev_b32 v18, 16, v76
    v_and_b32 v19, 0xffff0000, v76
    v_fmac_f32 v96, v18, v123
    v_fmac_f32 v97, v19, v123
    v_lshlrev_b32 v18, 16, v77
    v_and_b32 v19, 0xffff0000, v77
    v_fmac_f32 v98, v18, v123
    v_fmac_f32 v99, v19, v123
    v_lshlrev_b32 v18, 16, v78
    v_and_b32 v19, 0xffff0000, v78
    v_fmac_f32 v100, v18, v123
    v_fmac_f32 v101, v19, v123
    v_lshlrev_b32 v18, 16, v79
    v_and_b32 v19, 0xffff0000, v79
    v_fmac_f32 v102, v18, v123
    v_fmac_f32 v103, v19, v123
    s_waitcnt vmcnt(15)
    v_lshlrev_b32 v18, 16, v80
    v_and_b32 v19, 0xffff0000, v80
    v_fmac_f32 v96, v18, v124
    v_fmac_f32 v97, v19, v124
    v_lshlrev_b32 v18, 16, v81
    v_and_b32 v19, 0xffff0000, v81
    v_fmac_f32 v98, v18, v124
    v_fmac_f32 v99, v19, v124
    v_lshlrev_b32 v18, 16, v82
    v_and_b32 v19, 0xffff0000, v82
    v_fmac_f32 v100, v18, v124
    v_fmac_f32 v101, v19, v124
    v_lshlrev_b32 v18, 16, v83
    v_and_b32 v19, 0xffff0000, v83
    v_fmac_f32 v102, v18, v124
    v_fmac_f32 v103, v19, v124
    s_waitcnt vmcnt(14)
    v_lshlrev_b32 v18, 16, v84
    v_and_b32 v19, 0xffff0000, v84
    v_fmac_f32 v96, v18, v125
    v_fmac_f32 v97, v19, v125
    v_lshlrev_b32 v18, 16, v85
    v_and_b32 v19, 0xffff0000, v85
    v_fmac_f32 v98, v18, v125
    v_fmac_f32 v99, v19, v125
    v_lshlrev_b32 v18, 16, v86
    v_and_b32 v19, 0xffff0000, v86
    v_fmac_f32 v100, v18, v125
    v_fmac_f32 v101, v19, v125
    v_lshlrev_b32 v18, 16, v87
    v_and_b32 v19, 0xffff0000, v87
    v_fmac_f32 v102, v18, v125
    v_fmac_f32 v103, v19, v125
    s_waitcnt vmcnt(13)
    v_lshlrev_b32 v18, 16, v88
    v_and_b32 v19, 0xffff0000, v88
    v_fmac_f32 v96, v18, v126
    v_fmac_f32 v97, v19, v126
    v_lshlrev_b32 v18, 16, v89
    v_and_b32 v19, 0xffff0000, v89
    v_fmac_f32 v98, v18, v126
    v_fmac_f32 v99, v19, v126
    v_lshlrev_b32 v18, 16, v90
    v_and_b32 v19, 0xffff0000, v90
    v_fmac_f32 v100, v18, v126
    v_fmac_f32 v101, v19, v126
    v_lshlrev_b32 v18, 16, v91
    v_and_b32 v19, 0xffff0000, v91
    v_fmac_f32 v102, v18, v126
    v_fmac_f32 v103, v19, v126
    s_waitcnt vmcnt(12)
    v_lshlrev_b32 v18, 16, v92
    v_and_b32 v19, 0xffff0000, v92
    v_fmac_f32 v96, v18, v127
    v_fmac_f32 v97, v19, v127
    v_lshlrev_b32 v18, 16, v93
    v_and_b32 v19, 0xffff0000, v93
    v_fmac_f32 v98, v18, v127
    v_fmac_f32 v99, v19, v127
    v_lshlrev_b32 v18, 16, v94
    v_and_b32 v19, 0xffff0000, v94
    v_fmac_f32 v100, v18, v127
    v_fmac_f32 v101, v19, v127
    v_lshlrev_b32 v18, 16, v95
    v_and_b32 v19, 0xffff0000, v95
    v_fmac_f32 v102, v18, v127
    v_fmac_f32 v103, v19, v127
    v_lshlrev_b32 v16, 5, v0
    ds_write_b128 v16, v[96:99]
    ds_write_b128 v16, v[100:103] offset:16
    s_waitcnt lgkmcnt(0)
    s_barrier
    s_cmp_lg_u32 s44, 0
    s_cbranch_scc1 L_mod_fin_99
    v_mov_b32 v18, 0
    ds_read_b32 v32, v12 offset:0
    ds_read_b32 v33, v12 offset:256
    ds_read_b32 v34, v12 offset:512
    ds_read_b32 v35, v12 offset:768
    ds_read_b32 v36, v12 offset:1024
    ds_read_b32 v37, v12 offset:1280
    ds_read_b32 v38, v12 offset:1536
    ds_read_b32 v39, v12 offset:1792
    ds_read_b32 v40, v12 offset:2048
    ds_read_b32 v41, v12 offset:2304
    ds_read_b32 v42, v12 offset:2560
    ds_read_b32 v43, v12 offset:2816
    ds_read_b32 v44, v12 offset:3072
    ds_read_b32 v45, v12 offset:3328
    ds_read_b32 v46, v12 offset:3584
    ds_read_b32 v47, v12 offset:3840
    s_waitcnt lgkmcnt(0)
    v_add_f32 v18, v18, v32
    v_add_f32 v18, v18, v33
    v_add_f32 v18, v18, v34
    v_add_f32 v18, v18, v35
    v_add_f32 v18, v18, v36
    v_add_f32 v18, v18, v37
    v_add_f32 v18, v18, v38
    v_add_f32 v18, v18, v39
    v_add_f32 v18, v18, v40
    v_add_f32 v18, v18, v41
    v_add_f32 v18, v18, v42
    v_add_f32 v18, v18, v43
    v_add_f32 v18, v18, v44
    v_add_f32 v18, v18, v45
    v_add_f32 v18, v18, v46
    v_add_f32 v18, v18, v47
    ds_read_b32 v32, v12 offset:4096
    ds_read_b32 v33, v12 offset:4352
    ds_read_b32 v34, v12 offset:4608
    ds_read_b32 v35, v12 offset:4864
    ds_read_b32 v36, v12 offset:5120
    ds_read_b32 v37, v12 offset:5376
    ds_read_b32 v38, v12 offset:5632
    ds_read_b32 v39, v12 offset:5888
    ds_read_b32 v40, v12 offset:6144
    ds_read_b32 v41, v12 offset:6400
    ds_read_b32 v42, v12 offset:6656
    ds_read_b32 v43, v12 offset:6912
    ds_read_b32 v44, v12 offset:7168
    ds_read_b32 v45, v12 offset:7424
    ds_read_b32 v46, v12 offset:7680
    ds_read_b32 v47, v12 offset:7936
    s_waitcnt lgkmcnt(0)
    v_add_f32 v18, v18, v32
    v_add_f32 v18, v18, v33
    v_add_f32 v18, v18, v34
    v_add_f32 v18, v18, v35
    v_add_f32 v18, v18, v36
    v_add_f32 v18, v18, v37
    v_add_f32 v18, v18, v38
    v_add_f32 v18, v18, v39
    v_add_f32 v18, v18, v40
    v_add_f32 v18, v18, v41
    v_add_f32 v18, v18, v42
    v_add_f32 v18, v18, v43
    v_add_f32 v18, v18, v44
    v_add_f32 v18, v18, v45
    v_add_f32 v18, v18, v46
    v_add_f32 v18, v18, v47
    s_lshr_b32 s45, s39, 1
    s_lshl_b32 s45, s45, 8
    s_mul_i32 s46, s47, 24576
    s_add_u32 s45, s45, s46
    buffer_store_dword v18, v12, s[12:15], s45 offen sc1
L_mod_fin_99:
    s_waitcnt vmcnt(0)
    s_barrier
    s_cmp_lg_u32 s44, 0
    s_cbranch_scc1 L_cnt_100
    v_mov_b32 v30, 1
    v_mov_b32 v31, 128
    s_mov_b64 exec, 1
    buffer_atomic_add v30, v31, s[16:19], 0 offen sc1
    s_mov_b64 exec, -1
L_cnt_100:
    v_lshlrev_b32 v192, 16, v128
    v_and_b32 v193, 0xffff0000, v128
    v_lshlrev_b32 v194, 16, v129
    v_and_b32 v195, 0xffff0000, v129
    v_lshlrev_b32 v196, 16, v130
    v_and_b32 v197, 0xffff0000, v130
    v_lshlrev_b32 v198, 16, v131
    v_and_b32 v199, 0xffff0000, v131
    v_lshlrev_b32 v200, 16, v132
    v_and_b32 v201, 0xffff0000, v132
    v_lshlrev_b32 v202, 16, v133
    v_and_b32 v203, 0xffff0000, v133
    v_lshlrev_b32 v204, 16, v134
    v_and_b32 v205, 0xffff0000, v134
    v_lshlrev_b32 v206, 16, v135
    v_and_b32 v207, 0xffff0000, v135
    v_add_f32 v26, v192, v193
    v_add_f32 v26, v26, v194
    v_add_f32 v26, v26, v195
    v_add_f32 v26, v26, v196
    v_add_f32 v26, v26, v197
    v_add_f32 v26, v26, v198
    v_add_f32 v26, v26, v199
    v_add_f32 v26, v26, v200
    v_add_f32 v26, v26, v201
    v_add_f32 v26, v26, v202
    v_add_f32 v26, v26, v203
    v_add_f32 v26, v26, v204
    v_add_f32 v26, v26, v205
    v_add_f32 v26, v26, v206
    v_add_f32 v26, v26, v207
    s_nop 1
    v_add_f32_dpp v26, v26, v26 row_shr:1 row_mask:0xf bank_mask:0xf bound_ctrl:0
    s_nop 1
    v_add_f32_dpp v26, v26, v26 row_shr:2 row_mask:0xf bank_mask:0xf bound_ctrl:0
    s_nop 1
    v_add_f32_dpp v26, v26, v26 row_shr:4 row_mask:0xf bank_mask:0xf bound_ctrl:0
    s_nop 1
    v_add_f32_dpp v26, v26, v26 row_shr:8 row_mask:0xf bank_mask:0xf bound_ctrl:0
    s_nop 1
    v_add_f32_dpp v26, v26, v26 row_bcast:15 row_mask:0xa bank_mask:0xf
    s_nop 1
    v_add_f32_dpp v26, v26, v26 row_bcast:31 row_mask:0xc bank_mask:0xf
    s_nop 1
    v_readlane_b32 s66, v26, 63
    s_nop 1
    v_mov_b32 v27, s66
    v_mul_f32 v27, 0x3a800000, v27
    v_mov_b32 v26, 0
    v_sub_f32 v28, v192, v27
    v_fmac_f32 v26, v28, v28
    v_sub_f32 v28, v193, v27
    v_fmac_f32 v26, v28, v28
    v_sub_f32 v28, v194, v27
    v_fmac_f32 v26, v28, v28
    v_sub_f32 v28, v195, v27
    v_fmac_f32 v26, v28, v28
    v_sub_f32 v28, v196, v27
    v_fmac_f32 v26, v28, v28
    v_sub_f32 v28, v197, v27
    v_fmac_f32 v26, v28, v28
    v_sub_f32 v28, v198, v27
    v_fmac_f32 v26, v28, v28
    v_sub_f32 v28, v199, v27
    v_fmac_f32 v26, v28, v28
    v_sub_f32 v28, v200, v27
    v_fmac_f32 v26, v28, v28
    v_sub_f32 v28, v201, v27
    v_fmac_f32 v26, v28, v28
    v_sub_f32 v28, v202, v27
    v_fmac_f32 v26, v28, v28
    v_sub_f32 v28, v203, v27
    v_fmac_f32 v26, v28, v28
    v_sub_f32 v28, v204, v27
    v_fmac_f32 v26, v28, v28
    v_sub_f32 v28, v205, v27
    v_fmac_f32 v26, v28, v28
    v_sub_f32 v28, v206, v27
    v_fmac_f32 v26, v28, v28
    v_sub_f32 v28, v207, v27
    v_fmac_f32 v26, v28, v28
    s_nop 1
    v_add_f32_dpp v26, v26, v26 row_shr:1 row_mask:0xf bank_mask:0xf bound_ctrl:0
    s_nop 1
    v_add_f32_dpp v26, v26, v26 row_shr:2 row_mask:0xf bank_mask:0xf bound_ctrl:0
    s_nop 1
    v_add_f32_dpp v26, v26, v26 row_shr:4 row_mask:0xf bank_mask:0xf bound_ctrl:0
    s_nop 1
    v_add_f32_dpp v26, v26, v26 row_shr:8 row_mask:0xf bank_mask:0xf bound_ctrl:0
    s_nop 1
    v_add_f32_dpp v26, v26, v26 row_bcast:15 row_mask:0xa bank_mask:0xf
    s_nop 1
    v_add_f32_dpp v26, v26, v26 row_bcast:31 row_mask:0xc bank_mask:0xf
    s_nop 1
    v_readlane_b32 s66, v26, 63
    s_nop 1
    v_mov_b32 v26, s66
    v_mul_f32 v26, 0x3a800000, v26
    v_cvt_pk_bf16_f32 v26, v26, v26
    v_lshlrev_b32 v26, 16, v26
    v_cvt_pk_bf16_f32 v27, v27, v27
    v_lshlrev_b32 v27, 16, v27
    v_add_f32 v26, 0x3727c5ac, v26
    v_cvt_pk_bf16_f32 v26, v26, v26
    v_lshlrev_b32 v26, 16, v26
    v_sqrt_f32 v26, v26
    s_nop 0
    v_cvt_pk_bf16_f32 v26, v26, v26
    v_lshlrev_b32 v26, 16, v26
    v_rcp_f32 v26, v26
    s_nop 0
    v_sub_f32 v192, v192, v27
    v_cvt_pk_bf16_f32 v192, v192, v192
    v_lshlrev_b32 v192, 16, v192
    v_mul_f32 v192, v192, v26
    v_cvt_pk_bf16_f32 v192, v192, v192
    v_lshlrev_b32 v192, 16, v192
    v_sub_f32 v193, v193, v27
    v_cvt_pk_bf16_f32 v193, v193, v193
    v_lshlrev_b32 v193, 16, v193
    v_mul_f32 v193, v193, v26
    v_cvt_pk_bf16_f32 v193, v193, v193
    v_lshlrev_b32 v193, 16, v193
    v_sub_f32 v194, v194, v27
    v_cvt_pk_bf16_f32 v194, v194, v194
    v_lshlrev_b32 v194, 16, v194
    v_mul_f32 v194, v194, v26
    v_cvt_pk_bf16_f32 v194, v194, v194
    v_lshlrev_b32 v194, 16, v194
    v_sub_f32 v195, v195, v27
    v_cvt_pk_bf16_f32 v195, v195, v195
    v_lshlrev_b32 v195, 16, v195
    v_mul_f32 v195, v195, v26
    v_cvt_pk_bf16_f32 v195, v195, v195
    v_lshlrev_b32 v195, 16, v195
    v_sub_f32 v196, v196, v27
    v_cvt_pk_bf16_f32 v196, v196, v196
    v_lshlrev_b32 v196, 16, v196
    v_mul_f32 v196, v196, v26
    v_cvt_pk_bf16_f32 v196, v196, v196
    v_lshlrev_b32 v196, 16, v196
    v_sub_f32 v197, v197, v27
    v_cvt_pk_bf16_f32 v197, v197, v197
    v_lshlrev_b32 v197, 16, v197
    v_mul_f32 v197, v197, v26
    v_cvt_pk_bf16_f32 v197, v197, v197
    v_lshlrev_b32 v197, 16, v197
    v_sub_f32 v198, v198, v27
    v_cvt_pk_bf16_f32 v198, v198, v198
    v_lshlrev_b32 v198, 16, v198
    v_mul_f32 v198, v198, v26
    v_cvt_pk_bf16_f32 v198, v198, v198
    v_lshlrev_b32 v198, 16, v198
    v_sub_f32 v199, v199, v27
    v_cvt_pk_bf16_f32 v199, v199, v199
    v_lshlrev_b32 v199, 16, v199
    v_mul_f32 v199, v199, v26
    v_cvt_pk_bf16_f32 v199, v199, v199
    v_lshlrev_b32 v199, 16, v199
    v_sub_f32 v200, v200, v27
    v_cvt_pk_bf16_f32 v200, v200, v200
    v_lshlrev_b32 v200, 16, v200
    v_mul_f32 v200, v200, v26
    v_cvt_pk_bf16_f32 v200, v200, v200
    v_lshlrev_b32 v200, 16, v200
    v_sub_f32 v201, v201, v27
    v_cvt_pk_bf16_f32 v201, v201, v201
    v_lshlrev_b32 v201, 16, v201
    v_mul_f32 v201, v201, v26
    v_cvt_pk_bf16_f32 v201, v201, v201
    v_lshlrev_b32 v201, 16, v201
    v_sub_f32 v202, v202, v27
    v_cvt_pk_bf16_f32 v202, v202, v202
    v_lshlrev_b32 v202, 16, v202
    v_mul_f32 v202, v202, v26
    v_cvt_pk_bf16_f32 v202, v202, v202
    v_lshlrev_b32 v202, 16, v202
    v_sub_f32 v203, v203, v27
    v_cvt_pk_bf16_f32 v203, v203, v203
    v_lshlrev_b32 v203, 16, v203
    v_mul_f32 v203, v203, v26
    v_cvt_pk_bf16_f32 v203, v203, v203
    v_lshlrev_b32 v203, 16, v203
    v_sub_f32 v204, v204, v27
    v_cvt_pk_bf16_f32 v204, v204, v204
    v_lshlrev_b32 v204, 16, v204
    v_mul_f32 v204, v204, v26
    v_cvt_pk_bf16_f32 v204, v204, v204
    v_lshlrev_b32 v204, 16, v204
    v_sub_f32 v205, v205, v27
    v_cvt_pk_bf16_f32 v205, v205, v205
    v_lshlrev_b32 v205, 16, v205
    v_mul_f32 v205, v205, v26
    v_cvt_pk_bf16_f32 v205, v205, v205
    v_lshlrev_b32 v205, 16, v205
    v_sub_f32 v206, v206, v27
    v_cvt_pk_bf16_f32 v206, v206, v206
    v_lshlrev_b32 v206, 16, v206
    v_mul_f32 v206, v206, v26
    v_cvt_pk_bf16_f32 v206, v206, v206
    v_lshlrev_b32 v206, 16, v206
    v_sub_f32 v207, v207, v27
    v_cvt_pk_bf16_f32 v207, v207, v207
    v_lshlrev_b32 v207, 16, v207
    v_mul_f32 v207, v207, v26
    v_cvt_pk_bf16_f32 v207, v207, v207
    v_lshlrev_b32 v207, 16, v207
    v_lshlrev_b32 v208, 16, v136
    v_and_b32 v209, 0xffff0000, v136
    v_lshlrev_b32 v210, 16, v137
    v_and_b32 v211, 0xffff0000, v137
    v_lshlrev_b32 v212, 16, v138
    v_and_b32 v213, 0xffff0000, v138
    v_lshlrev_b32 v214, 16, v139
    v_and_b32 v215, 0xffff0000, v139
    v_lshlrev_b32 v216, 16, v140
    v_and_b32 v217, 0xffff0000, v140
    v_lshlrev_b32 v218, 16, v141
    v_and_b32 v219, 0xffff0000, v141
    v_lshlrev_b32 v220, 16, v142
    v_and_b32 v221, 0xffff0000, v142
    v_lshlrev_b32 v222, 16, v143
    v_and_b32 v223, 0xffff0000, v143
    v_add_f32 v26, v208, v209
    v_add_f32 v26, v26, v210
    v_add_f32 v26, v26, v211
    v_add_f32 v26, v26, v212
    v_add_f32 v26, v26, v213
    v_add_f32 v26, v26, v214
    v_add_f32 v26, v26, v215
    v_add_f32 v26, v26, v216
    v_add_f32 v26, v26, v217
    v_add_f32 v26, v26, v218
    v_add_f32 v26, v26, v219
    v_add_f32 v26, v26, v220
    v_add_f32 v26, v26, v221
    v_add_f32 v26, v26, v222
    v_add_f32 v26, v26, v223
    s_nop 1
    v_add_f32_dpp v26, v26, v26 row_shr:1 row_mask:0xf bank_mask:0xf bound_ctrl:0
    s_nop 1
    v_add_f32_dpp v26, v26, v26 row_shr:2 row_mask:0xf bank_mask:0xf bound_ctrl:0
    s_nop 1
    v_add_f32_dpp v26, v26, v26 row_shr:4 row_mask:0xf bank_mask:0xf bound_ctrl:0
    s_nop 1
    v_add_f32_dpp v26, v26, v26 row_shr:8 row_mask:0xf bank_mask:0xf bound_ctrl:0
    s_nop 1
    v_add_f32_dpp v26, v26, v26 row_bcast:15 row_mask:0xa bank_mask:0xf
    s_nop 1
    v_add_f32_dpp v26, v26, v26 row_bcast:31 row_mask:0xc bank_mask:0xf
    s_nop 1
    v_readlane_b32 s66, v26, 63
    s_nop 1
    v_mov_b32 v27, s66
    v_mul_f32 v27, 0x3a800000, v27
    v_mov_b32 v26, 0
    v_sub_f32 v28, v208, v27
    v_fmac_f32 v26, v28, v28
    v_sub_f32 v28, v209, v27
    v_fmac_f32 v26, v28, v28
    v_sub_f32 v28, v210, v27
    v_fmac_f32 v26, v28, v28
    v_sub_f32 v28, v211, v27
    v_fmac_f32 v26, v28, v28
    v_sub_f32 v28, v212, v27
    v_fmac_f32 v26, v28, v28
    v_sub_f32 v28, v213, v27
    v_fmac_f32 v26, v28, v28
    v_sub_f32 v28, v214, v27
    v_fmac_f32 v26, v28, v28
    v_sub_f32 v28, v215, v27
    v_fmac_f32 v26, v28, v28
    v_sub_f32 v28, v216, v27
    v_fmac_f32 v26, v28, v28
    v_sub_f32 v28, v217, v27
    v_fmac_f32 v26, v28, v28
    v_sub_f32 v28, v218, v27
    v_fmac_f32 v26, v28, v28
    v_sub_f32 v28, v219, v27
    v_fmac_f32 v26, v28, v28
    v_sub_f32 v28, v220, v27
    v_fmac_f32 v26, v28, v28
    v_sub_f32 v28, v221, v27
    v_fmac_f32 v26, v28, v28
    v_sub_f32 v28, v222, v27
    v_fmac_f32 v26, v28, v28
    v_sub_f32 v28, v223, v27
    v_fmac_f32 v26, v28, v28
    s_nop 1
    v_add_f32_dpp v26, v26, v26 row_shr:1 row_mask:0xf bank_mask:0xf bound_ctrl:0
    s_nop 1
    v_add_f32_dpp v26, v26, v26 row_shr:2 row_mask:0xf bank_mask:0xf bound_ctrl:0
    s_nop 1
    v_add_f32_dpp v26, v26, v26 row_shr:4 row_mask:0xf bank_mask:0xf bound_ctrl:0
    s_nop 1
    v_add_f32_dpp v26, v26, v26 row_shr:8 row_mask:0xf bank_mask:0xf bound_ctrl:0
    s_nop 1
    v_add_f32_dpp v26, v26, v26 row_bcast:15 row_mask:0xa bank_mask:0xf
    s_nop 1
    v_add_f32_dpp v26, v26, v26 row_bcast:31 row_mask:0xc bank_mask:0xf
    s_nop 1
    v_readlane_b32 s66, v26, 63
    s_nop 1
    v_mov_b32 v26, s66
    v_mul_f32 v26, 0x3a800000, v26
    v_cvt_pk_bf16_f32 v26, v26, v26
    v_lshlrev_b32 v26, 16, v26
    v_cvt_pk_bf16_f32 v27, v27, v27
    v_lshlrev_b32 v27, 16, v27
    v_add_f32 v26, 0x3727c5ac, v26
    v_cvt_pk_bf16_f32 v26, v26, v26
    v_lshlrev_b32 v26, 16, v26
    v_sqrt_f32 v26, v26
    s_nop 0
    v_cvt_pk_bf16_f32 v26, v26, v26
    v_lshlrev_b32 v26, 16, v26
    v_rcp_f32 v26, v26
    s_nop 0
    v_sub_f32 v208, v208, v27
    v_cvt_pk_bf16_f32 v208, v208, v208
    v_lshlrev_b32 v208, 16, v208
    v_mul_f32 v208, v208, v26
    v_cvt_pk_bf16_f32 v208, v208, v208
    v_lshlrev_b32 v208, 16, v208
    v_sub_f32 v209, v209, v27
    v_cvt_pk_bf16_f32 v209, v209, v209
    v_lshlrev_b32 v209, 16, v209
    v_mul_f32 v209, v209, v26
    v_cvt_pk_bf16_f32 v209, v209, v209
    v_lshlrev_b32 v209, 16, v209
    v_sub_f32 v210, v210, v27
    v_cvt_pk_bf16_f32 v210, v210, v210
    v_lshlrev_b32 v210, 16, v210
    v_mul_f32 v210, v210, v26
    v_cvt_pk_bf16_f32 v210, v210, v210
    v_lshlrev_b32 v210, 16, v210
    v_sub_f32 v211, v211, v27
    v_cvt_pk_bf16_f32 v211, v211, v211
    v_lshlrev_b32 v211, 16, v211
    v_mul_f32 v211, v211, v26
    v_cvt_pk_bf16_f32 v211, v211, v211
    v_lshlrev_b32 v211, 16, v211
    v_sub_f32 v212, v212, v27
    v_cvt_pk_bf16_f32 v212, v212, v212
    v_lshlrev_b32 v212, 16, v212
    v_mul_f32 v212, v212, v26
    v_cvt_pk_bf16_f32 v212, v212, v212
    v_lshlrev_b32 v212, 16, v212
    v_sub_f32 v213, v213, v27
    v_cvt_pk_bf16_f32 v213, v213, v213
    v_lshlrev_b32 v213, 16, v213
    v_mul_f32 v213, v213, v26
    v_cvt_pk_bf16_f32 v213, v213, v213
    v_lshlrev_b32 v213, 16, v213
    v_sub_f32 v214, v214, v27
    v_cvt_pk_bf16_f32 v214, v214, v214
    v_lshlrev_b32 v214, 16, v214
    v_mul_f32 v214, v214, v26
    v_cvt_pk_bf16_f32 v214, v214, v214
    v_lshlrev_b32 v214, 16, v214
    v_sub_f32 v215, v215, v27
    v_cvt_pk_bf16_f32 v215, v215, v215
    v_lshlrev_b32 v215, 16, v215
    v_mul_f32 v215, v215, v26
    v_cvt_pk_bf16_f32 v215, v215, v215
    v_lshlrev_b32 v215, 16, v215
    v_sub_f32 v216, v216, v27
    v_cvt_pk_bf16_f32 v216, v216, v216
    v_lshlrev_b32 v216, 16, v216
    v_mul_f32 v216, v216, v26
    v_cvt_pk_bf16_f32 v216, v216, v216
    v_lshlrev_b32 v216, 16, v216
    v_sub_f32 v217, v217, v27
    v_cvt_pk_bf16_f32 v217, v217, v217
    v_lshlrev_b32 v217, 16, v217
    v_mul_f32 v217, v217, v26
    v_cvt_pk_bf16_f32 v217, v217, v217
    v_lshlrev_b32 v217, 16, v217
    v_sub_f32 v218, v218, v27
    v_cvt_pk_bf16_f32 v218, v218, v218
    v_lshlrev_b32 v218, 16, v218
    v_mul_f32 v218, v218, v26
    v_cvt_pk_bf16_f32 v218, v218, v218
    v_lshlrev_b32 v218, 16, v218
    v_sub_f32 v219, v219, v27
    v_cvt_pk_bf16_f32 v219, v219, v219
    v_lshlrev_b32 v219, 16, v219
    v_mul_f32 v219, v219, v26
    v_cvt_pk_bf16_f32 v219, v219, v219
    v_lshlrev_b32 v219, 16, v219
    v_sub_f32 v220, v220, v27
    v_cvt_pk_bf16_f32 v220, v220, v220
    v_lshlrev_b32 v220, 16, v220
    v_mul_f32 v220, v220, v26
    v_cvt_pk_bf16_f32 v220, v220, v220
    v_lshlrev_b32 v220, 16, v220
    v_sub_f32 v221, v221, v27
    v_cvt_pk_bf16_f32 v221, v221, v221
    v_lshlrev_b32 v221, 16, v221
    v_mul_f32 v221, v221, v26
    v_cvt_pk_bf16_f32 v221, v221, v221
    v_lshlrev_b32 v221, 16, v221
    v_sub_f32 v222, v222, v27
    v_cvt_pk_bf16_f32 v222, v222, v222
    v_lshlrev_b32 v222, 16, v222
    v_mul_f32 v222, v222, v26
    v_cvt_pk_bf16_f32 v222, v222, v222
    v_lshlrev_b32 v222, 16, v222
    v_sub_f32 v223, v223, v27
    v_cvt_pk_bf16_f32 v223, v223, v223
    v_lshlrev_b32 v223, 16, v223
    v_mul_f32 v223, v223, v26
    v_cvt_pk_bf16_f32 v223, v223, v223
    v_lshlrev_b32 v223, 16, v223
    s_cmp_lg_u32 s44, 0
    s_cbranch_scc1 L_pd_101
    v_mov_b32 v29, 8
    s_mov_b32 s46, 32
    s_mov_b64 exec, 1
    s_mov_b32 s70, 0
L_wp_102:
    buffer_load_dword v31, v29, s[16:19], 0 offen sc1
    s_add_u32 s70, s70, 1
    s_cmp_ge_u32 s70, 0x200000
    s_cbranch_scc1 L_w_done_96
    s_waitcnt vmcnt(0)
    v_cmp_gt_u32 vcc, s46, v31
    s_nop 1
    s_cbranch_vccz L_wp_102_ok
    s_sleep 3
    s_branch L_wp_102
L_wp_102_ok:
    s_mov_b64 exec, -1
L_pd_101:
    s_barrier
    s_cmp_lg_u32 s44, 0
    s_cbranch_scc1 L_pd_103
    v_mov_b32 v29, 128
    s_mov_b32 s46, 96
    s_mov_b64 exec, 1
    s_mov_b32 s70, 0
L_wp_104:
    buffer_load_dword v31, v29, s[16:19], 0 offen sc1
    s_add_u32 s70, s70, 1
    s_cmp_ge_u32 s70, 0x200000
    s_cbranch_scc1 L_w_done_96
    s_waitcnt vmcnt(0)
    v_cmp_gt_u32 vcc, s46, v31
    s_nop 1
    s_cbranch_vccz L_wp_104_ok
    s_sleep 1
    s_branch L_wp_104
L_wp_104_ok:
    s_mov_b64 exec, -1
L_pd_103:
    s_barrier
    v_lshlrev_b32 v29, 5, v1
    s_mov_b32 s45, 0
    buffer_load_dwordx4 v[96:99], v29, s[12:15], s45 offen offset:0 sc1
    buffer_load_dwordx4 v[100:103], v29, s[12:15], s45 offen offset:16 sc1
    buffer_load_dwordx4 v[104:107], v29, s[12:15], s45 offen offset:2048 sc1
    buffer_load_dwordx4 v[108:111], v29, s[12:15], s45 offen offset:2064 sc1
    s_mov_b32 s45, 24576
    buffer_load_dwordx4 v[32:35], v29, s[12:15], s45 offen offset:0 sc1
    buffer_load_dwordx4 v[36:39], v29, s[12:15], s45 offen offset:16 sc1
    buffer_load_dwordx4 v[40:43], v29, s[12:15], s45 offen offset:2048 sc1
    buffer_load_dwordx4 v[44:47], v29, s[12:15], s45 offen offset:2064 sc1
    s_mov_b32 s45, 4096
    buffer_load_dwordx4 v[112:115], v29, s[12:15], s45 offen offset:0 sc1
    buffer_load_dwordx4 v[116:119], v29, s[12:15], s45 offen offset:16 sc1
    buffer_load_dwordx4 v[120:123], v29, s[12:15], s45 offen offset:2048 sc1
    buffer_load_dwordx4 v[124:127], v29, s[12:15], s45 offen offset:2064 sc1
    s_mov_b32 s45, 28672
    buffer_load_dwordx4 v[48:51], v29, s[12:15], s45 offen offset:0 sc1
    buffer_load_dwordx4 v[52:55], v29, s[12:15], s45 offen offset:16 sc1
    buffer_load_dwordx4 v[56:59], v29, s[12:15], s45 offen offset:2048 sc1
    buffer_load_dwordx4 v[60:63], v29, s[12:15], s45 offen offset:2064 sc1
    s_waitcnt vmcnt(0)
    v_add_f32 v96, v96, v32
    v_cvt_pk_bf16_f32 v96, v96, v96
    v_lshlrev_b32 v96, 16, v96
    v_add_f32 v97, v97, v33
    v_cvt_pk_bf16_f32 v97, v97, v97
    v_lshlrev_b32 v97, 16, v97
    v_add_f32 v98, v98, v34
    v_cvt_pk_bf16_f32 v98, v98, v98
    v_lshlrev_b32 v98, 16, v98
    v_add_f32 v99, v99, v35
    v_cvt_pk_bf16_f32 v99, v99, v99
    v_lshlrev_b32 v99, 16, v99
    v_add_f32 v100, v100, v36
    v_cvt_pk_bf16_f32 v100, v100, v100
    v_lshlrev_b32 v100, 16, v100
    v_add_f32 v101, v101, v37
    v_cvt_pk_bf16_f32 v101, v101, v101
    v_lshlrev_b32 v101, 16, v101
    v_add_f32 v102, v102, v38
    v_cvt_pk_bf16_f32 v102, v102, v102
    v_lshlrev_b32 v102, 16, v102
    v_add_f32 v103, v103, v39
    v_cvt_pk_bf16_f32 v103, v103, v103
    v_lshlrev_b32 v103, 16, v103
    v_add_f32 v104, v104, v40
    v_cvt_pk_bf16_f32 v104, v104, v104
    v_lshlrev_b32 v104, 16, v104
    v_add_f32 v105, v105, v41
    v_cvt_pk_bf16_f32 v105, v105, v105
    v_lshlrev_b32 v105, 16, v105
    v_add_f32 v106, v106, v42
    v_cvt_pk_bf16_f32 v106, v106, v106
    v_lshlrev_b32 v106, 16, v106
    v_add_f32 v107, v107, v43
    v_cvt_pk_bf16_f32 v107, v107, v107
    v_lshlrev_b32 v107, 16, v107
    v_add_f32 v108, v108, v44
    v_cvt_pk_bf16_f32 v108, v108, v108
    v_lshlrev_b32 v108, 16, v108
    v_add_f32 v109, v109, v45
    v_cvt_pk_bf16_f32 v109, v109, v109
    v_lshlrev_b32 v109, 16, v109
    v_add_f32 v110, v110, v46
    v_cvt_pk_bf16_f32 v110, v110, v110
    v_lshlrev_b32 v110, 16, v110
    v_add_f32 v111, v111, v47
    v_cvt_pk_bf16_f32 v111, v111, v111
    v_lshlrev_b32 v111, 16, v111
    v_add_f32 v112, v112, v48
    v_cvt_pk_bf16_f32 v112, v112, v112
    v_lshlrev_b32 v112, 16, v112
    v_add_f32 v112, 1.0, v112
    v_cvt_pk_bf16_f32 v112, v112, v112
    v_lshlrev_b32 v112, 16, v112
    v_add_f32 v113, v113, v49
    v_cvt_pk_bf16_f32 v113, v113, v113
    v_lshlrev_b32 v113, 16, v113
    v_add_f32 v113, 1.0, v113
    v_cvt_pk_bf16_f32 v113, v113, v113
    v_lshlrev_b32 v113, 16, v113
    v_add_f32 v114, v114, v50
    v_cvt_pk_bf16_f32 v114, v114, v114
    v_lshlrev_b32 v114, 16, v114
    v_add_f32 v114, 1.0, v114
    v_cvt_pk_bf16_f32 v114, v114, v114
    v_lshlrev_b32 v114, 16, v114
    v_add_f32 v115, v115, v51
    v_cvt_pk_bf16_f32 v115, v115, v115
    v_lshlrev_b32 v115, 16, v115
    v_add_f32 v115, 1.0, v115
    v_cvt_pk_bf16_f32 v115, v115, v115
    v_lshlrev_b32 v115, 16, v115
    v_add_f32 v116, v116, v52
    v_cvt_pk_bf16_f32 v116, v116, v116
    v_lshlrev_b32 v116, 16, v116
    v_add_f32 v116, 1.0, v116
    v_cvt_pk_bf16_f32 v116, v116, v116
    v_lshlrev_b32 v116, 16, v116
    v_add_f32 v117, v117, v53
    v_cvt_pk_bf16_f32 v117, v117, v117
    v_lshlrev_b32 v117, 16, v117
    v_add_f32 v117, 1.0, v117
    v_cvt_pk_bf16_f32 v117, v117, v117
    v_lshlrev_b32 v117, 16, v117
    v_add_f32 v118, v118, v54
    v_cvt_pk_bf16_f32 v118, v118, v118
    v_lshlrev_b32 v118, 16, v118
    v_add_f32 v118, 1.0, v118
    v_cvt_pk_bf16_f32 v118, v118, v118
    v_lshlrev_b32 v118, 16, v118
    v_add_f32 v119, v119, v55
    v_cvt_pk_bf16_f32 v119, v119, v119
    v_lshlrev_b32 v119, 16, v119
    v_add_f32 v119, 1.0, v119
    v_cvt_pk_bf16_f32 v119, v119, v119
    v_lshlrev_b32 v119, 16, v119
    v_add_f32 v120, v120, v56
    v_cvt_pk_bf16_f32 v120, v120, v120
    v_lshlrev_b32 v120, 16, v120
    v_add_f32 v120, 1.0, v120
    v_cvt_pk_bf16_f32 v120, v120, v120
    v_lshlrev_b32 v120, 16, v120
    v_add_f32 v121, v121, v57
    v_cvt_pk_bf16_f32 v121, v121, v121
    v_lshlrev_b32 v121, 16, v121
    v_add_f32 v121, 1.0, v121
    v_cvt_pk_bf16_f32 v121, v121, v121
    v_lshlrev_b32 v121, 16, v121
    v_add_f32 v122, v122, v58
    v_cvt_pk_bf16_f32 v122, v122, v122
    v_lshlrev_b32 v122, 16, v122
    v_add_f32 v122, 1.0, v122
    v_cvt_pk_bf16_f32 v122, v122, v122
    v_lshlrev_b32 v122, 16, v122
    v_add_f32 v123, v123, v59
    v_cvt_pk_bf16_f32 v123, v123, v123
    v_lshlrev_b32 v123, 16, v123
    v_add_f32 v123, 1.0, v123
    v_cvt_pk_bf16_f32 v123, v123, v123
    v_lshlrev_b32 v123, 16, v123
    v_add_f32 v124, v124, v60
    v_cvt_pk_bf16_f32 v124, v124, v124
    v_lshlrev_b32 v124, 16, v124
    v_add_f32 v124, 1.0, v124
    v_cvt_pk_bf16_f32 v124, v124, v124
    v_lshlrev_b32 v124, 16, v124
    v_add_f32 v125, v125, v61
    v_cvt_pk_bf16_f32 v125, v125, v125
    v_lshlrev_b32 v125, 16, v125
    v_add_f32 v125, 1.0, v125
    v_cvt_pk_bf16_f32 v125, v125, v125
    v_lshlrev_b32 v125, 16, v125
    v_add_f32 v126, v126, v62
    v_cvt_pk_bf16_f32 v126, v126, v126
    v_lshlrev_b32 v126, 16, v126
    v_add_f32 v126, 1.0, v126
    v_cvt_pk_bf16_f32 v126, v126, v126
    v_lshlrev_b32 v126, 16, v126
    v_add_f32 v127, v127, v63
    v_cvt_pk_bf16_f32 v127, v127, v127
    v_lshlrev_b32 v127, 16, v127
    v_add_f32 v127, 1.0, v127
    v_cvt_pk_bf16_f32 v127, v127, v127
    v_lshlrev_b32 v127, 16, v127
    v_mul_f32 v192, v192, v112
    v_cvt_pk_bf16_f32 v192, v192, v192
    v_lshlrev_b32 v192, 16, v192
    v_add_f32 v192, v192, v96
    v_mul_f32 v193, v193, v113
    v_cvt_pk_bf16_f32 v193, v193, v193
    v_lshlrev_b32 v193, 16, v193
    v_add_f32 v193, v193, v97
    v_mul_f32 v194, v194, v114
    v_cvt_pk_bf16_f32 v194, v194, v194
    v_lshlrev_b32 v194, 16, v194
    v_add_f32 v194, v194, v98
    v_mul_f32 v195, v195, v115
    v_cvt_pk_bf16_f32 v195, v195, v195
    v_lshlrev_b32 v195, 16, v195
    v_add_f32 v195, v195, v99
    v_mul_f32 v196, v196, v116
    v_cvt_pk_bf16_f32 v196, v196, v196
    v_lshlrev_b32 v196, 16, v196
    v_add_f32 v196, v196, v100
    v_mul_f32 v197, v197, v117
    v_cvt_pk_bf16_f32 v197, v197, v197
    v_lshlrev_b32 v197, 16, v197
    v_add_f32 v197, v197, v101
    v_mul_f32 v198, v198, v118
    v_cvt_pk_bf16_f32 v198, v198, v198
    v_lshlrev_b32 v198, 16, v198
    v_add_f32 v198, v198, v102
    v_mul_f32 v199, v199, v119
    v_cvt_pk_bf16_f32 v199, v199, v199
    v_lshlrev_b32 v199, 16, v199
    v_add_f32 v199, v199, v103
    v_mul_f32 v200, v200, v120
    v_cvt_pk_bf16_f32 v200, v200, v200
    v_lshlrev_b32 v200, 16, v200
    v_add_f32 v200, v200, v104
    v_mul_f32 v201, v201, v121
    v_cvt_pk_bf16_f32 v201, v201, v201
    v_lshlrev_b32 v201, 16, v201
    v_add_f32 v201, v201, v105
    v_mul_f32 v202, v202, v122
    v_cvt_pk_bf16_f32 v202, v202, v202
    v_lshlrev_b32 v202, 16, v202
    v_add_f32 v202, v202, v106
    v_mul_f32 v203, v203, v123
    v_cvt_pk_bf16_f32 v203, v203, v203
    v_lshlrev_b32 v203, 16, v203
    v_add_f32 v203, v203, v107
    v_mul_f32 v204, v204, v124
    v_cvt_pk_bf16_f32 v204, v204, v204
    v_lshlrev_b32 v204, 16, v204
    v_add_f32 v204, v204, v108
    v_mul_f32 v205, v205, v125
    v_cvt_pk_bf16_f32 v205, v205, v205
    v_lshlrev_b32 v205, 16, v205
    v_add_f32 v205, v205, v109
    v_mul_f32 v206, v206, v126
    v_cvt_pk_bf16_f32 v206, v206, v206
    v_lshlrev_b32 v206, 16, v206
    v_add_f32 v206, v206, v110
    v_mul_f32 v207, v207, v127
    v_cvt_pk_bf16_f32 v207, v207, v207
    v_lshlrev_b32 v207, 16, v207
    v_add_f32 v207, v207, v111
    v_cvt_pk_bf16_f32 v80, v192, v193
    v_cvt_pk_bf16_f32 v81, v194, v195
    v_cvt_pk_bf16_f32 v82, v196, v197
    v_cvt_pk_bf16_f32 v83, v198, v199
    v_cvt_pk_bf16_f32 v84, v200, v201
    v_cvt_pk_bf16_f32 v85, v202, v203
    v_cvt_pk_bf16_f32 v86, v204, v205
    v_cvt_pk_bf16_f32 v87, v206, v207
    s_lshr_b32 s45, s63, 5
    s_lshl_b32 s45, s45, 16
    s_and_b32 s46, s63, 31
    s_lshl_b32 s46, s46, 8
    s_add_u32 s45, s45, s46
    s_add_u32 s45, s45, 0x400000
    s_add_u32 s46, s45, 32768
    buffer_store_dwordx4 v[80:83], v2, s[12:15], s45 offen sc1
    buffer_store_dwordx4 v[84:87], v2, s[12:15], s46 offen sc1
    s_add_u32 s63, s63, 384
    v_mul_f32 v208, v208, v112
    v_cvt_pk_bf16_f32 v208, v208, v208
    v_lshlrev_b32 v208, 16, v208
    v_add_f32 v208, v208, v96
    v_mul_f32 v209, v209, v113
    v_cvt_pk_bf16_f32 v209, v209, v209
    v_lshlrev_b32 v209, 16, v209
    v_add_f32 v209, v209, v97
    v_mul_f32 v210, v210, v114
    v_cvt_pk_bf16_f32 v210, v210, v210
    v_lshlrev_b32 v210, 16, v210
    v_add_f32 v210, v210, v98
    v_mul_f32 v211, v211, v115
    v_cvt_pk_bf16_f32 v211, v211, v211
    v_lshlrev_b32 v211, 16, v211
    v_add_f32 v211, v211, v99
    v_mul_f32 v212, v212, v116
    v_cvt_pk_bf16_f32 v212, v212, v212
    v_lshlrev_b32 v212, 16, v212
    v_add_f32 v212, v212, v100
    v_mul_f32 v213, v213, v117
    v_cvt_pk_bf16_f32 v213, v213, v213
    v_lshlrev_b32 v213, 16, v213
    v_add_f32 v213, v213, v101
    v_mul_f32 v214, v214, v118
    v_cvt_pk_bf16_f32 v214, v214, v214
    v_lshlrev_b32 v214, 16, v214
    v_add_f32 v214, v214, v102
    v_mul_f32 v215, v215, v119
    v_cvt_pk_bf16_f32 v215, v215, v215
    v_lshlrev_b32 v215, 16, v215
    v_add_f32 v215, v215, v103
    v_mul_f32 v216, v216, v120
    v_cvt_pk_bf16_f32 v216, v216, v216
    v_lshlrev_b32 v216, 16, v216
    v_add_f32 v216, v216, v104
    v_mul_f32 v217, v217, v121
    v_cvt_pk_bf16_f32 v217, v217, v217
    v_lshlrev_b32 v217, 16, v217
    v_add_f32 v217, v217, v105
    v_mul_f32 v218, v218, v122
    v_cvt_pk_bf16_f32 v218, v218, v218
    v_lshlrev_b32 v218, 16, v218
    v_add_f32 v218, v218, v106
    v_mul_f32 v219, v219, v123
    v_cvt_pk_bf16_f32 v219, v219, v219
    v_lshlrev_b32 v219, 16, v219
    v_add_f32 v219, v219, v107
    v_mul_f32 v220, v220, v124
    v_cvt_pk_bf16_f32 v220, v220, v220
    v_lshlrev_b32 v220, 16, v220
    v_add_f32 v220, v220, v108
    v_mul_f32 v221, v221, v125
    v_cvt_pk_bf16_f32 v221, v221, v221
    v_lshlrev_b32 v221, 16, v221
    v_add_f32 v221, v221, v109
    v_mul_f32 v222, v222, v126
    v_cvt_pk_bf16_f32 v222, v222, v222
    v_lshlrev_b32 v222, 16, v222
    v_add_f32 v222, v222, v110
    v_mul_f32 v223, v223, v127
    v_cvt_pk_bf16_f32 v223, v223, v223
    v_lshlrev_b32 v223, 16, v223
    v_add_f32 v223, v223, v111
    v_cvt_pk_bf16_f32 v88, v208, v209
    v_cvt_pk_bf16_f32 v89, v210, v211
    v_cvt_pk_bf16_f32 v90, v212, v213
    v_cvt_pk_bf16_f32 v91, v214, v215
    v_cvt_pk_bf16_f32 v92, v216, v217
    v_cvt_pk_bf16_f32 v93, v218, v219
    v_cvt_pk_bf16_f32 v94, v220, v221
    v_cvt_pk_bf16_f32 v95, v222, v223
    s_lshr_b32 s45, s63, 5
    s_lshl_b32 s45, s45, 16
    s_and_b32 s46, s63, 31
    s_lshl_b32 s46, s46, 8
    s_add_u32 s45, s45, s46
    s_add_u32 s45, s45, 0x400000
    s_add_u32 s46, s45, 32768
    buffer_store_dwordx4 v[88:91], v2, s[12:15], s45 offen sc1
    buffer_store_dwordx4 v[92:95], v2, s[12:15], s46 offen sc1
    s_waitcnt vmcnt(2)
    s_barrier
    s_cmp_lg_u32 s44, 0
    s_cbranch_scc1 L_cnt_106
    v_mov_b32 v30, 1
    v_mov_b32 v31, 126976
    s_mov_b64 exec, 1
    buffer_atomic_add v30, v31, s[12:15], 0 offen sc1
    s_mov_b64 exec, -1
L_cnt_106:
    s_add_u32 s63, s63, 384
    v_lshlrev_b32 v64, 16, v144
    v_and_b32 v65, 0xffff0000, v144
    v_lshlrev_b32 v66, 16, v145
    v_and_b32 v67, 0xffff0000, v145
    v_lshlrev_b32 v68, 16, v146
    v_and_b32 v69, 0xffff0000, v146
    v_lshlrev_b32 v70, 16, v147
    v_and_b32 v71, 0xffff0000, v147
    v_lshlrev_b32 v72, 16, v148
    v_and_b32 v73, 0xffff0000, v148
    v_lshlrev_b32 v74, 16, v149
    v_and_b32 v75, 0xffff0000, v149
    v_lshlrev_b32 v76, 16, v150
    v_and_b32 v77, 0xffff0000, v150
    v_lshlrev_b32 v78, 16, v151
    v_and_b32 v79, 0xffff0000, v151
    v_add_f32 v26, v64, v65
    v_add_f32 v26, v26, v66
    v_add_f32 v26, v26, v67
    v_add_f32 v26, v26, v68
    v_add_f32 v26, v26, v69
    v_add_f32 v26, v26, v70
    v_add_f32 v26, v26, v71
    v_add_f32 v26, v26, v72
    v_add_f32 v26, v26, v73
    v_add_f32 v26, v26, v74
    v_add_f32 v26, v26, v75
    v_add_f32 v26, v26, v76
    v_add_f32 v26, v26, v77
    v_add_f32 v26, v26, v78
    v_add_f32 v26, v26, v79
    s_nop 1
    v_add_f32_dpp v26, v26, v26 row_shr:1 row_mask:0xf bank_mask:0xf bound_ctrl:0
    s_nop 1
    v_add_f32_dpp v26, v26, v26 row_shr:2 row_mask:0xf bank_mask:0xf bound_ctrl:0
    s_nop 1
    v_add_f32_dpp v26, v26, v26 row_shr:4 row_mask:0xf bank_mask:0xf bound_ctrl:0
    s_nop 1
    v_add_f32_dpp v26, v26, v26 row_shr:8 row_mask:0xf bank_mask:0xf bound_ctrl:0
    s_nop 1
    v_add_f32_dpp v26, v26, v26 row_bcast:15 row_mask:0xa bank_mask:0xf
    s_nop 1
    v_add_f32_dpp v26, v26, v26 row_bcast:31 row_mask:0xc bank_mask:0xf
    s_nop 1
    v_readlane_b32 s66, v26, 63
    s_nop 1
    v_mov_b32 v27, s66
    v_mul_f32 v27, 0x3a800000, v27
    v_mov_b32 v26, 0
    v_sub_f32 v28, v64, v27
    v_fmac_f32 v26, v28, v28
    v_sub_f32 v28, v65, v27
    v_fmac_f32 v26, v28, v28
    v_sub_f32 v28, v66, v27
    v_fmac_f32 v26, v28, v28
    v_sub_f32 v28, v67, v27
    v_fmac_f32 v26, v28, v28
    v_sub_f32 v28, v68, v27
    v_fmac_f32 v26, v28, v28
    v_sub_f32 v28, v69, v27
    v_fmac_f32 v26, v28, v28
    v_sub_f32 v28, v70, v27
    v_fmac_f32 v26, v28, v28
    v_sub_f32 v28, v71, v27
    v_fmac_f32 v26, v28, v28
    v_sub_f32 v28, v72, v27
    v_fmac_f32 v26, v28, v28
    v_sub_f32 v28, v73, v27
    v_fmac_f32 v26, v28, v28
    v_sub_f32 v28, v74, v27
    v_fmac_f32 v26, v28, v28
    v_sub_f32 v28, v75, v27
    v_fmac_f32 v26, v28, v28
    v_sub_f32 v28, v76, v27
    v_fmac_f32 v26, v28, v28
    v_sub_f32 v28, v77, v27
    v_fmac_f32 v26, v28, v28
    v_sub_f32 v28, v78, v27
    v_fmac_f32 v26, v28, v28
    v_sub_f32 v28, v79, v27
    v_fmac_f32 v26, v28, v28
    s_nop 1
    v_add_f32_dpp v26, v26, v26 row_shr:1 row_mask:0xf bank_mask:0xf bound_ctrl:0
    s_nop 1
    v_add_f32_dpp v26, v26, v26 row_shr:2 row_mask:0xf bank_mask:0xf bound_ctrl:0
    s_nop 1
    v_add_f32_dpp v26, v26, v26 row_shr:4 row_mask:0xf bank_mask:0xf bound_ctrl:0
    s_nop 1
    v_add_f32_dpp v26, v26, v26 row_shr:8 row_mask:0xf bank_mask:0xf bound_ctrl:0
    s_nop 1
    v_add_f32_dpp v26, v26, v26 row_bcast:15 row_mask:0xa bank_mask:0xf
    s_nop 1
    v_add_f32_dpp v26, v26, v26 row_bcast:31 row_mask:0xc bank_mask:0xf
    s_nop 1
    v_readlane_b32 s66, v26, 63
    s_nop 1
    v_mov_b32 v26, s66
    v_mul_f32 v26, 0x3a800000, v26
    v_cvt_pk_bf16_f32 v26, v26, v26
    v_lshlrev_b32 v26, 16, v26
    v_cvt_pk_bf16_f32 v27, v27, v27
    v_lshlrev_b32 v27, 16, v27
    v_add_f32 v26, 0x3727c5ac, v26
    v_cvt_pk_bf16_f32 v26, v26, v26
    v_lshlrev_b32 v26, 16, v26
    v_sqrt_f32 v26, v26
    s_nop 0
    v_cvt_pk_bf16_f32 v26, v26, v26
    v_lshlrev_b32 v26, 16, v26
    v_rcp_f32 v26, v26
    s_nop 0
    v_sub_f32 v64, v64, v27
    v_cvt_pk_bf16_f32 v64, v64, v64
    v_lshlrev_b32 v64, 16, v64
    v_mul_f32 v64, v64, v26
    v_cvt_pk_bf16_f32 v64, v64, v64
    v_lshlrev_b32 v64, 16, v64
    v_sub_f32 v65, v65, v27
    v_cvt_pk_bf16_f32 v65, v65, v65
    v_lshlrev_b32 v65, 16, v65
    v_mul_f32 v65, v65, v26
    v_cvt_pk_bf16_f32 v65, v65, v65
    v_lshlrev_b32 v65, 16, v65
    v_sub_f32 v66, v66, v27
    v_cvt_pk_bf16_f32 v66, v66, v66
    v_lshlrev_b32 v66, 16, v66
    v_mul_f32 v66, v66, v26
    v_cvt_pk_bf16_f32 v66, v66, v66
    v_lshlrev_b32 v66, 16, v66
    v_sub_f32 v67, v67, v27
    v_cvt_pk_bf16_f32 v67, v67, v67
    v_lshlrev_b32 v67, 16, v67
    v_mul_f32 v67, v67, v26
    v_cvt_pk_bf16_f32 v67, v67, v67
    v_lshlrev_b32 v67, 16, v67
    v_sub_f32 v68, v68, v27
    v_cvt_pk_bf16_f32 v68, v68, v68
    v_lshlrev_b32 v68, 16, v68
    v_mul_f32 v68, v68, v26
    v_cvt_pk_bf16_f32 v68, v68, v68
    v_lshlrev_b32 v68, 16, v68
    v_sub_f32 v69, v69, v27
    v_cvt_pk_bf16_f32 v69, v69, v69
    v_lshlrev_b32 v69, 16, v69
    v_mul_f32 v69, v69, v26
    v_cvt_pk_bf16_f32 v69, v69, v69
    v_lshlrev_b32 v69, 16, v69
    v_sub_f32 v70, v70, v27
    v_cvt_pk_bf16_f32 v70, v70, v70
    v_lshlrev_b32 v70, 16, v70
    v_mul_f32 v70, v70, v26
    v_cvt_pk_bf16_f32 v70, v70, v70
    v_lshlrev_b32 v70, 16, v70
    v_sub_f32 v71, v71, v27
    v_cvt_pk_bf16_f32 v71, v71, v71
    v_lshlrev_b32 v71, 16, v71
    v_mul_f32 v71, v71, v26
    v_cvt_pk_bf16_f32 v71, v71, v71
    v_lshlrev_b32 v71, 16, v71
    v_sub_f32 v72, v72, v27
    v_cvt_pk_bf16_f32 v72, v72, v72
    v_lshlrev_b32 v72, 16, v72
    v_mul_f32 v72, v72, v26
    v_cvt_pk_bf16_f32 v72, v72, v72
    v_lshlrev_b32 v72, 16, v72
    v_sub_f32 v73, v73, v27
    v_cvt_pk_bf16_f32 v73, v73, v73
    v_lshlrev_b32 v73, 16, v73
    v_mul_f32 v73, v73, v26
    v_cvt_pk_bf16_f32 v73, v73, v73
    v_lshlrev_b32 v73, 16, v73
    v_sub_f32 v74, v74, v27
    v_cvt_pk_bf16_f32 v74, v74, v74
    v_lshlrev_b32 v74, 16, v74
    v_mul_f32 v74, v74, v26
    v_cvt_pk_bf16_f32 v74, v74, v74
    v_lshlrev_b32 v74, 16, v74
    v_sub_f32 v75, v75, v27
    v_cvt_pk_bf16_f32 v75, v75, v75
    v_lshlrev_b32 v75, 16, v75
    v_mul_f32 v75, v75, v26
    v_cvt_pk_bf16_f32 v75, v75, v75
    v_lshlrev_b32 v75, 16, v75
    v_sub_f32 v76, v76, v27
    v_cvt_pk_bf16_f32 v76, v76, v76
    v_lshlrev_b32 v76, 16, v76
    v_mul_f32 v76, v76, v26
    v_cvt_pk_bf16_f32 v76, v76, v76
    v_lshlrev_b32 v76, 16, v76
    v_sub_f32 v77, v77, v27
    v_cvt_pk_bf16_f32 v77, v77, v77
    v_lshlrev_b32 v77, 16, v77
    v_mul_f32 v77, v77, v26
    v_cvt_pk_bf16_f32 v77, v77, v77
    v_lshlrev_b32 v77, 16, v77
    v_sub_f32 v78, v78, v27
    v_cvt_pk_bf16_f32 v78, v78, v78
    v_lshlrev_b32 v78, 16, v78
    v_mul_f32 v78, v78, v26
    v_cvt_pk_bf16_f32 v78, v78, v78
    v_lshlrev_b32 v78, 16, v78
    v_sub_f32 v79, v79, v27
    v_cvt_pk_bf16_f32 v79, v79, v79
    v_lshlrev_b32 v79, 16, v79
    v_mul_f32 v79, v79, v26
    v_cvt_pk_bf16_f32 v79, v79, v79
    v_lshlrev_b32 v79, 16, v79
    v_mul_f32 v64, v64, v112
    v_cvt_pk_bf16_f32 v64, v64, v64
    v_lshlrev_b32 v64, 16, v64
    v_add_f32 v64, v64, v96
    v_mul_f32 v65, v65, v113
    v_cvt_pk_bf16_f32 v65, v65, v65
    v_lshlrev_b32 v65, 16, v65
    v_add_f32 v65, v65, v97
    v_mul_f32 v66, v66, v114
    v_cvt_pk_bf16_f32 v66, v66, v66
    v_lshlrev_b32 v66, 16, v66
    v_add_f32 v66, v66, v98
    v_mul_f32 v67, v67, v115
    v_cvt_pk_bf16_f32 v67, v67, v67
    v_lshlrev_b32 v67, 16, v67
    v_add_f32 v67, v67, v99
    v_mul_f32 v68, v68, v116
    v_cvt_pk_bf16_f32 v68, v68, v68
    v_lshlrev_b32 v68, 16, v68
    v_add_f32 v68, v68, v100
    v_mul_f32 v69, v69, v117
    v_cvt_pk_bf16_f32 v69, v69, v69
    v_lshlrev_b32 v69, 16, v69
    v_add_f32 v69, v69, v101
    v_mul_f32 v70, v70, v118
    v_cvt_pk_bf16_f32 v70, v70, v70
    v_lshlrev_b32 v70, 16, v70
    v_add_f32 v70, v70, v102
    v_mul_f32 v71, v71, v119
    v_cvt_pk_bf16_f32 v71, v71, v71
    v_lshlrev_b32 v71, 16, v71
    v_add_f32 v71, v71, v103
    v_mul_f32 v72, v72, v120
    v_cvt_pk_bf16_f32 v72, v72, v72
    v_lshlrev_b32 v72, 16, v72
    v_add_f32 v72, v72, v104
    v_mul_f32 v73, v73, v121
    v_cvt_pk_bf16_f32 v73, v73, v73
    v_lshlrev_b32 v73, 16, v73
    v_add_f32 v73, v73, v105
    v_mul_f32 v74, v74, v122
    v_cvt_pk_bf16_f32 v74, v74, v74
    v_lshlrev_b32 v74, 16, v74
    v_add_f32 v74, v74, v106
    v_mul_f32 v75, v75, v123
    v_cvt_pk_bf16_f32 v75, v75, v75
    v_lshlrev_b32 v75, 16, v75
    v_add_f32 v75, v75, v107
    v_mul_f32 v76, v76, v124
    v_cvt_pk_bf16_f32 v76, v76, v76
    v_lshlrev_b32 v76, 16, v76
    v_add_f32 v76, v76, v108
    v_mul_f32 v77, v77, v125
    v_cvt_pk_bf16_f32 v77, v77, v77
    v_lshlrev_b32 v77, 16, v77
    v_add_f32 v77, v77, v109
    v_mul_f32 v78, v78, v126
    v_cvt_pk_bf16_f32 v78, v78, v78
    v_lshlrev_b32 v78, 16, v78
    v_add_f32 v78, v78, v110
    v_mul_f32 v79, v79, v127
    v_cvt_pk_bf16_f32 v79, v79, v79
    v_lshlrev_b32 v79, 16, v79
    v_add_f32 v79, v79, v111
    v_cvt_pk_bf16_f32 v80, v64, v65
    v_cvt_pk_bf16_f32 v81, v66, v67
    v_cvt_pk_bf16_f32 v82, v68, v69
    v_cvt_pk_bf16_f32 v83, v70, v71
    v_cvt_pk_bf16_f32 v84, v72, v73
    v_cvt_pk_bf16_f32 v85, v74, v75
    v_cvt_pk_bf16_f32 v86, v76, v77
    v_cvt_pk_bf16_f32 v87, v78, v79
    s_lshr_b32 s45, s63, 5
    s_lshl_b32 s45, s45, 16
    s_and_b32 s46, s63, 31
    s_lshl_b32 s46, s46, 8
    s_add_u32 s45, s45, s46
    s_add_u32 s45, s45, 0x400000
    s_add_u32 s46, s45, 32768
    buffer_store_dwordx4 v[80:83], v2, s[12:15], s45 offen sc1
    buffer_store_dwordx4 v[84:87], v2, s[12:15], s46 offen sc1
    s_add_u32 s63, s63, 384
    v_lshlrev_b32 v64, 16, v152
    v_and_b32 v65, 0xffff0000, v152
    v_lshlrev_b32 v66, 16, v153
    v_and_b32 v67, 0xffff0000, v153
    v_lshlrev_b32 v68, 16, v154
    v_and_b32 v69, 0xffff0000, v154
    v_lshlrev_b32 v70, 16, v155
    v_and_b32 v71, 0xffff0000, v155
    v_lshlrev_b32 v72, 16, v156
    v_and_b32 v73, 0xffff0000, v156
    v_lshlrev_b32 v74, 16, v157
    v_and_b32 v75, 0xffff0000, v157
    v_lshlrev_b32 v76, 16, v158
    v_and_b32 v77, 0xffff0000, v158
    v_lshlrev_b32 v78, 16, v159
    v_and_b32 v79, 0xffff0000, v159
    v_add_f32 v26, v64, v65
    v_add_f32 v26, v26, v66
    v_add_f32 v26, v26, v67
    v_add_f32 v26, v26, v68
    v_add_f32 v26, v26, v69
    v_add_f32 v26, v26, v70
    v_add_f32 v26, v26, v71
    v_add_f32 v26, v26, v72
    v_add_f32 v26, v26, v73
    v_add_f32 v26, v26, v74
    v_add_f32 v26, v26, v75
    v_add_f32 v26, v26, v76
    v_add_f32 v26, v26, v77
    v_add_f32 v26, v26, v78
    v_add_f32 v26, v26, v79
    s_nop 1
    v_add_f32_dpp v26, v26, v26 row_shr:1 row_mask:0xf bank_mask:0xf bound_ctrl:0
    s_nop 1
    v_add_f32_dpp v26, v26, v26 row_shr:2 row_mask:0xf bank_mask:0xf bound_ctrl:0
    s_nop 1
    v_add_f32_dpp v26, v26, v26 row_shr:4 row_mask:0xf bank_mask:0xf bound_ctrl:0
    s_nop 1
    v_add_f32_dpp v26, v26, v26 row_shr:8 row_mask:0xf bank_mask:0xf bound_ctrl:0
    s_nop 1
    v_add_f32_dpp v26, v26, v26 row_bcast:15 row_mask:0xa bank_mask:0xf
    s_nop 1
    v_add_f32_dpp v26, v26, v26 row_bcast:31 row_mask:0xc bank_mask:0xf
    s_nop 1
    v_readlane_b32 s66, v26, 63
    s_nop 1
    v_mov_b32 v27, s66
    v_mul_f32 v27, 0x3a800000, v27
    v_mov_b32 v26, 0
    v_sub_f32 v28, v64, v27
    v_fmac_f32 v26, v28, v28
    v_sub_f32 v28, v65, v27
    v_fmac_f32 v26, v28, v28
    v_sub_f32 v28, v66, v27
    v_fmac_f32 v26, v28, v28
    v_sub_f32 v28, v67, v27
    v_fmac_f32 v26, v28, v28
    v_sub_f32 v28, v68, v27
    v_fmac_f32 v26, v28, v28
    v_sub_f32 v28, v69, v27
    v_fmac_f32 v26, v28, v28
    v_sub_f32 v28, v70, v27
    v_fmac_f32 v26, v28, v28
    v_sub_f32 v28, v71, v27
    v_fmac_f32 v26, v28, v28
    v_sub_f32 v28, v72, v27
    v_fmac_f32 v26, v28, v28
    v_sub_f32 v28, v73, v27
    v_fmac_f32 v26, v28, v28
    v_sub_f32 v28, v74, v27
    v_fmac_f32 v26, v28, v28
    v_sub_f32 v28, v75, v27
    v_fmac_f32 v26, v28, v28
    v_sub_f32 v28, v76, v27
    v_fmac_f32 v26, v28, v28
    v_sub_f32 v28, v77, v27
    v_fmac_f32 v26, v28, v28
    v_sub_f32 v28, v78, v27
    v_fmac_f32 v26, v28, v28
    v_sub_f32 v28, v79, v27
    v_fmac_f32 v26, v28, v28
    s_nop 1
    v_add_f32_dpp v26, v26, v26 row_shr:1 row_mask:0xf bank_mask:0xf bound_ctrl:0
    s_nop 1
    v_add_f32_dpp v26, v26, v26 row_shr:2 row_mask:0xf bank_mask:0xf bound_ctrl:0
    s_nop 1
    v_add_f32_dpp v26, v26, v26 row_shr:4 row_mask:0xf bank_mask:0xf bound_ctrl:0
    s_nop 1
    v_add_f32_dpp v26, v26, v26 row_shr:8 row_mask:0xf bank_mask:0xf bound_ctrl:0
    s_nop 1
    v_add_f32_dpp v26, v26, v26 row_bcast:15 row_mask:0xa bank_mask:0xf
    s_nop 1
    v_add_f32_dpp v26, v26, v26 row_bcast:31 row_mask:0xc bank_mask:0xf
    s_nop 1
    v_readlane_b32 s66, v26, 63
    s_nop 1
    v_mov_b32 v26, s66
    v_mul_f32 v26, 0x3a800000, v26
    v_cvt_pk_bf16_f32 v26, v26, v26
    v_lshlrev_b32 v26, 16, v26
    v_cvt_pk_bf16_f32 v27, v27, v27
    v_lshlrev_b32 v27, 16, v27
    v_add_f32 v26, 0x3727c5ac, v26
    v_cvt_pk_bf16_f32 v26, v26, v26
    v_lshlrev_b32 v26, 16, v26
    v_sqrt_f32 v26, v26
    s_nop 0
    v_cvt_pk_bf16_f32 v26, v26, v26
    v_lshlrev_b32 v26, 16, v26
    v_rcp_f32 v26, v26
    s_nop 0
    v_sub_f32 v64, v64, v27
    v_cvt_pk_bf16_f32 v64, v64, v64
    v_lshlrev_b32 v64, 16, v64
    v_mul_f32 v64, v64, v26
    v_cvt_pk_bf16_f32 v64, v64, v64
    v_lshlrev_b32 v64, 16, v64
    v_sub_f32 v65, v65, v27
    v_cvt_pk_bf16_f32 v65, v65, v65
    v_lshlrev_b32 v65, 16, v65
    v_mul_f32 v65, v65, v26
    v_cvt_pk_bf16_f32 v65, v65, v65
    v_lshlrev_b32 v65, 16, v65
    v_sub_f32 v66, v66, v27
    v_cvt_pk_bf16_f32 v66, v66, v66
    v_lshlrev_b32 v66, 16, v66
    v_mul_f32 v66, v66, v26
    v_cvt_pk_bf16_f32 v66, v66, v66
    v_lshlrev_b32 v66, 16, v66
    v_sub_f32 v67, v67, v27
    v_cvt_pk_bf16_f32 v67, v67, v67
    v_lshlrev_b32 v67, 16, v67
    v_mul_f32 v67, v67, v26
    v_cvt_pk_bf16_f32 v67, v67, v67
    v_lshlrev_b32 v67, 16, v67
    v_sub_f32 v68, v68, v27
    v_cvt_pk_bf16_f32 v68, v68, v68
    v_lshlrev_b32 v68, 16, v68
    v_mul_f32 v68, v68, v26
    v_cvt_pk_bf16_f32 v68, v68, v68
    v_lshlrev_b32 v68, 16, v68
    v_sub_f32 v69, v69, v27
    v_cvt_pk_bf16_f32 v69, v69, v69
    v_lshlrev_b32 v69, 16, v69
    v_mul_f32 v69, v69, v26
    v_cvt_pk_bf16_f32 v69, v69, v69
    v_lshlrev_b32 v69, 16, v69
    v_sub_f32 v70, v70, v27
    v_cvt_pk_bf16_f32 v70, v70, v70
    v_lshlrev_b32 v70, 16, v70
    v_mul_f32 v70, v70, v26
    v_cvt_pk_bf16_f32 v70, v70, v70
    v_lshlrev_b32 v70, 16, v70
    v_sub_f32 v71, v71, v27
    v_cvt_pk_bf16_f32 v71, v71, v71
    v_lshlrev_b32 v71, 16, v71
    v_mul_f32 v71, v71, v26
    v_cvt_pk_bf16_f32 v71, v71, v71
    v_lshlrev_b32 v71, 16, v71
    v_sub_f32 v72, v72, v27
    v_cvt_pk_bf16_f32 v72, v72, v72
    v_lshlrev_b32 v72, 16, v72
    v_mul_f32 v72, v72, v26
    v_cvt_pk_bf16_f32 v72, v72, v72
    v_lshlrev_b32 v72, 16, v72
    v_sub_f32 v73, v73, v27
    v_cvt_pk_bf16_f32 v73, v73, v73
    v_lshlrev_b32 v73, 16, v73
    v_mul_f32 v73, v73, v26
    v_cvt_pk_bf16_f32 v73, v73, v73
    v_lshlrev_b32 v73, 16, v73
    v_sub_f32 v74, v74, v27
    v_cvt_pk_bf16_f32 v74, v74, v74
    v_lshlrev_b32 v74, 16, v74
    v_mul_f32 v74, v74, v26
    v_cvt_pk_bf16_f32 v74, v74, v74
    v_lshlrev_b32 v74, 16, v74
    v_sub_f32 v75, v75, v27
    v_cvt_pk_bf16_f32 v75, v75, v75
    v_lshlrev_b32 v75, 16, v75
    v_mul_f32 v75, v75, v26
    v_cvt_pk_bf16_f32 v75, v75, v75
    v_lshlrev_b32 v75, 16, v75
    v_sub_f32 v76, v76, v27
    v_cvt_pk_bf16_f32 v76, v76, v76
    v_lshlrev_b32 v76, 16, v76
    v_mul_f32 v76, v76, v26
    v_cvt_pk_bf16_f32 v76, v76, v76
    v_lshlrev_b32 v76, 16, v76
    v_sub_f32 v77, v77, v27
    v_cvt_pk_bf16_f32 v77, v77, v77
    v_lshlrev_b32 v77, 16, v77
    v_mul_f32 v77, v77, v26
    v_cvt_pk_bf16_f32 v77, v77, v77
    v_lshlrev_b32 v77, 16, v77
    v_sub_f32 v78, v78, v27
    v_cvt_pk_bf16_f32 v78, v78, v78
    v_lshlrev_b32 v78, 16, v78
    v_mul_f32 v78, v78, v26
    v_cvt_pk_bf16_f32 v78, v78, v78
    v_lshlrev_b32 v78, 16, v78
    v_sub_f32 v79, v79, v27
    v_cvt_pk_bf16_f32 v79, v79, v79
    v_lshlrev_b32 v79, 16, v79
    v_mul_f32 v79, v79, v26
    v_cvt_pk_bf16_f32 v79, v79, v79
    v_lshlrev_b32 v79, 16, v79
    v_mul_f32 v64, v64, v112
    v_cvt_pk_bf16_f32 v64, v64, v64
    v_lshlrev_b32 v64, 16, v64
    v_add_f32 v64, v64, v96
    v_mul_f32 v65, v65, v113
    v_cvt_pk_bf16_f32 v65, v65, v65
    v_lshlrev_b32 v65, 16, v65
    v_add_f32 v65, v65, v97
    v_mul_f32 v66, v66, v114
    v_cvt_pk_bf16_f32 v66, v66, v66
    v_lshlrev_b32 v66, 16, v66
    v_add_f32 v66, v66, v98
    v_mul_f32 v67, v67, v115
    v_cvt_pk_bf16_f32 v67, v67, v67
    v_lshlrev_b32 v67, 16, v67
    v_add_f32 v67, v67, v99
    v_mul_f32 v68, v68, v116
    v_cvt_pk_bf16_f32 v68, v68, v68
    v_lshlrev_b32 v68, 16, v68
    v_add_f32 v68, v68, v100
    v_mul_f32 v69, v69, v117
    v_cvt_pk_bf16_f32 v69, v69, v69
    v_lshlrev_b32 v69, 16, v69
    v_add_f32 v69, v69, v101
    v_mul_f32 v70, v70, v118
    v_cvt_pk_bf16_f32 v70, v70, v70
    v_lshlrev_b32 v70, 16, v70
    v_add_f32 v70, v70, v102
    v_mul_f32 v71, v71, v119
    v_cvt_pk_bf16_f32 v71, v71, v71
    v_lshlrev_b32 v71, 16, v71
    v_add_f32 v71, v71, v103
    v_mul_f32 v72, v72, v120
    v_cvt_pk_bf16_f32 v72, v72, v72
    v_lshlrev_b32 v72, 16, v72
    v_add_f32 v72, v72, v104
    v_mul_f32 v73, v73, v121
    v_cvt_pk_bf16_f32 v73, v73, v73
    v_lshlrev_b32 v73, 16, v73
    v_add_f32 v73, v73, v105
    v_mul_f32 v74, v74, v122
    v_cvt_pk_bf16_f32 v74, v74, v74
    v_lshlrev_b32 v74, 16, v74
    v_add_f32 v74, v74, v106
    v_mul_f32 v75, v75, v123
    v_cvt_pk_bf16_f32 v75, v75, v75
    v_lshlrev_b32 v75, 16, v75
    v_add_f32 v75, v75, v107
    v_mul_f32 v76, v76, v124
    v_cvt_pk_bf16_f32 v76, v76, v76
    v_lshlrev_b32 v76, 16, v76
    v_add_f32 v76, v76, v108
    v_mul_f32 v77, v77, v125
    v_cvt_pk_bf16_f32 v77, v77, v77
    v_lshlrev_b32 v77, 16, v77
    v_add_f32 v77, v77, v109
    v_mul_f32 v78, v78, v126
    v_cvt_pk_bf16_f32 v78, v78, v78
    v_lshlrev_b32 v78, 16, v78
    v_add_f32 v78, v78, v110
    v_mul_f32 v79, v79, v127
    v_cvt_pk_bf16_f32 v79, v79, v79
    v_lshlrev_b32 v79, 16, v79
    v_add_f32 v79, v79, v111
    v_cvt_pk_bf16_f32 v80, v64, v65
    v_cvt_pk_bf16_f32 v81, v66, v67
    v_cvt_pk_bf16_f32 v82, v68, v69
    v_cvt_pk_bf16_f32 v83, v70, v71
    v_cvt_pk_bf16_f32 v84, v72, v73
    v_cvt_pk_bf16_f32 v85, v74, v75
    v_cvt_pk_bf16_f32 v86, v76, v77
    v_cvt_pk_bf16_f32 v87, v78, v79
    s_lshr_b32 s45, s63, 5
    s_lshl_b32 s45, s45, 16
    s_and_b32 s46, s63, 31
    s_lshl_b32 s46, s46, 8
    s_add_u32 s45, s45, s46
    s_add_u32 s45, s45, 0x400000
    s_add_u32 s46, s45, 32768
    buffer_store_dwordx4 v[80:83], v2, s[12:15], s45 offen sc1
    buffer_store_dwordx4 v[84:87], v2, s[12:15], s46 offen sc1
    s_add_u32 s63, s63, 384
    v_lshlrev_b32 v64, 16, v160
    v_and_b32 v65, 0xffff0000, v160
    v_lshlrev_b32 v66, 16, v161
    v_and_b32 v67, 0xffff0000, v161
    v_lshlrev_b32 v68, 16, v162
    v_and_b32 v69, 0xffff0000, v162
    v_lshlrev_b32 v70, 16, v163
    v_and_b32 v71, 0xffff0000, v163
    v_lshlrev_b32 v72, 16, v164
    v_and_b32 v73, 0xffff0000, v164
    v_lshlrev_b32 v74, 16, v165
    v_and_b32 v75, 0xffff0000, v165
    v_lshlrev_b32 v76, 16, v166
    v_and_b32 v77, 0xffff0000, v166
    v_lshlrev_b32 v78, 16, v167
    v_and_b32 v79, 0xffff0000, v167
    v_add_f32 v26, v64, v65
    v_add_f32 v26, v26, v66
    v_add_f32 v26, v26, v67
    v_add_f32 v26, v26, v68
    v_add_f32 v26, v26, v69
    v_add_f32 v26, v26, v70
    v_add_f32 v26, v26, v71
    v_add_f32 v26, v26, v72
    v_add_f32 v26, v26, v73
    v_add_f32 v26, v26, v74
    v_add_f32 v26, v26, v75
    v_add_f32 v26, v26, v76
    v_add_f32 v26, v26, v77
    v_add_f32 v26, v26, v78
    v_add_f32 v26, v26, v79
    s_nop 1
    v_add_f32_dpp v26, v26, v26 row_shr:1 row_mask:0xf bank_mask:0xf bound_ctrl:0
    s_nop 1
    v_add_f32_dpp v26, v26, v26 row_shr:2 row_mask:0xf bank_mask:0xf bound_ctrl:0
    s_nop 1
    v_add_f32_dpp v26, v26, v26 row_shr:4 row_mask:0xf bank_mask:0xf bound_ctrl:0
    s_nop 1
    v_add_f32_dpp v26, v26, v26 row_shr:8 row_mask:0xf bank_mask:0xf bound_ctrl:0
    s_nop 1
    v_add_f32_dpp v26, v26, v26 row_bcast:15 row_mask:0xa bank_mask:0xf
    s_nop 1
    v_add_f32_dpp v26, v26, v26 row_bcast:31 row_mask:0xc bank_mask:0xf
    s_nop 1
    v_readlane_b32 s66, v26, 63
    s_nop 1
    v_mov_b32 v27, s66
    v_mul_f32 v27, 0x3a800000, v27
    v_mov_b32 v26, 0
    v_sub_f32 v28, v64, v27
    v_fmac_f32 v26, v28, v28
    v_sub_f32 v28, v65, v27
    v_fmac_f32 v26, v28, v28
    v_sub_f32 v28, v66, v27
    v_fmac_f32 v26, v28, v28
    v_sub_f32 v28, v67, v27
    v_fmac_f32 v26, v28, v28
    v_sub_f32 v28, v68, v27
    v_fmac_f32 v26, v28, v28
    v_sub_f32 v28, v69, v27
    v_fmac_f32 v26, v28, v28
    v_sub_f32 v28, v70, v27
    v_fmac_f32 v26, v28, v28
    v_sub_f32 v28, v71, v27
    v_fmac_f32 v26, v28, v28
    v_sub_f32 v28, v72, v27
    v_fmac_f32 v26, v28, v28
    v_sub_f32 v28, v73, v27
    v_fmac_f32 v26, v28, v28
    v_sub_f32 v28, v74, v27
    v_fmac_f32 v26, v28, v28
    v_sub_f32 v28, v75, v27
    v_fmac_f32 v26, v28, v28
    v_sub_f32 v28, v76, v27
    v_fmac_f32 v26, v28, v28
    v_sub_f32 v28, v77, v27
    v_fmac_f32 v26, v28, v28
    v_sub_f32 v28, v78, v27
    v_fmac_f32 v26, v28, v28
    v_sub_f32 v28, v79, v27
    v_fmac_f32 v26, v28, v28
    s_nop 1
    v_add_f32_dpp v26, v26, v26 row_shr:1 row_mask:0xf bank_mask:0xf bound_ctrl:0
    s_nop 1
    v_add_f32_dpp v26, v26, v26 row_shr:2 row_mask:0xf bank_mask:0xf bound_ctrl:0
    s_nop 1
    v_add_f32_dpp v26, v26, v26 row_shr:4 row_mask:0xf bank_mask:0xf bound_ctrl:0
    s_nop 1
    v_add_f32_dpp v26, v26, v26 row_shr:8 row_mask:0xf bank_mask:0xf bound_ctrl:0
    s_nop 1
    v_add_f32_dpp v26, v26, v26 row_bcast:15 row_mask:0xa bank_mask:0xf
    s_nop 1
    v_add_f32_dpp v26, v26, v26 row_bcast:31 row_mask:0xc bank_mask:0xf
    s_nop 1
    v_readlane_b32 s66, v26, 63
    s_nop 1
    v_mov_b32 v26, s66
    v_mul_f32 v26, 0x3a800000, v26
    v_cvt_pk_bf16_f32 v26, v26, v26
    v_lshlrev_b32 v26, 16, v26
    v_cvt_pk_bf16_f32 v27, v27, v27
    v_lshlrev_b32 v27, 16, v27
    v_add_f32 v26, 0x3727c5ac, v26
    v_cvt_pk_bf16_f32 v26, v26, v26
    v_lshlrev_b32 v26, 16, v26
    v_sqrt_f32 v26, v26
    s_nop 0
    v_cvt_pk_bf16_f32 v26, v26, v26
    v_lshlrev_b32 v26, 16, v26
    v_rcp_f32 v26, v26
    s_nop 0
    v_sub_f32 v64, v64, v27
    v_cvt_pk_bf16_f32 v64, v64, v64
    v_lshlrev_b32 v64, 16, v64
    v_mul_f32 v64, v64, v26
    v_cvt_pk_bf16_f32 v64, v64, v64
    v_lshlrev_b32 v64, 16, v64
    v_sub_f32 v65, v65, v27
    v_cvt_pk_bf16_f32 v65, v65, v65
    v_lshlrev_b32 v65, 16, v65
    v_mul_f32 v65, v65, v26
    v_cvt_pk_bf16_f32 v65, v65, v65
    v_lshlrev_b32 v65, 16, v65
    v_sub_f32 v66, v66, v27
    v_cvt_pk_bf16_f32 v66, v66, v66
    v_lshlrev_b32 v66, 16, v66
    v_mul_f32 v66, v66, v26
    v_cvt_pk_bf16_f32 v66, v66, v66
    v_lshlrev_b32 v66, 16, v66
    v_sub_f32 v67, v67, v27
    v_cvt_pk_bf16_f32 v67, v67, v67
    v_lshlrev_b32 v67, 16, v67
    v_mul_f32 v67, v67, v26
    v_cvt_pk_bf16_f32 v67, v67, v67
    v_lshlrev_b32 v67, 16, v67
    v_sub_f32 v68, v68, v27
    v_cvt_pk_bf16_f32 v68, v68, v68
    v_lshlrev_b32 v68, 16, v68
    v_mul_f32 v68, v68, v26
    v_cvt_pk_bf16_f32 v68, v68, v68
    v_lshlrev_b32 v68, 16, v68
    v_sub_f32 v69, v69, v27
    v_cvt_pk_bf16_f32 v69, v69, v69
    v_lshlrev_b32 v69, 16, v69
    v_mul_f32 v69, v69, v26
    v_cvt_pk_bf16_f32 v69, v69, v69
    v_lshlrev_b32 v69, 16, v69
    v_sub_f32 v70, v70, v27
    v_cvt_pk_bf16_f32 v70, v70, v70
    v_lshlrev_b32 v70, 16, v70
    v_mul_f32 v70, v70, v26
    v_cvt_pk_bf16_f32 v70, v70, v70
    v_lshlrev_b32 v70, 16, v70
    v_sub_f32 v71, v71, v27
    v_cvt_pk_bf16_f32 v71, v71, v71
    v_lshlrev_b32 v71, 16, v71
    v_mul_f32 v71, v71, v26
    v_cvt_pk_bf16_f32 v71, v71, v71
    v_lshlrev_b32 v71, 16, v71
    v_sub_f32 v72, v72, v27
    v_cvt_pk_bf16_f32 v72, v72, v72
    v_lshlrev_b32 v72, 16, v72
    v_mul_f32 v72, v72, v26
    v_cvt_pk_bf16_f32 v72, v72, v72
    v_lshlrev_b32 v72, 16, v72
    v_sub_f32 v73, v73, v27
    v_cvt_pk_bf16_f32 v73, v73, v73
    v_lshlrev_b32 v73, 16, v73
    v_mul_f32 v73, v73, v26
    v_cvt_pk_bf16_f32 v73, v73, v73
    v_lshlrev_b32 v73, 16, v73
    v_sub_f32 v74, v74, v27
    v_cvt_pk_bf16_f32 v74, v74, v74
    v_lshlrev_b32 v74, 16, v74
    v_mul_f32 v74, v74, v26
    v_cvt_pk_bf16_f32 v74, v74, v74
    v_lshlrev_b32 v74, 16, v74
    v_sub_f32 v75, v75, v27
    v_cvt_pk_bf16_f32 v75, v75, v75
    v_lshlrev_b32 v75, 16, v75
    v_mul_f32 v75, v75, v26
    v_cvt_pk_bf16_f32 v75, v75, v75
    v_lshlrev_b32 v75, 16, v75
    v_sub_f32 v76, v76, v27
    v_cvt_pk_bf16_f32 v76, v76, v76
    v_lshlrev_b32 v76, 16, v76
    v_mul_f32 v76, v76, v26
    v_cvt_pk_bf16_f32 v76, v76, v76
    v_lshlrev_b32 v76, 16, v76
    v_sub_f32 v77, v77, v27
    v_cvt_pk_bf16_f32 v77, v77, v77
    v_lshlrev_b32 v77, 16, v77
    v_mul_f32 v77, v77, v26
    v_cvt_pk_bf16_f32 v77, v77, v77
    v_lshlrev_b32 v77, 16, v77
    v_sub_f32 v78, v78, v27
    v_cvt_pk_bf16_f32 v78, v78, v78
    v_lshlrev_b32 v78, 16, v78
    v_mul_f32 v78, v78, v26
    v_cvt_pk_bf16_f32 v78, v78, v78
    v_lshlrev_b32 v78, 16, v78
    v_sub_f32 v79, v79, v27
    v_cvt_pk_bf16_f32 v79, v79, v79
    v_lshlrev_b32 v79, 16, v79
    v_mul_f32 v79, v79, v26
    v_cvt_pk_bf16_f32 v79, v79, v79
    v_lshlrev_b32 v79, 16, v79
    v_mul_f32 v64, v64, v112
    v_cvt_pk_bf16_f32 v64, v64, v64
    v_lshlrev_b32 v64, 16, v64
    v_add_f32 v64, v64, v96
    v_mul_f32 v65, v65, v113
    v_cvt_pk_bf16_f32 v65, v65, v65
    v_lshlrev_b32 v65, 16, v65
    v_add_f32 v65, v65, v97
    v_mul_f32 v66, v66, v114
    v_cvt_pk_bf16_f32 v66, v66, v66
    v_lshlrev_b32 v66, 16, v66
    v_add_f32 v66, v66, v98
    v_mul_f32 v67, v67, v115
    v_cvt_pk_bf16_f32 v67, v67, v67
    v_lshlrev_b32 v67, 16, v67
    v_add_f32 v67, v67, v99
    v_mul_f32 v68, v68, v116
    v_cvt_pk_bf16_f32 v68, v68, v68
    v_lshlrev_b32 v68, 16, v68
    v_add_f32 v68, v68, v100
    v_mul_f32 v69, v69, v117
    v_cvt_pk_bf16_f32 v69, v69, v69
    v_lshlrev_b32 v69, 16, v69
    v_add_f32 v69, v69, v101
    v_mul_f32 v70, v70, v118
    v_cvt_pk_bf16_f32 v70, v70, v70
    v_lshlrev_b32 v70, 16, v70
    v_add_f32 v70, v70, v102
    v_mul_f32 v71, v71, v119
    v_cvt_pk_bf16_f32 v71, v71, v71
    v_lshlrev_b32 v71, 16, v71
    v_add_f32 v71, v71, v103
    v_mul_f32 v72, v72, v120
    v_cvt_pk_bf16_f32 v72, v72, v72
    v_lshlrev_b32 v72, 16, v72
    v_add_f32 v72, v72, v104
    v_mul_f32 v73, v73, v121
    v_cvt_pk_bf16_f32 v73, v73, v73
    v_lshlrev_b32 v73, 16, v73
    v_add_f32 v73, v73, v105
    v_mul_f32 v74, v74, v122
    v_cvt_pk_bf16_f32 v74, v74, v74
    v_lshlrev_b32 v74, 16, v74
    v_add_f32 v74, v74, v106
    v_mul_f32 v75, v75, v123
    v_cvt_pk_bf16_f32 v75, v75, v75
    v_lshlrev_b32 v75, 16, v75
    v_add_f32 v75, v75, v107
    v_mul_f32 v76, v76, v124
    v_cvt_pk_bf16_f32 v76, v76, v76
    v_lshlrev_b32 v76, 16, v76
    v_add_f32 v76, v76, v108
    v_mul_f32 v77, v77, v125
    v_cvt_pk_bf16_f32 v77, v77, v77
    v_lshlrev_b32 v77, 16, v77
    v_add_f32 v77, v77, v109
    v_mul_f32 v78, v78, v126
    v_cvt_pk_bf16_f32 v78, v78, v78
    v_lshlrev_b32 v78, 16, v78
    v_add_f32 v78, v78, v110
    v_mul_f32 v79, v79, v127
    v_cvt_pk_bf16_f32 v79, v79, v79
    v_lshlrev_b32 v79, 16, v79
    v_add_f32 v79, v79, v111
    v_cvt_pk_bf16_f32 v80, v64, v65
    v_cvt_pk_bf16_f32 v81, v66, v67
    v_cvt_pk_bf16_f32 v82, v68, v69
    v_cvt_pk_bf16_f32 v83, v70, v71
    v_cvt_pk_bf16_f32 v84, v72, v73
    v_cvt_pk_bf16_f32 v85, v74, v75
    v_cvt_pk_bf16_f32 v86, v76, v77
    v_cvt_pk_bf16_f32 v87, v78, v79
    s_lshr_b32 s45, s63, 5
    s_lshl_b32 s45, s45, 16
    s_and_b32 s46, s63, 31
    s_lshl_b32 s46, s46, 8
    s_add_u32 s45, s45, s46
    s_add_u32 s45, s45, 0x400000
    s_add_u32 s46, s45, 32768
    buffer_store_dwordx4 v[80:83], v2, s[12:15], s45 offen sc1
    buffer_store_dwordx4 v[84:87], v2, s[12:15], s46 offen sc1
    s_add_u32 s63, s63, 384
    s_cmp_ge_u32 s63, 2048
    s_cbranch_scc1 L_ln_done_105
    v_lshlrev_b32 v64, 16, v168
    v_and_b32 v65, 0xffff0000, v168
    v_lshlrev_b32 v66, 16, v169
    v_and_b32 v67, 0xffff0000, v169
    v_lshlrev_b32 v68, 16, v170
    v_and_b32 v69, 0xffff0000, v170
    v_lshlrev_b32 v70, 16, v171
    v_and_b32 v71, 0xffff0000, v171
    v_lshlrev_b32 v72, 16, v172
    v_and_b32 v73, 0xffff0000, v172
    v_lshlrev_b32 v74, 16, v173
    v_and_b32 v75, 0xffff0000, v173
    v_lshlrev_b32 v76, 16, v174
    v_and_b32 v77, 0xffff0000, v174
    v_lshlrev_b32 v78, 16, v175
    v_and_b32 v79, 0xffff0000, v175
    v_add_f32 v26, v64, v65
    v_add_f32 v26, v26, v66
    v_add_f32 v26, v26, v67
    v_add_f32 v26, v26, v68
    v_add_f32 v26, v26, v69
    v_add_f32 v26, v26, v70
    v_add_f32 v26, v26, v71
    v_add_f32 v26, v26, v72
    v_add_f32 v26, v26, v73
    v_add_f32 v26, v26, v74
    v_add_f32 v26, v26, v75
    v_add_f32 v26, v26, v76
    v_add_f32 v26, v26, v77
    v_add_f32 v26, v26, v78
    v_add_f32 v26, v26, v79
    s_nop 1
    v_add_f32_dpp v26, v26, v26 row_shr:1 row_mask:0xf bank_mask:0xf bound_ctrl:0
    s_nop 1
    v_add_f32_dpp v26, v26, v26 row_shr:2 row_mask:0xf bank_mask:0xf bound_ctrl:0
    s_nop 1
    v_add_f32_dpp v26, v26, v26 row_shr:4 row_mask:0xf bank_mask:0xf bound_ctrl:0
    s_nop 1
    v_add_f32_dpp v26, v26, v26 row_shr:8 row_mask:0xf bank_mask:0xf bound_ctrl:0
    s_nop 1
    v_add_f32_dpp v26, v26, v26 row_bcast:15 row_mask:0xa bank_mask:0xf
    s_nop 1
    v_add_f32_dpp v26, v26, v26 row_bcast:31 row_mask:0xc bank_mask:0xf
    s_nop 1
    v_readlane_b32 s66, v26, 63
    s_nop 1
    v_mov_b32 v27, s66
    v_mul_f32 v27, 0x3a800000, v27
    v_mov_b32 v26, 0
    v_sub_f32 v28, v64, v27
    v_fmac_f32 v26, v28, v28
    v_sub_f32 v28, v65, v27
    v_fmac_f32 v26, v28, v28
    v_sub_f32 v28, v66, v27
    v_fmac_f32 v26, v28, v28
    v_sub_f32 v28, v67, v27
    v_fmac_f32 v26, v28, v28
    v_sub_f32 v28, v68, v27
    v_fmac_f32 v26, v28, v28
    v_sub_f32 v28, v69, v27
    v_fmac_f32 v26, v28, v28
    v_sub_f32 v28, v70, v27
    v_fmac_f32 v26, v28, v28
    v_sub_f32 v28, v71, v27
    v_fmac_f32 v26, v28, v28
    v_sub_f32 v28, v72, v27
    v_fmac_f32 v26, v28, v28
    v_sub_f32 v28, v73, v27
    v_fmac_f32 v26, v28, v28
    v_sub_f32 v28, v74, v27
    v_fmac_f32 v26, v28, v28
    v_sub_f32 v28, v75, v27
    v_fmac_f32 v26, v28, v28
    v_sub_f32 v28, v76, v27
    v_fmac_f32 v26, v28, v28
    v_sub_f32 v28, v77, v27
    v_fmac_f32 v26, v28, v28
    v_sub_f32 v28, v78, v27
    v_fmac_f32 v26, v28, v28
    v_sub_f32 v28, v79, v27
    v_fmac_f32 v26, v28, v28
    s_nop 1
    v_add_f32_dpp v26, v26, v26 row_shr:1 row_mask:0xf bank_mask:0xf bound_ctrl:0
    s_nop 1
    v_add_f32_dpp v26, v26, v26 row_shr:2 row_mask:0xf bank_mask:0xf bound_ctrl:0
    s_nop 1
    v_add_f32_dpp v26, v26, v26 row_shr:4 row_mask:0xf bank_mask:0xf bound_ctrl:0
    s_nop 1
    v_add_f32_dpp v26, v26, v26 row_shr:8 row_mask:0xf bank_mask:0xf bound_ctrl:0
    s_nop 1
    v_add_f32_dpp v26, v26, v26 row_bcast:15 row_mask:0xa bank_mask:0xf
    s_nop 1
    v_add_f32_dpp v26, v26, v26 row_bcast:31 row_mask:0xc bank_mask:0xf
    s_nop 1
    v_readlane_b32 s66, v26, 63
    s_nop 1
    v_mov_b32 v26, s66
    v_mul_f32 v26, 0x3a800000, v26
    v_cvt_pk_bf16_f32 v26, v26, v26
    v_lshlrev_b32 v26, 16, v26
    v_cvt_pk_bf16_f32 v27, v27, v27
    v_lshlrev_b32 v27, 16, v27
    v_add_f32 v26, 0x3727c5ac, v26
    v_cvt_pk_bf16_f32 v26, v26, v26
    v_lshlrev_b32 v26, 16, v26
    v_sqrt_f32 v26, v26
    s_nop 0
    v_cvt_pk_bf16_f32 v26, v26, v26
    v_lshlrev_b32 v26, 16, v26
    v_rcp_f32 v26, v26
    s_nop 0
    v_sub_f32 v64, v64, v27
    v_cvt_pk_bf16_f32 v64, v64, v64
    v_lshlrev_b32 v64, 16, v64
    v_mul_f32 v64, v64, v26
    v_cvt_pk_bf16_f32 v64, v64, v64
    v_lshlrev_b32 v64, 16, v64
    v_sub_f32 v65, v65, v27
    v_cvt_pk_bf16_f32 v65, v65, v65
    v_lshlrev_b32 v65, 16, v65
    v_mul_f32 v65, v65, v26
    v_cvt_pk_bf16_f32 v65, v65, v65
    v_lshlrev_b32 v65, 16, v65
    v_sub_f32 v66, v66, v27
    v_cvt_pk_bf16_f32 v66, v66, v66
    v_lshlrev_b32 v66, 16, v66
    v_mul_f32 v66, v66, v26
    v_cvt_pk_bf16_f32 v66, v66, v66
    v_lshlrev_b32 v66, 16, v66
    v_sub_f32 v67, v67, v27
    v_cvt_pk_bf16_f32 v67, v67, v67
    v_lshlrev_b32 v67, 16, v67
    v_mul_f32 v67, v67, v26
    v_cvt_pk_bf16_f32 v67, v67, v67
    v_lshlrev_b32 v67, 16, v67
    v_sub_f32 v68, v68, v27
    v_cvt_pk_bf16_f32 v68, v68, v68
    v_lshlrev_b32 v68, 16, v68
    v_mul_f32 v68, v68, v26
    v_cvt_pk_bf16_f32 v68, v68, v68
    v_lshlrev_b32 v68, 16, v68
    v_sub_f32 v69, v69, v27
    v_cvt_pk_bf16_f32 v69, v69, v69
    v_lshlrev_b32 v69, 16, v69
    v_mul_f32 v69, v69, v26
    v_cvt_pk_bf16_f32 v69, v69, v69
    v_lshlrev_b32 v69, 16, v69
    v_sub_f32 v70, v70, v27
    v_cvt_pk_bf16_f32 v70, v70, v70
    v_lshlrev_b32 v70, 16, v70
    v_mul_f32 v70, v70, v26
    v_cvt_pk_bf16_f32 v70, v70, v70
    v_lshlrev_b32 v70, 16, v70
    v_sub_f32 v71, v71, v27
    v_cvt_pk_bf16_f32 v71, v71, v71
    v_lshlrev_b32 v71, 16, v71
    v_mul_f32 v71, v71, v26
    v_cvt_pk_bf16_f32 v71, v71, v71
    v_lshlrev_b32 v71, 16, v71
    v_sub_f32 v72, v72, v27
    v_cvt_pk_bf16_f32 v72, v72, v72
    v_lshlrev_b32 v72, 16, v72
    v_mul_f32 v72, v72, v26
    v_cvt_pk_bf16_f32 v72, v72, v72
    v_lshlrev_b32 v72, 16, v72
    v_sub_f32 v73, v73, v27
    v_cvt_pk_bf16_f32 v73, v73, v73
    v_lshlrev_b32 v73, 16, v73
    v_mul_f32 v73, v73, v26
    v_cvt_pk_bf16_f32 v73, v73, v73
    v_lshlrev_b32 v73, 16, v73
    v_sub_f32 v74, v74, v27
    v_cvt_pk_bf16_f32 v74, v74, v74
    v_lshlrev_b32 v74, 16, v74
    v_mul_f32 v74, v74, v26
    v_cvt_pk_bf16_f32 v74, v74, v74
    v_lshlrev_b32 v74, 16, v74
    v_sub_f32 v75, v75, v27
    v_cvt_pk_bf16_f32 v75, v75, v75
    v_lshlrev_b32 v75, 16, v75
    v_mul_f32 v75, v75, v26
    v_cvt_pk_bf16_f32 v75, v75, v75
    v_lshlrev_b32 v75, 16, v75
    v_sub_f32 v76, v76, v27
    v_cvt_pk_bf16_f32 v76, v76, v76
    v_lshlrev_b32 v76, 16, v76
    v_mul_f32 v76, v76, v26
    v_cvt_pk_bf16_f32 v76, v76, v76
    v_lshlrev_b32 v76, 16, v76
    v_sub_f32 v77, v77, v27
    v_cvt_pk_bf16_f32 v77, v77, v77
    v_lshlrev_b32 v77, 16, v77
    v_mul_f32 v77, v77, v26
    v_cvt_pk_bf16_f32 v77, v77, v77
    v_lshlrev_b32 v77, 16, v77
    v_sub_f32 v78, v78, v27
    v_cvt_pk_bf16_f32 v78, v78, v78
    v_lshlrev_b32 v78, 16, v78
    v_mul_f32 v78, v78, v26
    v_cvt_pk_bf16_f32 v78, v78, v78
    v_lshlrev_b32 v78, 16, v78
    v_sub_f32 v79, v79, v27
    v_cvt_pk_bf16_f32 v79, v79, v79
    v_lshlrev_b32 v79, 16, v79
    v_mul_f32 v79, v79, v26
    v_cvt_pk_bf16_f32 v79, v79, v79
    v_lshlrev_b32 v79, 16, v79
    v_mul_f32 v64, v64, v112
    v_cvt_pk_bf16_f32 v64, v64, v64
    v_lshlrev_b32 v64, 16, v64
    v_add_f32 v64, v64, v96
    v_mul_f32 v65, v65, v113
    v_cvt_pk_bf16_f32 v65, v65, v65
    v_lshlrev_b32 v65, 16, v65
    v_add_f32 v65, v65, v97
    v_mul_f32 v66, v66, v114
    v_cvt_pk_bf16_f32 v66, v66, v66
    v_lshlrev_b32 v66, 16, v66
    v_add_f32 v66, v66, v98
    v_mul_f32 v67, v67, v115
    v_cvt_pk_bf16_f32 v67, v67, v67
    v_lshlrev_b32 v67, 16, v67
    v_add_f32 v67, v67, v99
    v_mul_f32 v68, v68, v116
    v_cvt_pk_bf16_f32 v68, v68, v68
    v_lshlrev_b32 v68, 16, v68
    v_add_f32 v68, v68, v100
    v_mul_f32 v69, v69, v117
    v_cvt_pk_bf16_f32 v69, v69, v69
    v_lshlrev_b32 v69, 16, v69
    v_add_f32 v69, v69, v101
    v_mul_f32 v70, v70, v118
    v_cvt_pk_bf16_f32 v70, v70, v70
    v_lshlrev_b32 v70, 16, v70
    v_add_f32 v70, v70, v102
    v_mul_f32 v71, v71, v119
    v_cvt_pk_bf16_f32 v71, v71, v71
    v_lshlrev_b32 v71, 16, v71
    v_add_f32 v71, v71, v103
    v_mul_f32 v72, v72, v120
    v_cvt_pk_bf16_f32 v72, v72, v72
    v_lshlrev_b32 v72, 16, v72
    v_add_f32 v72, v72, v104
    v_mul_f32 v73, v73, v121
    v_cvt_pk_bf16_f32 v73, v73, v73
    v_lshlrev_b32 v73, 16, v73
    v_add_f32 v73, v73, v105
    v_mul_f32 v74, v74, v122
    v_cvt_pk_bf16_f32 v74, v74, v74
    v_lshlrev_b32 v74, 16, v74
    v_add_f32 v74, v74, v106
    v_mul_f32 v75, v75, v123
    v_cvt_pk_bf16_f32 v75, v75, v75
    v_lshlrev_b32 v75, 16, v75
    v_add_f32 v75, v75, v107
    v_mul_f32 v76, v76, v124
    v_cvt_pk_bf16_f32 v76, v76, v76
    v_lshlrev_b32 v76, 16, v76
    v_add_f32 v76, v76, v108
    v_mul_f32 v77, v77, v125
    v_cvt_pk_bf16_f32 v77, v77, v77
    v_lshlrev_b32 v77, 16, v77
    v_add_f32 v77, v77, v109
    v_mul_f32 v78, v78, v126
    v_cvt_pk_bf16_f32 v78, v78, v78
    v_lshlrev_b32 v78, 16, v78
    v_add_f32 v78, v78, v110
    v_mul_f32 v79, v79, v127
    v_cvt_pk_bf16_f32 v79, v79, v79
    v_lshlrev_b32 v79, 16, v79
    v_add_f32 v79, v79, v111
    v_cvt_pk_bf16_f32 v80, v64, v65
    v_cvt_pk_bf16_f32 v81, v66, v67
    v_cvt_pk_bf16_f32 v82, v68, v69
    v_cvt_pk_bf16_f32 v83, v70, v71
    v_cvt_pk_bf16_f32 v84, v72, v73
    v_cvt_pk_bf16_f32 v85, v74, v75
    v_cvt_pk_bf16_f32 v86, v76, v77
    v_cvt_pk_bf16_f32 v87, v78, v79
    s_lshr_b32 s45, s63, 5
    s_lshl_b32 s45, s45, 16
    s_and_b32 s46, s63, 31
    s_lshl_b32 s46, s46, 8
    s_add_u32 s45, s45, s46
    s_add_u32 s45, s45, 0x400000
    s_add_u32 s46, s45, 32768
    buffer_store_dwordx4 v[80:83], v2, s[12:15], s45 offen sc1
    buffer_store_dwordx4 v[84:87], v2, s[12:15], s46 offen sc1
    s_add_u32 s63, s63, 384
L_ln_done_105:
    s_waitcnt vmcnt(0)
    s_barrier
    s_cmp_lg_u32 s44, 0
    s_cbranch_scc1 L_cnt_107
    v_mov_b32 v30, 1
    v_mov_b32 v31, 127104
    s_mov_b64 exec, 1
    buffer_atomic_add v30, v31, s[12:15], 0 offen sc1
    s_mov_b64 exec, -1
L_cnt_107:
    s_cmp_lg_u32 s44, 0
    s_cbranch_scc1 L_pd_108
    v_mov_b32 v29, 127360
    s_mov_b32 s46, 64
    s_mov_b64 exec, 1
    s_mov_b32 s70, 0
L_wp_109:
    buffer_load_dword v31, v29, s[12:15], 0 offen sc1
    s_add_u32 s70, s70, 1
    s_cmp_ge_u32 s70, 0x200000
    s_cbranch_scc1 L_w_done_96
    s_waitcnt vmcnt(0)
    v_cmp_gt_u32 vcc, s46, v31
    s_nop 1
    s_cbranch_vccz L_wp_109_ok
    s_sleep 8
    s_branch L_wp_109
L_wp_109_ok:
    s_mov_b64 exec, -1
L_pd_108:
    s_barrier
    s_add_u32 s39, s39, 96
    s_load_dwordx2 s[4:5], s[0:1], 96
    s_load_dwordx2 s[6:7], s[0:1], 104
    v_and_b32 v14, 7, v0
    v_lshrrev_b32 v15, 3, v0
    s_waitcnt lgkmcnt(0)
    s_mov_b32 s32, s4
    s_and_b32 s33, s5, 0xffff
    s_mov_b32 s34, 0x800
    s_mov_b32 s35, 0x00020000
    s_mov_b32 s24, s6
    s_and_b32 s25, s7, 0xffff
    s_mov_b32 s26, 0xc00000
    s_mov_b32 s27, 0x00020000
    s_and_b32 s47, s39, 1
    s_lshl_b32 s45, s47, 10
    v_lshlrev_b32 v16, 5, v15
    buffer_load_dwordx4 v[104:107], v16, s[32:35], s45 offen
    buffer_load_dwordx4 v[108:111], v16, s[32:35], s45 offen offset:16
    s_mov_b32 s45, 196608
    v_mul_lo_u32 v17, v15, s45
    v_lshlrev_b32 v18, 4, v14
    v_add_u32 v17, v17, v18
    s_lshr_b32 s46, s39, 1
    s_lshl_b32 s46, s46, 7
    s_mul_i32 s45, s47, 6291456
    s_add_u32 s46, s46, s45
    buffer_load_dwordx4 v[32:35], v17, s[24:27], s46 offen
    v_add_u32 v17, 12288, v17
    buffer_load_dwordx4 v[36:39], v17, s[24:27], s46 offen
    v_add_u32 v17, 12288, v17
    buffer_load_dwordx4 v[40:43], v17, s[24:27], s46 offen
    v_add_u32 v17, 12288, v17
    buffer_load_dwordx4 v[44:47], v17, s[24:27], s46 offen
    v_add_u32 v17, 12288, v17
    buffer_load_dwordx4 v[48:51], v17, s[24:27], s46 offen
    v_add_u32 v17, 12288, v17
    buffer_load_dwordx4 v[52:55], v17, s[24:27], s46 offen
    v_add_u32 v17, 12288, v17
    buffer_load_dwordx4 v[56:59], v17, s[24:27], s46 offen
    v_add_u32 v17, 12288, v17
    buffer_load_dwordx4 v[60:63], v17, s[24:27], s46 offen
    v_add_u32 v17, 12288, v17
    buffer_load_dwordx4 v[64:67], v17, s[24:27], s46 offen
    v_add_u32 v17, 12288, v17
    buffer_load_dwordx4 v[68:71], v17, s[24:27], s46 offen
    v_add_u32 v17, 12288, v17
    buffer_load_dwordx4 v[72:75], v17, s[24:27], s46 offen
    v_add_u32 v17, 12288, v17
    buffer_load_dwordx4 v[76:79], v17, s[24:27], s46 offen
    v_add_u32 v17, 12288, v17
    buffer_load_dwordx4 v[80:83], v17, s[24:27], s46 offen
    v_add_u32 v17, 12288, v17
    buffer_load_dwordx4 v[84:87], v17, s[24:27], s46 offen
    v_add_u32 v17, 12288, v17
    buffer_load_dwordx4 v[88:91], v17, s[24:27], s46 offen
    v_add_u32 v17, 12288, v17
    buffer_load_dwordx4 v[92:95], v17, s[24:27], s46 offen
    s_waitcnt vmcnt(16)
    v_lshlrev_b32 v112, 16, v104
    v_and_b32 v113, 0xffff0000, v104
    v_lshlrev_b32 v114, 16, v105
    v_and_b32 v115, 0xffff0000, v105
    v_lshlrev_b32 v116, 16, v106
    v_and_b32 v117, 0xffff0000, v106
    v_lshlrev_b32 v118, 16, v107
    v_and_b32 v119, 0xffff0000, v107
    v_lshlrev_b32 v120, 16, v108
    v_and_b32 v121, 0xffff0000, v108
    v_lshlrev_b32 v122, 16, v109
    v_and_b32 v123, 0xffff0000, v109
    v_lshlrev_b32 v124, 16, v110
    v_and_b32 v125, 0xffff0000, v110
    v_lshlrev_b32 v126, 16, v111
    v_and_b32 v127, 0xffff0000, v111
    v_mul_f32 v18, 0xbfb8aa3b, v112
    v_exp_f32 v18, v18
    s_nop 0
    v_add_f32 v18, 1.0, v18
    v_rcp_f32 v18, v18
    s_nop 0
    v_mul_f32 v112, v112, v18
    v_cvt_pk_bf16_f32 v112, v112, v112
    v_lshlrev_b32 v112, 16, v112
    v_mul_f32 v18, 0xbfb8aa3b, v113
    v_exp_f32 v18, v18
    s_nop 0
    v_add_f32 v18, 1.0, v18
    v_rcp_f32 v18, v18
    s_nop 0
    v_mul_f32 v113, v113, v18
    v_cvt_pk_bf16_f32 v113, v113, v113
    v_lshlrev_b32 v113, 16, v113
    v_mul_f32 v18, 0xbfb8aa3b, v114
    v_exp_f32 v18, v18
    s_nop 0
    v_add_f32 v18, 1.0, v18
    v_rcp_f32 v18, v18
    s_nop 0
    v_mul_f32 v114, v114, v18
    v_cvt_pk_bf16_f32 v114, v114, v114
    v_lshlrev_b32 v114, 16, v114
    v_mul_f32 v18, 0xbfb8aa3b, v115
    v_exp_f32 v18, v18
    s_nop 0
    v_add_f32 v18, 1.0, v18
    v_rcp_f32 v18, v18
    s_nop 0
    v_mul_f32 v115, v115, v18
    v_cvt_pk_bf16_f32 v115, v115, v115
    v_lshlrev_b32 v115, 16, v115
    v_mul_f32 v18, 0xbfb8aa3b, v116
    v_exp_f32 v18, v18
    s_nop 0
    v_add_f32 v18, 1.0, v18
    v_rcp_f32 v18, v18
    s_nop 0
    v_mul_f32 v116, v116, v18
    v_cvt_pk_bf16_f32 v116, v116, v116
    v_lshlrev_b32 v116, 16, v116
    v_mul_f32 v18, 0xbfb8aa3b, v117
    v_exp_f32 v18, v18
    s_nop 0
    v_add_f32 v18, 1.0, v18
    v_rcp_f32 v18, v18
    s_nop 0
    v_mul_f32 v117, v117, v18
    v_cvt_pk_bf16_f32 v117, v117, v117
    v_lshlrev_b32 v117, 16, v117
    v_mul_f32 v18, 0xbfb8aa3b, v118
    v_exp_f32 v18, v18
    s_nop 0
    v_add_f32 v18, 1.0, v18
    v_rcp_f32 v18, v18
    s_nop 0
    v_mul_f32 v118, v118, v18
    v_cvt_pk_bf16_f32 v118, v118, v118
    v_lshlrev_b32 v118, 16, v118
    v_mul_f32 v18, 0xbfb8aa3b, v119
    v_exp_f32 v18, v18
    s_nop 0
    v_add_f32 v18, 1.0, v18
    v_rcp_f32 v18, v18
    s_nop 0
    v_mul_f32 v119, v119, v18
    v_cvt_pk_bf16_f32 v119, v119, v119
    v_lshlrev_b32 v119, 16, v119
    v_mul_f32 v18, 0xbfb8aa3b, v120
    v_exp_f32 v18, v18
    s_nop 0
    v_add_f32 v18, 1.0, v18
    v_rcp_f32 v18, v18
    s_nop 0
    v_mul_f32 v120, v120, v18
    v_cvt_pk_bf16_f32 v120, v120, v120
    v_lshlrev_b32 v120, 16, v120
    v_mul_f32 v18, 0xbfb8aa3b, v121
    v_exp_f32 v18, v18
    s_nop 0
    v_add_f32 v18, 1.0, v18
    v_rcp_f32 v18, v18
    s_nop 0
    v_mul_f32 v121, v121, v18
    v_cvt_pk_bf16_f32 v121, v121, v121
    v_lshlrev_b32 v121, 16, v121
    v_mul_f32 v18, 0xbfb8aa3b, v122
    v_exp_f32 v18, v18
    s_nop 0
    v_add_f32 v18, 1.0, v18
    v_rcp_f32 v18, v18
    s_nop 0
    v_mul_f32 v122, v122, v18
    v_cvt_pk_bf16_f32 v122, v122, v122
    v_lshlrev_b32 v122, 16, v122
    v_mul_f32 v18, 0xbfb8aa3b, v123
    v_exp_f32 v18, v18
    s_nop 0
    v_add_f32 v18, 1.0, v18
    v_rcp_f32 v18, v18
    s_nop 0
    v_mul_f32 v123, v123, v18
    v_cvt_pk_bf16_f32 v123, v123, v123
    v_lshlrev_b32 v123, 16, v123
    v_mul_f32 v18, 0xbfb8aa3b, v124
    v_exp_f32 v18, v18
    s_nop 0
    v_add_f32 v18, 1.0, v18
    v_rcp_f32 v18, v18
    s_nop 0
    v_mul_f32 v124, v124, v18
    v_cvt_pk_bf16_f32 v124, v124, v124
    v_lshlrev_b32 v124, 16, v124
    v_mul_f32 v18, 0xbfb8aa3b, v125
    v_exp_f32 v18, v18
    s_nop 0
    v_add_f32 v18, 1.0, v18
    v_rcp_f32 v18, v18
    s_nop 0
    v_mul_f32 v125, v125, v18
    v_cvt_pk_bf16_f32 v125, v125, v125
    v_lshlrev_b32 v125, 16, v125
    v_mul_f32 v18, 0xbfb8aa3b, v126
    v_exp_f32 v18, v18
    s_nop 0
    v_add_f32 v18, 1.0, v18
    v_rcp_f32 v18, v18
    s_nop 0
    v_mul_f32 v126, v126, v18
    v_cvt_pk_bf16_f32 v126, v126, v126
    v_lshlrev_b32 v126, 16, v126
    v_mul_f32 v18, 0xbfb8aa3b, v127
    v_exp_f32 v18, v18
    s_nop 0
    v_add_f32 v18, 1.0, v18
    v_rcp_f32 v18, v18
    s_nop 0
    v_mul_f32 v127, v127, v18
    v_cvt_pk_bf16_f32 v127, v127, v127
    v_lshlrev_b32 v127, 16, v127
    v_mov_b32 v96, 0
    v_mov_b32 v97, 0
    v_mov_b32 v98, 0
    v_mov_b32 v99, 0
    v_mov_b32 v100, 0
    v_mov_b32 v101, 0
    v_mov_b32 v102, 0
    v_mov_b32 v103, 0
    s_waitcnt vmcnt(15)
    v_lshlrev_b32 v18, 16, v32
    v_and_b32 v19, 0xffff0000, v32
    v_fmac_f32 v96, v18, v112
    v_fmac_f32 v97, v19, v112
    v_lshlrev_b32 v18, 16, v33
    v_and_b32 v19, 0xffff0000, v33
    v_fmac_f32 v98, v18, v112
    v_fmac_f32 v99, v19, v112
    v_lshlrev_b32 v18, 16, v34
    v_and_b32 v19, 0xffff0000, v34
    v_fmac_f32 v100, v18, v112
    v_fmac_f32 v101, v19, v112
    v_lshlrev_b32 v18, 16, v35
    v_and_b32 v19, 0xffff0000, v35
    v_fmac_f32 v102, v18, v112
    v_fmac_f32 v103, v19, v112
    s_waitcnt vmcnt(14)
    v_lshlrev_b32 v18, 16, v36
    v_and_b32 v19, 0xffff0000, v36
    v_fmac_f32 v96, v18, v113
    v_fmac_f32 v97, v19, v113
    v_lshlrev_b32 v18, 16, v37
    v_and_b32 v19, 0xffff0000, v37
    v_fmac_f32 v98, v18, v113
    v_fmac_f32 v99, v19, v113
    v_lshlrev_b32 v18, 16, v38
    v_and_b32 v19, 0xffff0000, v38
    v_fmac_f32 v100, v18, v113
    v_fmac_f32 v101, v19, v113
    v_lshlrev_b32 v18, 16, v39
    v_and_b32 v19, 0xffff0000, v39
    v_fmac_f32 v102, v18, v113
    v_fmac_f32 v103, v19, v113
    s_waitcnt vmcnt(13)
    v_lshlrev_b32 v18, 16, v40
    v_and_b32 v19, 0xffff0000, v40
    v_fmac_f32 v96, v18, v114
    v_fmac_f32 v97, v19, v114
    v_lshlrev_b32 v18, 16, v41
    v_and_b32 v19, 0xffff0000, v41
    v_fmac_f32 v98, v18, v114
    v_fmac_f32 v99, v19, v114
    v_lshlrev_b32 v18, 16, v42
    v_and_b32 v19, 0xffff0000, v42
    v_fmac_f32 v100, v18, v114
    v_fmac_f32 v101, v19, v114
    v_lshlrev_b32 v18, 16, v43
    v_and_b32 v19, 0xffff0000, v43
    v_fmac_f32 v102, v18, v114
    v_fmac_f32 v103, v19, v114
    s_waitcnt vmcnt(12)
    v_lshlrev_b32 v18, 16, v44
    v_and_b32 v19, 0xffff0000, v44
    v_fmac_f32 v96, v18, v115
    v_fmac_f32 v97, v19, v115
    v_lshlrev_b32 v18, 16, v45
    v_and_b32 v19, 0xffff0000, v45
    v_fmac_f32 v98, v18, v115
    v_fmac_f32 v99, v19, v115
    v_lshlrev_b32 v18, 16, v46
    v_and_b32 v19, 0xffff0000, v46
    v_fmac_f32 v100, v18, v115
    v_fmac_f32 v101, v19, v115
    v_lshlrev_b32 v18, 16, v47
    v_and_b32 v19, 0xffff0000, v47
    v_fmac_f32 v102, v18, v115
    v_fmac_f32 v103, v19, v115
    s_waitcnt vmcnt(11)
    v_lshlrev_b32 v18, 16, v48
    v_and_b32 v19, 0xffff0000, v48
    v_fmac_f32 v96, v18, v116
    v_fmac_f32 v97, v19, v116
    v_lshlrev_b32 v18, 16, v49
    v_and_b32 v19, 0xffff0000, v49
    v_fmac_f32 v98, v18, v116
    v_fmac_f32 v99, v19, v116
    v_lshlrev_b32 v18, 16, v50
    v_and_b32 v19, 0xffff0000, v50
    v_fmac_f32 v100, v18, v116
    v_fmac_f32 v101, v19, v116
    v_lshlrev_b32 v18, 16, v51
    v_and_b32 v19, 0xffff0000, v51
    v_fmac_f32 v102, v18, v116
    v_fmac_f32 v103, v19, v116
    s_waitcnt vmcnt(10)
    v_lshlrev_b32 v18, 16, v52
    v_and_b32 v19, 0xffff0000, v52
    v_fmac_f32 v96, v18, v117
    v_fmac_f32 v97, v19, v117
    v_lshlrev_b32 v18, 16, v53
    v_and_b32 v19, 0xffff0000, v53
    v_fmac_f32 v98, v18, v117
    v_fmac_f32 v99, v19, v117
    v_lshlrev_b32 v18, 16, v54
    v_and_b32 v19, 0xffff0000, v54
    v_fmac_f32 v100, v18, v117
    v_fmac_f32 v101, v19, v117
    v_lshlrev_b32 v18, 16, v55
    v_and_b32 v19, 0xffff0000, v55
    v_fmac_f32 v102, v18, v117
    v_fmac_f32 v103, v19, v117
    s_waitcnt vmcnt(9)
    v_lshlrev_b32 v18, 16, v56
    v_and_b32 v19, 0xffff0000, v56
    v_fmac_f32 v96, v18, v118
    v_fmac_f32 v97, v19, v118
    v_lshlrev_b32 v18, 16, v57
    v_and_b32 v19, 0xffff0000, v57
    v_fmac_f32 v98, v18, v118
    v_fmac_f32 v99, v19, v118
    v_lshlrev_b32 v18, 16, v58
    v_and_b32 v19, 0xffff0000, v58
    v_fmac_f32 v100, v18, v118
    v_fmac_f32 v101, v19, v118
    v_lshlrev_b32 v18, 16, v59
    v_and_b32 v19, 0xffff0000, v59
    v_fmac_f32 v102, v18, v118
    v_fmac_f32 v103, v19, v118
    s_waitcnt vmcnt(8)
    v_lshlrev_b32 v18, 16, v60
    v_and_b32 v19, 0xffff0000, v60
    v_fmac_f32 v96, v18, v119
    v_fmac_f32 v97, v19, v119
    v_lshlrev_b32 v18, 16, v61
    v_and_b32 v19, 0xffff0000, v61
    v_fmac_f32 v98, v18, v119
    v_fmac_f32 v99, v19, v119
    v_lshlrev_b32 v18, 16, v62
    v_and_b32 v19, 0xffff0000, v62
    v_fmac_f32 v100, v18, v119
    v_fmac_f32 v101, v19, v119
    v_lshlrev_b32 v18, 16, v63
    v_and_b32 v19, 0xffff0000, v63
    v_fmac_f32 v102, v18, v119
    v_fmac_f32 v103, v19, v119
    s_waitcnt vmcnt(7)
    v_lshlrev_b32 v18, 16, v64
    v_and_b32 v19, 0xffff0000, v64
    v_fmac_f32 v96, v18, v120
    v_fmac_f32 v97, v19, v120
    v_lshlrev_b32 v18, 16, v65
    v_and_b32 v19, 0xffff0000, v65
    v_fmac_f32 v98, v18, v120
    v_fmac_f32 v99, v19, v120
    v_lshlrev_b32 v18, 16, v66
    v_and_b32 v19, 0xffff0000, v66
    v_fmac_f32 v100, v18, v120
    v_fmac_f32 v101, v19, v120
    v_lshlrev_b32 v18, 16, v67
    v_and_b32 v19, 0xffff0000, v67
    v_fmac_f32 v102, v18, v120
    v_fmac_f32 v103, v19, v120
    s_waitcnt vmcnt(6)
    v_lshlrev_b32 v18, 16, v68
    v_and_b32 v19, 0xffff0000, v68
    v_fmac_f32 v96, v18, v121
    v_fmac_f32 v97, v19, v121
    v_lshlrev_b32 v18, 16, v69
    v_and_b32 v19, 0xffff0000, v69
    v_fmac_f32 v98, v18, v121
    v_fmac_f32 v99, v19, v121
    v_lshlrev_b32 v18, 16, v70
    v_and_b32 v19, 0xffff0000, v70
    v_fmac_f32 v100, v18, v121
    v_fmac_f32 v101, v19, v121
    v_lshlrev_b32 v18, 16, v71
    v_and_b32 v19, 0xffff0000, v71
    v_fmac_f32 v102, v18, v121
    v_fmac_f32 v103, v19, v121
    s_waitcnt vmcnt(5)
    v_lshlrev_b32 v18, 16, v72
    v_and_b32 v19, 0xffff0000, v72
    v_fmac_f32 v96, v18, v122
    v_fmac_f32 v97, v19, v122
    v_lshlrev_b32 v18, 16, v73
    v_and_b32 v19, 0xffff0000, v73
    v_fmac_f32 v98, v18, v122
    v_fmac_f32 v99, v19, v122
    v_lshlrev_b32 v18, 16, v74
    v_and_b32 v19, 0xffff0000, v74
    v_fmac_f32 v100, v18, v122
    v_fmac_f32 v101, v19, v122
    v_lshlrev_b32 v18, 16, v75
    v_and_b32 v19, 0xffff0000, v75
    v_fmac_f32 v102, v18, v122
    v_fmac_f32 v103, v19, v122
    s_waitcnt vmcnt(4)
    v_lshlrev_b32 v18, 16, v76
    v_and_b32 v19, 0xffff0000, v76
    v_fmac_f32 v96, v18, v123
    v_fmac_f32 v97, v19, v123
    v_lshlrev_b32 v18, 16, v77
    v_and_b32 v19, 0xffff0000, v77
    v_fmac_f32 v98, v18, v123
    v_fmac_f32 v99, v19, v123
    v_lshlrev_b32 v18, 16, v78
    v_and_b32 v19, 0xffff0000, v78
    v_fmac_f32 v100, v18, v123
    v_fmac_f32 v101, v19, v123
    v_lshlrev_b32 v18, 16, v79
    v_and_b32 v19, 0xffff0000, v79
    v_fmac_f32 v102, v18, v123
    v_fmac_f32 v103, v19, v123
    s_waitcnt vmcnt(3)
    v_lshlrev_b32 v18, 16, v80
    v_and_b32 v19, 0xffff0000, v80
    v_fmac_f32 v96, v18, v124
    v_fmac_f32 v97, v19, v124
    v_lshlrev_b32 v18, 16, v81
    v_and_b32 v19, 0xffff0000, v81
    v_fmac_f32 v98, v18, v124
    v_fmac_f32 v99, v19, v124
    v_lshlrev_b32 v18, 16, v82
    v_and_b32 v19, 0xffff0000, v82
    v_fmac_f32 v100, v18, v124
    v_fmac_f32 v101, v19, v124
    v_lshlrev_b32 v18, 16, v83
    v_and_b32 v19, 0xffff0000, v83
    v_fmac_f32 v102, v18, v124
    v_fmac_f32 v103, v19, v124
    s_waitcnt vmcnt(2)
    v_lshlrev_b32 v18, 16, v84
    v_and_b32 v19, 0xffff0000, v84
    v_fmac_f32 v96, v18, v125
    v_fmac_f32 v97, v19, v125
    v_lshlrev_b32 v18, 16, v85
    v_and_b32 v19, 0xffff0000, v85
    v_fmac_f32 v98, v18, v125
    v_fmac_f32 v99, v19, v125
    v_lshlrev_b32 v18, 16, v86
    v_and_b32 v19, 0xffff0000, v86
    v_fmac_f32 v100, v18, v125
    v_fmac_f32 v101, v19, v125
    v_lshlrev_b32 v18, 16, v87
    v_and_b32 v19, 0xffff0000, v87
    v_fmac_f32 v102, v18, v125
    v_fmac_f32 v103, v19, v125
    s_waitcnt vmcnt(1)
    v_lshlrev_b32 v18, 16, v88
    v_and_b32 v19, 0xffff0000, v88
    v_fmac_f32 v96, v18, v126
    v_fmac_f32 v97, v19, v126
    v_lshlrev_b32 v18, 16, v89
    v_and_b32 v19, 0xffff0000, v89
    v_fmac_f32 v98, v18, v126
    v_fmac_f32 v99, v19, v126
    v_lshlrev_b32 v18, 16, v90
    v_and_b32 v19, 0xffff0000, v90
    v_fmac_f32 v100, v18, v126
    v_fmac_f32 v101, v19, v126
    v_lshlrev_b32 v18, 16, v91
    v_and_b32 v19, 0xffff0000, v91
    v_fmac_f32 v102, v18, v126
    v_fmac_f32 v103, v19, v126
    s_waitcnt vmcnt(0)
    v_lshlrev_b32 v18, 16, v92
    v_and_b32 v19, 0xffff0000, v92
    v_fmac_f32 v96, v18, v127
    v_fmac_f32 v97, v19, v127
    v_lshlrev_b32 v18, 16, v93
    v_and_b32 v19, 0xffff0000, v93
    v_fmac_f32 v98, v18, v127
    v_fmac_f32 v99, v19, v127
    v_lshlrev_b32 v18, 16, v94
    v_and_b32 v19, 0xffff0000, v94
    v_fmac_f32 v100, v18, v127
    v_fmac_f32 v101, v19, v127
    v_lshlrev_b32 v18, 16, v95
    v_and_b32 v19, 0xffff0000, v95
    v_fmac_f32 v102, v18, v127
    v_fmac_f32 v103, v19, v127
    v_lshlrev_b32 v16, 5, v0
    ds_write_b128 v16, v[96:99]
    ds_write_b128 v16, v[100:103] offset:16
    s_waitcnt lgkmcnt(0)
    s_barrier
    s_cmp_lg_u32 s44, 0
    s_cbranch_scc1 L_mod_fin_110
    v_mov_b32 v18, 0
    ds_read_b32 v32, v12 offset:0
    ds_read_b32 v33, v12 offset:256
    ds_read_b32 v34, v12 offset:512
    ds_read_b32 v35, v12 offset:768
    ds_read_b32 v36, v12 offset:1024
    ds_read_b32 v37, v12 offset:1280
    ds_read_b32 v38, v12 offset:1536
    ds_read_b32 v39, v12 offset:1792
    ds_read_b32 v40, v12 offset:2048
    ds_read_b32 v41, v12 offset:2304
    ds_read_b32 v42, v12 offset:2560
    ds_read_b32 v43, v12 offset:2816
    ds_read_b32 v44, v12 offset:3072
    ds_read_b32 v45, v12 offset:3328
    ds_read_b32 v46, v12 offset:3584
    ds_read_b32 v47, v12 offset:3840
    s_waitcnt lgkmcnt(0)
    v_add_f32 v18, v18, v32
    v_add_f32 v18, v18, v33
    v_add_f32 v18, v18, v34
    v_add_f32 v18, v18, v35
    v_add_f32 v18, v18, v36
    v_add_f32 v18, v18, v37
    v_add_f32 v18, v18, v38
    v_add_f32 v18, v18, v39
    v_add_f32 v18, v18, v40
    v_add_f32 v18, v18, v41
    v_add_f32 v18, v18, v42
    v_add_f32 v18, v18, v43
    v_add_f32 v18, v18, v44
    v_add_f32 v18, v18, v45
    v_add_f32 v18, v18, v46
    v_add_f32 v18, v18, v47
    ds_read_b32 v32, v12 offset:4096
    ds_read_b32 v33, v12 offset:4352
    ds_read_b32 v34, v12 offset:4608
    ds_read_b32 v35, v12 offset:4864
    ds_read_b32 v36, v12 offset:5120
    ds_read_b32 v37, v12 offset:5376
    ds_read_b32 v38, v12 offset:5632
    ds_read_b32 v39, v12 offset:5888
    ds_read_b32 v40, v12 offset:6144
    ds_read_b32 v41, v12 offset:6400
    ds_read_b32 v42, v12 offset:6656
    ds_read_b32 v43, v12 offset:6912
    ds_read_b32 v44, v12 offset:7168
    ds_read_b32 v45, v12 offset:7424
    ds_read_b32 v46, v12 offset:7680
    ds_read_b32 v47, v12 offset:7936
    s_waitcnt lgkmcnt(0)
    v_add_f32 v18, v18, v32
    v_add_f32 v18, v18, v33
    v_add_f32 v18, v18, v34
    v_add_f32 v18, v18, v35
    v_add_f32 v18, v18, v36
    v_add_f32 v18, v18, v37
    v_add_f32 v18, v18, v38
    v_add_f32 v18, v18, v39
    v_add_f32 v18, v18, v40
    v_add_f32 v18, v18, v41
    v_add_f32 v18, v18, v42
    v_add_f32 v18, v18, v43
    v_add_f32 v18, v18, v44
    v_add_f32 v18, v18, v45
    v_add_f32 v18, v18, v46
    v_add_f32 v18, v18, v47
    s_lshr_b32 s45, s39, 1
    s_lshl_b32 s45, s45, 8
    s_mul_i32 s46, s47, 24576
    s_add_u32 s45, s45, s46
    buffer_store_dword v18, v12, s[12:15], s45 offen sc1
L_mod_fin_110:
    s_waitcnt vmcnt(0)
    s_barrier
    s_cmp_lg_u32 s44, 0
    s_cbranch_scc1 L_cnt_111
    v_mov_b32 v30, 1
    v_mov_b32 v31, 127232
    s_mov_b64 exec, 1
    buffer_atomic_add v30, v31, s[12:15], 0 offen sc1
    s_mov_b64 exec, -1
L_cnt_111:
    s_branch L_w_roles_98
L_w_kv_97:
    s_lshl_b32 s45, s43, 3
    s_add_u32 s45, s45, 16
    s_load_dwordx2 s[6:7], s[0:1], s45
    s_waitcnt lgkmcnt(0)
    s_mov_b32 s24, s6
    s_and_b32 s25, s7, 0xffff
    s_mov_b32 s26, 0x800000
    s_mov_b32 s27, 0x00020000
    s_lshl_b32 s46, s41, 8
    s_barrier
    v_lshrrev_b32 v20, 4, v1
    s_lshl_b32 s45, s44, 2
    v_add_u32 v21, s45, v20
    s_mov_b32 s45, 8192
    v_mul_lo_u32 v21, v21, s45
    v_lshlrev_b32 v22, 2, v20
    v_and_b32 v23, 15, v1
    v_xor_b32 v22, v22, v23
    v_lshlrev_b32 v22, 4, v22
    v_add_u32 v21, v21, v22
    v_bfe_u32 v22, v1, 2, 2
    v_lshlrev_b32 v23, 3, v20
    v_add_u32 v23, v23, v22
    v_lshlrev_b32 v23, 8, v23
    v_xor_b32 v22, s44, v22
    v_lshlrev_b32 v22, 6, v22
    v_add_u32 v23, v23, v22
    v_and_b32 v22, 3, v1
    v_lshlrev_b32 v22, 4, v22
    v_add_u32 v23, v23, v22
    v_add_u32 v24, 65536, v23
    v_add_u32 v25, 131072, v23
    s_lshl_b32 s47, s44, 10
    s_add_u32 s45, s46, 0x0
    s_add_u32 m0, s47, 0
    s_nop 0
    buffer_load_dwordx4 v21, s[24:27], s45 offen  lds
    s_add_u32 s45, s46, 0x20000
    s_add_u32 m0, s47, 4096
    s_nop 0
    buffer_load_dwordx4 v21, s[24:27], s45 offen  lds
    s_add_u32 s45, s46, 0x40000
    s_add_u32 m0, s47, 8192
    s_nop 0
    buffer_load_dwordx4 v21, s[24:27], s45 offen  lds
    s_add_u32 s45, s46, 0x60000
    s_add_u32 m0, s47, 12288
    s_nop 0
    buffer_load_dwordx4 v21, s[24:27], s45 offen  lds
    s_add_u32 s45, s46, 0x80000
    s_add_u32 m0, s47, 16384
    s_nop 0
    buffer_load_dwordx4 v21, s[24:27], s45 offen  lds
    s_add_u32 s45, s46, 0xa0000
    s_add_u32 m0, s47, 20480
    s_nop 0
    buffer_load_dwordx4 v21, s[24:27], s45 offen  lds
    s_add_u32 s45, s46, 0xc0000
    s_add_u32 m0, s47, 24576
    s_nop 0
    buffer_load_dwordx4 v21, s[24:27], s45 offen  lds
    s_add_u32 s45, s46, 0xe0000
    s_add_u32 m0, s47, 28672
    s_nop 0
    buffer_load_dwordx4 v21, s[24:27], s45 offen  lds
    s_add_u32 s45, s46, 0x100000
    s_add_u32 m0, s47, 32768
    s_nop 0
    buffer_load_dwordx4 v21, s[24:27], s45 offen  lds
    s_add_u32 s45, s46, 0x120000
    s_add_u32 m0, s47, 36864
    s_nop 0
    buffer_load_dwordx4 v21, s[24:27], s45 offen  lds
    s_add_u32 s45, s46, 0x140000
    s_add_u32 m0, s47, 40960
    s_nop 0
    buffer_load_dwordx4 v21, s[24:27], s45 offen  lds
    s_add_u32 s45, s46, 0x160000
    s_add_u32 m0, s47, 45056
    s_nop 0
    buffer_load_dwordx4 v21, s[24:27], s45 offen  lds
    s_add_u32 s45, s46, 0x180000
    s_add_u32 m0, s47, 49152
    s_nop 0
    buffer_load_dwordx4 v21, s[24:27], s45 offen  lds
    s_add_u32 s45, s46, 0x1a0000
    s_add_u32 m0, s47, 53248
    s_nop 0
    buffer_load_dwordx4 v21, s[24:27], s45 offen  lds
    s_add_u32 s45, s46, 0x1c0000
    s_add_u32 m0, s47, 57344
    s_nop 0
    buffer_load_dwordx4 v21, s[24:27], s45 offen  lds
    s_add_u32 s45, s46, 0x1e0000
    s_add_u32 m0, s47, 61440
    s_nop 0
    buffer_load_dwordx4 v21, s[24:27], s45 offen  lds
    s_add_u32 s45, s46, 0x200000
    s_add_u32 m0, s47, 65536
    s_nop 0
    buffer_load_dwordx4 v21, s[24:27], s45 offen  lds
    s_add_u32 s45, s46, 0x220000
    s_add_u32 m0, s47, 69632
    s_nop 0
    buffer_load_dwordx4 v21, s[24:27], s45 offen  lds
    s_add_u32 s45, s46, 0x240000
    s_add_u32 m0, s47, 73728
    s_nop 0
    buffer_load_dwordx4 v21, s[24:27], s45 offen  lds
    s_add_u32 s45, s46, 0x260000
    s_add_u32 m0, s47, 77824
    s_nop 0
    buffer_load_dwordx4 v21, s[24:27], s45 offen  lds
    s_add_u32 s45, s46, 0x280000
    s_add_u32 m0, s47, 81920
    s_nop 0
    buffer_load_dwordx4 v21, s[24:27], s45 offen  lds
    s_add_u32 s45, s46, 0x2a0000
    s_add_u32 m0, s47, 86016
    s_nop 0
    buffer_load_dwordx4 v21, s[24:27], s45 offen  lds
    s_add_u32 s45, s46, 0x2c0000
    s_add_u32 m0, s47, 90112
    s_nop 0
    buffer_load_dwordx4 v21, s[24:27], s45 offen  lds
    s_add_u32 s45, s46, 0x2e0000
    s_add_u32 m0, s47, 94208
    s_nop 0
    buffer_load_dwordx4 v21, s[24:27], s45 offen  lds
    s_add_u32 s45, s46, 0x300000
    s_add_u32 m0, s47, 98304
    s_nop 0
    buffer_load_dwordx4 v21, s[24:27], s45 offen  lds
    s_add_u32 s45, s46, 0x320000
    s_add_u32 m0, s47, 102400
    s_nop 0
    buffer_load_dwordx4 v21, s[24:27], s45 offen  lds
    s_add_u32 s45, s46, 0x340000
    s_add_u32 m0, s47, 106496
    s_nop 0
    buffer_load_dwordx4 v21, s[24:27], s45 offen  lds
    s_add_u32 s45, s46, 0x360000
    s_add_u32 m0, s47, 110592
    s_nop 0
    buffer_load_dwordx4 v21, s[24:27], s45 offen  lds
    s_add_u32 s45, s46, 0x380000
    s_add_u32 m0, s47, 114688
    s_nop 0
    buffer_load_dwordx4 v21, s[24:27], s45 offen  lds
    s_add_u32 s45, s46, 0x3a0000
    s_add_u32 m0, s47, 118784
    s_nop 0
    buffer_load_dwordx4 v21, s[24:27], s45 offen  lds
    s_add_u32 s45, s46, 0x3c0000
    s_add_u32 m0, s47, 122880
    s_nop 0
    buffer_load_dwordx4 v21, s[24:27], s45 offen  lds
    s_add_u32 s45, s46, 0x3e0000
    s_add_u32 m0, s47, 126976
    s_nop 0
    buffer_load_dwordx4 v21, s[24:27], s45 offen  lds
    s_waitcnt vmcnt(28)
    s_barrier
    s_add_u32 s45, s46, 0x400000
    s_add_u32 m0, s47, 131072
    s_nop 0
    buffer_load_dwordx4 v21, s[24:27], s45 offen  lds
    s_add_u32 s45, s46, 0x420000
    s_add_u32 m0, s47, 135168
    s_nop 0
    buffer_load_dwordx4 v21, s[24:27], s45 offen  lds
    s_add_u32 s45, s46, 0x440000
    s_add_u32 m0, s47, 139264
    s_nop 0
    buffer_load_dwordx4 v21, s[24:27], s45 offen  lds
    s_add_u32 s45, s46, 0x460000
    s_add_u32 m0, s47, 143360
    s_nop 0
    buffer_load_dwordx4 v21, s[24:27], s45 offen  lds
    ds_read_b64_tr_b16 a[0:1], v23 offset:0
    ds_read_b64_tr_b16 a[2:3], v23 offset:1024
    ds_read_b64_tr_b16 a[4:5], v23 offset:8
    ds_read_b64_tr_b16 a[6:7], v23 offset:1032
    ds_read_b64_tr_b16 a[8:9], v23 offset:8192
    ds_read_b64_tr_b16 a[10:11], v23 offset:9216
    ds_read_b64_tr_b16 a[12:13], v23 offset:8200
    ds_read_b64_tr_b16 a[14:15], v23 offset:9224
    s_waitcnt lgkmcnt(0)
    s_waitcnt vmcnt(28)
    s_barrier
    s_add_u32 s45, s46, 0x480000
    s_add_u32 m0, s47, 0
    s_nop 0
    buffer_load_dwordx4 v21, s[24:27], s45 offen  lds
    s_add_u32 s45, s46, 0x4a0000
    s_add_u32 m0, s47, 4096
    s_nop 0
    buffer_load_dwordx4 v21, s[24:27], s45 offen  lds
    s_add_u32 s45, s46, 0x4c0000
    s_add_u32 m0, s47, 8192
    s_nop 0
    buffer_load_dwordx4 v21, s[24:27], s45 offen  lds
    s_add_u32 s45, s46, 0x4e0000
    s_add_u32 m0, s47, 12288
    s_nop 0
    buffer_load_dwordx4 v21, s[24:27], s45 offen  lds
    ds_read_b64_tr_b16 a[16:17], v23 offset:16384
    ds_read_b64_tr_b16 a[18:19], v23 offset:17408
    ds_read_b64_tr_b16 a[20:21], v23 offset:16392
    ds_read_b64_tr_b16 a[22:23], v23 offset:17416
    ds_read_b64_tr_b16 a[24:25], v23 offset:24576
    ds_read_b64_tr_b16 a[26:27], v23 offset:25600
    ds_read_b64_tr_b16 a[28:29], v23 offset:24584
    ds_read_b64_tr_b16 a[30:31], v23 offset:25608
    s_waitcnt lgkmcnt(0)
    s_waitcnt vmcnt(28)
    s_barrier
    s_add_u32 s45, s46, 0x500000
    s_add_u32 m0, s47, 16384
    s_nop 0
    buffer_load_dwordx4 v21, s[24:27], s45 offen  lds
    s_add_u32 s45, s46, 0x520000
    s_add_u32 m0, s47, 20480
    s_nop 0
    buffer_load_dwordx4 v21, s[24:27], s45 offen  lds
    s_add_u32 s45, s46, 0x540000
    s_add_u32 m0, s47, 24576
    s_nop 0
    buffer_load_dwordx4 v21, s[24:27], s45 offen  lds
    s_add_u32 s45, s46, 0x560000
    s_add_u32 m0, s47, 28672
    s_nop 0
    buffer_load_dwordx4 v21, s[24:27], s45 offen  lds
    ds_read_b64_tr_b16 a[32:33], v23 offset:32768
    ds_read_b64_tr_b16 a[34:35], v23 offset:33792
    ds_read_b64_tr_b16 a[36:37], v23 offset:32776
    ds_read_b64_tr_b16 a[38:39], v23 offset:33800
    ds_read_b64_tr_b16 a[40:41], v23 offset:40960
    ds_read_b64_tr_b16 a[42:43], v23 offset:41984
    ds_read_b64_tr_b16 a[44:45], v23 offset:40968
    ds_read_b64_tr_b16 a[46:47], v23 offset:41992
    s_waitcnt lgkmcnt(0)
    s_waitcnt vmcnt(28)
    s_barrier
    s_add_u32 s45, s46, 0x580000
    s_add_u32 m0, s47, 32768
    s_nop 0
    buffer_load_dwordx4 v21, s[24:27], s45 offen  lds
    s_add_u32 s45, s46, 0x5a0000
    s_add_u32 m0, s47, 36864
    s_nop 0
    buffer_load_dwordx4 v21, s[24:27], s45 offen  lds
    s_add_u32 s45, s46, 0x5c0000
    s_add_u32 m0, s47, 40960
    s_nop 0
    buffer_load_dwordx4 v21, s[24:27], s45 offen  lds
    s_add_u32 s45, s46, 0x5e0000
    s_add_u32 m0, s47, 45056
    s_nop 0
    buffer_load_dwordx4 v21, s[24:27], s45 offen  lds
    ds_read_b64_tr_b16 a[48:49], v23 offset:49152
    ds_read_b64_tr_b16 a[50:51], v23 offset:50176
    ds_read_b64_tr_b16 a[52:53], v23 offset:49160
    ds_read_b64_tr_b16 a[54:55], v23 offset:50184
    ds_read_b64_tr_b16 a[56:57], v23 offset:57344
    ds_read_b64_tr_b16 a[58:59], v23 offset:58368
    ds_read_b64_tr_b16 a[60:61], v23 offset:57352
    ds_read_b64_tr_b16 a[62:63], v23 offset:58376
    s_waitcnt lgkmcnt(0)
    s_waitcnt vmcnt(28)
    s_barrier
    s_add_u32 s45, s46, 0x600000
    s_add_u32 m0, s47, 49152
    s_nop 0
    buffer_load_dwordx4 v21, s[24:27], s45 offen  lds
    s_add_u32 s45, s46, 0x620000
    s_add_u32 m0, s47, 53248
    s_nop 0
    buffer_load_dwordx4 v21, s[24:27], s45 offen  lds
    s_add_u32 s45, s46, 0x640000
    s_add_u32 m0, s47, 57344
    s_nop 0
    buffer_load_dwordx4 v21, s[24:27], s45 offen  lds
    s_add_u32 s45, s46, 0x660000
    s_add_u32 m0, s47, 61440
    s_nop 0
    buffer_load_dwordx4 v21, s[24:27], s45 offen  lds
    ds_read_b64_tr_b16 a[64:65], v24 offset:0
    ds_read_b64_tr_b16 a[66:67], v24 offset:1024
    ds_read_b64_tr_b16 a[68:69], v24 offset:8
    ds_read_b64_tr_b16 a[70:71], v24 offset:1032
    ds_read_b64_tr_b16 a[72:73], v24 offset:8192
    ds_read_b64_tr_b16 a[74:75], v24 offset:9216
    ds_read_b64_tr_b16 a[76:77], v24 offset:8200
    ds_read_b64_tr_b16 a[78:79], v24 offset:9224
    s_waitcnt lgkmcnt(0)
    s_waitcnt vmcnt(28)
    s_barrier
    s_add_u32 s45, s46, 0x680000
    s_add_u32 m0, s47, 65536
    s_nop 0
    buffer_load_dwordx4 v21, s[24:27], s45 offen  lds
    s_add_u32 s45, s46, 0x6a0000
    s_add_u32 m0, s47, 69632
    s_nop 0
    buffer_load_dwordx4 v21, s[24:27], s45 offen  lds
    s_add_u32 s45, s46, 0x6c0000
    s_add_u32 m0, s47, 73728
    s_nop 0
    buffer_load_dwordx4 v21, s[24:27], s45 offen  lds
    s_add_u32 s45, s46, 0x6e0000
    s_add_u32 m0, s47, 77824
    s_nop 0
    buffer_load_dwordx4 v21, s[24:27], s45 offen  lds
    ds_read_b64_tr_b16 a[80:81], v24 offset:16384
    ds_read_b64_tr_b16 a[82:83], v24 offset:17408
    ds_read_b64_tr_b16 a[84:85], v24 offset:16392
    ds_read_b64_tr_b16 a[86:87], v24 offset:17416
    ds_read_b64_tr_b16 a[88:89], v24 offset:24576
    ds_read_b64_tr_b16 a[90:91], v24 offset:25600
    ds_read_b64_tr_b16 a[92:93], v24 offset:24584
    ds_read_b64_tr_b16 a[94:95], v24 offset:25608
    s_waitcnt lgkmcnt(0)
    s_waitcnt vmcnt(28)
    s_barrier
    s_add_u32 s45, s46, 0x700000
    s_add_u32 m0, s47, 81920
    s_nop 0
    buffer_load_dwordx4 v21, s[24:27], s45 offen  lds
    s_add_u32 s45, s46, 0x720000
    s_add_u32 m0, s47, 86016
    s_nop 0
    buffer_load_dwordx4 v21, s[24:27], s45 offen  lds
    s_add_u32 s45, s46, 0x740000
    s_add_u32 m0, s47, 90112
    s_nop 0
    buffer_load_dwordx4 v21, s[24:27], s45 offen  lds
    s_add_u32 s45, s46, 0x760000
    s_add_u32 m0, s47, 94208
    s_nop 0
    buffer_load_dwordx4 v21, s[24:27], s45 offen  lds
    ds_read_b64_tr_b16 a[96:97], v24 offset:32768
    ds_read_b64_tr_b16 a[98:99], v24 offset:33792
    ds_read_b64_tr_b16 a[100:101], v24 offset:32776
    ds_read_b64_tr_b16 a[102:103], v24 offset:33800
    ds_read_b64_tr_b16 a[104:105], v24 offset:40960
    ds_read_b64_tr_b16 a[106:107], v24 offset:41984
    ds_read_b64_tr_b16 a[108:109], v24 offset:40968
    ds_read_b64_tr_b16 a[110:111], v24 offset:41992
    s_waitcnt lgkmcnt(0)
    s_waitcnt vmcnt(28)
    s_barrier
    s_add_u32 s45, s46, 0x780000
    s_add_u32 m0, s47, 98304
    s_nop 0
    buffer_load_dwordx4 v21, s[24:27], s45 offen  lds
    s_add_u32 s45, s46, 0x7a0000
    s_add_u32 m0, s47, 102400
    s_nop 0
    buffer_load_dwordx4 v21, s[24:27], s45 offen  lds
    s_add_u32 s45, s46, 0x7c0000
    s_add_u32 m0, s47, 106496
    s_nop 0
    buffer_load_dwordx4 v21, s[24:27], s45 offen  lds
    s_add_u32 s45, s46, 0x7e0000
    s_add_u32 m0, s47, 110592
    s_nop 0
    buffer_load_dwordx4 v21, s[24:27], s45 offen  lds
    ds_read_b64_tr_b16 a[112:113], v24 offset:49152
    ds_read_b64_tr_b16 a[114:115], v24 offset:50176
    ds_read_b64_tr_b16 a[116:117], v24 offset:49160
    ds_read_b64_tr_b16 a[118:119], v24 offset:50184
    ds_read_b64_tr_b16 a[120:121], v24 offset:57344
    ds_read_b64_tr_b16 a[122:123], v24 offset:58368
    ds_read_b64_tr_b16 a[124:125], v24 offset:57352
    ds_read_b64_tr_b16 a[126:127], v24 offset:58376
    s_waitcnt lgkmcnt(0)
    s_waitcnt vmcnt(28)
    s_barrier
    ds_read_b64_tr_b16 a[128:129], v25 offset:0
    ds_read_b64_tr_b16 a[130:131], v25 offset:1024
    ds_read_b64_tr_b16 a[132:133], v25 offset:8
    ds_read_b64_tr_b16 a[134:135], v25 offset:1032
    ds_read_b64_tr_b16 a[136:137], v25 offset:8192
    ds_read_b64_tr_b16 a[138:139], v25 offset:9216
    ds_read_b64_tr_b16 a[140:141], v25 offset:8200
    ds_read_b64_tr_b16 a[142:143], v25 offset:9224
    s_waitcnt lgkmcnt(0)
    s_waitcnt vmcnt(24)
    s_barrier
    ds_read_b64_tr_b16 a[144:145], v23 offset:0
    ds_read_b64_tr_b16 a[146:147], v23 offset:1024
    ds_read_b64_tr_b16 a[148:149], v23 offset:8
    ds_read_b64_tr_b16 a[150:151], v23 offset:1032
    ds_read_b64_tr_b16 a[152:153], v23 offset:8192
    ds_read_b64_tr_b16 a[154:155], v23 offset:9216
    ds_read_b64_tr_b16 a[156:157], v23 offset:8200
    ds_read_b64_tr_b16 a[158:159], v23 offset:9224
    s_waitcnt lgkmcnt(0)
    s_waitcnt vmcnt(20)
    s_barrier
    ds_read_b64_tr_b16 a[160:161], v23 offset:16384
    ds_read_b64_tr_b16 a[162:163], v23 offset:17408
    ds_read_b64_tr_b16 a[164:165], v23 offset:16392
    ds_read_b64_tr_b16 a[166:167], v23 offset:17416
    ds_read_b64_tr_b16 a[168:169], v23 offset:24576
    ds_read_b64_tr_b16 a[170:171], v23 offset:25600
    ds_read_b64_tr_b16 a[172:173], v23 offset:24584
    ds_read_b64_tr_b16 a[174:175], v23 offset:25608
    s_waitcnt lgkmcnt(0)
    s_waitcnt vmcnt(16)
    s_barrier
    ds_read_b64_tr_b16 a[176:177], v23 offset:32768
    ds_read_b64_tr_b16 a[178:179], v23 offset:33792
    ds_read_b64_tr_b16 a[180:181], v23 offset:32776
    ds_read_b64_tr_b16 a[182:183], v23 offset:33800
    ds_read_b64_tr_b16 a[184:185], v23 offset:40960
    ds_read_b64_tr_b16 a[186:187], v23 offset:41984
    ds_read_b64_tr_b16 a[188:189], v23 offset:40968
    ds_read_b64_tr_b16 a[190:191], v23 offset:41992
    s_waitcnt lgkmcnt(0)
    s_waitcnt vmcnt(12)
    s_barrier
    ds_read_b64_tr_b16 a[192:193], v23 offset:49152
    ds_read_b64_tr_b16 a[194:195], v23 offset:50176
    ds_read_b64_tr_b16 a[196:197], v23 offset:49160
    ds_read_b64_tr_b16 a[198:199], v23 offset:50184
    ds_read_b64_tr_b16 a[200:201], v23 offset:57344
    ds_read_b64_tr_b16 a[202:203], v23 offset:58368
    ds_read_b64_tr_b16 a[204:205], v23 offset:57352
    ds_read_b64_tr_b16 a[206:207], v23 offset:58376
    s_waitcnt lgkmcnt(0)
    s_waitcnt vmcnt(8)
    s_barrier
    ds_read_b64_tr_b16 a[208:209], v24 offset:0
    ds_read_b64_tr_b16 a[210:211], v24 offset:1024
    ds_read_b64_tr_b16 a[212:213], v24 offset:8
    ds_read_b64_tr_b16 a[214:215], v24 offset:1032
    ds_read_b64_tr_b16 a[216:217], v24 offset:8192
    ds_read_b64_tr_b16 a[218:219], v24 offset:9216
    ds_read_b64_tr_b16 a[220:221], v24 offset:8200
    ds_read_b64_tr_b16 a[222:223], v24 offset:9224
    s_waitcnt lgkmcnt(0)
    s_waitcnt vmcnt(4)
    s_barrier
    ds_read_b64_tr_b16 a[224:225], v24 offset:16384
    ds_read_b64_tr_b16 a[226:227], v24 offset:17408
    ds_read_b64_tr_b16 a[228:229], v24 offset:16392
    ds_read_b64_tr_b16 a[230:231], v24 offset:17416
    ds_read_b64_tr_b16 a[232:233], v24 offset:24576
    ds_read_b64_tr_b16 a[234:235], v24 offset:25600
    ds_read_b64_tr_b16 a[236:237], v24 offset:24584
    ds_read_b64_tr_b16 a[238:239], v24 offset:25608
    s_waitcnt lgkmcnt(0)
    s_waitcnt vmcnt(0)
    s_barrier
    ds_read_b64_tr_b16 a[240:241], v24 offset:32768
    ds_read_b64_tr_b16 a[242:243], v24 offset:33792
    ds_read_b64_tr_b16 a[244:245], v24 offset:32776
    ds_read_b64_tr_b16 a[246:247], v24 offset:33800
    ds_read_b64_tr_b16 a[248:249], v24 offset:40960
    ds_read_b64_tr_b16 a[250:251], v24 offset:41984
    ds_read_b64_tr_b16 a[252:253], v24 offset:40968
    ds_read_b64_tr_b16 a[254:255], v24 offset:41992
    s_waitcnt lgkmcnt(0)
    s_barrier
    s_cmp_lg_u32 s44, 0
    s_cbranch_scc1 L_pd_112
    v_mov_b32 v29, 8
    s_mov_b32 s46, 32
    s_mov_b64 exec, 1
    s_mov_b32 s70, 0
L_wp_113:
    buffer_load_dword v31, v29, s[16:19], 0 offen sc1
    s_add_u32 s70, s70, 1
    s_cmp_ge_u32 s70, 0x200000
    s_cbranch_scc1 L_w_done_96
    s_waitcnt vmcnt(0)
    v_cmp_gt_u32 vcc, s46, v31
    s_nop 1
    s_cbranch_vccz L_wp_113_ok
    s_sleep 3
    s_branch L_wp_113
L_wp_113_ok:
    s_mov_b64 exec, -1
L_pd_112:
    s_barrier
    s_mov_b32 s60, 0
    s_mov_b32 s51, 1
    s_mov_b32 s71, 126976
    s_mov_b32 s52, 0x400000
    s_lshl_b32 s56, s39, 19
    s_add_u32 s56, s56, 0x2000000
L_w_qkv_114:
    s_cmp_lg_u32 s44, 0
    s_cbranch_scc1 L_pd_115
    v_mov_b32 v29, s71
    s_mov_b32 s46, 96
    s_mov_b64 exec, 1
    s_mov_b32 s70, 0
L_wp_116:
    buffer_load_dword v31, v29, s[12:15], 0 offen sc1
    s_add_u32 s70, s70, 1
    s_cmp_ge_u32 s70, 0x200000
    s_cbranch_scc1 L_w_done_96
    s_waitcnt vmcnt(0)
    v_cmp_gt_u32 vcc, s46, v31
    s_nop 1
    s_cbranch_vccz L_wp_116_ok
    s_sleep 2
    s_branch L_wp_116
L_wp_116_ok:
    s_mov_b64 exec, -1
L_pd_115:
    s_barrier
L_w_qkv_114_n:
    s_mov_b32 s50, s60
    s_mul_i32 s53, s50, 65536
    s_add_u32 s53, s53, s52
    s_lshl_b32 s54, s44, 13
    s_add_u32 s53, s53, s54
    s_mul_i32 s57, s50, 8192
    s_add_u32 s57, s57, s56
    s_lshl_b32 s45, s44, 11
    s_add_u32 s57, s57, s45
    s_add_u32 s55, s54, 65536
    s_mov_b32 s58, 0
    v_mov_b32 v13, v3
    v_add_u32 v14, 65536, v13
    v_xor_b32 v15, 64, v13
    v_xor_b32 v16, 64, v14
    s_mov_b32 s76, 0x20000000
    s_add_u32 s48, s53, 0
    s_add_u32 s49, s48, 4096
    s_add_u32 m0, s54, 0
    s_nop 0
    buffer_load_dwordx4 v6, s[12:15], s48 offen offset:0 sc1 lds
    s_add_u32 m0, s54, 1024
    s_nop 0
    buffer_load_dwordx4 v9, s[12:15], s48 offen offset:0 sc1 lds
    s_add_u32 m0, s54, 2048
    s_nop 0
    buffer_load_dwordx4 v6, s[12:15], s49 offen offset:0 sc1 lds
    s_add_u32 m0, s54, 3072
    s_nop 0
    buffer_load_dwordx4 v9, s[12:15], s49 offen offset:0 sc1 lds
    s_add_u32 m0, s54, 3968
    s_nop 0
    buffer_load_dwordx4 v6, s[12:15], s48 offen offset:128 sc1 lds
    s_add_u32 m0, s54, 4992
    s_nop 0
    buffer_load_dwordx4 v9, s[12:15], s48 offen offset:128 sc1 lds
    s_add_u32 m0, s54, 6016
    s_nop 0
    buffer_load_dwordx4 v6, s[12:15], s49 offen offset:128 sc1 lds
    s_add_u32 m0, s54, 7040
    s_nop 0
    buffer_load_dwordx4 v9, s[12:15], s49 offen offset:128 sc1 lds
    s_add_u32 s48, s53, 32768
    s_add_u32 s49, s48, 4096
    s_add_u32 s46, s54, 32768
    s_add_u32 m0, s46, 0
    s_nop 0
    buffer_load_dwordx4 v6, s[12:15], s48 offen offset:0 sc1 lds
    s_add_u32 m0, s46, 1024
    s_nop 0
    buffer_load_dwordx4 v9, s[12:15], s48 offen offset:0 sc1 lds
    s_add_u32 m0, s46, 2048
    s_nop 0
    buffer_load_dwordx4 v6, s[12:15], s49 offen offset:0 sc1 lds
    s_add_u32 m0, s46, 3072
    s_nop 0
    buffer_load_dwordx4 v9, s[12:15], s49 offen offset:0 sc1 lds
    s_add_u32 m0, s46, 3968
    s_nop 0
    buffer_load_dwordx4 v6, s[12:15], s48 offen offset:128 sc1 lds
    s_add_u32 m0, s46, 4992
    s_nop 0
    buffer_load_dwordx4 v9, s[12:15], s48 offen offset:128 sc1 lds
    s_add_u32 m0, s46, 6016
    s_nop 0
    buffer_load_dwordx4 v6, s[12:15], s49 offen offset:128 sc1 lds
    s_add_u32 m0, s46, 7040
    s_nop 0
    buffer_load_dwordx4 v9, s[12:15], s49 offen offset:128 sc1 lds
    s_cmp_eq_u32 s51, 1
    s_cbranch_scc1 L_e_one_118
    s_add_u32 s48, s53, 65536
    s_add_u32 s49, s48, 4096
    s_add_u32 m0, s55, 0
    s_nop 0
    buffer_load_dwordx4 v6, s[12:15], s48 offen offset:0 sc1 lds
    s_add_u32 m0, s55, 1024
    s_nop 0
    buffer_load_dwordx4 v9, s[12:15], s48 offen offset:0 sc1 lds
    s_add_u32 m0, s55, 2048
    s_nop 0
    buffer_load_dwordx4 v6, s[12:15], s49 offen offset:0 sc1 lds
    s_add_u32 m0, s55, 3072
    s_nop 0
    buffer_load_dwordx4 v9, s[12:15], s49 offen offset:0 sc1 lds
    s_add_u32 m0, s55, 3968
    s_nop 0
    buffer_load_dwordx4 v6, s[12:15], s48 offen offset:128 sc1 lds
    s_add_u32 m0, s55, 4992
    s_nop 0
    buffer_load_dwordx4 v9, s[12:15], s48 offen offset:128 sc1 lds
    s_add_u32 m0, s55, 6016
    s_nop 0
    buffer_load_dwordx4 v6, s[12:15], s49 offen offset:128 sc1 lds
    s_add_u32 m0, s55, 7040
    s_nop 0
    buffer_load_dwordx4 v9, s[12:15], s49 offen offset:128 sc1 lds
    s_waitcnt vmcnt(16)
    s_barrier
    ds_read_b128 v[32:35], v13 offset:0
    ds_read_b128 v[36:39], v13 offset:2048
    ds_read_b128 v[40:43], v15 offset:0
    ds_read_b128 v[44:47], v15 offset:2048
L_e_loop_117:
    s_add_u32 s48, s53, 98304
    s_add_u32 s46, s58, 1
    s_cmp_lt_u32 s46, s51
    s_cselect_b32 s48, s48, 0x20000000
    s_add_u32 s49, s48, 4096
    s_add_u32 s59, s55, 32768
    s_waitcnt lgkmcnt(2)
    v_mfma_f32_16x16x32_bf16 v[80:83], a[0:3], v[32:35], 0
    ds_read_b128 v[48:51], v13 offset:4096
    ds_read_b128 v[52:55], v13 offset:6144
    v_mfma_f32_16x16x32_bf16 v[84:87], a[4:7], v[32:35], 0
    ds_read_b128 v[56:59], v15 offset:4096
    ds_read_b128 v[60:63], v15 offset:6144
    v_mfma_f32_16x16x32_bf16 v[88:91], a[0:3], v[36:39], 0
    s_add_u32 m0, s59, 0
    s_nop 0
    buffer_load_dwordx4 v6, s[12:15], s48 offen offset:0 sc1 lds
    v_mfma_f32_16x16x32_bf16 v[92:95], a[4:7], v[36:39], 0
    s_waitcnt lgkmcnt(4)
    v_mfma_f32_16x16x32_bf16 v[80:83], a[8:11], v[40:43], v[80:83]
    ds_read_b128 v[32:35], v13 offset:8192
    ds_read_b128 v[36:39], v13 offset:10240
    v_mfma_f32_16x16x32_bf16 v[84:87], a[12:15], v[40:43], v[84:87]
    v_mfma_f32_16x16x32_bf16 v[88:91], a[8:11], v[44:47], v[88:91]
    s_add_u32 m0, s59, 1024
    s_nop 0
    buffer_load_dwordx4 v9, s[12:15], s48 offen offset:0 sc1 lds
    v_mfma_f32_16x16x32_bf16 v[92:95], a[12:15], v[44:47], v[92:95]
    s_waitcnt lgkmcnt(4)
    v_mfma_f32_16x16x32_bf16 v[80:83], a[16:19], v[48:51], v[80:83]
    ds_read_b128 v[40:43], v15 offset:8192
    ds_read_b128 v[44:47], v15 offset:10240
    v_mfma_f32_16x16x32_bf16 v[84:87], a[20:23], v[48:51], v[84:87]
    v_mfma_f32_16x16x32_bf16 v[88:91], a[16:19], v[52:55], v[88:91]
    s_add_u32 m0, s59, 2048
    s_nop 0
    buffer_load_dwordx4 v6, s[12:15], s49 offen offset:0 sc1 lds
    v_mfma_f32_16x16x32_bf16 v[92:95], a[20:23], v[52:55], v[92:95]
    s_waitcnt lgkmcnt(4)
    v_mfma_f32_16x16x32_bf16 v[80:83], a[24:27], v[56:59], v[80:83]
    ds_read_b128 v[48:51], v13 offset:12288
    ds_read_b128 v[52:55], v13 offset:14336
    v_mfma_f32_16x16x32_bf16 v[84:87], a[28:31], v[56:59], v[84:87]
    v_mfma_f32_16x16x32_bf16 v[88:91], a[24:27], v[60:63], v[88:91]
    s_add_u32 m0, s59, 3072
    s_nop 0
    buffer_load_dwordx4 v9, s[12:15], s49 offen offset:0 sc1 lds
    v_mfma_f32_16x16x32_bf16 v[92:95], a[28:31], v[60:63], v[92:95]
    s_waitcnt lgkmcnt(4)
    v_mfma_f32_16x16x32_bf16 v[80:83], a[32:35], v[32:35], v[80:83]
    ds_read_b128 v[56:59], v15 offset:12288
    ds_read_b128 v[60:63], v15 offset:14336
    v_mfma_f32_16x16x32_bf16 v[84:87], a[36:39], v[32:35], v[84:87]
    v_mfma_f32_16x16x32_bf16 v[88:91], a[32:35], v[36:39], v[88:91]
    s_add_u32 m0, s59, 3968
    s_nop 0
    buffer_load_dwordx4 v6, s[12:15], s48 offen offset:128 sc1 lds
    v_mfma_f32_16x16x32_bf16 v[92:95], a[36:39], v[36:39], v[92:95]
    s_waitcnt lgkmcnt(4)
    v_mfma_f32_16x16x32_bf16 v[80:83], a[40:43], v[40:43], v[80:83]
    ds_read_b128 v[32:35], v13 offset:16384
    ds_read_b128 v[36:39], v13 offset:18432
    v_mfma_f32_16x16x32_bf16 v[84:87], a[44:47], v[40:43], v[84:87]
    v_mfma_f32_16x16x32_bf16 v[88:91], a[40:43], v[44:47], v[88:91]
    s_add_u32 m0, s59, 4992
    s_nop 0
    buffer_load_dwordx4 v9, s[12:15], s48 offen offset:128 sc1 lds
    v_mfma_f32_16x16x32_bf16 v[92:95], a[44:47], v[44:47], v[92:95]
    s_waitcnt lgkmcnt(4)
    v_mfma_f32_16x16x32_bf16 v[80:83], a[48:51], v[48:51], v[80:83]
    ds_read_b128 v[40:43], v15 offset:16384
    ds_read_b128 v[44:47], v15 offset:18432
    v_mfma_f32_16x16x32_bf16 v[84:87], a[52:55], v[48:51], v[84:87]
    v_mfma_f32_16x16x32_bf16 v[88:91], a[48:51], v[52:55], v[88:91]
    s_add_u32 m0, s59, 6016
    s_nop 0
    buffer_load_dwordx4 v6, s[12:15], s49 offen offset:128 sc1 lds
    v_mfma_f32_16x16x32_bf16 v[92:95], a[52:55], v[52:55], v[92:95]
    s_waitcnt lgkmcnt(4)
    v_mfma_f32_16x16x32_bf16 v[80:83], a[56:59], v[56:59], v[80:83]
    ds_read_b128 v[48:51], v13 offset:20480
    ds_read_b128 v[52:55], v13 offset:22528
    v_mfma_f32_16x16x32_bf16 v[84:87], a[60:63], v[56:59], v[84:87]
    v_mfma_f32_16x16x32_bf16 v[88:91], a[56:59], v[60:63], v[88:91]
    s_add_u32 m0, s59, 7040
    s_nop 0
    buffer_load_dwordx4 v9, s[12:15], s49 offen offset:128 sc1 lds
    v_mfma_f32_16x16x32_bf16 v[92:95], a[60:63], v[60:63], v[92:95]
    s_waitcnt lgkmcnt(4)
    v_mfma_f32_16x16x32_bf16 v[80:83], a[64:67], v[32:35], v[80:83]
    ds_read_b128 v[56:59], v15 offset:20480
    ds_read_b128 v[60:63], v15 offset:22528
    v_mfma_f32_16x16x32_bf16 v[84:87], a[68:71], v[32:35], v[84:87]
    v_mfma_f32_16x16x32_bf16 v[88:91], a[64:67], v[36:39], v[88:91]
    v_mfma_f32_16x16x32_bf16 v[92:95], a[68:71], v[36:39], v[92:95]
    s_waitcnt lgkmcnt(4)
    v_mfma_f32_16x16x32_bf16 v[80:83], a[72:75], v[40:43], v[80:83]
    ds_read_b128 v[32:35], v13 offset:24576
    ds_read_b128 v[36:39], v13 offset:26624
    v_mfma_f32_16x16x32_bf16 v[84:87], a[76:79], v[40:43], v[84:87]
    v_mfma_f32_16x16x32_bf16 v[88:91], a[72:75], v[44:47], v[88:91]
    v_mfma_f32_16x16x32_bf16 v[92:95], a[76:79], v[44:47], v[92:95]
    s_waitcnt lgkmcnt(4)
    v_mfma_f32_16x16x32_bf16 v[80:83], a[80:83], v[48:51], v[80:83]
    ds_read_b128 v[40:43], v15 offset:24576
    ds_read_b128 v[44:47], v15 offset:26624
    v_mfma_f32_16x16x32_bf16 v[84:87], a[84:87], v[48:51], v[84:87]
    v_mfma_f32_16x16x32_bf16 v[88:91], a[80:83], v[52:55], v[88:91]
    v_mfma_f32_16x16x32_bf16 v[92:95], a[84:87], v[52:55], v[92:95]
    s_waitcnt lgkmcnt(4)
    v_mfma_f32_16x16x32_bf16 v[80:83], a[88:91], v[56:59], v[80:83]
    ds_read_b128 v[48:51], v13 offset:28672
    ds_read_b128 v[52:55], v13 offset:30720
    v_mfma_f32_16x16x32_bf16 v[84:87], a[92:95], v[56:59], v[84:87]
    v_mfma_f32_16x16x32_bf16 v[88:91], a[88:91], v[60:63], v[88:91]
    v_mfma_f32_16x16x32_bf16 v[92:95], a[92:95], v[60:63], v[92:95]
    s_waitcnt lgkmcnt(4)
    v_mfma_f32_16x16x32_bf16 v[80:83], a[96:99], v[32:35], v[80:83]
    ds_read_b128 v[56:59], v15 offset:28672
    ds_read_b128 v[60:63], v15 offset:30720
    v_mfma_f32_16x16x32_bf16 v[84:87], a[100:103], v[32:35], v[84:87]
    v_mfma_f32_16x16x32_bf16 v[88:91], a[96:99], v[36:39], v[88:91]
    v_mfma_f32_16x16x32_bf16 v[92:95], a[100:103], v[36:39], v[92:95]
    s_waitcnt lgkmcnt(4)
    v_mfma_f32_16x16x32_bf16 v[80:83], a[104:107], v[40:43], v[80:83]
    v_mfma_f32_16x16x32_bf16 v[84:87], a[108:111], v[40:43], v[84:87]
    v_mfma_f32_16x16x32_bf16 v[88:91], a[104:107], v[44:47], v[88:91]
    v_mfma_f32_16x16x32_bf16 v[92:95], a[108:111], v[44:47], v[92:95]
    s_waitcnt vmcnt(16) lgkmcnt(0)
    s_barrier
    v_mfma_f32_16x16x32_bf16 v[80:83], a[112:115], v[48:51], v[80:83]
    ds_read_b128 v[32:35], v13 offset:32768
    ds_read_b128 v[36:39], v13 offset:34816
    v_mfma_f32_16x16x32_bf16 v[84:87], a[116:119], v[48:51], v[84:87]
    v_mfma_f32_16x16x32_bf16 v[88:91], a[112:115], v[52:55], v[88:91]
    v_mfma_f32_16x16x32_bf16 v[92:95], a[116:119], v[52:55], v[92:95]
    v_mfma_f32_16x16x32_bf16 v[80:83], a[120:123], v[56:59], v[80:83]
    ds_read_b128 v[40:43], v15 offset:32768
    ds_read_b128 v[44:47], v15 offset:34816
    v_mfma_f32_16x16x32_bf16 v[84:87], a[124:127], v[56:59], v[84:87]
    v_mfma_f32_16x16x32_bf16 v[88:91], a[120:123], v[60:63], v[88:91]
    v_mfma_f32_16x16x32_bf16 v[92:95], a[124:127], v[60:63], v[92:95]
    s_add_u32 s48, s53, 131072
    s_add_u32 s46, s58, 2
    s_cmp_lt_u32 s46, s51
    s_cselect_b32 s48, s48, 0x20000000
    s_add_u32 s49, s48, 4096
    s_mov_b32 s59, s54
    s_waitcnt lgkmcnt(2)
    v_mfma_f32_16x16x32_bf16 v[80:83], a[128:131], v[32:35], v[80:83]
    ds_read_b128 v[48:51], v13 offset:36864
    ds_read_b128 v[52:55], v13 offset:38912
    v_mfma_f32_16x16x32_bf16 v[84:87], a[132:135], v[32:35], v[84:87]
    ds_read_b128 v[56:59], v15 offset:36864
    ds_read_b128 v[60:63], v15 offset:38912
    v_mfma_f32_16x16x32_bf16 v[88:91], a[128:131], v[36:39], v[88:91]
    s_add_u32 m0, s59, 0
    s_nop 0
    buffer_load_dwordx4 v6, s[12:15], s48 offen offset:0 sc1 lds
    v_mfma_f32_16x16x32_bf16 v[92:95], a[132:135], v[36:39], v[92:95]
    s_waitcnt lgkmcnt(4)
    v_mfma_f32_16x16x32_bf16 v[80:83], a[136:139], v[40:43], v[80:83]
    ds_read_b128 v[32:35], v13 offset:40960
    ds_read_b128 v[36:39], v13 offset:43008
    v_mfma_f32_16x16x32_bf16 v[84:87], a[140:143], v[40:43], v[84:87]
    v_mfma_f32_16x16x32_bf16 v[88:91], a[136:139], v[44:47], v[88:91]
    s_add_u32 m0, s59, 1024
    s_nop 0
    buffer_load_dwordx4 v9, s[12:15], s48 offen offset:0 sc1 lds
    v_mfma_f32_16x16x32_bf16 v[92:95], a[140:143], v[44:47], v[92:95]
    s_waitcnt lgkmcnt(4)
    v_mfma_f32_16x16x32_bf16 v[80:83], a[144:147], v[48:51], v[80:83]
    ds_read_b128 v[40:43], v15 offset:40960
    ds_read_b128 v[44:47], v15 offset:43008
    v_mfma_f32_16x16x32_bf16 v[84:87], a[148:151], v[48:51], v[84:87]
    v_mfma_f32_16x16x32_bf16 v[88:91], a[144:147], v[52:55], v[88:91]
    s_add_u32 m0, s59, 2048
    s_nop 0
    buffer_load_dwordx4 v6, s[12:15], s49 offen offset:0 sc1 lds
    v_mfma_f32_16x16x32_bf16 v[92:95], a[148:151], v[52:55], v[92:95]
    s_waitcnt lgkmcnt(4)
    v_mfma_f32_16x16x32_bf16 v[80:83], a[152:155], v[56:59], v[80:83]
    ds_read_b128 v[48:51], v13 offset:45056
    ds_read_b128 v[52:55], v13 offset:47104
    v_mfma_f32_16x16x32_bf16 v[84:87], a[156:159], v[56:59], v[84:87]
    v_mfma_f32_16x16x32_bf16 v[88:91], a[152:155], v[60:63], v[88:91]
    s_add_u32 m0, s59, 3072
    s_nop 0
    buffer_load_dwordx4 v9, s[12:15], s49 offen offset:0 sc1 lds
    v_mfma_f32_16x16x32_bf16 v[92:95], a[156:159], v[60:63], v[92:95]
    s_waitcnt lgkmcnt(4)
    v_mfma_f32_16x16x32_bf16 v[80:83], a[160:163], v[32:35], v[80:83]
    ds_read_b128 v[56:59], v15 offset:45056
    ds_read_b128 v[60:63], v15 offset:47104
    v_mfma_f32_16x16x32_bf16 v[84:87], a[164:167], v[32:35], v[84:87]
    v_mfma_f32_16x16x32_bf16 v[88:91], a[160:163], v[36:39], v[88:91]
    s_add_u32 m0, s59, 3968
    s_nop 0
    buffer_load_dwordx4 v6, s[12:15], s48 offen offset:128 sc1 lds
    v_mfma_f32_16x16x32_bf16 v[92:95], a[164:167], v[36:39], v[92:95]
    s_waitcnt lgkmcnt(4)
    v_mfma_f32_16x16x32_bf16 v[80:83], a[168:171], v[40:43], v[80:83]
    ds_read_b128 v[32:35], v13 offset:49152
    ds_read_b128 v[36:39], v13 offset:51200
    v_mfma_f32_16x16x32_bf16 v[84:87], a[172:175], v[40:43], v[84:87]
    v_mfma_f32_16x16x32_bf16 v[88:91], a[168:171], v[44:47], v[88:91]
    s_add_u32 m0, s59, 4992
    s_nop 0
    buffer_load_dwordx4 v9, s[12:15], s48 offen offset:128 sc1 lds
    v_mfma_f32_16x16x32_bf16 v[92:95], a[172:175], v[44:47], v[92:95]
    s_waitcnt lgkmcnt(4)
    v_mfma_f32_16x16x32_bf16 v[80:83], a[176:179], v[48:51], v[80:83]
    ds_read_b128 v[40:43], v15 offset:49152
    ds_read_b128 v[44:47], v15 offset:51200
    v_mfma_f32_16x16x32_bf16 v[84:87], a[180:183], v[48:51], v[84:87]
    v_mfma_f32_16x16x32_bf16 v[88:91], a[176:179], v[52:55], v[88:91]
    s_add_u32 m0, s59, 6016
    s_nop 0
    buffer_load_dwordx4 v6, s[12:15], s49 offen offset:128 sc1 lds
    v_mfma_f32_16x16x32_bf16 v[92:95], a[180:183], v[52:55], v[92:95]
    s_waitcnt lgkmcnt(4)
    v_mfma_f32_16x16x32_bf16 v[80:83], a[184:187], v[56:59], v[80:83]
    ds_read_b128 v[48:51], v13 offset:53248
    ds_read_b128 v[52:55], v13 offset:55296
    v_mfma_f32_16x16x32_bf16 v[84:87], a[188:191], v[56:59], v[84:87]
    v_mfma_f32_16x16x32_bf16 v[88:91], a[184:187], v[60:63], v[88:91]
    s_add_u32 m0, s59, 7040
    s_nop 0
    buffer_load_dwordx4 v9, s[12:15], s49 offen offset:128 sc1 lds
    v_mfma_f32_16x16x32_bf16 v[92:95], a[188:191], v[60:63], v[92:95]
    s_waitcnt lgkmcnt(4)
    v_mfma_f32_16x16x32_bf16 v[80:83], a[192:195], v[32:35], v[80:83]
    ds_read_b128 v[56:59], v15 offset:53248
    ds_read_b128 v[60:63], v15 offset:55296
    v_mfma_f32_16x16x32_bf16 v[84:87], a[196:199], v[32:35], v[84:87]
    v_mfma_f32_16x16x32_bf16 v[88:91], a[192:195], v[36:39], v[88:91]
    v_mfma_f32_16x16x32_bf16 v[92:95], a[196:199], v[36:39], v[92:95]
    s_waitcnt lgkmcnt(4)
    v_mfma_f32_16x16x32_bf16 v[80:83], a[200:203], v[40:43], v[80:83]
    ds_read_b128 v[32:35], v13 offset:57344
    ds_read_b128 v[36:39], v13 offset:59392
    v_mfma_f32_16x16x32_bf16 v[84:87], a[204:207], v[40:43], v[84:87]
    v_mfma_f32_16x16x32_bf16 v[88:91], a[200:203], v[44:47], v[88:91]
    v_mfma_f32_16x16x32_bf16 v[92:95], a[204:207], v[44:47], v[92:95]
    s_waitcnt lgkmcnt(4)
    v_mfma_f32_16x16x32_bf16 v[80:83], a[208:211], v[48:51], v[80:83]
    ds_read_b128 v[40:43], v15 offset:57344
    ds_read_b128 v[44:47], v15 offset:59392
    v_mfma_f32_16x16x32_bf16 v[84:87], a[212:215], v[48:51], v[84:87]
    v_mfma_f32_16x16x32_bf16 v[88:91], a[208:211], v[52:55], v[88:91]
    v_mfma_f32_16x16x32_bf16 v[92:95], a[212:215], v[52:55], v[92:95]
    s_waitcnt lgkmcnt(4)
    v_mfma_f32_16x16x32_bf16 v[80:83], a[216:219], v[56:59], v[80:83]
    ds_read_b128 v[48:51], v13 offset:61440
    ds_read_b128 v[52:55], v13 offset:63488
    v_mfma_f32_16x16x32_bf16 v[84:87], a[220:223], v[56:59], v[84:87]
    v_mfma_f32_16x16x32_bf16 v[88:91], a[216:219], v[60:63], v[88:91]
    v_mfma_f32_16x16x32_bf16 v[92:95], a[220:223], v[60:63], v[92:95]
    s_waitcnt lgkmcnt(4)
    v_mfma_f32_16x16x32_bf16 v[80:83], a[224:227], v[32:35], v[80:83]
    ds_read_b128 v[56:59], v15 offset:61440
    ds_read_b128 v[60:63], v15 offset:63488
    v_mfma_f32_16x16x32_bf16 v[84:87], a[228:231], v[32:35], v[84:87]
    v_mfma_f32_16x16x32_bf16 v[88:91], a[224:227], v[36:39], v[88:91]
    v_mfma_f32_16x16x32_bf16 v[92:95], a[228:231], v[36:39], v[92:95]
    s_waitcnt lgkmcnt(4)
    v_mfma_f32_16x16x32_bf16 v[80:83], a[232:235], v[40:43], v[80:83]
    v_mfma_f32_16x16x32_bf16 v[84:87], a[236:239], v[40:43], v[84:87]
    v_mfma_f32_16x16x32_bf16 v[88:91], a[232:235], v[44:47], v[88:91]
    v_mfma_f32_16x16x32_bf16 v[92:95], a[236:239], v[44:47], v[92:95]
    s_waitcnt vmcnt(16) lgkmcnt(0)
    s_barrier
    s_cmp_lg_u32 s44, 0
    s_cbranch_scc1 L_e_pr_120
    s_add_u32 s45, s58, s60
    v_mov_b32 v30, s45
    v_mov_b32 v31, 0
    s_mov_b64 exec, 1
    buffer_store_dword v30, v31, s[12:15], s61 offen sc1
    s_mov_b64 exec, -1
L_e_pr_120:
    v_mfma_f32_16x16x32_bf16 v[80:83], a[240:243], v[48:51], v[80:83]
    ds_read_b128 v[32:35], v14 offset:0
    ds_read_b128 v[36:39], v14 offset:2048
    v_mfma_f32_16x16x32_bf16 v[84:87], a[244:247], v[48:51], v[84:87]
    v_mfma_f32_16x16x32_bf16 v[88:91], a[240:243], v[52:55], v[88:91]
    v_mfma_f32_16x16x32_bf16 v[92:95], a[244:247], v[52:55], v[92:95]
    v_mfma_f32_16x16x32_bf16 v[80:83], a[248:251], v[56:59], v[80:83]
    ds_read_b128 v[40:43], v16 offset:0
    ds_read_b128 v[44:47], v16 offset:2048
    v_mfma_f32_16x16x32_bf16 v[84:87], a[252:255], v[56:59], v[84:87]
    v_mfma_f32_16x16x32_bf16 v[88:91], a[248:251], v[60:63], v[88:91]
    v_mfma_f32_16x16x32_bf16 v[92:95], a[252:255], v[60:63], v[92:95]
    s_add_u32 s53, s53, 65536
    s_add_u32 s58, s58, 1
    v_swap_b32 v13, v14
    s_xor_b32 s54, s54, 65536
    s_xor_b32 s55, s55, 65536
    s_mov_b32 s76, s57
    v_swap_b32 v15, v16
    s_add_u32 s57, s57, 8192
    v_cvt_pk_bf16_f32 v216, v80, v81
    v_cvt_pk_bf16_f32 v217, v82, v83
    v_cvt_pk_bf16_f32 v218, v84, v85
    v_cvt_pk_bf16_f32 v219, v86, v87
    v_cvt_pk_bf16_f32 v220, v88, v89
    v_cvt_pk_bf16_f32 v221, v90, v91
    v_cvt_pk_bf16_f32 v222, v92, v93
    v_cvt_pk_bf16_f32 v223, v94, v95
    buffer_store_dwordx4 v[216:219], v10, s[12:15], s76 offen sc1
    buffer_store_dwordx4 v[220:223], v10, s[12:15], s76 offen offset:1024 sc1
    s_cmp_lt_u32 s58, s51
    s_cbranch_scc1 L_e_loop_117
    s_branch L_e_fin_119
L_e_one_118:
    s_waitcnt vmcnt(8)
    s_barrier
    ds_read_b128 v[32:35], v13 offset:0
    ds_read_b128 v[36:39], v13 offset:2048
    ds_read_b128 v[40:43], v15 offset:0
    ds_read_b128 v[44:47], v15 offset:2048
    s_waitcnt lgkmcnt(2)
    v_mfma_f32_16x16x32_bf16 v[80:83], a[0:3], v[32:35], 0
    ds_read_b128 v[48:51], v13 offset:4096
    ds_read_b128 v[52:55], v13 offset:6144
    v_mfma_f32_16x16x32_bf16 v[84:87], a[4:7], v[32:35], 0
    ds_read_b128 v[56:59], v15 offset:4096
    ds_read_b128 v[60:63], v15 offset:6144
    v_mfma_f32_16x16x32_bf16 v[88:91], a[0:3], v[36:39], 0
    v_mfma_f32_16x16x32_bf16 v[92:95], a[4:7], v[36:39], 0
    s_waitcnt lgkmcnt(4)
    v_mfma_f32_16x16x32_bf16 v[80:83], a[8:11], v[40:43], v[80:83]
    ds_read_b128 v[32:35], v13 offset:8192
    ds_read_b128 v[36:39], v13 offset:10240
    v_mfma_f32_16x16x32_bf16 v[84:87], a[12:15], v[40:43], v[84:87]
    v_mfma_f32_16x16x32_bf16 v[88:91], a[8:11], v[44:47], v[88:91]
    v_mfma_f32_16x16x32_bf16 v[92:95], a[12:15], v[44:47], v[92:95]
    s_waitcnt lgkmcnt(4)
    v_mfma_f32_16x16x32_bf16 v[80:83], a[16:19], v[48:51], v[80:83]
    ds_read_b128 v[40:43], v15 offset:8192
    ds_read_b128 v[44:47], v15 offset:10240
    v_mfma_f32_16x16x32_bf16 v[84:87], a[20:23], v[48:51], v[84:87]
    v_mfma_f32_16x16x32_bf16 v[88:91], a[16:19], v[52:55], v[88:91]
    v_mfma_f32_16x16x32_bf16 v[92:95], a[20:23], v[52:55], v[92:95]
    s_waitcnt lgkmcnt(4)
    v_mfma_f32_16x16x32_bf16 v[80:83], a[24:27], v[56:59], v[80:83]
    ds_read_b128 v[48:51], v13 offset:12288
    ds_read_b128 v[52:55], v13 offset:14336
    v_mfma_f32_16x16x32_bf16 v[84:87], a[28:31], v[56:59], v[84:87]
    v_mfma_f32_16x16x32_bf16 v[88:91], a[24:27], v[60:63], v[88:91]
    v_mfma_f32_16x16x32_bf16 v[92:95], a[28:31], v[60:63], v[92:95]
    s_waitcnt lgkmcnt(4)
    v_mfma_f32_16x16x32_bf16 v[80:83], a[32:35], v[32:35], v[80:83]
    ds_read_b128 v[56:59], v15 offset:12288
    ds_read_b128 v[60:63], v15 offset:14336
    v_mfma_f32_16x16x32_bf16 v[84:87], a[36:39], v[32:35], v[84:87]
    v_mfma_f32_16x16x32_bf16 v[88:91], a[32:35], v[36:39], v[88:91]
    v_mfma_f32_16x16x32_bf16 v[92:95], a[36:39], v[36:39], v[92:95]
    s_waitcnt lgkmcnt(4)
    v_mfma_f32_16x16x32_bf16 v[80:83], a[40:43], v[40:43], v[80:83]
    ds_read_b128 v[32:35], v13 offset:16384
    ds_read_b128 v[36:39], v13 offset:18432
    v_mfma_f32_16x16x32_bf16 v[84:87], a[44:47], v[40:43], v[84:87]
    v_mfma_f32_16x16x32_bf16 v[88:91], a[40:43], v[44:47], v[88:91]
    v_mfma_f32_16x16x32_bf16 v[92:95], a[44:47], v[44:47], v[92:95]
    s_waitcnt lgkmcnt(4)
    v_mfma_f32_16x16x32_bf16 v[80:83], a[48:51], v[48:51], v[80:83]
    ds_read_b128 v[40:43], v15 offset:16384
    ds_read_b128 v[44:47], v15 offset:18432
    v_mfma_f32_16x16x32_bf16 v[84:87], a[52:55], v[48:51], v[84:87]
    v_mfma_f32_16x16x32_bf16 v[88:91], a[48:51], v[52:55], v[88:91]
    v_mfma_f32_16x16x32_bf16 v[92:95], a[52:55], v[52:55], v[92:95]
    s_waitcnt lgkmcnt(4)
    v_mfma_f32_16x16x32_bf16 v[80:83], a[56:59], v[56:59], v[80:83]
    ds_read_b128 v[48:51], v13 offset:20480
    ds_read_b128 v[52:55], v13 offset:22528
    v_mfma_f32_16x16x32_bf16 v[84:87], a[60:63], v[56:59], v[84:87]
    v_mfma_f32_16x16x32_bf16 v[88:91], a[56:59], v[60:63], v[88:91]
    v_mfma_f32_16x16x32_bf16 v[92:95], a[60:63], v[60:63], v[92:95]
    s_waitcnt lgkmcnt(4)
    v_mfma_f32_16x16x32_bf16 v[80:83], a[64:67], v[32:35], v[80:83]
    ds_read_b128 v[56:59], v15 offset:20480
    ds_read_b128 v[60:63], v15 offset:22528
    v_mfma_f32_16x16x32_bf16 v[84:87], a[68:71], v[32:35], v[84:87]
    v_mfma_f32_16x16x32_bf16 v[88:91], a[64:67], v[36:39], v[88:91]
    v_mfma_f32_16x16x32_bf16 v[92:95], a[68:71], v[36:39], v[92:95]
    s_waitcnt lgkmcnt(4)
    v_mfma_f32_16x16x32_bf16 v[80:83], a[72:75], v[40:43], v[80:83]
    ds_read_b128 v[32:35], v13 offset:24576
    ds_read_b128 v[36:39], v13 offset:26624
    v_mfma_f32_16x16x32_bf16 v[84:87], a[76:79], v[40:43], v[84:87]
    v_mfma_f32_16x16x32_bf16 v[88:91], a[72:75], v[44:47], v[88:91]
    v_mfma_f32_16x16x32_bf16 v[92:95], a[76:79], v[44:47], v[92:95]
    s_waitcnt lgkmcnt(4)
    v_mfma_f32_16x16x32_bf16 v[80:83], a[80:83], v[48:51], v[80:83]
    ds_read_b128 v[40:43], v15 offset:24576
    ds_read_b128 v[44:47], v15 offset:26624
    v_mfma_f32_16x16x32_bf16 v[84:87], a[84:87], v[48:51], v[84:87]
    v_mfma_f32_16x16x32_bf16 v[88:91], a[80:83], v[52:55], v[88:91]
    v_mfma_f32_16x16x32_bf16 v[92:95], a[84:87], v[52:55], v[92:95]
    s_waitcnt lgkmcnt(4)
    v_mfma_f32_16x16x32_bf16 v[80:83], a[88:91], v[56:59], v[80:83]
    ds_read_b128 v[48:51], v13 offset:28672
    ds_read_b128 v[52:55], v13 offset:30720
    v_mfma_f32_16x16x32_bf16 v[84:87], a[92:95], v[56:59], v[84:87]
    v_mfma_f32_16x16x32_bf16 v[88:91], a[88:91], v[60:63], v[88:91]
    v_mfma_f32_16x16x32_bf16 v[92:95], a[92:95], v[60:63], v[92:95]
    s_waitcnt lgkmcnt(4)
    v_mfma_f32_16x16x32_bf16 v[80:83], a[96:99], v[32:35], v[80:83]
    ds_read_b128 v[56:59], v15 offset:28672
    ds_read_b128 v[60:63], v15 offset:30720
    v_mfma_f32_16x16x32_bf16 v[84:87], a[100:103], v[32:35], v[84:87]
    v_mfma_f32_16x16x32_bf16 v[88:91], a[96:99], v[36:39], v[88:91]
    v_mfma_f32_16x16x32_bf16 v[92:95], a[100:103], v[36:39], v[92:95]
    s_waitcnt lgkmcnt(4)
    v_mfma_f32_16x16x32_bf16 v[80:83], a[104:107], v[40:43], v[80:83]
    v_mfma_f32_16x16x32_bf16 v[84:87], a[108:111], v[40:43], v[84:87]
    v_mfma_f32_16x16x32_bf16 v[88:91], a[104:107], v[44:47], v[88:91]
    v_mfma_f32_16x16x32_bf16 v[92:95], a[108:111], v[44:47], v[92:95]
    s_waitcnt vmcnt(0) lgkmcnt(0)
    s_barrier
    v_mfma_f32_16x16x32_bf16 v[80:83], a[112:115], v[48:51], v[80:83]
    ds_read_b128 v[32:35], v13 offset:32768
    ds_read_b128 v[36:39], v13 offset:34816
    v_mfma_f32_16x16x32_bf16 v[84:87], a[116:119], v[48:51], v[84:87]
    v_mfma_f32_16x16x32_bf16 v[88:91], a[112:115], v[52:55], v[88:91]
    v_mfma_f32_16x16x32_bf16 v[92:95], a[116:119], v[52:55], v[92:95]
    v_mfma_f32_16x16x32_bf16 v[80:83], a[120:123], v[56:59], v[80:83]
    ds_read_b128 v[40:43], v15 offset:32768
    ds_read_b128 v[44:47], v15 offset:34816
    v_mfma_f32_16x16x32_bf16 v[84:87], a[124:127], v[56:59], v[84:87]
    v_mfma_f32_16x16x32_bf16 v[88:91], a[120:123], v[60:63], v[88:91]
    v_mfma_f32_16x16x32_bf16 v[92:95], a[124:127], v[60:63], v[92:95]
    s_waitcnt lgkmcnt(2)
    v_mfma_f32_16x16x32_bf16 v[80:83], a[128:131], v[32:35], v[80:83]
    ds_read_b128 v[48:51], v13 offset:36864
    ds_read_b128 v[52:55], v13 offset:38912
    v_mfma_f32_16x16x32_bf16 v[84:87], a[132:135], v[32:35], v[84:87]
    ds_read_b128 v[56:59], v15 offset:36864
    ds_read_b128 v[60:63], v15 offset:38912
    v_mfma_f32_16x16x32_bf16 v[88:91], a[128:131], v[36:39], v[88:91]
    v_mfma_f32_16x16x32_bf16 v[92:95], a[132:135], v[36:39], v[92:95]
    s_waitcnt lgkmcnt(4)
    v_mfma_f32_16x16x32_bf16 v[80:83], a[136:139], v[40:43], v[80:83]
    ds_read_b128 v[32:35], v13 offset:40960
    ds_read_b128 v[36:39], v13 offset:43008
    v_mfma_f32_16x16x32_bf16 v[84:87], a[140:143], v[40:43], v[84:87]
    v_mfma_f32_16x16x32_bf16 v[88:91], a[136:139], v[44:47], v[88:91]
    v_mfma_f32_16x16x32_bf16 v[92:95], a[140:143], v[44:47], v[92:95]
    s_waitcnt lgkmcnt(4)
    v_mfma_f32_16x16x32_bf16 v[80:83], a[144:147], v[48:51], v[80:83]
    ds_read_b128 v[40:43], v15 offset:40960
    ds_read_b128 v[44:47], v15 offset:43008
    v_mfma_f32_16x16x32_bf16 v[84:87], a[148:151], v[48:51], v[84:87]
    v_mfma_f32_16x16x32_bf16 v[88:91], a[144:147], v[52:55], v[88:91]
    v_mfma_f32_16x16x32_bf16 v[92:95], a[148:151], v[52:55], v[92:95]
    s_waitcnt lgkmcnt(4)
    v_mfma_f32_16x16x32_bf16 v[80:83], a[152:155], v[56:59], v[80:83]
    ds_read_b128 v[48:51], v13 offset:45056
    ds_read_b128 v[52:55], v13 offset:47104
    v_mfma_f32_16x16x32_bf16 v[84:87], a[156:159], v[56:59], v[84:87]
    v_mfma_f32_16x16x32_bf16 v[88:91], a[152:155], v[60:63], v[88:91]
    v_mfma_f32_16x16x32_bf16 v[92:95], a[156:159], v[60:63], v[92:95]
    s_waitcnt lgkmcnt(4)
    v_mfma_f32_16x16x32_bf16 v[80:83], a[160:163], v[32:35], v[80:83]
    ds_read_b128 v[56:59], v15 offset:45056
    ds_read_b128 v[60:63], v15 offset:47104
    v_mfma_f32_16x16x32_bf16 v[84:87], a[164:167], v[32:35], v[84:87]
    v_mfma_f32_16x16x32_bf16 v[88:91], a[160:163], v[36:39], v[88:91]
    v_mfma_f32_16x16x32_bf16 v[92:95], a[164:167], v[36:39], v[92:95]
    s_waitcnt lgkmcnt(4)
    v_mfma_f32_16x16x32_bf16 v[80:83], a[168:171], v[40:43], v[80:83]
    ds_read_b128 v[32:35], v13 offset:49152
    ds_read_b128 v[36:39], v13 offset:51200
    v_mfma_f32_16x16x32_bf16 v[84:87], a[172:175], v[40:43], v[84:87]
    v_mfma_f32_16x16x32_bf16 v[88:91], a[168:171], v[44:47], v[88:91]
    v_mfma_f32_16x16x32_bf16 v[92:95], a[172:175], v[44:47], v[92:95]
    s_waitcnt lgkmcnt(4)
    v_mfma_f32_16x16x32_bf16 v[80:83], a[176:179], v[48:51], v[80:83]
    ds_read_b128 v[40:43], v15 offset:49152
    ds_read_b128 v[44:47], v15 offset:51200
    v_mfma_f32_16x16x32_bf16 v[84:87], a[180:183], v[48:51], v[84:87]
    v_mfma_f32_16x16x32_bf16 v[88:91], a[176:179], v[52:55], v[88:91]
    v_mfma_f32_16x16x32_bf16 v[92:95], a[180:183], v[52:55], v[92:95]
    s_waitcnt lgkmcnt(4)
    v_mfma_f32_16x16x32_bf16 v[80:83], a[184:187], v[56:59], v[80:83]
    ds_read_b128 v[48:51], v13 offset:53248
    ds_read_b128 v[52:55], v13 offset:55296
    v_mfma_f32_16x16x32_bf16 v[84:87], a[188:191], v[56:59], v[84:87]
    v_mfma_f32_16x16x32_bf16 v[88:91], a[184:187], v[60:63], v[88:91]
    v_mfma_f32_16x16x32_bf16 v[92:95], a[188:191], v[60:63], v[92:95]
    s_waitcnt lgkmcnt(4)
    v_mfma_f32_16x16x32_bf16 v[80:83], a[192:195], v[32:35], v[80:83]
    ds_read_b128 v[56:59], v15 offset:53248
    ds_read_b128 v[60:63], v15 offset:55296
    v_mfma_f32_16x16x32_bf16 v[84:87], a[196:199], v[32:35], v[84:87]
    v_mfma_f32_16x16x32_bf16 v[88:91], a[192:195], v[36:39], v[88:91]
    v_mfma_f32_16x16x32_bf16 v[92:95], a[196:199], v[36:39], v[92:95]
    s_waitcnt lgkmcnt(4)
    v_mfma_f32_16x16x32_bf16 v[80:83], a[200:203], v[40:43], v[80:83]
    ds_read_b128 v[32:35], v13 offset:57344
    ds_read_b128 v[36:39], v13 offset:59392
    v_mfma_f32_16x16x32_bf16 v[84:87], a[204:207], v[40:43], v[84:87]
    v_mfma_f32_16x16x32_bf16 v[88:91], a[200:203], v[44:47], v[88:91]
    v_mfma_f32_16x16x32_bf16 v[92:95], a[204:207], v[44:47], v[92:95]
    s_waitcnt lgkmcnt(4)
    v_mfma_f32_16x16x32_bf16 v[80:83], a[208:211], v[48:51], v[80:83]
    ds_read_b128 v[40:43], v15 offset:57344
    ds_read_b128 v[44:47], v15 offset:59392
    v_mfma_f32_16x16x32_bf16 v[84:87], a[212:215], v[48:51], v[84:87]
    v_mfma_f32_16x16x32_bf16 v[88:91], a[208:211], v[52:55], v[88:91]
    v_mfma_f32_16x16x32_bf16 v[92:95], a[212:215], v[52:55], v[92:95]
    s_waitcnt lgkmcnt(4)
    v_mfma_f32_16x16x32_bf16 v[80:83], a[216:219], v[56:59], v[80:83]
    ds_read_b128 v[48:51], v13 offset:61440
    ds_read_b128 v[52:55], v13 offset:63488
    v_mfma_f32_16x16x32_bf16 v[84:87], a[220:223], v[56:59], v[84:87]
    v_mfma_f32_16x16x32_bf16 v[88:91], a[216:219], v[60:63], v[88:91]
    v_mfma_f32_16x16x32_bf16 v[92:95], a[220:223], v[60:63], v[92:95]
    s_waitcnt lgkmcnt(4)
    v_mfma_f32_16x16x32_bf16 v[80:83], a[224:227], v[32:35], v[80:83]
    ds_read_b128 v[56:59], v15 offset:61440
    ds_read_b128 v[60:63], v15 offset:63488
    v_mfma_f32_16x16x32_bf16 v[84:87], a[228:231], v[32:35], v[84:87]
    v_mfma_f32_16x16x32_bf16 v[88:91], a[224:227], v[36:39], v[88:91]
    v_mfma_f32_16x16x32_bf16 v[92:95], a[228:231], v[36:39], v[92:95]
    s_waitcnt lgkmcnt(4)
    v_mfma_f32_16x16x32_bf16 v[80:83], a[232:235], v[40:43], v[80:83]
    v_mfma_f32_16x16x32_bf16 v[84:87], a[236:239], v[40:43], v[84:87]
    v_mfma_f32_16x16x32_bf16 v[88:91], a[232:235], v[44:47], v[88:91]
    v_mfma_f32_16x16x32_bf16 v[92:95], a[236:239], v[44:47], v[92:95]
    s_waitcnt lgkmcnt(0)
    v_mfma_f32_16x16x32_bf16 v[80:83], a[240:243], v[48:51], v[80:83]
    v_mfma_f32_16x16x32_bf16 v[84:87], a[244:247], v[48:51], v[84:87]
    v_mfma_f32_16x16x32_bf16 v[88:91], a[240:243], v[52:55], v[88:91]
    v_mfma_f32_16x16x32_bf16 v[92:95], a[244:247], v[52:55], v[92:95]
    v_mfma_f32_16x16x32_bf16 v[80:83], a[248:251], v[56:59], v[80:83]
    v_mfma_f32_16x16x32_bf16 v[84:87], a[252:255], v[56:59], v[84:87]
    v_mfma_f32_16x16x32_bf16 v[88:91], a[248:251], v[60:63], v[88:91]
    v_mfma_f32_16x16x32_bf16 v[92:95], a[252:255], v[60:63], v[92:95]
    s_mov_b32 s76, s57
    s_nop 6
    v_cvt_pk_bf16_f32 v216, v80, v81
    v_cvt_pk_bf16_f32 v217, v82, v83
    v_cvt_pk_bf16_f32 v218, v84, v85
    v_cvt_pk_bf16_f32 v219, v86, v87
    v_cvt_pk_bf16_f32 v220, v88, v89
    v_cvt_pk_bf16_f32 v221, v90, v91
    v_cvt_pk_bf16_f32 v222, v92, v93
    v_cvt_pk_bf16_f32 v223, v94, v95
    buffer_store_dwordx4 v[216:219], v10, s[12:15], s76 offen sc1
    buffer_store_dwordx4 v[220:223], v10, s[12:15], s76 offen offset:1024 sc1
L_e_fin_119:
    s_waitcnt lgkmcnt(0)
    s_add_u32 s60, s60, s51
    s_waitcnt vmcnt(0)
    s_barrier
    s_cmp_lg_u32 s44, 0
    s_cbranch_scc1 L_pub_121
    v_mov_b32 v30, s60
    v_mov_b32 v31, 0
    s_mov_b64 exec, 1
    buffer_store_dword v30, v31, s[12:15], s61 offen sc1
    s_mov_b64 exec, -1
L_pub_121:
    s_cmp_eq_u32 s60, 2
    s_cselect_b32 s51, 10, s51
    s_cmp_eq_u32 s60, 12
    s_cselect_b32 s51, 52, s51
    s_cselect_b32 s71, 127104, s71
    s_cbranch_scc1 L_w_qkv_114
    s_cmp_lt_u32 s60, 64
    s_cbranch_scc1 L_w_qkv_114_n
L_w_roles_98:
    s_cmp_lg_u32 s44, 0
    s_cbranch_scc1 L_gj_122
    s_getreg_b32 s45, hwreg(HW_REG_XCC_ID)
    s_and_b32 s45, s45, 15
    s_mul_i32 s46, s45, s45
    s_lshl_b32 s46, s46, 9
    s_add_u32 s45, s45, s46
    s_add_u32 s45, s45, 16777216
    v_mov_b32 v30, s45
    s_lshl_b32 s45, s40, 7
    v_mov_b32 v31, 127488
    s_mov_b64 exec, 1
    buffer_atomic_add v30, v31, s[12:15], s45 offen sc1
    s_mov_b64 exec, -1
L_gj_122:
    s_mov_b32 s36, 0x1111111
    s_mov_b32 s37, 0x55222081
    s_cmp_eq_u32 s42, 0
    s_cselect_b32 s36, s36, 0x10000000
    s_cselect_b32 s37, s37, 0xaa888410
    s_mov_b32 s72, 0x88888888
    s_mov_b32 s73, 0xffd55248
    s_lshr_b32 s38, s41, 3
    s_and_b32 s68, s41, 7
    s_cmp_eq_u32 s43, 1
    s_cbranch_scc1 L_role_b_123
    s_cmp_eq_u32 s43, 2
    s_cbranch_scc1 L_role_c_124
    s_load_dwordx2 s[6:7], s[0:1], 40
    s_waitcnt lgkmcnt(0)
    s_mov_b32 s24, s6
    s_and_b32 s25, s7, 0xffff
    s_mov_b32 s26, 0x800000
    s_mov_b32 s27, 0x00020000
    s_lshl_b32 s46, s38, 21
    s_lshl_b32 s45, s68, 8
    s_add_u32 s46, s46, s45
    s_waitcnt vmcnt(0)
    s_barrier
    v_lshrrev_b32 v20, 4, v1
    s_lshl_b32 s45, s44, 2
    v_add_u32 v21, s45, v20
    s_mov_b32 s45, 2048
    v_mul_lo_u32 v21, v21, s45
    v_lshlrev_b32 v22, 2, v20
    v_and_b32 v23, 15, v1
    v_xor_b32 v22, v22, v23
    v_lshlrev_b32 v22, 4, v22
    v_add_u32 v21, v21, v22
    v_bfe_u32 v22, v1, 2, 2
    v_lshlrev_b32 v23, 2, v20
    v_add_u32 v23, v23, v22
    v_lshlrev_b32 v23, 8, v23
    v_xor_b32 v22, s44, v22
    v_lshlrev_b32 v22, 6, v22
    v_add_u32 v23, v23, v22
    v_and_b32 v22, 3, v1
    v_lshlrev_b32 v22, 3, v22
    v_add_u32 v23, v23, v22
    v_add_u32 v24, 65536, v23
    v_add_u32 v25, 131072, v23
    s_lshl_b32 s47, s44, 10
    s_add_u32 s45, s46, 0x0
    s_add_u32 m0, s47, 0
    s_nop 0
    buffer_load_dwordx4 v21, s[24:27], s45 offen  lds
    s_add_u32 s45, s46, 0x8000
    s_add_u32 m0, s47, 4096
    s_nop 0
    buffer_load_dwordx4 v21, s[24:27], s45 offen  lds
    s_add_u32 s45, s46, 0x10000
    s_add_u32 m0, s47, 8192
    s_nop 0
    buffer_load_dwordx4 v21, s[24:27], s45 offen  lds
    s_add_u32 s45, s46, 0x18000
    s_add_u32 m0, s47, 12288
    s_nop 0
    buffer_load_dwordx4 v21, s[24:27], s45 offen  lds
    s_add_u32 s45, s46, 0x20000
    s_add_u32 m0, s47, 16384
    s_nop 0
    buffer_load_dwordx4 v21, s[24:27], s45 offen  lds
    s_add_u32 s45, s46, 0x28000
    s_add_u32 m0, s47, 20480
    s_nop 0
    buffer_load_dwordx4 v21, s[24:27], s45 offen  lds
    s_add_u32 s45, s46, 0x30000
    s_add_u32 m0, s47, 24576
    s_nop 0
    buffer_load_dwordx4 v21, s[24:27], s45 offen  lds
    s_add_u32 s45, s46, 0x38000
    s_add_u32 m0, s47, 28672
    s_nop 0
    buffer_load_dwordx4 v21, s[24:27], s45 offen  lds
    s_add_u32 s45, s46, 0x40000
    s_add_u32 m0, s47, 32768
    s_nop 0
    buffer_load_dwordx4 v21, s[24:27], s45 offen  lds
    s_add_u32 s45, s46, 0x48000
    s_add_u32 m0, s47, 36864
    s_nop 0
    buffer_load_dwordx4 v21, s[24:27], s45 offen  lds
    s_add_u32 s45, s46, 0x50000
    s_add_u32 m0, s47, 40960
    s_nop 0
    buffer_load_dwordx4 v21, s[24:27], s45 offen  lds
    s_add_u32 s45, s46, 0x58000
    s_add_u32 m0, s47, 45056
    s_nop 0
    buffer_load_dwordx4 v21, s[24:27], s45 offen  lds
    s_add_u32 s45, s46, 0x60000
    s_add_u32 m0, s47, 49152
    s_nop 0
    buffer_load_dwordx4 v21, s[24:27], s45 offen  lds
    s_add_u32 s45, s46, 0x68000
    s_add_u32 m0, s47, 53248
    s_nop 0
    buffer_load_dwordx4 v21, s[24:27], s45 offen  lds
    s_add_u32 s45, s46, 0x70000
    s_add_u32 m0, s47, 57344
    s_nop 0
    buffer_load_dwordx4 v21, s[24:27], s45 offen  lds
    s_add_u32 s45, s46, 0x78000
    s_add_u32 m0, s47, 61440
    s_nop 0
    buffer_load_dwordx4 v21, s[24:27], s45 offen  lds
    s_add_u32 s45, s46, 0x80000
    s_add_u32 m0, s47, 65536
    s_nop 0
    buffer_load_dwordx4 v21, s[24:27], s45 offen  lds
    s_add_u32 s45, s46, 0x88000
    s_add_u32 m0, s47, 69632
    s_nop 0
    buffer_load_dwordx4 v21, s[24:27], s45 offen  lds
    s_add_u32 s45, s46, 0x90000
    s_add_u32 m0, s47, 73728
    s_nop 0
    buffer_load_dwordx4 v21, s[24:27], s45 offen  lds
    s_add_u32 s45, s46, 0x98000
    s_add_u32 m0, s47, 77824
    s_nop 0
    buffer_load_dwordx4 v21, s[24:27], s45 offen  lds
    s_add_u32 s45, s46, 0xa0000
    s_add_u32 m0, s47, 81920
    s_nop 0
    buffer_load_dwordx4 v21, s[24:27], s45 offen  lds
    s_add_u32 s45, s46, 0xa8000
    s_add_u32 m0, s47, 86016
    s_nop 0
    buffer_load_dwordx4 v21, s[24:27], s45 offen  lds
    s_add_u32 s45, s46, 0xb0000
    s_add_u32 m0, s47, 90112
    s_nop 0
    buffer_load_dwordx4 v21, s[24:27], s45 offen  lds
    s_add_u32 s45, s46, 0xb8000
    s_add_u32 m0, s47, 94208
    s_nop 0
    buffer_load_dwordx4 v21, s[24:27], s45 offen  lds
    s_add_u32 s45, s46, 0xc0000
    s_add_u32 m0, s47, 98304
    s_nop 0
    buffer_load_dwordx4 v21, s[24:27], s45 offen  lds
    s_add_u32 s45, s46, 0xc8000
    s_add_u32 m0, s47, 102400
    s_nop 0
    buffer_load_dwordx4 v21, s[24:27], s45 offen  lds
    s_add_u32 s45, s46, 0xd0000
    s_add_u32 m0, s47, 106496
    s_nop 0
    buffer_load_dwordx4 v21, s[24:27], s45 offen  lds
    s_add_u32 s45, s46, 0xd8000
    s_add_u32 m0, s47, 110592
    s_nop 0
    buffer_load_dwordx4 v21, s[24:27], s45 offen  lds
    s_add_u32 s45, s46, 0xe0000
    s_add_u32 m0, s47, 114688
    s_nop 0
    buffer_load_dwordx4 v21, s[24:27], s45 offen  lds
    s_add_u32 s45, s46, 0xe8000
    s_add_u32 m0, s47, 118784
    s_nop 0
    buffer_load_dwordx4 v21, s[24:27], s45 offen  lds
    s_add_u32 s45, s46, 0xf0000
    s_add_u32 m0, s47, 122880
    s_nop 0
    buffer_load_dwordx4 v21, s[24:27], s45 offen  lds
    s_add_u32 s45, s46, 0xf8000
    s_add_u32 m0, s47, 126976
    s_nop 0
    buffer_load_dwordx4 v21, s[24:27], s45 offen  lds
    s_waitcnt vmcnt(28)
    s_barrier
    s_add_u32 s45, s46, 0x100000
    s_add_u32 m0, s47, 131072
    s_nop 0
    buffer_load_dwordx4 v21, s[24:27], s45 offen  lds
    s_add_u32 s45, s46, 0x108000
    s_add_u32 m0, s47, 135168
    s_nop 0
    buffer_load_dwordx4 v21, s[24:27], s45 offen  lds
    s_add_u32 s45, s46, 0x110000
    s_add_u32 m0, s47, 139264
    s_nop 0
    buffer_load_dwordx4 v21, s[24:27], s45 offen  lds
    s_add_u32 s45, s46, 0x118000
    s_add_u32 m0, s47, 143360
    s_nop 0
    buffer_load_dwordx4 v21, s[24:27], s45 offen  lds
    ds_read_b64_tr_b16 a[0:1], v23 offset:0
    ds_read_b64_tr_b16 a[2:3], v23 offset:4096
    ds_read_b64_tr_b16 a[4:5], v23 offset:32
    ds_read_b64_tr_b16 a[6:7], v23 offset:4128
    ds_read_b64_tr_b16 a[8:9], v23 offset:8192
    ds_read_b64_tr_b16 a[10:11], v23 offset:12288
    ds_read_b64_tr_b16 a[12:13], v23 offset:8224
    ds_read_b64_tr_b16 a[14:15], v23 offset:12320
    s_waitcnt lgkmcnt(0)
    s_waitcnt vmcnt(28)
    s_barrier
    s_add_u32 s45, s46, 0x120000
    s_add_u32 m0, s47, 0
    s_nop 0
    buffer_load_dwordx4 v21, s[24:27], s45 offen  lds
    s_add_u32 s45, s46, 0x128000
    s_add_u32 m0, s47, 4096
    s_nop 0
    buffer_load_dwordx4 v21, s[24:27], s45 offen  lds
    s_add_u32 s45, s46, 0x130000
    s_add_u32 m0, s47, 8192
    s_nop 0
    buffer_load_dwordx4 v21, s[24:27], s45 offen  lds
    s_add_u32 s45, s46, 0x138000
    s_add_u32 m0, s47, 12288
    s_nop 0
    buffer_load_dwordx4 v21, s[24:27], s45 offen  lds
    ds_read_b64_tr_b16 a[16:17], v23 offset:16384
    ds_read_b64_tr_b16 a[18:19], v23 offset:20480
    ds_read_b64_tr_b16 a[20:21], v23 offset:16416
    ds_read_b64_tr_b16 a[22:23], v23 offset:20512
    ds_read_b64_tr_b16 a[24:25], v23 offset:24576
    ds_read_b64_tr_b16 a[26:27], v23 offset:28672
    ds_read_b64_tr_b16 a[28:29], v23 offset:24608
    ds_read_b64_tr_b16 a[30:31], v23 offset:28704
    s_waitcnt lgkmcnt(0)
    s_waitcnt vmcnt(28)
    s_barrier
    s_add_u32 s45, s46, 0x140000
    s_add_u32 m0, s47, 16384
    s_nop 0
    buffer_load_dwordx4 v21, s[24:27], s45 offen  lds
    s_add_u32 s45, s46, 0x148000
    s_add_u32 m0, s47, 20480
    s_nop 0
    buffer_load_dwordx4 v21, s[24:27], s45 offen  lds
    s_add_u32 s45, s46, 0x150000
    s_add_u32 m0, s47, 24576
    s_nop 0
    buffer_load_dwordx4 v21, s[24:27], s45 offen  lds
    s_add_u32 s45, s46, 0x158000
    s_add_u32 m0, s47, 28672
    s_nop 0
    buffer_load_dwordx4 v21, s[24:27], s45 offen  lds
    ds_read_b64_tr_b16 a[32:33], v23 offset:32768
    ds_read_b64_tr_b16 a[34:35], v23 offset:36864
    ds_read_b64_tr_b16 a[36:37], v23 offset:32800
    ds_read_b64_tr_b16 a[38:39], v23 offset:36896
    ds_read_b64_tr_b16 a[40:41], v23 offset:40960
    ds_read_b64_tr_b16 a[42:43], v23 offset:45056
    ds_read_b64_tr_b16 a[44:45], v23 offset:40992
    ds_read_b64_tr_b16 a[46:47], v23 offset:45088
    s_waitcnt lgkmcnt(0)
    s_waitcnt vmcnt(28)
    s_barrier
    s_add_u32 s45, s46, 0x160000
    s_add_u32 m0, s47, 32768
    s_nop 0
    buffer_load_dwordx4 v21, s[24:27], s45 offen  lds
    s_add_u32 s45, s46, 0x168000
    s_add_u32 m0, s47, 36864
    s_nop 0
    buffer_load_dwordx4 v21, s[24:27], s45 offen  lds
    s_add_u32 s45, s46, 0x170000
    s_add_u32 m0, s47, 40960
    s_nop 0
    buffer_load_dwordx4 v21, s[24:27], s45 offen  lds
    s_add_u32 s45, s46, 0x178000
    s_add_u32 m0, s47, 45056
    s_nop 0
    buffer_load_dwordx4 v21, s[24:27], s45 offen  lds
    ds_read_b64_tr_b16 a[48:49], v23 offset:49152
    ds_read_b64_tr_b16 a[50:51], v23 offset:53248
    ds_read_b64_tr_b16 a[52:53], v23 offset:49184
    ds_read_b64_tr_b16 a[54:55], v23 offset:53280
    ds_read_b64_tr_b16 a[56:57], v23 offset:57344
    ds_read_b64_tr_b16 a[58:59], v23 offset:61440
    ds_read_b64_tr_b16 a[60:61], v23 offset:57376
    ds_read_b64_tr_b16 a[62:63], v23 offset:61472
    s_waitcnt lgkmcnt(0)
    s_waitcnt vmcnt(28)
    s_barrier
    s_add_u32 s45, s46, 0x180000
    s_add_u32 m0, s47, 49152
    s_nop 0
    buffer_load_dwordx4 v21, s[24:27], s45 offen  lds
    s_add_u32 s45, s46, 0x188000
    s_add_u32 m0, s47, 53248
    s_nop 0
    buffer_load_dwordx4 v21, s[24:27], s45 offen  lds
    s_add_u32 s45, s46, 0x190000
    s_add_u32 m0, s47, 57344
    s_nop 0
    buffer_load_dwordx4 v21, s[24:27], s45 offen  lds
    s_add_u32 s45, s46, 0x198000
    s_add_u32 m0, s47, 61440
    s_nop 0
    buffer_load_dwordx4 v21, s[24:27], s45 offen  lds
    ds_read_b64_tr_b16 a[64:65], v24 offset:0
    ds_read_b64_tr_b16 a[66:67], v24 offset:4096
    ds_read_b64_tr_b16 a[68:69], v24 offset:32
    ds_read_b64_tr_b16 a[70:71], v24 offset:4128
    ds_read_b64_tr_b16 a[72:73], v24 offset:8192
    ds_read_b64_tr_b16 a[74:75], v24 offset:12288
    ds_read_b64_tr_b16 a[76:77], v24 offset:8224
    ds_read_b64_tr_b16 a[78:79], v24 offset:12320
    s_waitcnt lgkmcnt(0)
    s_waitcnt vmcnt(28)
    s_barrier
    s_add_u32 s45, s46, 0x1a0000
    s_add_u32 m0, s47, 65536
    s_nop 0
    buffer_load_dwordx4 v21, s[24:27], s45 offen  lds
    s_add_u32 s45, s46, 0x1a8000
    s_add_u32 m0, s47, 69632
    s_nop 0
    buffer_load_dwordx4 v21, s[24:27], s45 offen  lds
    s_add_u32 s45, s46, 0x1b0000
    s_add_u32 m0, s47, 73728
    s_nop 0
    buffer_load_dwordx4 v21, s[24:27], s45 offen  lds
    s_add_u32 s45, s46, 0x1b8000
    s_add_u32 m0, s47, 77824
    s_nop 0
    buffer_load_dwordx4 v21, s[24:27], s45 offen  lds
    ds_read_b64_tr_b16 a[80:81], v24 offset:16384
    ds_read_b64_tr_b16 a[82:83], v24 offset:20480
    ds_read_b64_tr_b16 a[84:85], v24 offset:16416
    ds_read_b64_tr_b16 a[86:87], v24 offset:20512
    ds_read_b64_tr_b16 a[88:89], v24 offset:24576
    ds_read_b64_tr_b16 a[90:91], v24 offset:28672
    ds_read_b64_tr_b16 a[92:93], v24 offset:24608
    ds_read_b64_tr_b16 a[94:95], v24 offset:28704
    s_waitcnt lgkmcnt(0)
    s_waitcnt vmcnt(28)
    s_barrier
    s_add_u32 s45, s46, 0x1c0000
    s_add_u32 m0, s47, 81920
    s_nop 0
    buffer_load_dwordx4 v21, s[24:27], s45 offen  lds
    s_add_u32 s45, s46, 0x1c8000
    s_add_u32 m0, s47, 86016
    s_nop 0
    buffer_load_dwordx4 v21, s[24:27], s45 offen  lds
    s_add_u32 s45, s46, 0x1d0000
    s_add_u32 m0, s47, 90112
    s_nop 0
    buffer_load_dwordx4 v21, s[24:27], s45 offen  lds
    s_add_u32 s45, s46, 0x1d8000
    s_add_u32 m0, s47, 94208
    s_nop 0
    buffer_load_dwordx4 v21, s[24:27], s45 offen  lds
    ds_read_b64_tr_b16 a[96:97], v24 offset:32768
    ds_read_b64_tr_b16 a[98:99], v24 offset:36864
    ds_read_b64_tr_b16 a[100:101], v24 offset:32800
    ds_read_b64_tr_b16 a[102:103], v24 offset:36896
    ds_read_b64_tr_b16 a[104:105], v24 offset:40960
    ds_read_b64_tr_b16 a[106:107], v24 offset:45056
    ds_read_b64_tr_b16 a[108:109], v24 offset:40992
    ds_read_b64_tr_b16 a[110:111], v24 offset:45088
    s_waitcnt lgkmcnt(0)
    s_waitcnt vmcnt(28)
    s_barrier
    s_add_u32 s45, s46, 0x1e0000
    s_add_u32 m0, s47, 98304
    s_nop 0
    buffer_load_dwordx4 v21, s[24:27], s45 offen  lds
    s_add_u32 s45, s46, 0x1e8000
    s_add_u32 m0, s47, 102400
    s_nop 0
    buffer_load_dwordx4 v21, s[24:27], s45 offen  lds
    s_add_u32 s45, s46, 0x1f0000
    s_add_u32 m0, s47, 106496
    s_nop 0
    buffer_load_dwordx4 v21, s[24:27], s45 offen  lds
    s_add_u32 s45, s46, 0x1f8000
    s_add_u32 m0, s47, 110592
    s_nop 0
    buffer_load_dwordx4 v21, s[24:27], s45 offen  lds
    ds_read_b64_tr_b16 a[112:113], v24 offset:49152
    ds_read_b64_tr_b16 a[114:115], v24 offset:53248
    ds_read_b64_tr_b16 a[116:117], v24 offset:49184
    ds_read_b64_tr_b16 a[118:119], v24 offset:53280
    ds_read_b64_tr_b16 a[120:121], v24 offset:57344
    ds_read_b64_tr_b16 a[122:123], v24 offset:61440
    ds_read_b64_tr_b16 a[124:125], v24 offset:57376
    ds_read_b64_tr_b16 a[126:127], v24 offset:61472
    s_waitcnt lgkmcnt(0)
    s_waitcnt vmcnt(28)
    s_barrier
    ds_read_b64_tr_b16 a[128:129], v25 offset:0
    ds_read_b64_tr_b16 a[130:131], v25 offset:4096
    ds_read_b64_tr_b16 a[132:133], v25 offset:32
    ds_read_b64_tr_b16 a[134:135], v25 offset:4128
    ds_read_b64_tr_b16 a[136:137], v25 offset:8192
    ds_read_b64_tr_b16 a[138:139], v25 offset:12288
    ds_read_b64_tr_b16 a[140:141], v25 offset:8224
    ds_read_b64_tr_b16 a[142:143], v25 offset:12320
    s_waitcnt lgkmcnt(0)
    s_waitcnt vmcnt(24)
    s_barrier
    ds_read_b64_tr_b16 a[144:145], v23 offset:0
    ds_read_b64_tr_b16 a[146:147], v23 offset:4096
    ds_read_b64_tr_b16 a[148:149], v23 offset:32
    ds_read_b64_tr_b16 a[150:151], v23 offset:4128
    ds_read_b64_tr_b16 a[152:153], v23 offset:8192
    ds_read_b64_tr_b16 a[154:155], v23 offset:12288
    ds_read_b64_tr_b16 a[156:157], v23 offset:8224
    ds_read_b64_tr_b16 a[158:159], v23 offset:12320
    s_waitcnt lgkmcnt(0)
    s_waitcnt vmcnt(20)
    s_barrier
    ds_read_b64_tr_b16 a[160:161], v23 offset:16384
    ds_read_b64_tr_b16 a[162:163], v23 offset:20480
    ds_read_b64_tr_b16 a[164:165], v23 offset:16416
    ds_read_b64_tr_b16 a[166:167], v23 offset:20512
    ds_read_b64_tr_b16 a[168:169], v23 offset:24576
    ds_read_b64_tr_b16 a[170:171], v23 offset:28672
    ds_read_b64_tr_b16 a[172:173], v23 offset:24608
    ds_read_b64_tr_b16 a[174:175], v23 offset:28704
    s_waitcnt lgkmcnt(0)
    s_waitcnt vmcnt(16)
    s_barrier
    ds_read_b64_tr_b16 a[176:177], v23 offset:32768
    ds_read_b64_tr_b16 a[178:179], v23 offset:36864
    ds_read_b64_tr_b16 a[180:181], v23 offset:32800
    ds_read_b64_tr_b16 a[182:183], v23 offset:36896
    ds_read_b64_tr_b16 a[184:185], v23 offset:40960
    ds_read_b64_tr_b16 a[186:187], v23 offset:45056
    ds_read_b64_tr_b16 a[188:189], v23 offset:40992
    ds_read_b64_tr_b16 a[190:191], v23 offset:45088
    s_waitcnt lgkmcnt(0)
    s_waitcnt vmcnt(12)
    s_barrier
    ds_read_b64_tr_b16 a[192:193], v23 offset:49152
    ds_read_b64_tr_b16 a[194:195], v23 offset:53248
    ds_read_b64_tr_b16 a[196:197], v23 offset:49184
    ds_read_b64_tr_b16 a[198:199], v23 offset:53280
    ds_read_b64_tr_b16 a[200:201], v23 offset:57344
    ds_read_b64_tr_b16 a[202:203], v23 offset:61440
    ds_read_b64_tr_b16 a[204:205], v23 offset:57376
    ds_read_b64_tr_b16 a[206:207], v23 offset:61472
    s_waitcnt lgkmcnt(0)
    s_waitcnt vmcnt(8)
    s_barrier
    ds_read_b64_tr_b16 a[208:209], v24 offset:0
    ds_read_b64_tr_b16 a[210:211], v24 offset:4096
    ds_read_b64_tr_b16 a[212:213], v24 offset:32
    ds_read_b64_tr_b16 a[214:215], v24 offset:4128
    ds_read_b64_tr_b16 a[216:217], v24 offset:8192
    ds_read_b64_tr_b16 a[218:219], v24 offset:12288
    ds_read_b64_tr_b16 a[220:221], v24 offset:8224
    ds_read_b64_tr_b16 a[222:223], v24 offset:12320
    s_waitcnt lgkmcnt(0)
    s_waitcnt vmcnt(4)
    s_barrier
    ds_read_b64_tr_b16 a[224:225], v24 offset:16384
    ds_read_b64_tr_b16 a[226:227], v24 offset:20480
    ds_read_b64_tr_b16 a[228:229], v24 offset:16416
    ds_read_b64_tr_b16 a[230:231], v24 offset:20512
    ds_read_b64_tr_b16 a[232:233], v24 offset:24576
    ds_read_b64_tr_b16 a[234:235], v24 offset:28672
    ds_read_b64_tr_b16 a[236:237], v24 offset:24608
    ds_read_b64_tr_b16 a[238:239], v24 offset:28704
    s_waitcnt lgkmcnt(0)
    s_waitcnt vmcnt(0)
    s_barrier
    ds_read_b64_tr_b16 a[240:241], v24 offset:32768
    ds_read_b64_tr_b16 a[242:243], v24 offset:36864
    ds_read_b64_tr_b16 a[244:245], v24 offset:32800
    ds_read_b64_tr_b16 a[246:247], v24 offset:36896
    ds_read_b64_tr_b16 a[248:249], v24 offset:40960
    ds_read_b64_tr_b16 a[250:251], v24 offset:45056
    ds_read_b64_tr_b16 a[252:253], v24 offset:40992
    ds_read_b64_tr_b16 a[254:255], v24 offset:45088
    s_waitcnt lgkmcnt(0)
    s_barrier
    s_lshl_b32 s52, s38, 16
    s_add_u32 s52, s52, 0x5000000
    s_lshl_b32 s56, s38, 23
    s_lshl_b32 s45, s68, 9
    s_add_u32 s56, s56, s45
    s_add_u32 s56, s56, 0x8000000
    s_lshl_b32 s45, s40, 7
    s_add_u32 s45, s45, 127488
    v_mov_b32 v29, s45
    s_mov_b32 s46, 536870912
    s_mov_b64 exec, 1
    s_mov_b32 s70, 0
L_wp_127:
    buffer_load_dword v31, v29, s[12:15], 0 offen sc1
    s_add_u32 s70, s70, 1
    s_cmp_ge_u32 s70, 0x200000
    s_cbranch_scc1 L_w_done_96
    s_waitcnt vmcnt(0)
    v_cmp_gt_u32 vcc, s46, v31
    s_nop 1
    s_cbranch_vccz L_wp_127_ok
    s_sleep 2
    s_branch L_wp_127
L_wp_127_ok:
    s_mov_b64 exec, -1
    v_readfirstlane_b32 s45, v31
    s_nop 3
    s_and_b32 s46, s45, 511
    s_mul_i32 s46, s46, s46
    s_bfe_u32 s45, s45, 0xf0009
    s_lshl_b32 s45, s45, 5
    s_mov_b32 s80, s12
    s_mov_b32 s81, s13
    s_mov_b32 s83, 0x00020000
    s_mov_b32 s84, s12
    s_mov_b32 s85, s13
    s_mov_b32 s87, 0x00020000
    s_cmp_eq_u32 s45, s46
    s_cselect_b32 s82, s14, 0
    s_cselect_b32 s86, 0, s14
    s_sub_u32 s79, 3, s44
    s_mov_b32 s78, 0
    s_cmp_eq_u64 s[36:37], 0
    s_cbranch_scc1 L_xl_128
    s_ff1_i32_b64 s47, s[36:37]
    s_lshr_b64 s[74:75], s[72:73], s47
    s_ff1_i32_b64 s48, s[74:75]
    s_cmp_gt_u32 s79, s48
    s_cbranch_scc1 L_xl_128
    s_add_u32 s47, s47, s79
    s_cmp_lt_u32 s47, s78
    s_cbranch_scc1 L_xl_128_go
    s_lshl_b32 s45, s41, 7
    s_add_u32 s45, s45, 0x10010
    s_add_u32 s46, s47, 1
    s_mov_b64 exec, 7
    s_mov_b32 s70, 0
L_wp_129:
    buffer_load_dword v31, v12, s[12:15], s45 offen sc1
    s_add_u32 s70, s70, 1
    s_cmp_ge_u32 s70, 0x200000
    s_cbranch_scc1 L_w_done_96
    s_waitcnt vmcnt(0)
    v_cmp_gt_u32 vcc, s46, v31
    s_nop 1
    s_cbranch_vccz L_wp_129_ok
    s_sleep 2
    s_branch L_wp_129
L_wp_129_ok:
    s_mov_b64 exec, -1
    v_readlane_b32 s78, v31, 0
    v_readlane_b32 s45, v31, 1
    v_readlane_b32 s46, v31, 2
    s_nop 3
    s_min_u32 s78, s78, s45
    s_min_u32 s78, s78, s46
L_xl_128_go:
    s_lshl_b32 s45, s41, 19
    s_lshl_b32 s46, s47, 13
    s_add_u32 s45, s45, s46
    s_add_u32 s45, s45, 0x2000000
    s_add_u32 s46, s45, 4096
    s_add_u32 s48, s45, 16777216
    s_add_u32 s49, s48, 4096
    s_add_u32 s76, s48, 16777216
    s_add_u32 s77, s76, 4096
    buffer_load_dwordx4 v[96:99], v10, s[12:15], s76 offen offset:0 sc1
    buffer_load_dwordx4 v[128:131], v10, s[12:15], s45 offen offset:0 sc1
    buffer_load_dwordx4 v[160:163], v10, s[12:15], s48 offen offset:0 sc1
    buffer_load_dwordx4 v[100:103], v10, s[12:15], s76 offen offset:1024 sc1
    buffer_load_dwordx4 v[144:147], v10, s[12:15], s45 offen offset:1024 sc1
    buffer_load_dwordx4 v[176:179], v10, s[12:15], s48 offen offset:1024 sc1
    buffer_load_dwordx4 v[104:107], v10, s[12:15], s76 offen offset:2048 sc1
    buffer_load_dwordx4 v[132:135], v10, s[12:15], s45 offen offset:2048 sc1
    buffer_load_dwordx4 v[164:167], v10, s[12:15], s48 offen offset:2048 sc1
    buffer_load_dwordx4 v[108:111], v10, s[12:15], s76 offen offset:3072 sc1
    buffer_load_dwordx4 v[148:151], v10, s[12:15], s45 offen offset:3072 sc1
    buffer_load_dwordx4 v[180:183], v10, s[12:15], s48 offen offset:3072 sc1
    buffer_load_dwordx4 v[112:115], v10, s[12:15], s77 offen offset:0 sc1
    buffer_load_dwordx4 v[136:139], v10, s[12:15], s46 offen offset:0 sc1
    buffer_load_dwordx4 v[168:171], v10, s[12:15], s49 offen offset:0 sc1
    buffer_load_dwordx4 v[116:119], v10, s[12:15], s77 offen offset:1024 sc1
    buffer_load_dwordx4 v[152:155], v10, s[12:15], s46 offen offset:1024 sc1
    buffer_load_dwordx4 v[184:187], v10, s[12:15], s49 offen offset:1024 sc1
    buffer_load_dwordx4 v[120:123], v10, s[12:15], s77 offen offset:2048 sc1
    buffer_load_dwordx4 v[140:143], v10, s[12:15], s46 offen offset:2048 sc1
    buffer_load_dwordx4 v[172:175], v10, s[12:15], s49 offen offset:2048 sc1
    buffer_load_dwordx4 v[124:127], v10, s[12:15], s77 offen offset:3072 sc1
    buffer_load_dwordx4 v[156:159], v10, s[12:15], s46 offen offset:3072 sc1
    buffer_load_dwordx4 v[188:191], v10, s[12:15], s49 offen offset:3072 sc1
L_xl_128:
L_a_loop_125:
    s_cmp_eq_u64 s[36:37], 0
    s_cbranch_scc1 L_w_done_96
    s_ff1_i32_b64 s50, s[36:37]
    s_bitset0_b64 s[36:37], s50
    s_lshr_b64 s[74:75], s[72:73], s50
    s_ff1_i32_b64 s51, s[74:75]
    s_add_u32 s51, s51, 1
    s_add_u32 s62, s50, s51
    s_add_u32 s63, s50, s79
    s_cmp_ge_u32 s79, s51
    s_cbranch_scc1 L_xs1_130
    s_lshl_b32 s47, s44, 13
    v_add_u32 v18, s47, v10
    v_and_b32 v14, 15, v1
    v_lshrrev_b32 v16, 4, v1
    s_waitcnt vmcnt(0)
    ds_write_b128 v18, v[96:99] offset:0
    ds_write_b128 v18, v[100:103] offset:1024
    ds_write_b128 v18, v[104:107] offset:2048
    ds_write_b128 v18, v[108:111] offset:3072
    ds_write_b128 v18, v[112:115] offset:4096
    ds_write_b128 v18, v[116:119] offset:5120
    ds_write_b128 v18, v[120:123] offset:6144
    ds_write_b128 v18, v[124:127] offset:7168
    v_mfma_f32_16x16x32_bf16 v[32:35], v[160:163], v[128:131], 0
    v_mfma_f32_16x16x32_bf16 v[36:39], v[160:163], v[144:147], 0
    v_mfma_f32_16x16x32_bf16 v[44:47], v[176:179], v[144:147], 0
    v_mfma_f32_16x16x32_bf16 v[32:35], v[164:167], v[132:135], v[32:35]
    v_mfma_f32_16x16x32_bf16 v[36:39], v[164:167], v[148:151], v[36:39]
    v_mfma_f32_16x16x32_bf16 v[44:47], v[180:183], v[148:151], v[44:47]
    v_mfma_f32_16x16x32_bf16 v[32:35], v[168:171], v[136:139], v[32:35]
    v_mfma_f32_16x16x32_bf16 v[36:39], v[168:171], v[152:155], v[36:39]
    v_mfma_f32_16x16x32_bf16 v[44:47], v[184:187], v[152:155], v[44:47]
    v_mfma_f32_16x16x32_bf16 v[32:35], v[172:175], v[140:143], v[32:35]
    v_mfma_f32_16x16x32_bf16 v[36:39], v[172:175], v[156:159], v[36:39]
    v_mfma_f32_16x16x32_bf16 v[44:47], v[188:191], v[156:159], v[44:47]
    v_lshlrev_b32 v19, 2, v16
    v_lshrrev_b32 v20, 2, v1
    v_lshlrev_b32 v20, 4, v20
    v_and_b32 v21, 1, v1
    v_lshlrev_b32 v21, 3, v21
    v_add3_u32 v20, v20, v21, s47
    v_and_b32 v21, 2, v1
    v_lshlrev_b32 v21, 7, v21
    v_add_u32 v20, v20, v21
    v_mov_b32 v22, 0xff800000
    s_waitcnt lgkmcnt(0)
    ds_read_b64_tr_b16 v[208:209], v20 offset:0
    ds_read_b64_tr_b16 v[210:211], v20 offset:1024
    ds_read_b64_tr_b16 v[212:213], v20 offset:512
    ds_read_b64_tr_b16 v[214:215], v20 offset:1536
    ds_read_b64_tr_b16 v[216:217], v20 offset:2048
    ds_read_b64_tr_b16 v[218:219], v20 offset:3072
    ds_read_b64_tr_b16 v[220:221], v20 offset:2560
    ds_read_b64_tr_b16 v[222:223], v20 offset:3584
    ds_read_b64_tr_b16 v[224:225], v20 offset:4096
    ds_read_b64_tr_b16 v[226:227], v20 offset:5120
    ds_read_b64_tr_b16 v[228:229], v20 offset:4608
    ds_read_b64_tr_b16 v[230:231], v20 offset:5632
    ds_read_b64_tr_b16 v[232:233], v20 offset:6144
    ds_read_b64_tr_b16 v[234:235], v20 offset:7168
    ds_read_b64_tr_b16 v[236:237], v20 offset:6656
    ds_read_b64_tr_b16 v[238:239], v20 offset:7680
    v_add_u32 v21, 0, v19
    v_cmp_gt_u32 vcc, v21, v14
    s_nop 1
    v_cndmask_b32 v32, v32, v22, vcc
    v_cndmask_b32 v44, v44, v22, vcc
    v_add_u32 v21, 1, v19
    v_cmp_gt_u32 vcc, v21, v14
    s_nop 1
    v_cndmask_b32 v33, v33, v22, vcc
    v_cndmask_b32 v45, v45, v22, vcc
    v_add_u32 v21, 2, v19
    v_cmp_gt_u32 vcc, v21, v14
    s_nop 1
    v_cndmask_b32 v34, v34, v22, vcc
    v_cndmask_b32 v46, v46, v22, vcc
    v_add_u32 v21, 3, v19
    v_cmp_gt_u32 vcc, v21, v14
    s_nop 1
    v_cndmask_b32 v35, v35, v22, vcc
    v_cndmask_b32 v47, v47, v22, vcc
L_xs1_130:
    s_lshl_b32 s45, s41, 7
    s_add_u32 s45, s45, 0x11000
    s_cmp_lg_u32 s44, 0
    s_cbranch_scc1 L_pw_132
    s_mov_b64 exec, 255
    s_mov_b32 s70, 0
L_wp_133:
    buffer_load_dword v31, v12, s[12:15], s45 offen sc1
    s_add_u32 s70, s70, 1
    s_cmp_ge_u32 s70, 0x200000
    s_cbranch_scc1 L_w_done_96
    s_waitcnt vmcnt(0)
    v_cmp_gt_u32 vcc, s62, v31
    s_nop 1
    s_cbranch_vccz L_wp_133_ok
    s_sleep 2
    s_branch L_wp_133
L_wp_133_ok:
    s_mov_b64 exec, -1
L_pw_132:
    s_barrier
    s_cmp_ge_u32 s79, s51
    s_cbranch_scc1 L_xs2_131
    s_lshl_b32 s45, s63, 17
    s_lshl_b32 s46, s41, 12
    s_add_u32 s45, s45, s46
    s_lshr_b32 s46, s45, 1
    s_add_u32 s45, s45, 0x1000000
    s_add_u32 s46, s46, 0x1800000
    v_lshlrev_b32 v21, 3, v1
    buffer_load_dwordx4 v[192:195], v10, s[12:15], s45 offen offset:0 sc1
    buffer_load_dwordx4 v[196:199], v10, s[12:15], s45 offen offset:1024 sc1
    buffer_load_dwordx4 v[200:203], v10, s[12:15], s45 offen offset:2048 sc1
    buffer_load_dwordx4 v[204:207], v10, s[12:15], s45 offen offset:3072 sc1
    buffer_load_dwordx2 v[240:241], v21, s[12:15], s46 offen offset:0 sc1
    buffer_load_dwordx2 v[242:243], v21, s[12:15], s46 offen offset:512 sc1
    buffer_load_dwordx2 v[244:245], v21, s[12:15], s46 offen offset:1024 sc1
    buffer_load_dwordx2 v[246:247], v21, s[12:15], s46 offen offset:1536 sc1
    s_waitcnt vmcnt(4)
    v_mfma_f32_16x16x32_bf16 v[48:51], v[192:195], v[128:131], 0
    v_mfma_f32_16x16x32_bf16 v[52:55], v[192:195], v[144:147], 0
    v_mfma_f32_16x16x32_bf16 v[48:51], v[196:199], v[132:135], v[48:51]
    v_mfma_f32_16x16x32_bf16 v[52:55], v[196:199], v[148:151], v[52:55]
    v_mfma_f32_16x16x32_bf16 v[48:51], v[200:203], v[136:139], v[48:51]
    v_mfma_f32_16x16x32_bf16 v[52:55], v[200:203], v[152:155], v[52:55]
    v_mfma_f32_16x16x32_bf16 v[48:51], v[204:207], v[140:143], v[48:51]
    v_mfma_f32_16x16x32_bf16 v[52:55], v[204:207], v[156:159], v[52:55]
    s_mov_b32 s45, 0x3e0293ee
    s_nop 6
    v_permlane32_swap_b32 v48, v50
    v_permlane32_swap_b32 v49, v51
    v_pk_add_f32 v[48:49], v[48:49], v[50:51]
    v_permlane32_swap_b32 v52, v54
    v_permlane32_swap_b32 v53, v55
    v_pk_add_f32 v[52:53], v[52:53], v[54:55]
    v_max_f32 v22, v32, v33
    v_max3_f32 v22, v22, v34, v35
    v_max3_f32 v22, v22, v48, v49
    v_max_f32 v23, v36, v37
    v_max3_f32 v23, v23, v38, v39
    v_max3_f32 v23, v23, v44, v45
    v_max3_f32 v23, v23, v46, v47
    v_max3_f32 v23, v23, v52, v53
    v_mov_b32 v24, v22
    v_mov_b32 v25, v23
    s_nop 0
    v_permlane32_swap_b32 v22, v24
    v_permlane32_swap_b32 v23, v25
    v_max_f32 v22, v22, v24
    v_max_f32 v23, v23, v25
    v_mov_b32 v24, v22
    v_mov_b32 v25, v23
    s_nop 0
    v_permlane16_swap_b32 v22, v24
    v_permlane16_swap_b32 v23, v25
    v_max_f32 v22, v22, v24
    v_max_f32 v23, v23, v25
    v_mul_f32 v22, s45, v22
    v_mul_f32 v23, s45, v23
    v_fma_f32 v32, v32, s45, -v22
    v_fma_f32 v33, v33, s45, -v22
    v_fma_f32 v34, v34, s45, -v22
    v_fma_f32 v35, v35, s45, -v22
    v_fma_f32 v48, v48, s45, -v22
    v_fma_f32 v49, v49, s45, -v22
    v_exp_f32 v32, v32
    v_exp_f32 v33, v33
    v_exp_f32 v34, v34
    v_exp_f32 v35, v35
    v_exp_f32 v48, v48
    v_exp_f32 v49, v49
    v_fma_f32 v36, v36, s45, -v23
    v_fma_f32 v37, v37, s45, -v23
    v_fma_f32 v38, v38, s45, -v23
    v_fma_f32 v39, v39, s45, -v23
    v_fma_f32 v44, v44, s45, -v23
    v_fma_f32 v45, v45, s45, -v23
    v_fma_f32 v46, v46, s45, -v23
    v_fma_f32 v47, v47, s45, -v23
    v_fma_f32 v52, v52, s45, -v23
    v_fma_f32 v53, v53, s45, -v23
    v_exp_f32 v36, v36
    v_exp_f32 v37, v37
    v_exp_f32 v38, v38
    v_exp_f32 v39, v39
    v_exp_f32 v44, v44
    v_exp_f32 v45, v45
    v_exp_f32 v46, v46
    v_exp_f32 v47, v47
    v_exp_f32 v52, v52
    v_exp_f32 v53, v53
    v_add_f32 v22, v32, v33
    v_add_f32 v22, v22, v34
    v_add_f32 v22, v22, v35
    v_add_f32 v22, v22, v48
    v_add_f32 v22, v22, v49
    v_add_f32 v23, v36, v37
    v_add_f32 v23, v23, v38
    v_add_f32 v23, v23, v39
    v_add_f32 v23, v23, v44
    v_add_f32 v23, v23, v45
    v_add_f32 v23, v23, v46
    v_add_f32 v23, v23, v47
    v_add_f32 v23, v23, v52
    v_add_f32 v23, v23, v53
    v_mov_b32 v24, v22
    v_mov_b32 v25, v23
    s_nop 0
    v_permlane32_swap_b32 v22, v24
    v_permlane32_swap_b32 v23, v25
    v_add_f32 v22, v22, v24
    v_add_f32 v23, v23, v25
    v_mov_b32 v24, v22
    v_mov_b32 v25, v23
    s_nop 0
    v_permlane16_swap_b32 v22, v24
    v_permlane16_swap_b32 v23, v25
    v_add_f32 v22, v22, v24
    v_add_f32 v23, v23, v25
    v_rcp_f32 v22, v22
    v_rcp_f32 v23, v23
    s_nop 0
    v_mul_f32 v32, v32, v22
    v_mul_f32 v33, v33, v22
    v_mul_f32 v34, v34, v22
    v_mul_f32 v35, v35, v22
    v_mul_f32 v48, v48, v22
    v_mul_f32 v49, v49, v22
    v_mul_f32 v36, v36, v23
    v_mul_f32 v37, v37, v23
    v_mul_f32 v38, v38, v23
    v_mul_f32 v39, v39, v23
    v_mul_f32 v44, v44, v23
    v_mul_f32 v45, v45, v23
    v_mul_f32 v46, v46, v23
    v_mul_f32 v47, v47, v23
    v_mul_f32 v52, v52, v23
    v_mul_f32 v53, v53, v23
    v_cvt_pk_bf16_f32 v128, v32, v33
    v_cvt_pk_bf16_f32 v129, v34, v35
    v_mov_b32 v130, 0
    v_mov_b32 v131, 0
    v_cvt_pk_bf16_f32 v132, v48, v49
    v_mov_b32 v133, 0
    v_mov_b32 v134, 0
    v_cvt_pk_bf16_f32 v135, v48, v49
    v_cvt_pk_bf16_f32 v136, v36, v37
    v_cvt_pk_bf16_f32 v137, v38, v39
    v_cvt_pk_bf16_f32 v138, v44, v45
    v_cvt_pk_bf16_f32 v139, v46, v47
    v_cvt_pk_bf16_f32 v140, v52, v53
    v_mov_b32 v141, 0
    v_mov_b32 v142, 0
    v_cvt_pk_bf16_f32 v143, v52, v53
    s_waitcnt vmcnt(0) lgkmcnt(0)
    s_nop 0
    v_mfma_f32_16x16x32_bf16 v[64:67], v[208:211], v[128:131], 0
    v_mfma_f32_16x16x32_bf16 v[68:71], v[212:215], v[128:131], 0
    v_mfma_f32_16x16x32_bf16 v[72:75], v[216:219], v[128:131], 0
    v_mfma_f32_16x16x32_bf16 v[76:79], v[220:223], v[128:131], 0
    v_mfma_f32_16x16x32_bf16 v[80:83], v[224:227], v[128:131], 0
    v_mfma_f32_16x16x32_bf16 v[84:87], v[228:231], v[128:131], 0
    v_mfma_f32_16x16x32_bf16 v[88:91], v[232:235], v[128:131], 0
    v_mfma_f32_16x16x32_bf16 v[92:95], v[236:239], v[128:131], 0
    v_mfma_f32_16x16x16_bf16 v[64:67], v[240:241], v[132:133], v[64:67]
    v_mfma_f32_16x16x16_bf16 v[68:71], v[240:241], v[134:135], v[68:71]
    v_mfma_f32_16x16x16_bf16 v[72:75], v[242:243], v[132:133], v[72:75]
    v_mfma_f32_16x16x16_bf16 v[76:79], v[242:243], v[134:135], v[76:79]
    v_mfma_f32_16x16x16_bf16 v[80:83], v[244:245], v[132:133], v[80:83]
    v_mfma_f32_16x16x16_bf16 v[84:87], v[244:245], v[134:135], v[84:87]
    v_mfma_f32_16x16x16_bf16 v[88:91], v[246:247], v[132:133], v[88:91]
    v_mfma_f32_16x16x16_bf16 v[92:95], v[246:247], v[134:135], v[92:95]
    v_mfma_f32_16x16x32_bf16 v[96:99], v[208:211], v[136:139], 0
    v_mfma_f32_16x16x32_bf16 v[100:103], v[212:215], v[136:139], 0
    v_mfma_f32_16x16x32_bf16 v[104:107], v[216:219], v[136:139], 0
    v_mfma_f32_16x16x32_bf16 v[108:111], v[220:223], v[136:139], 0
    v_mfma_f32_16x16x32_bf16 v[112:115], v[224:227], v[136:139], 0
    v_mfma_f32_16x16x32_bf16 v[116:119], v[228:231], v[136:139], 0
    v_mfma_f32_16x16x32_bf16 v[120:123], v[232:235], v[136:139], 0
    v_mfma_f32_16x16x32_bf16 v[124:127], v[236:239], v[136:139], 0
    v_mfma_f32_16x16x16_bf16 v[96:99], v[240:241], v[140:141], v[96:99]
    v_mfma_f32_16x16x16_bf16 v[100:103], v[240:241], v[142:143], v[100:103]
    v_mfma_f32_16x16x16_bf16 v[104:107], v[242:243], v[140:141], v[104:107]
    v_mfma_f32_16x16x16_bf16 v[108:111], v[242:243], v[142:143], v[108:111]
    v_mfma_f32_16x16x16_bf16 v[112:115], v[244:245], v[140:141], v[112:115]
    v_mfma_f32_16x16x16_bf16 v[116:119], v[244:245], v[142:143], v[116:119]
    v_mfma_f32_16x16x16_bf16 v[120:123], v[246:247], v[140:141], v[120:123]
    v_mfma_f32_16x16x16_bf16 v[124:127], v[246:247], v[142:143], v[124:127]
    s_lshl_b32 s45, s63, 18
    s_lshl_b32 s46, s41, 13
    s_add_u32 s45, s45, s46
    s_add_u32 s45, s45, 0x5000000
    s_add_u32 s46, s45, 4096
    v_cvt_pk_bf16_f32 v64, v64, v65
    v_cvt_pk_bf16_f32 v65, v66, v67
    v_cvt_pk_bf16_f32 v66, v68, v69
    v_cvt_pk_bf16_f32 v67, v70, v71
    buffer_store_dwordx4 v[64:67], v10, s[12:15], s45 offen offset:0 sc1
    v_cvt_pk_bf16_f32 v72, v72, v73
    v_cvt_pk_bf16_f32 v73, v74, v75
    v_cvt_pk_bf16_f32 v74, v76, v77
    v_cvt_pk_bf16_f32 v75, v78, v79
    buffer_store_dwordx4 v[72:75], v10, s[12:15], s45 offen offset:2048 sc1
    v_cvt_pk_bf16_f32 v80, v80, v81
    v_cvt_pk_bf16_f32 v81, v82, v83
    v_cvt_pk_bf16_f32 v82, v84, v85
    v_cvt_pk_bf16_f32 v83, v86, v87
    buffer_store_dwordx4 v[80:83], v10, s[12:15], s46 offen offset:0 sc1
    v_cvt_pk_bf16_f32 v88, v88, v89
    v_cvt_pk_bf16_f32 v89, v90, v91
    v_cvt_pk_bf16_f32 v90, v92, v93
    v_cvt_pk_bf16_f32 v91, v94, v95
    buffer_store_dwordx4 v[88:91], v10, s[12:15], s46 offen offset:2048 sc1
    v_cvt_pk_bf16_f32 v96, v96, v97
    v_cvt_pk_bf16_f32 v97, v98, v99
    v_cvt_pk_bf16_f32 v98, v100, v101
    v_cvt_pk_bf16_f32 v99, v102, v103
    buffer_store_dwordx4 v[96:99], v10, s[12:15], s45 offen offset:1024 sc1
    v_cvt_pk_bf16_f32 v104, v104, v105
    v_cvt_pk_bf16_f32 v105, v106, v107
    v_cvt_pk_bf16_f32 v106, v108, v109
    v_cvt_pk_bf16_f32 v107, v110, v111
    buffer_store_dwordx4 v[104:107], v10, s[12:15], s45 offen offset:3072 sc1
    v_cvt_pk_bf16_f32 v112, v112, v113
    v_cvt_pk_bf16_f32 v113, v114, v115
    v_cvt_pk_bf16_f32 v114, v116, v117
    v_cvt_pk_bf16_f32 v115, v118, v119
    buffer_store_dwordx4 v[112:115], v10, s[12:15], s46 offen offset:1024 sc1
    v_cvt_pk_bf16_f32 v120, v120, v121
    v_cvt_pk_bf16_f32 v121, v122, v123
    v_cvt_pk_bf16_f32 v122, v124, v125
    v_cvt_pk_bf16_f32 v123, v126, v127
    buffer_store_dwordx4 v[120:123], v10, s[12:15], s46 offen offset:3072 sc1
L_xs2_131:
    s_waitcnt vmcnt(0)
    s_barrier
    s_cmp_lg_u32 s44, 0
    s_cbranch_scc1 L_pub_134
    v_mov_b32 v30, s62
    v_mov_b32 v31, 0
    s_mov_b64 exec, 1
    buffer_store_dword v30, v31, s[80:83], s65 offen
    buffer_store_dword v30, v31, s[84:87], s65 offen sc1
    s_mov_b64 exec, -1
L_pub_134:
    s_cmp_eq_u64 s[36:37], 0
    s_cbranch_scc1 L_xl_135
    s_ff1_i32_b64 s47, s[36:37]
    s_lshr_b64 s[74:75], s[72:73], s47
    s_ff1_i32_b64 s48, s[74:75]
    s_cmp_gt_u32 s79, s48
    s_cbranch_scc1 L_xl_135
    s_add_u32 s47, s47, s79
    s_cmp_lt_u32 s47, s78
    s_cbranch_scc1 L_xl_135_go
    s_lshl_b32 s45, s41, 7
    s_add_u32 s45, s45, 0x10010
    s_add_u32 s46, s47, 1
    s_mov_b64 exec, 7
    s_mov_b32 s70, 0
L_wp_136:
    buffer_load_dword v31, v12, s[12:15], s45 offen sc1
    s_add_u32 s70, s70, 1
    s_cmp_ge_u32 s70, 0x200000
    s_cbranch_scc1 L_w_done_96
    s_waitcnt vmcnt(0)
    v_cmp_gt_u32 vcc, s46, v31
    s_nop 1
    s_cbranch_vccz L_wp_136_ok
    s_sleep 2
    s_branch L_wp_136
L_wp_136_ok:
    s_mov_b64 exec, -1
    v_readlane_b32 s78, v31, 0
    v_readlane_b32 s45, v31, 1
    v_readlane_b32 s46, v31, 2
    s_nop 3
    s_min_u32 s78, s78, s45
    s_min_u32 s78, s78, s46
L_xl_135_go:
    s_lshl_b32 s45, s41, 19
    s_lshl_b32 s46, s47, 13
    s_add_u32 s45, s45, s46
    s_add_u32 s45, s45, 0x2000000
    s_add_u32 s46, s45, 4096
    s_add_u32 s48, s45, 16777216
    s_add_u32 s49, s48, 4096
    s_add_u32 s76, s48, 16777216
    s_add_u32 s77, s76, 4096
    buffer_load_dwordx4 v[96:99], v10, s[12:15], s76 offen offset:0 sc1
    buffer_load_dwordx4 v[128:131], v10, s[12:15], s45 offen offset:0 sc1
    buffer_load_dwordx4 v[160:163], v10, s[12:15], s48 offen offset:0 sc1
    buffer_load_dwordx4 v[100:103], v10, s[12:15], s76 offen offset:1024 sc1
    buffer_load_dwordx4 v[144:147], v10, s[12:15], s45 offen offset:1024 sc1
    buffer_load_dwordx4 v[176:179], v10, s[12:15], s48 offen offset:1024 sc1
    buffer_load_dwordx4 v[104:107], v10, s[12:15], s76 offen offset:2048 sc1
    buffer_load_dwordx4 v[132:135], v10, s[12:15], s45 offen offset:2048 sc1
    buffer_load_dwordx4 v[164:167], v10, s[12:15], s48 offen offset:2048 sc1
    buffer_load_dwordx4 v[108:111], v10, s[12:15], s76 offen offset:3072 sc1
    buffer_load_dwordx4 v[148:151], v10, s[12:15], s45 offen offset:3072 sc1
    buffer_load_dwordx4 v[180:183], v10, s[12:15], s48 offen offset:3072 sc1
    buffer_load_dwordx4 v[112:115], v10, s[12:15], s77 offen offset:0 sc1
    buffer_load_dwordx4 v[136:139], v10, s[12:15], s46 offen offset:0 sc1
    buffer_load_dwordx4 v[168:171], v10, s[12:15], s49 offen offset:0 sc1
    buffer_load_dwordx4 v[116:119], v10, s[12:15], s77 offen offset:1024 sc1
    buffer_load_dwordx4 v[152:155], v10, s[12:15], s46 offen offset:1024 sc1
    buffer_load_dwordx4 v[184:187], v10, s[12:15], s49 offen offset:1024 sc1
    buffer_load_dwordx4 v[120:123], v10, s[12:15], s77 offen offset:2048 sc1
    buffer_load_dwordx4 v[140:143], v10, s[12:15], s46 offen offset:2048 sc1
    buffer_load_dwordx4 v[172:175], v10, s[12:15], s49 offen offset:2048 sc1
    buffer_load_dwordx4 v[124:127], v10, s[12:15], s77 offen offset:3072 sc1
    buffer_load_dwordx4 v[156:159], v10, s[12:15], s46 offen offset:3072 sc1
    buffer_load_dwordx4 v[188:191], v10, s[12:15], s49 offen offset:3072 sc1
L_xl_135:
    s_lshl_b32 s45, s38, 10
    s_add_u32 s45, s45, s64
    s_cmp_lg_u32 s44, 0
    s_cbranch_scc1 L_pw_137
    s_mov_b64 exec, 255
    s_mov_b32 s70, 0
L_wp_138:
    buffer_load_dword v31, v5, s[12:15], s45 offen sc1
    s_add_u32 s70, s70, 1
    s_cmp_ge_u32 s70, 0x200000
    s_cbranch_scc1 L_w_done_96
    s_waitcnt vmcnt(0)
    v_cmp_gt_u32 vcc, s62, v31
    s_nop 1
    s_cbranch_vccz L_wp_138_ok
    s_sleep 1
    s_branch L_wp_138
L_wp_138_ok:
    s_mov_b64 exec, -1
L_pw_137:
    s_barrier
    s_mul_i32 s53, s50, 262144
    s_add_u32 s53, s53, s52
    s_lshl_b32 s54, s44, 13
    s_add_u32 s53, s53, s54
    s_mul_i32 s57, s50, 131072
    s_add_u32 s57, s57, s56
    s_lshl_b32 s45, s44, 7
    s_add_u32 s57, s57, s45
    s_add_u32 s55, s54, 65536
    s_mov_b32 s58, 0
    v_mov_b32 v13, v10
    v_add_u32 v14, 65536, v13
    v_xor_b32 v15, 64, v13
    v_xor_b32 v16, 64, v14
    s_mov_b32 s76, 0x20000000
    s_add_u32 s48, s53, 0
    s_add_u32 s49, s48, 4096
    s_add_u32 m0, s54, 0
    s_nop 0
    buffer_load_dwordx4 v10, s[12:15], s48 offen offset:0 sc1 lds
    buffer_load_dwordx4 v10, s[12:15], s48 offen offset:1024 sc1 lds
    buffer_load_dwordx4 v10, s[12:15], s48 offen offset:2048 sc1 lds
    buffer_load_dwordx4 v10, s[12:15], s48 offen offset:3072 sc1 lds
    s_add_u32 m0, s54, 4096
    s_nop 0
    buffer_load_dwordx4 v10, s[12:15], s49 offen offset:0 sc1 lds
    buffer_load_dwordx4 v10, s[12:15], s49 offen offset:1024 sc1 lds
    buffer_load_dwordx4 v10, s[12:15], s49 offen offset:2048 sc1 lds
    buffer_load_dwordx4 v10, s[12:15], s49 offen offset:3072 sc1 lds
    s_add_u32 s48, s53, 32768
    s_add_u32 s49, s48, 4096
    s_add_u32 s46, s54, 32768
    s_add_u32 m0, s46, 0
    s_nop 0
    buffer_load_dwordx4 v10, s[12:15], s48 offen offset:0 sc1 lds
    buffer_load_dwordx4 v10, s[12:15], s48 offen offset:1024 sc1 lds
    buffer_load_dwordx4 v10, s[12:15], s48 offen offset:2048 sc1 lds
    buffer_load_dwordx4 v10, s[12:15], s48 offen offset:3072 sc1 lds
    s_add_u32 m0, s46, 4096
    s_nop 0
    buffer_load_dwordx4 v10, s[12:15], s49 offen offset:0 sc1 lds
    buffer_load_dwordx4 v10, s[12:15], s49 offen offset:1024 sc1 lds
    buffer_load_dwordx4 v10, s[12:15], s49 offen offset:2048 sc1 lds
    buffer_load_dwordx4 v10, s[12:15], s49 offen offset:3072 sc1 lds
    s_cmp_eq_u32 s51, 1
    s_cbranch_scc1 L_e_one_140
    s_add_u32 s48, s53, 262144
    s_add_u32 s49, s48, 4096
    s_add_u32 m0, s55, 0
    s_nop 0
    buffer_load_dwordx4 v10, s[12:15], s48 offen offset:0 sc1 lds
    buffer_load_dwordx4 v10, s[12:15], s48 offen offset:1024 sc1 lds
    buffer_load_dwordx4 v10, s[12:15], s48 offen offset:2048 sc1 lds
    buffer_load_dwordx4 v10, s[12:15], s48 offen offset:3072 sc1 lds
    s_add_u32 m0, s55, 4096
    s_nop 0
    buffer_load_dwordx4 v10, s[12:15], s49 offen offset:0 sc1 lds
    buffer_load_dwordx4 v10, s[12:15], s49 offen offset:1024 sc1 lds
    buffer_load_dwordx4 v10, s[12:15], s49 offen offset:2048 sc1 lds
    buffer_load_dwordx4 v10, s[12:15], s49 offen offset:3072 sc1 lds
    s_waitcnt vmcnt(16)
    s_barrier
    ds_read_b128 v[32:35], v13 offset:0
    ds_read_b128 v[36:39], v13 offset:1024
    ds_read_b128 v[40:43], v13 offset:2048
    ds_read_b128 v[44:47], v13 offset:3072
L_e_loop_139:
    s_add_u32 s48, s53, 294912
    s_add_u32 s46, s58, 1
    s_cmp_lt_u32 s46, s51
    s_cselect_b32 s48, s48, 0x20000000
    s_add_u32 s49, s48, 4096
    s_add_u32 s59, s55, 32768
    s_waitcnt lgkmcnt(2)
    v_mfma_f32_16x16x32_bf16 v[80:83], a[0:3], v[32:35], 0
    ds_read_b128 v[48:51], v13 offset:4096
    ds_read_b128 v[52:55], v13 offset:5120
    v_mfma_f32_16x16x32_bf16 v[84:87], a[4:7], v[32:35], 0
    ds_read_b128 v[56:59], v13 offset:6144
    ds_read_b128 v[60:63], v13 offset:7168
    v_mfma_f32_16x16x32_bf16 v[88:91], a[0:3], v[36:39], 0
    s_add_u32 m0, s59, 0
    s_nop 0
    buffer_load_dwordx4 v10, s[12:15], s48 offen offset:0 sc1 lds
    v_mfma_f32_16x16x32_bf16 v[92:95], a[4:7], v[36:39], 0
    s_waitcnt lgkmcnt(4)
    v_mfma_f32_16x16x32_bf16 v[80:83], a[8:11], v[40:43], v[80:83]
    ds_read_b128 v[32:35], v13 offset:8192
    ds_read_b128 v[36:39], v13 offset:9216
    v_mfma_f32_16x16x32_bf16 v[84:87], a[12:15], v[40:43], v[84:87]
    v_mfma_f32_16x16x32_bf16 v[88:91], a[8:11], v[44:47], v[88:91]
    buffer_load_dwordx4 v10, s[12:15], s48 offen offset:1024 sc1 lds
    v_mfma_f32_16x16x32_bf16 v[92:95], a[12:15], v[44:47], v[92:95]
    s_waitcnt lgkmcnt(4)
    v_mfma_f32_16x16x32_bf16 v[80:83], a[16:19], v[48:51], v[80:83]
    ds_read_b128 v[40:43], v13 offset:10240
    ds_read_b128 v[44:47], v13 offset:11264
    v_mfma_f32_16x16x32_bf16 v[84:87], a[20:23], v[48:51], v[84:87]
    v_mfma_f32_16x16x32_bf16 v[88:91], a[16:19], v[52:55], v[88:91]
    buffer_load_dwordx4 v10, s[12:15], s48 offen offset:2048 sc1 lds
    v_mfma_f32_16x16x32_bf16 v[92:95], a[20:23], v[52:55], v[92:95]
    s_waitcnt lgkmcnt(4)
    v_mfma_f32_16x16x32_bf16 v[80:83], a[24:27], v[56:59], v[80:83]
    ds_read_b128 v[48:51], v13 offset:12288
    ds_read_b128 v[52:55], v13 offset:13312
    v_mfma_f32_16x16x32_bf16 v[84:87], a[28:31], v[56:59], v[84:87]
    v_mfma_f32_16x16x32_bf16 v[88:91], a[24:27], v[60:63], v[88:91]
    buffer_load_dwordx4 v10, s[12:15], s48 offen offset:3072 sc1 lds
    v_mfma_f32_16x16x32_bf16 v[92:95], a[28:31], v[60:63], v[92:95]
    s_waitcnt lgkmcnt(4)
    v_mfma_f32_16x16x32_bf16 v[80:83], a[32:35], v[32:35], v[80:83]
    ds_read_b128 v[56:59], v13 offset:14336
    ds_read_b128 v[60:63], v13 offset:15360
    v_mfma_f32_16x16x32_bf16 v[84:87], a[36:39], v[32:35], v[84:87]
    v_mfma_f32_16x16x32_bf16 v[88:91], a[32:35], v[36:39], v[88:91]
    s_add_u32 m0, s59, 4096
    s_nop 0
    buffer_load_dwordx4 v10, s[12:15], s49 offen offset:0 sc1 lds
    v_mfma_f32_16x16x32_bf16 v[92:95], a[36:39], v[36:39], v[92:95]
    s_waitcnt lgkmcnt(4)
    v_mfma_f32_16x16x32_bf16 v[80:83], a[40:43], v[40:43], v[80:83]
    ds_read_b128 v[32:35], v13 offset:16384
    ds_read_b128 v[36:39], v13 offset:17408
    v_mfma_f32_16x16x32_bf16 v[84:87], a[44:47], v[40:43], v[84:87]
    v_mfma_f32_16x16x32_bf16 v[88:91], a[40:43], v[44:47], v[88:91]
    buffer_load_dwordx4 v10, s[12:15], s49 offen offset:1024 sc1 lds
    v_mfma_f32_16x16x32_bf16 v[92:95], a[44:47], v[44:47], v[92:95]
    s_waitcnt lgkmcnt(4)
    v_mfma_f32_16x16x32_bf16 v[80:83], a[48:51], v[48:51], v[80:83]
    ds_read_b128 v[40:43], v13 offset:18432
    ds_read_b128 v[44:47], v13 offset:19456
    v_mfma_f32_16x16x32_bf16 v[84:87], a[52:55], v[48:51], v[84:87]
    v_mfma_f32_16x16x32_bf16 v[88:91], a[48:51], v[52:55], v[88:91]
    buffer_load_dwordx4 v10, s[12:15], s49 offen offset:2048 sc1 lds
    v_mfma_f32_16x16x32_bf16 v[92:95], a[52:55], v[52:55], v[92:95]
    s_waitcnt lgkmcnt(4)
    v_mfma_f32_16x16x32_bf16 v[80:83], a[56:59], v[56:59], v[80:83]
    ds_read_b128 v[48:51], v13 offset:20480
    ds_read_b128 v[52:55], v13 offset:21504
    v_mfma_f32_16x16x32_bf16 v[84:87], a[60:63], v[56:59], v[84:87]
    v_mfma_f32_16x16x32_bf16 v[88:91], a[56:59], v[60:63], v[88:91]
    buffer_load_dwordx4 v10, s[12:15], s49 offen offset:3072 sc1 lds
    v_mfma_f32_16x16x32_bf16 v[92:95], a[60:63], v[60:63], v[92:95]
    s_waitcnt lgkmcnt(4)
    v_mfma_f32_16x16x32_bf16 v[80:83], a[64:67], v[32:35], v[80:83]
    ds_read_b128 v[56:59], v13 offset:22528
    ds_read_b128 v[60:63], v13 offset:23552
    v_mfma_f32_16x16x32_bf16 v[84:87], a[68:71], v[32:35], v[84:87]
    v_mfma_f32_16x16x32_bf16 v[88:91], a[64:67], v[36:39], v[88:91]
    v_mfma_f32_16x16x32_bf16 v[92:95], a[68:71], v[36:39], v[92:95]
    s_waitcnt lgkmcnt(4)
    v_mfma_f32_16x16x32_bf16 v[80:83], a[72:75], v[40:43], v[80:83]
    ds_read_b128 v[32:35], v13 offset:24576
    ds_read_b128 v[36:39], v13 offset:25600
    v_mfma_f32_16x16x32_bf16 v[84:87], a[76:79], v[40:43], v[84:87]
    v_mfma_f32_16x16x32_bf16 v[88:91], a[72:75], v[44:47], v[88:91]
    v_mfma_f32_16x16x32_bf16 v[92:95], a[76:79], v[44:47], v[92:95]
    s_waitcnt lgkmcnt(4)
    v_mfma_f32_16x16x32_bf16 v[80:83], a[80:83], v[48:51], v[80:83]
    ds_read_b128 v[40:43], v13 offset:26624
    ds_read_b128 v[44:47], v13 offset:27648
    v_mfma_f32_16x16x32_bf16 v[84:87], a[84:87], v[48:51], v[84:87]
    v_mfma_f32_16x16x32_bf16 v[88:91], a[80:83], v[52:55], v[88:91]
    v_mfma_f32_16x16x32_bf16 v[92:95], a[84:87], v[52:55], v[92:95]
    s_waitcnt lgkmcnt(4)
    v_mfma_f32_16x16x32_bf16 v[80:83], a[88:91], v[56:59], v[80:83]
    ds_read_b128 v[48:51], v13 offset:28672
    ds_read_b128 v[52:55], v13 offset:29696
    v_mfma_f32_16x16x32_bf16 v[84:87], a[92:95], v[56:59], v[84:87]
    v_mfma_f32_16x16x32_bf16 v[88:91], a[88:91], v[60:63], v[88:91]
    v_mfma_f32_16x16x32_bf16 v[92:95], a[92:95], v[60:63], v[92:95]
    s_waitcnt lgkmcnt(4)
    v_mfma_f32_16x16x32_bf16 v[80:83], a[96:99], v[32:35], v[80:83]
    ds_read_b128 v[56:59], v13 offset:30720
    ds_read_b128 v[60:63], v13 offset:31744
    v_mfma_f32_16x16x32_bf16 v[84:87], a[100:103], v[32:35], v[84:87]
    v_mfma_f32_16x16x32_bf16 v[88:91], a[96:99], v[36:39], v[88:91]
    v_mfma_f32_16x16x32_bf16 v[92:95], a[100:103], v[36:39], v[92:95]
    s_waitcnt lgkmcnt(4)
    v_mfma_f32_16x16x32_bf16 v[80:83], a[104:107], v[40:43], v[80:83]
    ds_read_b128 v[216:219], v8 offset:0
    ds_read_b128 v[220:223], v8 offset:1152
    v_mfma_f32_16x16x32_bf16 v[84:87], a[108:111], v[40:43], v[84:87]
    ds_read_b128 v[224:227], v8 offset:2304
    ds_read_b128 v[228:231], v8 offset:3456
    v_mfma_f32_16x16x32_bf16 v[88:91], a[104:107], v[44:47], v[88:91]
    v_mfma_f32_16x16x32_bf16 v[92:95], a[108:111], v[44:47], v[92:95]
    s_waitcnt vmcnt(16) lgkmcnt(0)
    s_barrier
    v_mfma_f32_16x16x32_bf16 v[80:83], a[112:115], v[48:51], v[80:83]
    ds_read_b128 v[32:35], v13 offset:32768
    ds_read_b128 v[36:39], v13 offset:33792
    v_mfma_f32_16x16x32_bf16 v[84:87], a[116:119], v[48:51], v[84:87]
    buffer_store_dwordx4 v[216:219], v11, s[12:15], s76 offen sc1
    v_mfma_f32_16x16x32_bf16 v[88:91], a[112:115], v[52:55], v[88:91]
    s_add_u32 s76, s76, 32768
    v_mfma_f32_16x16x32_bf16 v[92:95], a[116:119], v[52:55], v[92:95]
    buffer_store_dwordx4 v[220:223], v11, s[12:15], s76 offen sc1
    v_mfma_f32_16x16x32_bf16 v[80:83], a[120:123], v[56:59], v[80:83]
    ds_read_b128 v[40:43], v13 offset:34816
    ds_read_b128 v[44:47], v13 offset:35840
    v_mfma_f32_16x16x32_bf16 v[84:87], a[124:127], v[56:59], v[84:87]
    s_add_u32 s76, s76, 32768
    v_mfma_f32_16x16x32_bf16 v[88:91], a[120:123], v[60:63], v[88:91]
    buffer_store_dwordx4 v[224:227], v11, s[12:15], s76 offen sc1
    v_mfma_f32_16x16x32_bf16 v[92:95], a[124:127], v[60:63], v[92:95]
    s_add_u32 s76, s76, 32768
    s_add_u32 s48, s53, 524288
    s_add_u32 s46, s58, 2
    s_cmp_lt_u32 s46, s51
    s_cselect_b32 s48, s48, 0x20000000
    s_add_u32 s49, s48, 4096
    s_mov_b32 s59, s54
    s_waitcnt lgkmcnt(2)
    v_mfma_f32_16x16x32_bf16 v[80:83], a[128:131], v[32:35], v[80:83]
    ds_read_b128 v[48:51], v13 offset:36864
    ds_read_b128 v[52:55], v13 offset:37888
    v_mfma_f32_16x16x32_bf16 v[84:87], a[132:135], v[32:35], v[84:87]
    ds_read_b128 v[56:59], v13 offset:38912
    ds_read_b128 v[60:63], v13 offset:39936
    v_mfma_f32_16x16x32_bf16 v[88:91], a[128:131], v[36:39], v[88:91]
    s_add_u32 m0, s59, 0
    s_nop 0
    buffer_load_dwordx4 v10, s[12:15], s48 offen offset:0 sc1 lds
    v_mfma_f32_16x16x32_bf16 v[92:95], a[132:135], v[36:39], v[92:95]
    buffer_store_dwordx4 v[228:231], v11, s[12:15], s76 offen sc1
    s_waitcnt lgkmcnt(4)
    v_mfma_f32_16x16x32_bf16 v[80:83], a[136:139], v[40:43], v[80:83]
    ds_read_b128 v[32:35], v13 offset:40960
    ds_read_b128 v[36:39], v13 offset:41984
    v_mfma_f32_16x16x32_bf16 v[84:87], a[140:143], v[40:43], v[84:87]
    v_mfma_f32_16x16x32_bf16 v[88:91], a[136:139], v[44:47], v[88:91]
    buffer_load_dwordx4 v10, s[12:15], s48 offen offset:1024 sc1 lds
    v_mfma_f32_16x16x32_bf16 v[92:95], a[140:143], v[44:47], v[92:95]
    s_waitcnt lgkmcnt(4)
    v_mfma_f32_16x16x32_bf16 v[80:83], a[144:147], v[48:51], v[80:83]
    ds_read_b128 v[40:43], v13 offset:43008
    ds_read_b128 v[44:47], v13 offset:44032
    v_mfma_f32_16x16x32_bf16 v[84:87], a[148:151], v[48:51], v[84:87]
    v_mfma_f32_16x16x32_bf16 v[88:91], a[144:147], v[52:55], v[88:91]
    buffer_load_dwordx4 v10, s[12:15], s48 offen offset:2048 sc1 lds
    v_mfma_f32_16x16x32_bf16 v[92:95], a[148:151], v[52:55], v[92:95]
    s_waitcnt lgkmcnt(4)
    v_mfma_f32_16x16x32_bf16 v[80:83], a[152:155], v[56:59], v[80:83]
    ds_read_b128 v[48:51], v13 offset:45056
    ds_read_b128 v[52:55], v13 offset:46080
    v_mfma_f32_16x16x32_bf16 v[84:87], a[156:159], v[56:59], v[84:87]
    v_mfma_f32_16x16x32_bf16 v[88:91], a[152:155], v[60:63], v[88:91]
    buffer_load_dwordx4 v10, s[12:15], s48 offen offset:3072 sc1 lds
    v_mfma_f32_16x16x32_bf16 v[92:95], a[156:159], v[60:63], v[92:95]
    s_waitcnt lgkmcnt(4)
    v_mfma_f32_16x16x32_bf16 v[80:83], a[160:163], v[32:35], v[80:83]
    ds_read_b128 v[56:59], v13 offset:47104
    ds_read_b128 v[60:63], v13 offset:48128
    v_mfma_f32_16x16x32_bf16 v[84:87], a[164:167], v[32:35], v[84:87]
    v_mfma_f32_16x16x32_bf16 v[88:91], a[160:163], v[36:39], v[88:91]
    s_add_u32 m0, s59, 4096
    s_nop 0
    buffer_load_dwordx4 v10, s[12:15], s49 offen offset:0 sc1 lds
    v_mfma_f32_16x16x32_bf16 v[92:95], a[164:167], v[36:39], v[92:95]
    s_waitcnt lgkmcnt(4)
    v_mfma_f32_16x16x32_bf16 v[80:83], a[168:171], v[40:43], v[80:83]
    ds_read_b128 v[32:35], v13 offset:49152
    ds_read_b128 v[36:39], v13 offset:50176
    v_mfma_f32_16x16x32_bf16 v[84:87], a[172:175], v[40:43], v[84:87]
    v_mfma_f32_16x16x32_bf16 v[88:91], a[168:171], v[44:47], v[88:91]
    buffer_load_dwordx4 v10, s[12:15], s49 offen offset:1024 sc1 lds
    v_mfma_f32_16x16x32_bf16 v[92:95], a[172:175], v[44:47], v[92:95]
    s_waitcnt lgkmcnt(4)
    v_mfma_f32_16x16x32_bf16 v[80:83], a[176:179], v[48:51], v[80:83]
    ds_read_b128 v[40:43], v13 offset:51200
    ds_read_b128 v[44:47], v13 offset:52224
    v_mfma_f32_16x16x32_bf16 v[84:87], a[180:183], v[48:51], v[84:87]
    v_mfma_f32_16x16x32_bf16 v[88:91], a[176:179], v[52:55], v[88:91]
    buffer_load_dwordx4 v10, s[12:15], s49 offen offset:2048 sc1 lds
    v_mfma_f32_16x16x32_bf16 v[92:95], a[180:183], v[52:55], v[92:95]
    s_waitcnt lgkmcnt(4)
    v_mfma_f32_16x16x32_bf16 v[80:83], a[184:187], v[56:59], v[80:83]
    ds_read_b128 v[48:51], v13 offset:53248
    ds_read_b128 v[52:55], v13 offset:54272
    v_mfma_f32_16x16x32_bf16 v[84:87], a[188:191], v[56:59], v[84:87]
    v_mfma_f32_16x16x32_bf16 v[88:91], a[184:187], v[60:63], v[88:91]
    buffer_load_dwordx4 v10, s[12:15], s49 offen offset:3072 sc1 lds
    v_mfma_f32_16x16x32_bf16 v[92:95], a[188:191], v[60:63], v[92:95]
    s_waitcnt lgkmcnt(4)
    v_mfma_f32_16x16x32_bf16 v[80:83], a[192:195], v[32:35], v[80:83]
    ds_read_b128 v[56:59], v13 offset:55296
    ds_read_b128 v[60:63], v13 offset:56320
    v_mfma_f32_16x16x32_bf16 v[84:87], a[196:199], v[32:35], v[84:87]
    v_mfma_f32_16x16x32_bf16 v[88:91], a[192:195], v[36:39], v[88:91]
    v_mfma_f32_16x16x32_bf16 v[92:95], a[196:199], v[36:39], v[92:95]
    s_waitcnt lgkmcnt(4)
    v_mfma_f32_16x16x32_bf16 v[80:83], a[200:203], v[40:43], v[80:83]
    ds_read_b128 v[32:35], v13 offset:57344
    ds_read_b128 v[36:39], v13 offset:58368
    v_mfma_f32_16x16x32_bf16 v[84:87], a[204:207], v[40:43], v[84:87]
    v_mfma_f32_16x16x32_bf16 v[88:91], a[200:203], v[44:47], v[88:91]
    v_mfma_f32_16x16x32_bf16 v[92:95], a[204:207], v[44:47], v[92:95]
    s_waitcnt lgkmcnt(4)
    v_mfma_f32_16x16x32_bf16 v[80:83], a[208:211], v[48:51], v[80:83]
    ds_read_b128 v[40:43], v13 offset:59392
    ds_read_b128 v[44:47], v13 offset:60416
    v_mfma_f32_16x16x32_bf16 v[84:87], a[212:215], v[48:51], v[84:87]
    v_mfma_f32_16x16x32_bf16 v[88:91], a[208:211], v[52:55], v[88:91]
    v_mfma_f32_16x16x32_bf16 v[92:95], a[212:215], v[52:55], v[92:95]
    s_waitcnt lgkmcnt(4)
    v_mfma_f32_16x16x32_bf16 v[80:83], a[216:219], v[56:59], v[80:83]
    ds_read_b128 v[48:51], v13 offset:61440
    ds_read_b128 v[52:55], v13 offset:62464
    v_mfma_f32_16x16x32_bf16 v[84:87], a[220:223], v[56:59], v[84:87]
    v_mfma_f32_16x16x32_bf16 v[88:91], a[216:219], v[60:63], v[88:91]
    v_mfma_f32_16x16x32_bf16 v[92:95], a[220:223], v[60:63], v[92:95]
    s_waitcnt lgkmcnt(4)
    v_mfma_f32_16x16x32_bf16 v[80:83], a[224:227], v[32:35], v[80:83]
    ds_read_b128 v[56:59], v13 offset:63488
    ds_read_b128 v[60:63], v13 offset:64512
    v_mfma_f32_16x16x32_bf16 v[84:87], a[228:231], v[32:35], v[84:87]
    v_mfma_f32_16x16x32_bf16 v[88:91], a[224:227], v[36:39], v[88:91]
    v_mfma_f32_16x16x32_bf16 v[92:95], a[228:231], v[36:39], v[92:95]
    s_waitcnt lgkmcnt(4)
    v_mfma_f32_16x16x32_bf16 v[80:83], a[232:235], v[40:43], v[80:83]
    v_mfma_f32_16x16x32_bf16 v[84:87], a[236:239], v[40:43], v[84:87]
    v_mfma_f32_16x16x32_bf16 v[88:91], a[232:235], v[44:47], v[88:91]
    v_mfma_f32_16x16x32_bf16 v[92:95], a[236:239], v[44:47], v[92:95]
    s_waitcnt vmcnt(16) lgkmcnt(0)
    s_barrier
    v_mfma_f32_16x16x32_bf16 v[80:83], a[240:243], v[48:51], v[80:83]
    ds_read_b128 v[32:35], v14 offset:0
    ds_read_b128 v[36:39], v14 offset:1024
    v_mfma_f32_16x16x32_bf16 v[84:87], a[244:247], v[48:51], v[84:87]
    v_mfma_f32_16x16x32_bf16 v[88:91], a[240:243], v[52:55], v[88:91]
    v_mfma_f32_16x16x32_bf16 v[92:95], a[244:247], v[52:55], v[92:95]
    v_mfma_f32_16x16x32_bf16 v[80:83], a[248:251], v[56:59], v[80:83]
    ds_read_b128 v[40:43], v14 offset:2048
    ds_read_b128 v[44:47], v14 offset:3072
    v_mfma_f32_16x16x32_bf16 v[84:87], a[252:255], v[56:59], v[84:87]
    v_mfma_f32_16x16x32_bf16 v[88:91], a[248:251], v[60:63], v[88:91]
    v_mfma_f32_16x16x32_bf16 v[92:95], a[252:255], v[60:63], v[92:95]
    s_add_u32 s53, s53, 262144
    s_add_u32 s58, s58, 1
    v_swap_b32 v13, v14
    s_xor_b32 s54, s54, 65536
    s_xor_b32 s55, s55, 65536
    s_mov_b32 s76, s57
    v_swap_b32 v15, v16
    s_add_u32 s57, s57, 131072
    ds_write_b128 v7, v[80:83] offset:0
    ds_write_b128 v7, v[84:87] offset:64
    ds_write_b128 v7, v[88:91] offset:2304
    ds_write_b128 v7, v[92:95] offset:2368
    s_cmp_lt_u32 s58, s51
    s_cbranch_scc1 L_e_loop_139
    s_branch L_e_fin_141
L_e_one_140:
    s_waitcnt vmcnt(8)
    s_barrier
    ds_read_b128 v[32:35], v13 offset:0
    ds_read_b128 v[36:39], v13 offset:1024
    ds_read_b128 v[40:43], v13 offset:2048
    ds_read_b128 v[44:47], v13 offset:3072
    s_waitcnt lgkmcnt(2)
    v_mfma_f32_16x16x32_bf16 v[80:83], a[0:3], v[32:35], 0
    ds_read_b128 v[48:51], v13 offset:4096
    ds_read_b128 v[52:55], v13 offset:5120
    v_mfma_f32_16x16x32_bf16 v[84:87], a[4:7], v[32:35], 0
    ds_read_b128 v[56:59], v13 offset:6144
    ds_read_b128 v[60:63], v13 offset:7168
    v_mfma_f32_16x16x32_bf16 v[88:91], a[0:3], v[36:39], 0
    v_mfma_f32_16x16x32_bf16 v[92:95], a[4:7], v[36:39], 0
    s_waitcnt lgkmcnt(4)
    v_mfma_f32_16x16x32_bf16 v[80:83], a[8:11], v[40:43], v[80:83]
    ds_read_b128 v[32:35], v13 offset:8192
    ds_read_b128 v[36:39], v13 offset:9216
    v_mfma_f32_16x16x32_bf16 v[84:87], a[12:15], v[40:43], v[84:87]
    v_mfma_f32_16x16x32_bf16 v[88:91], a[8:11], v[44:47], v[88:91]
    v_mfma_f32_16x16x32_bf16 v[92:95], a[12:15], v[44:47], v[92:95]
    s_waitcnt lgkmcnt(4)
    v_mfma_f32_16x16x32_bf16 v[80:83], a[16:19], v[48:51], v[80:83]
    ds_read_b128 v[40:43], v13 offset:10240
    ds_read_b128 v[44:47], v13 offset:11264
    v_mfma_f32_16x16x32_bf16 v[84:87], a[20:23], v[48:51], v[84:87]
    v_mfma_f32_16x16x32_bf16 v[88:91], a[16:19], v[52:55], v[88:91]
    v_mfma_f32_16x16x32_bf16 v[92:95], a[20:23], v[52:55], v[92:95]
    s_waitcnt lgkmcnt(4)
    v_mfma_f32_16x16x32_bf16 v[80:83], a[24:27], v[56:59], v[80:83]
    ds_read_b128 v[48:51], v13 offset:12288
    ds_read_b128 v[52:55], v13 offset:13312
    v_mfma_f32_16x16x32_bf16 v[84:87], a[28:31], v[56:59], v[84:87]
    v_mfma_f32_16x16x32_bf16 v[88:91], a[24:27], v[60:63], v[88:91]
    v_mfma_f32_16x16x32_bf16 v[92:95], a[28:31], v[60:63], v[92:95]
    s_waitcnt lgkmcnt(4)
    v_mfma_f32_16x16x32_bf16 v[80:83], a[32:35], v[32:35], v[80:83]
    ds_read_b128 v[56:59], v13 offset:14336
    ds_read_b128 v[60:63], v13 offset:15360
    v_mfma_f32_16x16x32_bf16 v[84:87], a[36:39], v[32:35], v[84:87]
    v_mfma_f32_16x16x32_bf16 v[88:91], a[32:35], v[36:39], v[88:91]
    v_mfma_f32_16x16x32_bf16 v[92:95], a[36:39], v[36:39], v[92:95]
    s_waitcnt lgkmcnt(4)
    v_mfma_f32_16x16x32_bf16 v[80:83], a[40:43], v[40:43], v[80:83]
    ds_read_b128 v[32:35], v13 offset:16384
    ds_read_b128 v[36:39], v13 offset:17408
    v_mfma_f32_16x16x32_bf16 v[84:87], a[44:47], v[40:43], v[84:87]
    v_mfma_f32_16x16x32_bf16 v[88:91], a[40:43], v[44:47], v[88:91]
    v_mfma_f32_16x16x32_bf16 v[92:95], a[44:47], v[44:47], v[92:95]
    s_waitcnt lgkmcnt(4)
    v_mfma_f32_16x16x32_bf16 v[80:83], a[48:51], v[48:51], v[80:83]
    ds_read_b128 v[40:43], v13 offset:18432
    ds_read_b128 v[44:47], v13 offset:19456
    v_mfma_f32_16x16x32_bf16 v[84:87], a[52:55], v[48:51], v[84:87]
    v_mfma_f32_16x16x32_bf16 v[88:91], a[48:51], v[52:55], v[88:91]
    v_mfma_f32_16x16x32_bf16 v[92:95], a[52:55], v[52:55], v[92:95]
    s_waitcnt lgkmcnt(4)
    v_mfma_f32_16x16x32_bf16 v[80:83], a[56:59], v[56:59], v[80:83]
    ds_read_b128 v[48:51], v13 offset:20480
    ds_read_b128 v[52:55], v13 offset:21504
    v_mfma_f32_16x16x32_bf16 v[84:87], a[60:63], v[56:59], v[84:87]
    v_mfma_f32_16x16x32_bf16 v[88:91], a[56:59], v[60:63], v[88:91]
    v_mfma_f32_16x16x32_bf16 v[92:95], a[60:63], v[60:63], v[92:95]
    s_waitcnt lgkmcnt(4)
    v_mfma_f32_16x16x32_bf16 v[80:83], a[64:67], v[32:35], v[80:83]
    ds_read_b128 v[56:59], v13 offset:22528
    ds_read_b128 v[60:63], v13 offset:23552
    v_mfma_f32_16x16x32_bf16 v[84:87], a[68:71], v[32:35], v[84:87]
    v_mfma_f32_16x16x32_bf16 v[88:91], a[64:67], v[36:39], v[88:91]
    v_mfma_f32_16x16x32_bf16 v[92:95], a[68:71], v[36:39], v[92:95]
    s_waitcnt lgkmcnt(4)
    v_mfma_f32_16x16x32_bf16 v[80:83], a[72:75], v[40:43], v[80:83]
    ds_read_b128 v[32:35], v13 offset:24576
    ds_read_b128 v[36:39], v13 offset:25600
    v_mfma_f32_16x16x32_bf16 v[84:87], a[76:79], v[40:43], v[84:87]
    v_mfma_f32_16x16x32_bf16 v[88:91], a[72:75], v[44:47], v[88:91]
    v_mfma_f32_16x16x32_bf16 v[92:95], a[76:79], v[44:47], v[92:95]
    s_waitcnt lgkmcnt(4)
    v_mfma_f32_16x16x32_bf16 v[80:83], a[80:83], v[48:51], v[80:83]
    ds_read_b128 v[40:43], v13 offset:26624
    ds_read_b128 v[44:47], v13 offset:27648
    v_mfma_f32_16x16x32_bf16 v[84:87], a[84:87], v[48:51], v[84:87]
    v_mfma_f32_16x16x32_bf16 v[88:91], a[80:83], v[52:55], v[88:91]
    v_mfma_f32_16x16x32_bf16 v[92:95], a[84:87], v[52:55], v[92:95]
    s_waitcnt lgkmcnt(4)
    v_mfma_f32_16x16x32_bf16 v[80:83], a[88:91], v[56:59], v[80:83]
    ds_read_b128 v[48:51], v13 offset:28672
    ds_read_b128 v[52:55], v13 offset:29696
    v_mfma_f32_16x16x32_bf16 v[84:87], a[92:95], v[56:59], v[84:87]
    v_mfma_f32_16x16x32_bf16 v[88:91], a[88:91], v[60:63], v[88:91]
    v_mfma_f32_16x16x32_bf16 v[92:95], a[92:95], v[60:63], v[92:95]
    s_waitcnt lgkmcnt(4)
    v_mfma_f32_16x16x32_bf16 v[80:83], a[96:99], v[32:35], v[80:83]
    ds_read_b128 v[56:59], v13 offset:30720
    ds_read_b128 v[60:63], v13 offset:31744
    v_mfma_f32_16x16x32_bf16 v[84:87], a[100:103], v[32:35], v[84:87]
    v_mfma_f32_16x16x32_bf16 v[88:91], a[96:99], v[36:39], v[88:91]
    v_mfma_f32_16x16x32_bf16 v[92:95], a[100:103], v[36:39], v[92:95]
    s_waitcnt lgkmcnt(4)
    v_mfma_f32_16x16x32_bf16 v[80:83], a[104:107], v[40:43], v[80:83]
    v_mfma_f32_16x16x32_bf16 v[84:87], a[108:111], v[40:43], v[84:87]
    v_mfma_f32_16x16x32_bf16 v[88:91], a[104:107], v[44:47], v[88:91]
    v_mfma_f32_16x16x32_bf16 v[92:95], a[108:111], v[44:47], v[92:95]
    s_waitcnt vmcnt(0) lgkmcnt(0)
    s_barrier
    v_mfma_f32_16x16x32_bf16 v[80:83], a[112:115], v[48:51], v[80:83]
    ds_read_b128 v[32:35], v13 offset:32768
    ds_read_b128 v[36:39], v13 offset:33792
    v_mfma_f32_16x16x32_bf16 v[84:87], a[116:119], v[48:51], v[84:87]
    v_mfma_f32_16x16x32_bf16 v[88:91], a[112:115], v[52:55], v[88:91]
    v_mfma_f32_16x16x32_bf16 v[92:95], a[116:119], v[52:55], v[92:95]
    v_mfma_f32_16x16x32_bf16 v[80:83], a[120:123], v[56:59], v[80:83]
    ds_read_b128 v[40:43], v13 offset:34816
    ds_read_b128 v[44:47], v13 offset:35840
    v_mfma_f32_16x16x32_bf16 v[84:87], a[124:127], v[56:59], v[84:87]
    v_mfma_f32_16x16x32_bf16 v[88:91], a[120:123], v[60:63], v[88:91]
    v_mfma_f32_16x16x32_bf16 v[92:95], a[124:127], v[60:63], v[92:95]
    s_waitcnt lgkmcnt(2)
    v_mfma_f32_16x16x32_bf16 v[80:83], a[128:131], v[32:35], v[80:83]
    ds_read_b128 v[48:51], v13 offset:36864
    ds_read_b128 v[52:55], v13 offset:37888
    v_mfma_f32_16x16x32_bf16 v[84:87], a[132:135], v[32:35], v[84:87]
    ds_read_b128 v[56:59], v13 offset:38912
    ds_read_b128 v[60:63], v13 offset:39936
    v_mfma_f32_16x16x32_bf16 v[88:91], a[128:131], v[36:39], v[88:91]
    v_mfma_f32_16x16x32_bf16 v[92:95], a[132:135], v[36:39], v[92:95]
    s_waitcnt lgkmcnt(4)
    v_mfma_f32_16x16x32_bf16 v[80:83], a[136:139], v[40:43], v[80:83]
    ds_read_b128 v[32:35], v13 offset:40960
    ds_read_b128 v[36:39], v13 offset:41984
    v_mfma_f32_16x16x32_bf16 v[84:87], a[140:143], v[40:43], v[84:87]
    v_mfma_f32_16x16x32_bf16 v[88:91], a[136:139], v[44:47], v[88:91]
    v_mfma_f32_16x16x32_bf16 v[92:95], a[140:143], v[44:47], v[92:95]
    s_waitcnt lgkmcnt(4)
    v_mfma_f32_16x16x32_bf16 v[80:83], a[144:147], v[48:51], v[80:83]
    ds_read_b128 v[40:43], v13 offset:43008
    ds_read_b128 v[44:47], v13 offset:44032
    v_mfma_f32_16x16x32_bf16 v[84:87], a[148:151], v[48:51], v[84:87]
    v_mfma_f32_16x16x32_bf16 v[88:91], a[144:147], v[52:55], v[88:91]
    v_mfma_f32_16x16x32_bf16 v[92:95], a[148:151], v[52:55], v[92:95]
    s_waitcnt lgkmcnt(4)
    v_mfma_f32_16x16x32_bf16 v[80:83], a[152:155], v[56:59], v[80:83]
    ds_read_b128 v[48:51], v13 offset:45056
    ds_read_b128 v[52:55], v13 offset:46080
    v_mfma_f32_16x16x32_bf16 v[84:87], a[156:159], v[56:59], v[84:87]
    v_mfma_f32_16x16x32_bf16 v[88:91], a[152:155], v[60:63], v[88:91]
    v_mfma_f32_16x16x32_bf16 v[92:95], a[156:159], v[60:63], v[92:95]
    s_waitcnt lgkmcnt(4)
    v_mfma_f32_16x16x32_bf16 v[80:83], a[160:163], v[32:35], v[80:83]
    ds_read_b128 v[56:59], v13 offset:47104
    ds_read_b128 v[60:63], v13 offset:48128
    v_mfma_f32_16x16x32_bf16 v[84:87], a[164:167], v[32:35], v[84:87]
    v_mfma_f32_16x16x32_bf16 v[88:91], a[160:163], v[36:39], v[88:91]
    v_mfma_f32_16x16x32_bf16 v[92:95], a[164:167], v[36:39], v[92:95]
    s_waitcnt lgkmcnt(4)
    v_mfma_f32_16x16x32_bf16 v[80:83], a[168:171], v[40:43], v[80:83]
    ds_read_b128 v[32:35], v13 offset:49152
    ds_read_b128 v[36:39], v13 offset:50176
    v_mfma_f32_16x16x32_bf16 v[84:87], a[172:175], v[40:43], v[84:87]
    v_mfma_f32_16x16x32_bf16 v[88:91], a[168:171], v[44:47], v[88:91]
    v_mfma_f32_16x16x32_bf16 v[92:95], a[172:175], v[44:47], v[92:95]
    s_waitcnt lgkmcnt(4)
    v_mfma_f32_16x16x32_bf16 v[80:83], a[176:179], v[48:51], v[80:83]
    ds_read_b128 v[40:43], v13 offset:51200
    ds_read_b128 v[44:47], v13 offset:52224
    v_mfma_f32_16x16x32_bf16 v[84:87], a[180:183], v[48:51], v[84:87]
    v_mfma_f32_16x16x32_bf16 v[88:91], a[176:179], v[52:55], v[88:91]
    v_mfma_f32_16x16x32_bf16 v[92:95], a[180:183], v[52:55], v[92:95]
    s_waitcnt lgkmcnt(4)
    v_mfma_f32_16x16x32_bf16 v[80:83], a[184:187], v[56:59], v[80:83]
    ds_read_b128 v[48:51], v13 offset:53248
    ds_read_b128 v[52:55], v13 offset:54272
    v_mfma_f32_16x16x32_bf16 v[84:87], a[188:191], v[56:59], v[84:87]
    v_mfma_f32_16x16x32_bf16 v[88:91], a[184:187], v[60:63], v[88:91]
    v_mfma_f32_16x16x32_bf16 v[92:95], a[188:191], v[60:63], v[92:95]
    s_waitcnt lgkmcnt(4)
    v_mfma_f32_16x16x32_bf16 v[80:83], a[192:195], v[32:35], v[80:83]
    ds_read_b128 v[56:59], v13 offset:55296
    ds_read_b128 v[60:63], v13 offset:56320
    v_mfma_f32_16x16x32_bf16 v[84:87], a[196:199], v[32:35], v[84:87]
    v_mfma_f32_16x16x32_bf16 v[88:91], a[192:195], v[36:39], v[88:91]
    v_mfma_f32_16x16x32_bf16 v[92:95], a[196:199], v[36:39], v[92:95]
    s_waitcnt lgkmcnt(4)
    v_mfma_f32_16x16x32_bf16 v[80:83], a[200:203], v[40:43], v[80:83]
    ds_read_b128 v[32:35], v13 offset:57344
    ds_read_b128 v[36:39], v13 offset:58368
    v_mfma_f32_16x16x32_bf16 v[84:87], a[204:207], v[40:43], v[84:87]
    v_mfma_f32_16x16x32_bf16 v[88:91], a[200:203], v[44:47], v[88:91]
    v_mfma_f32_16x16x32_bf16 v[92:95], a[204:207], v[44:47], v[92:95]
    s_waitcnt lgkmcnt(4)
    v_mfma_f32_16x16x32_bf16 v[80:83], a[208:211], v[48:51], v[80:83]
    ds_read_b128 v[40:43], v13 offset:59392
    ds_read_b128 v[44:47], v13 offset:60416
    v_mfma_f32_16x16x32_bf16 v[84:87], a[212:215], v[48:51], v[84:87]
    v_mfma_f32_16x16x32_bf16 v[88:91], a[208:211], v[52:55], v[88:91]
    v_mfma_f32_16x16x32_bf16 v[92:95], a[212:215], v[52:55], v[92:95]
    s_waitcnt lgkmcnt(4)
    v_mfma_f32_16x16x32_bf16 v[80:83], a[216:219], v[56:59], v[80:83]
    ds_read_b128 v[48:51], v13 offset:61440
    ds_read_b128 v[52:55], v13 offset:62464
    v_mfma_f32_16x16x32_bf16 v[84:87], a[220:223], v[56:59], v[84:87]
    v_mfma_f32_16x16x32_bf16 v[88:91], a[216:219], v[60:63], v[88:91]
    v_mfma_f32_16x16x32_bf16 v[92:95], a[220:223], v[60:63], v[92:95]
    s_waitcnt lgkmcnt(4)
    v_mfma_f32_16x16x32_bf16 v[80:83], a[224:227], v[32:35], v[80:83]
    ds_read_b128 v[56:59], v13 offset:63488
    ds_read_b128 v[60:63], v13 offset:64512
    v_mfma_f32_16x16x32_bf16 v[84:87], a[228:231], v[32:35], v[84:87]
    v_mfma_f32_16x16x32_bf16 v[88:91], a[224:227], v[36:39], v[88:91]
    v_mfma_f32_16x16x32_bf16 v[92:95], a[228:231], v[36:39], v[92:95]
    s_waitcnt lgkmcnt(4)
    v_mfma_f32_16x16x32_bf16 v[80:83], a[232:235], v[40:43], v[80:83]
    v_mfma_f32_16x16x32_bf16 v[84:87], a[236:239], v[40:43], v[84:87]
    v_mfma_f32_16x16x32_bf16 v[88:91], a[232:235], v[44:47], v[88:91]
    v_mfma_f32_16x16x32_bf16 v[92:95], a[236:239], v[44:47], v[92:95]
    s_waitcnt lgkmcnt(0)
    v_mfma_f32_16x16x32_bf16 v[80:83], a[240:243], v[48:51], v[80:83]
    v_mfma_f32_16x16x32_bf16 v[84:87], a[244:247], v[48:51], v[84:87]
    v_mfma_f32_16x16x32_bf16 v[88:91], a[240:243], v[52:55], v[88:91]
    v_mfma_f32_16x16x32_bf16 v[92:95], a[244:247], v[52:55], v[92:95]
    v_mfma_f32_16x16x32_bf16 v[80:83], a[248:251], v[56:59], v[80:83]
    v_mfma_f32_16x16x32_bf16 v[84:87], a[252:255], v[56:59], v[84:87]
    v_mfma_f32_16x16x32_bf16 v[88:91], a[248:251], v[60:63], v[88:91]
    v_mfma_f32_16x16x32_bf16 v[92:95], a[252:255], v[60:63], v[92:95]
    s_mov_b32 s76, s57
    s_nop 6
    ds_write_b128 v7, v[80:83] offset:0
    ds_write_b128 v7, v[84:87] offset:64
    ds_write_b128 v7, v[88:91] offset:2304
    ds_write_b128 v7, v[92:95] offset:2368
L_e_fin_141:
    s_waitcnt lgkmcnt(0)
    ds_read_b128 v[216:219], v8 offset:0
    ds_read_b128 v[220:223], v8 offset:1152
    ds_read_b128 v[224:227], v8 offset:2304
    ds_read_b128 v[228:231], v8 offset:3456
    s_waitcnt lgkmcnt(0)
    buffer_store_dwordx4 v[216:219], v11, s[12:15], s76 offen sc1
    s_add_u32 s76, s76, 32768
    buffer_store_dwordx4 v[220:223], v11, s[12:15], s76 offen sc1
    s_add_u32 s76, s76, 32768
    buffer_store_dwordx4 v[224:227], v11, s[12:15], s76 offen sc1
    s_add_u32 s76, s76, 32768
    buffer_store_dwordx4 v[228:231], v11, s[12:15], s76 offen sc1
    s_waitcnt vmcnt(0)
    s_barrier
    s_cmp_lg_u32 s44, 0
    s_cbranch_scc1 L_pub_142
    v_mov_b32 v30, s62
    v_mov_b32 v31, 0
    s_mov_b64 exec, 1
    buffer_store_dword v30, v31, s[12:15], s67 offen sc1
    s_mov_b64 exec, -1
L_pub_142:
    s_branch L_a_loop_125
L_role_b_123:
    s_load_dwordx2 s[6:7], s[0:1], 64
    s_load_dwordx2 s[8:9], s[0:1], 72
    s_waitcnt lgkmcnt(0)
    s_mov_b32 s24, s6
    s_and_b32 s25, s7, 0xffff
    s_mov_b32 s26, 0x700000
    s_mov_b32 s27, 0x00020000
    s_mov_b32 s32, s8
    s_and_b32 s33, s9, 0xffff
    s_mov_b32 s34, 0x1c00
    s_mov_b32 s35, 0x00020000
    s_min_u32 s45, s41, 27
    s_lshl_b32 s46, s45, 8
    s_waitcnt vmcnt(0)
    s_barrier
    v_lshrrev_b32 v20, 4, v1
    s_lshl_b32 s45, s44, 2
    v_add_u32 v21, s45, v20
    s_mov_b32 s45, 7168
    v_mul_lo_u32 v21, v21, s45
    v_lshlrev_b32 v22, 2, v20
    v_and_b32 v23, 15, v1
    v_xor_b32 v22, v22, v23
    v_lshlrev_b32 v22, 4, v22
    v_add_u32 v21, v21, v22
    v_bfe_u32 v22, v1, 2, 2
    v_lshlrev_b32 v23, 3, v20
    v_add_u32 v23, v23, v22
    v_lshlrev_b32 v23, 8, v23
    v_xor_b32 v22, s44, v22
    v_lshlrev_b32 v22, 6, v22
    v_add_u32 v23, v23, v22
    v_and_b32 v22, 3, v1
    v_lshlrev_b32 v22, 4, v22
    v_add_u32 v23, v23, v22
    v_add_u32 v24, 65536, v23
    v_add_u32 v25, 131072, v23
    s_lshl_b32 s47, s44, 10
    s_add_u32 s45, s46, 0x0
    s_add_u32 m0, s47, 0
    s_nop 0
    buffer_load_dwordx4 v21, s[24:27], s45 offen  lds
    s_add_u32 s45, s46, 0x1c000
    s_add_u32 m0, s47, 4096
    s_nop 0
    buffer_load_dwordx4 v21, s[24:27], s45 offen  lds
    s_add_u32 s45, s46, 0x38000
    s_add_u32 m0, s47, 8192
    s_nop 0
    buffer_load_dwordx4 v21, s[24:27], s45 offen  lds
    s_add_u32 s45, s46, 0x54000
    s_add_u32 m0, s47, 12288
    s_nop 0
    buffer_load_dwordx4 v21, s[24:27], s45 offen  lds
    s_add_u32 s45, s46, 0x70000
    s_add_u32 m0, s47, 16384
    s_nop 0
    buffer_load_dwordx4 v21, s[24:27], s45 offen  lds
    s_add_u32 s45, s46, 0x8c000
    s_add_u32 m0, s47, 20480
    s_nop 0
    buffer_load_dwordx4 v21, s[24:27], s45 offen  lds
    s_add_u32 s45, s46, 0xa8000
    s_add_u32 m0, s47, 24576
    s_nop 0
    buffer_load_dwordx4 v21, s[24:27], s45 offen  lds
    s_add_u32 s45, s46, 0xc4000
    s_add_u32 m0, s47, 28672
    s_nop 0
    buffer_load_dwordx4 v21, s[24:27], s45 offen  lds
    s_add_u32 s45, s46, 0xe0000
    s_add_u32 m0, s47, 32768
    s_nop 0
    buffer_load_dwordx4 v21, s[24:27], s45 offen  lds
    s_add_u32 s45, s46, 0xfc000
    s_add_u32 m0, s47, 36864
    s_nop 0
    buffer_load_dwordx4 v21, s[24:27], s45 offen  lds
    s_add_u32 s45, s46, 0x118000
    s_add_u32 m0, s47, 40960
    s_nop 0
    buffer_load_dwordx4 v21, s[24:27], s45 offen  lds
    s_add_u32 s45, s46, 0x134000
    s_add_u32 m0, s47, 45056
    s_nop 0
    buffer_load_dwordx4 v21, s[24:27], s45 offen  lds
    s_add_u32 s45, s46, 0x150000
    s_add_u32 m0, s47, 49152
    s_nop 0
    buffer_load_dwordx4 v21, s[24:27], s45 offen  lds
    s_add_u32 s45, s46, 0x16c000
    s_add_u32 m0, s47, 53248
    s_nop 0
    buffer_load_dwordx4 v21, s[24:27], s45 offen  lds
    s_add_u32 s45, s46, 0x188000
    s_add_u32 m0, s47, 57344
    s_nop 0
    buffer_load_dwordx4 v21, s[24:27], s45 offen  lds
    s_add_u32 s45, s46, 0x1a4000
    s_add_u32 m0, s47, 61440
    s_nop 0
    buffer_load_dwordx4 v21, s[24:27], s45 offen  lds
    s_add_u32 s45, s46, 0x1c0000
    s_add_u32 m0, s47, 65536
    s_nop 0
    buffer_load_dwordx4 v21, s[24:27], s45 offen  lds
    s_add_u32 s45, s46, 0x1dc000
    s_add_u32 m0, s47, 69632
    s_nop 0
    buffer_load_dwordx4 v21, s[24:27], s45 offen  lds
    s_add_u32 s45, s46, 0x1f8000
    s_add_u32 m0, s47, 73728
    s_nop 0
    buffer_load_dwordx4 v21, s[24:27], s45 offen  lds
    s_add_u32 s45, s46, 0x214000
    s_add_u32 m0, s47, 77824
    s_nop 0
    buffer_load_dwordx4 v21, s[24:27], s45 offen  lds
    s_add_u32 s45, s46, 0x230000
    s_add_u32 m0, s47, 81920
    s_nop 0
    buffer_load_dwordx4 v21, s[24:27], s45 offen  lds
    s_add_u32 s45, s46, 0x24c000
    s_add_u32 m0, s47, 86016
    s_nop 0
    buffer_load_dwordx4 v21, s[24:27], s45 offen  lds
    s_add_u32 s45, s46, 0x268000
    s_add_u32 m0, s47, 90112
    s_nop 0
    buffer_load_dwordx4 v21, s[24:27], s45 offen  lds
    s_add_u32 s45, s46, 0x284000
    s_add_u32 m0, s47, 94208
    s_nop 0
    buffer_load_dwordx4 v21, s[24:27], s45 offen  lds
    s_add_u32 s45, s46, 0x2a0000
    s_add_u32 m0, s47, 98304
    s_nop 0
    buffer_load_dwordx4 v21, s[24:27], s45 offen  lds
    s_add_u32 s45, s46, 0x2bc000
    s_add_u32 m0, s47, 102400
    s_nop 0
    buffer_load_dwordx4 v21, s[24:27], s45 offen  lds
    s_add_u32 s45, s46, 0x2d8000
    s_add_u32 m0, s47, 106496
    s_nop 0
    buffer_load_dwordx4 v21, s[24:27], s45 offen  lds
    s_add_u32 s45, s46, 0x2f4000
    s_add_u32 m0, s47, 110592
    s_nop 0
    buffer_load_dwordx4 v21, s[24:27], s45 offen  lds
    s_add_u32 s45, s46, 0x310000
    s_add_u32 m0, s47, 114688
    s_nop 0
    buffer_load_dwordx4 v21, s[24:27], s45 offen  lds
    s_add_u32 s45, s46, 0x32c000
    s_add_u32 m0, s47, 118784
    s_nop 0
    buffer_load_dwordx4 v21, s[24:27], s45 offen  lds
    s_add_u32 s45, s46, 0x348000
    s_add_u32 m0, s47, 122880
    s_nop 0
    buffer_load_dwordx4 v21, s[24:27], s45 offen  lds
    s_add_u32 s45, s46, 0x364000
    s_add_u32 m0, s47, 126976
    s_nop 0
    buffer_load_dwordx4 v21, s[24:27], s45 offen  lds
    s_waitcnt vmcnt(28)
    s_barrier
    s_add_u32 s45, s46, 0x380000
    s_add_u32 m0, s47, 131072
    s_nop 0
    buffer_load_dwordx4 v21, s[24:27], s45 offen  lds
    s_add_u32 s45, s46, 0x39c000
    s_add_u32 m0, s47, 135168
    s_nop 0
    buffer_load_dwordx4 v21, s[24:27], s45 offen  lds
    s_add_u32 s45, s46, 0x3b8000
    s_add_u32 m0, s47, 139264
    s_nop 0
    buffer_load_dwordx4 v21, s[24:27], s45 offen  lds
    s_add_u32 s45, s46, 0x3d4000
    s_add_u32 m0, s47, 143360
    s_nop 0
    buffer_load_dwordx4 v21, s[24:27], s45 offen  lds
    ds_read_b64_tr_b16 a[0:1], v23 offset:0
    ds_read_b64_tr_b16 a[2:3], v23 offset:1024
    ds_read_b64_tr_b16 a[4:5], v23 offset:8
    ds_read_b64_tr_b16 a[6:7], v23 offset:1032
    ds_read_b64_tr_b16 a[8:9], v23 offset:8192
    ds_read_b64_tr_b16 a[10:11], v23 offset:9216
    ds_read_b64_tr_b16 a[12:13], v23 offset:8200
    ds_read_b64_tr_b16 a[14:15], v23 offset:9224
    s_waitcnt lgkmcnt(0)
    s_waitcnt vmcnt(28)
    s_barrier
    s_add_u32 s45, s46, 0x3f0000
    s_add_u32 m0, s47, 0
    s_nop 0
    buffer_load_dwordx4 v21, s[24:27], s45 offen  lds
    s_add_u32 s45, s46, 0x40c000
    s_add_u32 m0, s47, 4096
    s_nop 0
    buffer_load_dwordx4 v21, s[24:27], s45 offen  lds
    s_add_u32 s45, s46, 0x428000
    s_add_u32 m0, s47, 8192
    s_nop 0
    buffer_load_dwordx4 v21, s[24:27], s45 offen  lds
    s_add_u32 s45, s46, 0x444000
    s_add_u32 m0, s47, 12288
    s_nop 0
    buffer_load_dwordx4 v21, s[24:27], s45 offen  lds
    ds_read_b64_tr_b16 a[16:17], v23 offset:16384
    ds_read_b64_tr_b16 a[18:19], v23 offset:17408
    ds_read_b64_tr_b16 a[20:21], v23 offset:16392
    ds_read_b64_tr_b16 a[22:23], v23 offset:17416
    ds_read_b64_tr_b16 a[24:25], v23 offset:24576
    ds_read_b64_tr_b16 a[26:27], v23 offset:25600
    ds_read_b64_tr_b16 a[28:29], v23 offset:24584
    ds_read_b64_tr_b16 a[30:31], v23 offset:25608
    s_waitcnt lgkmcnt(0)
    s_waitcnt vmcnt(28)
    s_barrier
    s_add_u32 s45, s46, 0x460000
    s_add_u32 m0, s47, 16384
    s_nop 0
    buffer_load_dwordx4 v21, s[24:27], s45 offen  lds
    s_add_u32 s45, s46, 0x47c000
    s_add_u32 m0, s47, 20480
    s_nop 0
    buffer_load_dwordx4 v21, s[24:27], s45 offen  lds
    s_add_u32 s45, s46, 0x498000
    s_add_u32 m0, s47, 24576
    s_nop 0
    buffer_load_dwordx4 v21, s[24:27], s45 offen  lds
    s_add_u32 s45, s46, 0x4b4000
    s_add_u32 m0, s47, 28672
    s_nop 0
    buffer_load_dwordx4 v21, s[24:27], s45 offen  lds
    ds_read_b64_tr_b16 a[32:33], v23 offset:32768
    ds_read_b64_tr_b16 a[34:35], v23 offset:33792
    ds_read_b64_tr_b16 a[36:37], v23 offset:32776
    ds_read_b64_tr_b16 a[38:39], v23 offset:33800
    ds_read_b64_tr_b16 a[40:41], v23 offset:40960
    ds_read_b64_tr_b16 a[42:43], v23 offset:41984
    ds_read_b64_tr_b16 a[44:45], v23 offset:40968
    ds_read_b64_tr_b16 a[46:47], v23 offset:41992
    s_waitcnt lgkmcnt(0)
    s_waitcnt vmcnt(28)
    s_barrier
    s_add_u32 s45, s46, 0x4d0000
    s_add_u32 m0, s47, 32768
    s_nop 0
    buffer_load_dwordx4 v21, s[24:27], s45 offen  lds
    s_add_u32 s45, s46, 0x4ec000
    s_add_u32 m0, s47, 36864
    s_nop 0
    buffer_load_dwordx4 v21, s[24:27], s45 offen  lds
    s_add_u32 s45, s46, 0x508000
    s_add_u32 m0, s47, 40960
    s_nop 0
    buffer_load_dwordx4 v21, s[24:27], s45 offen  lds
    s_add_u32 s45, s46, 0x524000
    s_add_u32 m0, s47, 45056
    s_nop 0
    buffer_load_dwordx4 v21, s[24:27], s45 offen  lds
    ds_read_b64_tr_b16 a[48:49], v23 offset:49152
    ds_read_b64_tr_b16 a[50:51], v23 offset:50176
    ds_read_b64_tr_b16 a[52:53], v23 offset:49160
    ds_read_b64_tr_b16 a[54:55], v23 offset:50184
    ds_read_b64_tr_b16 a[56:57], v23 offset:57344
    ds_read_b64_tr_b16 a[58:59], v23 offset:58368
    ds_read_b64_tr_b16 a[60:61], v23 offset:57352
    ds_read_b64_tr_b16 a[62:63], v23 offset:58376
    s_waitcnt lgkmcnt(0)
    s_waitcnt vmcnt(28)
    s_barrier
    s_add_u32 s45, s46, 0x540000
    s_add_u32 m0, s47, 49152
    s_nop 0
    buffer_load_dwordx4 v21, s[24:27], s45 offen  lds
    s_add_u32 s45, s46, 0x55c000
    s_add_u32 m0, s47, 53248
    s_nop 0
    buffer_load_dwordx4 v21, s[24:27], s45 offen  lds
    s_add_u32 s45, s46, 0x578000
    s_add_u32 m0, s47, 57344
    s_nop 0
    buffer_load_dwordx4 v21, s[24:27], s45 offen  lds
    s_add_u32 s45, s46, 0x594000
    s_add_u32 m0, s47, 61440
    s_nop 0
    buffer_load_dwordx4 v21, s[24:27], s45 offen  lds
    ds_read_b64_tr_b16 a[64:65], v24 offset:0
    ds_read_b64_tr_b16 a[66:67], v24 offset:1024
    ds_read_b64_tr_b16 a[68:69], v24 offset:8
    ds_read_b64_tr_b16 a[70:71], v24 offset:1032
    ds_read_b64_tr_b16 a[72:73], v24 offset:8192
    ds_read_b64_tr_b16 a[74:75], v24 offset:9216
    ds_read_b64_tr_b16 a[76:77], v24 offset:8200
    ds_read_b64_tr_b16 a[78:79], v24 offset:9224
    s_waitcnt lgkmcnt(0)
    s_waitcnt vmcnt(28)
    s_barrier
    s_add_u32 s45, s46, 0x5b0000
    s_add_u32 m0, s47, 65536
    s_nop 0
    buffer_load_dwordx4 v21, s[24:27], s45 offen  lds
    s_add_u32 s45, s46, 0x5cc000
    s_add_u32 m0, s47, 69632
    s_nop 0
    buffer_load_dwordx4 v21, s[24:27], s45 offen  lds
    s_add_u32 s45, s46, 0x5e8000
    s_add_u32 m0, s47, 73728
    s_nop 0
    buffer_load_dwordx4 v21, s[24:27], s45 offen  lds
    s_add_u32 s45, s46, 0x604000
    s_add_u32 m0, s47, 77824
    s_nop 0
    buffer_load_dwordx4 v21, s[24:27], s45 offen  lds
    ds_read_b64_tr_b16 a[80:81], v24 offset:16384
    ds_read_b64_tr_b16 a[82:83], v24 offset:17408
    ds_read_b64_tr_b16 a[84:85], v24 offset:16392
    ds_read_b64_tr_b16 a[86:87], v24 offset:17416
    ds_read_b64_tr_b16 a[88:89], v24 offset:24576
    ds_read_b64_tr_b16 a[90:91], v24 offset:25600
    ds_read_b64_tr_b16 a[92:93], v24 offset:24584
    ds_read_b64_tr_b16 a[94:95], v24 offset:25608
    s_waitcnt lgkmcnt(0)
    s_waitcnt vmcnt(28)
    s_barrier
    s_add_u32 s45, s46, 0x620000
    s_add_u32 m0, s47, 81920
    s_nop 0
    buffer_load_dwordx4 v21, s[24:27], s45 offen  lds
    s_add_u32 s45, s46, 0x63c000
    s_add_u32 m0, s47, 86016
    s_nop 0
    buffer_load_dwordx4 v21, s[24:27], s45 offen  lds
    s_add_u32 s45, s46, 0x658000
    s_add_u32 m0, s47, 90112
    s_nop 0
    buffer_load_dwordx4 v21, s[24:27], s45 offen  lds
    s_add_u32 s45, s46, 0x674000
    s_add_u32 m0, s47, 94208
    s_nop 0
    buffer_load_dwordx4 v21, s[24:27], s45 offen  lds
    ds_read_b64_tr_b16 a[96:97], v24 offset:32768
    ds_read_b64_tr_b16 a[98:99], v24 offset:33792
    ds_read_b64_tr_b16 a[100:101], v24 offset:32776
    ds_read_b64_tr_b16 a[102:103], v24 offset:33800
    ds_read_b64_tr_b16 a[104:105], v24 offset:40960
    ds_read_b64_tr_b16 a[106:107], v24 offset:41984
    ds_read_b64_tr_b16 a[108:109], v24 offset:40968
    ds_read_b64_tr_b16 a[110:111], v24 offset:41992
    s_waitcnt lgkmcnt(0)
    s_waitcnt vmcnt(28)
    s_barrier
    s_add_u32 s45, s46, 0x690000
    s_add_u32 m0, s47, 98304
    s_nop 0
    buffer_load_dwordx4 v21, s[24:27], s45 offen  lds
    s_add_u32 s45, s46, 0x6ac000
    s_add_u32 m0, s47, 102400
    s_nop 0
    buffer_load_dwordx4 v21, s[24:27], s45 offen  lds
    s_add_u32 s45, s46, 0x6c8000
    s_add_u32 m0, s47, 106496
    s_nop 0
    buffer_load_dwordx4 v21, s[24:27], s45 offen  lds
    s_add_u32 s45, s46, 0x6e4000
    s_add_u32 m0, s47, 110592
    s_nop 0
    buffer_load_dwordx4 v21, s[24:27], s45 offen  lds
    ds_read_b64_tr_b16 a[112:113], v24 offset:49152
    ds_read_b64_tr_b16 a[114:115], v24 offset:50176
    ds_read_b64_tr_b16 a[116:117], v24 offset:49160
    ds_read_b64_tr_b16 a[118:119], v24 offset:50184
    ds_read_b64_tr_b16 a[120:121], v24 offset:57344
    ds_read_b64_tr_b16 a[122:123], v24 offset:58368
    ds_read_b64_tr_b16 a[124:125], v24 offset:57352
    ds_read_b64_tr_b16 a[126:127], v24 offset:58376
    s_waitcnt lgkmcnt(0)
    s_waitcnt vmcnt(28)
    s_barrier
    ds_read_b64_tr_b16 a[128:129], v25 offset:0
    ds_read_b64_tr_b16 a[130:131], v25 offset:1024
    ds_read_b64_tr_b16 a[132:133], v25 offset:8
    ds_read_b64_tr_b16 a[134:135], v25 offset:1032
    ds_read_b64_tr_b16 a[136:137], v25 offset:8192
    ds_read_b64_tr_b16 a[138:139], v25 offset:9216
    ds_read_b64_tr_b16 a[140:141], v25 offset:8200
    ds_read_b64_tr_b16 a[142:143], v25 offset:9224
    s_waitcnt lgkmcnt(0)
    s_waitcnt vmcnt(24)
    s_barrier
    ds_read_b64_tr_b16 a[144:145], v23 offset:0
    ds_read_b64_tr_b16 a[146:147], v23 offset:1024
    ds_read_b64_tr_b16 a[148:149], v23 offset:8
    ds_read_b64_tr_b16 a[150:151], v23 offset:1032
    ds_read_b64_tr_b16 a[152:153], v23 offset:8192
    ds_read_b64_tr_b16 a[154:155], v23 offset:9216
    ds_read_b64_tr_b16 a[156:157], v23 offset:8200
    ds_read_b64_tr_b16 a[158:159], v23 offset:9224
    s_waitcnt lgkmcnt(0)
    s_waitcnt vmcnt(20)
    s_barrier
    ds_read_b64_tr_b16 a[160:161], v23 offset:16384
    ds_read_b64_tr_b16 a[162:163], v23 offset:17408
    ds_read_b64_tr_b16 a[164:165], v23 offset:16392
    ds_read_b64_tr_b16 a[166:167], v23 offset:17416
    ds_read_b64_tr_b16 a[168:169], v23 offset:24576
    ds_read_b64_tr_b16 a[170:171], v23 offset:25600
    ds_read_b64_tr_b16 a[172:173], v23 offset:24584
    ds_read_b64_tr_b16 a[174:175], v23 offset:25608
    s_waitcnt lgkmcnt(0)
    s_waitcnt vmcnt(16)
    s_barrier
    ds_read_b64_tr_b16 a[176:177], v23 offset:32768
    ds_read_b64_tr_b16 a[178:179], v23 offset:33792
    ds_read_b64_tr_b16 a[180:181], v23 offset:32776
    ds_read_b64_tr_b16 a[182:183], v23 offset:33800
    ds_read_b64_tr_b16 a[184:185], v23 offset:40960
    ds_read_b64_tr_b16 a[186:187], v23 offset:41984
    ds_read_b64_tr_b16 a[188:189], v23 offset:40968
    ds_read_b64_tr_b16 a[190:191], v23 offset:41992
    s_waitcnt lgkmcnt(0)
    s_waitcnt vmcnt(12)
    s_barrier
    ds_read_b64_tr_b16 a[192:193], v23 offset:49152
    ds_read_b64_tr_b16 a[194:195], v23 offset:50176
    ds_read_b64_tr_b16 a[196:197], v23 offset:49160
    ds_read_b64_tr_b16 a[198:199], v23 offset:50184
    ds_read_b64_tr_b16 a[200:201], v23 offset:57344
    ds_read_b64_tr_b16 a[202:203], v23 offset:58368
    ds_read_b64_tr_b16 a[204:205], v23 offset:57352
    ds_read_b64_tr_b16 a[206:207], v23 offset:58376
    s_waitcnt lgkmcnt(0)
    s_waitcnt vmcnt(8)
    s_barrier
    ds_read_b64_tr_b16 a[208:209], v24 offset:0
    ds_read_b64_tr_b16 a[210:211], v24 offset:1024
    ds_read_b64_tr_b16 a[212:213], v24 offset:8
    ds_read_b64_tr_b16 a[214:215], v24 offset:1032
    ds_read_b64_tr_b16 a[216:217], v24 offset:8192
    ds_read_b64_tr_b16 a[218:219], v24 offset:9216
    ds_read_b64_tr_b16 a[220:221], v24 offset:8200
    ds_read_b64_tr_b16 a[222:223], v24 offset:9224
    s_waitcnt lgkmcnt(0)
    s_waitcnt vmcnt(4)
    s_barrier
    ds_read_b64_tr_b16 a[224:225], v24 offset:16384
    ds_read_b64_tr_b16 a[226:227], v24 offset:17408
    ds_read_b64_tr_b16 a[228:229], v24 offset:16392
    ds_read_b64_tr_b16 a[230:231], v24 offset:17416
    ds_read_b64_tr_b16 a[232:233], v24 offset:24576
    ds_read_b64_tr_b16 a[234:235], v24 offset:25600
    ds_read_b64_tr_b16 a[236:237], v24 offset:24584
    ds_read_b64_tr_b16 a[238:239], v24 offset:25608
    s_waitcnt lgkmcnt(0)
    s_waitcnt vmcnt(0)
    s_barrier
    ds_read_b64_tr_b16 a[240:241], v24 offset:32768
    ds_read_b64_tr_b16 a[242:243], v24 offset:33792
    ds_read_b64_tr_b16 a[244:245], v24 offset:32776
    ds_read_b64_tr_b16 a[246:247], v24 offset:33800
    ds_read_b64_tr_b16 a[248:249], v24 offset:40960
    ds_read_b64_tr_b16 a[250:251], v24 offset:41984
    ds_read_b64_tr_b16 a[252:253], v24 offset:40968
    ds_read_b64_tr_b16 a[254:255], v24 offset:41992
    s_waitcnt lgkmcnt(0)
    s_barrier
    s_min_u32 s45, s41, 27
    s_lshl_b32 s45, s45, 8
    s_lshl_b32 s46, s44, 6
    s_add_u32 s45, s45, s46
    v_lshrrev_b32 v29, 4, v1
    v_lshlrev_b32 v29, 4, v29
    buffer_load_dwordx4 v[80:83], v29, s[32:35], s45 offen
    s_waitcnt vmcnt(0)
    v_lshlrev_b32 v96, 16, v80
    v_and_b32 v97, 0xffff0000, v80
    v_lshlrev_b32 v98, 16, v81
    v_and_b32 v99, 0xffff0000, v81
    v_lshlrev_b32 v100, 16, v82
    v_and_b32 v101, 0xffff0000, v82
    v_lshlrev_b32 v102, 16, v83
    v_and_b32 v103, 0xffff0000, v83
    v_mov_b32 v104, 0xbdd2d3e8
    v_mov_b32 v105, v104
    v_mov_b32 v106, 0xc0135761
    v_mov_b32 v107, v106
    s_cmp_lg_u32 s44, 0
    s_cbranch_scc1 L_pd_143
    v_mov_b32 v29, 127232
    s_mov_b32 s46, 96
    s_mov_b64 exec, 1
    s_mov_b32 s70, 0
L_wp_144:
    buffer_load_dword v31, v29, s[12:15], 0 offen sc1
    s_add_u32 s70, s70, 1
    s_cmp_ge_u32 s70, 0x200000
    s_cbranch_scc1 L_w_done_96
    s_waitcnt vmcnt(0)
    v_cmp_gt_u32 vcc, s46, v31
    s_nop 1
    s_cbranch_vccz L_wp_144_ok
    s_sleep 3
    s_branch L_wp_144
L_wp_144_ok:
    s_mov_b64 exec, -1
L_pd_143:
    s_barrier
    v_lshlrev_b32 v29, 5, v1
    s_mov_b32 s45, 8192
    buffer_load_dwordx4 v[112:115], v29, s[12:15], s45 offen offset:0 sc1
    buffer_load_dwordx4 v[116:119], v29, s[12:15], s45 offen offset:16 sc1
    buffer_load_dwordx4 v[120:123], v29, s[12:15], s45 offen offset:2048 sc1
    buffer_load_dwordx4 v[124:127], v29, s[12:15], s45 offen offset:2064 sc1
    s_mov_b32 s45, 32768
    buffer_load_dwordx4 v[32:35], v29, s[12:15], s45 offen offset:0 sc1
    buffer_load_dwordx4 v[36:39], v29, s[12:15], s45 offen offset:16 sc1
    buffer_load_dwordx4 v[40:43], v29, s[12:15], s45 offen offset:2048 sc1
    buffer_load_dwordx4 v[44:47], v29, s[12:15], s45 offen offset:2064 sc1
    s_mov_b32 s45, 12288
    buffer_load_dwordx4 v[128:131], v29, s[12:15], s45 offen offset:0 sc1
    buffer_load_dwordx4 v[132:135], v29, s[12:15], s45 offen offset:16 sc1
    buffer_load_dwordx4 v[136:139], v29, s[12:15], s45 offen offset:2048 sc1
    buffer_load_dwordx4 v[140:143], v29, s[12:15], s45 offen offset:2064 sc1
    s_mov_b32 s45, 36864
    buffer_load_dwordx4 v[48:51], v29, s[12:15], s45 offen offset:0 sc1
    buffer_load_dwordx4 v[52:55], v29, s[12:15], s45 offen offset:16 sc1
    buffer_load_dwordx4 v[56:59], v29, s[12:15], s45 offen offset:2048 sc1
    buffer_load_dwordx4 v[60:63], v29, s[12:15], s45 offen offset:2064 sc1
    s_mov_b32 s45, 16384
    buffer_load_dwordx4 v[144:147], v29, s[12:15], s45 offen offset:0 sc1
    buffer_load_dwordx4 v[148:151], v29, s[12:15], s45 offen offset:16 sc1
    buffer_load_dwordx4 v[152:155], v29, s[12:15], s45 offen offset:2048 sc1
    buffer_load_dwordx4 v[156:159], v29, s[12:15], s45 offen offset:2064 sc1
    s_mov_b32 s45, 40960
    buffer_load_dwordx4 v[64:67], v29, s[12:15], s45 offen offset:0 sc1
    buffer_load_dwordx4 v[68:71], v29, s[12:15], s45 offen offset:16 sc1
    buffer_load_dwordx4 v[72:75], v29, s[12:15], s45 offen offset:2048 sc1
    buffer_load_dwordx4 v[76:79], v29, s[12:15], s45 offen offset:2064 sc1
    s_waitcnt vmcnt(0)
    v_add_f32 v112, v112, v32
    v_cvt_pk_bf16_f32 v112, v112, v112
    v_lshlrev_b32 v112, 16, v112
    v_add_f32 v113, v113, v33
    v_cvt_pk_bf16_f32 v113, v113, v113
    v_lshlrev_b32 v113, 16, v113
    v_add_f32 v114, v114, v34
    v_cvt_pk_bf16_f32 v114, v114, v114
    v_lshlrev_b32 v114, 16, v114
    v_add_f32 v115, v115, v35
    v_cvt_pk_bf16_f32 v115, v115, v115
    v_lshlrev_b32 v115, 16, v115
    v_add_f32 v116, v116, v36
    v_cvt_pk_bf16_f32 v116, v116, v116
    v_lshlrev_b32 v116, 16, v116
    v_add_f32 v117, v117, v37
    v_cvt_pk_bf16_f32 v117, v117, v117
    v_lshlrev_b32 v117, 16, v117
    v_add_f32 v118, v118, v38
    v_cvt_pk_bf16_f32 v118, v118, v118
    v_lshlrev_b32 v118, 16, v118
    v_add_f32 v119, v119, v39
    v_cvt_pk_bf16_f32 v119, v119, v119
    v_lshlrev_b32 v119, 16, v119
    v_add_f32 v120, v120, v40
    v_cvt_pk_bf16_f32 v120, v120, v120
    v_lshlrev_b32 v120, 16, v120
    v_add_f32 v121, v121, v41
    v_cvt_pk_bf16_f32 v121, v121, v121
    v_lshlrev_b32 v121, 16, v121
    v_add_f32 v122, v122, v42
    v_cvt_pk_bf16_f32 v122, v122, v122
    v_lshlrev_b32 v122, 16, v122
    v_add_f32 v123, v123, v43
    v_cvt_pk_bf16_f32 v123, v123, v123
    v_lshlrev_b32 v123, 16, v123
    v_add_f32 v124, v124, v44
    v_cvt_pk_bf16_f32 v124, v124, v124
    v_lshlrev_b32 v124, 16, v124
    v_add_f32 v125, v125, v45
    v_cvt_pk_bf16_f32 v125, v125, v125
    v_lshlrev_b32 v125, 16, v125
    v_add_f32 v126, v126, v46
    v_cvt_pk_bf16_f32 v126, v126, v126
    v_lshlrev_b32 v126, 16, v126
    v_add_f32 v127, v127, v47
    v_cvt_pk_bf16_f32 v127, v127, v127
    v_lshlrev_b32 v127, 16, v127
    v_add_f32 v128, v128, v48
    v_cvt_pk_bf16_f32 v128, v128, v128
    v_lshlrev_b32 v128, 16, v128
    v_add_f32 v129, v129, v49
    v_cvt_pk_bf16_f32 v129, v129, v129
    v_lshlrev_b32 v129, 16, v129
    v_add_f32 v130, v130, v50
    v_cvt_pk_bf16_f32 v130, v130, v130
    v_lshlrev_b32 v130, 16, v130
    v_add_f32 v131, v131, v51
    v_cvt_pk_bf16_f32 v131, v131, v131
    v_lshlrev_b32 v131, 16, v131
    v_add_f32 v132, v132, v52
    v_cvt_pk_bf16_f32 v132, v132, v132
    v_lshlrev_b32 v132, 16, v132
    v_add_f32 v133, v133, v53
    v_cvt_pk_bf16_f32 v133, v133, v133
    v_lshlrev_b32 v133, 16, v133
    v_add_f32 v134, v134, v54
    v_cvt_pk_bf16_f32 v134, v134, v134
    v_lshlrev_b32 v134, 16, v134
    v_add_f32 v135, v135, v55
    v_cvt_pk_bf16_f32 v135, v135, v135
    v_lshlrev_b32 v135, 16, v135
    v_add_f32 v136, v136, v56
    v_cvt_pk_bf16_f32 v136, v136, v136
    v_lshlrev_b32 v136, 16, v136
    v_add_f32 v137, v137, v57
    v_cvt_pk_bf16_f32 v137, v137, v137
    v_lshlrev_b32 v137, 16, v137
    v_add_f32 v138, v138, v58
    v_cvt_pk_bf16_f32 v138, v138, v138
    v_lshlrev_b32 v138, 16, v138
    v_add_f32 v139, v139, v59
    v_cvt_pk_bf16_f32 v139, v139, v139
    v_lshlrev_b32 v139, 16, v139
    v_add_f32 v140, v140, v60
    v_cvt_pk_bf16_f32 v140, v140, v140
    v_lshlrev_b32 v140, 16, v140
    v_add_f32 v141, v141, v61
    v_cvt_pk_bf16_f32 v141, v141, v141
    v_lshlrev_b32 v141, 16, v141
    v_add_f32 v142, v142, v62
    v_cvt_pk_bf16_f32 v142, v142, v142
    v_lshlrev_b32 v142, 16, v142
    v_add_f32 v143, v143, v63
    v_cvt_pk_bf16_f32 v143, v143, v143
    v_lshlrev_b32 v143, 16, v143
    v_add_f32 v144, v144, v64
    v_cvt_pk_bf16_f32 v144, v144, v144
    v_lshlrev_b32 v144, 16, v144
    v_add_f32 v144, 1.0, v144
    v_cvt_pk_bf16_f32 v144, v144, v144
    v_lshlrev_b32 v144, 16, v144
    v_add_f32 v145, v145, v65
    v_cvt_pk_bf16_f32 v145, v145, v145
    v_lshlrev_b32 v145, 16, v145
    v_add_f32 v145, 1.0, v145
    v_cvt_pk_bf16_f32 v145, v145, v145
    v_lshlrev_b32 v145, 16, v145
    v_add_f32 v146, v146, v66
    v_cvt_pk_bf16_f32 v146, v146, v146
    v_lshlrev_b32 v146, 16, v146
    v_add_f32 v146, 1.0, v146
    v_cvt_pk_bf16_f32 v146, v146, v146
    v_lshlrev_b32 v146, 16, v146
    v_add_f32 v147, v147, v67
    v_cvt_pk_bf16_f32 v147, v147, v147
    v_lshlrev_b32 v147, 16, v147
    v_add_f32 v147, 1.0, v147
    v_cvt_pk_bf16_f32 v147, v147, v147
    v_lshlrev_b32 v147, 16, v147
    v_add_f32 v148, v148, v68
    v_cvt_pk_bf16_f32 v148, v148, v148
    v_lshlrev_b32 v148, 16, v148
    v_add_f32 v148, 1.0, v148
    v_cvt_pk_bf16_f32 v148, v148, v148
    v_lshlrev_b32 v148, 16, v148
    v_add_f32 v149, v149, v69
    v_cvt_pk_bf16_f32 v149, v149, v149
    v_lshlrev_b32 v149, 16, v149
    v_add_f32 v149, 1.0, v149
    v_cvt_pk_bf16_f32 v149, v149, v149
    v_lshlrev_b32 v149, 16, v149
    v_add_f32 v150, v150, v70
    v_cvt_pk_bf16_f32 v150, v150, v150
    v_lshlrev_b32 v150, 16, v150
    v_add_f32 v150, 1.0, v150
    v_cvt_pk_bf16_f32 v150, v150, v150
    v_lshlrev_b32 v150, 16, v150
    v_add_f32 v151, v151, v71
    v_cvt_pk_bf16_f32 v151, v151, v151
    v_lshlrev_b32 v151, 16, v151
    v_add_f32 v151, 1.0, v151
    v_cvt_pk_bf16_f32 v151, v151, v151
    v_lshlrev_b32 v151, 16, v151
    v_add_f32 v152, v152, v72
    v_cvt_pk_bf16_f32 v152, v152, v152
    v_lshlrev_b32 v152, 16, v152
    v_add_f32 v152, 1.0, v152
    v_cvt_pk_bf16_f32 v152, v152, v152
    v_lshlrev_b32 v152, 16, v152
    v_add_f32 v153, v153, v73
    v_cvt_pk_bf16_f32 v153, v153, v153
    v_lshlrev_b32 v153, 16, v153
    v_add_f32 v153, 1.0, v153
    v_cvt_pk_bf16_f32 v153, v153, v153
    v_lshlrev_b32 v153, 16, v153
    v_add_f32 v154, v154, v74
    v_cvt_pk_bf16_f32 v154, v154, v154
    v_lshlrev_b32 v154, 16, v154
    v_add_f32 v154, 1.0, v154
    v_cvt_pk_bf16_f32 v154, v154, v154
    v_lshlrev_b32 v154, 16, v154
    v_add_f32 v155, v155, v75
    v_cvt_pk_bf16_f32 v155, v155, v155
    v_lshlrev_b32 v155, 16, v155
    v_add_f32 v155, 1.0, v155
    v_cvt_pk_bf16_f32 v155, v155, v155
    v_lshlrev_b32 v155, 16, v155
    v_add_f32 v156, v156, v76
    v_cvt_pk_bf16_f32 v156, v156, v156
    v_lshlrev_b32 v156, 16, v156
    v_add_f32 v156, 1.0, v156
    v_cvt_pk_bf16_f32 v156, v156, v156
    v_lshlrev_b32 v156, 16, v156
    v_add_f32 v157, v157, v77
    v_cvt_pk_bf16_f32 v157, v157, v157
    v_lshlrev_b32 v157, 16, v157
    v_add_f32 v157, 1.0, v157
    v_cvt_pk_bf16_f32 v157, v157, v157
    v_lshlrev_b32 v157, 16, v157
    v_add_f32 v158, v158, v78
    v_cvt_pk_bf16_f32 v158, v158, v158
    v_lshlrev_b32 v158, 16, v158
    v_add_f32 v158, 1.0, v158
    v_cvt_pk_bf16_f32 v158, v158, v158
    v_lshlrev_b32 v158, 16, v158
    v_add_f32 v159, v159, v79
    v_cvt_pk_bf16_f32 v159, v159, v159
    v_lshlrev_b32 v159, 16, v159
    v_add_f32 v159, 1.0, v159
    v_cvt_pk_bf16_f32 v159, v159, v159
    v_lshlrev_b32 v159, 16, v159
    s_lshl_b32 s46, s44, 10
    s_add_u32 s45, s46, 8192
    buffer_load_dwordx4 v[18:21], v10, s[12:15], s45 offen sc1
    s_add_u32 s45, s46, 32768
    buffer_load_dwordx4 v[32:35], v10, s[12:15], s45 offen sc1
    s_add_u32 s45, s46, 12288
    buffer_load_dwordx4 v[22:25], v10, s[12:15], s45 offen sc1
    s_add_u32 s45, s46, 36864
    buffer_load_dwordx4 v[36:39], v10, s[12:15], s45 offen sc1
    s_add_u32 s45, s46, 16384
    buffer_load_dwordx4 v[108:111], v10, s[12:15], s45 offen sc1
    s_add_u32 s45, s46, 40960
    buffer_load_dwordx4 v[40:43], v10, s[12:15], s45 offen sc1
    s_waitcnt vmcnt(0)
    v_add_f32 v18, v18, v32
    v_cvt_pk_bf16_f32 v18, v18, v18
    v_lshlrev_b32 v18, 16, v18
    v_add_f32 v19, v19, v33
    v_cvt_pk_bf16_f32 v19, v19, v19
    v_lshlrev_b32 v19, 16, v19
    v_add_f32 v20, v20, v34
    v_cvt_pk_bf16_f32 v20, v20, v20
    v_lshlrev_b32 v20, 16, v20
    v_add_f32 v21, v21, v35
    v_cvt_pk_bf16_f32 v21, v21, v21
    v_lshlrev_b32 v21, 16, v21
    v_add_f32 v22, v22, v36
    v_cvt_pk_bf16_f32 v22, v22, v22
    v_lshlrev_b32 v22, 16, v22
    v_add_f32 v23, v23, v37
    v_cvt_pk_bf16_f32 v23, v23, v23
    v_lshlrev_b32 v23, 16, v23
    v_add_f32 v24, v24, v38
    v_cvt_pk_bf16_f32 v24, v24, v24
    v_lshlrev_b32 v24, 16, v24
    v_add_f32 v25, v25, v39
    v_cvt_pk_bf16_f32 v25, v25, v25
    v_lshlrev_b32 v25, 16, v25
    v_add_f32 v108, v108, v40
    v_cvt_pk_bf16_f32 v108, v108, v108
    v_lshlrev_b32 v108, 16, v108
    v_add_f32 v108, 1.0, v108
    v_cvt_pk_bf16_f32 v108, v108, v108
    v_lshlrev_b32 v108, 16, v108
    v_add_f32 v109, v109, v41
    v_cvt_pk_bf16_f32 v109, v109, v109
    v_lshlrev_b32 v109, 16, v109
    v_add_f32 v109, 1.0, v109
    v_cvt_pk_bf16_f32 v109, v109, v109
    v_lshlrev_b32 v109, 16, v109
    v_add_f32 v110, v110, v42
    v_cvt_pk_bf16_f32 v110, v110, v110
    v_lshlrev_b32 v110, 16, v110
    v_add_f32 v110, 1.0, v110
    v_cvt_pk_bf16_f32 v110, v110, v110
    v_lshlrev_b32 v110, 16, v110
    v_add_f32 v111, v111, v43
    v_cvt_pk_bf16_f32 v111, v111, v111
    v_lshlrev_b32 v111, 16, v111
    v_add_f32 v111, 1.0, v111
    v_cvt_pk_bf16_f32 v111, v111, v111
    v_lshlrev_b32 v111, 16, v111
    s_mov_b32 s52, 0xc00000
    s_lshl_b32 s56, s41, 13
    s_add_u32 s56, s56, 0x6000000
    s_lshl_b32 s45, s40, 7
    s_add_u32 s45, s45, 127488
    v_mov_b32 v29, s45
    s_mov_b32 s46, 536870912
    s_mov_b64 exec, 1
    s_mov_b32 s70, 0
L_wp_148:
    buffer_load_dword v31, v29, s[12:15], 0 offen sc1
    s_add_u32 s70, s70, 1
    s_cmp_ge_u32 s70, 0x200000
    s_cbranch_scc1 L_w_done_96
    s_waitcnt vmcnt(0)
    v_cmp_gt_u32 vcc, s46, v31
    s_nop 1
    s_cbranch_vccz L_wp_148_ok
    s_sleep 2
    s_branch L_wp_148
L_wp_148_ok:
    s_mov_b64 exec, -1
    v_readfirstlane_b32 s45, v31
    s_nop 3
    s_and_b32 s46, s45, 511
    s_mul_i32 s46, s46, s46
    s_bfe_u32 s45, s45, 0xf0009
    s_lshl_b32 s45, s45, 5
    s_mov_b32 s80, s12
    s_mov_b32 s81, s13
    s_mov_b32 s83, 0x00020000
    s_mov_b32 s84, s12
    s_mov_b32 s85, s13
    s_mov_b32 s87, 0x00020000
    s_cmp_eq_u32 s45, s46
    s_cselect_b32 s82, s14, 0
    s_cselect_b32 s86, 0, s14
L_b_loop_145:
    s_cmp_eq_u64 s[36:37], 0
    s_cbranch_scc1 L_w_done_96
    s_ff1_i32_b64 s50, s[36:37]
    s_bitset0_b64 s[36:37], s50
    s_lshr_b64 s[74:75], s[72:73], s50
    s_ff1_i32_b64 s51, s[74:75]
    s_add_u32 s51, s51, 1
    s_add_u32 s62, s50, s51
    s_cmp_lg_u32 s51, 1
    s_cbranch_scc1 L_b_skip2_147
    s_lshl_b32 s63, s50, 5
    s_add_u32 s63, s63, s41
    s_lshl_b32 s47, s63, 11
    s_lshl_b32 s45, s44, 9
    s_add_u32 s47, s47, s45
    v_lshlrev_b32 v17, 3, v1
    buffer_load_dwordx2 v[208:209], v17, s[28:31], s47 offen
    s_add_u32 s45, s64, 4096
    s_waitcnt vmcnt(0)
    s_cmp_lg_u32 s44, 0
    s_cbranch_scc1 L_pw_149
    s_mov_b32 exec_hi, 0
    s_mov_b32 s70, 0
L_wp_150:
    buffer_load_dword v31, v5, s[12:15], s45 offen sc1
    s_add_u32 s70, s70, 1
    s_cmp_ge_u32 s70, 0x200000
    s_cbranch_scc1 L_w_done_96
    s_waitcnt vmcnt(0)
    v_cmp_gt_u32 vcc, s62, v31
    s_nop 1
    s_cbranch_vccz L_wp_150_ok
    s_sleep 1
    s_branch L_wp_150
L_wp_150_ok:
    s_mov_b64 exec, -1
L_pw_149:
    s_barrier
    s_lshl_b32 s45, s63, 12
    s_lshl_b32 s46, s44, 10
    s_add_u32 s45, s45, s46
    s_add_u32 s45, s45, 0x8000000
    buffer_load_dwordx4 v[64:67], v10, s[12:15], s45 offen sc1
    s_add_u32 s45, s45, 0x800000
    buffer_load_dwordx4 v[68:71], v10, s[12:15], s45 offen sc1
    s_add_u32 s45, s45, 0x800000
    buffer_load_dwordx4 v[72:75], v10, s[12:15], s45 offen sc1
    s_add_u32 s45, s45, 0x800000
    buffer_load_dwordx4 v[76:79], v10, s[12:15], s45 offen sc1
    v_lshlrev_b32 v160, 16, v208
    v_and_b32 v161, 0xffff0000, v208
    v_lshlrev_b32 v162, 16, v209
    v_and_b32 v163, 0xffff0000, v209
    s_waitcnt vmcnt(0)
    v_pk_add_f32 v[64:65], v[64:65], v[68:69]
    v_pk_add_f32 v[72:73], v[72:73], v[76:77]
    v_pk_add_f32 v[66:67], v[66:67], v[70:71]
    v_pk_add_f32 v[74:75], v[74:75], v[78:79]
    v_pk_add_f32 v[64:65], v[64:65], v[72:73]
    v_pk_add_f32 v[66:67], v[66:67], v[74:75]
    v_cvt_pk_bf16_f32 v64, v64, v64
    v_lshlrev_b32 v64, 16, v64
    v_cvt_pk_bf16_f32 v65, v65, v65
    v_lshlrev_b32 v65, 16, v65
    v_cvt_pk_bf16_f32 v66, v66, v66
    v_lshlrev_b32 v66, 16, v66
    v_cvt_pk_bf16_f32 v67, v67, v67
    v_lshlrev_b32 v67, 16, v67
    v_mul_f32 v64, v64, v18
    v_cvt_pk_bf16_f32 v64, v64, v64
    v_lshlrev_b32 v64, 16, v64
    v_add_f32 v64, v64, v160
    v_mul_f32 v65, v65, v19
    v_cvt_pk_bf16_f32 v65, v65, v65
    v_lshlrev_b32 v65, 16, v65
    v_add_f32 v65, v65, v161
    v_mul_f32 v66, v66, v20
    v_cvt_pk_bf16_f32 v66, v66, v66
    v_lshlrev_b32 v66, 16, v66
    v_add_f32 v66, v66, v162
    v_mul_f32 v67, v67, v21
    v_cvt_pk_bf16_f32 v67, v67, v67
    v_lshlrev_b32 v67, 16, v67
    v_add_f32 v67, v67, v163
    v_cvt_pk_bf16_f32 v208, v64, v65
    v_cvt_pk_bf16_f32 v209, v66, v67
    s_add_u32 s47, s47, 0x800000
    buffer_store_dwordx2 v[208:209], v17, s[12:15], s47 offen sc1
    v_lshlrev_b32 v64, 16, v208
    v_and_b32 v65, 0xffff0000, v208
    v_lshlrev_b32 v66, 16, v209
    v_and_b32 v67, 0xffff0000, v209
    v_add_f32 v26, v64, v65
    v_add_f32 v27, v66, v67
    v_add_f32 v26, v26, v27
    s_nop 1
    v_add_f32_dpp v26, v26, v26 row_shr:1 row_mask:0xf bank_mask:0xf bound_ctrl:0
    s_nop 1
    v_add_f32_dpp v26, v26, v26 row_shr:2 row_mask:0xf bank_mask:0xf bound_ctrl:0
    s_nop 1
    v_add_f32_dpp v26, v26, v26 row_shr:4 row_mask:0xf bank_mask:0xf bound_ctrl:0
    s_nop 1
    v_add_f32_dpp v26, v26, v26 row_shr:8 row_mask:0xf bank_mask:0xf bound_ctrl:0
    s_nop 1
    v_add_f32_dpp v26, v26, v26 row_bcast:15 row_mask:0xa bank_mask:0xf
    s_nop 1
    v_add_f32_dpp v26, v26, v26 row_bcast:31 row_mask:0xc bank_mask:0xf
    s_nop 1
    v_readlane_b32 s66, v26, 63
    s_nop 1
    v_mov_b32 v28, s66
    v_mul_f32 v28, 0x3b800000, v28
    v_mov_b32 v26, 0
    v_sub_f32 v27, v64, v28
    v_fmac_f32 v26, v27, v27
    v_sub_f32 v27, v65, v28
    v_fmac_f32 v26, v27, v27
    v_sub_f32 v27, v66, v28
    v_fmac_f32 v26, v27, v27
    v_sub_f32 v27, v67, v28
    v_fmac_f32 v26, v27, v27
    s_nop 1
    v_add_f32_dpp v26, v26, v26 row_shr:1 row_mask:0xf bank_mask:0xf bound_ctrl:0
    s_nop 1
    v_add_f32_dpp v26, v26, v26 row_shr:2 row_mask:0xf bank_mask:0xf bound_ctrl:0
    s_nop 1
    v_add_f32_dpp v26, v26, v26 row_shr:4 row_mask:0xf bank_mask:0xf bound_ctrl:0
    s_nop 1
    v_add_f32_dpp v26, v26, v26 row_shr:8 row_mask:0xf bank_mask:0xf bound_ctrl:0
    s_nop 1
    v_add_f32_dpp v26, v26, v26 row_bcast:15 row_mask:0xa bank_mask:0xf
    s_nop 1
    v_add_f32_dpp v26, v26, v26 row_bcast:31 row_mask:0xc bank_mask:0xf
    s_nop 1
    v_readlane_b32 s66, v26, 63
    s_lshl_b32 s45, s44, 3
    s_add_u32 s45, s45, 131072
    v_mov_b32 v29, s66
    v_mov_b32 v27, s45
    ds_write_b64 v27, v[28:29]
    v_mov_b32 v27, 131072
    s_waitcnt lgkmcnt(0)
    s_barrier
    ds_read_b128 v[68:71], v27
    ds_read_b128 v[72:75], v27 offset:16
    s_waitcnt lgkmcnt(0)
    v_add_f32 v27, v68, v70
    v_add_f32 v26, v72, v74
    v_add_f32 v27, v27, v26
    v_mul_f32 v27, 0x3e800000, v27
    v_add_f32 v26, v69, v71
    v_add_f32 v28, v73, v75
    v_add_f32 v26, v26, v28
    v_mov_b32 v28, 0
    v_sub_f32 v68, v68, v27
    v_fmac_f32 v28, v68, v68
    v_sub_f32 v70, v70, v27
    v_fmac_f32 v28, v70, v70
    v_sub_f32 v72, v72, v27
    v_fmac_f32 v28, v72, v72
    v_sub_f32 v74, v74, v27
    v_fmac_f32 v28, v74, v74
    v_mul_f32 v28, 0x43800000, v28
    v_add_f32 v26, v26, v28
    v_mul_f32 v26, 0x3a800000, v26
    v_cvt_pk_bf16_f32 v26, v26, v26
    v_lshlrev_b32 v26, 16, v26
    v_cvt_pk_bf16_f32 v27, v27, v27
    v_lshlrev_b32 v27, 16, v27
    v_add_f32 v26, 0x3727c5ac, v26
    v_cvt_pk_bf16_f32 v26, v26, v26
    v_lshlrev_b32 v26, 16, v26
    v_sqrt_f32 v26, v26
    s_nop 0
    v_cvt_pk_bf16_f32 v26, v26, v26
    v_lshlrev_b32 v26, 16, v26
    v_rcp_f32 v26, v26
    s_nop 0
    v_sub_f32 v64, v64, v27
    v_cvt_pk_bf16_f32 v64, v64, v64
    v_lshlrev_b32 v64, 16, v64
    v_mul_f32 v64, v64, v26
    v_cvt_pk_bf16_f32 v64, v64, v64
    v_lshlrev_b32 v64, 16, v64
    v_mul_f32 v64, v64, v108
    v_cvt_pk_bf16_f32 v64, v64, v64
    v_lshlrev_b32 v64, 16, v64
    v_add_f32 v64, v64, v22
    v_sub_f32 v65, v65, v27
    v_cvt_pk_bf16_f32 v65, v65, v65
    v_lshlrev_b32 v65, 16, v65
    v_mul_f32 v65, v65, v26
    v_cvt_pk_bf16_f32 v65, v65, v65
    v_lshlrev_b32 v65, 16, v65
    v_mul_f32 v65, v65, v109
    v_cvt_pk_bf16_f32 v65, v65, v65
    v_lshlrev_b32 v65, 16, v65
    v_add_f32 v65, v65, v23
    v_sub_f32 v66, v66, v27
    v_cvt_pk_bf16_f32 v66, v66, v66
    v_lshlrev_b32 v66, 16, v66
    v_mul_f32 v66, v66, v26
    v_cvt_pk_bf16_f32 v66, v66, v66
    v_lshlrev_b32 v66, 16, v66
    v_mul_f32 v66, v66, v110
    v_cvt_pk_bf16_f32 v66, v66, v66
    v_lshlrev_b32 v66, 16, v66
    v_add_f32 v66, v66, v24
    v_sub_f32 v67, v67, v27
    v_cvt_pk_bf16_f32 v67, v67, v67
    v_lshlrev_b32 v67, 16, v67
    v_mul_f32 v67, v67, v26
    v_cvt_pk_bf16_f32 v67, v67, v67
    v_lshlrev_b32 v67, 16, v67
    v_mul_f32 v67, v67, v111
    v_cvt_pk_bf16_f32 v67, v67, v67
    v_lshlrev_b32 v67, 16, v67
    v_add_f32 v67, v67, v25
    v_cvt_pk_bf16_f32 v64, v64, v65
    v_cvt_pk_bf16_f32 v65, v66, v67
    v_lshrrev_b32 v26, 5, v1
    v_lshlrev_b32 v26, 13, v26
    v_and_b32 v27, 255, v17
    v_add_u32 v26, v26, v27
    s_lshl_b32 s45, s50, 16
    s_lshl_b32 s46, s41, 8
    s_add_u32 s45, s45, s46
    s_lshl_b32 s46, s44, 14
    s_add_u32 s45, s45, s46
    s_add_u32 s45, s45, 0xc00000
    buffer_store_dwordx2 v[64:65], v26, s[12:15], s45 offen sc1
    s_branch L_b_skip_146
L_b_skip2_147:
    s_add_u32 s63, s50, s44
    s_lshl_b32 s63, s63, 5
    s_add_u32 s63, s63, s41
    s_lshl_b32 s47, s63, 11
    buffer_load_dwordx4 v[208:211], v10, s[28:31], s47 offen
    buffer_load_dwordx4 v[212:215], v10, s[28:31], s47 offen offset:1024
    s_add_u32 s45, s64, 4096
    s_cmp_lg_u32 s44, 0
    s_cbranch_scc1 L_pw_151
    s_mov_b32 exec_hi, 0
    s_mov_b32 s70, 0
L_wp_152:
    buffer_load_dword v31, v5, s[12:15], s45 offen sc1
    s_add_u32 s70, s70, 1
    s_cmp_ge_u32 s70, 0x200000
    s_cbranch_scc1 L_w_done_96
    s_waitcnt vmcnt(0)
    v_cmp_gt_u32 vcc, s62, v31
    s_nop 1
    s_cbranch_vccz L_wp_152_ok
    s_sleep 2
    s_branch L_wp_152
L_wp_152_ok:
    s_mov_b64 exec, -1
L_pw_151:
    s_barrier
    s_cmp_ge_u32 s44, s51
    s_cbranch_scc1 L_b_skip_146
    s_lshl_b32 s45, s63, 12
    s_add_u32 s45, s45, 0x8000000
    v_lshlrev_b32 v29, 5, v1
    buffer_load_dwordx4 v[64:67], v29, s[12:15], s45 offen offset:0 sc1
    buffer_load_dwordx4 v[68:71], v29, s[12:15], s45 offen offset:16 sc1
    buffer_load_dwordx4 v[72:75], v29, s[12:15], s45 offen offset:2048 sc1
    buffer_load_dwordx4 v[76:79], v29, s[12:15], s45 offen offset:2064 sc1
    s_add_u32 s45, s45, 0x800000
    buffer_load_dwordx4 v[160:163], v29, s[12:15], s45 offen offset:0 sc1
    buffer_load_dwordx4 v[164:167], v29, s[12:15], s45 offen offset:16 sc1
    buffer_load_dwordx4 v[168:171], v29, s[12:15], s45 offen offset:2048 sc1
    buffer_load_dwordx4 v[172:175], v29, s[12:15], s45 offen offset:2064 sc1
    s_add_u32 s45, s45, 0x800000
    buffer_load_dwordx4 v[176:179], v29, s[12:15], s45 offen offset:0 sc1
    buffer_load_dwordx4 v[180:183], v29, s[12:15], s45 offen offset:16 sc1
    buffer_load_dwordx4 v[184:187], v29, s[12:15], s45 offen offset:2048 sc1
    buffer_load_dwordx4 v[188:191], v29, s[12:15], s45 offen offset:2064 sc1
    s_add_u32 s45, s45, 0x800000
    buffer_load_dwordx4 v[192:195], v29, s[12:15], s45 offen offset:0 sc1
    buffer_load_dwordx4 v[196:199], v29, s[12:15], s45 offen offset:16 sc1
    buffer_load_dwordx4 v[200:203], v29, s[12:15], s45 offen offset:2048 sc1
    buffer_load_dwordx4 v[204:207], v29, s[12:15], s45 offen offset:2064 sc1
    s_waitcnt vmcnt(0)
    v_pk_add_f32 v[64:65], v[64:65], v[160:161]
    v_pk_add_f32 v[176:177], v[176:177], v[192:193]
    v_pk_add_f32 v[66:67], v[66:67], v[162:163]
    v_pk_add_f32 v[178:179], v[178:179], v[194:195]
    v_pk_add_f32 v[68:69], v[68:69], v[164:165]
    v_pk_add_f32 v[180:181], v[180:181], v[196:197]
    v_pk_add_f32 v[70:71], v[70:71], v[166:167]
    v_pk_add_f32 v[182:183], v[182:183], v[198:199]
    v_pk_add_f32 v[72:73], v[72:73], v[168:169]
    v_pk_add_f32 v[184:185], v[184:185], v[200:201]
    v_pk_add_f32 v[74:75], v[74:75], v[170:171]
    v_pk_add_f32 v[186:187], v[186:187], v[202:203]
    v_pk_add_f32 v[76:77], v[76:77], v[172:173]
    v_pk_add_f32 v[188:189], v[188:189], v[204:205]
    v_pk_add_f32 v[78:79], v[78:79], v[174:175]
    v_pk_add_f32 v[190:191], v[190:191], v[206:207]
    v_pk_add_f32 v[64:65], v[64:65], v[176:177]
    v_pk_add_f32 v[66:67], v[66:67], v[178:179]
    v_pk_add_f32 v[68:69], v[68:69], v[180:181]
    v_pk_add_f32 v[70:71], v[70:71], v[182:183]
    v_pk_add_f32 v[72:73], v[72:73], v[184:185]
    v_pk_add_f32 v[74:75], v[74:75], v[186:187]
    v_pk_add_f32 v[76:77], v[76:77], v[188:189]
    v_pk_add_f32 v[78:79], v[78:79], v[190:191]
    v_cvt_pk_bf16_f32 v64, v64, v64
    v_lshlrev_b32 v64, 16, v64
    v_cvt_pk_bf16_f32 v65, v65, v65
    v_lshlrev_b32 v65, 16, v65
    v_cvt_pk_bf16_f32 v66, v66, v66
    v_lshlrev_b32 v66, 16, v66
    v_cvt_pk_bf16_f32 v67, v67, v67
    v_lshlrev_b32 v67, 16, v67
    v_cvt_pk_bf16_f32 v68, v68, v68
    v_lshlrev_b32 v68, 16, v68
    v_cvt_pk_bf16_f32 v69, v69, v69
    v_lshlrev_b32 v69, 16, v69
    v_cvt_pk_bf16_f32 v70, v70, v70
    v_lshlrev_b32 v70, 16, v70
    v_cvt_pk_bf16_f32 v71, v71, v71
    v_lshlrev_b32 v71, 16, v71
    v_cvt_pk_bf16_f32 v72, v72, v72
    v_lshlrev_b32 v72, 16, v72
    v_cvt_pk_bf16_f32 v73, v73, v73
    v_lshlrev_b32 v73, 16, v73
    v_cvt_pk_bf16_f32 v74, v74, v74
    v_lshlrev_b32 v74, 16, v74
    v_cvt_pk_bf16_f32 v75, v75, v75
    v_lshlrev_b32 v75, 16, v75
    v_cvt_pk_bf16_f32 v76, v76, v76
    v_lshlrev_b32 v76, 16, v76
    v_cvt_pk_bf16_f32 v77, v77, v77
    v_lshlrev_b32 v77, 16, v77
    v_cvt_pk_bf16_f32 v78, v78, v78
    v_lshlrev_b32 v78, 16, v78
    v_cvt_pk_bf16_f32 v79, v79, v79
    v_lshlrev_b32 v79, 16, v79
    v_lshlrev_b32 v160, 16, v208
    v_and_b32 v161, 0xffff0000, v208
    v_lshlrev_b32 v162, 16, v209
    v_and_b32 v163, 0xffff0000, v209
    v_lshlrev_b32 v164, 16, v210
    v_and_b32 v165, 0xffff0000, v210
    v_lshlrev_b32 v166, 16, v211
    v_and_b32 v167, 0xffff0000, v211
    v_lshlrev_b32 v168, 16, v212
    v_and_b32 v169, 0xffff0000, v212
    v_lshlrev_b32 v170, 16, v213
    v_and_b32 v171, 0xffff0000, v213
    v_lshlrev_b32 v172, 16, v214
    v_and_b32 v173, 0xffff0000, v214
    v_lshlrev_b32 v174, 16, v215
    v_and_b32 v175, 0xffff0000, v215
    v_mul_f32 v64, v64, v112
    v_cvt_pk_bf16_f32 v64, v64, v64
    v_lshlrev_b32 v64, 16, v64
    v_add_f32 v64, v64, v160
    v_mul_f32 v65, v65, v113
    v_cvt_pk_bf16_f32 v65, v65, v65
    v_lshlrev_b32 v65, 16, v65
    v_add_f32 v65, v65, v161
    v_mul_f32 v66, v66, v114
    v_cvt_pk_bf16_f32 v66, v66, v66
    v_lshlrev_b32 v66, 16, v66
    v_add_f32 v66, v66, v162
    v_mul_f32 v67, v67, v115
    v_cvt_pk_bf16_f32 v67, v67, v67
    v_lshlrev_b32 v67, 16, v67
    v_add_f32 v67, v67, v163
    v_mul_f32 v68, v68, v116
    v_cvt_pk_bf16_f32 v68, v68, v68
    v_lshlrev_b32 v68, 16, v68
    v_add_f32 v68, v68, v164
    v_mul_f32 v69, v69, v117
    v_cvt_pk_bf16_f32 v69, v69, v69
    v_lshlrev_b32 v69, 16, v69
    v_add_f32 v69, v69, v165
    v_mul_f32 v70, v70, v118
    v_cvt_pk_bf16_f32 v70, v70, v70
    v_lshlrev_b32 v70, 16, v70
    v_add_f32 v70, v70, v166
    v_mul_f32 v71, v71, v119
    v_cvt_pk_bf16_f32 v71, v71, v71
    v_lshlrev_b32 v71, 16, v71
    v_add_f32 v71, v71, v167
    v_mul_f32 v72, v72, v120
    v_cvt_pk_bf16_f32 v72, v72, v72
    v_lshlrev_b32 v72, 16, v72
    v_add_f32 v72, v72, v168
    v_mul_f32 v73, v73, v121
    v_cvt_pk_bf16_f32 v73, v73, v73
    v_lshlrev_b32 v73, 16, v73
    v_add_f32 v73, v73, v169
    v_mul_f32 v74, v74, v122
    v_cvt_pk_bf16_f32 v74, v74, v74
    v_lshlrev_b32 v74, 16, v74
    v_add_f32 v74, v74, v170
    v_mul_f32 v75, v75, v123
    v_cvt_pk_bf16_f32 v75, v75, v75
    v_lshlrev_b32 v75, 16, v75
    v_add_f32 v75, v75, v171
    v_mul_f32 v76, v76, v124
    v_cvt_pk_bf16_f32 v76, v76, v76
    v_lshlrev_b32 v76, 16, v76
    v_add_f32 v76, v76, v172
    v_mul_f32 v77, v77, v125
    v_cvt_pk_bf16_f32 v77, v77, v77
    v_lshlrev_b32 v77, 16, v77
    v_add_f32 v77, v77, v173
    v_mul_f32 v78, v78, v126
    v_cvt_pk_bf16_f32 v78, v78, v78
    v_lshlrev_b32 v78, 16, v78
    v_add_f32 v78, v78, v174
    v_mul_f32 v79, v79, v127
    v_cvt_pk_bf16_f32 v79, v79, v79
    v_lshlrev_b32 v79, 16, v79
    v_add_f32 v79, v79, v175
    v_cvt_pk_bf16_f32 v208, v64, v65
    v_cvt_pk_bf16_f32 v209, v66, v67
    v_cvt_pk_bf16_f32 v210, v68, v69
    v_cvt_pk_bf16_f32 v211, v70, v71
    v_cvt_pk_bf16_f32 v212, v72, v73
    v_cvt_pk_bf16_f32 v213, v74, v75
    v_cvt_pk_bf16_f32 v214, v76, v77
    v_cvt_pk_bf16_f32 v215, v78, v79
    s_add_u32 s47, s47, 0x800000
    buffer_store_dwordx4 v[208:211], v10, s[12:15], s47 offen sc1
    buffer_store_dwordx4 v[212:215], v10, s[12:15], s47 offen offset:1024 sc1
    v_lshlrev_b32 v64, 16, v208
    v_and_b32 v65, 0xffff0000, v208
    v_lshlrev_b32 v66, 16, v209
    v_and_b32 v67, 0xffff0000, v209
    v_lshlrev_b32 v68, 16, v210
    v_and_b32 v69, 0xffff0000, v210
    v_lshlrev_b32 v70, 16, v211
    v_and_b32 v71, 0xffff0000, v211
    v_lshlrev_b32 v72, 16, v212
    v_and_b32 v73, 0xffff0000, v212
    v_lshlrev_b32 v74, 16, v213
    v_and_b32 v75, 0xffff0000, v213
    v_lshlrev_b32 v76, 16, v214
    v_and_b32 v77, 0xffff0000, v214
    v_lshlrev_b32 v78, 16, v215
    v_and_b32 v79, 0xffff0000, v215
    v_add_f32 v26, v64, v65
    v_add_f32 v26, v26, v66
    v_add_f32 v26, v26, v67
    v_add_f32 v26, v26, v68
    v_add_f32 v26, v26, v69
    v_add_f32 v26, v26, v70
    v_add_f32 v26, v26, v71
    v_add_f32 v26, v26, v72
    v_add_f32 v26, v26, v73
    v_add_f32 v26, v26, v74
    v_add_f32 v26, v26, v75
    v_add_f32 v26, v26, v76
    v_add_f32 v26, v26, v77
    v_add_f32 v26, v26, v78
    v_add_f32 v26, v26, v79
    s_nop 1
    v_add_f32_dpp v26, v26, v26 row_shr:1 row_mask:0xf bank_mask:0xf bound_ctrl:0
    s_nop 1
    v_add_f32_dpp v26, v26, v26 row_shr:2 row_mask:0xf bank_mask:0xf bound_ctrl:0
    s_nop 1
    v_add_f32_dpp v26, v26, v26 row_shr:4 row_mask:0xf bank_mask:0xf bound_ctrl:0
    s_nop 1
    v_add_f32_dpp v26, v26, v26 row_shr:8 row_mask:0xf bank_mask:0xf bound_ctrl:0
    s_nop 1
    v_add_f32_dpp v26, v26, v26 row_bcast:15 row_mask:0xa bank_mask:0xf
    s_nop 1
    v_add_f32_dpp v26, v26, v26 row_bcast:31 row_mask:0xc bank_mask:0xf
    s_nop 1
    v_readlane_b32 s66, v26, 63
    s_nop 1
    v_mov_b32 v27, s66
    v_mul_f32 v27, 0x3a800000, v27
    v_mov_b32 v26, 0
    v_sub_f32 v28, v64, v27
    v_fmac_f32 v26, v28, v28
    v_sub_f32 v28, v65, v27
    v_fmac_f32 v26, v28, v28
    v_sub_f32 v28, v66, v27
    v_fmac_f32 v26, v28, v28
    v_sub_f32 v28, v67, v27
    v_fmac_f32 v26, v28, v28
    v_sub_f32 v28, v68, v27
    v_fmac_f32 v26, v28, v28
    v_sub_f32 v28, v69, v27
    v_fmac_f32 v26, v28, v28
    v_sub_f32 v28, v70, v27
    v_fmac_f32 v26, v28, v28
    v_sub_f32 v28, v71, v27
    v_fmac_f32 v26, v28, v28
    v_sub_f32 v28, v72, v27
    v_fmac_f32 v26, v28, v28
    v_sub_f32 v28, v73, v27
    v_fmac_f32 v26, v28, v28
    v_sub_f32 v28, v74, v27
    v_fmac_f32 v26, v28, v28
    v_sub_f32 v28, v75, v27
    v_fmac_f32 v26, v28, v28
    v_sub_f32 v28, v76, v27
    v_fmac_f32 v26, v28, v28
    v_sub_f32 v28, v77, v27
    v_fmac_f32 v26, v28, v28
    v_sub_f32 v28, v78, v27
    v_fmac_f32 v26, v28, v28
    v_sub_f32 v28, v79, v27
    v_fmac_f32 v26, v28, v28
    s_nop 1
    v_add_f32_dpp v26, v26, v26 row_shr:1 row_mask:0xf bank_mask:0xf bound_ctrl:0
    s_nop 1
    v_add_f32_dpp v26, v26, v26 row_shr:2 row_mask:0xf bank_mask:0xf bound_ctrl:0
    s_nop 1
    v_add_f32_dpp v26, v26, v26 row_shr:4 row_mask:0xf bank_mask:0xf bound_ctrl:0
    s_nop 1
    v_add_f32_dpp v26, v26, v26 row_shr:8 row_mask:0xf bank_mask:0xf bound_ctrl:0
    s_nop 1
    v_add_f32_dpp v26, v26, v26 row_bcast:15 row_mask:0xa bank_mask:0xf
    s_nop 1
    v_add_f32_dpp v26, v26, v26 row_bcast:31 row_mask:0xc bank_mask:0xf
    s_nop 1
    v_readlane_b32 s66, v26, 63
    s_nop 1
    v_mov_b32 v26, s66
    v_mul_f32 v26, 0x3a800000, v26
    v_cvt_pk_bf16_f32 v26, v26, v26
    v_lshlrev_b32 v26, 16, v26
    v_cvt_pk_bf16_f32 v27, v27, v27
    v_lshlrev_b32 v27, 16, v27
    v_add_f32 v26, 0x3727c5ac, v26
    v_cvt_pk_bf16_f32 v26, v26, v26
    v_lshlrev_b32 v26, 16, v26
    v_sqrt_f32 v26, v26
    s_nop 0
    v_cvt_pk_bf16_f32 v26, v26, v26
    v_lshlrev_b32 v26, 16, v26
    v_rcp_f32 v26, v26
    s_nop 0
    v_sub_f32 v64, v64, v27
    v_cvt_pk_bf16_f32 v64, v64, v64
    v_lshlrev_b32 v64, 16, v64
    v_mul_f32 v64, v64, v26
    v_cvt_pk_bf16_f32 v64, v64, v64
    v_lshlrev_b32 v64, 16, v64
    v_sub_f32 v65, v65, v27
    v_cvt_pk_bf16_f32 v65, v65, v65
    v_lshlrev_b32 v65, 16, v65
    v_mul_f32 v65, v65, v26
    v_cvt_pk_bf16_f32 v65, v65, v65
    v_lshlrev_b32 v65, 16, v65
    v_sub_f32 v66, v66, v27
    v_cvt_pk_bf16_f32 v66, v66, v66
    v_lshlrev_b32 v66, 16, v66
    v_mul_f32 v66, v66, v26
    v_cvt_pk_bf16_f32 v66, v66, v66
    v_lshlrev_b32 v66, 16, v66
    v_sub_f32 v67, v67, v27
    v_cvt_pk_bf16_f32 v67, v67, v67
    v_lshlrev_b32 v67, 16, v67
    v_mul_f32 v67, v67, v26
    v_cvt_pk_bf16_f32 v67, v67, v67
    v_lshlrev_b32 v67, 16, v67
    v_sub_f32 v68, v68, v27
    v_cvt_pk_bf16_f32 v68, v68, v68
    v_lshlrev_b32 v68, 16, v68
    v_mul_f32 v68, v68, v26
    v_cvt_pk_bf16_f32 v68, v68, v68
    v_lshlrev_b32 v68, 16, v68
    v_sub_f32 v69, v69, v27
    v_cvt_pk_bf16_f32 v69, v69, v69
    v_lshlrev_b32 v69, 16, v69
    v_mul_f32 v69, v69, v26
    v_cvt_pk_bf16_f32 v69, v69, v69
    v_lshlrev_b32 v69, 16, v69
    v_sub_f32 v70, v70, v27
    v_cvt_pk_bf16_f32 v70, v70, v70
    v_lshlrev_b32 v70, 16, v70
    v_mul_f32 v70, v70, v26
    v_cvt_pk_bf16_f32 v70, v70, v70
    v_lshlrev_b32 v70, 16, v70
    v_sub_f32 v71, v71, v27
    v_cvt_pk_bf16_f32 v71, v71, v71
    v_lshlrev_b32 v71, 16, v71
    v_mul_f32 v71, v71, v26
    v_cvt_pk_bf16_f32 v71, v71, v71
    v_lshlrev_b32 v71, 16, v71
    v_sub_f32 v72, v72, v27
    v_cvt_pk_bf16_f32 v72, v72, v72
    v_lshlrev_b32 v72, 16, v72
    v_mul_f32 v72, v72, v26
    v_cvt_pk_bf16_f32 v72, v72, v72
    v_lshlrev_b32 v72, 16, v72
    v_sub_f32 v73, v73, v27
    v_cvt_pk_bf16_f32 v73, v73, v73
    v_lshlrev_b32 v73, 16, v73
    v_mul_f32 v73, v73, v26
    v_cvt_pk_bf16_f32 v73, v73, v73
    v_lshlrev_b32 v73, 16, v73
    v_sub_f32 v74, v74, v27
    v_cvt_pk_bf16_f32 v74, v74, v74
    v_lshlrev_b32 v74, 16, v74
    v_mul_f32 v74, v74, v26
    v_cvt_pk_bf16_f32 v74, v74, v74
    v_lshlrev_b32 v74, 16, v74
    v_sub_f32 v75, v75, v27
    v_cvt_pk_bf16_f32 v75, v75, v75
    v_lshlrev_b32 v75, 16, v75
    v_mul_f32 v75, v75, v26
    v_cvt_pk_bf16_f32 v75, v75, v75
    v_lshlrev_b32 v75, 16, v75
    v_sub_f32 v76, v76, v27
    v_cvt_pk_bf16_f32 v76, v76, v76
    v_lshlrev_b32 v76, 16, v76
    v_mul_f32 v76, v76, v26
    v_cvt_pk_bf16_f32 v76, v76, v76
    v_lshlrev_b32 v76, 16, v76
    v_sub_f32 v77, v77, v27
    v_cvt_pk_bf16_f32 v77, v77, v77
    v_lshlrev_b32 v77, 16, v77
    v_mul_f32 v77, v77, v26
    v_cvt_pk_bf16_f32 v77, v77, v77
    v_lshlrev_b32 v77, 16, v77
    v_sub_f32 v78, v78, v27
    v_cvt_pk_bf16_f32 v78, v78, v78
    v_lshlrev_b32 v78, 16, v78
    v_mul_f32 v78, v78, v26
    v_cvt_pk_bf16_f32 v78, v78, v78
    v_lshlrev_b32 v78, 16, v78
    v_sub_f32 v79, v79, v27
    v_cvt_pk_bf16_f32 v79, v79, v79
    v_lshlrev_b32 v79, 16, v79
    v_mul_f32 v79, v79, v26
    v_cvt_pk_bf16_f32 v79, v79, v79
    v_lshlrev_b32 v79, 16, v79
    v_mul_f32 v64, v64, v144
    v_cvt_pk_bf16_f32 v64, v64, v64
    v_lshlrev_b32 v64, 16, v64
    v_add_f32 v64, v64, v128
    v_mul_f32 v65, v65, v145
    v_cvt_pk_bf16_f32 v65, v65, v65
    v_lshlrev_b32 v65, 16, v65
    v_add_f32 v65, v65, v129
    v_mul_f32 v66, v66, v146
    v_cvt_pk_bf16_f32 v66, v66, v66
    v_lshlrev_b32 v66, 16, v66
    v_add_f32 v66, v66, v130
    v_mul_f32 v67, v67, v147
    v_cvt_pk_bf16_f32 v67, v67, v67
    v_lshlrev_b32 v67, 16, v67
    v_add_f32 v67, v67, v131
    v_mul_f32 v68, v68, v148
    v_cvt_pk_bf16_f32 v68, v68, v68
    v_lshlrev_b32 v68, 16, v68
    v_add_f32 v68, v68, v132
    v_mul_f32 v69, v69, v149
    v_cvt_pk_bf16_f32 v69, v69, v69
    v_lshlrev_b32 v69, 16, v69
    v_add_f32 v69, v69, v133
    v_mul_f32 v70, v70, v150
    v_cvt_pk_bf16_f32 v70, v70, v70
    v_lshlrev_b32 v70, 16, v70
    v_add_f32 v70, v70, v134
    v_mul_f32 v71, v71, v151
    v_cvt_pk_bf16_f32 v71, v71, v71
    v_lshlrev_b32 v71, 16, v71
    v_add_f32 v71, v71, v135
    v_mul_f32 v72, v72, v152
    v_cvt_pk_bf16_f32 v72, v72, v72
    v_lshlrev_b32 v72, 16, v72
    v_add_f32 v72, v72, v136
    v_mul_f32 v73, v73, v153
    v_cvt_pk_bf16_f32 v73, v73, v73
    v_lshlrev_b32 v73, 16, v73
    v_add_f32 v73, v73, v137
    v_mul_f32 v74, v74, v154
    v_cvt_pk_bf16_f32 v74, v74, v74
    v_lshlrev_b32 v74, 16, v74
    v_add_f32 v74, v74, v138
    v_mul_f32 v75, v75, v155
    v_cvt_pk_bf16_f32 v75, v75, v75
    v_lshlrev_b32 v75, 16, v75
    v_add_f32 v75, v75, v139
    v_mul_f32 v76, v76, v156
    v_cvt_pk_bf16_f32 v76, v76, v76
    v_lshlrev_b32 v76, 16, v76
    v_add_f32 v76, v76, v140
    v_mul_f32 v77, v77, v157
    v_cvt_pk_bf16_f32 v77, v77, v77
    v_lshlrev_b32 v77, 16, v77
    v_add_f32 v77, v77, v141
    v_mul_f32 v78, v78, v158
    v_cvt_pk_bf16_f32 v78, v78, v78
    v_lshlrev_b32 v78, 16, v78
    v_add_f32 v78, v78, v142
    v_mul_f32 v79, v79, v159
    v_cvt_pk_bf16_f32 v79, v79, v79
    v_lshlrev_b32 v79, 16, v79
    v_add_f32 v79, v79, v143
    v_cvt_pk_bf16_f32 v80, v64, v65
    v_cvt_pk_bf16_f32 v81, v66, v67
    v_cvt_pk_bf16_f32 v82, v68, v69
    v_cvt_pk_bf16_f32 v83, v70, v71
    v_cvt_pk_bf16_f32 v84, v72, v73
    v_cvt_pk_bf16_f32 v85, v74, v75
    v_cvt_pk_bf16_f32 v86, v76, v77
    v_cvt_pk_bf16_f32 v87, v78, v79
    s_lshr_b32 s45, s63, 5
    s_lshl_b32 s45, s45, 16
    s_and_b32 s46, s63, 31
    s_lshl_b32 s46, s46, 8
    s_add_u32 s45, s45, s46
    s_add_u32 s45, s45, 0xc00000
    s_add_u32 s46, s45, 32768
    buffer_store_dwordx4 v[80:83], v2, s[12:15], s45 offen sc1
    buffer_store_dwordx4 v[84:87], v2, s[12:15], s46 offen sc1
L_b_skip_146:
    s_waitcnt vmcnt(0)
    s_barrier
    s_cmp_lg_u32 s44, 0
    s_cbranch_scc1 L_pub_153
    v_mov_b32 v30, s62
    v_mov_b32 v31, 0
    s_mov_b64 exec, 1
    buffer_store_dword v30, v31, s[80:83], s65 offen
    buffer_store_dword v30, v31, s[84:87], s65 offen sc1
    s_mov_b64 exec, -1
L_pub_153:
    s_cmp_ge_u32 s41, 28
    s_cbranch_scc1 L_b_loop_145
    s_add_u32 s45, s64, 8192
    s_cmp_lg_u32 s44, 0
    s_cbranch_scc1 L_pw_154
    s_mov_b32 exec_hi, 0
    s_mov_b32 s70, 0
L_wp_155:
    buffer_load_dword v31, v5, s[12:15], s45 offen sc1
    s_add_u32 s70, s70, 1
    s_cmp_ge_u32 s70, 0x200000
    s_cbranch_scc1 L_w_done_96
    s_waitcnt vmcnt(0)
    v_cmp_gt_u32 vcc, s62, v31
    s_nop 1
    s_cbranch_vccz L_wp_155_ok
    s_sleep 1
    s_branch L_wp_155
L_wp_155_ok:
    s_mov_b64 exec, -1
L_pw_154:
    s_barrier
    s_mul_i32 s53, s50, 65536
    s_add_u32 s53, s53, s52
    s_lshl_b32 s54, s44, 13
    s_add_u32 s53, s53, s54
    s_mul_i32 s57, s50, 229376
    s_add_u32 s57, s57, s56
    s_lshl_b32 s45, s44, 11
    s_add_u32 s57, s57, s45
    s_add_u32 s55, s54, 65536
    s_mov_b32 s58, 0
    v_mov_b32 v13, v3
    v_add_u32 v14, 65536, v13
    v_xor_b32 v15, 64, v13
    v_xor_b32 v16, 64, v14
    s_mov_b32 s76, 0x20000000
    s_add_u32 s48, s53, 0
    s_add_u32 s49, s48, 4096
    s_add_u32 m0, s54, 0
    s_nop 0
    buffer_load_dwordx4 v6, s[12:15], s48 offen offset:0 sc1 lds
    s_add_u32 m0, s54, 1024
    s_nop 0
    buffer_load_dwordx4 v9, s[12:15], s48 offen offset:0 sc1 lds
    s_add_u32 m0, s54, 2048
    s_nop 0
    buffer_load_dwordx4 v6, s[12:15], s49 offen offset:0 sc1 lds
    s_add_u32 m0, s54, 3072
    s_nop 0
    buffer_load_dwordx4 v9, s[12:15], s49 offen offset:0 sc1 lds
    s_add_u32 m0, s54, 3968
    s_nop 0
    buffer_load_dwordx4 v6, s[12:15], s48 offen offset:128 sc1 lds
    s_add_u32 m0, s54, 4992
    s_nop 0
    buffer_load_dwordx4 v9, s[12:15], s48 offen offset:128 sc1 lds
    s_add_u32 m0, s54, 6016
    s_nop 0
    buffer_load_dwordx4 v6, s[12:15], s49 offen offset:128 sc1 lds
    s_add_u32 m0, s54, 7040
    s_nop 0
    buffer_load_dwordx4 v9, s[12:15], s49 offen offset:128 sc1 lds
    s_add_u32 s48, s53, 32768
    s_add_u32 s49, s48, 4096
    s_add_u32 s46, s54, 32768
    s_add_u32 m0, s46, 0
    s_nop 0
    buffer_load_dwordx4 v6, s[12:15], s48 offen offset:0 sc1 lds
    s_add_u32 m0, s46, 1024
    s_nop 0
    buffer_load_dwordx4 v9, s[12:15], s48 offen offset:0 sc1 lds
    s_add_u32 m0, s46, 2048
    s_nop 0
    buffer_load_dwordx4 v6, s[12:15], s49 offen offset:0 sc1 lds
    s_add_u32 m0, s46, 3072
    s_nop 0
    buffer_load_dwordx4 v9, s[12:15], s49 offen offset:0 sc1 lds
    s_add_u32 m0, s46, 3968
    s_nop 0
    buffer_load_dwordx4 v6, s[12:15], s48 offen offset:128 sc1 lds
    s_add_u32 m0, s46, 4992
    s_nop 0
    buffer_load_dwordx4 v9, s[12:15], s48 offen offset:128 sc1 lds
    s_add_u32 m0, s46, 6016
    s_nop 0
    buffer_load_dwordx4 v6, s[12:15], s49 offen offset:128 sc1 lds
    s_add_u32 m0, s46, 7040
    s_nop 0
    buffer_load_dwordx4 v9, s[12:15], s49 offen offset:128 sc1 lds
    s_cmp_eq_u32 s51, 1
    s_cbranch_scc1 L_e_one_157
    s_add_u32 s48, s53, 65536
    s_add_u32 s49, s48, 4096
    s_add_u32 m0, s55, 0
    s_nop 0
    buffer_load_dwordx4 v6, s[12:15], s48 offen offset:0 sc1 lds
    s_add_u32 m0, s55, 1024
    s_nop 0
    buffer_load_dwordx4 v9, s[12:15], s48 offen offset:0 sc1 lds
    s_add_u32 m0, s55, 2048
    s_nop 0
    buffer_load_dwordx4 v6, s[12:15], s49 offen offset:0 sc1 lds
    s_add_u32 m0, s55, 3072
    s_nop 0
    buffer_load_dwordx4 v9, s[12:15], s49 offen offset:0 sc1 lds
    s_add_u32 m0, s55, 3968
    s_nop 0
    buffer_load_dwordx4 v6, s[12:15], s48 offen offset:128 sc1 lds
    s_add_u32 m0, s55, 4992
    s_nop 0
    buffer_load_dwordx4 v9, s[12:15], s48 offen offset:128 sc1 lds
    s_add_u32 m0, s55, 6016
    s_nop 0
    buffer_load_dwordx4 v6, s[12:15], s49 offen offset:128 sc1 lds
    s_add_u32 m0, s55, 7040
    s_nop 0
    buffer_load_dwordx4 v9, s[12:15], s49 offen offset:128 sc1 lds
    s_waitcnt vmcnt(16)
    s_barrier
    ds_read_b128 v[32:35], v13 offset:0
    ds_read_b128 v[36:39], v13 offset:2048
    ds_read_b128 v[40:43], v15 offset:0
    ds_read_b128 v[44:47], v15 offset:2048
L_e_loop_156:
    s_add_u32 s48, s53, 98304
    s_add_u32 s46, s58, 1
    s_cmp_lt_u32 s46, s51
    s_cselect_b32 s48, s48, 0x20000000
    s_add_u32 s49, s48, 4096
    s_add_u32 s59, s55, 32768
    s_waitcnt lgkmcnt(2)
    v_mfma_f32_16x16x32_bf16 v[80:83], a[0:3], v[32:35], 0
    ds_read_b128 v[48:51], v13 offset:4096
    ds_read_b128 v[52:55], v13 offset:6144
    v_mfma_f32_16x16x32_bf16 v[84:87], a[4:7], v[32:35], 0
    ds_read_b128 v[56:59], v15 offset:4096
    ds_read_b128 v[60:63], v15 offset:6144
    v_mfma_f32_16x16x32_bf16 v[88:91], a[0:3], v[36:39], 0
    s_add_u32 m0, s59, 0
    s_nop 0
    buffer_load_dwordx4 v6, s[12:15], s48 offen offset:0 sc1 lds
    v_mfma_f32_16x16x32_bf16 v[92:95], a[4:7], v[36:39], 0
    v_lshlrev_b32 v224, 16, v216
    v_and_b32 v225, 0xffff0000, v216
    s_waitcnt lgkmcnt(4)
    v_mfma_f32_16x16x32_bf16 v[80:83], a[8:11], v[40:43], v[80:83]
    ds_read_b128 v[32:35], v13 offset:8192
    ds_read_b128 v[36:39], v13 offset:10240
    v_mfma_f32_16x16x32_bf16 v[84:87], a[12:15], v[40:43], v[84:87]
    v_lshlrev_b32 v226, 16, v217
    v_and_b32 v227, 0xffff0000, v217
    v_mfma_f32_16x16x32_bf16 v[88:91], a[8:11], v[44:47], v[88:91]
    s_add_u32 m0, s59, 1024
    s_nop 0
    buffer_load_dwordx4 v9, s[12:15], s48 offen offset:0 sc1 lds
    v_mfma_f32_16x16x32_bf16 v[92:95], a[12:15], v[44:47], v[92:95]
    v_lshlrev_b32 v228, 16, v218
    v_and_b32 v229, 0xffff0000, v218
    s_waitcnt lgkmcnt(4)
    v_mfma_f32_16x16x32_bf16 v[80:83], a[16:19], v[48:51], v[80:83]
    ds_read_b128 v[40:43], v15 offset:8192
    ds_read_b128 v[44:47], v15 offset:10240
    v_mfma_f32_16x16x32_bf16 v[84:87], a[20:23], v[48:51], v[84:87]
    v_lshlrev_b32 v230, 16, v219
    v_and_b32 v231, 0xffff0000, v219
    v_mfma_f32_16x16x32_bf16 v[88:91], a[16:19], v[52:55], v[88:91]
    s_add_u32 m0, s59, 2048
    s_nop 0
    buffer_load_dwordx4 v6, s[12:15], s49 offen offset:0 sc1 lds
    v_mfma_f32_16x16x32_bf16 v[92:95], a[20:23], v[52:55], v[92:95]
    v_lshlrev_b32 v232, 16, v220
    v_and_b32 v233, 0xffff0000, v220
    s_waitcnt lgkmcnt(4)
    v_mfma_f32_16x16x32_bf16 v[80:83], a[24:27], v[56:59], v[80:83]
    ds_read_b128 v[48:51], v13 offset:12288
    ds_read_b128 v[52:55], v13 offset:14336
    v_mfma_f32_16x16x32_bf16 v[84:87], a[28:31], v[56:59], v[84:87]
    v_lshlrev_b32 v234, 16, v221
    v_and_b32 v235, 0xffff0000, v221
    v_mfma_f32_16x16x32_bf16 v[88:91], a[24:27], v[60:63], v[88:91]
    s_add_u32 m0, s59, 3072
    s_nop 0
    buffer_load_dwordx4 v9, s[12:15], s49 offen offset:0 sc1 lds
    v_mfma_f32_16x16x32_bf16 v[92:95], a[28:31], v[60:63], v[92:95]
    v_lshlrev_b32 v236, 16, v222
    v_and_b32 v237, 0xffff0000, v222
    s_waitcnt lgkmcnt(4)
    v_mfma_f32_16x16x32_bf16 v[80:83], a[32:35], v[32:35], v[80:83]
    ds_read_b128 v[56:59], v15 offset:12288
    ds_read_b128 v[60:63], v15 offset:14336
    v_mfma_f32_16x16x32_bf16 v[84:87], a[36:39], v[32:35], v[84:87]
    v_lshlrev_b32 v238, 16, v223
    v_and_b32 v239, 0xffff0000, v223
    v_mfma_f32_16x16x32_bf16 v[88:91], a[32:35], v[36:39], v[88:91]
    s_add_u32 m0, s59, 3968
    s_nop 0
    buffer_load_dwordx4 v6, s[12:15], s48 offen offset:128 sc1 lds
    v_mfma_f32_16x16x32_bf16 v[92:95], a[36:39], v[36:39], v[92:95]
    v_pk_add_f32 v[224:225], v[224:225], v[96:97]
    v_pk_add_f32 v[226:227], v[226:227], v[98:99]
    s_waitcnt lgkmcnt(4)
    v_mfma_f32_16x16x32_bf16 v[80:83], a[40:43], v[40:43], v[80:83]
    ds_read_b128 v[32:35], v13 offset:16384
    ds_read_b128 v[36:39], v13 offset:18432
    v_mfma_f32_16x16x32_bf16 v[84:87], a[44:47], v[40:43], v[84:87]
    v_pk_add_f32 v[228:229], v[228:229], v[100:101]
    v_pk_add_f32 v[230:231], v[230:231], v[102:103]
    v_mfma_f32_16x16x32_bf16 v[88:91], a[40:43], v[44:47], v[88:91]
    s_add_u32 m0, s59, 4992
    s_nop 0
    buffer_load_dwordx4 v9, s[12:15], s48 offen offset:128 sc1 lds
    v_mfma_f32_16x16x32_bf16 v[92:95], a[44:47], v[44:47], v[92:95]
    v_pk_add_f32 v[232:233], v[232:233], v[96:97]
    v_pk_add_f32 v[234:235], v[234:235], v[98:99]
    s_waitcnt lgkmcnt(4)
    v_mfma_f32_16x16x32_bf16 v[80:83], a[48:51], v[48:51], v[80:83]
    ds_read_b128 v[40:43], v15 offset:16384
    ds_read_b128 v[44:47], v15 offset:18432
    v_mfma_f32_16x16x32_bf16 v[84:87], a[52:55], v[48:51], v[84:87]
    v_pk_add_f32 v[236:237], v[236:237], v[100:101]
    v_pk_add_f32 v[238:239], v[238:239], v[102:103]
    v_mfma_f32_16x16x32_bf16 v[88:91], a[48:51], v[52:55], v[88:91]
    s_add_u32 m0, s59, 6016
    s_nop 0
    buffer_load_dwordx4 v6, s[12:15], s49 offen offset:128 sc1 lds
    v_mfma_f32_16x16x32_bf16 v[92:95], a[52:55], v[52:55], v[92:95]
    v_cvt_pk_bf16_f32 v216, v224, v225
    v_cvt_pk_bf16_f32 v217, v226, v227
    s_waitcnt lgkmcnt(4)
    v_mfma_f32_16x16x32_bf16 v[80:83], a[56:59], v[56:59], v[80:83]
    ds_read_b128 v[48:51], v13 offset:20480
    ds_read_b128 v[52:55], v13 offset:22528
    v_mfma_f32_16x16x32_bf16 v[84:87], a[60:63], v[56:59], v[84:87]
    v_cvt_pk_bf16_f32 v218, v228, v229
    v_cvt_pk_bf16_f32 v219, v230, v231
    v_mfma_f32_16x16x32_bf16 v[88:91], a[56:59], v[60:63], v[88:91]
    s_add_u32 m0, s59, 7040
    s_nop 0
    buffer_load_dwordx4 v9, s[12:15], s49 offen offset:128 sc1 lds
    v_mfma_f32_16x16x32_bf16 v[92:95], a[60:63], v[60:63], v[92:95]
    v_cvt_pk_bf16_f32 v220, v232, v233
    v_cvt_pk_bf16_f32 v221, v234, v235
    s_waitcnt lgkmcnt(4)
    v_mfma_f32_16x16x32_bf16 v[80:83], a[64:67], v[32:35], v[80:83]
    ds_read_b128 v[56:59], v15 offset:20480
    ds_read_b128 v[60:63], v15 offset:22528
    v_mfma_f32_16x16x32_bf16 v[84:87], a[68:71], v[32:35], v[84:87]
    v_cvt_pk_bf16_f32 v222, v236, v237
    v_cvt_pk_bf16_f32 v223, v238, v239
    v_mfma_f32_16x16x32_bf16 v[88:91], a[64:67], v[36:39], v[88:91]
    v_lshlrev_b32 v224, 16, v216
    v_and_b32 v225, 0xffff0000, v216
    v_mfma_f32_16x16x32_bf16 v[92:95], a[68:71], v[36:39], v[92:95]
    v_lshlrev_b32 v226, 16, v217
    v_and_b32 v227, 0xffff0000, v217
    s_waitcnt lgkmcnt(4)
    v_mfma_f32_16x16x32_bf16 v[80:83], a[72:75], v[40:43], v[80:83]
    ds_read_b128 v[32:35], v13 offset:24576
    ds_read_b128 v[36:39], v13 offset:26624
    v_mfma_f32_16x16x32_bf16 v[84:87], a[76:79], v[40:43], v[84:87]
    v_lshlrev_b32 v228, 16, v218
    v_and_b32 v229, 0xffff0000, v218
    v_mfma_f32_16x16x32_bf16 v[88:91], a[72:75], v[44:47], v[88:91]
    v_lshlrev_b32 v230, 16, v219
    v_and_b32 v231, 0xffff0000, v219
    v_mfma_f32_16x16x32_bf16 v[92:95], a[76:79], v[44:47], v[92:95]
    v_lshlrev_b32 v232, 16, v220
    v_and_b32 v233, 0xffff0000, v220
    s_waitcnt lgkmcnt(4)
    v_mfma_f32_16x16x32_bf16 v[80:83], a[80:83], v[48:51], v[80:83]
    ds_read_b128 v[40:43], v15 offset:24576
    ds_read_b128 v[44:47], v15 offset:26624
    v_mfma_f32_16x16x32_bf16 v[84:87], a[84:87], v[48:51], v[84:87]
    v_lshlrev_b32 v234, 16, v221
    v_and_b32 v235, 0xffff0000, v221
    v_mfma_f32_16x16x32_bf16 v[88:91], a[80:83], v[52:55], v[88:91]
    v_lshlrev_b32 v236, 16, v222
    v_and_b32 v237, 0xffff0000, v222
    v_mfma_f32_16x16x32_bf16 v[92:95], a[84:87], v[52:55], v[92:95]
    v_lshlrev_b32 v238, 16, v223
    v_and_b32 v239, 0xffff0000, v223
    s_waitcnt lgkmcnt(4)
    v_mfma_f32_16x16x32_bf16 v[80:83], a[88:91], v[56:59], v[80:83]
    ds_read_b128 v[48:51], v13 offset:28672
    ds_read_b128 v[52:55], v13 offset:30720
    v_mfma_f32_16x16x32_bf16 v[84:87], a[92:95], v[56:59], v[84:87]
    v_pk_mul_f32 v[240:241], v[224:225], v[224:225]
    v_pk_mul_f32 v[242:243], v[226:227], v[226:227]
    v_mfma_f32_16x16x32_bf16 v[88:91], a[88:91], v[60:63], v[88:91]
    v_pk_mul_f32 v[244:245], v[228:229], v[228:229]
    v_pk_mul_f32 v[246:247], v[230:231], v[230:231]
    v_mfma_f32_16x16x32_bf16 v[92:95], a[92:95], v[60:63], v[92:95]
    v_pk_mul_f32 v[248:249], v[232:233], v[232:233]
    v_pk_mul_f32 v[250:251], v[234:235], v[234:235]
    s_waitcnt lgkmcnt(4)
    v_mfma_f32_16x16x32_bf16 v[80:83], a[96:99], v[32:35], v[80:83]
    ds_read_b128 v[56:59], v15 offset:28672
    ds_read_b128 v[60:63], v15 offset:30720
    v_mfma_f32_16x16x32_bf16 v[84:87], a[100:103], v[32:35], v[84:87]
    v_pk_mul_f32 v[252:253], v[236:237], v[236:237]
    v_pk_mul_f32 v[254:255], v[238:239], v[238:239]
    v_mfma_f32_16x16x32_bf16 v[88:91], a[96:99], v[36:39], v[88:91]
    v_pk_fma_f32 v[240:241], v[240:241], v[104:105], v[106:107]
    v_pk_fma_f32 v[242:243], v[242:243], v[104:105], v[106:107]
    v_mfma_f32_16x16x32_bf16 v[92:95], a[100:103], v[36:39], v[92:95]
    v_pk_fma_f32 v[244:245], v[244:245], v[104:105], v[106:107]
    v_pk_fma_f32 v[246:247], v[246:247], v[104:105], v[106:107]
    s_waitcnt lgkmcnt(4)
    v_mfma_f32_16x16x32_bf16 v[80:83], a[104:107], v[40:43], v[80:83]
    v_pk_fma_f32 v[248:249], v[248:249], v[104:105], v[106:107]
    v_pk_fma_f32 v[250:251], v[250:251], v[104:105], v[106:107]
    v_mfma_f32_16x16x32_bf16 v[84:87], a[108:111], v[40:43], v[84:87]
    v_pk_fma_f32 v[252:253], v[252:253], v[104:105], v[106:107]
    v_pk_fma_f32 v[254:255], v[254:255], v[104:105], v[106:107]
    v_mfma_f32_16x16x32_bf16 v[88:91], a[104:107], v[44:47], v[88:91]
    v_pk_mul_f32 v[240:241], v[240:241], v[224:225]
    v_pk_mul_f32 v[242:243], v[242:243], v[226:227]
    v_mfma_f32_16x16x32_bf16 v[92:95], a[108:111], v[44:47], v[92:95]
    v_pk_mul_f32 v[244:245], v[244:245], v[228:229]
    v_pk_mul_f32 v[246:247], v[246:247], v[230:231]
    s_waitcnt vmcnt(16) lgkmcnt(0)
    s_barrier
    v_mfma_f32_16x16x32_bf16 v[80:83], a[112:115], v[48:51], v[80:83]
    ds_read_b128 v[32:35], v13 offset:32768
    ds_read_b128 v[36:39], v13 offset:34816
    v_mfma_f32_16x16x32_bf16 v[84:87], a[116:119], v[48:51], v[84:87]
    v_pk_mul_f32 v[248:249], v[248:249], v[232:233]
    v_pk_mul_f32 v[250:251], v[250:251], v[234:235]
    v_mfma_f32_16x16x32_bf16 v[88:91], a[112:115], v[52:55], v[88:91]
    v_pk_mul_f32 v[252:253], v[252:253], v[236:237]
    v_pk_mul_f32 v[254:255], v[254:255], v[238:239]
    v_mfma_f32_16x16x32_bf16 v[92:95], a[116:119], v[52:55], v[92:95]
    v_exp_f32 v240, v240
    v_mfma_f32_16x16x32_bf16 v[80:83], a[120:123], v[56:59], v[80:83]
    ds_read_b128 v[40:43], v15 offset:32768
    ds_read_b128 v[44:47], v15 offset:34816
    v_mfma_f32_16x16x32_bf16 v[84:87], a[124:127], v[56:59], v[84:87]
    v_exp_f32 v241, v241
    v_exp_f32 v242, v242
    v_mfma_f32_16x16x32_bf16 v[88:91], a[120:123], v[60:63], v[88:91]
    v_exp_f32 v243, v243
    v_mfma_f32_16x16x32_bf16 v[92:95], a[124:127], v[60:63], v[92:95]
    v_exp_f32 v244, v244
    s_add_u32 s48, s53, 131072
    s_add_u32 s46, s58, 2
    s_cmp_lt_u32 s46, s51
    s_cselect_b32 s48, s48, 0x20000000
    s_add_u32 s49, s48, 4096
    s_mov_b32 s59, s54
    s_waitcnt lgkmcnt(2)
    v_mfma_f32_16x16x32_bf16 v[80:83], a[128:131], v[32:35], v[80:83]
    ds_read_b128 v[48:51], v13 offset:36864
    ds_read_b128 v[52:55], v13 offset:38912
    v_mfma_f32_16x16x32_bf16 v[84:87], a[132:135], v[32:35], v[84:87]
    ds_read_b128 v[56:59], v15 offset:36864
    ds_read_b128 v[60:63], v15 offset:38912
    v_mfma_f32_16x16x32_bf16 v[88:91], a[128:131], v[36:39], v[88:91]
    s_add_u32 m0, s59, 0
    s_nop 0
    buffer_load_dwordx4 v6, s[12:15], s48 offen offset:0 sc1 lds
    v_mfma_f32_16x16x32_bf16 v[92:95], a[132:135], v[36:39], v[92:95]
    v_exp_f32 v245, v245
    v_exp_f32 v246, v246
    s_waitcnt lgkmcnt(4)
    v_mfma_f32_16x16x32_bf16 v[80:83], a[136:139], v[40:43], v[80:83]
    ds_read_b128 v[32:35], v13 offset:40960
    ds_read_b128 v[36:39], v13 offset:43008
    v_mfma_f32_16x16x32_bf16 v[84:87], a[140:143], v[40:43], v[84:87]
    v_exp_f32 v247, v247
    v_exp_f32 v248, v248
    v_mfma_f32_16x16x32_bf16 v[88:91], a[136:139], v[44:47], v[88:91]
    s_add_u32 m0, s59, 1024
    s_nop 0
    buffer_load_dwordx4 v9, s[12:15], s48 offen offset:0 sc1 lds
    v_mfma_f32_16x16x32_bf16 v[92:95], a[140:143], v[44:47], v[92:95]
    v_exp_f32 v249, v249
    v_exp_f32 v250, v250
    s_waitcnt lgkmcnt(4)
    v_mfma_f32_16x16x32_bf16 v[80:83], a[144:147], v[48:51], v[80:83]
    ds_read_b128 v[40:43], v15 offset:40960
    ds_read_b128 v[44:47], v15 offset:43008
    v_mfma_f32_16x16x32_bf16 v[84:87], a[148:151], v[48:51], v[84:87]
    v_exp_f32 v251, v251
    v_exp_f32 v252, v252
    v_mfma_f32_16x16x32_bf16 v[88:91], a[144:147], v[52:55], v[88:91]
    s_add_u32 m0, s59, 2048
    s_nop 0
    buffer_load_dwordx4 v6, s[12:15], s49 offen offset:0 sc1 lds
    v_mfma_f32_16x16x32_bf16 v[92:95], a[148:151], v[52:55], v[92:95]
    v_exp_f32 v253, v253
    v_exp_f32 v254, v254
    s_waitcnt lgkmcnt(4)
    v_mfma_f32_16x16x32_bf16 v[80:83], a[152:155], v[56:59], v[80:83]
    ds_read_b128 v[48:51], v13 offset:45056
    ds_read_b128 v[52:55], v13 offset:47104
    v_mfma_f32_16x16x32_bf16 v[84:87], a[156:159], v[56:59], v[84:87]
    v_exp_f32 v255, v255
    v_add_f32 v240, 1.0, v240
    v_mfma_f32_16x16x32_bf16 v[88:91], a[152:155], v[60:63], v[88:91]
    s_add_u32 m0, s59, 3072
    s_nop 0
    buffer_load_dwordx4 v9, s[12:15], s49 offen offset:0 sc1 lds
    v_mfma_f32_16x16x32_bf16 v[92:95], a[156:159], v[60:63], v[92:95]
    v_add_f32 v241, 1.0, v241
    v_add_f32 v242, 1.0, v242
    s_waitcnt lgkmcnt(4)
    v_mfma_f32_16x16x32_bf16 v[80:83], a[160:163], v[32:35], v[80:83]
    ds_read_b128 v[56:59], v15 offset:45056
    ds_read_b128 v[60:63], v15 offset:47104
    v_mfma_f32_16x16x32_bf16 v[84:87], a[164:167], v[32:35], v[84:87]
    v_add_f32 v243, 1.0, v243
    v_add_f32 v244, 1.0, v244
    v_mfma_f32_16x16x32_bf16 v[88:91], a[160:163], v[36:39], v[88:91]
    s_add_u32 m0, s59, 3968
    s_nop 0
    buffer_load_dwordx4 v6, s[12:15], s48 offen offset:128 sc1 lds
    v_mfma_f32_16x16x32_bf16 v[92:95], a[164:167], v[36:39], v[92:95]
    v_add_f32 v245, 1.0, v245
    v_add_f32 v246, 1.0, v246
    s_waitcnt lgkmcnt(4)
    v_mfma_f32_16x16x32_bf16 v[80:83], a[168:171], v[40:43], v[80:83]
    ds_read_b128 v[32:35], v13 offset:49152
    ds_read_b128 v[36:39], v13 offset:51200
    v_mfma_f32_16x16x32_bf16 v[84:87], a[172:175], v[40:43], v[84:87]
    v_add_f32 v247, 1.0, v247
    v_add_f32 v248, 1.0, v248
    v_mfma_f32_16x16x32_bf16 v[88:91], a[168:171], v[44:47], v[88:91]
    s_add_u32 m0, s59, 4992
    s_nop 0
    buffer_load_dwordx4 v9, s[12:15], s48 offen offset:128 sc1 lds
    v_mfma_f32_16x16x32_bf16 v[92:95], a[172:175], v[44:47], v[92:95]
    v_add_f32 v249, 1.0, v249
    v_add_f32 v250, 1.0, v250
    s_waitcnt lgkmcnt(4)
    v_mfma_f32_16x16x32_bf16 v[80:83], a[176:179], v[48:51], v[80:83]
    ds_read_b128 v[40:43], v15 offset:49152
    ds_read_b128 v[44:47], v15 offset:51200
    v_mfma_f32_16x16x32_bf16 v[84:87], a[180:183], v[48:51], v[84:87]
    v_add_f32 v251, 1.0, v251
    v_add_f32 v252, 1.0, v252
    v_mfma_f32_16x16x32_bf16 v[88:91], a[176:179], v[52:55], v[88:91]
    s_add_u32 m0, s59, 6016
    s_nop 0
    buffer_load_dwordx4 v6, s[12:15], s49 offen offset:128 sc1 lds
    v_mfma_f32_16x16x32_bf16 v[92:95], a[180:183], v[52:55], v[92:95]
    v_add_f32 v253, 1.0, v253
    v_add_f32 v254, 1.0, v254
    s_waitcnt lgkmcnt(4)
    v_mfma_f32_16x16x32_bf16 v[80:83], a[184:187], v[56:59], v[80:83]
    ds_read_b128 v[48:51], v13 offset:53248
    ds_read_b128 v[52:55], v13 offset:55296
    v_mfma_f32_16x16x32_bf16 v[84:87], a[188:191], v[56:59], v[84:87]
    v_add_f32 v255, 1.0, v255
    v_rcp_f32 v240, v240
    v_mfma_f32_16x16x32_bf16 v[88:91], a[184:187], v[60:63], v[88:91]
    s_add_u32 m0, s59, 7040
    s_nop 0
    buffer_load_dwordx4 v9, s[12:15], s49 offen offset:128 sc1 lds
    v_mfma_f32_16x16x32_bf16 v[92:95], a[188:191], v[60:63], v[92:95]
    v_rcp_f32 v241, v241
    v_rcp_f32 v242, v242
    s_waitcnt lgkmcnt(4)
    v_mfma_f32_16x16x32_bf16 v[80:83], a[192:195], v[32:35], v[80:83]
    ds_read_b128 v[56:59], v15 offset:53248
    ds_read_b128 v[60:63], v15 offset:55296
    v_mfma_f32_16x16x32_bf16 v[84:87], a[196:199], v[32:35], v[84:87]
    v_rcp_f32 v243, v243
    v_rcp_f32 v244, v244
    v_mfma_f32_16x16x32_bf16 v[88:91], a[192:195], v[36:39], v[88:91]
    v_rcp_f32 v245, v245
    v_rcp_f32 v246, v246
    v_mfma_f32_16x16x32_bf16 v[92:95], a[196:199], v[36:39], v[92:95]
    v_rcp_f32 v247, v247
    v_rcp_f32 v248, v248
    s_waitcnt lgkmcnt(4)
    v_mfma_f32_16x16x32_bf16 v[80:83], a[200:203], v[40:43], v[80:83]
    ds_read_b128 v[32:35], v13 offset:57344
    ds_read_b128 v[36:39], v13 offset:59392
    v_mfma_f32_16x16x32_bf16 v[84:87], a[204:207], v[40:43], v[84:87]
    v_rcp_f32 v249, v249
    v_rcp_f32 v250, v250
    v_mfma_f32_16x16x32_bf16 v[88:91], a[200:203], v[44:47], v[88:91]
    v_rcp_f32 v251, v251
    v_mfma_f32_16x16x32_bf16 v[92:95], a[204:207], v[44:47], v[92:95]
    v_rcp_f32 v252, v252
    s_waitcnt lgkmcnt(4)
    v_mfma_f32_16x16x32_bf16 v[80:83], a[208:211], v[48:51], v[80:83]
    ds_read_b128 v[40:43], v15 offset:57344
    ds_read_b128 v[44:47], v15 offset:59392
    v_mfma_f32_16x16x32_bf16 v[84:87], a[212:215], v[48:51], v[84:87]
    v_rcp_f32 v253, v253
    v_rcp_f32 v254, v254
    v_mfma_f32_16x16x32_bf16 v[88:91], a[208:211], v[52:55], v[88:91]
    v_rcp_f32 v255, v255
    v_mfma_f32_16x16x32_bf16 v[92:95], a[212:215], v[52:55], v[92:95]
    v_pk_mul_f32 v[224:225], v[224:225], v[240:241]
    s_waitcnt lgkmcnt(4)
    v_mfma_f32_16x16x32_bf16 v[80:83], a[216:219], v[56:59], v[80:83]
    ds_read_b128 v[48:51], v13 offset:61440
    ds_read_b128 v[52:55], v13 offset:63488
    v_mfma_f32_16x16x32_bf16 v[84:87], a[220:223], v[56:59], v[84:87]
    v_pk_mul_f32 v[226:227], v[226:227], v[242:243]
    v_pk_mul_f32 v[228:229], v[228:229], v[244:245]
    v_mfma_f32_16x16x32_bf16 v[88:91], a[216:219], v[60:63], v[88:91]
    v_pk_mul_f32 v[230:231], v[230:231], v[246:247]
    v_mfma_f32_16x16x32_bf16 v[92:95], a[220:223], v[60:63], v[92:95]
    v_pk_mul_f32 v[232:233], v[232:233], v[248:249]
    s_waitcnt lgkmcnt(4)
    v_mfma_f32_16x16x32_bf16 v[80:83], a[224:227], v[32:35], v[80:83]
    ds_read_b128 v[56:59], v15 offset:61440
    ds_read_b128 v[60:63], v15 offset:63488
    v_mfma_f32_16x16x32_bf16 v[84:87], a[228:231], v[32:35], v[84:87]
    v_pk_mul_f32 v[234:235], v[234:235], v[250:251]
    v_pk_mul_f32 v[236:237], v[236:237], v[252:253]
    v_mfma_f32_16x16x32_bf16 v[88:91], a[224:227], v[36:39], v[88:91]
    v_pk_mul_f32 v[238:239], v[238:239], v[254:255]
    v_mfma_f32_16x16x32_bf16 v[92:95], a[228:231], v[36:39], v[92:95]
    v_cvt_pk_bf16_f32 v240, v224, v225
    s_waitcnt lgkmcnt(4)
    v_mfma_f32_16x16x32_bf16 v[80:83], a[232:235], v[40:43], v[80:83]
    v_cvt_pk_bf16_f32 v241, v226, v227
    v_mfma_f32_16x16x32_bf16 v[84:87], a[236:239], v[40:43], v[84:87]
    v_cvt_pk_bf16_f32 v242, v228, v229
    v_mfma_f32_16x16x32_bf16 v[88:91], a[232:235], v[44:47], v[88:91]
    v_cvt_pk_bf16_f32 v243, v230, v231
    v_mfma_f32_16x16x32_bf16 v[92:95], a[236:239], v[44:47], v[92:95]
    v_cvt_pk_bf16_f32 v244, v232, v233
    s_waitcnt vmcnt(16) lgkmcnt(0)
    s_barrier
    v_mfma_f32_16x16x32_bf16 v[80:83], a[240:243], v[48:51], v[80:83]
    ds_read_b128 v[32:35], v14 offset:0
    ds_read_b128 v[36:39], v14 offset:2048
    v_mfma_f32_16x16x32_bf16 v[84:87], a[244:247], v[48:51], v[84:87]
    v_cvt_pk_bf16_f32 v245, v234, v235
    v_cvt_pk_bf16_f32 v246, v236, v237
    v_mfma_f32_16x16x32_bf16 v[88:91], a[240:243], v[52:55], v[88:91]
    v_cvt_pk_bf16_f32 v247, v238, v239
    v_mfma_f32_16x16x32_bf16 v[92:95], a[244:247], v[52:55], v[92:95]
    buffer_store_dwordx4 v[240:243], v10, s[12:15], s76 offen sc1
    v_mfma_f32_16x16x32_bf16 v[80:83], a[248:251], v[56:59], v[80:83]
    ds_read_b128 v[40:43], v16 offset:0
    ds_read_b128 v[44:47], v16 offset:2048
    v_mfma_f32_16x16x32_bf16 v[84:87], a[252:255], v[56:59], v[84:87]
    buffer_store_dwordx4 v[244:247], v10, s[12:15], s76 offen offset:1024 sc1
    v_mfma_f32_16x16x32_bf16 v[88:91], a[248:251], v[60:63], v[88:91]
    v_mfma_f32_16x16x32_bf16 v[92:95], a[252:255], v[60:63], v[92:95]
    s_add_u32 s53, s53, 65536
    s_add_u32 s58, s58, 1
    v_swap_b32 v13, v14
    s_xor_b32 s54, s54, 65536
    s_xor_b32 s55, s55, 65536
    s_mov_b32 s76, s57
    v_swap_b32 v15, v16
    s_add_u32 s57, s57, 229376
    v_cvt_pk_bf16_f32 v216, v80, v81
    v_cvt_pk_bf16_f32 v217, v82, v83
    v_cvt_pk_bf16_f32 v218, v84, v85
    v_cvt_pk_bf16_f32 v219, v86, v87
    v_cvt_pk_bf16_f32 v220, v88, v89
    v_cvt_pk_bf16_f32 v221, v90, v91
    v_cvt_pk_bf16_f32 v222, v92, v93
    v_cvt_pk_bf16_f32 v223, v94, v95
    s_cmp_lt_u32 s58, s51
    s_cbranch_scc1 L_e_loop_156
    s_branch L_e_fin_158
L_e_one_157:
    s_waitcnt vmcnt(8)
    s_barrier
    ds_read_b128 v[32:35], v13 offset:0
    ds_read_b128 v[36:39], v13 offset:2048
    ds_read_b128 v[40:43], v15 offset:0
    ds_read_b128 v[44:47], v15 offset:2048
    s_waitcnt lgkmcnt(2)
    v_mfma_f32_16x16x32_bf16 v[80:83], a[0:3], v[32:35], 0
    ds_read_b128 v[48:51], v13 offset:4096
    ds_read_b128 v[52:55], v13 offset:6144
    v_mfma_f32_16x16x32_bf16 v[84:87], a[4:7], v[32:35], 0
    ds_read_b128 v[56:59], v15 offset:4096
    ds_read_b128 v[60:63], v15 offset:6144
    v_mfma_f32_16x16x32_bf16 v[88:91], a[0:3], v[36:39], 0
    v_mfma_f32_16x16x32_bf16 v[92:95], a[4:7], v[36:39], 0
    s_waitcnt lgkmcnt(4)
    v_mfma_f32_16x16x32_bf16 v[80:83], a[8:11], v[40:43], v[80:83]
    ds_read_b128 v[32:35], v13 offset:8192
    ds_read_b128 v[36:39], v13 offset:10240
    v_mfma_f32_16x16x32_bf16 v[84:87], a[12:15], v[40:43], v[84:87]
    v_mfma_f32_16x16x32_bf16 v[88:91], a[8:11], v[44:47], v[88:91]
    v_mfma_f32_16x16x32_bf16 v[92:95], a[12:15], v[44:47], v[92:95]
    s_waitcnt lgkmcnt(4)
    v_mfma_f32_16x16x32_bf16 v[80:83], a[16:19], v[48:51], v[80:83]
    ds_read_b128 v[40:43], v15 offset:8192
    ds_read_b128 v[44:47], v15 offset:10240
    v_mfma_f32_16x16x32_bf16 v[84:87], a[20:23], v[48:51], v[84:87]
    v_mfma_f32_16x16x32_bf16 v[88:91], a[16:19], v[52:55], v[88:91]
    v_mfma_f32_16x16x32_bf16 v[92:95], a[20:23], v[52:55], v[92:95]
    s_waitcnt lgkmcnt(4)
    v_mfma_f32_16x16x32_bf16 v[80:83], a[24:27], v[56:59], v[80:83]
    ds_read_b128 v[48:51], v13 offset:12288
    ds_read_b128 v[52:55], v13 offset:14336
    v_mfma_f32_16x16x32_bf16 v[84:87], a[28:31], v[56:59], v[84:87]
    v_mfma_f32_16x16x32_bf16 v[88:91], a[24:27], v[60:63], v[88:91]
    v_mfma_f32_16x16x32_bf16 v[92:95], a[28:31], v[60:63], v[92:95]
    s_waitcnt lgkmcnt(4)
    v_mfma_f32_16x16x32_bf16 v[80:83], a[32:35], v[32:35], v[80:83]
    ds_read_b128 v[56:59], v15 offset:12288
    ds_read_b128 v[60:63], v15 offset:14336
    v_mfma_f32_16x16x32_bf16 v[84:87], a[36:39], v[32:35], v[84:87]
    v_mfma_f32_16x16x32_bf16 v[88:91], a[32:35], v[36:39], v[88:91]
    v_mfma_f32_16x16x32_bf16 v[92:95], a[36:39], v[36:39], v[92:95]
    s_waitcnt lgkmcnt(4)
    v_mfma_f32_16x16x32_bf16 v[80:83], a[40:43], v[40:43], v[80:83]
    ds_read_b128 v[32:35], v13 offset:16384
    ds_read_b128 v[36:39], v13 offset:18432
    v_mfma_f32_16x16x32_bf16 v[84:87], a[44:47], v[40:43], v[84:87]
    v_mfma_f32_16x16x32_bf16 v[88:91], a[40:43], v[44:47], v[88:91]
    v_mfma_f32_16x16x32_bf16 v[92:95], a[44:47], v[44:47], v[92:95]
    s_waitcnt lgkmcnt(4)
    v_mfma_f32_16x16x32_bf16 v[80:83], a[48:51], v[48:51], v[80:83]
    ds_read_b128 v[40:43], v15 offset:16384
    ds_read_b128 v[44:47], v15 offset:18432
    v_mfma_f32_16x16x32_bf16 v[84:87], a[52:55], v[48:51], v[84:87]
    v_mfma_f32_16x16x32_bf16 v[88:91], a[48:51], v[52:55], v[88:91]
    v_mfma_f32_16x16x32_bf16 v[92:95], a[52:55], v[52:55], v[92:95]
    s_waitcnt lgkmcnt(4)
    v_mfma_f32_16x16x32_bf16 v[80:83], a[56:59], v[56:59], v[80:83]
    ds_read_b128 v[48:51], v13 offset:20480
    ds_read_b128 v[52:55], v13 offset:22528
    v_mfma_f32_16x16x32_bf16 v[84:87], a[60:63], v[56:59], v[84:87]
    v_mfma_f32_16x16x32_bf16 v[88:91], a[56:59], v[60:63], v[88:91]
    v_mfma_f32_16x16x32_bf16 v[92:95], a[60:63], v[60:63], v[92:95]
    s_waitcnt lgkmcnt(4)
    v_mfma_f32_16x16x32_bf16 v[80:83], a[64:67], v[32:35], v[80:83]
    ds_read_b128 v[56:59], v15 offset:20480
    ds_read_b128 v[60:63], v15 offset:22528
    v_mfma_f32_16x16x32_bf16 v[84:87], a[68:71], v[32:35], v[84:87]
    v_mfma_f32_16x16x32_bf16 v[88:91], a[64:67], v[36:39], v[88:91]
    v_mfma_f32_16x16x32_bf16 v[92:95], a[68:71], v[36:39], v[92:95]
    s_waitcnt lgkmcnt(4)
    v_mfma_f32_16x16x32_bf16 v[80:83], a[72:75], v[40:43], v[80:83]
    ds_read_b128 v[32:35], v13 offset:24576
    ds_read_b128 v[36:39], v13 offset:26624
    v_mfma_f32_16x16x32_bf16 v[84:87], a[76:79], v[40:43], v[84:87]
    v_mfma_f32_16x16x32_bf16 v[88:91], a[72:75], v[44:47], v[88:91]
    v_mfma_f32_16x16x32_bf16 v[92:95], a[76:79], v[44:47], v[92:95]
    s_waitcnt lgkmcnt(4)
    v_mfma_f32_16x16x32_bf16 v[80:83], a[80:83], v[48:51], v[80:83]
    ds_read_b128 v[40:43], v15 offset:24576
    ds_read_b128 v[44:47], v15 offset:26624
    v_mfma_f32_16x16x32_bf16 v[84:87], a[84:87], v[48:51], v[84:87]
    v_mfma_f32_16x16x32_bf16 v[88:91], a[80:83], v[52:55], v[88:91]
    v_mfma_f32_16x16x32_bf16 v[92:95], a[84:87], v[52:55], v[92:95]
    s_waitcnt lgkmcnt(4)
    v_mfma_f32_16x16x32_bf16 v[80:83], a[88:91], v[56:59], v[80:83]
    ds_read_b128 v[48:51], v13 offset:28672
    ds_read_b128 v[52:55], v13 offset:30720
    v_mfma_f32_16x16x32_bf16 v[84:87], a[92:95], v[56:59], v[84:87]
    v_mfma_f32_16x16x32_bf16 v[88:91], a[88:91], v[60:63], v[88:91]
    v_mfma_f32_16x16x32_bf16 v[92:95], a[92:95], v[60:63], v[92:95]
    s_waitcnt lgkmcnt(4)
    v_mfma_f32_16x16x32_bf16 v[80:83], a[96:99], v[32:35], v[80:83]
    ds_read_b128 v[56:59], v15 offset:28672
    ds_read_b128 v[60:63], v15 offset:30720
    v_mfma_f32_16x16x32_bf16 v[84:87], a[100:103], v[32:35], v[84:87]
    v_mfma_f32_16x16x32_bf16 v[88:91], a[96:99], v[36:39], v[88:91]
    v_mfma_f32_16x16x32_bf16 v[92:95], a[100:103], v[36:39], v[92:95]
    s_waitcnt lgkmcnt(4)
    v_mfma_f32_16x16x32_bf16 v[80:83], a[104:107], v[40:43], v[80:83]
    v_mfma_f32_16x16x32_bf16 v[84:87], a[108:111], v[40:43], v[84:87]
    v_mfma_f32_16x16x32_bf16 v[88:91], a[104:107], v[44:47], v[88:91]
    v_mfma_f32_16x16x32_bf16 v[92:95], a[108:111], v[44:47], v[92:95]
    s_waitcnt vmcnt(0) lgkmcnt(0)
    s_barrier
    v_mfma_f32_16x16x32_bf16 v[80:83], a[112:115], v[48:51], v[80:83]
    ds_read_b128 v[32:35], v13 offset:32768
    ds_read_b128 v[36:39], v13 offset:34816
    v_mfma_f32_16x16x32_bf16 v[84:87], a[116:119], v[48:51], v[84:87]
    v_mfma_f32_16x16x32_bf16 v[88:91], a[112:115], v[52:55], v[88:91]
    v_mfma_f32_16x16x32_bf16 v[92:95], a[116:119], v[52:55], v[92:95]
    v_mfma_f32_16x16x32_bf16 v[80:83], a[120:123], v[56:59], v[80:83]
    ds_read_b128 v[40:43], v15 offset:32768
    ds_read_b128 v[44:47], v15 offset:34816
    v_mfma_f32_16x16x32_bf16 v[84:87], a[124:127], v[56:59], v[84:87]
    v_mfma_f32_16x16x32_bf16 v[88:91], a[120:123], v[60:63], v[88:91]
    v_mfma_f32_16x16x32_bf16 v[92:95], a[124:127], v[60:63], v[92:95]
    s_waitcnt lgkmcnt(2)
    v_mfma_f32_16x16x32_bf16 v[80:83], a[128:131], v[32:35], v[80:83]
    ds_read_b128 v[48:51], v13 offset:36864
    ds_read_b128 v[52:55], v13 offset:38912
    v_mfma_f32_16x16x32_bf16 v[84:87], a[132:135], v[32:35], v[84:87]
    ds_read_b128 v[56:59], v15 offset:36864
    ds_read_b128 v[60:63], v15 offset:38912
    v_mfma_f32_16x16x32_bf16 v[88:91], a[128:131], v[36:39], v[88:91]
    v_mfma_f32_16x16x32_bf16 v[92:95], a[132:135], v[36:39], v[92:95]
    s_waitcnt lgkmcnt(4)
    v_mfma_f32_16x16x32_bf16 v[80:83], a[136:139], v[40:43], v[80:83]
    ds_read_b128 v[32:35], v13 offset:40960
    ds_read_b128 v[36:39], v13 offset:43008
    v_mfma_f32_16x16x32_bf16 v[84:87], a[140:143], v[40:43], v[84:87]
    v_mfma_f32_16x16x32_bf16 v[88:91], a[136:139], v[44:47], v[88:91]
    v_mfma_f32_16x16x32_bf16 v[92:95], a[140:143], v[44:47], v[92:95]
    s_waitcnt lgkmcnt(4)
    v_mfma_f32_16x16x32_bf16 v[80:83], a[144:147], v[48:51], v[80:83]
    ds_read_b128 v[40:43], v15 offset:40960
    ds_read_b128 v[44:47], v15 offset:43008
    v_mfma_f32_16x16x32_bf16 v[84:87], a[148:151], v[48:51], v[84:87]
    v_mfma_f32_16x16x32_bf16 v[88:91], a[144:147], v[52:55], v[88:91]
    v_mfma_f32_16x16x32_bf16 v[92:95], a[148:151], v[52:55], v[92:95]
    s_waitcnt lgkmcnt(4)
    v_mfma_f32_16x16x32_bf16 v[80:83], a[152:155], v[56:59], v[80:83]
    ds_read_b128 v[48:51], v13 offset:45056
    ds_read_b128 v[52:55], v13 offset:47104
    v_mfma_f32_16x16x32_bf16 v[84:87], a[156:159], v[56:59], v[84:87]
    v_mfma_f32_16x16x32_bf16 v[88:91], a[152:155], v[60:63], v[88:91]
    v_mfma_f32_16x16x32_bf16 v[92:95], a[156:159], v[60:63], v[92:95]
    s_waitcnt lgkmcnt(4)
    v_mfma_f32_16x16x32_bf16 v[80:83], a[160:163], v[32:35], v[80:83]
    ds_read_b128 v[56:59], v15 offset:45056
    ds_read_b128 v[60:63], v15 offset:47104
    v_mfma_f32_16x16x32_bf16 v[84:87], a[164:167], v[32:35], v[84:87]
    v_mfma_f32_16x16x32_bf16 v[88:91], a[160:163], v[36:39], v[88:91]
    v_mfma_f32_16x16x32_bf16 v[92:95], a[164:167], v[36:39], v[92:95]
    s_waitcnt lgkmcnt(4)
    v_mfma_f32_16x16x32_bf16 v[80:83], a[168:171], v[40:43], v[80:83]
    ds_read_b128 v[32:35], v13 offset:49152
    ds_read_b128 v[36:39], v13 offset:51200
    v_mfma_f32_16x16x32_bf16 v[84:87], a[172:175], v[40:43], v[84:87]
    v_mfma_f32_16x16x32_bf16 v[88:91], a[168:171], v[44:47], v[88:91]
    v_mfma_f32_16x16x32_bf16 v[92:95], a[172:175], v[44:47], v[92:95]
    s_waitcnt lgkmcnt(4)
    v_mfma_f32_16x16x32_bf16 v[80:83], a[176:179], v[48:51], v[80:83]
    ds_read_b128 v[40:43], v15 offset:49152
    ds_read_b128 v[44:47], v15 offset:51200
    v_mfma_f32_16x16x32_bf16 v[84:87], a[180:183], v[48:51], v[84:87]
    v_mfma_f32_16x16x32_bf16 v[88:91], a[176:179], v[52:55], v[88:91]
    v_mfma_f32_16x16x32_bf16 v[92:95], a[180:183], v[52:55], v[92:95]
    s_waitcnt lgkmcnt(4)
    v_mfma_f32_16x16x32_bf16 v[80:83], a[184:187], v[56:59], v[80:83]
    ds_read_b128 v[48:51], v13 offset:53248
    ds_read_b128 v[52:55], v13 offset:55296
    v_mfma_f32_16x16x32_bf16 v[84:87], a[188:191], v[56:59], v[84:87]
    v_mfma_f32_16x16x32_bf16 v[88:91], a[184:187], v[60:63], v[88:91]
    v_mfma_f32_16x16x32_bf16 v[92:95], a[188:191], v[60:63], v[92:95]
    s_waitcnt lgkmcnt(4)
    v_mfma_f32_16x16x32_bf16 v[80:83], a[192:195], v[32:35], v[80:83]
    ds_read_b128 v[56:59], v15 offset:53248
    ds_read_b128 v[60:63], v15 offset:55296
    v_mfma_f32_16x16x32_bf16 v[84:87], a[196:199], v[32:35], v[84:87]
    v_mfma_f32_16x16x32_bf16 v[88:91], a[192:195], v[36:39], v[88:91]
    v_mfma_f32_16x16x32_bf16 v[92:95], a[196:199], v[36:39], v[92:95]
    s_waitcnt lgkmcnt(4)
    v_mfma_f32_16x16x32_bf16 v[80:83], a[200:203], v[40:43], v[80:83]
    ds_read_b128 v[32:35], v13 offset:57344
    ds_read_b128 v[36:39], v13 offset:59392
    v_mfma_f32_16x16x32_bf16 v[84:87], a[204:207], v[40:43], v[84:87]
    v_mfma_f32_16x16x32_bf16 v[88:91], a[200:203], v[44:47], v[88:91]
    v_mfma_f32_16x16x32_bf16 v[92:95], a[204:207], v[44:47], v[92:95]
    s_waitcnt lgkmcnt(4)
    v_mfma_f32_16x16x32_bf16 v[80:83], a[208:211], v[48:51], v[80:83]
    ds_read_b128 v[40:43], v15 offset:57344
    ds_read_b128 v[44:47], v15 offset:59392
    v_mfma_f32_16x16x32_bf16 v[84:87], a[212:215], v[48:51], v[84:87]
    v_mfma_f32_16x16x32_bf16 v[88:91], a[208:211], v[52:55], v[88:91]
    v_mfma_f32_16x16x32_bf16 v[92:95], a[212:215], v[52:55], v[92:95]
    s_waitcnt lgkmcnt(4)
    v_mfma_f32_16x16x32_bf16 v[80:83], a[216:219], v[56:59], v[80:83]
    ds_read_b128 v[48:51], v13 offset:61440
    ds_read_b128 v[52:55], v13 offset:63488
    v_mfma_f32_16x16x32_bf16 v[84:87], a[220:223], v[56:59], v[84:87]
    v_mfma_f32_16x16x32_bf16 v[88:91], a[216:219], v[60:63], v[88:91]
    v_mfma_f32_16x16x32_bf16 v[92:95], a[220:223], v[60:63], v[92:95]
    s_waitcnt lgkmcnt(4)
    v_mfma_f32_16x16x32_bf16 v[80:83], a[224:227], v[32:35], v[80:83]
    ds_read_b128 v[56:59], v15 offset:61440
    ds_read_b128 v[60:63], v15 offset:63488
    v_mfma_f32_16x16x32_bf16 v[84:87], a[228:231], v[32:35], v[84:87]
    v_mfma_f32_16x16x32_bf16 v[88:91], a[224:227], v[36:39], v[88:91]
    v_mfma_f32_16x16x32_bf16 v[92:95], a[228:231], v[36:39], v[92:95]
    s_waitcnt lgkmcnt(4)
    v_mfma_f32_16x16x32_bf16 v[80:83], a[232:235], v[40:43], v[80:83]
    v_mfma_f32_16x16x32_bf16 v[84:87], a[236:239], v[40:43], v[84:87]
    v_mfma_f32_16x16x32_bf16 v[88:91], a[232:235], v[44:47], v[88:91]
    v_mfma_f32_16x16x32_bf16 v[92:95], a[236:239], v[44:47], v[92:95]
    s_waitcnt lgkmcnt(0)
    v_mfma_f32_16x16x32_bf16 v[80:83], a[240:243], v[48:51], v[80:83]
    v_mfma_f32_16x16x32_bf16 v[84:87], a[244:247], v[48:51], v[84:87]
    v_mfma_f32_16x16x32_bf16 v[88:91], a[240:243], v[52:55], v[88:91]
    v_mfma_f32_16x16x32_bf16 v[92:95], a[244:247], v[52:55], v[92:95]
    v_mfma_f32_16x16x32_bf16 v[80:83], a[248:251], v[56:59], v[80:83]
    v_mfma_f32_16x16x32_bf16 v[84:87], a[252:255], v[56:59], v[84:87]
    v_mfma_f32_16x16x32_bf16 v[88:91], a[248:251], v[60:63], v[88:91]
    v_mfma_f32_16x16x32_bf16 v[92:95], a[252:255], v[60:63], v[92:95]
    s_mov_b32 s76, s57
    s_nop 6
    v_cvt_pk_bf16_f32 v216, v80, v81
    v_cvt_pk_bf16_f32 v217, v82, v83
    v_cvt_pk_bf16_f32 v218, v84, v85
    v_cvt_pk_bf16_f32 v219, v86, v87
    v_cvt_pk_bf16_f32 v220, v88, v89
    v_cvt_pk_bf16_f32 v221, v90, v91
    v_cvt_pk_bf16_f32 v222, v92, v93
    v_cvt_pk_bf16_f32 v223, v94, v95
L_e_fin_158:
    v_lshlrev_b32 v224, 16, v216
    v_and_b32 v225, 0xffff0000, v216
    v_lshlrev_b32 v226, 16, v217
    v_and_b32 v227, 0xffff0000, v217
    v_lshlrev_b32 v228, 16, v218
    v_and_b32 v229, 0xffff0000, v218
    v_lshlrev_b32 v230, 16, v219
    v_and_b32 v231, 0xffff0000, v219
    v_lshlrev_b32 v232, 16, v220
    v_and_b32 v233, 0xffff0000, v220
    v_lshlrev_b32 v234, 16, v221
    v_and_b32 v235, 0xffff0000, v221
    v_lshlrev_b32 v236, 16, v222
    v_and_b32 v237, 0xffff0000, v222
    v_lshlrev_b32 v238, 16, v223
    v_and_b32 v239, 0xffff0000, v223
    v_pk_add_f32 v[224:225], v[224:225], v[96:97]
    v_pk_add_f32 v[226:227], v[226:227], v[98:99]
    v_pk_add_f32 v[228:229], v[228:229], v[100:101]
    v_pk_add_f32 v[230:231], v[230:231], v[102:103]
    v_pk_add_f32 v[232:233], v[232:233], v[96:97]
    v_pk_add_f32 v[234:235], v[234:235], v[98:99]
    v_pk_add_f32 v[236:237], v[236:237], v[100:101]
    v_pk_add_f32 v[238:239], v[238:239], v[102:103]
    v_cvt_pk_bf16_f32 v216, v224, v225
    v_cvt_pk_bf16_f32 v217, v226, v227
    v_cvt_pk_bf16_f32 v218, v228, v229
    v_cvt_pk_bf16_f32 v219, v230, v231
    v_cvt_pk_bf16_f32 v220, v232, v233
    v_cvt_pk_bf16_f32 v221, v234, v235
    v_cvt_pk_bf16_f32 v222, v236, v237
    v_cvt_pk_bf16_f32 v223, v238, v239
    v_lshlrev_b32 v224, 16, v216
    v_and_b32 v225, 0xffff0000, v216
    v_lshlrev_b32 v226, 16, v217
    v_and_b32 v227, 0xffff0000, v217
    v_lshlrev_b32 v228, 16, v218
    v_and_b32 v229, 0xffff0000, v218
    v_lshlrev_b32 v230, 16, v219
    v_and_b32 v231, 0xffff0000, v219
    v_lshlrev_b32 v232, 16, v220
    v_and_b32 v233, 0xffff0000, v220
    v_lshlrev_b32 v234, 16, v221
    v_and_b32 v235, 0xffff0000, v221
    v_lshlrev_b32 v236, 16, v222
    v_and_b32 v237, 0xffff0000, v222
    v_lshlrev_b32 v238, 16, v223
    v_and_b32 v239, 0xffff0000, v223
    v_pk_mul_f32 v[240:241], v[224:225], v[224:225]
    v_pk_mul_f32 v[242:243], v[226:227], v[226:227]
    v_pk_mul_f32 v[244:245], v[228:229], v[228:229]
    v_pk_mul_f32 v[246:247], v[230:231], v[230:231]
    v_pk_mul_f32 v[248:249], v[232:233], v[232:233]
    v_pk_mul_f32 v[250:251], v[234:235], v[234:235]
    v_pk_mul_f32 v[252:253], v[236:237], v[236:237]
    v_pk_mul_f32 v[254:255], v[238:239], v[238:239]
    v_pk_fma_f32 v[240:241], v[240:241], v[104:105], v[106:107]
    v_pk_fma_f32 v[242:243], v[242:243], v[104:105], v[106:107]
    v_pk_fma_f32 v[244:245], v[244:245], v[104:105], v[106:107]
    v_pk_fma_f32 v[246:247], v[246:247], v[104:105], v[106:107]
    v_pk_fma_f32 v[248:249], v[248:249], v[104:105], v[106:107]
    v_pk_fma_f32 v[250:251], v[250:251], v[104:105], v[106:107]
    v_pk_fma_f32 v[252:253], v[252:253], v[104:105], v[106:107]
    v_pk_fma_f32 v[254:255], v[254:255], v[104:105], v[106:107]
    v_pk_mul_f32 v[240:241], v[240:241], v[224:225]
    v_pk_mul_f32 v[242:243], v[242:243], v[226:227]
    v_pk_mul_f32 v[244:245], v[244:245], v[228:229]
    v_pk_mul_f32 v[246:247], v[246:247], v[230:231]
    v_pk_mul_f32 v[248:249], v[248:249], v[232:233]
    v_pk_mul_f32 v[250:251], v[250:251], v[234:235]
    v_pk_mul_f32 v[252:253], v[252:253], v[236:237]
    v_pk_mul_f32 v[254:255], v[254:255], v[238:239]
    v_exp_f32 v240, v240
    v_exp_f32 v241, v241
    v_exp_f32 v242, v242
    v_exp_f32 v243, v243
    v_exp_f32 v244, v244
    v_exp_f32 v245, v245
    v_exp_f32 v246, v246
    v_exp_f32 v247, v247
    v_exp_f32 v248, v248
    v_exp_f32 v249, v249
    v_exp_f32 v250, v250
    v_exp_f32 v251, v251
    v_exp_f32 v252, v252
    v_exp_f32 v253, v253
    v_exp_f32 v254, v254
    v_exp_f32 v255, v255
    v_add_f32 v240, 1.0, v240
    v_add_f32 v241, 1.0, v241
    v_add_f32 v242, 1.0, v242
    v_add_f32 v243, 1.0, v243
    v_add_f32 v244, 1.0, v244
    v_add_f32 v245, 1.0, v245
    v_add_f32 v246, 1.0, v246
    v_add_f32 v247, 1.0, v247
    v_add_f32 v248, 1.0, v248
    v_add_f32 v249, 1.0, v249
    v_add_f32 v250, 1.0, v250
    v_add_f32 v251, 1.0, v251
    v_add_f32 v252, 1.0, v252
    v_add_f32 v253, 1.0, v253
    v_add_f32 v254, 1.0, v254
    v_add_f32 v255, 1.0, v255
    v_rcp_f32 v240, v240
    v_rcp_f32 v241, v241
    v_rcp_f32 v242, v242
    v_rcp_f32 v243, v243
    v_rcp_f32 v244, v244
    v_rcp_f32 v245, v245
    v_rcp_f32 v246, v246
    v_rcp_f32 v247, v247
    v_rcp_f32 v248, v248
    v_rcp_f32 v249, v249
    v_rcp_f32 v250, v250
    v_rcp_f32 v251, v251
    v_rcp_f32 v252, v252
    v_rcp_f32 v253, v253
    v_rcp_f32 v254, v254
    v_rcp_f32 v255, v255
    v_pk_mul_f32 v[224:225], v[224:225], v[240:241]
    v_pk_mul_f32 v[226:227], v[226:227], v[242:243]
    v_pk_mul_f32 v[228:229], v[228:229], v[244:245]
    v_pk_mul_f32 v[230:231], v[230:231], v[246:247]
    v_pk_mul_f32 v[232:233], v[232:233], v[248:249]
    v_pk_mul_f32 v[234:235], v[234:235], v[250:251]
    v_pk_mul_f32 v[236:237], v[236:237], v[252:253]
    v_pk_mul_f32 v[238:239], v[238:239], v[254:255]
    v_cvt_pk_bf16_f32 v240, v224, v225
    v_cvt_pk_bf16_f32 v241, v226, v227
    v_cvt_pk_bf16_f32 v242, v228, v229
    v_cvt_pk_bf16_f32 v243, v230, v231
    v_cvt_pk_bf16_f32 v244, v232, v233
    v_cvt_pk_bf16_f32 v245, v234, v235
    v_cvt_pk_bf16_f32 v246, v236, v237
    v_cvt_pk_bf16_f32 v247, v238, v239
    buffer_store_dwordx4 v[240:243], v10, s[12:15], s76 offen sc1
    buffer_store_dwordx4 v[244:247], v10, s[12:15], s76 offen offset:1024 sc1
    s_waitcnt lgkmcnt(0)
    s_waitcnt vmcnt(0)
    s_barrier
    s_cmp_lg_u32 s44, 0
    s_cbranch_scc1 L_pub_159
    v_mov_b32 v30, s62
    v_mov_b32 v31, 0
    s_mov_b64 exec, 1
    buffer_store_dword v30, v31, s[12:15], s67 offen sc1
    s_mov_b64 exec, -1
L_pub_159:
    s_branch L_b_loop_145
L_role_c_124:
    s_load_dwordx2 s[6:7], s[0:1], 80
    s_load_dwordx2 s[8:9], s[0:1], 88
    s_load_dwordx2 s[10:11], s[0:1], 112
    s_waitcnt lgkmcnt(0)
    s_mov_b32 s24, s6
    s_and_b32 s25, s7, 0xffff
    s_mov_b32 s26, 0x700000
    s_mov_b32 s27, 0x00020000
    s_mov_b32 s28, s8
    s_and_b32 s29, s9, 0xffff
    s_mov_b32 s30, 0x800
    s_mov_b32 s31, 0x00020000
    s_mov_b32 s32, s10
    s_and_b32 s33, s11, 0xffff
    s_mov_b32 s34, 0x400000
    s_mov_b32 s35, 0x00020000
    s_mul_i32 s46, s38, 1835008
    s_lshl_b32 s45, s68, 8
    s_add_u32 s46, s46, s45
    s_waitcnt vmcnt(0)
    s_barrier
    v_lshrrev_b32 v20, 4, v1
    s_lshl_b32 s45, s44, 2
    v_add_u32 v21, s45, v20
    s_mov_b32 s45, 2048
    v_mul_lo_u32 v21, v21, s45
    v_lshlrev_b32 v22, 2, v20
    v_and_b32 v23, 15, v1
    v_xor_b32 v22, v22, v23
    v_lshlrev_b32 v22, 4, v22
    v_add_u32 v21, v21, v22
    v_bfe_u32 v22, v1, 2, 2
    v_lshlrev_b32 v23, 3, v20
    v_add_u32 v23, v23, v22
    v_lshlrev_b32 v23, 8, v23
    v_xor_b32 v22, s44, v22
    v_lshlrev_b32 v22, 6, v22
    v_add_u32 v23, v23, v22
    v_and_b32 v22, 3, v1
    v_lshlrev_b32 v22, 3, v22
    v_add_u32 v23, v23, v22
    v_add_u32 v24, 65536, v23
    v_add_u32 v25, 131072, v23
    s_lshl_b32 s47, s44, 10
    s_add_u32 s45, s46, 0x0
    s_add_u32 m0, s47, 0
    s_nop 0
    buffer_load_dwordx4 v21, s[24:27], s45 offen  lds
    s_add_u32 s45, s46, 0x8000
    s_add_u32 m0, s47, 4096
    s_nop 0
    buffer_load_dwordx4 v21, s[24:27], s45 offen  lds
    s_add_u32 s45, s46, 0x10000
    s_add_u32 m0, s47, 8192
    s_nop 0
    buffer_load_dwordx4 v21, s[24:27], s45 offen  lds
    s_add_u32 s45, s46, 0x18000
    s_add_u32 m0, s47, 12288
    s_nop 0
    buffer_load_dwordx4 v21, s[24:27], s45 offen  lds
    s_add_u32 s45, s46, 0x20000
    s_add_u32 m0, s47, 16384
    s_nop 0
    buffer_load_dwordx4 v21, s[24:27], s45 offen  lds
    s_add_u32 s45, s46, 0x28000
    s_add_u32 m0, s47, 20480
    s_nop 0
    buffer_load_dwordx4 v21, s[24:27], s45 offen  lds
    s_add_u32 s45, s46, 0x30000
    s_add_u32 m0, s47, 24576
    s_nop 0
    buffer_load_dwordx4 v21, s[24:27], s45 offen  lds
    s_add_u32 s45, s46, 0x38000
    s_add_u32 m0, s47, 28672
    s_nop 0
    buffer_load_dwordx4 v21, s[24:27], s45 offen  lds
    s_add_u32 s45, s46, 0x40000
    s_add_u32 m0, s47, 32768
    s_nop 0
    buffer_load_dwordx4 v21, s[24:27], s45 offen  lds
    s_add_u32 s45, s46, 0x48000
    s_add_u32 m0, s47, 36864
    s_nop 0
    buffer_load_dwordx4 v21, s[24:27], s45 offen  lds
    s_add_u32 s45, s46, 0x50000
    s_add_u32 m0, s47, 40960
    s_nop 0
    buffer_load_dwordx4 v21, s[24:27], s45 offen  lds
    s_add_u32 s45, s46, 0x58000
    s_add_u32 m0, s47, 45056
    s_nop 0
    buffer_load_dwordx4 v21, s[24:27], s45 offen  lds
    s_add_u32 s45, s46, 0x60000
    s_add_u32 m0, s47, 49152
    s_nop 0
    buffer_load_dwordx4 v21, s[24:27], s45 offen  lds
    s_add_u32 s45, s46, 0x68000
    s_add_u32 m0, s47, 53248
    s_nop 0
    buffer_load_dwordx4 v21, s[24:27], s45 offen  lds
    s_add_u32 s45, s46, 0x70000
    s_add_u32 m0, s47, 57344
    s_nop 0
    buffer_load_dwordx4 v21, s[24:27], s45 offen  lds
    s_add_u32 s45, s46, 0x78000
    s_add_u32 m0, s47, 61440
    s_nop 0
    buffer_load_dwordx4 v21, s[24:27], s45 offen  lds
    s_add_u32 s45, s46, 0x80000
    s_add_u32 m0, s47, 65536
    s_nop 0
    buffer_load_dwordx4 v21, s[24:27], s45 offen  lds
    s_add_u32 s45, s46, 0x88000
    s_add_u32 m0, s47, 69632
    s_nop 0
    buffer_load_dwordx4 v21, s[24:27], s45 offen  lds
    s_add_u32 s45, s46, 0x90000
    s_add_u32 m0, s47, 73728
    s_nop 0
    buffer_load_dwordx4 v21, s[24:27], s45 offen  lds
    s_add_u32 s45, s46, 0x98000
    s_add_u32 m0, s47, 77824
    s_nop 0
    buffer_load_dwordx4 v21, s[24:27], s45 offen  lds
    s_add_u32 s45, s46, 0xa0000
    s_add_u32 m0, s47, 81920
    s_nop 0
    buffer_load_dwordx4 v21, s[24:27], s45 offen  lds
    s_add_u32 s45, s46, 0xa8000
    s_add_u32 m0, s47, 86016
    s_nop 0
    buffer_load_dwordx4 v21, s[24:27], s45 offen  lds
    s_add_u32 s45, s46, 0xb0000
    s_add_u32 m0, s47, 90112
    s_nop 0
    buffer_load_dwordx4 v21, s[24:27], s45 offen  lds
    s_add_u32 s45, s46, 0xb8000
    s_add_u32 m0, s47, 94208
    s_nop 0
    buffer_load_dwordx4 v21, s[24:27], s45 offen  lds
    s_add_u32 s45, s46, 0xc0000
    s_add_u32 m0, s47, 98304
    s_nop 0
    buffer_load_dwordx4 v21, s[24:27], s45 offen  lds
    s_add_u32 s45, s46, 0xc8000
    s_add_u32 m0, s47, 102400
    s_nop 0
    buffer_load_dwordx4 v21, s[24:27], s45 offen  lds
    s_add_u32 s45, s46, 0xd0000
    s_add_u32 m0, s47, 106496
    s_nop 0
    buffer_load_dwordx4 v21, s[24:27], s45 offen  lds
    s_add_u32 s45, s46, 0xd8000
    s_add_u32 m0, s47, 110592
    s_nop 0
    buffer_load_dwordx4 v21, s[24:27], s45 offen  lds
    s_add_u32 s45, s46, 0xe0000
    s_add_u32 m0, s47, 114688
    s_nop 0
    buffer_load_dwordx4 v21, s[24:27], s45 offen  lds
    s_add_u32 s45, s46, 0xe8000
    s_add_u32 m0, s47, 118784
    s_nop 0
    buffer_load_dwordx4 v21, s[24:27], s45 offen  lds
    s_add_u32 s45, s46, 0xf0000
    s_add_u32 m0, s47, 122880
    s_nop 0
    buffer_load_dwordx4 v21, s[24:27], s45 offen  lds
    s_add_u32 s45, s46, 0xf8000
    s_add_u32 m0, s47, 126976
    s_nop 0
    buffer_load_dwordx4 v21, s[24:27], s45 offen  lds
    s_waitcnt vmcnt(28)
    s_barrier
    s_add_u32 s45, s46, 0x100000
    s_add_u32 m0, s47, 131072
    s_nop 0
    buffer_load_dwordx4 v21, s[24:27], s45 offen  lds
    s_add_u32 s45, s46, 0x108000
    s_add_u32 m0, s47, 135168
    s_nop 0
    buffer_load_dwordx4 v21, s[24:27], s45 offen  lds
    s_add_u32 s45, s46, 0x110000
    s_add_u32 m0, s47, 139264
    s_nop 0
    buffer_load_dwordx4 v21, s[24:27], s45 offen  lds
    s_add_u32 s45, s46, 0x118000
    s_add_u32 m0, s47, 143360
    s_nop 0
    buffer_load_dwordx4 v21, s[24:27], s45 offen  lds
    ds_read_b64_tr_b16 a[0:1], v23 offset:0
    ds_read_b64_tr_b16 a[2:3], v23 offset:1024
    ds_read_b64_tr_b16 a[4:5], v23 offset:32
    ds_read_b64_tr_b16 a[6:7], v23 offset:1056
    ds_read_b64_tr_b16 a[8:9], v23 offset:8192
    ds_read_b64_tr_b16 a[10:11], v23 offset:9216
    ds_read_b64_tr_b16 a[12:13], v23 offset:8224
    ds_read_b64_tr_b16 a[14:15], v23 offset:9248
    s_waitcnt lgkmcnt(0)
    s_waitcnt vmcnt(28)
    s_barrier
    s_add_u32 s45, s46, 0x120000
    s_add_u32 m0, s47, 0
    s_nop 0
    buffer_load_dwordx4 v21, s[24:27], s45 offen  lds
    s_add_u32 s45, s46, 0x128000
    s_add_u32 m0, s47, 4096
    s_nop 0
    buffer_load_dwordx4 v21, s[24:27], s45 offen  lds
    s_add_u32 s45, s46, 0x130000
    s_add_u32 m0, s47, 8192
    s_nop 0
    buffer_load_dwordx4 v21, s[24:27], s45 offen  lds
    s_add_u32 s45, s46, 0x138000
    s_add_u32 m0, s47, 12288
    s_nop 0
    buffer_load_dwordx4 v21, s[24:27], s45 offen  lds
    ds_read_b64_tr_b16 a[16:17], v23 offset:16384
    ds_read_b64_tr_b16 a[18:19], v23 offset:17408
    ds_read_b64_tr_b16 a[20:21], v23 offset:16416
    ds_read_b64_tr_b16 a[22:23], v23 offset:17440
    ds_read_b64_tr_b16 a[24:25], v23 offset:24576
    ds_read_b64_tr_b16 a[26:27], v23 offset:25600
    ds_read_b64_tr_b16 a[28:29], v23 offset:24608
    ds_read_b64_tr_b16 a[30:31], v23 offset:25632
    s_waitcnt lgkmcnt(0)
    s_waitcnt vmcnt(28)
    s_barrier
    s_add_u32 s45, s46, 0x140000
    s_add_u32 m0, s47, 16384
    s_nop 0
    buffer_load_dwordx4 v21, s[24:27], s45 offen  lds
    s_add_u32 s45, s46, 0x148000
    s_add_u32 m0, s47, 20480
    s_nop 0
    buffer_load_dwordx4 v21, s[24:27], s45 offen  lds
    s_add_u32 s45, s46, 0x150000
    s_add_u32 m0, s47, 24576
    s_nop 0
    buffer_load_dwordx4 v21, s[24:27], s45 offen  lds
    s_add_u32 s45, s46, 0x158000
    s_add_u32 m0, s47, 28672
    s_nop 0
    buffer_load_dwordx4 v21, s[24:27], s45 offen  lds
    ds_read_b64_tr_b16 a[32:33], v23 offset:32768
    ds_read_b64_tr_b16 a[34:35], v23 offset:33792
    ds_read_b64_tr_b16 a[36:37], v23 offset:32800
    ds_read_b64_tr_b16 a[38:39], v23 offset:33824
    ds_read_b64_tr_b16 a[40:41], v23 offset:40960
    ds_read_b64_tr_b16 a[42:43], v23 offset:41984
    ds_read_b64_tr_b16 a[44:45], v23 offset:40992
    ds_read_b64_tr_b16 a[46:47], v23 offset:42016
    s_waitcnt lgkmcnt(0)
    s_waitcnt vmcnt(28)
    s_barrier
    s_add_u32 s45, s46, 0x160000
    s_add_u32 m0, s47, 32768
    s_nop 0
    buffer_load_dwordx4 v21, s[24:27], s45 offen  lds
    s_add_u32 s45, s46, 0x168000
    s_add_u32 m0, s47, 36864
    s_nop 0
    buffer_load_dwordx4 v21, s[24:27], s45 offen  lds
    s_add_u32 s45, s46, 0x170000
    s_add_u32 m0, s47, 40960
    s_nop 0
    buffer_load_dwordx4 v21, s[24:27], s45 offen  lds
    s_add_u32 s45, s46, 0x178000
    s_add_u32 m0, s47, 45056
    s_nop 0
    buffer_load_dwordx4 v21, s[24:27], s45 offen  lds
    ds_read_b64_tr_b16 a[48:49], v23 offset:49152
    ds_read_b64_tr_b16 a[50:51], v23 offset:50176
    ds_read_b64_tr_b16 a[52:53], v23 offset:49184
    ds_read_b64_tr_b16 a[54:55], v23 offset:50208
    ds_read_b64_tr_b16 a[56:57], v23 offset:57344
    ds_read_b64_tr_b16 a[58:59], v23 offset:58368
    ds_read_b64_tr_b16 a[60:61], v23 offset:57376
    ds_read_b64_tr_b16 a[62:63], v23 offset:58400
    s_waitcnt lgkmcnt(0)
    s_waitcnt vmcnt(28)
    s_barrier
    s_add_u32 s45, s46, 0x180000
    s_add_u32 m0, s47, 49152
    s_nop 0
    buffer_load_dwordx4 v21, s[24:27], s45 offen  lds
    s_add_u32 s45, s46, 0x188000
    s_add_u32 m0, s47, 53248
    s_nop 0
    buffer_load_dwordx4 v21, s[24:27], s45 offen  lds
    s_add_u32 s45, s46, 0x190000
    s_add_u32 m0, s47, 57344
    s_nop 0
    buffer_load_dwordx4 v21, s[24:27], s45 offen  lds
    s_add_u32 s45, s46, 0x198000
    s_add_u32 m0, s47, 61440
    s_nop 0
    buffer_load_dwordx4 v21, s[24:27], s45 offen  lds
    ds_read_b64_tr_b16 a[64:65], v24 offset:0
    ds_read_b64_tr_b16 a[66:67], v24 offset:1024
    ds_read_b64_tr_b16 a[68:69], v24 offset:32
    ds_read_b64_tr_b16 a[70:71], v24 offset:1056
    ds_read_b64_tr_b16 a[72:73], v24 offset:8192
    ds_read_b64_tr_b16 a[74:75], v24 offset:9216
    ds_read_b64_tr_b16 a[76:77], v24 offset:8224
    ds_read_b64_tr_b16 a[78:79], v24 offset:9248
    s_waitcnt lgkmcnt(0)
    s_waitcnt vmcnt(28)
    s_barrier
    s_add_u32 s45, s46, 0x1a0000
    s_add_u32 m0, s47, 65536
    s_nop 0
    buffer_load_dwordx4 v21, s[24:27], s45 offen  lds
    s_add_u32 s45, s46, 0x1a8000
    s_add_u32 m0, s47, 69632
    s_nop 0
    buffer_load_dwordx4 v21, s[24:27], s45 offen  lds
    s_add_u32 s45, s46, 0x1b0000
    s_add_u32 m0, s47, 73728
    s_nop 0
    buffer_load_dwordx4 v21, s[24:27], s45 offen  lds
    s_add_u32 s45, s46, 0x1b8000
    s_add_u32 m0, s47, 77824
    s_nop 0
    buffer_load_dwordx4 v21, s[24:27], s45 offen  lds
    ds_read_b64_tr_b16 a[80:81], v24 offset:16384
    ds_read_b64_tr_b16 a[82:83], v24 offset:17408
    ds_read_b64_tr_b16 a[84:85], v24 offset:16416
    ds_read_b64_tr_b16 a[86:87], v24 offset:17440
    ds_read_b64_tr_b16 a[88:89], v24 offset:24576
    ds_read_b64_tr_b16 a[90:91], v24 offset:25600
    ds_read_b64_tr_b16 a[92:93], v24 offset:24608
    ds_read_b64_tr_b16 a[94:95], v24 offset:25632
    s_waitcnt lgkmcnt(0)
    s_waitcnt vmcnt(28)
    s_barrier
    ds_read_b64_tr_b16 a[96:97], v24 offset:32768
    ds_read_b64_tr_b16 a[98:99], v24 offset:33792
    ds_read_b64_tr_b16 a[100:101], v24 offset:32800
    ds_read_b64_tr_b16 a[102:103], v24 offset:33824
    ds_read_b64_tr_b16 a[104:105], v24 offset:40960
    ds_read_b64_tr_b16 a[106:107], v24 offset:41984
    ds_read_b64_tr_b16 a[108:109], v24 offset:40992
    ds_read_b64_tr_b16 a[110:111], v24 offset:42016
    s_waitcnt lgkmcnt(0)
    s_waitcnt vmcnt(24)
    s_barrier
    ds_read_b64_tr_b16 a[112:113], v24 offset:49152
    ds_read_b64_tr_b16 a[114:115], v24 offset:50176
    ds_read_b64_tr_b16 a[116:117], v24 offset:49184
    ds_read_b64_tr_b16 a[118:119], v24 offset:50208
    ds_read_b64_tr_b16 a[120:121], v24 offset:57344
    ds_read_b64_tr_b16 a[122:123], v24 offset:58368
    ds_read_b64_tr_b16 a[124:125], v24 offset:57376
    ds_read_b64_tr_b16 a[126:127], v24 offset:58400
    s_waitcnt lgkmcnt(0)
    s_waitcnt vmcnt(20)
    s_barrier
    ds_read_b64_tr_b16 a[128:129], v25 offset:0
    ds_read_b64_tr_b16 a[130:131], v25 offset:1024
    ds_read_b64_tr_b16 a[132:133], v25 offset:32
    ds_read_b64_tr_b16 a[134:135], v25 offset:1056
    ds_read_b64_tr_b16 a[136:137], v25 offset:8192
    ds_read_b64_tr_b16 a[138:139], v25 offset:9216
    ds_read_b64_tr_b16 a[140:141], v25 offset:8224
    ds_read_b64_tr_b16 a[142:143], v25 offset:9248
    s_waitcnt lgkmcnt(0)
    s_waitcnt vmcnt(16)
    s_barrier
    ds_read_b64_tr_b16 a[144:145], v23 offset:0
    ds_read_b64_tr_b16 a[146:147], v23 offset:1024
    ds_read_b64_tr_b16 a[148:149], v23 offset:32
    ds_read_b64_tr_b16 a[150:151], v23 offset:1056
    ds_read_b64_tr_b16 a[152:153], v23 offset:8192
    ds_read_b64_tr_b16 a[154:155], v23 offset:9216
    ds_read_b64_tr_b16 a[156:157], v23 offset:8224
    ds_read_b64_tr_b16 a[158:159], v23 offset:9248
    s_waitcnt lgkmcnt(0)
    s_waitcnt vmcnt(12)
    s_barrier
    ds_read_b64_tr_b16 a[160:161], v23 offset:16384
    ds_read_b64_tr_b16 a[162:163], v23 offset:17408
    ds_read_b64_tr_b16 a[164:165], v23 offset:16416
    ds_read_b64_tr_b16 a[166:167], v23 offset:17440
    ds_read_b64_tr_b16 a[168:169], v23 offset:24576
    ds_read_b64_tr_b16 a[170:171], v23 offset:25600
    ds_read_b64_tr_b16 a[172:173], v23 offset:24608
    ds_read_b64_tr_b16 a[174:175], v23 offset:25632
    s_waitcnt lgkmcnt(0)
    s_waitcnt vmcnt(8)
    s_barrier
    ds_read_b64_tr_b16 a[176:177], v23 offset:32768
    ds_read_b64_tr_b16 a[178:179], v23 offset:33792
    ds_read_b64_tr_b16 a[180:181], v23 offset:32800
    ds_read_b64_tr_b16 a[182:183], v23 offset:33824
    ds_read_b64_tr_b16 a[184:185], v23 offset:40960
    ds_read_b64_tr_b16 a[186:187], v23 offset:41984
    ds_read_b64_tr_b16 a[188:189], v23 offset:40992
    ds_read_b64_tr_b16 a[190:191], v23 offset:42016
    s_waitcnt lgkmcnt(0)
    s_waitcnt vmcnt(4)
    s_barrier
    ds_read_b64_tr_b16 a[192:193], v23 offset:49152
    ds_read_b64_tr_b16 a[194:195], v23 offset:50176
    ds_read_b64_tr_b16 a[196:197], v23 offset:49184
    ds_read_b64_tr_b16 a[198:199], v23 offset:50208
    ds_read_b64_tr_b16 a[200:201], v23 offset:57344
    ds_read_b64_tr_b16 a[202:203], v23 offset:58368
    ds_read_b64_tr_b16 a[204:205], v23 offset:57376
    ds_read_b64_tr_b16 a[206:207], v23 offset:58400
    s_waitcnt lgkmcnt(0)
    s_waitcnt vmcnt(0)
    s_barrier
    ds_read_b64_tr_b16 a[208:209], v24 offset:0
    ds_read_b64_tr_b16 a[210:211], v24 offset:1024
    ds_read_b64_tr_b16 a[212:213], v24 offset:32
    ds_read_b64_tr_b16 a[214:215], v24 offset:1056
    ds_read_b64_tr_b16 a[216:217], v24 offset:8192
    ds_read_b64_tr_b16 a[218:219], v24 offset:9216
    ds_read_b64_tr_b16 a[220:221], v24 offset:8224
    ds_read_b64_tr_b16 a[222:223], v24 offset:9248
    s_waitcnt lgkmcnt(0)
    s_barrier
    buffer_load_dwordx4 v[80:83], v10, s[28:31], 0 offen
    buffer_load_dwordx4 v[84:87], v10, s[28:31], 0 offen offset:1024
    s_waitcnt vmcnt(0)
    v_lshlrev_b32 v96, 16, v80
    v_and_b32 v97, 0xffff0000, v80
    v_lshlrev_b32 v98, 16, v81
    v_and_b32 v99, 0xffff0000, v81
    v_lshlrev_b32 v100, 16, v82
    v_and_b32 v101, 0xffff0000, v82
    v_lshlrev_b32 v102, 16, v83
    v_and_b32 v103, 0xffff0000, v83
    v_lshlrev_b32 v104, 16, v84
    v_and_b32 v105, 0xffff0000, v84
    v_lshlrev_b32 v106, 16, v85
    v_and_b32 v107, 0xffff0000, v85
    v_lshlrev_b32 v108, 16, v86
    v_and_b32 v109, 0xffff0000, v86
    v_lshlrev_b32 v110, 16, v87
    v_and_b32 v111, 0xffff0000, v87
    s_cmp_lg_u32 s44, 0
    s_cbranch_scc1 L_pd_160
    v_mov_b32 v29, 127232
    s_mov_b32 s46, 96
    s_mov_b64 exec, 1
    s_mov_b32 s70, 0
L_wp_161:
    buffer_load_dword v31, v29, s[12:15], 0 offen sc1
    s_add_u32 s70, s70, 1
    s_cmp_ge_u32 s70, 0x200000
    s_cbranch_scc1 L_w_done_96
    s_waitcnt vmcnt(0)
    v_cmp_gt_u32 vcc, s46, v31
    s_nop 1
    s_cbranch_vccz L_wp_161_ok
    s_sleep 3
    s_branch L_wp_161
L_wp_161_ok:
    s_mov_b64 exec, -1
L_pd_160:
    s_barrier
    v_lshlrev_b32 v29, 5, v1
    s_mov_b32 s45, 20480
    buffer_load_dwordx4 v[112:115], v29, s[12:15], s45 offen offset:0 sc1
    buffer_load_dwordx4 v[116:119], v29, s[12:15], s45 offen offset:16 sc1
    buffer_load_dwordx4 v[120:123], v29, s[12:15], s45 offen offset:2048 sc1
    buffer_load_dwordx4 v[124:127], v29, s[12:15], s45 offen offset:2064 sc1
    s_mov_b32 s45, 45056
    buffer_load_dwordx4 v[32:35], v29, s[12:15], s45 offen offset:0 sc1
    buffer_load_dwordx4 v[36:39], v29, s[12:15], s45 offen offset:16 sc1
    buffer_load_dwordx4 v[40:43], v29, s[12:15], s45 offen offset:2048 sc1
    buffer_load_dwordx4 v[44:47], v29, s[12:15], s45 offen offset:2064 sc1
    s_waitcnt vmcnt(0)
    v_add_f32 v112, v112, v32
    v_cvt_pk_bf16_f32 v112, v112, v112
    v_lshlrev_b32 v112, 16, v112
    v_add_f32 v113, v113, v33
    v_cvt_pk_bf16_f32 v113, v113, v113
    v_lshlrev_b32 v113, 16, v113
    v_add_f32 v114, v114, v34
    v_cvt_pk_bf16_f32 v114, v114, v114
    v_lshlrev_b32 v114, 16, v114
    v_add_f32 v115, v115, v35
    v_cvt_pk_bf16_f32 v115, v115, v115
    v_lshlrev_b32 v115, 16, v115
    v_add_f32 v116, v116, v36
    v_cvt_pk_bf16_f32 v116, v116, v116
    v_lshlrev_b32 v116, 16, v116
    v_add_f32 v117, v117, v37
    v_cvt_pk_bf16_f32 v117, v117, v117
    v_lshlrev_b32 v117, 16, v117
    v_add_f32 v118, v118, v38
    v_cvt_pk_bf16_f32 v118, v118, v118
    v_lshlrev_b32 v118, 16, v118
    v_add_f32 v119, v119, v39
    v_cvt_pk_bf16_f32 v119, v119, v119
    v_lshlrev_b32 v119, 16, v119
    v_add_f32 v120, v120, v40
    v_cvt_pk_bf16_f32 v120, v120, v120
    v_lshlrev_b32 v120, 16, v120
    v_add_f32 v121, v121, v41
    v_cvt_pk_bf16_f32 v121, v121, v121
    v_lshlrev_b32 v121, 16, v121
    v_add_f32 v122, v122, v42
    v_cvt_pk_bf16_f32 v122, v122, v122
    v_lshlrev_b32 v122, 16, v122
    v_add_f32 v123, v123, v43
    v_cvt_pk_bf16_f32 v123, v123, v123
    v_lshlrev_b32 v123, 16, v123
    v_add_f32 v124, v124, v44
    v_cvt_pk_bf16_f32 v124, v124, v124
    v_lshlrev_b32 v124, 16, v124
    v_add_f32 v125, v125, v45
    v_cvt_pk_bf16_f32 v125, v125, v125
    v_lshlrev_b32 v125, 16, v125
    v_add_f32 v126, v126, v46
    v_cvt_pk_bf16_f32 v126, v126, v126
    v_lshlrev_b32 v126, 16, v126
    v_add_f32 v127, v127, v47
    v_cvt_pk_bf16_f32 v127, v127, v127
    v_lshlrev_b32 v127, 16, v127
    s_lshl_b32 s46, s44, 10
    s_add_u32 s45, s46, 20480
    buffer_load_dwordx4 v[22:25], v10, s[12:15], s45 offen sc1
    s_add_u32 s45, s46, 45056
    buffer_load_dwordx4 v[32:35], v10, s[12:15], s45 offen sc1
    s_waitcnt vmcnt(0)
    v_add_f32 v22, v22, v32
    v_cvt_pk_bf16_f32 v22, v22, v22
    v_lshlrev_b32 v22, 16, v22
    v_add_f32 v23, v23, v33
    v_cvt_pk_bf16_f32 v23, v23, v23
    v_lshlrev_b32 v23, 16, v23
    v_add_f32 v24, v24, v34
    v_cvt_pk_bf16_f32 v24, v24, v24
    v_lshlrev_b32 v24, 16, v24
    v_add_f32 v25, v25, v35
    v_cvt_pk_bf16_f32 v25, v25, v25
    v_lshlrev_b32 v25, 16, v25
    v_lshlrev_b32 v17, 3, v1
    s_lshl_b32 s45, s44, 9
    buffer_load_dwordx2 v[80:81], v17, s[28:31], s45 offen
    s_waitcnt vmcnt(0)
    v_lshlrev_b32 v18, 16, v80
    v_and_b32 v19, 0xffff0000, v80
    v_lshlrev_b32 v20, 16, v81
    v_and_b32 v21, 0xffff0000, v81
    s_mul_i32 s52, s38, 57344
    s_add_u32 s52, s52, 0x6000000
    s_lshl_b32 s56, s38, 23
    s_lshl_b32 s45, s68, 9
    s_add_u32 s56, s56, s45
    s_add_u32 s56, s56, 0xc000000
    s_lshl_b32 s45, s40, 7
    s_add_u32 s45, s45, 127488
    v_mov_b32 v29, s45
    s_mov_b32 s46, 536870912
    s_mov_b64 exec, 1
    s_mov_b32 s70, 0
L_wp_164:
    buffer_load_dword v31, v29, s[12:15], 0 offen sc1
    s_add_u32 s70, s70, 1
    s_cmp_ge_u32 s70, 0x200000
    s_cbranch_scc1 L_w_done_96
    s_waitcnt vmcnt(0)
    v_cmp_gt_u32 vcc, s46, v31
    s_nop 1
    s_cbranch_vccz L_wp_164_ok
    s_sleep 2
    s_branch L_wp_164
L_wp_164_ok:
    s_mov_b64 exec, -1
    v_readfirstlane_b32 s45, v31
    s_nop 3
    s_and_b32 s46, s45, 511
    s_mul_i32 s46, s46, s46
    s_bfe_u32 s45, s45, 0xf0009
    s_lshl_b32 s45, s45, 5
    s_mov_b32 s80, s12
    s_mov_b32 s81, s13
    s_mov_b32 s83, 0x00020000
    s_mov_b32 s84, s12
    s_mov_b32 s85, s13
    s_mov_b32 s87, 0x00020000
    s_cmp_eq_u32 s45, s46
    s_cselect_b32 s82, s14, 0
    s_cselect_b32 s86, 0, s14
L_c_loop_162:
    s_cmp_eq_u64 s[36:37], 0
    s_cbranch_scc1 L_w_done_96
    s_ff1_i32_b64 s50, s[36:37]
    s_bitset0_b64 s[36:37], s50
    s_lshr_b64 s[74:75], s[72:73], s50
    s_ff1_i32_b64 s51, s[74:75]
    s_add_u32 s51, s51, 1
    s_add_u32 s62, s50, s51
    s_mul_i32 s45, s38, 896
    s_add_u32 s45, s45, s64
    s_add_u32 s45, s45, 12288
    s_cmp_lg_u32 s44, 0
    s_cbranch_scc1 L_pw_165
    s_mov_b64 exec, 127
    s_mov_b32 s70, 0
L_wp_166:
    buffer_load_dword v31, v5, s[12:15], s45 offen sc1
    s_add_u32 s70, s70, 1
    s_cmp_ge_u32 s70, 0x200000
    s_cbranch_scc1 L_w_done_96
    s_waitcnt vmcnt(0)
    v_cmp_gt_u32 vcc, s62, v31
    s_nop 1
    s_cbranch_vccz L_wp_166_ok
    s_sleep 2
    s_branch L_wp_166
L_wp_166_ok:
    s_mov_b64 exec, -1
L_pw_165:
    s_barrier
    s_mul_i32 s53, s50, 229376
    s_add_u32 s53, s53, s52
    s_lshl_b32 s54, s44, 13
    s_add_u32 s53, s53, s54
    s_mul_i32 s57, s50, 131072
    s_add_u32 s57, s57, s56
    s_lshl_b32 s45, s44, 7
    s_add_u32 s57, s57, s45
    s_add_u32 s55, s54, 65536
    s_mov_b32 s58, 0
    v_mov_b32 v13, v10
    v_add_u32 v14, 65536, v13
    v_xor_b32 v15, 64, v13
    v_xor_b32 v16, 64, v14
    s_mov_b32 s76, 0x20000000
    s_add_u32 s48, s53, 0
    s_add_u32 s49, s48, 4096
    s_add_u32 m0, s54, 0
    s_nop 0
    buffer_load_dwordx4 v10, s[12:15], s48 offen offset:0 sc1 lds
    buffer_load_dwordx4 v10, s[12:15], s48 offen offset:1024 sc1 lds
    buffer_load_dwordx4 v10, s[12:15], s48 offen offset:2048 sc1 lds
    buffer_load_dwordx4 v10, s[12:15], s48 offen offset:3072 sc1 lds
    s_add_u32 m0, s54, 4096
    s_nop 0
    buffer_load_dwordx4 v10, s[12:15], s49 offen offset:0 sc1 lds
    buffer_load_dwordx4 v10, s[12:15], s49 offen offset:1024 sc1 lds
    buffer_load_dwordx4 v10, s[12:15], s49 offen offset:2048 sc1 lds
    buffer_load_dwordx4 v10, s[12:15], s49 offen offset:3072 sc1 lds
    s_add_u32 s48, s53, 32768
    s_cmp_lt_u32 s44, 3
    s_cselect_b32 s48, s48, 0x20000000
    s_add_u32 s49, s48, 4096
    s_add_u32 s46, s54, 32768
    s_add_u32 m0, s46, 0
    s_nop 0
    buffer_load_dwordx4 v10, s[12:15], s48 offen offset:0 sc1 lds
    buffer_load_dwordx4 v10, s[12:15], s48 offen offset:1024 sc1 lds
    buffer_load_dwordx4 v10, s[12:15], s48 offen offset:2048 sc1 lds
    buffer_load_dwordx4 v10, s[12:15], s48 offen offset:3072 sc1 lds
    s_add_u32 m0, s46, 4096
    s_nop 0
    buffer_load_dwordx4 v10, s[12:15], s49 offen offset:0 sc1 lds
    buffer_load_dwordx4 v10, s[12:15], s49 offen offset:1024 sc1 lds
    buffer_load_dwordx4 v10, s[12:15], s49 offen offset:2048 sc1 lds
    buffer_load_dwordx4 v10, s[12:15], s49 offen offset:3072 sc1 lds
    s_cmp_eq_u32 s51, 1
    s_cbranch_scc1 L_e_one_168
    s_add_u32 s48, s53, 229376
    s_add_u32 s49, s48, 4096
    s_add_u32 m0, s55, 0
    s_nop 0
    buffer_load_dwordx4 v10, s[12:15], s48 offen offset:0 sc1 lds
    buffer_load_dwordx4 v10, s[12:15], s48 offen offset:1024 sc1 lds
    buffer_load_dwordx4 v10, s[12:15], s48 offen offset:2048 sc1 lds
    buffer_load_dwordx4 v10, s[12:15], s48 offen offset:3072 sc1 lds
    s_add_u32 m0, s55, 4096
    s_nop 0
    buffer_load_dwordx4 v10, s[12:15], s49 offen offset:0 sc1 lds
    buffer_load_dwordx4 v10, s[12:15], s49 offen offset:1024 sc1 lds
    buffer_load_dwordx4 v10, s[12:15], s49 offen offset:2048 sc1 lds
    buffer_load_dwordx4 v10, s[12:15], s49 offen offset:3072 sc1 lds
    s_waitcnt vmcnt(16)
    s_barrier
    ds_read_b128 v[32:35], v13 offset:0
    ds_read_b128 v[36:39], v13 offset:1024
    ds_read_b128 v[40:43], v13 offset:2048
    ds_read_b128 v[44:47], v13 offset:3072
L_e_loop_167:
    s_add_u32 s48, s53, 262144
    s_add_u32 s46, s58, 1
    s_cmp_lt_u32 s46, s51
    s_cselect_b32 s48, s48, 0x20000000
    s_cmp_lt_u32 s44, 3
    s_cselect_b32 s48, s48, 0x20000000
    s_add_u32 s49, s48, 4096
    s_add_u32 s59, s55, 32768
    s_waitcnt lgkmcnt(2)
    v_mfma_f32_16x16x32_bf16 v[80:83], a[0:3], v[32:35], 0
    ds_read_b128 v[48:51], v13 offset:4096
    ds_read_b128 v[52:55], v13 offset:5120
    v_mfma_f32_16x16x32_bf16 v[84:87], a[4:7], v[32:35], 0
    ds_read_b128 v[56:59], v13 offset:6144
    ds_read_b128 v[60:63], v13 offset:7168
    v_mfma_f32_16x16x32_bf16 v[88:91], a[0:3], v[36:39], 0
    s_add_u32 m0, s59, 0
    s_nop 0
    buffer_load_dwordx4 v10, s[12:15], s48 offen offset:0 sc1 lds
    v_mfma_f32_16x16x32_bf16 v[92:95], a[4:7], v[36:39], 0
    s_waitcnt lgkmcnt(4)
    v_mfma_f32_16x16x32_bf16 v[80:83], a[8:11], v[40:43], v[80:83]
    ds_read_b128 v[32:35], v13 offset:8192
    ds_read_b128 v[36:39], v13 offset:9216
    v_mfma_f32_16x16x32_bf16 v[84:87], a[12:15], v[40:43], v[84:87]
    v_mfma_f32_16x16x32_bf16 v[88:91], a[8:11], v[44:47], v[88:91]
    buffer_load_dwordx4 v10, s[12:15], s48 offen offset:1024 sc1 lds
    v_mfma_f32_16x16x32_bf16 v[92:95], a[12:15], v[44:47], v[92:95]
    s_waitcnt lgkmcnt(4)
    v_mfma_f32_16x16x32_bf16 v[80:83], a[16:19], v[48:51], v[80:83]
    ds_read_b128 v[40:43], v13 offset:10240
    ds_read_b128 v[44:47], v13 offset:11264
    v_mfma_f32_16x16x32_bf16 v[84:87], a[20:23], v[48:51], v[84:87]
    v_mfma_f32_16x16x32_bf16 v[88:91], a[16:19], v[52:55], v[88:91]
    buffer_load_dwordx4 v10, s[12:15], s48 offen offset:2048 sc1 lds
    v_mfma_f32_16x16x32_bf16 v[92:95], a[20:23], v[52:55], v[92:95]
    s_waitcnt lgkmcnt(4)
    v_mfma_f32_16x16x32_bf16 v[80:83], a[24:27], v[56:59], v[80:83]
    ds_read_b128 v[48:51], v13 offset:12288
    ds_read_b128 v[52:55], v13 offset:13312
    v_mfma_f32_16x16x32_bf16 v[84:87], a[28:31], v[56:59], v[84:87]
    v_mfma_f32_16x16x32_bf16 v[88:91], a[24:27], v[60:63], v[88:91]
    buffer_load_dwordx4 v10, s[12:15], s48 offen offset:3072 sc1 lds
    v_mfma_f32_16x16x32_bf16 v[92:95], a[28:31], v[60:63], v[92:95]
    s_waitcnt lgkmcnt(4)
    v_mfma_f32_16x16x32_bf16 v[80:83], a[32:35], v[32:35], v[80:83]
    ds_read_b128 v[56:59], v13 offset:14336
    ds_read_b128 v[60:63], v13 offset:15360
    v_mfma_f32_16x16x32_bf16 v[84:87], a[36:39], v[32:35], v[84:87]
    v_mfma_f32_16x16x32_bf16 v[88:91], a[32:35], v[36:39], v[88:91]
    s_add_u32 m0, s59, 4096
    s_nop 0
    buffer_load_dwordx4 v10, s[12:15], s49 offen offset:0 sc1 lds
    v_mfma_f32_16x16x32_bf16 v[92:95], a[36:39], v[36:39], v[92:95]
    s_waitcnt lgkmcnt(4)
    v_mfma_f32_16x16x32_bf16 v[80:83], a[40:43], v[40:43], v[80:83]
    ds_read_b128 v[32:35], v13 offset:16384
    ds_read_b128 v[36:39], v13 offset:17408
    v_mfma_f32_16x16x32_bf16 v[84:87], a[44:47], v[40:43], v[84:87]
    v_mfma_f32_16x16x32_bf16 v[88:91], a[40:43], v[44:47], v[88:91]
    buffer_load_dwordx4 v10, s[12:15], s49 offen offset:1024 sc1 lds
    v_mfma_f32_16x16x32_bf16 v[92:95], a[44:47], v[44:47], v[92:95]
    s_waitcnt lgkmcnt(4)
    v_mfma_f32_16x16x32_bf16 v[80:83], a[48:51], v[48:51], v[80:83]
    ds_read_b128 v[40:43], v13 offset:18432
    ds_read_b128 v[44:47], v13 offset:19456
    v_mfma_f32_16x16x32_bf16 v[84:87], a[52:55], v[48:51], v[84:87]
    v_mfma_f32_16x16x32_bf16 v[88:91], a[48:51], v[52:55], v[88:91]
    buffer_load_dwordx4 v10, s[12:15], s49 offen offset:2048 sc1 lds
    v_mfma_f32_16x16x32_bf16 v[92:95], a[52:55], v[52:55], v[92:95]
    s_waitcnt lgkmcnt(4)
    v_mfma_f32_16x16x32_bf16 v[80:83], a[56:59], v[56:59], v[80:83]
    ds_read_b128 v[48:51], v13 offset:20480
    ds_read_b128 v[52:55], v13 offset:21504
    v_mfma_f32_16x16x32_bf16 v[84:87], a[60:63], v[56:59], v[84:87]
    v_mfma_f32_16x16x32_bf16 v[88:91], a[56:59], v[60:63], v[88:91]
    buffer_load_dwordx4 v10, s[12:15], s49 offen offset:3072 sc1 lds
    v_mfma_f32_16x16x32_bf16 v[92:95], a[60:63], v[60:63], v[92:95]
    s_waitcnt lgkmcnt(4)
    v_mfma_f32_16x16x32_bf16 v[80:83], a[64:67], v[32:35], v[80:83]
    ds_read_b128 v[56:59], v13 offset:22528
    ds_read_b128 v[60:63], v13 offset:23552
    v_mfma_f32_16x16x32_bf16 v[84:87], a[68:71], v[32:35], v[84:87]
    v_mfma_f32_16x16x32_bf16 v[88:91], a[64:67], v[36:39], v[88:91]
    v_mfma_f32_16x16x32_bf16 v[92:95], a[68:71], v[36:39], v[92:95]
    s_waitcnt lgkmcnt(4)
    v_mfma_f32_16x16x32_bf16 v[80:83], a[72:75], v[40:43], v[80:83]
    ds_read_b128 v[32:35], v13 offset:24576
    ds_read_b128 v[36:39], v13 offset:25600
    v_mfma_f32_16x16x32_bf16 v[84:87], a[76:79], v[40:43], v[84:87]
    v_mfma_f32_16x16x32_bf16 v[88:91], a[72:75], v[44:47], v[88:91]
    v_mfma_f32_16x16x32_bf16 v[92:95], a[76:79], v[44:47], v[92:95]
    s_waitcnt lgkmcnt(4)
    v_mfma_f32_16x16x32_bf16 v[80:83], a[80:83], v[48:51], v[80:83]
    ds_read_b128 v[40:43], v13 offset:26624
    ds_read_b128 v[44:47], v13 offset:27648
    v_mfma_f32_16x16x32_bf16 v[84:87], a[84:87], v[48:51], v[84:87]
    v_mfma_f32_16x16x32_bf16 v[88:91], a[80:83], v[52:55], v[88:91]
    v_mfma_f32_16x16x32_bf16 v[92:95], a[84:87], v[52:55], v[92:95]
    s_waitcnt lgkmcnt(4)
    v_mfma_f32_16x16x32_bf16 v[80:83], a[88:91], v[56:59], v[80:83]
    ds_read_b128 v[48:51], v13 offset:28672
    ds_read_b128 v[52:55], v13 offset:29696
    v_mfma_f32_16x16x32_bf16 v[84:87], a[92:95], v[56:59], v[84:87]
    v_mfma_f32_16x16x32_bf16 v[88:91], a[88:91], v[60:63], v[88:91]
    v_mfma_f32_16x16x32_bf16 v[92:95], a[92:95], v[60:63], v[92:95]
    s_waitcnt lgkmcnt(4)
    v_mfma_f32_16x16x32_bf16 v[80:83], a[96:99], v[32:35], v[80:83]
    ds_read_b128 v[56:59], v13 offset:30720
    ds_read_b128 v[60:63], v13 offset:31744
    v_mfma_f32_16x16x32_bf16 v[84:87], a[100:103], v[32:35], v[84:87]
    v_mfma_f32_16x16x32_bf16 v[88:91], a[96:99], v[36:39], v[88:91]
    v_mfma_f32_16x16x32_bf16 v[92:95], a[100:103], v[36:39], v[92:95]
    s_waitcnt lgkmcnt(4)
    v_mfma_f32_16x16x32_bf16 v[80:83], a[104:107], v[40:43], v[80:83]
    ds_read_b128 v[216:219], v8 offset:0
    ds_read_b128 v[220:223], v8 offset:1152
    v_mfma_f32_16x16x32_bf16 v[84:87], a[108:111], v[40:43], v[84:87]
    ds_read_b128 v[224:227], v8 offset:2304
    ds_read_b128 v[228:231], v8 offset:3456
    v_mfma_f32_16x16x32_bf16 v[88:91], a[104:107], v[44:47], v[88:91]
    v_mfma_f32_16x16x32_bf16 v[92:95], a[108:111], v[44:47], v[92:95]
    s_waitcnt vmcnt(16) lgkmcnt(0)
    s_barrier
    v_mfma_f32_16x16x32_bf16 v[80:83], a[112:115], v[48:51], v[80:83]
    ds_read_b128 v[32:35], v13 offset:32768
    ds_read_b128 v[36:39], v13 offset:33792
    v_mfma_f32_16x16x32_bf16 v[84:87], a[116:119], v[48:51], v[84:87]
    buffer_store_dwordx4 v[216:219], v11, s[12:15], s76 offen sc1
    v_mfma_f32_16x16x32_bf16 v[88:91], a[112:115], v[52:55], v[88:91]
    s_add_u32 s76, s76, 32768
    v_mfma_f32_16x16x32_bf16 v[92:95], a[116:119], v[52:55], v[92:95]
    buffer_store_dwordx4 v[220:223], v11, s[12:15], s76 offen sc1
    v_mfma_f32_16x16x32_bf16 v[80:83], a[120:123], v[56:59], v[80:83]
    ds_read_b128 v[40:43], v13 offset:34816
    ds_read_b128 v[44:47], v13 offset:35840
    v_mfma_f32_16x16x32_bf16 v[84:87], a[124:127], v[56:59], v[84:87]
    s_add_u32 s76, s76, 32768
    v_mfma_f32_16x16x32_bf16 v[88:91], a[120:123], v[60:63], v[88:91]
    buffer_store_dwordx4 v[224:227], v11, s[12:15], s76 offen sc1
    v_mfma_f32_16x16x32_bf16 v[92:95], a[124:127], v[60:63], v[92:95]
    s_add_u32 s76, s76, 32768
    s_add_u32 s48, s53, 458752
    s_add_u32 s46, s58, 2
    s_cmp_lt_u32 s46, s51
    s_cselect_b32 s48, s48, 0x20000000
    s_add_u32 s49, s48, 4096
    s_mov_b32 s59, s54
    s_waitcnt lgkmcnt(2)
    v_mfma_f32_16x16x32_bf16 v[80:83], a[128:131], v[32:35], v[80:83]
    ds_read_b128 v[48:51], v13 offset:36864
    ds_read_b128 v[52:55], v13 offset:37888
    v_mfma_f32_16x16x32_bf16 v[84:87], a[132:135], v[32:35], v[84:87]
    ds_read_b128 v[56:59], v13 offset:38912
    ds_read_b128 v[60:63], v13 offset:39936
    v_mfma_f32_16x16x32_bf16 v[88:91], a[128:131], v[36:39], v[88:91]
    s_add_u32 m0, s59, 0
    s_nop 0
    buffer_load_dwordx4 v10, s[12:15], s48 offen offset:0 sc1 lds
    v_mfma_f32_16x16x32_bf16 v[92:95], a[132:135], v[36:39], v[92:95]
    buffer_store_dwordx4 v[228:231], v11, s[12:15], s76 offen sc1
    s_waitcnt lgkmcnt(4)
    v_mfma_f32_16x16x32_bf16 v[80:83], a[136:139], v[40:43], v[80:83]
    ds_read_b128 v[32:35], v13 offset:40960
    ds_read_b128 v[36:39], v13 offset:41984
    v_mfma_f32_16x16x32_bf16 v[84:87], a[140:143], v[40:43], v[84:87]
    v_mfma_f32_16x16x32_bf16 v[88:91], a[136:139], v[44:47], v[88:91]
    buffer_load_dwordx4 v10, s[12:15], s48 offen offset:1024 sc1 lds
    v_mfma_f32_16x16x32_bf16 v[92:95], a[140:143], v[44:47], v[92:95]
    s_waitcnt lgkmcnt(4)
    v_mfma_f32_16x16x32_bf16 v[80:83], a[144:147], v[48:51], v[80:83]
    ds_read_b128 v[40:43], v13 offset:43008
    ds_read_b128 v[44:47], v13 offset:44032
    v_mfma_f32_16x16x32_bf16 v[84:87], a[148:151], v[48:51], v[84:87]
    v_mfma_f32_16x16x32_bf16 v[88:91], a[144:147], v[52:55], v[88:91]
    buffer_load_dwordx4 v10, s[12:15], s48 offen offset:2048 sc1 lds
    v_mfma_f32_16x16x32_bf16 v[92:95], a[148:151], v[52:55], v[92:95]
    s_waitcnt lgkmcnt(4)
    v_mfma_f32_16x16x32_bf16 v[80:83], a[152:155], v[56:59], v[80:83]
    ds_read_b128 v[48:51], v13 offset:45056
    ds_read_b128 v[52:55], v13 offset:46080
    v_mfma_f32_16x16x32_bf16 v[84:87], a[156:159], v[56:59], v[84:87]
    v_mfma_f32_16x16x32_bf16 v[88:91], a[152:155], v[60:63], v[88:91]
    buffer_load_dwordx4 v10, s[12:15], s48 offen offset:3072 sc1 lds
    v_mfma_f32_16x16x32_bf16 v[92:95], a[156:159], v[60:63], v[92:95]
    s_waitcnt lgkmcnt(4)
    v_mfma_f32_16x16x32_bf16 v[80:83], a[160:163], v[32:35], v[80:83]
    ds_read_b128 v[56:59], v13 offset:47104
    ds_read_b128 v[60:63], v13 offset:48128
    v_mfma_f32_16x16x32_bf16 v[84:87], a[164:167], v[32:35], v[84:87]
    v_mfma_f32_16x16x32_bf16 v[88:91], a[160:163], v[36:39], v[88:91]
    s_add_u32 m0, s59, 4096
    s_nop 0
    buffer_load_dwordx4 v10, s[12:15], s49 offen offset:0 sc1 lds
    v_mfma_f32_16x16x32_bf16 v[92:95], a[164:167], v[36:39], v[92:95]
    s_waitcnt lgkmcnt(4)
    v_mfma_f32_16x16x32_bf16 v[80:83], a[168:171], v[40:43], v[80:83]
    ds_read_b128 v[32:35], v13 offset:49152
    ds_read_b128 v[36:39], v13 offset:50176
    v_mfma_f32_16x16x32_bf16 v[84:87], a[172:175], v[40:43], v[84:87]
    v_mfma_f32_16x16x32_bf16 v[88:91], a[168:171], v[44:47], v[88:91]
    buffer_load_dwordx4 v10, s[12:15], s49 offen offset:1024 sc1 lds
    v_mfma_f32_16x16x32_bf16 v[92:95], a[172:175], v[44:47], v[92:95]
    s_waitcnt lgkmcnt(4)
    v_mfma_f32_16x16x32_bf16 v[80:83], a[176:179], v[48:51], v[80:83]
    ds_read_b128 v[40:43], v13 offset:51200
    ds_read_b128 v[44:47], v13 offset:52224
    v_mfma_f32_16x16x32_bf16 v[84:87], a[180:183], v[48:51], v[84:87]
    v_mfma_f32_16x16x32_bf16 v[88:91], a[176:179], v[52:55], v[88:91]
    buffer_load_dwordx4 v10, s[12:15], s49 offen offset:2048 sc1 lds
    v_mfma_f32_16x16x32_bf16 v[92:95], a[180:183], v[52:55], v[92:95]
    s_waitcnt lgkmcnt(4)
    v_mfma_f32_16x16x32_bf16 v[80:83], a[184:187], v[56:59], v[80:83]
    ds_read_b128 v[48:51], v13 offset:53248
    ds_read_b128 v[52:55], v13 offset:54272
    v_mfma_f32_16x16x32_bf16 v[84:87], a[188:191], v[56:59], v[84:87]
    v_mfma_f32_16x16x32_bf16 v[88:91], a[184:187], v[60:63], v[88:91]
    buffer_load_dwordx4 v10, s[12:15], s49 offen offset:3072 sc1 lds
    v_mfma_f32_16x16x32_bf16 v[92:95], a[188:191], v[60:63], v[92:95]
    s_waitcnt lgkmcnt(4)
    v_mfma_f32_16x16x32_bf16 v[80:83], a[192:195], v[32:35], v[80:83]
    ds_read_b128 v[56:59], v13 offset:55296
    ds_read_b128 v[60:63], v13 offset:56320
    v_mfma_f32_16x16x32_bf16 v[84:87], a[196:199], v[32:35], v[84:87]
    v_mfma_f32_16x16x32_bf16 v[88:91], a[192:195], v[36:39], v[88:91]
    v_mfma_f32_16x16x32_bf16 v[92:95], a[196:199], v[36:39], v[92:95]
    s_waitcnt lgkmcnt(4)
    v_mfma_f32_16x16x32_bf16 v[80:83], a[200:203], v[40:43], v[80:83]
    v_mfma_f32_16x16x32_bf16 v[84:87], a[204:207], v[40:43], v[84:87]
    v_mfma_f32_16x16x32_bf16 v[88:91], a[200:203], v[44:47], v[88:91]
    v_mfma_f32_16x16x32_bf16 v[92:95], a[204:207], v[44:47], v[92:95]
    s_waitcnt vmcnt(16) lgkmcnt(0)
    s_barrier
    v_mfma_f32_16x16x32_bf16 v[80:83], a[208:211], v[48:51], v[80:83]
    ds_read_b128 v[32:35], v14 offset:0
    ds_read_b128 v[36:39], v14 offset:1024
    v_mfma_f32_16x16x32_bf16 v[84:87], a[212:215], v[48:51], v[84:87]
    v_mfma_f32_16x16x32_bf16 v[88:91], a[208:211], v[52:55], v[88:91]
    v_mfma_f32_16x16x32_bf16 v[92:95], a[212:215], v[52:55], v[92:95]
    v_mfma_f32_16x16x32_bf16 v[80:83], a[216:219], v[56:59], v[80:83]
    ds_read_b128 v[40:43], v14 offset:2048
    ds_read_b128 v[44:47], v14 offset:3072
    v_mfma_f32_16x16x32_bf16 v[84:87], a[220:223], v[56:59], v[84:87]
    v_mfma_f32_16x16x32_bf16 v[88:91], a[216:219], v[60:63], v[88:91]
    v_mfma_f32_16x16x32_bf16 v[92:95], a[220:223], v[60:63], v[92:95]
    s_add_u32 s53, s53, 229376
    s_add_u32 s58, s58, 1
    v_swap_b32 v13, v14
    s_xor_b32 s54, s54, 65536
    s_xor_b32 s55, s55, 65536
    s_mov_b32 s76, s57
    v_swap_b32 v15, v16
    s_add_u32 s57, s57, 131072
    ds_write_b128 v7, v[80:83] offset:0
    ds_write_b128 v7, v[84:87] offset:64
    ds_write_b128 v7, v[88:91] offset:2304
    ds_write_b128 v7, v[92:95] offset:2368
    s_cmp_lt_u32 s58, s51
    s_cbranch_scc1 L_e_loop_167
    s_branch L_e_fin_169
L_e_one_168:
    s_waitcnt vmcnt(8)
    s_barrier
    ds_read_b128 v[32:35], v13 offset:0
    ds_read_b128 v[36:39], v13 offset:1024
    ds_read_b128 v[40:43], v13 offset:2048
    ds_read_b128 v[44:47], v13 offset:3072
    s_waitcnt lgkmcnt(2)
    v_mfma_f32_16x16x32_bf16 v[80:83], a[0:3], v[32:35], 0
    ds_read_b128 v[48:51], v13 offset:4096
    ds_read_b128 v[52:55], v13 offset:5120
    v_mfma_f32_16x16x32_bf16 v[84:87], a[4:7], v[32:35], 0
    ds_read_b128 v[56:59], v13 offset:6144
    ds_read_b128 v[60:63], v13 offset:7168
    v_mfma_f32_16x16x32_bf16 v[88:91], a[0:3], v[36:39], 0
    v_mfma_f32_16x16x32_bf16 v[92:95], a[4:7], v[36:39], 0
    s_waitcnt lgkmcnt(4)
    v_mfma_f32_16x16x32_bf16 v[80:83], a[8:11], v[40:43], v[80:83]
    ds_read_b128 v[32:35], v13 offset:8192
    ds_read_b128 v[36:39], v13 offset:9216
    v_mfma_f32_16x16x32_bf16 v[84:87], a[12:15], v[40:43], v[84:87]
    v_mfma_f32_16x16x32_bf16 v[88:91], a[8:11], v[44:47], v[88:91]
    v_mfma_f32_16x16x32_bf16 v[92:95], a[12:15], v[44:47], v[92:95]
    s_waitcnt lgkmcnt(4)
    v_mfma_f32_16x16x32_bf16 v[80:83], a[16:19], v[48:51], v[80:83]
    ds_read_b128 v[40:43], v13 offset:10240
    ds_read_b128 v[44:47], v13 offset:11264
    v_mfma_f32_16x16x32_bf16 v[84:87], a[20:23], v[48:51], v[84:87]
    v_mfma_f32_16x16x32_bf16 v[88:91], a[16:19], v[52:55], v[88:91]
    v_mfma_f32_16x16x32_bf16 v[92:95], a[20:23], v[52:55], v[92:95]
    s_waitcnt lgkmcnt(4)
    v_mfma_f32_16x16x32_bf16 v[80:83], a[24:27], v[56:59], v[80:83]
    ds_read_b128 v[48:51], v13 offset:12288
    ds_read_b128 v[52:55], v13 offset:13312
    v_mfma_f32_16x16x32_bf16 v[84:87], a[28:31], v[56:59], v[84:87]
    v_mfma_f32_16x16x32_bf16 v[88:91], a[24:27], v[60:63], v[88:91]
    v_mfma_f32_16x16x32_bf16 v[92:95], a[28:31], v[60:63], v[92:95]
    s_waitcnt lgkmcnt(4)
    v_mfma_f32_16x16x32_bf16 v[80:83], a[32:35], v[32:35], v[80:83]
    ds_read_b128 v[56:59], v13 offset:14336
    ds_read_b128 v[60:63], v13 offset:15360
    v_mfma_f32_16x16x32_bf16 v[84:87], a[36:39], v[32:35], v[84:87]
    v_mfma_f32_16x16x32_bf16 v[88:91], a[32:35], v[36:39], v[88:91]
    v_mfma_f32_16x16x32_bf16 v[92:95], a[36:39], v[36:39], v[92:95]
    s_waitcnt lgkmcnt(4)
    v_mfma_f32_16x16x32_bf16 v[80:83], a[40:43], v[40:43], v[80:83]
    ds_read_b128 v[32:35], v13 offset:16384
    ds_read_b128 v[36:39], v13 offset:17408
    v_mfma_f32_16x16x32_bf16 v[84:87], a[44:47], v[40:43], v[84:87]
    v_mfma_f32_16x16x32_bf16 v[88:91], a[40:43], v[44:47], v[88:91]
    v_mfma_f32_16x16x32_bf16 v[92:95], a[44:47], v[44:47], v[92:95]
    s_waitcnt lgkmcnt(4)
    v_mfma_f32_16x16x32_bf16 v[80:83], a[48:51], v[48:51], v[80:83]
    ds_read_b128 v[40:43], v13 offset:18432
    ds_read_b128 v[44:47], v13 offset:19456
    v_mfma_f32_16x16x32_bf16 v[84:87], a[52:55], v[48:51], v[84:87]
    v_mfma_f32_16x16x32_bf16 v[88:91], a[48:51], v[52:55], v[88:91]
    v_mfma_f32_16x16x32_bf16 v[92:95], a[52:55], v[52:55], v[92:95]
    s_waitcnt lgkmcnt(4)
    v_mfma_f32_16x16x32_bf16 v[80:83], a[56:59], v[56:59], v[80:83]
    ds_read_b128 v[48:51], v13 offset:20480
    ds_read_b128 v[52:55], v13 offset:21504
    v_mfma_f32_16x16x32_bf16 v[84:87], a[60:63], v[56:59], v[84:87]
    v_mfma_f32_16x16x32_bf16 v[88:91], a[56:59], v[60:63], v[88:91]
    v_mfma_f32_16x16x32_bf16 v[92:95], a[60:63], v[60:63], v[92:95]
    s_waitcnt lgkmcnt(4)
    v_mfma_f32_16x16x32_bf16 v[80:83], a[64:67], v[32:35], v[80:83]
    ds_read_b128 v[56:59], v13 offset:22528
    ds_read_b128 v[60:63], v13 offset:23552
    v_mfma_f32_16x16x32_bf16 v[84:87], a[68:71], v[32:35], v[84:87]
    v_mfma_f32_16x16x32_bf16 v[88:91], a[64:67], v[36:39], v[88:91]
    v_mfma_f32_16x16x32_bf16 v[92:95], a[68:71], v[36:39], v[92:95]
    s_waitcnt lgkmcnt(4)
    v_mfma_f32_16x16x32_bf16 v[80:83], a[72:75], v[40:43], v[80:83]
    ds_read_b128 v[32:35], v13 offset:24576
    ds_read_b128 v[36:39], v13 offset:25600
    v_mfma_f32_16x16x32_bf16 v[84:87], a[76:79], v[40:43], v[84:87]
    v_mfma_f32_16x16x32_bf16 v[88:91], a[72:75], v[44:47], v[88:91]
    v_mfma_f32_16x16x32_bf16 v[92:95], a[76:79], v[44:47], v[92:95]
    s_waitcnt lgkmcnt(4)
    v_mfma_f32_16x16x32_bf16 v[80:83], a[80:83], v[48:51], v[80:83]
    ds_read_b128 v[40:43], v13 offset:26624
    ds_read_b128 v[44:47], v13 offset:27648
    v_mfma_f32_16x16x32_bf16 v[84:87], a[84:87], v[48:51], v[84:87]
    v_mfma_f32_16x16x32_bf16 v[88:91], a[80:83], v[52:55], v[88:91]
    v_mfma_f32_16x16x32_bf16 v[92:95], a[84:87], v[52:55], v[92:95]
    s_waitcnt lgkmcnt(4)
    v_mfma_f32_16x16x32_bf16 v[80:83], a[88:91], v[56:59], v[80:83]
    ds_read_b128 v[48:51], v13 offset:28672
    ds_read_b128 v[52:55], v13 offset:29696
    v_mfma_f32_16x16x32_bf16 v[84:87], a[92:95], v[56:59], v[84:87]
    v_mfma_f32_16x16x32_bf16 v[88:91], a[88:91], v[60:63], v[88:91]
    v_mfma_f32_16x16x32_bf16 v[92:95], a[92:95], v[60:63], v[92:95]
    s_waitcnt lgkmcnt(4)
    v_mfma_f32_16x16x32_bf16 v[80:83], a[96:99], v[32:35], v[80:83]
    ds_read_b128 v[56:59], v13 offset:30720
    ds_read_b128 v[60:63], v13 offset:31744
    v_mfma_f32_16x16x32_bf16 v[84:87], a[100:103], v[32:35], v[84:87]
    v_mfma_f32_16x16x32_bf16 v[88:91], a[96:99], v[36:39], v[88:91]
    v_mfma_f32_16x16x32_bf16 v[92:95], a[100:103], v[36:39], v[92:95]
    s_waitcnt lgkmcnt(4)
    v_mfma_f32_16x16x32_bf16 v[80:83], a[104:107], v[40:43], v[80:83]
    v_mfma_f32_16x16x32_bf16 v[84:87], a[108:111], v[40:43], v[84:87]
    v_mfma_f32_16x16x32_bf16 v[88:91], a[104:107], v[44:47], v[88:91]
    v_mfma_f32_16x16x32_bf16 v[92:95], a[108:111], v[44:47], v[92:95]
    s_waitcnt vmcnt(0) lgkmcnt(0)
    s_barrier
    v_mfma_f32_16x16x32_bf16 v[80:83], a[112:115], v[48:51], v[80:83]
    ds_read_b128 v[32:35], v13 offset:32768
    ds_read_b128 v[36:39], v13 offset:33792
    v_mfma_f32_16x16x32_bf16 v[84:87], a[116:119], v[48:51], v[84:87]
    v_mfma_f32_16x16x32_bf16 v[88:91], a[112:115], v[52:55], v[88:91]
    v_mfma_f32_16x16x32_bf16 v[92:95], a[116:119], v[52:55], v[92:95]
    v_mfma_f32_16x16x32_bf16 v[80:83], a[120:123], v[56:59], v[80:83]
    ds_read_b128 v[40:43], v13 offset:34816
    ds_read_b128 v[44:47], v13 offset:35840
    v_mfma_f32_16x16x32_bf16 v[84:87], a[124:127], v[56:59], v[84:87]
    v_mfma_f32_16x16x32_bf16 v[88:91], a[120:123], v[60:63], v[88:91]
    v_mfma_f32_16x16x32_bf16 v[92:95], a[124:127], v[60:63], v[92:95]
    s_waitcnt lgkmcnt(2)
    v_mfma_f32_16x16x32_bf16 v[80:83], a[128:131], v[32:35], v[80:83]
    ds_read_b128 v[48:51], v13 offset:36864
    ds_read_b128 v[52:55], v13 offset:37888
    v_mfma_f32_16x16x32_bf16 v[84:87], a[132:135], v[32:35], v[84:87]
    ds_read_b128 v[56:59], v13 offset:38912
    ds_read_b128 v[60:63], v13 offset:39936
    v_mfma_f32_16x16x32_bf16 v[88:91], a[128:131], v[36:39], v[88:91]
    v_mfma_f32_16x16x32_bf16 v[92:95], a[132:135], v[36:39], v[92:95]
    s_waitcnt lgkmcnt(4)
    v_mfma_f32_16x16x32_bf16 v[80:83], a[136:139], v[40:43], v[80:83]
    ds_read_b128 v[32:35], v13 offset:40960
    ds_read_b128 v[36:39], v13 offset:41984
    v_mfma_f32_16x16x32_bf16 v[84:87], a[140:143], v[40:43], v[84:87]
    v_mfma_f32_16x16x32_bf16 v[88:91], a[136:139], v[44:47], v[88:91]
    v_mfma_f32_16x16x32_bf16 v[92:95], a[140:143], v[44:47], v[92:95]
    s_waitcnt lgkmcnt(4)
    v_mfma_f32_16x16x32_bf16 v[80:83], a[144:147], v[48:51], v[80:83]
    ds_read_b128 v[40:43], v13 offset:43008
    ds_read_b128 v[44:47], v13 offset:44032
    v_mfma_f32_16x16x32_bf16 v[84:87], a[148:151], v[48:51], v[84:87]
    v_mfma_f32_16x16x32_bf16 v[88:91], a[144:147], v[52:55], v[88:91]
    v_mfma_f32_16x16x32_bf16 v[92:95], a[148:151], v[52:55], v[92:95]
    s_waitcnt lgkmcnt(4)
    v_mfma_f32_16x16x32_bf16 v[80:83], a[152:155], v[56:59], v[80:83]
    ds_read_b128 v[48:51], v13 offset:45056
    ds_read_b128 v[52:55], v13 offset:46080
    v_mfma_f32_16x16x32_bf16 v[84:87], a[156:159], v[56:59], v[84:87]
    v_mfma_f32_16x16x32_bf16 v[88:91], a[152:155], v[60:63], v[88:91]
    v_mfma_f32_16x16x32_bf16 v[92:95], a[156:159], v[60:63], v[92:95]
    s_waitcnt lgkmcnt(4)
    v_mfma_f32_16x16x32_bf16 v[80:83], a[160:163], v[32:35], v[80:83]
    ds_read_b128 v[56:59], v13 offset:47104
    ds_read_b128 v[60:63], v13 offset:48128
    v_mfma_f32_16x16x32_bf16 v[84:87], a[164:167], v[32:35], v[84:87]
    v_mfma_f32_16x16x32_bf16 v[88:91], a[160:163], v[36:39], v[88:91]
    v_mfma_f32_16x16x32_bf16 v[92:95], a[164:167], v[36:39], v[92:95]
    s_waitcnt lgkmcnt(4)
    v_mfma_f32_16x16x32_bf16 v[80:83], a[168:171], v[40:43], v[80:83]
    ds_read_b128 v[32:35], v13 offset:49152
    ds_read_b128 v[36:39], v13 offset:50176
    v_mfma_f32_16x16x32_bf16 v[84:87], a[172:175], v[40:43], v[84:87]
    v_mfma_f32_16x16x32_bf16 v[88:91], a[168:171], v[44:47], v[88:91]
    v_mfma_f32_16x16x32_bf16 v[92:95], a[172:175], v[44:47], v[92:95]
    s_waitcnt lgkmcnt(4)
    v_mfma_f32_16x16x32_bf16 v[80:83], a[176:179], v[48:51], v[80:83]
    ds_read_b128 v[40:43], v13 offset:51200
    ds_read_b128 v[44:47], v13 offset:52224
    v_mfma_f32_16x16x32_bf16 v[84:87], a[180:183], v[48:51], v[84:87]
    v_mfma_f32_16x16x32_bf16 v[88:91], a[176:179], v[52:55], v[88:91]
    v_mfma_f32_16x16x32_bf16 v[92:95], a[180:183], v[52:55], v[92:95]
    s_waitcnt lgkmcnt(4)
    v_mfma_f32_16x16x32_bf16 v[80:83], a[184:187], v[56:59], v[80:83]
    ds_read_b128 v[48:51], v13 offset:53248
    ds_read_b128 v[52:55], v13 offset:54272
    v_mfma_f32_16x16x32_bf16 v[84:87], a[188:191], v[56:59], v[84:87]
    v_mfma_f32_16x16x32_bf16 v[88:91], a[184:187], v[60:63], v[88:91]
    v_mfma_f32_16x16x32_bf16 v[92:95], a[188:191], v[60:63], v[92:95]
    s_waitcnt lgkmcnt(4)
    v_mfma_f32_16x16x32_bf16 v[80:83], a[192:195], v[32:35], v[80:83]
    ds_read_b128 v[56:59], v13 offset:55296
    ds_read_b128 v[60:63], v13 offset:56320
    v_mfma_f32_16x16x32_bf16 v[84:87], a[196:199], v[32:35], v[84:87]
    v_mfma_f32_16x16x32_bf16 v[88:91], a[192:195], v[36:39], v[88:91]
    v_mfma_f32_16x16x32_bf16 v[92:95], a[196:199], v[36:39], v[92:95]
    s_waitcnt lgkmcnt(4)
    v_mfma_f32_16x16x32_bf16 v[80:83], a[200:203], v[40:43], v[80:83]
    v_mfma_f32_16x16x32_bf16 v[84:87], a[204:207], v[40:43], v[84:87]
    v_mfma_f32_16x16x32_bf16 v[88:91], a[200:203], v[44:47], v[88:91]
    v_mfma_f32_16x16x32_bf16 v[92:95], a[204:207], v[44:47], v[92:95]
    s_waitcnt lgkmcnt(0)
    v_mfma_f32_16x16x32_bf16 v[80:83], a[208:211], v[48:51], v[80:83]
    v_mfma_f32_16x16x32_bf16 v[84:87], a[212:215], v[48:51], v[84:87]
    v_mfma_f32_16x16x32_bf16 v[88:91], a[208:211], v[52:55], v[88:91]
    v_mfma_f32_16x16x32_bf16 v[92:95], a[212:215], v[52:55], v[92:95]
    v_mfma_f32_16x16x32_bf16 v[80:83], a[216:219], v[56:59], v[80:83]
    v_mfma_f32_16x16x32_bf16 v[84:87], a[220:223], v[56:59], v[84:87]
    v_mfma_f32_16x16x32_bf16 v[88:91], a[216:219], v[60:63], v[88:91]
    v_mfma_f32_16x16x32_bf16 v[92:95], a[220:223], v[60:63], v[92:95]
    s_mov_b32 s76, s57
    s_nop 6
    ds_write_b128 v7, v[80:83] offset:0
    ds_write_b128 v7, v[84:87] offset:64
    ds_write_b128 v7, v[88:91] offset:2304
    ds_write_b128 v7, v[92:95] offset:2368
L_e_fin_169:
    s_waitcnt lgkmcnt(0)
    ds_read_b128 v[216:219], v8 offset:0
    ds_read_b128 v[220:223], v8 offset:1152
    ds_read_b128 v[224:227], v8 offset:2304
    ds_read_b128 v[228:231], v8 offset:3456
    s_waitcnt lgkmcnt(0)
    buffer_store_dwordx4 v[216:219], v11, s[12:15], s76 offen sc1
    s_add_u32 s76, s76, 32768
    buffer_store_dwordx4 v[220:223], v11, s[12:15], s76 offen sc1
    s_add_u32 s76, s76, 32768
    buffer_store_dwordx4 v[224:227], v11, s[12:15], s76 offen sc1
    s_add_u32 s76, s76, 32768
    buffer_store_dwordx4 v[228:231], v11, s[12:15], s76 offen sc1
    s_waitcnt vmcnt(0)
    s_barrier
    s_cmp_lg_u32 s44, 0
    s_cbranch_scc1 L_pub_170
    v_mov_b32 v30, s62
    v_mov_b32 v31, 0
    s_mov_b64 exec, 1
    buffer_store_dword v30, v31, s[80:83], s65 offen
    buffer_store_dword v30, v31, s[84:87], s65 offen sc1
    s_mov_b64 exec, -1
L_pub_170:
    s_cmp_lg_u32 s51, 1
    s_cbranch_scc1 L_c_skip_163
    s_lshl_b32 s63, s50, 5
    s_add_u32 s63, s63, s41
    s_lshl_b32 s47, s63, 11
    s_lshl_b32 s45, s44, 9
    s_add_u32 s47, s47, s45
    s_add_u32 s46, s47, 0x800000
    v_lshlrev_b32 v17, 3, v1
    buffer_load_dwordx2 v[208:209], v17, s[12:15], s46 offen sc1
    s_add_u32 s45, s64, 16384
    s_cmp_lg_u32 s44, 0
    s_cbranch_scc1 L_pw_171
    s_mov_b32 exec_hi, 0
    s_mov_b32 s70, 0
L_wp_172:
    buffer_load_dword v31, v5, s[12:15], s45 offen sc1
    s_add_u32 s70, s70, 1
    s_cmp_ge_u32 s70, 0x200000
    s_cbranch_scc1 L_w_done_96
    s_waitcnt vmcnt(0)
    v_cmp_gt_u32 vcc, s62, v31
    s_nop 1
    s_cbranch_vccz L_wp_172_ok
    s_sleep 1
    s_branch L_wp_172
L_wp_172_ok:
    s_mov_b64 exec, -1
L_pw_171:
    s_barrier
    s_waitcnt vmcnt(0)
    s_lshl_b32 s45, s63, 12
    s_lshl_b32 s46, s44, 10
    s_add_u32 s45, s45, s46
    s_add_u32 s45, s45, 0xc000000
    buffer_load_dwordx4 v[64:67], v10, s[12:15], s45 offen sc1
    s_add_u32 s45, s45, 0x800000
    buffer_load_dwordx4 v[68:71], v10, s[12:15], s45 offen sc1
    s_add_u32 s45, s45, 0x800000
    buffer_load_dwordx4 v[72:75], v10, s[12:15], s45 offen sc1
    s_add_u32 s45, s45, 0x800000
    buffer_load_dwordx4 v[76:79], v10, s[12:15], s45 offen sc1
    v_lshlrev_b32 v160, 16, v208
    v_and_b32 v161, 0xffff0000, v208
    v_lshlrev_b32 v162, 16, v209
    v_and_b32 v163, 0xffff0000, v209
    s_waitcnt vmcnt(0)
    v_pk_add_f32 v[64:65], v[64:65], v[68:69]
    v_pk_add_f32 v[72:73], v[72:73], v[76:77]
    v_pk_add_f32 v[66:67], v[66:67], v[70:71]
    v_pk_add_f32 v[74:75], v[74:75], v[78:79]
    v_pk_add_f32 v[64:65], v[64:65], v[72:73]
    v_pk_add_f32 v[66:67], v[66:67], v[74:75]
    v_cvt_pk_bf16_f32 v64, v64, v64
    v_lshlrev_b32 v64, 16, v64
    v_cvt_pk_bf16_f32 v65, v65, v65
    v_lshlrev_b32 v65, 16, v65
    v_cvt_pk_bf16_f32 v66, v66, v66
    v_lshlrev_b32 v66, 16, v66
    v_cvt_pk_bf16_f32 v67, v67, v67
    v_lshlrev_b32 v67, 16, v67
    v_add_f32 v64, v64, v18
    v_cvt_pk_bf16_f32 v64, v64, v64
    v_lshlrev_b32 v64, 16, v64
    v_mul_f32 v64, v64, v22
    v_cvt_pk_bf16_f32 v64, v64, v64
    v_lshlrev_b32 v64, 16, v64
    v_add_f32 v64, v64, v160
    v_add_f32 v65, v65, v19
    v_cvt_pk_bf16_f32 v65, v65, v65
    v_lshlrev_b32 v65, 16, v65
    v_mul_f32 v65, v65, v23
    v_cvt_pk_bf16_f32 v65, v65, v65
    v_lshlrev_b32 v65, 16, v65
    v_add_f32 v65, v65, v161
    v_add_f32 v66, v66, v20
    v_cvt_pk_bf16_f32 v66, v66, v66
    v_lshlrev_b32 v66, 16, v66
    v_mul_f32 v66, v66, v24
    v_cvt_pk_bf16_f32 v66, v66, v66
    v_lshlrev_b32 v66, 16, v66
    v_add_f32 v66, v66, v162
    v_add_f32 v67, v67, v21
    v_cvt_pk_bf16_f32 v67, v67, v67
    v_lshlrev_b32 v67, 16, v67
    v_mul_f32 v67, v67, v25
    v_cvt_pk_bf16_f32 v67, v67, v67
    v_lshlrev_b32 v67, 16, v67
    v_add_f32 v67, v67, v163
    v_cvt_pk_bf16_f32 v208, v64, v65
    v_cvt_pk_bf16_f32 v209, v66, v67
    buffer_store_dwordx2 v[208:209], v17, s[32:35], s47 offen
    s_branch L_c_loop_162
L_c_skip_163:
    s_add_u32 s63, s50, s44
    s_lshl_b32 s63, s63, 5
    s_add_u32 s63, s63, s41
    s_lshl_b32 s47, s63, 11
    s_add_u32 s46, s47, 0x800000
    s_cmp_lt_u32 s44, s51
    s_cselect_b32 s46, s46, 0x20000000
    buffer_load_dwordx4 v[208:211], v10, s[12:15], s46 offen sc1
    buffer_load_dwordx4 v[212:215], v10, s[12:15], s46 offen offset:1024 sc1
    s_add_u32 s45, s64, 16384
    s_cmp_lg_u32 s44, 0
    s_cbranch_scc1 L_pw_173
    s_mov_b32 exec_hi, 0
    s_mov_b32 s70, 0
L_wp_174:
    buffer_load_dword v31, v5, s[12:15], s45 offen sc1
    s_add_u32 s70, s70, 1
    s_cmp_ge_u32 s70, 0x200000
    s_cbranch_scc1 L_w_done_96
    s_waitcnt vmcnt(0)
    v_cmp_gt_u32 vcc, s62, v31
    s_nop 1
    s_cbranch_vccz L_wp_174_ok
    s_sleep 1
    s_branch L_wp_174
L_wp_174_ok:
    s_mov_b64 exec, -1
L_pw_173:
    s_barrier
    s_cmp_ge_u32 s44, s51
    s_cbranch_scc1 L_c_loop_162
    s_lshl_b32 s45, s63, 12
    s_add_u32 s45, s45, 0xc000000
    v_lshlrev_b32 v29, 5, v1
    buffer_load_dwordx4 v[64:67], v29, s[12:15], s45 offen offset:0 sc1
    buffer_load_dwordx4 v[68:71], v29, s[12:15], s45 offen offset:16 sc1
    buffer_load_dwordx4 v[72:75], v29, s[12:15], s45 offen offset:2048 sc1
    buffer_load_dwordx4 v[76:79], v29, s[12:15], s45 offen offset:2064 sc1
    s_add_u32 s45, s45, 0x800000
    buffer_load_dwordx4 v[160:163], v29, s[12:15], s45 offen offset:0 sc1
    buffer_load_dwordx4 v[164:167], v29, s[12:15], s45 offen offset:16 sc1
    buffer_load_dwordx4 v[168:171], v29, s[12:15], s45 offen offset:2048 sc1
    buffer_load_dwordx4 v[172:175], v29, s[12:15], s45 offen offset:2064 sc1
    s_add_u32 s45, s45, 0x800000
    buffer_load_dwordx4 v[176:179], v29, s[12:15], s45 offen offset:0 sc1
    buffer_load_dwordx4 v[180:183], v29, s[12:15], s45 offen offset:16 sc1
    buffer_load_dwordx4 v[184:187], v29, s[12:15], s45 offen offset:2048 sc1
    buffer_load_dwordx4 v[188:191], v29, s[12:15], s45 offen offset:2064 sc1
    s_add_u32 s45, s45, 0x800000
    buffer_load_dwordx4 v[192:195], v29, s[12:15], s45 offen offset:0 sc1
    buffer_load_dwordx4 v[196:199], v29, s[12:15], s45 offen offset:16 sc1
    buffer_load_dwordx4 v[200:203], v29, s[12:15], s45 offen offset:2048 sc1
    buffer_load_dwordx4 v[204:207], v29, s[12:15], s45 offen offset:2064 sc1
    s_waitcnt vmcnt(0)
    v_pk_add_f32 v[64:65], v[64:65], v[160:161]
    v_pk_add_f32 v[176:177], v[176:177], v[192:193]
    v_pk_add_f32 v[66:67], v[66:67], v[162:163]
    v_pk_add_f32 v[178:179], v[178:179], v[194:195]
    v_pk_add_f32 v[68:69], v[68:69], v[164:165]
    v_pk_add_f32 v[180:181], v[180:181], v[196:197]
    v_pk_add_f32 v[70:71], v[70:71], v[166:167]
    v_pk_add_f32 v[182:183], v[182:183], v[198:199]
    v_pk_add_f32 v[72:73], v[72:73], v[168:169]
    v_pk_add_f32 v[184:185], v[184:185], v[200:201]
    v_pk_add_f32 v[74:75], v[74:75], v[170:171]
    v_pk_add_f32 v[186:187], v[186:187], v[202:203]
    v_pk_add_f32 v[76:77], v[76:77], v[172:173]
    v_pk_add_f32 v[188:189], v[188:189], v[204:205]
    v_pk_add_f32 v[78:79], v[78:79], v[174:175]
    v_pk_add_f32 v[190:191], v[190:191], v[206:207]
    v_pk_add_f32 v[64:65], v[64:65], v[176:177]
    v_pk_add_f32 v[66:67], v[66:67], v[178:179]
    v_pk_add_f32 v[68:69], v[68:69], v[180:181]
    v_pk_add_f32 v[70:71], v[70:71], v[182:183]
    v_pk_add_f32 v[72:73], v[72:73], v[184:185]
    v_pk_add_f32 v[74:75], v[74:75], v[186:187]
    v_pk_add_f32 v[76:77], v[76:77], v[188:189]
    v_pk_add_f32 v[78:79], v[78:79], v[190:191]
    v_cvt_pk_bf16_f32 v64, v64, v64
    v_lshlrev_b32 v64, 16, v64
    v_cvt_pk_bf16_f32 v65, v65, v65
    v_lshlrev_b32 v65, 16, v65
    v_cvt_pk_bf16_f32 v66, v66, v66
    v_lshlrev_b32 v66, 16, v66
    v_cvt_pk_bf16_f32 v67, v67, v67
    v_lshlrev_b32 v67, 16, v67
    v_cvt_pk_bf16_f32 v68, v68, v68
    v_lshlrev_b32 v68, 16, v68
    v_cvt_pk_bf16_f32 v69, v69, v69
    v_lshlrev_b32 v69, 16, v69
    v_cvt_pk_bf16_f32 v70, v70, v70
    v_lshlrev_b32 v70, 16, v70
    v_cvt_pk_bf16_f32 v71, v71, v71
    v_lshlrev_b32 v71, 16, v71
    v_cvt_pk_bf16_f32 v72, v72, v72
    v_lshlrev_b32 v72, 16, v72
    v_cvt_pk_bf16_f32 v73, v73, v73
    v_lshlrev_b32 v73, 16, v73
    v_cvt_pk_bf16_f32 v74, v74, v74
    v_lshlrev_b32 v74, 16, v74
    v_cvt_pk_bf16_f32 v75, v75, v75
    v_lshlrev_b32 v75, 16, v75
    v_cvt_pk_bf16_f32 v76, v76, v76
    v_lshlrev_b32 v76, 16, v76
    v_cvt_pk_bf16_f32 v77, v77, v77
    v_lshlrev_b32 v77, 16, v77
    v_cvt_pk_bf16_f32 v78, v78, v78
    v_lshlrev_b32 v78, 16, v78
    v_cvt_pk_bf16_f32 v79, v79, v79
    v_lshlrev_b32 v79, 16, v79
    v_lshlrev_b32 v160, 16, v208
    v_and_b32 v161, 0xffff0000, v208
    v_lshlrev_b32 v162, 16, v209
    v_and_b32 v163, 0xffff0000, v209
    v_lshlrev_b32 v164, 16, v210
    v_and_b32 v165, 0xffff0000, v210
    v_lshlrev_b32 v166, 16, v211
    v_and_b32 v167, 0xffff0000, v211
    v_lshlrev_b32 v168, 16, v212
    v_and_b32 v169, 0xffff0000, v212
    v_lshlrev_b32 v170, 16, v213
    v_and_b32 v171, 0xffff0000, v213
    v_lshlrev_b32 v172, 16, v214
    v_and_b32 v173, 0xffff0000, v214
    v_lshlrev_b32 v174, 16, v215
    v_and_b32 v175, 0xffff0000, v215
    v_add_f32 v64, v64, v96
    v_cvt_pk_bf16_f32 v64, v64, v64
    v_lshlrev_b32 v64, 16, v64
    v_mul_f32 v64, v64, v112
    v_cvt_pk_bf16_f32 v64, v64, v64
    v_lshlrev_b32 v64, 16, v64
    v_add_f32 v64, v64, v160
    v_add_f32 v65, v65, v97
    v_cvt_pk_bf16_f32 v65, v65, v65
    v_lshlrev_b32 v65, 16, v65
    v_mul_f32 v65, v65, v113
    v_cvt_pk_bf16_f32 v65, v65, v65
    v_lshlrev_b32 v65, 16, v65
    v_add_f32 v65, v65, v161
    v_add_f32 v66, v66, v98
    v_cvt_pk_bf16_f32 v66, v66, v66
    v_lshlrev_b32 v66, 16, v66
    v_mul_f32 v66, v66, v114
    v_cvt_pk_bf16_f32 v66, v66, v66
    v_lshlrev_b32 v66, 16, v66
    v_add_f32 v66, v66, v162
    v_add_f32 v67, v67, v99
    v_cvt_pk_bf16_f32 v67, v67, v67
    v_lshlrev_b32 v67, 16, v67
    v_mul_f32 v67, v67, v115
    v_cvt_pk_bf16_f32 v67, v67, v67
    v_lshlrev_b32 v67, 16, v67
    v_add_f32 v67, v67, v163
    v_add_f32 v68, v68, v100
    v_cvt_pk_bf16_f32 v68, v68, v68
    v_lshlrev_b32 v68, 16, v68
    v_mul_f32 v68, v68, v116
    v_cvt_pk_bf16_f32 v68, v68, v68
    v_lshlrev_b32 v68, 16, v68
    v_add_f32 v68, v68, v164
    v_add_f32 v69, v69, v101
    v_cvt_pk_bf16_f32 v69, v69, v69
    v_lshlrev_b32 v69, 16, v69
    v_mul_f32 v69, v69, v117
    v_cvt_pk_bf16_f32 v69, v69, v69
    v_lshlrev_b32 v69, 16, v69
    v_add_f32 v69, v69, v165
    v_add_f32 v70, v70, v102
    v_cvt_pk_bf16_f32 v70, v70, v70
    v_lshlrev_b32 v70, 16, v70
    v_mul_f32 v70, v70, v118
    v_cvt_pk_bf16_f32 v70, v70, v70
    v_lshlrev_b32 v70, 16, v70
    v_add_f32 v70, v70, v166
    v_add_f32 v71, v71, v103
    v_cvt_pk_bf16_f32 v71, v71, v71
    v_lshlrev_b32 v71, 16, v71
    v_mul_f32 v71, v71, v119
    v_cvt_pk_bf16_f32 v71, v71, v71
    v_lshlrev_b32 v71, 16, v71
    v_add_f32 v71, v71, v167
    v_add_f32 v72, v72, v104
    v_cvt_pk_bf16_f32 v72, v72, v72
    v_lshlrev_b32 v72, 16, v72
    v_mul_f32 v72, v72, v120
    v_cvt_pk_bf16_f32 v72, v72, v72
    v_lshlrev_b32 v72, 16, v72
    v_add_f32 v72, v72, v168
    v_add_f32 v73, v73, v105
    v_cvt_pk_bf16_f32 v73, v73, v73
    v_lshlrev_b32 v73, 16, v73
    v_mul_f32 v73, v73, v121
    v_cvt_pk_bf16_f32 v73, v73, v73
    v_lshlrev_b32 v73, 16, v73
    v_add_f32 v73, v73, v169
    v_add_f32 v74, v74, v106
    v_cvt_pk_bf16_f32 v74, v74, v74
    v_lshlrev_b32 v74, 16, v74
    v_mul_f32 v74, v74, v122
    v_cvt_pk_bf16_f32 v74, v74, v74
    v_lshlrev_b32 v74, 16, v74
    v_add_f32 v74, v74, v170
    v_add_f32 v75, v75, v107
    v_cvt_pk_bf16_f32 v75, v75, v75
    v_lshlrev_b32 v75, 16, v75
    v_mul_f32 v75, v75, v123
    v_cvt_pk_bf16_f32 v75, v75, v75
    v_lshlrev_b32 v75, 16, v75
    v_add_f32 v75, v75, v171
    v_add_f32 v76, v76, v108
    v_cvt_pk_bf16_f32 v76, v76, v76
    v_lshlrev_b32 v76, 16, v76
    v_mul_f32 v76, v76, v124
    v_cvt_pk_bf16_f32 v76, v76, v76
    v_lshlrev_b32 v76, 16, v76
    v_add_f32 v76, v76, v172
    v_add_f32 v77, v77, v109
    v_cvt_pk_bf16_f32 v77, v77, v77
    v_lshlrev_b32 v77, 16, v77
    v_mul_f32 v77, v77, v125
    v_cvt_pk_bf16_f32 v77, v77, v77
    v_lshlrev_b32 v77, 16, v77
    v_add_f32 v77, v77, v173
    v_add_f32 v78, v78, v110
    v_cvt_pk_bf16_f32 v78, v78, v78
    v_lshlrev_b32 v78, 16, v78
    v_mul_f32 v78, v78, v126
    v_cvt_pk_bf16_f32 v78, v78, v78
    v_lshlrev_b32 v78, 16, v78
    v_add_f32 v78, v78, v174
    v_add_f32 v79, v79, v111
    v_cvt_pk_bf16_f32 v79, v79, v79
    v_lshlrev_b32 v79, 16, v79
    v_mul_f32 v79, v79, v127
    v_cvt_pk_bf16_f32 v79, v79, v79
    v_lshlrev_b32 v79, 16, v79
    v_add_f32 v79, v79, v175
    v_cvt_pk_bf16_f32 v208, v64, v65
    v_cvt_pk_bf16_f32 v209, v66, v67
    v_cvt_pk_bf16_f32 v210, v68, v69
    v_cvt_pk_bf16_f32 v211, v70, v71
    v_cvt_pk_bf16_f32 v212, v72, v73
    v_cvt_pk_bf16_f32 v213, v74, v75
    v_cvt_pk_bf16_f32 v214, v76, v77
    v_cvt_pk_bf16_f32 v215, v78, v79
    buffer_store_dwordx4 v[208:211], v10, s[32:35], s47 offen
    buffer_store_dwordx4 v[212:215], v10, s[32:35], s47 offen offset:1024
    s_branch L_c_loop_162
L_w_done_96:
    s_endpgm
.section .rodata,"a"
.p2align 6
.amdhsa_kernel adaLN_cond__memory_aug_recurrent_mem_tr__dense_activation_gelu__prompt_kernel
  .amdhsa_next_free_vgpr 512
  .amdhsa_next_free_sgpr 102
  .amdhsa_accum_offset 256
  .amdhsa_group_segment_fixed_size 0
  .amdhsa_kernarg_size 136
  .amdhsa_user_sgpr_count 2
  .amdhsa_user_sgpr_kernarg_segment_ptr 1
  .amdhsa_system_sgpr_workgroup_id_x 1
.end_amdhsa_kernel
```

```asm
; @launch kernel=adaLN_cond__memory_aug_recurrent_mem_tr__dense_activation_gelu__prompt_kernel grid=(256,1,1) block=(256,1,1) lds=163840
.amdgcn_target "amdgcn-amd-amdhsa--gfx950"
.text
.globl adaLN_cond__memory_aug_recurrent_mem_tr__dense_activation_gelu__prompt_kernel
.p2align 8
.type adaLN_cond__memory_aug_recurrent_mem_tr__dense_activation_gelu__prompt_kernel,@function
adaLN_cond__memory_aug_recurrent_mem_tr__dense_activation_gelu__prompt_kernel:
    s_cmp_lt_u32 s2, 256
    s_cbranch_scc1 L_c_done_1_go
    s_endpgm
L_c_done_1_go:
    s_and_b32 s40, s2, 7
    s_load_dwordx4 s[4:7], s[0:1], 16
    s_load_dwordx4 s[8:11], s[0:1], 32
    s_load_dwordx2 s[20:21], s[0:1], 128
    s_load_dwordx2 s[22:23], s[0:1], 120
    s_load_dwordx2 s[50:51], s[0:1], 8
    s_lshr_b32 s41, s2, 3
    s_and_b32 s42, s41, 15
    v_and_b32 v1, 63, v0
    v_lshrrev_b32 v2, 6, v0
    s_nop 0
    v_readfirstlane_b32 s44, v2
    s_waitcnt lgkmcnt(0)
    s_mov_b32 s24, s4
    s_and_b32 s25, s5, 0xffff
    s_mov_b32 s26, 0x800000
    s_mov_b32 s27, 0x00020000
    s_mov_b32 s28, s6
    s_and_b32 s29, s7, 0xffff
    s_mov_b32 s30, 0x800000
    s_mov_b32 s31, 0x00020000
    s_mov_b32 s32, s8
    s_and_b32 s33, s9, 0xffff
    s_mov_b32 s34, 0x800000
    s_mov_b32 s35, 0x00020000
    s_mov_b32 s36, s10
    s_and_b32 s37, s11, 0xffff
    s_mov_b32 s38, 0x800000
    s_mov_b32 s39, 0x00020000
    s_mov_b32 s12, s20
    s_and_b32 s13, s21, 0xffff
    s_mov_b32 s14, 0x10000000
    s_mov_b32 s15, 0x00020000
    s_mov_b32 s16, s22
    s_and_b32 s17, s23, 0xffff
    s_mov_b32 s18, 0x100
    s_mov_b32 s19, 0x00020000
    s_mov_b32 s52, s50
    s_and_b32 s53, s51, 0xffff
    s_mov_b32 s54, 0x4000
    s_mov_b32 s55, 0x00020000
    v_mov_b32 v41, 0
    s_cmp_lg_u32 s2, 1
    s_cbranch_scc1 L_worker_3_a
    s_getreg_b32 s45, hwreg(HW_REG_XCC_ID)
    s_and_b32 s45, s45, 1
    s_add_u32 s45, s45, 1
    v_mov_b32 v40, s45
    buffer_store_dword v40, v41, s[16:19], 0 offen offset:24 sc1
L_worker_3_a:
    s_cmp_eq_u32 s40, 1
    s_cbranch_scc1 L_worker_3_g0
    s_cmp_lt_u32 s40, 3
    s_cbranch_scc1 L_worker_3_q
    s_sub_u32 s40, s40, 2
    s_branch L_worker_3
L_worker_3_q:
    s_mov_b32 s70, 0
L_worker_3_p:
    buffer_load_dword v40, v41, s[16:19], 0 offen offset:24 sc1
    s_add_u32 s70, s70, 1
    s_cmp_ge_u32 s70, 0x200000
    s_cbranch_scc1 L_c_done_1
    s_waitcnt vmcnt(0)
    v_readfirstlane_b32 s45, v40
    s_nop 3
    s_cmp_eq_u32 s45, 0
    s_cbranch_scc1 L_worker_3_p
    s_and_b32 s45, s45, 2
    s_cmp_lg_u32 s45, s40
    s_mov_b32 s40, 1
    s_cbranch_scc1 L_worker_3_no
    s_mov_b32 s40, 0
    s_branch L_worker_3
L_worker_3_g0:
    s_mov_b32 s40, 0
L_worker_3_no:
    s_lshl_b32 s43, s40, 4
    s_add_u32 s43, s43, s42
    s_lshl_b32 s3, s43, 7
    s_lshr_b32 s45, s41, 4
    s_lshl_b32 s45, s45, 4
    s_add_u32 s3, s3, s45
    s_lshl_b32 s45, s44, 2
    s_add_u32 s3, s3, s45
    s_add_u32 s3, s3, 0x11000
    v_and_b32 v21, 8, v1
    v_cmp_eq_u32 s[56:57], 0, v21
    v_mov_b32 v2, 0xeeee
    v_mov_b32 v3, 0x4444
    v_cndmask_b32 v2, v2, v3, s[56:57]
    v_lshlrev_b32 v68, 4, v1
    s_lshl_b32 s45, s44, 12
    v_add_u32 v3, s45, v68
    v_add_u32 v4, 4096, v3
    v_and_b32 v4, 16383, v4
    v_add_u32 v21, 8192, v3
    v_and_b32 v21, 16383, v21
    v_add_u32 v23, 12288, v3
    v_and_b32 v23, 16383, v23
    s_mul_i32 s45, s44, 24576
    s_add_u32 s45, s45, 65536
    v_add_u32 v5, s45, v68
    v_lshrrev_b32 v63, 4, v1
    s_lshl_b32 s45, s44, 2
    v_add_u32 v64, s45, v63
    s_lshr_b32 s45, s44, 1
    s_lshl_b32 s45, s45, 2
    v_add_u32 v65, s45, v63
    v_bfe_u32 v66, v1, 1, 3
    v_xor_b32 v66, v66, v65
    v_lshlrev_b32 v66, 5, v66
    v_and_b32 v67, 1, v1
    v_lshlrev_b32 v67, 4, v67
    v_add_u32 v66, v66, v67
    v_lshlrev_b32 v64, 13, v64
    v_add_u32 v82, v64, v66
    s_lshl_b32 s47, s43, 8
    s_lshl_b32 s48, s44, 10
    v_bfe_u32 v64, v1, 2, 2
    v_bfe_u32 v65, v1, 4, 1
    v_lshlrev_b32 v65, 2, v65
    v_add_u32 v65, v65, v64
    v_lshlrev_b32 v66, 3, v63
    v_add_u32 v66, v66, v64
    v_lshlrev_b32 v66, 8, v66
    v_and_b32 v67, 3, v1
    v_lshlrev_b32 v67, 3, v67
    v_add_u32 v66, v66, v67
    s_lshl_b32 s45, s44, 1
    v_xor_b32 v65, s45, v65
    v_lshlrev_b32 v65, 5, v65
    v_add_u32 v80, v66, v65
    v_xor_b32 v81, 32, v80
    v_lshrrev_b32 v64, 5, v1
    v_mul_u32_u24 v64, 20480, v64
    v_add_u32 v64, 65536, v64
    v_add_u32 v84, v64, v80
    v_add_u32 v85, v64, v81
    v_add_u32 v86, 49152, v84
    v_add_u32 v87, 49152, v85
    v_mov_b32 v40, -1
    v_mov_b32 v41, -1
    v_mov_b32 v42, -1
    v_mov_b32 v43, -1
    v_mov_b32 v44, 0
    s_mov_b32 s68, 0
    s_cmp_ge_u32 s41, 16
    s_cbranch_scc1 L_c_vo_2
    s_lshl_b32 s45, s42, 11
    s_lshr_b32 s46, s44, 1
    s_lshl_b32 s46, s46, 10
    s_add_u32 s45, s45, s46
    s_and_b32 s46, s44, 1
    s_lshl_b32 s46, s46, 7
    s_add_u32 s45, s45, s46
    v_add_u32 v17, s45, v68
    v_mov_b32 v63, 0x20000000
    v_cndmask_b32 v17, v63, v17, s[56:57]
    s_lshl_b32 s62, s40, 17
    s_add_u32 s62, s62, 0x7040000
    s_add_u32 s63, s62, 0
    buffer_store_dwordx4 v[40:43], v17, s[12:15], s63 offen sc1
    s_add_u32 s63, s62, 32768
    buffer_store_dwordx4 v[40:43], v17, s[12:15], s63 offen sc1
    s_add_u32 s63, s62, 65536
    buffer_store_dwordx4 v[40:43], v17, s[12:15], s63 offen sc1
    s_add_u32 s63, s62, 98304
    buffer_store_dwordx4 v[40:43], v17, s[12:15], s63 offen sc1
    s_mov_b64 exec, -1
    s_lshl_b32 s45, s40, 12
    s_lshl_b32 s46, s42, 4
    s_add_u32 s45, s45, s46
    s_add_u32 s45, s45, 0x7080000
    s_lshl_b32 s46, s44, 2
    s_add_u32 s45, s45, s46
    v_lshlrev_b32 v20, 8, v1
    v_add_u32 v20, s45, v20
    v_cmp_gt_u32 vcc, 16, v1
    s_nop 1
    v_cndmask_b32 v20, v63, v20, vcc
    buffer_store_dword v44, v20, s[12:15], 0 offen sc1
    s_lshl_b32 s45, s43, 7
    s_add_u32 s45, s45, 0x10010
    v_lshlrev_b32 v64, 2, v1
    s_mov_b64 exec, 7
    buffer_store_dword v44, v64, s[12:15], s45 offen sc1
    s_mov_b64 exec, 1
    v_mov_b32 v65, 63
    buffer_store_dword v44, v64, s[12:15], s3 offen sc1
    buffer_store_dword v65, v64, s[12:15], s3 offen offset:16 sc1
    s_mov_b64 exec, 0xffff
    v_lshlrev_b32 v64, 7, v1
    s_cmp_eq_u32 s2, 1
    s_mov_b32 s45, 0x1f000
    s_cselect_b32 s45, s45, 0x20000000
    buffer_store_dword v44, v64, s[12:15], s45 offen sc1
    s_mov_b64 exec, -1
    s_add_u32 s79, s41, 0
    s_and_b32 s79, s79, 3
    s_lshl_b32 s79, s79, 19
    s_add_u32 s79, s79, s47
    s_add_u32 s46, s79, 0x0
    s_add_u32 m0, s48, 69632
    s_nop 0
    buffer_load_dwordx4 v82, s[24:27], s46 offen  lds
    s_add_u32 s46, s79, 0x20000
    s_add_u32 m0, s48, 94208
    s_nop 0
    buffer_load_dwordx4 v82, s[24:27], s46 offen  lds
    s_add_u32 s46, s79, 0x40000
    s_add_u32 m0, s48, 118784
    s_nop 0
    buffer_load_dwordx4 v82, s[24:27], s46 offen  lds
    s_add_u32 s46, s79, 0x60000
    s_add_u32 m0, s48, 143360
    s_nop 0
    buffer_load_dwordx4 v82, s[24:27], s46 offen  lds
    s_add_u32 s79, s41, 1
    s_and_b32 s79, s79, 3
    s_lshl_b32 s79, s79, 19
    s_add_u32 s79, s79, s47
    s_add_u32 s46, s79, 0x0
    s_add_u32 m0, s48, 73728
    s_nop 0
    buffer_load_dwordx4 v82, s[24:27], s46 offen  lds
    s_add_u32 s46, s79, 0x20000
    s_add_u32 m0, s48, 98304
    s_nop 0
    buffer_load_dwordx4 v82, s[24:27], s46 offen  lds
    s_add_u32 s46, s79, 0x40000
    s_add_u32 m0, s48, 122880
    s_nop 0
    buffer_load_dwordx4 v82, s[24:27], s46 offen  lds
    s_add_u32 s46, s79, 0x60000
    s_add_u32 m0, s48, 147456
    s_nop 0
    buffer_load_dwordx4 v82, s[24:27], s46 offen  lds
    s_add_u32 s79, s41, 2
    s_and_b32 s79, s79, 3
    s_lshl_b32 s79, s79, 19
    s_add_u32 s79, s79, s47
    s_add_u32 s46, s79, 0x0
    s_add_u32 m0, s48, 81920
    s_nop 0
    buffer_load_dwordx4 v82, s[24:27], s46 offen  lds
    s_add_u32 s46, s79, 0x20000
    s_add_u32 m0, s48, 106496
    s_nop 0
    buffer_load_dwordx4 v82, s[24:27], s46 offen  lds
    s_add_u32 s46, s79, 0x40000
    s_add_u32 m0, s48, 131072
    s_nop 0
    buffer_load_dwordx4 v82, s[24:27], s46 offen  lds
    s_add_u32 s46, s79, 0x60000
    s_add_u32 m0, s48, 155648
    s_nop 0
    buffer_load_dwordx4 v82, s[24:27], s46 offen  lds
    s_add_u32 s79, s41, 3
    s_and_b32 s79, s79, 3
    s_lshl_b32 s79, s79, 19
    s_add_u32 s79, s79, s47
    s_add_u32 s46, s79, 0x0
    s_add_u32 m0, s48, 86016
    s_nop 0
    buffer_load_dwordx4 v82, s[24:27], s46 offen  lds
    s_add_u32 s46, s79, 0x20000
    s_add_u32 m0, s48, 110592
    s_nop 0
    buffer_load_dwordx4 v82, s[24:27], s46 offen  lds
    s_add_u32 s46, s79, 0x40000
    s_add_u32 m0, s48, 135168
    s_nop 0
    buffer_load_dwordx4 v82, s[24:27], s46 offen  lds
    s_add_u32 s46, s79, 0x60000
    s_add_u32 m0, s48, 159744
    s_nop 0
    buffer_load_dwordx4 v82, s[24:27], s46 offen  lds
    s_add_u32 s79, s41, 4
    s_and_b32 s79, s79, 3
    s_lshl_b32 s79, s79, 19
    s_add_u32 s79, s79, s47
    s_add_u32 s46, s79, 0x200000
    s_add_u32 m0, s48, 0
    s_nop 0
    buffer_load_dwordx4 v82, s[24:27], s46 offen  lds
    s_add_u32 s46, s79, 0x220000
    s_add_u32 m0, s48, 4096
    s_nop 0
    buffer_load_dwordx4 v82, s[24:27], s46 offen  lds
    s_add_u32 s46, s79, 0x240000
    s_add_u32 m0, s48, 8192
    s_nop 0
    buffer_load_dwordx4 v82, s[24:27], s46 offen  lds
    s_add_u32 s46, s79, 0x260000
    s_add_u32 m0, s48, 12288
    s_nop 0
    buffer_load_dwordx4 v82, s[24:27], s46 offen  lds
    s_add_u32 s79, s41, 5
    s_and_b32 s79, s79, 3
    s_lshl_b32 s79, s79, 19
    s_add_u32 s79, s79, s47
    s_add_u32 s46, s79, 0x200000
    s_add_u32 m0, s48, 16384
    s_nop 0
    buffer_load_dwordx4 v82, s[24:27], s46 offen  lds
    s_add_u32 s46, s79, 0x220000
    s_add_u32 m0, s48, 20480
    s_nop 0
    buffer_load_dwordx4 v82, s[24:27], s46 offen  lds
    s_add_u32 s46, s79, 0x240000
    s_add_u32 m0, s48, 24576
    s_nop 0
    buffer_load_dwordx4 v82, s[24:27], s46 offen  lds
    s_add_u32 s46, s79, 0x260000
    s_add_u32 m0, s48, 28672
    s_nop 0
    buffer_load_dwordx4 v82, s[24:27], s46 offen  lds
    s_add_u32 s79, s41, 6
    s_and_b32 s79, s79, 3
    s_lshl_b32 s79, s79, 19
    s_add_u32 s79, s79, s47
    s_add_u32 s46, s79, 0x200000
    s_add_u32 m0, s48, 32768
    s_nop 0
    buffer_load_dwordx4 v82, s[24:27], s46 offen  lds
    s_add_u32 s46, s79, 0x220000
    s_add_u32 m0, s48, 36864
    s_nop 0
    buffer_load_dwordx4 v82, s[24:27], s46 offen  lds
    s_add_u32 s46, s79, 0x240000
    s_add_u32 m0, s48, 40960
    s_nop 0
    buffer_load_dwordx4 v82, s[24:27], s46 offen  lds
    s_add_u32 s46, s79, 0x260000
    s_add_u32 m0, s48, 45056
    s_nop 0
    buffer_load_dwordx4 v82, s[24:27], s46 offen  lds
    s_add_u32 s79, s41, 7
    s_and_b32 s79, s79, 3
    s_lshl_b32 s79, s79, 19
    s_add_u32 s79, s79, s47
    s_add_u32 s46, s79, 0x200000
    s_add_u32 m0, s48, 49152
    s_nop 0
    buffer_load_dwordx4 v82, s[24:27], s46 offen  lds
    s_add_u32 s46, s79, 0x220000
    s_add_u32 m0, s48, 53248
    s_nop 0
    buffer_load_dwordx4 v82, s[24:27], s46 offen  lds
    s_add_u32 s46, s79, 0x240000
    s_add_u32 m0, s48, 57344
    s_nop 0
    buffer_load_dwordx4 v82, s[24:27], s46 offen  lds
    s_add_u32 s46, s79, 0x260000
    s_add_u32 m0, s48, 61440
    s_nop 0
    buffer_load_dwordx4 v82, s[24:27], s46 offen  lds
    s_waitcnt vmcnt(28)
    s_barrier
    s_cmp_lg_u32 s44, 0
    s_cbranch_scc1 L_lw_4_0
    ds_read_b64_tr_b16 a[0:1], v84 offset:4096
    ds_read_b64_tr_b16 a[2:3], v84 offset:5120
    ds_read_b64_tr_b16 a[4:5], v86 offset:4096
    ds_read_b64_tr_b16 a[6:7], v86 offset:5120
    ds_read_b64_tr_b16 a[8:9], v85 offset:4096
    ds_read_b64_tr_b16 a[10:11], v85 offset:5120
    ds_read_b64_tr_b16 a[12:13], v87 offset:4096
    ds_read_b64_tr_b16 a[14:15], v87 offset:5120
    s_branch L_lw_4
L_lw_4_0:
    s_cmp_lg_u32 s44, 1
    s_cbranch_scc1 L_lw_4_1
    ds_read_b64_tr_b16 v[128:129], v84 offset:4096
    ds_read_b64_tr_b16 v[130:131], v84 offset:5120
    ds_read_b64_tr_b16 v[132:133], v86 offset:4096
    ds_read_b64_tr_b16 v[134:135], v86 offset:5120
    ds_read_b64_tr_b16 v[136:137], v85 offset:4096
    ds_read_b64_tr_b16 v[138:139], v85 offset:5120
    ds_read_b64_tr_b16 v[140:141], v87 offset:4096
    ds_read_b64_tr_b16 v[142:143], v87 offset:5120
    s_branch L_lw_4
L_lw_4_1:
    s_cmp_lg_u32 s44, 2
    s_cbranch_scc1 L_lw_4_2
    ds_read_b64_tr_b16 a[192:193], v84 offset:4096
    ds_read_b64_tr_b16 a[194:195], v84 offset:5120
    ds_read_b64_tr_b16 a[196:197], v86 offset:4096
    ds_read_b64_tr_b16 a[198:199], v86 offset:5120
    ds_read_b64_tr_b16 v[56:57], v85 offset:4096
    ds_read_b64_tr_b16 v[58:59], v85 offset:5120
    ds_read_b64_tr_b16 v[60:61], v87 offset:4096
    ds_read_b64_tr_b16 v[62:63], v87 offset:5120
    s_waitcnt lgkmcnt(0)
    ds_write_b128 v5, v[56:59] offset:0
    ds_write_b128 v5, v[60:63] offset:1024
    s_branch L_lw_4
L_lw_4_2:
    ds_read_b64_tr_b16 a[96:97], v84 offset:4096
    ds_read_b64_tr_b16 a[98:99], v84 offset:5120
    ds_read_b64_tr_b16 a[100:101], v86 offset:4096
    ds_read_b64_tr_b16 a[102:103], v86 offset:5120
    ds_read_b64_tr_b16 v[56:57], v85 offset:4096
    ds_read_b64_tr_b16 v[58:59], v85 offset:5120
    ds_read_b64_tr_b16 v[60:61], v87 offset:4096
    ds_read_b64_tr_b16 v[62:63], v87 offset:5120
    s_waitcnt lgkmcnt(0)
    ds_write_b128 v5, v[56:59] offset:2048
    ds_write_b128 v5, v[60:63] offset:3072
L_lw_4:
    s_waitcnt lgkmcnt(0)
    s_waitcnt vmcnt(24)
    s_barrier
    s_cmp_lg_u32 s44, 0
    s_cbranch_scc1 L_hs_5
    s_getreg_b32 s45, hwreg(HW_REG_XCC_ID)
    s_and_b32 s45, s45, 15
    s_mul_i32 s46, s45, s45
    s_lshl_b32 s46, s46, 9
    s_add_u32 s45, s45, s46
    s_cmp_eq_u32 s40, 0
    s_cselect_b32 s46, s45, 0
    s_cselect_b32 s45, 0, s45
    s_lshl_b32 s68, s68, 24
    s_add_u32 s46, s46, s68
    s_add_u32 s45, s45, 16777216
    v_mov_b32 v40, s46
    v_mov_b32 v41, s45
    v_mov_b32 v42, 0
    s_mov_b64 exec, 1
    buffer_atomic_add_x2 v[40:41], v42, s[16:19], 0 offen sc1
    v_mov_b32 v43, 1
    buffer_atomic_add v43, v42, s[16:19], 0 offen offset:8 sc1
    s_mov_b64 exec, -1
L_hs_5:
    s_cmp_lg_u32 s44, 0
    s_cbranch_scc1 L_lw_6_0
    ds_read_b64_tr_b16 a[32:33], v84 offset:8192
    ds_read_b64_tr_b16 a[34:35], v84 offset:9216
    ds_read_b64_tr_b16 a[36:37], v86 offset:8192
    ds_read_b64_tr_b16 a[38:39], v86 offset:9216
    ds_read_b64_tr_b16 a[40:41], v85 offset:8192
    ds_read_b64_tr_b16 a[42:43], v85 offset:9216
    ds_read_b64_tr_b16 a[44:45], v87 offset:8192
    ds_read_b64_tr_b16 a[46:47], v87 offset:9216
    s_branch L_lw_6
L_lw_6_0:
    s_cmp_lg_u32 s44, 1
    s_cbranch_scc1 L_lw_6_1
    ds_read_b64_tr_b16 v[160:161], v84 offset:8192
    ds_read_b64_tr_b16 v[162:163], v84 offset:9216
    ds_read_b64_tr_b16 v[164:165], v86 offset:8192
    ds_read_b64_tr_b16 v[166:167], v86 offset:9216
    ds_read_b64_tr_b16 v[168:169], v85 offset:8192
    ds_read_b64_tr_b16 v[170:171], v85 offset:9216
    ds_read_b64_tr_b16 v[172:173], v87 offset:8192
    ds_read_b64_tr_b16 v[174:175], v87 offset:9216
    s_branch L_lw_6
L_lw_6_1:
    s_cmp_lg_u32 s44, 2
    s_cbranch_scc1 L_lw_6_2
    ds_read_b64_tr_b16 a[216:217], v84 offset:8192
    ds_read_b64_tr_b16 a[218:219], v84 offset:9216
    ds_read_b64_tr_b16 a[220:221], v86 offset:8192
    ds_read_b64_tr_b16 a[222:223], v86 offset:9216
    ds_read_b64_tr_b16 v[56:57], v85 offset:8192
    ds_read_b64_tr_b16 v[58:59], v85 offset:9216
    ds_read_b64_tr_b16 v[60:61], v87 offset:8192
    ds_read_b64_tr_b16 v[62:63], v87 offset:9216
    s_waitcnt lgkmcnt(0)
    ds_write_b128 v5, v[56:59] offset:4096
    ds_write_b128 v5, v[60:63] offset:5120
    s_branch L_lw_6
L_lw_6_2:
    ds_read_b64_tr_b16 a[120:121], v84 offset:8192
    ds_read_b64_tr_b16 a[122:123], v84 offset:9216
    ds_read_b64_tr_b16 a[124:125], v86 offset:8192
    ds_read_b64_tr_b16 a[126:127], v86 offset:9216
    ds_read_b64_tr_b16 v[56:57], v85 offset:8192
    ds_read_b64_tr_b16 v[58:59], v85 offset:9216
    ds_read_b64_tr_b16 v[60:61], v87 offset:8192
    ds_read_b64_tr_b16 v[62:63], v87 offset:9216
    s_waitcnt lgkmcnt(0)
    ds_write_b128 v5, v[56:59] offset:6144
    ds_write_b128 v5, v[60:63] offset:7168
L_lw_6:
    s_waitcnt lgkmcnt(0)
    s_waitcnt vmcnt(20)
    s_barrier
    s_cmp_lg_u32 s44, 0
    s_cbranch_scc1 L_lw_7_0
    ds_read_b64_tr_b16 a[64:65], v84 offset:16384
    ds_read_b64_tr_b16 a[66:67], v84 offset:17408
    ds_read_b64_tr_b16 a[68:69], v86 offset:16384
    ds_read_b64_tr_b16 a[70:71], v86 offset:17408
    ds_read_b64_tr_b16 v[56:57], v85 offset:16384
    ds_read_b64_tr_b16 v[58:59], v85 offset:17408
    ds_read_b64_tr_b16 v[60:61], v87 offset:16384
    ds_read_b64_tr_b16 v[62:63], v87 offset:17408
    s_waitcnt lgkmcnt(0)
    ds_write_b128 v5, v[56:59] offset:8192
    ds_write_b128 v5, v[60:63] offset:9216
    s_branch L_lw_7
L_lw_7_0:
    s_cmp_lg_u32 s44, 1
    s_cbranch_scc1 L_lw_7_1
    ds_read_b64_tr_b16 v[192:193], v84 offset:16384
    ds_read_b64_tr_b16 v[194:195], v84 offset:17408
    ds_read_b64_tr_b16 v[196:197], v86 offset:16384
    ds_read_b64_tr_b16 v[198:199], v86 offset:17408
    ds_read_b64_tr_b16 v[200:201], v85 offset:16384
    ds_read_b64_tr_b16 v[202:203], v85 offset:17408
    ds_read_b64_tr_b16 v[204:205], v87 offset:16384
    ds_read_b64_tr_b16 v[206:207], v87 offset:17408
    s_branch L_lw_7
L_lw_7_1:
    s_cmp_lg_u32 s44, 2
    s_cbranch_scc1 L_lw_7_2
    ds_read_b64_tr_b16 a[240:241], v84 offset:16384
    ds_read_b64_tr_b16 a[242:243], v84 offset:17408
    ds_read_b64_tr_b16 a[244:245], v86 offset:16384
    ds_read_b64_tr_b16 a[246:247], v86 offset:17408
    ds_read_b64_tr_b16 v[56:57], v85 offset:16384
    ds_read_b64_tr_b16 v[58:59], v85 offset:17408
    ds_read_b64_tr_b16 v[60:61], v87 offset:16384
    ds_read_b64_tr_b16 v[62:63], v87 offset:17408
    s_waitcnt lgkmcnt(0)
    ds_write_b128 v5, v[56:59] offset:10240
    ds_write_b128 v5, v[60:63] offset:11264
    s_branch L_lw_7
L_lw_7_2:
    ds_read_b64_tr_b16 a[144:145], v84 offset:16384
    ds_read_b64_tr_b16 a[146:147], v84 offset:17408
    ds_read_b64_tr_b16 a[148:149], v86 offset:16384
    ds_read_b64_tr_b16 a[150:151], v86 offset:17408
    ds_read_b64_tr_b16 v[56:57], v85 offset:16384
    ds_read_b64_tr_b16 v[58:59], v85 offset:17408
    ds_read_b64_tr_b16 v[60:61], v87 offset:16384
    ds_read_b64_tr_b16 v[62:63], v87 offset:17408
    s_waitcnt lgkmcnt(0)
    ds_write_b128 v5, v[56:59] offset:12288
    ds_write_b128 v5, v[60:63] offset:13312
L_lw_7:
    s_waitcnt lgkmcnt(0)
    s_waitcnt vmcnt(16)
    s_barrier
    s_cmp_lg_u32 s44, 0
    s_cbranch_scc1 L_lw_8_0
    ds_read_b64_tr_b16 a[80:81], v84 offset:20480
    ds_read_b64_tr_b16 a[82:83], v84 offset:21504
    ds_read_b64_tr_b16 a[84:85], v86 offset:20480
    ds_read_b64_tr_b16 a[86:87], v86 offset:21504
    ds_read_b64_tr_b16 v[56:57], v85 offset:20480
    ds_read_b64_tr_b16 v[58:59], v85 offset:21504
    ds_read_b64_tr_b16 v[60:61], v87 offset:20480
    ds_read_b64_tr_b16 v[62:63], v87 offset:21504
    s_waitcnt lgkmcnt(0)
    ds_write_b128 v5, v[56:59] offset:14336
    ds_write_b128 v5, v[60:63] offset:15360
    s_branch L_lw_8
L_lw_8_0:
    s_cmp_lg_u32 s44, 1
    s_cbranch_scc1 L_lw_8_1
    ds_read_b64_tr_b16 v[224:225], v84 offset:20480
    ds_read_b64_tr_b16 v[226:227], v84 offset:21504
    ds_read_b64_tr_b16 v[228:229], v86 offset:20480
    ds_read_b64_tr_b16 v[230:231], v86 offset:21504
    ds_read_b64_tr_b16 v[232:233], v85 offset:20480
    ds_read_b64_tr_b16 v[234:235], v85 offset:21504
    ds_read_b64_tr_b16 v[236:237], v87 offset:20480
    ds_read_b64_tr_b16 v[238:239], v87 offset:21504
    s_branch L_lw_8
L_lw_8_1:
    s_cmp_lg_u32 s44, 2
    s_cbranch_scc1 L_lw_8_2
    ds_read_b64_tr_b16 v[104:105], v84 offset:20480
    ds_read_b64_tr_b16 v[106:107], v84 offset:21504
    ds_read_b64_tr_b16 v[108:109], v86 offset:20480
    ds_read_b64_tr_b16 v[110:111], v86 offset:21504
    ds_read_b64_tr_b16 v[56:57], v85 offset:20480
    ds_read_b64_tr_b16 v[58:59], v85 offset:21504
    ds_read_b64_tr_b16 v[60:61], v87 offset:20480
    ds_read_b64_tr_b16 v[62:63], v87 offset:21504
    s_waitcnt lgkmcnt(0)
    ds_write_b128 v5, v[56:59] offset:16384
    ds_write_b128 v5, v[60:63] offset:17408
    s_branch L_lw_8
L_lw_8_2:
    ds_read_b64_tr_b16 a[168:169], v84 offset:20480
    ds_read_b64_tr_b16 a[170:171], v84 offset:21504
    ds_read_b64_tr_b16 a[172:173], v86 offset:20480
    ds_read_b64_tr_b16 a[174:175], v86 offset:21504
    ds_read_b64_tr_b16 v[56:57], v85 offset:20480
    ds_read_b64_tr_b16 v[58:59], v85 offset:21504
    ds_read_b64_tr_b16 v[60:61], v87 offset:20480
    ds_read_b64_tr_b16 v[62:63], v87 offset:21504
    s_waitcnt lgkmcnt(0)
    ds_write_b128 v5, v[56:59] offset:18432
    ds_write_b128 v5, v[60:63] offset:19456
L_lw_8:
    s_waitcnt lgkmcnt(0)
    s_waitcnt vmcnt(12)
    s_barrier
    s_add_u32 s79, s41, 8
    s_and_b32 s79, s79, 3
    s_lshl_b32 s79, s79, 19
    s_add_u32 s79, s79, s47
    s_add_u32 s46, s79, 0x400000
    s_add_u32 m0, s48, 86016
    s_nop 0
    buffer_load_dwordx4 v82, s[24:27], s46 offen  lds
    s_add_u32 s46, s79, 0x420000
    s_add_u32 m0, s48, 110592
    s_nop 0
    buffer_load_dwordx4 v82, s[24:27], s46 offen  lds
    s_add_u32 s46, s79, 0x440000
    s_add_u32 m0, s48, 135168
    s_nop 0
    buffer_load_dwordx4 v82, s[24:27], s46 offen  lds
    s_add_u32 s46, s79, 0x460000
    s_add_u32 m0, s48, 159744
    s_nop 0
    buffer_load_dwordx4 v82, s[24:27], s46 offen  lds
    s_cmp_lg_u32 s44, 0
    s_cbranch_scc1 L_lw_9_0
    ds_read_b64_tr_b16 a[96:97], v80 offset:0
    ds_read_b64_tr_b16 a[98:99], v80 offset:1024
    ds_read_b64_tr_b16 a[100:101], v80 offset:8192
    ds_read_b64_tr_b16 a[102:103], v80 offset:9216
    ds_read_b64_tr_b16 v[56:57], v81 offset:0
    ds_read_b64_tr_b16 v[58:59], v81 offset:1024
    ds_read_b64_tr_b16 v[60:61], v81 offset:8192
    ds_read_b64_tr_b16 v[62:63], v81 offset:9216
    s_waitcnt lgkmcnt(0)
    ds_write_b128 v5, v[56:59] offset:2048
    ds_write_b128 v5, v[60:63] offset:3072
    s_branch L_lw_9
L_lw_9_0:
    s_cmp_lg_u32 s44, 1
    s_cbranch_scc1 L_lw_9_1
    ds_read_b64_tr_b16 a[0:1], v80 offset:0
    ds_read_b64_tr_b16 a[2:3], v80 offset:1024
    ds_read_b64_tr_b16 a[4:5], v80 offset:8192
    ds_read_b64_tr_b16 a[6:7], v80 offset:9216
    ds_read_b64_tr_b16 a[8:9], v81 offset:0
    ds_read_b64_tr_b16 a[10:11], v81 offset:1024
    ds_read_b64_tr_b16 a[12:13], v81 offset:8192
    ds_read_b64_tr_b16 a[14:15], v81 offset:9216
    s_branch L_lw_9
L_lw_9_1:
    s_cmp_lg_u32 s44, 2
    s_cbranch_scc1 L_lw_9_2
    ds_read_b64_tr_b16 v[128:129], v80 offset:0
    ds_read_b64_tr_b16 v[130:131], v80 offset:1024
    ds_read_b64_tr_b16 v[132:133], v80 offset:8192
    ds_read_b64_tr_b16 v[134:135], v80 offset:9216
    ds_read_b64_tr_b16 v[136:137], v81 offset:0
    ds_read_b64_tr_b16 v[138:139], v81 offset:1024
    ds_read_b64_tr_b16 v[140:141], v81 offset:8192
    ds_read_b64_tr_b16 v[142:143], v81 offset:9216
    s_branch L_lw_9
L_lw_9_2:
    ds_read_b64_tr_b16 a[192:193], v80 offset:0
    ds_read_b64_tr_b16 a[194:195], v80 offset:1024
    ds_read_b64_tr_b16 a[196:197], v80 offset:8192
    ds_read_b64_tr_b16 a[198:199], v80 offset:9216
    ds_read_b64_tr_b16 v[56:57], v81 offset:0
    ds_read_b64_tr_b16 v[58:59], v81 offset:1024
    ds_read_b64_tr_b16 v[60:61], v81 offset:8192
    ds_read_b64_tr_b16 v[62:63], v81 offset:9216
    s_waitcnt lgkmcnt(0)
    ds_write_b128 v5, v[56:59] offset:0
    ds_write_b128 v5, v[60:63] offset:1024
L_lw_9:
    s_waitcnt lgkmcnt(0)
    s_waitcnt vmcnt(12)
    s_barrier
    s_add_u32 s79, s41, 9
    s_and_b32 s79, s79, 3
    s_lshl_b32 s79, s79, 19
    s_add_u32 s79, s79, s47
    s_add_u32 s46, s79, 0x400000
    s_add_u32 m0, s48, 0
    s_nop 0
    buffer_load_dwordx4 v82, s[24:27], s46 offen  lds
    s_add_u32 s46, s79, 0x420000
    s_add_u32 m0, s48, 4096
    s_nop 0
    buffer_load_dwordx4 v82, s[24:27], s46 offen  lds
    s_add_u32 s46, s79, 0x440000
    s_add_u32 m0, s48, 8192
    s_nop 0
    buffer_load_dwordx4 v82, s[24:27], s46 offen  lds
    s_add_u32 s46, s79, 0x460000
    s_add_u32 m0, s48, 12288
    s_nop 0
    buffer_load_dwordx4 v82, s[24:27], s46 offen  lds
    s_cmp_lg_u32 s44, 0
    s_cbranch_scc1 L_lw_10_0
    ds_read_b64_tr_b16 a[120:121], v80 offset:16384
    ds_read_b64_tr_b16 a[122:123], v80 offset:17408
    ds_read_b64_tr_b16 a[124:125], v80 offset:24576
    ds_read_b64_tr_b16 a[126:127], v80 offset:25600
    ds_read_b64_tr_b16 v[56:57], v81 offset:16384
    ds_read_b64_tr_b16 v[58:59], v81 offset:17408
    ds_read_b64_tr_b16 v[60:61], v81 offset:24576
    ds_read_b64_tr_b16 v[62:63], v81 offset:25600
    s_waitcnt lgkmcnt(0)
    ds_write_b128 v5, v[56:59] offset:6144
    ds_write_b128 v5, v[60:63] offset:7168
    s_branch L_lw_10
L_lw_10_0:
    s_cmp_lg_u32 s44, 1
    s_cbranch_scc1 L_lw_10_1
    ds_read_b64_tr_b16 a[32:33], v80 offset:16384
    ds_read_b64_tr_b16 a[34:35], v80 offset:17408
    ds_read_b64_tr_b16 a[36:37], v80 offset:24576
    ds_read_b64_tr_b16 a[38:39], v80 offset:25600
    ds_read_b64_tr_b16 a[40:41], v81 offset:16384
    ds_read_b64_tr_b16 a[42:43], v81 offset:17408
    ds_read_b64_tr_b16 a[44:45], v81 offset:24576
    ds_read_b64_tr_b16 a[46:47], v81 offset:25600
    s_branch L_lw_10
L_lw_10_1:
    s_cmp_lg_u32 s44, 2
    s_cbranch_scc1 L_lw_10_2
    ds_read_b64_tr_b16 v[160:161], v80 offset:16384
    ds_read_b64_tr_b16 v[162:163], v80 offset:17408
    ds_read_b64_tr_b16 v[164:165], v80 offset:24576
    ds_read_b64_tr_b16 v[166:167], v80 offset:25600
    ds_read_b64_tr_b16 v[168:169], v81 offset:16384
    ds_read_b64_tr_b16 v[170:171], v81 offset:17408
    ds_read_b64_tr_b16 v[172:173], v81 offset:24576
    ds_read_b64_tr_b16 v[174:175], v81 offset:25600
    s_branch L_lw_10
L_lw_10_2:
    ds_read_b64_tr_b16 a[216:217], v80 offset:16384
    ds_read_b64_tr_b16 a[218:219], v80 offset:17408
    ds_read_b64_tr_b16 a[220:221], v80 offset:24576
    ds_read_b64_tr_b16 a[222:223], v80 offset:25600
    ds_read_b64_tr_b16 v[56:57], v81 offset:16384
    ds_read_b64_tr_b16 v[58:59], v81 offset:17408
    ds_read_b64_tr_b16 v[60:61], v81 offset:24576
    ds_read_b64_tr_b16 v[62:63], v81 offset:25600
    s_waitcnt lgkmcnt(0)
    ds_write_b128 v5, v[56:59] offset:4096
    ds_write_b128 v5, v[60:63] offset:5120
L_lw_10:
    s_waitcnt lgkmcnt(0)
    s_waitcnt vmcnt(12)
    s_barrier
    s_add_u32 s79, s41, 10
    s_and_b32 s79, s79, 3
    s_lshl_b32 s79, s79, 19
    s_add_u32 s79, s79, s47
    s_add_u32 s46, s79, 0x400000
    s_add_u32 m0, s48, 16384
    s_nop 0
    buffer_load_dwordx4 v82, s[24:27], s46 offen  lds
    s_add_u32 s46, s79, 0x420000
    s_add_u32 m0, s48, 20480
    s_nop 0
    buffer_load_dwordx4 v82, s[24:27], s46 offen  lds
    s_add_u32 s46, s79, 0x440000
    s_add_u32 m0, s48, 24576
    s_nop 0
    buffer_load_dwordx4 v82, s[24:27], s46 offen  lds
    s_add_u32 s46, s79, 0x460000
    s_add_u32 m0, s48, 28672
    s_nop 0
    buffer_load_dwordx4 v82, s[24:27], s46 offen  lds
    s_cmp_lg_u32 s44, 0
    s_cbranch_scc1 L_lw_11_0
    ds_read_b64_tr_b16 a[144:145], v80 offset:32768
    ds_read_b64_tr_b16 a[146:147], v80 offset:33792
    ds_read_b64_tr_b16 a[148:149], v80 offset:40960
    ds_read_b64_tr_b16 a[150:151], v80 offset:41984
    ds_read_b64_tr_b16 v[56:57], v81 offset:32768
    ds_read_b64_tr_b16 v[58:59], v81 offset:33792
    ds_read_b64_tr_b16 v[60:61], v81 offset:40960
    ds_read_b64_tr_b16 v[62:63], v81 offset:41984
    s_waitcnt lgkmcnt(0)
    ds_write_b128 v5, v[56:59] offset:12288
    ds_write_b128 v5, v[60:63] offset:13312
    s_branch L_lw_11
L_lw_11_0:
    s_cmp_lg_u32 s44, 1
    s_cbranch_scc1 L_lw_11_1
    ds_read_b64_tr_b16 a[64:65], v80 offset:32768
    ds_read_b64_tr_b16 a[66:67], v80 offset:33792
    ds_read_b64_tr_b16 a[68:69], v80 offset:40960
    ds_read_b64_tr_b16 a[70:71], v80 offset:41984
    ds_read_b64_tr_b16 v[56:57], v81 offset:32768
    ds_read_b64_tr_b16 v[58:59], v81 offset:33792
    ds_read_b64_tr_b16 v[60:61], v81 offset:40960
    ds_read_b64_tr_b16 v[62:63], v81 offset:41984
    s_waitcnt lgkmcnt(0)
    ds_write_b128 v5, v[56:59] offset:8192
    ds_write_b128 v5, v[60:63] offset:9216
    s_branch L_lw_11
L_lw_11_1:
    s_cmp_lg_u32 s44, 2
    s_cbranch_scc1 L_lw_11_2
    ds_read_b64_tr_b16 v[192:193], v80 offset:32768
    ds_read_b64_tr_b16 v[194:195], v80 offset:33792
    ds_read_b64_tr_b16 v[196:197], v80 offset:40960
    ds_read_b64_tr_b16 v[198:199], v80 offset:41984
    ds_read_b64_tr_b16 v[200:201], v81 offset:32768
    ds_read_b64_tr_b16 v[202:203], v81 offset:33792
    ds_read_b64_tr_b16 v[204:205], v81 offset:40960
    ds_read_b64_tr_b16 v[206:207], v81 offset:41984
    s_branch L_lw_11
L_lw_11_2:
    ds_read_b64_tr_b16 a[240:241], v80 offset:32768
    ds_read_b64_tr_b16 a[242:243], v80 offset:33792
    ds_read_b64_tr_b16 a[244:245], v80 offset:40960
    ds_read_b64_tr_b16 a[246:247], v80 offset:41984
    ds_read_b64_tr_b16 v[56:57], v81 offset:32768
    ds_read_b64_tr_b16 v[58:59], v81 offset:33792
    ds_read_b64_tr_b16 v[60:61], v81 offset:40960
    ds_read_b64_tr_b16 v[62:63], v81 offset:41984
    s_waitcnt lgkmcnt(0)
    ds_write_b128 v5, v[56:59] offset:10240
    ds_write_b128 v5, v[60:63] offset:11264
L_lw_11:
    s_waitcnt lgkmcnt(0)
    s_waitcnt vmcnt(12)
    s_barrier
    s_add_u32 s79, s41, 11
    s_and_b32 s79, s79, 3
    s_lshl_b32 s79, s79, 19
    s_add_u32 s79, s79, s47
    s_add_u32 s46, s79, 0x400000
    s_add_u32 m0, s48, 32768
    s_nop 0
    buffer_load_dwordx4 v82, s[24:27], s46 offen  lds
    s_add_u32 s46, s79, 0x420000
    s_add_u32 m0, s48, 36864
    s_nop 0
    buffer_load_dwordx4 v82, s[24:27], s46 offen  lds
    s_add_u32 s46, s79, 0x440000
    s_add_u32 m0, s48, 40960
    s_nop 0
    buffer_load_dwordx4 v82, s[24:27], s46 offen  lds
    s_add_u32 s46, s79, 0x460000
    s_add_u32 m0, s48, 45056
    s_nop 0
    buffer_load_dwordx4 v82, s[24:27], s46 offen  lds
    s_cmp_lg_u32 s44, 0
    s_cbranch_scc1 L_lw_12_0
    ds_read_b64_tr_b16 a[168:169], v80 offset:49152
    ds_read_b64_tr_b16 a[170:171], v80 offset:50176
    ds_read_b64_tr_b16 a[172:173], v80 offset:57344
    ds_read_b64_tr_b16 a[174:175], v80 offset:58368
    ds_read_b64_tr_b16 v[56:57], v81 offset:49152
    ds_read_b64_tr_b16 v[58:59], v81 offset:50176
    ds_read_b64_tr_b16 v[60:61], v81 offset:57344
    ds_read_b64_tr_b16 v[62:63], v81 offset:58368
    s_waitcnt lgkmcnt(0)
    ds_write_b128 v5, v[56:59] offset:18432
    ds_write_b128 v5, v[60:63] offset:19456
    s_branch L_lw_12
L_lw_12_0:
    s_cmp_lg_u32 s44, 1
    s_cbranch_scc1 L_lw_12_1
    ds_read_b64_tr_b16 a[80:81], v80 offset:49152
    ds_read_b64_tr_b16 a[82:83], v80 offset:50176
    ds_read_b64_tr_b16 a[84:85], v80 offset:57344
    ds_read_b64_tr_b16 a[86:87], v80 offset:58368
    ds_read_b64_tr_b16 v[56:57], v81 offset:49152
    ds_read_b64_tr_b16 v[58:59], v81 offset:50176
    ds_read_b64_tr_b16 v[60:61], v81 offset:57344
    ds_read_b64_tr_b16 v[62:63], v81 offset:58368
    s_waitcnt lgkmcnt(0)
    ds_write_b128 v5, v[56:59] offset:14336
    ds_write_b128 v5, v[60:63] offset:15360
    s_branch L_lw_12
L_lw_12_1:
    s_cmp_lg_u32 s44, 2
    s_cbranch_scc1 L_lw_12_2
    ds_read_b64_tr_b16 v[224:225], v80 offset:49152
    ds_read_b64_tr_b16 v[226:227], v80 offset:50176
    ds_read_b64_tr_b16 v[228:229], v80 offset:57344
    ds_read_b64_tr_b16 v[230:231], v80 offset:58368
    ds_read_b64_tr_b16 v[232:233], v81 offset:49152
    ds_read_b64_tr_b16 v[234:235], v81 offset:50176
    ds_read_b64_tr_b16 v[236:237], v81 offset:57344
    ds_read_b64_tr_b16 v[238:239], v81 offset:58368
    s_branch L_lw_12
L_lw_12_2:
    ds_read_b64_tr_b16 v[104:105], v80 offset:49152
    ds_read_b64_tr_b16 v[106:107], v80 offset:50176
    ds_read_b64_tr_b16 v[108:109], v80 offset:57344
    ds_read_b64_tr_b16 v[110:111], v80 offset:58368
    ds_read_b64_tr_b16 v[56:57], v81 offset:49152
    ds_read_b64_tr_b16 v[58:59], v81 offset:50176
    ds_read_b64_tr_b16 v[60:61], v81 offset:57344
    ds_read_b64_tr_b16 v[62:63], v81 offset:58368
    s_waitcnt lgkmcnt(0)
    ds_write_b128 v5, v[56:59] offset:16384
    ds_write_b128 v5, v[60:63] offset:17408
L_lw_12:
    s_waitcnt lgkmcnt(0)
    s_waitcnt vmcnt(12)
    s_barrier
    s_add_u32 s79, s41, 12
    s_and_b32 s79, s79, 3
    s_lshl_b32 s79, s79, 19
    s_add_u32 s79, s79, s47
    s_add_u32 s46, s79, 0x600000
    s_add_u32 m0, s48, 49152
    s_nop 0
    buffer_load_dwordx4 v82, s[24:27], s46 offen  lds
    s_add_u32 s46, s79, 0x620000
    s_add_u32 m0, s48, 53248
    s_nop 0
    buffer_load_dwordx4 v82, s[24:27], s46 offen  lds
    s_add_u32 s46, s79, 0x640000
    s_add_u32 m0, s48, 57344
    s_nop 0
    buffer_load_dwordx4 v82, s[24:27], s46 offen  lds
    s_add_u32 s46, s79, 0x660000
    s_add_u32 m0, s48, 61440
    s_nop 0
    buffer_load_dwordx4 v82, s[24:27], s46 offen  lds
    s_cmp_lg_u32 s44, 0
    s_cbranch_scc1 L_lw_13_0
    ds_read_b64_tr_b16 a[192:193], v84 offset:20480
    ds_read_b64_tr_b16 a[194:195], v84 offset:21504
    ds_read_b64_tr_b16 a[196:197], v86 offset:20480
    ds_read_b64_tr_b16 a[198:199], v86 offset:21504
    ds_read_b64_tr_b16 v[56:57], v85 offset:20480
    ds_read_b64_tr_b16 v[58:59], v85 offset:21504
    ds_read_b64_tr_b16 v[60:61], v87 offset:20480
    ds_read_b64_tr_b16 v[62:63], v87 offset:21504
    s_waitcnt lgkmcnt(0)
    ds_write_b128 v5, v[56:59] offset:0
    ds_write_b128 v5, v[60:63] offset:1024
    s_branch L_lw_13
L_lw_13_0:
    s_cmp_lg_u32 s44, 1
    s_cbranch_scc1 L_lw_13_1
    ds_read_b64_tr_b16 a[96:97], v84 offset:20480
    ds_read_b64_tr_b16 a[98:99], v84 offset:21504
    ds_read_b64_tr_b16 a[100:101], v86 offset:20480
    ds_read_b64_tr_b16 a[102:103], v86 offset:21504
    ds_read_b64_tr_b16 v[56:57], v85 offset:20480
    ds_read_b64_tr_b16 v[58:59], v85 offset:21504
    ds_read_b64_tr_b16 v[60:61], v87 offset:20480
    ds_read_b64_tr_b16 v[62:63], v87 offset:21504
    s_waitcnt lgkmcnt(0)
    ds_write_b128 v5, v[56:59] offset:2048
    ds_write_b128 v5, v[60:63] offset:3072
    s_branch L_lw_13
L_lw_13_1:
    s_cmp_lg_u32 s44, 2
    s_cbranch_scc1 L_lw_13_2
    ds_read_b64_tr_b16 a[0:1], v84 offset:20480
    ds_read_b64_tr_b16 a[2:3], v84 offset:21504
    ds_read_b64_tr_b16 a[4:5], v86 offset:20480
    ds_read_b64_tr_b16 a[6:7], v86 offset:21504
    ds_read_b64_tr_b16 a[8:9], v85 offset:20480
    ds_read_b64_tr_b16 a[10:11], v85 offset:21504
    ds_read_b64_tr_b16 a[12:13], v87 offset:20480
    ds_read_b64_tr_b16 a[14:15], v87 offset:21504
    s_branch L_lw_13
L_lw_13_2:
    ds_read_b64_tr_b16 v[128:129], v84 offset:20480
    ds_read_b64_tr_b16 v[130:131], v84 offset:21504
    ds_read_b64_tr_b16 v[132:133], v86 offset:20480
    ds_read_b64_tr_b16 v[134:135], v86 offset:21504
    ds_read_b64_tr_b16 v[136:137], v85 offset:20480
    ds_read_b64_tr_b16 v[138:139], v85 offset:21504
    ds_read_b64_tr_b16 v[140:141], v87 offset:20480
    ds_read_b64_tr_b16 v[142:143], v87 offset:21504
L_lw_13:
    s_waitcnt lgkmcnt(0)
    s_waitcnt vmcnt(12)
    s_barrier
    s_add_u32 s79, s41, 13
    s_and_b32 s79, s79, 3
    s_lshl_b32 s79, s79, 19
    s_add_u32 s79, s79, s47
    s_add_u32 s46, s79, 0x600000
    s_add_u32 m0, s48, 86016
    s_nop 0
    buffer_load_dwordx4 v82, s[24:27], s46 offen  lds
    s_add_u32 s46, s79, 0x620000
    s_add_u32 m0, s48, 110592
    s_nop 0
    buffer_load_dwordx4 v82, s[24:27], s46 offen  lds
    s_add_u32 s46, s79, 0x640000
    s_add_u32 m0, s48, 135168
    s_nop 0
    buffer_load_dwordx4 v82, s[24:27], s46 offen  lds
    s_add_u32 s46, s79, 0x660000
    s_add_u32 m0, s48, 159744
    s_nop 0
    buffer_load_dwordx4 v82, s[24:27], s46 offen  lds
    s_cmp_lg_u32 s44, 0
    s_cbranch_scc1 L_lw_14_0
    ds_read_b64_tr_b16 a[216:217], v80 offset:0
    ds_read_b64_tr_b16 a[218:219], v80 offset:1024
    ds_read_b64_tr_b16 a[220:221], v80 offset:8192
    ds_read_b64_tr_b16 a[222:223], v80 offset:9216
    ds_read_b64_tr_b16 v[56:57], v81 offset:0
    ds_read_b64_tr_b16 v[58:59], v81 offset:1024
    ds_read_b64_tr_b16 v[60:61], v81 offset:8192
    ds_read_b64_tr_b16 v[62:63], v81 offset:9216
    s_waitcnt lgkmcnt(0)
    ds_write_b128 v5, v[56:59] offset:4096
    ds_write_b128 v5, v[60:63] offset:5120
    s_branch L_lw_14
L_lw_14_0:
    s_cmp_lg_u32 s44, 1
    s_cbranch_scc1 L_lw_14_1
    ds_read_b64_tr_b16 a[120:121], v80 offset:0
    ds_read_b64_tr_b16 a[122:123], v80 offset:1024
    ds_read_b64_tr_b16 a[124:125], v80 offset:8192
    ds_read_b64_tr_b16 a[126:127], v80 offset:9216
    ds_read_b64_tr_b16 v[56:57], v81 offset:0
    ds_read_b64_tr_b16 v[58:59], v81 offset:1024
    ds_read_b64_tr_b16 v[60:61], v81 offset:8192
    ds_read_b64_tr_b16 v[62:63], v81 offset:9216
    s_waitcnt lgkmcnt(0)
    ds_write_b128 v5, v[56:59] offset:6144
    ds_write_b128 v5, v[60:63] offset:7168
    s_branch L_lw_14
L_lw_14_1:
    s_cmp_lg_u32 s44, 2
    s_cbranch_scc1 L_lw_14_2
    ds_read_b64_tr_b16 a[32:33], v80 offset:0
    ds_read_b64_tr_b16 a[34:35], v80 offset:1024
    ds_read_b64_tr_b16 a[36:37], v80 offset:8192
    ds_read_b64_tr_b16 a[38:39], v80 offset:9216
    ds_read_b64_tr_b16 a[40:41], v81 offset:0
    ds_read_b64_tr_b16 a[42:43], v81 offset:1024
    ds_read_b64_tr_b16 a[44:45], v81 offset:8192
    ds_read_b64_tr_b16 a[46:47], v81 offset:9216
    s_branch L_lw_14
L_lw_14_2:
    ds_read_b64_tr_b16 v[160:161], v80 offset:0
    ds_read_b64_tr_b16 v[162:163], v80 offset:1024
    ds_read_b64_tr_b16 v[164:165], v80 offset:8192
    ds_read_b64_tr_b16 v[166:167], v80 offset:9216
    ds_read_b64_tr_b16 v[168:169], v81 offset:0
    ds_read_b64_tr_b16 v[170:171], v81 offset:1024
    ds_read_b64_tr_b16 v[172:173], v81 offset:8192
    ds_read_b64_tr_b16 v[174:175], v81 offset:9216
L_lw_14:
    s_waitcnt lgkmcnt(0)
    s_waitcnt vmcnt(12)
    s_barrier
    s_add_u32 s79, s41, 14
    s_and_b32 s79, s79, 3
    s_lshl_b32 s79, s79, 19
    s_add_u32 s79, s79, s47
    s_add_u32 s46, s79, 0x600000
    s_add_u32 m0, s48, 0
    s_nop 0
    buffer_load_dwordx4 v82, s[24:27], s46 offen  lds
    s_add_u32 s46, s79, 0x620000
    s_add_u32 m0, s48, 4096
    s_nop 0
    buffer_load_dwordx4 v82, s[24:27], s46 offen  lds
    s_add_u32 s46, s79, 0x640000
    s_add_u32 m0, s48, 8192
    s_nop 0
    buffer_load_dwordx4 v82, s[24:27], s46 offen  lds
    s_add_u32 s46, s79, 0x660000
    s_add_u32 m0, s48, 12288
    s_nop 0
    buffer_load_dwordx4 v82, s[24:27], s46 offen  lds
    s_cmp_lg_u32 s44, 0
    s_cbranch_scc1 L_lw_15_0
    ds_read_b64_tr_b16 a[240:241], v80 offset:16384
    ds_read_b64_tr_b16 a[242:243], v80 offset:17408
    ds_read_b64_tr_b16 a[244:245], v80 offset:24576
    ds_read_b64_tr_b16 a[246:247], v80 offset:25600
    ds_read_b64_tr_b16 v[56:57], v81 offset:16384
    ds_read_b64_tr_b16 v[58:59], v81 offset:17408
    ds_read_b64_tr_b16 v[60:61], v81 offset:24576
    ds_read_b64_tr_b16 v[62:63], v81 offset:25600
    s_waitcnt lgkmcnt(0)
    ds_write_b128 v5, v[56:59] offset:10240
    ds_write_b128 v5, v[60:63] offset:11264
    s_branch L_lw_15
L_lw_15_0:
    s_cmp_lg_u32 s44, 1
    s_cbranch_scc1 L_lw_15_1
    ds_read_b64_tr_b16 a[144:145], v80 offset:16384
    ds_read_b64_tr_b16 a[146:147], v80 offset:17408
    ds_read_b64_tr_b16 a[148:149], v80 offset:24576
    ds_read_b64_tr_b16 a[150:151], v80 offset:25600
    ds_read_b64_tr_b16 v[56:57], v81 offset:16384
    ds_read_b64_tr_b16 v[58:59], v81 offset:17408
    ds_read_b64_tr_b16 v[60:61], v81 offset:24576
    ds_read_b64_tr_b16 v[62:63], v81 offset:25600
    s_waitcnt lgkmcnt(0)
    ds_write_b128 v5, v[56:59] offset:12288
    ds_write_b128 v5, v[60:63] offset:13312
    s_branch L_lw_15
L_lw_15_1:
    s_cmp_lg_u32 s44, 2
    s_cbranch_scc1 L_lw_15_2
    ds_read_b64_tr_b16 a[64:65], v80 offset:16384
    ds_read_b64_tr_b16 a[66:67], v80 offset:17408
    ds_read_b64_tr_b16 a[68:69], v80 offset:24576
    ds_read_b64_tr_b16 a[70:71], v80 offset:25600
    ds_read_b64_tr_b16 v[56:57], v81 offset:16384
    ds_read_b64_tr_b16 v[58:59], v81 offset:17408
    ds_read_b64_tr_b16 v[60:61], v81 offset:24576
    ds_read_b64_tr_b16 v[62:63], v81 offset:25600
    s_waitcnt lgkmcnt(0)
    ds_write_b128 v5, v[56:59] offset:8192
    ds_write_b128 v5, v[60:63] offset:9216
    s_branch L_lw_15
L_lw_15_2:
    ds_read_b64_tr_b16 v[192:193], v80 offset:16384
    ds_read_b64_tr_b16 v[194:195], v80 offset:17408
    ds_read_b64_tr_b16 v[196:197], v80 offset:24576
    ds_read_b64_tr_b16 v[198:199], v80 offset:25600
    ds_read_b64_tr_b16 v[200:201], v81 offset:16384
    ds_read_b64_tr_b16 v[202:203], v81 offset:17408
    ds_read_b64_tr_b16 v[204:205], v81 offset:24576
    ds_read_b64_tr_b16 v[206:207], v81 offset:25600
L_lw_15:
    s_waitcnt lgkmcnt(0)
    s_waitcnt vmcnt(12)
    s_barrier
    s_add_u32 s79, s41, 15
    s_and_b32 s79, s79, 3
    s_lshl_b32 s79, s79, 19
    s_add_u32 s79, s79, s47
    s_add_u32 s46, s79, 0x600000
    s_add_u32 m0, s48, 16384
    s_nop 0
    buffer_load_dwordx4 v82, s[24:27], s46 offen  lds
    s_add_u32 s46, s79, 0x620000
    s_add_u32 m0, s48, 20480
    s_nop 0
    buffer_load_dwordx4 v82, s[24:27], s46 offen  lds
    s_add_u32 s46, s79, 0x640000
    s_add_u32 m0, s48, 24576
    s_nop 0
    buffer_load_dwordx4 v82, s[24:27], s46 offen  lds
    s_add_u32 s46, s79, 0x660000
    s_add_u32 m0, s48, 28672
    s_nop 0
    buffer_load_dwordx4 v82, s[24:27], s46 offen  lds
    s_cmp_lg_u32 s44, 0
    s_cbranch_scc1 L_lw_16_0
    ds_read_b64_tr_b16 v[104:105], v80 offset:32768
    ds_read_b64_tr_b16 v[106:107], v80 offset:33792
    ds_read_b64_tr_b16 v[108:109], v80 offset:40960
    ds_read_b64_tr_b16 v[110:111], v80 offset:41984
    ds_read_b64_tr_b16 v[56:57], v81 offset:32768
    ds_read_b64_tr_b16 v[58:59], v81 offset:33792
    ds_read_b64_tr_b16 v[60:61], v81 offset:40960
    ds_read_b64_tr_b16 v[62:63], v81 offset:41984
    s_waitcnt lgkmcnt(0)
    ds_write_b128 v5, v[56:59] offset:16384
    ds_write_b128 v5, v[60:63] offset:17408
    s_branch L_lw_16
L_lw_16_0:
    s_cmp_lg_u32 s44, 1
    s_cbranch_scc1 L_lw_16_1
    ds_read_b64_tr_b16 a[168:169], v80 offset:32768
    ds_read_b64_tr_b16 a[170:171], v80 offset:33792
    ds_read_b64_tr_b16 a[172:173], v80 offset:40960
    ds_read_b64_tr_b16 a[174:175], v80 offset:41984
    ds_read_b64_tr_b16 v[56:57], v81 offset:32768
    ds_read_b64_tr_b16 v[58:59], v81 offset:33792
    ds_read_b64_tr_b16 v[60:61], v81 offset:40960
    ds_read_b64_tr_b16 v[62:63], v81 offset:41984
    s_waitcnt lgkmcnt(0)
    ds_write_b128 v5, v[56:59] offset:18432
    ds_write_b128 v5, v[60:63] offset:19456
    s_branch L_lw_16
L_lw_16_1:
    s_cmp_lg_u32 s44, 2
    s_cbranch_scc1 L_lw_16_2
    ds_read_b64_tr_b16 a[80:81], v80 offset:32768
    ds_read_b64_tr_b16 a[82:83], v80 offset:33792
    ds_read_b64_tr_b16 a[84:85], v80 offset:40960
    ds_read_b64_tr_b16 a[86:87], v80 offset:41984
    ds_read_b64_tr_b16 v[56:57], v81 offset:32768
    ds_read_b64_tr_b16 v[58:59], v81 offset:33792
    ds_read_b64_tr_b16 v[60:61], v81 offset:40960
    ds_read_b64_tr_b16 v[62:63], v81 offset:41984
    s_waitcnt lgkmcnt(0)
    ds_write_b128 v5, v[56:59] offset:14336
    ds_write_b128 v5, v[60:63] offset:15360
    s_branch L_lw_16
L_lw_16_2:
    ds_read_b64_tr_b16 v[224:225], v80 offset:32768
    ds_read_b64_tr_b16 v[226:227], v80 offset:33792
    ds_read_b64_tr_b16 v[228:229], v80 offset:40960
    ds_read_b64_tr_b16 v[230:231], v80 offset:41984
    ds_read_b64_tr_b16 v[232:233], v81 offset:32768
    ds_read_b64_tr_b16 v[234:235], v81 offset:33792
    ds_read_b64_tr_b16 v[236:237], v81 offset:40960
    ds_read_b64_tr_b16 v[238:239], v81 offset:41984
L_lw_16:
    s_waitcnt lgkmcnt(0)
    s_waitcnt vmcnt(12)
    s_barrier
    s_add_u32 s79, s41, 0
    s_and_b32 s79, s79, 3
    s_lshl_b32 s79, s79, 19
    s_add_u32 s79, s79, s47
    s_add_u32 s46, s79, 0x0
    s_add_u32 m0, s48, 32768
    s_nop 0
    buffer_load_dwordx4 v82, s[28:31], s46 offen  lds
    s_add_u32 s46, s79, 0x20000
    s_add_u32 m0, s48, 36864
    s_nop 0
    buffer_load_dwordx4 v82, s[28:31], s46 offen  lds
    s_add_u32 s46, s79, 0x40000
    s_add_u32 m0, s48, 40960
    s_nop 0
    buffer_load_dwordx4 v82, s[28:31], s46 offen  lds
    s_add_u32 s46, s79, 0x60000
    s_add_u32 m0, s48, 45056
    s_nop 0
    buffer_load_dwordx4 v82, s[28:31], s46 offen  lds
    s_cmp_lg_u32 s44, 0
    s_cbranch_scc1 L_lw_17_0
    ds_read_b64_tr_b16 v[128:129], v80 offset:49152
    ds_read_b64_tr_b16 v[130:131], v80 offset:50176
    ds_read_b64_tr_b16 v[132:133], v80 offset:57344
    ds_read_b64_tr_b16 v[134:135], v80 offset:58368
    ds_read_b64_tr_b16 v[136:137], v81 offset:49152
    ds_read_b64_tr_b16 v[138:139], v81 offset:50176
    ds_read_b64_tr_b16 v[140:141], v81 offset:57344
    ds_read_b64_tr_b16 v[142:143], v81 offset:58368
    s_branch L_lw_17
L_lw_17_0:
    s_cmp_lg_u32 s44, 1
    s_cbranch_scc1 L_lw_17_1
    ds_read_b64_tr_b16 a[192:193], v80 offset:49152
    ds_read_b64_tr_b16 a[194:195], v80 offset:50176
    ds_read_b64_tr_b16 a[196:197], v80 offset:57344
    ds_read_b64_tr_b16 a[198:199], v80 offset:58368
    ds_read_b64_tr_b16 v[56:57], v81 offset:49152
    ds_read_b64_tr_b16 v[58:59], v81 offset:50176
    ds_read_b64_tr_b16 v[60:61], v81 offset:57344
    ds_read_b64_tr_b16 v[62:63], v81 offset:58368
    s_waitcnt lgkmcnt(0)
    ds_write_b128 v5, v[56:59] offset:0
    ds_write_b128 v5, v[60:63] offset:1024
    s_branch L_lw_17
L_lw_17_1:
    s_cmp_lg_u32 s44, 2
    s_cbranch_scc1 L_lw_17_2
    ds_read_b64_tr_b16 a[96:97], v80 offset:49152
    ds_read_b64_tr_b16 a[98:99], v80 offset:50176
    ds_read_b64_tr_b16 a[100:101], v80 offset:57344
    ds_read_b64_tr_b16 a[102:103], v80 offset:58368
    ds_read_b64_tr_b16 v[56:57], v81 offset:49152
    ds_read_b64_tr_b16 v[58:59], v81 offset:50176
    ds_read_b64_tr_b16 v[60:61], v81 offset:57344
    ds_read_b64_tr_b16 v[62:63], v81 offset:58368
    s_waitcnt lgkmcnt(0)
    ds_write_b128 v5, v[56:59] offset:2048
    ds_write_b128 v5, v[60:63] offset:3072
    s_branch L_lw_17
L_lw_17_2:
    ds_read_b64_tr_b16 a[0:1], v80 offset:49152
    ds_read_b64_tr_b16 a[2:3], v80 offset:50176
    ds_read_b64_tr_b16 a[4:5], v80 offset:57344
    ds_read_b64_tr_b16 a[6:7], v80 offset:58368
    ds_read_b64_tr_b16 a[8:9], v81 offset:49152
    ds_read_b64_tr_b16 a[10:11], v81 offset:50176
    ds_read_b64_tr_b16 a[12:13], v81 offset:57344
    ds_read_b64_tr_b16 a[14:15], v81 offset:58368
L_lw_17:
    s_waitcnt lgkmcnt(0)
    s_waitcnt vmcnt(12)
    s_barrier
    s_add_u32 s79, s41, 1
    s_and_b32 s79, s79, 3
    s_lshl_b32 s79, s79, 19
    s_add_u32 s79, s79, s47
    s_add_u32 s46, s79, 0x0
    s_add_u32 m0, s48, 49152
    s_nop 0
    buffer_load_dwordx4 v82, s[28:31], s46 offen  lds
    s_add_u32 s46, s79, 0x20000
    s_add_u32 m0, s48, 53248
    s_nop 0
    buffer_load_dwordx4 v82, s[28:31], s46 offen  lds
    s_add_u32 s46, s79, 0x40000
    s_add_u32 m0, s48, 57344
    s_nop 0
    buffer_load_dwordx4 v82, s[28:31], s46 offen  lds
    s_add_u32 s46, s79, 0x60000
    s_add_u32 m0, s48, 61440
    s_nop 0
    buffer_load_dwordx4 v82, s[28:31], s46 offen  lds
    s_cmp_lg_u32 s44, 0
    s_cbranch_scc1 L_lw_18_0
    ds_read_b64_tr_b16 v[160:161], v84 offset:20480
    ds_read_b64_tr_b16 v[162:163], v84 offset:21504
    ds_read_b64_tr_b16 v[164:165], v86 offset:20480
    ds_read_b64_tr_b16 v[166:167], v86 offset:21504
    ds_read_b64_tr_b16 v[168:169], v85 offset:20480
    ds_read_b64_tr_b16 v[170:171], v85 offset:21504
    ds_read_b64_tr_b16 v[172:173], v87 offset:20480
    ds_read_b64_tr_b16 v[174:175], v87 offset:21504
    s_branch L_lw_18
L_lw_18_0:
    s_cmp_lg_u32 s44, 1
    s_cbranch_scc1 L_lw_18_1
    ds_read_b64_tr_b16 a[216:217], v84 offset:20480
    ds_read_b64_tr_b16 a[218:219], v84 offset:21504
    ds_read_b64_tr_b16 a[220:221], v86 offset:20480
    ds_read_b64_tr_b16 a[222:223], v86 offset:21504
    ds_read_b64_tr_b16 v[56:57], v85 offset:20480
    ds_read_b64_tr_b16 v[58:59], v85 offset:21504
    ds_read_b64_tr_b16 v[60:61], v87 offset:20480
    ds_read_b64_tr_b16 v[62:63], v87 offset:21504
    s_waitcnt lgkmcnt(0)
    ds_write_b128 v5, v[56:59] offset:4096
    ds_write_b128 v5, v[60:63] offset:5120
    s_branch L_lw_18
L_lw_18_1:
    s_cmp_lg_u32 s44, 2
    s_cbranch_scc1 L_lw_18_2
    ds_read_b64_tr_b16 a[120:121], v84 offset:20480
    ds_read_b64_tr_b16 a[122:123], v84 offset:21504
    ds_read_b64_tr_b16 a[124:125], v86 offset:20480
    ds_read_b64_tr_b16 a[126:127], v86 offset:21504
    ds_read_b64_tr_b16 v[56:57], v85 offset:20480
    ds_read_b64_tr_b16 v[58:59], v85 offset:21504
    ds_read_b64_tr_b16 v[60:61], v87 offset:20480
    ds_read_b64_tr_b16 v[62:63], v87 offset:21504
    s_waitcnt lgkmcnt(0)
    ds_write_b128 v5, v[56:59] offset:6144
    ds_write_b128 v5, v[60:63] offset:7168
    s_branch L_lw_18
L_lw_18_2:
    ds_read_b64_tr_b16 a[32:33], v84 offset:20480
    ds_read_b64_tr_b16 a[34:35], v84 offset:21504
    ds_read_b64_tr_b16 a[36:37], v86 offset:20480
    ds_read_b64_tr_b16 a[38:39], v86 offset:21504
    ds_read_b64_tr_b16 a[40:41], v85 offset:20480
    ds_read_b64_tr_b16 a[42:43], v85 offset:21504
    ds_read_b64_tr_b16 a[44:45], v87 offset:20480
    ds_read_b64_tr_b16 a[46:47], v87 offset:21504
L_lw_18:
    s_waitcnt lgkmcnt(0)
    s_waitcnt vmcnt(12)
    s_barrier
    s_cmp_lg_u32 s44, 0
    s_cbranch_scc1 L_lw_19_0
    ds_read_b64_tr_b16 v[192:193], v80 offset:0
    ds_read_b64_tr_b16 v[194:195], v80 offset:1024
    ds_read_b64_tr_b16 v[196:197], v80 offset:8192
    ds_read_b64_tr_b16 v[198:199], v80 offset:9216
    ds_read_b64_tr_b16 v[200:201], v81 offset:0
    ds_read_b64_tr_b16 v[202:203], v81 offset:1024
    ds_read_b64_tr_b16 v[204:205], v81 offset:8192
    ds_read_b64_tr_b16 v[206:207], v81 offset:9216
    s_branch L_lw_19
L_lw_19_0:
    s_cmp_lg_u32 s44, 1
    s_cbranch_scc1 L_lw_19_1
    ds_read_b64_tr_b16 a[240:241], v80 offset:0
    ds_read_b64_tr_b16 a[242:243], v80 offset:1024
    ds_read_b64_tr_b16 a[244:245], v80 offset:8192
    ds_read_b64_tr_b16 a[246:247], v80 offset:9216
    ds_read_b64_tr_b16 v[56:57], v81 offset:0
    ds_read_b64_tr_b16 v[58:59], v81 offset:1024
    ds_read_b64_tr_b16 v[60:61], v81 offset:8192
    ds_read_b64_tr_b16 v[62:63], v81 offset:9216
    s_waitcnt lgkmcnt(0)
    ds_write_b128 v5, v[56:59] offset:10240
    ds_write_b128 v5, v[60:63] offset:11264
    s_branch L_lw_19
L_lw_19_1:
    s_cmp_lg_u32 s44, 2
    s_cbranch_scc1 L_lw_19_2
    ds_read_b64_tr_b16 a[144:145], v80 offset:0
    ds_read_b64_tr_b16 a[146:147], v80 offset:1024
    ds_read_b64_tr_b16 a[148:149], v80 offset:8192
    ds_read_b64_tr_b16 a[150:151], v80 offset:9216
    ds_read_b64_tr_b16 v[56:57], v81 offset:0
    ds_read_b64_tr_b16 v[58:59], v81 offset:1024
    ds_read_b64_tr_b16 v[60:61], v81 offset:8192
    ds_read_b64_tr_b16 v[62:63], v81 offset:9216
    s_waitcnt lgkmcnt(0)
    ds_write_b128 v5, v[56:59] offset:12288
    ds_write_b128 v5, v[60:63] offset:13312
    s_branch L_lw_19
L_lw_19_2:
    ds_read_b64_tr_b16 a[64:65], v80 offset:0
    ds_read_b64_tr_b16 a[66:67], v80 offset:1024
    ds_read_b64_tr_b16 a[68:69], v80 offset:8192
    ds_read_b64_tr_b16 a[70:71], v80 offset:9216
    ds_read_b64_tr_b16 v[56:57], v81 offset:0
    ds_read_b64_tr_b16 v[58:59], v81 offset:1024
    ds_read_b64_tr_b16 v[60:61], v81 offset:8192
    ds_read_b64_tr_b16 v[62:63], v81 offset:9216
    s_waitcnt lgkmcnt(0)
    ds_write_b128 v5, v[56:59] offset:8192
    ds_write_b128 v5, v[60:63] offset:9216
L_lw_19:
    s_waitcnt lgkmcnt(0)
    s_waitcnt vmcnt(8)
    s_barrier
    s_add_u32 s79, s41, 2
    s_and_b32 s79, s79, 3
    s_lshl_b32 s79, s79, 19
    s_add_u32 s79, s79, s47
    s_add_u32 s46, s79, 0x0
    s_add_u32 m0, s48, 0
    s_nop 0
    buffer_load_dwordx4 v82, s[28:31], s46 offen  lds
    s_add_u32 s46, s79, 0x20000
    s_add_u32 m0, s48, 4096
    s_nop 0
    buffer_load_dwordx4 v82, s[28:31], s46 offen  lds
    s_add_u32 s46, s79, 0x40000
    s_add_u32 m0, s48, 8192
    s_nop 0
    buffer_load_dwordx4 v82, s[28:31], s46 offen  lds
    s_add_u32 s46, s79, 0x60000
    s_add_u32 m0, s48, 12288
    s_nop 0
    buffer_load_dwordx4 v82, s[28:31], s46 offen  lds
    s_cmp_lg_u32 s44, 0
    s_cbranch_scc1 L_lw_20_0
    ds_read_b64_tr_b16 v[224:225], v80 offset:16384
    ds_read_b64_tr_b16 v[226:227], v80 offset:17408
    ds_read_b64_tr_b16 v[228:229], v80 offset:24576
    ds_read_b64_tr_b16 v[230:231], v80 offset:25600
    ds_read_b64_tr_b16 v[232:233], v81 offset:16384
    ds_read_b64_tr_b16 v[234:235], v81 offset:17408
    ds_read_b64_tr_b16 v[236:237], v81 offset:24576
    ds_read_b64_tr_b16 v[238:239], v81 offset:25600
    s_branch L_lw_20
L_lw_20_0:
    s_cmp_lg_u32 s44, 1
    s_cbranch_scc1 L_lw_20_1
    ds_read_b64_tr_b16 v[104:105], v80 offset:16384
    ds_read_b64_tr_b16 v[106:107], v80 offset:17408
    ds_read_b64_tr_b16 v[108:109], v80 offset:24576
    ds_read_b64_tr_b16 v[110:111], v80 offset:25600
    ds_read_b64_tr_b16 v[56:57], v81 offset:16384
    ds_read_b64_tr_b16 v[58:59], v81 offset:17408
    ds_read_b64_tr_b16 v[60:61], v81 offset:24576
    ds_read_b64_tr_b16 v[62:63], v81 offset:25600
    s_waitcnt lgkmcnt(0)
    ds_write_b128 v5, v[56:59] offset:16384
    ds_write_b128 v5, v[60:63] offset:17408
    s_branch L_lw_20
L_lw_20_1:
    s_cmp_lg_u32 s44, 2
    s_cbranch_scc1 L_lw_20_2
    ds_read_b64_tr_b16 a[168:169], v80 offset:16384
    ds_read_b64_tr_b16 a[170:171], v80 offset:17408
    ds_read_b64_tr_b16 a[172:173], v80 offset:24576
    ds_read_b64_tr_b16 a[174:175], v80 offset:25600
    ds_read_b64_tr_b16 v[56:57], v81 offset:16384
    ds_read_b64_tr_b16 v[58:59], v81 offset:17408
    ds_read_b64_tr_b16 v[60:61], v81 offset:24576
    ds_read_b64_tr_b16 v[62:63], v81 offset:25600
    s_waitcnt lgkmcnt(0)
    ds_write_b128 v5, v[56:59] offset:18432
    ds_write_b128 v5, v[60:63] offset:19456
    s_branch L_lw_20
L_lw_20_2:
    ds_read_b64_tr_b16 a[80:81], v80 offset:16384
    ds_read_b64_tr_b16 a[82:83], v80 offset:17408
    ds_read_b64_tr_b16 a[84:85], v80 offset:24576
    ds_read_b64_tr_b16 a[86:87], v80 offset:25600
    ds_read_b64_tr_b16 v[56:57], v81 offset:16384
    ds_read_b64_tr_b16 v[58:59], v81 offset:17408
    ds_read_b64_tr_b16 v[60:61], v81 offset:24576
    ds_read_b64_tr_b16 v[62:63], v81 offset:25600
    s_waitcnt lgkmcnt(0)
    ds_write_b128 v5, v[56:59] offset:14336
    ds_write_b128 v5, v[60:63] offset:15360
L_lw_20:
    s_waitcnt lgkmcnt(0)
    s_waitcnt vmcnt(8)
    s_barrier
    s_add_u32 s79, s41, 3
    s_and_b32 s79, s79, 3
    s_lshl_b32 s79, s79, 19
    s_add_u32 s79, s79, s47
    s_add_u32 s46, s79, 0x0
    s_add_u32 m0, s48, 16384
    s_nop 0
    buffer_load_dwordx4 v82, s[28:31], s46 offen  lds
    s_add_u32 s46, s79, 0x20000
    s_add_u32 m0, s48, 20480
    s_nop 0
    buffer_load_dwordx4 v82, s[28:31], s46 offen  lds
    s_add_u32 s46, s79, 0x40000
    s_add_u32 m0, s48, 24576
    s_nop 0
    buffer_load_dwordx4 v82, s[28:31], s46 offen  lds
    s_add_u32 s46, s79, 0x60000
    s_add_u32 m0, s48, 28672
    s_nop 0
    buffer_load_dwordx4 v82, s[28:31], s46 offen  lds
    s_cmp_lg_u32 s44, 0
    s_cbranch_scc1 L_lw_21_0
    ds_read_b64_tr_b16 a[16:17], v80 offset:32768
    ds_read_b64_tr_b16 a[18:19], v80 offset:33792
    ds_read_b64_tr_b16 a[20:21], v80 offset:40960
    ds_read_b64_tr_b16 a[22:23], v80 offset:41984
    ds_read_b64_tr_b16 a[24:25], v81 offset:32768
    ds_read_b64_tr_b16 a[26:27], v81 offset:33792
    ds_read_b64_tr_b16 a[28:29], v81 offset:40960
    ds_read_b64_tr_b16 a[30:31], v81 offset:41984
    s_branch L_lw_21
L_lw_21_0:
    s_cmp_lg_u32 s44, 1
    s_cbranch_scc1 L_lw_21_1
    ds_read_b64_tr_b16 v[144:145], v80 offset:32768
    ds_read_b64_tr_b16 v[146:147], v80 offset:33792
    ds_read_b64_tr_b16 v[148:149], v80 offset:40960
    ds_read_b64_tr_b16 v[150:151], v80 offset:41984
    ds_read_b64_tr_b16 v[152:153], v81 offset:32768
    ds_read_b64_tr_b16 v[154:155], v81 offset:33792
    ds_read_b64_tr_b16 v[156:157], v81 offset:40960
    ds_read_b64_tr_b16 v[158:159], v81 offset:41984
    s_branch L_lw_21
L_lw_21_1:
    s_cmp_lg_u32 s44, 2
    s_cbranch_scc1 L_lw_21_2
    ds_read_b64_tr_b16 a[200:201], v80 offset:32768
    ds_read_b64_tr_b16 a[202:203], v80 offset:33792
    ds_read_b64_tr_b16 a[204:205], v80 offset:40960
    ds_read_b64_tr_b16 a[206:207], v80 offset:41984
    ds_read_b64_tr_b16 a[208:209], v81 offset:32768
    ds_read_b64_tr_b16 a[210:211], v81 offset:33792
    ds_read_b64_tr_b16 a[212:213], v81 offset:40960
    ds_read_b64_tr_b16 a[214:215], v81 offset:41984
    s_branch L_lw_21
L_lw_21_2:
    ds_read_b64_tr_b16 a[104:105], v80 offset:32768
    ds_read_b64_tr_b16 a[106:107], v80 offset:33792
    ds_read_b64_tr_b16 a[108:109], v80 offset:40960
    ds_read_b64_tr_b16 a[110:111], v80 offset:41984
    ds_read_b64_tr_b16 a[112:113], v81 offset:32768
    ds_read_b64_tr_b16 a[114:115], v81 offset:33792
    ds_read_b64_tr_b16 a[116:117], v81 offset:40960
    ds_read_b64_tr_b16 a[118:119], v81 offset:41984
L_lw_21:
    s_waitcnt lgkmcnt(0)
    s_waitcnt vmcnt(8)
    s_barrier
    s_add_u32 s79, s41, 4
    s_and_b32 s79, s79, 3
    s_lshl_b32 s79, s79, 19
    s_add_u32 s79, s79, s47
    s_add_u32 s46, s79, 0x200000
    s_add_u32 m0, s48, 32768
    s_nop 0
    buffer_load_dwordx4 v82, s[28:31], s46 offen  lds
    s_add_u32 s46, s79, 0x220000
    s_add_u32 m0, s48, 36864
    s_nop 0
    buffer_load_dwordx4 v82, s[28:31], s46 offen  lds
    s_add_u32 s46, s79, 0x240000
    s_add_u32 m0, s48, 40960
    s_nop 0
    buffer_load_dwordx4 v82, s[28:31], s46 offen  lds
    s_add_u32 s46, s79, 0x260000
    s_add_u32 m0, s48, 45056
    s_nop 0
    buffer_load_dwordx4 v82, s[28:31], s46 offen  lds
    s_cmp_lg_u32 s44, 0
    s_cbranch_scc1 L_lw_22_0
    ds_read_b64_tr_b16 a[48:49], v80 offset:49152
    ds_read_b64_tr_b16 a[50:51], v80 offset:50176
    ds_read_b64_tr_b16 a[52:53], v80 offset:57344
    ds_read_b64_tr_b16 a[54:55], v80 offset:58368
    ds_read_b64_tr_b16 a[56:57], v81 offset:49152
    ds_read_b64_tr_b16 a[58:59], v81 offset:50176
    ds_read_b64_tr_b16 a[60:61], v81 offset:57344
    ds_read_b64_tr_b16 a[62:63], v81 offset:58368
    s_branch L_lw_22
L_lw_22_0:
    s_cmp_lg_u32 s44, 1
    s_cbranch_scc1 L_lw_22_1
    ds_read_b64_tr_b16 v[176:177], v80 offset:49152
    ds_read_b64_tr_b16 v[178:179], v80 offset:50176
    ds_read_b64_tr_b16 v[180:181], v80 offset:57344
    ds_read_b64_tr_b16 v[182:183], v80 offset:58368
    ds_read_b64_tr_b16 v[184:185], v81 offset:49152
    ds_read_b64_tr_b16 v[186:187], v81 offset:50176
    ds_read_b64_tr_b16 v[188:189], v81 offset:57344
    ds_read_b64_tr_b16 v[190:191], v81 offset:58368
    s_branch L_lw_22
L_lw_22_1:
    s_cmp_lg_u32 s44, 2
    s_cbranch_scc1 L_lw_22_2
    ds_read_b64_tr_b16 a[224:225], v80 offset:49152
    ds_read_b64_tr_b16 a[226:227], v80 offset:50176
    ds_read_b64_tr_b16 a[228:229], v80 offset:57344
    ds_read_b64_tr_b16 a[230:231], v80 offset:58368
    ds_read_b64_tr_b16 a[232:233], v81 offset:49152
    ds_read_b64_tr_b16 a[234:235], v81 offset:50176
    ds_read_b64_tr_b16 a[236:237], v81 offset:57344
    ds_read_b64_tr_b16 a[238:239], v81 offset:58368
    s_branch L_lw_22
L_lw_22_2:
    ds_read_b64_tr_b16 a[128:129], v80 offset:49152
    ds_read_b64_tr_b16 a[130:131], v80 offset:50176
    ds_read_b64_tr_b16 a[132:133], v80 offset:57344
    ds_read_b64_tr_b16 a[134:135], v80 offset:58368
    ds_read_b64_tr_b16 a[136:137], v81 offset:49152
    ds_read_b64_tr_b16 a[138:139], v81 offset:50176
    ds_read_b64_tr_b16 a[140:141], v81 offset:57344
    ds_read_b64_tr_b16 a[142:143], v81 offset:58368
L_lw_22:
    s_waitcnt lgkmcnt(0)
    s_waitcnt vmcnt(8)
    s_barrier
    s_add_u32 s79, s41, 5
    s_and_b32 s79, s79, 3
    s_lshl_b32 s79, s79, 19
    s_add_u32 s79, s79, s47
    s_add_u32 s46, s79, 0x200000
    s_add_u32 m0, s48, 49152
    s_nop 0
    buffer_load_dwordx4 v82, s[28:31], s46 offen  lds
    s_add_u32 s46, s79, 0x220000
    s_add_u32 m0, s48, 53248
    s_nop 0
    buffer_load_dwordx4 v82, s[28:31], s46 offen  lds
    s_add_u32 s46, s79, 0x240000
    s_add_u32 m0, s48, 57344
    s_nop 0
    buffer_load_dwordx4 v82, s[28:31], s46 offen  lds
    s_add_u32 s46, s79, 0x260000
    s_add_u32 m0, s48, 61440
    s_nop 0
    buffer_load_dwordx4 v82, s[28:31], s46 offen  lds
    s_cmp_lg_u32 s44, 0
    s_cbranch_scc1 L_lw_23_0
    ds_read_b64_tr_b16 a[72:73], v80 offset:0
    ds_read_b64_tr_b16 a[74:75], v80 offset:1024
    ds_read_b64_tr_b16 a[76:77], v80 offset:8192
    ds_read_b64_tr_b16 a[78:79], v80 offset:9216
    ds_read_b64_tr_b16 v[56:57], v81 offset:0
    ds_read_b64_tr_b16 v[58:59], v81 offset:1024
    ds_read_b64_tr_b16 v[60:61], v81 offset:8192
    ds_read_b64_tr_b16 v[62:63], v81 offset:9216
    s_waitcnt lgkmcnt(0)
    ds_write_b128 v5, v[56:59] offset:20480
    ds_write_b128 v5, v[60:63] offset:21504
    s_branch L_lw_23
L_lw_23_0:
    s_cmp_lg_u32 s44, 1
    s_cbranch_scc1 L_lw_23_1
    ds_read_b64_tr_b16 v[208:209], v80 offset:0
    ds_read_b64_tr_b16 v[210:211], v80 offset:1024
    ds_read_b64_tr_b16 v[212:213], v80 offset:8192
    ds_read_b64_tr_b16 v[214:215], v80 offset:9216
    ds_read_b64_tr_b16 v[216:217], v81 offset:0
    ds_read_b64_tr_b16 v[218:219], v81 offset:1024
    ds_read_b64_tr_b16 v[220:221], v81 offset:8192
    ds_read_b64_tr_b16 v[222:223], v81 offset:9216
    s_branch L_lw_23
L_lw_23_1:
    s_cmp_lg_u32 s44, 2
    s_cbranch_scc1 L_lw_23_2
    ds_read_b64_tr_b16 a[248:249], v80 offset:0
    ds_read_b64_tr_b16 a[250:251], v80 offset:1024
    ds_read_b64_tr_b16 a[252:253], v80 offset:8192
    ds_read_b64_tr_b16 a[254:255], v80 offset:9216
    ds_read_b64_tr_b16 v[96:97], v81 offset:0
    ds_read_b64_tr_b16 v[98:99], v81 offset:1024
    ds_read_b64_tr_b16 v[100:101], v81 offset:8192
    ds_read_b64_tr_b16 v[102:103], v81 offset:9216
    s_branch L_lw_23
L_lw_23_2:
    ds_read_b64_tr_b16 a[152:153], v80 offset:0
    ds_read_b64_tr_b16 a[154:155], v80 offset:1024
    ds_read_b64_tr_b16 a[156:157], v80 offset:8192
    ds_read_b64_tr_b16 a[158:159], v80 offset:9216
    ds_read_b64_tr_b16 a[160:161], v81 offset:0
    ds_read_b64_tr_b16 a[162:163], v81 offset:1024
    ds_read_b64_tr_b16 a[164:165], v81 offset:8192
    ds_read_b64_tr_b16 a[166:167], v81 offset:9216
L_lw_23:
    s_waitcnt lgkmcnt(0)
    s_waitcnt vmcnt(8)
    s_barrier
    s_add_u32 s79, s41, 6
    s_and_b32 s79, s79, 3
    s_lshl_b32 s79, s79, 19
    s_add_u32 s79, s79, s47
    s_add_u32 s46, s79, 0x200000
    s_add_u32 m0, s48, 0
    s_nop 0
    buffer_load_dwordx4 v82, s[28:31], s46 offen  lds
    s_add_u32 s46, s79, 0x220000
    s_add_u32 m0, s48, 4096
    s_nop 0
    buffer_load_dwordx4 v82, s[28:31], s46 offen  lds
    s_add_u32 s46, s79, 0x240000
    s_add_u32 m0, s48, 8192
    s_nop 0
    buffer_load_dwordx4 v82, s[28:31], s46 offen  lds
    s_add_u32 s46, s79, 0x260000
    s_add_u32 m0, s48, 12288
    s_nop 0
    buffer_load_dwordx4 v82, s[28:31], s46 offen  lds
    s_cmp_lg_u32 s44, 0
    s_cbranch_scc1 L_lw_24_0
    ds_read_b64_tr_b16 a[88:89], v80 offset:16384
    ds_read_b64_tr_b16 a[90:91], v80 offset:17408
    ds_read_b64_tr_b16 a[92:93], v80 offset:24576
    ds_read_b64_tr_b16 a[94:95], v80 offset:25600
    ds_read_b64_tr_b16 v[56:57], v81 offset:16384
    ds_read_b64_tr_b16 v[58:59], v81 offset:17408
    ds_read_b64_tr_b16 v[60:61], v81 offset:24576
    ds_read_b64_tr_b16 v[62:63], v81 offset:25600
    s_waitcnt lgkmcnt(0)
    ds_write_b128 v5, v[56:59] offset:22528
    ds_write_b128 v5, v[60:63] offset:23552
    s_branch L_lw_24
L_lw_24_0:
    s_cmp_lg_u32 s44, 1
    s_cbranch_scc1 L_lw_24_1
    ds_read_b64_tr_b16 v[240:241], v80 offset:16384
    ds_read_b64_tr_b16 v[242:243], v80 offset:17408
    ds_read_b64_tr_b16 v[244:245], v80 offset:24576
    ds_read_b64_tr_b16 v[246:247], v80 offset:25600
    ds_read_b64_tr_b16 v[248:249], v81 offset:16384
    ds_read_b64_tr_b16 v[250:251], v81 offset:17408
    ds_read_b64_tr_b16 v[252:253], v81 offset:24576
    ds_read_b64_tr_b16 v[254:255], v81 offset:25600
    s_branch L_lw_24
L_lw_24_1:
    s_cmp_lg_u32 s44, 2
    s_cbranch_scc1 L_lw_24_2
    ds_read_b64_tr_b16 v[112:113], v80 offset:16384
    ds_read_b64_tr_b16 v[114:115], v80 offset:17408
    ds_read_b64_tr_b16 v[116:117], v80 offset:24576
    ds_read_b64_tr_b16 v[118:119], v80 offset:25600
    ds_read_b64_tr_b16 v[120:121], v81 offset:16384
    ds_read_b64_tr_b16 v[122:123], v81 offset:17408
    ds_read_b64_tr_b16 v[124:125], v81 offset:24576
    ds_read_b64_tr_b16 v[126:127], v81 offset:25600
    s_branch L_lw_24
L_lw_24_2:
    ds_read_b64_tr_b16 a[176:177], v80 offset:16384
    ds_read_b64_tr_b16 a[178:179], v80 offset:17408
    ds_read_b64_tr_b16 a[180:181], v80 offset:24576
    ds_read_b64_tr_b16 a[182:183], v80 offset:25600
    ds_read_b64_tr_b16 a[184:185], v81 offset:16384
    ds_read_b64_tr_b16 a[186:187], v81 offset:17408
    ds_read_b64_tr_b16 a[188:189], v81 offset:24576
    ds_read_b64_tr_b16 a[190:191], v81 offset:25600
L_lw_24:
    s_waitcnt lgkmcnt(0)
    s_waitcnt vmcnt(8)
    s_barrier
    s_add_u32 s79, s41, 7
    s_and_b32 s79, s79, 3
    s_lshl_b32 s79, s79, 19
    s_add_u32 s79, s79, s47
    s_add_u32 s46, s79, 0x200000
    s_add_u32 m0, s48, 16384
    s_nop 0
    buffer_load_dwordx4 v82, s[28:31], s46 offen  lds
    s_add_u32 s46, s79, 0x220000
    s_add_u32 m0, s48, 20480
    s_nop 0
    buffer_load_dwordx4 v82, s[28:31], s46 offen  lds
    s_add_u32 s46, s79, 0x240000
    s_add_u32 m0, s48, 24576
    s_nop 0
    buffer_load_dwordx4 v82, s[28:31], s46 offen  lds
    s_add_u32 s46, s79, 0x260000
    s_add_u32 m0, s48, 28672
    s_nop 0
    buffer_load_dwordx4 v82, s[28:31], s46 offen  lds
    s_cmp_lg_u32 s44, 0
    s_cbranch_scc1 L_lw_25_0
    ds_read_b64_tr_b16 a[104:105], v80 offset:32768
    ds_read_b64_tr_b16 a[106:107], v80 offset:33792
    ds_read_b64_tr_b16 a[108:109], v80 offset:40960
    ds_read_b64_tr_b16 a[110:111], v80 offset:41984
    ds_read_b64_tr_b16 a[112:113], v81 offset:32768
    ds_read_b64_tr_b16 a[114:115], v81 offset:33792
    ds_read_b64_tr_b16 a[116:117], v81 offset:40960
    ds_read_b64_tr_b16 a[118:119], v81 offset:41984
    s_branch L_lw_25
L_lw_25_0:
    s_cmp_lg_u32 s44, 1
    s_cbranch_scc1 L_lw_25_1
    ds_read_b64_tr_b16 a[16:17], v80 offset:32768
    ds_read_b64_tr_b16 a[18:19], v80 offset:33792
    ds_read_b64_tr_b16 a[20:21], v80 offset:40960
    ds_read_b64_tr_b16 a[22:23], v80 offset:41984
    ds_read_b64_tr_b16 a[24:25], v81 offset:32768
    ds_read_b64_tr_b16 a[26:27], v81 offset:33792
    ds_read_b64_tr_b16 a[28:29], v81 offset:40960
    ds_read_b64_tr_b16 a[30:31], v81 offset:41984
    s_branch L_lw_25
L_lw_25_1:
    s_cmp_lg_u32 s44, 2
    s_cbranch_scc1 L_lw_25_2
    ds_read_b64_tr_b16 v[144:145], v80 offset:32768
    ds_read_b64_tr_b16 v[146:147], v80 offset:33792
    ds_read_b64_tr_b16 v[148:149], v80 offset:40960
    ds_read_b64_tr_b16 v[150:151], v80 offset:41984
    ds_read_b64_tr_b16 v[152:153], v81 offset:32768
    ds_read_b64_tr_b16 v[154:155], v81 offset:33792
    ds_read_b64_tr_b16 v[156:157], v81 offset:40960
    ds_read_b64_tr_b16 v[158:159], v81 offset:41984
    s_branch L_lw_25
L_lw_25_2:
    ds_read_b64_tr_b16 a[200:201], v80 offset:32768
    ds_read_b64_tr_b16 a[202:203], v80 offset:33792
    ds_read_b64_tr_b16 a[204:205], v80 offset:40960
    ds_read_b64_tr_b16 a[206:207], v80 offset:41984
    ds_read_b64_tr_b16 a[208:209], v81 offset:32768
    ds_read_b64_tr_b16 a[210:211], v81 offset:33792
    ds_read_b64_tr_b16 a[212:213], v81 offset:40960
    ds_read_b64_tr_b16 a[214:215], v81 offset:41984
L_lw_25:
    s_waitcnt lgkmcnt(0)
    s_waitcnt vmcnt(8)
    s_barrier
    s_add_u32 s79, s41, 8
    s_and_b32 s79, s79, 3
    s_lshl_b32 s79, s79, 19
    s_add_u32 s79, s79, s47
    s_add_u32 s46, s79, 0x400000
    s_add_u32 m0, s48, 32768
    s_nop 0
    buffer_load_dwordx4 v82, s[28:31], s46 offen  lds
    s_add_u32 s46, s79, 0x420000
    s_add_u32 m0, s48, 36864
    s_nop 0
    buffer_load_dwordx4 v82, s[28:31], s46 offen  lds
    s_add_u32 s46, s79, 0x440000
    s_add_u32 m0, s48, 40960
    s_nop 0
    buffer_load_dwordx4 v82, s[28:31], s46 offen  lds
    s_add_u32 s46, s79, 0x460000
    s_add_u32 m0, s48, 45056
    s_nop 0
    buffer_load_dwordx4 v82, s[28:31], s46 offen  lds
    s_cmp_lg_u32 s44, 0
    s_cbranch_scc1 L_lw_26_0
    ds_read_b64_tr_b16 a[128:129], v80 offset:49152
    ds_read_b64_tr_b16 a[130:131], v80 offset:50176
    ds_read_b64_tr_b16 a[132:133], v80 offset:57344
    ds_read_b64_tr_b16 a[134:135], v80 offset:58368
    ds_read_b64_tr_b16 a[136:137], v81 offset:49152
    ds_read_b64_tr_b16 a[138:139], v81 offset:50176
    ds_read_b64_tr_b16 a[140:141], v81 offset:57344
    ds_read_b64_tr_b16 a[142:143], v81 offset:58368
    s_branch L_lw_26
L_lw_26_0:
    s_cmp_lg_u32 s44, 1
    s_cbranch_scc1 L_lw_26_1
    ds_read_b64_tr_b16 a[48:49], v80 offset:49152
    ds_read_b64_tr_b16 a[50:51], v80 offset:50176
    ds_read_b64_tr_b16 a[52:53], v80 offset:57344
    ds_read_b64_tr_b16 a[54:55], v80 offset:58368
    ds_read_b64_tr_b16 a[56:57], v81 offset:49152
    ds_read_b64_tr_b16 a[58:59], v81 offset:50176
    ds_read_b64_tr_b16 a[60:61], v81 offset:57344
    ds_read_b64_tr_b16 a[62:63], v81 offset:58368
    s_branch L_lw_26
L_lw_26_1:
    s_cmp_lg_u32 s44, 2
    s_cbranch_scc1 L_lw_26_2
    ds_read_b64_tr_b16 v[176:177], v80 offset:49152
    ds_read_b64_tr_b16 v[178:179], v80 offset:50176
    ds_read_b64_tr_b16 v[180:181], v80 offset:57344
    ds_read_b64_tr_b16 v[182:183], v80 offset:58368
    ds_read_b64_tr_b16 v[184:185], v81 offset:49152
    ds_read_b64_tr_b16 v[186:187], v81 offset:50176
    ds_read_b64_tr_b16 v[188:189], v81 offset:57344
    ds_read_b64_tr_b16 v[190:191], v81 offset:58368
    s_branch L_lw_26
L_lw_26_2:
    ds_read_b64_tr_b16 a[224:225], v80 offset:49152
    ds_read_b64_tr_b16 a[226:227], v80 offset:50176
    ds_read_b64_tr_b16 a[228:229], v80 offset:57344
    ds_read_b64_tr_b16 a[230:231], v80 offset:58368
    ds_read_b64_tr_b16 a[232:233], v81 offset:49152
    ds_read_b64_tr_b16 a[234:235], v81 offset:50176
    ds_read_b64_tr_b16 a[236:237], v81 offset:57344
    ds_read_b64_tr_b16 a[238:239], v81 offset:58368
L_lw_26:
    s_waitcnt lgkmcnt(0)
    s_waitcnt vmcnt(8)
    s_barrier
    s_add_u32 s79, s41, 9
    s_and_b32 s79, s79, 3
    s_lshl_b32 s79, s79, 19
    s_add_u32 s79, s79, s47
    s_add_u32 s46, s79, 0x400000
    s_add_u32 m0, s48, 49152
    s_nop 0
    buffer_load_dwordx4 v82, s[28:31], s46 offen  lds
    s_add_u32 s46, s79, 0x420000
    s_add_u32 m0, s48, 53248
    s_nop 0
    buffer_load_dwordx4 v82, s[28:31], s46 offen  lds
    s_add_u32 s46, s79, 0x440000
    s_add_u32 m0, s48, 57344
    s_nop 0
    buffer_load_dwordx4 v82, s[28:31], s46 offen  lds
    s_add_u32 s46, s79, 0x460000
    s_add_u32 m0, s48, 61440
    s_nop 0
    buffer_load_dwordx4 v82, s[28:31], s46 offen  lds
    s_cmp_lg_u32 s44, 0
    s_cbranch_scc1 L_lw_27_0
    ds_read_b64_tr_b16 a[152:153], v80 offset:0
    ds_read_b64_tr_b16 a[154:155], v80 offset:1024
    ds_read_b64_tr_b16 a[156:157], v80 offset:8192
    ds_read_b64_tr_b16 a[158:159], v80 offset:9216
    ds_read_b64_tr_b16 a[160:161], v81 offset:0
    ds_read_b64_tr_b16 a[162:163], v81 offset:1024
    ds_read_b64_tr_b16 a[164:165], v81 offset:8192
    ds_read_b64_tr_b16 a[166:167], v81 offset:9216
    s_branch L_lw_27
L_lw_27_0:
    s_cmp_lg_u32 s44, 1
    s_cbranch_scc1 L_lw_27_1
    ds_read_b64_tr_b16 a[72:73], v80 offset:0
    ds_read_b64_tr_b16 a[74:75], v80 offset:1024
    ds_read_b64_tr_b16 a[76:77], v80 offset:8192
    ds_read_b64_tr_b16 a[78:79], v80 offset:9216
    ds_read_b64_tr_b16 v[56:57], v81 offset:0
    ds_read_b64_tr_b16 v[58:59], v81 offset:1024
    ds_read_b64_tr_b16 v[60:61], v81 offset:8192
    ds_read_b64_tr_b16 v[62:63], v81 offset:9216
    s_waitcnt lgkmcnt(0)
    ds_write_b128 v5, v[56:59] offset:20480
    ds_write_b128 v5, v[60:63] offset:21504
    s_branch L_lw_27
L_lw_27_1:
    s_cmp_lg_u32 s44, 2
    s_cbranch_scc1 L_lw_27_2
    ds_read_b64_tr_b16 v[208:209], v80 offset:0
    ds_read_b64_tr_b16 v[210:211], v80 offset:1024
    ds_read_b64_tr_b16 v[212:213], v80 offset:8192
    ds_read_b64_tr_b16 v[214:215], v80 offset:9216
    ds_read_b64_tr_b16 v[216:217], v81 offset:0
    ds_read_b64_tr_b16 v[218:219], v81 offset:1024
    ds_read_b64_tr_b16 v[220:221], v81 offset:8192
    ds_read_b64_tr_b16 v[222:223], v81 offset:9216
    s_branch L_lw_27
L_lw_27_2:
    ds_read_b64_tr_b16 a[248:249], v80 offset:0
    ds_read_b64_tr_b16 a[250:251], v80 offset:1024
    ds_read_b64_tr_b16 a[252:253], v80 offset:8192
    ds_read_b64_tr_b16 a[254:255], v80 offset:9216
    ds_read_b64_tr_b16 v[96:97], v81 offset:0
    ds_read_b64_tr_b16 v[98:99], v81 offset:1024
    ds_read_b64_tr_b16 v[100:101], v81 offset:8192
    ds_read_b64_tr_b16 v[102:103], v81 offset:9216
L_lw_27:
    s_waitcnt lgkmcnt(0)
    s_waitcnt vmcnt(8)
    s_barrier
    s_add_u32 s79, s41, 10
    s_and_b32 s79, s79, 3
    s_lshl_b32 s79, s79, 19
    s_add_u32 s79, s79, s47
    s_add_u32 s46, s79, 0x400000
    s_add_u32 m0, s48, 0
    s_nop 0
    buffer_load_dwordx4 v82, s[28:31], s46 offen  lds
    s_add_u32 s46, s79, 0x420000
    s_add_u32 m0, s48, 4096
    s_nop 0
    buffer_load_dwordx4 v82, s[28:31], s46 offen  lds
    s_add_u32 s46, s79, 0x440000
    s_add_u32 m0, s48, 8192
    s_nop 0
    buffer_load_dwordx4 v82, s[28:31], s46 offen  lds
    s_add_u32 s46, s79, 0x460000
    s_add_u32 m0, s48, 12288
    s_nop 0
    buffer_load_dwordx4 v82, s[28:31], s46 offen  lds
    s_cmp_lg_u32 s44, 0
    s_cbranch_scc1 L_lw_28_0
    ds_read_b64_tr_b16 a[176:177], v80 offset:16384
    ds_read_b64_tr_b16 a[178:179], v80 offset:17408
    ds_read_b64_tr_b16 a[180:181], v80 offset:24576
    ds_read_b64_tr_b16 a[182:183], v80 offset:25600
    ds_read_b64_tr_b16 a[184:185], v81 offset:16384
    ds_read_b64_tr_b16 a[186:187], v81 offset:17408
    ds_read_b64_tr_b16 a[188:189], v81 offset:24576
    ds_read_b64_tr_b16 a[190:191], v81 offset:25600
    s_branch L_lw_28
L_lw_28_0:
    s_cmp_lg_u32 s44, 1
    s_cbranch_scc1 L_lw_28_1
    ds_read_b64_tr_b16 a[88:89], v80 offset:16384
    ds_read_b64_tr_b16 a[90:91], v80 offset:17408
    ds_read_b64_tr_b16 a[92:93], v80 offset:24576
    ds_read_b64_tr_b16 a[94:95], v80 offset:25600
    ds_read_b64_tr_b16 v[56:57], v81 offset:16384
    ds_read_b64_tr_b16 v[58:59], v81 offset:17408
    ds_read_b64_tr_b16 v[60:61], v81 offset:24576
    ds_read_b64_tr_b16 v[62:63], v81 offset:25600
    s_waitcnt lgkmcnt(0)
    ds_write_b128 v5, v[56:59] offset:22528
    ds_write_b128 v5, v[60:63] offset:23552
    s_branch L_lw_28
L_lw_28_1:
    s_cmp_lg_u32 s44, 2
    s_cbranch_scc1 L_lw_28_2
    ds_read_b64_tr_b16 v[240:241], v80 offset:16384
    ds_read_b64_tr_b16 v[242:243], v80 offset:17408
    ds_read_b64_tr_b16 v[244:245], v80 offset:24576
    ds_read_b64_tr_b16 v[246:247], v80 offset:25600
    ds_read_b64_tr_b16 v[248:249], v81 offset:16384
    ds_read_b64_tr_b16 v[250:251], v81 offset:17408
    ds_read_b64_tr_b16 v[252:253], v81 offset:24576
    ds_read_b64_tr_b16 v[254:255], v81 offset:25600
    s_branch L_lw_28
L_lw_28_2:
    ds_read_b64_tr_b16 v[112:113], v80 offset:16384
    ds_read_b64_tr_b16 v[114:115], v80 offset:17408
    ds_read_b64_tr_b16 v[116:117], v80 offset:24576
    ds_read_b64_tr_b16 v[118:119], v80 offset:25600
    ds_read_b64_tr_b16 v[120:121], v81 offset:16384
    ds_read_b64_tr_b16 v[122:123], v81 offset:17408
    ds_read_b64_tr_b16 v[124:125], v81 offset:24576
    ds_read_b64_tr_b16 v[126:127], v81 offset:25600
L_lw_28:
    s_waitcnt lgkmcnt(0)
    s_waitcnt vmcnt(8)
    s_barrier
    s_add_u32 s79, s41, 11
    s_and_b32 s79, s79, 3
    s_lshl_b32 s79, s79, 19
    s_add_u32 s79, s79, s47
    s_add_u32 s46, s79, 0x400000
    s_add_u32 m0, s48, 16384
    s_nop 0
    buffer_load_dwordx4 v82, s[28:31], s46 offen  lds
    s_add_u32 s46, s79, 0x420000
    s_add_u32 m0, s48, 20480
    s_nop 0
    buffer_load_dwordx4 v82, s[28:31], s46 offen  lds
    s_add_u32 s46, s79, 0x440000
    s_add_u32 m0, s48, 24576
    s_nop 0
    buffer_load_dwordx4 v82, s[28:31], s46 offen  lds
    s_add_u32 s46, s79, 0x460000
    s_add_u32 m0, s48, 28672
    s_nop 0
    buffer_load_dwordx4 v82, s[28:31], s46 offen  lds
    s_cmp_lg_u32 s44, 0
    s_cbranch_scc1 L_lw_29_0
    ds_read_b64_tr_b16 a[200:201], v80 offset:32768
    ds_read_b64_tr_b16 a[202:203], v80 offset:33792
    ds_read_b64_tr_b16 a[204:205], v80 offset:40960
    ds_read_b64_tr_b16 a[206:207], v80 offset:41984
    ds_read_b64_tr_b16 a[208:209], v81 offset:32768
    ds_read_b64_tr_b16 a[210:211], v81 offset:33792
    ds_read_b64_tr_b16 a[212:213], v81 offset:40960
    ds_read_b64_tr_b16 a[214:215], v81 offset:41984
    s_branch L_lw_29
L_lw_29_0:
    s_cmp_lg_u32 s44, 1
    s_cbranch_scc1 L_lw_29_1
    ds_read_b64_tr_b16 a[104:105], v80 offset:32768
    ds_read_b64_tr_b16 a[106:107], v80 offset:33792
    ds_read_b64_tr_b16 a[108:109], v80 offset:40960
    ds_read_b64_tr_b16 a[110:111], v80 offset:41984
    ds_read_b64_tr_b16 a[112:113], v81 offset:32768
    ds_read_b64_tr_b16 a[114:115], v81 offset:33792
    ds_read_b64_tr_b16 a[116:117], v81 offset:40960
    ds_read_b64_tr_b16 a[118:119], v81 offset:41984
    s_branch L_lw_29
L_lw_29_1:
    s_cmp_lg_u32 s44, 2
    s_cbranch_scc1 L_lw_29_2
    ds_read_b64_tr_b16 a[16:17], v80 offset:32768
    ds_read_b64_tr_b16 a[18:19], v80 offset:33792
    ds_read_b64_tr_b16 a[20:21], v80 offset:40960
    ds_read_b64_tr_b16 a[22:23], v80 offset:41984
    ds_read_b64_tr_b16 a[24:25], v81 offset:32768
    ds_read_b64_tr_b16 a[26:27], v81 offset:33792
    ds_read_b64_tr_b16 a[28:29], v81 offset:40960
    ds_read_b64_tr_b16 a[30:31], v81 offset:41984
    s_branch L_lw_29
L_lw_29_2:
    ds_read_b64_tr_b16 v[144:145], v80 offset:32768
    ds_read_b64_tr_b16 v[146:147], v80 offset:33792
    ds_read_b64_tr_b16 v[148:149], v80 offset:40960
    ds_read_b64_tr_b16 v[150:151], v80 offset:41984
    ds_read_b64_tr_b16 v[152:153], v81 offset:32768
    ds_read_b64_tr_b16 v[154:155], v81 offset:33792
    ds_read_b64_tr_b16 v[156:157], v81 offset:40960
    ds_read_b64_tr_b16 v[158:159], v81 offset:41984
L_lw_29:
    s_waitcnt lgkmcnt(0)
    s_waitcnt vmcnt(8)
    s_barrier
    s_add_u32 s79, s41, 12
    s_and_b32 s79, s79, 3
    s_lshl_b32 s79, s79, 19
    s_add_u32 s79, s79, s47
    s_add_u32 s46, s79, 0x600000
    s_add_u32 m0, s48, 32768
    s_nop 0
    buffer_load_dwordx4 v82, s[28:31], s46 offen  lds
    s_add_u32 s46, s79, 0x620000
    s_add_u32 m0, s48, 36864
    s_nop 0
    buffer_load_dwordx4 v82, s[28:31], s46 offen  lds
    s_add_u32 s46, s79, 0x640000
    s_add_u32 m0, s48, 40960
    s_nop 0
    buffer_load_dwordx4 v82, s[28:31], s46 offen  lds
    s_add_u32 s46, s79, 0x660000
    s_add_u32 m0, s48, 45056
    s_nop 0
    buffer_load_dwordx4 v82, s[28:31], s46 offen  lds
    s_cmp_lg_u32 s44, 0
    s_cbranch_scc1 L_lw_30_0
    ds_read_b64_tr_b16 a[224:225], v80 offset:49152
    ds_read_b64_tr_b16 a[226:227], v80 offset:50176
    ds_read_b64_tr_b16 a[228:229], v80 offset:57344
    ds_read_b64_tr_b16 a[230:231], v80 offset:58368
    ds_read_b64_tr_b16 a[232:233], v81 offset:49152
    ds_read_b64_tr_b16 a[234:235], v81 offset:50176
    ds_read_b64_tr_b16 a[236:237], v81 offset:57344
    ds_read_b64_tr_b16 a[238:239], v81 offset:58368
    s_branch L_lw_30
L_lw_30_0:
    s_cmp_lg_u32 s44, 1
    s_cbranch_scc1 L_lw_30_1
    ds_read_b64_tr_b16 a[128:129], v80 offset:49152
    ds_read_b64_tr_b16 a[130:131], v80 offset:50176
    ds_read_b64_tr_b16 a[132:133], v80 offset:57344
    ds_read_b64_tr_b16 a[134:135], v80 offset:58368
    ds_read_b64_tr_b16 a[136:137], v81 offset:49152
    ds_read_b64_tr_b16 a[138:139], v81 offset:50176
    ds_read_b64_tr_b16 a[140:141], v81 offset:57344
    ds_read_b64_tr_b16 a[142:143], v81 offset:58368
    s_branch L_lw_30
L_lw_30_1:
    s_cmp_lg_u32 s44, 2
    s_cbranch_scc1 L_lw_30_2
    ds_read_b64_tr_b16 a[48:49], v80 offset:49152
    ds_read_b64_tr_b16 a[50:51], v80 offset:50176
    ds_read_b64_tr_b16 a[52:53], v80 offset:57344
    ds_read_b64_tr_b16 a[54:55], v80 offset:58368
    ds_read_b64_tr_b16 a[56:57], v81 offset:49152
    ds_read_b64_tr_b16 a[58:59], v81 offset:50176
    ds_read_b64_tr_b16 a[60:61], v81 offset:57344
    ds_read_b64_tr_b16 a[62:63], v81 offset:58368
    s_branch L_lw_30
L_lw_30_2:
    ds_read_b64_tr_b16 v[176:177], v80 offset:49152
    ds_read_b64_tr_b16 v[178:179], v80 offset:50176
    ds_read_b64_tr_b16 v[180:181], v80 offset:57344
    ds_read_b64_tr_b16 v[182:183], v80 offset:58368
    ds_read_b64_tr_b16 v[184:185], v81 offset:49152
    ds_read_b64_tr_b16 v[186:187], v81 offset:50176
    ds_read_b64_tr_b16 v[188:189], v81 offset:57344
    ds_read_b64_tr_b16 v[190:191], v81 offset:58368
L_lw_30:
    s_waitcnt lgkmcnt(0)
    s_waitcnt vmcnt(8)
    s_barrier
    s_add_u32 s79, s41, 13
    s_and_b32 s79, s79, 3
    s_lshl_b32 s79, s79, 19
    s_add_u32 s79, s79, s47
    s_add_u32 s46, s79, 0x600000
    s_add_u32 m0, s48, 49152
    s_nop 0
    buffer_load_dwordx4 v82, s[28:31], s46 offen  lds
    s_add_u32 s46, s79, 0x620000
    s_add_u32 m0, s48, 53248
    s_nop 0
    buffer_load_dwordx4 v82, s[28:31], s46 offen  lds
    s_add_u32 s46, s79, 0x640000
    s_add_u32 m0, s48, 57344
    s_nop 0
    buffer_load_dwordx4 v82, s[28:31], s46 offen  lds
    s_add_u32 s46, s79, 0x660000
    s_add_u32 m0, s48, 61440
    s_nop 0
    buffer_load_dwordx4 v82, s[28:31], s46 offen  lds
    s_cmp_lg_u32 s44, 0
    s_cbranch_scc1 L_lw_31_0
    ds_read_b64_tr_b16 a[248:249], v80 offset:0
    ds_read_b64_tr_b16 a[250:251], v80 offset:1024
    ds_read_b64_tr_b16 a[252:253], v80 offset:8192
    ds_read_b64_tr_b16 a[254:255], v80 offset:9216
    ds_read_b64_tr_b16 v[96:97], v81 offset:0
    ds_read_b64_tr_b16 v[98:99], v81 offset:1024
    ds_read_b64_tr_b16 v[100:101], v81 offset:8192
    ds_read_b64_tr_b16 v[102:103], v81 offset:9216
    s_branch L_lw_31
L_lw_31_0:
    s_cmp_lg_u32 s44, 1
    s_cbranch_scc1 L_lw_31_1
    ds_read_b64_tr_b16 a[152:153], v80 offset:0
    ds_read_b64_tr_b16 a[154:155], v80 offset:1024
    ds_read_b64_tr_b16 a[156:157], v80 offset:8192
    ds_read_b64_tr_b16 a[158:159], v80 offset:9216
    ds_read_b64_tr_b16 a[160:161], v81 offset:0
    ds_read_b64_tr_b16 a[162:163], v81 offset:1024
    ds_read_b64_tr_b16 a[164:165], v81 offset:8192
    ds_read_b64_tr_b16 a[166:167], v81 offset:9216
    s_branch L_lw_31
L_lw_31_1:
    s_cmp_lg_u32 s44, 2
    s_cbranch_scc1 L_lw_31_2
    ds_read_b64_tr_b16 a[72:73], v80 offset:0
    ds_read_b64_tr_b16 a[74:75], v80 offset:1024
    ds_read_b64_tr_b16 a[76:77], v80 offset:8192
    ds_read_b64_tr_b16 a[78:79], v80 offset:9216
    ds_read_b64_tr_b16 v[56:57], v81 offset:0
    ds_read_b64_tr_b16 v[58:59], v81 offset:1024
    ds_read_b64_tr_b16 v[60:61], v81 offset:8192
    ds_read_b64_tr_b16 v[62:63], v81 offset:9216
    s_waitcnt lgkmcnt(0)
    ds_write_b128 v5, v[56:59] offset:20480
    ds_write_b128 v5, v[60:63] offset:21504
    s_branch L_lw_31
L_lw_31_2:
    ds_read_b64_tr_b16 v[208:209], v80 offset:0
    ds_read_b64_tr_b16 v[210:211], v80 offset:1024
    ds_read_b64_tr_b16 v[212:213], v80 offset:8192
    ds_read_b64_tr_b16 v[214:215], v80 offset:9216
    ds_read_b64_tr_b16 v[216:217], v81 offset:0
    ds_read_b64_tr_b16 v[218:219], v81 offset:1024
    ds_read_b64_tr_b16 v[220:221], v81 offset:8192
    ds_read_b64_tr_b16 v[222:223], v81 offset:9216
L_lw_31:
    s_waitcnt lgkmcnt(0)
    s_waitcnt vmcnt(8)
    s_barrier
    s_add_u32 s79, s41, 14
    s_and_b32 s79, s79, 3
    s_lshl_b32 s79, s79, 19
    s_add_u32 s79, s79, s47
    s_add_u32 s46, s79, 0x600000
    s_add_u32 m0, s48, 0
    s_nop 0
    buffer_load_dwordx4 v82, s[28:31], s46 offen  lds
    s_add_u32 s46, s79, 0x620000
    s_add_u32 m0, s48, 4096
    s_nop 0
    buffer_load_dwordx4 v82, s[28:31], s46 offen  lds
    s_add_u32 s46, s79, 0x640000
    s_add_u32 m0, s48, 8192
    s_nop 0
    buffer_load_dwordx4 v82, s[28:31], s46 offen  lds
    s_add_u32 s46, s79, 0x660000
    s_add_u32 m0, s48, 12288
    s_nop 0
    buffer_load_dwordx4 v82, s[28:31], s46 offen  lds
    s_cmp_lg_u32 s44, 0
    s_cbranch_scc1 L_lw_32_0
    ds_read_b64_tr_b16 v[112:113], v80 offset:16384
    ds_read_b64_tr_b16 v[114:115], v80 offset:17408
    ds_read_b64_tr_b16 v[116:117], v80 offset:24576
    ds_read_b64_tr_b16 v[118:119], v80 offset:25600
    ds_read_b64_tr_b16 v[120:121], v81 offset:16384
    ds_read_b64_tr_b16 v[122:123], v81 offset:17408
    ds_read_b64_tr_b16 v[124:125], v81 offset:24576
    ds_read_b64_tr_b16 v[126:127], v81 offset:25600
    s_branch L_lw_32
L_lw_32_0:
    s_cmp_lg_u32 s44, 1
    s_cbranch_scc1 L_lw_32_1
    ds_read_b64_tr_b16 a[176:177], v80 offset:16384
    ds_read_b64_tr_b16 a[178:179], v80 offset:17408
    ds_read_b64_tr_b16 a[180:181], v80 offset:24576
    ds_read_b64_tr_b16 a[182:183], v80 offset:25600
    ds_read_b64_tr_b16 a[184:185], v81 offset:16384
    ds_read_b64_tr_b16 a[186:187], v81 offset:17408
    ds_read_b64_tr_b16 a[188:189], v81 offset:24576
    ds_read_b64_tr_b16 a[190:191], v81 offset:25600
    s_branch L_lw_32
L_lw_32_1:
    s_cmp_lg_u32 s44, 2
    s_cbranch_scc1 L_lw_32_2
    ds_read_b64_tr_b16 a[88:89], v80 offset:16384
    ds_read_b64_tr_b16 a[90:91], v80 offset:17408
    ds_read_b64_tr_b16 a[92:93], v80 offset:24576
    ds_read_b64_tr_b16 a[94:95], v80 offset:25600
    ds_read_b64_tr_b16 v[56:57], v81 offset:16384
    ds_read_b64_tr_b16 v[58:59], v81 offset:17408
    ds_read_b64_tr_b16 v[60:61], v81 offset:24576
    ds_read_b64_tr_b16 v[62:63], v81 offset:25600
    s_waitcnt lgkmcnt(0)
    ds_write_b128 v5, v[56:59] offset:22528
    ds_write_b128 v5, v[60:63] offset:23552
    s_branch L_lw_32
L_lw_32_2:
    ds_read_b64_tr_b16 v[240:241], v80 offset:16384
    ds_read_b64_tr_b16 v[242:243], v80 offset:17408
    ds_read_b64_tr_b16 v[244:245], v80 offset:24576
    ds_read_b64_tr_b16 v[246:247], v80 offset:25600
    ds_read_b64_tr_b16 v[248:249], v81 offset:16384
    ds_read_b64_tr_b16 v[250:251], v81 offset:17408
    ds_read_b64_tr_b16 v[252:253], v81 offset:24576
    ds_read_b64_tr_b16 v[254:255], v81 offset:25600
L_lw_32:
    s_waitcnt lgkmcnt(0)
    s_waitcnt vmcnt(8)
    s_barrier
    s_add_u32 s79, s41, 15
    s_and_b32 s79, s79, 3
    s_lshl_b32 s79, s79, 19
    s_add_u32 s79, s79, s47
    s_add_u32 s46, s79, 0x600000
    s_add_u32 m0, s48, 16384
    s_nop 0
    buffer_load_dwordx4 v82, s[28:31], s46 offen  lds
    s_add_u32 s46, s79, 0x620000
    s_add_u32 m0, s48, 20480
    s_nop 0
    buffer_load_dwordx4 v82, s[28:31], s46 offen  lds
    s_add_u32 s46, s79, 0x640000
    s_add_u32 m0, s48, 24576
    s_nop 0
    buffer_load_dwordx4 v82, s[28:31], s46 offen  lds
    s_add_u32 s46, s79, 0x660000
    s_add_u32 m0, s48, 28672
    s_nop 0
    buffer_load_dwordx4 v82, s[28:31], s46 offen  lds
    v_mov_b32 v46, 0
    buffer_load_dwordx2 v[44:45], v46, s[16:19], 0 offen sc1
    s_cmp_lg_u32 s44, 0
    s_cbranch_scc1 L_lw_33_0
    ds_read_b64_tr_b16 v[144:145], v80 offset:32768
    ds_read_b64_tr_b16 v[146:147], v80 offset:33792
    ds_read_b64_tr_b16 v[148:149], v80 offset:40960
    ds_read_b64_tr_b16 v[150:151], v80 offset:41984
    ds_read_b64_tr_b16 v[152:153], v81 offset:32768
    ds_read_b64_tr_b16 v[154:155], v81 offset:33792
    ds_read_b64_tr_b16 v[156:157], v81 offset:40960
    ds_read_b64_tr_b16 v[158:159], v81 offset:41984
    s_branch L_lw_33
L_lw_33_0:
    s_cmp_lg_u32 s44, 1
    s_cbranch_scc1 L_lw_33_1
    ds_read_b64_tr_b16 a[200:201], v80 offset:32768
    ds_read_b64_tr_b16 a[202:203], v80 offset:33792
    ds_read_b64_tr_b16 a[204:205], v80 offset:40960
    ds_read_b64_tr_b16 a[206:207], v80 offset:41984
    ds_read_b64_tr_b16 a[208:209], v81 offset:32768
    ds_read_b64_tr_b16 a[210:211], v81 offset:33792
    ds_read_b64_tr_b16 a[212:213], v81 offset:40960
    ds_read_b64_tr_b16 a[214:215], v81 offset:41984
    s_branch L_lw_33
L_lw_33_1:
    s_cmp_lg_u32 s44, 2
    s_cbranch_scc1 L_lw_33_2
    ds_read_b64_tr_b16 a[104:105], v80 offset:32768
    ds_read_b64_tr_b16 a[106:107], v80 offset:33792
    ds_read_b64_tr_b16 a[108:109], v80 offset:40960
    ds_read_b64_tr_b16 a[110:111], v80 offset:41984
    ds_read_b64_tr_b16 a[112:113], v81 offset:32768
    ds_read_b64_tr_b16 a[114:115], v81 offset:33792
    ds_read_b64_tr_b16 a[116:117], v81 offset:40960
    ds_read_b64_tr_b16 a[118:119], v81 offset:41984
    s_branch L_lw_33
L_lw_33_2:
    ds_read_b64_tr_b16 a[16:17], v80 offset:32768
    ds_read_b64_tr_b16 a[18:19], v80 offset:33792
    ds_read_b64_tr_b16 a[20:21], v80 offset:40960
    ds_read_b64_tr_b16 a[22:23], v80 offset:41984
    ds_read_b64_tr_b16 a[24:25], v81 offset:32768
    ds_read_b64_tr_b16 a[26:27], v81 offset:33792
    ds_read_b64_tr_b16 a[28:29], v81 offset:40960
    ds_read_b64_tr_b16 a[30:31], v81 offset:41984
L_lw_33:
    s_waitcnt lgkmcnt(0)
    s_waitcnt vmcnt(8)
    s_barrier
    s_cmp_lg_u32 s44, 0
    s_cbranch_scc1 L_lw_34_0
    ds_read_b64_tr_b16 v[176:177], v80 offset:49152
    ds_read_b64_tr_b16 v[178:179], v80 offset:50176
    ds_read_b64_tr_b16 v[180:181], v80 offset:57344
    ds_read_b64_tr_b16 v[182:183], v80 offset:58368
    ds_read_b64_tr_b16 v[184:185], v81 offset:49152
    ds_read_b64_tr_b16 v[186:187], v81 offset:50176
    ds_read_b64_tr_b16 v[188:189], v81 offset:57344
    ds_read_b64_tr_b16 v[190:191], v81 offset:58368
    s_branch L_lw_34
L_lw_34_0:
    s_cmp_lg_u32 s44, 1
    s_cbranch_scc1 L_lw_34_1
    ds_read_b64_tr_b16 a[224:225], v80 offset:49152
    ds_read_b64_tr_b16 a[226:227], v80 offset:50176
    ds_read_b64_tr_b16 a[228:229], v80 offset:57344
    ds_read_b64_tr_b16 a[230:231], v80 offset:58368
    ds_read_b64_tr_b16 a[232:233], v81 offset:49152
    ds_read_b64_tr_b16 a[234:235], v81 offset:50176
    ds_read_b64_tr_b16 a[236:237], v81 offset:57344
    ds_read_b64_tr_b16 a[238:239], v81 offset:58368
    s_branch L_lw_34
L_lw_34_1:
    s_cmp_lg_u32 s44, 2
    s_cbranch_scc1 L_lw_34_2
    ds_read_b64_tr_b16 a[128:129], v80 offset:49152
    ds_read_b64_tr_b16 a[130:131], v80 offset:50176
    ds_read_b64_tr_b16 a[132:133], v80 offset:57344
    ds_read_b64_tr_b16 a[134:135], v80 offset:58368
    ds_read_b64_tr_b16 a[136:137], v81 offset:49152
    ds_read_b64_tr_b16 a[138:139], v81 offset:50176
    ds_read_b64_tr_b16 a[140:141], v81 offset:57344
    ds_read_b64_tr_b16 a[142:143], v81 offset:58368
    s_branch L_lw_34
L_lw_34_2:
    ds_read_b64_tr_b16 a[48:49], v80 offset:49152
    ds_read_b64_tr_b16 a[50:51], v80 offset:50176
    ds_read_b64_tr_b16 a[52:53], v80 offset:57344
    ds_read_b64_tr_b16 a[54:55], v80 offset:58368
    ds_read_b64_tr_b16 a[56:57], v81 offset:49152
    ds_read_b64_tr_b16 a[58:59], v81 offset:50176
    ds_read_b64_tr_b16 a[60:61], v81 offset:57344
    ds_read_b64_tr_b16 a[62:63], v81 offset:58368
L_lw_34:
    s_waitcnt lgkmcnt(0)
    s_waitcnt vmcnt(4)
    s_barrier
    s_cmp_lg_u32 s44, 0
    s_cbranch_scc1 L_lw_35_0
    ds_read_b64_tr_b16 v[208:209], v80 offset:0
    ds_read_b64_tr_b16 v[210:211], v80 offset:1024
    ds_read_b64_tr_b16 v[212:213], v80 offset:8192
    ds_read_b64_tr_b16 v[214:215], v80 offset:9216
    ds_read_b64_tr_b16 v[216:217], v81 offset:0
    ds_read_b64_tr_b16 v[218:219], v81 offset:1024
    ds_read_b64_tr_b16 v[220:221], v81 offset:8192
    ds_read_b64_tr_b16 v[222:223], v81 offset:9216
    s_branch L_lw_35
L_lw_35_0:
    s_cmp_lg_u32 s44, 1
    s_cbranch_scc1 L_lw_35_1
    ds_read_b64_tr_b16 a[248:249], v80 offset:0
    ds_read_b64_tr_b16 a[250:251], v80 offset:1024
    ds_read_b64_tr_b16 a[252:253], v80 offset:8192
    ds_read_b64_tr_b16 a[254:255], v80 offset:9216
    ds_read_b64_tr_b16 v[96:97], v81 offset:0
    ds_read_b64_tr_b16 v[98:99], v81 offset:1024
    ds_read_b64_tr_b16 v[100:101], v81 offset:8192
    ds_read_b64_tr_b16 v[102:103], v81 offset:9216
    s_branch L_lw_35
L_lw_35_1:
    s_cmp_lg_u32 s44, 2
    s_cbranch_scc1 L_lw_35_2
    ds_read_b64_tr_b16 a[152:153], v80 offset:0
    ds_read_b64_tr_b16 a[154:155], v80 offset:1024
    ds_read_b64_tr_b16 a[156:157], v80 offset:8192
    ds_read_b64_tr_b16 a[158:159], v80 offset:9216
    ds_read_b64_tr_b16 a[160:161], v81 offset:0
    ds_read_b64_tr_b16 a[162:163], v81 offset:1024
    ds_read_b64_tr_b16 a[164:165], v81 offset:8192
    ds_read_b64_tr_b16 a[166:167], v81 offset:9216
    s_branch L_lw_35
L_lw_35_2:
    ds_read_b64_tr_b16 a[72:73], v80 offset:0
    ds_read_b64_tr_b16 a[74:75], v80 offset:1024
    ds_read_b64_tr_b16 a[76:77], v80 offset:8192
    ds_read_b64_tr_b16 a[78:79], v80 offset:9216
    ds_read_b64_tr_b16 v[56:57], v81 offset:0
    ds_read_b64_tr_b16 v[58:59], v81 offset:1024
    ds_read_b64_tr_b16 v[60:61], v81 offset:8192
    ds_read_b64_tr_b16 v[62:63], v81 offset:9216
    s_waitcnt lgkmcnt(0)
    ds_write_b128 v5, v[56:59] offset:20480
    ds_write_b128 v5, v[60:63] offset:21504
L_lw_35:
    s_waitcnt lgkmcnt(0)
    s_waitcnt vmcnt(0)
    s_barrier
    s_add_u32 s63, s62, 0
    buffer_load_dword v47, v17, s[12:15], s63 offen sc1
    s_add_u32 s63, s62, 32768
    buffer_load_dword v47, v17, s[12:15], s63 offen sc1
    s_add_u32 s63, s62, 65536
    buffer_load_dword v47, v17, s[12:15], s63 offen sc1
    s_add_u32 s63, s62, 98304
    buffer_load_dword v47, v17, s[12:15], s63 offen sc1
    buffer_load_dword v47, v20, s[12:15], 0 offen sc1
    s_cmp_lg_u32 s44, 0
    s_cbranch_scc1 L_lw_36_0
    ds_read_b64_tr_b16 v[240:241], v80 offset:16384
    ds_read_b64_tr_b16 v[242:243], v80 offset:17408
    ds_read_b64_tr_b16 v[244:245], v80 offset:24576
    ds_read_b64_tr_b16 v[246:247], v80 offset:25600
    ds_read_b64_tr_b16 v[248:249], v81 offset:16384
    ds_read_b64_tr_b16 v[250:251], v81 offset:17408
    ds_read_b64_tr_b16 v[252:253], v81 offset:24576
    ds_read_b64_tr_b16 v[254:255], v81 offset:25600
    s_branch L_lw_36
L_lw_36_0:
    s_cmp_lg_u32 s44, 1
    s_cbranch_scc1 L_lw_36_1
    ds_read_b64_tr_b16 v[112:113], v80 offset:16384
    ds_read_b64_tr_b16 v[114:115], v80 offset:17408
    ds_read_b64_tr_b16 v[116:117], v80 offset:24576
    ds_read_b64_tr_b16 v[118:119], v80 offset:25600
    ds_read_b64_tr_b16 v[120:121], v81 offset:16384
    ds_read_b64_tr_b16 v[122:123], v81 offset:17408
    ds_read_b64_tr_b16 v[124:125], v81 offset:24576
    ds_read_b64_tr_b16 v[126:127], v81 offset:25600
    s_branch L_lw_36
L_lw_36_1:
    s_cmp_lg_u32 s44, 2
    s_cbranch_scc1 L_lw_36_2
    ds_read_b64_tr_b16 a[176:177], v80 offset:16384
    ds_read_b64_tr_b16 a[178:179], v80 offset:17408
    ds_read_b64_tr_b16 a[180:181], v80 offset:24576
    ds_read_b64_tr_b16 a[182:183], v80 offset:25600
    ds_read_b64_tr_b16 a[184:185], v81 offset:16384
    ds_read_b64_tr_b16 a[186:187], v81 offset:17408
    ds_read_b64_tr_b16 a[188:189], v81 offset:24576
    ds_read_b64_tr_b16 a[190:191], v81 offset:25600
    s_branch L_lw_36
L_lw_36_2:
    ds_read_b64_tr_b16 a[88:89], v80 offset:16384
    ds_read_b64_tr_b16 a[90:91], v80 offset:17408
    ds_read_b64_tr_b16 a[92:93], v80 offset:24576
    ds_read_b64_tr_b16 a[94:95], v80 offset:25600
    ds_read_b64_tr_b16 v[56:57], v81 offset:16384
    ds_read_b64_tr_b16 v[58:59], v81 offset:17408
    ds_read_b64_tr_b16 v[60:61], v81 offset:24576
    ds_read_b64_tr_b16 v[62:63], v81 offset:25600
    s_waitcnt lgkmcnt(0)
    ds_write_b128 v5, v[56:59] offset:22528
    ds_write_b128 v5, v[60:63] offset:23552
L_lw_36:
    s_waitcnt lgkmcnt(0)
    s_barrier
    v_and_b32 v63, 15, v1
    v_lshrrev_b32 v64, 4, v1
    v_lshrrev_b32 v65, 5, v1
    v_lshlrev_b32 v65, 4, v65
    v_add_u32 v65, v65, v63
    v_lshlrev_b32 v65, 4, v65
    v_and_b32 v66, 1, v64
    v_lshlrev_b32 v66, 3, v66
    s_lshl_b32 s45, s44, 9
    s_add_u32 s45, s45, 53248
    v_add3_u32 v6, v65, v66, s45
    v_bfe_u32 v65, v1, 2, 2
    v_lshlrev_b32 v66, 3, v64
    v_add_u32 v65, v65, v66
    v_lshlrev_b32 v65, 4, v65
    v_and_b32 v66, 1, v1
    v_lshlrev_b32 v66, 3, v66
    v_add_u32 v65, v65, v66
    v_add_u32 v7, 53248, v65
    v_bfe_u32 v65, v1, 2, 1
    v_mul_u32_u24 v65, 520, v65
    v_bfe_u32 v66, v1, 3, 1
    v_lshlrev_b32 v14, 7, v66
    v_and_b32 v67, 3, v1
    v_lshlrev_b32 v67, 5, v67
    v_add3_u32 v65, v65, v14, v67
    v_lshlrev_b32 v66, 1, v66
    v_xor_b32 v66, v66, v64
    v_lshlrev_b32 v66, 3, v66
    s_mul_i32 s45, s44, 1040
    s_add_u32 s45, s45, 55296
    v_add3_u32 v18, v65, v66, s45
    v_lshlrev_b32 v14, 3, v1
    v_and_b32 v65, 16, v1
    v_xor_b32 v14, v14, v65
    v_lshlrev_b32 v16, 3, v1
    v_lshlrev_b32 v8, 4, v1
    v_lshrrev_b32 v65, 2, v1
    v_lshlrev_b32 v65, 4, v65
    v_and_b32 v66, 1, v1
    v_lshlrev_b32 v66, 3, v66
    s_lshl_b32 s45, s44, 11
    v_add3_u32 v65, v65, v66, s45
    v_and_b32 v66, 2, v1
    v_lshlrev_b32 v66, 7, v66
    v_add_u32 v9, v65, v66
    s_lshl_b32 s45, s43, 11
    s_lshl_b32 s46, s44, 9
    s_add_u32 s45, s45, s46
    s_add_u32 s51, s45, 0x7020000
    s_lshl_b32 s63, s43, 19
    s_add_u32 s63, s63, 0x3000000
    s_mov_b32 s50, 0
    s_lshl_b32 s64, s44, 11
    s_sub_u32 s63, s63, s64
    s_add_u32 s64, s64, 16384
    s_add_u32 s65, s64, 8192
    s_lshl_b32 s66, s43, 12
    s_add_u32 s66, s66, 0x1000000
    s_mov_b32 s69, 16384
    s_mov_b32 s52, 0x3e0293ee
    s_mov_b32 s53, 0x41800000
    s_lshl_b32 s45, s40, 4
    s_add_u32 s45, s45, s41
    s_lshl_b32 s45, s45, 8
    s_lshl_b32 s46, s44, 6
    s_add_u32 s45, s45, s46
    s_add_u32 s45, s45, 0x7082000
    v_and_b32 v19, 15, v1
    v_lshlrev_b32 v19, 2, v19
    v_add_u32 v19, s45, v19
    s_mov_b32 s70, 0
    v_mov_b32 v41, 0
    s_branch L_hw_37_c
L_hw_37:
    buffer_load_dwordx2 v[44:45], v41, s[16:19], 0 offen sc1
    s_add_u32 s70, s70, 1
    s_cmp_ge_u32 s70, 0x100000
    s_cbranch_scc1 L_c_done_1
L_hw_37_c:
    s_waitcnt vmcnt(0)
    v_readfirstlane_b32 s45, v44
    v_readfirstlane_b32 s46, v45
    s_nop 3
    s_lshr_b32 s47, s46, 24
    s_cmp_lg_u32 s47, 64
    s_cbranch_scc1 L_hw_37
    s_lshr_b32 s68, s45, 24
    s_and_b32 s47, s45, 511
    s_mul_i32 s47, s47, s47
    s_bfe_u32 s45, s45, 0xf0009
    s_lshl_b32 s45, s45, 5
    s_sub_u32 s45, s45, s47
    s_and_b32 s47, s46, 511
    s_mul_i32 s47, s47, s47
    s_bfe_u32 s46, s46, 0xf0009
    s_lshl_b32 s46, s46, 5
    s_sub_u32 s46, s46, s47
    s_or_b32 s45, s45, s46
    s_cmp_eq_u32 s45, 0
    s_cselect_b32 s67, 1, 0
    s_mov_b32 s24, s12
    s_mov_b32 s25, s13
    s_mov_b32 s28, s12
    s_mov_b32 s29, s13
    s_cmp_eq_u32 s67, 1
    s_cselect_b32 s26, s14, 0
    s_cselect_b32 s30, 0, s14
    s_cmp_ge_u32 s68, 16
    s_cselect_b32 s68, 8192, 0
    s_mov_b32 s6, 0x11111111
    s_mov_b32 s7, 0xffaaa491
    s_mov_b32 s60, 0
    s_lshl_b32 s58, s40, 16
    s_add_u32 s58, s58, 0x7000000
    s_mov_b32 s61, s58
    s_lshl_b32 s59, s40, 17
    s_add_u32 s59, s59, 0x7040000
    s_mov_b32 s62, s59
    s_add_u32 s32, s41, 0
    s_and_b32 s32, s32, 3
    s_lshl_b32 s32, s32, 10
    s_add_u32 s33, s41, 1
    s_and_b32 s33, s33, 3
    s_lshl_b32 s33, s33, 10
    s_add_u32 s34, s41, 2
    s_and_b32 s34, s34, 3
    s_lshl_b32 s34, s34, 10
    s_add_u32 s35, s41, 3
    s_and_b32 s35, s35, 3
    s_lshl_b32 s35, s35, 10
    s_mov_b32 s47, 0
    s_cmp_lt_u32 s47, s50
    s_cbranch_scc1 L_kv_rdy_38
    s_lshl_b32 s45, s43, 7
    s_add_u32 s45, s45, 0x10014
    v_mov_b32 v0, 0
    s_mov_b32 s70, 0
L_kv_rdy_38_p:
    buffer_load_dwordx2 v[10:11], v0, s[12:15], s45 offen sc1
    s_add_u32 s70, s70, 1
    s_cmp_ge_u32 s70, 0x200000
    s_cbranch_scc1 L_c_done_1
    s_waitcnt vmcnt(0)
    v_min_u32 v10, v10, v11
    s_nop 0
    v_readfirstlane_b32 s50, v10
    s_nop 3
    s_cmp_lt_u32 s47, s50
    s_cbranch_scc1 L_kv_rdy_38
    s_sleep 2
    s_branch L_kv_rdy_38_p
L_kv_rdy_38:
    s_mov_b32 m0, s64
    s_add_u32 s46, s63, 0x1000000
    buffer_load_dwordx4 v3, s[12:15], s63 offen sc1 lds
    buffer_load_dwordx4 v3, s[12:15], s63 offen offset:1024 sc1 lds
    s_mov_b32 m0, s65
    s_add_u32 s63, s63, 8192
    buffer_load_dwordx4 v3, s[12:15], s46 offen sc1 lds
    buffer_load_dwordx4 v3, s[12:15], s46 offen offset:1024 sc1 lds
    s_add_u32 s64, s64, 16384
    s_add_u32 s65, s65, 16384
    s_cmp_lg_u32 s44, 0
    s_cbranch_scc1 L_ld_39
    v_mov_b32 v40, 1
    v_mov_b32 v41, 127360
    s_mov_b64 exec, 1
    buffer_atomic_add v40, v41, s[12:15], 0 offen sc1
    s_mov_b64 exec, -1
L_ld_39:
L_q_loop_40:
    ds_read_b128 v[56:59], v5 offset:8192
    ds_read_b128 v[60:63], v5 offset:9216
    ds_read_b128 v[64:67], v5 offset:20480
    ds_read_b128 v[68:71], v5 offset:21504
    ds_read_b128 v[72:75], v5 offset:14336
    ds_read_b128 v[76:79], v5 offset:15360
    ds_read_b128 v[80:83], v5 offset:22528
    ds_read_b128 v[84:87], v5 offset:23552
    ds_read_b128 v[88:91], v5 offset:2048
    ds_read_b128 v[92:95], v5 offset:3072
    s_add_u32 s46, s60, 1
    v_mov_b32 v15, s46
    v_mov_b32 v0, -1
    s_add_u32 s8, s61, s32
    s_add_u32 s9, s61, s33
    s_add_u32 s10, s61, s34
    s_add_u32 s11, s61, s35
    s_cmp_eq_u32 s60, 0
    s_cbranch_scc1 L_q_first_41
    s_sleep 16
    s_waitcnt vmcnt(0)
    s_mov_b64 exec, 65535
    buffer_load_dword v10, v19, s[12:15], 0 offen sc1
    s_nop 15
    buffer_load_dword v11, v19, s[12:15], 0 offen sc1
    s_nop 15
    buffer_load_dword v12, v19, s[12:15], 0 offen sc1
    s_nop 15
    buffer_load_dword v13, v19, s[12:15], 0 offen sc1
    s_mov_b32 s70, 0
L_pp_42:
    s_waitcnt vmcnt(3)
    v_cmp_gt_u32 vcc, s60, v10
    s_add_u32 s70, s70, 1
    s_nop 0
    s_cbranch_vccz L_ppd_43
    buffer_load_dword v10, v19, s[12:15], 0 offen sc1
    s_waitcnt vmcnt(3)
    v_cmp_gt_u32 vcc, s60, v11
    s_add_u32 s70, s70, 1
    s_nop 0
    s_cbranch_vccz L_ppd_43
    buffer_load_dword v11, v19, s[12:15], 0 offen sc1
    s_waitcnt vmcnt(3)
    v_cmp_gt_u32 vcc, s60, v12
    s_add_u32 s70, s70, 1
    s_nop 0
    s_cbranch_vccz L_ppd_43
    buffer_load_dword v12, v19, s[12:15], 0 offen sc1
    s_waitcnt vmcnt(3)
    v_cmp_gt_u32 vcc, s60, v13
    s_add_u32 s70, s70, 1
    s_nop 0
    s_cbranch_vccz L_ppd_43
    buffer_load_dword v13, v19, s[12:15], 0 offen sc1
    s_cmp_lt_u32 s70, 0x400000
    s_cbranch_scc1 L_pp_42
    s_branch L_c_done_1
L_ppd_43:
    s_mov_b64 exec, -1
L_q_first_41:
    s_waitcnt lgkmcnt(0)
    buffer_load_dwordx4 v[40:43], v3, s[12:15], s8 offen sc1
    v_mov_b32 v24, 0
    v_mov_b32 v25, 0
    v_mov_b32 v26, 0
    v_mov_b32 v27, 0
    v_mov_b32 v28, 0
    buffer_load_dwordx4 v[44:47], v3, s[12:15], s9 offen sc1
    v_mov_b32 v29, 0
    v_mov_b32 v30, 0
    v_mov_b32 v31, 0
    v_mov_b32 v32, 0
    v_mov_b32 v33, 0
    buffer_load_dwordx4 v[48:51], v3, s[12:15], s10 offen sc1
    v_mov_b32 v34, 0
    v_mov_b32 v35, 0
    v_mov_b32 v36, 0
    v_mov_b32 v37, 0
    v_mov_b32 v38, 0
    buffer_load_dwordx4 v[52:55], v3, s[12:15], s11 offen sc1
    s_mov_b32 s70, 0
    v_mov_b32 v39, 0
L_mg_44_p:
    s_waitcnt vmcnt(3)
    ds_write_b128 v3, v[40:43] offset:0
    v_smfmac_f32_16x16x64_bf16 v[24:27], v[40:43], a[0:7], v2
    s_waitcnt vmcnt(2)
    ds_write_b128 v3, v[44:47] offset:1024
    v_smfmac_f32_16x16x64_bf16 v[28:31], v[40:43], a[8:15], v2
    s_waitcnt vmcnt(1)
    ds_write_b128 v3, v[48:51] offset:2048
    v_smfmac_f32_16x16x64_bf16 v[32:35], v[40:43], a[16:23], v2
    s_waitcnt vmcnt(0)
    ds_write_b128 v3, v[52:55] offset:3072
    v_smfmac_f32_16x16x64_bf16 v[36:39], v[40:43], a[24:31], v2
    v_max3_u32 v22, v40, v41, v42
    v_max3_u32 v22, v22, v43, v44
    v_max3_u32 v22, v22, v45, v46
    v_smfmac_f32_16x16x64_bf16 v[24:27], v[44:47], a[32:39], v2
    v_max3_u32 v22, v22, v47, v48
    v_max3_u32 v22, v22, v49, v50
    v_smfmac_f32_16x16x64_bf16 v[28:31], v[44:47], a[40:47], v2
    v_max3_u32 v22, v22, v51, v52
    v_max3_u32 v22, v22, v53, v54
    v_smfmac_f32_16x16x64_bf16 v[32:35], v[44:47], a[48:55], v2
    v_max_u32 v22, v22, v55
    v_cmp_eq_u32 vcc, -1, v22
    v_smfmac_f32_16x16x64_bf16 v[36:39], v[44:47], a[56:63], v2
    s_waitcnt lgkmcnt(0)
    s_cbranch_vccnz L_mg_44_r
    s_barrier
    ds_read_b128 v[40:43], v4 offset:0
    ds_read_b128 v[44:47], v4 offset:1024
    v_smfmac_f32_16x16x64_bf16 v[24:27], v[48:51], a[64:71], v2
    v_smfmac_f32_16x16x64_bf16 v[28:31], v[48:51], v[56:63], v2
    ds_read_b128 v[56:59], v5 offset:6144
    v_smfmac_f32_16x16x64_bf16 v[32:35], v[48:51], a[72:79], v2
    ds_read_b128 v[60:63], v5 offset:7168
    v_smfmac_f32_16x16x64_bf16 v[36:39], v[48:51], v[64:71], v2
    ds_read_b128 v[48:51], v4 offset:2048
    v_smfmac_f32_16x16x64_bf16 v[24:27], v[52:55], a[80:87], v2
    ds_read_b128 v[64:67], v5 offset:12288
    v_smfmac_f32_16x16x64_bf16 v[28:31], v[52:55], v[72:79], v2
    ds_read_b128 v[68:71], v5 offset:13312
    v_smfmac_f32_16x16x64_bf16 v[32:35], v[52:55], a[88:95], v2
    ds_read_b128 v[72:75], v5 offset:18432
    v_smfmac_f32_16x16x64_bf16 v[36:39], v[52:55], v[80:87], v2
    ds_read_b128 v[52:55], v4 offset:3072
    ds_read_b128 v[76:79], v5 offset:19456
    s_waitcnt lgkmcnt(5)
    v_smfmac_f32_16x16x64_bf16 v[24:27], v[40:43], a[96:103], v2
    ds_read_b128 v[80:83], v5 offset:0
    v_smfmac_f32_16x16x64_bf16 v[28:31], v[40:43], v[88:95], v2
    ds_read_b128 v[84:87], v5 offset:1024
    v_smfmac_f32_16x16x64_bf16 v[32:35], v[40:43], a[104:111], v2
    ds_read_b128 v[88:91], v5 offset:4096
    v_smfmac_f32_16x16x64_bf16 v[36:39], v[40:43], a[112:119], v2
    ds_read_b128 v[40:43], v21 offset:0
    v_smfmac_f32_16x16x64_bf16 v[24:27], v[44:47], a[120:127], v2
    ds_read_b128 v[92:95], v5 offset:5120
    v_smfmac_f32_16x16x64_bf16 v[28:31], v[44:47], v[56:63], v2
    ds_read_b128 v[56:59], v5 offset:10240
    v_smfmac_f32_16x16x64_bf16 v[32:35], v[44:47], a[128:135], v2
    ds_read_b128 v[60:63], v5 offset:11264
    v_smfmac_f32_16x16x64_bf16 v[36:39], v[44:47], a[136:143], v2
    ds_read_b128 v[44:47], v21 offset:1024
    v_smfmac_f32_16x16x64_bf16 v[24:27], v[48:51], a[144:151], v2
    s_waitcnt lgkmcnt(3)
    v_smfmac_f32_16x16x64_bf16 v[28:31], v[48:51], v[64:71], v2
    ds_read_b128 v[48:51], v21 offset:2048
    v_smfmac_f32_16x16x64_bf16 v[24:27], v[52:55], a[168:175], v2
    ds_read_b128 v[64:67], v5 offset:16384
    v_smfmac_f32_16x16x64_bf16 v[28:31], v[52:55], v[72:79], v2
    ds_read_b128 v[52:55], v21 offset:3072
    v_smfmac_f32_16x16x64_bf16 v[24:27], v[40:43], a[192:199], v2
    ds_read_b128 v[68:71], v5 offset:17408
    v_smfmac_f32_16x16x64_bf16 v[28:31], v[40:43], v[80:87], v2
    ds_read_b128 v[40:43], v23 offset:0
    s_waitcnt lgkmcnt(4)
    v_smfmac_f32_16x16x64_bf16 v[24:27], v[44:47], a[216:223], v2
    v_smfmac_f32_16x16x64_bf16 v[28:31], v[44:47], v[88:95], v2
    ds_read_b128 v[44:47], v23 offset:1024
    v_smfmac_f32_16x16x64_bf16 v[24:27], v[48:51], a[240:247], v2
    v_smfmac_f32_16x16x64_bf16 v[28:31], v[48:51], v[56:63], v2
    ds_read_b128 v[48:51], v23 offset:2048
    s_waitcnt lgkmcnt(2)
    v_smfmac_f32_16x16x64_bf16 v[24:27], v[52:55], v[104:111], v2
    v_smfmac_f32_16x16x64_bf16 v[28:31], v[52:55], v[64:71], v2
    ds_read_b128 v[52:55], v23 offset:3072
    v_smfmac_f32_16x16x64_bf16 v[24:27], v[40:43], v[128:135], v2
    ds_read_b128 v[72:75], v8 offset:20480
    v_smfmac_f32_16x16x64_bf16 v[28:31], v[40:43], v[136:143], v2
    ds_read_b128 v[76:79], v8 offset:21504
    s_waitcnt lgkmcnt(3)
    v_smfmac_f32_16x16x64_bf16 v[24:27], v[44:47], v[160:167], v2
    ds_read_b128 v[56:59], v8 offset:16384
    v_smfmac_f32_16x16x64_bf16 v[28:31], v[44:47], v[168:175], v2
    ds_read_b128 v[60:63], v8 offset:17408
    v_smfmac_f32_16x16x64_bf16 v[24:27], v[48:51], v[192:199], v2
    ds_read_b128 v[64:67], v8 offset:18432
    v_smfmac_f32_16x16x64_bf16 v[28:31], v[48:51], v[200:207], v2
    ds_read_b128 v[68:71], v8 offset:19456
    s_waitcnt lgkmcnt(4)
    v_smfmac_f32_16x16x64_bf16 v[24:27], v[52:55], v[224:231], v2
    v_smfmac_f32_16x16x64_bf16 v[28:31], v[52:55], v[232:239], v2
    v_smfmac_f32_16x16x64_bf16 v[32:35], v[52:55], v[240:247], v2
    v_smfmac_f32_16x16x64_bf16 v[36:39], v[52:55], v[248:255], v2
    ds_read_b128 v[52:55], v21 offset:3072
    v_smfmac_f32_16x16x64_bf16 v[32:35], v[48:51], v[208:215], v2
    s_nop 3
    v_permlane32_swap_b32 v24, v28
    v_permlane32_swap_b32 v25, v29
    v_smfmac_f32_16x16x64_bf16 v[36:39], v[48:51], v[216:223], v2
    ds_read_b128 v[48:51], v21 offset:2048
    v_permlane32_swap_b32 v26, v30
    v_smfmac_f32_16x16x64_bf16 v[32:35], v[44:47], v[176:183], v2
    v_permlane32_swap_b32 v27, v31
    v_add_f32 v24, v24, v28
    v_smfmac_f32_16x16x64_bf16 v[36:39], v[44:47], v[184:191], v2
    ds_read_b128 v[44:47], v21 offset:1024
    v_add_f32 v25, v25, v29
    v_smfmac_f32_16x16x64_bf16 v[32:35], v[40:43], v[144:151], v2
    v_add_f32 v26, v26, v30
    v_add_f32 v27, v27, v31
    v_smfmac_f32_16x16x64_bf16 v[36:39], v[40:43], v[152:159], v2
    ds_read_b128 v[40:43], v21 offset:0
    v_cvt_pk_bf16_f32 v24, v24, v25
    s_waitcnt lgkmcnt(2)
    v_smfmac_f32_16x16x64_bf16 v[32:35], v[52:55], v[112:119], v2
    v_cvt_pk_bf16_f32 v25, v26, v27
    v_smfmac_f32_16x16x64_bf16 v[36:39], v[52:55], v[120:127], v2
    ds_read_b128 v[52:55], v4 offset:3072
    v_smfmac_f32_16x16x64_bf16 v[32:35], v[48:51], a[248:255], v2
    ds_write_b64 v6, v[24:25]
    v_smfmac_f32_16x16x64_bf16 v[36:39], v[48:51], v[96:103], v2
    ds_read_b128 v[48:51], v4 offset:2048
    s_waitcnt lgkmcnt(3)
    v_smfmac_f32_16x16x64_bf16 v[32:35], v[44:47], a[224:231], v2
    v_smfmac_f32_16x16x64_bf16 v[36:39], v[44:47], a[232:239], v2
    s_waitcnt lgkmcnt(1)
    s_barrier
    ds_read_b64_tr_b16 v[80:81], v7 offset:0
    v_smfmac_f32_16x16x64_bf16 v[32:35], v[40:43], a[200:207], v2
    ds_read_b64_tr_b16 v[82:83], v7 offset:64
    ds_read_b64_tr_b16 v[84:85], v7 offset:512
    v_smfmac_f32_16x16x64_bf16 v[36:39], v[40:43], a[208:215], v2
    ds_read_b64_tr_b16 v[86:87], v7 offset:576
    ds_read_b64_tr_b16 v[88:89], v7 offset:1024
    v_smfmac_f32_16x16x64_bf16 v[32:35], v[52:55], a[176:183], v2
    ds_read_b64_tr_b16 v[90:91], v7 offset:1088
    v_smfmac_f32_16x16x64_bf16 v[36:39], v[52:55], a[184:191], v2
    ds_read_b64_tr_b16 v[92:93], v7 offset:1536
    s_waitcnt lgkmcnt(6)
    v_smfmac_f32_16x16x64_bf16 v[32:35], v[48:51], a[152:159], v2
    ds_read_b64_tr_b16 v[94:95], v7 offset:1600
    v_smfmac_f32_16x16x64_bf16 v[36:39], v[48:51], a[160:167], v2
    s_waitcnt lgkmcnt(3)
    v_mfma_f32_16x16x32_bf16 v[24:27], v[56:59], v[80:83], 0
    ds_read_b128 v[56:59], v8 offset:22528
    v_mfma_f32_16x16x32_bf16 v[28:31], v[60:63], v[80:83], 0
    ds_read_b128 v[60:63], v8 offset:23552
    v_mfma_f32_16x16x32_bf16 v[24:27], v[64:67], v[84:87], v[24:27]
    s_nop 1
    v_cvt_pk_bf16_f32 v32, v32, v33
    v_cvt_pk_bf16_f32 v33, v34, v35
    v_cvt_pk_bf16_f32 v34, v36, v37
    v_cvt_pk_bf16_f32 v35, v38, v39
    ds_write2_b64 v18, v[32:33], v[34:35] offset1:32
    v_mfma_f32_16x16x32_bf16 v[28:31], v[68:71], v[84:87], v[28:31]
    s_waitcnt lgkmcnt(3)
    v_mfma_f32_16x16x32_bf16 v[24:27], v[72:75], v[88:91], v[24:27]
    ds_read_b64_tr_b16 v[64:65], v9 offset:24576
    v_mfma_f32_16x16x32_bf16 v[28:31], v[76:79], v[88:91], v[28:31]
    ds_read_b64_tr_b16 v[66:67], v9 offset:25600
    s_waitcnt lgkmcnt(3)
    v_mfma_f32_16x16x32_bf16 v[24:27], v[56:59], v[92:95], v[24:27]
    ds_read_b64_tr_b16 v[68:69], v9 offset:25088
    v_mfma_f32_16x16x32_bf16 v[28:31], v[60:63], v[92:95], v[28:31]
    ds_read_b64_tr_b16 v[70:71], v9 offset:26112
    v_mov_b32 v57, 0
    v_mov_b32 v58, 0
    s_cmp_eq_u32 s60, 63
    s_waitcnt lgkmcnt(4)
    s_barrier
    ds_read_b64_tr_b16 v[40:41], v14 offset:55296
    ds_read_b64_tr_b16 v[42:43], v14 offset:55816
    ds_read_b64_tr_b16 v[44:45], v14 offset:56336
    ds_read_b64_tr_b16 v[46:47], v14 offset:56856
    ds_read_b64_tr_b16 v[48:49], v14 offset:57376
    ds_read_b64_tr_b16 v[50:51], v14 offset:57896
    ds_read_b64_tr_b16 v[52:53], v14 offset:58416
    ds_read_b64_tr_b16 v[54:55], v14 offset:58936
    s_cbranch_scc1 L_q_last_45
    v_max3_f32 v11, v24, v25, v26
    v_max3_f32 v13, v27, v28, v29
    v_max3_f32 v11, v11, v30, v31
    v_max_f32 v12, v11, v13
    v_max_f32 v13, v11, v13
    v_mov_b32 v32, 0x3f803f80
    v_mov_b32 v33, 0x3f803f80
    v_mov_b32 v34, 0x3f803f80
    v_mov_b32 v35, 0x3f803f80
    buffer_load_dwordx2 v[0:1], v16, s[12:15], s51 offen sc1
    s_waitcnt lgkmcnt(4)
    v_mfma_f32_16x16x32_bf16 v[36:39], v[40:43], v[80:83], 0
    v_permlane32_swap_b32 v12, v13
    v_mfma_f32_16x16x32_bf16 v[36:39], v[44:47], v[84:87], v[36:39]
    v_max_f32 v22, v12, v13
    v_max_f32 v13, v12, v13
    s_waitcnt lgkmcnt(0)
    v_mfma_f32_16x16x32_bf16 v[36:39], v[48:51], v[88:91], v[36:39]
    v_permlane16_swap_b32 v22, v13
    v_mfma_f32_16x16x32_bf16 v[36:39], v[52:55], v[92:95], v[36:39]
    v_max_f32 v11, v22, v13
    v_mul_f32 v10, s52, v11
    v_fma_f32 v24, v24, s52, -v10
    v_fma_f32 v25, v25, s52, -v10
    v_fma_f32 v26, v26, s52, -v10
    v_fma_f32 v27, v27, s52, -v10
    v_fma_f32 v28, v28, s52, -v10
    v_fma_f32 v29, v29, s52, -v10
    v_fma_f32 v30, v30, s52, -v10
    v_fma_f32 v31, v31, s52, -v10
    v_exp_f32 v24, v24
    v_exp_f32 v25, v25
    v_exp_f32 v26, v26
    v_exp_f32 v27, v27
    v_exp_f32 v28, v28
    v_exp_f32 v29, v29
    v_exp_f32 v30, v30
    v_exp_f32 v31, v31
    v_cvt_pk_bf16_f32 v60, v24, v25
    v_cvt_pk_bf16_f32 v61, v26, v27
    v_cvt_pk_bf16_f32 v62, v28, v29
    v_cvt_pk_bf16_f32 v63, v30, v31
    v_permlane32_swap_b32 v36, v38
    v_permlane32_swap_b32 v37, v39
    v_mfma_f32_16x16x32_bf16 v[72:75], v[64:67], v[60:63], 0
    v_add_f32 v36, v36, v38
    v_add_f32 v37, v37, v39
    v_mfma_f32_16x16x32_bf16 v[76:79], v[68:71], v[60:63], 0
    v_fma_f32 v12, v36, s52, -v10
    v_fma_f32 v13, v37, s52, -v10
    v_mfma_f32_16x16x32_bf16 v[24:27], v[32:35], v[60:63], 0
    buffer_store_dword v15, v20, s[24:27], 0 offen
    v_exp_f32 v36, v12
    v_exp_f32 v37, v13
    v_max_f32 v11, v12, v13
    s_waitcnt vmcnt(1)
    v_max_u32 v22, v0, v1
    v_cmp_lt_f32 s[8:9], s53, v11
    v_cmp_eq_u32 vcc, -1, v22
    v_cvt_pk_bf16_f32 v56, v36, v37
    v_cvt_pk_bf16_f32 v59, v36, v37
    s_or_b64 s[10:11], vcc, s[8:9]
    s_cbranch_scc1 L_q_vm_46_s
L_q_vm_46_j:
    v_mfma_f32_16x16x16_bf16 v[24:27], v[32:33], v[56:57], v[24:27]
    v_mfma_f32_16x16x16_bf16 v[72:75], v[0:1], v[56:57], v[72:75]
    v_mfma_f32_16x16x16_bf16 v[76:79], v[0:1], v[58:59], v[76:79]
    s_nop 5
    v_rcp_f32 v12, v24
    s_nop 0
    v_pk_mul_f32 v[72:73], v[72:73], v[12:13] op_sel_hi:[1,0]
    v_pk_mul_f32 v[74:75], v[74:75], v[12:13] op_sel_hi:[1,0]
    v_pk_mul_f32 v[76:77], v[76:77], v[12:13] op_sel_hi:[1,0]
    v_pk_mul_f32 v[78:79], v[78:79], v[12:13] op_sel_hi:[1,0]
    v_cvt_pk_bf16_f32 v72, v72, v73
    v_cvt_pk_bf16_f32 v73, v74, v75
    v_cvt_pk_bf16_f32 v74, v76, v77
    v_cvt_pk_bf16_f32 v75, v78, v79
    buffer_store_dwordx4 v[72:75], v17, s[24:27], s62 offen
    buffer_store_dwordx4 v[72:75], v17, s[28:31], s62 offen sc1
    buffer_store_dword v15, v20, s[28:31], 0 offen sc1
    v_mov_b32 v60, -1
    v_mov_b32 v61, -1
    v_mov_b32 v62, -1
    v_mov_b32 v63, -1
    s_add_u32 s45, s60, 3
    s_and_b32 s45, s45, 3
    s_lshl_b32 s45, s45, 15
    s_add_u32 s45, s45, s59
    buffer_store_dwordx4 v[60:63], v17, s[24:27], s45 offen
    buffer_store_dwordx4 v[60:63], v17, s[28:31], s45 offen sc1
    s_barrier
    s_and_b32 s45, s51, 0xffff
    s_lshl_b32 s46, s60, 16
    s_add_u32 s45, s45, s46
    s_add_u32 s45, s45, 0x1800000
    buffer_store_dwordx2 v[0:1], v16, s[12:15], s45 offen sc1
L_q_last_45:
    s_waitcnt lgkmcnt(0)
    v_lshlrev_b32 v22, 1, v16
    s_cmp_lg_u32 s44, 0
    s_cbranch_scc1 L_q_km_47_0
    buffer_store_dwordx4 v[40:43], v22, s[12:15], s66 offen offset:0 sc1
L_q_km_47_0:
    s_cmp_lg_u32 s44, 1
    s_cbranch_scc1 L_q_km_47_1
    buffer_store_dwordx4 v[44:47], v22, s[12:15], s66 offen offset:1024 sc1
L_q_km_47_1:
    s_cmp_lg_u32 s44, 2
    s_cbranch_scc1 L_q_km_47_2
    buffer_store_dwordx4 v[48:51], v22, s[12:15], s66 offen offset:2048 sc1
L_q_km_47_2:
    s_cmp_lg_u32 s44, 3
    s_cbranch_scc1 L_q_km_47_3
    buffer_store_dwordx4 v[52:55], v22, s[12:15], s66 offen offset:3072 sc1
L_q_km_47_3:
    s_cmp_eq_u32 s60, 63
    s_cbranch_scc1 L_q_fin_48
    s_cmp_eq_u32 s60, 62
    s_cbranch_scc1 L_q_fin_48_n
    s_add_u32 s47, s60, 1
    s_cmp_lt_u32 s47, s50
    s_cbranch_scc1 L_kv_rdy_49
    s_lshl_b32 s45, s43, 7
    s_add_u32 s45, s45, 0x10014
    v_mov_b32 v0, 0
    s_mov_b32 s70, 0
L_kv_rdy_49_p:
    buffer_load_dwordx2 v[10:11], v0, s[12:15], s45 offen sc1
    s_add_u32 s70, s70, 1
    s_cmp_ge_u32 s70, 0x200000
    s_cbranch_scc1 L_c_done_1
    s_waitcnt vmcnt(0)
    v_min_u32 v10, v10, v11
    s_nop 0
    v_readfirstlane_b32 s50, v10
    s_nop 3
    s_cmp_lt_u32 s47, s50
    s_cbranch_scc1 L_kv_rdy_49
    s_sleep 2
    s_branch L_kv_rdy_49_p
L_kv_rdy_49:
    s_mov_b32 m0, s64
    s_add_u32 s46, s63, 0x1000000
    buffer_load_dwordx4 v3, s[12:15], s63 offen sc1 lds
    buffer_load_dwordx4 v3, s[12:15], s63 offen offset:1024 sc1 lds
    s_mov_b32 m0, s65
    s_add_u32 s63, s63, 8192
    buffer_load_dwordx4 v3, s[12:15], s46 offen sc1 lds
    buffer_load_dwordx4 v3, s[12:15], s46 offen offset:1024 sc1 lds
    s_branch L_q_fin_48_k
L_q_fin_48_n:
    s_waitcnt vmcnt(0)
L_q_fin_48_k:
    s_add_u32 s47, s60, 1
    s_bitcmp1_b64 s[6:7], s47
    s_cselect_b32 s47, s47, s60
    s_cbranch_scc0 L_q_fin_48_m
    s_waitcnt vmcnt(4)
L_q_fin_48_m:
    v_mov_b32 v22, s47
    v_mov_b32 v0, 0
    s_mov_b64 exec, 1
    buffer_store_dword v22, v0, s[12:15], s3 offen sc1
    s_mov_b64 exec, -1
    s_mov_b64 exec, -1
    v_add_u32 v8, s69, v8
    v_add_u32 v9, s69, v9
    s_sub_u32 s64, s64, s69
    s_sub_u32 s65, s65, s69
    s_sub_u32 s69, 0, s69
    s_add_u32 s66, s66, 131072
    s_xor_b32 s51, s51, 65536
    s_add_u32 s60, s60, 1
    s_and_b32 s45, s60, 3
    s_lshl_b32 s46, s45, 14
    s_add_u32 s61, s58, s46
    s_lshl_b32 s46, s45, 15
    s_add_u32 s62, s59, s46
    s_branch L_q_loop_40
L_q_fin_48:
    s_waitcnt vmcnt(0)
    v_mov_b32 v22, 64
    v_mov_b32 v0, 0
    s_mov_b64 exec, 1
    buffer_store_dword v22, v0, s[12:15], s3 offen sc1
    s_mov_b64 exec, -1
    s_endpgm
L_mg_44_r:
    buffer_load_dwordx4 v[40:43], v3, s[12:15], s8 offen sc1
    buffer_load_dwordx4 v[44:47], v3, s[12:15], s9 offen sc1
    buffer_load_dwordx4 v[48:51], v3, s[12:15], s10 offen sc1
    buffer_load_dwordx4 v[52:55], v3, s[12:15], s11 offen sc1
    s_add_u32 s70, s70, 1
    s_cmp_ge_u32 s70, 0x100000
    s_cbranch_scc1 L_c_done_1
    s_nop 1
    v_mov_b32 v24, 0
    v_mov_b32 v25, 0
    v_mov_b32 v26, 0
    v_mov_b32 v27, 0
    v_mov_b32 v28, 0
    v_mov_b32 v29, 0
    v_mov_b32 v30, 0
    v_mov_b32 v31, 0
    v_mov_b32 v32, 0
    v_mov_b32 v33, 0
    v_mov_b32 v34, 0
    v_mov_b32 v35, 0
    v_mov_b32 v36, 0
    v_mov_b32 v37, 0
    v_mov_b32 v38, 0
    v_mov_b32 v39, 0
    s_branch L_mg_44_p
L_q_vm_46_s:
    s_cbranch_vccz L_q_vm_46_t
    buffer_load_dwordx2 v[0:1], v16, s[12:15], s51 offen sc1
    s_add_u32 s70, s70, 1
    s_nop 0
    s_cmp_ge_u32 s70, 0x100000
    s_cbranch_scc1 L_c_done_1
    s_waitcnt vmcnt(0)
    v_max_u32 v22, v0, v1
    v_cmp_eq_u32 vcc, -1, v22
    s_nop 1
    s_branch L_q_vm_46_s
L_q_vm_46_t:
    s_cmp_eq_u64 s[8:9], 0
    s_cbranch_scc1 L_q_vm_46_j
    v_max_f32 v11, 0, v11
    v_mov_b32 v22, v11
    s_nop 1
    v_permlane32_swap_b32 v11, v22
    v_max_f32 v11, v11, v22
    v_mov_b32 v22, v11
    s_nop 1
    v_permlane16_swap_b32 v11, v22
    v_max_f32 v11, v11, v22
    v_sub_f32 v12, v12, v11
    v_sub_f32 v13, v13, v11
    v_sub_f32 v11, 0, v11
    v_exp_f32 v36, v12
    v_exp_f32 v37, v13
    v_exp_f32 v11, v11
    s_nop 7
    v_mul_f32 v72, v72, v11
    v_mul_f32 v73, v73, v11
    v_mul_f32 v74, v74, v11
    v_mul_f32 v75, v75, v11
    v_mul_f32 v76, v76, v11
    v_mul_f32 v77, v77, v11
    v_mul_f32 v78, v78, v11
    v_mul_f32 v79, v79, v11
    v_mul_f32 v24, v24, v11
    v_cvt_pk_bf16_f32 v56, v36, v37
    v_cvt_pk_bf16_f32 v59, v36, v37
    s_nop 1
    s_branch L_q_vm_46_j
L_c_vo_2:
    s_lshl_b32 s45, s43, 11
    s_lshl_b32 s46, s44, 9
    s_add_u32 s45, s45, s46
    v_lshlrev_b32 v10, 3, v1
    v_add_u32 v10, s45, v10
    v_lshlrev_b32 v11, 3, v0
    v_bfe_u32 v69, v1, 4, 1
    v_lshlrev_b32 v69, 2, v69
    v_lshrrev_b32 v63, 5, v1
    v_lshlrev_b32 v63, 1, v63
    v_and_b32 v64, 1, v1
    v_add3_u32 v69, v69, v63, v64
    v_bfe_u32 v63, v1, 1, 1
    v_lshlrev_b32 v63, 3, v63
    v_add_u32 v63, v63, v69
    v_lshlrev_b32 v63, 4, v63
    v_bfe_u32 v64, v1, 2, 2
    v_lshlrev_b32 v64, 2, v64
    s_lshl_b32 s45, s42, 10
    s_lshl_b32 s46, s44, 8
    s_add_u32 s45, s45, s46
    v_add3_u32 v12, v63, v64, s45
    v_and_b32 v64, 1, v1
    v_cmp_eq_u32 vcc, 0, v64
    v_mov_b32 v9, 0x07060302
    v_mov_b32 v63, 0x01000504
    v_cndmask_b32 v9, v9, v63, vcc
    s_lshl_b32 s63, s40, 19
    s_lshl_b32 s45, s42, 15
    s_add_u32 s63, s63, s45
    s_add_u32 s63, s63, 0x7100000
    s_xor_b32 s64, s63, 524288
    s_lshl_b32 s45, s40, 12
    s_lshl_b32 s46, s44, 2
    s_add_u32 s45, s45, s46
    s_lshl_b32 s46, s42, 4
    s_add_u32 s45, s45, s46
    s_add_u32 s45, s45, 0x7082000
    v_lshlrev_b32 v20, 8, v1
    v_add_u32 v20, s45, v20
    v_mov_b32 v63, 0x20000000
    v_cmp_gt_u32 vcc, 16, v1
    s_nop 1
    v_cndmask_b32 v20, v63, v20, vcc
    buffer_store_dword v44, v20, s[12:15], 0 offen sc1
    s_mov_b32 s45, 0x7020000
    buffer_store_dwordx2 v[40:41], v10, s[12:15], s45 offen sc1
    s_mov_b32 s45, 0x7030000
    buffer_store_dwordx2 v[40:41], v10, s[12:15], s45 offen sc1
    s_add_u32 s45, s63, 0
    buffer_store_dwordx2 v[40:41], v11, s[12:15], s45 offen sc1
    s_add_u32 s45, s63, 4096
    buffer_store_dwordx2 v[40:41], v11, s[12:15], s45 offen sc1
    s_add_u32 s45, s63, 8192
    buffer_store_dwordx2 v[40:41], v11, s[12:15], s45 offen sc1
    s_add_u32 s45, s63, 12288
    buffer_store_dwordx2 v[40:41], v11, s[12:15], s45 offen sc1
    s_add_u32 s45, s63, 16384
    buffer_store_dwordx2 v[40:41], v11, s[12:15], s45 offen sc1
    s_add_u32 s45, s63, 20480
    buffer_store_dwordx2 v[40:41], v11, s[12:15], s45 offen sc1
    s_add_u32 s45, s63, 24576
    buffer_store_dwordx2 v[40:41], v11, s[12:15], s45 offen sc1
    s_add_u32 s45, s63, 28672
    buffer_store_dwordx2 v[40:41], v11, s[12:15], s45 offen sc1
    s_lshl_b32 s61, s40, 16
    s_add_u32 s61, s61, 0x7000000
    s_add_u32 s45, s61, 16384
    buffer_store_dword v40, v12, s[12:15], s45 offen sc1
    s_add_u32 s45, s61, 32768
    buffer_store_dword v40, v12, s[12:15], s45 offen sc1
    s_add_u32 s45, s61, 49152
    buffer_store_dword v40, v12, s[12:15], s45 offen sc1
    v_lshlrev_b32 v63, 11, v69
    v_and_b32 v64, 14, v1
    v_lshlrev_b32 v64, 1, v64
    v_add_u32 v63, v63, v64
    s_lshl_b32 s45, s42, 7
    s_lshl_b32 s46, s44, 5
    s_add_u32 s45, s45, s46
    buffer_load_dword v45, v63, s[52:55], s45 offen
    s_mov_b32 s76, -1
    s_mov_b32 s77, -1
    v_lshrrev_b32 v63, 3, v1
    v_lshlrev_b32 v63, 11, v63
    v_bfe_u32 v64, v1, 1, 2
    v_and_b32 v65, 1, v1
    v_lshlrev_b32 v65, 4, v65
    v_add_u32 v63, v63, v65
    v_xor_b32 v66, 0, v64
    v_lshlrev_b32 v66, 5, v66
    v_add_u32 v70, v63, v66
    v_xor_b32 v66, 1, v64
    v_lshlrev_b32 v66, 5, v66
    v_add_u32 v71, v63, v66
    v_xor_b32 v66, 2, v64
    v_lshlrev_b32 v66, 5, v66
    v_add_u32 v72, v63, v66
    v_xor_b32 v66, 3, v64
    v_lshlrev_b32 v66, 5, v66
    v_add_u32 v73, v63, v66
    v_bfe_u32 v63, v1, 3, 1
    v_lshlrev_b32 v63, 1, v63
    v_bfe_u32 v64, v1, 4, 1
    v_add_u32 v63, v63, v64
    v_lshlrev_b32 v64, 3, v63
    v_lshrrev_b32 v65, 5, v1
    v_lshlrev_b32 v65, 2, v65
    v_add_u32 v64, v64, v65
    v_bfe_u32 v65, v1, 2, 1
    v_add_u32 v64, v64, v65
    v_lshlrev_b32 v64, 7, v64
    v_and_b32 v65, 3, v1
    v_lshlrev_b32 v65, 3, v65
    v_add_u32 v64, v64, v65
    s_lshl_b32 s45, s44, 12
    v_add_u32 v64, s45, v64
    s_add_u32 s45, s44, 1
    s_and_b32 s45, s45, 3
    v_xor_b32 v65, s45, v63
    v_lshlrev_b32 v65, 5, v65
    v_add_u32 v74, v64, v65
    s_mul_i32 s45, s44, 20480
    s_add_u32 s45, s45, 65536
    v_add_u32 v88, s45, v74
    s_add_u32 s45, s44, 2
    s_and_b32 s45, s45, 3
    v_xor_b32 v65, s45, v63
    v_lshlrev_b32 v65, 5, v65
    v_add_u32 v75, v64, v65
    s_mul_i32 s45, s44, 20480
    s_add_u32 s45, s45, 65536
    v_add_u32 v89, s45, v75
    s_add_u32 s45, s44, 3
    s_and_b32 s45, s45, 3
    v_xor_b32 v65, s45, v63
    v_lshlrev_b32 v65, 5, v65
    v_add_u32 v76, v64, v65
    s_mul_i32 s45, s44, 20480
    s_add_u32 s45, s45, 65536
    v_add_u32 v90, s45, v76
    s_add_u32 s45, s44, 4
    s_and_b32 s45, s45, 3
    v_xor_b32 v65, s45, v63
    v_lshlrev_b32 v65, 5, v65
    v_add_u32 v77, v64, v65
    s_mul_i32 s45, s44, 20480
    s_add_u32 s45, s45, 65536
    v_add_u32 v91, s45, v77
    s_mul_i32 s65, s44, 24576
    s_lshl_b32 s49, s40, 22
    s_lshl_b32 s45, s44, 20
    s_add_u32 s49, s49, s45
    s_lshl_b32 s45, s42, 7
    s_add_u32 s49, s49, s45
    s_lshl_b32 s50, s44, 12
    s_mul_i32 s69, s42, 1
    s_add_u32 s51, s69, 0
    s_and_b32 s51, s51, 7
    s_lshl_b32 s51, s51, 17
    s_add_u32 s51, s51, s49
    s_add_u32 s46, s51, 0x0
    s_add_u32 m0, s65, 65536
    s_nop 0
    buffer_load_dwordx4 v70, s[36:39], s46 offen  lds
    s_add_u32 s46, s51, 0x8000
    s_add_u32 m0, s65, 66560
    s_nop 0
    buffer_load_dwordx4 v71, s[36:39], s46 offen  lds
    s_add_u32 s46, s51, 0x10000
    s_add_u32 m0, s65, 67584
    s_nop 0
    buffer_load_dwordx4 v72, s[36:39], s46 offen  lds
    s_add_u32 s46, s51, 0x18000
    s_add_u32 m0, s65, 68608
    s_nop 0
    buffer_load_dwordx4 v73, s[36:39], s46 offen  lds
    s_add_u32 s51, s69, 0
    s_and_b32 s51, s51, 7
    s_lshl_b32 s51, s51, 17
    s_add_u32 s51, s51, s49
    s_add_u32 s46, s51, 0x4000
    s_add_u32 m0, s65, 69632
    s_nop 0
    buffer_load_dwordx4 v70, s[36:39], s46 offen  lds
    s_add_u32 s46, s51, 0xc000
    s_add_u32 m0, s65, 70656
    s_nop 0
    buffer_load_dwordx4 v71, s[36:39], s46 offen  lds
    s_add_u32 s46, s51, 0x14000
    s_add_u32 m0, s65, 71680
    s_nop 0
    buffer_load_dwordx4 v72, s[36:39], s46 offen  lds
    s_add_u32 s46, s51, 0x1c000
    s_add_u32 m0, s65, 72704
    s_nop 0
    buffer_load_dwordx4 v73, s[36:39], s46 offen  lds
    s_add_u32 s51, s69, 1
    s_and_b32 s51, s51, 7
    s_lshl_b32 s51, s51, 17
    s_add_u32 s51, s51, s49
    s_add_u32 s46, s51, 0x0
    s_add_u32 m0, s65, 73728
    s_nop 0
    buffer_load_dwordx4 v70, s[36:39], s46 offen  lds
    s_add_u32 s46, s51, 0x8000
    s_add_u32 m0, s65, 74752
    s_nop 0
    buffer_load_dwordx4 v71, s[36:39], s46 offen  lds
    s_add_u32 s46, s51, 0x10000
    s_add_u32 m0, s65, 75776
    s_nop 0
    buffer_load_dwordx4 v72, s[36:39], s46 offen  lds
    s_add_u32 s46, s51, 0x18000
    s_add_u32 m0, s65, 76800
    s_nop 0
    buffer_load_dwordx4 v73, s[36:39], s46 offen  lds
    s_add_u32 s51, s69, 1
    s_and_b32 s51, s51, 7
    s_lshl_b32 s51, s51, 17
    s_add_u32 s51, s51, s49
    s_add_u32 s46, s51, 0x4000
    s_add_u32 m0, s65, 77824
    s_nop 0
    buffer_load_dwordx4 v70, s[36:39], s46 offen  lds
    s_add_u32 s46, s51, 0xc000
    s_add_u32 m0, s65, 78848
    s_nop 0
    buffer_load_dwordx4 v71, s[36:39], s46 offen  lds
    s_add_u32 s46, s51, 0x14000
    s_add_u32 m0, s65, 79872
    s_nop 0
    buffer_load_dwordx4 v72, s[36:39], s46 offen  lds
    s_add_u32 s46, s51, 0x1c000
    s_add_u32 m0, s65, 80896
    s_nop 0
    buffer_load_dwordx4 v73, s[36:39], s46 offen  lds
    s_add_u32 s51, s69, 2
    s_and_b32 s51, s51, 7
    s_lshl_b32 s51, s51, 17
    s_add_u32 s51, s51, s49
    s_add_u32 s46, s51, 0x0
    s_add_u32 m0, s65, 81920
    s_nop 0
    buffer_load_dwordx4 v70, s[36:39], s46 offen  lds
    s_add_u32 s46, s51, 0x8000
    s_add_u32 m0, s65, 82944
    s_nop 0
    buffer_load_dwordx4 v71, s[36:39], s46 offen  lds
    s_add_u32 s46, s51, 0x10000
    s_add_u32 m0, s65, 83968
    s_nop 0
    buffer_load_dwordx4 v72, s[36:39], s46 offen  lds
    s_add_u32 s46, s51, 0x18000
    s_add_u32 m0, s65, 84992
    s_nop 0
    buffer_load_dwordx4 v73, s[36:39], s46 offen  lds
    s_add_u32 s51, s69, 2
    s_and_b32 s51, s51, 7
    s_lshl_b32 s51, s51, 17
    s_add_u32 s51, s51, s49
    s_add_u32 s46, s51, 0x4000
    s_add_u32 m0, s65, 86016
    s_nop 0
    buffer_load_dwordx4 v70, s[36:39], s46 offen  lds
    s_add_u32 s46, s51, 0xc000
    s_add_u32 m0, s65, 87040
    s_nop 0
    buffer_load_dwordx4 v71, s[36:39], s46 offen  lds
    s_add_u32 s46, s51, 0x14000
    s_add_u32 m0, s65, 88064
    s_nop 0
    buffer_load_dwordx4 v72, s[36:39], s46 offen  lds
    s_add_u32 s46, s51, 0x1c000
    s_add_u32 m0, s65, 89088
    s_nop 0
    buffer_load_dwordx4 v73, s[36:39], s46 offen  lds
    s_add_u32 s51, s69, 3
    s_and_b32 s51, s51, 7
    s_lshl_b32 s51, s51, 17
    s_add_u32 s51, s51, s49
    s_add_u32 s46, s51, 0x0
    s_add_u32 m0, s50, 0
    s_nop 0
    buffer_load_dwordx4 v70, s[36:39], s46 offen  lds
    s_add_u32 s46, s51, 0x8000
    s_add_u32 m0, s50, 1024
    s_nop 0
    buffer_load_dwordx4 v71, s[36:39], s46 offen  lds
    s_add_u32 s46, s51, 0x10000
    s_add_u32 m0, s50, 2048
    s_nop 0
    buffer_load_dwordx4 v72, s[36:39], s46 offen  lds
    s_add_u32 s46, s51, 0x18000
    s_add_u32 m0, s50, 3072
    s_nop 0
    buffer_load_dwordx4 v73, s[36:39], s46 offen  lds
    s_add_u32 s51, s69, 3
    s_and_b32 s51, s51, 7
    s_lshl_b32 s51, s51, 17
    s_add_u32 s51, s51, s49
    s_add_u32 s46, s51, 0x4000
    s_add_u32 m0, s50, 16384
    s_nop 0
    buffer_load_dwordx4 v70, s[36:39], s46 offen  lds
    s_add_u32 s46, s51, 0xc000
    s_add_u32 m0, s50, 17408
    s_nop 0
    buffer_load_dwordx4 v71, s[36:39], s46 offen  lds
    s_add_u32 s46, s51, 0x14000
    s_add_u32 m0, s50, 18432
    s_nop 0
    buffer_load_dwordx4 v72, s[36:39], s46 offen  lds
    s_add_u32 s46, s51, 0x1c000
    s_add_u32 m0, s50, 19456
    s_nop 0
    buffer_load_dwordx4 v73, s[36:39], s46 offen  lds
    s_add_u32 s51, s69, 4
    s_and_b32 s51, s51, 7
    s_lshl_b32 s51, s51, 17
    s_add_u32 s51, s51, s49
    s_add_u32 s46, s51, 0x0
    s_add_u32 m0, s50, 32768
    s_nop 0
    buffer_load_dwordx4 v70, s[36:39], s46 offen  lds
    s_add_u32 s46, s51, 0x8000
    s_add_u32 m0, s50, 33792
    s_nop 0
    buffer_load_dwordx4 v71, s[36:39], s46 offen  lds
    s_add_u32 s46, s51, 0x10000
    s_add_u32 m0, s50, 34816
    s_nop 0
    buffer_load_dwordx4 v72, s[36:39], s46 offen  lds
    s_add_u32 s46, s51, 0x18000
    s_add_u32 m0, s50, 35840
    s_nop 0
    buffer_load_dwordx4 v73, s[36:39], s46 offen  lds
    s_add_u32 s51, s69, 4
    s_and_b32 s51, s51, 7
    s_lshl_b32 s51, s51, 17
    s_add_u32 s51, s51, s49
    s_add_u32 s46, s51, 0x4000
    s_add_u32 m0, s50, 49152
    s_nop 0
    buffer_load_dwordx4 v70, s[36:39], s46 offen  lds
    s_add_u32 s46, s51, 0xc000
    s_add_u32 m0, s50, 50176
    s_nop 0
    buffer_load_dwordx4 v71, s[36:39], s46 offen  lds
    s_add_u32 s46, s51, 0x14000
    s_add_u32 m0, s50, 51200
    s_nop 0
    buffer_load_dwordx4 v72, s[36:39], s46 offen  lds
    s_add_u32 s46, s51, 0x1c000
    s_add_u32 m0, s50, 52224
    s_nop 0
    buffer_load_dwordx4 v73, s[36:39], s46 offen  lds
    s_waitcnt vmcnt(40)
    v_min_u32 v45, -2, v45
    buffer_store_dword v45, v12, s[12:15], s61 offen sc1
    s_waitcnt vmcnt(36)
    s_barrier
    ds_read_b64_tr_b16 a[160:161], v88 offset:0
    ds_read_b64_tr_b16 a[162:163], v88 offset:256
    ds_read_b64_tr_b16 a[168:169], v89 offset:0
    ds_read_b64_tr_b16 a[170:171], v89 offset:256
    ds_read_b64_tr_b16 a[176:177], v90 offset:0
    ds_read_b64_tr_b16 a[178:179], v90 offset:256
    ds_read_b64_tr_b16 a[184:185], v91 offset:0
    ds_read_b64_tr_b16 a[186:187], v91 offset:256
L_lw_50:
    s_waitcnt lgkmcnt(0)
    s_cmp_lg_u32 s44, 0
    s_cbranch_scc1 L_v_probe_51
    s_add_u32 s45, s63, 0
    s_memtime s[72:73]
    s_waitcnt lgkmcnt(0)
    s_load_dword s78, s[20:21], s45
    s_waitcnt lgkmcnt(0)
    s_memtime s[74:75]
    s_waitcnt lgkmcnt(0)
    s_sub_u32 s45, s74, s72
    s_min_u32 s76, s76, s45
    s_cmp_lt_u32 s77, s76
    s_cselect_b32 s68, 1, 0
L_v_probe_51:
    s_waitcnt vmcnt(32)
    s_barrier
    s_add_u32 s51, s69, 5
    s_and_b32 s51, s51, 7
    s_lshl_b32 s51, s51, 17
    s_add_u32 s51, s51, s49
    s_add_u32 s46, s51, 0x0
    s_add_u32 m0, s65, 65536
    s_nop 0
    buffer_load_dwordx4 v70, s[36:39], s46 offen  lds
    s_add_u32 s46, s51, 0x8000
    s_add_u32 m0, s65, 66560
    s_nop 0
    buffer_load_dwordx4 v71, s[36:39], s46 offen  lds
    s_add_u32 s46, s51, 0x10000
    s_add_u32 m0, s65, 67584
    s_nop 0
    buffer_load_dwordx4 v72, s[36:39], s46 offen  lds
    s_add_u32 s46, s51, 0x18000
    s_add_u32 m0, s65, 68608
    s_nop 0
    buffer_load_dwordx4 v73, s[36:39], s46 offen  lds
    ds_read_b64_tr_b16 a[164:165], v88 offset:4096
    ds_read_b64_tr_b16 a[166:167], v88 offset:4352
    ds_read_b64_tr_b16 a[172:173], v89 offset:4096
    ds_read_b64_tr_b16 a[174:175], v89 offset:4352
    ds_read_b64_tr_b16 a[180:181], v90 offset:4096
    ds_read_b64_tr_b16 a[182:183], v90 offset:4352
    ds_read_b64_tr_b16 a[188:189], v91 offset:4096
    ds_read_b64_tr_b16 a[190:191], v91 offset:4352
L_lw_52:
    s_waitcnt lgkmcnt(0)
    s_cmp_lg_u32 s44, 0
    s_cbranch_scc1 L_v_probe_53
    s_add_u32 s45, s63, 8192
    s_memtime s[72:73]
    s_waitcnt lgkmcnt(0)
    s_load_dword s78, s[20:21], s45
    s_waitcnt lgkmcnt(0)
    s_memtime s[74:75]
    s_waitcnt lgkmcnt(0)
    s_sub_u32 s45, s74, s72
    s_min_u32 s77, s77, s45
    s_cmp_lt_u32 s77, s76
    s_cselect_b32 s68, 1, 0
L_v_probe_53:
    s_waitcnt vmcnt(32)
    s_barrier
    s_add_u32 s51, s69, 5
    s_and_b32 s51, s51, 7
    s_lshl_b32 s51, s51, 17
    s_add_u32 s51, s51, s49
    s_add_u32 s46, s51, 0x4000
    s_add_u32 m0, s65, 69632
    s_nop 0
    buffer_load_dwordx4 v70, s[36:39], s46 offen  lds
    s_add_u32 s46, s51, 0xc000
    s_add_u32 m0, s65, 70656
    s_nop 0
    buffer_load_dwordx4 v71, s[36:39], s46 offen  lds
    s_add_u32 s46, s51, 0x14000
    s_add_u32 m0, s65, 71680
    s_nop 0
    buffer_load_dwordx4 v72, s[36:39], s46 offen  lds
    s_add_u32 s46, s51, 0x1c000
    s_add_u32 m0, s65, 72704
    s_nop 0
    buffer_load_dwordx4 v73, s[36:39], s46 offen  lds
    ds_read_b64_tr_b16 a[192:193], v88 offset:8192
    ds_read_b64_tr_b16 a[194:195], v88 offset:8448
    ds_read_b64_tr_b16 a[200:201], v89 offset:8192
    ds_read_b64_tr_b16 a[202:203], v89 offset:8448
    ds_read_b64_tr_b16 a[208:209], v90 offset:8192
    ds_read_b64_tr_b16 a[210:211], v90 offset:8448
    ds_read_b64_tr_b16 a[216:217], v91 offset:8192
    ds_read_b64_tr_b16 a[218:219], v91 offset:8448
L_lw_54:
    s_waitcnt lgkmcnt(0)
    s_cmp_lg_u32 s44, 0
    s_cbranch_scc1 L_v_probe_55
    s_add_u32 s45, s63, 128
    s_memtime s[72:73]
    s_waitcnt lgkmcnt(0)
    s_load_dword s78, s[20:21], s45
    s_waitcnt lgkmcnt(0)
    s_memtime s[74:75]
    s_waitcnt lgkmcnt(0)
    s_sub_u32 s45, s74, s72
    s_min_u32 s76, s76, s45
    s_cmp_lt_u32 s77, s76
    s_cselect_b32 s68, 1, 0
L_v_probe_55:
    s_waitcnt vmcnt(32)
    s_barrier
    s_add_u32 s51, s69, 6
    s_and_b32 s51, s51, 7
    s_lshl_b32 s51, s51, 17
    s_add_u32 s51, s51, s49
    s_add_u32 s46, s51, 0x0
    s_add_u32 m0, s65, 73728
    s_nop 0
    buffer_load_dwordx4 v70, s[36:39], s46 offen  lds
    s_add_u32 s46, s51, 0x8000
    s_add_u32 m0, s65, 74752
    s_nop 0
    buffer_load_dwordx4 v71, s[36:39], s46 offen  lds
    s_add_u32 s46, s51, 0x10000
    s_add_u32 m0, s65, 75776
    s_nop 0
    buffer_load_dwordx4 v72, s[36:39], s46 offen  lds
    s_add_u32 s46, s51, 0x18000
    s_add_u32 m0, s65, 76800
    s_nop 0
    buffer_load_dwordx4 v73, s[36:39], s46 offen  lds
    ds_read_b64_tr_b16 a[196:197], v88 offset:12288
    ds_read_b64_tr_b16 a[198:199], v88 offset:12544
    ds_read_b64_tr_b16 a[204:205], v89 offset:12288
    ds_read_b64_tr_b16 a[206:207], v89 offset:12544
    ds_read_b64_tr_b16 a[212:213], v90 offset:12288
    ds_read_b64_tr_b16 a[214:215], v90 offset:12544
    ds_read_b64_tr_b16 a[220:221], v91 offset:12288
    ds_read_b64_tr_b16 a[222:223], v91 offset:12544
L_lw_56:
    s_waitcnt lgkmcnt(0)
    s_cmp_lg_u32 s44, 0
    s_cbranch_scc1 L_v_probe_57
    s_add_u32 s45, s63, 8320
    s_memtime s[72:73]
    s_waitcnt lgkmcnt(0)
    s_load_dword s78, s[20:21], s45
    s_waitcnt lgkmcnt(0)
    s_memtime s[74:75]
    s_waitcnt lgkmcnt(0)
    s_sub_u32 s45, s74, s72
    s_min_u32 s77, s77, s45
    s_cmp_lt_u32 s77, s76
    s_cselect_b32 s68, 1, 0
L_v_probe_57:
    s_waitcnt vmcnt(32)
    s_barrier
    s_add_u32 s51, s69, 6
    s_and_b32 s51, s51, 7
    s_lshl_b32 s51, s51, 17
    s_add_u32 s51, s51, s49
    s_add_u32 s46, s51, 0x4000
    s_add_u32 m0, s65, 77824
    s_nop 0
    buffer_load_dwordx4 v70, s[36:39], s46 offen  lds
    s_add_u32 s46, s51, 0xc000
    s_add_u32 m0, s65, 78848
    s_nop 0
    buffer_load_dwordx4 v71, s[36:39], s46 offen  lds
    s_add_u32 s46, s51, 0x14000
    s_add_u32 m0, s65, 79872
    s_nop 0
    buffer_load_dwordx4 v72, s[36:39], s46 offen  lds
    s_add_u32 s46, s51, 0x1c000
    s_add_u32 m0, s65, 80896
    s_nop 0
    buffer_load_dwordx4 v73, s[36:39], s46 offen  lds
    ds_read_b64_tr_b16 a[224:225], v88 offset:16384
    ds_read_b64_tr_b16 a[226:227], v88 offset:16640
    ds_read_b64_tr_b16 a[232:233], v89 offset:16384
    ds_read_b64_tr_b16 a[234:235], v89 offset:16640
    ds_read_b64_tr_b16 a[240:241], v90 offset:16384
    ds_read_b64_tr_b16 a[242:243], v90 offset:16640
    ds_read_b64_tr_b16 a[248:249], v91 offset:16384
    ds_read_b64_tr_b16 a[250:251], v91 offset:16640
L_lw_58:
    s_waitcnt lgkmcnt(0)
    s_cmp_lg_u32 s44, 0
    s_cbranch_scc1 L_v_probe_59
    s_add_u32 s45, s63, 256
    s_memtime s[72:73]
    s_waitcnt lgkmcnt(0)
    s_load_dword s78, s[20:21], s45
    s_waitcnt lgkmcnt(0)
    s_memtime s[74:75]
    s_waitcnt lgkmcnt(0)
    s_sub_u32 s45, s74, s72
    s_min_u32 s76, s76, s45
    s_cmp_lt_u32 s77, s76
    s_cselect_b32 s68, 1, 0
L_v_probe_59:
    s_waitcnt vmcnt(32)
    s_barrier
    s_add_u32 s51, s69, 7
    s_and_b32 s51, s51, 7
    s_lshl_b32 s51, s51, 17
    s_add_u32 s51, s51, s49
    s_add_u32 s46, s51, 0x0
    s_add_u32 m0, s65, 81920
    s_nop 0
    buffer_load_dwordx4 v70, s[36:39], s46 offen  lds
    s_add_u32 s46, s51, 0x8000
    s_add_u32 m0, s65, 82944
    s_nop 0
    buffer_load_dwordx4 v71, s[36:39], s46 offen  lds
    s_add_u32 s46, s51, 0x10000
    s_add_u32 m0, s65, 83968
    s_nop 0
    buffer_load_dwordx4 v72, s[36:39], s46 offen  lds
    s_add_u32 s46, s51, 0x18000
    s_add_u32 m0, s65, 84992
    s_nop 0
    buffer_load_dwordx4 v73, s[36:39], s46 offen  lds
    ds_read_b64_tr_b16 a[228:229], v88 offset:20480
    ds_read_b64_tr_b16 a[230:231], v88 offset:20736
    ds_read_b64_tr_b16 a[236:237], v89 offset:20480
    ds_read_b64_tr_b16 a[238:239], v89 offset:20736
    ds_read_b64_tr_b16 a[244:245], v90 offset:20480
    ds_read_b64_tr_b16 a[246:247], v90 offset:20736
    ds_read_b64_tr_b16 a[252:253], v91 offset:20480
    ds_read_b64_tr_b16 a[254:255], v91 offset:20736
L_lw_60:
    s_waitcnt lgkmcnt(0)
    s_cmp_lg_u32 s44, 0
    s_cbranch_scc1 L_v_probe_61
    s_add_u32 s45, s63, 8448
    s_memtime s[72:73]
    s_waitcnt lgkmcnt(0)
    s_load_dword s78, s[20:21], s45
    s_waitcnt lgkmcnt(0)
    s_memtime s[74:75]
    s_waitcnt lgkmcnt(0)
    s_sub_u32 s45, s74, s72
    s_min_u32 s77, s77, s45
    s_cmp_lt_u32 s77, s76
    s_cselect_b32 s68, 1, 0
L_v_probe_61:
    s_waitcnt vmcnt(32)
    s_barrier
    s_add_u32 s51, s69, 7
    s_and_b32 s51, s51, 7
    s_lshl_b32 s51, s51, 17
    s_add_u32 s51, s51, s49
    s_add_u32 s46, s51, 0x4000
    s_add_u32 m0, s65, 86016
    s_nop 0
    buffer_load_dwordx4 v70, s[36:39], s46 offen  lds
    s_add_u32 s46, s51, 0xc000
    s_add_u32 m0, s65, 87040
    s_nop 0
    buffer_load_dwordx4 v71, s[36:39], s46 offen  lds
    s_add_u32 s46, s51, 0x14000
    s_add_u32 m0, s65, 88064
    s_nop 0
    buffer_load_dwordx4 v72, s[36:39], s46 offen  lds
    s_add_u32 s46, s51, 0x1c000
    s_add_u32 m0, s65, 89088
    s_nop 0
    buffer_load_dwordx4 v73, s[36:39], s46 offen  lds
    ds_read_b64_tr_b16 v[96:97], v74 offset:0
    ds_read_b64_tr_b16 v[98:99], v74 offset:256
    ds_read_b64_tr_b16 v[104:105], v75 offset:0
    ds_read_b64_tr_b16 v[106:107], v75 offset:256
    ds_read_b64_tr_b16 v[112:113], v76 offset:0
    ds_read_b64_tr_b16 v[114:115], v76 offset:256
    ds_read_b64_tr_b16 v[120:121], v77 offset:0
    ds_read_b64_tr_b16 v[122:123], v77 offset:256
L_lw_62:
    s_waitcnt lgkmcnt(0)
    s_waitcnt vmcnt(32)
    s_barrier
    s_add_u32 s79, s41, 0
    s_and_b32 s79, s79, 3
    s_lshl_b32 s79, s79, 19
    s_add_u32 s79, s79, s47
    s_add_u32 s46, s79, 0x0
    s_add_u32 m0, s48, 0
    s_nop 0
    buffer_load_dwordx4 v82, s[32:35], s46 offen  lds
    s_add_u32 s46, s79, 0x20000
    s_add_u32 m0, s48, 4096
    s_nop 0
    buffer_load_dwordx4 v82, s[32:35], s46 offen  lds
    s_add_u32 s46, s79, 0x40000
    s_add_u32 m0, s48, 8192
    s_nop 0
    buffer_load_dwordx4 v82, s[32:35], s46 offen  lds
    s_add_u32 s46, s79, 0x60000
    s_add_u32 m0, s48, 12288
    s_nop 0
    buffer_load_dwordx4 v82, s[32:35], s46 offen  lds
    ds_read_b64_tr_b16 v[100:101], v74 offset:16384
    ds_read_b64_tr_b16 v[102:103], v74 offset:16640
    ds_read_b64_tr_b16 v[108:109], v75 offset:16384
    ds_read_b64_tr_b16 v[110:111], v75 offset:16640
    ds_read_b64_tr_b16 v[116:117], v76 offset:16384
    ds_read_b64_tr_b16 v[118:119], v76 offset:16640
    ds_read_b64_tr_b16 v[124:125], v77 offset:16384
    ds_read_b64_tr_b16 v[126:127], v77 offset:16640
L_lw_63:
    s_waitcnt lgkmcnt(0)
    s_waitcnt vmcnt(32)
    s_barrier
    s_add_u32 s79, s41, 1
    s_and_b32 s79, s79, 3
    s_lshl_b32 s79, s79, 19
    s_add_u32 s79, s79, s47
    s_add_u32 s46, s79, 0x0
    s_add_u32 m0, s48, 16384
    s_nop 0
    buffer_load_dwordx4 v82, s[32:35], s46 offen  lds
    s_add_u32 s46, s79, 0x20000
    s_add_u32 m0, s48, 20480
    s_nop 0
    buffer_load_dwordx4 v82, s[32:35], s46 offen  lds
    s_add_u32 s46, s79, 0x40000
    s_add_u32 m0, s48, 24576
    s_nop 0
    buffer_load_dwordx4 v82, s[32:35], s46 offen  lds
    s_add_u32 s46, s79, 0x60000
    s_add_u32 m0, s48, 28672
    s_nop 0
    buffer_load_dwordx4 v82, s[32:35], s46 offen  lds
    ds_read_b64_tr_b16 v[128:129], v74 offset:32768
    ds_read_b64_tr_b16 v[130:131], v74 offset:33024
    ds_read_b64_tr_b16 v[136:137], v75 offset:32768
    ds_read_b64_tr_b16 v[138:139], v75 offset:33024
    ds_read_b64_tr_b16 v[144:145], v76 offset:32768
    ds_read_b64_tr_b16 v[146:147], v76 offset:33024
    ds_read_b64_tr_b16 v[152:153], v77 offset:32768
    ds_read_b64_tr_b16 v[154:155], v77 offset:33024
L_lw_64:
    s_waitcnt lgkmcnt(0)
    s_waitcnt vmcnt(32)
    s_barrier
    s_add_u32 s79, s41, 2
    s_and_b32 s79, s79, 3
    s_lshl_b32 s79, s79, 19
    s_add_u32 s79, s79, s47
    s_add_u32 s46, s79, 0x0
    s_add_u32 m0, s48, 32768
    s_nop 0
    buffer_load_dwordx4 v82, s[32:35], s46 offen  lds
    s_add_u32 s46, s79, 0x20000
    s_add_u32 m0, s48, 36864
    s_nop 0
    buffer_load_dwordx4 v82, s[32:35], s46 offen  lds
    s_add_u32 s46, s79, 0x40000
    s_add_u32 m0, s48, 40960
    s_nop 0
    buffer_load_dwordx4 v82, s[32:35], s46 offen  lds
    s_add_u32 s46, s79, 0x60000
    s_add_u32 m0, s48, 45056
    s_nop 0
    buffer_load_dwordx4 v82, s[32:35], s46 offen  lds
    ds_read_b64_tr_b16 v[132:133], v74 offset:49152
    ds_read_b64_tr_b16 v[134:135], v74 offset:49408
    ds_read_b64_tr_b16 v[140:141], v75 offset:49152
    ds_read_b64_tr_b16 v[142:143], v75 offset:49408
    ds_read_b64_tr_b16 v[148:149], v76 offset:49152
    ds_read_b64_tr_b16 v[150:151], v76 offset:49408
    ds_read_b64_tr_b16 v[156:157], v77 offset:49152
    ds_read_b64_tr_b16 v[158:159], v77 offset:49408
L_lw_65:
    s_waitcnt lgkmcnt(0)
    s_waitcnt vmcnt(32)
    s_barrier
    s_add_u32 s79, s41, 3
    s_and_b32 s79, s79, 3
    s_lshl_b32 s79, s79, 19
    s_add_u32 s79, s79, s47
    s_add_u32 s46, s79, 0x0
    s_add_u32 m0, s48, 49152
    s_nop 0
    buffer_load_dwordx4 v82, s[32:35], s46 offen  lds
    s_add_u32 s46, s79, 0x20000
    s_add_u32 m0, s48, 53248
    s_nop 0
    buffer_load_dwordx4 v82, s[32:35], s46 offen  lds
    s_add_u32 s46, s79, 0x40000
    s_add_u32 m0, s48, 57344
    s_nop 0
    buffer_load_dwordx4 v82, s[32:35], s46 offen  lds
    s_add_u32 s46, s79, 0x60000
    s_add_u32 m0, s48, 61440
    s_nop 0
    buffer_load_dwordx4 v82, s[32:35], s46 offen  lds
    ds_read_b64_tr_b16 v[160:161], v88 offset:0
    ds_read_b64_tr_b16 v[162:163], v88 offset:256
    ds_read_b64_tr_b16 v[168:169], v89 offset:0
    ds_read_b64_tr_b16 v[170:171], v89 offset:256
    ds_read_b64_tr_b16 v[176:177], v90 offset:0
    ds_read_b64_tr_b16 v[178:179], v90 offset:256
    ds_read_b64_tr_b16 v[184:185], v91 offset:0
    ds_read_b64_tr_b16 v[186:187], v91 offset:256
L_lw_66:
    s_waitcnt lgkmcnt(0)
    s_waitcnt vmcnt(32)
    s_barrier
    s_cmp_lg_u32 s44, 0
    s_cbranch_scc1 L_hs_67
    s_getreg_b32 s45, hwreg(HW_REG_XCC_ID)
    s_and_b32 s45, s45, 15
    s_mul_i32 s46, s45, s45
    s_lshl_b32 s46, s46, 9
    s_add_u32 s45, s45, s46
    s_cmp_eq_u32 s40, 0
    s_cselect_b32 s46, s45, 0
    s_cselect_b32 s45, 0, s45
    s_lshl_b32 s68, s68, 24
    s_add_u32 s46, s46, s68
    s_add_u32 s45, s45, 16777216
    v_mov_b32 v40, s46
    v_mov_b32 v41, s45
    v_mov_b32 v42, 0
    s_mov_b64 exec, 1
    buffer_atomic_add_x2 v[40:41], v42, s[16:19], 0 offen sc1
    s_mov_b64 exec, -1
L_hs_67:
    ds_read_b64_tr_b16 v[164:165], v88 offset:4096
    ds_read_b64_tr_b16 v[166:167], v88 offset:4352
    ds_read_b64_tr_b16 v[172:173], v89 offset:4096
    ds_read_b64_tr_b16 v[174:175], v89 offset:4352
    ds_read_b64_tr_b16 v[180:181], v90 offset:4096
    ds_read_b64_tr_b16 v[182:183], v90 offset:4352
    ds_read_b64_tr_b16 v[188:189], v91 offset:4096
    ds_read_b64_tr_b16 v[190:191], v91 offset:4352
L_lw_68:
    s_waitcnt lgkmcnt(0)
    s_waitcnt vmcnt(28)
    s_barrier
    ds_read_b64_tr_b16 v[192:193], v88 offset:8192
    ds_read_b64_tr_b16 v[194:195], v88 offset:8448
    ds_read_b64_tr_b16 v[200:201], v89 offset:8192
    ds_read_b64_tr_b16 v[202:203], v89 offset:8448
    ds_read_b64_tr_b16 v[208:209], v90 offset:8192
    ds_read_b64_tr_b16 v[210:211], v90 offset:8448
    ds_read_b64_tr_b16 v[216:217], v91 offset:8192
    ds_read_b64_tr_b16 v[218:219], v91 offset:8448
L_lw_69:
    s_waitcnt lgkmcnt(0)
    s_waitcnt vmcnt(24)
    s_barrier
    ds_read_b64_tr_b16 v[196:197], v88 offset:12288
    ds_read_b64_tr_b16 v[198:199], v88 offset:12544
    ds_read_b64_tr_b16 v[204:205], v89 offset:12288
    ds_read_b64_tr_b16 v[206:207], v89 offset:12544
    ds_read_b64_tr_b16 v[212:213], v90 offset:12288
    ds_read_b64_tr_b16 v[214:215], v90 offset:12544
    ds_read_b64_tr_b16 v[220:221], v91 offset:12288
    ds_read_b64_tr_b16 v[222:223], v91 offset:12544
L_lw_70:
    s_waitcnt lgkmcnt(0)
    s_waitcnt vmcnt(20)
    s_barrier
    ds_read_b64_tr_b16 v[224:225], v88 offset:16384
    ds_read_b64_tr_b16 v[226:227], v88 offset:16640
    ds_read_b64_tr_b16 v[232:233], v89 offset:16384
    ds_read_b64_tr_b16 v[234:235], v89 offset:16640
    ds_read_b64_tr_b16 v[240:241], v90 offset:16384
    ds_read_b64_tr_b16 v[242:243], v90 offset:16640
    ds_read_b64_tr_b16 v[248:249], v91 offset:16384
    ds_read_b64_tr_b16 v[250:251], v91 offset:16640
L_lw_71:
    s_waitcnt lgkmcnt(0)
    s_waitcnt vmcnt(16)
    s_barrier
    ds_read_b64_tr_b16 v[228:229], v88 offset:20480
    ds_read_b64_tr_b16 v[230:231], v88 offset:20736
    ds_read_b64_tr_b16 v[236:237], v89 offset:20480
    ds_read_b64_tr_b16 v[238:239], v89 offset:20736
    ds_read_b64_tr_b16 v[244:245], v90 offset:20480
    ds_read_b64_tr_b16 v[246:247], v90 offset:20736
    ds_read_b64_tr_b16 v[252:253], v91 offset:20480
    ds_read_b64_tr_b16 v[254:255], v91 offset:20736
L_lw_72:
    s_waitcnt lgkmcnt(0)
    s_waitcnt vmcnt(12)
    s_barrier
    s_cmp_lg_u32 s44, 0
    s_cbranch_scc1 L_lw_73_0
    ds_read_b64_tr_b16 a[0:1], v80 offset:0
    ds_read_b64_tr_b16 a[2:3], v80 offset:1024
    ds_read_b64_tr_b16 a[4:5], v80 offset:8192
    ds_read_b64_tr_b16 a[6:7], v80 offset:9216
    ds_read_b64_tr_b16 a[8:9], v81 offset:0
    ds_read_b64_tr_b16 a[10:11], v81 offset:1024
    ds_read_b64_tr_b16 a[12:13], v81 offset:8192
    ds_read_b64_tr_b16 a[14:15], v81 offset:9216
    s_branch L_lw_73
L_lw_73_0:
    s_cmp_lg_u32 s44, 1
    s_cbranch_scc1 L_lw_73_1
    ds_read_b64_tr_b16 a[120:121], v80 offset:0
    ds_read_b64_tr_b16 a[122:123], v80 offset:1024
    ds_read_b64_tr_b16 a[124:125], v80 offset:8192
    ds_read_b64_tr_b16 a[126:127], v80 offset:9216
    ds_read_b64_tr_b16 v[56:57], v81 offset:0
    ds_read_b64_tr_b16 v[58:59], v81 offset:1024
    ds_read_b64_tr_b16 v[60:61], v81 offset:8192
    ds_read_b64_tr_b16 v[62:63], v81 offset:9216
    s_waitcnt lgkmcnt(0)
    ds_write_b128 v5, v[56:59] offset:0
    ds_write_b128 v5, v[60:63] offset:1024
    s_branch L_lw_73
L_lw_73_1:
    s_cmp_lg_u32 s44, 2
    s_cbranch_scc1 L_lw_73_2
    ds_read_b64_tr_b16 a[80:81], v80 offset:0
    ds_read_b64_tr_b16 a[82:83], v80 offset:1024
    ds_read_b64_tr_b16 a[84:85], v80 offset:8192
    ds_read_b64_tr_b16 a[86:87], v80 offset:9216
    ds_read_b64_tr_b16 v[56:57], v81 offset:0
    ds_read_b64_tr_b16 v[58:59], v81 offset:1024
    ds_read_b64_tr_b16 v[60:61], v81 offset:8192
    ds_read_b64_tr_b16 v[62:63], v81 offset:9216
    s_waitcnt lgkmcnt(0)
    ds_write_b128 v5, v[56:59] offset:2048
    ds_write_b128 v5, v[60:63] offset:3072
    s_branch L_lw_73
L_lw_73_2:
    ds_read_b64_tr_b16 a[48:49], v80 offset:0
    ds_read_b64_tr_b16 a[50:51], v80 offset:1024
    ds_read_b64_tr_b16 a[52:53], v80 offset:8192
    ds_read_b64_tr_b16 a[54:55], v80 offset:9216
    ds_read_b64_tr_b16 v[56:57], v81 offset:0
    ds_read_b64_tr_b16 v[58:59], v81 offset:1024
    ds_read_b64_tr_b16 v[60:61], v81 offset:8192
    ds_read_b64_tr_b16 v[62:63], v81 offset:9216
    s_waitcnt lgkmcnt(0)
    ds_write_b128 v5, v[56:59] offset:4096
    ds_write_b128 v5, v[60:63] offset:5120
L_lw_73:
    s_waitcnt lgkmcnt(0)
    s_waitcnt vmcnt(8)
    s_barrier
    s_add_u32 s79, s41, 4
    s_and_b32 s79, s79, 3
    s_lshl_b32 s79, s79, 19
    s_add_u32 s79, s79, s47
    s_add_u32 s46, s79, 0x200000
    s_add_u32 m0, s48, 0
    s_nop 0
    buffer_load_dwordx4 v82, s[32:35], s46 offen  lds
    s_add_u32 s46, s79, 0x220000
    s_add_u32 m0, s48, 4096
    s_nop 0
    buffer_load_dwordx4 v82, s[32:35], s46 offen  lds
    s_add_u32 s46, s79, 0x240000
    s_add_u32 m0, s48, 8192
    s_nop 0
    buffer_load_dwordx4 v82, s[32:35], s46 offen  lds
    s_add_u32 s46, s79, 0x260000
    s_add_u32 m0, s48, 12288
    s_nop 0
    buffer_load_dwordx4 v82, s[32:35], s46 offen  lds
    s_cmp_lg_u32 s44, 0
    s_cbranch_scc1 L_lw_74_0
    ds_read_b64_tr_b16 a[16:17], v80 offset:16384
    ds_read_b64_tr_b16 a[18:19], v80 offset:17408
    ds_read_b64_tr_b16 a[20:21], v80 offset:24576
    ds_read_b64_tr_b16 a[22:23], v80 offset:25600
    ds_read_b64_tr_b16 a[24:25], v81 offset:16384
    ds_read_b64_tr_b16 a[26:27], v81 offset:17408
    ds_read_b64_tr_b16 a[28:29], v81 offset:24576
    ds_read_b64_tr_b16 a[30:31], v81 offset:25600
    s_branch L_lw_74
L_lw_74_0:
    s_cmp_lg_u32 s44, 1
    s_cbranch_scc1 L_lw_74_1
    ds_read_b64_tr_b16 a[128:129], v80 offset:16384
    ds_read_b64_tr_b16 a[130:131], v80 offset:17408
    ds_read_b64_tr_b16 a[132:133], v80 offset:24576
    ds_read_b64_tr_b16 a[134:135], v80 offset:25600
    ds_read_b64_tr_b16 a[136:137], v81 offset:16384
    ds_read_b64_tr_b16 a[138:139], v81 offset:17408
    ds_read_b64_tr_b16 a[140:141], v81 offset:24576
    ds_read_b64_tr_b16 a[142:143], v81 offset:25600
    s_branch L_lw_74
L_lw_74_1:
    s_cmp_lg_u32 s44, 2
    s_cbranch_scc1 L_lw_74_2
    ds_read_b64_tr_b16 a[88:89], v80 offset:16384
    ds_read_b64_tr_b16 a[90:91], v80 offset:17408
    ds_read_b64_tr_b16 a[92:93], v80 offset:24576
    ds_read_b64_tr_b16 a[94:95], v80 offset:25600
    ds_read_b64_tr_b16 a[96:97], v81 offset:16384
    ds_read_b64_tr_b16 a[98:99], v81 offset:17408
    ds_read_b64_tr_b16 a[100:101], v81 offset:24576
    ds_read_b64_tr_b16 a[102:103], v81 offset:25600
    s_branch L_lw_74
L_lw_74_2:
    ds_read_b64_tr_b16 a[56:57], v80 offset:16384
    ds_read_b64_tr_b16 a[58:59], v80 offset:17408
    ds_read_b64_tr_b16 a[60:61], v80 offset:24576
    ds_read_b64_tr_b16 a[62:63], v80 offset:25600
    ds_read_b64_tr_b16 v[56:57], v81 offset:16384
    ds_read_b64_tr_b16 v[58:59], v81 offset:17408
    ds_read_b64_tr_b16 v[60:61], v81 offset:24576
    ds_read_b64_tr_b16 v[62:63], v81 offset:25600
    s_waitcnt lgkmcnt(0)
    ds_write_b128 v5, v[56:59] offset:6144
    ds_write_b128 v5, v[60:63] offset:7168
L_lw_74:
    s_waitcnt lgkmcnt(0)
    s_waitcnt vmcnt(8)
    s_barrier
    s_add_u32 s79, s41, 5
    s_and_b32 s79, s79, 3
    s_lshl_b32 s79, s79, 19
    s_add_u32 s79, s79, s47
    s_add_u32 s46, s79, 0x200000
    s_add_u32 m0, s48, 16384
    s_nop 0
    buffer_load_dwordx4 v82, s[32:35], s46 offen  lds
    s_add_u32 s46, s79, 0x220000
    s_add_u32 m0, s48, 20480
    s_nop 0
    buffer_load_dwordx4 v82, s[32:35], s46 offen  lds
    s_add_u32 s46, s79, 0x240000
    s_add_u32 m0, s48, 24576
    s_nop 0
    buffer_load_dwordx4 v82, s[32:35], s46 offen  lds
    s_add_u32 s46, s79, 0x260000
    s_add_u32 m0, s48, 28672
    s_nop 0
    buffer_load_dwordx4 v82, s[32:35], s46 offen  lds
    s_cmp_lg_u32 s44, 0
    s_cbranch_scc1 L_lw_75_0
    ds_read_b64_tr_b16 a[32:33], v80 offset:32768
    ds_read_b64_tr_b16 a[34:35], v80 offset:33792
    ds_read_b64_tr_b16 a[36:37], v80 offset:40960
    ds_read_b64_tr_b16 a[38:39], v80 offset:41984
    ds_read_b64_tr_b16 v[56:57], v81 offset:32768
    ds_read_b64_tr_b16 v[58:59], v81 offset:33792
    ds_read_b64_tr_b16 v[60:61], v81 offset:40960
    ds_read_b64_tr_b16 v[62:63], v81 offset:41984
    s_waitcnt lgkmcnt(0)
    ds_write_b128 v5, v[56:59] offset:8192
    ds_write_b128 v5, v[60:63] offset:9216
    s_branch L_lw_75
L_lw_75_0:
    s_cmp_lg_u32 s44, 1
    s_cbranch_scc1 L_lw_75_1
    ds_read_b64_tr_b16 a[144:145], v80 offset:32768
    ds_read_b64_tr_b16 a[146:147], v80 offset:33792
    ds_read_b64_tr_b16 a[148:149], v80 offset:40960
    ds_read_b64_tr_b16 a[150:151], v80 offset:41984
    ds_read_b64_tr_b16 v[56:57], v81 offset:32768
    ds_read_b64_tr_b16 v[58:59], v81 offset:33792
    ds_read_b64_tr_b16 v[60:61], v81 offset:40960
    ds_read_b64_tr_b16 v[62:63], v81 offset:41984
    s_waitcnt lgkmcnt(0)
    ds_write_b128 v5, v[56:59] offset:10240
    ds_write_b128 v5, v[60:63] offset:11264
    s_branch L_lw_75
L_lw_75_1:
    s_cmp_lg_u32 s44, 2
    s_cbranch_scc1 L_lw_75_2
    ds_read_b64_tr_b16 a[104:105], v80 offset:32768
    ds_read_b64_tr_b16 a[106:107], v80 offset:33792
    ds_read_b64_tr_b16 a[108:109], v80 offset:40960
    ds_read_b64_tr_b16 a[110:111], v80 offset:41984
    ds_read_b64_tr_b16 v[56:57], v81 offset:32768
    ds_read_b64_tr_b16 v[58:59], v81 offset:33792
    ds_read_b64_tr_b16 v[60:61], v81 offset:40960
    ds_read_b64_tr_b16 v[62:63], v81 offset:41984
    s_waitcnt lgkmcnt(0)
    ds_write_b128 v5, v[56:59] offset:12288
    ds_write_b128 v5, v[60:63] offset:13312
    s_branch L_lw_75
L_lw_75_2:
    ds_read_b64_tr_b16 a[64:65], v80 offset:32768
    ds_read_b64_tr_b16 a[66:67], v80 offset:33792
    ds_read_b64_tr_b16 a[68:69], v80 offset:40960
    ds_read_b64_tr_b16 a[70:71], v80 offset:41984
    ds_read_b64_tr_b16 v[56:57], v81 offset:32768
    ds_read_b64_tr_b16 v[58:59], v81 offset:33792
    ds_read_b64_tr_b16 v[60:61], v81 offset:40960
    ds_read_b64_tr_b16 v[62:63], v81 offset:41984
    s_waitcnt lgkmcnt(0)
    ds_write_b128 v5, v[56:59] offset:14336
    ds_write_b128 v5, v[60:63] offset:15360
L_lw_75:
    s_waitcnt lgkmcnt(0)
    s_waitcnt vmcnt(8)
    s_barrier
    s_add_u32 s79, s41, 6
    s_and_b32 s79, s79, 3
    s_lshl_b32 s79, s79, 19
    s_add_u32 s79, s79, s47
    s_add_u32 s46, s79, 0x200000
    s_add_u32 m0, s48, 32768
    s_nop 0
    buffer_load_dwordx4 v82, s[32:35], s46 offen  lds
    s_add_u32 s46, s79, 0x220000
    s_add_u32 m0, s48, 36864
    s_nop 0
    buffer_load_dwordx4 v82, s[32:35], s46 offen  lds
    s_add_u32 s46, s79, 0x240000
    s_add_u32 m0, s48, 40960
    s_nop 0
    buffer_load_dwordx4 v82, s[32:35], s46 offen  lds
    s_add_u32 s46, s79, 0x260000
    s_add_u32 m0, s48, 45056
    s_nop 0
    buffer_load_dwordx4 v82, s[32:35], s46 offen  lds
    s_cmp_lg_u32 s44, 0
    s_cbranch_scc1 L_lw_76_0
    ds_read_b64_tr_b16 a[40:41], v80 offset:49152
    ds_read_b64_tr_b16 a[42:43], v80 offset:50176
    ds_read_b64_tr_b16 a[44:45], v80 offset:57344
    ds_read_b64_tr_b16 a[46:47], v80 offset:58368
    ds_read_b64_tr_b16 v[56:57], v81 offset:49152
    ds_read_b64_tr_b16 v[58:59], v81 offset:50176
    ds_read_b64_tr_b16 v[60:61], v81 offset:57344
    ds_read_b64_tr_b16 v[62:63], v81 offset:58368
    s_waitcnt lgkmcnt(0)
    ds_write_b128 v5, v[56:59] offset:16384
    ds_write_b128 v5, v[60:63] offset:17408
    s_branch L_lw_76
L_lw_76_0:
    s_cmp_lg_u32 s44, 1
    s_cbranch_scc1 L_lw_76_1
    ds_read_b64_tr_b16 a[152:153], v80 offset:49152
    ds_read_b64_tr_b16 a[154:155], v80 offset:50176
    ds_read_b64_tr_b16 a[156:157], v80 offset:57344
    ds_read_b64_tr_b16 a[158:159], v80 offset:58368
    ds_read_b64_tr_b16 v[56:57], v81 offset:49152
    ds_read_b64_tr_b16 v[58:59], v81 offset:50176
    ds_read_b64_tr_b16 v[60:61], v81 offset:57344
    ds_read_b64_tr_b16 v[62:63], v81 offset:58368
    s_waitcnt lgkmcnt(0)
    ds_write_b128 v5, v[56:59] offset:18432
    ds_write_b128 v5, v[60:63] offset:19456
    s_branch L_lw_76
L_lw_76_1:
    s_cmp_lg_u32 s44, 2
    s_cbranch_scc1 L_lw_76_2
    ds_read_b64_tr_b16 a[112:113], v80 offset:49152
    ds_read_b64_tr_b16 a[114:115], v80 offset:50176
    ds_read_b64_tr_b16 a[116:117], v80 offset:57344
    ds_read_b64_tr_b16 a[118:119], v80 offset:58368
    ds_read_b64_tr_b16 v[56:57], v81 offset:49152
    ds_read_b64_tr_b16 v[58:59], v81 offset:50176
    ds_read_b64_tr_b16 v[60:61], v81 offset:57344
    ds_read_b64_tr_b16 v[62:63], v81 offset:58368
    s_waitcnt lgkmcnt(0)
    ds_write_b128 v5, v[56:59] offset:20480
    ds_write_b128 v5, v[60:63] offset:21504
    s_branch L_lw_76
L_lw_76_2:
    ds_read_b64_tr_b16 a[72:73], v80 offset:49152
    ds_read_b64_tr_b16 a[74:75], v80 offset:50176
    ds_read_b64_tr_b16 a[76:77], v80 offset:57344
    ds_read_b64_tr_b16 a[78:79], v80 offset:58368
    ds_read_b64_tr_b16 v[56:57], v81 offset:49152
    ds_read_b64_tr_b16 v[58:59], v81 offset:50176
    ds_read_b64_tr_b16 v[60:61], v81 offset:57344
    ds_read_b64_tr_b16 v[62:63], v81 offset:58368
    s_waitcnt lgkmcnt(0)
    ds_write_b128 v5, v[56:59] offset:22528
    ds_write_b128 v5, v[60:63] offset:23552
L_lw_76:
    s_waitcnt lgkmcnt(0)
    s_waitcnt vmcnt(8)
    s_barrier
    s_add_u32 s79, s41, 7
    s_and_b32 s79, s79, 3
    s_lshl_b32 s79, s79, 19
    s_add_u32 s79, s79, s47
    s_add_u32 s46, s79, 0x200000
    s_add_u32 m0, s48, 49152
    s_nop 0
    buffer_load_dwordx4 v82, s[32:35], s46 offen  lds
    s_add_u32 s46, s79, 0x220000
    s_add_u32 m0, s48, 53248
    s_nop 0
    buffer_load_dwordx4 v82, s[32:35], s46 offen  lds
    s_add_u32 s46, s79, 0x240000
    s_add_u32 m0, s48, 57344
    s_nop 0
    buffer_load_dwordx4 v82, s[32:35], s46 offen  lds
    s_add_u32 s46, s79, 0x260000
    s_add_u32 m0, s48, 61440
    s_nop 0
    buffer_load_dwordx4 v82, s[32:35], s46 offen  lds
    s_cmp_lg_u32 s44, 0
    s_cbranch_scc1 L_lw_77_0
    ds_read_b64_tr_b16 a[48:49], v80 offset:0
    ds_read_b64_tr_b16 a[50:51], v80 offset:1024
    ds_read_b64_tr_b16 a[52:53], v80 offset:8192
    ds_read_b64_tr_b16 a[54:55], v80 offset:9216
    ds_read_b64_tr_b16 v[56:57], v81 offset:0
    ds_read_b64_tr_b16 v[58:59], v81 offset:1024
    ds_read_b64_tr_b16 v[60:61], v81 offset:8192
    ds_read_b64_tr_b16 v[62:63], v81 offset:9216
    s_waitcnt lgkmcnt(0)
    ds_write_b128 v5, v[56:59] offset:4096
    ds_write_b128 v5, v[60:63] offset:5120
    s_branch L_lw_77
L_lw_77_0:
    s_cmp_lg_u32 s44, 1
    s_cbranch_scc1 L_lw_77_1
    ds_read_b64_tr_b16 a[0:1], v80 offset:0
    ds_read_b64_tr_b16 a[2:3], v80 offset:1024
    ds_read_b64_tr_b16 a[4:5], v80 offset:8192
    ds_read_b64_tr_b16 a[6:7], v80 offset:9216
    ds_read_b64_tr_b16 a[8:9], v81 offset:0
    ds_read_b64_tr_b16 a[10:11], v81 offset:1024
    ds_read_b64_tr_b16 a[12:13], v81 offset:8192
    ds_read_b64_tr_b16 a[14:15], v81 offset:9216
    s_branch L_lw_77
L_lw_77_1:
    s_cmp_lg_u32 s44, 2
    s_cbranch_scc1 L_lw_77_2
    ds_read_b64_tr_b16 a[120:121], v80 offset:0
    ds_read_b64_tr_b16 a[122:123], v80 offset:1024
    ds_read_b64_tr_b16 a[124:125], v80 offset:8192
    ds_read_b64_tr_b16 a[126:127], v80 offset:9216
    ds_read_b64_tr_b16 v[56:57], v81 offset:0
    ds_read_b64_tr_b16 v[58:59], v81 offset:1024
    ds_read_b64_tr_b16 v[60:61], v81 offset:8192
    ds_read_b64_tr_b16 v[62:63], v81 offset:9216
    s_waitcnt lgkmcnt(0)
    ds_write_b128 v5, v[56:59] offset:0
    ds_write_b128 v5, v[60:63] offset:1024
    s_branch L_lw_77
L_lw_77_2:
    ds_read_b64_tr_b16 a[80:81], v80 offset:0
    ds_read_b64_tr_b16 a[82:83], v80 offset:1024
    ds_read_b64_tr_b16 a[84:85], v80 offset:8192
    ds_read_b64_tr_b16 a[86:87], v80 offset:9216
    ds_read_b64_tr_b16 v[56:57], v81 offset:0
    ds_read_b64_tr_b16 v[58:59], v81 offset:1024
    ds_read_b64_tr_b16 v[60:61], v81 offset:8192
    ds_read_b64_tr_b16 v[62:63], v81 offset:9216
    s_waitcnt lgkmcnt(0)
    ds_write_b128 v5, v[56:59] offset:2048
    ds_write_b128 v5, v[60:63] offset:3072
L_lw_77:
    s_waitcnt lgkmcnt(0)
    s_waitcnt vmcnt(8)
    s_barrier
    s_add_u32 s79, s41, 8
    s_and_b32 s79, s79, 3
    s_lshl_b32 s79, s79, 19
    s_add_u32 s79, s79, s47
    s_add_u32 s46, s79, 0x400000
    s_add_u32 m0, s48, 0
    s_nop 0
    buffer_load_dwordx4 v82, s[32:35], s46 offen  lds
    s_add_u32 s46, s79, 0x420000
    s_add_u32 m0, s48, 4096
    s_nop 0
    buffer_load_dwordx4 v82, s[32:35], s46 offen  lds
    s_add_u32 s46, s79, 0x440000
    s_add_u32 m0, s48, 8192
    s_nop 0
    buffer_load_dwordx4 v82, s[32:35], s46 offen  lds
    s_add_u32 s46, s79, 0x460000
    s_add_u32 m0, s48, 12288
    s_nop 0
    buffer_load_dwordx4 v82, s[32:35], s46 offen  lds
    s_cmp_lg_u32 s44, 0
    s_cbranch_scc1 L_lw_78_0
    ds_read_b64_tr_b16 a[56:57], v80 offset:16384
    ds_read_b64_tr_b16 a[58:59], v80 offset:17408
    ds_read_b64_tr_b16 a[60:61], v80 offset:24576
    ds_read_b64_tr_b16 a[62:63], v80 offset:25600
    ds_read_b64_tr_b16 v[56:57], v81 offset:16384
    ds_read_b64_tr_b16 v[58:59], v81 offset:17408
    ds_read_b64_tr_b16 v[60:61], v81 offset:24576
    ds_read_b64_tr_b16 v[62:63], v81 offset:25600
    s_waitcnt lgkmcnt(0)
    ds_write_b128 v5, v[56:59] offset:6144
    ds_write_b128 v5, v[60:63] offset:7168
    s_branch L_lw_78
L_lw_78_0:
    s_cmp_lg_u32 s44, 1
    s_cbranch_scc1 L_lw_78_1
    ds_read_b64_tr_b16 a[16:17], v80 offset:16384
    ds_read_b64_tr_b16 a[18:19], v80 offset:17408
    ds_read_b64_tr_b16 a[20:21], v80 offset:24576
    ds_read_b64_tr_b16 a[22:23], v80 offset:25600
    ds_read_b64_tr_b16 a[24:25], v81 offset:16384
    ds_read_b64_tr_b16 a[26:27], v81 offset:17408
    ds_read_b64_tr_b16 a[28:29], v81 offset:24576
    ds_read_b64_tr_b16 a[30:31], v81 offset:25600
    s_branch L_lw_78
L_lw_78_1:
    s_cmp_lg_u32 s44, 2
    s_cbranch_scc1 L_lw_78_2
    ds_read_b64_tr_b16 a[128:129], v80 offset:16384
    ds_read_b64_tr_b16 a[130:131], v80 offset:17408
    ds_read_b64_tr_b16 a[132:133], v80 offset:24576
    ds_read_b64_tr_b16 a[134:135], v80 offset:25600
    ds_read_b64_tr_b16 a[136:137], v81 offset:16384
    ds_read_b64_tr_b16 a[138:139], v81 offset:17408
    ds_read_b64_tr_b16 a[140:141], v81 offset:24576
    ds_read_b64_tr_b16 a[142:143], v81 offset:25600
    s_branch L_lw_78
L_lw_78_2:
    ds_read_b64_tr_b16 a[88:89], v80 offset:16384
    ds_read_b64_tr_b16 a[90:91], v80 offset:17408
    ds_read_b64_tr_b16 a[92:93], v80 offset:24576
    ds_read_b64_tr_b16 a[94:95], v80 offset:25600
    ds_read_b64_tr_b16 a[96:97], v81 offset:16384
    ds_read_b64_tr_b16 a[98:99], v81 offset:17408
    ds_read_b64_tr_b16 a[100:101], v81 offset:24576
    ds_read_b64_tr_b16 a[102:103], v81 offset:25600
L_lw_78:
    s_waitcnt lgkmcnt(0)
    s_waitcnt vmcnt(8)
    s_barrier
    s_add_u32 s79, s41, 9
    s_and_b32 s79, s79, 3
    s_lshl_b32 s79, s79, 19
    s_add_u32 s79, s79, s47
    s_add_u32 s46, s79, 0x400000
    s_add_u32 m0, s48, 16384
    s_nop 0
    buffer_load_dwordx4 v82, s[32:35], s46 offen  lds
    s_add_u32 s46, s79, 0x420000
    s_add_u32 m0, s48, 20480
    s_nop 0
    buffer_load_dwordx4 v82, s[32:35], s46 offen  lds
    s_add_u32 s46, s79, 0x440000
    s_add_u32 m0, s48, 24576
    s_nop 0
    buffer_load_dwordx4 v82, s[32:35], s46 offen  lds
    s_add_u32 s46, s79, 0x460000
    s_add_u32 m0, s48, 28672
    s_nop 0
    buffer_load_dwordx4 v82, s[32:35], s46 offen  lds
    s_cmp_lg_u32 s44, 0
    s_cbranch_scc1 L_lw_79_0
    ds_read_b64_tr_b16 a[64:65], v80 offset:32768
    ds_read_b64_tr_b16 a[66:67], v80 offset:33792
    ds_read_b64_tr_b16 a[68:69], v80 offset:40960
    ds_read_b64_tr_b16 a[70:71], v80 offset:41984
    ds_read_b64_tr_b16 v[56:57], v81 offset:32768
    ds_read_b64_tr_b16 v[58:59], v81 offset:33792
    ds_read_b64_tr_b16 v[60:61], v81 offset:40960
    ds_read_b64_tr_b16 v[62:63], v81 offset:41984
    s_waitcnt lgkmcnt(0)
    ds_write_b128 v5, v[56:59] offset:14336
    ds_write_b128 v5, v[60:63] offset:15360
    s_branch L_lw_79
L_lw_79_0:
    s_cmp_lg_u32 s44, 1
    s_cbranch_scc1 L_lw_79_1
    ds_read_b64_tr_b16 a[32:33], v80 offset:32768
    ds_read_b64_tr_b16 a[34:35], v80 offset:33792
    ds_read_b64_tr_b16 a[36:37], v80 offset:40960
    ds_read_b64_tr_b16 a[38:39], v80 offset:41984
    ds_read_b64_tr_b16 v[56:57], v81 offset:32768
    ds_read_b64_tr_b16 v[58:59], v81 offset:33792
    ds_read_b64_tr_b16 v[60:61], v81 offset:40960
    ds_read_b64_tr_b16 v[62:63], v81 offset:41984
    s_waitcnt lgkmcnt(0)
    ds_write_b128 v5, v[56:59] offset:8192
    ds_write_b128 v5, v[60:63] offset:9216
    s_branch L_lw_79
L_lw_79_1:
    s_cmp_lg_u32 s44, 2
    s_cbranch_scc1 L_lw_79_2
    ds_read_b64_tr_b16 a[144:145], v80 offset:32768
    ds_read_b64_tr_b16 a[146:147], v80 offset:33792
    ds_read_b64_tr_b16 a[148:149], v80 offset:40960
    ds_read_b64_tr_b16 a[150:151], v80 offset:41984
    ds_read_b64_tr_b16 v[56:57], v81 offset:32768
    ds_read_b64_tr_b16 v[58:59], v81 offset:33792
    ds_read_b64_tr_b16 v[60:61], v81 offset:40960
    ds_read_b64_tr_b16 v[62:63], v81 offset:41984
    s_waitcnt lgkmcnt(0)
    ds_write_b128 v5, v[56:59] offset:10240
    ds_write_b128 v5, v[60:63] offset:11264
    s_branch L_lw_79
L_lw_79_2:
    ds_read_b64_tr_b16 a[104:105], v80 offset:32768
    ds_read_b64_tr_b16 a[106:107], v80 offset:33792
    ds_read_b64_tr_b16 a[108:109], v80 offset:40960
    ds_read_b64_tr_b16 a[110:111], v80 offset:41984
    ds_read_b64_tr_b16 v[56:57], v81 offset:32768
    ds_read_b64_tr_b16 v[58:59], v81 offset:33792
    ds_read_b64_tr_b16 v[60:61], v81 offset:40960
    ds_read_b64_tr_b16 v[62:63], v81 offset:41984
    s_waitcnt lgkmcnt(0)
    ds_write_b128 v5, v[56:59] offset:12288
    ds_write_b128 v5, v[60:63] offset:13312
L_lw_79:
    s_waitcnt lgkmcnt(0)
    s_waitcnt vmcnt(8)
    s_barrier
    s_add_u32 s79, s41, 10
    s_and_b32 s79, s79, 3
    s_lshl_b32 s79, s79, 19
    s_add_u32 s79, s79, s47
    s_add_u32 s46, s79, 0x400000
    s_add_u32 m0, s48, 32768
    s_nop 0
    buffer_load_dwordx4 v82, s[32:35], s46 offen  lds
    s_add_u32 s46, s79, 0x420000
    s_add_u32 m0, s48, 36864
    s_nop 0
    buffer_load_dwordx4 v82, s[32:35], s46 offen  lds
    s_add_u32 s46, s79, 0x440000
    s_add_u32 m0, s48, 40960
    s_nop 0
    buffer_load_dwordx4 v82, s[32:35], s46 offen  lds
    s_add_u32 s46, s79, 0x460000
    s_add_u32 m0, s48, 45056
    s_nop 0
    buffer_load_dwordx4 v82, s[32:35], s46 offen  lds
    s_cmp_lg_u32 s44, 0
    s_cbranch_scc1 L_lw_80_0
    ds_read_b64_tr_b16 a[72:73], v80 offset:49152
    ds_read_b64_tr_b16 a[74:75], v80 offset:50176
    ds_read_b64_tr_b16 a[76:77], v80 offset:57344
    ds_read_b64_tr_b16 a[78:79], v80 offset:58368
    ds_read_b64_tr_b16 v[56:57], v81 offset:49152
    ds_read_b64_tr_b16 v[58:59], v81 offset:50176
    ds_read_b64_tr_b16 v[60:61], v81 offset:57344
    ds_read_b64_tr_b16 v[62:63], v81 offset:58368
    s_waitcnt lgkmcnt(0)
    ds_write_b128 v5, v[56:59] offset:22528
    ds_write_b128 v5, v[60:63] offset:23552
    s_branch L_lw_80
L_lw_80_0:
    s_cmp_lg_u32 s44, 1
    s_cbranch_scc1 L_lw_80_1
    ds_read_b64_tr_b16 a[40:41], v80 offset:49152
    ds_read_b64_tr_b16 a[42:43], v80 offset:50176
    ds_read_b64_tr_b16 a[44:45], v80 offset:57344
    ds_read_b64_tr_b16 a[46:47], v80 offset:58368
    ds_read_b64_tr_b16 v[56:57], v81 offset:49152
    ds_read_b64_tr_b16 v[58:59], v81 offset:50176
    ds_read_b64_tr_b16 v[60:61], v81 offset:57344
    ds_read_b64_tr_b16 v[62:63], v81 offset:58368
    s_waitcnt lgkmcnt(0)
    ds_write_b128 v5, v[56:59] offset:16384
    ds_write_b128 v5, v[60:63] offset:17408
    s_branch L_lw_80
L_lw_80_1:
    s_cmp_lg_u32 s44, 2
    s_cbranch_scc1 L_lw_80_2
    ds_read_b64_tr_b16 a[152:153], v80 offset:49152
    ds_read_b64_tr_b16 a[154:155], v80 offset:50176
    ds_read_b64_tr_b16 a[156:157], v80 offset:57344
    ds_read_b64_tr_b16 a[158:159], v80 offset:58368
    ds_read_b64_tr_b16 v[56:57], v81 offset:49152
    ds_read_b64_tr_b16 v[58:59], v81 offset:50176
    ds_read_b64_tr_b16 v[60:61], v81 offset:57344
    ds_read_b64_tr_b16 v[62:63], v81 offset:58368
    s_waitcnt lgkmcnt(0)
    ds_write_b128 v5, v[56:59] offset:18432
    ds_write_b128 v5, v[60:63] offset:19456
    s_branch L_lw_80
L_lw_80_2:
    ds_read_b64_tr_b16 a[112:113], v80 offset:49152
    ds_read_b64_tr_b16 a[114:115], v80 offset:50176
    ds_read_b64_tr_b16 a[116:117], v80 offset:57344
    ds_read_b64_tr_b16 a[118:119], v80 offset:58368
    ds_read_b64_tr_b16 v[56:57], v81 offset:49152
    ds_read_b64_tr_b16 v[58:59], v81 offset:50176
    ds_read_b64_tr_b16 v[60:61], v81 offset:57344
    ds_read_b64_tr_b16 v[62:63], v81 offset:58368
    s_waitcnt lgkmcnt(0)
    ds_write_b128 v5, v[56:59] offset:20480
    ds_write_b128 v5, v[60:63] offset:21504
L_lw_80:
    s_waitcnt lgkmcnt(0)
    s_waitcnt vmcnt(8)
    s_barrier
    s_add_u32 s79, s41, 11
    s_and_b32 s79, s79, 3
    s_lshl_b32 s79, s79, 19
    s_add_u32 s79, s79, s47
    s_add_u32 s46, s79, 0x400000
    s_add_u32 m0, s48, 49152
    s_nop 0
    buffer_load_dwordx4 v82, s[32:35], s46 offen  lds
    s_add_u32 s46, s79, 0x420000
    s_add_u32 m0, s48, 53248
    s_nop 0
    buffer_load_dwordx4 v82, s[32:35], s46 offen  lds
    s_add_u32 s46, s79, 0x440000
    s_add_u32 m0, s48, 57344
    s_nop 0
    buffer_load_dwordx4 v82, s[32:35], s46 offen  lds
    s_add_u32 s46, s79, 0x460000
    s_add_u32 m0, s48, 61440
    s_nop 0
    buffer_load_dwordx4 v82, s[32:35], s46 offen  lds
    s_cmp_lg_u32 s44, 0
    s_cbranch_scc1 L_lw_81_0
    ds_read_b64_tr_b16 a[80:81], v80 offset:0
    ds_read_b64_tr_b16 a[82:83], v80 offset:1024
    ds_read_b64_tr_b16 a[84:85], v80 offset:8192
    ds_read_b64_tr_b16 a[86:87], v80 offset:9216
    ds_read_b64_tr_b16 v[56:57], v81 offset:0
    ds_read_b64_tr_b16 v[58:59], v81 offset:1024
    ds_read_b64_tr_b16 v[60:61], v81 offset:8192
    ds_read_b64_tr_b16 v[62:63], v81 offset:9216
    s_waitcnt lgkmcnt(0)
    ds_write_b128 v5, v[56:59] offset:2048
    ds_write_b128 v5, v[60:63] offset:3072
    s_branch L_lw_81
L_lw_81_0:
    s_cmp_lg_u32 s44, 1
    s_cbranch_scc1 L_lw_81_1
    ds_read_b64_tr_b16 a[48:49], v80 offset:0
    ds_read_b64_tr_b16 a[50:51], v80 offset:1024
    ds_read_b64_tr_b16 a[52:53], v80 offset:8192
    ds_read_b64_tr_b16 a[54:55], v80 offset:9216
    ds_read_b64_tr_b16 v[56:57], v81 offset:0
    ds_read_b64_tr_b16 v[58:59], v81 offset:1024
    ds_read_b64_tr_b16 v[60:61], v81 offset:8192
    ds_read_b64_tr_b16 v[62:63], v81 offset:9216
    s_waitcnt lgkmcnt(0)
    ds_write_b128 v5, v[56:59] offset:4096
    ds_write_b128 v5, v[60:63] offset:5120
    s_branch L_lw_81
L_lw_81_1:
    s_cmp_lg_u32 s44, 2
    s_cbranch_scc1 L_lw_81_2
    ds_read_b64_tr_b16 a[0:1], v80 offset:0
    ds_read_b64_tr_b16 a[2:3], v80 offset:1024
    ds_read_b64_tr_b16 a[4:5], v80 offset:8192
    ds_read_b64_tr_b16 a[6:7], v80 offset:9216
    ds_read_b64_tr_b16 a[8:9], v81 offset:0
    ds_read_b64_tr_b16 a[10:11], v81 offset:1024
    ds_read_b64_tr_b16 a[12:13], v81 offset:8192
    ds_read_b64_tr_b16 a[14:15], v81 offset:9216
    s_branch L_lw_81
L_lw_81_2:
    ds_read_b64_tr_b16 a[120:121], v80 offset:0
    ds_read_b64_tr_b16 a[122:123], v80 offset:1024
    ds_read_b64_tr_b16 a[124:125], v80 offset:8192
    ds_read_b64_tr_b16 a[126:127], v80 offset:9216
    ds_read_b64_tr_b16 v[56:57], v81 offset:0
    ds_read_b64_tr_b16 v[58:59], v81 offset:1024
    ds_read_b64_tr_b16 v[60:61], v81 offset:8192
    ds_read_b64_tr_b16 v[62:63], v81 offset:9216
    s_waitcnt lgkmcnt(0)
    ds_write_b128 v5, v[56:59] offset:0
    ds_write_b128 v5, v[60:63] offset:1024
L_lw_81:
    s_waitcnt lgkmcnt(0)
    s_waitcnt vmcnt(8)
    s_barrier
    s_add_u32 s79, s41, 12
    s_and_b32 s79, s79, 3
    s_lshl_b32 s79, s79, 19
    s_add_u32 s79, s79, s47
    s_add_u32 s46, s79, 0x600000
    s_add_u32 m0, s48, 0
    s_nop 0
    buffer_load_dwordx4 v82, s[32:35], s46 offen  lds
    s_add_u32 s46, s79, 0x620000
    s_add_u32 m0, s48, 4096
    s_nop 0
    buffer_load_dwordx4 v82, s[32:35], s46 offen  lds
    s_add_u32 s46, s79, 0x640000
    s_add_u32 m0, s48, 8192
    s_nop 0
    buffer_load_dwordx4 v82, s[32:35], s46 offen  lds
    s_add_u32 s46, s79, 0x660000
    s_add_u32 m0, s48, 12288
    s_nop 0
    buffer_load_dwordx4 v82, s[32:35], s46 offen  lds
    s_cmp_lg_u32 s44, 0
    s_cbranch_scc1 L_lw_82_0
    ds_read_b64_tr_b16 a[88:89], v80 offset:16384
    ds_read_b64_tr_b16 a[90:91], v80 offset:17408
    ds_read_b64_tr_b16 a[92:93], v80 offset:24576
    ds_read_b64_tr_b16 a[94:95], v80 offset:25600
    ds_read_b64_tr_b16 a[96:97], v81 offset:16384
    ds_read_b64_tr_b16 a[98:99], v81 offset:17408
    ds_read_b64_tr_b16 a[100:101], v81 offset:24576
    ds_read_b64_tr_b16 a[102:103], v81 offset:25600
    s_branch L_lw_82
L_lw_82_0:
    s_cmp_lg_u32 s44, 1
    s_cbranch_scc1 L_lw_82_1
    ds_read_b64_tr_b16 a[56:57], v80 offset:16384
    ds_read_b64_tr_b16 a[58:59], v80 offset:17408
    ds_read_b64_tr_b16 a[60:61], v80 offset:24576
    ds_read_b64_tr_b16 a[62:63], v80 offset:25600
    ds_read_b64_tr_b16 v[56:57], v81 offset:16384
    ds_read_b64_tr_b16 v[58:59], v81 offset:17408
    ds_read_b64_tr_b16 v[60:61], v81 offset:24576
    ds_read_b64_tr_b16 v[62:63], v81 offset:25600
    s_waitcnt lgkmcnt(0)
    ds_write_b128 v5, v[56:59] offset:6144
    ds_write_b128 v5, v[60:63] offset:7168
    s_branch L_lw_82
L_lw_82_1:
    s_cmp_lg_u32 s44, 2
    s_cbranch_scc1 L_lw_82_2
    ds_read_b64_tr_b16 a[16:17], v80 offset:16384
    ds_read_b64_tr_b16 a[18:19], v80 offset:17408
    ds_read_b64_tr_b16 a[20:21], v80 offset:24576
    ds_read_b64_tr_b16 a[22:23], v80 offset:25600
    ds_read_b64_tr_b16 a[24:25], v81 offset:16384
    ds_read_b64_tr_b16 a[26:27], v81 offset:17408
    ds_read_b64_tr_b16 a[28:29], v81 offset:24576
    ds_read_b64_tr_b16 a[30:31], v81 offset:25600
    s_branch L_lw_82
L_lw_82_2:
    ds_read_b64_tr_b16 a[128:129], v80 offset:16384
    ds_read_b64_tr_b16 a[130:131], v80 offset:17408
    ds_read_b64_tr_b16 a[132:133], v80 offset:24576
    ds_read_b64_tr_b16 a[134:135], v80 offset:25600
    ds_read_b64_tr_b16 a[136:137], v81 offset:16384
    ds_read_b64_tr_b16 a[138:139], v81 offset:17408
    ds_read_b64_tr_b16 a[140:141], v81 offset:24576
    ds_read_b64_tr_b16 a[142:143], v81 offset:25600
L_lw_82:
    s_waitcnt lgkmcnt(0)
    s_waitcnt vmcnt(8)
    s_barrier
    s_add_u32 s79, s41, 13
    s_and_b32 s79, s79, 3
    s_lshl_b32 s79, s79, 19
    s_add_u32 s79, s79, s47
    s_add_u32 s46, s79, 0x600000
    s_add_u32 m0, s48, 16384
    s_nop 0
    buffer_load_dwordx4 v82, s[32:35], s46 offen  lds
    s_add_u32 s46, s79, 0x620000
    s_add_u32 m0, s48, 20480
    s_nop 0
    buffer_load_dwordx4 v82, s[32:35], s46 offen  lds
    s_add_u32 s46, s79, 0x640000
    s_add_u32 m0, s48, 24576
    s_nop 0
    buffer_load_dwordx4 v82, s[32:35], s46 offen  lds
    s_add_u32 s46, s79, 0x660000
    s_add_u32 m0, s48, 28672
    s_nop 0
    buffer_load_dwordx4 v82, s[32:35], s46 offen  lds
    s_cmp_lg_u32 s44, 0
    s_cbranch_scc1 L_lw_83_0
    ds_read_b64_tr_b16 a[104:105], v80 offset:32768
    ds_read_b64_tr_b16 a[106:107], v80 offset:33792
    ds_read_b64_tr_b16 a[108:109], v80 offset:40960
    ds_read_b64_tr_b16 a[110:111], v80 offset:41984
    ds_read_b64_tr_b16 v[56:57], v81 offset:32768
    ds_read_b64_tr_b16 v[58:59], v81 offset:33792
    ds_read_b64_tr_b16 v[60:61], v81 offset:40960
    ds_read_b64_tr_b16 v[62:63], v81 offset:41984
    s_waitcnt lgkmcnt(0)
    ds_write_b128 v5, v[56:59] offset:12288
    ds_write_b128 v5, v[60:63] offset:13312
    s_branch L_lw_83
L_lw_83_0:
    s_cmp_lg_u32 s44, 1
    s_cbranch_scc1 L_lw_83_1
    ds_read_b64_tr_b16 a[64:65], v80 offset:32768
    ds_read_b64_tr_b16 a[66:67], v80 offset:33792
    ds_read_b64_tr_b16 a[68:69], v80 offset:40960
    ds_read_b64_tr_b16 a[70:71], v80 offset:41984
    ds_read_b64_tr_b16 v[56:57], v81 offset:32768
    ds_read_b64_tr_b16 v[58:59], v81 offset:33792
    ds_read_b64_tr_b16 v[60:61], v81 offset:40960
    ds_read_b64_tr_b16 v[62:63], v81 offset:41984
    s_waitcnt lgkmcnt(0)
    ds_write_b128 v5, v[56:59] offset:14336
    ds_write_b128 v5, v[60:63] offset:15360
    s_branch L_lw_83
L_lw_83_1:
    s_cmp_lg_u32 s44, 2
    s_cbranch_scc1 L_lw_83_2
    ds_read_b64_tr_b16 a[32:33], v80 offset:32768
    ds_read_b64_tr_b16 a[34:35], v80 offset:33792
    ds_read_b64_tr_b16 a[36:37], v80 offset:40960
    ds_read_b64_tr_b16 a[38:39], v80 offset:41984
    ds_read_b64_tr_b16 v[56:57], v81 offset:32768
    ds_read_b64_tr_b16 v[58:59], v81 offset:33792
    ds_read_b64_tr_b16 v[60:61], v81 offset:40960
    ds_read_b64_tr_b16 v[62:63], v81 offset:41984
    s_waitcnt lgkmcnt(0)
    ds_write_b128 v5, v[56:59] offset:8192
    ds_write_b128 v5, v[60:63] offset:9216
    s_branch L_lw_83
L_lw_83_2:
    ds_read_b64_tr_b16 a[144:145], v80 offset:32768
    ds_read_b64_tr_b16 a[146:147], v80 offset:33792
    ds_read_b64_tr_b16 a[148:149], v80 offset:40960
    ds_read_b64_tr_b16 a[150:151], v80 offset:41984
    ds_read_b64_tr_b16 v[56:57], v81 offset:32768
    ds_read_b64_tr_b16 v[58:59], v81 offset:33792
    ds_read_b64_tr_b16 v[60:61], v81 offset:40960
    ds_read_b64_tr_b16 v[62:63], v81 offset:41984
    s_waitcnt lgkmcnt(0)
    ds_write_b128 v5, v[56:59] offset:10240
    ds_write_b128 v5, v[60:63] offset:11264
L_lw_83:
    s_waitcnt lgkmcnt(0)
    s_waitcnt vmcnt(8)
    s_barrier
    s_add_u32 s79, s41, 14
    s_and_b32 s79, s79, 3
    s_lshl_b32 s79, s79, 19
    s_add_u32 s79, s79, s47
    s_add_u32 s46, s79, 0x600000
    s_add_u32 m0, s48, 32768
    s_nop 0
    buffer_load_dwordx4 v82, s[32:35], s46 offen  lds
    s_add_u32 s46, s79, 0x620000
    s_add_u32 m0, s48, 36864
    s_nop 0
    buffer_load_dwordx4 v82, s[32:35], s46 offen  lds
    s_add_u32 s46, s79, 0x640000
    s_add_u32 m0, s48, 40960
    s_nop 0
    buffer_load_dwordx4 v82, s[32:35], s46 offen  lds
    s_add_u32 s46, s79, 0x660000
    s_add_u32 m0, s48, 45056
    s_nop 0
    buffer_load_dwordx4 v82, s[32:35], s46 offen  lds
    s_cmp_lg_u32 s44, 0
    s_cbranch_scc1 L_lw_84_0
    ds_read_b64_tr_b16 a[112:113], v80 offset:49152
    ds_read_b64_tr_b16 a[114:115], v80 offset:50176
    ds_read_b64_tr_b16 a[116:117], v80 offset:57344
    ds_read_b64_tr_b16 a[118:119], v80 offset:58368
    ds_read_b64_tr_b16 v[56:57], v81 offset:49152
    ds_read_b64_tr_b16 v[58:59], v81 offset:50176
    ds_read_b64_tr_b16 v[60:61], v81 offset:57344
    ds_read_b64_tr_b16 v[62:63], v81 offset:58368
    s_waitcnt lgkmcnt(0)
    ds_write_b128 v5, v[56:59] offset:20480
    ds_write_b128 v5, v[60:63] offset:21504
    s_branch L_lw_84
L_lw_84_0:
    s_cmp_lg_u32 s44, 1
    s_cbranch_scc1 L_lw_84_1
    ds_read_b64_tr_b16 a[72:73], v80 offset:49152
    ds_read_b64_tr_b16 a[74:75], v80 offset:50176
    ds_read_b64_tr_b16 a[76:77], v80 offset:57344
    ds_read_b64_tr_b16 a[78:79], v80 offset:58368
    ds_read_b64_tr_b16 v[56:57], v81 offset:49152
    ds_read_b64_tr_b16 v[58:59], v81 offset:50176
    ds_read_b64_tr_b16 v[60:61], v81 offset:57344
    ds_read_b64_tr_b16 v[62:63], v81 offset:58368
    s_waitcnt lgkmcnt(0)
    ds_write_b128 v5, v[56:59] offset:22528
    ds_write_b128 v5, v[60:63] offset:23552
    s_branch L_lw_84
L_lw_84_1:
    s_cmp_lg_u32 s44, 2
    s_cbranch_scc1 L_lw_84_2
    ds_read_b64_tr_b16 a[40:41], v80 offset:49152
    ds_read_b64_tr_b16 a[42:43], v80 offset:50176
    ds_read_b64_tr_b16 a[44:45], v80 offset:57344
    ds_read_b64_tr_b16 a[46:47], v80 offset:58368
    ds_read_b64_tr_b16 v[56:57], v81 offset:49152
    ds_read_b64_tr_b16 v[58:59], v81 offset:50176
    ds_read_b64_tr_b16 v[60:61], v81 offset:57344
    ds_read_b64_tr_b16 v[62:63], v81 offset:58368
    s_waitcnt lgkmcnt(0)
    ds_write_b128 v5, v[56:59] offset:16384
    ds_write_b128 v5, v[60:63] offset:17408
    s_branch L_lw_84
L_lw_84_2:
    ds_read_b64_tr_b16 a[152:153], v80 offset:49152
    ds_read_b64_tr_b16 a[154:155], v80 offset:50176
    ds_read_b64_tr_b16 a[156:157], v80 offset:57344
    ds_read_b64_tr_b16 a[158:159], v80 offset:58368
    ds_read_b64_tr_b16 v[56:57], v81 offset:49152
    ds_read_b64_tr_b16 v[58:59], v81 offset:50176
    ds_read_b64_tr_b16 v[60:61], v81 offset:57344
    ds_read_b64_tr_b16 v[62:63], v81 offset:58368
    s_waitcnt lgkmcnt(0)
    ds_write_b128 v5, v[56:59] offset:18432
    ds_write_b128 v5, v[60:63] offset:19456
L_lw_84:
    s_waitcnt lgkmcnt(0)
    s_waitcnt vmcnt(8)
    s_barrier
    s_add_u32 s79, s41, 15
    s_and_b32 s79, s79, 3
    s_lshl_b32 s79, s79, 19
    s_add_u32 s79, s79, s47
    s_add_u32 s46, s79, 0x600000
    s_add_u32 m0, s48, 49152
    s_nop 0
    buffer_load_dwordx4 v82, s[32:35], s46 offen  lds
    s_add_u32 s46, s79, 0x620000
    s_add_u32 m0, s48, 53248
    s_nop 0
    buffer_load_dwordx4 v82, s[32:35], s46 offen  lds
    s_add_u32 s46, s79, 0x640000
    s_add_u32 m0, s48, 57344
    s_nop 0
    buffer_load_dwordx4 v82, s[32:35], s46 offen  lds
    s_add_u32 s46, s79, 0x660000
    s_add_u32 m0, s48, 61440
    s_nop 0
    buffer_load_dwordx4 v82, s[32:35], s46 offen  lds
    v_mov_b32 v46, 0
    buffer_load_dwordx2 v[44:45], v46, s[16:19], 0 offen sc1
    s_cmp_lg_u32 s44, 0
    s_cbranch_scc1 L_lw_85_0
    ds_read_b64_tr_b16 a[120:121], v80 offset:0
    ds_read_b64_tr_b16 a[122:123], v80 offset:1024
    ds_read_b64_tr_b16 a[124:125], v80 offset:8192
    ds_read_b64_tr_b16 a[126:127], v80 offset:9216
    ds_read_b64_tr_b16 v[56:57], v81 offset:0
    ds_read_b64_tr_b16 v[58:59], v81 offset:1024
    ds_read_b64_tr_b16 v[60:61], v81 offset:8192
    ds_read_b64_tr_b16 v[62:63], v81 offset:9216
    s_waitcnt lgkmcnt(0)
    ds_write_b128 v5, v[56:59] offset:0
    ds_write_b128 v5, v[60:63] offset:1024
    s_branch L_lw_85
L_lw_85_0:
    s_cmp_lg_u32 s44, 1
    s_cbranch_scc1 L_lw_85_1
    ds_read_b64_tr_b16 a[80:81], v80 offset:0
    ds_read_b64_tr_b16 a[82:83], v80 offset:1024
    ds_read_b64_tr_b16 a[84:85], v80 offset:8192
    ds_read_b64_tr_b16 a[86:87], v80 offset:9216
    ds_read_b64_tr_b16 v[56:57], v81 offset:0
    ds_read_b64_tr_b16 v[58:59], v81 offset:1024
    ds_read_b64_tr_b16 v[60:61], v81 offset:8192
    ds_read_b64_tr_b16 v[62:63], v81 offset:9216
    s_waitcnt lgkmcnt(0)
    ds_write_b128 v5, v[56:59] offset:2048
    ds_write_b128 v5, v[60:63] offset:3072
    s_branch L_lw_85
L_lw_85_1:
    s_cmp_lg_u32 s44, 2
    s_cbranch_scc1 L_lw_85_2
    ds_read_b64_tr_b16 a[48:49], v80 offset:0
    ds_read_b64_tr_b16 a[50:51], v80 offset:1024
    ds_read_b64_tr_b16 a[52:53], v80 offset:8192
    ds_read_b64_tr_b16 a[54:55], v80 offset:9216
    ds_read_b64_tr_b16 v[56:57], v81 offset:0
    ds_read_b64_tr_b16 v[58:59], v81 offset:1024
    ds_read_b64_tr_b16 v[60:61], v81 offset:8192
    ds_read_b64_tr_b16 v[62:63], v81 offset:9216
    s_waitcnt lgkmcnt(0)
    ds_write_b128 v5, v[56:59] offset:4096
    ds_write_b128 v5, v[60:63] offset:5120
    s_branch L_lw_85
L_lw_85_2:
    ds_read_b64_tr_b16 a[0:1], v80 offset:0
    ds_read_b64_tr_b16 a[2:3], v80 offset:1024
    ds_read_b64_tr_b16 a[4:5], v80 offset:8192
    ds_read_b64_tr_b16 a[6:7], v80 offset:9216
    ds_read_b64_tr_b16 a[8:9], v81 offset:0
    ds_read_b64_tr_b16 a[10:11], v81 offset:1024
    ds_read_b64_tr_b16 a[12:13], v81 offset:8192
    ds_read_b64_tr_b16 a[14:15], v81 offset:9216
L_lw_85:
    s_waitcnt lgkmcnt(0)
    s_waitcnt vmcnt(8)
    s_barrier
    s_cmp_lg_u32 s44, 0
    s_cbranch_scc1 L_lw_86_0
    ds_read_b64_tr_b16 a[128:129], v80 offset:16384
    ds_read_b64_tr_b16 a[130:131], v80 offset:17408
    ds_read_b64_tr_b16 a[132:133], v80 offset:24576
    ds_read_b64_tr_b16 a[134:135], v80 offset:25600
    ds_read_b64_tr_b16 a[136:137], v81 offset:16384
    ds_read_b64_tr_b16 a[138:139], v81 offset:17408
    ds_read_b64_tr_b16 a[140:141], v81 offset:24576
    ds_read_b64_tr_b16 a[142:143], v81 offset:25600
    s_branch L_lw_86
L_lw_86_0:
    s_cmp_lg_u32 s44, 1
    s_cbranch_scc1 L_lw_86_1
    ds_read_b64_tr_b16 a[88:89], v80 offset:16384
    ds_read_b64_tr_b16 a[90:91], v80 offset:17408
    ds_read_b64_tr_b16 a[92:93], v80 offset:24576
    ds_read_b64_tr_b16 a[94:95], v80 offset:25600
    ds_read_b64_tr_b16 a[96:97], v81 offset:16384
    ds_read_b64_tr_b16 a[98:99], v81 offset:17408
    ds_read_b64_tr_b16 a[100:101], v81 offset:24576
    ds_read_b64_tr_b16 a[102:103], v81 offset:25600
    s_branch L_lw_86
L_lw_86_1:
    s_cmp_lg_u32 s44, 2
    s_cbranch_scc1 L_lw_86_2
    ds_read_b64_tr_b16 a[56:57], v80 offset:16384
    ds_read_b64_tr_b16 a[58:59], v80 offset:17408
    ds_read_b64_tr_b16 a[60:61], v80 offset:24576
    ds_read_b64_tr_b16 a[62:63], v80 offset:25600
    ds_read_b64_tr_b16 v[56:57], v81 offset:16384
    ds_read_b64_tr_b16 v[58:59], v81 offset:17408
    ds_read_b64_tr_b16 v[60:61], v81 offset:24576
    ds_read_b64_tr_b16 v[62:63], v81 offset:25600
    s_waitcnt lgkmcnt(0)
    ds_write_b128 v5, v[56:59] offset:6144
    ds_write_b128 v5, v[60:63] offset:7168
    s_branch L_lw_86
L_lw_86_2:
    ds_read_b64_tr_b16 a[16:17], v80 offset:16384
    ds_read_b64_tr_b16 a[18:19], v80 offset:17408
    ds_read_b64_tr_b16 a[20:21], v80 offset:24576
    ds_read_b64_tr_b16 a[22:23], v80 offset:25600
    ds_read_b64_tr_b16 a[24:25], v81 offset:16384
    ds_read_b64_tr_b16 a[26:27], v81 offset:17408
    ds_read_b64_tr_b16 a[28:29], v81 offset:24576
    ds_read_b64_tr_b16 a[30:31], v81 offset:25600
L_lw_86:
    s_waitcnt lgkmcnt(0)
    s_waitcnt vmcnt(4)
    s_barrier
    s_cmp_lg_u32 s44, 0
    s_cbranch_scc1 L_lw_87_0
    ds_read_b64_tr_b16 a[144:145], v80 offset:32768
    ds_read_b64_tr_b16 a[146:147], v80 offset:33792
    ds_read_b64_tr_b16 a[148:149], v80 offset:40960
    ds_read_b64_tr_b16 a[150:151], v80 offset:41984
    ds_read_b64_tr_b16 v[56:57], v81 offset:32768
    ds_read_b64_tr_b16 v[58:59], v81 offset:33792
    ds_read_b64_tr_b16 v[60:61], v81 offset:40960
    ds_read_b64_tr_b16 v[62:63], v81 offset:41984
    s_waitcnt lgkmcnt(0)
    ds_write_b128 v5, v[56:59] offset:10240
    ds_write_b128 v5, v[60:63] offset:11264
    s_branch L_lw_87
L_lw_87_0:
    s_cmp_lg_u32 s44, 1
    s_cbranch_scc1 L_lw_87_1
    ds_read_b64_tr_b16 a[104:105], v80 offset:32768
    ds_read_b64_tr_b16 a[106:107], v80 offset:33792
    ds_read_b64_tr_b16 a[108:109], v80 offset:40960
    ds_read_b64_tr_b16 a[110:111], v80 offset:41984
    ds_read_b64_tr_b16 v[56:57], v81 offset:32768
    ds_read_b64_tr_b16 v[58:59], v81 offset:33792
    ds_read_b64_tr_b16 v[60:61], v81 offset:40960
    ds_read_b64_tr_b16 v[62:63], v81 offset:41984
    s_waitcnt lgkmcnt(0)
    ds_write_b128 v5, v[56:59] offset:12288
    ds_write_b128 v5, v[60:63] offset:13312
    s_branch L_lw_87
L_lw_87_1:
    s_cmp_lg_u32 s44, 2
    s_cbranch_scc1 L_lw_87_2
    ds_read_b64_tr_b16 a[64:65], v80 offset:32768
    ds_read_b64_tr_b16 a[66:67], v80 offset:33792
    ds_read_b64_tr_b16 a[68:69], v80 offset:40960
    ds_read_b64_tr_b16 a[70:71], v80 offset:41984
    ds_read_b64_tr_b16 v[56:57], v81 offset:32768
    ds_read_b64_tr_b16 v[58:59], v81 offset:33792
    ds_read_b64_tr_b16 v[60:61], v81 offset:40960
    ds_read_b64_tr_b16 v[62:63], v81 offset:41984
    s_waitcnt lgkmcnt(0)
    ds_write_b128 v5, v[56:59] offset:14336
    ds_write_b128 v5, v[60:63] offset:15360
    s_branch L_lw_87
L_lw_87_2:
    ds_read_b64_tr_b16 a[32:33], v80 offset:32768
    ds_read_b64_tr_b16 a[34:35], v80 offset:33792
    ds_read_b64_tr_b16 a[36:37], v80 offset:40960
    ds_read_b64_tr_b16 a[38:39], v80 offset:41984
    ds_read_b64_tr_b16 v[56:57], v81 offset:32768
    ds_read_b64_tr_b16 v[58:59], v81 offset:33792
    ds_read_b64_tr_b16 v[60:61], v81 offset:40960
    ds_read_b64_tr_b16 v[62:63], v81 offset:41984
    s_waitcnt lgkmcnt(0)
    ds_write_b128 v5, v[56:59] offset:8192
    ds_write_b128 v5, v[60:63] offset:9216
L_lw_87:
    s_waitcnt lgkmcnt(0)
    s_waitcnt vmcnt(0)
    s_barrier
    s_add_u32 s45, s61, 0
    buffer_load_dword v47, v12, s[12:15], s45 offen sc1
    s_add_u32 s45, s61, 16384
    buffer_load_dword v47, v12, s[12:15], s45 offen sc1
    s_add_u32 s45, s61, 32768
    buffer_load_dword v47, v12, s[12:15], s45 offen sc1
    s_add_u32 s45, s61, 49152
    buffer_load_dword v47, v12, s[12:15], s45 offen sc1
    s_mov_b32 s45, 0x7020000
    buffer_load_dword v47, v10, s[12:15], s45 offen sc1
    s_mov_b32 s45, 0x7030000
    buffer_load_dword v47, v10, s[12:15], s45 offen sc1
    buffer_load_dword v47, v20, s[12:15], 0 offen sc1
    s_cmp_lg_u32 s44, 0
    s_cbranch_scc1 L_lw_88_0
    ds_read_b64_tr_b16 a[152:153], v80 offset:49152
    ds_read_b64_tr_b16 a[154:155], v80 offset:50176
    ds_read_b64_tr_b16 a[156:157], v80 offset:57344
    ds_read_b64_tr_b16 a[158:159], v80 offset:58368
    ds_read_b64_tr_b16 v[56:57], v81 offset:49152
    ds_read_b64_tr_b16 v[58:59], v81 offset:50176
    ds_read_b64_tr_b16 v[60:61], v81 offset:57344
    ds_read_b64_tr_b16 v[62:63], v81 offset:58368
    s_waitcnt lgkmcnt(0)
    ds_write_b128 v5, v[56:59] offset:18432
    ds_write_b128 v5, v[60:63] offset:19456
    s_branch L_lw_88
L_lw_88_0:
    s_cmp_lg_u32 s44, 1
    s_cbranch_scc1 L_lw_88_1
    ds_read_b64_tr_b16 a[112:113], v80 offset:49152
    ds_read_b64_tr_b16 a[114:115], v80 offset:50176
    ds_read_b64_tr_b16 a[116:117], v80 offset:57344
    ds_read_b64_tr_b16 a[118:119], v80 offset:58368
    ds_read_b64_tr_b16 v[56:57], v81 offset:49152
    ds_read_b64_tr_b16 v[58:59], v81 offset:50176
    ds_read_b64_tr_b16 v[60:61], v81 offset:57344
    ds_read_b64_tr_b16 v[62:63], v81 offset:58368
    s_waitcnt lgkmcnt(0)
    ds_write_b128 v5, v[56:59] offset:20480
    ds_write_b128 v5, v[60:63] offset:21504
    s_branch L_lw_88
L_lw_88_1:
    s_cmp_lg_u32 s44, 2
    s_cbranch_scc1 L_lw_88_2
    ds_read_b64_tr_b16 a[72:73], v80 offset:49152
    ds_read_b64_tr_b16 a[74:75], v80 offset:50176
    ds_read_b64_tr_b16 a[76:77], v80 offset:57344
    ds_read_b64_tr_b16 a[78:79], v80 offset:58368
    ds_read_b64_tr_b16 v[56:57], v81 offset:49152
    ds_read_b64_tr_b16 v[58:59], v81 offset:50176
    ds_read_b64_tr_b16 v[60:61], v81 offset:57344
    ds_read_b64_tr_b16 v[62:63], v81 offset:58368
    s_waitcnt lgkmcnt(0)
    ds_write_b128 v5, v[56:59] offset:22528
    ds_write_b128 v5, v[60:63] offset:23552
    s_branch L_lw_88
L_lw_88_2:
    ds_read_b64_tr_b16 a[40:41], v80 offset:49152
    ds_read_b64_tr_b16 a[42:43], v80 offset:50176
    ds_read_b64_tr_b16 a[44:45], v80 offset:57344
    ds_read_b64_tr_b16 a[46:47], v80 offset:58368
    ds_read_b64_tr_b16 v[56:57], v81 offset:49152
    ds_read_b64_tr_b16 v[58:59], v81 offset:50176
    ds_read_b64_tr_b16 v[60:61], v81 offset:57344
    ds_read_b64_tr_b16 v[62:63], v81 offset:58368
    s_waitcnt lgkmcnt(0)
    ds_write_b128 v5, v[56:59] offset:16384
    ds_write_b128 v5, v[60:63] offset:17408
L_lw_88:
    s_waitcnt lgkmcnt(0)
    s_barrier
    v_lshlrev_b32 v68, 4, v1
    s_mul_i32 s45, s44, 3072
    s_add_u32 s45, s45, 53248
    v_add_u32 v6, s45, v68
    s_sub_u32 s45, s44, 1
    s_and_b32 s45, s45, 3
    s_mul_i32 s45, s45, 3072
    s_add_u32 s45, s45, 53248
    v_add_u32 v7, s45, v68
    s_sub_u32 s45, s44, 2
    s_and_b32 s45, s45, 3
    s_mul_i32 s45, s45, 3072
    s_add_u32 s45, s45, 54272
    v_add_u32 v8, s45, v68
    s_sub_u32 s45, s44, 3
    s_and_b32 s45, s45, 3
    s_mul_i32 s45, s45, 3072
    s_add_u32 s45, s45, 55296
    v_add_u32 v18, s45, v68
    v_lshlrev_b32 v68, 4, v1
    s_add_u32 s45, s69, 0
    s_and_b32 s45, s45, 7
    s_lshl_b32 s45, s45, 10
    s_lshl_b32 s46, s44, 13
    s_add_u32 s45, s45, s46
    v_add_u32 v80, s45, v68
    s_add_u32 s45, s69, 1
    s_and_b32 s45, s45, 7
    s_lshl_b32 s45, s45, 10
    s_lshl_b32 s46, s44, 13
    s_add_u32 s45, s45, s46
    v_add_u32 v81, s45, v68
    s_add_u32 s45, s69, 2
    s_and_b32 s45, s45, 7
    s_lshl_b32 s45, s45, 10
    s_lshl_b32 s46, s44, 13
    s_add_u32 s45, s45, s46
    v_add_u32 v82, s45, v68
    s_add_u32 s45, s69, 3
    s_and_b32 s45, s45, 7
    s_lshl_b32 s45, s45, 10
    s_lshl_b32 s46, s44, 13
    s_add_u32 s45, s45, s46
    v_add_u32 v83, s45, v68
    s_add_u32 s45, s69, 4
    s_and_b32 s45, s45, 7
    s_lshl_b32 s45, s45, 10
    s_lshl_b32 s46, s44, 13
    s_add_u32 s45, s45, s46
    v_add_u32 v84, s45, v68
    s_add_u32 s45, s69, 5
    s_and_b32 s45, s45, 7
    s_lshl_b32 s45, s45, 10
    s_lshl_b32 s46, s44, 13
    s_add_u32 s45, s45, s46
    v_add_u32 v85, s45, v68
    s_add_u32 s45, s69, 6
    s_and_b32 s45, s45, 7
    s_lshl_b32 s45, s45, 10
    s_lshl_b32 s46, s44, 13
    s_add_u32 s45, s45, s46
    v_add_u32 v86, s45, v68
    s_add_u32 s45, s69, 7
    s_and_b32 s45, s45, 7
    s_lshl_b32 s45, s45, 10
    s_lshl_b32 s46, s44, 13
    s_add_u32 s45, s45, s46
    v_add_u32 v87, s45, v68
    s_lshl_b32 s45, s40, 4
    s_add_u32 s45, s45, s42
    s_lshl_b32 s45, s45, 8
    s_lshl_b32 s46, s44, 6
    s_add_u32 s45, s45, s46
    s_add_u32 s45, s45, 0x7080000
    v_and_b32 v13, 15, v1
    v_lshlrev_b32 v13, 2, v13
    v_add_u32 v13, s45, v13
    s_mov_b32 s66, 0x1800000
    v_mov_b32 v14, -1
    v_mov_b32 v15, -1
    s_mov_b32 s70, 0
    v_mov_b32 v41, 0
    s_branch L_hw_89_c
L_hw_89:
    buffer_load_dwordx2 v[44:45], v41, s[16:19], 0 offen sc1
    s_add_u32 s70, s70, 1
    s_cmp_ge_u32 s70, 0x100000
    s_cbranch_scc1 L_c_done_1
L_hw_89_c:
    s_waitcnt vmcnt(0)
    v_readfirstlane_b32 s45, v44
    v_readfirstlane_b32 s46, v45
    s_nop 3
    s_lshr_b32 s47, s46, 24
    s_cmp_lg_u32 s47, 64
    s_cbranch_scc1 L_hw_89
    s_lshr_b32 s68, s45, 24
    s_and_b32 s47, s45, 511
    s_mul_i32 s47, s47, s47
    s_bfe_u32 s45, s45, 0xf0009
    s_lshl_b32 s45, s45, 5
    s_sub_u32 s45, s45, s47
    s_and_b32 s47, s46, 511
    s_mul_i32 s47, s47, s47
    s_bfe_u32 s46, s46, 0xf0009
    s_lshl_b32 s46, s46, 5
    s_sub_u32 s46, s46, s47
    s_or_b32 s45, s45, s46
    s_cmp_eq_u32 s45, 0
    s_cselect_b32 s67, 1, 0
    s_mov_b32 s24, s12
    s_mov_b32 s25, s13
    s_mov_b32 s28, s12
    s_mov_b32 s29, s13
    s_cmp_eq_u32 s67, 1
    s_cselect_b32 s26, s14, 0
    s_cselect_b32 s30, 0, s14
    s_cmp_ge_u32 s68, 16
    s_cselect_b32 s68, 8192, 0
    s_mov_b32 s6, 0x11111111
    s_mov_b32 s7, 0xffaaa491
    s_mov_b32 s60, 0
    s_lshl_b32 s58, s40, 16
    s_add_u32 s58, s58, 0x7000000
    s_mov_b32 s61, s58
    s_lshl_b32 s59, s40, 17
    s_add_u32 s59, s59, 0x7040000
    s_mov_b32 s62, s59
    s_add_u32 s32, s41, 0
    s_and_b32 s32, s32, 3
    s_lshl_b32 s32, s32, 10
    s_add_u32 s33, s41, 1
    s_and_b32 s33, s33, 3
    s_lshl_b32 s33, s33, 10
    s_add_u32 s34, s41, 2
    s_and_b32 s34, s34, 3
    s_lshl_b32 s34, s34, 10
    s_add_u32 s35, s41, 3
    s_and_b32 s35, s35, 3
    s_lshl_b32 s35, s35, 10
    s_cmp_lg_u32 s44, 0
    s_cbranch_scc1 L_ld_90
    v_mov_b32 v40, 1
    v_mov_b32 v41, 127360
    s_mov_b64 exec, 1
    buffer_atomic_add v40, v41, s[12:15], 0 offen sc1
    s_mov_b64 exec, -1
L_ld_90:
    s_add_u32 s63, s63, s68
    s_add_u32 s64, s64, s68
    ds_read_b128 v[56:59], v5 offset:8192
    ds_read_b128 v[60:63], v5 offset:9216
    ds_read_b128 v[64:67], v5 offset:16384
    ds_read_b128 v[68:71], v5 offset:17408
    ds_read_b128 v[72:75], v5 offset:4096
    ds_read_b128 v[76:79], v5 offset:5120
    ds_read_b128 v[88:91], v5 offset:6144
    ds_read_b128 v[92:95], v5 offset:7168
    ds_read_b128 v[32:35], v5 offset:14336
    ds_read_b128 v[36:39], v5 offset:15360
L_v_loop_91:
    s_add_u32 s8, s61, s32
    s_add_u32 s9, s61, s33
    s_add_u32 s10, s61, s34
    s_add_u32 s11, s61, s35
    s_nop 15
    s_nop 15
    s_waitcnt lgkmcnt(0)
    buffer_load_dwordx4 v[40:43], v3, s[12:15], s8 offen sc1
    v_mov_b32 v24, 0
    v_mov_b32 v25, 0
    v_mov_b32 v26, 0
    v_mov_b32 v27, 0
    v_mov_b32 v28, 0
    buffer_load_dwordx4 v[44:47], v3, s[12:15], s9 offen sc1
    v_mov_b32 v29, 0
    v_mov_b32 v30, 0
    v_mov_b32 v31, 0
    s_nop 1
    buffer_load_dwordx4 v[48:51], v3, s[12:15], s10 offen sc1
    s_nop 4
    buffer_load_dwordx4 v[52:55], v3, s[12:15], s11 offen sc1
    s_mov_b32 s70, 0
    s_waitcnt vmcnt(3)
    v_max3_u32 v22, v40, v41, v42
    ds_write_b128 v3, v[40:43] offset:0
    v_max_u32 v22, v22, v43
    v_cmp_eq_u32 vcc, -1, v22
    s_nop 0
    s_nop 0
    s_cbranch_vccnz L_mg_92_r0
L_mg_92_c0:
    v_smfmac_f32_16x16x64_bf16 v[24:27], v[40:43], a[0:7], v2
    s_waitcnt vmcnt(2)
    v_max3_u32 v22, v44, v45, v46
    ds_write_b128 v3, v[44:47] offset:1024
    v_max_u32 v22, v22, v47
    v_cmp_eq_u32 vcc, -1, v22
    v_smfmac_f32_16x16x64_bf16 v[28:31], v[40:43], a[8:15], v2
    s_nop 0
    s_cbranch_vccnz L_mg_92_r1
L_mg_92_c1:
    v_smfmac_f32_16x16x64_bf16 v[24:27], v[44:47], a[16:23], v2
    s_waitcnt vmcnt(1)
    v_max3_u32 v22, v48, v49, v50
    ds_write_b128 v3, v[48:51] offset:2048
    v_max_u32 v22, v22, v51
    v_cmp_eq_u32 vcc, -1, v22
    v_smfmac_f32_16x16x64_bf16 v[28:31], v[44:47], a[24:31], v2
    s_nop 0
    s_cbranch_vccnz L_mg_92_r2
L_mg_92_c2:
    s_waitcnt vmcnt(0)
    v_max3_u32 v22, v52, v53, v54
    ds_write_b128 v3, v[52:55] offset:3072
    v_max_u32 v22, v22, v55
    v_cmp_eq_u32 vcc, -1, v22
    s_waitcnt lgkmcnt(0)
    s_nop 0
    s_cbranch_vccnz L_mg_92_r3
L_mg_92_c3:
    s_barrier
    ds_read_b128 v[40:43], v4 offset:0
    ds_read_b128 v[44:47], v4 offset:1024
    v_smfmac_f32_16x16x64_bf16 v[24:27], v[48:51], a[32:39], v2
    v_smfmac_f32_16x16x64_bf16 v[28:31], v[48:51], v[56:63], v2
    ds_read_b128 v[48:51], v4 offset:2048
    v_smfmac_f32_16x16x64_bf16 v[24:27], v[52:55], a[40:47], v2
    ds_read_b128 v[56:59], v5 offset:22528
    v_smfmac_f32_16x16x64_bf16 v[28:31], v[52:55], v[64:71], v2
    ds_read_b128 v[52:55], v4 offset:3072
    ds_read_b128 v[60:63], v5 offset:23552
    s_waitcnt lgkmcnt(4)
    v_smfmac_f32_16x16x64_bf16 v[24:27], v[40:43], a[48:55], v2
    ds_read_b128 v[64:67], v5 offset:2048
    v_smfmac_f32_16x16x64_bf16 v[28:31], v[40:43], v[72:79], v2
    ds_read_b128 v[40:43], v21 offset:0
    ds_read_b128 v[68:71], v5 offset:3072
    v_smfmac_f32_16x16x64_bf16 v[24:27], v[44:47], a[56:63], v2
    ds_read_b128 v[72:75], v5 offset:12288
    v_smfmac_f32_16x16x64_bf16 v[28:31], v[44:47], v[88:95], v2
    ds_read_b128 v[44:47], v21 offset:1024
    ds_read_b128 v[76:79], v5 offset:13312
    s_waitcnt lgkmcnt(6)
    v_smfmac_f32_16x16x64_bf16 v[24:27], v[48:51], a[64:71], v2
    ds_read_b128 v[88:91], v5 offset:20480
    v_smfmac_f32_16x16x64_bf16 v[28:31], v[48:51], v[32:39], v2
    ds_read_b128 v[48:51], v21 offset:2048
    ds_read_b128 v[92:95], v5 offset:21504
    v_smfmac_f32_16x16x64_bf16 v[24:27], v[52:55], a[72:79], v2
    ds_read_b128 v[32:35], v5 offset:0
    v_smfmac_f32_16x16x64_bf16 v[28:31], v[52:55], v[56:63], v2
    ds_read_b128 v[52:55], v21 offset:3072
    ds_read_b128 v[36:39], v5 offset:1024
    s_waitcnt lgkmcnt(6)
    v_smfmac_f32_16x16x64_bf16 v[24:27], v[40:43], a[80:87], v2
    ds_read_b128 v[56:59], v5 offset:10240
    v_smfmac_f32_16x16x64_bf16 v[28:31], v[40:43], v[64:71], v2
    ds_read_b128 v[40:43], v23 offset:0
    ds_read_b128 v[60:63], v5 offset:11264
    v_smfmac_f32_16x16x64_bf16 v[24:27], v[44:47], a[88:95], v2
    ds_read_b128 v[64:67], v5 offset:18432
    v_smfmac_f32_16x16x64_bf16 v[28:31], v[44:47], a[96:103], v2
    ds_read_b128 v[44:47], v23 offset:1024
    s_waitcnt lgkmcnt(5)
    v_smfmac_f32_16x16x64_bf16 v[24:27], v[48:51], a[104:111], v2
    ds_read_b128 v[68:71], v5 offset:19456
    v_smfmac_f32_16x16x64_bf16 v[28:31], v[48:51], v[72:79], v2
    ds_read_b128 v[48:51], v23 offset:2048
    v_smfmac_f32_16x16x64_bf16 v[24:27], v[52:55], a[112:119], v2
    v_smfmac_f32_16x16x64_bf16 v[28:31], v[52:55], v[88:95], v2
    ds_read_b128 v[52:55], v23 offset:3072
    s_waitcnt lgkmcnt(3)
    v_smfmac_f32_16x16x64_bf16 v[24:27], v[40:43], a[120:127], v2
    v_smfmac_f32_16x16x64_bf16 v[28:31], v[40:43], v[32:39], v2
    v_smfmac_f32_16x16x64_bf16 v[24:27], v[44:47], a[128:135], v2
    v_smfmac_f32_16x16x64_bf16 v[28:31], v[44:47], a[136:143], v2
    s_waitcnt lgkmcnt(0)
    v_smfmac_f32_16x16x64_bf16 v[24:27], v[48:51], a[144:151], v2
    v_smfmac_f32_16x16x64_bf16 v[28:31], v[48:51], v[56:63], v2
    v_smfmac_f32_16x16x64_bf16 v[24:27], v[52:55], a[152:159], v2
    v_smfmac_f32_16x16x64_bf16 v[28:31], v[52:55], v[64:71], v2
    s_and_b32 s45, s60, 1
    s_lshl_b32 s45, s45, 16
    s_add_u32 s45, s45, 0x7020000
    s_xor_b32 s46, s45, 65536
    s_nop 3
    v_permlane32_swap_b32 v24, v26
    v_permlane32_swap_b32 v25, v27
    v_permlane32_swap_b32 v28, v30
    v_permlane32_swap_b32 v29, v31
    v_pk_add_f32 v[24:25], v[24:25], v[26:27]
    v_pk_add_f32 v[28:29], v[28:29], v[30:31]
    v_cvt_pk_bf16_f32 v16, v24, v25
    v_cvt_pk_bf16_f32 v17, v28, v29
    s_add_u32 s47, s60, 3
    s_and_b32 s47, s47, 3
    s_lshl_b32 s47, s47, 14
    s_add_u32 s47, s47, s58
    buffer_store_dwordx2 v[16:17], v10, s[24:27], s45 offen
    buffer_store_dwordx2 v[14:15], v10, s[24:27], s46 offen
    buffer_store_dword v14, v12, s[24:27], s47 offen
    buffer_store_dwordx2 v[16:17], v10, s[28:31], s45 offen sc1
    buffer_store_dwordx2 v[14:15], v10, s[28:31], s46 offen sc1
    buffer_store_dword v14, v12, s[28:31], s47 offen sc1
    s_barrier
    s_cmp_eq_u32 s60, 63
    s_cbranch_scc1 L_v_fin_93
    s_and_b32 s65, s60, 1
    s_lshl_b32 s65, s65, 12
    s_and_b32 s45, s60, 2
    s_lshl_b32 s45, s45, 13
    s_add_u32 s65, s65, s45
    s_xor_b32 s45, s65, 16384
    s_add_u32 s45, s45, s63
    buffer_store_dwordx2 v[14:15], v11, s[12:15], s45 offen sc1
    s_add_u32 s48, s63, s65
    s_add_u32 s49, s64, s65
    s_sleep 8
    s_waitcnt vmcnt(0)
    s_mov_b64 exec, 65535
    buffer_load_dword v88, v13, s[12:15], 0 offen sc1
    s_nop 15
    buffer_load_dword v89, v13, s[12:15], 0 offen sc1
    s_nop 15
    buffer_load_dword v90, v13, s[12:15], 0 offen sc1
    s_nop 15
    buffer_load_dword v91, v13, s[12:15], 0 offen sc1
    s_mov_b32 s70, 0
L_pp_94:
    s_waitcnt vmcnt(3)
    v_cmp_ge_u32 vcc, s60, v88
    s_add_u32 s70, s70, 1
    s_nop 0
    s_cbranch_vccz L_ppd_95
    buffer_load_dword v88, v13, s[12:15], 0 offen sc1
    s_waitcnt vmcnt(3)
    v_cmp_ge_u32 vcc, s60, v89
    s_add_u32 s70, s70, 1
    s_nop 0
    s_cbranch_vccz L_ppd_95
    buffer_load_dword v89, v13, s[12:15], 0 offen sc1
    s_waitcnt vmcnt(3)
    v_cmp_ge_u32 vcc, s60, v90
    s_add_u32 s70, s70, 1
    s_nop 0
    s_cbranch_vccz L_ppd_95
    buffer_load_dword v90, v13, s[12:15], 0 offen sc1
    s_waitcnt vmcnt(3)
    v_cmp_ge_u32 vcc, s60, v91
    s_add_u32 s70, s70, 1
    s_nop 0
    s_cbranch_vccz L_ppd_95
    buffer_load_dword v91, v13, s[12:15], 0 offen sc1
    s_cmp_lt_u32 s70, 0x400000
    s_cbranch_scc1 L_pp_94
    s_branch L_c_done_1
L_ppd_95:
    s_mov_b64 exec, -1
    s_nop 3
    s_mov_b32 s70, 0
    buffer_load_dwordx4 v[40:43], v80, s[12:15], s62 offen sc1
    v_mov_b32 v24, 0
    v_mov_b32 v25, 0
    v_mov_b32 v26, 0
    v_mov_b32 v27, 0
    s_nop 3
    buffer_load_dwordx4 v[44:47], v81, s[12:15], s62 offen sc1
    v_mov_b32 v28, 0
    v_mov_b32 v29, 0
    v_mov_b32 v30, 0
    v_mov_b32 v31, 0
    s_nop 3
    buffer_load_dwordx4 v[48:51], v82, s[12:15], s62 offen sc1
    v_mov_b32 v32, 0
    v_mov_b32 v33, 0
    v_mov_b32 v34, 0
    v_mov_b32 v35, 0
    s_nop 3
    buffer_load_dwordx4 v[52:55], v83, s[12:15], s62 offen sc1
    v_mov_b32 v36, 0
    v_mov_b32 v37, 0
    v_mov_b32 v38, 0
    v_mov_b32 v39, 0
    s_nop 3
    buffer_load_dwordx4 v[56:59], v84, s[12:15], s62 offen sc1
    s_nop 7
    buffer_load_dwordx4 v[60:63], v85, s[12:15], s62 offen sc1
    s_waitcnt vmcnt(5)
    v_cmp_eq_u32 vcc, -1, v43
    s_nop 1
    s_cbranch_vccnz L_v_og_96_r0
L_v_og_96_c0:
    v_smfmac_f32_16x16x64_bf16 v[24:27], v[40:43], a[160:167], v2
    s_waitcnt vmcnt(4)
    v_smfmac_f32_16x16x64_bf16 v[28:31], v[40:43], a[168:175], v2
    v_cmp_eq_u32 vcc, -1, v47
    v_smfmac_f32_16x16x64_bf16 v[32:35], v[40:43], a[176:183], v2
    buffer_load_dwordx4 v[64:67], v86, s[12:15], s62 offen sc1
    v_smfmac_f32_16x16x64_bf16 v[36:39], v[40:43], a[184:191], v2
    s_cbranch_vccnz L_v_og_96_r1
L_v_og_96_c1:
    v_smfmac_f32_16x16x64_bf16 v[24:27], v[44:47], a[192:199], v2
    s_waitcnt vmcnt(4)
    v_smfmac_f32_16x16x64_bf16 v[28:31], v[44:47], a[200:207], v2
    v_cmp_eq_u32 vcc, -1, v51
    v_smfmac_f32_16x16x64_bf16 v[32:35], v[44:47], a[208:215], v2
    buffer_load_dwordx4 v[68:71], v87, s[12:15], s62 offen sc1
    v_smfmac_f32_16x16x64_bf16 v[36:39], v[44:47], a[216:223], v2
    s_cbranch_vccnz L_v_og_96_r2
L_v_og_96_c2:
    v_smfmac_f32_16x16x64_bf16 v[24:27], v[48:51], a[224:231], v2
    s_waitcnt vmcnt(4)
    v_smfmac_f32_16x16x64_bf16 v[28:31], v[48:51], a[232:239], v2
    v_cmp_eq_u32 vcc, -1, v55
    v_smfmac_f32_16x16x64_bf16 v[32:35], v[48:51], a[240:247], v2
    v_smfmac_f32_16x16x64_bf16 v[36:39], v[48:51], a[248:255], v2
    s_cbranch_vccnz L_v_og_96_r3
L_v_og_96_c3:
    v_smfmac_f32_16x16x64_bf16 v[24:27], v[52:55], v[96:103], v2
    s_waitcnt vmcnt(3)
    v_cmp_eq_u32 vcc, -1, v59
    v_smfmac_f32_16x16x64_bf16 v[28:31], v[52:55], v[104:111], v2
    v_smfmac_f32_16x16x64_bf16 v[32:35], v[52:55], v[112:119], v2
    s_cbranch_vccnz L_v_og_96_r4
L_v_og_96_c4:
    v_smfmac_f32_16x16x64_bf16 v[24:27], v[56:59], v[128:135], v2
    s_waitcnt vmcnt(2)
    v_cmp_eq_u32 vcc, -1, v63
    v_smfmac_f32_16x16x64_bf16 v[28:31], v[56:59], v[136:143], v2
    v_smfmac_f32_16x16x64_bf16 v[32:35], v[56:59], v[144:151], v2
    s_cbranch_vccnz L_v_og_96_r5
L_v_og_96_c5:
    v_smfmac_f32_16x16x64_bf16 v[24:27], v[60:63], v[160:167], v2
    s_waitcnt vmcnt(1)
    v_cmp_eq_u32 vcc, -1, v67
    v_smfmac_f32_16x16x64_bf16 v[28:31], v[60:63], v[168:175], v2
    v_smfmac_f32_16x16x64_bf16 v[32:35], v[60:63], v[176:183], v2
    s_cbranch_vccnz L_v_og_96_r6
L_v_og_96_c6:
    v_smfmac_f32_16x16x64_bf16 v[24:27], v[64:67], v[192:199], v2
    s_waitcnt vmcnt(0)
    v_cmp_eq_u32 vcc, -1, v71
    v_smfmac_f32_16x16x64_bf16 v[28:31], v[64:67], v[200:207], v2
    v_smfmac_f32_16x16x64_bf16 v[32:35], v[64:67], v[208:215], v2
    s_cbranch_vccnz L_v_og_96_r7
L_v_og_96_c7:
    v_smfmac_f32_16x16x64_bf16 v[24:27], v[68:71], v[224:231], v2
    v_smfmac_f32_16x16x64_bf16 v[28:31], v[68:71], v[232:239], v2
    v_smfmac_f32_16x16x64_bf16 v[32:35], v[68:71], v[240:247], v2
    v_smfmac_f32_16x16x64_bf16 v[36:39], v[52:55], v[120:127], v2
    s_add_u32 s46, s60, 1
    v_smfmac_f32_16x16x64_bf16 v[36:39], v[56:59], v[152:159], v2
    s_and_b32 s45, s46, 3
    v_smfmac_f32_16x16x64_bf16 v[36:39], v[60:63], v[184:191], v2
    s_mov_b32 s60, s46
    ds_write_b128 v6, v[24:27] offset:0
    v_smfmac_f32_16x16x64_bf16 v[36:39], v[64:67], v[216:223], v2
    ds_write_b128 v6, v[28:31] offset:1024
    v_smfmac_f32_16x16x64_bf16 v[36:39], v[68:71], v[248:255], v2
    ds_write_b128 v6, v[32:35] offset:2048
    s_lshl_b32 s46, s45, 14
    s_add_u32 s61, s58, s46
    s_lshl_b32 s46, s45, 15
    s_add_u32 s62, s59, s46
    s_waitcnt lgkmcnt(0)
    s_barrier
    ds_read_b128 v[40:43], v7
    ds_read_b128 v[44:47], v8
    ds_read_b128 v[48:51], v18
    v_mov_b32 v19, s60
    s_waitcnt lgkmcnt(2)
    v_pk_add_f32 v[36:37], v[36:37], v[40:41]
    v_pk_add_f32 v[38:39], v[38:39], v[42:43]
    s_waitcnt lgkmcnt(1)
    v_pk_add_f32 v[36:37], v[36:37], v[44:45]
    v_pk_add_f32 v[38:39], v[38:39], v[46:47]
    s_waitcnt lgkmcnt(0)
    v_pk_add_f32 v[36:37], v[36:37], v[48:49]
    v_pk_add_f32 v[38:39], v[38:39], v[50:51]
    s_nop 1
    v_permlane32_swap_b32 v36, v38
    v_permlane32_swap_b32 v37, v39
    v_pk_add_f32 v[24:25], v[36:37], v[38:39]
    buffer_store_dwordx2 v[24:25], v11, s[12:15], s48 offen sc1
    ds_read_b128 v[56:59], v5 offset:8192
    ds_read_b128 v[60:63], v5 offset:9216
    ds_read_b128 v[64:67], v5 offset:16384
    ds_read_b128 v[68:71], v5 offset:17408
    ds_read_b128 v[72:75], v5 offset:4096
    ds_read_b128 v[76:79], v5 offset:5120
    ds_read_b128 v[88:91], v5 offset:6144
    ds_read_b128 v[92:95], v5 offset:7168
    ds_read_b128 v[32:35], v5 offset:14336
    ds_read_b128 v[36:39], v5 offset:15360
    s_sleep 4
    buffer_load_dwordx2 v[40:41], v11, s[12:15], s49 offen sc1
    s_mov_b32 s70, 0
L_v_xp_97:
    s_waitcnt vmcnt(0)
    v_max_u32 v22, v40, v41
    v_cmp_eq_u32 vcc, -1, v22
    v_pk_add_f32 v[28:29], v[24:25], v[40:41]
    v_cvt_pk_bf16_f32 v28, v28, v29
    s_cbranch_vccnz L_v_xp_97_r
L_v_xp_97_ok:
    buffer_store_dword v19, v20, s[24:27], 0 offen
    v_mov_b32_dpp v29, v28 quad_perm:[1,0,3,2] row_mask:0xf bank_mask:0xf
    v_perm_b32 v28, v28, v29, v9
    buffer_store_dword v28, v12, s[24:27], s61 offen
    buffer_store_dword v28, v12, s[28:31], s61 offen sc1
    buffer_store_dword v19, v20, s[28:31], 0 offen sc1
    s_add_u32 s66, s66, 65536
    s_branch L_v_loop_91
L_v_fin_93:
    buffer_store_dwordx2 v[16:17], v10, s[12:15], s66 offen sc1
    s_waitcnt vmcnt(0)
    v_mov_b32 v22, 64
    v_mov_b32 v0, 0
    s_mov_b64 exec, 1
    buffer_store_dword v22, v0, s[12:15], s3 offen sc1
    s_mov_b64 exec, -1
L_c_done_1:
    s_endpgm
L_v_og_96_r0:
    buffer_load_dwordx4 v[40:43], v80, s[12:15], s62 offen sc1
    buffer_load_dwordx4 v[44:47], v81, s[12:15], s62 offen sc1
    buffer_load_dwordx4 v[48:51], v82, s[12:15], s62 offen sc1
    buffer_load_dwordx4 v[52:55], v83, s[12:15], s62 offen sc1
    buffer_load_dwordx4 v[56:59], v84, s[12:15], s62 offen sc1
    buffer_load_dwordx4 v[60:63], v85, s[12:15], s62 offen sc1
    s_add_u32 s70, s70, 1
    s_cmp_ge_u32 s70, 0x100000
    s_cbranch_scc1 L_c_done_1
    s_waitcnt vmcnt(5)
    v_cmp_eq_u32 vcc, -1, v43
    s_nop 1
    s_cbranch_vccnz L_v_og_96_r0
    s_branch L_v_og_96_c0
L_v_og_96_r1:
    buffer_load_dwordx4 v[44:47], v81, s[12:15], s62 offen sc1
    buffer_load_dwordx4 v[48:51], v82, s[12:15], s62 offen sc1
    buffer_load_dwordx4 v[52:55], v83, s[12:15], s62 offen sc1
    buffer_load_dwordx4 v[56:59], v84, s[12:15], s62 offen sc1
    buffer_load_dwordx4 v[60:63], v85, s[12:15], s62 offen sc1
    buffer_load_dwordx4 v[64:67], v86, s[12:15], s62 offen sc1
    s_add_u32 s70, s70, 1
    s_cmp_ge_u32 s70, 0x100000
    s_cbranch_scc1 L_c_done_1
    s_waitcnt vmcnt(5)
    v_cmp_eq_u32 vcc, -1, v47
    s_nop 1
    s_cbranch_vccnz L_v_og_96_r1
    s_branch L_v_og_96_c1
L_v_og_96_r2:
    buffer_load_dwordx4 v[48:51], v82, s[12:15], s62 offen sc1
    buffer_load_dwordx4 v[52:55], v83, s[12:15], s62 offen sc1
    buffer_load_dwordx4 v[56:59], v84, s[12:15], s62 offen sc1
    buffer_load_dwordx4 v[60:63], v85, s[12:15], s62 offen sc1
    buffer_load_dwordx4 v[64:67], v86, s[12:15], s62 offen sc1
    buffer_load_dwordx4 v[68:71], v87, s[12:15], s62 offen sc1
    s_add_u32 s70, s70, 1
    s_cmp_ge_u32 s70, 0x100000
    s_cbranch_scc1 L_c_done_1
    s_waitcnt vmcnt(5)
    v_cmp_eq_u32 vcc, -1, v51
    s_nop 1
    s_cbranch_vccnz L_v_og_96_r2
    s_branch L_v_og_96_c2
L_v_og_96_r3:
    buffer_load_dwordx4 v[52:55], v83, s[12:15], s62 offen sc1
    buffer_load_dwordx4 v[56:59], v84, s[12:15], s62 offen sc1
    buffer_load_dwordx4 v[60:63], v85, s[12:15], s62 offen sc1
    buffer_load_dwordx4 v[64:67], v86, s[12:15], s62 offen sc1
    buffer_load_dwordx4 v[68:71], v87, s[12:15], s62 offen sc1
    s_add_u32 s70, s70, 1
    s_cmp_ge_u32 s70, 0x100000
    s_cbranch_scc1 L_c_done_1
    s_waitcnt vmcnt(4)
    v_cmp_eq_u32 vcc, -1, v55
    s_nop 1
    s_cbranch_vccnz L_v_og_96_r3
    s_branch L_v_og_96_c3
L_v_og_96_r4:
    buffer_load_dwordx4 v[56:59], v84, s[12:15], s62 offen sc1
    buffer_load_dwordx4 v[60:63], v85, s[12:15], s62 offen sc1
    buffer_load_dwordx4 v[64:67], v86, s[12:15], s62 offen sc1
    buffer_load_dwordx4 v[68:71], v87, s[12:15], s62 offen sc1
    s_add_u32 s70, s70, 1
    s_cmp_ge_u32 s70, 0x100000
    s_cbranch_scc1 L_c_done_1
    s_waitcnt vmcnt(3)
    v_cmp_eq_u32 vcc, -1, v59
    s_nop 1
    s_cbranch_vccnz L_v_og_96_r4
    s_branch L_v_og_96_c4
L_v_og_96_r5:
    buffer_load_dwordx4 v[60:63], v85, s[12:15], s62 offen sc1
    buffer_load_dwordx4 v[64:67], v86, s[12:15], s62 offen sc1
    buffer_load_dwordx4 v[68:71], v87, s[12:15], s62 offen sc1
    s_add_u32 s70, s70, 1
    s_cmp_ge_u32 s70, 0x100000
    s_cbranch_scc1 L_c_done_1
    s_waitcnt vmcnt(2)
    v_cmp_eq_u32 vcc, -1, v63
    s_nop 1
    s_cbranch_vccnz L_v_og_96_r5
    s_branch L_v_og_96_c5
L_v_og_96_r6:
    buffer_load_dwordx4 v[64:67], v86, s[12:15], s62 offen sc1
    buffer_load_dwordx4 v[68:71], v87, s[12:15], s62 offen sc1
    s_add_u32 s70, s70, 1
    s_cmp_ge_u32 s70, 0x100000
    s_cbranch_scc1 L_c_done_1
    s_waitcnt vmcnt(1)
    v_cmp_eq_u32 vcc, -1, v67
    s_nop 1
    s_cbranch_vccnz L_v_og_96_r6
    s_branch L_v_og_96_c6
L_v_og_96_r7:
    buffer_load_dwordx4 v[68:71], v87, s[12:15], s62 offen sc1
    s_add_u32 s70, s70, 1
    s_cmp_ge_u32 s70, 0x100000
    s_cbranch_scc1 L_c_done_1
    s_waitcnt vmcnt(0)
    v_cmp_eq_u32 vcc, -1, v71
    s_nop 1
    s_cbranch_vccnz L_v_og_96_r7
    s_branch L_v_og_96_c7
L_mg_92_r0:
    buffer_load_dwordx4 v[40:43], v3, s[12:15], s8 offen sc1
    buffer_load_dwordx4 v[44:47], v3, s[12:15], s9 offen sc1
    buffer_load_dwordx4 v[48:51], v3, s[12:15], s10 offen sc1
    buffer_load_dwordx4 v[52:55], v3, s[12:15], s11 offen sc1
    s_add_u32 s70, s70, 1
    s_cmp_ge_u32 s70, 0x100000
    s_cbranch_scc1 L_c_done_1
    s_waitcnt vmcnt(3)
    ds_write_b128 v3, v[40:43] offset:0
    v_max3_u32 v22, v40, v41, v42
    v_max_u32 v22, v22, v43
    v_cmp_eq_u32 vcc, -1, v22
    s_waitcnt lgkmcnt(0)
    s_nop 0
    s_cbranch_vccnz L_mg_92_r0
    s_branch L_mg_92_c0
L_mg_92_r1:
    buffer_load_dwordx4 v[44:47], v3, s[12:15], s9 offen sc1
    buffer_load_dwordx4 v[48:51], v3, s[12:15], s10 offen sc1
    buffer_load_dwordx4 v[52:55], v3, s[12:15], s11 offen sc1
    s_add_u32 s70, s70, 1
    s_cmp_ge_u32 s70, 0x100000
    s_cbranch_scc1 L_c_done_1
    s_waitcnt vmcnt(2)
    ds_write_b128 v3, v[44:47] offset:1024
    v_max3_u32 v22, v44, v45, v46
    v_max_u32 v22, v22, v47
    v_cmp_eq_u32 vcc, -1, v22
    s_waitcnt lgkmcnt(0)
    s_nop 0
    s_cbranch_vccnz L_mg_92_r1
    s_branch L_mg_92_c1
L_mg_92_r2:
    buffer_load_dwordx4 v[48:51], v3, s[12:15], s10 offen sc1
    buffer_load_dwordx4 v[52:55], v3, s[12:15], s11 offen sc1
    s_add_u32 s70, s70, 1
    s_cmp_ge_u32 s70, 0x100000
    s_cbranch_scc1 L_c_done_1
    s_waitcnt vmcnt(1)
    ds_write_b128 v3, v[48:51] offset:2048
    v_max3_u32 v22, v48, v49, v50
    v_max_u32 v22, v22, v51
    v_cmp_eq_u32 vcc, -1, v22
    s_waitcnt lgkmcnt(0)
    s_nop 0
    s_cbranch_vccnz L_mg_92_r2
    s_branch L_mg_92_c2
L_mg_92_r3:
    buffer_load_dwordx4 v[52:55], v3, s[12:15], s11 offen sc1
    s_add_u32 s70, s70, 1
    s_cmp_ge_u32 s70, 0x100000
    s_cbranch_scc1 L_c_done_1
    s_waitcnt vmcnt(0)
    ds_write_b128 v3, v[52:55] offset:3072
    v_max3_u32 v22, v52, v53, v54
    v_max_u32 v22, v22, v55
    v_cmp_eq_u32 vcc, -1, v22
    s_waitcnt lgkmcnt(0)
    s_nop 0
    s_cbranch_vccnz L_mg_92_r3
    s_branch L_mg_92_c3
L_v_xp_97_r:
    buffer_load_dwordx2 v[40:41], v11, s[12:15], s49 offen sc1
    s_add_u32 s70, s70, 1
    s_cmp_lt_u32 s70, 0x100000
    s_cbranch_scc1 L_v_xp_97
    s_endpgm
L_worker_3:
    s_lshr_b32 s41, s2, 3
    s_and_b32 s42, s40, 1
    s_lshr_b32 s43, s40, 1
    s_lshl_b32 s39, s43, 5
    s_add_u32 s39, s39, s41
    s_load_dwordx2 s[4:5], s[0:1], 0
    s_waitcnt lgkmcnt(0)
    s_mov_b32 s28, s4
    s_and_b32 s29, s5, 0xffff
    s_mov_b32 s30, 0x400000
    s_mov_b32 s31, 0x00020000
    v_lshrrev_b32 v2, 4, v1
    v_and_b32 v4, 15, v1
    v_lshrrev_b32 v3, 1, v4
    v_xor_b32 v3, v3, v2
    v_lshlrev_b32 v3, 4, v3
    v_lshlrev_b32 v6, 7, v4
    v_add_u32 v3, v3, v6
    v_mul_u32_u24 v7, 144, v4
    v_lshlrev_b32 v6, 4, v2
    s_mul_i32 s45, s44, 4608
    s_add_u32 s45, s45, 131072
    v_add3_u32 v7, v7, v6, s45
    v_lshrrev_b32 v9, 3, v1
    v_mul_u32_u24 v8, 144, v9
    v_and_b32 v6, 7, v1
    v_lshlrev_b32 v6, 4, v6
    v_add3_u32 v8, v8, v6, s45
    v_lshlrev_b32 v11, 12, v9
    v_add_u32 v11, v11, v6
    v_lshlrev_b32 v2, 13, v2
    v_lshlrev_b32 v6, 4, v4
    v_add_u32 v2, v2, v6
    v_lshrrev_b32 v6, 3, v1
    v_lshrrev_b32 v9, 4, v1
    v_and_b32 v4, 7, v1
    v_xor_b32 v9, v9, v4
    v_lshlrev_b32 v9, 4, v9
    v_lshlrev_b32 v6, 8, v6
    v_add_u32 v6, v6, v9
    v_xor_b32 v9, 64, v6
    v_add_u32 v9, 2048, v9
    v_lshlrev_b32 v10, 4, v1
    v_lshlrev_b32 v12, 2, v1
    v_lshlrev_b32 v5, 7, v1
    s_lshl_b32 s61, s41, 7
    s_lshl_b32 s45, s43, 2
    s_add_u32 s61, s61, s45
    s_add_u32 s61, s61, 0x10010
    s_mul_i32 s64, s42, 24576
    s_add_u32 s64, s64, 0x12000
    s_lshl_b32 s45, s41, 7
    s_add_u32 s65, s64, s45
    s_lshl_b32 s45, s43, 13
    s_add_u32 s65, s65, s45
    s_add_u32 s67, s65, 4096
    s_cmp_lg_u32 s42, 0
    s_cbranch_scc1 L_w_kv_99
    v_mov_b32 v30, 0
    v_mov_b32 v31, 0
    v_mov_b32 v29, 24576
    s_mov_b64 exec, 1
    buffer_store_dword v30, v31, s[12:15], s65 offen sc1
    buffer_store_dword v30, v31, s[12:15], s67 offen sc1
    buffer_store_dword v30, v29, s[12:15], s65 offen sc1
    buffer_store_dword v30, v29, s[12:15], s67 offen sc1
    s_mov_b64 exec, -1
    s_lshl_b32 s63, s39, 2
    s_add_u32 s63, s63, s44
    s_load_dwordx2 s[4:5], s[0:1], 96
    s_load_dwordx2 s[6:7], s[0:1], 104
    v_and_b32 v14, 7, v0
    v_lshrrev_b32 v15, 3, v0
    s_waitcnt lgkmcnt(0)
    s_mov_b32 s32, s4
    s_and_b32 s33, s5, 0xffff
    s_mov_b32 s34, 0x800
    s_mov_b32 s35, 0x00020000
    s_mov_b32 s24, s6
    s_and_b32 s25, s7, 0xffff
    s_mov_b32 s26, 0xc00000
    s_mov_b32 s27, 0x00020000
    s_and_b32 s47, s39, 1
    s_lshl_b32 s45, s47, 10
    v_lshlrev_b32 v16, 5, v15
    buffer_load_dwordx4 v[104:107], v16, s[32:35], s45 offen
    buffer_load_dwordx4 v[108:111], v16, s[32:35], s45 offen offset:16
    s_mov_b32 s45, 196608
    v_mul_lo_u32 v17, v15, s45
    v_lshlrev_b32 v18, 4, v14
    v_add_u32 v17, v17, v18
    s_lshr_b32 s46, s39, 1
    s_lshl_b32 s46, s46, 7
    s_mul_i32 s45, s47, 6291456
    s_add_u32 s46, s46, s45
    buffer_load_dwordx4 v[32:35], v17, s[24:27], s46 offen
    v_add_u32 v17, 12288, v17
    buffer_load_dwordx4 v[36:39], v17, s[24:27], s46 offen
    v_add_u32 v17, 12288, v17
    buffer_load_dwordx4 v[40:43], v17, s[24:27], s46 offen
    v_add_u32 v17, 12288, v17
    buffer_load_dwordx4 v[44:47], v17, s[24:27], s46 offen
    v_add_u32 v17, 12288, v17
    buffer_load_dwordx4 v[48:51], v17, s[24:27], s46 offen
    v_add_u32 v17, 12288, v17
    buffer_load_dwordx4 v[52:55], v17, s[24:27], s46 offen
    v_add_u32 v17, 12288, v17
    buffer_load_dwordx4 v[56:59], v17, s[24:27], s46 offen
    v_add_u32 v17, 12288, v17
    buffer_load_dwordx4 v[60:63], v17, s[24:27], s46 offen
    v_add_u32 v17, 12288, v17
    buffer_load_dwordx4 v[64:67], v17, s[24:27], s46 offen
    v_add_u32 v17, 12288, v17
    buffer_load_dwordx4 v[68:71], v17, s[24:27], s46 offen
    v_add_u32 v17, 12288, v17
    buffer_load_dwordx4 v[72:75], v17, s[24:27], s46 offen
    v_add_u32 v17, 12288, v17
    buffer_load_dwordx4 v[76:79], v17, s[24:27], s46 offen
    v_add_u32 v17, 12288, v17
    buffer_load_dwordx4 v[80:83], v17, s[24:27], s46 offen
    v_add_u32 v17, 12288, v17
    buffer_load_dwordx4 v[84:87], v17, s[24:27], s46 offen
    v_add_u32 v17, 12288, v17
    buffer_load_dwordx4 v[88:91], v17, s[24:27], s46 offen
    v_add_u32 v17, 12288, v17
    buffer_load_dwordx4 v[92:95], v17, s[24:27], s46 offen
    s_add_u32 s45, s63, 0
    s_lshl_b32 s45, s45, 11
    buffer_load_dwordx4 v[128:131], v10, s[28:31], s45 offen
    buffer_load_dwordx4 v[132:135], v10, s[28:31], s45 offen offset:1024
    s_add_u32 s45, s63, 384
    s_lshl_b32 s45, s45, 11
    buffer_load_dwordx4 v[136:139], v10, s[28:31], s45 offen
    buffer_load_dwordx4 v[140:143], v10, s[28:31], s45 offen offset:1024
    s_add_u32 s45, s63, 768
    s_lshl_b32 s45, s45, 11
    buffer_load_dwordx4 v[144:147], v10, s[28:31], s45 offen
    buffer_load_dwordx4 v[148:151], v10, s[28:31], s45 offen offset:1024
    s_add_u32 s45, s63, 1152
    s_lshl_b32 s45, s45, 11
    buffer_load_dwordx4 v[152:155], v10, s[28:31], s45 offen
    buffer_load_dwordx4 v[156:159], v10, s[28:31], s45 offen offset:1024
    s_add_u32 s45, s63, 1536
    s_lshl_b32 s45, s45, 11
    buffer_load_dwordx4 v[160:163], v10, s[28:31], s45 offen
    buffer_load_dwordx4 v[164:167], v10, s[28:31], s45 offen offset:1024
    s_add_u32 s45, s63, 1920
    s_lshl_b32 s45, s45, 11
    buffer_load_dwordx4 v[168:171], v10, s[28:31], s45 offen
    buffer_load_dwordx4 v[172:175], v10, s[28:31], s45 offen offset:1024
    s_waitcnt vmcnt(28)
    v_lshlrev_b32 v112, 16, v104
    v_and_b32 v113, 0xffff0000, v104
    v_lshlrev_b32 v114, 16, v105
    v_and_b32 v115, 0xffff0000, v105
    v_lshlrev_b32 v116, 16, v106
    v_and_b32 v117, 0xffff0000, v106
    v_lshlrev_b32 v118, 16, v107
    v_and_b32 v119, 0xffff0000, v107
    v_lshlrev_b32 v120, 16, v108
    v_and_b32 v121, 0xffff0000, v108
    v_lshlrev_b32 v122, 16, v109
    v_and_b32 v123, 0xffff0000, v109
    v_lshlrev_b32 v124, 16, v110
    v_and_b32 v125, 0xffff0000, v110
    v_lshlrev_b32 v126, 16, v111
    v_and_b32 v127, 0xffff0000, v111
    v_mul_f32 v18, 0xbfb8aa3b, v112
    v_exp_f32 v18, v18
    s_nop 0
    v_add_f32 v18, 1.0, v18
    v_rcp_f32 v18, v18
    s_nop 0
    v_mul_f32 v112, v112, v18
    v_cvt_pk_bf16_f32 v112, v112, v112
    v_lshlrev_b32 v112, 16, v112
    v_mul_f32 v18, 0xbfb8aa3b, v113
    v_exp_f32 v18, v18
    s_nop 0
    v_add_f32 v18, 1.0, v18
    v_rcp_f32 v18, v18
    s_nop 0
    v_mul_f32 v113, v113, v18
    v_cvt_pk_bf16_f32 v113, v113, v113
    v_lshlrev_b32 v113, 16, v113
    v_mul_f32 v18, 0xbfb8aa3b, v114
    v_exp_f32 v18, v18
    s_nop 0
    v_add_f32 v18, 1.0, v18
    v_rcp_f32 v18, v18
    s_nop 0
    v_mul_f32 v114, v114, v18
    v_cvt_pk_bf16_f32 v114, v114, v114
    v_lshlrev_b32 v114, 16, v114
    v_mul_f32 v18, 0xbfb8aa3b, v115
    v_exp_f32 v18, v18
    s_nop 0
    v_add_f32 v18, 1.0, v18
    v_rcp_f32 v18, v18
    s_nop 0
    v_mul_f32 v115, v115, v18
    v_cvt_pk_bf16_f32 v115, v115, v115
    v_lshlrev_b32 v115, 16, v115
    v_mul_f32 v18, 0xbfb8aa3b, v116
    v_exp_f32 v18, v18
    s_nop 0
    v_add_f32 v18, 1.0, v18
    v_rcp_f32 v18, v18
    s_nop 0
    v_mul_f32 v116, v116, v18
    v_cvt_pk_bf16_f32 v116, v116, v116
    v_lshlrev_b32 v116, 16, v116
    v_mul_f32 v18, 0xbfb8aa3b, v117
    v_exp_f32 v18, v18
    s_nop 0
    v_add_f32 v18, 1.0, v18
    v_rcp_f32 v18, v18
    s_nop 0
    v_mul_f32 v117, v117, v18
    v_cvt_pk_bf16_f32 v117, v117, v117
    v_lshlrev_b32 v117, 16, v117
    v_mul_f32 v18, 0xbfb8aa3b, v118
    v_exp_f32 v18, v18
    s_nop 0
    v_add_f32 v18, 1.0, v18
    v_rcp_f32 v18, v18
    s_nop 0
    v_mul_f32 v118, v118, v18
    v_cvt_pk_bf16_f32 v118, v118, v118
    v_lshlrev_b32 v118, 16, v118
    v_mul_f32 v18, 0xbfb8aa3b, v119
    v_exp_f32 v18, v18
    s_nop 0
    v_add_f32 v18, 1.0, v18
    v_rcp_f32 v18, v18
    s_nop 0
    v_mul_f32 v119, v119, v18
    v_cvt_pk_bf16_f32 v119, v119, v119
    v_lshlrev_b32 v119, 16, v119
    v_mul_f32 v18, 0xbfb8aa3b, v120
    v_exp_f32 v18, v18
    s_nop 0
    v_add_f32 v18, 1.0, v18
    v_rcp_f32 v18, v18
    s_nop 0
    v_mul_f32 v120, v120, v18
    v_cvt_pk_bf16_f32 v120, v120, v120
    v_lshlrev_b32 v120, 16, v120
    v_mul_f32 v18, 0xbfb8aa3b, v121
    v_exp_f32 v18, v18
    s_nop 0
    v_add_f32 v18, 1.0, v18
    v_rcp_f32 v18, v18
    s_nop 0
    v_mul_f32 v121, v121, v18
    v_cvt_pk_bf16_f32 v121, v121, v121
    v_lshlrev_b32 v121, 16, v121
    v_mul_f32 v18, 0xbfb8aa3b, v122
    v_exp_f32 v18, v18
    s_nop 0
    v_add_f32 v18, 1.0, v18
    v_rcp_f32 v18, v18
    s_nop 0
    v_mul_f32 v122, v122, v18
    v_cvt_pk_bf16_f32 v122, v122, v122
    v_lshlrev_b32 v122, 16, v122
    v_mul_f32 v18, 0xbfb8aa3b, v123
    v_exp_f32 v18, v18
    s_nop 0
    v_add_f32 v18, 1.0, v18
    v_rcp_f32 v18, v18
    s_nop 0
    v_mul_f32 v123, v123, v18
    v_cvt_pk_bf16_f32 v123, v123, v123
    v_lshlrev_b32 v123, 16, v123
    v_mul_f32 v18, 0xbfb8aa3b, v124
    v_exp_f32 v18, v18
    s_nop 0
    v_add_f32 v18, 1.0, v18
    v_rcp_f32 v18, v18
    s_nop 0
    v_mul_f32 v124, v124, v18
    v_cvt_pk_bf16_f32 v124, v124, v124
    v_lshlrev_b32 v124, 16, v124
    v_mul_f32 v18, 0xbfb8aa3b, v125
    v_exp_f32 v18, v18
    s_nop 0
    v_add_f32 v18, 1.0, v18
    v_rcp_f32 v18, v18
    s_nop 0
    v_mul_f32 v125, v125, v18
    v_cvt_pk_bf16_f32 v125, v125, v125
    v_lshlrev_b32 v125, 16, v125
    v_mul_f32 v18, 0xbfb8aa3b, v126
    v_exp_f32 v18, v18
    s_nop 0
    v_add_f32 v18, 1.0, v18
    v_rcp_f32 v18, v18
    s_nop 0
    v_mul_f32 v126, v126, v18
    v_cvt_pk_bf16_f32 v126, v126, v126
    v_lshlrev_b32 v126, 16, v126
    v_mul_f32 v18, 0xbfb8aa3b, v127
    v_exp_f32 v18, v18
    s_nop 0
    v_add_f32 v18, 1.0, v18
    v_rcp_f32 v18, v18
    s_nop 0
    v_mul_f32 v127, v127, v18
    v_cvt_pk_bf16_f32 v127, v127, v127
    v_lshlrev_b32 v127, 16, v127
    v_mov_b32 v96, 0
    v_mov_b32 v97, 0
    v_mov_b32 v98, 0
    v_mov_b32 v99, 0
    v_mov_b32 v100, 0
    v_mov_b32 v101, 0
    v_mov_b32 v102, 0
    v_mov_b32 v103, 0
    s_waitcnt vmcnt(27)
    v_lshlrev_b32 v18, 16, v32
    v_and_b32 v19, 0xffff0000, v32
    v_fmac_f32 v96, v18, v112
    v_fmac_f32 v97, v19, v112
    v_lshlrev_b32 v18, 16, v33
    v_and_b32 v19, 0xffff0000, v33
    v_fmac_f32 v98, v18, v112
    v_fmac_f32 v99, v19, v112
    v_lshlrev_b32 v18, 16, v34
    v_and_b32 v19, 0xffff0000, v34
    v_fmac_f32 v100, v18, v112
    v_fmac_f32 v101, v19, v112
    v_lshlrev_b32 v18, 16, v35
    v_and_b32 v19, 0xffff0000, v35
    v_fmac_f32 v102, v18, v112
    v_fmac_f32 v103, v19, v112
    s_waitcnt vmcnt(26)
    v_lshlrev_b32 v18, 16, v36
    v_and_b32 v19, 0xffff0000, v36
    v_fmac_f32 v96, v18, v113
    v_fmac_f32 v97, v19, v113
    v_lshlrev_b32 v18, 16, v37
    v_and_b32 v19, 0xffff0000, v37
    v_fmac_f32 v98, v18, v113
    v_fmac_f32 v99, v19, v113
    v_lshlrev_b32 v18, 16, v38
    v_and_b32 v19, 0xffff0000, v38
    v_fmac_f32 v100, v18, v113
    v_fmac_f32 v101, v19, v113
    v_lshlrev_b32 v18, 16, v39
    v_and_b32 v19, 0xffff0000, v39
    v_fmac_f32 v102, v18, v113
    v_fmac_f32 v103, v19, v113
    s_waitcnt vmcnt(25)
    v_lshlrev_b32 v18, 16, v40
    v_and_b32 v19, 0xffff0000, v40
    v_fmac_f32 v96, v18, v114
    v_fmac_f32 v97, v19, v114
    v_lshlrev_b32 v18, 16, v41
    v_and_b32 v19, 0xffff0000, v41
    v_fmac_f32 v98, v18, v114
    v_fmac_f32 v99, v19, v114
    v_lshlrev_b32 v18, 16, v42
    v_and_b32 v19, 0xffff0000, v42
    v_fmac_f32 v100, v18, v114
    v_fmac_f32 v101, v19, v114
    v_lshlrev_b32 v18, 16, v43
    v_and_b32 v19, 0xffff0000, v43
    v_fmac_f32 v102, v18, v114
    v_fmac_f32 v103, v19, v114
    s_waitcnt vmcnt(24)
    v_lshlrev_b32 v18, 16, v44
    v_and_b32 v19, 0xffff0000, v44
    v_fmac_f32 v96, v18, v115
    v_fmac_f32 v97, v19, v115
    v_lshlrev_b32 v18, 16, v45
    v_and_b32 v19, 0xffff0000, v45
    v_fmac_f32 v98, v18, v115
    v_fmac_f32 v99, v19, v115
    v_lshlrev_b32 v18, 16, v46
    v_and_b32 v19, 0xffff0000, v46
    v_fmac_f32 v100, v18, v115
    v_fmac_f32 v101, v19, v115
    v_lshlrev_b32 v18, 16, v47
    v_and_b32 v19, 0xffff0000, v47
    v_fmac_f32 v102, v18, v115
    v_fmac_f32 v103, v19, v115
    s_waitcnt vmcnt(23)
    v_lshlrev_b32 v18, 16, v48
    v_and_b32 v19, 0xffff0000, v48
    v_fmac_f32 v96, v18, v116
    v_fmac_f32 v97, v19, v116
    v_lshlrev_b32 v18, 16, v49
    v_and_b32 v19, 0xffff0000, v49
    v_fmac_f32 v98, v18, v116
    v_fmac_f32 v99, v19, v116
    v_lshlrev_b32 v18, 16, v50
    v_and_b32 v19, 0xffff0000, v50
    v_fmac_f32 v100, v18, v116
    v_fmac_f32 v101, v19, v116
    v_lshlrev_b32 v18, 16, v51
    v_and_b32 v19, 0xffff0000, v51
    v_fmac_f32 v102, v18, v116
    v_fmac_f32 v103, v19, v116
    s_waitcnt vmcnt(22)
    v_lshlrev_b32 v18, 16, v52
    v_and_b32 v19, 0xffff0000, v52
    v_fmac_f32 v96, v18, v117
    v_fmac_f32 v97, v19, v117
    v_lshlrev_b32 v18, 16, v53
    v_and_b32 v19, 0xffff0000, v53
    v_fmac_f32 v98, v18, v117
    v_fmac_f32 v99, v19, v117
    v_lshlrev_b32 v18, 16, v54
    v_and_b32 v19, 0xffff0000, v54
    v_fmac_f32 v100, v18, v117
    v_fmac_f32 v101, v19, v117
    v_lshlrev_b32 v18, 16, v55
    v_and_b32 v19, 0xffff0000, v55
    v_fmac_f32 v102, v18, v117
    v_fmac_f32 v103, v19, v117
    s_waitcnt vmcnt(21)
    v_lshlrev_b32 v18, 16, v56
    v_and_b32 v19, 0xffff0000, v56
    v_fmac_f32 v96, v18, v118
    v_fmac_f32 v97, v19, v118
    v_lshlrev_b32 v18, 16, v57
    v_and_b32 v19, 0xffff0000, v57
    v_fmac_f32 v98, v18, v118
    v_fmac_f32 v99, v19, v118
    v_lshlrev_b32 v18, 16, v58
    v_and_b32 v19, 0xffff0000, v58
    v_fmac_f32 v100, v18, v118
    v_fmac_f32 v101, v19, v118
    v_lshlrev_b32 v18, 16, v59
    v_and_b32 v19, 0xffff0000, v59
    v_fmac_f32 v102, v18, v118
    v_fmac_f32 v103, v19, v118
    s_waitcnt vmcnt(20)
    v_lshlrev_b32 v18, 16, v60
    v_and_b32 v19, 0xffff0000, v60
    v_fmac_f32 v96, v18, v119
    v_fmac_f32 v97, v19, v119
    v_lshlrev_b32 v18, 16, v61
    v_and_b32 v19, 0xffff0000, v61
    v_fmac_f32 v98, v18, v119
    v_fmac_f32 v99, v19, v119
    v_lshlrev_b32 v18, 16, v62
    v_and_b32 v19, 0xffff0000, v62
    v_fmac_f32 v100, v18, v119
    v_fmac_f32 v101, v19, v119
    v_lshlrev_b32 v18, 16, v63
    v_and_b32 v19, 0xffff0000, v63
    v_fmac_f32 v102, v18, v119
    v_fmac_f32 v103, v19, v119
    s_waitcnt vmcnt(19)
    v_lshlrev_b32 v18, 16, v64
    v_and_b32 v19, 0xffff0000, v64
    v_fmac_f32 v96, v18, v120
    v_fmac_f32 v97, v19, v120
    v_lshlrev_b32 v18, 16, v65
    v_and_b32 v19, 0xffff0000, v65
    v_fmac_f32 v98, v18, v120
    v_fmac_f32 v99, v19, v120
    v_lshlrev_b32 v18, 16, v66
    v_and_b32 v19, 0xffff0000, v66
    v_fmac_f32 v100, v18, v120
    v_fmac_f32 v101, v19, v120
    v_lshlrev_b32 v18, 16, v67
    v_and_b32 v19, 0xffff0000, v67
    v_fmac_f32 v102, v18, v120
    v_fmac_f32 v103, v19, v120
    s_waitcnt vmcnt(18)
    v_lshlrev_b32 v18, 16, v68
    v_and_b32 v19, 0xffff0000, v68
    v_fmac_f32 v96, v18, v121
    v_fmac_f32 v97, v19, v121
    v_lshlrev_b32 v18, 16, v69
    v_and_b32 v19, 0xffff0000, v69
    v_fmac_f32 v98, v18, v121
    v_fmac_f32 v99, v19, v121
    v_lshlrev_b32 v18, 16, v70
    v_and_b32 v19, 0xffff0000, v70
    v_fmac_f32 v100, v18, v121
    v_fmac_f32 v101, v19, v121
    v_lshlrev_b32 v18, 16, v71
    v_and_b32 v19, 0xffff0000, v71
    v_fmac_f32 v102, v18, v121
    v_fmac_f32 v103, v19, v121
    s_waitcnt vmcnt(17)
    v_lshlrev_b32 v18, 16, v72
    v_and_b32 v19, 0xffff0000, v72
    v_fmac_f32 v96, v18, v122
    v_fmac_f32 v97, v19, v122
    v_lshlrev_b32 v18, 16, v73
    v_and_b32 v19, 0xffff0000, v73
    v_fmac_f32 v98, v18, v122
    v_fmac_f32 v99, v19, v122
    v_lshlrev_b32 v18, 16, v74
    v_and_b32 v19, 0xffff0000, v74
    v_fmac_f32 v100, v18, v122
    v_fmac_f32 v101, v19, v122
    v_lshlrev_b32 v18, 16, v75
    v_and_b32 v19, 0xffff0000, v75
    v_fmac_f32 v102, v18, v122
    v_fmac_f32 v103, v19, v122
    s_waitcnt vmcnt(16)
    v_lshlrev_b32 v18, 16, v76
    v_and_b32 v19, 0xffff0000, v76
    v_fmac_f32 v96, v18, v123
    v_fmac_f32 v97, v19, v123
    v_lshlrev_b32 v18, 16, v77
    v_and_b32 v19, 0xffff0000, v77
    v_fmac_f32 v98, v18, v123
    v_fmac_f32 v99, v19, v123
    v_lshlrev_b32 v18, 16, v78
    v_and_b32 v19, 0xffff0000, v78
    v_fmac_f32 v100, v18, v123
    v_fmac_f32 v101, v19, v123
    v_lshlrev_b32 v18, 16, v79
    v_and_b32 v19, 0xffff0000, v79
    v_fmac_f32 v102, v18, v123
    v_fmac_f32 v103, v19, v123
    s_waitcnt vmcnt(15)
    v_lshlrev_b32 v18, 16, v80
    v_and_b32 v19, 0xffff0000, v80
    v_fmac_f32 v96, v18, v124
    v_fmac_f32 v97, v19, v124
    v_lshlrev_b32 v18, 16, v81
    v_and_b32 v19, 0xffff0000, v81
    v_fmac_f32 v98, v18, v124
    v_fmac_f32 v99, v19, v124
    v_lshlrev_b32 v18, 16, v82
    v_and_b32 v19, 0xffff0000, v82
    v_fmac_f32 v100, v18, v124
    v_fmac_f32 v101, v19, v124
    v_lshlrev_b32 v18, 16, v83
    v_and_b32 v19, 0xffff0000, v83
    v_fmac_f32 v102, v18, v124
    v_fmac_f32 v103, v19, v124
    s_waitcnt vmcnt(14)
    v_lshlrev_b32 v18, 16, v84
    v_and_b32 v19, 0xffff0000, v84
    v_fmac_f32 v96, v18, v125
    v_fmac_f32 v97, v19, v125
    v_lshlrev_b32 v18, 16, v85
    v_and_b32 v19, 0xffff0000, v85
    v_fmac_f32 v98, v18, v125
    v_fmac_f32 v99, v19, v125
    v_lshlrev_b32 v18, 16, v86
    v_and_b32 v19, 0xffff0000, v86
    v_fmac_f32 v100, v18, v125
    v_fmac_f32 v101, v19, v125
    v_lshlrev_b32 v18, 16, v87
    v_and_b32 v19, 0xffff0000, v87
    v_fmac_f32 v102, v18, v125
    v_fmac_f32 v103, v19, v125
    s_waitcnt vmcnt(13)
    v_lshlrev_b32 v18, 16, v88
    v_and_b32 v19, 0xffff0000, v88
    v_fmac_f32 v96, v18, v126
    v_fmac_f32 v97, v19, v126
    v_lshlrev_b32 v18, 16, v89
    v_and_b32 v19, 0xffff0000, v89
    v_fmac_f32 v98, v18, v126
    v_fmac_f32 v99, v19, v126
    v_lshlrev_b32 v18, 16, v90
    v_and_b32 v19, 0xffff0000, v90
    v_fmac_f32 v100, v18, v126
    v_fmac_f32 v101, v19, v126
    v_lshlrev_b32 v18, 16, v91
    v_and_b32 v19, 0xffff0000, v91
    v_fmac_f32 v102, v18, v126
    v_fmac_f32 v103, v19, v126
    s_waitcnt vmcnt(12)
    v_lshlrev_b32 v18, 16, v92
    v_and_b32 v19, 0xffff0000, v92
    v_fmac_f32 v96, v18, v127
    v_fmac_f32 v97, v19, v127
    v_lshlrev_b32 v18, 16, v93
    v_and_b32 v19, 0xffff0000, v93
    v_fmac_f32 v98, v18, v127
    v_fmac_f32 v99, v19, v127
    v_lshlrev_b32 v18, 16, v94
    v_and_b32 v19, 0xffff0000, v94
    v_fmac_f32 v100, v18, v127
    v_fmac_f32 v101, v19, v127
    v_lshlrev_b32 v18, 16, v95
    v_and_b32 v19, 0xffff0000, v95
    v_fmac_f32 v102, v18, v127
    v_fmac_f32 v103, v19, v127
    v_lshlrev_b32 v16, 5, v0
    ds_write_b128 v16, v[96:99]
    ds_write_b128 v16, v[100:103] offset:16
    s_waitcnt lgkmcnt(0)
    s_barrier
    s_cmp_lg_u32 s44, 0
    s_cbranch_scc1 L_mod_fin_101
    v_mov_b32 v18, 0
    ds_read_b32 v32, v12 offset:0
    ds_read_b32 v33, v12 offset:256
    ds_read_b32 v34, v12 offset:512
    ds_read_b32 v35, v12 offset:768
    ds_read_b32 v36, v12 offset:1024
    ds_read_b32 v37, v12 offset:1280
    ds_read_b32 v38, v12 offset:1536
    ds_read_b32 v39, v12 offset:1792
    ds_read_b32 v40, v12 offset:2048
    ds_read_b32 v41, v12 offset:2304
    ds_read_b32 v42, v12 offset:2560
    ds_read_b32 v43, v12 offset:2816
    ds_read_b32 v44, v12 offset:3072
    ds_read_b32 v45, v12 offset:3328
    ds_read_b32 v46, v12 offset:3584
    ds_read_b32 v47, v12 offset:3840
    s_waitcnt lgkmcnt(0)
    v_add_f32 v18, v18, v32
    v_add_f32 v18, v18, v33
    v_add_f32 v18, v18, v34
    v_add_f32 v18, v18, v35
    v_add_f32 v18, v18, v36
    v_add_f32 v18, v18, v37
    v_add_f32 v18, v18, v38
    v_add_f32 v18, v18, v39
    v_add_f32 v18, v18, v40
    v_add_f32 v18, v18, v41
    v_add_f32 v18, v18, v42
    v_add_f32 v18, v18, v43
    v_add_f32 v18, v18, v44
    v_add_f32 v18, v18, v45
    v_add_f32 v18, v18, v46
    v_add_f32 v18, v18, v47
    ds_read_b32 v32, v12 offset:4096
    ds_read_b32 v33, v12 offset:4352
    ds_read_b32 v34, v12 offset:4608
    ds_read_b32 v35, v12 offset:4864
    ds_read_b32 v36, v12 offset:5120
    ds_read_b32 v37, v12 offset:5376
    ds_read_b32 v38, v12 offset:5632
    ds_read_b32 v39, v12 offset:5888
    ds_read_b32 v40, v12 offset:6144
    ds_read_b32 v41, v12 offset:6400
    ds_read_b32 v42, v12 offset:6656
    ds_read_b32 v43, v12 offset:6912
    ds_read_b32 v44, v12 offset:7168
    ds_read_b32 v45, v12 offset:7424
    ds_read_b32 v46, v12 offset:7680
    ds_read_b32 v47, v12 offset:7936
    s_waitcnt lgkmcnt(0)
    v_add_f32 v18, v18, v32
    v_add_f32 v18, v18, v33
    v_add_f32 v18, v18, v34
    v_add_f32 v18, v18, v35
    v_add_f32 v18, v18, v36
    v_add_f32 v18, v18, v37
    v_add_f32 v18, v18, v38
    v_add_f32 v18, v18, v39
    v_add_f32 v18, v18, v40
    v_add_f32 v18, v18, v41
    v_add_f32 v18, v18, v42
    v_add_f32 v18, v18, v43
    v_add_f32 v18, v18, v44
    v_add_f32 v18, v18, v45
    v_add_f32 v18, v18, v46
    v_add_f32 v18, v18, v47
    s_lshr_b32 s45, s39, 1
    s_lshl_b32 s45, s45, 8
    s_mul_i32 s46, s47, 24576
    s_add_u32 s45, s45, s46
    buffer_store_dword v18, v12, s[12:15], s45 offen sc1
L_mod_fin_101:
    s_waitcnt vmcnt(0)
    s_barrier
    s_cmp_lg_u32 s44, 0
    s_cbranch_scc1 L_cnt_102
    v_mov_b32 v30, 1
    v_mov_b32 v31, 128
    s_mov_b64 exec, 1
    buffer_atomic_add v30, v31, s[16:19], 0 offen sc1
    s_mov_b64 exec, -1
L_cnt_102:
    v_lshlrev_b32 v192, 16, v128
    v_and_b32 v193, 0xffff0000, v128
    v_lshlrev_b32 v194, 16, v129
    v_and_b32 v195, 0xffff0000, v129
    v_lshlrev_b32 v196, 16, v130
    v_and_b32 v197, 0xffff0000, v130
    v_lshlrev_b32 v198, 16, v131
    v_and_b32 v199, 0xffff0000, v131
    v_lshlrev_b32 v200, 16, v132
    v_and_b32 v201, 0xffff0000, v132
    v_lshlrev_b32 v202, 16, v133
    v_and_b32 v203, 0xffff0000, v133
    v_lshlrev_b32 v204, 16, v134
    v_and_b32 v205, 0xffff0000, v134
    v_lshlrev_b32 v206, 16, v135
    v_and_b32 v207, 0xffff0000, v135
    v_add_f32 v26, v192, v193
    v_add_f32 v26, v26, v194
    v_add_f32 v26, v26, v195
    v_add_f32 v26, v26, v196
    v_add_f32 v26, v26, v197
    v_add_f32 v26, v26, v198
    v_add_f32 v26, v26, v199
    v_add_f32 v26, v26, v200
    v_add_f32 v26, v26, v201
    v_add_f32 v26, v26, v202
    v_add_f32 v26, v26, v203
    v_add_f32 v26, v26, v204
    v_add_f32 v26, v26, v205
    v_add_f32 v26, v26, v206
    v_add_f32 v26, v26, v207
    s_nop 1
    v_add_f32_dpp v26, v26, v26 row_shr:1 row_mask:0xf bank_mask:0xf bound_ctrl:0
    s_nop 1
    v_add_f32_dpp v26, v26, v26 row_shr:2 row_mask:0xf bank_mask:0xf bound_ctrl:0
    s_nop 1
    v_add_f32_dpp v26, v26, v26 row_shr:4 row_mask:0xf bank_mask:0xf bound_ctrl:0
    s_nop 1
    v_add_f32_dpp v26, v26, v26 row_shr:8 row_mask:0xf bank_mask:0xf bound_ctrl:0
    s_nop 1
    v_add_f32_dpp v26, v26, v26 row_bcast:15 row_mask:0xa bank_mask:0xf
    s_nop 1
    v_add_f32_dpp v26, v26, v26 row_bcast:31 row_mask:0xc bank_mask:0xf
    s_nop 1
    v_readlane_b32 s66, v26, 63
    s_nop 1
    v_mov_b32 v27, s66
    v_mul_f32 v27, 0x3a800000, v27
    v_mov_b32 v26, 0
    v_sub_f32 v28, v192, v27
    v_fmac_f32 v26, v28, v28
    v_sub_f32 v28, v193, v27
    v_fmac_f32 v26, v28, v28
    v_sub_f32 v28, v194, v27
    v_fmac_f32 v26, v28, v28
    v_sub_f32 v28, v195, v27
    v_fmac_f32 v26, v28, v28
    v_sub_f32 v28, v196, v27
    v_fmac_f32 v26, v28, v28
    v_sub_f32 v28, v197, v27
    v_fmac_f32 v26, v28, v28
    v_sub_f32 v28, v198, v27
    v_fmac_f32 v26, v28, v28
    v_sub_f32 v28, v199, v27
    v_fmac_f32 v26, v28, v28
    v_sub_f32 v28, v200, v27
    v_fmac_f32 v26, v28, v28
    v_sub_f32 v28, v201, v27
    v_fmac_f32 v26, v28, v28
    v_sub_f32 v28, v202, v27
    v_fmac_f32 v26, v28, v28
    v_sub_f32 v28, v203, v27
    v_fmac_f32 v26, v28, v28
    v_sub_f32 v28, v204, v27
    v_fmac_f32 v26, v28, v28
    v_sub_f32 v28, v205, v27
    v_fmac_f32 v26, v28, v28
    v_sub_f32 v28, v206, v27
    v_fmac_f32 v26, v28, v28
    v_sub_f32 v28, v207, v27
    v_fmac_f32 v26, v28, v28
    s_nop 1
    v_add_f32_dpp v26, v26, v26 row_shr:1 row_mask:0xf bank_mask:0xf bound_ctrl:0
    s_nop 1
    v_add_f32_dpp v26, v26, v26 row_shr:2 row_mask:0xf bank_mask:0xf bound_ctrl:0
    s_nop 1
    v_add_f32_dpp v26, v26, v26 row_shr:4 row_mask:0xf bank_mask:0xf bound_ctrl:0
    s_nop 1
    v_add_f32_dpp v26, v26, v26 row_shr:8 row_mask:0xf bank_mask:0xf bound_ctrl:0
    s_nop 1
    v_add_f32_dpp v26, v26, v26 row_bcast:15 row_mask:0xa bank_mask:0xf
    s_nop 1
    v_add_f32_dpp v26, v26, v26 row_bcast:31 row_mask:0xc bank_mask:0xf
    s_nop 1
    v_readlane_b32 s66, v26, 63
    s_nop 1
    v_mov_b32 v26, s66
    v_mul_f32 v26, 0x3a800000, v26
    v_cvt_pk_bf16_f32 v26, v26, v26
    v_lshlrev_b32 v26, 16, v26
    v_cvt_pk_bf16_f32 v27, v27, v27
    v_lshlrev_b32 v27, 16, v27
    v_add_f32 v26, 0x3727c5ac, v26
    v_cvt_pk_bf16_f32 v26, v26, v26
    v_lshlrev_b32 v26, 16, v26
    v_sqrt_f32 v26, v26
    s_nop 0
    v_cvt_pk_bf16_f32 v26, v26, v26
    v_lshlrev_b32 v26, 16, v26
    v_rcp_f32 v26, v26
    s_nop 0
    v_sub_f32 v192, v192, v27
    v_cvt_pk_bf16_f32 v192, v192, v192
    v_lshlrev_b32 v192, 16, v192
    v_mul_f32 v192, v192, v26
    v_cvt_pk_bf16_f32 v192, v192, v192
    v_lshlrev_b32 v192, 16, v192
    v_sub_f32 v193, v193, v27
    v_cvt_pk_bf16_f32 v193, v193, v193
    v_lshlrev_b32 v193, 16, v193
    v_mul_f32 v193, v193, v26
    v_cvt_pk_bf16_f32 v193, v193, v193
    v_lshlrev_b32 v193, 16, v193
    v_sub_f32 v194, v194, v27
    v_cvt_pk_bf16_f32 v194, v194, v194
    v_lshlrev_b32 v194, 16, v194
    v_mul_f32 v194, v194, v26
    v_cvt_pk_bf16_f32 v194, v194, v194
    v_lshlrev_b32 v194, 16, v194
    v_sub_f32 v195, v195, v27
    v_cvt_pk_bf16_f32 v195, v195, v195
    v_lshlrev_b32 v195, 16, v195
    v_mul_f32 v195, v195, v26
    v_cvt_pk_bf16_f32 v195, v195, v195
    v_lshlrev_b32 v195, 16, v195
    v_sub_f32 v196, v196, v27
    v_cvt_pk_bf16_f32 v196, v196, v196
    v_lshlrev_b32 v196, 16, v196
    v_mul_f32 v196, v196, v26
    v_cvt_pk_bf16_f32 v196, v196, v196
    v_lshlrev_b32 v196, 16, v196
    v_sub_f32 v197, v197, v27
    v_cvt_pk_bf16_f32 v197, v197, v197
    v_lshlrev_b32 v197, 16, v197
    v_mul_f32 v197, v197, v26
    v_cvt_pk_bf16_f32 v197, v197, v197
    v_lshlrev_b32 v197, 16, v197
    v_sub_f32 v198, v198, v27
    v_cvt_pk_bf16_f32 v198, v198, v198
    v_lshlrev_b32 v198, 16, v198
    v_mul_f32 v198, v198, v26
    v_cvt_pk_bf16_f32 v198, v198, v198
    v_lshlrev_b32 v198, 16, v198
    v_sub_f32 v199, v199, v27
    v_cvt_pk_bf16_f32 v199, v199, v199
    v_lshlrev_b32 v199, 16, v199
    v_mul_f32 v199, v199, v26
    v_cvt_pk_bf16_f32 v199, v199, v199
    v_lshlrev_b32 v199, 16, v199
    v_sub_f32 v200, v200, v27
    v_cvt_pk_bf16_f32 v200, v200, v200
    v_lshlrev_b32 v200, 16, v200
    v_mul_f32 v200, v200, v26
    v_cvt_pk_bf16_f32 v200, v200, v200
    v_lshlrev_b32 v200, 16, v200
    v_sub_f32 v201, v201, v27
    v_cvt_pk_bf16_f32 v201, v201, v201
    v_lshlrev_b32 v201, 16, v201
    v_mul_f32 v201, v201, v26
    v_cvt_pk_bf16_f32 v201, v201, v201
    v_lshlrev_b32 v201, 16, v201
    v_sub_f32 v202, v202, v27
    v_cvt_pk_bf16_f32 v202, v202, v202
    v_lshlrev_b32 v202, 16, v202
    v_mul_f32 v202, v202, v26
    v_cvt_pk_bf16_f32 v202, v202, v202
    v_lshlrev_b32 v202, 16, v202
    v_sub_f32 v203, v203, v27
    v_cvt_pk_bf16_f32 v203, v203, v203
    v_lshlrev_b32 v203, 16, v203
    v_mul_f32 v203, v203, v26
    v_cvt_pk_bf16_f32 v203, v203, v203
    v_lshlrev_b32 v203, 16, v203
    v_sub_f32 v204, v204, v27
    v_cvt_pk_bf16_f32 v204, v204, v204
    v_lshlrev_b32 v204, 16, v204
    v_mul_f32 v204, v204, v26
    v_cvt_pk_bf16_f32 v204, v204, v204
    v_lshlrev_b32 v204, 16, v204
    v_sub_f32 v205, v205, v27
    v_cvt_pk_bf16_f32 v205, v205, v205
    v_lshlrev_b32 v205, 16, v205
    v_mul_f32 v205, v205, v26
    v_cvt_pk_bf16_f32 v205, v205, v205
    v_lshlrev_b32 v205, 16, v205
    v_sub_f32 v206, v206, v27
    v_cvt_pk_bf16_f32 v206, v206, v206
    v_lshlrev_b32 v206, 16, v206
    v_mul_f32 v206, v206, v26
    v_cvt_pk_bf16_f32 v206, v206, v206
    v_lshlrev_b32 v206, 16, v206
    v_sub_f32 v207, v207, v27
    v_cvt_pk_bf16_f32 v207, v207, v207
    v_lshlrev_b32 v207, 16, v207
    v_mul_f32 v207, v207, v26
    v_cvt_pk_bf16_f32 v207, v207, v207
    v_lshlrev_b32 v207, 16, v207
    v_lshlrev_b32 v208, 16, v136
    v_and_b32 v209, 0xffff0000, v136
    v_lshlrev_b32 v210, 16, v137
    v_and_b32 v211, 0xffff0000, v137
    v_lshlrev_b32 v212, 16, v138
    v_and_b32 v213, 0xffff0000, v138
    v_lshlrev_b32 v214, 16, v139
    v_and_b32 v215, 0xffff0000, v139
    v_lshlrev_b32 v216, 16, v140
    v_and_b32 v217, 0xffff0000, v140
    v_lshlrev_b32 v218, 16, v141
    v_and_b32 v219, 0xffff0000, v141
    v_lshlrev_b32 v220, 16, v142
    v_and_b32 v221, 0xffff0000, v142
    v_lshlrev_b32 v222, 16, v143
    v_and_b32 v223, 0xffff0000, v143
    v_add_f32 v26, v208, v209
    v_add_f32 v26, v26, v210
    v_add_f32 v26, v26, v211
    v_add_f32 v26, v26, v212
    v_add_f32 v26, v26, v213
    v_add_f32 v26, v26, v214
    v_add_f32 v26, v26, v215
    v_add_f32 v26, v26, v216
    v_add_f32 v26, v26, v217
    v_add_f32 v26, v26, v218
    v_add_f32 v26, v26, v219
    v_add_f32 v26, v26, v220
    v_add_f32 v26, v26, v221
    v_add_f32 v26, v26, v222
    v_add_f32 v26, v26, v223
    s_nop 1
    v_add_f32_dpp v26, v26, v26 row_shr:1 row_mask:0xf bank_mask:0xf bound_ctrl:0
    s_nop 1
    v_add_f32_dpp v26, v26, v26 row_shr:2 row_mask:0xf bank_mask:0xf bound_ctrl:0
    s_nop 1
    v_add_f32_dpp v26, v26, v26 row_shr:4 row_mask:0xf bank_mask:0xf bound_ctrl:0
    s_nop 1
    v_add_f32_dpp v26, v26, v26 row_shr:8 row_mask:0xf bank_mask:0xf bound_ctrl:0
    s_nop 1
    v_add_f32_dpp v26, v26, v26 row_bcast:15 row_mask:0xa bank_mask:0xf
    s_nop 1
    v_add_f32_dpp v26, v26, v26 row_bcast:31 row_mask:0xc bank_mask:0xf
    s_nop 1
    v_readlane_b32 s66, v26, 63
    s_nop 1
    v_mov_b32 v27, s66
    v_mul_f32 v27, 0x3a800000, v27
    v_mov_b32 v26, 0
    v_sub_f32 v28, v208, v27
    v_fmac_f32 v26, v28, v28
    v_sub_f32 v28, v209, v27
    v_fmac_f32 v26, v28, v28
    v_sub_f32 v28, v210, v27
    v_fmac_f32 v26, v28, v28
    v_sub_f32 v28, v211, v27
    v_fmac_f32 v26, v28, v28
    v_sub_f32 v28, v212, v27
    v_fmac_f32 v26, v28, v28
    v_sub_f32 v28, v213, v27
    v_fmac_f32 v26, v28, v28
    v_sub_f32 v28, v214, v27
    v_fmac_f32 v26, v28, v28
    v_sub_f32 v28, v215, v27
    v_fmac_f32 v26, v28, v28
    v_sub_f32 v28, v216, v27
    v_fmac_f32 v26, v28, v28
    v_sub_f32 v28, v217, v27
    v_fmac_f32 v26, v28, v28
    v_sub_f32 v28, v218, v27
    v_fmac_f32 v26, v28, v28
    v_sub_f32 v28, v219, v27
    v_fmac_f32 v26, v28, v28
    v_sub_f32 v28, v220, v27
    v_fmac_f32 v26, v28, v28
    v_sub_f32 v28, v221, v27
    v_fmac_f32 v26, v28, v28
    v_sub_f32 v28, v222, v27
    v_fmac_f32 v26, v28, v28
    v_sub_f32 v28, v223, v27
    v_fmac_f32 v26, v28, v28
    s_nop 1
    v_add_f32_dpp v26, v26, v26 row_shr:1 row_mask:0xf bank_mask:0xf bound_ctrl:0
    s_nop 1
    v_add_f32_dpp v26, v26, v26 row_shr:2 row_mask:0xf bank_mask:0xf bound_ctrl:0
    s_nop 1
    v_add_f32_dpp v26, v26, v26 row_shr:4 row_mask:0xf bank_mask:0xf bound_ctrl:0
    s_nop 1
    v_add_f32_dpp v26, v26, v26 row_shr:8 row_mask:0xf bank_mask:0xf bound_ctrl:0
    s_nop 1
    v_add_f32_dpp v26, v26, v26 row_bcast:15 row_mask:0xa bank_mask:0xf
    s_nop 1
    v_add_f32_dpp v26, v26, v26 row_bcast:31 row_mask:0xc bank_mask:0xf
    s_nop 1
    v_readlane_b32 s66, v26, 63
    s_nop 1
    v_mov_b32 v26, s66
    v_mul_f32 v26, 0x3a800000, v26
    v_cvt_pk_bf16_f32 v26, v26, v26
    v_lshlrev_b32 v26, 16, v26
    v_cvt_pk_bf16_f32 v27, v27, v27
    v_lshlrev_b32 v27, 16, v27
    v_add_f32 v26, 0x3727c5ac, v26
    v_cvt_pk_bf16_f32 v26, v26, v26
    v_lshlrev_b32 v26, 16, v26
    v_sqrt_f32 v26, v26
    s_nop 0
    v_cvt_pk_bf16_f32 v26, v26, v26
    v_lshlrev_b32 v26, 16, v26
    v_rcp_f32 v26, v26
    s_nop 0
    v_sub_f32 v208, v208, v27
    v_cvt_pk_bf16_f32 v208, v208, v208
    v_lshlrev_b32 v208, 16, v208
    v_mul_f32 v208, v208, v26
    v_cvt_pk_bf16_f32 v208, v208, v208
    v_lshlrev_b32 v208, 16, v208
    v_sub_f32 v209, v209, v27
    v_cvt_pk_bf16_f32 v209, v209, v209
    v_lshlrev_b32 v209, 16, v209
    v_mul_f32 v209, v209, v26
    v_cvt_pk_bf16_f32 v209, v209, v209
    v_lshlrev_b32 v209, 16, v209
    v_sub_f32 v210, v210, v27
    v_cvt_pk_bf16_f32 v210, v210, v210
    v_lshlrev_b32 v210, 16, v210
    v_mul_f32 v210, v210, v26
    v_cvt_pk_bf16_f32 v210, v210, v210
    v_lshlrev_b32 v210, 16, v210
    v_sub_f32 v211, v211, v27
    v_cvt_pk_bf16_f32 v211, v211, v211
    v_lshlrev_b32 v211, 16, v211
    v_mul_f32 v211, v211, v26
    v_cvt_pk_bf16_f32 v211, v211, v211
    v_lshlrev_b32 v211, 16, v211
    v_sub_f32 v212, v212, v27
    v_cvt_pk_bf16_f32 v212, v212, v212
    v_lshlrev_b32 v212, 16, v212
    v_mul_f32 v212, v212, v26
    v_cvt_pk_bf16_f32 v212, v212, v212
    v_lshlrev_b32 v212, 16, v212
    v_sub_f32 v213, v213, v27
    v_cvt_pk_bf16_f32 v213, v213, v213
    v_lshlrev_b32 v213, 16, v213
    v_mul_f32 v213, v213, v26
    v_cvt_pk_bf16_f32 v213, v213, v213
    v_lshlrev_b32 v213, 16, v213
    v_sub_f32 v214, v214, v27
    v_cvt_pk_bf16_f32 v214, v214, v214
    v_lshlrev_b32 v214, 16, v214
    v_mul_f32 v214, v214, v26
    v_cvt_pk_bf16_f32 v214, v214, v214
    v_lshlrev_b32 v214, 16, v214
    v_sub_f32 v215, v215, v27
    v_cvt_pk_bf16_f32 v215, v215, v215
    v_lshlrev_b32 v215, 16, v215
    v_mul_f32 v215, v215, v26
    v_cvt_pk_bf16_f32 v215, v215, v215
    v_lshlrev_b32 v215, 16, v215
    v_sub_f32 v216, v216, v27
    v_cvt_pk_bf16_f32 v216, v216, v216
    v_lshlrev_b32 v216, 16, v216
    v_mul_f32 v216, v216, v26
    v_cvt_pk_bf16_f32 v216, v216, v216
    v_lshlrev_b32 v216, 16, v216
    v_sub_f32 v217, v217, v27
    v_cvt_pk_bf16_f32 v217, v217, v217
    v_lshlrev_b32 v217, 16, v217
    v_mul_f32 v217, v217, v26
    v_cvt_pk_bf16_f32 v217, v217, v217
    v_lshlrev_b32 v217, 16, v217
    v_sub_f32 v218, v218, v27
    v_cvt_pk_bf16_f32 v218, v218, v218
    v_lshlrev_b32 v218, 16, v218
    v_mul_f32 v218, v218, v26
    v_cvt_pk_bf16_f32 v218, v218, v218
    v_lshlrev_b32 v218, 16, v218
    v_sub_f32 v219, v219, v27
    v_cvt_pk_bf16_f32 v219, v219, v219
    v_lshlrev_b32 v219, 16, v219
    v_mul_f32 v219, v219, v26
    v_cvt_pk_bf16_f32 v219, v219, v219
    v_lshlrev_b32 v219, 16, v219
    v_sub_f32 v220, v220, v27
    v_cvt_pk_bf16_f32 v220, v220, v220
    v_lshlrev_b32 v220, 16, v220
    v_mul_f32 v220, v220, v26
    v_cvt_pk_bf16_f32 v220, v220, v220
    v_lshlrev_b32 v220, 16, v220
    v_sub_f32 v221, v221, v27
    v_cvt_pk_bf16_f32 v221, v221, v221
    v_lshlrev_b32 v221, 16, v221
    v_mul_f32 v221, v221, v26
    v_cvt_pk_bf16_f32 v221, v221, v221
    v_lshlrev_b32 v221, 16, v221
    v_sub_f32 v222, v222, v27
    v_cvt_pk_bf16_f32 v222, v222, v222
    v_lshlrev_b32 v222, 16, v222
    v_mul_f32 v222, v222, v26
    v_cvt_pk_bf16_f32 v222, v222, v222
    v_lshlrev_b32 v222, 16, v222
    v_sub_f32 v223, v223, v27
    v_cvt_pk_bf16_f32 v223, v223, v223
    v_lshlrev_b32 v223, 16, v223
    v_mul_f32 v223, v223, v26
    v_cvt_pk_bf16_f32 v223, v223, v223
    v_lshlrev_b32 v223, 16, v223
    s_cmp_lg_u32 s44, 0
    s_cbranch_scc1 L_pd_103
    v_mov_b32 v29, 8
    s_mov_b32 s46, 32
    s_mov_b64 exec, 1
    s_mov_b32 s70, 0
L_wp_104:
    buffer_load_dword v31, v29, s[16:19], 0 offen sc1
    s_add_u32 s70, s70, 1
    s_cmp_ge_u32 s70, 0x200000
    s_cbranch_scc1 L_w_done_98
    s_waitcnt vmcnt(0)
    v_cmp_gt_u32 vcc, s46, v31
    s_nop 1
    s_cbranch_vccz L_wp_104_ok
    s_sleep 3
    s_branch L_wp_104
L_wp_104_ok:
    s_mov_b64 exec, -1
L_pd_103:
    s_barrier
    s_cmp_lg_u32 s44, 0
    s_cbranch_scc1 L_pd_105
    v_mov_b32 v29, 128
    s_mov_b32 s46, 96
    s_mov_b64 exec, 1
    s_mov_b32 s70, 0
L_wp_106:
    buffer_load_dword v31, v29, s[16:19], 0 offen sc1
    s_add_u32 s70, s70, 1
    s_cmp_ge_u32 s70, 0x200000
    s_cbranch_scc1 L_w_done_98
    s_waitcnt vmcnt(0)
    v_cmp_gt_u32 vcc, s46, v31
    s_nop 1
    s_cbranch_vccz L_wp_106_ok
    s_sleep 1
    s_branch L_wp_106
L_wp_106_ok:
    s_mov_b64 exec, -1
L_pd_105:
    s_barrier
    v_lshlrev_b32 v29, 5, v1
    s_mov_b32 s45, 0
    buffer_load_dwordx4 v[96:99], v29, s[12:15], s45 offen offset:0 sc1
    buffer_load_dwordx4 v[100:103], v29, s[12:15], s45 offen offset:16 sc1
    buffer_load_dwordx4 v[104:107], v29, s[12:15], s45 offen offset:2048 sc1
    buffer_load_dwordx4 v[108:111], v29, s[12:15], s45 offen offset:2064 sc1
    s_mov_b32 s45, 24576
    buffer_load_dwordx4 v[32:35], v29, s[12:15], s45 offen offset:0 sc1
    buffer_load_dwordx4 v[36:39], v29, s[12:15], s45 offen offset:16 sc1
    buffer_load_dwordx4 v[40:43], v29, s[12:15], s45 offen offset:2048 sc1
    buffer_load_dwordx4 v[44:47], v29, s[12:15], s45 offen offset:2064 sc1
    s_mov_b32 s45, 4096
    buffer_load_dwordx4 v[112:115], v29, s[12:15], s45 offen offset:0 sc1
    buffer_load_dwordx4 v[116:119], v29, s[12:15], s45 offen offset:16 sc1
    buffer_load_dwordx4 v[120:123], v29, s[12:15], s45 offen offset:2048 sc1
    buffer_load_dwordx4 v[124:127], v29, s[12:15], s45 offen offset:2064 sc1
    s_mov_b32 s45, 28672
    buffer_load_dwordx4 v[48:51], v29, s[12:15], s45 offen offset:0 sc1
    buffer_load_dwordx4 v[52:55], v29, s[12:15], s45 offen offset:16 sc1
    buffer_load_dwordx4 v[56:59], v29, s[12:15], s45 offen offset:2048 sc1
    buffer_load_dwordx4 v[60:63], v29, s[12:15], s45 offen offset:2064 sc1
    s_waitcnt vmcnt(0)
    v_add_f32 v96, v96, v32
    v_cvt_pk_bf16_f32 v96, v96, v96
    v_lshlrev_b32 v96, 16, v96
    v_add_f32 v97, v97, v33
    v_cvt_pk_bf16_f32 v97, v97, v97
    v_lshlrev_b32 v97, 16, v97
    v_add_f32 v98, v98, v34
    v_cvt_pk_bf16_f32 v98, v98, v98
    v_lshlrev_b32 v98, 16, v98
    v_add_f32 v99, v99, v35
    v_cvt_pk_bf16_f32 v99, v99, v99
    v_lshlrev_b32 v99, 16, v99
    v_add_f32 v100, v100, v36
    v_cvt_pk_bf16_f32 v100, v100, v100
    v_lshlrev_b32 v100, 16, v100
    v_add_f32 v101, v101, v37
    v_cvt_pk_bf16_f32 v101, v101, v101
    v_lshlrev_b32 v101, 16, v101
    v_add_f32 v102, v102, v38
    v_cvt_pk_bf16_f32 v102, v102, v102
    v_lshlrev_b32 v102, 16, v102
    v_add_f32 v103, v103, v39
    v_cvt_pk_bf16_f32 v103, v103, v103
    v_lshlrev_b32 v103, 16, v103
    v_add_f32 v104, v104, v40
    v_cvt_pk_bf16_f32 v104, v104, v104
    v_lshlrev_b32 v104, 16, v104
    v_add_f32 v105, v105, v41
    v_cvt_pk_bf16_f32 v105, v105, v105
    v_lshlrev_b32 v105, 16, v105
    v_add_f32 v106, v106, v42
    v_cvt_pk_bf16_f32 v106, v106, v106
    v_lshlrev_b32 v106, 16, v106
    v_add_f32 v107, v107, v43
    v_cvt_pk_bf16_f32 v107, v107, v107
    v_lshlrev_b32 v107, 16, v107
    v_add_f32 v108, v108, v44
    v_cvt_pk_bf16_f32 v108, v108, v108
    v_lshlrev_b32 v108, 16, v108
    v_add_f32 v109, v109, v45
    v_cvt_pk_bf16_f32 v109, v109, v109
    v_lshlrev_b32 v109, 16, v109
    v_add_f32 v110, v110, v46
    v_cvt_pk_bf16_f32 v110, v110, v110
    v_lshlrev_b32 v110, 16, v110
    v_add_f32 v111, v111, v47
    v_cvt_pk_bf16_f32 v111, v111, v111
    v_lshlrev_b32 v111, 16, v111
    v_add_f32 v112, v112, v48
    v_cvt_pk_bf16_f32 v112, v112, v112
    v_lshlrev_b32 v112, 16, v112
    v_add_f32 v112, 1.0, v112
    v_cvt_pk_bf16_f32 v112, v112, v112
    v_lshlrev_b32 v112, 16, v112
    v_add_f32 v113, v113, v49
    v_cvt_pk_bf16_f32 v113, v113, v113
    v_lshlrev_b32 v113, 16, v113
    v_add_f32 v113, 1.0, v113
    v_cvt_pk_bf16_f32 v113, v113, v113
    v_lshlrev_b32 v113, 16, v113
    v_add_f32 v114, v114, v50
    v_cvt_pk_bf16_f32 v114, v114, v114
    v_lshlrev_b32 v114, 16, v114
    v_add_f32 v114, 1.0, v114
    v_cvt_pk_bf16_f32 v114, v114, v114
    v_lshlrev_b32 v114, 16, v114
    v_add_f32 v115, v115, v51
    v_cvt_pk_bf16_f32 v115, v115, v115
    v_lshlrev_b32 v115, 16, v115
    v_add_f32 v115, 1.0, v115
    v_cvt_pk_bf16_f32 v115, v115, v115
    v_lshlrev_b32 v115, 16, v115
    v_add_f32 v116, v116, v52
    v_cvt_pk_bf16_f32 v116, v116, v116
    v_lshlrev_b32 v116, 16, v116
    v_add_f32 v116, 1.0, v116
    v_cvt_pk_bf16_f32 v116, v116, v116
    v_lshlrev_b32 v116, 16, v116
    v_add_f32 v117, v117, v53
    v_cvt_pk_bf16_f32 v117, v117, v117
    v_lshlrev_b32 v117, 16, v117
    v_add_f32 v117, 1.0, v117
    v_cvt_pk_bf16_f32 v117, v117, v117
    v_lshlrev_b32 v117, 16, v117
    v_add_f32 v118, v118, v54
    v_cvt_pk_bf16_f32 v118, v118, v118
    v_lshlrev_b32 v118, 16, v118
    v_add_f32 v118, 1.0, v118
    v_cvt_pk_bf16_f32 v118, v118, v118
    v_lshlrev_b32 v118, 16, v118
    v_add_f32 v119, v119, v55
    v_cvt_pk_bf16_f32 v119, v119, v119
    v_lshlrev_b32 v119, 16, v119
    v_add_f32 v119, 1.0, v119
    v_cvt_pk_bf16_f32 v119, v119, v119
    v_lshlrev_b32 v119, 16, v119
    v_add_f32 v120, v120, v56
    v_cvt_pk_bf16_f32 v120, v120, v120
    v_lshlrev_b32 v120, 16, v120
    v_add_f32 v120, 1.0, v120
    v_cvt_pk_bf16_f32 v120, v120, v120
    v_lshlrev_b32 v120, 16, v120
    v_add_f32 v121, v121, v57
    v_cvt_pk_bf16_f32 v121, v121, v121
    v_lshlrev_b32 v121, 16, v121
    v_add_f32 v121, 1.0, v121
    v_cvt_pk_bf16_f32 v121, v121, v121
    v_lshlrev_b32 v121, 16, v121
    v_add_f32 v122, v122, v58
    v_cvt_pk_bf16_f32 v122, v122, v122
    v_lshlrev_b32 v122, 16, v122
    v_add_f32 v122, 1.0, v122
    v_cvt_pk_bf16_f32 v122, v122, v122
    v_lshlrev_b32 v122, 16, v122
    v_add_f32 v123, v123, v59
    v_cvt_pk_bf16_f32 v123, v123, v123
    v_lshlrev_b32 v123, 16, v123
    v_add_f32 v123, 1.0, v123
    v_cvt_pk_bf16_f32 v123, v123, v123
    v_lshlrev_b32 v123, 16, v123
    v_add_f32 v124, v124, v60
    v_cvt_pk_bf16_f32 v124, v124, v124
    v_lshlrev_b32 v124, 16, v124
    v_add_f32 v124, 1.0, v124
    v_cvt_pk_bf16_f32 v124, v124, v124
    v_lshlrev_b32 v124, 16, v124
    v_add_f32 v125, v125, v61
    v_cvt_pk_bf16_f32 v125, v125, v125
    v_lshlrev_b32 v125, 16, v125
    v_add_f32 v125, 1.0, v125
    v_cvt_pk_bf16_f32 v125, v125, v125
    v_lshlrev_b32 v125, 16, v125
    v_add_f32 v126, v126, v62
    v_cvt_pk_bf16_f32 v126, v126, v126
    v_lshlrev_b32 v126, 16, v126
    v_add_f32 v126, 1.0, v126
    v_cvt_pk_bf16_f32 v126, v126, v126
    v_lshlrev_b32 v126, 16, v126
    v_add_f32 v127, v127, v63
    v_cvt_pk_bf16_f32 v127, v127, v127
    v_lshlrev_b32 v127, 16, v127
    v_add_f32 v127, 1.0, v127
    v_cvt_pk_bf16_f32 v127, v127, v127
    v_lshlrev_b32 v127, 16, v127
    v_mul_f32 v192, v192, v112
    v_cvt_pk_bf16_f32 v192, v192, v192
    v_lshlrev_b32 v192, 16, v192
    v_add_f32 v192, v192, v96
    v_mul_f32 v193, v193, v113
    v_cvt_pk_bf16_f32 v193, v193, v193
    v_lshlrev_b32 v193, 16, v193
    v_add_f32 v193, v193, v97
    v_mul_f32 v194, v194, v114
    v_cvt_pk_bf16_f32 v194, v194, v194
    v_lshlrev_b32 v194, 16, v194
    v_add_f32 v194, v194, v98
    v_mul_f32 v195, v195, v115
    v_cvt_pk_bf16_f32 v195, v195, v195
    v_lshlrev_b32 v195, 16, v195
    v_add_f32 v195, v195, v99
    v_mul_f32 v196, v196, v116
    v_cvt_pk_bf16_f32 v196, v196, v196
    v_lshlrev_b32 v196, 16, v196
    v_add_f32 v196, v196, v100
    v_mul_f32 v197, v197, v117
    v_cvt_pk_bf16_f32 v197, v197, v197
    v_lshlrev_b32 v197, 16, v197
    v_add_f32 v197, v197, v101
    v_mul_f32 v198, v198, v118
    v_cvt_pk_bf16_f32 v198, v198, v198
    v_lshlrev_b32 v198, 16, v198
    v_add_f32 v198, v198, v102
    v_mul_f32 v199, v199, v119
    v_cvt_pk_bf16_f32 v199, v199, v199
    v_lshlrev_b32 v199, 16, v199
    v_add_f32 v199, v199, v103
    v_mul_f32 v200, v200, v120
    v_cvt_pk_bf16_f32 v200, v200, v200
    v_lshlrev_b32 v200, 16, v200
    v_add_f32 v200, v200, v104
    v_mul_f32 v201, v201, v121
    v_cvt_pk_bf16_f32 v201, v201, v201
    v_lshlrev_b32 v201, 16, v201
    v_add_f32 v201, v201, v105
    v_mul_f32 v202, v202, v122
    v_cvt_pk_bf16_f32 v202, v202, v202
    v_lshlrev_b32 v202, 16, v202
    v_add_f32 v202, v202, v106
    v_mul_f32 v203, v203, v123
    v_cvt_pk_bf16_f32 v203, v203, v203
    v_lshlrev_b32 v203, 16, v203
    v_add_f32 v203, v203, v107
    v_mul_f32 v204, v204, v124
    v_cvt_pk_bf16_f32 v204, v204, v204
    v_lshlrev_b32 v204, 16, v204
    v_add_f32 v204, v204, v108
    v_mul_f32 v205, v205, v125
    v_cvt_pk_bf16_f32 v205, v205, v205
    v_lshlrev_b32 v205, 16, v205
    v_add_f32 v205, v205, v109
    v_mul_f32 v206, v206, v126
    v_cvt_pk_bf16_f32 v206, v206, v206
    v_lshlrev_b32 v206, 16, v206
    v_add_f32 v206, v206, v110
    v_mul_f32 v207, v207, v127
    v_cvt_pk_bf16_f32 v207, v207, v207
    v_lshlrev_b32 v207, 16, v207
    v_add_f32 v207, v207, v111
    v_cvt_pk_bf16_f32 v80, v192, v193
    v_cvt_pk_bf16_f32 v81, v194, v195
    v_cvt_pk_bf16_f32 v82, v196, v197
    v_cvt_pk_bf16_f32 v83, v198, v199
    v_cvt_pk_bf16_f32 v84, v200, v201
    v_cvt_pk_bf16_f32 v85, v202, v203
    v_cvt_pk_bf16_f32 v86, v204, v205
    v_cvt_pk_bf16_f32 v87, v206, v207
    s_lshr_b32 s45, s63, 5
    s_lshl_b32 s45, s45, 16
    s_and_b32 s46, s63, 31
    s_lshl_b32 s46, s46, 8
    s_add_u32 s45, s45, s46
    s_add_u32 s45, s45, 0x400000
    s_add_u32 s46, s45, 32768
    buffer_store_dwordx4 v[80:83], v2, s[12:15], s45 offen sc1
    buffer_store_dwordx4 v[84:87], v2, s[12:15], s46 offen sc1
    s_add_u32 s63, s63, 384
    v_mul_f32 v208, v208, v112
    v_cvt_pk_bf16_f32 v208, v208, v208
    v_lshlrev_b32 v208, 16, v208
    v_add_f32 v208, v208, v96
    v_mul_f32 v209, v209, v113
    v_cvt_pk_bf16_f32 v209, v209, v209
    v_lshlrev_b32 v209, 16, v209
    v_add_f32 v209, v209, v97
    v_mul_f32 v210, v210, v114
    v_cvt_pk_bf16_f32 v210, v210, v210
    v_lshlrev_b32 v210, 16, v210
    v_add_f32 v210, v210, v98
    v_mul_f32 v211, v211, v115
    v_cvt_pk_bf16_f32 v211, v211, v211
    v_lshlrev_b32 v211, 16, v211
    v_add_f32 v211, v211, v99
    v_mul_f32 v212, v212, v116
    v_cvt_pk_bf16_f32 v212, v212, v212
    v_lshlrev_b32 v212, 16, v212
    v_add_f32 v212, v212, v100
    v_mul_f32 v213, v213, v117
    v_cvt_pk_bf16_f32 v213, v213, v213
    v_lshlrev_b32 v213, 16, v213
    v_add_f32 v213, v213, v101
    v_mul_f32 v214, v214, v118
    v_cvt_pk_bf16_f32 v214, v214, v214
    v_lshlrev_b32 v214, 16, v214
    v_add_f32 v214, v214, v102
    v_mul_f32 v215, v215, v119
    v_cvt_pk_bf16_f32 v215, v215, v215
    v_lshlrev_b32 v215, 16, v215
    v_add_f32 v215, v215, v103
    v_mul_f32 v216, v216, v120
    v_cvt_pk_bf16_f32 v216, v216, v216
    v_lshlrev_b32 v216, 16, v216
    v_add_f32 v216, v216, v104
    v_mul_f32 v217, v217, v121
    v_cvt_pk_bf16_f32 v217, v217, v217
    v_lshlrev_b32 v217, 16, v217
    v_add_f32 v217, v217, v105
    v_mul_f32 v218, v218, v122
    v_cvt_pk_bf16_f32 v218, v218, v218
    v_lshlrev_b32 v218, 16, v218
    v_add_f32 v218, v218, v106
    v_mul_f32 v219, v219, v123
    v_cvt_pk_bf16_f32 v219, v219, v219
    v_lshlrev_b32 v219, 16, v219
    v_add_f32 v219, v219, v107
    v_mul_f32 v220, v220, v124
    v_cvt_pk_bf16_f32 v220, v220, v220
    v_lshlrev_b32 v220, 16, v220
    v_add_f32 v220, v220, v108
    v_mul_f32 v221, v221, v125
    v_cvt_pk_bf16_f32 v221, v221, v221
    v_lshlrev_b32 v221, 16, v221
    v_add_f32 v221, v221, v109
    v_mul_f32 v222, v222, v126
    v_cvt_pk_bf16_f32 v222, v222, v222
    v_lshlrev_b32 v222, 16, v222
    v_add_f32 v222, v222, v110
    v_mul_f32 v223, v223, v127
    v_cvt_pk_bf16_f32 v223, v223, v223
    v_lshlrev_b32 v223, 16, v223
    v_add_f32 v223, v223, v111
    v_cvt_pk_bf16_f32 v88, v208, v209
    v_cvt_pk_bf16_f32 v89, v210, v211
    v_cvt_pk_bf16_f32 v90, v212, v213
    v_cvt_pk_bf16_f32 v91, v214, v215
    v_cvt_pk_bf16_f32 v92, v216, v217
    v_cvt_pk_bf16_f32 v93, v218, v219
    v_cvt_pk_bf16_f32 v94, v220, v221
    v_cvt_pk_bf16_f32 v95, v222, v223
    s_lshr_b32 s45, s63, 5
    s_lshl_b32 s45, s45, 16
    s_and_b32 s46, s63, 31
    s_lshl_b32 s46, s46, 8
    s_add_u32 s45, s45, s46
    s_add_u32 s45, s45, 0x400000
    s_add_u32 s46, s45, 32768
    buffer_store_dwordx4 v[88:91], v2, s[12:15], s45 offen sc1
    buffer_store_dwordx4 v[92:95], v2, s[12:15], s46 offen sc1
    s_waitcnt vmcnt(2)
    s_barrier
    s_cmp_lg_u32 s44, 0
    s_cbranch_scc1 L_cnt_108
    v_mov_b32 v30, 1
    v_mov_b32 v31, 126976
    s_mov_b64 exec, 1
    buffer_atomic_add v30, v31, s[12:15], 0 offen sc1
    s_mov_b64 exec, -1
L_cnt_108:
    s_add_u32 s63, s63, 384
    v_lshlrev_b32 v64, 16, v144
    v_and_b32 v65, 0xffff0000, v144
    v_lshlrev_b32 v66, 16, v145
    v_and_b32 v67, 0xffff0000, v145
    v_lshlrev_b32 v68, 16, v146
    v_and_b32 v69, 0xffff0000, v146
    v_lshlrev_b32 v70, 16, v147
    v_and_b32 v71, 0xffff0000, v147
    v_lshlrev_b32 v72, 16, v148
    v_and_b32 v73, 0xffff0000, v148
    v_lshlrev_b32 v74, 16, v149
    v_and_b32 v75, 0xffff0000, v149
    v_lshlrev_b32 v76, 16, v150
    v_and_b32 v77, 0xffff0000, v150
    v_lshlrev_b32 v78, 16, v151
    v_and_b32 v79, 0xffff0000, v151
    v_add_f32 v26, v64, v65
    v_add_f32 v26, v26, v66
    v_add_f32 v26, v26, v67
    v_add_f32 v26, v26, v68
    v_add_f32 v26, v26, v69
    v_add_f32 v26, v26, v70
    v_add_f32 v26, v26, v71
    v_add_f32 v26, v26, v72
    v_add_f32 v26, v26, v73
    v_add_f32 v26, v26, v74
    v_add_f32 v26, v26, v75
    v_add_f32 v26, v26, v76
    v_add_f32 v26, v26, v77
    v_add_f32 v26, v26, v78
    v_add_f32 v26, v26, v79
    s_nop 1
    v_add_f32_dpp v26, v26, v26 row_shr:1 row_mask:0xf bank_mask:0xf bound_ctrl:0
    s_nop 1
    v_add_f32_dpp v26, v26, v26 row_shr:2 row_mask:0xf bank_mask:0xf bound_ctrl:0
    s_nop 1
    v_add_f32_dpp v26, v26, v26 row_shr:4 row_mask:0xf bank_mask:0xf bound_ctrl:0
    s_nop 1
    v_add_f32_dpp v26, v26, v26 row_shr:8 row_mask:0xf bank_mask:0xf bound_ctrl:0
    s_nop 1
    v_add_f32_dpp v26, v26, v26 row_bcast:15 row_mask:0xa bank_mask:0xf
    s_nop 1
    v_add_f32_dpp v26, v26, v26 row_bcast:31 row_mask:0xc bank_mask:0xf
    s_nop 1
    v_readlane_b32 s66, v26, 63
    s_nop 1
    v_mov_b32 v27, s66
    v_mul_f32 v27, 0x3a800000, v27
    v_mov_b32 v26, 0
    v_sub_f32 v28, v64, v27
    v_fmac_f32 v26, v28, v28
    v_sub_f32 v28, v65, v27
    v_fmac_f32 v26, v28, v28
    v_sub_f32 v28, v66, v27
    v_fmac_f32 v26, v28, v28
    v_sub_f32 v28, v67, v27
    v_fmac_f32 v26, v28, v28
    v_sub_f32 v28, v68, v27
    v_fmac_f32 v26, v28, v28
    v_sub_f32 v28, v69, v27
    v_fmac_f32 v26, v28, v28
    v_sub_f32 v28, v70, v27
    v_fmac_f32 v26, v28, v28
    v_sub_f32 v28, v71, v27
    v_fmac_f32 v26, v28, v28
    v_sub_f32 v28, v72, v27
    v_fmac_f32 v26, v28, v28
    v_sub_f32 v28, v73, v27
    v_fmac_f32 v26, v28, v28
    v_sub_f32 v28, v74, v27
    v_fmac_f32 v26, v28, v28
    v_sub_f32 v28, v75, v27
    v_fmac_f32 v26, v28, v28
    v_sub_f32 v28, v76, v27
    v_fmac_f32 v26, v28, v28
    v_sub_f32 v28, v77, v27
    v_fmac_f32 v26, v28, v28
    v_sub_f32 v28, v78, v27
    v_fmac_f32 v26, v28, v28
    v_sub_f32 v28, v79, v27
    v_fmac_f32 v26, v28, v28
    s_nop 1
    v_add_f32_dpp v26, v26, v26 row_shr:1 row_mask:0xf bank_mask:0xf bound_ctrl:0
    s_nop 1
    v_add_f32_dpp v26, v26, v26 row_shr:2 row_mask:0xf bank_mask:0xf bound_ctrl:0
    s_nop 1
    v_add_f32_dpp v26, v26, v26 row_shr:4 row_mask:0xf bank_mask:0xf bound_ctrl:0
    s_nop 1
    v_add_f32_dpp v26, v26, v26 row_shr:8 row_mask:0xf bank_mask:0xf bound_ctrl:0
    s_nop 1
    v_add_f32_dpp v26, v26, v26 row_bcast:15 row_mask:0xa bank_mask:0xf
    s_nop 1
    v_add_f32_dpp v26, v26, v26 row_bcast:31 row_mask:0xc bank_mask:0xf
    s_nop 1
    v_readlane_b32 s66, v26, 63
    s_nop 1
    v_mov_b32 v26, s66
    v_mul_f32 v26, 0x3a800000, v26
    v_cvt_pk_bf16_f32 v26, v26, v26
    v_lshlrev_b32 v26, 16, v26
    v_cvt_pk_bf16_f32 v27, v27, v27
    v_lshlrev_b32 v27, 16, v27
    v_add_f32 v26, 0x3727c5ac, v26
    v_cvt_pk_bf16_f32 v26, v26, v26
    v_lshlrev_b32 v26, 16, v26
    v_sqrt_f32 v26, v26
    s_nop 0
    v_cvt_pk_bf16_f32 v26, v26, v26
    v_lshlrev_b32 v26, 16, v26
    v_rcp_f32 v26, v26
    s_nop 0
    v_sub_f32 v64, v64, v27
    v_cvt_pk_bf16_f32 v64, v64, v64
    v_lshlrev_b32 v64, 16, v64
    v_mul_f32 v64, v64, v26
    v_cvt_pk_bf16_f32 v64, v64, v64
    v_lshlrev_b32 v64, 16, v64
    v_sub_f32 v65, v65, v27
    v_cvt_pk_bf16_f32 v65, v65, v65
    v_lshlrev_b32 v65, 16, v65
    v_mul_f32 v65, v65, v26
    v_cvt_pk_bf16_f32 v65, v65, v65
    v_lshlrev_b32 v65, 16, v65
    v_sub_f32 v66, v66, v27
    v_cvt_pk_bf16_f32 v66, v66, v66
    v_lshlrev_b32 v66, 16, v66
    v_mul_f32 v66, v66, v26
    v_cvt_pk_bf16_f32 v66, v66, v66
    v_lshlrev_b32 v66, 16, v66
    v_sub_f32 v67, v67, v27
    v_cvt_pk_bf16_f32 v67, v67, v67
    v_lshlrev_b32 v67, 16, v67
    v_mul_f32 v67, v67, v26
    v_cvt_pk_bf16_f32 v67, v67, v67
    v_lshlrev_b32 v67, 16, v67
    v_sub_f32 v68, v68, v27
    v_cvt_pk_bf16_f32 v68, v68, v68
    v_lshlrev_b32 v68, 16, v68
    v_mul_f32 v68, v68, v26
    v_cvt_pk_bf16_f32 v68, v68, v68
    v_lshlrev_b32 v68, 16, v68
    v_sub_f32 v69, v69, v27
    v_cvt_pk_bf16_f32 v69, v69, v69
    v_lshlrev_b32 v69, 16, v69
    v_mul_f32 v69, v69, v26
    v_cvt_pk_bf16_f32 v69, v69, v69
    v_lshlrev_b32 v69, 16, v69
    v_sub_f32 v70, v70, v27
    v_cvt_pk_bf16_f32 v70, v70, v70
    v_lshlrev_b32 v70, 16, v70
    v_mul_f32 v70, v70, v26
    v_cvt_pk_bf16_f32 v70, v70, v70
    v_lshlrev_b32 v70, 16, v70
    v_sub_f32 v71, v71, v27
    v_cvt_pk_bf16_f32 v71, v71, v71
    v_lshlrev_b32 v71, 16, v71
    v_mul_f32 v71, v71, v26
    v_cvt_pk_bf16_f32 v71, v71, v71
    v_lshlrev_b32 v71, 16, v71
    v_sub_f32 v72, v72, v27
    v_cvt_pk_bf16_f32 v72, v72, v72
    v_lshlrev_b32 v72, 16, v72
    v_mul_f32 v72, v72, v26
    v_cvt_pk_bf16_f32 v72, v72, v72
    v_lshlrev_b32 v72, 16, v72
    v_sub_f32 v73, v73, v27
    v_cvt_pk_bf16_f32 v73, v73, v73
    v_lshlrev_b32 v73, 16, v73
    v_mul_f32 v73, v73, v26
    v_cvt_pk_bf16_f32 v73, v73, v73
    v_lshlrev_b32 v73, 16, v73
    v_sub_f32 v74, v74, v27
    v_cvt_pk_bf16_f32 v74, v74, v74
    v_lshlrev_b32 v74, 16, v74
    v_mul_f32 v74, v74, v26
    v_cvt_pk_bf16_f32 v74, v74, v74
    v_lshlrev_b32 v74, 16, v74
    v_sub_f32 v75, v75, v27
    v_cvt_pk_bf16_f32 v75, v75, v75
    v_lshlrev_b32 v75, 16, v75
    v_mul_f32 v75, v75, v26
    v_cvt_pk_bf16_f32 v75, v75, v75
    v_lshlrev_b32 v75, 16, v75
    v_sub_f32 v76, v76, v27
    v_cvt_pk_bf16_f32 v76, v76, v76
    v_lshlrev_b32 v76, 16, v76
    v_mul_f32 v76, v76, v26
    v_cvt_pk_bf16_f32 v76, v76, v76
    v_lshlrev_b32 v76, 16, v76
    v_sub_f32 v77, v77, v27
    v_cvt_pk_bf16_f32 v77, v77, v77
    v_lshlrev_b32 v77, 16, v77
    v_mul_f32 v77, v77, v26
    v_cvt_pk_bf16_f32 v77, v77, v77
    v_lshlrev_b32 v77, 16, v77
    v_sub_f32 v78, v78, v27
    v_cvt_pk_bf16_f32 v78, v78, v78
    v_lshlrev_b32 v78, 16, v78
    v_mul_f32 v78, v78, v26
    v_cvt_pk_bf16_f32 v78, v78, v78
    v_lshlrev_b32 v78, 16, v78
    v_sub_f32 v79, v79, v27
    v_cvt_pk_bf16_f32 v79, v79, v79
    v_lshlrev_b32 v79, 16, v79
    v_mul_f32 v79, v79, v26
    v_cvt_pk_bf16_f32 v79, v79, v79
    v_lshlrev_b32 v79, 16, v79
    v_mul_f32 v64, v64, v112
    v_cvt_pk_bf16_f32 v64, v64, v64
    v_lshlrev_b32 v64, 16, v64
    v_add_f32 v64, v64, v96
    v_mul_f32 v65, v65, v113
    v_cvt_pk_bf16_f32 v65, v65, v65
    v_lshlrev_b32 v65, 16, v65
    v_add_f32 v65, v65, v97
    v_mul_f32 v66, v66, v114
    v_cvt_pk_bf16_f32 v66, v66, v66
    v_lshlrev_b32 v66, 16, v66
    v_add_f32 v66, v66, v98
    v_mul_f32 v67, v67, v115
    v_cvt_pk_bf16_f32 v67, v67, v67
    v_lshlrev_b32 v67, 16, v67
    v_add_f32 v67, v67, v99
    v_mul_f32 v68, v68, v116
    v_cvt_pk_bf16_f32 v68, v68, v68
    v_lshlrev_b32 v68, 16, v68
    v_add_f32 v68, v68, v100
    v_mul_f32 v69, v69, v117
    v_cvt_pk_bf16_f32 v69, v69, v69
    v_lshlrev_b32 v69, 16, v69
    v_add_f32 v69, v69, v101
    v_mul_f32 v70, v70, v118
    v_cvt_pk_bf16_f32 v70, v70, v70
    v_lshlrev_b32 v70, 16, v70
    v_add_f32 v70, v70, v102
    v_mul_f32 v71, v71, v119
    v_cvt_pk_bf16_f32 v71, v71, v71
    v_lshlrev_b32 v71, 16, v71
    v_add_f32 v71, v71, v103
    v_mul_f32 v72, v72, v120
    v_cvt_pk_bf16_f32 v72, v72, v72
    v_lshlrev_b32 v72, 16, v72
    v_add_f32 v72, v72, v104
    v_mul_f32 v73, v73, v121
    v_cvt_pk_bf16_f32 v73, v73, v73
    v_lshlrev_b32 v73, 16, v73
    v_add_f32 v73, v73, v105
    v_mul_f32 v74, v74, v122
    v_cvt_pk_bf16_f32 v74, v74, v74
    v_lshlrev_b32 v74, 16, v74
    v_add_f32 v74, v74, v106
    v_mul_f32 v75, v75, v123
    v_cvt_pk_bf16_f32 v75, v75, v75
    v_lshlrev_b32 v75, 16, v75
    v_add_f32 v75, v75, v107
    v_mul_f32 v76, v76, v124
    v_cvt_pk_bf16_f32 v76, v76, v76
    v_lshlrev_b32 v76, 16, v76
    v_add_f32 v76, v76, v108
    v_mul_f32 v77, v77, v125
    v_cvt_pk_bf16_f32 v77, v77, v77
    v_lshlrev_b32 v77, 16, v77
    v_add_f32 v77, v77, v109
    v_mul_f32 v78, v78, v126
    v_cvt_pk_bf16_f32 v78, v78, v78
    v_lshlrev_b32 v78, 16, v78
    v_add_f32 v78, v78, v110
    v_mul_f32 v79, v79, v127
    v_cvt_pk_bf16_f32 v79, v79, v79
    v_lshlrev_b32 v79, 16, v79
    v_add_f32 v79, v79, v111
    v_cvt_pk_bf16_f32 v80, v64, v65
    v_cvt_pk_bf16_f32 v81, v66, v67
    v_cvt_pk_bf16_f32 v82, v68, v69
    v_cvt_pk_bf16_f32 v83, v70, v71
    v_cvt_pk_bf16_f32 v84, v72, v73
    v_cvt_pk_bf16_f32 v85, v74, v75
    v_cvt_pk_bf16_f32 v86, v76, v77
    v_cvt_pk_bf16_f32 v87, v78, v79
    s_lshr_b32 s45, s63, 5
    s_lshl_b32 s45, s45, 16
    s_and_b32 s46, s63, 31
    s_lshl_b32 s46, s46, 8
    s_add_u32 s45, s45, s46
    s_add_u32 s45, s45, 0x400000
    s_add_u32 s46, s45, 32768
    buffer_store_dwordx4 v[80:83], v2, s[12:15], s45 offen sc1
    buffer_store_dwordx4 v[84:87], v2, s[12:15], s46 offen sc1
    s_add_u32 s63, s63, 384
    v_lshlrev_b32 v64, 16, v152
    v_and_b32 v65, 0xffff0000, v152
    v_lshlrev_b32 v66, 16, v153
    v_and_b32 v67, 0xffff0000, v153
    v_lshlrev_b32 v68, 16, v154
    v_and_b32 v69, 0xffff0000, v154
    v_lshlrev_b32 v70, 16, v155
    v_and_b32 v71, 0xffff0000, v155
    v_lshlrev_b32 v72, 16, v156
    v_and_b32 v73, 0xffff0000, v156
    v_lshlrev_b32 v74, 16, v157
    v_and_b32 v75, 0xffff0000, v157
    v_lshlrev_b32 v76, 16, v158
    v_and_b32 v77, 0xffff0000, v158
    v_lshlrev_b32 v78, 16, v159
    v_and_b32 v79, 0xffff0000, v159
    v_add_f32 v26, v64, v65
    v_add_f32 v26, v26, v66
    v_add_f32 v26, v26, v67
    v_add_f32 v26, v26, v68
    v_add_f32 v26, v26, v69
    v_add_f32 v26, v26, v70
    v_add_f32 v26, v26, v71
    v_add_f32 v26, v26, v72
    v_add_f32 v26, v26, v73
    v_add_f32 v26, v26, v74
    v_add_f32 v26, v26, v75
    v_add_f32 v26, v26, v76
    v_add_f32 v26, v26, v77
    v_add_f32 v26, v26, v78
    v_add_f32 v26, v26, v79
    s_nop 1
    v_add_f32_dpp v26, v26, v26 row_shr:1 row_mask:0xf bank_mask:0xf bound_ctrl:0
    s_nop 1
    v_add_f32_dpp v26, v26, v26 row_shr:2 row_mask:0xf bank_mask:0xf bound_ctrl:0
    s_nop 1
    v_add_f32_dpp v26, v26, v26 row_shr:4 row_mask:0xf bank_mask:0xf bound_ctrl:0
    s_nop 1
    v_add_f32_dpp v26, v26, v26 row_shr:8 row_mask:0xf bank_mask:0xf bound_ctrl:0
    s_nop 1
    v_add_f32_dpp v26, v26, v26 row_bcast:15 row_mask:0xa bank_mask:0xf
    s_nop 1
    v_add_f32_dpp v26, v26, v26 row_bcast:31 row_mask:0xc bank_mask:0xf
    s_nop 1
    v_readlane_b32 s66, v26, 63
    s_nop 1
    v_mov_b32 v27, s66
    v_mul_f32 v27, 0x3a800000, v27
    v_mov_b32 v26, 0
    v_sub_f32 v28, v64, v27
    v_fmac_f32 v26, v28, v28
    v_sub_f32 v28, v65, v27
    v_fmac_f32 v26, v28, v28
    v_sub_f32 v28, v66, v27
    v_fmac_f32 v26, v28, v28
    v_sub_f32 v28, v67, v27
    v_fmac_f32 v26, v28, v28
    v_sub_f32 v28, v68, v27
    v_fmac_f32 v26, v28, v28
    v_sub_f32 v28, v69, v27
    v_fmac_f32 v26, v28, v28
    v_sub_f32 v28, v70, v27
    v_fmac_f32 v26, v28, v28
    v_sub_f32 v28, v71, v27
    v_fmac_f32 v26, v28, v28
    v_sub_f32 v28, v72, v27
    v_fmac_f32 v26, v28, v28
    v_sub_f32 v28, v73, v27
    v_fmac_f32 v26, v28, v28
    v_sub_f32 v28, v74, v27
    v_fmac_f32 v26, v28, v28
    v_sub_f32 v28, v75, v27
    v_fmac_f32 v26, v28, v28
    v_sub_f32 v28, v76, v27
    v_fmac_f32 v26, v28, v28
    v_sub_f32 v28, v77, v27
    v_fmac_f32 v26, v28, v28
    v_sub_f32 v28, v78, v27
    v_fmac_f32 v26, v28, v28
    v_sub_f32 v28, v79, v27
    v_fmac_f32 v26, v28, v28
    s_nop 1
    v_add_f32_dpp v26, v26, v26 row_shr:1 row_mask:0xf bank_mask:0xf bound_ctrl:0
    s_nop 1
    v_add_f32_dpp v26, v26, v26 row_shr:2 row_mask:0xf bank_mask:0xf bound_ctrl:0
    s_nop 1
    v_add_f32_dpp v26, v26, v26 row_shr:4 row_mask:0xf bank_mask:0xf bound_ctrl:0
    s_nop 1
    v_add_f32_dpp v26, v26, v26 row_shr:8 row_mask:0xf bank_mask:0xf bound_ctrl:0
    s_nop 1
    v_add_f32_dpp v26, v26, v26 row_bcast:15 row_mask:0xa bank_mask:0xf
    s_nop 1
    v_add_f32_dpp v26, v26, v26 row_bcast:31 row_mask:0xc bank_mask:0xf
    s_nop 1
    v_readlane_b32 s66, v26, 63
    s_nop 1
    v_mov_b32 v26, s66
    v_mul_f32 v26, 0x3a800000, v26
    v_cvt_pk_bf16_f32 v26, v26, v26
    v_lshlrev_b32 v26, 16, v26
    v_cvt_pk_bf16_f32 v27, v27, v27
    v_lshlrev_b32 v27, 16, v27
    v_add_f32 v26, 0x3727c5ac, v26
    v_cvt_pk_bf16_f32 v26, v26, v26
    v_lshlrev_b32 v26, 16, v26
    v_sqrt_f32 v26, v26
    s_nop 0
    v_cvt_pk_bf16_f32 v26, v26, v26
    v_lshlrev_b32 v26, 16, v26
    v_rcp_f32 v26, v26
    s_nop 0
    v_sub_f32 v64, v64, v27
    v_cvt_pk_bf16_f32 v64, v64, v64
    v_lshlrev_b32 v64, 16, v64
    v_mul_f32 v64, v64, v26
    v_cvt_pk_bf16_f32 v64, v64, v64
    v_lshlrev_b32 v64, 16, v64
    v_sub_f32 v65, v65, v27
    v_cvt_pk_bf16_f32 v65, v65, v65
    v_lshlrev_b32 v65, 16, v65
    v_mul_f32 v65, v65, v26
    v_cvt_pk_bf16_f32 v65, v65, v65
    v_lshlrev_b32 v65, 16, v65
    v_sub_f32 v66, v66, v27
    v_cvt_pk_bf16_f32 v66, v66, v66
    v_lshlrev_b32 v66, 16, v66
    v_mul_f32 v66, v66, v26
    v_cvt_pk_bf16_f32 v66, v66, v66
    v_lshlrev_b32 v66, 16, v66
    v_sub_f32 v67, v67, v27
    v_cvt_pk_bf16_f32 v67, v67, v67
    v_lshlrev_b32 v67, 16, v67
    v_mul_f32 v67, v67, v26
    v_cvt_pk_bf16_f32 v67, v67, v67
    v_lshlrev_b32 v67, 16, v67
    v_sub_f32 v68, v68, v27
    v_cvt_pk_bf16_f32 v68, v68, v68
    v_lshlrev_b32 v68, 16, v68
    v_mul_f32 v68, v68, v26
    v_cvt_pk_bf16_f32 v68, v68, v68
    v_lshlrev_b32 v68, 16, v68
    v_sub_f32 v69, v69, v27
    v_cvt_pk_bf16_f32 v69, v69, v69
    v_lshlrev_b32 v69, 16, v69
    v_mul_f32 v69, v69, v26
    v_cvt_pk_bf16_f32 v69, v69, v69
    v_lshlrev_b32 v69, 16, v69
    v_sub_f32 v70, v70, v27
    v_cvt_pk_bf16_f32 v70, v70, v70
    v_lshlrev_b32 v70, 16, v70
    v_mul_f32 v70, v70, v26
    v_cvt_pk_bf16_f32 v70, v70, v70
    v_lshlrev_b32 v70, 16, v70
    v_sub_f32 v71, v71, v27
    v_cvt_pk_bf16_f32 v71, v71, v71
    v_lshlrev_b32 v71, 16, v71
    v_mul_f32 v71, v71, v26
    v_cvt_pk_bf16_f32 v71, v71, v71
    v_lshlrev_b32 v71, 16, v71
    v_sub_f32 v72, v72, v27
    v_cvt_pk_bf16_f32 v72, v72, v72
    v_lshlrev_b32 v72, 16, v72
    v_mul_f32 v72, v72, v26
    v_cvt_pk_bf16_f32 v72, v72, v72
    v_lshlrev_b32 v72, 16, v72
    v_sub_f32 v73, v73, v27
    v_cvt_pk_bf16_f32 v73, v73, v73
    v_lshlrev_b32 v73, 16, v73
    v_mul_f32 v73, v73, v26
    v_cvt_pk_bf16_f32 v73, v73, v73
    v_lshlrev_b32 v73, 16, v73
    v_sub_f32 v74, v74, v27
    v_cvt_pk_bf16_f32 v74, v74, v74
    v_lshlrev_b32 v74, 16, v74
    v_mul_f32 v74, v74, v26
    v_cvt_pk_bf16_f32 v74, v74, v74
    v_lshlrev_b32 v74, 16, v74
    v_sub_f32 v75, v75, v27
    v_cvt_pk_bf16_f32 v75, v75, v75
    v_lshlrev_b32 v75, 16, v75
    v_mul_f32 v75, v75, v26
    v_cvt_pk_bf16_f32 v75, v75, v75
    v_lshlrev_b32 v75, 16, v75
    v_sub_f32 v76, v76, v27
    v_cvt_pk_bf16_f32 v76, v76, v76
    v_lshlrev_b32 v76, 16, v76
    v_mul_f32 v76, v76, v26
    v_cvt_pk_bf16_f32 v76, v76, v76
    v_lshlrev_b32 v76, 16, v76
    v_sub_f32 v77, v77, v27
    v_cvt_pk_bf16_f32 v77, v77, v77
    v_lshlrev_b32 v77, 16, v77
    v_mul_f32 v77, v77, v26
    v_cvt_pk_bf16_f32 v77, v77, v77
    v_lshlrev_b32 v77, 16, v77
    v_sub_f32 v78, v78, v27
    v_cvt_pk_bf16_f32 v78, v78, v78
    v_lshlrev_b32 v78, 16, v78
    v_mul_f32 v78, v78, v26
    v_cvt_pk_bf16_f32 v78, v78, v78
    v_lshlrev_b32 v78, 16, v78
    v_sub_f32 v79, v79, v27
    v_cvt_pk_bf16_f32 v79, v79, v79
    v_lshlrev_b32 v79, 16, v79
    v_mul_f32 v79, v79, v26
    v_cvt_pk_bf16_f32 v79, v79, v79
    v_lshlrev_b32 v79, 16, v79
    v_mul_f32 v64, v64, v112
    v_cvt_pk_bf16_f32 v64, v64, v64
    v_lshlrev_b32 v64, 16, v64
    v_add_f32 v64, v64, v96
    v_mul_f32 v65, v65, v113
    v_cvt_pk_bf16_f32 v65, v65, v65
    v_lshlrev_b32 v65, 16, v65
    v_add_f32 v65, v65, v97
    v_mul_f32 v66, v66, v114
    v_cvt_pk_bf16_f32 v66, v66, v66
    v_lshlrev_b32 v66, 16, v66
    v_add_f32 v66, v66, v98
    v_mul_f32 v67, v67, v115
    v_cvt_pk_bf16_f32 v67, v67, v67
    v_lshlrev_b32 v67, 16, v67
    v_add_f32 v67, v67, v99
    v_mul_f32 v68, v68, v116
    v_cvt_pk_bf16_f32 v68, v68, v68
    v_lshlrev_b32 v68, 16, v68
    v_add_f32 v68, v68, v100
    v_mul_f32 v69, v69, v117
    v_cvt_pk_bf16_f32 v69, v69, v69
    v_lshlrev_b32 v69, 16, v69
    v_add_f32 v69, v69, v101
    v_mul_f32 v70, v70, v118
    v_cvt_pk_bf16_f32 v70, v70, v70
    v_lshlrev_b32 v70, 16, v70
    v_add_f32 v70, v70, v102
    v_mul_f32 v71, v71, v119
    v_cvt_pk_bf16_f32 v71, v71, v71
    v_lshlrev_b32 v71, 16, v71
    v_add_f32 v71, v71, v103
    v_mul_f32 v72, v72, v120
    v_cvt_pk_bf16_f32 v72, v72, v72
    v_lshlrev_b32 v72, 16, v72
    v_add_f32 v72, v72, v104
    v_mul_f32 v73, v73, v121
    v_cvt_pk_bf16_f32 v73, v73, v73
    v_lshlrev_b32 v73, 16, v73
    v_add_f32 v73, v73, v105
    v_mul_f32 v74, v74, v122
    v_cvt_pk_bf16_f32 v74, v74, v74
    v_lshlrev_b32 v74, 16, v74
    v_add_f32 v74, v74, v106
    v_mul_f32 v75, v75, v123
    v_cvt_pk_bf16_f32 v75, v75, v75
    v_lshlrev_b32 v75, 16, v75
    v_add_f32 v75, v75, v107
    v_mul_f32 v76, v76, v124
    v_cvt_pk_bf16_f32 v76, v76, v76
    v_lshlrev_b32 v76, 16, v76
    v_add_f32 v76, v76, v108
    v_mul_f32 v77, v77, v125
    v_cvt_pk_bf16_f32 v77, v77, v77
    v_lshlrev_b32 v77, 16, v77
    v_add_f32 v77, v77, v109
    v_mul_f32 v78, v78, v126
    v_cvt_pk_bf16_f32 v78, v78, v78
    v_lshlrev_b32 v78, 16, v78
    v_add_f32 v78, v78, v110
    v_mul_f32 v79, v79, v127
    v_cvt_pk_bf16_f32 v79, v79, v79
    v_lshlrev_b32 v79, 16, v79
    v_add_f32 v79, v79, v111
    v_cvt_pk_bf16_f32 v80, v64, v65
    v_cvt_pk_bf16_f32 v81, v66, v67
    v_cvt_pk_bf16_f32 v82, v68, v69
    v_cvt_pk_bf16_f32 v83, v70, v71
    v_cvt_pk_bf16_f32 v84, v72, v73
    v_cvt_pk_bf16_f32 v85, v74, v75
    v_cvt_pk_bf16_f32 v86, v76, v77
    v_cvt_pk_bf16_f32 v87, v78, v79
    s_lshr_b32 s45, s63, 5
    s_lshl_b32 s45, s45, 16
    s_and_b32 s46, s63, 31
    s_lshl_b32 s46, s46, 8
    s_add_u32 s45, s45, s46
    s_add_u32 s45, s45, 0x400000
    s_add_u32 s46, s45, 32768
    buffer_store_dwordx4 v[80:83], v2, s[12:15], s45 offen sc1
    buffer_store_dwordx4 v[84:87], v2, s[12:15], s46 offen sc1
    s_add_u32 s63, s63, 384
    v_lshlrev_b32 v64, 16, v160
    v_and_b32 v65, 0xffff0000, v160
    v_lshlrev_b32 v66, 16, v161
    v_and_b32 v67, 0xffff0000, v161
    v_lshlrev_b32 v68, 16, v162
    v_and_b32 v69, 0xffff0000, v162
    v_lshlrev_b32 v70, 16, v163
    v_and_b32 v71, 0xffff0000, v163
    v_lshlrev_b32 v72, 16, v164
    v_and_b32 v73, 0xffff0000, v164
    v_lshlrev_b32 v74, 16, v165
    v_and_b32 v75, 0xffff0000, v165
    v_lshlrev_b32 v76, 16, v166
    v_and_b32 v77, 0xffff0000, v166
    v_lshlrev_b32 v78, 16, v167
    v_and_b32 v79, 0xffff0000, v167
    v_add_f32 v26, v64, v65
    v_add_f32 v26, v26, v66
    v_add_f32 v26, v26, v67
    v_add_f32 v26, v26, v68
    v_add_f32 v26, v26, v69
    v_add_f32 v26, v26, v70
    v_add_f32 v26, v26, v71
    v_add_f32 v26, v26, v72
    v_add_f32 v26, v26, v73
    v_add_f32 v26, v26, v74
    v_add_f32 v26, v26, v75
    v_add_f32 v26, v26, v76
    v_add_f32 v26, v26, v77
    v_add_f32 v26, v26, v78
    v_add_f32 v26, v26, v79
    s_nop 1
    v_add_f32_dpp v26, v26, v26 row_shr:1 row_mask:0xf bank_mask:0xf bound_ctrl:0
    s_nop 1
    v_add_f32_dpp v26, v26, v26 row_shr:2 row_mask:0xf bank_mask:0xf bound_ctrl:0
    s_nop 1
    v_add_f32_dpp v26, v26, v26 row_shr:4 row_mask:0xf bank_mask:0xf bound_ctrl:0
    s_nop 1
    v_add_f32_dpp v26, v26, v26 row_shr:8 row_mask:0xf bank_mask:0xf bound_ctrl:0
    s_nop 1
    v_add_f32_dpp v26, v26, v26 row_bcast:15 row_mask:0xa bank_mask:0xf
    s_nop 1
    v_add_f32_dpp v26, v26, v26 row_bcast:31 row_mask:0xc bank_mask:0xf
    s_nop 1
    v_readlane_b32 s66, v26, 63
    s_nop 1
    v_mov_b32 v27, s66
    v_mul_f32 v27, 0x3a800000, v27
    v_mov_b32 v26, 0
    v_sub_f32 v28, v64, v27
    v_fmac_f32 v26, v28, v28
    v_sub_f32 v28, v65, v27
    v_fmac_f32 v26, v28, v28
    v_sub_f32 v28, v66, v27
    v_fmac_f32 v26, v28, v28
    v_sub_f32 v28, v67, v27
    v_fmac_f32 v26, v28, v28
    v_sub_f32 v28, v68, v27
    v_fmac_f32 v26, v28, v28
    v_sub_f32 v28, v69, v27
    v_fmac_f32 v26, v28, v28
    v_sub_f32 v28, v70, v27
    v_fmac_f32 v26, v28, v28
    v_sub_f32 v28, v71, v27
    v_fmac_f32 v26, v28, v28
    v_sub_f32 v28, v72, v27
    v_fmac_f32 v26, v28, v28
    v_sub_f32 v28, v73, v27
    v_fmac_f32 v26, v28, v28
    v_sub_f32 v28, v74, v27
    v_fmac_f32 v26, v28, v28
    v_sub_f32 v28, v75, v27
    v_fmac_f32 v26, v28, v28
    v_sub_f32 v28, v76, v27
    v_fmac_f32 v26, v28, v28
    v_sub_f32 v28, v77, v27
    v_fmac_f32 v26, v28, v28
    v_sub_f32 v28, v78, v27
    v_fmac_f32 v26, v28, v28
    v_sub_f32 v28, v79, v27
    v_fmac_f32 v26, v28, v28
    s_nop 1
    v_add_f32_dpp v26, v26, v26 row_shr:1 row_mask:0xf bank_mask:0xf bound_ctrl:0
    s_nop 1
    v_add_f32_dpp v26, v26, v26 row_shr:2 row_mask:0xf bank_mask:0xf bound_ctrl:0
    s_nop 1
    v_add_f32_dpp v26, v26, v26 row_shr:4 row_mask:0xf bank_mask:0xf bound_ctrl:0
    s_nop 1
    v_add_f32_dpp v26, v26, v26 row_shr:8 row_mask:0xf bank_mask:0xf bound_ctrl:0
    s_nop 1
    v_add_f32_dpp v26, v26, v26 row_bcast:15 row_mask:0xa bank_mask:0xf
    s_nop 1
    v_add_f32_dpp v26, v26, v26 row_bcast:31 row_mask:0xc bank_mask:0xf
    s_nop 1
    v_readlane_b32 s66, v26, 63
    s_nop 1
    v_mov_b32 v26, s66
    v_mul_f32 v26, 0x3a800000, v26
    v_cvt_pk_bf16_f32 v26, v26, v26
    v_lshlrev_b32 v26, 16, v26
    v_cvt_pk_bf16_f32 v27, v27, v27
    v_lshlrev_b32 v27, 16, v27
    v_add_f32 v26, 0x3727c5ac, v26
    v_cvt_pk_bf16_f32 v26, v26, v26
    v_lshlrev_b32 v26, 16, v26
    v_sqrt_f32 v26, v26
    s_nop 0
    v_cvt_pk_bf16_f32 v26, v26, v26
    v_lshlrev_b32 v26, 16, v26
    v_rcp_f32 v26, v26
    s_nop 0
    v_sub_f32 v64, v64, v27
    v_cvt_pk_bf16_f32 v64, v64, v64
    v_lshlrev_b32 v64, 16, v64
    v_mul_f32 v64, v64, v26
    v_cvt_pk_bf16_f32 v64, v64, v64
    v_lshlrev_b32 v64, 16, v64
    v_sub_f32 v65, v65, v27
    v_cvt_pk_bf16_f32 v65, v65, v65
    v_lshlrev_b32 v65, 16, v65
    v_mul_f32 v65, v65, v26
    v_cvt_pk_bf16_f32 v65, v65, v65
    v_lshlrev_b32 v65, 16, v65
    v_sub_f32 v66, v66, v27
    v_cvt_pk_bf16_f32 v66, v66, v66
    v_lshlrev_b32 v66, 16, v66
    v_mul_f32 v66, v66, v26
    v_cvt_pk_bf16_f32 v66, v66, v66
    v_lshlrev_b32 v66, 16, v66
    v_sub_f32 v67, v67, v27
    v_cvt_pk_bf16_f32 v67, v67, v67
    v_lshlrev_b32 v67, 16, v67
    v_mul_f32 v67, v67, v26
    v_cvt_pk_bf16_f32 v67, v67, v67
    v_lshlrev_b32 v67, 16, v67
    v_sub_f32 v68, v68, v27
    v_cvt_pk_bf16_f32 v68, v68, v68
    v_lshlrev_b32 v68, 16, v68
    v_mul_f32 v68, v68, v26
    v_cvt_pk_bf16_f32 v68, v68, v68
    v_lshlrev_b32 v68, 16, v68
    v_sub_f32 v69, v69, v27
    v_cvt_pk_bf16_f32 v69, v69, v69
    v_lshlrev_b32 v69, 16, v69
    v_mul_f32 v69, v69, v26
    v_cvt_pk_bf16_f32 v69, v69, v69
    v_lshlrev_b32 v69, 16, v69
    v_sub_f32 v70, v70, v27
    v_cvt_pk_bf16_f32 v70, v70, v70
    v_lshlrev_b32 v70, 16, v70
    v_mul_f32 v70, v70, v26
    v_cvt_pk_bf16_f32 v70, v70, v70
    v_lshlrev_b32 v70, 16, v70
    v_sub_f32 v71, v71, v27
    v_cvt_pk_bf16_f32 v71, v71, v71
    v_lshlrev_b32 v71, 16, v71
    v_mul_f32 v71, v71, v26
    v_cvt_pk_bf16_f32 v71, v71, v71
    v_lshlrev_b32 v71, 16, v71
    v_sub_f32 v72, v72, v27
    v_cvt_pk_bf16_f32 v72, v72, v72
    v_lshlrev_b32 v72, 16, v72
    v_mul_f32 v72, v72, v26
    v_cvt_pk_bf16_f32 v72, v72, v72
    v_lshlrev_b32 v72, 16, v72
    v_sub_f32 v73, v73, v27
    v_cvt_pk_bf16_f32 v73, v73, v73
    v_lshlrev_b32 v73, 16, v73
    v_mul_f32 v73, v73, v26
    v_cvt_pk_bf16_f32 v73, v73, v73
    v_lshlrev_b32 v73, 16, v73
    v_sub_f32 v74, v74, v27
    v_cvt_pk_bf16_f32 v74, v74, v74
    v_lshlrev_b32 v74, 16, v74
    v_mul_f32 v74, v74, v26
    v_cvt_pk_bf16_f32 v74, v74, v74
    v_lshlrev_b32 v74, 16, v74
    v_sub_f32 v75, v75, v27
    v_cvt_pk_bf16_f32 v75, v75, v75
    v_lshlrev_b32 v75, 16, v75
    v_mul_f32 v75, v75, v26
    v_cvt_pk_bf16_f32 v75, v75, v75
    v_lshlrev_b32 v75, 16, v75
    v_sub_f32 v76, v76, v27
    v_cvt_pk_bf16_f32 v76, v76, v76
    v_lshlrev_b32 v76, 16, v76
    v_mul_f32 v76, v76, v26
    v_cvt_pk_bf16_f32 v76, v76, v76
    v_lshlrev_b32 v76, 16, v76
    v_sub_f32 v77, v77, v27
    v_cvt_pk_bf16_f32 v77, v77, v77
    v_lshlrev_b32 v77, 16, v77
    v_mul_f32 v77, v77, v26
    v_cvt_pk_bf16_f32 v77, v77, v77
    v_lshlrev_b32 v77, 16, v77
    v_sub_f32 v78, v78, v27
    v_cvt_pk_bf16_f32 v78, v78, v78
    v_lshlrev_b32 v78, 16, v78
    v_mul_f32 v78, v78, v26
    v_cvt_pk_bf16_f32 v78, v78, v78
    v_lshlrev_b32 v78, 16, v78
    v_sub_f32 v79, v79, v27
    v_cvt_pk_bf16_f32 v79, v79, v79
    v_lshlrev_b32 v79, 16, v79
    v_mul_f32 v79, v79, v26
    v_cvt_pk_bf16_f32 v79, v79, v79
    v_lshlrev_b32 v79, 16, v79
    v_mul_f32 v64, v64, v112
    v_cvt_pk_bf16_f32 v64, v64, v64
    v_lshlrev_b32 v64, 16, v64
    v_add_f32 v64, v64, v96
    v_mul_f32 v65, v65, v113
    v_cvt_pk_bf16_f32 v65, v65, v65
    v_lshlrev_b32 v65, 16, v65
    v_add_f32 v65, v65, v97
    v_mul_f32 v66, v66, v114
    v_cvt_pk_bf16_f32 v66, v66, v66
    v_lshlrev_b32 v66, 16, v66
    v_add_f32 v66, v66, v98
    v_mul_f32 v67, v67, v115
    v_cvt_pk_bf16_f32 v67, v67, v67
    v_lshlrev_b32 v67, 16, v67
    v_add_f32 v67, v67, v99
    v_mul_f32 v68, v68, v116
    v_cvt_pk_bf16_f32 v68, v68, v68
    v_lshlrev_b32 v68, 16, v68
    v_add_f32 v68, v68, v100
    v_mul_f32 v69, v69, v117
    v_cvt_pk_bf16_f32 v69, v69, v69
    v_lshlrev_b32 v69, 16, v69
    v_add_f32 v69, v69, v101
    v_mul_f32 v70, v70, v118
    v_cvt_pk_bf16_f32 v70, v70, v70
    v_lshlrev_b32 v70, 16, v70
    v_add_f32 v70, v70, v102
    v_mul_f32 v71, v71, v119
    v_cvt_pk_bf16_f32 v71, v71, v71
    v_lshlrev_b32 v71, 16, v71
    v_add_f32 v71, v71, v103
    v_mul_f32 v72, v72, v120
    v_cvt_pk_bf16_f32 v72, v72, v72
    v_lshlrev_b32 v72, 16, v72
    v_add_f32 v72, v72, v104
    v_mul_f32 v73, v73, v121
    v_cvt_pk_bf16_f32 v73, v73, v73
    v_lshlrev_b32 v73, 16, v73
    v_add_f32 v73, v73, v105
    v_mul_f32 v74, v74, v122
    v_cvt_pk_bf16_f32 v74, v74, v74
    v_lshlrev_b32 v74, 16, v74
    v_add_f32 v74, v74, v106
    v_mul_f32 v75, v75, v123
    v_cvt_pk_bf16_f32 v75, v75, v75
    v_lshlrev_b32 v75, 16, v75
    v_add_f32 v75, v75, v107
    v_mul_f32 v76, v76, v124
    v_cvt_pk_bf16_f32 v76, v76, v76
    v_lshlrev_b32 v76, 16, v76
    v_add_f32 v76, v76, v108
    v_mul_f32 v77, v77, v125
    v_cvt_pk_bf16_f32 v77, v77, v77
    v_lshlrev_b32 v77, 16, v77
    v_add_f32 v77, v77, v109
    v_mul_f32 v78, v78, v126
    v_cvt_pk_bf16_f32 v78, v78, v78
    v_lshlrev_b32 v78, 16, v78
    v_add_f32 v78, v78, v110
    v_mul_f32 v79, v79, v127
    v_cvt_pk_bf16_f32 v79, v79, v79
    v_lshlrev_b32 v79, 16, v79
    v_add_f32 v79, v79, v111
    v_cvt_pk_bf16_f32 v80, v64, v65
    v_cvt_pk_bf16_f32 v81, v66, v67
    v_cvt_pk_bf16_f32 v82, v68, v69
    v_cvt_pk_bf16_f32 v83, v70, v71
    v_cvt_pk_bf16_f32 v84, v72, v73
    v_cvt_pk_bf16_f32 v85, v74, v75
    v_cvt_pk_bf16_f32 v86, v76, v77
    v_cvt_pk_bf16_f32 v87, v78, v79
    s_lshr_b32 s45, s63, 5
    s_lshl_b32 s45, s45, 16
    s_and_b32 s46, s63, 31
    s_lshl_b32 s46, s46, 8
    s_add_u32 s45, s45, s46
    s_add_u32 s45, s45, 0x400000
    s_add_u32 s46, s45, 32768
    buffer_store_dwordx4 v[80:83], v2, s[12:15], s45 offen sc1
    buffer_store_dwordx4 v[84:87], v2, s[12:15], s46 offen sc1
    s_add_u32 s63, s63, 384
    s_cmp_ge_u32 s63, 2048
    s_cbranch_scc1 L_ln_done_107
    v_lshlrev_b32 v64, 16, v168
    v_and_b32 v65, 0xffff0000, v168
    v_lshlrev_b32 v66, 16, v169
    v_and_b32 v67, 0xffff0000, v169
    v_lshlrev_b32 v68, 16, v170
    v_and_b32 v69, 0xffff0000, v170
    v_lshlrev_b32 v70, 16, v171
    v_and_b32 v71, 0xffff0000, v171
    v_lshlrev_b32 v72, 16, v172
    v_and_b32 v73, 0xffff0000, v172
    v_lshlrev_b32 v74, 16, v173
    v_and_b32 v75, 0xffff0000, v173
    v_lshlrev_b32 v76, 16, v174
    v_and_b32 v77, 0xffff0000, v174
    v_lshlrev_b32 v78, 16, v175
    v_and_b32 v79, 0xffff0000, v175
    v_add_f32 v26, v64, v65
    v_add_f32 v26, v26, v66
    v_add_f32 v26, v26, v67
    v_add_f32 v26, v26, v68
    v_add_f32 v26, v26, v69
    v_add_f32 v26, v26, v70
    v_add_f32 v26, v26, v71
    v_add_f32 v26, v26, v72
    v_add_f32 v26, v26, v73
    v_add_f32 v26, v26, v74
    v_add_f32 v26, v26, v75
    v_add_f32 v26, v26, v76
    v_add_f32 v26, v26, v77
    v_add_f32 v26, v26, v78
    v_add_f32 v26, v26, v79
    s_nop 1
    v_add_f32_dpp v26, v26, v26 row_shr:1 row_mask:0xf bank_mask:0xf bound_ctrl:0
    s_nop 1
    v_add_f32_dpp v26, v26, v26 row_shr:2 row_mask:0xf bank_mask:0xf bound_ctrl:0
    s_nop 1
    v_add_f32_dpp v26, v26, v26 row_shr:4 row_mask:0xf bank_mask:0xf bound_ctrl:0
    s_nop 1
    v_add_f32_dpp v26, v26, v26 row_shr:8 row_mask:0xf bank_mask:0xf bound_ctrl:0
    s_nop 1
    v_add_f32_dpp v26, v26, v26 row_bcast:15 row_mask:0xa bank_mask:0xf
    s_nop 1
    v_add_f32_dpp v26, v26, v26 row_bcast:31 row_mask:0xc bank_mask:0xf
    s_nop 1
    v_readlane_b32 s66, v26, 63
    s_nop 1
    v_mov_b32 v27, s66
    v_mul_f32 v27, 0x3a800000, v27
    v_mov_b32 v26, 0
    v_sub_f32 v28, v64, v27
    v_fmac_f32 v26, v28, v28
    v_sub_f32 v28, v65, v27
    v_fmac_f32 v26, v28, v28
    v_sub_f32 v28, v66, v27
    v_fmac_f32 v26, v28, v28
    v_sub_f32 v28, v67, v27
    v_fmac_f32 v26, v28, v28
    v_sub_f32 v28, v68, v27
    v_fmac_f32 v26, v28, v28
    v_sub_f32 v28, v69, v27
    v_fmac_f32 v26, v28, v28
    v_sub_f32 v28, v70, v27
    v_fmac_f32 v26, v28, v28
    v_sub_f32 v28, v71, v27
    v_fmac_f32 v26, v28, v28
    v_sub_f32 v28, v72, v27
    v_fmac_f32 v26, v28, v28
    v_sub_f32 v28, v73, v27
    v_fmac_f32 v26, v28, v28
    v_sub_f32 v28, v74, v27
    v_fmac_f32 v26, v28, v28
    v_sub_f32 v28, v75, v27
    v_fmac_f32 v26, v28, v28
    v_sub_f32 v28, v76, v27
    v_fmac_f32 v26, v28, v28
    v_sub_f32 v28, v77, v27
    v_fmac_f32 v26, v28, v28
    v_sub_f32 v28, v78, v27
    v_fmac_f32 v26, v28, v28
    v_sub_f32 v28, v79, v27
    v_fmac_f32 v26, v28, v28
    s_nop 1
    v_add_f32_dpp v26, v26, v26 row_shr:1 row_mask:0xf bank_mask:0xf bound_ctrl:0
    s_nop 1
    v_add_f32_dpp v26, v26, v26 row_shr:2 row_mask:0xf bank_mask:0xf bound_ctrl:0
    s_nop 1
    v_add_f32_dpp v26, v26, v26 row_shr:4 row_mask:0xf bank_mask:0xf bound_ctrl:0
    s_nop 1
    v_add_f32_dpp v26, v26, v26 row_shr:8 row_mask:0xf bank_mask:0xf bound_ctrl:0
    s_nop 1
    v_add_f32_dpp v26, v26, v26 row_bcast:15 row_mask:0xa bank_mask:0xf
    s_nop 1
    v_add_f32_dpp v26, v26, v26 row_bcast:31 row_mask:0xc bank_mask:0xf
    s_nop 1
    v_readlane_b32 s66, v26, 63
    s_nop 1
    v_mov_b32 v26, s66
    v_mul_f32 v26, 0x3a800000, v26
    v_cvt_pk_bf16_f32 v26, v26, v26
    v_lshlrev_b32 v26, 16, v26
    v_cvt_pk_bf16_f32 v27, v27, v27
    v_lshlrev_b32 v27, 16, v27
    v_add_f32 v26, 0x3727c5ac, v26
    v_cvt_pk_bf16_f32 v26, v26, v26
    v_lshlrev_b32 v26, 16, v26
    v_sqrt_f32 v26, v26
    s_nop 0
    v_cvt_pk_bf16_f32 v26, v26, v26
    v_lshlrev_b32 v26, 16, v26
    v_rcp_f32 v26, v26
    s_nop 0
    v_sub_f32 v64, v64, v27
    v_cvt_pk_bf16_f32 v64, v64, v64
    v_lshlrev_b32 v64, 16, v64
    v_mul_f32 v64, v64, v26
    v_cvt_pk_bf16_f32 v64, v64, v64
    v_lshlrev_b32 v64, 16, v64
    v_sub_f32 v65, v65, v27
    v_cvt_pk_bf16_f32 v65, v65, v65
    v_lshlrev_b32 v65, 16, v65
    v_mul_f32 v65, v65, v26
    v_cvt_pk_bf16_f32 v65, v65, v65
    v_lshlrev_b32 v65, 16, v65
    v_sub_f32 v66, v66, v27
    v_cvt_pk_bf16_f32 v66, v66, v66
    v_lshlrev_b32 v66, 16, v66
    v_mul_f32 v66, v66, v26
    v_cvt_pk_bf16_f32 v66, v66, v66
    v_lshlrev_b32 v66, 16, v66
    v_sub_f32 v67, v67, v27
    v_cvt_pk_bf16_f32 v67, v67, v67
    v_lshlrev_b32 v67, 16, v67
    v_mul_f32 v67, v67, v26
    v_cvt_pk_bf16_f32 v67, v67, v67
    v_lshlrev_b32 v67, 16, v67
    v_sub_f32 v68, v68, v27
    v_cvt_pk_bf16_f32 v68, v68, v68
    v_lshlrev_b32 v68, 16, v68
    v_mul_f32 v68, v68, v26
    v_cvt_pk_bf16_f32 v68, v68, v68
    v_lshlrev_b32 v68, 16, v68
    v_sub_f32 v69, v69, v27
    v_cvt_pk_bf16_f32 v69, v69, v69
    v_lshlrev_b32 v69, 16, v69
    v_mul_f32 v69, v69, v26
    v_cvt_pk_bf16_f32 v69, v69, v69
    v_lshlrev_b32 v69, 16, v69
    v_sub_f32 v70, v70, v27
    v_cvt_pk_bf16_f32 v70, v70, v70
    v_lshlrev_b32 v70, 16, v70
    v_mul_f32 v70, v70, v26
    v_cvt_pk_bf16_f32 v70, v70, v70
    v_lshlrev_b32 v70, 16, v70
    v_sub_f32 v71, v71, v27
    v_cvt_pk_bf16_f32 v71, v71, v71
    v_lshlrev_b32 v71, 16, v71
    v_mul_f32 v71, v71, v26
    v_cvt_pk_bf16_f32 v71, v71, v71
    v_lshlrev_b32 v71, 16, v71
    v_sub_f32 v72, v72, v27
    v_cvt_pk_bf16_f32 v72, v72, v72
    v_lshlrev_b32 v72, 16, v72
    v_mul_f32 v72, v72, v26
    v_cvt_pk_bf16_f32 v72, v72, v72
    v_lshlrev_b32 v72, 16, v72
    v_sub_f32 v73, v73, v27
    v_cvt_pk_bf16_f32 v73, v73, v73
    v_lshlrev_b32 v73, 16, v73
    v_mul_f32 v73, v73, v26
    v_cvt_pk_bf16_f32 v73, v73, v73
    v_lshlrev_b32 v73, 16, v73
    v_sub_f32 v74, v74, v27
    v_cvt_pk_bf16_f32 v74, v74, v74
    v_lshlrev_b32 v74, 16, v74
    v_mul_f32 v74, v74, v26
    v_cvt_pk_bf16_f32 v74, v74, v74
    v_lshlrev_b32 v74, 16, v74
    v_sub_f32 v75, v75, v27
    v_cvt_pk_bf16_f32 v75, v75, v75
    v_lshlrev_b32 v75, 16, v75
    v_mul_f32 v75, v75, v26
    v_cvt_pk_bf16_f32 v75, v75, v75
    v_lshlrev_b32 v75, 16, v75
    v_sub_f32 v76, v76, v27
    v_cvt_pk_bf16_f32 v76, v76, v76
    v_lshlrev_b32 v76, 16, v76
    v_mul_f32 v76, v76, v26
    v_cvt_pk_bf16_f32 v76, v76, v76
    v_lshlrev_b32 v76, 16, v76
    v_sub_f32 v77, v77, v27
    v_cvt_pk_bf16_f32 v77, v77, v77
    v_lshlrev_b32 v77, 16, v77
    v_mul_f32 v77, v77, v26
    v_cvt_pk_bf16_f32 v77, v77, v77
    v_lshlrev_b32 v77, 16, v77
    v_sub_f32 v78, v78, v27
    v_cvt_pk_bf16_f32 v78, v78, v78
    v_lshlrev_b32 v78, 16, v78
    v_mul_f32 v78, v78, v26
    v_cvt_pk_bf16_f32 v78, v78, v78
    v_lshlrev_b32 v78, 16, v78
    v_sub_f32 v79, v79, v27
    v_cvt_pk_bf16_f32 v79, v79, v79
    v_lshlrev_b32 v79, 16, v79
    v_mul_f32 v79, v79, v26
    v_cvt_pk_bf16_f32 v79, v79, v79
    v_lshlrev_b32 v79, 16, v79
    v_mul_f32 v64, v64, v112
    v_cvt_pk_bf16_f32 v64, v64, v64
    v_lshlrev_b32 v64, 16, v64
    v_add_f32 v64, v64, v96
    v_mul_f32 v65, v65, v113
    v_cvt_pk_bf16_f32 v65, v65, v65
    v_lshlrev_b32 v65, 16, v65
    v_add_f32 v65, v65, v97
    v_mul_f32 v66, v66, v114
    v_cvt_pk_bf16_f32 v66, v66, v66
    v_lshlrev_b32 v66, 16, v66
    v_add_f32 v66, v66, v98
    v_mul_f32 v67, v67, v115
    v_cvt_pk_bf16_f32 v67, v67, v67
    v_lshlrev_b32 v67, 16, v67
    v_add_f32 v67, v67, v99
    v_mul_f32 v68, v68, v116
    v_cvt_pk_bf16_f32 v68, v68, v68
    v_lshlrev_b32 v68, 16, v68
    v_add_f32 v68, v68, v100
    v_mul_f32 v69, v69, v117
    v_cvt_pk_bf16_f32 v69, v69, v69
    v_lshlrev_b32 v69, 16, v69
    v_add_f32 v69, v69, v101
    v_mul_f32 v70, v70, v118
    v_cvt_pk_bf16_f32 v70, v70, v70
    v_lshlrev_b32 v70, 16, v70
    v_add_f32 v70, v70, v102
    v_mul_f32 v71, v71, v119
    v_cvt_pk_bf16_f32 v71, v71, v71
    v_lshlrev_b32 v71, 16, v71
    v_add_f32 v71, v71, v103
    v_mul_f32 v72, v72, v120
    v_cvt_pk_bf16_f32 v72, v72, v72
    v_lshlrev_b32 v72, 16, v72
    v_add_f32 v72, v72, v104
    v_mul_f32 v73, v73, v121
    v_cvt_pk_bf16_f32 v73, v73, v73
    v_lshlrev_b32 v73, 16, v73
    v_add_f32 v73, v73, v105
    v_mul_f32 v74, v74, v122
    v_cvt_pk_bf16_f32 v74, v74, v74
    v_lshlrev_b32 v74, 16, v74
    v_add_f32 v74, v74, v106
    v_mul_f32 v75, v75, v123
    v_cvt_pk_bf16_f32 v75, v75, v75
    v_lshlrev_b32 v75, 16, v75
    v_add_f32 v75, v75, v107
    v_mul_f32 v76, v76, v124
    v_cvt_pk_bf16_f32 v76, v76, v76
    v_lshlrev_b32 v76, 16, v76
    v_add_f32 v76, v76, v108
    v_mul_f32 v77, v77, v125
    v_cvt_pk_bf16_f32 v77, v77, v77
    v_lshlrev_b32 v77, 16, v77
    v_add_f32 v77, v77, v109
    v_mul_f32 v78, v78, v126
    v_cvt_pk_bf16_f32 v78, v78, v78
    v_lshlrev_b32 v78, 16, v78
    v_add_f32 v78, v78, v110
    v_mul_f32 v79, v79, v127
    v_cvt_pk_bf16_f32 v79, v79, v79
    v_lshlrev_b32 v79, 16, v79
    v_add_f32 v79, v79, v111
    v_cvt_pk_bf16_f32 v80, v64, v65
    v_cvt_pk_bf16_f32 v81, v66, v67
    v_cvt_pk_bf16_f32 v82, v68, v69
    v_cvt_pk_bf16_f32 v83, v70, v71
    v_cvt_pk_bf16_f32 v84, v72, v73
    v_cvt_pk_bf16_f32 v85, v74, v75
    v_cvt_pk_bf16_f32 v86, v76, v77
    v_cvt_pk_bf16_f32 v87, v78, v79
    s_lshr_b32 s45, s63, 5
    s_lshl_b32 s45, s45, 16
    s_and_b32 s46, s63, 31
    s_lshl_b32 s46, s46, 8
    s_add_u32 s45, s45, s46
    s_add_u32 s45, s45, 0x400000
    s_add_u32 s46, s45, 32768
    buffer_store_dwordx4 v[80:83], v2, s[12:15], s45 offen sc1
    buffer_store_dwordx4 v[84:87], v2, s[12:15], s46 offen sc1
    s_add_u32 s63, s63, 384
L_ln_done_107:
    s_waitcnt vmcnt(0)
    s_barrier
    s_cmp_lg_u32 s44, 0
    s_cbranch_scc1 L_cnt_109
    v_mov_b32 v30, 1
    v_mov_b32 v31, 127104
    s_mov_b64 exec, 1
    buffer_atomic_add v30, v31, s[12:15], 0 offen sc1
    s_mov_b64 exec, -1
L_cnt_109:
    s_cmp_lg_u32 s44, 0
    s_cbranch_scc1 L_pd_110
    v_mov_b32 v29, 127360
    s_mov_b32 s46, 64
    s_mov_b64 exec, 1
    s_mov_b32 s70, 0
L_wp_111:
    buffer_load_dword v31, v29, s[12:15], 0 offen sc1
    s_add_u32 s70, s70, 1
    s_cmp_ge_u32 s70, 0x200000
    s_cbranch_scc1 L_w_done_98
    s_waitcnt vmcnt(0)
    v_cmp_gt_u32 vcc, s46, v31
    s_nop 1
    s_cbranch_vccz L_wp_111_ok
    s_sleep 8
    s_branch L_wp_111
L_wp_111_ok:
    s_mov_b64 exec, -1
L_pd_110:
    s_barrier
    s_add_u32 s39, s39, 96
    s_load_dwordx2 s[4:5], s[0:1], 96
    s_load_dwordx2 s[6:7], s[0:1], 104
    v_and_b32 v14, 7, v0
    v_lshrrev_b32 v15, 3, v0
    s_waitcnt lgkmcnt(0)
    s_mov_b32 s32, s4
    s_and_b32 s33, s5, 0xffff
    s_mov_b32 s34, 0x800
    s_mov_b32 s35, 0x00020000
    s_mov_b32 s24, s6
    s_and_b32 s25, s7, 0xffff
    s_mov_b32 s26, 0xc00000
    s_mov_b32 s27, 0x00020000
    s_and_b32 s47, s39, 1
    s_lshl_b32 s45, s47, 10
    v_lshlrev_b32 v16, 5, v15
    buffer_load_dwordx4 v[104:107], v16, s[32:35], s45 offen
    buffer_load_dwordx4 v[108:111], v16, s[32:35], s45 offen offset:16
    s_mov_b32 s45, 196608
    v_mul_lo_u32 v17, v15, s45
    v_lshlrev_b32 v18, 4, v14
    v_add_u32 v17, v17, v18
    s_lshr_b32 s46, s39, 1
    s_lshl_b32 s46, s46, 7
    s_mul_i32 s45, s47, 6291456
    s_add_u32 s46, s46, s45
    buffer_load_dwordx4 v[32:35], v17, s[24:27], s46 offen
    v_add_u32 v17, 12288, v17
    buffer_load_dwordx4 v[36:39], v17, s[24:27], s46 offen
    v_add_u32 v17, 12288, v17
    buffer_load_dwordx4 v[40:43], v17, s[24:27], s46 offen
    v_add_u32 v17, 12288, v17
    buffer_load_dwordx4 v[44:47], v17, s[24:27], s46 offen
    v_add_u32 v17, 12288, v17
    buffer_load_dwordx4 v[48:51], v17, s[24:27], s46 offen
    v_add_u32 v17, 12288, v17
    buffer_load_dwordx4 v[52:55], v17, s[24:27], s46 offen
    v_add_u32 v17, 12288, v17
    buffer_load_dwordx4 v[56:59], v17, s[24:27], s46 offen
    v_add_u32 v17, 12288, v17
    buffer_load_dwordx4 v[60:63], v17, s[24:27], s46 offen
    v_add_u32 v17, 12288, v17
    buffer_load_dwordx4 v[64:67], v17, s[24:27], s46 offen
    v_add_u32 v17, 12288, v17
    buffer_load_dwordx4 v[68:71], v17, s[24:27], s46 offen
    v_add_u32 v17, 12288, v17
    buffer_load_dwordx4 v[72:75], v17, s[24:27], s46 offen
    v_add_u32 v17, 12288, v17
    buffer_load_dwordx4 v[76:79], v17, s[24:27], s46 offen
    v_add_u32 v17, 12288, v17
    buffer_load_dwordx4 v[80:83], v17, s[24:27], s46 offen
    v_add_u32 v17, 12288, v17
    buffer_load_dwordx4 v[84:87], v17, s[24:27], s46 offen
    v_add_u32 v17, 12288, v17
    buffer_load_dwordx4 v[88:91], v17, s[24:27], s46 offen
    v_add_u32 v17, 12288, v17
    buffer_load_dwordx4 v[92:95], v17, s[24:27], s46 offen
    s_waitcnt vmcnt(16)
    v_lshlrev_b32 v112, 16, v104
    v_and_b32 v113, 0xffff0000, v104
    v_lshlrev_b32 v114, 16, v105
    v_and_b32 v115, 0xffff0000, v105
    v_lshlrev_b32 v116, 16, v106
    v_and_b32 v117, 0xffff0000, v106
    v_lshlrev_b32 v118, 16, v107
    v_and_b32 v119, 0xffff0000, v107
    v_lshlrev_b32 v120, 16, v108
    v_and_b32 v121, 0xffff0000, v108
    v_lshlrev_b32 v122, 16, v109
    v_and_b32 v123, 0xffff0000, v109
    v_lshlrev_b32 v124, 16, v110
    v_and_b32 v125, 0xffff0000, v110
    v_lshlrev_b32 v126, 16, v111
    v_and_b32 v127, 0xffff0000, v111
    v_mul_f32 v18, 0xbfb8aa3b, v112
    v_exp_f32 v18, v18
    s_nop 0
    v_add_f32 v18, 1.0, v18
    v_rcp_f32 v18, v18
    s_nop 0
    v_mul_f32 v112, v112, v18
    v_cvt_pk_bf16_f32 v112, v112, v112
    v_lshlrev_b32 v112, 16, v112
    v_mul_f32 v18, 0xbfb8aa3b, v113
    v_exp_f32 v18, v18
    s_nop 0
    v_add_f32 v18, 1.0, v18
    v_rcp_f32 v18, v18
    s_nop 0
    v_mul_f32 v113, v113, v18
    v_cvt_pk_bf16_f32 v113, v113, v113
    v_lshlrev_b32 v113, 16, v113
    v_mul_f32 v18, 0xbfb8aa3b, v114
    v_exp_f32 v18, v18
    s_nop 0
    v_add_f32 v18, 1.0, v18
    v_rcp_f32 v18, v18
    s_nop 0
    v_mul_f32 v114, v114, v18
    v_cvt_pk_bf16_f32 v114, v114, v114
    v_lshlrev_b32 v114, 16, v114
    v_mul_f32 v18, 0xbfb8aa3b, v115
    v_exp_f32 v18, v18
    s_nop 0
    v_add_f32 v18, 1.0, v18
    v_rcp_f32 v18, v18
    s_nop 0
    v_mul_f32 v115, v115, v18
    v_cvt_pk_bf16_f32 v115, v115, v115
    v_lshlrev_b32 v115, 16, v115
    v_mul_f32 v18, 0xbfb8aa3b, v116
    v_exp_f32 v18, v18
    s_nop 0
    v_add_f32 v18, 1.0, v18
    v_rcp_f32 v18, v18
    s_nop 0
    v_mul_f32 v116, v116, v18
    v_cvt_pk_bf16_f32 v116, v116, v116
    v_lshlrev_b32 v116, 16, v116
    v_mul_f32 v18, 0xbfb8aa3b, v117
    v_exp_f32 v18, v18
    s_nop 0
    v_add_f32 v18, 1.0, v18
    v_rcp_f32 v18, v18
    s_nop 0
    v_mul_f32 v117, v117, v18
    v_cvt_pk_bf16_f32 v117, v117, v117
    v_lshlrev_b32 v117, 16, v117
    v_mul_f32 v18, 0xbfb8aa3b, v118
    v_exp_f32 v18, v18
    s_nop 0
    v_add_f32 v18, 1.0, v18
    v_rcp_f32 v18, v18
    s_nop 0
    v_mul_f32 v118, v118, v18
    v_cvt_pk_bf16_f32 v118, v118, v118
    v_lshlrev_b32 v118, 16, v118
    v_mul_f32 v18, 0xbfb8aa3b, v119
    v_exp_f32 v18, v18
    s_nop 0
    v_add_f32 v18, 1.0, v18
    v_rcp_f32 v18, v18
    s_nop 0
    v_mul_f32 v119, v119, v18
    v_cvt_pk_bf16_f32 v119, v119, v119
    v_lshlrev_b32 v119, 16, v119
    v_mul_f32 v18, 0xbfb8aa3b, v120
    v_exp_f32 v18, v18
    s_nop 0
    v_add_f32 v18, 1.0, v18
    v_rcp_f32 v18, v18
    s_nop 0
    v_mul_f32 v120, v120, v18
    v_cvt_pk_bf16_f32 v120, v120, v120
    v_lshlrev_b32 v120, 16, v120
    v_mul_f32 v18, 0xbfb8aa3b, v121
    v_exp_f32 v18, v18
    s_nop 0
    v_add_f32 v18, 1.0, v18
    v_rcp_f32 v18, v18
    s_nop 0
    v_mul_f32 v121, v121, v18
    v_cvt_pk_bf16_f32 v121, v121, v121
    v_lshlrev_b32 v121, 16, v121
    v_mul_f32 v18, 0xbfb8aa3b, v122
    v_exp_f32 v18, v18
    s_nop 0
    v_add_f32 v18, 1.0, v18
    v_rcp_f32 v18, v18
    s_nop 0
    v_mul_f32 v122, v122, v18
    v_cvt_pk_bf16_f32 v122, v122, v122
    v_lshlrev_b32 v122, 16, v122
    v_mul_f32 v18, 0xbfb8aa3b, v123
    v_exp_f32 v18, v18
    s_nop 0
    v_add_f32 v18, 1.0, v18
    v_rcp_f32 v18, v18
    s_nop 0
    v_mul_f32 v123, v123, v18
    v_cvt_pk_bf16_f32 v123, v123, v123
    v_lshlrev_b32 v123, 16, v123
    v_mul_f32 v18, 0xbfb8aa3b, v124
    v_exp_f32 v18, v18
    s_nop 0
    v_add_f32 v18, 1.0, v18
    v_rcp_f32 v18, v18
    s_nop 0
    v_mul_f32 v124, v124, v18
    v_cvt_pk_bf16_f32 v124, v124, v124
    v_lshlrev_b32 v124, 16, v124
    v_mul_f32 v18, 0xbfb8aa3b, v125
    v_exp_f32 v18, v18
    s_nop 0
    v_add_f32 v18, 1.0, v18
    v_rcp_f32 v18, v18
    s_nop 0
    v_mul_f32 v125, v125, v18
    v_cvt_pk_bf16_f32 v125, v125, v125
    v_lshlrev_b32 v125, 16, v125
    v_mul_f32 v18, 0xbfb8aa3b, v126
    v_exp_f32 v18, v18
    s_nop 0
    v_add_f32 v18, 1.0, v18
    v_rcp_f32 v18, v18
    s_nop 0
    v_mul_f32 v126, v126, v18
    v_cvt_pk_bf16_f32 v126, v126, v126
    v_lshlrev_b32 v126, 16, v126
    v_mul_f32 v18, 0xbfb8aa3b, v127
    v_exp_f32 v18, v18
    s_nop 0
    v_add_f32 v18, 1.0, v18
    v_rcp_f32 v18, v18
    s_nop 0
    v_mul_f32 v127, v127, v18
    v_cvt_pk_bf16_f32 v127, v127, v127
    v_lshlrev_b32 v127, 16, v127
    v_mov_b32 v96, 0
    v_mov_b32 v97, 0
    v_mov_b32 v98, 0
    v_mov_b32 v99, 0
    v_mov_b32 v100, 0
    v_mov_b32 v101, 0
    v_mov_b32 v102, 0
    v_mov_b32 v103, 0
    s_waitcnt vmcnt(15)
    v_lshlrev_b32 v18, 16, v32
    v_and_b32 v19, 0xffff0000, v32
    v_fmac_f32 v96, v18, v112
    v_fmac_f32 v97, v19, v112
    v_lshlrev_b32 v18, 16, v33
    v_and_b32 v19, 0xffff0000, v33
    v_fmac_f32 v98, v18, v112
    v_fmac_f32 v99, v19, v112
    v_lshlrev_b32 v18, 16, v34
    v_and_b32 v19, 0xffff0000, v34
    v_fmac_f32 v100, v18, v112
    v_fmac_f32 v101, v19, v112
    v_lshlrev_b32 v18, 16, v35
    v_and_b32 v19, 0xffff0000, v35
    v_fmac_f32 v102, v18, v112
    v_fmac_f32 v103, v19, v112
    s_waitcnt vmcnt(14)
    v_lshlrev_b32 v18, 16, v36
    v_and_b32 v19, 0xffff0000, v36
    v_fmac_f32 v96, v18, v113
    v_fmac_f32 v97, v19, v113
    v_lshlrev_b32 v18, 16, v37
    v_and_b32 v19, 0xffff0000, v37
    v_fmac_f32 v98, v18, v113
    v_fmac_f32 v99, v19, v113
    v_lshlrev_b32 v18, 16, v38
    v_and_b32 v19, 0xffff0000, v38
    v_fmac_f32 v100, v18, v113
    v_fmac_f32 v101, v19, v113
    v_lshlrev_b32 v18, 16, v39
    v_and_b32 v19, 0xffff0000, v39
    v_fmac_f32 v102, v18, v113
    v_fmac_f32 v103, v19, v113
    s_waitcnt vmcnt(13)
    v_lshlrev_b32 v18, 16, v40
    v_and_b32 v19, 0xffff0000, v40
    v_fmac_f32 v96, v18, v114
    v_fmac_f32 v97, v19, v114
    v_lshlrev_b32 v18, 16, v41
    v_and_b32 v19, 0xffff0000, v41
    v_fmac_f32 v98, v18, v114
    v_fmac_f32 v99, v19, v114
    v_lshlrev_b32 v18, 16, v42
    v_and_b32 v19, 0xffff0000, v42
    v_fmac_f32 v100, v18, v114
    v_fmac_f32 v101, v19, v114
    v_lshlrev_b32 v18, 16, v43
    v_and_b32 v19, 0xffff0000, v43
    v_fmac_f32 v102, v18, v114
    v_fmac_f32 v103, v19, v114
    s_waitcnt vmcnt(12)
    v_lshlrev_b32 v18, 16, v44
    v_and_b32 v19, 0xffff0000, v44
    v_fmac_f32 v96, v18, v115
    v_fmac_f32 v97, v19, v115
    v_lshlrev_b32 v18, 16, v45
    v_and_b32 v19, 0xffff0000, v45
    v_fmac_f32 v98, v18, v115
    v_fmac_f32 v99, v19, v115
    v_lshlrev_b32 v18, 16, v46
    v_and_b32 v19, 0xffff0000, v46
    v_fmac_f32 v100, v18, v115
    v_fmac_f32 v101, v19, v115
    v_lshlrev_b32 v18, 16, v47
    v_and_b32 v19, 0xffff0000, v47
    v_fmac_f32 v102, v18, v115
    v_fmac_f32 v103, v19, v115
    s_waitcnt vmcnt(11)
    v_lshlrev_b32 v18, 16, v48
    v_and_b32 v19, 0xffff0000, v48
    v_fmac_f32 v96, v18, v116
    v_fmac_f32 v97, v19, v116
    v_lshlrev_b32 v18, 16, v49
    v_and_b32 v19, 0xffff0000, v49
    v_fmac_f32 v98, v18, v116
    v_fmac_f32 v99, v19, v116
    v_lshlrev_b32 v18, 16, v50
    v_and_b32 v19, 0xffff0000, v50
    v_fmac_f32 v100, v18, v116
    v_fmac_f32 v101, v19, v116
    v_lshlrev_b32 v18, 16, v51
    v_and_b32 v19, 0xffff0000, v51
    v_fmac_f32 v102, v18, v116
    v_fmac_f32 v103, v19, v116
    s_waitcnt vmcnt(10)
    v_lshlrev_b32 v18, 16, v52
    v_and_b32 v19, 0xffff0000, v52
    v_fmac_f32 v96, v18, v117
    v_fmac_f32 v97, v19, v117
    v_lshlrev_b32 v18, 16, v53
    v_and_b32 v19, 0xffff0000, v53
    v_fmac_f32 v98, v18, v117
    v_fmac_f32 v99, v19, v117
    v_lshlrev_b32 v18, 16, v54
    v_and_b32 v19, 0xffff0000, v54
    v_fmac_f32 v100, v18, v117
    v_fmac_f32 v101, v19, v117
    v_lshlrev_b32 v18, 16, v55
    v_and_b32 v19, 0xffff0000, v55
    v_fmac_f32 v102, v18, v117
    v_fmac_f32 v103, v19, v117
    s_waitcnt vmcnt(9)
    v_lshlrev_b32 v18, 16, v56
    v_and_b32 v19, 0xffff0000, v56
    v_fmac_f32 v96, v18, v118
    v_fmac_f32 v97, v19, v118
    v_lshlrev_b32 v18, 16, v57
    v_and_b32 v19, 0xffff0000, v57
    v_fmac_f32 v98, v18, v118
    v_fmac_f32 v99, v19, v118
    v_lshlrev_b32 v18, 16, v58
    v_and_b32 v19, 0xffff0000, v58
    v_fmac_f32 v100, v18, v118
    v_fmac_f32 v101, v19, v118
    v_lshlrev_b32 v18, 16, v59
    v_and_b32 v19, 0xffff0000, v59
    v_fmac_f32 v102, v18, v118
    v_fmac_f32 v103, v19, v118
    s_waitcnt vmcnt(8)
    v_lshlrev_b32 v18, 16, v60
    v_and_b32 v19, 0xffff0000, v60
    v_fmac_f32 v96, v18, v119
    v_fmac_f32 v97, v19, v119
    v_lshlrev_b32 v18, 16, v61
    v_and_b32 v19, 0xffff0000, v61
    v_fmac_f32 v98, v18, v119
    v_fmac_f32 v99, v19, v119
    v_lshlrev_b32 v18, 16, v62
    v_and_b32 v19, 0xffff0000, v62
    v_fmac_f32 v100, v18, v119
    v_fmac_f32 v101, v19, v119
    v_lshlrev_b32 v18, 16, v63
    v_and_b32 v19, 0xffff0000, v63
    v_fmac_f32 v102, v18, v119
    v_fmac_f32 v103, v19, v119
    s_waitcnt vmcnt(7)
    v_lshlrev_b32 v18, 16, v64
    v_and_b32 v19, 0xffff0000, v64
    v_fmac_f32 v96, v18, v120
    v_fmac_f32 v97, v19, v120
    v_lshlrev_b32 v18, 16, v65
    v_and_b32 v19, 0xffff0000, v65
    v_fmac_f32 v98, v18, v120
    v_fmac_f32 v99, v19, v120
    v_lshlrev_b32 v18, 16, v66
    v_and_b32 v19, 0xffff0000, v66
    v_fmac_f32 v100, v18, v120
    v_fmac_f32 v101, v19, v120
    v_lshlrev_b32 v18, 16, v67
    v_and_b32 v19, 0xffff0000, v67
    v_fmac_f32 v102, v18, v120
    v_fmac_f32 v103, v19, v120
    s_waitcnt vmcnt(6)
    v_lshlrev_b32 v18, 16, v68
    v_and_b32 v19, 0xffff0000, v68
    v_fmac_f32 v96, v18, v121
    v_fmac_f32 v97, v19, v121
    v_lshlrev_b32 v18, 16, v69
    v_and_b32 v19, 0xffff0000, v69
    v_fmac_f32 v98, v18, v121
    v_fmac_f32 v99, v19, v121
    v_lshlrev_b32 v18, 16, v70
    v_and_b32 v19, 0xffff0000, v70
    v_fmac_f32 v100, v18, v121
    v_fmac_f32 v101, v19, v121
    v_lshlrev_b32 v18, 16, v71
    v_and_b32 v19, 0xffff0000, v71
    v_fmac_f32 v102, v18, v121
    v_fmac_f32 v103, v19, v121
    s_waitcnt vmcnt(5)
    v_lshlrev_b32 v18, 16, v72
    v_and_b32 v19, 0xffff0000, v72
    v_fmac_f32 v96, v18, v122
    v_fmac_f32 v97, v19, v122
    v_lshlrev_b32 v18, 16, v73
    v_and_b32 v19, 0xffff0000, v73
    v_fmac_f32 v98, v18, v122
    v_fmac_f32 v99, v19, v122
    v_lshlrev_b32 v18, 16, v74
    v_and_b32 v19, 0xffff0000, v74
    v_fmac_f32 v100, v18, v122
    v_fmac_f32 v101, v19, v122
    v_lshlrev_b32 v18, 16, v75
    v_and_b32 v19, 0xffff0000, v75
    v_fmac_f32 v102, v18, v122
    v_fmac_f32 v103, v19, v122
    s_waitcnt vmcnt(4)
    v_lshlrev_b32 v18, 16, v76
    v_and_b32 v19, 0xffff0000, v76
    v_fmac_f32 v96, v18, v123
    v_fmac_f32 v97, v19, v123
    v_lshlrev_b32 v18, 16, v77
    v_and_b32 v19, 0xffff0000, v77
    v_fmac_f32 v98, v18, v123
    v_fmac_f32 v99, v19, v123
    v_lshlrev_b32 v18, 16, v78
    v_and_b32 v19, 0xffff0000, v78
    v_fmac_f32 v100, v18, v123
    v_fmac_f32 v101, v19, v123
    v_lshlrev_b32 v18, 16, v79
    v_and_b32 v19, 0xffff0000, v79
    v_fmac_f32 v102, v18, v123
    v_fmac_f32 v103, v19, v123
    s_waitcnt vmcnt(3)
    v_lshlrev_b32 v18, 16, v80
    v_and_b32 v19, 0xffff0000, v80
    v_fmac_f32 v96, v18, v124
    v_fmac_f32 v97, v19, v124
    v_lshlrev_b32 v18, 16, v81
    v_and_b32 v19, 0xffff0000, v81
    v_fmac_f32 v98, v18, v124
    v_fmac_f32 v99, v19, v124
    v_lshlrev_b32 v18, 16, v82
    v_and_b32 v19, 0xffff0000, v82
    v_fmac_f32 v100, v18, v124
    v_fmac_f32 v101, v19, v124
    v_lshlrev_b32 v18, 16, v83
    v_and_b32 v19, 0xffff0000, v83
    v_fmac_f32 v102, v18, v124
    v_fmac_f32 v103, v19, v124
    s_waitcnt vmcnt(2)
    v_lshlrev_b32 v18, 16, v84
    v_and_b32 v19, 0xffff0000, v84
    v_fmac_f32 v96, v18, v125
    v_fmac_f32 v97, v19, v125
    v_lshlrev_b32 v18, 16, v85
    v_and_b32 v19, 0xffff0000, v85
    v_fmac_f32 v98, v18, v125
    v_fmac_f32 v99, v19, v125
    v_lshlrev_b32 v18, 16, v86
    v_and_b32 v19, 0xffff0000, v86
    v_fmac_f32 v100, v18, v125
    v_fmac_f32 v101, v19, v125
    v_lshlrev_b32 v18, 16, v87
    v_and_b32 v19, 0xffff0000, v87
    v_fmac_f32 v102, v18, v125
    v_fmac_f32 v103, v19, v125
    s_waitcnt vmcnt(1)
    v_lshlrev_b32 v18, 16, v88
    v_and_b32 v19, 0xffff0000, v88
    v_fmac_f32 v96, v18, v126
    v_fmac_f32 v97, v19, v126
    v_lshlrev_b32 v18, 16, v89
    v_and_b32 v19, 0xffff0000, v89
    v_fmac_f32 v98, v18, v126
    v_fmac_f32 v99, v19, v126
    v_lshlrev_b32 v18, 16, v90
    v_and_b32 v19, 0xffff0000, v90
    v_fmac_f32 v100, v18, v126
    v_fmac_f32 v101, v19, v126
    v_lshlrev_b32 v18, 16, v91
    v_and_b32 v19, 0xffff0000, v91
    v_fmac_f32 v102, v18, v126
    v_fmac_f32 v103, v19, v126
    s_waitcnt vmcnt(0)
    v_lshlrev_b32 v18, 16, v92
    v_and_b32 v19, 0xffff0000, v92
    v_fmac_f32 v96, v18, v127
    v_fmac_f32 v97, v19, v127
    v_lshlrev_b32 v18, 16, v93
    v_and_b32 v19, 0xffff0000, v93
    v_fmac_f32 v98, v18, v127
    v_fmac_f32 v99, v19, v127
    v_lshlrev_b32 v18, 16, v94
    v_and_b32 v19, 0xffff0000, v94
    v_fmac_f32 v100, v18, v127
    v_fmac_f32 v101, v19, v127
    v_lshlrev_b32 v18, 16, v95
    v_and_b32 v19, 0xffff0000, v95
    v_fmac_f32 v102, v18, v127
    v_fmac_f32 v103, v19, v127
    v_lshlrev_b32 v16, 5, v0
    ds_write_b128 v16, v[96:99]
    ds_write_b128 v16, v[100:103] offset:16
    s_waitcnt lgkmcnt(0)
    s_barrier
    s_cmp_lg_u32 s44, 0
    s_cbranch_scc1 L_mod_fin_112
    v_mov_b32 v18, 0
    ds_read_b32 v32, v12 offset:0
    ds_read_b32 v33, v12 offset:256
    ds_read_b32 v34, v12 offset:512
    ds_read_b32 v35, v12 offset:768
    ds_read_b32 v36, v12 offset:1024
    ds_read_b32 v37, v12 offset:1280
    ds_read_b32 v38, v12 offset:1536
    ds_read_b32 v39, v12 offset:1792
    ds_read_b32 v40, v12 offset:2048
    ds_read_b32 v41, v12 offset:2304
    ds_read_b32 v42, v12 offset:2560
    ds_read_b32 v43, v12 offset:2816
    ds_read_b32 v44, v12 offset:3072
    ds_read_b32 v45, v12 offset:3328
    ds_read_b32 v46, v12 offset:3584
    ds_read_b32 v47, v12 offset:3840
    s_waitcnt lgkmcnt(0)
    v_add_f32 v18, v18, v32
    v_add_f32 v18, v18, v33
    v_add_f32 v18, v18, v34
    v_add_f32 v18, v18, v35
    v_add_f32 v18, v18, v36
    v_add_f32 v18, v18, v37
    v_add_f32 v18, v18, v38
    v_add_f32 v18, v18, v39
    v_add_f32 v18, v18, v40
    v_add_f32 v18, v18, v41
    v_add_f32 v18, v18, v42
    v_add_f32 v18, v18, v43
    v_add_f32 v18, v18, v44
    v_add_f32 v18, v18, v45
    v_add_f32 v18, v18, v46
    v_add_f32 v18, v18, v47
    ds_read_b32 v32, v12 offset:4096
    ds_read_b32 v33, v12 offset:4352
    ds_read_b32 v34, v12 offset:4608
    ds_read_b32 v35, v12 offset:4864
    ds_read_b32 v36, v12 offset:5120
    ds_read_b32 v37, v12 offset:5376
    ds_read_b32 v38, v12 offset:5632
    ds_read_b32 v39, v12 offset:5888
    ds_read_b32 v40, v12 offset:6144
    ds_read_b32 v41, v12 offset:6400
    ds_read_b32 v42, v12 offset:6656
    ds_read_b32 v43, v12 offset:6912
    ds_read_b32 v44, v12 offset:7168
    ds_read_b32 v45, v12 offset:7424
    ds_read_b32 v46, v12 offset:7680
    ds_read_b32 v47, v12 offset:7936
    s_waitcnt lgkmcnt(0)
    v_add_f32 v18, v18, v32
    v_add_f32 v18, v18, v33
    v_add_f32 v18, v18, v34
    v_add_f32 v18, v18, v35
    v_add_f32 v18, v18, v36
    v_add_f32 v18, v18, v37
    v_add_f32 v18, v18, v38
    v_add_f32 v18, v18, v39
    v_add_f32 v18, v18, v40
    v_add_f32 v18, v18, v41
    v_add_f32 v18, v18, v42
    v_add_f32 v18, v18, v43
    v_add_f32 v18, v18, v44
    v_add_f32 v18, v18, v45
    v_add_f32 v18, v18, v46
    v_add_f32 v18, v18, v47
    s_lshr_b32 s45, s39, 1
    s_lshl_b32 s45, s45, 8
    s_mul_i32 s46, s47, 24576
    s_add_u32 s45, s45, s46
    buffer_store_dword v18, v12, s[12:15], s45 offen sc1
L_mod_fin_112:
    s_waitcnt vmcnt(0)
    s_barrier
    s_cmp_lg_u32 s44, 0
    s_cbranch_scc1 L_cnt_113
    v_mov_b32 v30, 1
    v_mov_b32 v31, 127232
    s_mov_b64 exec, 1
    buffer_atomic_add v30, v31, s[12:15], 0 offen sc1
    s_mov_b64 exec, -1
L_cnt_113:
    s_branch L_w_roles_100
L_w_kv_99:
    s_lshl_b32 s45, s43, 3
    s_add_u32 s45, s45, 16
    s_load_dwordx2 s[6:7], s[0:1], s45
    s_waitcnt lgkmcnt(0)
    s_mov_b32 s24, s6
    s_and_b32 s25, s7, 0xffff
    s_mov_b32 s26, 0x800000
    s_mov_b32 s27, 0x00020000
    s_lshl_b32 s46, s41, 8
    s_barrier
    v_lshrrev_b32 v20, 4, v1
    s_lshl_b32 s45, s44, 2
    v_add_u32 v21, s45, v20
    s_mov_b32 s45, 8192
    v_mul_lo_u32 v21, v21, s45
    v_lshlrev_b32 v22, 2, v20
    v_and_b32 v23, 15, v1
    v_xor_b32 v22, v22, v23
    v_lshlrev_b32 v22, 4, v22
    v_add_u32 v21, v21, v22
    v_bfe_u32 v22, v1, 2, 2
    v_lshlrev_b32 v23, 3, v20
    v_add_u32 v23, v23, v22
    v_lshlrev_b32 v23, 8, v23
    v_xor_b32 v22, s44, v22
    v_lshlrev_b32 v22, 6, v22
    v_add_u32 v23, v23, v22
    v_and_b32 v22, 3, v1
    v_lshlrev_b32 v22, 4, v22
    v_add_u32 v23, v23, v22
    v_add_u32 v24, 65536, v23
    v_add_u32 v25, 131072, v23
    s_lshl_b32 s47, s44, 10
    s_add_u32 s45, s46, 0x0
    s_add_u32 m0, s47, 0
    s_nop 0
    buffer_load_dwordx4 v21, s[24:27], s45 offen  lds
    s_add_u32 s45, s46, 0x20000
    s_add_u32 m0, s47, 4096
    s_nop 0
    buffer_load_dwordx4 v21, s[24:27], s45 offen  lds
    s_add_u32 s45, s46, 0x40000
    s_add_u32 m0, s47, 8192
    s_nop 0
    buffer_load_dwordx4 v21, s[24:27], s45 offen  lds
    s_add_u32 s45, s46, 0x60000
    s_add_u32 m0, s47, 12288
    s_nop 0
    buffer_load_dwordx4 v21, s[24:27], s45 offen  lds
    s_add_u32 s45, s46, 0x80000
    s_add_u32 m0, s47, 16384
    s_nop 0
    buffer_load_dwordx4 v21, s[24:27], s45 offen  lds
    s_add_u32 s45, s46, 0xa0000
    s_add_u32 m0, s47, 20480
    s_nop 0
    buffer_load_dwordx4 v21, s[24:27], s45 offen  lds
    s_add_u32 s45, s46, 0xc0000
    s_add_u32 m0, s47, 24576
    s_nop 0
    buffer_load_dwordx4 v21, s[24:27], s45 offen  lds
    s_add_u32 s45, s46, 0xe0000
    s_add_u32 m0, s47, 28672
    s_nop 0
    buffer_load_dwordx4 v21, s[24:27], s45 offen  lds
    s_add_u32 s45, s46, 0x100000
    s_add_u32 m0, s47, 32768
    s_nop 0
    buffer_load_dwordx4 v21, s[24:27], s45 offen  lds
    s_add_u32 s45, s46, 0x120000
    s_add_u32 m0, s47, 36864
    s_nop 0
    buffer_load_dwordx4 v21, s[24:27], s45 offen  lds
    s_add_u32 s45, s46, 0x140000
    s_add_u32 m0, s47, 40960
    s_nop 0
    buffer_load_dwordx4 v21, s[24:27], s45 offen  lds
    s_add_u32 s45, s46, 0x160000
    s_add_u32 m0, s47, 45056
    s_nop 0
    buffer_load_dwordx4 v21, s[24:27], s45 offen  lds
    s_add_u32 s45, s46, 0x180000
    s_add_u32 m0, s47, 49152
    s_nop 0
    buffer_load_dwordx4 v21, s[24:27], s45 offen  lds
    s_add_u32 s45, s46, 0x1a0000
    s_add_u32 m0, s47, 53248
    s_nop 0
    buffer_load_dwordx4 v21, s[24:27], s45 offen  lds
    s_add_u32 s45, s46, 0x1c0000
    s_add_u32 m0, s47, 57344
    s_nop 0
    buffer_load_dwordx4 v21, s[24:27], s45 offen  lds
    s_add_u32 s45, s46, 0x1e0000
    s_add_u32 m0, s47, 61440
    s_nop 0
    buffer_load_dwordx4 v21, s[24:27], s45 offen  lds
    s_add_u32 s45, s46, 0x200000
    s_add_u32 m0, s47, 65536
    s_nop 0
    buffer_load_dwordx4 v21, s[24:27], s45 offen  lds
    s_add_u32 s45, s46, 0x220000
    s_add_u32 m0, s47, 69632
    s_nop 0
    buffer_load_dwordx4 v21, s[24:27], s45 offen  lds
    s_add_u32 s45, s46, 0x240000
    s_add_u32 m0, s47, 73728
    s_nop 0
    buffer_load_dwordx4 v21, s[24:27], s45 offen  lds
    s_add_u32 s45, s46, 0x260000
    s_add_u32 m0, s47, 77824
    s_nop 0
    buffer_load_dwordx4 v21, s[24:27], s45 offen  lds
    s_add_u32 s45, s46, 0x280000
    s_add_u32 m0, s47, 81920
    s_nop 0
    buffer_load_dwordx4 v21, s[24:27], s45 offen  lds
    s_add_u32 s45, s46, 0x2a0000
    s_add_u32 m0, s47, 86016
    s_nop 0
    buffer_load_dwordx4 v21, s[24:27], s45 offen  lds
    s_add_u32 s45, s46, 0x2c0000
    s_add_u32 m0, s47, 90112
    s_nop 0
    buffer_load_dwordx4 v21, s[24:27], s45 offen  lds
    s_add_u32 s45, s46, 0x2e0000
    s_add_u32 m0, s47, 94208
    s_nop 0
    buffer_load_dwordx4 v21, s[24:27], s45 offen  lds
    s_add_u32 s45, s46, 0x300000
    s_add_u32 m0, s47, 98304
    s_nop 0
    buffer_load_dwordx4 v21, s[24:27], s45 offen  lds
    s_add_u32 s45, s46, 0x320000
    s_add_u32 m0, s47, 102400
    s_nop 0
    buffer_load_dwordx4 v21, s[24:27], s45 offen  lds
    s_add_u32 s45, s46, 0x340000
    s_add_u32 m0, s47, 106496
    s_nop 0
    buffer_load_dwordx4 v21, s[24:27], s45 offen  lds
    s_add_u32 s45, s46, 0x360000
    s_add_u32 m0, s47, 110592
    s_nop 0
    buffer_load_dwordx4 v21, s[24:27], s45 offen  lds
    s_add_u32 s45, s46, 0x380000
    s_add_u32 m0, s47, 114688
    s_nop 0
    buffer_load_dwordx4 v21, s[24:27], s45 offen  lds
    s_add_u32 s45, s46, 0x3a0000
    s_add_u32 m0, s47, 118784
    s_nop 0
    buffer_load_dwordx4 v21, s[24:27], s45 offen  lds
    s_add_u32 s45, s46, 0x3c0000
    s_add_u32 m0, s47, 122880
    s_nop 0
    buffer_load_dwordx4 v21, s[24:27], s45 offen  lds
    s_add_u32 s45, s46, 0x3e0000
    s_add_u32 m0, s47, 126976
    s_nop 0
    buffer_load_dwordx4 v21, s[24:27], s45 offen  lds
    s_waitcnt vmcnt(28)
    s_barrier
    s_add_u32 s45, s46, 0x400000
    s_add_u32 m0, s47, 131072
    s_nop 0
    buffer_load_dwordx4 v21, s[24:27], s45 offen  lds
    s_add_u32 s45, s46, 0x420000
    s_add_u32 m0, s47, 135168
    s_nop 0
    buffer_load_dwordx4 v21, s[24:27], s45 offen  lds
    s_add_u32 s45, s46, 0x440000
    s_add_u32 m0, s47, 139264
    s_nop 0
    buffer_load_dwordx4 v21, s[24:27], s45 offen  lds
    s_add_u32 s45, s46, 0x460000
    s_add_u32 m0, s47, 143360
    s_nop 0
    buffer_load_dwordx4 v21, s[24:27], s45 offen  lds
    ds_read_b64_tr_b16 a[0:1], v23 offset:0
    ds_read_b64_tr_b16 a[2:3], v23 offset:1024
    ds_read_b64_tr_b16 a[4:5], v23 offset:8
    ds_read_b64_tr_b16 a[6:7], v23 offset:1032
    ds_read_b64_tr_b16 a[8:9], v23 offset:8192
    ds_read_b64_tr_b16 a[10:11], v23 offset:9216
    ds_read_b64_tr_b16 a[12:13], v23 offset:8200
    ds_read_b64_tr_b16 a[14:15], v23 offset:9224
    s_waitcnt lgkmcnt(0)
    s_waitcnt vmcnt(28)
    s_barrier
    s_add_u32 s45, s46, 0x480000
    s_add_u32 m0, s47, 0
    s_nop 0
    buffer_load_dwordx4 v21, s[24:27], s45 offen  lds
    s_add_u32 s45, s46, 0x4a0000
    s_add_u32 m0, s47, 4096
    s_nop 0
    buffer_load_dwordx4 v21, s[24:27], s45 offen  lds
    s_add_u32 s45, s46, 0x4c0000
    s_add_u32 m0, s47, 8192
    s_nop 0
    buffer_load_dwordx4 v21, s[24:27], s45 offen  lds
    s_add_u32 s45, s46, 0x4e0000
    s_add_u32 m0, s47, 12288
    s_nop 0
    buffer_load_dwordx4 v21, s[24:27], s45 offen  lds
    ds_read_b64_tr_b16 a[16:17], v23 offset:16384
    ds_read_b64_tr_b16 a[18:19], v23 offset:17408
    ds_read_b64_tr_b16 a[20:21], v23 offset:16392
    ds_read_b64_tr_b16 a[22:23], v23 offset:17416
    ds_read_b64_tr_b16 a[24:25], v23 offset:24576
    ds_read_b64_tr_b16 a[26:27], v23 offset:25600
    ds_read_b64_tr_b16 a[28:29], v23 offset:24584
    ds_read_b64_tr_b16 a[30:31], v23 offset:25608
    s_waitcnt lgkmcnt(0)
    s_waitcnt vmcnt(28)
    s_barrier
    s_add_u32 s45, s46, 0x500000
    s_add_u32 m0, s47, 16384
    s_nop 0
    buffer_load_dwordx4 v21, s[24:27], s45 offen  lds
    s_add_u32 s45, s46, 0x520000
    s_add_u32 m0, s47, 20480
    s_nop 0
    buffer_load_dwordx4 v21, s[24:27], s45 offen  lds
    s_add_u32 s45, s46, 0x540000
    s_add_u32 m0, s47, 24576
    s_nop 0
    buffer_load_dwordx4 v21, s[24:27], s45 offen  lds
    s_add_u32 s45, s46, 0x560000
    s_add_u32 m0, s47, 28672
    s_nop 0
    buffer_load_dwordx4 v21, s[24:27], s45 offen  lds
    ds_read_b64_tr_b16 a[32:33], v23 offset:32768
    ds_read_b64_tr_b16 a[34:35], v23 offset:33792
    ds_read_b64_tr_b16 a[36:37], v23 offset:32776
    ds_read_b64_tr_b16 a[38:39], v23 offset:33800
    ds_read_b64_tr_b16 a[40:41], v23 offset:40960
    ds_read_b64_tr_b16 a[42:43], v23 offset:41984
    ds_read_b64_tr_b16 a[44:45], v23 offset:40968
    ds_read_b64_tr_b16 a[46:47], v23 offset:41992
    s_waitcnt lgkmcnt(0)
    s_waitcnt vmcnt(28)
    s_barrier
    s_add_u32 s45, s46, 0x580000
    s_add_u32 m0, s47, 32768
    s_nop 0
    buffer_load_dwordx4 v21, s[24:27], s45 offen  lds
    s_add_u32 s45, s46, 0x5a0000
    s_add_u32 m0, s47, 36864
    s_nop 0
    buffer_load_dwordx4 v21, s[24:27], s45 offen  lds
    s_add_u32 s45, s46, 0x5c0000
    s_add_u32 m0, s47, 40960
    s_nop 0
    buffer_load_dwordx4 v21, s[24:27], s45 offen  lds
    s_add_u32 s45, s46, 0x5e0000
    s_add_u32 m0, s47, 45056
    s_nop 0
    buffer_load_dwordx4 v21, s[24:27], s45 offen  lds
    ds_read_b64_tr_b16 a[48:49], v23 offset:49152
    ds_read_b64_tr_b16 a[50:51], v23 offset:50176
    ds_read_b64_tr_b16 a[52:53], v23 offset:49160
    ds_read_b64_tr_b16 a[54:55], v23 offset:50184
    ds_read_b64_tr_b16 a[56:57], v23 offset:57344
    ds_read_b64_tr_b16 a[58:59], v23 offset:58368
    ds_read_b64_tr_b16 a[60:61], v23 offset:57352
    ds_read_b64_tr_b16 a[62:63], v23 offset:58376
    s_waitcnt lgkmcnt(0)
    s_waitcnt vmcnt(28)
    s_barrier
    s_add_u32 s45, s46, 0x600000
    s_add_u32 m0, s47, 49152
    s_nop 0
    buffer_load_dwordx4 v21, s[24:27], s45 offen  lds
    s_add_u32 s45, s46, 0x620000
    s_add_u32 m0, s47, 53248
    s_nop 0
    buffer_load_dwordx4 v21, s[24:27], s45 offen  lds
    s_add_u32 s45, s46, 0x640000
    s_add_u32 m0, s47, 57344
    s_nop 0
    buffer_load_dwordx4 v21, s[24:27], s45 offen  lds
    s_add_u32 s45, s46, 0x660000
    s_add_u32 m0, s47, 61440
    s_nop 0
    buffer_load_dwordx4 v21, s[24:27], s45 offen  lds
    ds_read_b64_tr_b16 a[64:65], v24 offset:0
    ds_read_b64_tr_b16 a[66:67], v24 offset:1024
    ds_read_b64_tr_b16 a[68:69], v24 offset:8
    ds_read_b64_tr_b16 a[70:71], v24 offset:1032
    ds_read_b64_tr_b16 a[72:73], v24 offset:8192
    ds_read_b64_tr_b16 a[74:75], v24 offset:9216
    ds_read_b64_tr_b16 a[76:77], v24 offset:8200
    ds_read_b64_tr_b16 a[78:79], v24 offset:9224
    s_waitcnt lgkmcnt(0)
    s_waitcnt vmcnt(28)
    s_barrier
    s_add_u32 s45, s46, 0x680000
    s_add_u32 m0, s47, 65536
    s_nop 0
    buffer_load_dwordx4 v21, s[24:27], s45 offen  lds
    s_add_u32 s45, s46, 0x6a0000
    s_add_u32 m0, s47, 69632
    s_nop 0
    buffer_load_dwordx4 v21, s[24:27], s45 offen  lds
    s_add_u32 s45, s46, 0x6c0000
    s_add_u32 m0, s47, 73728
    s_nop 0
    buffer_load_dwordx4 v21, s[24:27], s45 offen  lds
    s_add_u32 s45, s46, 0x6e0000
    s_add_u32 m0, s47, 77824
    s_nop 0
    buffer_load_dwordx4 v21, s[24:27], s45 offen  lds
    ds_read_b64_tr_b16 a[80:81], v24 offset:16384
    ds_read_b64_tr_b16 a[82:83], v24 offset:17408
    ds_read_b64_tr_b16 a[84:85], v24 offset:16392
    ds_read_b64_tr_b16 a[86:87], v24 offset:17416
    ds_read_b64_tr_b16 a[88:89], v24 offset:24576
    ds_read_b64_tr_b16 a[90:91], v24 offset:25600
    ds_read_b64_tr_b16 a[92:93], v24 offset:24584
    ds_read_b64_tr_b16 a[94:95], v24 offset:25608
    s_waitcnt lgkmcnt(0)
    s_waitcnt vmcnt(28)
    s_barrier
    s_add_u32 s45, s46, 0x700000
    s_add_u32 m0, s47, 81920
    s_nop 0
    buffer_load_dwordx4 v21, s[24:27], s45 offen  lds
    s_add_u32 s45, s46, 0x720000
    s_add_u32 m0, s47, 86016
    s_nop 0
    buffer_load_dwordx4 v21, s[24:27], s45 offen  lds
    s_add_u32 s45, s46, 0x740000
    s_add_u32 m0, s47, 90112
    s_nop 0
    buffer_load_dwordx4 v21, s[24:27], s45 offen  lds
    s_add_u32 s45, s46, 0x760000
    s_add_u32 m0, s47, 94208
    s_nop 0
    buffer_load_dwordx4 v21, s[24:27], s45 offen  lds
    ds_read_b64_tr_b16 a[96:97], v24 offset:32768
    ds_read_b64_tr_b16 a[98:99], v24 offset:33792
    ds_read_b64_tr_b16 a[100:101], v24 offset:32776
    ds_read_b64_tr_b16 a[102:103], v24 offset:33800
    ds_read_b64_tr_b16 a[104:105], v24 offset:40960
    ds_read_b64_tr_b16 a[106:107], v24 offset:41984
    ds_read_b64_tr_b16 a[108:109], v24 offset:40968
    ds_read_b64_tr_b16 a[110:111], v24 offset:41992
    s_waitcnt lgkmcnt(0)
    s_waitcnt vmcnt(28)
    s_barrier
    s_add_u32 s45, s46, 0x780000
    s_add_u32 m0, s47, 98304
    s_nop 0
    buffer_load_dwordx4 v21, s[24:27], s45 offen  lds
    s_add_u32 s45, s46, 0x7a0000
    s_add_u32 m0, s47, 102400
    s_nop 0
    buffer_load_dwordx4 v21, s[24:27], s45 offen  lds
    s_add_u32 s45, s46, 0x7c0000
    s_add_u32 m0, s47, 106496
    s_nop 0
    buffer_load_dwordx4 v21, s[24:27], s45 offen  lds
    s_add_u32 s45, s46, 0x7e0000
    s_add_u32 m0, s47, 110592
    s_nop 0
    buffer_load_dwordx4 v21, s[24:27], s45 offen  lds
    ds_read_b64_tr_b16 a[112:113], v24 offset:49152
    ds_read_b64_tr_b16 a[114:115], v24 offset:50176
    ds_read_b64_tr_b16 a[116:117], v24 offset:49160
    ds_read_b64_tr_b16 a[118:119], v24 offset:50184
    ds_read_b64_tr_b16 a[120:121], v24 offset:57344
    ds_read_b64_tr_b16 a[122:123], v24 offset:58368
    ds_read_b64_tr_b16 a[124:125], v24 offset:57352
    ds_read_b64_tr_b16 a[126:127], v24 offset:58376
    s_waitcnt lgkmcnt(0)
    s_waitcnt vmcnt(28)
    s_barrier
    ds_read_b64_tr_b16 a[128:129], v25 offset:0
    ds_read_b64_tr_b16 a[130:131], v25 offset:1024
    ds_read_b64_tr_b16 a[132:133], v25 offset:8
    ds_read_b64_tr_b16 a[134:135], v25 offset:1032
    ds_read_b64_tr_b16 a[136:137], v25 offset:8192
    ds_read_b64_tr_b16 a[138:139], v25 offset:9216
    ds_read_b64_tr_b16 a[140:141], v25 offset:8200
    ds_read_b64_tr_b16 a[142:143], v25 offset:9224
    s_waitcnt lgkmcnt(0)
    s_waitcnt vmcnt(24)
    s_barrier
    ds_read_b64_tr_b16 a[144:145], v23 offset:0
    ds_read_b64_tr_b16 a[146:147], v23 offset:1024
    ds_read_b64_tr_b16 a[148:149], v23 offset:8
    ds_read_b64_tr_b16 a[150:151], v23 offset:1032
    ds_read_b64_tr_b16 a[152:153], v23 offset:8192
    ds_read_b64_tr_b16 a[154:155], v23 offset:9216
    ds_read_b64_tr_b16 a[156:157], v23 offset:8200
    ds_read_b64_tr_b16 a[158:159], v23 offset:9224
    s_waitcnt lgkmcnt(0)
    s_waitcnt vmcnt(20)
    s_barrier
    ds_read_b64_tr_b16 a[160:161], v23 offset:16384
    ds_read_b64_tr_b16 a[162:163], v23 offset:17408
    ds_read_b64_tr_b16 a[164:165], v23 offset:16392
    ds_read_b64_tr_b16 a[166:167], v23 offset:17416
    ds_read_b64_tr_b16 a[168:169], v23 offset:24576
    ds_read_b64_tr_b16 a[170:171], v23 offset:25600
    ds_read_b64_tr_b16 a[172:173], v23 offset:24584
    ds_read_b64_tr_b16 a[174:175], v23 offset:25608
    s_waitcnt lgkmcnt(0)
    s_waitcnt vmcnt(16)
    s_barrier
    ds_read_b64_tr_b16 a[176:177], v23 offset:32768
    ds_read_b64_tr_b16 a[178:179], v23 offset:33792
    ds_read_b64_tr_b16 a[180:181], v23 offset:32776
    ds_read_b64_tr_b16 a[182:183], v23 offset:33800
    ds_read_b64_tr_b16 a[184:185], v23 offset:40960
    ds_read_b64_tr_b16 a[186:187], v23 offset:41984
    ds_read_b64_tr_b16 a[188:189], v23 offset:40968
    ds_read_b64_tr_b16 a[190:191], v23 offset:41992
    s_waitcnt lgkmcnt(0)
    s_waitcnt vmcnt(12)
    s_barrier
    ds_read_b64_tr_b16 a[192:193], v23 offset:49152
    ds_read_b64_tr_b16 a[194:195], v23 offset:50176
    ds_read_b64_tr_b16 a[196:197], v23 offset:49160
    ds_read_b64_tr_b16 a[198:199], v23 offset:50184
    ds_read_b64_tr_b16 a[200:201], v23 offset:57344
    ds_read_b64_tr_b16 a[202:203], v23 offset:58368
    ds_read_b64_tr_b16 a[204:205], v23 offset:57352
    ds_read_b64_tr_b16 a[206:207], v23 offset:58376
    s_waitcnt lgkmcnt(0)
    s_waitcnt vmcnt(8)
    s_barrier
    ds_read_b64_tr_b16 a[208:209], v24 offset:0
    ds_read_b64_tr_b16 a[210:211], v24 offset:1024
    ds_read_b64_tr_b16 a[212:213], v24 offset:8
    ds_read_b64_tr_b16 a[214:215], v24 offset:1032
    ds_read_b64_tr_b16 a[216:217], v24 offset:8192
    ds_read_b64_tr_b16 a[218:219], v24 offset:9216
    ds_read_b64_tr_b16 a[220:221], v24 offset:8200
    ds_read_b64_tr_b16 a[222:223], v24 offset:9224
    s_waitcnt lgkmcnt(0)
    s_waitcnt vmcnt(4)
    s_barrier
    ds_read_b64_tr_b16 a[224:225], v24 offset:16384
    ds_read_b64_tr_b16 a[226:227], v24 offset:17408
    ds_read_b64_tr_b16 a[228:229], v24 offset:16392
    ds_read_b64_tr_b16 a[230:231], v24 offset:17416
    ds_read_b64_tr_b16 a[232:233], v24 offset:24576
    ds_read_b64_tr_b16 a[234:235], v24 offset:25600
    ds_read_b64_tr_b16 a[236:237], v24 offset:24584
    ds_read_b64_tr_b16 a[238:239], v24 offset:25608
    s_waitcnt lgkmcnt(0)
    s_waitcnt vmcnt(0)
    s_barrier
    ds_read_b64_tr_b16 a[240:241], v24 offset:32768
    ds_read_b64_tr_b16 a[242:243], v24 offset:33792
    ds_read_b64_tr_b16 a[244:245], v24 offset:32776
    ds_read_b64_tr_b16 a[246:247], v24 offset:33800
    ds_read_b64_tr_b16 a[248:249], v24 offset:40960
    ds_read_b64_tr_b16 a[250:251], v24 offset:41984
    ds_read_b64_tr_b16 a[252:253], v24 offset:40968
    ds_read_b64_tr_b16 a[254:255], v24 offset:41992
    s_waitcnt lgkmcnt(0)
    s_barrier
    s_cmp_lg_u32 s44, 0
    s_cbranch_scc1 L_pd_114
    v_mov_b32 v29, 8
    s_mov_b32 s46, 32
    s_mov_b64 exec, 1
    s_mov_b32 s70, 0
L_wp_115:
    buffer_load_dword v31, v29, s[16:19], 0 offen sc1
    s_add_u32 s70, s70, 1
    s_cmp_ge_u32 s70, 0x200000
    s_cbranch_scc1 L_w_done_98
    s_waitcnt vmcnt(0)
    v_cmp_gt_u32 vcc, s46, v31
    s_nop 1
    s_cbranch_vccz L_wp_115_ok
    s_sleep 3
    s_branch L_wp_115
L_wp_115_ok:
    s_mov_b64 exec, -1
L_pd_114:
    s_barrier
    s_mov_b32 s60, 0
    s_mov_b32 s51, 1
    s_mov_b32 s71, 126976
    s_mov_b32 s52, 0x400000
    s_lshl_b32 s56, s39, 19
    s_add_u32 s56, s56, 0x2000000
L_w_qkv_116:
    s_cmp_lg_u32 s44, 0
    s_cbranch_scc1 L_pd_117
    v_mov_b32 v29, s71
    s_mov_b32 s46, 96
    s_mov_b64 exec, 1
    s_mov_b32 s70, 0
L_wp_118:
    buffer_load_dword v31, v29, s[12:15], 0 offen sc1
    s_add_u32 s70, s70, 1
    s_cmp_ge_u32 s70, 0x200000
    s_cbranch_scc1 L_w_done_98
    s_waitcnt vmcnt(0)
    v_cmp_gt_u32 vcc, s46, v31
    s_nop 1
    s_cbranch_vccz L_wp_118_ok
    s_sleep 2
    s_branch L_wp_118
L_wp_118_ok:
    s_mov_b64 exec, -1
L_pd_117:
    s_barrier
L_w_qkv_116_n:
    s_mov_b32 s50, s60
    s_mul_i32 s53, s50, 65536
    s_add_u32 s53, s53, s52
    s_lshl_b32 s54, s44, 13
    s_add_u32 s53, s53, s54
    s_mul_i32 s57, s50, 8192
    s_add_u32 s57, s57, s56
    s_lshl_b32 s45, s44, 11
    s_add_u32 s57, s57, s45
    s_add_u32 s55, s54, 65536
    s_mov_b32 s58, 0
    v_mov_b32 v13, v3
    v_add_u32 v14, 65536, v13
    v_xor_b32 v15, 64, v13
    v_xor_b32 v16, 64, v14
    s_mov_b32 s76, 0x20000000
    s_add_u32 s48, s53, 0
    s_add_u32 s49, s48, 4096
    s_add_u32 m0, s54, 0
    s_nop 0
    buffer_load_dwordx4 v6, s[12:15], s48 offen offset:0 sc1 lds
    s_add_u32 m0, s54, 1024
    s_nop 0
    buffer_load_dwordx4 v9, s[12:15], s48 offen offset:0 sc1 lds
    s_add_u32 m0, s54, 2048
    s_nop 0
    buffer_load_dwordx4 v6, s[12:15], s49 offen offset:0 sc1 lds
    s_add_u32 m0, s54, 3072
    s_nop 0
    buffer_load_dwordx4 v9, s[12:15], s49 offen offset:0 sc1 lds
    s_add_u32 m0, s54, 3968
    s_nop 0
    buffer_load_dwordx4 v6, s[12:15], s48 offen offset:128 sc1 lds
    s_add_u32 m0, s54, 4992
    s_nop 0
    buffer_load_dwordx4 v9, s[12:15], s48 offen offset:128 sc1 lds
    s_add_u32 m0, s54, 6016
    s_nop 0
    buffer_load_dwordx4 v6, s[12:15], s49 offen offset:128 sc1 lds
    s_add_u32 m0, s54, 7040
    s_nop 0
    buffer_load_dwordx4 v9, s[12:15], s49 offen offset:128 sc1 lds
    s_add_u32 s48, s53, 32768
    s_add_u32 s49, s48, 4096
    s_add_u32 s46, s54, 32768
    s_add_u32 m0, s46, 0
    s_nop 0
    buffer_load_dwordx4 v6, s[12:15], s48 offen offset:0 sc1 lds
    s_add_u32 m0, s46, 1024
    s_nop 0
    buffer_load_dwordx4 v9, s[12:15], s48 offen offset:0 sc1 lds
    s_add_u32 m0, s46, 2048
    s_nop 0
    buffer_load_dwordx4 v6, s[12:15], s49 offen offset:0 sc1 lds
    s_add_u32 m0, s46, 3072
    s_nop 0
    buffer_load_dwordx4 v9, s[12:15], s49 offen offset:0 sc1 lds
    s_add_u32 m0, s46, 3968
    s_nop 0
    buffer_load_dwordx4 v6, s[12:15], s48 offen offset:128 sc1 lds
    s_add_u32 m0, s46, 4992
    s_nop 0
    buffer_load_dwordx4 v9, s[12:15], s48 offen offset:128 sc1 lds
    s_add_u32 m0, s46, 6016
    s_nop 0
    buffer_load_dwordx4 v6, s[12:15], s49 offen offset:128 sc1 lds
    s_add_u32 m0, s46, 7040
    s_nop 0
    buffer_load_dwordx4 v9, s[12:15], s49 offen offset:128 sc1 lds
    s_cmp_eq_u32 s51, 1
    s_cbranch_scc1 L_e_one_120
    s_add_u32 s48, s53, 65536
    s_add_u32 s49, s48, 4096
    s_add_u32 m0, s55, 0
    s_nop 0
    buffer_load_dwordx4 v6, s[12:15], s48 offen offset:0 sc1 lds
    s_add_u32 m0, s55, 1024
    s_nop 0
    buffer_load_dwordx4 v9, s[12:15], s48 offen offset:0 sc1 lds
    s_add_u32 m0, s55, 2048
    s_nop 0
    buffer_load_dwordx4 v6, s[12:15], s49 offen offset:0 sc1 lds
    s_add_u32 m0, s55, 3072
    s_nop 0
    buffer_load_dwordx4 v9, s[12:15], s49 offen offset:0 sc1 lds
    s_add_u32 m0, s55, 3968
    s_nop 0
    buffer_load_dwordx4 v6, s[12:15], s48 offen offset:128 sc1 lds
    s_add_u32 m0, s55, 4992
    s_nop 0
    buffer_load_dwordx4 v9, s[12:15], s48 offen offset:128 sc1 lds
    s_add_u32 m0, s55, 6016
    s_nop 0
    buffer_load_dwordx4 v6, s[12:15], s49 offen offset:128 sc1 lds
    s_add_u32 m0, s55, 7040
    s_nop 0
    buffer_load_dwordx4 v9, s[12:15], s49 offen offset:128 sc1 lds
    s_waitcnt vmcnt(16)
    s_barrier
    ds_read_b128 v[32:35], v13 offset:0
    ds_read_b128 v[36:39], v13 offset:2048
    ds_read_b128 v[40:43], v15 offset:0
    ds_read_b128 v[44:47], v15 offset:2048
L_e_loop_119:
    s_add_u32 s48, s53, 98304
    s_add_u32 s46, s58, 1
    s_cmp_lt_u32 s46, s51
    s_cselect_b32 s48, s48, 0x20000000
    s_add_u32 s49, s48, 4096
    s_add_u32 s59, s55, 32768
    s_waitcnt lgkmcnt(2)
    v_mfma_f32_16x16x32_bf16 v[80:83], a[0:3], v[32:35], 0
    ds_read_b128 v[48:51], v13 offset:4096
    ds_read_b128 v[52:55], v13 offset:6144
    v_mfma_f32_16x16x32_bf16 v[84:87], a[4:7], v[32:35], 0
    ds_read_b128 v[56:59], v15 offset:4096
    ds_read_b128 v[60:63], v15 offset:6144
    s_add_u32 m0, s59, 0
    v_mfma_f32_16x16x32_bf16 v[88:91], a[0:3], v[36:39], 0
    buffer_load_dwordx4 v6, s[12:15], s48 offen offset:0 sc1 lds
    v_mfma_f32_16x16x32_bf16 v[92:95], a[4:7], v[36:39], 0
    s_waitcnt lgkmcnt(4)
    v_mfma_f32_16x16x32_bf16 v[80:83], a[8:11], v[40:43], v[80:83]
    ds_read_b128 v[32:35], v13 offset:8192
    ds_read_b128 v[36:39], v13 offset:10240
    v_mfma_f32_16x16x32_bf16 v[84:87], a[12:15], v[40:43], v[84:87]
    s_add_u32 m0, s59, 1024
    v_mfma_f32_16x16x32_bf16 v[88:91], a[8:11], v[44:47], v[88:91]
    buffer_load_dwordx4 v9, s[12:15], s48 offen offset:0 sc1 lds
    v_mfma_f32_16x16x32_bf16 v[92:95], a[12:15], v[44:47], v[92:95]
    s_waitcnt lgkmcnt(4)
    v_mfma_f32_16x16x32_bf16 v[80:83], a[16:19], v[48:51], v[80:83]
    ds_read_b128 v[40:43], v15 offset:8192
    ds_read_b128 v[44:47], v15 offset:10240
    v_mfma_f32_16x16x32_bf16 v[84:87], a[20:23], v[48:51], v[84:87]
    s_add_u32 m0, s59, 2048
    v_mfma_f32_16x16x32_bf16 v[88:91], a[16:19], v[52:55], v[88:91]
    buffer_load_dwordx4 v6, s[12:15], s49 offen offset:0 sc1 lds
    v_mfma_f32_16x16x32_bf16 v[92:95], a[20:23], v[52:55], v[92:95]
    s_waitcnt lgkmcnt(4)
    v_mfma_f32_16x16x32_bf16 v[80:83], a[24:27], v[56:59], v[80:83]
    ds_read_b128 v[48:51], v13 offset:12288
    ds_read_b128 v[52:55], v13 offset:14336
    v_mfma_f32_16x16x32_bf16 v[84:87], a[28:31], v[56:59], v[84:87]
    s_add_u32 m0, s59, 3072
    v_mfma_f32_16x16x32_bf16 v[88:91], a[24:27], v[60:63], v[88:91]
    buffer_load_dwordx4 v9, s[12:15], s49 offen offset:0 sc1 lds
    v_mfma_f32_16x16x32_bf16 v[92:95], a[28:31], v[60:63], v[92:95]
    s_waitcnt lgkmcnt(4)
    v_mfma_f32_16x16x32_bf16 v[80:83], a[32:35], v[32:35], v[80:83]
    ds_read_b128 v[56:59], v15 offset:12288
    ds_read_b128 v[60:63], v15 offset:14336
    v_mfma_f32_16x16x32_bf16 v[84:87], a[36:39], v[32:35], v[84:87]
    s_add_u32 m0, s59, 3968
    v_mfma_f32_16x16x32_bf16 v[88:91], a[32:35], v[36:39], v[88:91]
    buffer_load_dwordx4 v6, s[12:15], s48 offen offset:128 sc1 lds
    v_mfma_f32_16x16x32_bf16 v[92:95], a[36:39], v[36:39], v[92:95]
    s_waitcnt lgkmcnt(4)
    v_mfma_f32_16x16x32_bf16 v[80:83], a[40:43], v[40:43], v[80:83]
    ds_read_b128 v[32:35], v13 offset:16384
    ds_read_b128 v[36:39], v13 offset:18432
    v_mfma_f32_16x16x32_bf16 v[84:87], a[44:47], v[40:43], v[84:87]
    s_add_u32 m0, s59, 4992
    v_mfma_f32_16x16x32_bf16 v[88:91], a[40:43], v[44:47], v[88:91]
    buffer_load_dwordx4 v9, s[12:15], s48 offen offset:128 sc1 lds
    v_mfma_f32_16x16x32_bf16 v[92:95], a[44:47], v[44:47], v[92:95]
    s_waitcnt lgkmcnt(4)
    v_mfma_f32_16x16x32_bf16 v[80:83], a[48:51], v[48:51], v[80:83]
    ds_read_b128 v[40:43], v15 offset:16384
    ds_read_b128 v[44:47], v15 offset:18432
    v_mfma_f32_16x16x32_bf16 v[84:87], a[52:55], v[48:51], v[84:87]
    s_add_u32 m0, s59, 6016
    v_mfma_f32_16x16x32_bf16 v[88:91], a[48:51], v[52:55], v[88:91]
    buffer_load_dwordx4 v6, s[12:15], s49 offen offset:128 sc1 lds
    v_mfma_f32_16x16x32_bf16 v[92:95], a[52:55], v[52:55], v[92:95]
    s_waitcnt lgkmcnt(4)
    v_mfma_f32_16x16x32_bf16 v[80:83], a[56:59], v[56:59], v[80:83]
    ds_read_b128 v[48:51], v13 offset:20480
    ds_read_b128 v[52:55], v13 offset:22528
    v_mfma_f32_16x16x32_bf16 v[84:87], a[60:63], v[56:59], v[84:87]
    s_add_u32 m0, s59, 7040
    v_mfma_f32_16x16x32_bf16 v[88:91], a[56:59], v[60:63], v[88:91]
    buffer_load_dwordx4 v9, s[12:15], s49 offen offset:128 sc1 lds
    v_mfma_f32_16x16x32_bf16 v[92:95], a[60:63], v[60:63], v[92:95]
    s_waitcnt lgkmcnt(4)
    v_mfma_f32_16x16x32_bf16 v[80:83], a[64:67], v[32:35], v[80:83]
    ds_read_b128 v[56:59], v15 offset:20480
    ds_read_b128 v[60:63], v15 offset:22528
    v_mfma_f32_16x16x32_bf16 v[84:87], a[68:71], v[32:35], v[84:87]
    v_mfma_f32_16x16x32_bf16 v[88:91], a[64:67], v[36:39], v[88:91]
    v_mfma_f32_16x16x32_bf16 v[92:95], a[68:71], v[36:39], v[92:95]
    s_waitcnt lgkmcnt(4)
    v_mfma_f32_16x16x32_bf16 v[80:83], a[72:75], v[40:43], v[80:83]
    ds_read_b128 v[32:35], v13 offset:24576
    ds_read_b128 v[36:39], v13 offset:26624
    v_mfma_f32_16x16x32_bf16 v[84:87], a[76:79], v[40:43], v[84:87]
    v_mfma_f32_16x16x32_bf16 v[88:91], a[72:75], v[44:47], v[88:91]
    v_mfma_f32_16x16x32_bf16 v[92:95], a[76:79], v[44:47], v[92:95]
    s_waitcnt lgkmcnt(4)
    v_mfma_f32_16x16x32_bf16 v[80:83], a[80:83], v[48:51], v[80:83]
    ds_read_b128 v[40:43], v15 offset:24576
    ds_read_b128 v[44:47], v15 offset:26624
    v_mfma_f32_16x16x32_bf16 v[84:87], a[84:87], v[48:51], v[84:87]
    v_mfma_f32_16x16x32_bf16 v[88:91], a[80:83], v[52:55], v[88:91]
    v_mfma_f32_16x16x32_bf16 v[92:95], a[84:87], v[52:55], v[92:95]
    s_waitcnt lgkmcnt(4)
    v_mfma_f32_16x16x32_bf16 v[80:83], a[88:91], v[56:59], v[80:83]
    ds_read_b128 v[48:51], v13 offset:28672
    ds_read_b128 v[52:55], v13 offset:30720
    v_mfma_f32_16x16x32_bf16 v[84:87], a[92:95], v[56:59], v[84:87]
    v_mfma_f32_16x16x32_bf16 v[88:91], a[88:91], v[60:63], v[88:91]
    v_mfma_f32_16x16x32_bf16 v[92:95], a[92:95], v[60:63], v[92:95]
    s_waitcnt lgkmcnt(4)
    v_mfma_f32_16x16x32_bf16 v[80:83], a[96:99], v[32:35], v[80:83]
    ds_read_b128 v[56:59], v15 offset:28672
    ds_read_b128 v[60:63], v15 offset:30720
    v_mfma_f32_16x16x32_bf16 v[84:87], a[100:103], v[32:35], v[84:87]
    v_mfma_f32_16x16x32_bf16 v[88:91], a[96:99], v[36:39], v[88:91]
    v_mfma_f32_16x16x32_bf16 v[92:95], a[100:103], v[36:39], v[92:95]
    s_waitcnt lgkmcnt(4)
    v_mfma_f32_16x16x32_bf16 v[80:83], a[104:107], v[40:43], v[80:83]
    v_mfma_f32_16x16x32_bf16 v[84:87], a[108:111], v[40:43], v[84:87]
    v_mfma_f32_16x16x32_bf16 v[88:91], a[104:107], v[44:47], v[88:91]
    v_mfma_f32_16x16x32_bf16 v[92:95], a[108:111], v[44:47], v[92:95]
    s_waitcnt vmcnt(16) lgkmcnt(0)
    s_barrier
    v_mfma_f32_16x16x32_bf16 v[80:83], a[112:115], v[48:51], v[80:83]
    ds_read_b128 v[32:35], v13 offset:32768
    ds_read_b128 v[36:39], v13 offset:34816
    v_mfma_f32_16x16x32_bf16 v[84:87], a[116:119], v[48:51], v[84:87]
    v_mfma_f32_16x16x32_bf16 v[88:91], a[112:115], v[52:55], v[88:91]
    v_mfma_f32_16x16x32_bf16 v[92:95], a[116:119], v[52:55], v[92:95]
    v_mfma_f32_16x16x32_bf16 v[80:83], a[120:123], v[56:59], v[80:83]
    ds_read_b128 v[40:43], v15 offset:32768
    ds_read_b128 v[44:47], v15 offset:34816
    v_mfma_f32_16x16x32_bf16 v[84:87], a[124:127], v[56:59], v[84:87]
    v_mfma_f32_16x16x32_bf16 v[88:91], a[120:123], v[60:63], v[88:91]
    v_mfma_f32_16x16x32_bf16 v[92:95], a[124:127], v[60:63], v[92:95]
    s_add_u32 s48, s53, 131072
    s_add_u32 s46, s58, 2
    s_cmp_lt_u32 s46, s51
    s_cselect_b32 s48, s48, 0x20000000
    s_add_u32 s49, s48, 4096
    s_mov_b32 s59, s54
    s_waitcnt lgkmcnt(2)
    v_mfma_f32_16x16x32_bf16 v[80:83], a[128:131], v[32:35], v[80:83]
    ds_read_b128 v[48:51], v13 offset:36864
    ds_read_b128 v[52:55], v13 offset:38912
    v_mfma_f32_16x16x32_bf16 v[84:87], a[132:135], v[32:35], v[84:87]
    ds_read_b128 v[56:59], v15 offset:36864
    ds_read_b128 v[60:63], v15 offset:38912
    s_add_u32 m0, s59, 0
    v_mfma_f32_16x16x32_bf16 v[88:91], a[128:131], v[36:39], v[88:91]
    buffer_load_dwordx4 v6, s[12:15], s48 offen offset:0 sc1 lds
    v_mfma_f32_16x16x32_bf16 v[92:95], a[132:135], v[36:39], v[92:95]
    s_waitcnt lgkmcnt(4)
    v_mfma_f32_16x16x32_bf16 v[80:83], a[136:139], v[40:43], v[80:83]
    ds_read_b128 v[32:35], v13 offset:40960
    ds_read_b128 v[36:39], v13 offset:43008
    v_mfma_f32_16x16x32_bf16 v[84:87], a[140:143], v[40:43], v[84:87]
    s_add_u32 m0, s59, 1024
    v_mfma_f32_16x16x32_bf16 v[88:91], a[136:139], v[44:47], v[88:91]
    buffer_load_dwordx4 v9, s[12:15], s48 offen offset:0 sc1 lds
    v_mfma_f32_16x16x32_bf16 v[92:95], a[140:143], v[44:47], v[92:95]
    s_waitcnt lgkmcnt(4)
    v_mfma_f32_16x16x32_bf16 v[80:83], a[144:147], v[48:51], v[80:83]
    ds_read_b128 v[40:43], v15 offset:40960
    ds_read_b128 v[44:47], v15 offset:43008
    v_mfma_f32_16x16x32_bf16 v[84:87], a[148:151], v[48:51], v[84:87]
    s_add_u32 m0, s59, 2048
    v_mfma_f32_16x16x32_bf16 v[88:91], a[144:147], v[52:55], v[88:91]
    buffer_load_dwordx4 v6, s[12:15], s49 offen offset:0 sc1 lds
    v_mfma_f32_16x16x32_bf16 v[92:95], a[148:151], v[52:55], v[92:95]
    s_waitcnt lgkmcnt(4)
    v_mfma_f32_16x16x32_bf16 v[80:83], a[152:155], v[56:59], v[80:83]
    ds_read_b128 v[48:51], v13 offset:45056
    ds_read_b128 v[52:55], v13 offset:47104
    v_mfma_f32_16x16x32_bf16 v[84:87], a[156:159], v[56:59], v[84:87]
    s_add_u32 m0, s59, 3072
    v_mfma_f32_16x16x32_bf16 v[88:91], a[152:155], v[60:63], v[88:91]
    buffer_load_dwordx4 v9, s[12:15], s49 offen offset:0 sc1 lds
    v_mfma_f32_16x16x32_bf16 v[92:95], a[156:159], v[60:63], v[92:95]
    s_waitcnt lgkmcnt(4)
    v_mfma_f32_16x16x32_bf16 v[80:83], a[160:163], v[32:35], v[80:83]
    ds_read_b128 v[56:59], v15 offset:45056
    ds_read_b128 v[60:63], v15 offset:47104
    v_mfma_f32_16x16x32_bf16 v[84:87], a[164:167], v[32:35], v[84:87]
    s_add_u32 m0, s59, 3968
    v_mfma_f32_16x16x32_bf16 v[88:91], a[160:163], v[36:39], v[88:91]
    buffer_load_dwordx4 v6, s[12:15], s48 offen offset:128 sc1 lds
    v_mfma_f32_16x16x32_bf16 v[92:95], a[164:167], v[36:39], v[92:95]
    s_waitcnt lgkmcnt(4)
    v_mfma_f32_16x16x32_bf16 v[80:83], a[168:171], v[40:43], v[80:83]
    ds_read_b128 v[32:35], v13 offset:49152
    ds_read_b128 v[36:39], v13 offset:51200
    v_mfma_f32_16x16x32_bf16 v[84:87], a[172:175], v[40:43], v[84:87]
    s_add_u32 m0, s59, 4992
    v_mfma_f32_16x16x32_bf16 v[88:91], a[168:171], v[44:47], v[88:91]
    buffer_load_dwordx4 v9, s[12:15], s48 offen offset:128 sc1 lds
    v_mfma_f32_16x16x32_bf16 v[92:95], a[172:175], v[44:47], v[92:95]
    s_waitcnt lgkmcnt(4)
    v_mfma_f32_16x16x32_bf16 v[80:83], a[176:179], v[48:51], v[80:83]
    ds_read_b128 v[40:43], v15 offset:49152
    ds_read_b128 v[44:47], v15 offset:51200
    v_mfma_f32_16x16x32_bf16 v[84:87], a[180:183], v[48:51], v[84:87]
    s_add_u32 m0, s59, 6016
    v_mfma_f32_16x16x32_bf16 v[88:91], a[176:179], v[52:55], v[88:91]
    buffer_load_dwordx4 v6, s[12:15], s49 offen offset:128 sc1 lds
    v_mfma_f32_16x16x32_bf16 v[92:95], a[180:183], v[52:55], v[92:95]
    s_waitcnt lgkmcnt(4)
    v_mfma_f32_16x16x32_bf16 v[80:83], a[184:187], v[56:59], v[80:83]
    ds_read_b128 v[48:51], v13 offset:53248
    ds_read_b128 v[52:55], v13 offset:55296
    v_mfma_f32_16x16x32_bf16 v[84:87], a[188:191], v[56:59], v[84:87]
    s_add_u32 m0, s59, 7040
    v_mfma_f32_16x16x32_bf16 v[88:91], a[184:187], v[60:63], v[88:91]
    buffer_load_dwordx4 v9, s[12:15], s49 offen offset:128 sc1 lds
    v_mfma_f32_16x16x32_bf16 v[92:95], a[188:191], v[60:63], v[92:95]
    s_waitcnt lgkmcnt(4)
    v_mfma_f32_16x16x32_bf16 v[80:83], a[192:195], v[32:35], v[80:83]
    ds_read_b128 v[56:59], v15 offset:53248
    ds_read_b128 v[60:63], v15 offset:55296
    v_mfma_f32_16x16x32_bf16 v[84:87], a[196:199], v[32:35], v[84:87]
    v_mfma_f32_16x16x32_bf16 v[88:91], a[192:195], v[36:39], v[88:91]
    v_mfma_f32_16x16x32_bf16 v[92:95], a[196:199], v[36:39], v[92:95]
    s_waitcnt lgkmcnt(4)
    v_mfma_f32_16x16x32_bf16 v[80:83], a[200:203], v[40:43], v[80:83]
    ds_read_b128 v[32:35], v13 offset:57344
    ds_read_b128 v[36:39], v13 offset:59392
    v_mfma_f32_16x16x32_bf16 v[84:87], a[204:207], v[40:43], v[84:87]
    v_mfma_f32_16x16x32_bf16 v[88:91], a[200:203], v[44:47], v[88:91]
    v_mfma_f32_16x16x32_bf16 v[92:95], a[204:207], v[44:47], v[92:95]
    s_waitcnt lgkmcnt(4)
    v_mfma_f32_16x16x32_bf16 v[80:83], a[208:211], v[48:51], v[80:83]
    ds_read_b128 v[40:43], v15 offset:57344
    ds_read_b128 v[44:47], v15 offset:59392
    v_mfma_f32_16x16x32_bf16 v[84:87], a[212:215], v[48:51], v[84:87]
    v_mfma_f32_16x16x32_bf16 v[88:91], a[208:211], v[52:55], v[88:91]
    v_mfma_f32_16x16x32_bf16 v[92:95], a[212:215], v[52:55], v[92:95]
    s_waitcnt lgkmcnt(4)
    v_mfma_f32_16x16x32_bf16 v[80:83], a[216:219], v[56:59], v[80:83]
    ds_read_b128 v[48:51], v13 offset:61440
    ds_read_b128 v[52:55], v13 offset:63488
    v_mfma_f32_16x16x32_bf16 v[84:87], a[220:223], v[56:59], v[84:87]
    v_mfma_f32_16x16x32_bf16 v[88:91], a[216:219], v[60:63], v[88:91]
    v_mfma_f32_16x16x32_bf16 v[92:95], a[220:223], v[60:63], v[92:95]
    s_waitcnt lgkmcnt(4)
    v_mfma_f32_16x16x32_bf16 v[80:83], a[224:227], v[32:35], v[80:83]
    ds_read_b128 v[56:59], v15 offset:61440
    ds_read_b128 v[60:63], v15 offset:63488
    v_mfma_f32_16x16x32_bf16 v[84:87], a[228:231], v[32:35], v[84:87]
    v_mfma_f32_16x16x32_bf16 v[88:91], a[224:227], v[36:39], v[88:91]
    v_mfma_f32_16x16x32_bf16 v[92:95], a[228:231], v[36:39], v[92:95]
    s_waitcnt lgkmcnt(4)
    v_mfma_f32_16x16x32_bf16 v[80:83], a[232:235], v[40:43], v[80:83]
    v_mfma_f32_16x16x32_bf16 v[84:87], a[236:239], v[40:43], v[84:87]
    v_mfma_f32_16x16x32_bf16 v[88:91], a[232:235], v[44:47], v[88:91]
    v_mfma_f32_16x16x32_bf16 v[92:95], a[236:239], v[44:47], v[92:95]
    s_waitcnt vmcnt(16) lgkmcnt(0)
    s_barrier
    s_cmp_lg_u32 s44, 0
    s_cbranch_scc1 L_e_pr_122
    s_add_u32 s45, s58, s60
    v_mov_b32 v30, s45
    v_mov_b32 v31, 0
    s_mov_b64 exec, 1
    buffer_store_dword v30, v31, s[12:15], s61 offen sc1
    s_mov_b64 exec, -1
L_e_pr_122:
    v_mfma_f32_16x16x32_bf16 v[80:83], a[240:243], v[48:51], v[80:83]
    ds_read_b128 v[32:35], v14 offset:0
    ds_read_b128 v[36:39], v14 offset:2048
    v_mfma_f32_16x16x32_bf16 v[84:87], a[244:247], v[48:51], v[84:87]
    v_mfma_f32_16x16x32_bf16 v[88:91], a[240:243], v[52:55], v[88:91]
    v_mfma_f32_16x16x32_bf16 v[92:95], a[244:247], v[52:55], v[92:95]
    v_mfma_f32_16x16x32_bf16 v[80:83], a[248:251], v[56:59], v[80:83]
    ds_read_b128 v[40:43], v16 offset:0
    ds_read_b128 v[44:47], v16 offset:2048
    v_mfma_f32_16x16x32_bf16 v[84:87], a[252:255], v[56:59], v[84:87]
    v_mfma_f32_16x16x32_bf16 v[88:91], a[248:251], v[60:63], v[88:91]
    v_mfma_f32_16x16x32_bf16 v[92:95], a[252:255], v[60:63], v[92:95]
    s_add_u32 s53, s53, 65536
    s_add_u32 s58, s58, 1
    v_swap_b32 v13, v14
    s_xor_b32 s54, s54, 65536
    s_xor_b32 s55, s55, 65536
    s_mov_b32 s76, s57
    v_swap_b32 v15, v16
    s_add_u32 s57, s57, 8192
    v_cvt_pk_bf16_f32 v216, v80, v81
    v_cvt_pk_bf16_f32 v217, v82, v83
    v_cvt_pk_bf16_f32 v218, v84, v85
    v_cvt_pk_bf16_f32 v219, v86, v87
    v_cvt_pk_bf16_f32 v220, v88, v89
    v_cvt_pk_bf16_f32 v221, v90, v91
    v_cvt_pk_bf16_f32 v222, v92, v93
    v_cvt_pk_bf16_f32 v223, v94, v95
    buffer_store_dwordx4 v[216:219], v10, s[12:15], s76 offen sc1
    buffer_store_dwordx4 v[220:223], v10, s[12:15], s76 offen offset:1024 sc1
    s_cmp_lt_u32 s58, s51
    s_cbranch_scc1 L_e_loop_119
    s_branch L_e_fin_121
L_e_one_120:
    s_waitcnt vmcnt(8)
    s_barrier
    ds_read_b128 v[32:35], v13 offset:0
    ds_read_b128 v[36:39], v13 offset:2048
    ds_read_b128 v[40:43], v15 offset:0
    ds_read_b128 v[44:47], v15 offset:2048
    s_waitcnt lgkmcnt(2)
    v_mfma_f32_16x16x32_bf16 v[80:83], a[0:3], v[32:35], 0
    ds_read_b128 v[48:51], v13 offset:4096
    ds_read_b128 v[52:55], v13 offset:6144
    v_mfma_f32_16x16x32_bf16 v[84:87], a[4:7], v[32:35], 0
    ds_read_b128 v[56:59], v15 offset:4096
    ds_read_b128 v[60:63], v15 offset:6144
    v_mfma_f32_16x16x32_bf16 v[88:91], a[0:3], v[36:39], 0
    v_mfma_f32_16x16x32_bf16 v[92:95], a[4:7], v[36:39], 0
    s_waitcnt lgkmcnt(4)
    v_mfma_f32_16x16x32_bf16 v[80:83], a[8:11], v[40:43], v[80:83]
    ds_read_b128 v[32:35], v13 offset:8192
    ds_read_b128 v[36:39], v13 offset:10240
    v_mfma_f32_16x16x32_bf16 v[84:87], a[12:15], v[40:43], v[84:87]
    v_mfma_f32_16x16x32_bf16 v[88:91], a[8:11], v[44:47], v[88:91]
    v_mfma_f32_16x16x32_bf16 v[92:95], a[12:15], v[44:47], v[92:95]
    s_waitcnt lgkmcnt(4)
    v_mfma_f32_16x16x32_bf16 v[80:83], a[16:19], v[48:51], v[80:83]
    ds_read_b128 v[40:43], v15 offset:8192
    ds_read_b128 v[44:47], v15 offset:10240
    v_mfma_f32_16x16x32_bf16 v[84:87], a[20:23], v[48:51], v[84:87]
    v_mfma_f32_16x16x32_bf16 v[88:91], a[16:19], v[52:55], v[88:91]
    v_mfma_f32_16x16x32_bf16 v[92:95], a[20:23], v[52:55], v[92:95]
    s_waitcnt lgkmcnt(4)
    v_mfma_f32_16x16x32_bf16 v[80:83], a[24:27], v[56:59], v[80:83]
    ds_read_b128 v[48:51], v13 offset:12288
    ds_read_b128 v[52:55], v13 offset:14336
    v_mfma_f32_16x16x32_bf16 v[84:87], a[28:31], v[56:59], v[84:87]
    v_mfma_f32_16x16x32_bf16 v[88:91], a[24:27], v[60:63], v[88:91]
    v_mfma_f32_16x16x32_bf16 v[92:95], a[28:31], v[60:63], v[92:95]
    s_waitcnt lgkmcnt(4)
    v_mfma_f32_16x16x32_bf16 v[80:83], a[32:35], v[32:35], v[80:83]
    ds_read_b128 v[56:59], v15 offset:12288
    ds_read_b128 v[60:63], v15 offset:14336
    v_mfma_f32_16x16x32_bf16 v[84:87], a[36:39], v[32:35], v[84:87]
    v_mfma_f32_16x16x32_bf16 v[88:91], a[32:35], v[36:39], v[88:91]
    v_mfma_f32_16x16x32_bf16 v[92:95], a[36:39], v[36:39], v[92:95]
    s_waitcnt lgkmcnt(4)
    v_mfma_f32_16x16x32_bf16 v[80:83], a[40:43], v[40:43], v[80:83]
    ds_read_b128 v[32:35], v13 offset:16384
    ds_read_b128 v[36:39], v13 offset:18432
    v_mfma_f32_16x16x32_bf16 v[84:87], a[44:47], v[40:43], v[84:87]
    v_mfma_f32_16x16x32_bf16 v[88:91], a[40:43], v[44:47], v[88:91]
    v_mfma_f32_16x16x32_bf16 v[92:95], a[44:47], v[44:47], v[92:95]
    s_waitcnt lgkmcnt(4)
    v_mfma_f32_16x16x32_bf16 v[80:83], a[48:51], v[48:51], v[80:83]
    ds_read_b128 v[40:43], v15 offset:16384
    ds_read_b128 v[44:47], v15 offset:18432
    v_mfma_f32_16x16x32_bf16 v[84:87], a[52:55], v[48:51], v[84:87]
    v_mfma_f32_16x16x32_bf16 v[88:91], a[48:51], v[52:55], v[88:91]
    v_mfma_f32_16x16x32_bf16 v[92:95], a[52:55], v[52:55], v[92:95]
    s_waitcnt lgkmcnt(4)
    v_mfma_f32_16x16x32_bf16 v[80:83], a[56:59], v[56:59], v[80:83]
    ds_read_b128 v[48:51], v13 offset:20480
    ds_read_b128 v[52:55], v13 offset:22528
    v_mfma_f32_16x16x32_bf16 v[84:87], a[60:63], v[56:59], v[84:87]
    v_mfma_f32_16x16x32_bf16 v[88:91], a[56:59], v[60:63], v[88:91]
    v_mfma_f32_16x16x32_bf16 v[92:95], a[60:63], v[60:63], v[92:95]
    s_waitcnt lgkmcnt(4)
    v_mfma_f32_16x16x32_bf16 v[80:83], a[64:67], v[32:35], v[80:83]
    ds_read_b128 v[56:59], v15 offset:20480
    ds_read_b128 v[60:63], v15 offset:22528
    v_mfma_f32_16x16x32_bf16 v[84:87], a[68:71], v[32:35], v[84:87]
    v_mfma_f32_16x16x32_bf16 v[88:91], a[64:67], v[36:39], v[88:91]
    v_mfma_f32_16x16x32_bf16 v[92:95], a[68:71], v[36:39], v[92:95]
    s_waitcnt lgkmcnt(4)
    v_mfma_f32_16x16x32_bf16 v[80:83], a[72:75], v[40:43], v[80:83]
    ds_read_b128 v[32:35], v13 offset:24576
    ds_read_b128 v[36:39], v13 offset:26624
    v_mfma_f32_16x16x32_bf16 v[84:87], a[76:79], v[40:43], v[84:87]
    v_mfma_f32_16x16x32_bf16 v[88:91], a[72:75], v[44:47], v[88:91]
    v_mfma_f32_16x16x32_bf16 v[92:95], a[76:79], v[44:47], v[92:95]
    s_waitcnt lgkmcnt(4)
    v_mfma_f32_16x16x32_bf16 v[80:83], a[80:83], v[48:51], v[80:83]
    ds_read_b128 v[40:43], v15 offset:24576
    ds_read_b128 v[44:47], v15 offset:26624
    v_mfma_f32_16x16x32_bf16 v[84:87], a[84:87], v[48:51], v[84:87]
    v_mfma_f32_16x16x32_bf16 v[88:91], a[80:83], v[52:55], v[88:91]
    v_mfma_f32_16x16x32_bf16 v[92:95], a[84:87], v[52:55], v[92:95]
    s_waitcnt lgkmcnt(4)
    v_mfma_f32_16x16x32_bf16 v[80:83], a[88:91], v[56:59], v[80:83]
    ds_read_b128 v[48:51], v13 offset:28672
    ds_read_b128 v[52:55], v13 offset:30720
    v_mfma_f32_16x16x32_bf16 v[84:87], a[92:95], v[56:59], v[84:87]
    v_mfma_f32_16x16x32_bf16 v[88:91], a[88:91], v[60:63], v[88:91]
    v_mfma_f32_16x16x32_bf16 v[92:95], a[92:95], v[60:63], v[92:95]
    s_waitcnt lgkmcnt(4)
    v_mfma_f32_16x16x32_bf16 v[80:83], a[96:99], v[32:35], v[80:83]
    ds_read_b128 v[56:59], v15 offset:28672
    ds_read_b128 v[60:63], v15 offset:30720
    v_mfma_f32_16x16x32_bf16 v[84:87], a[100:103], v[32:35], v[84:87]
    v_mfma_f32_16x16x32_bf16 v[88:91], a[96:99], v[36:39], v[88:91]
    v_mfma_f32_16x16x32_bf16 v[92:95], a[100:103], v[36:39], v[92:95]
    s_waitcnt lgkmcnt(4)
    v_mfma_f32_16x16x32_bf16 v[80:83], a[104:107], v[40:43], v[80:83]
    v_mfma_f32_16x16x32_bf16 v[84:87], a[108:111], v[40:43], v[84:87]
    v_mfma_f32_16x16x32_bf16 v[88:91], a[104:107], v[44:47], v[88:91]
    v_mfma_f32_16x16x32_bf16 v[92:95], a[108:111], v[44:47], v[92:95]
    s_waitcnt vmcnt(0) lgkmcnt(0)
    s_barrier
    v_mfma_f32_16x16x32_bf16 v[80:83], a[112:115], v[48:51], v[80:83]
    ds_read_b128 v[32:35], v13 offset:32768
    ds_read_b128 v[36:39], v13 offset:34816
    v_mfma_f32_16x16x32_bf16 v[84:87], a[116:119], v[48:51], v[84:87]
    v_mfma_f32_16x16x32_bf16 v[88:91], a[112:115], v[52:55], v[88:91]
    v_mfma_f32_16x16x32_bf16 v[92:95], a[116:119], v[52:55], v[92:95]
    v_mfma_f32_16x16x32_bf16 v[80:83], a[120:123], v[56:59], v[80:83]
    ds_read_b128 v[40:43], v15 offset:32768
    ds_read_b128 v[44:47], v15 offset:34816
    v_mfma_f32_16x16x32_bf16 v[84:87], a[124:127], v[56:59], v[84:87]
    v_mfma_f32_16x16x32_bf16 v[88:91], a[120:123], v[60:63], v[88:91]
    v_mfma_f32_16x16x32_bf16 v[92:95], a[124:127], v[60:63], v[92:95]
    s_waitcnt lgkmcnt(2)
    v_mfma_f32_16x16x32_bf16 v[80:83], a[128:131], v[32:35], v[80:83]
    ds_read_b128 v[48:51], v13 offset:36864
    ds_read_b128 v[52:55], v13 offset:38912
    v_mfma_f32_16x16x32_bf16 v[84:87], a[132:135], v[32:35], v[84:87]
    ds_read_b128 v[56:59], v15 offset:36864
    ds_read_b128 v[60:63], v15 offset:38912
    v_mfma_f32_16x16x32_bf16 v[88:91], a[128:131], v[36:39], v[88:91]
    v_mfma_f32_16x16x32_bf16 v[92:95], a[132:135], v[36:39], v[92:95]
    s_waitcnt lgkmcnt(4)
    v_mfma_f32_16x16x32_bf16 v[80:83], a[136:139], v[40:43], v[80:83]
    ds_read_b128 v[32:35], v13 offset:40960
    ds_read_b128 v[36:39], v13 offset:43008
    v_mfma_f32_16x16x32_bf16 v[84:87], a[140:143], v[40:43], v[84:87]
    v_mfma_f32_16x16x32_bf16 v[88:91], a[136:139], v[44:47], v[88:91]
    v_mfma_f32_16x16x32_bf16 v[92:95], a[140:143], v[44:47], v[92:95]
    s_waitcnt lgkmcnt(4)
    v_mfma_f32_16x16x32_bf16 v[80:83], a[144:147], v[48:51], v[80:83]
    ds_read_b128 v[40:43], v15 offset:40960
    ds_read_b128 v[44:47], v15 offset:43008
    v_mfma_f32_16x16x32_bf16 v[84:87], a[148:151], v[48:51], v[84:87]
    v_mfma_f32_16x16x32_bf16 v[88:91], a[144:147], v[52:55], v[88:91]
    v_mfma_f32_16x16x32_bf16 v[92:95], a[148:151], v[52:55], v[92:95]
    s_waitcnt lgkmcnt(4)
    v_mfma_f32_16x16x32_bf16 v[80:83], a[152:155], v[56:59], v[80:83]
    ds_read_b128 v[48:51], v13 offset:45056
    ds_read_b128 v[52:55], v13 offset:47104
    v_mfma_f32_16x16x32_bf16 v[84:87], a[156:159], v[56:59], v[84:87]
    v_mfma_f32_16x16x32_bf16 v[88:91], a[152:155], v[60:63], v[88:91]
    v_mfma_f32_16x16x32_bf16 v[92:95], a[156:159], v[60:63], v[92:95]
    s_waitcnt lgkmcnt(4)
    v_mfma_f32_16x16x32_bf16 v[80:83], a[160:163], v[32:35], v[80:83]
    ds_read_b128 v[56:59], v15 offset:45056
    ds_read_b128 v[60:63], v15 offset:47104
    v_mfma_f32_16x16x32_bf16 v[84:87], a[164:167], v[32:35], v[84:87]
    v_mfma_f32_16x16x32_bf16 v[88:91], a[160:163], v[36:39], v[88:91]
    v_mfma_f32_16x16x32_bf16 v[92:95], a[164:167], v[36:39], v[92:95]
    s_waitcnt lgkmcnt(4)
    v_mfma_f32_16x16x32_bf16 v[80:83], a[168:171], v[40:43], v[80:83]
    ds_read_b128 v[32:35], v13 offset:49152
    ds_read_b128 v[36:39], v13 offset:51200
    v_mfma_f32_16x16x32_bf16 v[84:87], a[172:175], v[40:43], v[84:87]
    v_mfma_f32_16x16x32_bf16 v[88:91], a[168:171], v[44:47], v[88:91]
    v_mfma_f32_16x16x32_bf16 v[92:95], a[172:175], v[44:47], v[92:95]
    s_waitcnt lgkmcnt(4)
    v_mfma_f32_16x16x32_bf16 v[80:83], a[176:179], v[48:51], v[80:83]
    ds_read_b128 v[40:43], v15 offset:49152
    ds_read_b128 v[44:47], v15 offset:51200
    v_mfma_f32_16x16x32_bf16 v[84:87], a[180:183], v[48:51], v[84:87]
    v_mfma_f32_16x16x32_bf16 v[88:91], a[176:179], v[52:55], v[88:91]
    v_mfma_f32_16x16x32_bf16 v[92:95], a[180:183], v[52:55], v[92:95]
    s_waitcnt lgkmcnt(4)
    v_mfma_f32_16x16x32_bf16 v[80:83], a[184:187], v[56:59], v[80:83]
    ds_read_b128 v[48:51], v13 offset:53248
    ds_read_b128 v[52:55], v13 offset:55296
    v_mfma_f32_16x16x32_bf16 v[84:87], a[188:191], v[56:59], v[84:87]
    v_mfma_f32_16x16x32_bf16 v[88:91], a[184:187], v[60:63], v[88:91]
    v_mfma_f32_16x16x32_bf16 v[92:95], a[188:191], v[60:63], v[92:95]
    s_waitcnt lgkmcnt(4)
    v_mfma_f32_16x16x32_bf16 v[80:83], a[192:195], v[32:35], v[80:83]
    ds_read_b128 v[56:59], v15 offset:53248
    ds_read_b128 v[60:63], v15 offset:55296
    v_mfma_f32_16x16x32_bf16 v[84:87], a[196:199], v[32:35], v[84:87]
    v_mfma_f32_16x16x32_bf16 v[88:91], a[192:195], v[36:39], v[88:91]
    v_mfma_f32_16x16x32_bf16 v[92:95], a[196:199], v[36:39], v[92:95]
    s_waitcnt lgkmcnt(4)
    v_mfma_f32_16x16x32_bf16 v[80:83], a[200:203], v[40:43], v[80:83]
    ds_read_b128 v[32:35], v13 offset:57344
    ds_read_b128 v[36:39], v13 offset:59392
    v_mfma_f32_16x16x32_bf16 v[84:87], a[204:207], v[40:43], v[84:87]
    v_mfma_f32_16x16x32_bf16 v[88:91], a[200:203], v[44:47], v[88:91]
    v_mfma_f32_16x16x32_bf16 v[92:95], a[204:207], v[44:47], v[92:95]
    s_waitcnt lgkmcnt(4)
    v_mfma_f32_16x16x32_bf16 v[80:83], a[208:211], v[48:51], v[80:83]
    ds_read_b128 v[40:43], v15 offset:57344
    ds_read_b128 v[44:47], v15 offset:59392
    v_mfma_f32_16x16x32_bf16 v[84:87], a[212:215], v[48:51], v[84:87]
    v_mfma_f32_16x16x32_bf16 v[88:91], a[208:211], v[52:55], v[88:91]
    v_mfma_f32_16x16x32_bf16 v[92:95], a[212:215], v[52:55], v[92:95]
    s_waitcnt lgkmcnt(4)
    v_mfma_f32_16x16x32_bf16 v[80:83], a[216:219], v[56:59], v[80:83]
    ds_read_b128 v[48:51], v13 offset:61440
    ds_read_b128 v[52:55], v13 offset:63488
    v_mfma_f32_16x16x32_bf16 v[84:87], a[220:223], v[56:59], v[84:87]
    v_mfma_f32_16x16x32_bf16 v[88:91], a[216:219], v[60:63], v[88:91]
    v_mfma_f32_16x16x32_bf16 v[92:95], a[220:223], v[60:63], v[92:95]
    s_waitcnt lgkmcnt(4)
    v_mfma_f32_16x16x32_bf16 v[80:83], a[224:227], v[32:35], v[80:83]
    ds_read_b128 v[56:59], v15 offset:61440
    ds_read_b128 v[60:63], v15 offset:63488
    v_mfma_f32_16x16x32_bf16 v[84:87], a[228:231], v[32:35], v[84:87]
    v_mfma_f32_16x16x32_bf16 v[88:91], a[224:227], v[36:39], v[88:91]
    v_mfma_f32_16x16x32_bf16 v[92:95], a[228:231], v[36:39], v[92:95]
    s_waitcnt lgkmcnt(4)
    v_mfma_f32_16x16x32_bf16 v[80:83], a[232:235], v[40:43], v[80:83]
    v_mfma_f32_16x16x32_bf16 v[84:87], a[236:239], v[40:43], v[84:87]
    v_mfma_f32_16x16x32_bf16 v[88:91], a[232:235], v[44:47], v[88:91]
    v_mfma_f32_16x16x32_bf16 v[92:95], a[236:239], v[44:47], v[92:95]
    s_waitcnt lgkmcnt(0)
    v_mfma_f32_16x16x32_bf16 v[80:83], a[240:243], v[48:51], v[80:83]
    v_mfma_f32_16x16x32_bf16 v[84:87], a[244:247], v[48:51], v[84:87]
    v_mfma_f32_16x16x32_bf16 v[88:91], a[240:243], v[52:55], v[88:91]
    v_mfma_f32_16x16x32_bf16 v[92:95], a[244:247], v[52:55], v[92:95]
    v_mfma_f32_16x16x32_bf16 v[80:83], a[248:251], v[56:59], v[80:83]
    v_mfma_f32_16x16x32_bf16 v[84:87], a[252:255], v[56:59], v[84:87]
    v_mfma_f32_16x16x32_bf16 v[88:91], a[248:251], v[60:63], v[88:91]
    v_mfma_f32_16x16x32_bf16 v[92:95], a[252:255], v[60:63], v[92:95]
    s_mov_b32 s76, s57
    s_nop 6
    v_cvt_pk_bf16_f32 v216, v80, v81
    v_cvt_pk_bf16_f32 v217, v82, v83
    v_cvt_pk_bf16_f32 v218, v84, v85
    v_cvt_pk_bf16_f32 v219, v86, v87
    v_cvt_pk_bf16_f32 v220, v88, v89
    v_cvt_pk_bf16_f32 v221, v90, v91
    v_cvt_pk_bf16_f32 v222, v92, v93
    v_cvt_pk_bf16_f32 v223, v94, v95
    buffer_store_dwordx4 v[216:219], v10, s[12:15], s76 offen sc1
    buffer_store_dwordx4 v[220:223], v10, s[12:15], s76 offen offset:1024 sc1
L_e_fin_121:
    s_waitcnt lgkmcnt(0)
    s_add_u32 s60, s60, s51
    s_waitcnt vmcnt(0)
    s_barrier
    s_cmp_lg_u32 s44, 0
    s_cbranch_scc1 L_pub_123
    v_mov_b32 v30, s60
    v_mov_b32 v31, 0
    s_mov_b64 exec, 1
    buffer_store_dword v30, v31, s[12:15], s61 offen sc1
    s_mov_b64 exec, -1
L_pub_123:
    s_cmp_eq_u32 s60, 2
    s_cselect_b32 s51, 10, s51
    s_cmp_eq_u32 s60, 12
    s_cselect_b32 s51, 52, s51
    s_cselect_b32 s71, 127104, s71
    s_cbranch_scc1 L_w_qkv_116
    s_cmp_lt_u32 s60, 64
    s_cbranch_scc1 L_w_qkv_116_n
L_w_roles_100:
    s_cmp_lg_u32 s44, 0
    s_cbranch_scc1 L_gj_124
    s_getreg_b32 s45, hwreg(HW_REG_XCC_ID)
    s_and_b32 s45, s45, 15
    s_mul_i32 s46, s45, s45
    s_lshl_b32 s46, s46, 9
    s_add_u32 s45, s45, s46
    s_add_u32 s45, s45, 16777216
    v_mov_b32 v30, s45
    s_lshl_b32 s45, s40, 7
    v_mov_b32 v31, 127488
    s_mov_b64 exec, 1
    buffer_atomic_add v30, v31, s[12:15], s45 offen sc1
    s_mov_b64 exec, -1
L_gj_124:
    s_mov_b32 s36, 0x1111111
    s_mov_b32 s37, 0x55222081
    s_cmp_eq_u32 s42, 0
    s_cselect_b32 s36, s36, 0x10000000
    s_cselect_b32 s37, s37, 0xaa888410
    s_mov_b32 s72, 0x88888888
    s_mov_b32 s73, 0xffd55248
    s_lshr_b32 s38, s41, 3
    s_and_b32 s68, s41, 7
    s_cmp_eq_u32 s43, 1
    s_cbranch_scc1 L_role_b_125
    s_cmp_eq_u32 s43, 2
    s_cbranch_scc1 L_role_c_126
    s_load_dwordx2 s[6:7], s[0:1], 40
    s_waitcnt lgkmcnt(0)
    s_mov_b32 s24, s6
    s_and_b32 s25, s7, 0xffff
    s_mov_b32 s26, 0x800000
    s_mov_b32 s27, 0x00020000
    s_lshl_b32 s46, s38, 21
    s_lshl_b32 s45, s68, 8
    s_add_u32 s46, s46, s45
    s_waitcnt vmcnt(0)
    s_barrier
    v_lshrrev_b32 v20, 4, v1
    s_lshl_b32 s45, s44, 2
    v_add_u32 v21, s45, v20
    s_mov_b32 s45, 2048
    v_mul_lo_u32 v21, v21, s45
    v_lshlrev_b32 v22, 2, v20
    v_and_b32 v23, 15, v1
    v_xor_b32 v22, v22, v23
    v_lshlrev_b32 v22, 4, v22
    v_add_u32 v21, v21, v22
    v_bfe_u32 v22, v1, 2, 2
    v_lshlrev_b32 v23, 2, v20
    v_add_u32 v23, v23, v22
    v_lshlrev_b32 v23, 8, v23
    v_xor_b32 v22, s44, v22
    v_lshlrev_b32 v22, 6, v22
    v_add_u32 v23, v23, v22
    v_and_b32 v22, 3, v1
    v_lshlrev_b32 v22, 3, v22
    v_add_u32 v23, v23, v22
    v_add_u32 v24, 65536, v23
    v_add_u32 v25, 131072, v23
    s_lshl_b32 s47, s44, 10
    s_add_u32 s45, s46, 0x0
    s_add_u32 m0, s47, 0
    s_nop 0
    buffer_load_dwordx4 v21, s[24:27], s45 offen  lds
    s_add_u32 s45, s46, 0x8000
    s_add_u32 m0, s47, 4096
    s_nop 0
    buffer_load_dwordx4 v21, s[24:27], s45 offen  lds
    s_add_u32 s45, s46, 0x10000
    s_add_u32 m0, s47, 8192
    s_nop 0
    buffer_load_dwordx4 v21, s[24:27], s45 offen  lds
    s_add_u32 s45, s46, 0x18000
    s_add_u32 m0, s47, 12288
    s_nop 0
    buffer_load_dwordx4 v21, s[24:27], s45 offen  lds
    s_add_u32 s45, s46, 0x20000
    s_add_u32 m0, s47, 16384
    s_nop 0
    buffer_load_dwordx4 v21, s[24:27], s45 offen  lds
    s_add_u32 s45, s46, 0x28000
    s_add_u32 m0, s47, 20480
    s_nop 0
    buffer_load_dwordx4 v21, s[24:27], s45 offen  lds
    s_add_u32 s45, s46, 0x30000
    s_add_u32 m0, s47, 24576
    s_nop 0
    buffer_load_dwordx4 v21, s[24:27], s45 offen  lds
    s_add_u32 s45, s46, 0x38000
    s_add_u32 m0, s47, 28672
    s_nop 0
    buffer_load_dwordx4 v21, s[24:27], s45 offen  lds
    s_add_u32 s45, s46, 0x40000
    s_add_u32 m0, s47, 32768
    s_nop 0
    buffer_load_dwordx4 v21, s[24:27], s45 offen  lds
    s_add_u32 s45, s46, 0x48000
    s_add_u32 m0, s47, 36864
    s_nop 0
    buffer_load_dwordx4 v21, s[24:27], s45 offen  lds
    s_add_u32 s45, s46, 0x50000
    s_add_u32 m0, s47, 40960
    s_nop 0
    buffer_load_dwordx4 v21, s[24:27], s45 offen  lds
    s_add_u32 s45, s46, 0x58000
    s_add_u32 m0, s47, 45056
    s_nop 0
    buffer_load_dwordx4 v21, s[24:27], s45 offen  lds
    s_add_u32 s45, s46, 0x60000
    s_add_u32 m0, s47, 49152
    s_nop 0
    buffer_load_dwordx4 v21, s[24:27], s45 offen  lds
    s_add_u32 s45, s46, 0x68000
    s_add_u32 m0, s47, 53248
    s_nop 0
    buffer_load_dwordx4 v21, s[24:27], s45 offen  lds
    s_add_u32 s45, s46, 0x70000
    s_add_u32 m0, s47, 57344
    s_nop 0
    buffer_load_dwordx4 v21, s[24:27], s45 offen  lds
    s_add_u32 s45, s46, 0x78000
    s_add_u32 m0, s47, 61440
    s_nop 0
    buffer_load_dwordx4 v21, s[24:27], s45 offen  lds
    s_add_u32 s45, s46, 0x80000
    s_add_u32 m0, s47, 65536
    s_nop 0
    buffer_load_dwordx4 v21, s[24:27], s45 offen  lds
    s_add_u32 s45, s46, 0x88000
    s_add_u32 m0, s47, 69632
    s_nop 0
    buffer_load_dwordx4 v21, s[24:27], s45 offen  lds
    s_add_u32 s45, s46, 0x90000
    s_add_u32 m0, s47, 73728
    s_nop 0
    buffer_load_dwordx4 v21, s[24:27], s45 offen  lds
    s_add_u32 s45, s46, 0x98000
    s_add_u32 m0, s47, 77824
    s_nop 0
    buffer_load_dwordx4 v21, s[24:27], s45 offen  lds
    s_add_u32 s45, s46, 0xa0000
    s_add_u32 m0, s47, 81920
    s_nop 0
    buffer_load_dwordx4 v21, s[24:27], s45 offen  lds
    s_add_u32 s45, s46, 0xa8000
    s_add_u32 m0, s47, 86016
    s_nop 0
    buffer_load_dwordx4 v21, s[24:27], s45 offen  lds
    s_add_u32 s45, s46, 0xb0000
    s_add_u32 m0, s47, 90112
    s_nop 0
    buffer_load_dwordx4 v21, s[24:27], s45 offen  lds
    s_add_u32 s45, s46, 0xb8000
    s_add_u32 m0, s47, 94208
    s_nop 0
    buffer_load_dwordx4 v21, s[24:27], s45 offen  lds
    s_add_u32 s45, s46, 0xc0000
    s_add_u32 m0, s47, 98304
    s_nop 0
    buffer_load_dwordx4 v21, s[24:27], s45 offen  lds
    s_add_u32 s45, s46, 0xc8000
    s_add_u32 m0, s47, 102400
    s_nop 0
    buffer_load_dwordx4 v21, s[24:27], s45 offen  lds
    s_add_u32 s45, s46, 0xd0000
    s_add_u32 m0, s47, 106496
    s_nop 0
    buffer_load_dwordx4 v21, s[24:27], s45 offen  lds
    s_add_u32 s45, s46, 0xd8000
    s_add_u32 m0, s47, 110592
    s_nop 0
    buffer_load_dwordx4 v21, s[24:27], s45 offen  lds
    s_add_u32 s45, s46, 0xe0000
    s_add_u32 m0, s47, 114688
    s_nop 0
    buffer_load_dwordx4 v21, s[24:27], s45 offen  lds
    s_add_u32 s45, s46, 0xe8000
    s_add_u32 m0, s47, 118784
    s_nop 0
    buffer_load_dwordx4 v21, s[24:27], s45 offen  lds
    s_add_u32 s45, s46, 0xf0000
    s_add_u32 m0, s47, 122880
    s_nop 0
    buffer_load_dwordx4 v21, s[24:27], s45 offen  lds
    s_add_u32 s45, s46, 0xf8000
    s_add_u32 m0, s47, 126976
    s_nop 0
    buffer_load_dwordx4 v21, s[24:27], s45 offen  lds
    s_waitcnt vmcnt(28)
    s_barrier
    s_add_u32 s45, s46, 0x100000
    s_add_u32 m0, s47, 131072
    s_nop 0
    buffer_load_dwordx4 v21, s[24:27], s45 offen  lds
    s_add_u32 s45, s46, 0x108000
    s_add_u32 m0, s47, 135168
    s_nop 0
    buffer_load_dwordx4 v21, s[24:27], s45 offen  lds
    s_add_u32 s45, s46, 0x110000
    s_add_u32 m0, s47, 139264
    s_nop 0
    buffer_load_dwordx4 v21, s[24:27], s45 offen  lds
    s_add_u32 s45, s46, 0x118000
    s_add_u32 m0, s47, 143360
    s_nop 0
    buffer_load_dwordx4 v21, s[24:27], s45 offen  lds
    ds_read_b64_tr_b16 a[0:1], v23 offset:0
    ds_read_b64_tr_b16 a[2:3], v23 offset:4096
    ds_read_b64_tr_b16 a[4:5], v23 offset:32
    ds_read_b64_tr_b16 a[6:7], v23 offset:4128
    ds_read_b64_tr_b16 a[8:9], v23 offset:8192
    ds_read_b64_tr_b16 a[10:11], v23 offset:12288
    ds_read_b64_tr_b16 a[12:13], v23 offset:8224
    ds_read_b64_tr_b16 a[14:15], v23 offset:12320
    s_waitcnt lgkmcnt(0)
    s_waitcnt vmcnt(28)
    s_barrier
    s_add_u32 s45, s46, 0x120000
    s_add_u32 m0, s47, 0
    s_nop 0
    buffer_load_dwordx4 v21, s[24:27], s45 offen  lds
    s_add_u32 s45, s46, 0x128000
    s_add_u32 m0, s47, 4096
    s_nop 0
    buffer_load_dwordx4 v21, s[24:27], s45 offen  lds
    s_add_u32 s45, s46, 0x130000
    s_add_u32 m0, s47, 8192
    s_nop 0
    buffer_load_dwordx4 v21, s[24:27], s45 offen  lds
    s_add_u32 s45, s46, 0x138000
    s_add_u32 m0, s47, 12288
    s_nop 0
    buffer_load_dwordx4 v21, s[24:27], s45 offen  lds
    ds_read_b64_tr_b16 a[16:17], v23 offset:16384
    ds_read_b64_tr_b16 a[18:19], v23 offset:20480
    ds_read_b64_tr_b16 a[20:21], v23 offset:16416
    ds_read_b64_tr_b16 a[22:23], v23 offset:20512
    ds_read_b64_tr_b16 a[24:25], v23 offset:24576
    ds_read_b64_tr_b16 a[26:27], v23 offset:28672
    ds_read_b64_tr_b16 a[28:29], v23 offset:24608
    ds_read_b64_tr_b16 a[30:31], v23 offset:28704
    s_waitcnt lgkmcnt(0)
    s_waitcnt vmcnt(28)
    s_barrier
    s_add_u32 s45, s46, 0x140000
    s_add_u32 m0, s47, 16384
    s_nop 0
    buffer_load_dwordx4 v21, s[24:27], s45 offen  lds
    s_add_u32 s45, s46, 0x148000
    s_add_u32 m0, s47, 20480
    s_nop 0
    buffer_load_dwordx4 v21, s[24:27], s45 offen  lds
    s_add_u32 s45, s46, 0x150000
    s_add_u32 m0, s47, 24576
    s_nop 0
    buffer_load_dwordx4 v21, s[24:27], s45 offen  lds
    s_add_u32 s45, s46, 0x158000
    s_add_u32 m0, s47, 28672
    s_nop 0
    buffer_load_dwordx4 v21, s[24:27], s45 offen  lds
    ds_read_b64_tr_b16 a[32:33], v23 offset:32768
    ds_read_b64_tr_b16 a[34:35], v23 offset:36864
    ds_read_b64_tr_b16 a[36:37], v23 offset:32800
    ds_read_b64_tr_b16 a[38:39], v23 offset:36896
    ds_read_b64_tr_b16 a[40:41], v23 offset:40960
    ds_read_b64_tr_b16 a[42:43], v23 offset:45056
    ds_read_b64_tr_b16 a[44:45], v23 offset:40992
    ds_read_b64_tr_b16 a[46:47], v23 offset:45088
    s_waitcnt lgkmcnt(0)
    s_waitcnt vmcnt(28)
    s_barrier
    s_add_u32 s45, s46, 0x160000
    s_add_u32 m0, s47, 32768
    s_nop 0
    buffer_load_dwordx4 v21, s[24:27], s45 offen  lds
    s_add_u32 s45, s46, 0x168000
    s_add_u32 m0, s47, 36864
    s_nop 0
    buffer_load_dwordx4 v21, s[24:27], s45 offen  lds
    s_add_u32 s45, s46, 0x170000
    s_add_u32 m0, s47, 40960
    s_nop 0
    buffer_load_dwordx4 v21, s[24:27], s45 offen  lds
    s_add_u32 s45, s46, 0x178000
    s_add_u32 m0, s47, 45056
    s_nop 0
    buffer_load_dwordx4 v21, s[24:27], s45 offen  lds
    ds_read_b64_tr_b16 a[48:49], v23 offset:49152
    ds_read_b64_tr_b16 a[50:51], v23 offset:53248
    ds_read_b64_tr_b16 a[52:53], v23 offset:49184
    ds_read_b64_tr_b16 a[54:55], v23 offset:53280
    ds_read_b64_tr_b16 a[56:57], v23 offset:57344
    ds_read_b64_tr_b16 a[58:59], v23 offset:61440
    ds_read_b64_tr_b16 a[60:61], v23 offset:57376
    ds_read_b64_tr_b16 a[62:63], v23 offset:61472
    s_waitcnt lgkmcnt(0)
    s_waitcnt vmcnt(28)
    s_barrier
    s_add_u32 s45, s46, 0x180000
    s_add_u32 m0, s47, 49152
    s_nop 0
    buffer_load_dwordx4 v21, s[24:27], s45 offen  lds
    s_add_u32 s45, s46, 0x188000
    s_add_u32 m0, s47, 53248
    s_nop 0
    buffer_load_dwordx4 v21, s[24:27], s45 offen  lds
    s_add_u32 s45, s46, 0x190000
    s_add_u32 m0, s47, 57344
    s_nop 0
    buffer_load_dwordx4 v21, s[24:27], s45 offen  lds
    s_add_u32 s45, s46, 0x198000
    s_add_u32 m0, s47, 61440
    s_nop 0
    buffer_load_dwordx4 v21, s[24:27], s45 offen  lds
    ds_read_b64_tr_b16 a[64:65], v24 offset:0
    ds_read_b64_tr_b16 a[66:67], v24 offset:4096
    ds_read_b64_tr_b16 a[68:69], v24 offset:32
    ds_read_b64_tr_b16 a[70:71], v24 offset:4128
    ds_read_b64_tr_b16 a[72:73], v24 offset:8192
    ds_read_b64_tr_b16 a[74:75], v24 offset:12288
    ds_read_b64_tr_b16 a[76:77], v24 offset:8224
    ds_read_b64_tr_b16 a[78:79], v24 offset:12320
    s_waitcnt lgkmcnt(0)
    s_waitcnt vmcnt(28)
    s_barrier
    s_add_u32 s45, s46, 0x1a0000
    s_add_u32 m0, s47, 65536
    s_nop 0
    buffer_load_dwordx4 v21, s[24:27], s45 offen  lds
    s_add_u32 s45, s46, 0x1a8000
    s_add_u32 m0, s47, 69632
    s_nop 0
    buffer_load_dwordx4 v21, s[24:27], s45 offen  lds
    s_add_u32 s45, s46, 0x1b0000
    s_add_u32 m0, s47, 73728
    s_nop 0
    buffer_load_dwordx4 v21, s[24:27], s45 offen  lds
    s_add_u32 s45, s46, 0x1b8000
    s_add_u32 m0, s47, 77824
    s_nop 0
    buffer_load_dwordx4 v21, s[24:27], s45 offen  lds
    ds_read_b64_tr_b16 a[80:81], v24 offset:16384
    ds_read_b64_tr_b16 a[82:83], v24 offset:20480
    ds_read_b64_tr_b16 a[84:85], v24 offset:16416
    ds_read_b64_tr_b16 a[86:87], v24 offset:20512
    ds_read_b64_tr_b16 a[88:89], v24 offset:24576
    ds_read_b64_tr_b16 a[90:91], v24 offset:28672
    ds_read_b64_tr_b16 a[92:93], v24 offset:24608
    ds_read_b64_tr_b16 a[94:95], v24 offset:28704
    s_waitcnt lgkmcnt(0)
    s_waitcnt vmcnt(28)
    s_barrier
    s_add_u32 s45, s46, 0x1c0000
    s_add_u32 m0, s47, 81920
    s_nop 0
    buffer_load_dwordx4 v21, s[24:27], s45 offen  lds
    s_add_u32 s45, s46, 0x1c8000
    s_add_u32 m0, s47, 86016
    s_nop 0
    buffer_load_dwordx4 v21, s[24:27], s45 offen  lds
    s_add_u32 s45, s46, 0x1d0000
    s_add_u32 m0, s47, 90112
    s_nop 0
    buffer_load_dwordx4 v21, s[24:27], s45 offen  lds
    s_add_u32 s45, s46, 0x1d8000
    s_add_u32 m0, s47, 94208
    s_nop 0
    buffer_load_dwordx4 v21, s[24:27], s45 offen  lds
    ds_read_b64_tr_b16 a[96:97], v24 offset:32768
    ds_read_b64_tr_b16 a[98:99], v24 offset:36864
    ds_read_b64_tr_b16 a[100:101], v24 offset:32800
    ds_read_b64_tr_b16 a[102:103], v24 offset:36896
    ds_read_b64_tr_b16 a[104:105], v24 offset:40960
    ds_read_b64_tr_b16 a[106:107], v24 offset:45056
    ds_read_b64_tr_b16 a[108:109], v24 offset:40992
    ds_read_b64_tr_b16 a[110:111], v24 offset:45088
    s_waitcnt lgkmcnt(0)
    s_waitcnt vmcnt(28)
    s_barrier
    s_add_u32 s45, s46, 0x1e0000
    s_add_u32 m0, s47, 98304
    s_nop 0
    buffer_load_dwordx4 v21, s[24:27], s45 offen  lds
    s_add_u32 s45, s46, 0x1e8000
    s_add_u32 m0, s47, 102400
    s_nop 0
    buffer_load_dwordx4 v21, s[24:27], s45 offen  lds
    s_add_u32 s45, s46, 0x1f0000
    s_add_u32 m0, s47, 106496
    s_nop 0
    buffer_load_dwordx4 v21, s[24:27], s45 offen  lds
    s_add_u32 s45, s46, 0x1f8000
    s_add_u32 m0, s47, 110592
    s_nop 0
    buffer_load_dwordx4 v21, s[24:27], s45 offen  lds
    ds_read_b64_tr_b16 a[112:113], v24 offset:49152
    ds_read_b64_tr_b16 a[114:115], v24 offset:53248
    ds_read_b64_tr_b16 a[116:117], v24 offset:49184
    ds_read_b64_tr_b16 a[118:119], v24 offset:53280
    ds_read_b64_tr_b16 a[120:121], v24 offset:57344
    ds_read_b64_tr_b16 a[122:123], v24 offset:61440
    ds_read_b64_tr_b16 a[124:125], v24 offset:57376
    ds_read_b64_tr_b16 a[126:127], v24 offset:61472
    s_waitcnt lgkmcnt(0)
    s_waitcnt vmcnt(28)
    s_barrier
    ds_read_b64_tr_b16 a[128:129], v25 offset:0
    ds_read_b64_tr_b16 a[130:131], v25 offset:4096
    ds_read_b64_tr_b16 a[132:133], v25 offset:32
    ds_read_b64_tr_b16 a[134:135], v25 offset:4128
    ds_read_b64_tr_b16 a[136:137], v25 offset:8192
    ds_read_b64_tr_b16 a[138:139], v25 offset:12288
    ds_read_b64_tr_b16 a[140:141], v25 offset:8224
    ds_read_b64_tr_b16 a[142:143], v25 offset:12320
    s_waitcnt lgkmcnt(0)
    s_waitcnt vmcnt(24)
    s_barrier
    ds_read_b64_tr_b16 a[144:145], v23 offset:0
    ds_read_b64_tr_b16 a[146:147], v23 offset:4096
    ds_read_b64_tr_b16 a[148:149], v23 offset:32
    ds_read_b64_tr_b16 a[150:151], v23 offset:4128
    ds_read_b64_tr_b16 a[152:153], v23 offset:8192
    ds_read_b64_tr_b16 a[154:155], v23 offset:12288
    ds_read_b64_tr_b16 a[156:157], v23 offset:8224
    ds_read_b64_tr_b16 a[158:159], v23 offset:12320
    s_waitcnt lgkmcnt(0)
    s_waitcnt vmcnt(20)
    s_barrier
    ds_read_b64_tr_b16 a[160:161], v23 offset:16384
    ds_read_b64_tr_b16 a[162:163], v23 offset:20480
    ds_read_b64_tr_b16 a[164:165], v23 offset:16416
    ds_read_b64_tr_b16 a[166:167], v23 offset:20512
    ds_read_b64_tr_b16 a[168:169], v23 offset:24576
    ds_read_b64_tr_b16 a[170:171], v23 offset:28672
    ds_read_b64_tr_b16 a[172:173], v23 offset:24608
    ds_read_b64_tr_b16 a[174:175], v23 offset:28704
    s_waitcnt lgkmcnt(0)
    s_waitcnt vmcnt(16)
    s_barrier
    ds_read_b64_tr_b16 a[176:177], v23 offset:32768
    ds_read_b64_tr_b16 a[178:179], v23 offset:36864
    ds_read_b64_tr_b16 a[180:181], v23 offset:32800
    ds_read_b64_tr_b16 a[182:183], v23 offset:36896
    ds_read_b64_tr_b16 a[184:185], v23 offset:40960
    ds_read_b64_tr_b16 a[186:187], v23 offset:45056
    ds_read_b64_tr_b16 a[188:189], v23 offset:40992
    ds_read_b64_tr_b16 a[190:191], v23 offset:45088
    s_waitcnt lgkmcnt(0)
    s_waitcnt vmcnt(12)
    s_barrier
    ds_read_b64_tr_b16 a[192:193], v23 offset:49152
    ds_read_b64_tr_b16 a[194:195], v23 offset:53248
    ds_read_b64_tr_b16 a[196:197], v23 offset:49184
    ds_read_b64_tr_b16 a[198:199], v23 offset:53280
    ds_read_b64_tr_b16 a[200:201], v23 offset:57344
    ds_read_b64_tr_b16 a[202:203], v23 offset:61440
    ds_read_b64_tr_b16 a[204:205], v23 offset:57376
    ds_read_b64_tr_b16 a[206:207], v23 offset:61472
    s_waitcnt lgkmcnt(0)
    s_waitcnt vmcnt(8)
    s_barrier
    ds_read_b64_tr_b16 a[208:209], v24 offset:0
    ds_read_b64_tr_b16 a[210:211], v24 offset:4096
    ds_read_b64_tr_b16 a[212:213], v24 offset:32
    ds_read_b64_tr_b16 a[214:215], v24 offset:4128
    ds_read_b64_tr_b16 a[216:217], v24 offset:8192
    ds_read_b64_tr_b16 a[218:219], v24 offset:12288
    ds_read_b64_tr_b16 a[220:221], v24 offset:8224
    ds_read_b64_tr_b16 a[222:223], v24 offset:12320
    s_waitcnt lgkmcnt(0)
    s_waitcnt vmcnt(4)
    s_barrier
    ds_read_b64_tr_b16 a[224:225], v24 offset:16384
    ds_read_b64_tr_b16 a[226:227], v24 offset:20480
    ds_read_b64_tr_b16 a[228:229], v24 offset:16416
    ds_read_b64_tr_b16 a[230:231], v24 offset:20512
    ds_read_b64_tr_b16 a[232:233], v24 offset:24576
    ds_read_b64_tr_b16 a[234:235], v24 offset:28672
    ds_read_b64_tr_b16 a[236:237], v24 offset:24608
    ds_read_b64_tr_b16 a[238:239], v24 offset:28704
    s_waitcnt lgkmcnt(0)
    s_waitcnt vmcnt(0)
    s_barrier
    ds_read_b64_tr_b16 a[240:241], v24 offset:32768
    ds_read_b64_tr_b16 a[242:243], v24 offset:36864
    ds_read_b64_tr_b16 a[244:245], v24 offset:32800
    ds_read_b64_tr_b16 a[246:247], v24 offset:36896
    ds_read_b64_tr_b16 a[248:249], v24 offset:40960
    ds_read_b64_tr_b16 a[250:251], v24 offset:45056
    ds_read_b64_tr_b16 a[252:253], v24 offset:40992
    ds_read_b64_tr_b16 a[254:255], v24 offset:45088
    s_waitcnt lgkmcnt(0)
    s_barrier
    s_lshl_b32 s52, s38, 16
    s_add_u32 s52, s52, 0x5000000
    s_lshl_b32 s56, s38, 23
    s_lshl_b32 s45, s68, 9
    s_add_u32 s56, s56, s45
    s_add_u32 s56, s56, 0x8000000
    s_lshl_b32 s45, s40, 7
    s_add_u32 s45, s45, 127488
    v_mov_b32 v29, s45
    s_mov_b32 s46, 536870912
    s_mov_b64 exec, 1
    s_mov_b32 s70, 0
L_wp_129:
    buffer_load_dword v31, v29, s[12:15], 0 offen sc1
    s_add_u32 s70, s70, 1
    s_cmp_ge_u32 s70, 0x200000
    s_cbranch_scc1 L_w_done_98
    s_waitcnt vmcnt(0)
    v_cmp_gt_u32 vcc, s46, v31
    s_nop 1
    s_cbranch_vccz L_wp_129_ok
    s_sleep 2
    s_branch L_wp_129
L_wp_129_ok:
    s_mov_b64 exec, -1
    v_readfirstlane_b32 s45, v31
    s_nop 3
    s_and_b32 s46, s45, 511
    s_mul_i32 s46, s46, s46
    s_bfe_u32 s45, s45, 0xf0009
    s_lshl_b32 s45, s45, 5
    s_mov_b32 s80, s12
    s_mov_b32 s81, s13
    s_mov_b32 s83, 0x00020000
    s_mov_b32 s84, s12
    s_mov_b32 s85, s13
    s_mov_b32 s87, 0x00020000
    s_cmp_eq_u32 s45, s46
    s_cselect_b32 s82, s14, 0
    s_cselect_b32 s86, 0, s14
    s_sub_u32 s79, 3, s44
    s_mov_b32 s78, 0
    s_cmp_eq_u64 s[36:37], 0
    s_cbranch_scc1 L_xl_130
    s_ff1_i32_b64 s47, s[36:37]
    s_lshr_b64 s[74:75], s[72:73], s47
    s_ff1_i32_b64 s48, s[74:75]
    s_cmp_gt_u32 s79, s48
    s_cbranch_scc1 L_xl_130
    s_add_u32 s47, s47, s79
    s_cmp_lt_u32 s47, s78
    s_cbranch_scc1 L_xl_130_go
    s_lshl_b32 s45, s41, 7
    s_add_u32 s45, s45, 0x10010
    s_add_u32 s46, s47, 1
    s_mov_b64 exec, 7
    s_mov_b32 s70, 0
L_wp_131:
    buffer_load_dword v31, v12, s[12:15], s45 offen sc1
    s_add_u32 s70, s70, 1
    s_cmp_ge_u32 s70, 0x200000
    s_cbranch_scc1 L_w_done_98
    s_waitcnt vmcnt(0)
    v_cmp_gt_u32 vcc, s46, v31
    s_nop 1
    s_cbranch_vccz L_wp_131_ok
    s_sleep 2
    s_branch L_wp_131
L_wp_131_ok:
    s_mov_b64 exec, -1
    v_readlane_b32 s78, v31, 0
    v_readlane_b32 s45, v31, 1
    v_readlane_b32 s46, v31, 2
    s_nop 3
    s_min_u32 s78, s78, s45
    s_min_u32 s78, s78, s46
L_xl_130_go:
    s_lshl_b32 s45, s41, 19
    s_lshl_b32 s46, s47, 13
    s_add_u32 s45, s45, s46
    s_add_u32 s45, s45, 0x2000000
    s_add_u32 s46, s45, 4096
    s_add_u32 s48, s45, 16777216
    s_add_u32 s49, s48, 4096
    s_add_u32 s76, s48, 16777216
    s_add_u32 s77, s76, 4096
    buffer_load_dwordx4 v[96:99], v10, s[12:15], s76 offen offset:0 sc1
    buffer_load_dwordx4 v[128:131], v10, s[12:15], s45 offen offset:0 sc1
    buffer_load_dwordx4 v[160:163], v10, s[12:15], s48 offen offset:0 sc1
    buffer_load_dwordx4 v[100:103], v10, s[12:15], s76 offen offset:1024 sc1
    buffer_load_dwordx4 v[144:147], v10, s[12:15], s45 offen offset:1024 sc1
    buffer_load_dwordx4 v[176:179], v10, s[12:15], s48 offen offset:1024 sc1
    buffer_load_dwordx4 v[104:107], v10, s[12:15], s76 offen offset:2048 sc1
    buffer_load_dwordx4 v[132:135], v10, s[12:15], s45 offen offset:2048 sc1
    buffer_load_dwordx4 v[164:167], v10, s[12:15], s48 offen offset:2048 sc1
    buffer_load_dwordx4 v[108:111], v10, s[12:15], s76 offen offset:3072 sc1
    buffer_load_dwordx4 v[148:151], v10, s[12:15], s45 offen offset:3072 sc1
    buffer_load_dwordx4 v[180:183], v10, s[12:15], s48 offen offset:3072 sc1
    buffer_load_dwordx4 v[112:115], v10, s[12:15], s77 offen offset:0 sc1
    buffer_load_dwordx4 v[136:139], v10, s[12:15], s46 offen offset:0 sc1
    buffer_load_dwordx4 v[168:171], v10, s[12:15], s49 offen offset:0 sc1
    buffer_load_dwordx4 v[116:119], v10, s[12:15], s77 offen offset:1024 sc1
    buffer_load_dwordx4 v[152:155], v10, s[12:15], s46 offen offset:1024 sc1
    buffer_load_dwordx4 v[184:187], v10, s[12:15], s49 offen offset:1024 sc1
    buffer_load_dwordx4 v[120:123], v10, s[12:15], s77 offen offset:2048 sc1
    buffer_load_dwordx4 v[140:143], v10, s[12:15], s46 offen offset:2048 sc1
    buffer_load_dwordx4 v[172:175], v10, s[12:15], s49 offen offset:2048 sc1
    buffer_load_dwordx4 v[124:127], v10, s[12:15], s77 offen offset:3072 sc1
    buffer_load_dwordx4 v[156:159], v10, s[12:15], s46 offen offset:3072 sc1
    buffer_load_dwordx4 v[188:191], v10, s[12:15], s49 offen offset:3072 sc1
L_xl_130:
L_a_loop_127:
    s_cmp_eq_u64 s[36:37], 0
    s_cbranch_scc1 L_w_done_98
    s_ff1_i32_b64 s50, s[36:37]
    s_bitset0_b64 s[36:37], s50
    s_lshr_b64 s[74:75], s[72:73], s50
    s_ff1_i32_b64 s51, s[74:75]
    s_add_u32 s51, s51, 1
    s_add_u32 s62, s50, s51
    s_add_u32 s63, s50, s79
    s_cmp_ge_u32 s79, s51
    s_cbranch_scc1 L_xs1_132
    s_lshl_b32 s47, s44, 13
    v_add_u32 v18, s47, v10
    v_and_b32 v14, 15, v1
    v_lshrrev_b32 v16, 4, v1
    s_waitcnt vmcnt(0)
    ds_write_b128 v18, v[96:99] offset:0
    ds_write_b128 v18, v[100:103] offset:1024
    ds_write_b128 v18, v[104:107] offset:2048
    ds_write_b128 v18, v[108:111] offset:3072
    ds_write_b128 v18, v[112:115] offset:4096
    ds_write_b128 v18, v[116:119] offset:5120
    ds_write_b128 v18, v[120:123] offset:6144
    ds_write_b128 v18, v[124:127] offset:7168
    v_mfma_f32_16x16x32_bf16 v[32:35], v[160:163], v[128:131], 0
    v_mfma_f32_16x16x32_bf16 v[36:39], v[160:163], v[144:147], 0
    v_mfma_f32_16x16x32_bf16 v[44:47], v[176:179], v[144:147], 0
    v_mfma_f32_16x16x32_bf16 v[32:35], v[164:167], v[132:135], v[32:35]
    v_mfma_f32_16x16x32_bf16 v[36:39], v[164:167], v[148:151], v[36:39]
    v_mfma_f32_16x16x32_bf16 v[44:47], v[180:183], v[148:151], v[44:47]
    v_mfma_f32_16x16x32_bf16 v[32:35], v[168:171], v[136:139], v[32:35]
    v_mfma_f32_16x16x32_bf16 v[36:39], v[168:171], v[152:155], v[36:39]
    v_mfma_f32_16x16x32_bf16 v[44:47], v[184:187], v[152:155], v[44:47]
    v_mfma_f32_16x16x32_bf16 v[32:35], v[172:175], v[140:143], v[32:35]
    v_mfma_f32_16x16x32_bf16 v[36:39], v[172:175], v[156:159], v[36:39]
    v_mfma_f32_16x16x32_bf16 v[44:47], v[188:191], v[156:159], v[44:47]
    v_lshlrev_b32 v19, 2, v16
    v_lshrrev_b32 v20, 2, v1
    v_lshlrev_b32 v20, 4, v20
    v_and_b32 v21, 1, v1
    v_lshlrev_b32 v21, 3, v21
    v_add3_u32 v20, v20, v21, s47
    v_and_b32 v21, 2, v1
    v_lshlrev_b32 v21, 7, v21
    v_add_u32 v20, v20, v21
    v_mov_b32 v22, 0xff800000
    s_waitcnt lgkmcnt(0)
    ds_read_b64_tr_b16 v[208:209], v20 offset:0
    ds_read_b64_tr_b16 v[210:211], v20 offset:1024
    ds_read_b64_tr_b16 v[212:213], v20 offset:512
    ds_read_b64_tr_b16 v[214:215], v20 offset:1536
    ds_read_b64_tr_b16 v[216:217], v20 offset:2048
    ds_read_b64_tr_b16 v[218:219], v20 offset:3072
    ds_read_b64_tr_b16 v[220:221], v20 offset:2560
    ds_read_b64_tr_b16 v[222:223], v20 offset:3584
    ds_read_b64_tr_b16 v[224:225], v20 offset:4096
    ds_read_b64_tr_b16 v[226:227], v20 offset:5120
    ds_read_b64_tr_b16 v[228:229], v20 offset:4608
    ds_read_b64_tr_b16 v[230:231], v20 offset:5632
    ds_read_b64_tr_b16 v[232:233], v20 offset:6144
    ds_read_b64_tr_b16 v[234:235], v20 offset:7168
    ds_read_b64_tr_b16 v[236:237], v20 offset:6656
    ds_read_b64_tr_b16 v[238:239], v20 offset:7680
    v_add_u32 v21, 0, v19
    v_cmp_gt_u32 vcc, v21, v14
    s_nop 1
    v_cndmask_b32 v32, v32, v22, vcc
    v_cndmask_b32 v44, v44, v22, vcc
    v_add_u32 v21, 1, v19
    v_cmp_gt_u32 vcc, v21, v14
    s_nop 1
    v_cndmask_b32 v33, v33, v22, vcc
    v_cndmask_b32 v45, v45, v22, vcc
    v_add_u32 v21, 2, v19
    v_cmp_gt_u32 vcc, v21, v14
    s_nop 1
    v_cndmask_b32 v34, v34, v22, vcc
    v_cndmask_b32 v46, v46, v22, vcc
    v_add_u32 v21, 3, v19
    v_cmp_gt_u32 vcc, v21, v14
    s_nop 1
    v_cndmask_b32 v35, v35, v22, vcc
    v_cndmask_b32 v47, v47, v22, vcc
L_xs1_132:
    s_lshl_b32 s45, s41, 7
    s_add_u32 s45, s45, 0x11000
    s_cmp_lg_u32 s44, 0
    s_cbranch_scc1 L_pw_134
    s_mov_b64 exec, 255
    s_mov_b32 s70, 0
L_wp_135:
    buffer_load_dword v31, v12, s[12:15], s45 offen sc1
    s_add_u32 s70, s70, 1
    s_cmp_ge_u32 s70, 0x200000
    s_cbranch_scc1 L_w_done_98
    s_waitcnt vmcnt(0)
    v_cmp_gt_u32 vcc, s62, v31
    s_nop 1
    s_cbranch_vccz L_wp_135_ok
    s_sleep 2
    s_branch L_wp_135
L_wp_135_ok:
    s_mov_b64 exec, -1
L_pw_134:
    s_barrier
    s_cmp_ge_u32 s79, s51
    s_cbranch_scc1 L_xs2_133
    s_lshl_b32 s45, s63, 17
    s_lshl_b32 s46, s41, 12
    s_add_u32 s45, s45, s46
    s_lshr_b32 s46, s45, 1
    s_add_u32 s45, s45, 0x1000000
    s_add_u32 s46, s46, 0x1800000
    v_lshlrev_b32 v21, 3, v1
    buffer_load_dwordx4 v[192:195], v10, s[12:15], s45 offen offset:0 sc1
    buffer_load_dwordx4 v[196:199], v10, s[12:15], s45 offen offset:1024 sc1
    buffer_load_dwordx4 v[200:203], v10, s[12:15], s45 offen offset:2048 sc1
    buffer_load_dwordx4 v[204:207], v10, s[12:15], s45 offen offset:3072 sc1
    buffer_load_dwordx2 v[240:241], v21, s[12:15], s46 offen offset:0 sc1
    buffer_load_dwordx2 v[242:243], v21, s[12:15], s46 offen offset:512 sc1
    buffer_load_dwordx2 v[244:245], v21, s[12:15], s46 offen offset:1024 sc1
    buffer_load_dwordx2 v[246:247], v21, s[12:15], s46 offen offset:1536 sc1
    s_waitcnt vmcnt(4)
    v_mfma_f32_16x16x32_bf16 v[48:51], v[192:195], v[128:131], 0
    v_mfma_f32_16x16x32_bf16 v[52:55], v[192:195], v[144:147], 0
    v_mfma_f32_16x16x32_bf16 v[48:51], v[196:199], v[132:135], v[48:51]
    v_mfma_f32_16x16x32_bf16 v[52:55], v[196:199], v[148:151], v[52:55]
    v_mfma_f32_16x16x32_bf16 v[48:51], v[200:203], v[136:139], v[48:51]
    v_mfma_f32_16x16x32_bf16 v[52:55], v[200:203], v[152:155], v[52:55]
    v_mfma_f32_16x16x32_bf16 v[48:51], v[204:207], v[140:143], v[48:51]
    v_mfma_f32_16x16x32_bf16 v[52:55], v[204:207], v[156:159], v[52:55]
    s_mov_b32 s45, 0x3e0293ee
    s_nop 6
    v_permlane32_swap_b32 v48, v50
    v_permlane32_swap_b32 v49, v51
    v_pk_add_f32 v[48:49], v[48:49], v[50:51]
    v_permlane32_swap_b32 v52, v54
    v_permlane32_swap_b32 v53, v55
    v_pk_add_f32 v[52:53], v[52:53], v[54:55]
    v_max_f32 v22, v32, v33
    v_max3_f32 v22, v22, v34, v35
    v_max3_f32 v22, v22, v48, v49
    v_max_f32 v23, v36, v37
    v_max3_f32 v23, v23, v38, v39
    v_max3_f32 v23, v23, v44, v45
    v_max3_f32 v23, v23, v46, v47
    v_max3_f32 v23, v23, v52, v53
    v_mov_b32 v24, v22
    v_mov_b32 v25, v23
    s_nop 0
    v_permlane32_swap_b32 v22, v24
    v_permlane32_swap_b32 v23, v25
    v_max_f32 v22, v22, v24
    v_max_f32 v23, v23, v25
    v_mov_b32 v24, v22
    v_mov_b32 v25, v23
    s_nop 0
    v_permlane16_swap_b32 v22, v24
    v_permlane16_swap_b32 v23, v25
    v_max_f32 v22, v22, v24
    v_max_f32 v23, v23, v25
    v_mul_f32 v22, s45, v22
    v_mul_f32 v23, s45, v23
    v_fma_f32 v32, v32, s45, -v22
    v_fma_f32 v33, v33, s45, -v22
    v_fma_f32 v34, v34, s45, -v22
    v_fma_f32 v35, v35, s45, -v22
    v_fma_f32 v48, v48, s45, -v22
    v_fma_f32 v49, v49, s45, -v22
    v_exp_f32 v32, v32
    v_exp_f32 v33, v33
    v_exp_f32 v34, v34
    v_exp_f32 v35, v35
    v_exp_f32 v48, v48
    v_exp_f32 v49, v49
    v_fma_f32 v36, v36, s45, -v23
    v_fma_f32 v37, v37, s45, -v23
    v_fma_f32 v38, v38, s45, -v23
    v_fma_f32 v39, v39, s45, -v23
    v_fma_f32 v44, v44, s45, -v23
    v_fma_f32 v45, v45, s45, -v23
    v_fma_f32 v46, v46, s45, -v23
    v_fma_f32 v47, v47, s45, -v23
    v_fma_f32 v52, v52, s45, -v23
    v_fma_f32 v53, v53, s45, -v23
    v_exp_f32 v36, v36
    v_exp_f32 v37, v37
    v_exp_f32 v38, v38
    v_exp_f32 v39, v39
    v_exp_f32 v44, v44
    v_exp_f32 v45, v45
    v_exp_f32 v46, v46
    v_exp_f32 v47, v47
    v_exp_f32 v52, v52
    v_exp_f32 v53, v53
    v_add_f32 v22, v32, v33
    v_add_f32 v22, v22, v34
    v_add_f32 v22, v22, v35
    v_add_f32 v22, v22, v48
    v_add_f32 v22, v22, v49
    v_add_f32 v23, v36, v37
    v_add_f32 v23, v23, v38
    v_add_f32 v23, v23, v39
    v_add_f32 v23, v23, v44
    v_add_f32 v23, v23, v45
    v_add_f32 v23, v23, v46
    v_add_f32 v23, v23, v47
    v_add_f32 v23, v23, v52
    v_add_f32 v23, v23, v53
    v_mov_b32 v24, v22
    v_mov_b32 v25, v23
    s_nop 0
    v_permlane32_swap_b32 v22, v24
    v_permlane32_swap_b32 v23, v25
    v_add_f32 v22, v22, v24
    v_add_f32 v23, v23, v25
    v_mov_b32 v24, v22
    v_mov_b32 v25, v23
    s_nop 0
    v_permlane16_swap_b32 v22, v24
    v_permlane16_swap_b32 v23, v25
    v_add_f32 v22, v22, v24
    v_add_f32 v23, v23, v25
    v_rcp_f32 v22, v22
    v_rcp_f32 v23, v23
    s_nop 0
    v_mul_f32 v32, v32, v22
    v_mul_f32 v33, v33, v22
    v_mul_f32 v34, v34, v22
    v_mul_f32 v35, v35, v22
    v_mul_f32 v48, v48, v22
    v_mul_f32 v49, v49, v22
    v_mul_f32 v36, v36, v23
    v_mul_f32 v37, v37, v23
    v_mul_f32 v38, v38, v23
    v_mul_f32 v39, v39, v23
    v_mul_f32 v44, v44, v23
    v_mul_f32 v45, v45, v23
    v_mul_f32 v46, v46, v23
    v_mul_f32 v47, v47, v23
    v_mul_f32 v52, v52, v23
    v_mul_f32 v53, v53, v23
    v_cvt_pk_bf16_f32 v128, v32, v33
    v_cvt_pk_bf16_f32 v129, v34, v35
    v_mov_b32 v130, 0
    v_mov_b32 v131, 0
    v_cvt_pk_bf16_f32 v132, v48, v49
    v_mov_b32 v133, 0
    v_mov_b32 v134, 0
    v_cvt_pk_bf16_f32 v135, v48, v49
    v_cvt_pk_bf16_f32 v136, v36, v37
    v_cvt_pk_bf16_f32 v137, v38, v39
    v_cvt_pk_bf16_f32 v138, v44, v45
    v_cvt_pk_bf16_f32 v139, v46, v47
    v_cvt_pk_bf16_f32 v140, v52, v53
    v_mov_b32 v141, 0
    v_mov_b32 v142, 0
    v_cvt_pk_bf16_f32 v143, v52, v53
    s_waitcnt vmcnt(0) lgkmcnt(0)
    s_nop 0
    v_mfma_f32_16x16x32_bf16 v[64:67], v[208:211], v[128:131], 0
    v_mfma_f32_16x16x32_bf16 v[68:71], v[212:215], v[128:131], 0
    v_mfma_f32_16x16x32_bf16 v[72:75], v[216:219], v[128:131], 0
    v_mfma_f32_16x16x32_bf16 v[76:79], v[220:223], v[128:131], 0
    v_mfma_f32_16x16x32_bf16 v[80:83], v[224:227], v[128:131], 0
    v_mfma_f32_16x16x32_bf16 v[84:87], v[228:231], v[128:131], 0
    v_mfma_f32_16x16x32_bf16 v[88:91], v[232:235], v[128:131], 0
    v_mfma_f32_16x16x32_bf16 v[92:95], v[236:239], v[128:131], 0
    v_mfma_f32_16x16x16_bf16 v[64:67], v[240:241], v[132:133], v[64:67]
    v_mfma_f32_16x16x16_bf16 v[68:71], v[240:241], v[134:135], v[68:71]
    v_mfma_f32_16x16x16_bf16 v[72:75], v[242:243], v[132:133], v[72:75]
    v_mfma_f32_16x16x16_bf16 v[76:79], v[242:243], v[134:135], v[76:79]
    v_mfma_f32_16x16x16_bf16 v[80:83], v[244:245], v[132:133], v[80:83]
    v_mfma_f32_16x16x16_bf16 v[84:87], v[244:245], v[134:135], v[84:87]
    v_mfma_f32_16x16x16_bf16 v[88:91], v[246:247], v[132:133], v[88:91]
    v_mfma_f32_16x16x16_bf16 v[92:95], v[246:247], v[134:135], v[92:95]
    v_mfma_f32_16x16x32_bf16 v[96:99], v[208:211], v[136:139], 0
    v_mfma_f32_16x16x32_bf16 v[100:103], v[212:215], v[136:139], 0
    v_mfma_f32_16x16x32_bf16 v[104:107], v[216:219], v[136:139], 0
    v_mfma_f32_16x16x32_bf16 v[108:111], v[220:223], v[136:139], 0
    v_mfma_f32_16x16x32_bf16 v[112:115], v[224:227], v[136:139], 0
    v_mfma_f32_16x16x32_bf16 v[116:119], v[228:231], v[136:139], 0
    v_mfma_f32_16x16x32_bf16 v[120:123], v[232:235], v[136:139], 0
    v_mfma_f32_16x16x32_bf16 v[124:127], v[236:239], v[136:139], 0
    v_mfma_f32_16x16x16_bf16 v[96:99], v[240:241], v[140:141], v[96:99]
    v_mfma_f32_16x16x16_bf16 v[100:103], v[240:241], v[142:143], v[100:103]
    v_mfma_f32_16x16x16_bf16 v[104:107], v[242:243], v[140:141], v[104:107]
    v_mfma_f32_16x16x16_bf16 v[108:111], v[242:243], v[142:143], v[108:111]
    v_mfma_f32_16x16x16_bf16 v[112:115], v[244:245], v[140:141], v[112:115]
    v_mfma_f32_16x16x16_bf16 v[116:119], v[244:245], v[142:143], v[116:119]
    v_mfma_f32_16x16x16_bf16 v[120:123], v[246:247], v[140:141], v[120:123]
    v_mfma_f32_16x16x16_bf16 v[124:127], v[246:247], v[142:143], v[124:127]
    s_lshl_b32 s45, s63, 18
    s_lshl_b32 s46, s41, 13
    s_add_u32 s45, s45, s46
    s_add_u32 s45, s45, 0x5000000
    s_add_u32 s46, s45, 4096
    v_cvt_pk_bf16_f32 v64, v64, v65
    v_cvt_pk_bf16_f32 v65, v66, v67
    v_cvt_pk_bf16_f32 v66, v68, v69
    v_cvt_pk_bf16_f32 v67, v70, v71
    buffer_store_dwordx4 v[64:67], v10, s[12:15], s45 offen offset:0 sc1
    v_cvt_pk_bf16_f32 v72, v72, v73
    v_cvt_pk_bf16_f32 v73, v74, v75
    v_cvt_pk_bf16_f32 v74, v76, v77
    v_cvt_pk_bf16_f32 v75, v78, v79
    buffer_store_dwordx4 v[72:75], v10, s[12:15], s45 offen offset:2048 sc1
    v_cvt_pk_bf16_f32 v80, v80, v81
    v_cvt_pk_bf16_f32 v81, v82, v83
    v_cvt_pk_bf16_f32 v82, v84, v85
    v_cvt_pk_bf16_f32 v83, v86, v87
    buffer_store_dwordx4 v[80:83], v10, s[12:15], s46 offen offset:0 sc1
    v_cvt_pk_bf16_f32 v88, v88, v89
    v_cvt_pk_bf16_f32 v89, v90, v91
    v_cvt_pk_bf16_f32 v90, v92, v93
    v_cvt_pk_bf16_f32 v91, v94, v95
    buffer_store_dwordx4 v[88:91], v10, s[12:15], s46 offen offset:2048 sc1
    v_cvt_pk_bf16_f32 v96, v96, v97
    v_cvt_pk_bf16_f32 v97, v98, v99
    v_cvt_pk_bf16_f32 v98, v100, v101
    v_cvt_pk_bf16_f32 v99, v102, v103
    buffer_store_dwordx4 v[96:99], v10, s[12:15], s45 offen offset:1024 sc1
    v_cvt_pk_bf16_f32 v104, v104, v105
    v_cvt_pk_bf16_f32 v105, v106, v107
    v_cvt_pk_bf16_f32 v106, v108, v109
    v_cvt_pk_bf16_f32 v107, v110, v111
    buffer_store_dwordx4 v[104:107], v10, s[12:15], s45 offen offset:3072 sc1
    v_cvt_pk_bf16_f32 v112, v112, v113
    v_cvt_pk_bf16_f32 v113, v114, v115
    v_cvt_pk_bf16_f32 v114, v116, v117
    v_cvt_pk_bf16_f32 v115, v118, v119
    buffer_store_dwordx4 v[112:115], v10, s[12:15], s46 offen offset:1024 sc1
    v_cvt_pk_bf16_f32 v120, v120, v121
    v_cvt_pk_bf16_f32 v121, v122, v123
    v_cvt_pk_bf16_f32 v122, v124, v125
    v_cvt_pk_bf16_f32 v123, v126, v127
    buffer_store_dwordx4 v[120:123], v10, s[12:15], s46 offen offset:3072 sc1
L_xs2_133:
    s_waitcnt vmcnt(0)
    s_barrier
    s_cmp_lg_u32 s44, 0
    s_cbranch_scc1 L_pub_136
    v_mov_b32 v30, s62
    v_mov_b32 v31, 0
    s_mov_b64 exec, 1
    buffer_store_dword v30, v31, s[80:83], s65 offen
    buffer_store_dword v30, v31, s[84:87], s65 offen sc1
    s_mov_b64 exec, -1
L_pub_136:
    s_cmp_eq_u64 s[36:37], 0
    s_cbranch_scc1 L_xl_137
    s_ff1_i32_b64 s47, s[36:37]
    s_lshr_b64 s[74:75], s[72:73], s47
    s_ff1_i32_b64 s48, s[74:75]
    s_cmp_gt_u32 s79, s48
    s_cbranch_scc1 L_xl_137
    s_add_u32 s47, s47, s79
    s_cmp_lt_u32 s47, s78
    s_cbranch_scc1 L_xl_137_go
    s_lshl_b32 s45, s41, 7
    s_add_u32 s45, s45, 0x10010
    s_add_u32 s46, s47, 1
    s_mov_b64 exec, 7
    s_mov_b32 s70, 0
L_wp_138:
    buffer_load_dword v31, v12, s[12:15], s45 offen sc1
    s_add_u32 s70, s70, 1
    s_cmp_ge_u32 s70, 0x200000
    s_cbranch_scc1 L_w_done_98
    s_waitcnt vmcnt(0)
    v_cmp_gt_u32 vcc, s46, v31
    s_nop 1
    s_cbranch_vccz L_wp_138_ok
    s_sleep 2
    s_branch L_wp_138
L_wp_138_ok:
    s_mov_b64 exec, -1
    v_readlane_b32 s78, v31, 0
    v_readlane_b32 s45, v31, 1
    v_readlane_b32 s46, v31, 2
    s_nop 3
    s_min_u32 s78, s78, s45
    s_min_u32 s78, s78, s46
L_xl_137_go:
    s_lshl_b32 s45, s41, 19
    s_lshl_b32 s46, s47, 13
    s_add_u32 s45, s45, s46
    s_add_u32 s45, s45, 0x2000000
    s_add_u32 s46, s45, 4096
    s_add_u32 s48, s45, 16777216
    s_add_u32 s49, s48, 4096
    s_add_u32 s76, s48, 16777216
    s_add_u32 s77, s76, 4096
    buffer_load_dwordx4 v[96:99], v10, s[12:15], s76 offen offset:0 sc1
    buffer_load_dwordx4 v[128:131], v10, s[12:15], s45 offen offset:0 sc1
    buffer_load_dwordx4 v[160:163], v10, s[12:15], s48 offen offset:0 sc1
    buffer_load_dwordx4 v[100:103], v10, s[12:15], s76 offen offset:1024 sc1
    buffer_load_dwordx4 v[144:147], v10, s[12:15], s45 offen offset:1024 sc1
    buffer_load_dwordx4 v[176:179], v10, s[12:15], s48 offen offset:1024 sc1
    buffer_load_dwordx4 v[104:107], v10, s[12:15], s76 offen offset:2048 sc1
    buffer_load_dwordx4 v[132:135], v10, s[12:15], s45 offen offset:2048 sc1
    buffer_load_dwordx4 v[164:167], v10, s[12:15], s48 offen offset:2048 sc1
    buffer_load_dwordx4 v[108:111], v10, s[12:15], s76 offen offset:3072 sc1
    buffer_load_dwordx4 v[148:151], v10, s[12:15], s45 offen offset:3072 sc1
    buffer_load_dwordx4 v[180:183], v10, s[12:15], s48 offen offset:3072 sc1
    buffer_load_dwordx4 v[112:115], v10, s[12:15], s77 offen offset:0 sc1
    buffer_load_dwordx4 v[136:139], v10, s[12:15], s46 offen offset:0 sc1
    buffer_load_dwordx4 v[168:171], v10, s[12:15], s49 offen offset:0 sc1
    buffer_load_dwordx4 v[116:119], v10, s[12:15], s77 offen offset:1024 sc1
    buffer_load_dwordx4 v[152:155], v10, s[12:15], s46 offen offset:1024 sc1
    buffer_load_dwordx4 v[184:187], v10, s[12:15], s49 offen offset:1024 sc1
    buffer_load_dwordx4 v[120:123], v10, s[12:15], s77 offen offset:2048 sc1
    buffer_load_dwordx4 v[140:143], v10, s[12:15], s46 offen offset:2048 sc1
    buffer_load_dwordx4 v[172:175], v10, s[12:15], s49 offen offset:2048 sc1
    buffer_load_dwordx4 v[124:127], v10, s[12:15], s77 offen offset:3072 sc1
    buffer_load_dwordx4 v[156:159], v10, s[12:15], s46 offen offset:3072 sc1
    buffer_load_dwordx4 v[188:191], v10, s[12:15], s49 offen offset:3072 sc1
L_xl_137:
    s_lshl_b32 s45, s38, 10
    s_add_u32 s45, s45, s64
    s_cmp_lg_u32 s44, 0
    s_cbranch_scc1 L_pw_139
    s_mov_b64 exec, 255
    s_mov_b32 s70, 0
L_wp_140:
    buffer_load_dword v31, v5, s[12:15], s45 offen sc1
    s_add_u32 s70, s70, 1
    s_cmp_ge_u32 s70, 0x200000
    s_cbranch_scc1 L_w_done_98
    s_waitcnt vmcnt(0)
    v_cmp_gt_u32 vcc, s62, v31
    s_nop 1
    s_cbranch_vccz L_wp_140_ok
    s_sleep 1
    s_branch L_wp_140
L_wp_140_ok:
    s_mov_b64 exec, -1
L_pw_139:
    s_barrier
    s_mul_i32 s53, s50, 262144
    s_add_u32 s53, s53, s52
    s_lshl_b32 s54, s44, 13
    s_add_u32 s53, s53, s54
    s_mul_i32 s57, s50, 131072
    s_add_u32 s57, s57, s56
    s_lshl_b32 s45, s44, 7
    s_add_u32 s57, s57, s45
    s_add_u32 s55, s54, 65536
    s_mov_b32 s58, 0
    v_mov_b32 v13, v10
    v_add_u32 v14, 65536, v13
    v_xor_b32 v15, 64, v13
    v_xor_b32 v16, 64, v14
    s_mov_b32 s76, 0x20000000
    s_add_u32 s48, s53, 0
    s_add_u32 s49, s48, 4096
    s_add_u32 m0, s54, 0
    s_nop 0
    buffer_load_dwordx4 v10, s[12:15], s48 offen offset:0 sc1 lds
    buffer_load_dwordx4 v10, s[12:15], s48 offen offset:1024 sc1 lds
    buffer_load_dwordx4 v10, s[12:15], s48 offen offset:2048 sc1 lds
    buffer_load_dwordx4 v10, s[12:15], s48 offen offset:3072 sc1 lds
    s_add_u32 m0, s54, 4096
    s_nop 0
    buffer_load_dwordx4 v10, s[12:15], s49 offen offset:0 sc1 lds
    buffer_load_dwordx4 v10, s[12:15], s49 offen offset:1024 sc1 lds
    buffer_load_dwordx4 v10, s[12:15], s49 offen offset:2048 sc1 lds
    buffer_load_dwordx4 v10, s[12:15], s49 offen offset:3072 sc1 lds
    s_add_u32 s48, s53, 32768
    s_add_u32 s49, s48, 4096
    s_add_u32 s46, s54, 32768
    s_add_u32 m0, s46, 0
    s_nop 0
    buffer_load_dwordx4 v10, s[12:15], s48 offen offset:0 sc1 lds
    buffer_load_dwordx4 v10, s[12:15], s48 offen offset:1024 sc1 lds
    buffer_load_dwordx4 v10, s[12:15], s48 offen offset:2048 sc1 lds
    buffer_load_dwordx4 v10, s[12:15], s48 offen offset:3072 sc1 lds
    s_add_u32 m0, s46, 4096
    s_nop 0
    buffer_load_dwordx4 v10, s[12:15], s49 offen offset:0 sc1 lds
    buffer_load_dwordx4 v10, s[12:15], s49 offen offset:1024 sc1 lds
    buffer_load_dwordx4 v10, s[12:15], s49 offen offset:2048 sc1 lds
    buffer_load_dwordx4 v10, s[12:15], s49 offen offset:3072 sc1 lds
    s_cmp_eq_u32 s51, 1
    s_cbranch_scc1 L_e_one_142
    s_add_u32 s48, s53, 262144
    s_add_u32 s49, s48, 4096
    s_add_u32 m0, s55, 0
    s_nop 0
    buffer_load_dwordx4 v10, s[12:15], s48 offen offset:0 sc1 lds
    buffer_load_dwordx4 v10, s[12:15], s48 offen offset:1024 sc1 lds
    buffer_load_dwordx4 v10, s[12:15], s48 offen offset:2048 sc1 lds
    buffer_load_dwordx4 v10, s[12:15], s48 offen offset:3072 sc1 lds
    s_add_u32 m0, s55, 4096
    s_nop 0
    buffer_load_dwordx4 v10, s[12:15], s49 offen offset:0 sc1 lds
    buffer_load_dwordx4 v10, s[12:15], s49 offen offset:1024 sc1 lds
    buffer_load_dwordx4 v10, s[12:15], s49 offen offset:2048 sc1 lds
    buffer_load_dwordx4 v10, s[12:15], s49 offen offset:3072 sc1 lds
    s_waitcnt vmcnt(16)
    s_barrier
    ds_read_b128 v[32:35], v13 offset:0
    ds_read_b128 v[36:39], v13 offset:1024
    ds_read_b128 v[40:43], v13 offset:2048
    ds_read_b128 v[44:47], v13 offset:3072
L_e_loop_141:
    s_add_u32 s48, s53, 294912
    s_add_u32 s46, s58, 1
    s_cmp_lt_u32 s46, s51
    s_cselect_b32 s48, s48, 0x20000000
    s_add_u32 s49, s48, 4096
    s_add_u32 s59, s55, 32768
    s_waitcnt lgkmcnt(2)
    v_mfma_f32_16x16x32_bf16 v[80:83], a[0:3], v[32:35], 0
    ds_read_b128 v[48:51], v13 offset:4096
    ds_read_b128 v[52:55], v13 offset:5120
    v_mfma_f32_16x16x32_bf16 v[84:87], a[4:7], v[32:35], 0
    ds_read_b128 v[56:59], v13 offset:6144
    ds_read_b128 v[60:63], v13 offset:7168
    s_add_u32 m0, s59, 0
    v_mfma_f32_16x16x32_bf16 v[88:91], a[0:3], v[36:39], 0
    buffer_load_dwordx4 v10, s[12:15], s48 offen offset:0 sc1 lds
    v_mfma_f32_16x16x32_bf16 v[92:95], a[4:7], v[36:39], 0
    s_waitcnt lgkmcnt(4)
    v_mfma_f32_16x16x32_bf16 v[80:83], a[8:11], v[40:43], v[80:83]
    ds_read_b128 v[32:35], v13 offset:8192
    ds_read_b128 v[36:39], v13 offset:9216
    v_mfma_f32_16x16x32_bf16 v[84:87], a[12:15], v[40:43], v[84:87]
    v_mfma_f32_16x16x32_bf16 v[88:91], a[8:11], v[44:47], v[88:91]
    buffer_load_dwordx4 v10, s[12:15], s48 offen offset:1024 sc1 lds
    v_mfma_f32_16x16x32_bf16 v[92:95], a[12:15], v[44:47], v[92:95]
    s_waitcnt lgkmcnt(4)
    v_mfma_f32_16x16x32_bf16 v[80:83], a[16:19], v[48:51], v[80:83]
    ds_read_b128 v[40:43], v13 offset:10240
    ds_read_b128 v[44:47], v13 offset:11264
    v_mfma_f32_16x16x32_bf16 v[84:87], a[20:23], v[48:51], v[84:87]
    v_mfma_f32_16x16x32_bf16 v[88:91], a[16:19], v[52:55], v[88:91]
    buffer_load_dwordx4 v10, s[12:15], s48 offen offset:2048 sc1 lds
    v_mfma_f32_16x16x32_bf16 v[92:95], a[20:23], v[52:55], v[92:95]
    s_waitcnt lgkmcnt(4)
    v_mfma_f32_16x16x32_bf16 v[80:83], a[24:27], v[56:59], v[80:83]
    ds_read_b128 v[48:51], v13 offset:12288
    ds_read_b128 v[52:55], v13 offset:13312
    v_mfma_f32_16x16x32_bf16 v[84:87], a[28:31], v[56:59], v[84:87]
    v_mfma_f32_16x16x32_bf16 v[88:91], a[24:27], v[60:63], v[88:91]
    buffer_load_dwordx4 v10, s[12:15], s48 offen offset:3072 sc1 lds
    v_mfma_f32_16x16x32_bf16 v[92:95], a[28:31], v[60:63], v[92:95]
    s_waitcnt lgkmcnt(4)
    v_mfma_f32_16x16x32_bf16 v[80:83], a[32:35], v[32:35], v[80:83]
    ds_read_b128 v[56:59], v13 offset:14336
    ds_read_b128 v[60:63], v13 offset:15360
    v_mfma_f32_16x16x32_bf16 v[84:87], a[36:39], v[32:35], v[84:87]
    s_add_u32 m0, s59, 4096
    v_mfma_f32_16x16x32_bf16 v[88:91], a[32:35], v[36:39], v[88:91]
    buffer_load_dwordx4 v10, s[12:15], s49 offen offset:0 sc1 lds
    v_mfma_f32_16x16x32_bf16 v[92:95], a[36:39], v[36:39], v[92:95]
    s_waitcnt lgkmcnt(4)
    v_mfma_f32_16x16x32_bf16 v[80:83], a[40:43], v[40:43], v[80:83]
    ds_read_b128 v[32:35], v13 offset:16384
    ds_read_b128 v[36:39], v13 offset:17408
    v_mfma_f32_16x16x32_bf16 v[84:87], a[44:47], v[40:43], v[84:87]
    v_mfma_f32_16x16x32_bf16 v[88:91], a[40:43], v[44:47], v[88:91]
    buffer_load_dwordx4 v10, s[12:15], s49 offen offset:1024 sc1 lds
    v_mfma_f32_16x16x32_bf16 v[92:95], a[44:47], v[44:47], v[92:95]
    s_waitcnt lgkmcnt(4)
    v_mfma_f32_16x16x32_bf16 v[80:83], a[48:51], v[48:51], v[80:83]
    ds_read_b128 v[40:43], v13 offset:18432
    ds_read_b128 v[44:47], v13 offset:19456
    v_mfma_f32_16x16x32_bf16 v[84:87], a[52:55], v[48:51], v[84:87]
    v_mfma_f32_16x16x32_bf16 v[88:91], a[48:51], v[52:55], v[88:91]
    buffer_load_dwordx4 v10, s[12:15], s49 offen offset:2048 sc1 lds
    v_mfma_f32_16x16x32_bf16 v[92:95], a[52:55], v[52:55], v[92:95]
    s_waitcnt lgkmcnt(4)
    v_mfma_f32_16x16x32_bf16 v[80:83], a[56:59], v[56:59], v[80:83]
    ds_read_b128 v[48:51], v13 offset:20480
    ds_read_b128 v[52:55], v13 offset:21504
    v_mfma_f32_16x16x32_bf16 v[84:87], a[60:63], v[56:59], v[84:87]
    v_mfma_f32_16x16x32_bf16 v[88:91], a[56:59], v[60:63], v[88:91]
    buffer_load_dwordx4 v10, s[12:15], s49 offen offset:3072 sc1 lds
    v_mfma_f32_16x16x32_bf16 v[92:95], a[60:63], v[60:63], v[92:95]
    s_waitcnt lgkmcnt(4)
    v_mfma_f32_16x16x32_bf16 v[80:83], a[64:67], v[32:35], v[80:83]
    ds_read_b128 v[56:59], v13 offset:22528
    ds_read_b128 v[60:63], v13 offset:23552
    v_mfma_f32_16x16x32_bf16 v[84:87], a[68:71], v[32:35], v[84:87]
    v_mfma_f32_16x16x32_bf16 v[88:91], a[64:67], v[36:39], v[88:91]
    v_mfma_f32_16x16x32_bf16 v[92:95], a[68:71], v[36:39], v[92:95]
    s_waitcnt lgkmcnt(4)
    v_mfma_f32_16x16x32_bf16 v[80:83], a[72:75], v[40:43], v[80:83]
    ds_read_b128 v[32:35], v13 offset:24576
    ds_read_b128 v[36:39], v13 offset:25600
    v_mfma_f32_16x16x32_bf16 v[84:87], a[76:79], v[40:43], v[84:87]
    v_mfma_f32_16x16x32_bf16 v[88:91], a[72:75], v[44:47], v[88:91]
    v_mfma_f32_16x16x32_bf16 v[92:95], a[76:79], v[44:47], v[92:95]
    s_waitcnt lgkmcnt(4)
    v_mfma_f32_16x16x32_bf16 v[80:83], a[80:83], v[48:51], v[80:83]
    ds_read_b128 v[40:43], v13 offset:26624
    ds_read_b128 v[44:47], v13 offset:27648
    v_mfma_f32_16x16x32_bf16 v[84:87], a[84:87], v[48:51], v[84:87]
    v_mfma_f32_16x16x32_bf16 v[88:91], a[80:83], v[52:55], v[88:91]
    v_mfma_f32_16x16x32_bf16 v[92:95], a[84:87], v[52:55], v[92:95]
    s_waitcnt lgkmcnt(4)
    v_mfma_f32_16x16x32_bf16 v[80:83], a[88:91], v[56:59], v[80:83]
    ds_read_b128 v[48:51], v13 offset:28672
    ds_read_b128 v[52:55], v13 offset:29696
    v_mfma_f32_16x16x32_bf16 v[84:87], a[92:95], v[56:59], v[84:87]
    v_mfma_f32_16x16x32_bf16 v[88:91], a[88:91], v[60:63], v[88:91]
    v_mfma_f32_16x16x32_bf16 v[92:95], a[92:95], v[60:63], v[92:95]
    s_waitcnt lgkmcnt(4)
    v_mfma_f32_16x16x32_bf16 v[80:83], a[96:99], v[32:35], v[80:83]
    ds_read_b128 v[56:59], v13 offset:30720
    ds_read_b128 v[60:63], v13 offset:31744
    v_mfma_f32_16x16x32_bf16 v[84:87], a[100:103], v[32:35], v[84:87]
    v_mfma_f32_16x16x32_bf16 v[88:91], a[96:99], v[36:39], v[88:91]
    v_mfma_f32_16x16x32_bf16 v[92:95], a[100:103], v[36:39], v[92:95]
    s_waitcnt lgkmcnt(4)
    v_mfma_f32_16x16x32_bf16 v[80:83], a[104:107], v[40:43], v[80:83]
    ds_read_b128 v[216:219], v8 offset:0
    ds_read_b128 v[220:223], v8 offset:1152
    v_mfma_f32_16x16x32_bf16 v[84:87], a[108:111], v[40:43], v[84:87]
    ds_read_b128 v[224:227], v8 offset:2304
    ds_read_b128 v[228:231], v8 offset:3456
    v_mfma_f32_16x16x32_bf16 v[88:91], a[104:107], v[44:47], v[88:91]
    v_mfma_f32_16x16x32_bf16 v[92:95], a[108:111], v[44:47], v[92:95]
    s_waitcnt vmcnt(16) lgkmcnt(0)
    s_barrier
    v_mfma_f32_16x16x32_bf16 v[80:83], a[112:115], v[48:51], v[80:83]
    ds_read_b128 v[32:35], v13 offset:32768
    ds_read_b128 v[36:39], v13 offset:33792
    v_mfma_f32_16x16x32_bf16 v[84:87], a[116:119], v[48:51], v[84:87]
    buffer_store_dwordx4 v[216:219], v11, s[12:15], s76 offen sc1
    s_add_u32 s76, s76, 32768
    v_mfma_f32_16x16x32_bf16 v[88:91], a[112:115], v[52:55], v[88:91]
    buffer_store_dwordx4 v[220:223], v11, s[12:15], s76 offen sc1
    s_add_u32 s76, s76, 32768
    v_mfma_f32_16x16x32_bf16 v[92:95], a[116:119], v[52:55], v[92:95]
    buffer_store_dwordx4 v[224:227], v11, s[12:15], s76 offen sc1
    s_add_u32 s76, s76, 32768
    v_mfma_f32_16x16x32_bf16 v[80:83], a[120:123], v[56:59], v[80:83]
    ds_read_b128 v[40:43], v13 offset:34816
    ds_read_b128 v[44:47], v13 offset:35840
    v_mfma_f32_16x16x32_bf16 v[84:87], a[124:127], v[56:59], v[84:87]
    buffer_store_dwordx4 v[228:231], v11, s[12:15], s76 offen sc1
    v_mfma_f32_16x16x32_bf16 v[88:91], a[120:123], v[60:63], v[88:91]
    v_mfma_f32_16x16x32_bf16 v[92:95], a[124:127], v[60:63], v[92:95]
    s_add_u32 s48, s53, 524288
    s_add_u32 s46, s58, 2
    s_cmp_lt_u32 s46, s51
    s_cselect_b32 s48, s48, 0x20000000
    s_add_u32 s49, s48, 4096
    s_mov_b32 s59, s54
    s_waitcnt lgkmcnt(2)
    v_mfma_f32_16x16x32_bf16 v[80:83], a[128:131], v[32:35], v[80:83]
    ds_read_b128 v[48:51], v13 offset:36864
    ds_read_b128 v[52:55], v13 offset:37888
    v_mfma_f32_16x16x32_bf16 v[84:87], a[132:135], v[32:35], v[84:87]
    ds_read_b128 v[56:59], v13 offset:38912
    ds_read_b128 v[60:63], v13 offset:39936
    s_add_u32 m0, s59, 0
    v_mfma_f32_16x16x32_bf16 v[88:91], a[128:131], v[36:39], v[88:91]
    buffer_load_dwordx4 v10, s[12:15], s48 offen offset:0 sc1 lds
    v_mfma_f32_16x16x32_bf16 v[92:95], a[132:135], v[36:39], v[92:95]
    s_waitcnt lgkmcnt(4)
    v_mfma_f32_16x16x32_bf16 v[80:83], a[136:139], v[40:43], v[80:83]
    ds_read_b128 v[32:35], v13 offset:40960
    ds_read_b128 v[36:39], v13 offset:41984
    v_mfma_f32_16x16x32_bf16 v[84:87], a[140:143], v[40:43], v[84:87]
    v_mfma_f32_16x16x32_bf16 v[88:91], a[136:139], v[44:47], v[88:91]
    buffer_load_dwordx4 v10, s[12:15], s48 offen offset:1024 sc1 lds
    v_mfma_f32_16x16x32_bf16 v[92:95], a[140:143], v[44:47], v[92:95]
    s_waitcnt lgkmcnt(4)
    v_mfma_f32_16x16x32_bf16 v[80:83], a[144:147], v[48:51], v[80:83]
    ds_read_b128 v[40:43], v13 offset:43008
    ds_read_b128 v[44:47], v13 offset:44032
    v_mfma_f32_16x16x32_bf16 v[84:87], a[148:151], v[48:51], v[84:87]
    v_mfma_f32_16x16x32_bf16 v[88:91], a[144:147], v[52:55], v[88:91]
    buffer_load_dwordx4 v10, s[12:15], s48 offen offset:2048 sc1 lds
    v_mfma_f32_16x16x32_bf16 v[92:95], a[148:151], v[52:55], v[92:95]
    s_waitcnt lgkmcnt(4)
    v_mfma_f32_16x16x32_bf16 v[80:83], a[152:155], v[56:59], v[80:83]
    ds_read_b128 v[48:51], v13 offset:45056
    ds_read_b128 v[52:55], v13 offset:46080
    v_mfma_f32_16x16x32_bf16 v[84:87], a[156:159], v[56:59], v[84:87]
    v_mfma_f32_16x16x32_bf16 v[88:91], a[152:155], v[60:63], v[88:91]
    buffer_load_dwordx4 v10, s[12:15], s48 offen offset:3072 sc1 lds
    v_mfma_f32_16x16x32_bf16 v[92:95], a[156:159], v[60:63], v[92:95]
    s_waitcnt lgkmcnt(4)
    v_mfma_f32_16x16x32_bf16 v[80:83], a[160:163], v[32:35], v[80:83]
    ds_read_b128 v[56:59], v13 offset:47104
    ds_read_b128 v[60:63], v13 offset:48128
    v_mfma_f32_16x16x32_bf16 v[84:87], a[164:167], v[32:35], v[84:87]
    s_add_u32 m0, s59, 4096
    v_mfma_f32_16x16x32_bf16 v[88:91], a[160:163], v[36:39], v[88:91]
    buffer_load_dwordx4 v10, s[12:15], s49 offen offset:0 sc1 lds
    v_mfma_f32_16x16x32_bf16 v[92:95], a[164:167], v[36:39], v[92:95]
    s_waitcnt lgkmcnt(4)
    v_mfma_f32_16x16x32_bf16 v[80:83], a[168:171], v[40:43], v[80:83]
    ds_read_b128 v[32:35], v13 offset:49152
    ds_read_b128 v[36:39], v13 offset:50176
    v_mfma_f32_16x16x32_bf16 v[84:87], a[172:175], v[40:43], v[84:87]
    v_mfma_f32_16x16x32_bf16 v[88:91], a[168:171], v[44:47], v[88:91]
    buffer_load_dwordx4 v10, s[12:15], s49 offen offset:1024 sc1 lds
    v_mfma_f32_16x16x32_bf16 v[92:95], a[172:175], v[44:47], v[92:95]
    s_waitcnt lgkmcnt(4)
    v_mfma_f32_16x16x32_bf16 v[80:83], a[176:179], v[48:51], v[80:83]
    ds_read_b128 v[40:43], v13 offset:51200
    ds_read_b128 v[44:47], v13 offset:52224
    v_mfma_f32_16x16x32_bf16 v[84:87], a[180:183], v[48:51], v[84:87]
    v_mfma_f32_16x16x32_bf16 v[88:91], a[176:179], v[52:55], v[88:91]
    buffer_load_dwordx4 v10, s[12:15], s49 offen offset:2048 sc1 lds
    v_mfma_f32_16x16x32_bf16 v[92:95], a[180:183], v[52:55], v[92:95]
    s_waitcnt lgkmcnt(4)
    v_mfma_f32_16x16x32_bf16 v[80:83], a[184:187], v[56:59], v[80:83]
    ds_read_b128 v[48:51], v13 offset:53248
    ds_read_b128 v[52:55], v13 offset:54272
    v_mfma_f32_16x16x32_bf16 v[84:87], a[188:191], v[56:59], v[84:87]
    v_mfma_f32_16x16x32_bf16 v[88:91], a[184:187], v[60:63], v[88:91]
    buffer_load_dwordx4 v10, s[12:15], s49 offen offset:3072 sc1 lds
    v_mfma_f32_16x16x32_bf16 v[92:95], a[188:191], v[60:63], v[92:95]
    s_waitcnt lgkmcnt(4)
    v_mfma_f32_16x16x32_bf16 v[80:83], a[192:195], v[32:35], v[80:83]
    ds_read_b128 v[56:59], v13 offset:55296
    ds_read_b128 v[60:63], v13 offset:56320
    v_mfma_f32_16x16x32_bf16 v[84:87], a[196:199], v[32:35], v[84:87]
    v_mfma_f32_16x16x32_bf16 v[88:91], a[192:195], v[36:39], v[88:91]
    v_mfma_f32_16x16x32_bf16 v[92:95], a[196:199], v[36:39], v[92:95]
    s_waitcnt lgkmcnt(4)
    v_mfma_f32_16x16x32_bf16 v[80:83], a[200:203], v[40:43], v[80:83]
    ds_read_b128 v[32:35], v13 offset:57344
    ds_read_b128 v[36:39], v13 offset:58368
    v_mfma_f32_16x16x32_bf16 v[84:87], a[204:207], v[40:43], v[84:87]
    v_mfma_f32_16x16x32_bf16 v[88:91], a[200:203], v[44:47], v[88:91]
    v_mfma_f32_16x16x32_bf16 v[92:95], a[204:207], v[44:47], v[92:95]
    s_waitcnt lgkmcnt(4)
    v_mfma_f32_16x16x32_bf16 v[80:83], a[208:211], v[48:51], v[80:83]
    ds_read_b128 v[40:43], v13 offset:59392
    ds_read_b128 v[44:47], v13 offset:60416
    v_mfma_f32_16x16x32_bf16 v[84:87], a[212:215], v[48:51], v[84:87]
    v_mfma_f32_16x16x32_bf16 v[88:91], a[208:211], v[52:55], v[88:91]
    v_mfma_f32_16x16x32_bf16 v[92:95], a[212:215], v[52:55], v[92:95]
    s_waitcnt lgkmcnt(4)
    v_mfma_f32_16x16x32_bf16 v[80:83], a[216:219], v[56:59], v[80:83]
    ds_read_b128 v[48:51], v13 offset:61440
    ds_read_b128 v[52:55], v13 offset:62464
    v_mfma_f32_16x16x32_bf16 v[84:87], a[220:223], v[56:59], v[84:87]
    v_mfma_f32_16x16x32_bf16 v[88:91], a[216:219], v[60:63], v[88:91]
    v_mfma_f32_16x16x32_bf16 v[92:95], a[220:223], v[60:63], v[92:95]
    s_waitcnt lgkmcnt(4)
    v_mfma_f32_16x16x32_bf16 v[80:83], a[224:227], v[32:35], v[80:83]
    ds_read_b128 v[56:59], v13 offset:63488
    ds_read_b128 v[60:63], v13 offset:64512
    v_mfma_f32_16x16x32_bf16 v[84:87], a[228:231], v[32:35], v[84:87]
    v_mfma_f32_16x16x32_bf16 v[88:91], a[224:227], v[36:39], v[88:91]
    v_mfma_f32_16x16x32_bf16 v[92:95], a[228:231], v[36:39], v[92:95]
    s_waitcnt lgkmcnt(4)
    v_mfma_f32_16x16x32_bf16 v[80:83], a[232:235], v[40:43], v[80:83]
    v_mfma_f32_16x16x32_bf16 v[84:87], a[236:239], v[40:43], v[84:87]
    v_mfma_f32_16x16x32_bf16 v[88:91], a[232:235], v[44:47], v[88:91]
    v_mfma_f32_16x16x32_bf16 v[92:95], a[236:239], v[44:47], v[92:95]
    s_waitcnt vmcnt(16) lgkmcnt(0)
    s_barrier
    v_mfma_f32_16x16x32_bf16 v[80:83], a[240:243], v[48:51], v[80:83]
    ds_read_b128 v[32:35], v14 offset:0
    ds_read_b128 v[36:39], v14 offset:1024
    v_mfma_f32_16x16x32_bf16 v[84:87], a[244:247], v[48:51], v[84:87]
    v_mfma_f32_16x16x32_bf16 v[88:91], a[240:243], v[52:55], v[88:91]
    v_mfma_f32_16x16x32_bf16 v[92:95], a[244:247], v[52:55], v[92:95]
    v_mfma_f32_16x16x32_bf16 v[80:83], a[248:251], v[56:59], v[80:83]
    ds_read_b128 v[40:43], v14 offset:2048
    ds_read_b128 v[44:47], v14 offset:3072
    v_mfma_f32_16x16x32_bf16 v[84:87], a[252:255], v[56:59], v[84:87]
    v_mfma_f32_16x16x32_bf16 v[88:91], a[248:251], v[60:63], v[88:91]
    v_mfma_f32_16x16x32_bf16 v[92:95], a[252:255], v[60:63], v[92:95]
    s_add_u32 s53, s53, 262144
    s_add_u32 s58, s58, 1
    v_swap_b32 v13, v14
    s_xor_b32 s54, s54, 65536
    s_xor_b32 s55, s55, 65536
    s_mov_b32 s76, s57
    v_swap_b32 v15, v16
    s_add_u32 s57, s57, 131072
    ds_write_b128 v7, v[80:83] offset:0
    ds_write_b128 v7, v[84:87] offset:64
    ds_write_b128 v7, v[88:91] offset:2304
    ds_write_b128 v7, v[92:95] offset:2368
    s_cmp_lt_u32 s58, s51
    s_cbranch_scc1 L_e_loop_141
    s_branch L_e_fin_143
L_e_one_142:
    s_waitcnt vmcnt(8)
    s_barrier
    ds_read_b128 v[32:35], v13 offset:0
    ds_read_b128 v[36:39], v13 offset:1024
    ds_read_b128 v[40:43], v13 offset:2048
    ds_read_b128 v[44:47], v13 offset:3072
    s_waitcnt lgkmcnt(2)
    v_mfma_f32_16x16x32_bf16 v[80:83], a[0:3], v[32:35], 0
    ds_read_b128 v[48:51], v13 offset:4096
    ds_read_b128 v[52:55], v13 offset:5120
    v_mfma_f32_16x16x32_bf16 v[84:87], a[4:7], v[32:35], 0
    ds_read_b128 v[56:59], v13 offset:6144
    ds_read_b128 v[60:63], v13 offset:7168
    v_mfma_f32_16x16x32_bf16 v[88:91], a[0:3], v[36:39], 0
    v_mfma_f32_16x16x32_bf16 v[92:95], a[4:7], v[36:39], 0
    s_waitcnt lgkmcnt(4)
    v_mfma_f32_16x16x32_bf16 v[80:83], a[8:11], v[40:43], v[80:83]
    ds_read_b128 v[32:35], v13 offset:8192
    ds_read_b128 v[36:39], v13 offset:9216
    v_mfma_f32_16x16x32_bf16 v[84:87], a[12:15], v[40:43], v[84:87]
    v_mfma_f32_16x16x32_bf16 v[88:91], a[8:11], v[44:47], v[88:91]
    v_mfma_f32_16x16x32_bf16 v[92:95], a[12:15], v[44:47], v[92:95]
    s_waitcnt lgkmcnt(4)
    v_mfma_f32_16x16x32_bf16 v[80:83], a[16:19], v[48:51], v[80:83]
    ds_read_b128 v[40:43], v13 offset:10240
    ds_read_b128 v[44:47], v13 offset:11264
    v_mfma_f32_16x16x32_bf16 v[84:87], a[20:23], v[48:51], v[84:87]
    v_mfma_f32_16x16x32_bf16 v[88:91], a[16:19], v[52:55], v[88:91]
    v_mfma_f32_16x16x32_bf16 v[92:95], a[20:23], v[52:55], v[92:95]
    s_waitcnt lgkmcnt(4)
    v_mfma_f32_16x16x32_bf16 v[80:83], a[24:27], v[56:59], v[80:83]
    ds_read_b128 v[48:51], v13 offset:12288
    ds_read_b128 v[52:55], v13 offset:13312
    v_mfma_f32_16x16x32_bf16 v[84:87], a[28:31], v[56:59], v[84:87]
    v_mfma_f32_16x16x32_bf16 v[88:91], a[24:27], v[60:63], v[88:91]
    v_mfma_f32_16x16x32_bf16 v[92:95], a[28:31], v[60:63], v[92:95]
    s_waitcnt lgkmcnt(4)
    v_mfma_f32_16x16x32_bf16 v[80:83], a[32:35], v[32:35], v[80:83]
    ds_read_b128 v[56:59], v13 offset:14336
    ds_read_b128 v[60:63], v13 offset:15360
    v_mfma_f32_16x16x32_bf16 v[84:87], a[36:39], v[32:35], v[84:87]
    v_mfma_f32_16x16x32_bf16 v[88:91], a[32:35], v[36:39], v[88:91]
    v_mfma_f32_16x16x32_bf16 v[92:95], a[36:39], v[36:39], v[92:95]
    s_waitcnt lgkmcnt(4)
    v_mfma_f32_16x16x32_bf16 v[80:83], a[40:43], v[40:43], v[80:83]
    ds_read_b128 v[32:35], v13 offset:16384
    ds_read_b128 v[36:39], v13 offset:17408
    v_mfma_f32_16x16x32_bf16 v[84:87], a[44:47], v[40:43], v[84:87]
    v_mfma_f32_16x16x32_bf16 v[88:91], a[40:43], v[44:47], v[88:91]
    v_mfma_f32_16x16x32_bf16 v[92:95], a[44:47], v[44:47], v[92:95]
    s_waitcnt lgkmcnt(4)
    v_mfma_f32_16x16x32_bf16 v[80:83], a[48:51], v[48:51], v[80:83]
    ds_read_b128 v[40:43], v13 offset:18432
    ds_read_b128 v[44:47], v13 offset:19456
    v_mfma_f32_16x16x32_bf16 v[84:87], a[52:55], v[48:51], v[84:87]
    v_mfma_f32_16x16x32_bf16 v[88:91], a[48:51], v[52:55], v[88:91]
    v_mfma_f32_16x16x32_bf16 v[92:95], a[52:55], v[52:55], v[92:95]
    s_waitcnt lgkmcnt(4)
    v_mfma_f32_16x16x32_bf16 v[80:83], a[56:59], v[56:59], v[80:83]
    ds_read_b128 v[48:51], v13 offset:20480
    ds_read_b128 v[52:55], v13 offset:21504
    v_mfma_f32_16x16x32_bf16 v[84:87], a[60:63], v[56:59], v[84:87]
    v_mfma_f32_16x16x32_bf16 v[88:91], a[56:59], v[60:63], v[88:91]
    v_mfma_f32_16x16x32_bf16 v[92:95], a[60:63], v[60:63], v[92:95]
    s_waitcnt lgkmcnt(4)
    v_mfma_f32_16x16x32_bf16 v[80:83], a[64:67], v[32:35], v[80:83]
    ds_read_b128 v[56:59], v13 offset:22528
    ds_read_b128 v[60:63], v13 offset:23552
    v_mfma_f32_16x16x32_bf16 v[84:87], a[68:71], v[32:35], v[84:87]
    v_mfma_f32_16x16x32_bf16 v[88:91], a[64:67], v[36:39], v[88:91]
    v_mfma_f32_16x16x32_bf16 v[92:95], a[68:71], v[36:39], v[92:95]
    s_waitcnt lgkmcnt(4)
    v_mfma_f32_16x16x32_bf16 v[80:83], a[72:75], v[40:43], v[80:83]
    ds_read_b128 v[32:35], v13 offset:24576
    ds_read_b128 v[36:39], v13 offset:25600
    v_mfma_f32_16x16x32_bf16 v[84:87], a[76:79], v[40:43], v[84:87]
    v_mfma_f32_16x16x32_bf16 v[88:91], a[72:75], v[44:47], v[88:91]
    v_mfma_f32_16x16x32_bf16 v[92:95], a[76:79], v[44:47], v[92:95]
    s_waitcnt lgkmcnt(4)
    v_mfma_f32_16x16x32_bf16 v[80:83], a[80:83], v[48:51], v[80:83]
    ds_read_b128 v[40:43], v13 offset:26624
    ds_read_b128 v[44:47], v13 offset:27648
    v_mfma_f32_16x16x32_bf16 v[84:87], a[84:87], v[48:51], v[84:87]
    v_mfma_f32_16x16x32_bf16 v[88:91], a[80:83], v[52:55], v[88:91]
    v_mfma_f32_16x16x32_bf16 v[92:95], a[84:87], v[52:55], v[92:95]
    s_waitcnt lgkmcnt(4)
    v_mfma_f32_16x16x32_bf16 v[80:83], a[88:91], v[56:59], v[80:83]
    ds_read_b128 v[48:51], v13 offset:28672
    ds_read_b128 v[52:55], v13 offset:29696
    v_mfma_f32_16x16x32_bf16 v[84:87], a[92:95], v[56:59], v[84:87]
    v_mfma_f32_16x16x32_bf16 v[88:91], a[88:91], v[60:63], v[88:91]
    v_mfma_f32_16x16x32_bf16 v[92:95], a[92:95], v[60:63], v[92:95]
    s_waitcnt lgkmcnt(4)
    v_mfma_f32_16x16x32_bf16 v[80:83], a[96:99], v[32:35], v[80:83]
    ds_read_b128 v[56:59], v13 offset:30720
    ds_read_b128 v[60:63], v13 offset:31744
    v_mfma_f32_16x16x32_bf16 v[84:87], a[100:103], v[32:35], v[84:87]
    v_mfma_f32_16x16x32_bf16 v[88:91], a[96:99], v[36:39], v[88:91]
    v_mfma_f32_16x16x32_bf16 v[92:95], a[100:103], v[36:39], v[92:95]
    s_waitcnt lgkmcnt(4)
    v_mfma_f32_16x16x32_bf16 v[80:83], a[104:107], v[40:43], v[80:83]
    v_mfma_f32_16x16x32_bf16 v[84:87], a[108:111], v[40:43], v[84:87]
    v_mfma_f32_16x16x32_bf16 v[88:91], a[104:107], v[44:47], v[88:91]
    v_mfma_f32_16x16x32_bf16 v[92:95], a[108:111], v[44:47], v[92:95]
    s_waitcnt vmcnt(0) lgkmcnt(0)
    s_barrier
    v_mfma_f32_16x16x32_bf16 v[80:83], a[112:115], v[48:51], v[80:83]
    ds_read_b128 v[32:35], v13 offset:32768
    ds_read_b128 v[36:39], v13 offset:33792
    v_mfma_f32_16x16x32_bf16 v[84:87], a[116:119], v[48:51], v[84:87]
    v_mfma_f32_16x16x32_bf16 v[88:91], a[112:115], v[52:55], v[88:91]
    v_mfma_f32_16x16x32_bf16 v[92:95], a[116:119], v[52:55], v[92:95]
    v_mfma_f32_16x16x32_bf16 v[80:83], a[120:123], v[56:59], v[80:83]
    ds_read_b128 v[40:43], v13 offset:34816
    ds_read_b128 v[44:47], v13 offset:35840
    v_mfma_f32_16x16x32_bf16 v[84:87], a[124:127], v[56:59], v[84:87]
    v_mfma_f32_16x16x32_bf16 v[88:91], a[120:123], v[60:63], v[88:91]
    v_mfma_f32_16x16x32_bf16 v[92:95], a[124:127], v[60:63], v[92:95]
    s_waitcnt lgkmcnt(2)
    v_mfma_f32_16x16x32_bf16 v[80:83], a[128:131], v[32:35], v[80:83]
    ds_read_b128 v[48:51], v13 offset:36864
    ds_read_b128 v[52:55], v13 offset:37888
    v_mfma_f32_16x16x32_bf16 v[84:87], a[132:135], v[32:35], v[84:87]
    ds_read_b128 v[56:59], v13 offset:38912
    ds_read_b128 v[60:63], v13 offset:39936
    v_mfma_f32_16x16x32_bf16 v[88:91], a[128:131], v[36:39], v[88:91]
    v_mfma_f32_16x16x32_bf16 v[92:95], a[132:135], v[36:39], v[92:95]
    s_waitcnt lgkmcnt(4)
    v_mfma_f32_16x16x32_bf16 v[80:83], a[136:139], v[40:43], v[80:83]
    ds_read_b128 v[32:35], v13 offset:40960
    ds_read_b128 v[36:39], v13 offset:41984
    v_mfma_f32_16x16x32_bf16 v[84:87], a[140:143], v[40:43], v[84:87]
    v_mfma_f32_16x16x32_bf16 v[88:91], a[136:139], v[44:47], v[88:91]
    v_mfma_f32_16x16x32_bf16 v[92:95], a[140:143], v[44:47], v[92:95]
    s_waitcnt lgkmcnt(4)
    v_mfma_f32_16x16x32_bf16 v[80:83], a[144:147], v[48:51], v[80:83]
    ds_read_b128 v[40:43], v13 offset:43008
    ds_read_b128 v[44:47], v13 offset:44032
    v_mfma_f32_16x16x32_bf16 v[84:87], a[148:151], v[48:51], v[84:87]
    v_mfma_f32_16x16x32_bf16 v[88:91], a[144:147], v[52:55], v[88:91]
    v_mfma_f32_16x16x32_bf16 v[92:95], a[148:151], v[52:55], v[92:95]
    s_waitcnt lgkmcnt(4)
    v_mfma_f32_16x16x32_bf16 v[80:83], a[152:155], v[56:59], v[80:83]
    ds_read_b128 v[48:51], v13 offset:45056
    ds_read_b128 v[52:55], v13 offset:46080
    v_mfma_f32_16x16x32_bf16 v[84:87], a[156:159], v[56:59], v[84:87]
    v_mfma_f32_16x16x32_bf16 v[88:91], a[152:155], v[60:63], v[88:91]
    v_mfma_f32_16x16x32_bf16 v[92:95], a[156:159], v[60:63], v[92:95]
    s_waitcnt lgkmcnt(4)
    v_mfma_f32_16x16x32_bf16 v[80:83], a[160:163], v[32:35], v[80:83]
    ds_read_b128 v[56:59], v13 offset:47104
    ds_read_b128 v[60:63], v13 offset:48128
    v_mfma_f32_16x16x32_bf16 v[84:87], a[164:167], v[32:35], v[84:87]
    v_mfma_f32_16x16x32_bf16 v[88:91], a[160:163], v[36:39], v[88:91]
    v_mfma_f32_16x16x32_bf16 v[92:95], a[164:167], v[36:39], v[92:95]
    s_waitcnt lgkmcnt(4)
    v_mfma_f32_16x16x32_bf16 v[80:83], a[168:171], v[40:43], v[80:83]
    ds_read_b128 v[32:35], v13 offset:49152
    ds_read_b128 v[36:39], v13 offset:50176
    v_mfma_f32_16x16x32_bf16 v[84:87], a[172:175], v[40:43], v[84:87]
    v_mfma_f32_16x16x32_bf16 v[88:91], a[168:171], v[44:47], v[88:91]
    v_mfma_f32_16x16x32_bf16 v[92:95], a[172:175], v[44:47], v[92:95]
    s_waitcnt lgkmcnt(4)
    v_mfma_f32_16x16x32_bf16 v[80:83], a[176:179], v[48:51], v[80:83]
    ds_read_b128 v[40:43], v13 offset:51200
    ds_read_b128 v[44:47], v13 offset:52224
    v_mfma_f32_16x16x32_bf16 v[84:87], a[180:183], v[48:51], v[84:87]
    v_mfma_f32_16x16x32_bf16 v[88:91], a[176:179], v[52:55], v[88:91]
    v_mfma_f32_16x16x32_bf16 v[92:95], a[180:183], v[52:55], v[92:95]
    s_waitcnt lgkmcnt(4)
    v_mfma_f32_16x16x32_bf16 v[80:83], a[184:187], v[56:59], v[80:83]
    ds_read_b128 v[48:51], v13 offset:53248
    ds_read_b128 v[52:55], v13 offset:54272
    v_mfma_f32_16x16x32_bf16 v[84:87], a[188:191], v[56:59], v[84:87]
    v_mfma_f32_16x16x32_bf16 v[88:91], a[184:187], v[60:63], v[88:91]
    v_mfma_f32_16x16x32_bf16 v[92:95], a[188:191], v[60:63], v[92:95]
    s_waitcnt lgkmcnt(4)
    v_mfma_f32_16x16x32_bf16 v[80:83], a[192:195], v[32:35], v[80:83]
    ds_read_b128 v[56:59], v13 offset:55296
    ds_read_b128 v[60:63], v13 offset:56320
    v_mfma_f32_16x16x32_bf16 v[84:87], a[196:199], v[32:35], v[84:87]
    v_mfma_f32_16x16x32_bf16 v[88:91], a[192:195], v[36:39], v[88:91]
    v_mfma_f32_16x16x32_bf16 v[92:95], a[196:199], v[36:39], v[92:95]
    s_waitcnt lgkmcnt(4)
    v_mfma_f32_16x16x32_bf16 v[80:83], a[200:203], v[40:43], v[80:83]
    ds_read_b128 v[32:35], v13 offset:57344
    ds_read_b128 v[36:39], v13 offset:58368
    v_mfma_f32_16x16x32_bf16 v[84:87], a[204:207], v[40:43], v[84:87]
    v_mfma_f32_16x16x32_bf16 v[88:91], a[200:203], v[44:47], v[88:91]
    v_mfma_f32_16x16x32_bf16 v[92:95], a[204:207], v[44:47], v[92:95]
    s_waitcnt lgkmcnt(4)
    v_mfma_f32_16x16x32_bf16 v[80:83], a[208:211], v[48:51], v[80:83]
    ds_read_b128 v[40:43], v13 offset:59392
    ds_read_b128 v[44:47], v13 offset:60416
    v_mfma_f32_16x16x32_bf16 v[84:87], a[212:215], v[48:51], v[84:87]
    v_mfma_f32_16x16x32_bf16 v[88:91], a[208:211], v[52:55], v[88:91]
    v_mfma_f32_16x16x32_bf16 v[92:95], a[212:215], v[52:55], v[92:95]
    s_waitcnt lgkmcnt(4)
    v_mfma_f32_16x16x32_bf16 v[80:83], a[216:219], v[56:59], v[80:83]
    ds_read_b128 v[48:51], v13 offset:61440
    ds_read_b128 v[52:55], v13 offset:62464
    v_mfma_f32_16x16x32_bf16 v[84:87], a[220:223], v[56:59], v[84:87]
    v_mfma_f32_16x16x32_bf16 v[88:91], a[216:219], v[60:63], v[88:91]
    v_mfma_f32_16x16x32_bf16 v[92:95], a[220:223], v[60:63], v[92:95]
    s_waitcnt lgkmcnt(4)
    v_mfma_f32_16x16x32_bf16 v[80:83], a[224:227], v[32:35], v[80:83]
    ds_read_b128 v[56:59], v13 offset:63488
    ds_read_b128 v[60:63], v13 offset:64512
    v_mfma_f32_16x16x32_bf16 v[84:87], a[228:231], v[32:35], v[84:87]
    v_mfma_f32_16x16x32_bf16 v[88:91], a[224:227], v[36:39], v[88:91]
    v_mfma_f32_16x16x32_bf16 v[92:95], a[228:231], v[36:39], v[92:95]
    s_waitcnt lgkmcnt(4)
    v_mfma_f32_16x16x32_bf16 v[80:83], a[232:235], v[40:43], v[80:83]
    v_mfma_f32_16x16x32_bf16 v[84:87], a[236:239], v[40:43], v[84:87]
    v_mfma_f32_16x16x32_bf16 v[88:91], a[232:235], v[44:47], v[88:91]
    v_mfma_f32_16x16x32_bf16 v[92:95], a[236:239], v[44:47], v[92:95]
    s_waitcnt lgkmcnt(0)
    v_mfma_f32_16x16x32_bf16 v[80:83], a[240:243], v[48:51], v[80:83]
    v_mfma_f32_16x16x32_bf16 v[84:87], a[244:247], v[48:51], v[84:87]
    v_mfma_f32_16x16x32_bf16 v[88:91], a[240:243], v[52:55], v[88:91]
    v_mfma_f32_16x16x32_bf16 v[92:95], a[244:247], v[52:55], v[92:95]
    v_mfma_f32_16x16x32_bf16 v[80:83], a[248:251], v[56:59], v[80:83]
    v_mfma_f32_16x16x32_bf16 v[84:87], a[252:255], v[56:59], v[84:87]
    v_mfma_f32_16x16x32_bf16 v[88:91], a[248:251], v[60:63], v[88:91]
    v_mfma_f32_16x16x32_bf16 v[92:95], a[252:255], v[60:63], v[92:95]
    s_mov_b32 s76, s57
    s_nop 6
    ds_write_b128 v7, v[80:83] offset:0
    ds_write_b128 v7, v[84:87] offset:64
    ds_write_b128 v7, v[88:91] offset:2304
    ds_write_b128 v7, v[92:95] offset:2368
L_e_fin_143:
    s_waitcnt lgkmcnt(0)
    ds_read_b128 v[216:219], v8 offset:0
    ds_read_b128 v[220:223], v8 offset:1152
    ds_read_b128 v[224:227], v8 offset:2304
    ds_read_b128 v[228:231], v8 offset:3456
    s_waitcnt lgkmcnt(0)
    buffer_store_dwordx4 v[216:219], v11, s[12:15], s76 offen sc1
    s_add_u32 s76, s76, 32768
    buffer_store_dwordx4 v[220:223], v11, s[12:15], s76 offen sc1
    s_add_u32 s76, s76, 32768
    buffer_store_dwordx4 v[224:227], v11, s[12:15], s76 offen sc1
    s_add_u32 s76, s76, 32768
    buffer_store_dwordx4 v[228:231], v11, s[12:15], s76 offen sc1
    s_waitcnt vmcnt(0)
    s_barrier
    s_cmp_lg_u32 s44, 0
    s_cbranch_scc1 L_pub_144
    v_mov_b32 v30, s62
    v_mov_b32 v31, 0
    s_mov_b64 exec, 1
    buffer_store_dword v30, v31, s[12:15], s67 offen sc1
    s_mov_b64 exec, -1
L_pub_144:
    s_branch L_a_loop_127
L_role_b_125:
    s_load_dwordx2 s[6:7], s[0:1], 64
    s_load_dwordx2 s[8:9], s[0:1], 72
    s_waitcnt lgkmcnt(0)
    s_mov_b32 s24, s6
    s_and_b32 s25, s7, 0xffff
    s_mov_b32 s26, 0x700000
    s_mov_b32 s27, 0x00020000
    s_mov_b32 s32, s8
    s_and_b32 s33, s9, 0xffff
    s_mov_b32 s34, 0x1c00
    s_mov_b32 s35, 0x00020000
    s_min_u32 s45, s41, 27
    s_lshl_b32 s46, s45, 8
    s_waitcnt vmcnt(0)
    s_barrier
    v_lshrrev_b32 v20, 4, v1
    s_lshl_b32 s45, s44, 2
    v_add_u32 v21, s45, v20
    s_mov_b32 s45, 7168
    v_mul_lo_u32 v21, v21, s45
    v_lshlrev_b32 v22, 2, v20
    v_and_b32 v23, 15, v1
    v_xor_b32 v22, v22, v23
    v_lshlrev_b32 v22, 4, v22
    v_add_u32 v21, v21, v22
    v_bfe_u32 v22, v1, 2, 2
    v_lshlrev_b32 v23, 3, v20
    v_add_u32 v23, v23, v22
    v_lshlrev_b32 v23, 8, v23
    v_xor_b32 v22, s44, v22
    v_lshlrev_b32 v22, 6, v22
    v_add_u32 v23, v23, v22
    v_and_b32 v22, 3, v1
    v_lshlrev_b32 v22, 4, v22
    v_add_u32 v23, v23, v22
    v_add_u32 v24, 65536, v23
    v_add_u32 v25, 131072, v23
    s_lshl_b32 s47, s44, 10
    s_add_u32 s45, s46, 0x0
    s_add_u32 m0, s47, 0
    s_nop 0
    buffer_load_dwordx4 v21, s[24:27], s45 offen  lds
    s_add_u32 s45, s46, 0x1c000
    s_add_u32 m0, s47, 4096
    s_nop 0
    buffer_load_dwordx4 v21, s[24:27], s45 offen  lds
    s_add_u32 s45, s46, 0x38000
    s_add_u32 m0, s47, 8192
    s_nop 0
    buffer_load_dwordx4 v21, s[24:27], s45 offen  lds
    s_add_u32 s45, s46, 0x54000
    s_add_u32 m0, s47, 12288
    s_nop 0
    buffer_load_dwordx4 v21, s[24:27], s45 offen  lds
    s_add_u32 s45, s46, 0x70000
    s_add_u32 m0, s47, 16384
    s_nop 0
    buffer_load_dwordx4 v21, s[24:27], s45 offen  lds
    s_add_u32 s45, s46, 0x8c000
    s_add_u32 m0, s47, 20480
    s_nop 0
    buffer_load_dwordx4 v21, s[24:27], s45 offen  lds
    s_add_u32 s45, s46, 0xa8000
    s_add_u32 m0, s47, 24576
    s_nop 0
    buffer_load_dwordx4 v21, s[24:27], s45 offen  lds
    s_add_u32 s45, s46, 0xc4000
    s_add_u32 m0, s47, 28672
    s_nop 0
    buffer_load_dwordx4 v21, s[24:27], s45 offen  lds
    s_add_u32 s45, s46, 0xe0000
    s_add_u32 m0, s47, 32768
    s_nop 0
    buffer_load_dwordx4 v21, s[24:27], s45 offen  lds
    s_add_u32 s45, s46, 0xfc000
    s_add_u32 m0, s47, 36864
    s_nop 0
    buffer_load_dwordx4 v21, s[24:27], s45 offen  lds
    s_add_u32 s45, s46, 0x118000
    s_add_u32 m0, s47, 40960
    s_nop 0
    buffer_load_dwordx4 v21, s[24:27], s45 offen  lds
    s_add_u32 s45, s46, 0x134000
    s_add_u32 m0, s47, 45056
    s_nop 0
    buffer_load_dwordx4 v21, s[24:27], s45 offen  lds
    s_add_u32 s45, s46, 0x150000
    s_add_u32 m0, s47, 49152
    s_nop 0
    buffer_load_dwordx4 v21, s[24:27], s45 offen  lds
    s_add_u32 s45, s46, 0x16c000
    s_add_u32 m0, s47, 53248
    s_nop 0
    buffer_load_dwordx4 v21, s[24:27], s45 offen  lds
    s_add_u32 s45, s46, 0x188000
    s_add_u32 m0, s47, 57344
    s_nop 0
    buffer_load_dwordx4 v21, s[24:27], s45 offen  lds
    s_add_u32 s45, s46, 0x1a4000
    s_add_u32 m0, s47, 61440
    s_nop 0
    buffer_load_dwordx4 v21, s[24:27], s45 offen  lds
    s_add_u32 s45, s46, 0x1c0000
    s_add_u32 m0, s47, 65536
    s_nop 0
    buffer_load_dwordx4 v21, s[24:27], s45 offen  lds
    s_add_u32 s45, s46, 0x1dc000
    s_add_u32 m0, s47, 69632
    s_nop 0
    buffer_load_dwordx4 v21, s[24:27], s45 offen  lds
    s_add_u32 s45, s46, 0x1f8000
    s_add_u32 m0, s47, 73728
    s_nop 0
    buffer_load_dwordx4 v21, s[24:27], s45 offen  lds
    s_add_u32 s45, s46, 0x214000
    s_add_u32 m0, s47, 77824
    s_nop 0
    buffer_load_dwordx4 v21, s[24:27], s45 offen  lds
    s_add_u32 s45, s46, 0x230000
    s_add_u32 m0, s47, 81920
    s_nop 0
    buffer_load_dwordx4 v21, s[24:27], s45 offen  lds
    s_add_u32 s45, s46, 0x24c000
    s_add_u32 m0, s47, 86016
    s_nop 0
    buffer_load_dwordx4 v21, s[24:27], s45 offen  lds
    s_add_u32 s45, s46, 0x268000
    s_add_u32 m0, s47, 90112
    s_nop 0
    buffer_load_dwordx4 v21, s[24:27], s45 offen  lds
    s_add_u32 s45, s46, 0x284000
    s_add_u32 m0, s47, 94208
    s_nop 0
    buffer_load_dwordx4 v21, s[24:27], s45 offen  lds
    s_add_u32 s45, s46, 0x2a0000
    s_add_u32 m0, s47, 98304
    s_nop 0
    buffer_load_dwordx4 v21, s[24:27], s45 offen  lds
    s_add_u32 s45, s46, 0x2bc000
    s_add_u32 m0, s47, 102400
    s_nop 0
    buffer_load_dwordx4 v21, s[24:27], s45 offen  lds
    s_add_u32 s45, s46, 0x2d8000
    s_add_u32 m0, s47, 106496
    s_nop 0
    buffer_load_dwordx4 v21, s[24:27], s45 offen  lds
    s_add_u32 s45, s46, 0x2f4000
    s_add_u32 m0, s47, 110592
    s_nop 0
    buffer_load_dwordx4 v21, s[24:27], s45 offen  lds
    s_add_u32 s45, s46, 0x310000
    s_add_u32 m0, s47, 114688
    s_nop 0
    buffer_load_dwordx4 v21, s[24:27], s45 offen  lds
    s_add_u32 s45, s46, 0x32c000
    s_add_u32 m0, s47, 118784
    s_nop 0
    buffer_load_dwordx4 v21, s[24:27], s45 offen  lds
    s_add_u32 s45, s46, 0x348000
    s_add_u32 m0, s47, 122880
    s_nop 0
    buffer_load_dwordx4 v21, s[24:27], s45 offen  lds
    s_add_u32 s45, s46, 0x364000
    s_add_u32 m0, s47, 126976
    s_nop 0
    buffer_load_dwordx4 v21, s[24:27], s45 offen  lds
    s_waitcnt vmcnt(28)
    s_barrier
    s_add_u32 s45, s46, 0x380000
    s_add_u32 m0, s47, 131072
    s_nop 0
    buffer_load_dwordx4 v21, s[24:27], s45 offen  lds
    s_add_u32 s45, s46, 0x39c000
    s_add_u32 m0, s47, 135168
    s_nop 0
    buffer_load_dwordx4 v21, s[24:27], s45 offen  lds
    s_add_u32 s45, s46, 0x3b8000
    s_add_u32 m0, s47, 139264
    s_nop 0
    buffer_load_dwordx4 v21, s[24:27], s45 offen  lds
    s_add_u32 s45, s46, 0x3d4000
    s_add_u32 m0, s47, 143360
    s_nop 0
    buffer_load_dwordx4 v21, s[24:27], s45 offen  lds
    ds_read_b64_tr_b16 a[0:1], v23 offset:0
    ds_read_b64_tr_b16 a[2:3], v23 offset:1024
    ds_read_b64_tr_b16 a[4:5], v23 offset:8
    ds_read_b64_tr_b16 a[6:7], v23 offset:1032
    ds_read_b64_tr_b16 a[8:9], v23 offset:8192
    ds_read_b64_tr_b16 a[10:11], v23 offset:9216
    ds_read_b64_tr_b16 a[12:13], v23 offset:8200
    ds_read_b64_tr_b16 a[14:15], v23 offset:9224
    s_waitcnt lgkmcnt(0)
    s_waitcnt vmcnt(28)
    s_barrier
    s_add_u32 s45, s46, 0x3f0000
    s_add_u32 m0, s47, 0
    s_nop 0
    buffer_load_dwordx4 v21, s[24:27], s45 offen  lds
    s_add_u32 s45, s46, 0x40c000
    s_add_u32 m0, s47, 4096
    s_nop 0
    buffer_load_dwordx4 v21, s[24:27], s45 offen  lds
    s_add_u32 s45, s46, 0x428000
    s_add_u32 m0, s47, 8192
    s_nop 0
    buffer_load_dwordx4 v21, s[24:27], s45 offen  lds
    s_add_u32 s45, s46, 0x444000
    s_add_u32 m0, s47, 12288
    s_nop 0
    buffer_load_dwordx4 v21, s[24:27], s45 offen  lds
    ds_read_b64_tr_b16 a[16:17], v23 offset:16384
    ds_read_b64_tr_b16 a[18:19], v23 offset:17408
    ds_read_b64_tr_b16 a[20:21], v23 offset:16392
    ds_read_b64_tr_b16 a[22:23], v23 offset:17416
    ds_read_b64_tr_b16 a[24:25], v23 offset:24576
    ds_read_b64_tr_b16 a[26:27], v23 offset:25600
    ds_read_b64_tr_b16 a[28:29], v23 offset:24584
    ds_read_b64_tr_b16 a[30:31], v23 offset:25608
    s_waitcnt lgkmcnt(0)
    s_waitcnt vmcnt(28)
    s_barrier
    s_add_u32 s45, s46, 0x460000
    s_add_u32 m0, s47, 16384
    s_nop 0
    buffer_load_dwordx4 v21, s[24:27], s45 offen  lds
    s_add_u32 s45, s46, 0x47c000
    s_add_u32 m0, s47, 20480
    s_nop 0
    buffer_load_dwordx4 v21, s[24:27], s45 offen  lds
    s_add_u32 s45, s46, 0x498000
    s_add_u32 m0, s47, 24576
    s_nop 0
    buffer_load_dwordx4 v21, s[24:27], s45 offen  lds
    s_add_u32 s45, s46, 0x4b4000
    s_add_u32 m0, s47, 28672
    s_nop 0
    buffer_load_dwordx4 v21, s[24:27], s45 offen  lds
    ds_read_b64_tr_b16 a[32:33], v23 offset:32768
    ds_read_b64_tr_b16 a[34:35], v23 offset:33792
    ds_read_b64_tr_b16 a[36:37], v23 offset:32776
    ds_read_b64_tr_b16 a[38:39], v23 offset:33800
    ds_read_b64_tr_b16 a[40:41], v23 offset:40960
    ds_read_b64_tr_b16 a[42:43], v23 offset:41984
    ds_read_b64_tr_b16 a[44:45], v23 offset:40968
    ds_read_b64_tr_b16 a[46:47], v23 offset:41992
    s_waitcnt lgkmcnt(0)
    s_waitcnt vmcnt(28)
    s_barrier
    s_add_u32 s45, s46, 0x4d0000
    s_add_u32 m0, s47, 32768
    s_nop 0
    buffer_load_dwordx4 v21, s[24:27], s45 offen  lds
    s_add_u32 s45, s46, 0x4ec000
    s_add_u32 m0, s47, 36864
    s_nop 0
    buffer_load_dwordx4 v21, s[24:27], s45 offen  lds
    s_add_u32 s45, s46, 0x508000
    s_add_u32 m0, s47, 40960
    s_nop 0
    buffer_load_dwordx4 v21, s[24:27], s45 offen  lds
    s_add_u32 s45, s46, 0x524000
    s_add_u32 m0, s47, 45056
    s_nop 0
    buffer_load_dwordx4 v21, s[24:27], s45 offen  lds
    ds_read_b64_tr_b16 a[48:49], v23 offset:49152
    ds_read_b64_tr_b16 a[50:51], v23 offset:50176
    ds_read_b64_tr_b16 a[52:53], v23 offset:49160
    ds_read_b64_tr_b16 a[54:55], v23 offset:50184
    ds_read_b64_tr_b16 a[56:57], v23 offset:57344
    ds_read_b64_tr_b16 a[58:59], v23 offset:58368
    ds_read_b64_tr_b16 a[60:61], v23 offset:57352
    ds_read_b64_tr_b16 a[62:63], v23 offset:58376
    s_waitcnt lgkmcnt(0)
    s_waitcnt vmcnt(28)
    s_barrier
    s_add_u32 s45, s46, 0x540000
    s_add_u32 m0, s47, 49152
    s_nop 0
    buffer_load_dwordx4 v21, s[24:27], s45 offen  lds
    s_add_u32 s45, s46, 0x55c000
    s_add_u32 m0, s47, 53248
    s_nop 0
    buffer_load_dwordx4 v21, s[24:27], s45 offen  lds
    s_add_u32 s45, s46, 0x578000
    s_add_u32 m0, s47, 57344
    s_nop 0
    buffer_load_dwordx4 v21, s[24:27], s45 offen  lds
    s_add_u32 s45, s46, 0x594000
    s_add_u32 m0, s47, 61440
    s_nop 0
    buffer_load_dwordx4 v21, s[24:27], s45 offen  lds
    ds_read_b64_tr_b16 a[64:65], v24 offset:0
    ds_read_b64_tr_b16 a[66:67], v24 offset:1024
    ds_read_b64_tr_b16 a[68:69], v24 offset:8
    ds_read_b64_tr_b16 a[70:71], v24 offset:1032
    ds_read_b64_tr_b16 a[72:73], v24 offset:8192
    ds_read_b64_tr_b16 a[74:75], v24 offset:9216
    ds_read_b64_tr_b16 a[76:77], v24 offset:8200
    ds_read_b64_tr_b16 a[78:79], v24 offset:9224
    s_waitcnt lgkmcnt(0)
    s_waitcnt vmcnt(28)
    s_barrier
    s_add_u32 s45, s46, 0x5b0000
    s_add_u32 m0, s47, 65536
    s_nop 0
    buffer_load_dwordx4 v21, s[24:27], s45 offen  lds
    s_add_u32 s45, s46, 0x5cc000
    s_add_u32 m0, s47, 69632
    s_nop 0
    buffer_load_dwordx4 v21, s[24:27], s45 offen  lds
    s_add_u32 s45, s46, 0x5e8000
    s_add_u32 m0, s47, 73728
    s_nop 0
    buffer_load_dwordx4 v21, s[24:27], s45 offen  lds
    s_add_u32 s45, s46, 0x604000
    s_add_u32 m0, s47, 77824
    s_nop 0
    buffer_load_dwordx4 v21, s[24:27], s45 offen  lds
    ds_read_b64_tr_b16 a[80:81], v24 offset:16384
    ds_read_b64_tr_b16 a[82:83], v24 offset:17408
    ds_read_b64_tr_b16 a[84:85], v24 offset:16392
    ds_read_b64_tr_b16 a[86:87], v24 offset:17416
    ds_read_b64_tr_b16 a[88:89], v24 offset:24576
    ds_read_b64_tr_b16 a[90:91], v24 offset:25600
    ds_read_b64_tr_b16 a[92:93], v24 offset:24584
    ds_read_b64_tr_b16 a[94:95], v24 offset:25608
    s_waitcnt lgkmcnt(0)
    s_waitcnt vmcnt(28)
    s_barrier
    s_add_u32 s45, s46, 0x620000
    s_add_u32 m0, s47, 81920
    s_nop 0
    buffer_load_dwordx4 v21, s[24:27], s45 offen  lds
    s_add_u32 s45, s46, 0x63c000
    s_add_u32 m0, s47, 86016
    s_nop 0
    buffer_load_dwordx4 v21, s[24:27], s45 offen  lds
    s_add_u32 s45, s46, 0x658000
    s_add_u32 m0, s47, 90112
    s_nop 0
    buffer_load_dwordx4 v21, s[24:27], s45 offen  lds
    s_add_u32 s45, s46, 0x674000
    s_add_u32 m0, s47, 94208
    s_nop 0
    buffer_load_dwordx4 v21, s[24:27], s45 offen  lds
    ds_read_b64_tr_b16 a[96:97], v24 offset:32768
    ds_read_b64_tr_b16 a[98:99], v24 offset:33792
    ds_read_b64_tr_b16 a[100:101], v24 offset:32776
    ds_read_b64_tr_b16 a[102:103], v24 offset:33800
    ds_read_b64_tr_b16 a[104:105], v24 offset:40960
    ds_read_b64_tr_b16 a[106:107], v24 offset:41984
    ds_read_b64_tr_b16 a[108:109], v24 offset:40968
    ds_read_b64_tr_b16 a[110:111], v24 offset:41992
    s_waitcnt lgkmcnt(0)
    s_waitcnt vmcnt(28)
    s_barrier
    s_add_u32 s45, s46, 0x690000
    s_add_u32 m0, s47, 98304
    s_nop 0
    buffer_load_dwordx4 v21, s[24:27], s45 offen  lds
    s_add_u32 s45, s46, 0x6ac000
    s_add_u32 m0, s47, 102400
    s_nop 0
    buffer_load_dwordx4 v21, s[24:27], s45 offen  lds
    s_add_u32 s45, s46, 0x6c8000
    s_add_u32 m0, s47, 106496
    s_nop 0
    buffer_load_dwordx4 v21, s[24:27], s45 offen  lds
    s_add_u32 s45, s46, 0x6e4000
    s_add_u32 m0, s47, 110592
    s_nop 0
    buffer_load_dwordx4 v21, s[24:27], s45 offen  lds
    ds_read_b64_tr_b16 a[112:113], v24 offset:49152
    ds_read_b64_tr_b16 a[114:115], v24 offset:50176
    ds_read_b64_tr_b16 a[116:117], v24 offset:49160
    ds_read_b64_tr_b16 a[118:119], v24 offset:50184
    ds_read_b64_tr_b16 a[120:121], v24 offset:57344
    ds_read_b64_tr_b16 a[122:123], v24 offset:58368
    ds_read_b64_tr_b16 a[124:125], v24 offset:57352
    ds_read_b64_tr_b16 a[126:127], v24 offset:58376
    s_waitcnt lgkmcnt(0)
    s_waitcnt vmcnt(28)
    s_barrier
    ds_read_b64_tr_b16 a[128:129], v25 offset:0
    ds_read_b64_tr_b16 a[130:131], v25 offset:1024
    ds_read_b64_tr_b16 a[132:133], v25 offset:8
    ds_read_b64_tr_b16 a[134:135], v25 offset:1032
    ds_read_b64_tr_b16 a[136:137], v25 offset:8192
    ds_read_b64_tr_b16 a[138:139], v25 offset:9216
    ds_read_b64_tr_b16 a[140:141], v25 offset:8200
    ds_read_b64_tr_b16 a[142:143], v25 offset:9224
    s_waitcnt lgkmcnt(0)
    s_waitcnt vmcnt(24)
    s_barrier
    ds_read_b64_tr_b16 a[144:145], v23 offset:0
    ds_read_b64_tr_b16 a[146:147], v23 offset:1024
    ds_read_b64_tr_b16 a[148:149], v23 offset:8
    ds_read_b64_tr_b16 a[150:151], v23 offset:1032
    ds_read_b64_tr_b16 a[152:153], v23 offset:8192
    ds_read_b64_tr_b16 a[154:155], v23 offset:9216
    ds_read_b64_tr_b16 a[156:157], v23 offset:8200
    ds_read_b64_tr_b16 a[158:159], v23 offset:9224
    s_waitcnt lgkmcnt(0)
    s_waitcnt vmcnt(20)
    s_barrier
    ds_read_b64_tr_b16 a[160:161], v23 offset:16384
    ds_read_b64_tr_b16 a[162:163], v23 offset:17408
    ds_read_b64_tr_b16 a[164:165], v23 offset:16392
    ds_read_b64_tr_b16 a[166:167], v23 offset:17416
    ds_read_b64_tr_b16 a[168:169], v23 offset:24576
    ds_read_b64_tr_b16 a[170:171], v23 offset:25600
    ds_read_b64_tr_b16 a[172:173], v23 offset:24584
    ds_read_b64_tr_b16 a[174:175], v23 offset:25608
    s_waitcnt lgkmcnt(0)
    s_waitcnt vmcnt(16)
    s_barrier
    ds_read_b64_tr_b16 a[176:177], v23 offset:32768
    ds_read_b64_tr_b16 a[178:179], v23 offset:33792
    ds_read_b64_tr_b16 a[180:181], v23 offset:32776
    ds_read_b64_tr_b16 a[182:183], v23 offset:33800
    ds_read_b64_tr_b16 a[184:185], v23 offset:40960
    ds_read_b64_tr_b16 a[186:187], v23 offset:41984
    ds_read_b64_tr_b16 a[188:189], v23 offset:40968
    ds_read_b64_tr_b16 a[190:191], v23 offset:41992
    s_waitcnt lgkmcnt(0)
    s_waitcnt vmcnt(12)
    s_barrier
    ds_read_b64_tr_b16 a[192:193], v23 offset:49152
    ds_read_b64_tr_b16 a[194:195], v23 offset:50176
    ds_read_b64_tr_b16 a[196:197], v23 offset:49160
    ds_read_b64_tr_b16 a[198:199], v23 offset:50184
    ds_read_b64_tr_b16 a[200:201], v23 offset:57344
    ds_read_b64_tr_b16 a[202:203], v23 offset:58368
    ds_read_b64_tr_b16 a[204:205], v23 offset:57352
    ds_read_b64_tr_b16 a[206:207], v23 offset:58376
    s_waitcnt lgkmcnt(0)
    s_waitcnt vmcnt(8)
    s_barrier
    ds_read_b64_tr_b16 a[208:209], v24 offset:0
    ds_read_b64_tr_b16 a[210:211], v24 offset:1024
    ds_read_b64_tr_b16 a[212:213], v24 offset:8
    ds_read_b64_tr_b16 a[214:215], v24 offset:1032
    ds_read_b64_tr_b16 a[216:217], v24 offset:8192
    ds_read_b64_tr_b16 a[218:219], v24 offset:9216
    ds_read_b64_tr_b16 a[220:221], v24 offset:8200
    ds_read_b64_tr_b16 a[222:223], v24 offset:9224
    s_waitcnt lgkmcnt(0)
    s_waitcnt vmcnt(4)
    s_barrier
    ds_read_b64_tr_b16 a[224:225], v24 offset:16384
    ds_read_b64_tr_b16 a[226:227], v24 offset:17408
    ds_read_b64_tr_b16 a[228:229], v24 offset:16392
    ds_read_b64_tr_b16 a[230:231], v24 offset:17416
    ds_read_b64_tr_b16 a[232:233], v24 offset:24576
    ds_read_b64_tr_b16 a[234:235], v24 offset:25600
    ds_read_b64_tr_b16 a[236:237], v24 offset:24584
    ds_read_b64_tr_b16 a[238:239], v24 offset:25608
    s_waitcnt lgkmcnt(0)
    s_waitcnt vmcnt(0)
    s_barrier
    ds_read_b64_tr_b16 a[240:241], v24 offset:32768
    ds_read_b64_tr_b16 a[242:243], v24 offset:33792
    ds_read_b64_tr_b16 a[244:245], v24 offset:32776
    ds_read_b64_tr_b16 a[246:247], v24 offset:33800
    ds_read_b64_tr_b16 a[248:249], v24 offset:40960
    ds_read_b64_tr_b16 a[250:251], v24 offset:41984
    ds_read_b64_tr_b16 a[252:253], v24 offset:40968
    ds_read_b64_tr_b16 a[254:255], v24 offset:41992
    s_waitcnt lgkmcnt(0)
    s_barrier
    s_min_u32 s45, s41, 27
    s_lshl_b32 s45, s45, 8
    s_lshl_b32 s46, s44, 6
    s_add_u32 s45, s45, s46
    v_lshrrev_b32 v29, 4, v1
    v_lshlrev_b32 v29, 4, v29
    buffer_load_dwordx4 v[80:83], v29, s[32:35], s45 offen
    s_waitcnt vmcnt(0)
    v_lshlrev_b32 v96, 16, v80
    v_and_b32 v97, 0xffff0000, v80
    v_lshlrev_b32 v98, 16, v81
    v_and_b32 v99, 0xffff0000, v81
    v_lshlrev_b32 v100, 16, v82
    v_and_b32 v101, 0xffff0000, v82
    v_lshlrev_b32 v102, 16, v83
    v_and_b32 v103, 0xffff0000, v83
    v_mov_b32 v104, 0xbdd2d3e8
    v_mov_b32 v105, v104
    v_mov_b32 v106, 0xc0135761
    v_mov_b32 v107, v106
    s_cmp_lg_u32 s44, 0
    s_cbranch_scc1 L_pd_145
    v_mov_b32 v29, 127232
    s_mov_b32 s46, 96
    s_mov_b64 exec, 1
    s_mov_b32 s70, 0
L_wp_146:
    buffer_load_dword v31, v29, s[12:15], 0 offen sc1
    s_add_u32 s70, s70, 1
    s_cmp_ge_u32 s70, 0x200000
    s_cbranch_scc1 L_w_done_98
    s_waitcnt vmcnt(0)
    v_cmp_gt_u32 vcc, s46, v31
    s_nop 1
    s_cbranch_vccz L_wp_146_ok
    s_sleep 3
    s_branch L_wp_146
L_wp_146_ok:
    s_mov_b64 exec, -1
L_pd_145:
    s_barrier
    v_lshlrev_b32 v29, 5, v1
    s_mov_b32 s45, 8192
    buffer_load_dwordx4 v[112:115], v29, s[12:15], s45 offen offset:0 sc1
    buffer_load_dwordx4 v[116:119], v29, s[12:15], s45 offen offset:16 sc1
    buffer_load_dwordx4 v[120:123], v29, s[12:15], s45 offen offset:2048 sc1
    buffer_load_dwordx4 v[124:127], v29, s[12:15], s45 offen offset:2064 sc1
    s_mov_b32 s45, 32768
    buffer_load_dwordx4 v[32:35], v29, s[12:15], s45 offen offset:0 sc1
    buffer_load_dwordx4 v[36:39], v29, s[12:15], s45 offen offset:16 sc1
    buffer_load_dwordx4 v[40:43], v29, s[12:15], s45 offen offset:2048 sc1
    buffer_load_dwordx4 v[44:47], v29, s[12:15], s45 offen offset:2064 sc1
    s_mov_b32 s45, 12288
    buffer_load_dwordx4 v[128:131], v29, s[12:15], s45 offen offset:0 sc1
    buffer_load_dwordx4 v[132:135], v29, s[12:15], s45 offen offset:16 sc1
    buffer_load_dwordx4 v[136:139], v29, s[12:15], s45 offen offset:2048 sc1
    buffer_load_dwordx4 v[140:143], v29, s[12:15], s45 offen offset:2064 sc1
    s_mov_b32 s45, 36864
    buffer_load_dwordx4 v[48:51], v29, s[12:15], s45 offen offset:0 sc1
    buffer_load_dwordx4 v[52:55], v29, s[12:15], s45 offen offset:16 sc1
    buffer_load_dwordx4 v[56:59], v29, s[12:15], s45 offen offset:2048 sc1
    buffer_load_dwordx4 v[60:63], v29, s[12:15], s45 offen offset:2064 sc1
    s_mov_b32 s45, 16384
    buffer_load_dwordx4 v[144:147], v29, s[12:15], s45 offen offset:0 sc1
    buffer_load_dwordx4 v[148:151], v29, s[12:15], s45 offen offset:16 sc1
    buffer_load_dwordx4 v[152:155], v29, s[12:15], s45 offen offset:2048 sc1
    buffer_load_dwordx4 v[156:159], v29, s[12:15], s45 offen offset:2064 sc1
    s_mov_b32 s45, 40960
    buffer_load_dwordx4 v[64:67], v29, s[12:15], s45 offen offset:0 sc1
    buffer_load_dwordx4 v[68:71], v29, s[12:15], s45 offen offset:16 sc1
    buffer_load_dwordx4 v[72:75], v29, s[12:15], s45 offen offset:2048 sc1
    buffer_load_dwordx4 v[76:79], v29, s[12:15], s45 offen offset:2064 sc1
    s_waitcnt vmcnt(0)
    v_add_f32 v112, v112, v32
    v_cvt_pk_bf16_f32 v112, v112, v112
    v_lshlrev_b32 v112, 16, v112
    v_add_f32 v113, v113, v33
    v_cvt_pk_bf16_f32 v113, v113, v113
    v_lshlrev_b32 v113, 16, v113
    v_add_f32 v114, v114, v34
    v_cvt_pk_bf16_f32 v114, v114, v114
    v_lshlrev_b32 v114, 16, v114
    v_add_f32 v115, v115, v35
    v_cvt_pk_bf16_f32 v115, v115, v115
    v_lshlrev_b32 v115, 16, v115
    v_add_f32 v116, v116, v36
    v_cvt_pk_bf16_f32 v116, v116, v116
    v_lshlrev_b32 v116, 16, v116
    v_add_f32 v117, v117, v37
    v_cvt_pk_bf16_f32 v117, v117, v117
    v_lshlrev_b32 v117, 16, v117
    v_add_f32 v118, v118, v38
    v_cvt_pk_bf16_f32 v118, v118, v118
    v_lshlrev_b32 v118, 16, v118
    v_add_f32 v119, v119, v39
    v_cvt_pk_bf16_f32 v119, v119, v119
    v_lshlrev_b32 v119, 16, v119
    v_add_f32 v120, v120, v40
    v_cvt_pk_bf16_f32 v120, v120, v120
    v_lshlrev_b32 v120, 16, v120
    v_add_f32 v121, v121, v41
    v_cvt_pk_bf16_f32 v121, v121, v121
    v_lshlrev_b32 v121, 16, v121
    v_add_f32 v122, v122, v42
    v_cvt_pk_bf16_f32 v122, v122, v122
    v_lshlrev_b32 v122, 16, v122
    v_add_f32 v123, v123, v43
    v_cvt_pk_bf16_f32 v123, v123, v123
    v_lshlrev_b32 v123, 16, v123
    v_add_f32 v124, v124, v44
    v_cvt_pk_bf16_f32 v124, v124, v124
    v_lshlrev_b32 v124, 16, v124
    v_add_f32 v125, v125, v45
    v_cvt_pk_bf16_f32 v125, v125, v125
    v_lshlrev_b32 v125, 16, v125
    v_add_f32 v126, v126, v46
    v_cvt_pk_bf16_f32 v126, v126, v126
    v_lshlrev_b32 v126, 16, v126
    v_add_f32 v127, v127, v47
    v_cvt_pk_bf16_f32 v127, v127, v127
    v_lshlrev_b32 v127, 16, v127
    v_add_f32 v128, v128, v48
    v_cvt_pk_bf16_f32 v128, v128, v128
    v_lshlrev_b32 v128, 16, v128
    v_add_f32 v129, v129, v49
    v_cvt_pk_bf16_f32 v129, v129, v129
    v_lshlrev_b32 v129, 16, v129
    v_add_f32 v130, v130, v50
    v_cvt_pk_bf16_f32 v130, v130, v130
    v_lshlrev_b32 v130, 16, v130
    v_add_f32 v131, v131, v51
    v_cvt_pk_bf16_f32 v131, v131, v131
    v_lshlrev_b32 v131, 16, v131
    v_add_f32 v132, v132, v52
    v_cvt_pk_bf16_f32 v132, v132, v132
    v_lshlrev_b32 v132, 16, v132
    v_add_f32 v133, v133, v53
    v_cvt_pk_bf16_f32 v133, v133, v133
    v_lshlrev_b32 v133, 16, v133
    v_add_f32 v134, v134, v54
    v_cvt_pk_bf16_f32 v134, v134, v134
    v_lshlrev_b32 v134, 16, v134
    v_add_f32 v135, v135, v55
    v_cvt_pk_bf16_f32 v135, v135, v135
    v_lshlrev_b32 v135, 16, v135
    v_add_f32 v136, v136, v56
    v_cvt_pk_bf16_f32 v136, v136, v136
    v_lshlrev_b32 v136, 16, v136
    v_add_f32 v137, v137, v57
    v_cvt_pk_bf16_f32 v137, v137, v137
    v_lshlrev_b32 v137, 16, v137
    v_add_f32 v138, v138, v58
    v_cvt_pk_bf16_f32 v138, v138, v138
    v_lshlrev_b32 v138, 16, v138
    v_add_f32 v139, v139, v59
    v_cvt_pk_bf16_f32 v139, v139, v139
    v_lshlrev_b32 v139, 16, v139
    v_add_f32 v140, v140, v60
    v_cvt_pk_bf16_f32 v140, v140, v140
    v_lshlrev_b32 v140, 16, v140
    v_add_f32 v141, v141, v61
    v_cvt_pk_bf16_f32 v141, v141, v141
    v_lshlrev_b32 v141, 16, v141
    v_add_f32 v142, v142, v62
    v_cvt_pk_bf16_f32 v142, v142, v142
    v_lshlrev_b32 v142, 16, v142
    v_add_f32 v143, v143, v63
    v_cvt_pk_bf16_f32 v143, v143, v143
    v_lshlrev_b32 v143, 16, v143
    v_add_f32 v144, v144, v64
    v_cvt_pk_bf16_f32 v144, v144, v144
    v_lshlrev_b32 v144, 16, v144
    v_add_f32 v144, 1.0, v144
    v_cvt_pk_bf16_f32 v144, v144, v144
    v_lshlrev_b32 v144, 16, v144
    v_add_f32 v145, v145, v65
    v_cvt_pk_bf16_f32 v145, v145, v145
    v_lshlrev_b32 v145, 16, v145
    v_add_f32 v145, 1.0, v145
    v_cvt_pk_bf16_f32 v145, v145, v145
    v_lshlrev_b32 v145, 16, v145
    v_add_f32 v146, v146, v66
    v_cvt_pk_bf16_f32 v146, v146, v146
    v_lshlrev_b32 v146, 16, v146
    v_add_f32 v146, 1.0, v146
    v_cvt_pk_bf16_f32 v146, v146, v146
    v_lshlrev_b32 v146, 16, v146
    v_add_f32 v147, v147, v67
    v_cvt_pk_bf16_f32 v147, v147, v147
    v_lshlrev_b32 v147, 16, v147
    v_add_f32 v147, 1.0, v147
    v_cvt_pk_bf16_f32 v147, v147, v147
    v_lshlrev_b32 v147, 16, v147
    v_add_f32 v148, v148, v68
    v_cvt_pk_bf16_f32 v148, v148, v148
    v_lshlrev_b32 v148, 16, v148
    v_add_f32 v148, 1.0, v148
    v_cvt_pk_bf16_f32 v148, v148, v148
    v_lshlrev_b32 v148, 16, v148
    v_add_f32 v149, v149, v69
    v_cvt_pk_bf16_f32 v149, v149, v149
    v_lshlrev_b32 v149, 16, v149
    v_add_f32 v149, 1.0, v149
    v_cvt_pk_bf16_f32 v149, v149, v149
    v_lshlrev_b32 v149, 16, v149
    v_add_f32 v150, v150, v70
    v_cvt_pk_bf16_f32 v150, v150, v150
    v_lshlrev_b32 v150, 16, v150
    v_add_f32 v150, 1.0, v150
    v_cvt_pk_bf16_f32 v150, v150, v150
    v_lshlrev_b32 v150, 16, v150
    v_add_f32 v151, v151, v71
    v_cvt_pk_bf16_f32 v151, v151, v151
    v_lshlrev_b32 v151, 16, v151
    v_add_f32 v151, 1.0, v151
    v_cvt_pk_bf16_f32 v151, v151, v151
    v_lshlrev_b32 v151, 16, v151
    v_add_f32 v152, v152, v72
    v_cvt_pk_bf16_f32 v152, v152, v152
    v_lshlrev_b32 v152, 16, v152
    v_add_f32 v152, 1.0, v152
    v_cvt_pk_bf16_f32 v152, v152, v152
    v_lshlrev_b32 v152, 16, v152
    v_add_f32 v153, v153, v73
    v_cvt_pk_bf16_f32 v153, v153, v153
    v_lshlrev_b32 v153, 16, v153
    v_add_f32 v153, 1.0, v153
    v_cvt_pk_bf16_f32 v153, v153, v153
    v_lshlrev_b32 v153, 16, v153
    v_add_f32 v154, v154, v74
    v_cvt_pk_bf16_f32 v154, v154, v154
    v_lshlrev_b32 v154, 16, v154
    v_add_f32 v154, 1.0, v154
    v_cvt_pk_bf16_f32 v154, v154, v154
    v_lshlrev_b32 v154, 16, v154
    v_add_f32 v155, v155, v75
    v_cvt_pk_bf16_f32 v155, v155, v155
    v_lshlrev_b32 v155, 16, v155
    v_add_f32 v155, 1.0, v155
    v_cvt_pk_bf16_f32 v155, v155, v155
    v_lshlrev_b32 v155, 16, v155
    v_add_f32 v156, v156, v76
    v_cvt_pk_bf16_f32 v156, v156, v156
    v_lshlrev_b32 v156, 16, v156
    v_add_f32 v156, 1.0, v156
    v_cvt_pk_bf16_f32 v156, v156, v156
    v_lshlrev_b32 v156, 16, v156
    v_add_f32 v157, v157, v77
    v_cvt_pk_bf16_f32 v157, v157, v157
    v_lshlrev_b32 v157, 16, v157
    v_add_f32 v157, 1.0, v157
    v_cvt_pk_bf16_f32 v157, v157, v157
    v_lshlrev_b32 v157, 16, v157
    v_add_f32 v158, v158, v78
    v_cvt_pk_bf16_f32 v158, v158, v158
    v_lshlrev_b32 v158, 16, v158
    v_add_f32 v158, 1.0, v158
    v_cvt_pk_bf16_f32 v158, v158, v158
    v_lshlrev_b32 v158, 16, v158
    v_add_f32 v159, v159, v79
    v_cvt_pk_bf16_f32 v159, v159, v159
    v_lshlrev_b32 v159, 16, v159
    v_add_f32 v159, 1.0, v159
    v_cvt_pk_bf16_f32 v159, v159, v159
    v_lshlrev_b32 v159, 16, v159
    s_lshl_b32 s46, s44, 10
    s_add_u32 s45, s46, 8192
    buffer_load_dwordx4 v[18:21], v10, s[12:15], s45 offen sc1
    s_add_u32 s45, s46, 32768
    buffer_load_dwordx4 v[32:35], v10, s[12:15], s45 offen sc1
    s_add_u32 s45, s46, 12288
    buffer_load_dwordx4 v[22:25], v10, s[12:15], s45 offen sc1
    s_add_u32 s45, s46, 36864
    buffer_load_dwordx4 v[36:39], v10, s[12:15], s45 offen sc1
    s_add_u32 s45, s46, 16384
    buffer_load_dwordx4 v[108:111], v10, s[12:15], s45 offen sc1
    s_add_u32 s45, s46, 40960
    buffer_load_dwordx4 v[40:43], v10, s[12:15], s45 offen sc1
    s_waitcnt vmcnt(0)
    v_add_f32 v18, v18, v32
    v_cvt_pk_bf16_f32 v18, v18, v18
    v_lshlrev_b32 v18, 16, v18
    v_add_f32 v19, v19, v33
    v_cvt_pk_bf16_f32 v19, v19, v19
    v_lshlrev_b32 v19, 16, v19
    v_add_f32 v20, v20, v34
    v_cvt_pk_bf16_f32 v20, v20, v20
    v_lshlrev_b32 v20, 16, v20
    v_add_f32 v21, v21, v35
    v_cvt_pk_bf16_f32 v21, v21, v21
    v_lshlrev_b32 v21, 16, v21
    v_add_f32 v22, v22, v36
    v_cvt_pk_bf16_f32 v22, v22, v22
    v_lshlrev_b32 v22, 16, v22
    v_add_f32 v23, v23, v37
    v_cvt_pk_bf16_f32 v23, v23, v23
    v_lshlrev_b32 v23, 16, v23
    v_add_f32 v24, v24, v38
    v_cvt_pk_bf16_f32 v24, v24, v24
    v_lshlrev_b32 v24, 16, v24
    v_add_f32 v25, v25, v39
    v_cvt_pk_bf16_f32 v25, v25, v25
    v_lshlrev_b32 v25, 16, v25
    v_add_f32 v108, v108, v40
    v_cvt_pk_bf16_f32 v108, v108, v108
    v_lshlrev_b32 v108, 16, v108
    v_add_f32 v108, 1.0, v108
    v_cvt_pk_bf16_f32 v108, v108, v108
    v_lshlrev_b32 v108, 16, v108
    v_add_f32 v109, v109, v41
    v_cvt_pk_bf16_f32 v109, v109, v109
    v_lshlrev_b32 v109, 16, v109
    v_add_f32 v109, 1.0, v109
    v_cvt_pk_bf16_f32 v109, v109, v109
    v_lshlrev_b32 v109, 16, v109
    v_add_f32 v110, v110, v42
    v_cvt_pk_bf16_f32 v110, v110, v110
    v_lshlrev_b32 v110, 16, v110
    v_add_f32 v110, 1.0, v110
    v_cvt_pk_bf16_f32 v110, v110, v110
    v_lshlrev_b32 v110, 16, v110
    v_add_f32 v111, v111, v43
    v_cvt_pk_bf16_f32 v111, v111, v111
    v_lshlrev_b32 v111, 16, v111
    v_add_f32 v111, 1.0, v111
    v_cvt_pk_bf16_f32 v111, v111, v111
    v_lshlrev_b32 v111, 16, v111
    s_mov_b32 s52, 0xc00000
    s_lshl_b32 s56, s41, 13
    s_add_u32 s56, s56, 0x6000000
    s_lshl_b32 s45, s40, 7
    s_add_u32 s45, s45, 127488
    v_mov_b32 v29, s45
    s_mov_b32 s46, 536870912
    s_mov_b64 exec, 1
    s_mov_b32 s70, 0
L_wp_150:
    buffer_load_dword v31, v29, s[12:15], 0 offen sc1
    s_add_u32 s70, s70, 1
    s_cmp_ge_u32 s70, 0x200000
    s_cbranch_scc1 L_w_done_98
    s_waitcnt vmcnt(0)
    v_cmp_gt_u32 vcc, s46, v31
    s_nop 1
    s_cbranch_vccz L_wp_150_ok
    s_sleep 2
    s_branch L_wp_150
L_wp_150_ok:
    s_mov_b64 exec, -1
    v_readfirstlane_b32 s45, v31
    s_nop 3
    s_and_b32 s46, s45, 511
    s_mul_i32 s46, s46, s46
    s_bfe_u32 s45, s45, 0xf0009
    s_lshl_b32 s45, s45, 5
    s_mov_b32 s80, s12
    s_mov_b32 s81, s13
    s_mov_b32 s83, 0x00020000
    s_mov_b32 s84, s12
    s_mov_b32 s85, s13
    s_mov_b32 s87, 0x00020000
    s_cmp_eq_u32 s45, s46
    s_cselect_b32 s82, s14, 0
    s_cselect_b32 s86, 0, s14
L_b_loop_147:
    s_cmp_eq_u64 s[36:37], 0
    s_cbranch_scc1 L_w_done_98
    s_ff1_i32_b64 s50, s[36:37]
    s_bitset0_b64 s[36:37], s50
    s_lshr_b64 s[74:75], s[72:73], s50
    s_ff1_i32_b64 s51, s[74:75]
    s_add_u32 s51, s51, 1
    s_add_u32 s62, s50, s51
    s_cmp_lg_u32 s51, 1
    s_cbranch_scc1 L_b_skip2_149
    s_lshl_b32 s63, s50, 5
    s_add_u32 s63, s63, s41
    s_lshl_b32 s47, s63, 11
    s_lshl_b32 s45, s44, 9
    s_add_u32 s47, s47, s45
    v_lshlrev_b32 v17, 3, v1
    buffer_load_dwordx2 v[208:209], v17, s[28:31], s47 offen
    s_add_u32 s45, s64, 4096
    s_waitcnt vmcnt(0)
    s_cmp_lg_u32 s44, 0
    s_cbranch_scc1 L_pw_151
    s_mov_b32 exec_hi, 0
    s_mov_b32 s70, 0
L_wp_152:
    buffer_load_dword v31, v5, s[12:15], s45 offen sc1
    s_add_u32 s70, s70, 1
    s_cmp_ge_u32 s70, 0x200000
    s_cbranch_scc1 L_w_done_98
    s_waitcnt vmcnt(0)
    v_cmp_gt_u32 vcc, s62, v31
    s_nop 1
    s_cbranch_vccz L_wp_152_ok
    s_sleep 1
    s_branch L_wp_152
L_wp_152_ok:
    s_mov_b64 exec, -1
L_pw_151:
    s_barrier
    s_lshl_b32 s45, s63, 12
    s_lshl_b32 s46, s44, 10
    s_add_u32 s45, s45, s46
    s_add_u32 s45, s45, 0x8000000
    buffer_load_dwordx4 v[64:67], v10, s[12:15], s45 offen sc1
    s_add_u32 s45, s45, 0x800000
    buffer_load_dwordx4 v[68:71], v10, s[12:15], s45 offen sc1
    s_add_u32 s45, s45, 0x800000
    buffer_load_dwordx4 v[72:75], v10, s[12:15], s45 offen sc1
    s_add_u32 s45, s45, 0x800000
    buffer_load_dwordx4 v[76:79], v10, s[12:15], s45 offen sc1
    v_lshlrev_b32 v160, 16, v208
    v_and_b32 v161, 0xffff0000, v208
    v_lshlrev_b32 v162, 16, v209
    v_and_b32 v163, 0xffff0000, v209
    s_waitcnt vmcnt(0)
    v_pk_add_f32 v[64:65], v[64:65], v[68:69]
    v_pk_add_f32 v[72:73], v[72:73], v[76:77]
    v_pk_add_f32 v[66:67], v[66:67], v[70:71]
    v_pk_add_f32 v[74:75], v[74:75], v[78:79]
    v_pk_add_f32 v[64:65], v[64:65], v[72:73]
    v_pk_add_f32 v[66:67], v[66:67], v[74:75]
    v_cvt_pk_bf16_f32 v64, v64, v64
    v_lshlrev_b32 v64, 16, v64
    v_cvt_pk_bf16_f32 v65, v65, v65
    v_lshlrev_b32 v65, 16, v65
    v_cvt_pk_bf16_f32 v66, v66, v66
    v_lshlrev_b32 v66, 16, v66
    v_cvt_pk_bf16_f32 v67, v67, v67
    v_lshlrev_b32 v67, 16, v67
    v_mul_f32 v64, v64, v18
    v_cvt_pk_bf16_f32 v64, v64, v64
    v_lshlrev_b32 v64, 16, v64
    v_add_f32 v64, v64, v160
    v_mul_f32 v65, v65, v19
    v_cvt_pk_bf16_f32 v65, v65, v65
    v_lshlrev_b32 v65, 16, v65
    v_add_f32 v65, v65, v161
    v_mul_f32 v66, v66, v20
    v_cvt_pk_bf16_f32 v66, v66, v66
    v_lshlrev_b32 v66, 16, v66
    v_add_f32 v66, v66, v162
    v_mul_f32 v67, v67, v21
    v_cvt_pk_bf16_f32 v67, v67, v67
    v_lshlrev_b32 v67, 16, v67
    v_add_f32 v67, v67, v163
    v_cvt_pk_bf16_f32 v208, v64, v65
    v_cvt_pk_bf16_f32 v209, v66, v67
    s_add_u32 s47, s47, 0x800000
    buffer_store_dwordx2 v[208:209], v17, s[12:15], s47 offen sc1
    v_lshlrev_b32 v64, 16, v208
    v_and_b32 v65, 0xffff0000, v208
    v_lshlrev_b32 v66, 16, v209
    v_and_b32 v67, 0xffff0000, v209
    v_add_f32 v26, v64, v65
    v_add_f32 v27, v66, v67
    v_add_f32 v26, v26, v27
    s_nop 1
    v_add_f32_dpp v26, v26, v26 row_shr:1 row_mask:0xf bank_mask:0xf bound_ctrl:0
    s_nop 1
    v_add_f32_dpp v26, v26, v26 row_shr:2 row_mask:0xf bank_mask:0xf bound_ctrl:0
    s_nop 1
    v_add_f32_dpp v26, v26, v26 row_shr:4 row_mask:0xf bank_mask:0xf bound_ctrl:0
    s_nop 1
    v_add_f32_dpp v26, v26, v26 row_shr:8 row_mask:0xf bank_mask:0xf bound_ctrl:0
    s_nop 1
    v_add_f32_dpp v26, v26, v26 row_bcast:15 row_mask:0xa bank_mask:0xf
    s_nop 1
    v_add_f32_dpp v26, v26, v26 row_bcast:31 row_mask:0xc bank_mask:0xf
    s_nop 1
    v_readlane_b32 s66, v26, 63
    s_nop 1
    v_mov_b32 v28, s66
    v_mul_f32 v28, 0x3b800000, v28
    v_mov_b32 v26, 0
    v_sub_f32 v27, v64, v28
    v_fmac_f32 v26, v27, v27
    v_sub_f32 v27, v65, v28
    v_fmac_f32 v26, v27, v27
    v_sub_f32 v27, v66, v28
    v_fmac_f32 v26, v27, v27
    v_sub_f32 v27, v67, v28
    v_fmac_f32 v26, v27, v27
    s_nop 1
    v_add_f32_dpp v26, v26, v26 row_shr:1 row_mask:0xf bank_mask:0xf bound_ctrl:0
    s_nop 1
    v_add_f32_dpp v26, v26, v26 row_shr:2 row_mask:0xf bank_mask:0xf bound_ctrl:0
    s_nop 1
    v_add_f32_dpp v26, v26, v26 row_shr:4 row_mask:0xf bank_mask:0xf bound_ctrl:0
    s_nop 1
    v_add_f32_dpp v26, v26, v26 row_shr:8 row_mask:0xf bank_mask:0xf bound_ctrl:0
    s_nop 1
    v_add_f32_dpp v26, v26, v26 row_bcast:15 row_mask:0xa bank_mask:0xf
    s_nop 1
    v_add_f32_dpp v26, v26, v26 row_bcast:31 row_mask:0xc bank_mask:0xf
    s_nop 1
    v_readlane_b32 s66, v26, 63
    s_lshl_b32 s45, s44, 3
    s_add_u32 s45, s45, 131072
    v_mov_b32 v29, s66
    v_mov_b32 v27, s45
    ds_write_b64 v27, v[28:29]
    v_mov_b32 v27, 131072
    s_waitcnt lgkmcnt(0)
    s_barrier
    ds_read_b128 v[68:71], v27
    ds_read_b128 v[72:75], v27 offset:16
    s_waitcnt lgkmcnt(0)
    v_add_f32 v27, v68, v70
    v_add_f32 v26, v72, v74
    v_add_f32 v27, v27, v26
    v_mul_f32 v27, 0x3e800000, v27
    v_add_f32 v26, v69, v71
    v_add_f32 v28, v73, v75
    v_add_f32 v26, v26, v28
    v_mov_b32 v28, 0
    v_sub_f32 v68, v68, v27
    v_fmac_f32 v28, v68, v68
    v_sub_f32 v70, v70, v27
    v_fmac_f32 v28, v70, v70
    v_sub_f32 v72, v72, v27
    v_fmac_f32 v28, v72, v72
    v_sub_f32 v74, v74, v27
    v_fmac_f32 v28, v74, v74
    v_mul_f32 v28, 0x43800000, v28
    v_add_f32 v26, v26, v28
    v_mul_f32 v26, 0x3a800000, v26
    v_cvt_pk_bf16_f32 v26, v26, v26
    v_lshlrev_b32 v26, 16, v26
    v_cvt_pk_bf16_f32 v27, v27, v27
    v_lshlrev_b32 v27, 16, v27
    v_add_f32 v26, 0x3727c5ac, v26
    v_cvt_pk_bf16_f32 v26, v26, v26
    v_lshlrev_b32 v26, 16, v26
    v_sqrt_f32 v26, v26
    s_nop 0
    v_cvt_pk_bf16_f32 v26, v26, v26
    v_lshlrev_b32 v26, 16, v26
    v_rcp_f32 v26, v26
    s_nop 0
    v_sub_f32 v64, v64, v27
    v_cvt_pk_bf16_f32 v64, v64, v64
    v_lshlrev_b32 v64, 16, v64
    v_mul_f32 v64, v64, v26
    v_cvt_pk_bf16_f32 v64, v64, v64
    v_lshlrev_b32 v64, 16, v64
    v_mul_f32 v64, v64, v108
    v_cvt_pk_bf16_f32 v64, v64, v64
    v_lshlrev_b32 v64, 16, v64
    v_add_f32 v64, v64, v22
    v_sub_f32 v65, v65, v27
    v_cvt_pk_bf16_f32 v65, v65, v65
    v_lshlrev_b32 v65, 16, v65
    v_mul_f32 v65, v65, v26
    v_cvt_pk_bf16_f32 v65, v65, v65
    v_lshlrev_b32 v65, 16, v65
    v_mul_f32 v65, v65, v109
    v_cvt_pk_bf16_f32 v65, v65, v65
    v_lshlrev_b32 v65, 16, v65
    v_add_f32 v65, v65, v23
    v_sub_f32 v66, v66, v27
    v_cvt_pk_bf16_f32 v66, v66, v66
    v_lshlrev_b32 v66, 16, v66
    v_mul_f32 v66, v66, v26
    v_cvt_pk_bf16_f32 v66, v66, v66
    v_lshlrev_b32 v66, 16, v66
    v_mul_f32 v66, v66, v110
    v_cvt_pk_bf16_f32 v66, v66, v66
    v_lshlrev_b32 v66, 16, v66
    v_add_f32 v66, v66, v24
    v_sub_f32 v67, v67, v27
    v_cvt_pk_bf16_f32 v67, v67, v67
    v_lshlrev_b32 v67, 16, v67
    v_mul_f32 v67, v67, v26
    v_cvt_pk_bf16_f32 v67, v67, v67
    v_lshlrev_b32 v67, 16, v67
    v_mul_f32 v67, v67, v111
    v_cvt_pk_bf16_f32 v67, v67, v67
    v_lshlrev_b32 v67, 16, v67
    v_add_f32 v67, v67, v25
    v_cvt_pk_bf16_f32 v64, v64, v65
    v_cvt_pk_bf16_f32 v65, v66, v67
    v_lshrrev_b32 v26, 5, v1
    v_lshlrev_b32 v26, 13, v26
    v_and_b32 v27, 255, v17
    v_add_u32 v26, v26, v27
    s_lshl_b32 s45, s50, 16
    s_lshl_b32 s46, s41, 8
    s_add_u32 s45, s45, s46
    s_lshl_b32 s46, s44, 14
    s_add_u32 s45, s45, s46
    s_add_u32 s45, s45, 0xc00000
    buffer_store_dwordx2 v[64:65], v26, s[12:15], s45 offen sc1
    s_branch L_b_skip_148
L_b_skip2_149:
    s_add_u32 s63, s50, s44
    s_lshl_b32 s63, s63, 5
    s_add_u32 s63, s63, s41
    s_lshl_b32 s47, s63, 11
    buffer_load_dwordx4 v[208:211], v10, s[28:31], s47 offen
    buffer_load_dwordx4 v[212:215], v10, s[28:31], s47 offen offset:1024
    s_add_u32 s45, s64, 4096
    s_cmp_lg_u32 s44, 0
    s_cbranch_scc1 L_pw_153
    s_mov_b32 exec_hi, 0
    s_mov_b32 s70, 0
L_wp_154:
    buffer_load_dword v31, v5, s[12:15], s45 offen sc1
    s_add_u32 s70, s70, 1
    s_cmp_ge_u32 s70, 0x200000
    s_cbranch_scc1 L_w_done_98
    s_waitcnt vmcnt(0)
    v_cmp_gt_u32 vcc, s62, v31
    s_nop 1
    s_cbranch_vccz L_wp_154_ok
    s_sleep 2
    s_branch L_wp_154
L_wp_154_ok:
    s_mov_b64 exec, -1
L_pw_153:
    s_barrier
    s_cmp_ge_u32 s44, s51
    s_cbranch_scc1 L_b_skip_148
    s_lshl_b32 s45, s63, 12
    s_add_u32 s45, s45, 0x8000000
    v_lshlrev_b32 v29, 5, v1
    buffer_load_dwordx4 v[64:67], v29, s[12:15], s45 offen offset:0 sc1
    buffer_load_dwordx4 v[68:71], v29, s[12:15], s45 offen offset:16 sc1
    buffer_load_dwordx4 v[72:75], v29, s[12:15], s45 offen offset:2048 sc1
    buffer_load_dwordx4 v[76:79], v29, s[12:15], s45 offen offset:2064 sc1
    s_add_u32 s45, s45, 0x800000
    buffer_load_dwordx4 v[160:163], v29, s[12:15], s45 offen offset:0 sc1
    buffer_load_dwordx4 v[164:167], v29, s[12:15], s45 offen offset:16 sc1
    buffer_load_dwordx4 v[168:171], v29, s[12:15], s45 offen offset:2048 sc1
    buffer_load_dwordx4 v[172:175], v29, s[12:15], s45 offen offset:2064 sc1
    s_add_u32 s45, s45, 0x800000
    buffer_load_dwordx4 v[176:179], v29, s[12:15], s45 offen offset:0 sc1
    buffer_load_dwordx4 v[180:183], v29, s[12:15], s45 offen offset:16 sc1
    buffer_load_dwordx4 v[184:187], v29, s[12:15], s45 offen offset:2048 sc1
    buffer_load_dwordx4 v[188:191], v29, s[12:15], s45 offen offset:2064 sc1
    s_add_u32 s45, s45, 0x800000
    buffer_load_dwordx4 v[192:195], v29, s[12:15], s45 offen offset:0 sc1
    buffer_load_dwordx4 v[196:199], v29, s[12:15], s45 offen offset:16 sc1
    buffer_load_dwordx4 v[200:203], v29, s[12:15], s45 offen offset:2048 sc1
    buffer_load_dwordx4 v[204:207], v29, s[12:15], s45 offen offset:2064 sc1
    s_waitcnt vmcnt(0)
    v_pk_add_f32 v[64:65], v[64:65], v[160:161]
    v_pk_add_f32 v[176:177], v[176:177], v[192:193]
    v_pk_add_f32 v[66:67], v[66:67], v[162:163]
    v_pk_add_f32 v[178:179], v[178:179], v[194:195]
    v_pk_add_f32 v[68:69], v[68:69], v[164:165]
    v_pk_add_f32 v[180:181], v[180:181], v[196:197]
    v_pk_add_f32 v[70:71], v[70:71], v[166:167]
    v_pk_add_f32 v[182:183], v[182:183], v[198:199]
    v_pk_add_f32 v[72:73], v[72:73], v[168:169]
    v_pk_add_f32 v[184:185], v[184:185], v[200:201]
    v_pk_add_f32 v[74:75], v[74:75], v[170:171]
    v_pk_add_f32 v[186:187], v[186:187], v[202:203]
    v_pk_add_f32 v[76:77], v[76:77], v[172:173]
    v_pk_add_f32 v[188:189], v[188:189], v[204:205]
    v_pk_add_f32 v[78:79], v[78:79], v[174:175]
    v_pk_add_f32 v[190:191], v[190:191], v[206:207]
    v_pk_add_f32 v[64:65], v[64:65], v[176:177]
    v_pk_add_f32 v[66:67], v[66:67], v[178:179]
    v_pk_add_f32 v[68:69], v[68:69], v[180:181]
    v_pk_add_f32 v[70:71], v[70:71], v[182:183]
    v_pk_add_f32 v[72:73], v[72:73], v[184:185]
    v_pk_add_f32 v[74:75], v[74:75], v[186:187]
    v_pk_add_f32 v[76:77], v[76:77], v[188:189]
    v_pk_add_f32 v[78:79], v[78:79], v[190:191]
    v_cvt_pk_bf16_f32 v64, v64, v64
    v_lshlrev_b32 v64, 16, v64
    v_cvt_pk_bf16_f32 v65, v65, v65
    v_lshlrev_b32 v65, 16, v65
    v_cvt_pk_bf16_f32 v66, v66, v66
    v_lshlrev_b32 v66, 16, v66
    v_cvt_pk_bf16_f32 v67, v67, v67
    v_lshlrev_b32 v67, 16, v67
    v_cvt_pk_bf16_f32 v68, v68, v68
    v_lshlrev_b32 v68, 16, v68
    v_cvt_pk_bf16_f32 v69, v69, v69
    v_lshlrev_b32 v69, 16, v69
    v_cvt_pk_bf16_f32 v70, v70, v70
    v_lshlrev_b32 v70, 16, v70
    v_cvt_pk_bf16_f32 v71, v71, v71
    v_lshlrev_b32 v71, 16, v71
    v_cvt_pk_bf16_f32 v72, v72, v72
    v_lshlrev_b32 v72, 16, v72
    v_cvt_pk_bf16_f32 v73, v73, v73
    v_lshlrev_b32 v73, 16, v73
    v_cvt_pk_bf16_f32 v74, v74, v74
    v_lshlrev_b32 v74, 16, v74
    v_cvt_pk_bf16_f32 v75, v75, v75
    v_lshlrev_b32 v75, 16, v75
    v_cvt_pk_bf16_f32 v76, v76, v76
    v_lshlrev_b32 v76, 16, v76
    v_cvt_pk_bf16_f32 v77, v77, v77
    v_lshlrev_b32 v77, 16, v77
    v_cvt_pk_bf16_f32 v78, v78, v78
    v_lshlrev_b32 v78, 16, v78
    v_cvt_pk_bf16_f32 v79, v79, v79
    v_lshlrev_b32 v79, 16, v79
    v_lshlrev_b32 v160, 16, v208
    v_and_b32 v161, 0xffff0000, v208
    v_lshlrev_b32 v162, 16, v209
    v_and_b32 v163, 0xffff0000, v209
    v_lshlrev_b32 v164, 16, v210
    v_and_b32 v165, 0xffff0000, v210
    v_lshlrev_b32 v166, 16, v211
    v_and_b32 v167, 0xffff0000, v211
    v_lshlrev_b32 v168, 16, v212
    v_and_b32 v169, 0xffff0000, v212
    v_lshlrev_b32 v170, 16, v213
    v_and_b32 v171, 0xffff0000, v213
    v_lshlrev_b32 v172, 16, v214
    v_and_b32 v173, 0xffff0000, v214
    v_lshlrev_b32 v174, 16, v215
    v_and_b32 v175, 0xffff0000, v215
    v_mul_f32 v64, v64, v112
    v_cvt_pk_bf16_f32 v64, v64, v64
    v_lshlrev_b32 v64, 16, v64
    v_add_f32 v64, v64, v160
    v_mul_f32 v65, v65, v113
    v_cvt_pk_bf16_f32 v65, v65, v65
    v_lshlrev_b32 v65, 16, v65
    v_add_f32 v65, v65, v161
    v_mul_f32 v66, v66, v114
    v_cvt_pk_bf16_f32 v66, v66, v66
    v_lshlrev_b32 v66, 16, v66
    v_add_f32 v66, v66, v162
    v_mul_f32 v67, v67, v115
    v_cvt_pk_bf16_f32 v67, v67, v67
    v_lshlrev_b32 v67, 16, v67
    v_add_f32 v67, v67, v163
    v_mul_f32 v68, v68, v116
    v_cvt_pk_bf16_f32 v68, v68, v68
    v_lshlrev_b32 v68, 16, v68
    v_add_f32 v68, v68, v164
    v_mul_f32 v69, v69, v117
    v_cvt_pk_bf16_f32 v69, v69, v69
    v_lshlrev_b32 v69, 16, v69
    v_add_f32 v69, v69, v165
    v_mul_f32 v70, v70, v118
    v_cvt_pk_bf16_f32 v70, v70, v70
    v_lshlrev_b32 v70, 16, v70
    v_add_f32 v70, v70, v166
    v_mul_f32 v71, v71, v119
    v_cvt_pk_bf16_f32 v71, v71, v71
    v_lshlrev_b32 v71, 16, v71
    v_add_f32 v71, v71, v167
    v_mul_f32 v72, v72, v120
    v_cvt_pk_bf16_f32 v72, v72, v72
    v_lshlrev_b32 v72, 16, v72
    v_add_f32 v72, v72, v168
    v_mul_f32 v73, v73, v121
    v_cvt_pk_bf16_f32 v73, v73, v73
    v_lshlrev_b32 v73, 16, v73
    v_add_f32 v73, v73, v169
    v_mul_f32 v74, v74, v122
    v_cvt_pk_bf16_f32 v74, v74, v74
    v_lshlrev_b32 v74, 16, v74
    v_add_f32 v74, v74, v170
    v_mul_f32 v75, v75, v123
    v_cvt_pk_bf16_f32 v75, v75, v75
    v_lshlrev_b32 v75, 16, v75
    v_add_f32 v75, v75, v171
    v_mul_f32 v76, v76, v124
    v_cvt_pk_bf16_f32 v76, v76, v76
    v_lshlrev_b32 v76, 16, v76
    v_add_f32 v76, v76, v172
    v_mul_f32 v77, v77, v125
    v_cvt_pk_bf16_f32 v77, v77, v77
    v_lshlrev_b32 v77, 16, v77
    v_add_f32 v77, v77, v173
    v_mul_f32 v78, v78, v126
    v_cvt_pk_bf16_f32 v78, v78, v78
    v_lshlrev_b32 v78, 16, v78
    v_add_f32 v78, v78, v174
    v_mul_f32 v79, v79, v127
    v_cvt_pk_bf16_f32 v79, v79, v79
    v_lshlrev_b32 v79, 16, v79
    v_add_f32 v79, v79, v175
    v_cvt_pk_bf16_f32 v208, v64, v65
    v_cvt_pk_bf16_f32 v209, v66, v67
    v_cvt_pk_bf16_f32 v210, v68, v69
    v_cvt_pk_bf16_f32 v211, v70, v71
    v_cvt_pk_bf16_f32 v212, v72, v73
    v_cvt_pk_bf16_f32 v213, v74, v75
    v_cvt_pk_bf16_f32 v214, v76, v77
    v_cvt_pk_bf16_f32 v215, v78, v79
    s_add_u32 s47, s47, 0x800000
    buffer_store_dwordx4 v[208:211], v10, s[12:15], s47 offen sc1
    buffer_store_dwordx4 v[212:215], v10, s[12:15], s47 offen offset:1024 sc1
    v_lshlrev_b32 v64, 16, v208
    v_and_b32 v65, 0xffff0000, v208
    v_lshlrev_b32 v66, 16, v209
    v_and_b32 v67, 0xffff0000, v209
    v_lshlrev_b32 v68, 16, v210
    v_and_b32 v69, 0xffff0000, v210
    v_lshlrev_b32 v70, 16, v211
    v_and_b32 v71, 0xffff0000, v211
    v_lshlrev_b32 v72, 16, v212
    v_and_b32 v73, 0xffff0000, v212
    v_lshlrev_b32 v74, 16, v213
    v_and_b32 v75, 0xffff0000, v213
    v_lshlrev_b32 v76, 16, v214
    v_and_b32 v77, 0xffff0000, v214
    v_lshlrev_b32 v78, 16, v215
    v_and_b32 v79, 0xffff0000, v215
    v_add_f32 v26, v64, v65
    v_add_f32 v26, v26, v66
    v_add_f32 v26, v26, v67
    v_add_f32 v26, v26, v68
    v_add_f32 v26, v26, v69
    v_add_f32 v26, v26, v70
    v_add_f32 v26, v26, v71
    v_add_f32 v26, v26, v72
    v_add_f32 v26, v26, v73
    v_add_f32 v26, v26, v74
    v_add_f32 v26, v26, v75
    v_add_f32 v26, v26, v76
    v_add_f32 v26, v26, v77
    v_add_f32 v26, v26, v78
    v_add_f32 v26, v26, v79
    s_nop 1
    v_add_f32_dpp v26, v26, v26 row_shr:1 row_mask:0xf bank_mask:0xf bound_ctrl:0
    s_nop 1
    v_add_f32_dpp v26, v26, v26 row_shr:2 row_mask:0xf bank_mask:0xf bound_ctrl:0
    s_nop 1
    v_add_f32_dpp v26, v26, v26 row_shr:4 row_mask:0xf bank_mask:0xf bound_ctrl:0
    s_nop 1
    v_add_f32_dpp v26, v26, v26 row_shr:8 row_mask:0xf bank_mask:0xf bound_ctrl:0
    s_nop 1
    v_add_f32_dpp v26, v26, v26 row_bcast:15 row_mask:0xa bank_mask:0xf
    s_nop 1
    v_add_f32_dpp v26, v26, v26 row_bcast:31 row_mask:0xc bank_mask:0xf
    s_nop 1
    v_readlane_b32 s66, v26, 63
    s_nop 1
    v_mov_b32 v27, s66
    v_mul_f32 v27, 0x3a800000, v27
    v_mov_b32 v26, 0
    v_sub_f32 v28, v64, v27
    v_fmac_f32 v26, v28, v28
    v_sub_f32 v28, v65, v27
    v_fmac_f32 v26, v28, v28
    v_sub_f32 v28, v66, v27
    v_fmac_f32 v26, v28, v28
    v_sub_f32 v28, v67, v27
    v_fmac_f32 v26, v28, v28
    v_sub_f32 v28, v68, v27
    v_fmac_f32 v26, v28, v28
    v_sub_f32 v28, v69, v27
    v_fmac_f32 v26, v28, v28
    v_sub_f32 v28, v70, v27
    v_fmac_f32 v26, v28, v28
    v_sub_f32 v28, v71, v27
    v_fmac_f32 v26, v28, v28
    v_sub_f32 v28, v72, v27
    v_fmac_f32 v26, v28, v28
    v_sub_f32 v28, v73, v27
    v_fmac_f32 v26, v28, v28
    v_sub_f32 v28, v74, v27
    v_fmac_f32 v26, v28, v28
    v_sub_f32 v28, v75, v27
    v_fmac_f32 v26, v28, v28
    v_sub_f32 v28, v76, v27
    v_fmac_f32 v26, v28, v28
    v_sub_f32 v28, v77, v27
    v_fmac_f32 v26, v28, v28
    v_sub_f32 v28, v78, v27
    v_fmac_f32 v26, v28, v28
    v_sub_f32 v28, v79, v27
    v_fmac_f32 v26, v28, v28
    s_nop 1
    v_add_f32_dpp v26, v26, v26 row_shr:1 row_mask:0xf bank_mask:0xf bound_ctrl:0
    s_nop 1
    v_add_f32_dpp v26, v26, v26 row_shr:2 row_mask:0xf bank_mask:0xf bound_ctrl:0
    s_nop 1
    v_add_f32_dpp v26, v26, v26 row_shr:4 row_mask:0xf bank_mask:0xf bound_ctrl:0
    s_nop 1
    v_add_f32_dpp v26, v26, v26 row_shr:8 row_mask:0xf bank_mask:0xf bound_ctrl:0
    s_nop 1
    v_add_f32_dpp v26, v26, v26 row_bcast:15 row_mask:0xa bank_mask:0xf
    s_nop 1
    v_add_f32_dpp v26, v26, v26 row_bcast:31 row_mask:0xc bank_mask:0xf
    s_nop 1
    v_readlane_b32 s66, v26, 63
    s_nop 1
    v_mov_b32 v26, s66
    v_mul_f32 v26, 0x3a800000, v26
    v_cvt_pk_bf16_f32 v26, v26, v26
    v_lshlrev_b32 v26, 16, v26
    v_cvt_pk_bf16_f32 v27, v27, v27
    v_lshlrev_b32 v27, 16, v27
    v_add_f32 v26, 0x3727c5ac, v26
    v_cvt_pk_bf16_f32 v26, v26, v26
    v_lshlrev_b32 v26, 16, v26
    v_sqrt_f32 v26, v26
    s_nop 0
    v_cvt_pk_bf16_f32 v26, v26, v26
    v_lshlrev_b32 v26, 16, v26
    v_rcp_f32 v26, v26
    s_nop 0
    v_sub_f32 v64, v64, v27
    v_cvt_pk_bf16_f32 v64, v64, v64
    v_lshlrev_b32 v64, 16, v64
    v_mul_f32 v64, v64, v26
    v_cvt_pk_bf16_f32 v64, v64, v64
    v_lshlrev_b32 v64, 16, v64
    v_sub_f32 v65, v65, v27
    v_cvt_pk_bf16_f32 v65, v65, v65
    v_lshlrev_b32 v65, 16, v65
    v_mul_f32 v65, v65, v26
    v_cvt_pk_bf16_f32 v65, v65, v65
    v_lshlrev_b32 v65, 16, v65
    v_sub_f32 v66, v66, v27
    v_cvt_pk_bf16_f32 v66, v66, v66
    v_lshlrev_b32 v66, 16, v66
    v_mul_f32 v66, v66, v26
    v_cvt_pk_bf16_f32 v66, v66, v66
    v_lshlrev_b32 v66, 16, v66
    v_sub_f32 v67, v67, v27
    v_cvt_pk_bf16_f32 v67, v67, v67
    v_lshlrev_b32 v67, 16, v67
    v_mul_f32 v67, v67, v26
    v_cvt_pk_bf16_f32 v67, v67, v67
    v_lshlrev_b32 v67, 16, v67
    v_sub_f32 v68, v68, v27
    v_cvt_pk_bf16_f32 v68, v68, v68
    v_lshlrev_b32 v68, 16, v68
    v_mul_f32 v68, v68, v26
    v_cvt_pk_bf16_f32 v68, v68, v68
    v_lshlrev_b32 v68, 16, v68
    v_sub_f32 v69, v69, v27
    v_cvt_pk_bf16_f32 v69, v69, v69
    v_lshlrev_b32 v69, 16, v69
    v_mul_f32 v69, v69, v26
    v_cvt_pk_bf16_f32 v69, v69, v69
    v_lshlrev_b32 v69, 16, v69
    v_sub_f32 v70, v70, v27
    v_cvt_pk_bf16_f32 v70, v70, v70
    v_lshlrev_b32 v70, 16, v70
    v_mul_f32 v70, v70, v26
    v_cvt_pk_bf16_f32 v70, v70, v70
    v_lshlrev_b32 v70, 16, v70
    v_sub_f32 v71, v71, v27
    v_cvt_pk_bf16_f32 v71, v71, v71
    v_lshlrev_b32 v71, 16, v71
    v_mul_f32 v71, v71, v26
    v_cvt_pk_bf16_f32 v71, v71, v71
    v_lshlrev_b32 v71, 16, v71
    v_sub_f32 v72, v72, v27
    v_cvt_pk_bf16_f32 v72, v72, v72
    v_lshlrev_b32 v72, 16, v72
    v_mul_f32 v72, v72, v26
    v_cvt_pk_bf16_f32 v72, v72, v72
    v_lshlrev_b32 v72, 16, v72
    v_sub_f32 v73, v73, v27
    v_cvt_pk_bf16_f32 v73, v73, v73
    v_lshlrev_b32 v73, 16, v73
    v_mul_f32 v73, v73, v26
    v_cvt_pk_bf16_f32 v73, v73, v73
    v_lshlrev_b32 v73, 16, v73
    v_sub_f32 v74, v74, v27
    v_cvt_pk_bf16_f32 v74, v74, v74
    v_lshlrev_b32 v74, 16, v74
    v_mul_f32 v74, v74, v26
    v_cvt_pk_bf16_f32 v74, v74, v74
    v_lshlrev_b32 v74, 16, v74
    v_sub_f32 v75, v75, v27
    v_cvt_pk_bf16_f32 v75, v75, v75
    v_lshlrev_b32 v75, 16, v75
    v_mul_f32 v75, v75, v26
    v_cvt_pk_bf16_f32 v75, v75, v75
    v_lshlrev_b32 v75, 16, v75
    v_sub_f32 v76, v76, v27
    v_cvt_pk_bf16_f32 v76, v76, v76
    v_lshlrev_b32 v76, 16, v76
    v_mul_f32 v76, v76, v26
    v_cvt_pk_bf16_f32 v76, v76, v76
    v_lshlrev_b32 v76, 16, v76
    v_sub_f32 v77, v77, v27
    v_cvt_pk_bf16_f32 v77, v77, v77
    v_lshlrev_b32 v77, 16, v77
    v_mul_f32 v77, v77, v26
    v_cvt_pk_bf16_f32 v77, v77, v77
    v_lshlrev_b32 v77, 16, v77
    v_sub_f32 v78, v78, v27
    v_cvt_pk_bf16_f32 v78, v78, v78
    v_lshlrev_b32 v78, 16, v78
    v_mul_f32 v78, v78, v26
    v_cvt_pk_bf16_f32 v78, v78, v78
    v_lshlrev_b32 v78, 16, v78
    v_sub_f32 v79, v79, v27
    v_cvt_pk_bf16_f32 v79, v79, v79
    v_lshlrev_b32 v79, 16, v79
    v_mul_f32 v79, v79, v26
    v_cvt_pk_bf16_f32 v79, v79, v79
    v_lshlrev_b32 v79, 16, v79
    v_mul_f32 v64, v64, v144
    v_cvt_pk_bf16_f32 v64, v64, v64
    v_lshlrev_b32 v64, 16, v64
    v_add_f32 v64, v64, v128
    v_mul_f32 v65, v65, v145
    v_cvt_pk_bf16_f32 v65, v65, v65
    v_lshlrev_b32 v65, 16, v65
    v_add_f32 v65, v65, v129
    v_mul_f32 v66, v66, v146
    v_cvt_pk_bf16_f32 v66, v66, v66
    v_lshlrev_b32 v66, 16, v66
    v_add_f32 v66, v66, v130
    v_mul_f32 v67, v67, v147
    v_cvt_pk_bf16_f32 v67, v67, v67
    v_lshlrev_b32 v67, 16, v67
    v_add_f32 v67, v67, v131
    v_mul_f32 v68, v68, v148
    v_cvt_pk_bf16_f32 v68, v68, v68
    v_lshlrev_b32 v68, 16, v68
    v_add_f32 v68, v68, v132
    v_mul_f32 v69, v69, v149
    v_cvt_pk_bf16_f32 v69, v69, v69
    v_lshlrev_b32 v69, 16, v69
    v_add_f32 v69, v69, v133
    v_mul_f32 v70, v70, v150
    v_cvt_pk_bf16_f32 v70, v70, v70
    v_lshlrev_b32 v70, 16, v70
    v_add_f32 v70, v70, v134
    v_mul_f32 v71, v71, v151
    v_cvt_pk_bf16_f32 v71, v71, v71
    v_lshlrev_b32 v71, 16, v71
    v_add_f32 v71, v71, v135
    v_mul_f32 v72, v72, v152
    v_cvt_pk_bf16_f32 v72, v72, v72
    v_lshlrev_b32 v72, 16, v72
    v_add_f32 v72, v72, v136
    v_mul_f32 v73, v73, v153
    v_cvt_pk_bf16_f32 v73, v73, v73
    v_lshlrev_b32 v73, 16, v73
    v_add_f32 v73, v73, v137
    v_mul_f32 v74, v74, v154
    v_cvt_pk_bf16_f32 v74, v74, v74
    v_lshlrev_b32 v74, 16, v74
    v_add_f32 v74, v74, v138
    v_mul_f32 v75, v75, v155
    v_cvt_pk_bf16_f32 v75, v75, v75
    v_lshlrev_b32 v75, 16, v75
    v_add_f32 v75, v75, v139
    v_mul_f32 v76, v76, v156
    v_cvt_pk_bf16_f32 v76, v76, v76
    v_lshlrev_b32 v76, 16, v76
    v_add_f32 v76, v76, v140
    v_mul_f32 v77, v77, v157
    v_cvt_pk_bf16_f32 v77, v77, v77
    v_lshlrev_b32 v77, 16, v77
    v_add_f32 v77, v77, v141
    v_mul_f32 v78, v78, v158
    v_cvt_pk_bf16_f32 v78, v78, v78
    v_lshlrev_b32 v78, 16, v78
    v_add_f32 v78, v78, v142
    v_mul_f32 v79, v79, v159
    v_cvt_pk_bf16_f32 v79, v79, v79
    v_lshlrev_b32 v79, 16, v79
    v_add_f32 v79, v79, v143
    v_cvt_pk_bf16_f32 v80, v64, v65
    v_cvt_pk_bf16_f32 v81, v66, v67
    v_cvt_pk_bf16_f32 v82, v68, v69
    v_cvt_pk_bf16_f32 v83, v70, v71
    v_cvt_pk_bf16_f32 v84, v72, v73
    v_cvt_pk_bf16_f32 v85, v74, v75
    v_cvt_pk_bf16_f32 v86, v76, v77
    v_cvt_pk_bf16_f32 v87, v78, v79
    s_lshr_b32 s45, s63, 5
    s_lshl_b32 s45, s45, 16
    s_and_b32 s46, s63, 31
    s_lshl_b32 s46, s46, 8
    s_add_u32 s45, s45, s46
    s_add_u32 s45, s45, 0xc00000
    s_add_u32 s46, s45, 32768
    buffer_store_dwordx4 v[80:83], v2, s[12:15], s45 offen sc1
    buffer_store_dwordx4 v[84:87], v2, s[12:15], s46 offen sc1
L_b_skip_148:
    s_waitcnt vmcnt(0)
    s_barrier
    s_cmp_lg_u32 s44, 0
    s_cbranch_scc1 L_pub_155
    v_mov_b32 v30, s62
    v_mov_b32 v31, 0
    s_mov_b64 exec, 1
    buffer_store_dword v30, v31, s[80:83], s65 offen
    buffer_store_dword v30, v31, s[84:87], s65 offen sc1
    s_mov_b64 exec, -1
L_pub_155:
    s_cmp_ge_u32 s41, 28
    s_cbranch_scc1 L_b_loop_147
    s_add_u32 s45, s64, 8192
    s_cmp_lg_u32 s44, 0
    s_cbranch_scc1 L_pw_156
    s_mov_b32 exec_hi, 0
    s_mov_b32 s70, 0
L_wp_157:
    buffer_load_dword v31, v5, s[12:15], s45 offen sc1
    s_add_u32 s70, s70, 1
    s_cmp_ge_u32 s70, 0x200000
    s_cbranch_scc1 L_w_done_98
    s_waitcnt vmcnt(0)
    v_cmp_gt_u32 vcc, s62, v31
    s_nop 1
    s_cbranch_vccz L_wp_157_ok
    s_sleep 1
    s_branch L_wp_157
L_wp_157_ok:
    s_mov_b64 exec, -1
L_pw_156:
    s_barrier
    s_mul_i32 s53, s50, 65536
    s_add_u32 s53, s53, s52
    s_lshl_b32 s54, s44, 13
    s_add_u32 s53, s53, s54
    s_mul_i32 s57, s50, 229376
    s_add_u32 s57, s57, s56
    s_lshl_b32 s45, s44, 11
    s_add_u32 s57, s57, s45
    s_add_u32 s55, s54, 65536
    s_mov_b32 s58, 0
    v_mov_b32 v13, v3
    v_add_u32 v14, 65536, v13
    v_xor_b32 v15, 64, v13
    v_xor_b32 v16, 64, v14
    s_mov_b32 s76, 0x20000000
    s_add_u32 s48, s53, 0
    s_add_u32 s49, s48, 4096
    s_add_u32 m0, s54, 0
    s_nop 0
    buffer_load_dwordx4 v6, s[12:15], s48 offen offset:0 sc1 lds
    s_add_u32 m0, s54, 1024
    s_nop 0
    buffer_load_dwordx4 v9, s[12:15], s48 offen offset:0 sc1 lds
    s_add_u32 m0, s54, 2048
    s_nop 0
    buffer_load_dwordx4 v6, s[12:15], s49 offen offset:0 sc1 lds
    s_add_u32 m0, s54, 3072
    s_nop 0
    buffer_load_dwordx4 v9, s[12:15], s49 offen offset:0 sc1 lds
    s_add_u32 m0, s54, 3968
    s_nop 0
    buffer_load_dwordx4 v6, s[12:15], s48 offen offset:128 sc1 lds
    s_add_u32 m0, s54, 4992
    s_nop 0
    buffer_load_dwordx4 v9, s[12:15], s48 offen offset:128 sc1 lds
    s_add_u32 m0, s54, 6016
    s_nop 0
    buffer_load_dwordx4 v6, s[12:15], s49 offen offset:128 sc1 lds
    s_add_u32 m0, s54, 7040
    s_nop 0
    buffer_load_dwordx4 v9, s[12:15], s49 offen offset:128 sc1 lds
    s_add_u32 s48, s53, 32768
    s_add_u32 s49, s48, 4096
    s_add_u32 s46, s54, 32768
    s_add_u32 m0, s46, 0
    s_nop 0
    buffer_load_dwordx4 v6, s[12:15], s48 offen offset:0 sc1 lds
    s_add_u32 m0, s46, 1024
    s_nop 0
    buffer_load_dwordx4 v9, s[12:15], s48 offen offset:0 sc1 lds
    s_add_u32 m0, s46, 2048
    s_nop 0
    buffer_load_dwordx4 v6, s[12:15], s49 offen offset:0 sc1 lds
    s_add_u32 m0, s46, 3072
    s_nop 0
    buffer_load_dwordx4 v9, s[12:15], s49 offen offset:0 sc1 lds
    s_add_u32 m0, s46, 3968
    s_nop 0
    buffer_load_dwordx4 v6, s[12:15], s48 offen offset:128 sc1 lds
    s_add_u32 m0, s46, 4992
    s_nop 0
    buffer_load_dwordx4 v9, s[12:15], s48 offen offset:128 sc1 lds
    s_add_u32 m0, s46, 6016
    s_nop 0
    buffer_load_dwordx4 v6, s[12:15], s49 offen offset:128 sc1 lds
    s_add_u32 m0, s46, 7040
    s_nop 0
    buffer_load_dwordx4 v9, s[12:15], s49 offen offset:128 sc1 lds
    s_cmp_eq_u32 s51, 1
    s_cbranch_scc1 L_e_one_159
    s_add_u32 s48, s53, 65536
    s_add_u32 s49, s48, 4096
    s_add_u32 m0, s55, 0
    s_nop 0
    buffer_load_dwordx4 v6, s[12:15], s48 offen offset:0 sc1 lds
    s_add_u32 m0, s55, 1024
    s_nop 0
    buffer_load_dwordx4 v9, s[12:15], s48 offen offset:0 sc1 lds
    s_add_u32 m0, s55, 2048
    s_nop 0
    buffer_load_dwordx4 v6, s[12:15], s49 offen offset:0 sc1 lds
    s_add_u32 m0, s55, 3072
    s_nop 0
    buffer_load_dwordx4 v9, s[12:15], s49 offen offset:0 sc1 lds
    s_add_u32 m0, s55, 3968
    s_nop 0
    buffer_load_dwordx4 v6, s[12:15], s48 offen offset:128 sc1 lds
    s_add_u32 m0, s55, 4992
    s_nop 0
    buffer_load_dwordx4 v9, s[12:15], s48 offen offset:128 sc1 lds
    s_add_u32 m0, s55, 6016
    s_nop 0
    buffer_load_dwordx4 v6, s[12:15], s49 offen offset:128 sc1 lds
    s_add_u32 m0, s55, 7040
    s_nop 0
    buffer_load_dwordx4 v9, s[12:15], s49 offen offset:128 sc1 lds
    s_waitcnt vmcnt(16)
    s_barrier
    ds_read_b128 v[32:35], v13 offset:0
    ds_read_b128 v[36:39], v13 offset:2048
    ds_read_b128 v[40:43], v15 offset:0
    ds_read_b128 v[44:47], v15 offset:2048
L_e_loop_158:
    s_add_u32 s48, s53, 98304
    s_add_u32 s46, s58, 1
    s_cmp_lt_u32 s46, s51
    s_cselect_b32 s48, s48, 0x20000000
    s_add_u32 s49, s48, 4096
    s_add_u32 s59, s55, 32768
    s_waitcnt lgkmcnt(2)
    v_mfma_f32_16x16x32_bf16 v[80:83], a[0:3], v[32:35], 0
    ds_read_b128 v[48:51], v13 offset:4096
    ds_read_b128 v[52:55], v13 offset:6144
    v_mfma_f32_16x16x32_bf16 v[84:87], a[4:7], v[32:35], 0
    ds_read_b128 v[56:59], v15 offset:4096
    ds_read_b128 v[60:63], v15 offset:6144
    s_add_u32 m0, s59, 0
    v_mfma_f32_16x16x32_bf16 v[88:91], a[0:3], v[36:39], 0
    buffer_load_dwordx4 v6, s[12:15], s48 offen offset:0 sc1 lds
    v_mfma_f32_16x16x32_bf16 v[92:95], a[4:7], v[36:39], 0
    v_mul_f32 v240, v224, v224
    v_mul_f32 v241, v225, v225
    s_waitcnt lgkmcnt(4)
    v_mfma_f32_16x16x32_bf16 v[80:83], a[8:11], v[40:43], v[80:83]
    ds_read_b128 v[32:35], v13 offset:8192
    ds_read_b128 v[36:39], v13 offset:10240
    v_mfma_f32_16x16x32_bf16 v[84:87], a[12:15], v[40:43], v[84:87]
    s_add_u32 m0, s59, 1024
    v_mul_f32 v242, v226, v226
    v_mfma_f32_16x16x32_bf16 v[88:91], a[8:11], v[44:47], v[88:91]
    buffer_load_dwordx4 v9, s[12:15], s48 offen offset:0 sc1 lds
    v_mfma_f32_16x16x32_bf16 v[92:95], a[12:15], v[44:47], v[92:95]
    v_mul_f32 v243, v227, v227
    v_mul_f32 v244, v228, v228
    s_waitcnt lgkmcnt(4)
    v_mfma_f32_16x16x32_bf16 v[80:83], a[16:19], v[48:51], v[80:83]
    ds_read_b128 v[40:43], v15 offset:8192
    ds_read_b128 v[44:47], v15 offset:10240
    v_mfma_f32_16x16x32_bf16 v[84:87], a[20:23], v[48:51], v[84:87]
    s_add_u32 m0, s59, 2048
    v_mul_f32 v245, v229, v229
    v_mfma_f32_16x16x32_bf16 v[88:91], a[16:19], v[52:55], v[88:91]
    buffer_load_dwordx4 v6, s[12:15], s49 offen offset:0 sc1 lds
    v_mfma_f32_16x16x32_bf16 v[92:95], a[20:23], v[52:55], v[92:95]
    v_mul_f32 v246, v230, v230
    v_mul_f32 v247, v231, v231
    s_waitcnt lgkmcnt(4)
    v_mfma_f32_16x16x32_bf16 v[80:83], a[24:27], v[56:59], v[80:83]
    ds_read_b128 v[48:51], v13 offset:12288
    ds_read_b128 v[52:55], v13 offset:14336
    v_mfma_f32_16x16x32_bf16 v[84:87], a[28:31], v[56:59], v[84:87]
    s_add_u32 m0, s59, 3072
    v_mul_f32 v248, v232, v232
    v_mfma_f32_16x16x32_bf16 v[88:91], a[24:27], v[60:63], v[88:91]
    buffer_load_dwordx4 v9, s[12:15], s49 offen offset:0 sc1 lds
    v_mfma_f32_16x16x32_bf16 v[92:95], a[28:31], v[60:63], v[92:95]
    v_mul_f32 v249, v233, v233
    v_mul_f32 v250, v234, v234
    s_waitcnt lgkmcnt(4)
    v_mfma_f32_16x16x32_bf16 v[80:83], a[32:35], v[32:35], v[80:83]
    ds_read_b128 v[56:59], v15 offset:12288
    ds_read_b128 v[60:63], v15 offset:14336
    v_mfma_f32_16x16x32_bf16 v[84:87], a[36:39], v[32:35], v[84:87]
    s_add_u32 m0, s59, 3968
    v_mul_f32 v251, v235, v235
    v_mfma_f32_16x16x32_bf16 v[88:91], a[32:35], v[36:39], v[88:91]
    buffer_load_dwordx4 v6, s[12:15], s48 offen offset:128 sc1 lds
    v_mfma_f32_16x16x32_bf16 v[92:95], a[36:39], v[36:39], v[92:95]
    v_mul_f32 v252, v236, v236
    v_mul_f32 v253, v237, v237
    v_mul_f32 v254, v238, v238
    s_waitcnt lgkmcnt(4)
    v_mfma_f32_16x16x32_bf16 v[80:83], a[40:43], v[40:43], v[80:83]
    ds_read_b128 v[32:35], v13 offset:16384
    ds_read_b128 v[36:39], v13 offset:18432
    v_mfma_f32_16x16x32_bf16 v[84:87], a[44:47], v[40:43], v[84:87]
    s_add_u32 m0, s59, 4992
    v_mul_f32 v255, v239, v239
    v_fma_f32 v240, v240, v104, v106
    v_mfma_f32_16x16x32_bf16 v[88:91], a[40:43], v[44:47], v[88:91]
    buffer_load_dwordx4 v9, s[12:15], s48 offen offset:128 sc1 lds
    v_mfma_f32_16x16x32_bf16 v[92:95], a[44:47], v[44:47], v[92:95]
    v_fma_f32 v241, v241, v105, v107
    v_fma_f32 v242, v242, v104, v106
    v_fma_f32 v243, v243, v105, v107
    s_waitcnt lgkmcnt(4)
    v_mfma_f32_16x16x32_bf16 v[80:83], a[48:51], v[48:51], v[80:83]
    ds_read_b128 v[40:43], v15 offset:16384
    ds_read_b128 v[44:47], v15 offset:18432
    v_mfma_f32_16x16x32_bf16 v[84:87], a[52:55], v[48:51], v[84:87]
    s_add_u32 m0, s59, 6016
    v_fma_f32 v244, v244, v104, v106
    v_fma_f32 v245, v245, v105, v107
    v_mfma_f32_16x16x32_bf16 v[88:91], a[48:51], v[52:55], v[88:91]
    buffer_load_dwordx4 v6, s[12:15], s49 offen offset:128 sc1 lds
    v_mfma_f32_16x16x32_bf16 v[92:95], a[52:55], v[52:55], v[92:95]
    v_fma_f32 v246, v246, v104, v106
    v_fma_f32 v247, v247, v105, v107
    v_fma_f32 v248, v248, v104, v106
    s_waitcnt lgkmcnt(4)
    v_mfma_f32_16x16x32_bf16 v[80:83], a[56:59], v[56:59], v[80:83]
    ds_read_b128 v[48:51], v13 offset:20480
    ds_read_b128 v[52:55], v13 offset:22528
    v_mfma_f32_16x16x32_bf16 v[84:87], a[60:63], v[56:59], v[84:87]
    s_add_u32 m0, s59, 7040
    v_fma_f32 v249, v249, v105, v107
    v_fma_f32 v250, v250, v104, v106
    v_mfma_f32_16x16x32_bf16 v[88:91], a[56:59], v[60:63], v[88:91]
    buffer_load_dwordx4 v9, s[12:15], s49 offen offset:128 sc1 lds
    v_mfma_f32_16x16x32_bf16 v[92:95], a[60:63], v[60:63], v[92:95]
    v_fma_f32 v251, v251, v105, v107
    v_fma_f32 v252, v252, v104, v106
    v_fma_f32 v253, v253, v105, v107
    s_waitcnt lgkmcnt(4)
    v_mfma_f32_16x16x32_bf16 v[80:83], a[64:67], v[32:35], v[80:83]
    ds_read_b128 v[56:59], v15 offset:20480
    ds_read_b128 v[60:63], v15 offset:22528
    v_mfma_f32_16x16x32_bf16 v[84:87], a[68:71], v[32:35], v[84:87]
    v_fma_f32 v254, v254, v104, v106
    v_fma_f32 v255, v255, v105, v107
    v_mul_f32 v240, v240, v224
    v_mfma_f32_16x16x32_bf16 v[88:91], a[64:67], v[36:39], v[88:91]
    v_mul_f32 v241, v241, v225
    v_mul_f32 v242, v242, v226
    v_mul_f32 v243, v243, v227
    v_mfma_f32_16x16x32_bf16 v[92:95], a[68:71], v[36:39], v[92:95]
    v_mul_f32 v244, v244, v228
    v_mul_f32 v245, v245, v229
    s_waitcnt lgkmcnt(4)
    v_mfma_f32_16x16x32_bf16 v[80:83], a[72:75], v[40:43], v[80:83]
    ds_read_b128 v[32:35], v13 offset:24576
    ds_read_b128 v[36:39], v13 offset:26624
    v_mfma_f32_16x16x32_bf16 v[84:87], a[76:79], v[40:43], v[84:87]
    v_mul_f32 v246, v246, v230
    v_mul_f32 v247, v247, v231
    v_mfma_f32_16x16x32_bf16 v[88:91], a[72:75], v[44:47], v[88:91]
    v_mul_f32 v248, v248, v232
    v_mul_f32 v249, v249, v233
    v_mfma_f32_16x16x32_bf16 v[92:95], a[76:79], v[44:47], v[92:95]
    v_mul_f32 v250, v250, v234
    v_mul_f32 v251, v251, v235
    s_waitcnt lgkmcnt(4)
    v_mfma_f32_16x16x32_bf16 v[80:83], a[80:83], v[48:51], v[80:83]
    ds_read_b128 v[40:43], v15 offset:24576
    ds_read_b128 v[44:47], v15 offset:26624
    v_mfma_f32_16x16x32_bf16 v[84:87], a[84:87], v[48:51], v[84:87]
    v_mul_f32 v252, v252, v236
    v_mul_f32 v253, v253, v237
    v_mfma_f32_16x16x32_bf16 v[88:91], a[80:83], v[52:55], v[88:91]
    v_mul_f32 v254, v254, v238
    v_mul_f32 v255, v255, v239
    v_mfma_f32_16x16x32_bf16 v[92:95], a[84:87], v[52:55], v[92:95]
    v_exp_f32 v240, v240
    s_waitcnt lgkmcnt(4)
    v_mfma_f32_16x16x32_bf16 v[80:83], a[88:91], v[56:59], v[80:83]
    ds_read_b128 v[48:51], v13 offset:28672
    ds_read_b128 v[52:55], v13 offset:30720
    v_mfma_f32_16x16x32_bf16 v[84:87], a[92:95], v[56:59], v[84:87]
    v_exp_f32 v241, v241
    v_mfma_f32_16x16x32_bf16 v[88:91], a[88:91], v[60:63], v[88:91]
    v_exp_f32 v242, v242
    v_mfma_f32_16x16x32_bf16 v[92:95], a[92:95], v[60:63], v[92:95]
    v_exp_f32 v243, v243
    s_waitcnt lgkmcnt(4)
    v_mfma_f32_16x16x32_bf16 v[80:83], a[96:99], v[32:35], v[80:83]
    ds_read_b128 v[56:59], v15 offset:28672
    ds_read_b128 v[60:63], v15 offset:30720
    v_mfma_f32_16x16x32_bf16 v[84:87], a[100:103], v[32:35], v[84:87]
    v_exp_f32 v244, v244
    v_mfma_f32_16x16x32_bf16 v[88:91], a[96:99], v[36:39], v[88:91]
    v_exp_f32 v245, v245
    v_mfma_f32_16x16x32_bf16 v[92:95], a[100:103], v[36:39], v[92:95]
    v_exp_f32 v246, v246
    s_waitcnt lgkmcnt(4)
    v_mfma_f32_16x16x32_bf16 v[80:83], a[104:107], v[40:43], v[80:83]
    v_exp_f32 v247, v247
    v_mfma_f32_16x16x32_bf16 v[84:87], a[108:111], v[40:43], v[84:87]
    v_exp_f32 v248, v248
    v_mfma_f32_16x16x32_bf16 v[88:91], a[104:107], v[44:47], v[88:91]
    v_exp_f32 v249, v249
    v_mfma_f32_16x16x32_bf16 v[92:95], a[108:111], v[44:47], v[92:95]
    v_exp_f32 v250, v250
    s_waitcnt vmcnt(16) lgkmcnt(0)
    s_barrier
    v_mfma_f32_16x16x32_bf16 v[80:83], a[112:115], v[48:51], v[80:83]
    ds_read_b128 v[32:35], v13 offset:32768
    ds_read_b128 v[36:39], v13 offset:34816
    v_mfma_f32_16x16x32_bf16 v[84:87], a[116:119], v[48:51], v[84:87]
    v_exp_f32 v251, v251
    v_mfma_f32_16x16x32_bf16 v[88:91], a[112:115], v[52:55], v[88:91]
    v_exp_f32 v252, v252
    v_mfma_f32_16x16x32_bf16 v[92:95], a[116:119], v[52:55], v[92:95]
    v_exp_f32 v253, v253
    v_mfma_f32_16x16x32_bf16 v[80:83], a[120:123], v[56:59], v[80:83]
    ds_read_b128 v[40:43], v15 offset:32768
    ds_read_b128 v[44:47], v15 offset:34816
    v_mfma_f32_16x16x32_bf16 v[84:87], a[124:127], v[56:59], v[84:87]
    v_exp_f32 v254, v254
    v_mfma_f32_16x16x32_bf16 v[88:91], a[120:123], v[60:63], v[88:91]
    v_exp_f32 v255, v255
    v_mfma_f32_16x16x32_bf16 v[92:95], a[124:127], v[60:63], v[92:95]
    v_add_f32 v240, 1.0, v240
    v_add_f32 v241, 1.0, v241
    s_add_u32 s48, s53, 131072
    s_add_u32 s46, s58, 2
    s_cmp_lt_u32 s46, s51
    s_cselect_b32 s48, s48, 0x20000000
    s_add_u32 s49, s48, 4096
    s_mov_b32 s59, s54
    s_waitcnt lgkmcnt(2)
    v_mfma_f32_16x16x32_bf16 v[80:83], a[128:131], v[32:35], v[80:83]
    ds_read_b128 v[48:51], v13 offset:36864
    ds_read_b128 v[52:55], v13 offset:38912
    v_mfma_f32_16x16x32_bf16 v[84:87], a[132:135], v[32:35], v[84:87]
    ds_read_b128 v[56:59], v15 offset:36864
    ds_read_b128 v[60:63], v15 offset:38912
    s_add_u32 m0, s59, 0
    v_mfma_f32_16x16x32_bf16 v[88:91], a[128:131], v[36:39], v[88:91]
    buffer_load_dwordx4 v6, s[12:15], s48 offen offset:0 sc1 lds
    v_mfma_f32_16x16x32_bf16 v[92:95], a[132:135], v[36:39], v[92:95]
    v_add_f32 v242, 1.0, v242
    v_add_f32 v243, 1.0, v243
    s_waitcnt lgkmcnt(4)
    v_mfma_f32_16x16x32_bf16 v[80:83], a[136:139], v[40:43], v[80:83]
    ds_read_b128 v[32:35], v13 offset:40960
    ds_read_b128 v[36:39], v13 offset:43008
    v_mfma_f32_16x16x32_bf16 v[84:87], a[140:143], v[40:43], v[84:87]
    s_add_u32 m0, s59, 1024
    v_add_f32 v244, 1.0, v244
    v_mfma_f32_16x16x32_bf16 v[88:91], a[136:139], v[44:47], v[88:91]
    buffer_load_dwordx4 v9, s[12:15], s48 offen offset:0 sc1 lds
    v_mfma_f32_16x16x32_bf16 v[92:95], a[140:143], v[44:47], v[92:95]
    v_add_f32 v245, 1.0, v245
    v_add_f32 v246, 1.0, v246
    s_waitcnt lgkmcnt(4)
    v_mfma_f32_16x16x32_bf16 v[80:83], a[144:147], v[48:51], v[80:83]
    ds_read_b128 v[40:43], v15 offset:40960
    ds_read_b128 v[44:47], v15 offset:43008
    v_mfma_f32_16x16x32_bf16 v[84:87], a[148:151], v[48:51], v[84:87]
    s_add_u32 m0, s59, 2048
    v_add_f32 v247, 1.0, v247
    v_mfma_f32_16x16x32_bf16 v[88:91], a[144:147], v[52:55], v[88:91]
    buffer_load_dwordx4 v6, s[12:15], s49 offen offset:0 sc1 lds
    v_mfma_f32_16x16x32_bf16 v[92:95], a[148:151], v[52:55], v[92:95]
    v_add_f32 v248, 1.0, v248
    v_add_f32 v249, 1.0, v249
    s_waitcnt lgkmcnt(4)
    v_mfma_f32_16x16x32_bf16 v[80:83], a[152:155], v[56:59], v[80:83]
    ds_read_b128 v[48:51], v13 offset:45056
    ds_read_b128 v[52:55], v13 offset:47104
    v_mfma_f32_16x16x32_bf16 v[84:87], a[156:159], v[56:59], v[84:87]
    s_add_u32 m0, s59, 3072
    v_add_f32 v250, 1.0, v250
    v_mfma_f32_16x16x32_bf16 v[88:91], a[152:155], v[60:63], v[88:91]
    buffer_load_dwordx4 v9, s[12:15], s49 offen offset:0 sc1 lds
    v_mfma_f32_16x16x32_bf16 v[92:95], a[156:159], v[60:63], v[92:95]
    v_add_f32 v251, 1.0, v251
    v_add_f32 v252, 1.0, v252
    v_add_f32 v253, 1.0, v253
    s_waitcnt lgkmcnt(4)
    v_mfma_f32_16x16x32_bf16 v[80:83], a[160:163], v[32:35], v[80:83]
    ds_read_b128 v[56:59], v15 offset:45056
    ds_read_b128 v[60:63], v15 offset:47104
    v_mfma_f32_16x16x32_bf16 v[84:87], a[164:167], v[32:35], v[84:87]
    s_add_u32 m0, s59, 3968
    v_add_f32 v254, 1.0, v254
    v_add_f32 v255, 1.0, v255
    v_mfma_f32_16x16x32_bf16 v[88:91], a[160:163], v[36:39], v[88:91]
    buffer_load_dwordx4 v6, s[12:15], s48 offen offset:128 sc1 lds
    v_mfma_f32_16x16x32_bf16 v[92:95], a[164:167], v[36:39], v[92:95]
    v_rcp_f32 v240, v240
    v_rcp_f32 v241, v241
    s_waitcnt lgkmcnt(4)
    v_mfma_f32_16x16x32_bf16 v[80:83], a[168:171], v[40:43], v[80:83]
    ds_read_b128 v[32:35], v13 offset:49152
    ds_read_b128 v[36:39], v13 offset:51200
    v_mfma_f32_16x16x32_bf16 v[84:87], a[172:175], v[40:43], v[84:87]
    s_add_u32 m0, s59, 4992
    v_rcp_f32 v242, v242
    v_mfma_f32_16x16x32_bf16 v[88:91], a[168:171], v[44:47], v[88:91]
    buffer_load_dwordx4 v9, s[12:15], s48 offen offset:128 sc1 lds
    v_mfma_f32_16x16x32_bf16 v[92:95], a[172:175], v[44:47], v[92:95]
    v_rcp_f32 v243, v243
    s_waitcnt lgkmcnt(4)
    v_mfma_f32_16x16x32_bf16 v[80:83], a[176:179], v[48:51], v[80:83]
    ds_read_b128 v[40:43], v15 offset:49152
    ds_read_b128 v[44:47], v15 offset:51200
    v_mfma_f32_16x16x32_bf16 v[84:87], a[180:183], v[48:51], v[84:87]
    s_add_u32 m0, s59, 6016
    v_rcp_f32 v244, v244
    v_mfma_f32_16x16x32_bf16 v[88:91], a[176:179], v[52:55], v[88:91]
    buffer_load_dwordx4 v6, s[12:15], s49 offen offset:128 sc1 lds
    v_mfma_f32_16x16x32_bf16 v[92:95], a[180:183], v[52:55], v[92:95]
    v_rcp_f32 v245, v245
    v_rcp_f32 v246, v246
    s_waitcnt lgkmcnt(4)
    v_mfma_f32_16x16x32_bf16 v[80:83], a[184:187], v[56:59], v[80:83]
    ds_read_b128 v[48:51], v13 offset:53248
    ds_read_b128 v[52:55], v13 offset:55296
    v_mfma_f32_16x16x32_bf16 v[84:87], a[188:191], v[56:59], v[84:87]
    s_add_u32 m0, s59, 7040
    v_rcp_f32 v247, v247
    v_mfma_f32_16x16x32_bf16 v[88:91], a[184:187], v[60:63], v[88:91]
    buffer_load_dwordx4 v9, s[12:15], s49 offen offset:128 sc1 lds
    v_mfma_f32_16x16x32_bf16 v[92:95], a[188:191], v[60:63], v[92:95]
    v_rcp_f32 v248, v248
    v_rcp_f32 v249, v249
    s_waitcnt lgkmcnt(4)
    v_mfma_f32_16x16x32_bf16 v[80:83], a[192:195], v[32:35], v[80:83]
    ds_read_b128 v[56:59], v15 offset:53248
    ds_read_b128 v[60:63], v15 offset:55296
    v_mfma_f32_16x16x32_bf16 v[84:87], a[196:199], v[32:35], v[84:87]
    v_rcp_f32 v250, v250
    v_mfma_f32_16x16x32_bf16 v[88:91], a[192:195], v[36:39], v[88:91]
    v_rcp_f32 v251, v251
    v_mfma_f32_16x16x32_bf16 v[92:95], a[196:199], v[36:39], v[92:95]
    v_rcp_f32 v252, v252
    s_waitcnt lgkmcnt(4)
    v_mfma_f32_16x16x32_bf16 v[80:83], a[200:203], v[40:43], v[80:83]
    ds_read_b128 v[32:35], v13 offset:57344
    ds_read_b128 v[36:39], v13 offset:59392
    v_mfma_f32_16x16x32_bf16 v[84:87], a[204:207], v[40:43], v[84:87]
    v_rcp_f32 v253, v253
    v_mfma_f32_16x16x32_bf16 v[88:91], a[200:203], v[44:47], v[88:91]
    v_rcp_f32 v254, v254
    v_mfma_f32_16x16x32_bf16 v[92:95], a[204:207], v[44:47], v[92:95]
    v_rcp_f32 v255, v255
    s_waitcnt lgkmcnt(4)
    v_mfma_f32_16x16x32_bf16 v[80:83], a[208:211], v[48:51], v[80:83]
    ds_read_b128 v[40:43], v15 offset:57344
    ds_read_b128 v[44:47], v15 offset:59392
    v_mfma_f32_16x16x32_bf16 v[84:87], a[212:215], v[48:51], v[84:87]
    v_mul_f32 v224, v224, v240
    v_mul_f32 v225, v225, v241
    v_mfma_f32_16x16x32_bf16 v[88:91], a[208:211], v[52:55], v[88:91]
    v_mul_f32 v226, v226, v242
    v_mul_f32 v227, v227, v243
    v_mfma_f32_16x16x32_bf16 v[92:95], a[212:215], v[52:55], v[92:95]
    v_mul_f32 v228, v228, v244
    v_mul_f32 v229, v229, v245
    s_waitcnt lgkmcnt(4)
    v_mfma_f32_16x16x32_bf16 v[80:83], a[216:219], v[56:59], v[80:83]
    ds_read_b128 v[48:51], v13 offset:61440
    ds_read_b128 v[52:55], v13 offset:63488
    v_mfma_f32_16x16x32_bf16 v[84:87], a[220:223], v[56:59], v[84:87]
    v_mul_f32 v230, v230, v246
    v_mul_f32 v231, v231, v247
    v_mfma_f32_16x16x32_bf16 v[88:91], a[216:219], v[60:63], v[88:91]
    v_mul_f32 v232, v232, v248
    v_mul_f32 v233, v233, v249
    v_mfma_f32_16x16x32_bf16 v[92:95], a[220:223], v[60:63], v[92:95]
    v_mul_f32 v234, v234, v250
    v_mul_f32 v235, v235, v251
    s_waitcnt lgkmcnt(4)
    v_mfma_f32_16x16x32_bf16 v[80:83], a[224:227], v[32:35], v[80:83]
    ds_read_b128 v[56:59], v15 offset:61440
    ds_read_b128 v[60:63], v15 offset:63488
    v_mfma_f32_16x16x32_bf16 v[84:87], a[228:231], v[32:35], v[84:87]
    v_mul_f32 v236, v236, v252
    v_mul_f32 v237, v237, v253
    v_mfma_f32_16x16x32_bf16 v[88:91], a[224:227], v[36:39], v[88:91]
    v_mul_f32 v238, v238, v254
    v_mul_f32 v239, v239, v255
    v_mfma_f32_16x16x32_bf16 v[92:95], a[228:231], v[36:39], v[92:95]
    v_cvt_pk_bf16_f32 v240, v224, v225
    v_cvt_pk_bf16_f32 v241, v226, v227
    s_waitcnt lgkmcnt(4)
    v_mfma_f32_16x16x32_bf16 v[80:83], a[232:235], v[40:43], v[80:83]
    v_cvt_pk_bf16_f32 v242, v228, v229
    v_cvt_pk_bf16_f32 v243, v230, v231
    v_mfma_f32_16x16x32_bf16 v[84:87], a[236:239], v[40:43], v[84:87]
    v_cvt_pk_bf16_f32 v244, v232, v233
    v_cvt_pk_bf16_f32 v245, v234, v235
    v_mfma_f32_16x16x32_bf16 v[88:91], a[232:235], v[44:47], v[88:91]
    v_cvt_pk_bf16_f32 v246, v236, v237
    v_cvt_pk_bf16_f32 v247, v238, v239
    v_mfma_f32_16x16x32_bf16 v[92:95], a[236:239], v[44:47], v[92:95]
    buffer_store_dwordx4 v[240:243], v10, s[12:15], s76 offen sc1
    buffer_store_dwordx4 v[244:247], v10, s[12:15], s76 offen offset:1024 sc1
    s_waitcnt vmcnt(16) lgkmcnt(0)
    s_barrier
    v_mfma_f32_16x16x32_bf16 v[80:83], a[240:243], v[48:51], v[80:83]
    ds_read_b128 v[32:35], v14 offset:0
    ds_read_b128 v[36:39], v14 offset:2048
    v_mfma_f32_16x16x32_bf16 v[84:87], a[244:247], v[48:51], v[84:87]
    v_mfma_f32_16x16x32_bf16 v[88:91], a[240:243], v[52:55], v[88:91]
    v_mfma_f32_16x16x32_bf16 v[92:95], a[244:247], v[52:55], v[92:95]
    v_mfma_f32_16x16x32_bf16 v[80:83], a[248:251], v[56:59], v[80:83]
    ds_read_b128 v[40:43], v16 offset:0
    ds_read_b128 v[44:47], v16 offset:2048
    v_mfma_f32_16x16x32_bf16 v[84:87], a[252:255], v[56:59], v[84:87]
    v_mfma_f32_16x16x32_bf16 v[88:91], a[248:251], v[60:63], v[88:91]
    v_mfma_f32_16x16x32_bf16 v[92:95], a[252:255], v[60:63], v[92:95]
    s_add_u32 s53, s53, 65536
    s_add_u32 s58, s58, 1
    v_swap_b32 v13, v14
    s_xor_b32 s54, s54, 65536
    s_xor_b32 s55, s55, 65536
    s_mov_b32 s76, s57
    v_swap_b32 v15, v16
    s_add_u32 s57, s57, 229376
    v_pk_add_f32 v[224:225], v[80:81], v[96:97]
    v_pk_add_f32 v[226:227], v[82:83], v[98:99]
    v_pk_add_f32 v[228:229], v[84:85], v[100:101]
    v_pk_add_f32 v[230:231], v[86:87], v[102:103]
    v_pk_add_f32 v[232:233], v[88:89], v[96:97]
    v_pk_add_f32 v[234:235], v[90:91], v[98:99]
    v_pk_add_f32 v[236:237], v[92:93], v[100:101]
    v_pk_add_f32 v[238:239], v[94:95], v[102:103]
    s_cmp_lt_u32 s58, s51
    s_cbranch_scc1 L_e_loop_158
    s_branch L_e_fin_160
L_e_one_159:
    s_waitcnt vmcnt(8)
    s_barrier
    ds_read_b128 v[32:35], v13 offset:0
    ds_read_b128 v[36:39], v13 offset:2048
    ds_read_b128 v[40:43], v15 offset:0
    ds_read_b128 v[44:47], v15 offset:2048
    s_waitcnt lgkmcnt(2)
    v_mfma_f32_16x16x32_bf16 v[80:83], a[0:3], v[32:35], 0
    ds_read_b128 v[48:51], v13 offset:4096
    ds_read_b128 v[52:55], v13 offset:6144
    v_mfma_f32_16x16x32_bf16 v[84:87], a[4:7], v[32:35], 0
    ds_read_b128 v[56:59], v15 offset:4096
    ds_read_b128 v[60:63], v15 offset:6144
    v_mfma_f32_16x16x32_bf16 v[88:91], a[0:3], v[36:39], 0
    v_mfma_f32_16x16x32_bf16 v[92:95], a[4:7], v[36:39], 0
    s_waitcnt lgkmcnt(4)
    v_mfma_f32_16x16x32_bf16 v[80:83], a[8:11], v[40:43], v[80:83]
    ds_read_b128 v[32:35], v13 offset:8192
    ds_read_b128 v[36:39], v13 offset:10240
    v_mfma_f32_16x16x32_bf16 v[84:87], a[12:15], v[40:43], v[84:87]
    v_mfma_f32_16x16x32_bf16 v[88:91], a[8:11], v[44:47], v[88:91]
    v_mfma_f32_16x16x32_bf16 v[92:95], a[12:15], v[44:47], v[92:95]
    s_waitcnt lgkmcnt(4)
    v_mfma_f32_16x16x32_bf16 v[80:83], a[16:19], v[48:51], v[80:83]
    ds_read_b128 v[40:43], v15 offset:8192
    ds_read_b128 v[44:47], v15 offset:10240
    v_mfma_f32_16x16x32_bf16 v[84:87], a[20:23], v[48:51], v[84:87]
    v_mfma_f32_16x16x32_bf16 v[88:91], a[16:19], v[52:55], v[88:91]
    v_mfma_f32_16x16x32_bf16 v[92:95], a[20:23], v[52:55], v[92:95]
    s_waitcnt lgkmcnt(4)
    v_mfma_f32_16x16x32_bf16 v[80:83], a[24:27], v[56:59], v[80:83]
    ds_read_b128 v[48:51], v13 offset:12288
    ds_read_b128 v[52:55], v13 offset:14336
    v_mfma_f32_16x16x32_bf16 v[84:87], a[28:31], v[56:59], v[84:87]
    v_mfma_f32_16x16x32_bf16 v[88:91], a[24:27], v[60:63], v[88:91]
    v_mfma_f32_16x16x32_bf16 v[92:95], a[28:31], v[60:63], v[92:95]
    s_waitcnt lgkmcnt(4)
    v_mfma_f32_16x16x32_bf16 v[80:83], a[32:35], v[32:35], v[80:83]
    ds_read_b128 v[56:59], v15 offset:12288
    ds_read_b128 v[60:63], v15 offset:14336
    v_mfma_f32_16x16x32_bf16 v[84:87], a[36:39], v[32:35], v[84:87]
    v_mfma_f32_16x16x32_bf16 v[88:91], a[32:35], v[36:39], v[88:91]
    v_mfma_f32_16x16x32_bf16 v[92:95], a[36:39], v[36:39], v[92:95]
    s_waitcnt lgkmcnt(4)
    v_mfma_f32_16x16x32_bf16 v[80:83], a[40:43], v[40:43], v[80:83]
    ds_read_b128 v[32:35], v13 offset:16384
    ds_read_b128 v[36:39], v13 offset:18432
    v_mfma_f32_16x16x32_bf16 v[84:87], a[44:47], v[40:43], v[84:87]
    v_mfma_f32_16x16x32_bf16 v[88:91], a[40:43], v[44:47], v[88:91]
    v_mfma_f32_16x16x32_bf16 v[92:95], a[44:47], v[44:47], v[92:95]
    s_waitcnt lgkmcnt(4)
    v_mfma_f32_16x16x32_bf16 v[80:83], a[48:51], v[48:51], v[80:83]
    ds_read_b128 v[40:43], v15 offset:16384
    ds_read_b128 v[44:47], v15 offset:18432
    v_mfma_f32_16x16x32_bf16 v[84:87], a[52:55], v[48:51], v[84:87]
    v_mfma_f32_16x16x32_bf16 v[88:91], a[48:51], v[52:55], v[88:91]
    v_mfma_f32_16x16x32_bf16 v[92:95], a[52:55], v[52:55], v[92:95]
    s_waitcnt lgkmcnt(4)
    v_mfma_f32_16x16x32_bf16 v[80:83], a[56:59], v[56:59], v[80:83]
    ds_read_b128 v[48:51], v13 offset:20480
    ds_read_b128 v[52:55], v13 offset:22528
    v_mfma_f32_16x16x32_bf16 v[84:87], a[60:63], v[56:59], v[84:87]
    v_mfma_f32_16x16x32_bf16 v[88:91], a[56:59], v[60:63], v[88:91]
    v_mfma_f32_16x16x32_bf16 v[92:95], a[60:63], v[60:63], v[92:95]
    s_waitcnt lgkmcnt(4)
    v_mfma_f32_16x16x32_bf16 v[80:83], a[64:67], v[32:35], v[80:83]
    ds_read_b128 v[56:59], v15 offset:20480
    ds_read_b128 v[60:63], v15 offset:22528
    v_mfma_f32_16x16x32_bf16 v[84:87], a[68:71], v[32:35], v[84:87]
    v_mfma_f32_16x16x32_bf16 v[88:91], a[64:67], v[36:39], v[88:91]
    v_mfma_f32_16x16x32_bf16 v[92:95], a[68:71], v[36:39], v[92:95]
    s_waitcnt lgkmcnt(4)
    v_mfma_f32_16x16x32_bf16 v[80:83], a[72:75], v[40:43], v[80:83]
    ds_read_b128 v[32:35], v13 offset:24576
    ds_read_b128 v[36:39], v13 offset:26624
    v_mfma_f32_16x16x32_bf16 v[84:87], a[76:79], v[40:43], v[84:87]
    v_mfma_f32_16x16x32_bf16 v[88:91], a[72:75], v[44:47], v[88:91]
    v_mfma_f32_16x16x32_bf16 v[92:95], a[76:79], v[44:47], v[92:95]
    s_waitcnt lgkmcnt(4)
    v_mfma_f32_16x16x32_bf16 v[80:83], a[80:83], v[48:51], v[80:83]
    ds_read_b128 v[40:43], v15 offset:24576
    ds_read_b128 v[44:47], v15 offset:26624
    v_mfma_f32_16x16x32_bf16 v[84:87], a[84:87], v[48:51], v[84:87]
    v_mfma_f32_16x16x32_bf16 v[88:91], a[80:83], v[52:55], v[88:91]
    v_mfma_f32_16x16x32_bf16 v[92:95], a[84:87], v[52:55], v[92:95]
    s_waitcnt lgkmcnt(4)
    v_mfma_f32_16x16x32_bf16 v[80:83], a[88:91], v[56:59], v[80:83]
    ds_read_b128 v[48:51], v13 offset:28672
    ds_read_b128 v[52:55], v13 offset:30720
    v_mfma_f32_16x16x32_bf16 v[84:87], a[92:95], v[56:59], v[84:87]
    v_mfma_f32_16x16x32_bf16 v[88:91], a[88:91], v[60:63], v[88:91]
    v_mfma_f32_16x16x32_bf16 v[92:95], a[92:95], v[60:63], v[92:95]
    s_waitcnt lgkmcnt(4)
    v_mfma_f32_16x16x32_bf16 v[80:83], a[96:99], v[32:35], v[80:83]
    ds_read_b128 v[56:59], v15 offset:28672
    ds_read_b128 v[60:63], v15 offset:30720
    v_mfma_f32_16x16x32_bf16 v[84:87], a[100:103], v[32:35], v[84:87]
    v_mfma_f32_16x16x32_bf16 v[88:91], a[96:99], v[36:39], v[88:91]
    v_mfma_f32_16x16x32_bf16 v[92:95], a[100:103], v[36:39], v[92:95]
    s_waitcnt lgkmcnt(4)
    v_mfma_f32_16x16x32_bf16 v[80:83], a[104:107], v[40:43], v[80:83]
    v_mfma_f32_16x16x32_bf16 v[84:87], a[108:111], v[40:43], v[84:87]
    v_mfma_f32_16x16x32_bf16 v[88:91], a[104:107], v[44:47], v[88:91]
    v_mfma_f32_16x16x32_bf16 v[92:95], a[108:111], v[44:47], v[92:95]
    s_waitcnt vmcnt(0) lgkmcnt(0)
    s_barrier
    v_mfma_f32_16x16x32_bf16 v[80:83], a[112:115], v[48:51], v[80:83]
    ds_read_b128 v[32:35], v13 offset:32768
    ds_read_b128 v[36:39], v13 offset:34816
    v_mfma_f32_16x16x32_bf16 v[84:87], a[116:119], v[48:51], v[84:87]
    v_mfma_f32_16x16x32_bf16 v[88:91], a[112:115], v[52:55], v[88:91]
    v_mfma_f32_16x16x32_bf16 v[92:95], a[116:119], v[52:55], v[92:95]
    v_mfma_f32_16x16x32_bf16 v[80:83], a[120:123], v[56:59], v[80:83]
    ds_read_b128 v[40:43], v15 offset:32768
    ds_read_b128 v[44:47], v15 offset:34816
    v_mfma_f32_16x16x32_bf16 v[84:87], a[124:127], v[56:59], v[84:87]
    v_mfma_f32_16x16x32_bf16 v[88:91], a[120:123], v[60:63], v[88:91]
    v_mfma_f32_16x16x32_bf16 v[92:95], a[124:127], v[60:63], v[92:95]
    s_waitcnt lgkmcnt(2)
    v_mfma_f32_16x16x32_bf16 v[80:83], a[128:131], v[32:35], v[80:83]
    ds_read_b128 v[48:51], v13 offset:36864
    ds_read_b128 v[52:55], v13 offset:38912
    v_mfma_f32_16x16x32_bf16 v[84:87], a[132:135], v[32:35], v[84:87]
    ds_read_b128 v[56:59], v15 offset:36864
    ds_read_b128 v[60:63], v15 offset:38912
    v_mfma_f32_16x16x32_bf16 v[88:91], a[128:131], v[36:39], v[88:91]
    v_mfma_f32_16x16x32_bf16 v[92:95], a[132:135], v[36:39], v[92:95]
    s_waitcnt lgkmcnt(4)
    v_mfma_f32_16x16x32_bf16 v[80:83], a[136:139], v[40:43], v[80:83]
    ds_read_b128 v[32:35], v13 offset:40960
    ds_read_b128 v[36:39], v13 offset:43008
    v_mfma_f32_16x16x32_bf16 v[84:87], a[140:143], v[40:43], v[84:87]
    v_mfma_f32_16x16x32_bf16 v[88:91], a[136:139], v[44:47], v[88:91]
    v_mfma_f32_16x16x32_bf16 v[92:95], a[140:143], v[44:47], v[92:95]
    s_waitcnt lgkmcnt(4)
    v_mfma_f32_16x16x32_bf16 v[80:83], a[144:147], v[48:51], v[80:83]
    ds_read_b128 v[40:43], v15 offset:40960
    ds_read_b128 v[44:47], v15 offset:43008
    v_mfma_f32_16x16x32_bf16 v[84:87], a[148:151], v[48:51], v[84:87]
    v_mfma_f32_16x16x32_bf16 v[88:91], a[144:147], v[52:55], v[88:91]
    v_mfma_f32_16x16x32_bf16 v[92:95], a[148:151], v[52:55], v[92:95]
    s_waitcnt lgkmcnt(4)
    v_mfma_f32_16x16x32_bf16 v[80:83], a[152:155], v[56:59], v[80:83]
    ds_read_b128 v[48:51], v13 offset:45056
    ds_read_b128 v[52:55], v13 offset:47104
    v_mfma_f32_16x16x32_bf16 v[84:87], a[156:159], v[56:59], v[84:87]
    v_mfma_f32_16x16x32_bf16 v[88:91], a[152:155], v[60:63], v[88:91]
    v_mfma_f32_16x16x32_bf16 v[92:95], a[156:159], v[60:63], v[92:95]
    s_waitcnt lgkmcnt(4)
    v_mfma_f32_16x16x32_bf16 v[80:83], a[160:163], v[32:35], v[80:83]
    ds_read_b128 v[56:59], v15 offset:45056
    ds_read_b128 v[60:63], v15 offset:47104
    v_mfma_f32_16x16x32_bf16 v[84:87], a[164:167], v[32:35], v[84:87]
    v_mfma_f32_16x16x32_bf16 v[88:91], a[160:163], v[36:39], v[88:91]
    v_mfma_f32_16x16x32_bf16 v[92:95], a[164:167], v[36:39], v[92:95]
    s_waitcnt lgkmcnt(4)
    v_mfma_f32_16x16x32_bf16 v[80:83], a[168:171], v[40:43], v[80:83]
    ds_read_b128 v[32:35], v13 offset:49152
    ds_read_b128 v[36:39], v13 offset:51200
    v_mfma_f32_16x16x32_bf16 v[84:87], a[172:175], v[40:43], v[84:87]
    v_mfma_f32_16x16x32_bf16 v[88:91], a[168:171], v[44:47], v[88:91]
    v_mfma_f32_16x16x32_bf16 v[92:95], a[172:175], v[44:47], v[92:95]
    s_waitcnt lgkmcnt(4)
    v_mfma_f32_16x16x32_bf16 v[80:83], a[176:179], v[48:51], v[80:83]
    ds_read_b128 v[40:43], v15 offset:49152
    ds_read_b128 v[44:47], v15 offset:51200
    v_mfma_f32_16x16x32_bf16 v[84:87], a[180:183], v[48:51], v[84:87]
    v_mfma_f32_16x16x32_bf16 v[88:91], a[176:179], v[52:55], v[88:91]
    v_mfma_f32_16x16x32_bf16 v[92:95], a[180:183], v[52:55], v[92:95]
    s_waitcnt lgkmcnt(4)
    v_mfma_f32_16x16x32_bf16 v[80:83], a[184:187], v[56:59], v[80:83]
    ds_read_b128 v[48:51], v13 offset:53248
    ds_read_b128 v[52:55], v13 offset:55296
    v_mfma_f32_16x16x32_bf16 v[84:87], a[188:191], v[56:59], v[84:87]
    v_mfma_f32_16x16x32_bf16 v[88:91], a[184:187], v[60:63], v[88:91]
    v_mfma_f32_16x16x32_bf16 v[92:95], a[188:191], v[60:63], v[92:95]
    s_waitcnt lgkmcnt(4)
    v_mfma_f32_16x16x32_bf16 v[80:83], a[192:195], v[32:35], v[80:83]
    ds_read_b128 v[56:59], v15 offset:53248
    ds_read_b128 v[60:63], v15 offset:55296
    v_mfma_f32_16x16x32_bf16 v[84:87], a[196:199], v[32:35], v[84:87]
    v_mfma_f32_16x16x32_bf16 v[88:91], a[192:195], v[36:39], v[88:91]
    v_mfma_f32_16x16x32_bf16 v[92:95], a[196:199], v[36:39], v[92:95]
    s_waitcnt lgkmcnt(4)
    v_mfma_f32_16x16x32_bf16 v[80:83], a[200:203], v[40:43], v[80:83]
    ds_read_b128 v[32:35], v13 offset:57344
    ds_read_b128 v[36:39], v13 offset:59392
    v_mfma_f32_16x16x32_bf16 v[84:87], a[204:207], v[40:43], v[84:87]
    v_mfma_f32_16x16x32_bf16 v[88:91], a[200:203], v[44:47], v[88:91]
    v_mfma_f32_16x16x32_bf16 v[92:95], a[204:207], v[44:47], v[92:95]
    s_waitcnt lgkmcnt(4)
    v_mfma_f32_16x16x32_bf16 v[80:83], a[208:211], v[48:51], v[80:83]
    ds_read_b128 v[40:43], v15 offset:57344
    ds_read_b128 v[44:47], v15 offset:59392
    v_mfma_f32_16x16x32_bf16 v[84:87], a[212:215], v[48:51], v[84:87]
    v_mfma_f32_16x16x32_bf16 v[88:91], a[208:211], v[52:55], v[88:91]
    v_mfma_f32_16x16x32_bf16 v[92:95], a[212:215], v[52:55], v[92:95]
    s_waitcnt lgkmcnt(4)
    v_mfma_f32_16x16x32_bf16 v[80:83], a[216:219], v[56:59], v[80:83]
    ds_read_b128 v[48:51], v13 offset:61440
    ds_read_b128 v[52:55], v13 offset:63488
    v_mfma_f32_16x16x32_bf16 v[84:87], a[220:223], v[56:59], v[84:87]
    v_mfma_f32_16x16x32_bf16 v[88:91], a[216:219], v[60:63], v[88:91]
    v_mfma_f32_16x16x32_bf16 v[92:95], a[220:223], v[60:63], v[92:95]
    s_waitcnt lgkmcnt(4)
    v_mfma_f32_16x16x32_bf16 v[80:83], a[224:227], v[32:35], v[80:83]
    ds_read_b128 v[56:59], v15 offset:61440
    ds_read_b128 v[60:63], v15 offset:63488
    v_mfma_f32_16x16x32_bf16 v[84:87], a[228:231], v[32:35], v[84:87]
    v_mfma_f32_16x16x32_bf16 v[88:91], a[224:227], v[36:39], v[88:91]
    v_mfma_f32_16x16x32_bf16 v[92:95], a[228:231], v[36:39], v[92:95]
    s_waitcnt lgkmcnt(4)
    v_mfma_f32_16x16x32_bf16 v[80:83], a[232:235], v[40:43], v[80:83]
    v_mfma_f32_16x16x32_bf16 v[84:87], a[236:239], v[40:43], v[84:87]
    v_mfma_f32_16x16x32_bf16 v[88:91], a[232:235], v[44:47], v[88:91]
    v_mfma_f32_16x16x32_bf16 v[92:95], a[236:239], v[44:47], v[92:95]
    s_waitcnt lgkmcnt(0)
    v_mfma_f32_16x16x32_bf16 v[80:83], a[240:243], v[48:51], v[80:83]
    v_mfma_f32_16x16x32_bf16 v[84:87], a[244:247], v[48:51], v[84:87]
    v_mfma_f32_16x16x32_bf16 v[88:91], a[240:243], v[52:55], v[88:91]
    v_mfma_f32_16x16x32_bf16 v[92:95], a[244:247], v[52:55], v[92:95]
    v_mfma_f32_16x16x32_bf16 v[80:83], a[248:251], v[56:59], v[80:83]
    v_mfma_f32_16x16x32_bf16 v[84:87], a[252:255], v[56:59], v[84:87]
    v_mfma_f32_16x16x32_bf16 v[88:91], a[248:251], v[60:63], v[88:91]
    v_mfma_f32_16x16x32_bf16 v[92:95], a[252:255], v[60:63], v[92:95]
    s_mov_b32 s76, s57
    s_nop 6
    v_pk_add_f32 v[224:225], v[80:81], v[96:97]
    v_pk_add_f32 v[226:227], v[82:83], v[98:99]
    v_pk_add_f32 v[228:229], v[84:85], v[100:101]
    v_pk_add_f32 v[230:231], v[86:87], v[102:103]
    v_pk_add_f32 v[232:233], v[88:89], v[96:97]
    v_pk_add_f32 v[234:235], v[90:91], v[98:99]
    v_pk_add_f32 v[236:237], v[92:93], v[100:101]
    v_pk_add_f32 v[238:239], v[94:95], v[102:103]
L_e_fin_160:
    v_pk_mul_f32 v[240:241], v[224:225], v[224:225]
    v_pk_mul_f32 v[242:243], v[226:227], v[226:227]
    v_pk_mul_f32 v[244:245], v[228:229], v[228:229]
    v_pk_mul_f32 v[246:247], v[230:231], v[230:231]
    v_pk_mul_f32 v[248:249], v[232:233], v[232:233]
    v_pk_mul_f32 v[250:251], v[234:235], v[234:235]
    v_pk_mul_f32 v[252:253], v[236:237], v[236:237]
    v_pk_mul_f32 v[254:255], v[238:239], v[238:239]
    v_pk_fma_f32 v[240:241], v[240:241], v[104:105], v[106:107]
    v_pk_fma_f32 v[242:243], v[242:243], v[104:105], v[106:107]
    v_pk_fma_f32 v[244:245], v[244:245], v[104:105], v[106:107]
    v_pk_fma_f32 v[246:247], v[246:247], v[104:105], v[106:107]
    v_pk_fma_f32 v[248:249], v[248:249], v[104:105], v[106:107]
    v_pk_fma_f32 v[250:251], v[250:251], v[104:105], v[106:107]
    v_pk_fma_f32 v[252:253], v[252:253], v[104:105], v[106:107]
    v_pk_fma_f32 v[254:255], v[254:255], v[104:105], v[106:107]
    v_pk_mul_f32 v[240:241], v[240:241], v[224:225]
    v_pk_mul_f32 v[242:243], v[242:243], v[226:227]
    v_pk_mul_f32 v[244:245], v[244:245], v[228:229]
    v_pk_mul_f32 v[246:247], v[246:247], v[230:231]
    v_pk_mul_f32 v[248:249], v[248:249], v[232:233]
    v_pk_mul_f32 v[250:251], v[250:251], v[234:235]
    v_pk_mul_f32 v[252:253], v[252:253], v[236:237]
    v_pk_mul_f32 v[254:255], v[254:255], v[238:239]
    v_exp_f32 v240, v240
    v_exp_f32 v241, v241
    v_exp_f32 v242, v242
    v_exp_f32 v243, v243
    v_exp_f32 v244, v244
    v_exp_f32 v245, v245
    v_exp_f32 v246, v246
    v_exp_f32 v247, v247
    v_exp_f32 v248, v248
    v_exp_f32 v249, v249
    v_exp_f32 v250, v250
    v_exp_f32 v251, v251
    v_exp_f32 v252, v252
    v_exp_f32 v253, v253
    v_exp_f32 v254, v254
    v_exp_f32 v255, v255
    v_add_f32 v240, 1.0, v240
    v_add_f32 v241, 1.0, v241
    v_add_f32 v242, 1.0, v242
    v_add_f32 v243, 1.0, v243
    v_add_f32 v244, 1.0, v244
    v_add_f32 v245, 1.0, v245
    v_add_f32 v246, 1.0, v246
    v_add_f32 v247, 1.0, v247
    v_add_f32 v248, 1.0, v248
    v_add_f32 v249, 1.0, v249
    v_add_f32 v250, 1.0, v250
    v_add_f32 v251, 1.0, v251
    v_add_f32 v252, 1.0, v252
    v_add_f32 v253, 1.0, v253
    v_add_f32 v254, 1.0, v254
    v_add_f32 v255, 1.0, v255
    v_rcp_f32 v240, v240
    v_rcp_f32 v241, v241
    v_rcp_f32 v242, v242
    v_rcp_f32 v243, v243
    v_rcp_f32 v244, v244
    v_rcp_f32 v245, v245
    v_rcp_f32 v246, v246
    v_rcp_f32 v247, v247
    v_rcp_f32 v248, v248
    v_rcp_f32 v249, v249
    v_rcp_f32 v250, v250
    v_rcp_f32 v251, v251
    v_rcp_f32 v252, v252
    v_rcp_f32 v253, v253
    v_rcp_f32 v254, v254
    v_rcp_f32 v255, v255
    v_pk_mul_f32 v[224:225], v[224:225], v[240:241]
    v_pk_mul_f32 v[226:227], v[226:227], v[242:243]
    v_pk_mul_f32 v[228:229], v[228:229], v[244:245]
    v_pk_mul_f32 v[230:231], v[230:231], v[246:247]
    v_pk_mul_f32 v[232:233], v[232:233], v[248:249]
    v_pk_mul_f32 v[234:235], v[234:235], v[250:251]
    v_pk_mul_f32 v[236:237], v[236:237], v[252:253]
    v_pk_mul_f32 v[238:239], v[238:239], v[254:255]
    v_cvt_pk_bf16_f32 v240, v224, v225
    v_cvt_pk_bf16_f32 v241, v226, v227
    v_cvt_pk_bf16_f32 v242, v228, v229
    v_cvt_pk_bf16_f32 v243, v230, v231
    v_cvt_pk_bf16_f32 v244, v232, v233
    v_cvt_pk_bf16_f32 v245, v234, v235
    v_cvt_pk_bf16_f32 v246, v236, v237
    v_cvt_pk_bf16_f32 v247, v238, v239
    buffer_store_dwordx4 v[240:243], v10, s[12:15], s76 offen sc1
    buffer_store_dwordx4 v[244:247], v10, s[12:15], s76 offen offset:1024 sc1
    s_waitcnt lgkmcnt(0)
    s_waitcnt vmcnt(0)
    s_barrier
    s_cmp_lg_u32 s44, 0
    s_cbranch_scc1 L_pub_161
    v_mov_b32 v30, s62
    v_mov_b32 v31, 0
    s_mov_b64 exec, 1
    buffer_store_dword v30, v31, s[12:15], s67 offen sc1
    s_mov_b64 exec, -1
L_pub_161:
    s_branch L_b_loop_147
L_role_c_126:
    s_load_dwordx2 s[6:7], s[0:1], 80
    s_load_dwordx2 s[8:9], s[0:1], 88
    s_load_dwordx2 s[10:11], s[0:1], 112
    s_waitcnt lgkmcnt(0)
    s_mov_b32 s24, s6
    s_and_b32 s25, s7, 0xffff
    s_mov_b32 s26, 0x700000
    s_mov_b32 s27, 0x00020000
    s_mov_b32 s28, s8
    s_and_b32 s29, s9, 0xffff
    s_mov_b32 s30, 0x800
    s_mov_b32 s31, 0x00020000
    s_mov_b32 s32, s10
    s_and_b32 s33, s11, 0xffff
    s_mov_b32 s34, 0x400000
    s_mov_b32 s35, 0x00020000
    s_mul_i32 s46, s38, 1835008
    s_lshl_b32 s45, s68, 8
    s_add_u32 s46, s46, s45
    s_waitcnt vmcnt(0)
    s_barrier
    v_lshrrev_b32 v20, 4, v1
    s_lshl_b32 s45, s44, 2
    v_add_u32 v21, s45, v20
    s_mov_b32 s45, 2048
    v_mul_lo_u32 v21, v21, s45
    v_lshlrev_b32 v22, 2, v20
    v_and_b32 v23, 15, v1
    v_xor_b32 v22, v22, v23
    v_lshlrev_b32 v22, 4, v22
    v_add_u32 v21, v21, v22
    v_bfe_u32 v22, v1, 2, 2
    v_lshlrev_b32 v23, 3, v20
    v_add_u32 v23, v23, v22
    v_lshlrev_b32 v23, 8, v23
    v_xor_b32 v22, s44, v22
    v_lshlrev_b32 v22, 6, v22
    v_add_u32 v23, v23, v22
    v_and_b32 v22, 3, v1
    v_lshlrev_b32 v22, 3, v22
    v_add_u32 v23, v23, v22
    v_add_u32 v24, 65536, v23
    v_add_u32 v25, 131072, v23
    s_lshl_b32 s47, s44, 10
    s_add_u32 s45, s46, 0x0
    s_add_u32 m0, s47, 0
    s_nop 0
    buffer_load_dwordx4 v21, s[24:27], s45 offen  lds
    s_add_u32 s45, s46, 0x8000
    s_add_u32 m0, s47, 4096
    s_nop 0
    buffer_load_dwordx4 v21, s[24:27], s45 offen  lds
    s_add_u32 s45, s46, 0x10000
    s_add_u32 m0, s47, 8192
    s_nop 0
    buffer_load_dwordx4 v21, s[24:27], s45 offen  lds
    s_add_u32 s45, s46, 0x18000
    s_add_u32 m0, s47, 12288
    s_nop 0
    buffer_load_dwordx4 v21, s[24:27], s45 offen  lds
    s_add_u32 s45, s46, 0x20000
    s_add_u32 m0, s47, 16384
    s_nop 0
    buffer_load_dwordx4 v21, s[24:27], s45 offen  lds
    s_add_u32 s45, s46, 0x28000
    s_add_u32 m0, s47, 20480
    s_nop 0
    buffer_load_dwordx4 v21, s[24:27], s45 offen  lds
    s_add_u32 s45, s46, 0x30000
    s_add_u32 m0, s47, 24576
    s_nop 0
    buffer_load_dwordx4 v21, s[24:27], s45 offen  lds
    s_add_u32 s45, s46, 0x38000
    s_add_u32 m0, s47, 28672
    s_nop 0
    buffer_load_dwordx4 v21, s[24:27], s45 offen  lds
    s_add_u32 s45, s46, 0x40000
    s_add_u32 m0, s47, 32768
    s_nop 0
    buffer_load_dwordx4 v21, s[24:27], s45 offen  lds
    s_add_u32 s45, s46, 0x48000
    s_add_u32 m0, s47, 36864
    s_nop 0
    buffer_load_dwordx4 v21, s[24:27], s45 offen  lds
    s_add_u32 s45, s46, 0x50000
    s_add_u32 m0, s47, 40960
    s_nop 0
    buffer_load_dwordx4 v21, s[24:27], s45 offen  lds
    s_add_u32 s45, s46, 0x58000
    s_add_u32 m0, s47, 45056
    s_nop 0
    buffer_load_dwordx4 v21, s[24:27], s45 offen  lds
    s_add_u32 s45, s46, 0x60000
    s_add_u32 m0, s47, 49152
    s_nop 0
    buffer_load_dwordx4 v21, s[24:27], s45 offen  lds
    s_add_u32 s45, s46, 0x68000
    s_add_u32 m0, s47, 53248
    s_nop 0
    buffer_load_dwordx4 v21, s[24:27], s45 offen  lds
    s_add_u32 s45, s46, 0x70000
    s_add_u32 m0, s47, 57344
    s_nop 0
    buffer_load_dwordx4 v21, s[24:27], s45 offen  lds
    s_add_u32 s45, s46, 0x78000
    s_add_u32 m0, s47, 61440
    s_nop 0
    buffer_load_dwordx4 v21, s[24:27], s45 offen  lds
    s_add_u32 s45, s46, 0x80000
    s_add_u32 m0, s47, 65536
    s_nop 0
    buffer_load_dwordx4 v21, s[24:27], s45 offen  lds
    s_add_u32 s45, s46, 0x88000
    s_add_u32 m0, s47, 69632
    s_nop 0
    buffer_load_dwordx4 v21, s[24:27], s45 offen  lds
    s_add_u32 s45, s46, 0x90000
    s_add_u32 m0, s47, 73728
    s_nop 0
    buffer_load_dwordx4 v21, s[24:27], s45 offen  lds
    s_add_u32 s45, s46, 0x98000
    s_add_u32 m0, s47, 77824
    s_nop 0
    buffer_load_dwordx4 v21, s[24:27], s45 offen  lds
    s_add_u32 s45, s46, 0xa0000
    s_add_u32 m0, s47, 81920
    s_nop 0
    buffer_load_dwordx4 v21, s[24:27], s45 offen  lds
    s_add_u32 s45, s46, 0xa8000
    s_add_u32 m0, s47, 86016
    s_nop 0
    buffer_load_dwordx4 v21, s[24:27], s45 offen  lds
    s_add_u32 s45, s46, 0xb0000
    s_add_u32 m0, s47, 90112
    s_nop 0
    buffer_load_dwordx4 v21, s[24:27], s45 offen  lds
    s_add_u32 s45, s46, 0xb8000
    s_add_u32 m0, s47, 94208
    s_nop 0
    buffer_load_dwordx4 v21, s[24:27], s45 offen  lds
    s_add_u32 s45, s46, 0xc0000
    s_add_u32 m0, s47, 98304
    s_nop 0
    buffer_load_dwordx4 v21, s[24:27], s45 offen  lds
    s_add_u32 s45, s46, 0xc8000
    s_add_u32 m0, s47, 102400
    s_nop 0
    buffer_load_dwordx4 v21, s[24:27], s45 offen  lds
    s_add_u32 s45, s46, 0xd0000
    s_add_u32 m0, s47, 106496
    s_nop 0
    buffer_load_dwordx4 v21, s[24:27], s45 offen  lds
    s_add_u32 s45, s46, 0xd8000
    s_add_u32 m0, s47, 110592
    s_nop 0
    buffer_load_dwordx4 v21, s[24:27], s45 offen  lds
    s_add_u32 s45, s46, 0xe0000
    s_add_u32 m0, s47, 114688
    s_nop 0
    buffer_load_dwordx4 v21, s[24:27], s45 offen  lds
    s_add_u32 s45, s46, 0xe8000
    s_add_u32 m0, s47, 118784
    s_nop 0
    buffer_load_dwordx4 v21, s[24:27], s45 offen  lds
    s_add_u32 s45, s46, 0xf0000
    s_add_u32 m0, s47, 122880
    s_nop 0
    buffer_load_dwordx4 v21, s[24:27], s45 offen  lds
    s_add_u32 s45, s46, 0xf8000
    s_add_u32 m0, s47, 126976
    s_nop 0
    buffer_load_dwordx4 v21, s[24:27], s45 offen  lds
    s_waitcnt vmcnt(28)
    s_barrier
    s_add_u32 s45, s46, 0x100000
    s_add_u32 m0, s47, 131072
    s_nop 0
    buffer_load_dwordx4 v21, s[24:27], s45 offen  lds
    s_add_u32 s45, s46, 0x108000
    s_add_u32 m0, s47, 135168
    s_nop 0
    buffer_load_dwordx4 v21, s[24:27], s45 offen  lds
    s_add_u32 s45, s46, 0x110000
    s_add_u32 m0, s47, 139264
    s_nop 0
    buffer_load_dwordx4 v21, s[24:27], s45 offen  lds
    s_add_u32 s45, s46, 0x118000
    s_add_u32 m0, s47, 143360
    s_nop 0
    buffer_load_dwordx4 v21, s[24:27], s45 offen  lds
    ds_read_b64_tr_b16 a[0:1], v23 offset:0
    ds_read_b64_tr_b16 a[2:3], v23 offset:1024
    ds_read_b64_tr_b16 a[4:5], v23 offset:32
    ds_read_b64_tr_b16 a[6:7], v23 offset:1056
    ds_read_b64_tr_b16 a[8:9], v23 offset:8192
    ds_read_b64_tr_b16 a[10:11], v23 offset:9216
    ds_read_b64_tr_b16 a[12:13], v23 offset:8224
    ds_read_b64_tr_b16 a[14:15], v23 offset:9248
    s_waitcnt lgkmcnt(0)
    s_waitcnt vmcnt(28)
    s_barrier
    s_add_u32 s45, s46, 0x120000
    s_add_u32 m0, s47, 0
    s_nop 0
    buffer_load_dwordx4 v21, s[24:27], s45 offen  lds
    s_add_u32 s45, s46, 0x128000
    s_add_u32 m0, s47, 4096
    s_nop 0
    buffer_load_dwordx4 v21, s[24:27], s45 offen  lds
    s_add_u32 s45, s46, 0x130000
    s_add_u32 m0, s47, 8192
    s_nop 0
    buffer_load_dwordx4 v21, s[24:27], s45 offen  lds
    s_add_u32 s45, s46, 0x138000
    s_add_u32 m0, s47, 12288
    s_nop 0
    buffer_load_dwordx4 v21, s[24:27], s45 offen  lds
    ds_read_b64_tr_b16 a[16:17], v23 offset:16384
    ds_read_b64_tr_b16 a[18:19], v23 offset:17408
    ds_read_b64_tr_b16 a[20:21], v23 offset:16416
    ds_read_b64_tr_b16 a[22:23], v23 offset:17440
    ds_read_b64_tr_b16 a[24:25], v23 offset:24576
    ds_read_b64_tr_b16 a[26:27], v23 offset:25600
    ds_read_b64_tr_b16 a[28:29], v23 offset:24608
    ds_read_b64_tr_b16 a[30:31], v23 offset:25632
    s_waitcnt lgkmcnt(0)
    s_waitcnt vmcnt(28)
    s_barrier
    s_add_u32 s45, s46, 0x140000
    s_add_u32 m0, s47, 16384
    s_nop 0
    buffer_load_dwordx4 v21, s[24:27], s45 offen  lds
    s_add_u32 s45, s46, 0x148000
    s_add_u32 m0, s47, 20480
    s_nop 0
    buffer_load_dwordx4 v21, s[24:27], s45 offen  lds
    s_add_u32 s45, s46, 0x150000
    s_add_u32 m0, s47, 24576
    s_nop 0
    buffer_load_dwordx4 v21, s[24:27], s45 offen  lds
    s_add_u32 s45, s46, 0x158000
    s_add_u32 m0, s47, 28672
    s_nop 0
    buffer_load_dwordx4 v21, s[24:27], s45 offen  lds
    ds_read_b64_tr_b16 a[32:33], v23 offset:32768
    ds_read_b64_tr_b16 a[34:35], v23 offset:33792
    ds_read_b64_tr_b16 a[36:37], v23 offset:32800
    ds_read_b64_tr_b16 a[38:39], v23 offset:33824
    ds_read_b64_tr_b16 a[40:41], v23 offset:40960
    ds_read_b64_tr_b16 a[42:43], v23 offset:41984
    ds_read_b64_tr_b16 a[44:45], v23 offset:40992
    ds_read_b64_tr_b16 a[46:47], v23 offset:42016
    s_waitcnt lgkmcnt(0)
    s_waitcnt vmcnt(28)
    s_barrier
    s_add_u32 s45, s46, 0x160000
    s_add_u32 m0, s47, 32768
    s_nop 0
    buffer_load_dwordx4 v21, s[24:27], s45 offen  lds
    s_add_u32 s45, s46, 0x168000
    s_add_u32 m0, s47, 36864
    s_nop 0
    buffer_load_dwordx4 v21, s[24:27], s45 offen  lds
    s_add_u32 s45, s46, 0x170000
    s_add_u32 m0, s47, 40960
    s_nop 0
    buffer_load_dwordx4 v21, s[24:27], s45 offen  lds
    s_add_u32 s45, s46, 0x178000
    s_add_u32 m0, s47, 45056
    s_nop 0
    buffer_load_dwordx4 v21, s[24:27], s45 offen  lds
    ds_read_b64_tr_b16 a[48:49], v23 offset:49152
    ds_read_b64_tr_b16 a[50:51], v23 offset:50176
    ds_read_b64_tr_b16 a[52:53], v23 offset:49184
    ds_read_b64_tr_b16 a[54:55], v23 offset:50208
    ds_read_b64_tr_b16 a[56:57], v23 offset:57344
    ds_read_b64_tr_b16 a[58:59], v23 offset:58368
    ds_read_b64_tr_b16 a[60:61], v23 offset:57376
    ds_read_b64_tr_b16 a[62:63], v23 offset:58400
    s_waitcnt lgkmcnt(0)
    s_waitcnt vmcnt(28)
    s_barrier
    s_add_u32 s45, s46, 0x180000
    s_add_u32 m0, s47, 49152
    s_nop 0
    buffer_load_dwordx4 v21, s[24:27], s45 offen  lds
    s_add_u32 s45, s46, 0x188000
    s_add_u32 m0, s47, 53248
    s_nop 0
    buffer_load_dwordx4 v21, s[24:27], s45 offen  lds
    s_add_u32 s45, s46, 0x190000
    s_add_u32 m0, s47, 57344
    s_nop 0
    buffer_load_dwordx4 v21, s[24:27], s45 offen  lds
    s_add_u32 s45, s46, 0x198000
    s_add_u32 m0, s47, 61440
    s_nop 0
    buffer_load_dwordx4 v21, s[24:27], s45 offen  lds
    ds_read_b64_tr_b16 a[64:65], v24 offset:0
    ds_read_b64_tr_b16 a[66:67], v24 offset:1024
    ds_read_b64_tr_b16 a[68:69], v24 offset:32
    ds_read_b64_tr_b16 a[70:71], v24 offset:1056
    ds_read_b64_tr_b16 a[72:73], v24 offset:8192
    ds_read_b64_tr_b16 a[74:75], v24 offset:9216
    ds_read_b64_tr_b16 a[76:77], v24 offset:8224
    ds_read_b64_tr_b16 a[78:79], v24 offset:9248
    s_waitcnt lgkmcnt(0)
    s_waitcnt vmcnt(28)
    s_barrier
    s_add_u32 s45, s46, 0x1a0000
    s_add_u32 m0, s47, 65536
    s_nop 0
    buffer_load_dwordx4 v21, s[24:27], s45 offen  lds
    s_add_u32 s45, s46, 0x1a8000
    s_add_u32 m0, s47, 69632
    s_nop 0
    buffer_load_dwordx4 v21, s[24:27], s45 offen  lds
    s_add_u32 s45, s46, 0x1b0000
    s_add_u32 m0, s47, 73728
    s_nop 0
    buffer_load_dwordx4 v21, s[24:27], s45 offen  lds
    s_add_u32 s45, s46, 0x1b8000
    s_add_u32 m0, s47, 77824
    s_nop 0
    buffer_load_dwordx4 v21, s[24:27], s45 offen  lds
    ds_read_b64_tr_b16 a[80:81], v24 offset:16384
    ds_read_b64_tr_b16 a[82:83], v24 offset:17408
    ds_read_b64_tr_b16 a[84:85], v24 offset:16416
    ds_read_b64_tr_b16 a[86:87], v24 offset:17440
    ds_read_b64_tr_b16 a[88:89], v24 offset:24576
    ds_read_b64_tr_b16 a[90:91], v24 offset:25600
    ds_read_b64_tr_b16 a[92:93], v24 offset:24608
    ds_read_b64_tr_b16 a[94:95], v24 offset:25632
    s_waitcnt lgkmcnt(0)
    s_waitcnt vmcnt(28)
    s_barrier
    ds_read_b64_tr_b16 a[96:97], v24 offset:32768
    ds_read_b64_tr_b16 a[98:99], v24 offset:33792
    ds_read_b64_tr_b16 a[100:101], v24 offset:32800
    ds_read_b64_tr_b16 a[102:103], v24 offset:33824
    ds_read_b64_tr_b16 a[104:105], v24 offset:40960
    ds_read_b64_tr_b16 a[106:107], v24 offset:41984
    ds_read_b64_tr_b16 a[108:109], v24 offset:40992
    ds_read_b64_tr_b16 a[110:111], v24 offset:42016
    s_waitcnt lgkmcnt(0)
    s_waitcnt vmcnt(24)
    s_barrier
    ds_read_b64_tr_b16 a[112:113], v24 offset:49152
    ds_read_b64_tr_b16 a[114:115], v24 offset:50176
    ds_read_b64_tr_b16 a[116:117], v24 offset:49184
    ds_read_b64_tr_b16 a[118:119], v24 offset:50208
    ds_read_b64_tr_b16 a[120:121], v24 offset:57344
    ds_read_b64_tr_b16 a[122:123], v24 offset:58368
    ds_read_b64_tr_b16 a[124:125], v24 offset:57376
    ds_read_b64_tr_b16 a[126:127], v24 offset:58400
    s_waitcnt lgkmcnt(0)
    s_waitcnt vmcnt(20)
    s_barrier
    ds_read_b64_tr_b16 a[128:129], v25 offset:0
    ds_read_b64_tr_b16 a[130:131], v25 offset:1024
    ds_read_b64_tr_b16 a[132:133], v25 offset:32
    ds_read_b64_tr_b16 a[134:135], v25 offset:1056
    ds_read_b64_tr_b16 a[136:137], v25 offset:8192
    ds_read_b64_tr_b16 a[138:139], v25 offset:9216
    ds_read_b64_tr_b16 a[140:141], v25 offset:8224
    ds_read_b64_tr_b16 a[142:143], v25 offset:9248
    s_waitcnt lgkmcnt(0)
    s_waitcnt vmcnt(16)
    s_barrier
    ds_read_b64_tr_b16 a[144:145], v23 offset:0
    ds_read_b64_tr_b16 a[146:147], v23 offset:1024
    ds_read_b64_tr_b16 a[148:149], v23 offset:32
    ds_read_b64_tr_b16 a[150:151], v23 offset:1056
    ds_read_b64_tr_b16 a[152:153], v23 offset:8192
    ds_read_b64_tr_b16 a[154:155], v23 offset:9216
    ds_read_b64_tr_b16 a[156:157], v23 offset:8224
    ds_read_b64_tr_b16 a[158:159], v23 offset:9248
    s_waitcnt lgkmcnt(0)
    s_waitcnt vmcnt(12)
    s_barrier
    ds_read_b64_tr_b16 a[160:161], v23 offset:16384
    ds_read_b64_tr_b16 a[162:163], v23 offset:17408
    ds_read_b64_tr_b16 a[164:165], v23 offset:16416
    ds_read_b64_tr_b16 a[166:167], v23 offset:17440
    ds_read_b64_tr_b16 a[168:169], v23 offset:24576
    ds_read_b64_tr_b16 a[170:171], v23 offset:25600
    ds_read_b64_tr_b16 a[172:173], v23 offset:24608
    ds_read_b64_tr_b16 a[174:175], v23 offset:25632
    s_waitcnt lgkmcnt(0)
    s_waitcnt vmcnt(8)
    s_barrier
    ds_read_b64_tr_b16 a[176:177], v23 offset:32768
    ds_read_b64_tr_b16 a[178:179], v23 offset:33792
    ds_read_b64_tr_b16 a[180:181], v23 offset:32800
    ds_read_b64_tr_b16 a[182:183], v23 offset:33824
    ds_read_b64_tr_b16 a[184:185], v23 offset:40960
    ds_read_b64_tr_b16 a[186:187], v23 offset:41984
    ds_read_b64_tr_b16 a[188:189], v23 offset:40992
    ds_read_b64_tr_b16 a[190:191], v23 offset:42016
    s_waitcnt lgkmcnt(0)
    s_waitcnt vmcnt(4)
    s_barrier
    ds_read_b64_tr_b16 a[192:193], v23 offset:49152
    ds_read_b64_tr_b16 a[194:195], v23 offset:50176
    ds_read_b64_tr_b16 a[196:197], v23 offset:49184
    ds_read_b64_tr_b16 a[198:199], v23 offset:50208
    ds_read_b64_tr_b16 a[200:201], v23 offset:57344
    ds_read_b64_tr_b16 a[202:203], v23 offset:58368
    ds_read_b64_tr_b16 a[204:205], v23 offset:57376
    ds_read_b64_tr_b16 a[206:207], v23 offset:58400
    s_waitcnt lgkmcnt(0)
    s_waitcnt vmcnt(0)
    s_barrier
    ds_read_b64_tr_b16 a[208:209], v24 offset:0
    ds_read_b64_tr_b16 a[210:211], v24 offset:1024
    ds_read_b64_tr_b16 a[212:213], v24 offset:32
    ds_read_b64_tr_b16 a[214:215], v24 offset:1056
    ds_read_b64_tr_b16 a[216:217], v24 offset:8192
    ds_read_b64_tr_b16 a[218:219], v24 offset:9216
    ds_read_b64_tr_b16 a[220:221], v24 offset:8224
    ds_read_b64_tr_b16 a[222:223], v24 offset:9248
    s_waitcnt lgkmcnt(0)
    s_barrier
    buffer_load_dwordx4 v[80:83], v10, s[28:31], 0 offen
    buffer_load_dwordx4 v[84:87], v10, s[28:31], 0 offen offset:1024
    s_waitcnt vmcnt(0)
    v_lshlrev_b32 v96, 16, v80
    v_and_b32 v97, 0xffff0000, v80
    v_lshlrev_b32 v98, 16, v81
    v_and_b32 v99, 0xffff0000, v81
    v_lshlrev_b32 v100, 16, v82
    v_and_b32 v101, 0xffff0000, v82
    v_lshlrev_b32 v102, 16, v83
    v_and_b32 v103, 0xffff0000, v83
    v_lshlrev_b32 v104, 16, v84
    v_and_b32 v105, 0xffff0000, v84
    v_lshlrev_b32 v106, 16, v85
    v_and_b32 v107, 0xffff0000, v85
    v_lshlrev_b32 v108, 16, v86
    v_and_b32 v109, 0xffff0000, v86
    v_lshlrev_b32 v110, 16, v87
    v_and_b32 v111, 0xffff0000, v87
    s_cmp_lg_u32 s44, 0
    s_cbranch_scc1 L_pd_162
    v_mov_b32 v29, 127232
    s_mov_b32 s46, 96
    s_mov_b64 exec, 1
    s_mov_b32 s70, 0
L_wp_163:
    buffer_load_dword v31, v29, s[12:15], 0 offen sc1
    s_add_u32 s70, s70, 1
    s_cmp_ge_u32 s70, 0x200000
    s_cbranch_scc1 L_w_done_98
    s_waitcnt vmcnt(0)
    v_cmp_gt_u32 vcc, s46, v31
    s_nop 1
    s_cbranch_vccz L_wp_163_ok
    s_sleep 3
    s_branch L_wp_163
L_wp_163_ok:
    s_mov_b64 exec, -1
L_pd_162:
    s_barrier
    v_lshlrev_b32 v29, 5, v1
    s_mov_b32 s45, 20480
    buffer_load_dwordx4 v[112:115], v29, s[12:15], s45 offen offset:0 sc1
    buffer_load_dwordx4 v[116:119], v29, s[12:15], s45 offen offset:16 sc1
    buffer_load_dwordx4 v[120:123], v29, s[12:15], s45 offen offset:2048 sc1
    buffer_load_dwordx4 v[124:127], v29, s[12:15], s45 offen offset:2064 sc1
    s_mov_b32 s45, 45056
    buffer_load_dwordx4 v[32:35], v29, s[12:15], s45 offen offset:0 sc1
    buffer_load_dwordx4 v[36:39], v29, s[12:15], s45 offen offset:16 sc1
    buffer_load_dwordx4 v[40:43], v29, s[12:15], s45 offen offset:2048 sc1
    buffer_load_dwordx4 v[44:47], v29, s[12:15], s45 offen offset:2064 sc1
    s_waitcnt vmcnt(0)
    v_add_f32 v112, v112, v32
    v_cvt_pk_bf16_f32 v112, v112, v112
    v_lshlrev_b32 v112, 16, v112
    v_add_f32 v113, v113, v33
    v_cvt_pk_bf16_f32 v113, v113, v113
    v_lshlrev_b32 v113, 16, v113
    v_add_f32 v114, v114, v34
    v_cvt_pk_bf16_f32 v114, v114, v114
    v_lshlrev_b32 v114, 16, v114
    v_add_f32 v115, v115, v35
    v_cvt_pk_bf16_f32 v115, v115, v115
    v_lshlrev_b32 v115, 16, v115
    v_add_f32 v116, v116, v36
    v_cvt_pk_bf16_f32 v116, v116, v116
    v_lshlrev_b32 v116, 16, v116
    v_add_f32 v117, v117, v37
    v_cvt_pk_bf16_f32 v117, v117, v117
    v_lshlrev_b32 v117, 16, v117
    v_add_f32 v118, v118, v38
    v_cvt_pk_bf16_f32 v118, v118, v118
    v_lshlrev_b32 v118, 16, v118
    v_add_f32 v119, v119, v39
    v_cvt_pk_bf16_f32 v119, v119, v119
    v_lshlrev_b32 v119, 16, v119
    v_add_f32 v120, v120, v40
    v_cvt_pk_bf16_f32 v120, v120, v120
    v_lshlrev_b32 v120, 16, v120
    v_add_f32 v121, v121, v41
    v_cvt_pk_bf16_f32 v121, v121, v121
    v_lshlrev_b32 v121, 16, v121
    v_add_f32 v122, v122, v42
    v_cvt_pk_bf16_f32 v122, v122, v122
    v_lshlrev_b32 v122, 16, v122
    v_add_f32 v123, v123, v43
    v_cvt_pk_bf16_f32 v123, v123, v123
    v_lshlrev_b32 v123, 16, v123
    v_add_f32 v124, v124, v44
    v_cvt_pk_bf16_f32 v124, v124, v124
    v_lshlrev_b32 v124, 16, v124
    v_add_f32 v125, v125, v45
    v_cvt_pk_bf16_f32 v125, v125, v125
    v_lshlrev_b32 v125, 16, v125
    v_add_f32 v126, v126, v46
    v_cvt_pk_bf16_f32 v126, v126, v126
    v_lshlrev_b32 v126, 16, v126
    v_add_f32 v127, v127, v47
    v_cvt_pk_bf16_f32 v127, v127, v127
    v_lshlrev_b32 v127, 16, v127
    s_lshl_b32 s46, s44, 10
    s_add_u32 s45, s46, 20480
    buffer_load_dwordx4 v[22:25], v10, s[12:15], s45 offen sc1
    s_add_u32 s45, s46, 45056
    buffer_load_dwordx4 v[32:35], v10, s[12:15], s45 offen sc1
    s_waitcnt vmcnt(0)
    v_add_f32 v22, v22, v32
    v_cvt_pk_bf16_f32 v22, v22, v22
    v_lshlrev_b32 v22, 16, v22
    v_add_f32 v23, v23, v33
    v_cvt_pk_bf16_f32 v23, v23, v23
    v_lshlrev_b32 v23, 16, v23
    v_add_f32 v24, v24, v34
    v_cvt_pk_bf16_f32 v24, v24, v24
    v_lshlrev_b32 v24, 16, v24
    v_add_f32 v25, v25, v35
    v_cvt_pk_bf16_f32 v25, v25, v25
    v_lshlrev_b32 v25, 16, v25
    v_lshlrev_b32 v17, 3, v1
    s_lshl_b32 s45, s44, 9
    buffer_load_dwordx2 v[80:81], v17, s[28:31], s45 offen
    s_waitcnt vmcnt(0)
    v_lshlrev_b32 v18, 16, v80
    v_and_b32 v19, 0xffff0000, v80
    v_lshlrev_b32 v20, 16, v81
    v_and_b32 v21, 0xffff0000, v81
    s_mul_i32 s52, s38, 57344
    s_add_u32 s52, s52, 0x6000000
    s_lshl_b32 s56, s38, 23
    s_lshl_b32 s45, s68, 9
    s_add_u32 s56, s56, s45
    s_add_u32 s56, s56, 0xc000000
    s_lshl_b32 s45, s40, 7
    s_add_u32 s45, s45, 127488
    v_mov_b32 v29, s45
    s_mov_b32 s46, 536870912
    s_mov_b64 exec, 1
    s_mov_b32 s70, 0
L_wp_166:
    buffer_load_dword v31, v29, s[12:15], 0 offen sc1
    s_add_u32 s70, s70, 1
    s_cmp_ge_u32 s70, 0x200000
    s_cbranch_scc1 L_w_done_98
    s_waitcnt vmcnt(0)
    v_cmp_gt_u32 vcc, s46, v31
    s_nop 1
    s_cbranch_vccz L_wp_166_ok
    s_sleep 2
    s_branch L_wp_166
L_wp_166_ok:
    s_mov_b64 exec, -1
    v_readfirstlane_b32 s45, v31
    s_nop 3
    s_and_b32 s46, s45, 511
    s_mul_i32 s46, s46, s46
    s_bfe_u32 s45, s45, 0xf0009
    s_lshl_b32 s45, s45, 5
    s_mov_b32 s80, s12
    s_mov_b32 s81, s13
    s_mov_b32 s83, 0x00020000
    s_mov_b32 s84, s12
    s_mov_b32 s85, s13
    s_mov_b32 s87, 0x00020000
    s_cmp_eq_u32 s45, s46
    s_cselect_b32 s82, s14, 0
    s_cselect_b32 s86, 0, s14
L_c_loop_164:
    s_cmp_eq_u64 s[36:37], 0
    s_cbranch_scc1 L_w_done_98
    s_ff1_i32_b64 s50, s[36:37]
    s_bitset0_b64 s[36:37], s50
    s_lshr_b64 s[74:75], s[72:73], s50
    s_ff1_i32_b64 s51, s[74:75]
    s_add_u32 s51, s51, 1
    s_add_u32 s62, s50, s51
    s_mul_i32 s45, s38, 896
    s_add_u32 s45, s45, s64
    s_add_u32 s45, s45, 12288
    s_cmp_lg_u32 s44, 0
    s_cbranch_scc1 L_pw_167
    s_mov_b64 exec, 127
    s_mov_b32 s70, 0
L_wp_168:
    buffer_load_dword v31, v5, s[12:15], s45 offen sc1
    s_add_u32 s70, s70, 1
    s_cmp_ge_u32 s70, 0x200000
    s_cbranch_scc1 L_w_done_98
    s_waitcnt vmcnt(0)
    v_cmp_gt_u32 vcc, s62, v31
    s_nop 1
    s_cbranch_vccz L_wp_168_ok
    s_sleep 2
    s_branch L_wp_168
L_wp_168_ok:
    s_mov_b64 exec, -1
L_pw_167:
    s_barrier
    s_mul_i32 s53, s50, 229376
    s_add_u32 s53, s53, s52
    s_lshl_b32 s54, s44, 13
    s_add_u32 s53, s53, s54
    s_mul_i32 s57, s50, 131072
    s_add_u32 s57, s57, s56
    s_lshl_b32 s45, s44, 7
    s_add_u32 s57, s57, s45
    s_add_u32 s55, s54, 65536
    s_mov_b32 s58, 0
    v_mov_b32 v13, v10
    v_add_u32 v14, 65536, v13
    v_xor_b32 v15, 64, v13
    v_xor_b32 v16, 64, v14
    s_mov_b32 s76, 0x20000000
    s_add_u32 s48, s53, 0
    s_add_u32 s49, s48, 4096
    s_add_u32 m0, s54, 0
    s_nop 0
    buffer_load_dwordx4 v10, s[12:15], s48 offen offset:0 sc1 lds
    buffer_load_dwordx4 v10, s[12:15], s48 offen offset:1024 sc1 lds
    buffer_load_dwordx4 v10, s[12:15], s48 offen offset:2048 sc1 lds
    buffer_load_dwordx4 v10, s[12:15], s48 offen offset:3072 sc1 lds
    s_add_u32 m0, s54, 4096
    s_nop 0
    buffer_load_dwordx4 v10, s[12:15], s49 offen offset:0 sc1 lds
    buffer_load_dwordx4 v10, s[12:15], s49 offen offset:1024 sc1 lds
    buffer_load_dwordx4 v10, s[12:15], s49 offen offset:2048 sc1 lds
    buffer_load_dwordx4 v10, s[12:15], s49 offen offset:3072 sc1 lds
    s_add_u32 s48, s53, 32768
    s_cmp_lt_u32 s44, 3
    s_cselect_b32 s48, s48, 0x20000000
    s_add_u32 s49, s48, 4096
    s_add_u32 s46, s54, 32768
    s_add_u32 m0, s46, 0
    s_nop 0
    buffer_load_dwordx4 v10, s[12:15], s48 offen offset:0 sc1 lds
    buffer_load_dwordx4 v10, s[12:15], s48 offen offset:1024 sc1 lds
    buffer_load_dwordx4 v10, s[12:15], s48 offen offset:2048 sc1 lds
    buffer_load_dwordx4 v10, s[12:15], s48 offen offset:3072 sc1 lds
    s_add_u32 m0, s46, 4096
    s_nop 0
    buffer_load_dwordx4 v10, s[12:15], s49 offen offset:0 sc1 lds
    buffer_load_dwordx4 v10, s[12:15], s49 offen offset:1024 sc1 lds
    buffer_load_dwordx4 v10, s[12:15], s49 offen offset:2048 sc1 lds
    buffer_load_dwordx4 v10, s[12:15], s49 offen offset:3072 sc1 lds
    s_cmp_eq_u32 s51, 1
    s_cbranch_scc1 L_e_one_170
    s_add_u32 s48, s53, 229376
    s_add_u32 s49, s48, 4096
    s_add_u32 m0, s55, 0
    s_nop 0
    buffer_load_dwordx4 v10, s[12:15], s48 offen offset:0 sc1 lds
    buffer_load_dwordx4 v10, s[12:15], s48 offen offset:1024 sc1 lds
    buffer_load_dwordx4 v10, s[12:15], s48 offen offset:2048 sc1 lds
    buffer_load_dwordx4 v10, s[12:15], s48 offen offset:3072 sc1 lds
    s_add_u32 m0, s55, 4096
    s_nop 0
    buffer_load_dwordx4 v10, s[12:15], s49 offen offset:0 sc1 lds
    buffer_load_dwordx4 v10, s[12:15], s49 offen offset:1024 sc1 lds
    buffer_load_dwordx4 v10, s[12:15], s49 offen offset:2048 sc1 lds
    buffer_load_dwordx4 v10, s[12:15], s49 offen offset:3072 sc1 lds
    s_waitcnt vmcnt(16)
    s_barrier
    ds_read_b128 v[32:35], v13 offset:0
    ds_read_b128 v[36:39], v13 offset:1024
    ds_read_b128 v[40:43], v13 offset:2048
    ds_read_b128 v[44:47], v13 offset:3072
L_e_loop_169:
    s_add_u32 s48, s53, 262144
    s_add_u32 s46, s58, 1
    s_cmp_lt_u32 s46, s51
    s_cselect_b32 s48, s48, 0x20000000
    s_cmp_lt_u32 s44, 3
    s_cselect_b32 s48, s48, 0x20000000
    s_add_u32 s49, s48, 4096
    s_add_u32 s59, s55, 32768
    s_waitcnt lgkmcnt(2)
    v_mfma_f32_16x16x32_bf16 v[80:83], a[0:3], v[32:35], 0
    ds_read_b128 v[48:51], v13 offset:4096
    ds_read_b128 v[52:55], v13 offset:5120
    v_mfma_f32_16x16x32_bf16 v[84:87], a[4:7], v[32:35], 0
    ds_read_b128 v[56:59], v13 offset:6144
    ds_read_b128 v[60:63], v13 offset:7168
    s_add_u32 m0, s59, 0
    v_mfma_f32_16x16x32_bf16 v[88:91], a[0:3], v[36:39], 0
    buffer_load_dwordx4 v10, s[12:15], s48 offen offset:0 sc1 lds
    v_mfma_f32_16x16x32_bf16 v[92:95], a[4:7], v[36:39], 0
    s_waitcnt lgkmcnt(4)
    v_mfma_f32_16x16x32_bf16 v[80:83], a[8:11], v[40:43], v[80:83]
    ds_read_b128 v[32:35], v13 offset:8192
    ds_read_b128 v[36:39], v13 offset:9216
    v_mfma_f32_16x16x32_bf16 v[84:87], a[12:15], v[40:43], v[84:87]
    v_mfma_f32_16x16x32_bf16 v[88:91], a[8:11], v[44:47], v[88:91]
    buffer_load_dwordx4 v10, s[12:15], s48 offen offset:1024 sc1 lds
    v_mfma_f32_16x16x32_bf16 v[92:95], a[12:15], v[44:47], v[92:95]
    s_waitcnt lgkmcnt(4)
    v_mfma_f32_16x16x32_bf16 v[80:83], a[16:19], v[48:51], v[80:83]
    ds_read_b128 v[40:43], v13 offset:10240
    ds_read_b128 v[44:47], v13 offset:11264
    v_mfma_f32_16x16x32_bf16 v[84:87], a[20:23], v[48:51], v[84:87]
    v_mfma_f32_16x16x32_bf16 v[88:91], a[16:19], v[52:55], v[88:91]
    buffer_load_dwordx4 v10, s[12:15], s48 offen offset:2048 sc1 lds
    v_mfma_f32_16x16x32_bf16 v[92:95], a[20:23], v[52:55], v[92:95]
    s_waitcnt lgkmcnt(4)
    v_mfma_f32_16x16x32_bf16 v[80:83], a[24:27], v[56:59], v[80:83]
    ds_read_b128 v[48:51], v13 offset:12288
    ds_read_b128 v[52:55], v13 offset:13312
    v_mfma_f32_16x16x32_bf16 v[84:87], a[28:31], v[56:59], v[84:87]
    v_mfma_f32_16x16x32_bf16 v[88:91], a[24:27], v[60:63], v[88:91]
    buffer_load_dwordx4 v10, s[12:15], s48 offen offset:3072 sc1 lds
    v_mfma_f32_16x16x32_bf16 v[92:95], a[28:31], v[60:63], v[92:95]
    s_waitcnt lgkmcnt(4)
    v_mfma_f32_16x16x32_bf16 v[80:83], a[32:35], v[32:35], v[80:83]
    ds_read_b128 v[56:59], v13 offset:14336
    ds_read_b128 v[60:63], v13 offset:15360
    v_mfma_f32_16x16x32_bf16 v[84:87], a[36:39], v[32:35], v[84:87]
    s_add_u32 m0, s59, 4096
    v_mfma_f32_16x16x32_bf16 v[88:91], a[32:35], v[36:39], v[88:91]
    buffer_load_dwordx4 v10, s[12:15], s49 offen offset:0 sc1 lds
    v_mfma_f32_16x16x32_bf16 v[92:95], a[36:39], v[36:39], v[92:95]
    s_waitcnt lgkmcnt(4)
    v_mfma_f32_16x16x32_bf16 v[80:83], a[40:43], v[40:43], v[80:83]
    ds_read_b128 v[32:35], v13 offset:16384
    ds_read_b128 v[36:39], v13 offset:17408
    v_mfma_f32_16x16x32_bf16 v[84:87], a[44:47], v[40:43], v[84:87]
    v_mfma_f32_16x16x32_bf16 v[88:91], a[40:43], v[44:47], v[88:91]
    buffer_load_dwordx4 v10, s[12:15], s49 offen offset:1024 sc1 lds
    v_mfma_f32_16x16x32_bf16 v[92:95], a[44:47], v[44:47], v[92:95]
    s_waitcnt lgkmcnt(4)
    v_mfma_f32_16x16x32_bf16 v[80:83], a[48:51], v[48:51], v[80:83]
    ds_read_b128 v[40:43], v13 offset:18432
    ds_read_b128 v[44:47], v13 offset:19456
    v_mfma_f32_16x16x32_bf16 v[84:87], a[52:55], v[48:51], v[84:87]
    v_mfma_f32_16x16x32_bf16 v[88:91], a[48:51], v[52:55], v[88:91]
    buffer_load_dwordx4 v10, s[12:15], s49 offen offset:2048 sc1 lds
    v_mfma_f32_16x16x32_bf16 v[92:95], a[52:55], v[52:55], v[92:95]
    s_waitcnt lgkmcnt(4)
    v_mfma_f32_16x16x32_bf16 v[80:83], a[56:59], v[56:59], v[80:83]
    ds_read_b128 v[48:51], v13 offset:20480
    ds_read_b128 v[52:55], v13 offset:21504
    v_mfma_f32_16x16x32_bf16 v[84:87], a[60:63], v[56:59], v[84:87]
    v_mfma_f32_16x16x32_bf16 v[88:91], a[56:59], v[60:63], v[88:91]
    buffer_load_dwordx4 v10, s[12:15], s49 offen offset:3072 sc1 lds
    v_mfma_f32_16x16x32_bf16 v[92:95], a[60:63], v[60:63], v[92:95]
    s_waitcnt lgkmcnt(4)
    v_mfma_f32_16x16x32_bf16 v[80:83], a[64:67], v[32:35], v[80:83]
    ds_read_b128 v[56:59], v13 offset:22528
    ds_read_b128 v[60:63], v13 offset:23552
    v_mfma_f32_16x16x32_bf16 v[84:87], a[68:71], v[32:35], v[84:87]
    v_mfma_f32_16x16x32_bf16 v[88:91], a[64:67], v[36:39], v[88:91]
    v_mfma_f32_16x16x32_bf16 v[92:95], a[68:71], v[36:39], v[92:95]
    s_waitcnt lgkmcnt(4)
    v_mfma_f32_16x16x32_bf16 v[80:83], a[72:75], v[40:43], v[80:83]
    ds_read_b128 v[32:35], v13 offset:24576
    ds_read_b128 v[36:39], v13 offset:25600
    v_mfma_f32_16x16x32_bf16 v[84:87], a[76:79], v[40:43], v[84:87]
    v_mfma_f32_16x16x32_bf16 v[88:91], a[72:75], v[44:47], v[88:91]
    v_mfma_f32_16x16x32_bf16 v[92:95], a[76:79], v[44:47], v[92:95]
    s_waitcnt lgkmcnt(4)
    v_mfma_f32_16x16x32_bf16 v[80:83], a[80:83], v[48:51], v[80:83]
    ds_read_b128 v[40:43], v13 offset:26624
    ds_read_b128 v[44:47], v13 offset:27648
    v_mfma_f32_16x16x32_bf16 v[84:87], a[84:87], v[48:51], v[84:87]
    v_mfma_f32_16x16x32_bf16 v[88:91], a[80:83], v[52:55], v[88:91]
    v_mfma_f32_16x16x32_bf16 v[92:95], a[84:87], v[52:55], v[92:95]
    s_waitcnt lgkmcnt(4)
    v_mfma_f32_16x16x32_bf16 v[80:83], a[88:91], v[56:59], v[80:83]
    ds_read_b128 v[48:51], v13 offset:28672
    ds_read_b128 v[52:55], v13 offset:29696
    v_mfma_f32_16x16x32_bf16 v[84:87], a[92:95], v[56:59], v[84:87]
    v_mfma_f32_16x16x32_bf16 v[88:91], a[88:91], v[60:63], v[88:91]
    v_mfma_f32_16x16x32_bf16 v[92:95], a[92:95], v[60:63], v[92:95]
    s_waitcnt lgkmcnt(4)
    v_mfma_f32_16x16x32_bf16 v[80:83], a[96:99], v[32:35], v[80:83]
    ds_read_b128 v[56:59], v13 offset:30720
    ds_read_b128 v[60:63], v13 offset:31744
    v_mfma_f32_16x16x32_bf16 v[84:87], a[100:103], v[32:35], v[84:87]
    v_mfma_f32_16x16x32_bf16 v[88:91], a[96:99], v[36:39], v[88:91]
    v_mfma_f32_16x16x32_bf16 v[92:95], a[100:103], v[36:39], v[92:95]
    s_waitcnt lgkmcnt(4)
    v_mfma_f32_16x16x32_bf16 v[80:83], a[104:107], v[40:43], v[80:83]
    ds_read_b128 v[216:219], v8 offset:0
    ds_read_b128 v[220:223], v8 offset:1152
    v_mfma_f32_16x16x32_bf16 v[84:87], a[108:111], v[40:43], v[84:87]
    ds_read_b128 v[224:227], v8 offset:2304
    ds_read_b128 v[228:231], v8 offset:3456
    v_mfma_f32_16x16x32_bf16 v[88:91], a[104:107], v[44:47], v[88:91]
    v_mfma_f32_16x16x32_bf16 v[92:95], a[108:111], v[44:47], v[92:95]
    s_waitcnt vmcnt(16) lgkmcnt(0)
    s_barrier
    v_mfma_f32_16x16x32_bf16 v[80:83], a[112:115], v[48:51], v[80:83]
    ds_read_b128 v[32:35], v13 offset:32768
    ds_read_b128 v[36:39], v13 offset:33792
    v_mfma_f32_16x16x32_bf16 v[84:87], a[116:119], v[48:51], v[84:87]
    buffer_store_dwordx4 v[216:219], v11, s[12:15], s76 offen sc1
    s_add_u32 s76, s76, 32768
    v_mfma_f32_16x16x32_bf16 v[88:91], a[112:115], v[52:55], v[88:91]
    buffer_store_dwordx4 v[220:223], v11, s[12:15], s76 offen sc1
    s_add_u32 s76, s76, 32768
    v_mfma_f32_16x16x32_bf16 v[92:95], a[116:119], v[52:55], v[92:95]
    buffer_store_dwordx4 v[224:227], v11, s[12:15], s76 offen sc1
    s_add_u32 s76, s76, 32768
    v_mfma_f32_16x16x32_bf16 v[80:83], a[120:123], v[56:59], v[80:83]
    ds_read_b128 v[40:43], v13 offset:34816
    ds_read_b128 v[44:47], v13 offset:35840
    v_mfma_f32_16x16x32_bf16 v[84:87], a[124:127], v[56:59], v[84:87]
    buffer_store_dwordx4 v[228:231], v11, s[12:15], s76 offen sc1
    v_mfma_f32_16x16x32_bf16 v[88:91], a[120:123], v[60:63], v[88:91]
    v_mfma_f32_16x16x32_bf16 v[92:95], a[124:127], v[60:63], v[92:95]
    s_add_u32 s48, s53, 458752
    s_add_u32 s46, s58, 2
    s_cmp_lt_u32 s46, s51
    s_cselect_b32 s48, s48, 0x20000000
    s_add_u32 s49, s48, 4096
    s_mov_b32 s59, s54
    s_waitcnt lgkmcnt(2)
    v_mfma_f32_16x16x32_bf16 v[80:83], a[128:131], v[32:35], v[80:83]
    ds_read_b128 v[48:51], v13 offset:36864
    ds_read_b128 v[52:55], v13 offset:37888
    v_mfma_f32_16x16x32_bf16 v[84:87], a[132:135], v[32:35], v[84:87]
    ds_read_b128 v[56:59], v13 offset:38912
    ds_read_b128 v[60:63], v13 offset:39936
    s_add_u32 m0, s59, 0
    v_mfma_f32_16x16x32_bf16 v[88:91], a[128:131], v[36:39], v[88:91]
    buffer_load_dwordx4 v10, s[12:15], s48 offen offset:0 sc1 lds
    v_mfma_f32_16x16x32_bf16 v[92:95], a[132:135], v[36:39], v[92:95]
    s_waitcnt lgkmcnt(4)
    v_mfma_f32_16x16x32_bf16 v[80:83], a[136:139], v[40:43], v[80:83]
    ds_read_b128 v[32:35], v13 offset:40960
    ds_read_b128 v[36:39], v13 offset:41984
    v_mfma_f32_16x16x32_bf16 v[84:87], a[140:143], v[40:43], v[84:87]
    v_mfma_f32_16x16x32_bf16 v[88:91], a[136:139], v[44:47], v[88:91]
    buffer_load_dwordx4 v10, s[12:15], s48 offen offset:1024 sc1 lds
    v_mfma_f32_16x16x32_bf16 v[92:95], a[140:143], v[44:47], v[92:95]
    s_waitcnt lgkmcnt(4)
    v_mfma_f32_16x16x32_bf16 v[80:83], a[144:147], v[48:51], v[80:83]
    ds_read_b128 v[40:43], v13 offset:43008
    ds_read_b128 v[44:47], v13 offset:44032
    v_mfma_f32_16x16x32_bf16 v[84:87], a[148:151], v[48:51], v[84:87]
    v_mfma_f32_16x16x32_bf16 v[88:91], a[144:147], v[52:55], v[88:91]
    buffer_load_dwordx4 v10, s[12:15], s48 offen offset:2048 sc1 lds
    v_mfma_f32_16x16x32_bf16 v[92:95], a[148:151], v[52:55], v[92:95]
    s_waitcnt lgkmcnt(4)
    v_mfma_f32_16x16x32_bf16 v[80:83], a[152:155], v[56:59], v[80:83]
    ds_read_b128 v[48:51], v13 offset:45056
    ds_read_b128 v[52:55], v13 offset:46080
    v_mfma_f32_16x16x32_bf16 v[84:87], a[156:159], v[56:59], v[84:87]
    v_mfma_f32_16x16x32_bf16 v[88:91], a[152:155], v[60:63], v[88:91]
    buffer_load_dwordx4 v10, s[12:15], s48 offen offset:3072 sc1 lds
    v_mfma_f32_16x16x32_bf16 v[92:95], a[156:159], v[60:63], v[92:95]
    s_waitcnt lgkmcnt(4)
    v_mfma_f32_16x16x32_bf16 v[80:83], a[160:163], v[32:35], v[80:83]
    ds_read_b128 v[56:59], v13 offset:47104
    ds_read_b128 v[60:63], v13 offset:48128
    v_mfma_f32_16x16x32_bf16 v[84:87], a[164:167], v[32:35], v[84:87]
    s_add_u32 m0, s59, 4096
    v_mfma_f32_16x16x32_bf16 v[88:91], a[160:163], v[36:39], v[88:91]
    buffer_load_dwordx4 v10, s[12:15], s49 offen offset:0 sc1 lds
    v_mfma_f32_16x16x32_bf16 v[92:95], a[164:167], v[36:39], v[92:95]
    s_waitcnt lgkmcnt(4)
    v_mfma_f32_16x16x32_bf16 v[80:83], a[168:171], v[40:43], v[80:83]
    ds_read_b128 v[32:35], v13 offset:49152
    ds_read_b128 v[36:39], v13 offset:50176
    v_mfma_f32_16x16x32_bf16 v[84:87], a[172:175], v[40:43], v[84:87]
    v_mfma_f32_16x16x32_bf16 v[88:91], a[168:171], v[44:47], v[88:91]
    buffer_load_dwordx4 v10, s[12:15], s49 offen offset:1024 sc1 lds
    v_mfma_f32_16x16x32_bf16 v[92:95], a[172:175], v[44:47], v[92:95]
    s_waitcnt lgkmcnt(4)
    v_mfma_f32_16x16x32_bf16 v[80:83], a[176:179], v[48:51], v[80:83]
    ds_read_b128 v[40:43], v13 offset:51200
    ds_read_b128 v[44:47], v13 offset:52224
    v_mfma_f32_16x16x32_bf16 v[84:87], a[180:183], v[48:51], v[84:87]
    v_mfma_f32_16x16x32_bf16 v[88:91], a[176:179], v[52:55], v[88:91]
    buffer_load_dwordx4 v10, s[12:15], s49 offen offset:2048 sc1 lds
    v_mfma_f32_16x16x32_bf16 v[92:95], a[180:183], v[52:55], v[92:95]
    s_waitcnt lgkmcnt(4)
    v_mfma_f32_16x16x32_bf16 v[80:83], a[184:187], v[56:59], v[80:83]
    ds_read_b128 v[48:51], v13 offset:53248
    ds_read_b128 v[52:55], v13 offset:54272
    v_mfma_f32_16x16x32_bf16 v[84:87], a[188:191], v[56:59], v[84:87]
    v_mfma_f32_16x16x32_bf16 v[88:91], a[184:187], v[60:63], v[88:91]
    buffer_load_dwordx4 v10, s[12:15], s49 offen offset:3072 sc1 lds
    v_mfma_f32_16x16x32_bf16 v[92:95], a[188:191], v[60:63], v[92:95]
    s_waitcnt lgkmcnt(4)
    v_mfma_f32_16x16x32_bf16 v[80:83], a[192:195], v[32:35], v[80:83]
    ds_read_b128 v[56:59], v13 offset:55296
    ds_read_b128 v[60:63], v13 offset:56320
    v_mfma_f32_16x16x32_bf16 v[84:87], a[196:199], v[32:35], v[84:87]
    v_mfma_f32_16x16x32_bf16 v[88:91], a[192:195], v[36:39], v[88:91]
    v_mfma_f32_16x16x32_bf16 v[92:95], a[196:199], v[36:39], v[92:95]
    s_waitcnt lgkmcnt(4)
    v_mfma_f32_16x16x32_bf16 v[80:83], a[200:203], v[40:43], v[80:83]
    v_mfma_f32_16x16x32_bf16 v[84:87], a[204:207], v[40:43], v[84:87]
    v_mfma_f32_16x16x32_bf16 v[88:91], a[200:203], v[44:47], v[88:91]
    v_mfma_f32_16x16x32_bf16 v[92:95], a[204:207], v[44:47], v[92:95]
    s_waitcnt vmcnt(16) lgkmcnt(0)
    s_barrier
    v_mfma_f32_16x16x32_bf16 v[80:83], a[208:211], v[48:51], v[80:83]
    ds_read_b128 v[32:35], v14 offset:0
    ds_read_b128 v[36:39], v14 offset:1024
    v_mfma_f32_16x16x32_bf16 v[84:87], a[212:215], v[48:51], v[84:87]
    v_mfma_f32_16x16x32_bf16 v[88:91], a[208:211], v[52:55], v[88:91]
    v_mfma_f32_16x16x32_bf16 v[92:95], a[212:215], v[52:55], v[92:95]
    v_mfma_f32_16x16x32_bf16 v[80:83], a[216:219], v[56:59], v[80:83]
    ds_read_b128 v[40:43], v14 offset:2048
    ds_read_b128 v[44:47], v14 offset:3072
    v_mfma_f32_16x16x32_bf16 v[84:87], a[220:223], v[56:59], v[84:87]
    v_mfma_f32_16x16x32_bf16 v[88:91], a[216:219], v[60:63], v[88:91]
    v_mfma_f32_16x16x32_bf16 v[92:95], a[220:223], v[60:63], v[92:95]
    s_add_u32 s53, s53, 229376
    s_add_u32 s58, s58, 1
    v_swap_b32 v13, v14
    s_xor_b32 s54, s54, 65536
    s_xor_b32 s55, s55, 65536
    s_mov_b32 s76, s57
    v_swap_b32 v15, v16
    s_add_u32 s57, s57, 131072
    ds_write_b128 v7, v[80:83] offset:0
    ds_write_b128 v7, v[84:87] offset:64
    ds_write_b128 v7, v[88:91] offset:2304
    ds_write_b128 v7, v[92:95] offset:2368
    s_cmp_lt_u32 s58, s51
    s_cbranch_scc1 L_e_loop_169
    s_branch L_e_fin_171
L_e_one_170:
    s_waitcnt vmcnt(8)
    s_barrier
    ds_read_b128 v[32:35], v13 offset:0
    ds_read_b128 v[36:39], v13 offset:1024
    ds_read_b128 v[40:43], v13 offset:2048
    ds_read_b128 v[44:47], v13 offset:3072
    s_waitcnt lgkmcnt(2)
    v_mfma_f32_16x16x32_bf16 v[80:83], a[0:3], v[32:35], 0
    ds_read_b128 v[48:51], v13 offset:4096
    ds_read_b128 v[52:55], v13 offset:5120
    v_mfma_f32_16x16x32_bf16 v[84:87], a[4:7], v[32:35], 0
    ds_read_b128 v[56:59], v13 offset:6144
    ds_read_b128 v[60:63], v13 offset:7168
    v_mfma_f32_16x16x32_bf16 v[88:91], a[0:3], v[36:39], 0
    v_mfma_f32_16x16x32_bf16 v[92:95], a[4:7], v[36:39], 0
    s_waitcnt lgkmcnt(4)
    v_mfma_f32_16x16x32_bf16 v[80:83], a[8:11], v[40:43], v[80:83]
    ds_read_b128 v[32:35], v13 offset:8192
    ds_read_b128 v[36:39], v13 offset:9216
    v_mfma_f32_16x16x32_bf16 v[84:87], a[12:15], v[40:43], v[84:87]
    v_mfma_f32_16x16x32_bf16 v[88:91], a[8:11], v[44:47], v[88:91]
    v_mfma_f32_16x16x32_bf16 v[92:95], a[12:15], v[44:47], v[92:95]
    s_waitcnt lgkmcnt(4)
    v_mfma_f32_16x16x32_bf16 v[80:83], a[16:19], v[48:51], v[80:83]
    ds_read_b128 v[40:43], v13 offset:10240
    ds_read_b128 v[44:47], v13 offset:11264
    v_mfma_f32_16x16x32_bf16 v[84:87], a[20:23], v[48:51], v[84:87]
    v_mfma_f32_16x16x32_bf16 v[88:91], a[16:19], v[52:55], v[88:91]
    v_mfma_f32_16x16x32_bf16 v[92:95], a[20:23], v[52:55], v[92:95]
    s_waitcnt lgkmcnt(4)
    v_mfma_f32_16x16x32_bf16 v[80:83], a[24:27], v[56:59], v[80:83]
    ds_read_b128 v[48:51], v13 offset:12288
    ds_read_b128 v[52:55], v13 offset:13312
    v_mfma_f32_16x16x32_bf16 v[84:87], a[28:31], v[56:59], v[84:87]
    v_mfma_f32_16x16x32_bf16 v[88:91], a[24:27], v[60:63], v[88:91]
    v_mfma_f32_16x16x32_bf16 v[92:95], a[28:31], v[60:63], v[92:95]
    s_waitcnt lgkmcnt(4)
    v_mfma_f32_16x16x32_bf16 v[80:83], a[32:35], v[32:35], v[80:83]
    ds_read_b128 v[56:59], v13 offset:14336
    ds_read_b128 v[60:63], v13 offset:15360
    v_mfma_f32_16x16x32_bf16 v[84:87], a[36:39], v[32:35], v[84:87]
    v_mfma_f32_16x16x32_bf16 v[88:91], a[32:35], v[36:39], v[88:91]
    v_mfma_f32_16x16x32_bf16 v[92:95], a[36:39], v[36:39], v[92:95]
    s_waitcnt lgkmcnt(4)
    v_mfma_f32_16x16x32_bf16 v[80:83], a[40:43], v[40:43], v[80:83]
    ds_read_b128 v[32:35], v13 offset:16384
    ds_read_b128 v[36:39], v13 offset:17408
    v_mfma_f32_16x16x32_bf16 v[84:87], a[44:47], v[40:43], v[84:87]
    v_mfma_f32_16x16x32_bf16 v[88:91], a[40:43], v[44:47], v[88:91]
    v_mfma_f32_16x16x32_bf16 v[92:95], a[44:47], v[44:47], v[92:95]
    s_waitcnt lgkmcnt(4)
    v_mfma_f32_16x16x32_bf16 v[80:83], a[48:51], v[48:51], v[80:83]
    ds_read_b128 v[40:43], v13 offset:18432
    ds_read_b128 v[44:47], v13 offset:19456
    v_mfma_f32_16x16x32_bf16 v[84:87], a[52:55], v[48:51], v[84:87]
    v_mfma_f32_16x16x32_bf16 v[88:91], a[48:51], v[52:55], v[88:91]
    v_mfma_f32_16x16x32_bf16 v[92:95], a[52:55], v[52:55], v[92:95]
    s_waitcnt lgkmcnt(4)
    v_mfma_f32_16x16x32_bf16 v[80:83], a[56:59], v[56:59], v[80:83]
    ds_read_b128 v[48:51], v13 offset:20480
    ds_read_b128 v[52:55], v13 offset:21504
    v_mfma_f32_16x16x32_bf16 v[84:87], a[60:63], v[56:59], v[84:87]
    v_mfma_f32_16x16x32_bf16 v[88:91], a[56:59], v[60:63], v[88:91]
    v_mfma_f32_16x16x32_bf16 v[92:95], a[60:63], v[60:63], v[92:95]
    s_waitcnt lgkmcnt(4)
    v_mfma_f32_16x16x32_bf16 v[80:83], a[64:67], v[32:35], v[80:83]
    ds_read_b128 v[56:59], v13 offset:22528
    ds_read_b128 v[60:63], v13 offset:23552
    v_mfma_f32_16x16x32_bf16 v[84:87], a[68:71], v[32:35], v[84:87]
    v_mfma_f32_16x16x32_bf16 v[88:91], a[64:67], v[36:39], v[88:91]
    v_mfma_f32_16x16x32_bf16 v[92:95], a[68:71], v[36:39], v[92:95]
    s_waitcnt lgkmcnt(4)
    v_mfma_f32_16x16x32_bf16 v[80:83], a[72:75], v[40:43], v[80:83]
    ds_read_b128 v[32:35], v13 offset:24576
    ds_read_b128 v[36:39], v13 offset:25600
    v_mfma_f32_16x16x32_bf16 v[84:87], a[76:79], v[40:43], v[84:87]
    v_mfma_f32_16x16x32_bf16 v[88:91], a[72:75], v[44:47], v[88:91]
    v_mfma_f32_16x16x32_bf16 v[92:95], a[76:79], v[44:47], v[92:95]
    s_waitcnt lgkmcnt(4)
    v_mfma_f32_16x16x32_bf16 v[80:83], a[80:83], v[48:51], v[80:83]
    ds_read_b128 v[40:43], v13 offset:26624
    ds_read_b128 v[44:47], v13 offset:27648
    v_mfma_f32_16x16x32_bf16 v[84:87], a[84:87], v[48:51], v[84:87]
    v_mfma_f32_16x16x32_bf16 v[88:91], a[80:83], v[52:55], v[88:91]
    v_mfma_f32_16x16x32_bf16 v[92:95], a[84:87], v[52:55], v[92:95]
    s_waitcnt lgkmcnt(4)
    v_mfma_f32_16x16x32_bf16 v[80:83], a[88:91], v[56:59], v[80:83]
    ds_read_b128 v[48:51], v13 offset:28672
    ds_read_b128 v[52:55], v13 offset:29696
    v_mfma_f32_16x16x32_bf16 v[84:87], a[92:95], v[56:59], v[84:87]
    v_mfma_f32_16x16x32_bf16 v[88:91], a[88:91], v[60:63], v[88:91]
    v_mfma_f32_16x16x32_bf16 v[92:95], a[92:95], v[60:63], v[92:95]
    s_waitcnt lgkmcnt(4)
    v_mfma_f32_16x16x32_bf16 v[80:83], a[96:99], v[32:35], v[80:83]
    ds_read_b128 v[56:59], v13 offset:30720
    ds_read_b128 v[60:63], v13 offset:31744
    v_mfma_f32_16x16x32_bf16 v[84:87], a[100:103], v[32:35], v[84:87]
    v_mfma_f32_16x16x32_bf16 v[88:91], a[96:99], v[36:39], v[88:91]
    v_mfma_f32_16x16x32_bf16 v[92:95], a[100:103], v[36:39], v[92:95]
    s_waitcnt lgkmcnt(4)
    v_mfma_f32_16x16x32_bf16 v[80:83], a[104:107], v[40:43], v[80:83]
    v_mfma_f32_16x16x32_bf16 v[84:87], a[108:111], v[40:43], v[84:87]
    v_mfma_f32_16x16x32_bf16 v[88:91], a[104:107], v[44:47], v[88:91]
    v_mfma_f32_16x16x32_bf16 v[92:95], a[108:111], v[44:47], v[92:95]
    s_waitcnt vmcnt(0) lgkmcnt(0)
    s_barrier
    v_mfma_f32_16x16x32_bf16 v[80:83], a[112:115], v[48:51], v[80:83]
    ds_read_b128 v[32:35], v13 offset:32768
    ds_read_b128 v[36:39], v13 offset:33792
    v_mfma_f32_16x16x32_bf16 v[84:87], a[116:119], v[48:51], v[84:87]
    v_mfma_f32_16x16x32_bf16 v[88:91], a[112:115], v[52:55], v[88:91]
    v_mfma_f32_16x16x32_bf16 v[92:95], a[116:119], v[52:55], v[92:95]
    v_mfma_f32_16x16x32_bf16 v[80:83], a[120:123], v[56:59], v[80:83]
    ds_read_b128 v[40:43], v13 offset:34816
    ds_read_b128 v[44:47], v13 offset:35840
    v_mfma_f32_16x16x32_bf16 v[84:87], a[124:127], v[56:59], v[84:87]
    v_mfma_f32_16x16x32_bf16 v[88:91], a[120:123], v[60:63], v[88:91]
    v_mfma_f32_16x16x32_bf16 v[92:95], a[124:127], v[60:63], v[92:95]
    s_waitcnt lgkmcnt(2)
    v_mfma_f32_16x16x32_bf16 v[80:83], a[128:131], v[32:35], v[80:83]
    ds_read_b128 v[48:51], v13 offset:36864
    ds_read_b128 v[52:55], v13 offset:37888
    v_mfma_f32_16x16x32_bf16 v[84:87], a[132:135], v[32:35], v[84:87]
    ds_read_b128 v[56:59], v13 offset:38912
    ds_read_b128 v[60:63], v13 offset:39936
    v_mfma_f32_16x16x32_bf16 v[88:91], a[128:131], v[36:39], v[88:91]
    v_mfma_f32_16x16x32_bf16 v[92:95], a[132:135], v[36:39], v[92:95]
    s_waitcnt lgkmcnt(4)
    v_mfma_f32_16x16x32_bf16 v[80:83], a[136:139], v[40:43], v[80:83]
    ds_read_b128 v[32:35], v13 offset:40960
    ds_read_b128 v[36:39], v13 offset:41984
    v_mfma_f32_16x16x32_bf16 v[84:87], a[140:143], v[40:43], v[84:87]
    v_mfma_f32_16x16x32_bf16 v[88:91], a[136:139], v[44:47], v[88:91]
    v_mfma_f32_16x16x32_bf16 v[92:95], a[140:143], v[44:47], v[92:95]
    s_waitcnt lgkmcnt(4)
    v_mfma_f32_16x16x32_bf16 v[80:83], a[144:147], v[48:51], v[80:83]
    ds_read_b128 v[40:43], v13 offset:43008
    ds_read_b128 v[44:47], v13 offset:44032
    v_mfma_f32_16x16x32_bf16 v[84:87], a[148:151], v[48:51], v[84:87]
    v_mfma_f32_16x16x32_bf16 v[88:91], a[144:147], v[52:55], v[88:91]
    v_mfma_f32_16x16x32_bf16 v[92:95], a[148:151], v[52:55], v[92:95]
    s_waitcnt lgkmcnt(4)
    v_mfma_f32_16x16x32_bf16 v[80:83], a[152:155], v[56:59], v[80:83]
    ds_read_b128 v[48:51], v13 offset:45056
    ds_read_b128 v[52:55], v13 offset:46080
    v_mfma_f32_16x16x32_bf16 v[84:87], a[156:159], v[56:59], v[84:87]
    v_mfma_f32_16x16x32_bf16 v[88:91], a[152:155], v[60:63], v[88:91]
    v_mfma_f32_16x16x32_bf16 v[92:95], a[156:159], v[60:63], v[92:95]
    s_waitcnt lgkmcnt(4)
    v_mfma_f32_16x16x32_bf16 v[80:83], a[160:163], v[32:35], v[80:83]
    ds_read_b128 v[56:59], v13 offset:47104
    ds_read_b128 v[60:63], v13 offset:48128
    v_mfma_f32_16x16x32_bf16 v[84:87], a[164:167], v[32:35], v[84:87]
    v_mfma_f32_16x16x32_bf16 v[88:91], a[160:163], v[36:39], v[88:91]
    v_mfma_f32_16x16x32_bf16 v[92:95], a[164:167], v[36:39], v[92:95]
    s_waitcnt lgkmcnt(4)
    v_mfma_f32_16x16x32_bf16 v[80:83], a[168:171], v[40:43], v[80:83]
    ds_read_b128 v[32:35], v13 offset:49152
    ds_read_b128 v[36:39], v13 offset:50176
    v_mfma_f32_16x16x32_bf16 v[84:87], a[172:175], v[40:43], v[84:87]
    v_mfma_f32_16x16x32_bf16 v[88:91], a[168:171], v[44:47], v[88:91]
    v_mfma_f32_16x16x32_bf16 v[92:95], a[172:175], v[44:47], v[92:95]
    s_waitcnt lgkmcnt(4)
    v_mfma_f32_16x16x32_bf16 v[80:83], a[176:179], v[48:51], v[80:83]
    ds_read_b128 v[40:43], v13 offset:51200
    ds_read_b128 v[44:47], v13 offset:52224
    v_mfma_f32_16x16x32_bf16 v[84:87], a[180:183], v[48:51], v[84:87]
    v_mfma_f32_16x16x32_bf16 v[88:91], a[176:179], v[52:55], v[88:91]
    v_mfma_f32_16x16x32_bf16 v[92:95], a[180:183], v[52:55], v[92:95]
    s_waitcnt lgkmcnt(4)
    v_mfma_f32_16x16x32_bf16 v[80:83], a[184:187], v[56:59], v[80:83]
    ds_read_b128 v[48:51], v13 offset:53248
    ds_read_b128 v[52:55], v13 offset:54272
    v_mfma_f32_16x16x32_bf16 v[84:87], a[188:191], v[56:59], v[84:87]
    v_mfma_f32_16x16x32_bf16 v[88:91], a[184:187], v[60:63], v[88:91]
    v_mfma_f32_16x16x32_bf16 v[92:95], a[188:191], v[60:63], v[92:95]
    s_waitcnt lgkmcnt(4)
    v_mfma_f32_16x16x32_bf16 v[80:83], a[192:195], v[32:35], v[80:83]
    ds_read_b128 v[56:59], v13 offset:55296
    ds_read_b128 v[60:63], v13 offset:56320
    v_mfma_f32_16x16x32_bf16 v[84:87], a[196:199], v[32:35], v[84:87]
    v_mfma_f32_16x16x32_bf16 v[88:91], a[192:195], v[36:39], v[88:91]
    v_mfma_f32_16x16x32_bf16 v[92:95], a[196:199], v[36:39], v[92:95]
    s_waitcnt lgkmcnt(4)
    v_mfma_f32_16x16x32_bf16 v[80:83], a[200:203], v[40:43], v[80:83]
    v_mfma_f32_16x16x32_bf16 v[84:87], a[204:207], v[40:43], v[84:87]
    v_mfma_f32_16x16x32_bf16 v[88:91], a[200:203], v[44:47], v[88:91]
    v_mfma_f32_16x16x32_bf16 v[92:95], a[204:207], v[44:47], v[92:95]
    s_waitcnt lgkmcnt(0)
    v_mfma_f32_16x16x32_bf16 v[80:83], a[208:211], v[48:51], v[80:83]
    v_mfma_f32_16x16x32_bf16 v[84:87], a[212:215], v[48:51], v[84:87]
    v_mfma_f32_16x16x32_bf16 v[88:91], a[208:211], v[52:55], v[88:91]
    v_mfma_f32_16x16x32_bf16 v[92:95], a[212:215], v[52:55], v[92:95]
    v_mfma_f32_16x16x32_bf16 v[80:83], a[216:219], v[56:59], v[80:83]
    v_mfma_f32_16x16x32_bf16 v[84:87], a[220:223], v[56:59], v[84:87]
    v_mfma_f32_16x16x32_bf16 v[88:91], a[216:219], v[60:63], v[88:91]
    v_mfma_f32_16x16x32_bf16 v[92:95], a[220:223], v[60:63], v[92:95]
    s_mov_b32 s76, s57
    s_nop 6
    ds_write_b128 v7, v[80:83] offset:0
    ds_write_b128 v7, v[84:87] offset:64
    ds_write_b128 v7, v[88:91] offset:2304
    ds_write_b128 v7, v[92:95] offset:2368
L_e_fin_171:
    s_waitcnt lgkmcnt(0)
    ds_read_b128 v[216:219], v8 offset:0
    ds_read_b128 v[220:223], v8 offset:1152
    ds_read_b128 v[224:227], v8 offset:2304
    ds_read_b128 v[228:231], v8 offset:3456
    s_waitcnt lgkmcnt(0)
    buffer_store_dwordx4 v[216:219], v11, s[12:15], s76 offen sc1
    s_add_u32 s76, s76, 32768
    buffer_store_dwordx4 v[220:223], v11, s[12:15], s76 offen sc1
    s_add_u32 s76, s76, 32768
    buffer_store_dwordx4 v[224:227], v11, s[12:15], s76 offen sc1
    s_add_u32 s76, s76, 32768
    buffer_store_dwordx4 v[228:231], v11, s[12:15], s76 offen sc1
    s_waitcnt vmcnt(0)
    s_barrier
    s_cmp_lg_u32 s44, 0
    s_cbranch_scc1 L_pub_172
    v_mov_b32 v30, s62
    v_mov_b32 v31, 0
    s_mov_b64 exec, 1
    buffer_store_dword v30, v31, s[80:83], s65 offen
    buffer_store_dword v30, v31, s[84:87], s65 offen sc1
    s_mov_b64 exec, -1
L_pub_172:
    s_cmp_lg_u32 s51, 1
    s_cbranch_scc1 L_c_skip_165
    s_lshl_b32 s63, s50, 5
    s_add_u32 s63, s63, s41
    s_lshl_b32 s47, s63, 11
    s_lshl_b32 s45, s44, 9
    s_add_u32 s47, s47, s45
    s_add_u32 s46, s47, 0x800000
    v_lshlrev_b32 v17, 3, v1
    buffer_load_dwordx2 v[208:209], v17, s[12:15], s46 offen sc1
    s_add_u32 s45, s64, 16384
    s_cmp_lg_u32 s44, 0
    s_cbranch_scc1 L_pw_173
    s_mov_b32 exec_hi, 0
    s_mov_b32 s70, 0
L_wp_174:
    buffer_load_dword v31, v5, s[12:15], s45 offen sc1
    s_add_u32 s70, s70, 1
    s_cmp_ge_u32 s70, 0x200000
    s_cbranch_scc1 L_w_done_98
    s_waitcnt vmcnt(0)
    v_cmp_gt_u32 vcc, s62, v31
    s_nop 1
    s_cbranch_vccz L_wp_174_ok
    s_sleep 1
    s_branch L_wp_174
L_wp_174_ok:
    s_mov_b64 exec, -1
L_pw_173:
    s_barrier
    s_waitcnt vmcnt(0)
    s_lshl_b32 s45, s63, 12
    s_lshl_b32 s46, s44, 10
    s_add_u32 s45, s45, s46
    s_add_u32 s45, s45, 0xc000000
    buffer_load_dwordx4 v[64:67], v10, s[12:15], s45 offen sc1
    s_add_u32 s45, s45, 0x800000
    buffer_load_dwordx4 v[68:71], v10, s[12:15], s45 offen sc1
    s_add_u32 s45, s45, 0x800000
    buffer_load_dwordx4 v[72:75], v10, s[12:15], s45 offen sc1
    s_add_u32 s45, s45, 0x800000
    buffer_load_dwordx4 v[76:79], v10, s[12:15], s45 offen sc1
    v_lshlrev_b32 v160, 16, v208
    v_and_b32 v161, 0xffff0000, v208
    v_lshlrev_b32 v162, 16, v209
    v_and_b32 v163, 0xffff0000, v209
    s_waitcnt vmcnt(0)
    v_pk_add_f32 v[64:65], v[64:65], v[68:69]
    v_pk_add_f32 v[72:73], v[72:73], v[76:77]
    v_pk_add_f32 v[66:67], v[66:67], v[70:71]
    v_pk_add_f32 v[74:75], v[74:75], v[78:79]
    v_pk_add_f32 v[64:65], v[64:65], v[72:73]
    v_pk_add_f32 v[66:67], v[66:67], v[74:75]
    v_cvt_pk_bf16_f32 v64, v64, v64
    v_lshlrev_b32 v64, 16, v64
    v_cvt_pk_bf16_f32 v65, v65, v65
    v_lshlrev_b32 v65, 16, v65
    v_cvt_pk_bf16_f32 v66, v66, v66
    v_lshlrev_b32 v66, 16, v66
    v_cvt_pk_bf16_f32 v67, v67, v67
    v_lshlrev_b32 v67, 16, v67
    v_add_f32 v64, v64, v18
    v_cvt_pk_bf16_f32 v64, v64, v64
    v_lshlrev_b32 v64, 16, v64
    v_mul_f32 v64, v64, v22
    v_cvt_pk_bf16_f32 v64, v64, v64
    v_lshlrev_b32 v64, 16, v64
    v_add_f32 v64, v64, v160
    v_add_f32 v65, v65, v19
    v_cvt_pk_bf16_f32 v65, v65, v65
    v_lshlrev_b32 v65, 16, v65
    v_mul_f32 v65, v65, v23
    v_cvt_pk_bf16_f32 v65, v65, v65
    v_lshlrev_b32 v65, 16, v65
    v_add_f32 v65, v65, v161
    v_add_f32 v66, v66, v20
    v_cvt_pk_bf16_f32 v66, v66, v66
    v_lshlrev_b32 v66, 16, v66
    v_mul_f32 v66, v66, v24
    v_cvt_pk_bf16_f32 v66, v66, v66
    v_lshlrev_b32 v66, 16, v66
    v_add_f32 v66, v66, v162
    v_add_f32 v67, v67, v21
    v_cvt_pk_bf16_f32 v67, v67, v67
    v_lshlrev_b32 v67, 16, v67
    v_mul_f32 v67, v67, v25
    v_cvt_pk_bf16_f32 v67, v67, v67
    v_lshlrev_b32 v67, 16, v67
    v_add_f32 v67, v67, v163
    v_cvt_pk_bf16_f32 v208, v64, v65
    v_cvt_pk_bf16_f32 v209, v66, v67
    buffer_store_dwordx2 v[208:209], v17, s[32:35], s47 offen
    s_branch L_c_loop_164
L_c_skip_165:
    s_add_u32 s63, s50, s44
    s_lshl_b32 s63, s63, 5
    s_add_u32 s63, s63, s41
    s_lshl_b32 s47, s63, 11
    s_add_u32 s46, s47, 0x800000
    s_cmp_lt_u32 s44, s51
    s_cselect_b32 s46, s46, 0x20000000
    buffer_load_dwordx4 v[208:211], v10, s[12:15], s46 offen sc1
    buffer_load_dwordx4 v[212:215], v10, s[12:15], s46 offen offset:1024 sc1
    s_add_u32 s45, s64, 16384
    s_cmp_lg_u32 s44, 0
    s_cbranch_scc1 L_pw_175
    s_mov_b32 exec_hi, 0
    s_mov_b32 s70, 0
L_wp_176:
    buffer_load_dword v31, v5, s[12:15], s45 offen sc1
    s_add_u32 s70, s70, 1
    s_cmp_ge_u32 s70, 0x200000
    s_cbranch_scc1 L_w_done_98
    s_waitcnt vmcnt(0)
    v_cmp_gt_u32 vcc, s62, v31
    s_nop 1
    s_cbranch_vccz L_wp_176_ok
    s_sleep 1
    s_branch L_wp_176
L_wp_176_ok:
    s_mov_b64 exec, -1
L_pw_175:
    s_barrier
    s_cmp_ge_u32 s44, s51
    s_cbranch_scc1 L_c_loop_164
    s_lshl_b32 s45, s63, 12
    s_add_u32 s45, s45, 0xc000000
    v_lshlrev_b32 v29, 5, v1
    buffer_load_dwordx4 v[64:67], v29, s[12:15], s45 offen offset:0 sc1
    buffer_load_dwordx4 v[68:71], v29, s[12:15], s45 offen offset:16 sc1
    buffer_load_dwordx4 v[72:75], v29, s[12:15], s45 offen offset:2048 sc1
    buffer_load_dwordx4 v[76:79], v29, s[12:15], s45 offen offset:2064 sc1
    s_add_u32 s45, s45, 0x800000
    buffer_load_dwordx4 v[160:163], v29, s[12:15], s45 offen offset:0 sc1
    buffer_load_dwordx4 v[164:167], v29, s[12:15], s45 offen offset:16 sc1
    buffer_load_dwordx4 v[168:171], v29, s[12:15], s45 offen offset:2048 sc1
    buffer_load_dwordx4 v[172:175], v29, s[12:15], s45 offen offset:2064 sc1
    s_add_u32 s45, s45, 0x800000
    buffer_load_dwordx4 v[176:179], v29, s[12:15], s45 offen offset:0 sc1
    buffer_load_dwordx4 v[180:183], v29, s[12:15], s45 offen offset:16 sc1
    buffer_load_dwordx4 v[184:187], v29, s[12:15], s45 offen offset:2048 sc1
    buffer_load_dwordx4 v[188:191], v29, s[12:15], s45 offen offset:2064 sc1
    s_add_u32 s45, s45, 0x800000
    buffer_load_dwordx4 v[192:195], v29, s[12:15], s45 offen offset:0 sc1
    buffer_load_dwordx4 v[196:199], v29, s[12:15], s45 offen offset:16 sc1
    buffer_load_dwordx4 v[200:203], v29, s[12:15], s45 offen offset:2048 sc1
    buffer_load_dwordx4 v[204:207], v29, s[12:15], s45 offen offset:2064 sc1
    s_waitcnt vmcnt(0)
    v_pk_add_f32 v[64:65], v[64:65], v[160:161]
    v_pk_add_f32 v[176:177], v[176:177], v[192:193]
    v_pk_add_f32 v[66:67], v[66:67], v[162:163]
    v_pk_add_f32 v[178:179], v[178:179], v[194:195]
    v_pk_add_f32 v[68:69], v[68:69], v[164:165]
    v_pk_add_f32 v[180:181], v[180:181], v[196:197]
    v_pk_add_f32 v[70:71], v[70:71], v[166:167]
    v_pk_add_f32 v[182:183], v[182:183], v[198:199]
    v_pk_add_f32 v[72:73], v[72:73], v[168:169]
    v_pk_add_f32 v[184:185], v[184:185], v[200:201]
    v_pk_add_f32 v[74:75], v[74:75], v[170:171]
    v_pk_add_f32 v[186:187], v[186:187], v[202:203]
    v_pk_add_f32 v[76:77], v[76:77], v[172:173]
    v_pk_add_f32 v[188:189], v[188:189], v[204:205]
    v_pk_add_f32 v[78:79], v[78:79], v[174:175]
    v_pk_add_f32 v[190:191], v[190:191], v[206:207]
    v_pk_add_f32 v[64:65], v[64:65], v[176:177]
    v_pk_add_f32 v[66:67], v[66:67], v[178:179]
    v_pk_add_f32 v[68:69], v[68:69], v[180:181]
    v_pk_add_f32 v[70:71], v[70:71], v[182:183]
    v_pk_add_f32 v[72:73], v[72:73], v[184:185]
    v_pk_add_f32 v[74:75], v[74:75], v[186:187]
    v_pk_add_f32 v[76:77], v[76:77], v[188:189]
    v_pk_add_f32 v[78:79], v[78:79], v[190:191]
    v_cvt_pk_bf16_f32 v64, v64, v64
    v_lshlrev_b32 v64, 16, v64
    v_cvt_pk_bf16_f32 v65, v65, v65
    v_lshlrev_b32 v65, 16, v65
    v_cvt_pk_bf16_f32 v66, v66, v66
    v_lshlrev_b32 v66, 16, v66
    v_cvt_pk_bf16_f32 v67, v67, v67
    v_lshlrev_b32 v67, 16, v67
    v_cvt_pk_bf16_f32 v68, v68, v68
    v_lshlrev_b32 v68, 16, v68
    v_cvt_pk_bf16_f32 v69, v69, v69
    v_lshlrev_b32 v69, 16, v69
    v_cvt_pk_bf16_f32 v70, v70, v70
    v_lshlrev_b32 v70, 16, v70
    v_cvt_pk_bf16_f32 v71, v71, v71
    v_lshlrev_b32 v71, 16, v71
    v_cvt_pk_bf16_f32 v72, v72, v72
    v_lshlrev_b32 v72, 16, v72
    v_cvt_pk_bf16_f32 v73, v73, v73
    v_lshlrev_b32 v73, 16, v73
    v_cvt_pk_bf16_f32 v74, v74, v74
    v_lshlrev_b32 v74, 16, v74
    v_cvt_pk_bf16_f32 v75, v75, v75
    v_lshlrev_b32 v75, 16, v75
    v_cvt_pk_bf16_f32 v76, v76, v76
    v_lshlrev_b32 v76, 16, v76
    v_cvt_pk_bf16_f32 v77, v77, v77
    v_lshlrev_b32 v77, 16, v77
    v_cvt_pk_bf16_f32 v78, v78, v78
    v_lshlrev_b32 v78, 16, v78
    v_cvt_pk_bf16_f32 v79, v79, v79
    v_lshlrev_b32 v79, 16, v79
    v_lshlrev_b32 v160, 16, v208
    v_and_b32 v161, 0xffff0000, v208
    v_lshlrev_b32 v162, 16, v209
    v_and_b32 v163, 0xffff0000, v209
    v_lshlrev_b32 v164, 16, v210
    v_and_b32 v165, 0xffff0000, v210
    v_lshlrev_b32 v166, 16, v211
    v_and_b32 v167, 0xffff0000, v211
    v_lshlrev_b32 v168, 16, v212
    v_and_b32 v169, 0xffff0000, v212
    v_lshlrev_b32 v170, 16, v213
    v_and_b32 v171, 0xffff0000, v213
    v_lshlrev_b32 v172, 16, v214
    v_and_b32 v173, 0xffff0000, v214
    v_lshlrev_b32 v174, 16, v215
    v_and_b32 v175, 0xffff0000, v215
    v_add_f32 v64, v64, v96
    v_cvt_pk_bf16_f32 v64, v64, v64
    v_lshlrev_b32 v64, 16, v64
    v_mul_f32 v64, v64, v112
    v_cvt_pk_bf16_f32 v64, v64, v64
    v_lshlrev_b32 v64, 16, v64
    v_add_f32 v64, v64, v160
    v_add_f32 v65, v65, v97
    v_cvt_pk_bf16_f32 v65, v65, v65
    v_lshlrev_b32 v65, 16, v65
    v_mul_f32 v65, v65, v113
    v_cvt_pk_bf16_f32 v65, v65, v65
    v_lshlrev_b32 v65, 16, v65
    v_add_f32 v65, v65, v161
    v_add_f32 v66, v66, v98
    v_cvt_pk_bf16_f32 v66, v66, v66
    v_lshlrev_b32 v66, 16, v66
    v_mul_f32 v66, v66, v114
    v_cvt_pk_bf16_f32 v66, v66, v66
    v_lshlrev_b32 v66, 16, v66
    v_add_f32 v66, v66, v162
    v_add_f32 v67, v67, v99
    v_cvt_pk_bf16_f32 v67, v67, v67
    v_lshlrev_b32 v67, 16, v67
    v_mul_f32 v67, v67, v115
    v_cvt_pk_bf16_f32 v67, v67, v67
    v_lshlrev_b32 v67, 16, v67
    v_add_f32 v67, v67, v163
    v_add_f32 v68, v68, v100
    v_cvt_pk_bf16_f32 v68, v68, v68
    v_lshlrev_b32 v68, 16, v68
    v_mul_f32 v68, v68, v116
    v_cvt_pk_bf16_f32 v68, v68, v68
    v_lshlrev_b32 v68, 16, v68
    v_add_f32 v68, v68, v164
    v_add_f32 v69, v69, v101
    v_cvt_pk_bf16_f32 v69, v69, v69
    v_lshlrev_b32 v69, 16, v69
    v_mul_f32 v69, v69, v117
    v_cvt_pk_bf16_f32 v69, v69, v69
    v_lshlrev_b32 v69, 16, v69
    v_add_f32 v69, v69, v165
    v_add_f32 v70, v70, v102
    v_cvt_pk_bf16_f32 v70, v70, v70
    v_lshlrev_b32 v70, 16, v70
    v_mul_f32 v70, v70, v118
    v_cvt_pk_bf16_f32 v70, v70, v70
    v_lshlrev_b32 v70, 16, v70
    v_add_f32 v70, v70, v166
    v_add_f32 v71, v71, v103
    v_cvt_pk_bf16_f32 v71, v71, v71
    v_lshlrev_b32 v71, 16, v71
    v_mul_f32 v71, v71, v119
    v_cvt_pk_bf16_f32 v71, v71, v71
    v_lshlrev_b32 v71, 16, v71
    v_add_f32 v71, v71, v167
    v_add_f32 v72, v72, v104
    v_cvt_pk_bf16_f32 v72, v72, v72
    v_lshlrev_b32 v72, 16, v72
    v_mul_f32 v72, v72, v120
    v_cvt_pk_bf16_f32 v72, v72, v72
    v_lshlrev_b32 v72, 16, v72
    v_add_f32 v72, v72, v168
    v_add_f32 v73, v73, v105
    v_cvt_pk_bf16_f32 v73, v73, v73
    v_lshlrev_b32 v73, 16, v73
    v_mul_f32 v73, v73, v121
    v_cvt_pk_bf16_f32 v73, v73, v73
    v_lshlrev_b32 v73, 16, v73
    v_add_f32 v73, v73, v169
    v_add_f32 v74, v74, v106
    v_cvt_pk_bf16_f32 v74, v74, v74
    v_lshlrev_b32 v74, 16, v74
    v_mul_f32 v74, v74, v122
    v_cvt_pk_bf16_f32 v74, v74, v74
    v_lshlrev_b32 v74, 16, v74
    v_add_f32 v74, v74, v170
    v_add_f32 v75, v75, v107
    v_cvt_pk_bf16_f32 v75, v75, v75
    v_lshlrev_b32 v75, 16, v75
    v_mul_f32 v75, v75, v123
    v_cvt_pk_bf16_f32 v75, v75, v75
    v_lshlrev_b32 v75, 16, v75
    v_add_f32 v75, v75, v171
    v_add_f32 v76, v76, v108
    v_cvt_pk_bf16_f32 v76, v76, v76
    v_lshlrev_b32 v76, 16, v76
    v_mul_f32 v76, v76, v124
    v_cvt_pk_bf16_f32 v76, v76, v76
    v_lshlrev_b32 v76, 16, v76
    v_add_f32 v76, v76, v172
    v_add_f32 v77, v77, v109
    v_cvt_pk_bf16_f32 v77, v77, v77
    v_lshlrev_b32 v77, 16, v77
    v_mul_f32 v77, v77, v125
    v_cvt_pk_bf16_f32 v77, v77, v77
    v_lshlrev_b32 v77, 16, v77
    v_add_f32 v77, v77, v173
    v_add_f32 v78, v78, v110
    v_cvt_pk_bf16_f32 v78, v78, v78
    v_lshlrev_b32 v78, 16, v78
    v_mul_f32 v78, v78, v126
    v_cvt_pk_bf16_f32 v78, v78, v78
    v_lshlrev_b32 v78, 16, v78
    v_add_f32 v78, v78, v174
    v_add_f32 v79, v79, v111
    v_cvt_pk_bf16_f32 v79, v79, v79
    v_lshlrev_b32 v79, 16, v79
    v_mul_f32 v79, v79, v127
    v_cvt_pk_bf16_f32 v79, v79, v79
    v_lshlrev_b32 v79, 16, v79
    v_add_f32 v79, v79, v175
    v_cvt_pk_bf16_f32 v208, v64, v65
    v_cvt_pk_bf16_f32 v209, v66, v67
    v_cvt_pk_bf16_f32 v210, v68, v69
    v_cvt_pk_bf16_f32 v211, v70, v71
    v_cvt_pk_bf16_f32 v212, v72, v73
    v_cvt_pk_bf16_f32 v213, v74, v75
    v_cvt_pk_bf16_f32 v214, v76, v77
    v_cvt_pk_bf16_f32 v215, v78, v79
    buffer_store_dwordx4 v[208:211], v10, s[32:35], s47 offen
    buffer_store_dwordx4 v[212:215], v10, s[32:35], s47 offen offset:1024
    s_branch L_c_loop_164
L_w_done_98:
    s_endpgm
.section .rodata,"a"
.p2align 6
.amdhsa_kernel adaLN_cond__memory_aug_recurrent_mem_tr__dense_activation_gelu__prompt_kernel
  .amdhsa_next_free_vgpr 512
  .amdhsa_next_free_sgpr 102
  .amdhsa_accum_offset 256
  .amdhsa_group_segment_fixed_size 0
  .amdhsa_kernarg_size 136
  .amdhsa_user_sgpr_count 2
  .amdhsa_user_sgpr_kernarg_segment_ptr 1
  .amdhsa_system_sgpr_workgroup_id_x 1
.end_amdhsa_kernel
```

```asm
; @launch kernel=adaLN_cond__memory_aug_recurrent_mem_tr__dense_activation_gelu__prompt_kernel grid=(256,1,1) block=(256,1,1) lds=163840
.amdgcn_target "amdgcn-amd-amdhsa--gfx950"
.text
.globl adaLN_cond__memory_aug_recurrent_mem_tr__dense_activation_gelu__prompt_kernel
.p2align 8
.type adaLN_cond__memory_aug_recurrent_mem_tr__dense_activation_gelu__prompt_kernel,@function
adaLN_cond__memory_aug_recurrent_mem_tr__dense_activation_gelu__prompt_kernel:
    s_cmp_lt_u32 s2, 256
    s_cbranch_scc1 L_c_done_1_go
    s_endpgm
L_c_done_1_go:
    s_and_b32 s40, s2, 7
    s_load_dwordx4 s[4:7], s[0:1], 16
    s_load_dwordx4 s[8:11], s[0:1], 32
    s_load_dwordx2 s[20:21], s[0:1], 128
    s_load_dwordx2 s[22:23], s[0:1], 120
    s_load_dwordx2 s[50:51], s[0:1], 8
    s_lshr_b32 s41, s2, 3
    s_and_b32 s42, s41, 15
    v_and_b32 v1, 63, v0
    v_lshrrev_b32 v2, 6, v0
    s_nop 0
    v_readfirstlane_b32 s44, v2
    s_waitcnt lgkmcnt(0)
    s_mov_b32 s24, s4
    s_and_b32 s25, s5, 0xffff
    s_mov_b32 s26, 0x800000
    s_mov_b32 s27, 0x00020000
    s_mov_b32 s28, s6
    s_and_b32 s29, s7, 0xffff
    s_mov_b32 s30, 0x800000
    s_mov_b32 s31, 0x00020000
    s_mov_b32 s32, s8
    s_and_b32 s33, s9, 0xffff
    s_mov_b32 s34, 0x800000
    s_mov_b32 s35, 0x00020000
    s_mov_b32 s36, s10
    s_and_b32 s37, s11, 0xffff
    s_mov_b32 s38, 0x800000
    s_mov_b32 s39, 0x00020000
    s_mov_b32 s12, s20
    s_and_b32 s13, s21, 0xffff
    s_mov_b32 s14, 0x10000000
    s_mov_b32 s15, 0x00020000
    s_mov_b32 s16, s22
    s_and_b32 s17, s23, 0xffff
    s_mov_b32 s18, 0x100
    s_mov_b32 s19, 0x00020000
    s_mov_b32 s52, s50
    s_and_b32 s53, s51, 0xffff
    s_mov_b32 s54, 0x4000
    s_mov_b32 s55, 0x00020000
    v_mov_b32 v41, 0
    s_cmp_lg_u32 s2, 1
    s_cbranch_scc1 L_worker_3_a
    s_getreg_b32 s45, hwreg(HW_REG_XCC_ID)
    s_and_b32 s45, s45, 1
    s_add_u32 s45, s45, 1
    v_mov_b32 v40, s45
    buffer_store_dword v40, v41, s[16:19], 0 offen offset:24 sc1
L_worker_3_a:
    s_cmp_eq_u32 s40, 1
    s_cbranch_scc1 L_worker_3_g0
    s_cmp_lt_u32 s40, 3
    s_cbranch_scc1 L_worker_3_q
    s_sub_u32 s40, s40, 2
    s_branch L_worker_3
L_worker_3_q:
    s_mov_b32 s70, 0
L_worker_3_p:
    buffer_load_dword v40, v41, s[16:19], 0 offen offset:24 sc1
    s_add_u32 s70, s70, 1
    s_cmp_ge_u32 s70, 0x200000
    s_cbranch_scc1 L_c_done_1
    s_waitcnt vmcnt(0)
    v_readfirstlane_b32 s45, v40
    s_nop 3
    s_cmp_eq_u32 s45, 0
    s_cbranch_scc1 L_worker_3_p
    s_and_b32 s45, s45, 2
    s_cmp_lg_u32 s45, s40
    s_mov_b32 s40, 1
    s_cbranch_scc1 L_worker_3_no
    s_mov_b32 s40, 0
    s_branch L_worker_3
L_worker_3_g0:
    s_mov_b32 s40, 0
L_worker_3_no:
    s_lshl_b32 s43, s40, 4
    s_add_u32 s43, s43, s42
    s_lshl_b32 s3, s43, 7
    s_lshr_b32 s45, s41, 4
    s_lshl_b32 s45, s45, 4
    s_add_u32 s3, s3, s45
    s_lshl_b32 s45, s44, 2
    s_add_u32 s3, s3, s45
    s_add_u32 s3, s3, 0x11000
    v_and_b32 v21, 8, v1
    v_cmp_eq_u32 s[56:57], 0, v21
    v_mov_b32 v2, 0xeeee
    v_mov_b32 v3, 0x4444
    v_cndmask_b32 v2, v2, v3, s[56:57]
    v_lshlrev_b32 v68, 4, v1
    s_lshl_b32 s45, s44, 12
    v_add_u32 v3, s45, v68
    v_add_u32 v4, 4096, v3
    v_and_b32 v4, 16383, v4
    v_add_u32 v21, 8192, v3
    v_and_b32 v21, 16383, v21
    v_add_u32 v23, 12288, v3
    v_and_b32 v23, 16383, v23
    s_mul_i32 s45, s44, 24576
    s_add_u32 s45, s45, 65536
    v_add_u32 v5, s45, v68
    v_lshrrev_b32 v63, 4, v1
    s_lshl_b32 s45, s44, 2
    v_add_u32 v64, s45, v63
    s_lshr_b32 s45, s44, 1
    s_lshl_b32 s45, s45, 2
    v_add_u32 v65, s45, v63
    v_bfe_u32 v66, v1, 1, 3
    v_xor_b32 v66, v66, v65
    v_lshlrev_b32 v66, 5, v66
    v_and_b32 v67, 1, v1
    v_lshlrev_b32 v67, 4, v67
    v_add_u32 v66, v66, v67
    v_lshlrev_b32 v64, 13, v64
    v_add_u32 v82, v64, v66
    s_lshl_b32 s47, s43, 8
    s_lshl_b32 s48, s44, 10
    v_bfe_u32 v64, v1, 2, 2
    v_bfe_u32 v65, v1, 4, 1
    v_lshlrev_b32 v65, 2, v65
    v_add_u32 v65, v65, v64
    v_lshlrev_b32 v66, 3, v63
    v_add_u32 v66, v66, v64
    v_lshlrev_b32 v66, 8, v66
    v_and_b32 v67, 3, v1
    v_lshlrev_b32 v67, 3, v67
    v_add_u32 v66, v66, v67
    s_lshl_b32 s45, s44, 1
    v_xor_b32 v65, s45, v65
    v_lshlrev_b32 v65, 5, v65
    v_add_u32 v80, v66, v65
    v_xor_b32 v81, 32, v80
    v_lshrrev_b32 v64, 5, v1
    v_mul_u32_u24 v64, 20480, v64
    v_add_u32 v64, 65536, v64
    v_add_u32 v84, v64, v80
    v_add_u32 v85, v64, v81
    v_add_u32 v86, 49152, v84
    v_add_u32 v87, 49152, v85
    v_mov_b32 v40, -1
    v_mov_b32 v41, -1
    v_mov_b32 v42, -1
    v_mov_b32 v43, -1
    v_mov_b32 v44, 0
    s_mov_b32 s68, 0
    s_cmp_ge_u32 s41, 16
    s_cbranch_scc1 L_c_vo_2
    s_lshl_b32 s45, s42, 11
    s_lshr_b32 s46, s44, 1
    s_lshl_b32 s46, s46, 10
    s_add_u32 s45, s45, s46
    s_and_b32 s46, s44, 1
    s_lshl_b32 s46, s46, 7
    s_add_u32 s45, s45, s46
    v_add_u32 v17, s45, v68
    v_mov_b32 v63, 0x20000000
    v_cndmask_b32 v17, v63, v17, s[56:57]
    s_lshl_b32 s62, s40, 17
    s_add_u32 s62, s62, 0x7040000
    s_add_u32 s63, s62, 0
    buffer_store_dwordx4 v[40:43], v17, s[12:15], s63 offen sc1
    s_add_u32 s63, s62, 32768
    buffer_store_dwordx4 v[40:43], v17, s[12:15], s63 offen sc1
    s_add_u32 s63, s62, 65536
    buffer_store_dwordx4 v[40:43], v17, s[12:15], s63 offen sc1
    s_add_u32 s63, s62, 98304
    buffer_store_dwordx4 v[40:43], v17, s[12:15], s63 offen sc1
    s_mov_b64 exec, -1
    s_lshl_b32 s45, s40, 12
    s_lshl_b32 s46, s42, 4
    s_add_u32 s45, s45, s46
    s_add_u32 s45, s45, 0x7080000
    s_lshl_b32 s46, s44, 2
    s_add_u32 s45, s45, s46
    v_lshlrev_b32 v20, 8, v1
    v_add_u32 v20, s45, v20
    v_cmp_gt_u32 vcc, 16, v1
    s_nop 1
    v_cndmask_b32 v20, v63, v20, vcc
    buffer_store_dword v44, v20, s[12:15], 0 offen sc1
    s_lshl_b32 s45, s43, 7
    s_add_u32 s45, s45, 0x10010
    v_lshlrev_b32 v64, 2, v1
    s_mov_b64 exec, 7
    buffer_store_dword v44, v64, s[12:15], s45 offen sc1
    s_mov_b64 exec, 1
    v_mov_b32 v65, 63
    buffer_store_dword v44, v64, s[12:15], s3 offen sc1
    buffer_store_dword v65, v64, s[12:15], s3 offen offset:16 sc1
    s_mov_b64 exec, 0xffff
    v_lshlrev_b32 v64, 7, v1
    s_cmp_eq_u32 s2, 1
    s_mov_b32 s45, 0x1f000
    s_cselect_b32 s45, s45, 0x20000000
    buffer_store_dword v44, v64, s[12:15], s45 offen sc1
    s_mov_b64 exec, -1
    s_add_u32 s79, s41, 0
    s_and_b32 s79, s79, 3
    s_lshl_b32 s79, s79, 19
    s_add_u32 s79, s79, s47
    s_add_u32 s46, s79, 0x0
    s_add_u32 m0, s48, 69632
    s_nop 0
    buffer_load_dwordx4 v82, s[24:27], s46 offen  lds
    s_add_u32 s46, s79, 0x20000
    s_add_u32 m0, s48, 94208
    s_nop 0
    buffer_load_dwordx4 v82, s[24:27], s46 offen  lds
    s_add_u32 s46, s79, 0x40000
    s_add_u32 m0, s48, 118784
    s_nop 0
    buffer_load_dwordx4 v82, s[24:27], s46 offen  lds
    s_add_u32 s46, s79, 0x60000
    s_add_u32 m0, s48, 143360
    s_nop 0
    buffer_load_dwordx4 v82, s[24:27], s46 offen  lds
    s_add_u32 s79, s41, 1
    s_and_b32 s79, s79, 3
    s_lshl_b32 s79, s79, 19
    s_add_u32 s79, s79, s47
    s_add_u32 s46, s79, 0x0
    s_add_u32 m0, s48, 73728
    s_nop 0
    buffer_load_dwordx4 v82, s[24:27], s46 offen  lds
    s_add_u32 s46, s79, 0x20000
    s_add_u32 m0, s48, 98304
    s_nop 0
    buffer_load_dwordx4 v82, s[24:27], s46 offen  lds
    s_add_u32 s46, s79, 0x40000
    s_add_u32 m0, s48, 122880
    s_nop 0
    buffer_load_dwordx4 v82, s[24:27], s46 offen  lds
    s_add_u32 s46, s79, 0x60000
    s_add_u32 m0, s48, 147456
    s_nop 0
    buffer_load_dwordx4 v82, s[24:27], s46 offen  lds
    s_add_u32 s79, s41, 2
    s_and_b32 s79, s79, 3
    s_lshl_b32 s79, s79, 19
    s_add_u32 s79, s79, s47
    s_add_u32 s46, s79, 0x0
    s_add_u32 m0, s48, 81920
    s_nop 0
    buffer_load_dwordx4 v82, s[24:27], s46 offen  lds
    s_add_u32 s46, s79, 0x20000
    s_add_u32 m0, s48, 106496
    s_nop 0
    buffer_load_dwordx4 v82, s[24:27], s46 offen  lds
    s_add_u32 s46, s79, 0x40000
    s_add_u32 m0, s48, 131072
    s_nop 0
    buffer_load_dwordx4 v82, s[24:27], s46 offen  lds
    s_add_u32 s46, s79, 0x60000
    s_add_u32 m0, s48, 155648
    s_nop 0
    buffer_load_dwordx4 v82, s[24:27], s46 offen  lds
    s_add_u32 s79, s41, 3
    s_and_b32 s79, s79, 3
    s_lshl_b32 s79, s79, 19
    s_add_u32 s79, s79, s47
    s_add_u32 s46, s79, 0x0
    s_add_u32 m0, s48, 86016
    s_nop 0
    buffer_load_dwordx4 v82, s[24:27], s46 offen  lds
    s_add_u32 s46, s79, 0x20000
    s_add_u32 m0, s48, 110592
    s_nop 0
    buffer_load_dwordx4 v82, s[24:27], s46 offen  lds
    s_add_u32 s46, s79, 0x40000
    s_add_u32 m0, s48, 135168
    s_nop 0
    buffer_load_dwordx4 v82, s[24:27], s46 offen  lds
    s_add_u32 s46, s79, 0x60000
    s_add_u32 m0, s48, 159744
    s_nop 0
    buffer_load_dwordx4 v82, s[24:27], s46 offen  lds
    s_add_u32 s79, s41, 4
    s_and_b32 s79, s79, 3
    s_lshl_b32 s79, s79, 19
    s_add_u32 s79, s79, s47
    s_add_u32 s46, s79, 0x200000
    s_add_u32 m0, s48, 0
    s_nop 0
    buffer_load_dwordx4 v82, s[24:27], s46 offen  lds
    s_add_u32 s46, s79, 0x220000
    s_add_u32 m0, s48, 4096
    s_nop 0
    buffer_load_dwordx4 v82, s[24:27], s46 offen  lds
    s_add_u32 s46, s79, 0x240000
    s_add_u32 m0, s48, 8192
    s_nop 0
    buffer_load_dwordx4 v82, s[24:27], s46 offen  lds
    s_add_u32 s46, s79, 0x260000
    s_add_u32 m0, s48, 12288
    s_nop 0
    buffer_load_dwordx4 v82, s[24:27], s46 offen  lds
    s_add_u32 s79, s41, 5
    s_and_b32 s79, s79, 3
    s_lshl_b32 s79, s79, 19
    s_add_u32 s79, s79, s47
    s_add_u32 s46, s79, 0x200000
    s_add_u32 m0, s48, 16384
    s_nop 0
    buffer_load_dwordx4 v82, s[24:27], s46 offen  lds
    s_add_u32 s46, s79, 0x220000
    s_add_u32 m0, s48, 20480
    s_nop 0
    buffer_load_dwordx4 v82, s[24:27], s46 offen  lds
    s_add_u32 s46, s79, 0x240000
    s_add_u32 m0, s48, 24576
    s_nop 0
    buffer_load_dwordx4 v82, s[24:27], s46 offen  lds
    s_add_u32 s46, s79, 0x260000
    s_add_u32 m0, s48, 28672
    s_nop 0
    buffer_load_dwordx4 v82, s[24:27], s46 offen  lds
    s_add_u32 s79, s41, 6
    s_and_b32 s79, s79, 3
    s_lshl_b32 s79, s79, 19
    s_add_u32 s79, s79, s47
    s_add_u32 s46, s79, 0x200000
    s_add_u32 m0, s48, 32768
    s_nop 0
    buffer_load_dwordx4 v82, s[24:27], s46 offen  lds
    s_add_u32 s46, s79, 0x220000
    s_add_u32 m0, s48, 36864
    s_nop 0
    buffer_load_dwordx4 v82, s[24:27], s46 offen  lds
    s_add_u32 s46, s79, 0x240000
    s_add_u32 m0, s48, 40960
    s_nop 0
    buffer_load_dwordx4 v82, s[24:27], s46 offen  lds
    s_add_u32 s46, s79, 0x260000
    s_add_u32 m0, s48, 45056
    s_nop 0
    buffer_load_dwordx4 v82, s[24:27], s46 offen  lds
    s_add_u32 s79, s41, 7
    s_and_b32 s79, s79, 3
    s_lshl_b32 s79, s79, 19
    s_add_u32 s79, s79, s47
    s_add_u32 s46, s79, 0x200000
    s_add_u32 m0, s48, 49152
    s_nop 0
    buffer_load_dwordx4 v82, s[24:27], s46 offen  lds
    s_add_u32 s46, s79, 0x220000
    s_add_u32 m0, s48, 53248
    s_nop 0
    buffer_load_dwordx4 v82, s[24:27], s46 offen  lds
    s_add_u32 s46, s79, 0x240000
    s_add_u32 m0, s48, 57344
    s_nop 0
    buffer_load_dwordx4 v82, s[24:27], s46 offen  lds
    s_add_u32 s46, s79, 0x260000
    s_add_u32 m0, s48, 61440
    s_nop 0
    buffer_load_dwordx4 v82, s[24:27], s46 offen  lds
    s_waitcnt vmcnt(28)
    s_barrier
    s_cmp_lg_u32 s44, 0
    s_cbranch_scc1 L_lw_4_0
    ds_read_b64_tr_b16 a[0:1], v84 offset:4096
    ds_read_b64_tr_b16 a[2:3], v84 offset:5120
    ds_read_b64_tr_b16 a[4:5], v86 offset:4096
    ds_read_b64_tr_b16 a[6:7], v86 offset:5120
    ds_read_b64_tr_b16 a[8:9], v85 offset:4096
    ds_read_b64_tr_b16 a[10:11], v85 offset:5120
    ds_read_b64_tr_b16 a[12:13], v87 offset:4096
    ds_read_b64_tr_b16 a[14:15], v87 offset:5120
    s_branch L_lw_4
L_lw_4_0:
    s_cmp_lg_u32 s44, 1
    s_cbranch_scc1 L_lw_4_1
    ds_read_b64_tr_b16 v[128:129], v84 offset:4096
    ds_read_b64_tr_b16 v[130:131], v84 offset:5120
    ds_read_b64_tr_b16 v[132:133], v86 offset:4096
    ds_read_b64_tr_b16 v[134:135], v86 offset:5120
    ds_read_b64_tr_b16 v[136:137], v85 offset:4096
    ds_read_b64_tr_b16 v[138:139], v85 offset:5120
    ds_read_b64_tr_b16 v[140:141], v87 offset:4096
    ds_read_b64_tr_b16 v[142:143], v87 offset:5120
    s_branch L_lw_4
L_lw_4_1:
    s_cmp_lg_u32 s44, 2
    s_cbranch_scc1 L_lw_4_2
    ds_read_b64_tr_b16 a[192:193], v84 offset:4096
    ds_read_b64_tr_b16 a[194:195], v84 offset:5120
    ds_read_b64_tr_b16 a[196:197], v86 offset:4096
    ds_read_b64_tr_b16 a[198:199], v86 offset:5120
    ds_read_b64_tr_b16 v[56:57], v85 offset:4096
    ds_read_b64_tr_b16 v[58:59], v85 offset:5120
    ds_read_b64_tr_b16 v[60:61], v87 offset:4096
    ds_read_b64_tr_b16 v[62:63], v87 offset:5120
    s_waitcnt lgkmcnt(0)
    ds_write_b128 v5, v[56:59] offset:0
    ds_write_b128 v5, v[60:63] offset:1024
    s_branch L_lw_4
L_lw_4_2:
    ds_read_b64_tr_b16 a[96:97], v84 offset:4096
    ds_read_b64_tr_b16 a[98:99], v84 offset:5120
    ds_read_b64_tr_b16 a[100:101], v86 offset:4096
    ds_read_b64_tr_b16 a[102:103], v86 offset:5120
    ds_read_b64_tr_b16 v[56:57], v85 offset:4096
    ds_read_b64_tr_b16 v[58:59], v85 offset:5120
    ds_read_b64_tr_b16 v[60:61], v87 offset:4096
    ds_read_b64_tr_b16 v[62:63], v87 offset:5120
    s_waitcnt lgkmcnt(0)
    ds_write_b128 v5, v[56:59] offset:2048
    ds_write_b128 v5, v[60:63] offset:3072
L_lw_4:
    s_waitcnt lgkmcnt(0)
    s_waitcnt vmcnt(24)
    s_barrier
    s_cmp_lg_u32 s44, 0
    s_cbranch_scc1 L_hs_5
    s_getreg_b32 s45, hwreg(HW_REG_XCC_ID)
    s_and_b32 s45, s45, 15
    s_mul_i32 s46, s45, s45
    s_lshl_b32 s46, s46, 9
    s_add_u32 s45, s45, s46
    s_cmp_eq_u32 s40, 0
    s_cselect_b32 s46, s45, 0
    s_cselect_b32 s45, 0, s45
    s_lshl_b32 s68, s68, 24
    s_add_u32 s46, s46, s68
    s_add_u32 s45, s45, 16777216
    v_mov_b32 v40, s46
    v_mov_b32 v41, s45
    v_mov_b32 v42, 0
    s_mov_b64 exec, 1
    buffer_atomic_add_x2 v[40:41], v42, s[16:19], 0 offen sc1
    v_mov_b32 v43, 1
    buffer_atomic_add v43, v42, s[16:19], 0 offen offset:8 sc1
    s_mov_b64 exec, -1
L_hs_5:
    s_cmp_lg_u32 s44, 0
    s_cbranch_scc1 L_lw_6_0
    ds_read_b64_tr_b16 a[32:33], v84 offset:8192
    ds_read_b64_tr_b16 a[34:35], v84 offset:9216
    ds_read_b64_tr_b16 a[36:37], v86 offset:8192
    ds_read_b64_tr_b16 a[38:39], v86 offset:9216
    ds_read_b64_tr_b16 a[40:41], v85 offset:8192
    ds_read_b64_tr_b16 a[42:43], v85 offset:9216
    ds_read_b64_tr_b16 a[44:45], v87 offset:8192
    ds_read_b64_tr_b16 a[46:47], v87 offset:9216
    s_branch L_lw_6
L_lw_6_0:
    s_cmp_lg_u32 s44, 1
    s_cbranch_scc1 L_lw_6_1
    ds_read_b64_tr_b16 v[160:161], v84 offset:8192
    ds_read_b64_tr_b16 v[162:163], v84 offset:9216
    ds_read_b64_tr_b16 v[164:165], v86 offset:8192
    ds_read_b64_tr_b16 v[166:167], v86 offset:9216
    ds_read_b64_tr_b16 v[168:169], v85 offset:8192
    ds_read_b64_tr_b16 v[170:171], v85 offset:9216
    ds_read_b64_tr_b16 v[172:173], v87 offset:8192
    ds_read_b64_tr_b16 v[174:175], v87 offset:9216
    s_branch L_lw_6
L_lw_6_1:
    s_cmp_lg_u32 s44, 2
    s_cbranch_scc1 L_lw_6_2
    ds_read_b64_tr_b16 a[216:217], v84 offset:8192
    ds_read_b64_tr_b16 a[218:219], v84 offset:9216
    ds_read_b64_tr_b16 a[220:221], v86 offset:8192
    ds_read_b64_tr_b16 a[222:223], v86 offset:9216
    ds_read_b64_tr_b16 v[56:57], v85 offset:8192
    ds_read_b64_tr_b16 v[58:59], v85 offset:9216
    ds_read_b64_tr_b16 v[60:61], v87 offset:8192
    ds_read_b64_tr_b16 v[62:63], v87 offset:9216
    s_waitcnt lgkmcnt(0)
    ds_write_b128 v5, v[56:59] offset:4096
    ds_write_b128 v5, v[60:63] offset:5120
    s_branch L_lw_6
L_lw_6_2:
    ds_read_b64_tr_b16 a[120:121], v84 offset:8192
    ds_read_b64_tr_b16 a[122:123], v84 offset:9216
    ds_read_b64_tr_b16 a[124:125], v86 offset:8192
    ds_read_b64_tr_b16 a[126:127], v86 offset:9216
    ds_read_b64_tr_b16 v[56:57], v85 offset:8192
    ds_read_b64_tr_b16 v[58:59], v85 offset:9216
    ds_read_b64_tr_b16 v[60:61], v87 offset:8192
    ds_read_b64_tr_b16 v[62:63], v87 offset:9216
    s_waitcnt lgkmcnt(0)
    ds_write_b128 v5, v[56:59] offset:6144
    ds_write_b128 v5, v[60:63] offset:7168
L_lw_6:
    s_waitcnt lgkmcnt(0)
    s_waitcnt vmcnt(20)
    s_barrier
    s_cmp_lg_u32 s44, 0
    s_cbranch_scc1 L_lw_7_0
    ds_read_b64_tr_b16 a[64:65], v84 offset:16384
    ds_read_b64_tr_b16 a[66:67], v84 offset:17408
    ds_read_b64_tr_b16 a[68:69], v86 offset:16384
    ds_read_b64_tr_b16 a[70:71], v86 offset:17408
    ds_read_b64_tr_b16 v[56:57], v85 offset:16384
    ds_read_b64_tr_b16 v[58:59], v85 offset:17408
    ds_read_b64_tr_b16 v[60:61], v87 offset:16384
    ds_read_b64_tr_b16 v[62:63], v87 offset:17408
    s_waitcnt lgkmcnt(0)
    ds_write_b128 v5, v[56:59] offset:8192
    ds_write_b128 v5, v[60:63] offset:9216
    s_branch L_lw_7
L_lw_7_0:
    s_cmp_lg_u32 s44, 1
    s_cbranch_scc1 L_lw_7_1
    ds_read_b64_tr_b16 v[192:193], v84 offset:16384
    ds_read_b64_tr_b16 v[194:195], v84 offset:17408
    ds_read_b64_tr_b16 v[196:197], v86 offset:16384
    ds_read_b64_tr_b16 v[198:199], v86 offset:17408
    ds_read_b64_tr_b16 v[200:201], v85 offset:16384
    ds_read_b64_tr_b16 v[202:203], v85 offset:17408
    ds_read_b64_tr_b16 v[204:205], v87 offset:16384
    ds_read_b64_tr_b16 v[206:207], v87 offset:17408
    s_branch L_lw_7
L_lw_7_1:
    s_cmp_lg_u32 s44, 2
    s_cbranch_scc1 L_lw_7_2
    ds_read_b64_tr_b16 a[240:241], v84 offset:16384
    ds_read_b64_tr_b16 a[242:243], v84 offset:17408
    ds_read_b64_tr_b16 a[244:245], v86 offset:16384
    ds_read_b64_tr_b16 a[246:247], v86 offset:17408
    ds_read_b64_tr_b16 v[56:57], v85 offset:16384
    ds_read_b64_tr_b16 v[58:59], v85 offset:17408
    ds_read_b64_tr_b16 v[60:61], v87 offset:16384
    ds_read_b64_tr_b16 v[62:63], v87 offset:17408
    s_waitcnt lgkmcnt(0)
    ds_write_b128 v5, v[56:59] offset:10240
    ds_write_b128 v5, v[60:63] offset:11264
    s_branch L_lw_7
L_lw_7_2:
    ds_read_b64_tr_b16 a[144:145], v84 offset:16384
    ds_read_b64_tr_b16 a[146:147], v84 offset:17408
    ds_read_b64_tr_b16 a[148:149], v86 offset:16384
    ds_read_b64_tr_b16 a[150:151], v86 offset:17408
    ds_read_b64_tr_b16 v[56:57], v85 offset:16384
    ds_read_b64_tr_b16 v[58:59], v85 offset:17408
    ds_read_b64_tr_b16 v[60:61], v87 offset:16384
    ds_read_b64_tr_b16 v[62:63], v87 offset:17408
    s_waitcnt lgkmcnt(0)
    ds_write_b128 v5, v[56:59] offset:12288
    ds_write_b128 v5, v[60:63] offset:13312
L_lw_7:
    s_waitcnt lgkmcnt(0)
    s_waitcnt vmcnt(16)
    s_barrier
    s_cmp_lg_u32 s44, 0
    s_cbranch_scc1 L_lw_8_0
    ds_read_b64_tr_b16 a[80:81], v84 offset:20480
    ds_read_b64_tr_b16 a[82:83], v84 offset:21504
    ds_read_b64_tr_b16 a[84:85], v86 offset:20480
    ds_read_b64_tr_b16 a[86:87], v86 offset:21504
    ds_read_b64_tr_b16 v[56:57], v85 offset:20480
    ds_read_b64_tr_b16 v[58:59], v85 offset:21504
    ds_read_b64_tr_b16 v[60:61], v87 offset:20480
    ds_read_b64_tr_b16 v[62:63], v87 offset:21504
    s_waitcnt lgkmcnt(0)
    ds_write_b128 v5, v[56:59] offset:14336
    ds_write_b128 v5, v[60:63] offset:15360
    s_branch L_lw_8
L_lw_8_0:
    s_cmp_lg_u32 s44, 1
    s_cbranch_scc1 L_lw_8_1
    ds_read_b64_tr_b16 v[224:225], v84 offset:20480
    ds_read_b64_tr_b16 v[226:227], v84 offset:21504
    ds_read_b64_tr_b16 v[228:229], v86 offset:20480
    ds_read_b64_tr_b16 v[230:231], v86 offset:21504
    ds_read_b64_tr_b16 v[232:233], v85 offset:20480
    ds_read_b64_tr_b16 v[234:235], v85 offset:21504
    ds_read_b64_tr_b16 v[236:237], v87 offset:20480
    ds_read_b64_tr_b16 v[238:239], v87 offset:21504
    s_branch L_lw_8
L_lw_8_1:
    s_cmp_lg_u32 s44, 2
    s_cbranch_scc1 L_lw_8_2
    ds_read_b64_tr_b16 v[104:105], v84 offset:20480
    ds_read_b64_tr_b16 v[106:107], v84 offset:21504
    ds_read_b64_tr_b16 v[108:109], v86 offset:20480
    ds_read_b64_tr_b16 v[110:111], v86 offset:21504
    ds_read_b64_tr_b16 v[56:57], v85 offset:20480
    ds_read_b64_tr_b16 v[58:59], v85 offset:21504
    ds_read_b64_tr_b16 v[60:61], v87 offset:20480
    ds_read_b64_tr_b16 v[62:63], v87 offset:21504
    s_waitcnt lgkmcnt(0)
    ds_write_b128 v5, v[56:59] offset:16384
    ds_write_b128 v5, v[60:63] offset:17408
    s_branch L_lw_8
L_lw_8_2:
    ds_read_b64_tr_b16 a[168:169], v84 offset:20480
    ds_read_b64_tr_b16 a[170:171], v84 offset:21504
    ds_read_b64_tr_b16 a[172:173], v86 offset:20480
    ds_read_b64_tr_b16 a[174:175], v86 offset:21504
    ds_read_b64_tr_b16 v[56:57], v85 offset:20480
    ds_read_b64_tr_b16 v[58:59], v85 offset:21504
    ds_read_b64_tr_b16 v[60:61], v87 offset:20480
    ds_read_b64_tr_b16 v[62:63], v87 offset:21504
    s_waitcnt lgkmcnt(0)
    ds_write_b128 v5, v[56:59] offset:18432
    ds_write_b128 v5, v[60:63] offset:19456
L_lw_8:
    s_waitcnt lgkmcnt(0)
    s_waitcnt vmcnt(12)
    s_barrier
    s_add_u32 s79, s41, 8
    s_and_b32 s79, s79, 3
    s_lshl_b32 s79, s79, 19
    s_add_u32 s79, s79, s47
    s_add_u32 s46, s79, 0x400000
    s_add_u32 m0, s48, 86016
    s_nop 0
    buffer_load_dwordx4 v82, s[24:27], s46 offen  lds
    s_add_u32 s46, s79, 0x420000
    s_add_u32 m0, s48, 110592
    s_nop 0
    buffer_load_dwordx4 v82, s[24:27], s46 offen  lds
    s_add_u32 s46, s79, 0x440000
    s_add_u32 m0, s48, 135168
    s_nop 0
    buffer_load_dwordx4 v82, s[24:27], s46 offen  lds
    s_add_u32 s46, s79, 0x460000
    s_add_u32 m0, s48, 159744
    s_nop 0
    buffer_load_dwordx4 v82, s[24:27], s46 offen  lds
    s_cmp_lg_u32 s44, 0
    s_cbranch_scc1 L_lw_9_0
    ds_read_b64_tr_b16 a[96:97], v80 offset:0
    ds_read_b64_tr_b16 a[98:99], v80 offset:1024
    ds_read_b64_tr_b16 a[100:101], v80 offset:8192
    ds_read_b64_tr_b16 a[102:103], v80 offset:9216
    ds_read_b64_tr_b16 v[56:57], v81 offset:0
    ds_read_b64_tr_b16 v[58:59], v81 offset:1024
    ds_read_b64_tr_b16 v[60:61], v81 offset:8192
    ds_read_b64_tr_b16 v[62:63], v81 offset:9216
    s_waitcnt lgkmcnt(0)
    ds_write_b128 v5, v[56:59] offset:2048
    ds_write_b128 v5, v[60:63] offset:3072
    s_branch L_lw_9
L_lw_9_0:
    s_cmp_lg_u32 s44, 1
    s_cbranch_scc1 L_lw_9_1
    ds_read_b64_tr_b16 a[0:1], v80 offset:0
    ds_read_b64_tr_b16 a[2:3], v80 offset:1024
    ds_read_b64_tr_b16 a[4:5], v80 offset:8192
    ds_read_b64_tr_b16 a[6:7], v80 offset:9216
    ds_read_b64_tr_b16 a[8:9], v81 offset:0
    ds_read_b64_tr_b16 a[10:11], v81 offset:1024
    ds_read_b64_tr_b16 a[12:13], v81 offset:8192
    ds_read_b64_tr_b16 a[14:15], v81 offset:9216
    s_branch L_lw_9
L_lw_9_1:
    s_cmp_lg_u32 s44, 2
    s_cbranch_scc1 L_lw_9_2
    ds_read_b64_tr_b16 v[128:129], v80 offset:0
    ds_read_b64_tr_b16 v[130:131], v80 offset:1024
    ds_read_b64_tr_b16 v[132:133], v80 offset:8192
    ds_read_b64_tr_b16 v[134:135], v80 offset:9216
    ds_read_b64_tr_b16 v[136:137], v81 offset:0
    ds_read_b64_tr_b16 v[138:139], v81 offset:1024
    ds_read_b64_tr_b16 v[140:141], v81 offset:8192
    ds_read_b64_tr_b16 v[142:143], v81 offset:9216
    s_branch L_lw_9
L_lw_9_2:
    ds_read_b64_tr_b16 a[192:193], v80 offset:0
    ds_read_b64_tr_b16 a[194:195], v80 offset:1024
    ds_read_b64_tr_b16 a[196:197], v80 offset:8192
    ds_read_b64_tr_b16 a[198:199], v80 offset:9216
    ds_read_b64_tr_b16 v[56:57], v81 offset:0
    ds_read_b64_tr_b16 v[58:59], v81 offset:1024
    ds_read_b64_tr_b16 v[60:61], v81 offset:8192
    ds_read_b64_tr_b16 v[62:63], v81 offset:9216
    s_waitcnt lgkmcnt(0)
    ds_write_b128 v5, v[56:59] offset:0
    ds_write_b128 v5, v[60:63] offset:1024
L_lw_9:
    s_waitcnt lgkmcnt(0)
    s_waitcnt vmcnt(12)
    s_barrier
    s_add_u32 s79, s41, 9
    s_and_b32 s79, s79, 3
    s_lshl_b32 s79, s79, 19
    s_add_u32 s79, s79, s47
    s_add_u32 s46, s79, 0x400000
    s_add_u32 m0, s48, 0
    s_nop 0
    buffer_load_dwordx4 v82, s[24:27], s46 offen  lds
    s_add_u32 s46, s79, 0x420000
    s_add_u32 m0, s48, 4096
    s_nop 0
    buffer_load_dwordx4 v82, s[24:27], s46 offen  lds
    s_add_u32 s46, s79, 0x440000
    s_add_u32 m0, s48, 8192
    s_nop 0
    buffer_load_dwordx4 v82, s[24:27], s46 offen  lds
    s_add_u32 s46, s79, 0x460000
    s_add_u32 m0, s48, 12288
    s_nop 0
    buffer_load_dwordx4 v82, s[24:27], s46 offen  lds
    s_cmp_lg_u32 s44, 0
    s_cbranch_scc1 L_lw_10_0
    ds_read_b64_tr_b16 a[120:121], v80 offset:16384
    ds_read_b64_tr_b16 a[122:123], v80 offset:17408
    ds_read_b64_tr_b16 a[124:125], v80 offset:24576
    ds_read_b64_tr_b16 a[126:127], v80 offset:25600
    ds_read_b64_tr_b16 v[56:57], v81 offset:16384
    ds_read_b64_tr_b16 v[58:59], v81 offset:17408
    ds_read_b64_tr_b16 v[60:61], v81 offset:24576
    ds_read_b64_tr_b16 v[62:63], v81 offset:25600
    s_waitcnt lgkmcnt(0)
    ds_write_b128 v5, v[56:59] offset:6144
    ds_write_b128 v5, v[60:63] offset:7168
    s_branch L_lw_10
L_lw_10_0:
    s_cmp_lg_u32 s44, 1
    s_cbranch_scc1 L_lw_10_1
    ds_read_b64_tr_b16 a[32:33], v80 offset:16384
    ds_read_b64_tr_b16 a[34:35], v80 offset:17408
    ds_read_b64_tr_b16 a[36:37], v80 offset:24576
    ds_read_b64_tr_b16 a[38:39], v80 offset:25600
    ds_read_b64_tr_b16 a[40:41], v81 offset:16384
    ds_read_b64_tr_b16 a[42:43], v81 offset:17408
    ds_read_b64_tr_b16 a[44:45], v81 offset:24576
    ds_read_b64_tr_b16 a[46:47], v81 offset:25600
    s_branch L_lw_10
L_lw_10_1:
    s_cmp_lg_u32 s44, 2
    s_cbranch_scc1 L_lw_10_2
    ds_read_b64_tr_b16 v[160:161], v80 offset:16384
    ds_read_b64_tr_b16 v[162:163], v80 offset:17408
    ds_read_b64_tr_b16 v[164:165], v80 offset:24576
    ds_read_b64_tr_b16 v[166:167], v80 offset:25600
    ds_read_b64_tr_b16 v[168:169], v81 offset:16384
    ds_read_b64_tr_b16 v[170:171], v81 offset:17408
    ds_read_b64_tr_b16 v[172:173], v81 offset:24576
    ds_read_b64_tr_b16 v[174:175], v81 offset:25600
    s_branch L_lw_10
L_lw_10_2:
    ds_read_b64_tr_b16 a[216:217], v80 offset:16384
    ds_read_b64_tr_b16 a[218:219], v80 offset:17408
    ds_read_b64_tr_b16 a[220:221], v80 offset:24576
    ds_read_b64_tr_b16 a[222:223], v80 offset:25600
    ds_read_b64_tr_b16 v[56:57], v81 offset:16384
    ds_read_b64_tr_b16 v[58:59], v81 offset:17408
    ds_read_b64_tr_b16 v[60:61], v81 offset:24576
    ds_read_b64_tr_b16 v[62:63], v81 offset:25600
    s_waitcnt lgkmcnt(0)
    ds_write_b128 v5, v[56:59] offset:4096
    ds_write_b128 v5, v[60:63] offset:5120
L_lw_10:
    s_waitcnt lgkmcnt(0)
    s_waitcnt vmcnt(12)
    s_barrier
    s_add_u32 s79, s41, 10
    s_and_b32 s79, s79, 3
    s_lshl_b32 s79, s79, 19
    s_add_u32 s79, s79, s47
    s_add_u32 s46, s79, 0x400000
    s_add_u32 m0, s48, 16384
    s_nop 0
    buffer_load_dwordx4 v82, s[24:27], s46 offen  lds
    s_add_u32 s46, s79, 0x420000
    s_add_u32 m0, s48, 20480
    s_nop 0
    buffer_load_dwordx4 v82, s[24:27], s46 offen  lds
    s_add_u32 s46, s79, 0x440000
    s_add_u32 m0, s48, 24576
    s_nop 0
    buffer_load_dwordx4 v82, s[24:27], s46 offen  lds
    s_add_u32 s46, s79, 0x460000
    s_add_u32 m0, s48, 28672
    s_nop 0
    buffer_load_dwordx4 v82, s[24:27], s46 offen  lds
    s_cmp_lg_u32 s44, 0
    s_cbranch_scc1 L_lw_11_0
    ds_read_b64_tr_b16 a[144:145], v80 offset:32768
    ds_read_b64_tr_b16 a[146:147], v80 offset:33792
    ds_read_b64_tr_b16 a[148:149], v80 offset:40960
    ds_read_b64_tr_b16 a[150:151], v80 offset:41984
    ds_read_b64_tr_b16 v[56:57], v81 offset:32768
    ds_read_b64_tr_b16 v[58:59], v81 offset:33792
    ds_read_b64_tr_b16 v[60:61], v81 offset:40960
    ds_read_b64_tr_b16 v[62:63], v81 offset:41984
    s_waitcnt lgkmcnt(0)
    ds_write_b128 v5, v[56:59] offset:12288
    ds_write_b128 v5, v[60:63] offset:13312
    s_branch L_lw_11
L_lw_11_0:
    s_cmp_lg_u32 s44, 1
    s_cbranch_scc1 L_lw_11_1
    ds_read_b64_tr_b16 a[64:65], v80 offset:32768
    ds_read_b64_tr_b16 a[66:67], v80 offset:33792
    ds_read_b64_tr_b16 a[68:69], v80 offset:40960
    ds_read_b64_tr_b16 a[70:71], v80 offset:41984
    ds_read_b64_tr_b16 v[56:57], v81 offset:32768
    ds_read_b64_tr_b16 v[58:59], v81 offset:33792
    ds_read_b64_tr_b16 v[60:61], v81 offset:40960
    ds_read_b64_tr_b16 v[62:63], v81 offset:41984
    s_waitcnt lgkmcnt(0)
    ds_write_b128 v5, v[56:59] offset:8192
    ds_write_b128 v5, v[60:63] offset:9216
    s_branch L_lw_11
L_lw_11_1:
    s_cmp_lg_u32 s44, 2
    s_cbranch_scc1 L_lw_11_2
    ds_read_b64_tr_b16 v[192:193], v80 offset:32768
    ds_read_b64_tr_b16 v[194:195], v80 offset:33792
    ds_read_b64_tr_b16 v[196:197], v80 offset:40960
    ds_read_b64_tr_b16 v[198:199], v80 offset:41984
    ds_read_b64_tr_b16 v[200:201], v81 offset:32768
    ds_read_b64_tr_b16 v[202:203], v81 offset:33792
    ds_read_b64_tr_b16 v[204:205], v81 offset:40960
    ds_read_b64_tr_b16 v[206:207], v81 offset:41984
    s_branch L_lw_11
L_lw_11_2:
    ds_read_b64_tr_b16 a[240:241], v80 offset:32768
    ds_read_b64_tr_b16 a[242:243], v80 offset:33792
    ds_read_b64_tr_b16 a[244:245], v80 offset:40960
    ds_read_b64_tr_b16 a[246:247], v80 offset:41984
    ds_read_b64_tr_b16 v[56:57], v81 offset:32768
    ds_read_b64_tr_b16 v[58:59], v81 offset:33792
    ds_read_b64_tr_b16 v[60:61], v81 offset:40960
    ds_read_b64_tr_b16 v[62:63], v81 offset:41984
    s_waitcnt lgkmcnt(0)
    ds_write_b128 v5, v[56:59] offset:10240
    ds_write_b128 v5, v[60:63] offset:11264
L_lw_11:
    s_waitcnt lgkmcnt(0)
    s_waitcnt vmcnt(12)
    s_barrier
    s_add_u32 s79, s41, 11
    s_and_b32 s79, s79, 3
    s_lshl_b32 s79, s79, 19
    s_add_u32 s79, s79, s47
    s_add_u32 s46, s79, 0x400000
    s_add_u32 m0, s48, 32768
    s_nop 0
    buffer_load_dwordx4 v82, s[24:27], s46 offen  lds
    s_add_u32 s46, s79, 0x420000
    s_add_u32 m0, s48, 36864
    s_nop 0
    buffer_load_dwordx4 v82, s[24:27], s46 offen  lds
    s_add_u32 s46, s79, 0x440000
    s_add_u32 m0, s48, 40960
    s_nop 0
    buffer_load_dwordx4 v82, s[24:27], s46 offen  lds
    s_add_u32 s46, s79, 0x460000
    s_add_u32 m0, s48, 45056
    s_nop 0
    buffer_load_dwordx4 v82, s[24:27], s46 offen  lds
    s_cmp_lg_u32 s44, 0
    s_cbranch_scc1 L_lw_12_0
    ds_read_b64_tr_b16 a[168:169], v80 offset:49152
    ds_read_b64_tr_b16 a[170:171], v80 offset:50176
    ds_read_b64_tr_b16 a[172:173], v80 offset:57344
    ds_read_b64_tr_b16 a[174:175], v80 offset:58368
    ds_read_b64_tr_b16 v[56:57], v81 offset:49152
    ds_read_b64_tr_b16 v[58:59], v81 offset:50176
    ds_read_b64_tr_b16 v[60:61], v81 offset:57344
    ds_read_b64_tr_b16 v[62:63], v81 offset:58368
    s_waitcnt lgkmcnt(0)
    ds_write_b128 v5, v[56:59] offset:18432
    ds_write_b128 v5, v[60:63] offset:19456
    s_branch L_lw_12
L_lw_12_0:
    s_cmp_lg_u32 s44, 1
    s_cbranch_scc1 L_lw_12_1
    ds_read_b64_tr_b16 a[80:81], v80 offset:49152
    ds_read_b64_tr_b16 a[82:83], v80 offset:50176
    ds_read_b64_tr_b16 a[84:85], v80 offset:57344
    ds_read_b64_tr_b16 a[86:87], v80 offset:58368
    ds_read_b64_tr_b16 v[56:57], v81 offset:49152
    ds_read_b64_tr_b16 v[58:59], v81 offset:50176
    ds_read_b64_tr_b16 v[60:61], v81 offset:57344
    ds_read_b64_tr_b16 v[62:63], v81 offset:58368
    s_waitcnt lgkmcnt(0)
    ds_write_b128 v5, v[56:59] offset:14336
    ds_write_b128 v5, v[60:63] offset:15360
    s_branch L_lw_12
L_lw_12_1:
    s_cmp_lg_u32 s44, 2
    s_cbranch_scc1 L_lw_12_2
    ds_read_b64_tr_b16 v[224:225], v80 offset:49152
    ds_read_b64_tr_b16 v[226:227], v80 offset:50176
    ds_read_b64_tr_b16 v[228:229], v80 offset:57344
    ds_read_b64_tr_b16 v[230:231], v80 offset:58368
    ds_read_b64_tr_b16 v[232:233], v81 offset:49152
    ds_read_b64_tr_b16 v[234:235], v81 offset:50176
    ds_read_b64_tr_b16 v[236:237], v81 offset:57344
    ds_read_b64_tr_b16 v[238:239], v81 offset:58368
    s_branch L_lw_12
L_lw_12_2:
    ds_read_b64_tr_b16 v[104:105], v80 offset:49152
    ds_read_b64_tr_b16 v[106:107], v80 offset:50176
    ds_read_b64_tr_b16 v[108:109], v80 offset:57344
    ds_read_b64_tr_b16 v[110:111], v80 offset:58368
    ds_read_b64_tr_b16 v[56:57], v81 offset:49152
    ds_read_b64_tr_b16 v[58:59], v81 offset:50176
    ds_read_b64_tr_b16 v[60:61], v81 offset:57344
    ds_read_b64_tr_b16 v[62:63], v81 offset:58368
    s_waitcnt lgkmcnt(0)
    ds_write_b128 v5, v[56:59] offset:16384
    ds_write_b128 v5, v[60:63] offset:17408
L_lw_12:
    s_waitcnt lgkmcnt(0)
    s_waitcnt vmcnt(12)
    s_barrier
    s_add_u32 s79, s41, 12
    s_and_b32 s79, s79, 3
    s_lshl_b32 s79, s79, 19
    s_add_u32 s79, s79, s47
    s_add_u32 s46, s79, 0x600000
    s_add_u32 m0, s48, 49152
    s_nop 0
    buffer_load_dwordx4 v82, s[24:27], s46 offen  lds
    s_add_u32 s46, s79, 0x620000
    s_add_u32 m0, s48, 53248
    s_nop 0
    buffer_load_dwordx4 v82, s[24:27], s46 offen  lds
    s_add_u32 s46, s79, 0x640000
    s_add_u32 m0, s48, 57344
    s_nop 0
    buffer_load_dwordx4 v82, s[24:27], s46 offen  lds
    s_add_u32 s46, s79, 0x660000
    s_add_u32 m0, s48, 61440
    s_nop 0
    buffer_load_dwordx4 v82, s[24:27], s46 offen  lds
    s_cmp_lg_u32 s44, 0
    s_cbranch_scc1 L_lw_13_0
    ds_read_b64_tr_b16 a[192:193], v84 offset:20480
    ds_read_b64_tr_b16 a[194:195], v84 offset:21504
    ds_read_b64_tr_b16 a[196:197], v86 offset:20480
    ds_read_b64_tr_b16 a[198:199], v86 offset:21504
    ds_read_b64_tr_b16 v[56:57], v85 offset:20480
    ds_read_b64_tr_b16 v[58:59], v85 offset:21504
    ds_read_b64_tr_b16 v[60:61], v87 offset:20480
    ds_read_b64_tr_b16 v[62:63], v87 offset:21504
    s_waitcnt lgkmcnt(0)
    ds_write_b128 v5, v[56:59] offset:0
    ds_write_b128 v5, v[60:63] offset:1024
    s_branch L_lw_13
L_lw_13_0:
    s_cmp_lg_u32 s44, 1
    s_cbranch_scc1 L_lw_13_1
    ds_read_b64_tr_b16 a[96:97], v84 offset:20480
    ds_read_b64_tr_b16 a[98:99], v84 offset:21504
    ds_read_b64_tr_b16 a[100:101], v86 offset:20480
    ds_read_b64_tr_b16 a[102:103], v86 offset:21504
    ds_read_b64_tr_b16 v[56:57], v85 offset:20480
    ds_read_b64_tr_b16 v[58:59], v85 offset:21504
    ds_read_b64_tr_b16 v[60:61], v87 offset:20480
    ds_read_b64_tr_b16 v[62:63], v87 offset:21504
    s_waitcnt lgkmcnt(0)
    ds_write_b128 v5, v[56:59] offset:2048
    ds_write_b128 v5, v[60:63] offset:3072
    s_branch L_lw_13
L_lw_13_1:
    s_cmp_lg_u32 s44, 2
    s_cbranch_scc1 L_lw_13_2
    ds_read_b64_tr_b16 a[0:1], v84 offset:20480
    ds_read_b64_tr_b16 a[2:3], v84 offset:21504
    ds_read_b64_tr_b16 a[4:5], v86 offset:20480
    ds_read_b64_tr_b16 a[6:7], v86 offset:21504
    ds_read_b64_tr_b16 a[8:9], v85 offset:20480
    ds_read_b64_tr_b16 a[10:11], v85 offset:21504
    ds_read_b64_tr_b16 a[12:13], v87 offset:20480
    ds_read_b64_tr_b16 a[14:15], v87 offset:21504
    s_branch L_lw_13
L_lw_13_2:
    ds_read_b64_tr_b16 v[128:129], v84 offset:20480
    ds_read_b64_tr_b16 v[130:131], v84 offset:21504
    ds_read_b64_tr_b16 v[132:133], v86 offset:20480
    ds_read_b64_tr_b16 v[134:135], v86 offset:21504
    ds_read_b64_tr_b16 v[136:137], v85 offset:20480
    ds_read_b64_tr_b16 v[138:139], v85 offset:21504
    ds_read_b64_tr_b16 v[140:141], v87 offset:20480
    ds_read_b64_tr_b16 v[142:143], v87 offset:21504
L_lw_13:
    s_waitcnt lgkmcnt(0)
    s_waitcnt vmcnt(12)
    s_barrier
    s_add_u32 s79, s41, 13
    s_and_b32 s79, s79, 3
    s_lshl_b32 s79, s79, 19
    s_add_u32 s79, s79, s47
    s_add_u32 s46, s79, 0x600000
    s_add_u32 m0, s48, 86016
    s_nop 0
    buffer_load_dwordx4 v82, s[24:27], s46 offen  lds
    s_add_u32 s46, s79, 0x620000
    s_add_u32 m0, s48, 110592
    s_nop 0
    buffer_load_dwordx4 v82, s[24:27], s46 offen  lds
    s_add_u32 s46, s79, 0x640000
    s_add_u32 m0, s48, 135168
    s_nop 0
    buffer_load_dwordx4 v82, s[24:27], s46 offen  lds
    s_add_u32 s46, s79, 0x660000
    s_add_u32 m0, s48, 159744
    s_nop 0
    buffer_load_dwordx4 v82, s[24:27], s46 offen  lds
    s_cmp_lg_u32 s44, 0
    s_cbranch_scc1 L_lw_14_0
    ds_read_b64_tr_b16 a[216:217], v80 offset:0
    ds_read_b64_tr_b16 a[218:219], v80 offset:1024
    ds_read_b64_tr_b16 a[220:221], v80 offset:8192
    ds_read_b64_tr_b16 a[222:223], v80 offset:9216
    ds_read_b64_tr_b16 v[56:57], v81 offset:0
    ds_read_b64_tr_b16 v[58:59], v81 offset:1024
    ds_read_b64_tr_b16 v[60:61], v81 offset:8192
    ds_read_b64_tr_b16 v[62:63], v81 offset:9216
    s_waitcnt lgkmcnt(0)
    ds_write_b128 v5, v[56:59] offset:4096
    ds_write_b128 v5, v[60:63] offset:5120
    s_branch L_lw_14
L_lw_14_0:
    s_cmp_lg_u32 s44, 1
    s_cbranch_scc1 L_lw_14_1
    ds_read_b64_tr_b16 a[120:121], v80 offset:0
    ds_read_b64_tr_b16 a[122:123], v80 offset:1024
    ds_read_b64_tr_b16 a[124:125], v80 offset:8192
    ds_read_b64_tr_b16 a[126:127], v80 offset:9216
    ds_read_b64_tr_b16 v[56:57], v81 offset:0
    ds_read_b64_tr_b16 v[58:59], v81 offset:1024
    ds_read_b64_tr_b16 v[60:61], v81 offset:8192
    ds_read_b64_tr_b16 v[62:63], v81 offset:9216
    s_waitcnt lgkmcnt(0)
    ds_write_b128 v5, v[56:59] offset:6144
    ds_write_b128 v5, v[60:63] offset:7168
    s_branch L_lw_14
L_lw_14_1:
    s_cmp_lg_u32 s44, 2
    s_cbranch_scc1 L_lw_14_2
    ds_read_b64_tr_b16 a[32:33], v80 offset:0
    ds_read_b64_tr_b16 a[34:35], v80 offset:1024
    ds_read_b64_tr_b16 a[36:37], v80 offset:8192
    ds_read_b64_tr_b16 a[38:39], v80 offset:9216
    ds_read_b64_tr_b16 a[40:41], v81 offset:0
    ds_read_b64_tr_b16 a[42:43], v81 offset:1024
    ds_read_b64_tr_b16 a[44:45], v81 offset:8192
    ds_read_b64_tr_b16 a[46:47], v81 offset:9216
    s_branch L_lw_14
L_lw_14_2:
    ds_read_b64_tr_b16 v[160:161], v80 offset:0
    ds_read_b64_tr_b16 v[162:163], v80 offset:1024
    ds_read_b64_tr_b16 v[164:165], v80 offset:8192
    ds_read_b64_tr_b16 v[166:167], v80 offset:9216
    ds_read_b64_tr_b16 v[168:169], v81 offset:0
    ds_read_b64_tr_b16 v[170:171], v81 offset:1024
    ds_read_b64_tr_b16 v[172:173], v81 offset:8192
    ds_read_b64_tr_b16 v[174:175], v81 offset:9216
L_lw_14:
    s_waitcnt lgkmcnt(0)
    s_waitcnt vmcnt(12)
    s_barrier
    s_add_u32 s79, s41, 14
    s_and_b32 s79, s79, 3
    s_lshl_b32 s79, s79, 19
    s_add_u32 s79, s79, s47
    s_add_u32 s46, s79, 0x600000
    s_add_u32 m0, s48, 0
    s_nop 0
    buffer_load_dwordx4 v82, s[24:27], s46 offen  lds
    s_add_u32 s46, s79, 0x620000
    s_add_u32 m0, s48, 4096
    s_nop 0
    buffer_load_dwordx4 v82, s[24:27], s46 offen  lds
    s_add_u32 s46, s79, 0x640000
    s_add_u32 m0, s48, 8192
    s_nop 0
    buffer_load_dwordx4 v82, s[24:27], s46 offen  lds
    s_add_u32 s46, s79, 0x660000
    s_add_u32 m0, s48, 12288
    s_nop 0
    buffer_load_dwordx4 v82, s[24:27], s46 offen  lds
    s_cmp_lg_u32 s44, 0
    s_cbranch_scc1 L_lw_15_0
    ds_read_b64_tr_b16 a[240:241], v80 offset:16384
    ds_read_b64_tr_b16 a[242:243], v80 offset:17408
    ds_read_b64_tr_b16 a[244:245], v80 offset:24576
    ds_read_b64_tr_b16 a[246:247], v80 offset:25600
    ds_read_b64_tr_b16 v[56:57], v81 offset:16384
    ds_read_b64_tr_b16 v[58:59], v81 offset:17408
    ds_read_b64_tr_b16 v[60:61], v81 offset:24576
    ds_read_b64_tr_b16 v[62:63], v81 offset:25600
    s_waitcnt lgkmcnt(0)
    ds_write_b128 v5, v[56:59] offset:10240
    ds_write_b128 v5, v[60:63] offset:11264
    s_branch L_lw_15
L_lw_15_0:
    s_cmp_lg_u32 s44, 1
    s_cbranch_scc1 L_lw_15_1
    ds_read_b64_tr_b16 a[144:145], v80 offset:16384
    ds_read_b64_tr_b16 a[146:147], v80 offset:17408
    ds_read_b64_tr_b16 a[148:149], v80 offset:24576
    ds_read_b64_tr_b16 a[150:151], v80 offset:25600
    ds_read_b64_tr_b16 v[56:57], v81 offset:16384
    ds_read_b64_tr_b16 v[58:59], v81 offset:17408
    ds_read_b64_tr_b16 v[60:61], v81 offset:24576
    ds_read_b64_tr_b16 v[62:63], v81 offset:25600
    s_waitcnt lgkmcnt(0)
    ds_write_b128 v5, v[56:59] offset:12288
    ds_write_b128 v5, v[60:63] offset:13312
    s_branch L_lw_15
L_lw_15_1:
    s_cmp_lg_u32 s44, 2
    s_cbranch_scc1 L_lw_15_2
    ds_read_b64_tr_b16 a[64:65], v80 offset:16384
    ds_read_b64_tr_b16 a[66:67], v80 offset:17408
    ds_read_b64_tr_b16 a[68:69], v80 offset:24576
    ds_read_b64_tr_b16 a[70:71], v80 offset:25600
    ds_read_b64_tr_b16 v[56:57], v81 offset:16384
    ds_read_b64_tr_b16 v[58:59], v81 offset:17408
    ds_read_b64_tr_b16 v[60:61], v81 offset:24576
    ds_read_b64_tr_b16 v[62:63], v81 offset:25600
    s_waitcnt lgkmcnt(0)
    ds_write_b128 v5, v[56:59] offset:8192
    ds_write_b128 v5, v[60:63] offset:9216
    s_branch L_lw_15
L_lw_15_2:
    ds_read_b64_tr_b16 v[192:193], v80 offset:16384
    ds_read_b64_tr_b16 v[194:195], v80 offset:17408
    ds_read_b64_tr_b16 v[196:197], v80 offset:24576
    ds_read_b64_tr_b16 v[198:199], v80 offset:25600
    ds_read_b64_tr_b16 v[200:201], v81 offset:16384
    ds_read_b64_tr_b16 v[202:203], v81 offset:17408
    ds_read_b64_tr_b16 v[204:205], v81 offset:24576
    ds_read_b64_tr_b16 v[206:207], v81 offset:25600
L_lw_15:
    s_waitcnt lgkmcnt(0)
    s_waitcnt vmcnt(12)
    s_barrier
    s_add_u32 s79, s41, 15
    s_and_b32 s79, s79, 3
    s_lshl_b32 s79, s79, 19
    s_add_u32 s79, s79, s47
    s_add_u32 s46, s79, 0x600000
    s_add_u32 m0, s48, 16384
    s_nop 0
    buffer_load_dwordx4 v82, s[24:27], s46 offen  lds
    s_add_u32 s46, s79, 0x620000
    s_add_u32 m0, s48, 20480
    s_nop 0
    buffer_load_dwordx4 v82, s[24:27], s46 offen  lds
    s_add_u32 s46, s79, 0x640000
    s_add_u32 m0, s48, 24576
    s_nop 0
    buffer_load_dwordx4 v82, s[24:27], s46 offen  lds
    s_add_u32 s46, s79, 0x660000
    s_add_u32 m0, s48, 28672
    s_nop 0
    buffer_load_dwordx4 v82, s[24:27], s46 offen  lds
    s_cmp_lg_u32 s44, 0
    s_cbranch_scc1 L_lw_16_0
    ds_read_b64_tr_b16 v[104:105], v80 offset:32768
    ds_read_b64_tr_b16 v[106:107], v80 offset:33792
    ds_read_b64_tr_b16 v[108:109], v80 offset:40960
    ds_read_b64_tr_b16 v[110:111], v80 offset:41984
    ds_read_b64_tr_b16 v[56:57], v81 offset:32768
    ds_read_b64_tr_b16 v[58:59], v81 offset:33792
    ds_read_b64_tr_b16 v[60:61], v81 offset:40960
    ds_read_b64_tr_b16 v[62:63], v81 offset:41984
    s_waitcnt lgkmcnt(0)
    ds_write_b128 v5, v[56:59] offset:16384
    ds_write_b128 v5, v[60:63] offset:17408
    s_branch L_lw_16
L_lw_16_0:
    s_cmp_lg_u32 s44, 1
    s_cbranch_scc1 L_lw_16_1
    ds_read_b64_tr_b16 a[168:169], v80 offset:32768
    ds_read_b64_tr_b16 a[170:171], v80 offset:33792
    ds_read_b64_tr_b16 a[172:173], v80 offset:40960
    ds_read_b64_tr_b16 a[174:175], v80 offset:41984
    ds_read_b64_tr_b16 v[56:57], v81 offset:32768
    ds_read_b64_tr_b16 v[58:59], v81 offset:33792
    ds_read_b64_tr_b16 v[60:61], v81 offset:40960
    ds_read_b64_tr_b16 v[62:63], v81 offset:41984
    s_waitcnt lgkmcnt(0)
    ds_write_b128 v5, v[56:59] offset:18432
    ds_write_b128 v5, v[60:63] offset:19456
    s_branch L_lw_16
L_lw_16_1:
    s_cmp_lg_u32 s44, 2
    s_cbranch_scc1 L_lw_16_2
    ds_read_b64_tr_b16 a[80:81], v80 offset:32768
    ds_read_b64_tr_b16 a[82:83], v80 offset:33792
    ds_read_b64_tr_b16 a[84:85], v80 offset:40960
    ds_read_b64_tr_b16 a[86:87], v80 offset:41984
    ds_read_b64_tr_b16 v[56:57], v81 offset:32768
    ds_read_b64_tr_b16 v[58:59], v81 offset:33792
    ds_read_b64_tr_b16 v[60:61], v81 offset:40960
    ds_read_b64_tr_b16 v[62:63], v81 offset:41984
    s_waitcnt lgkmcnt(0)
    ds_write_b128 v5, v[56:59] offset:14336
    ds_write_b128 v5, v[60:63] offset:15360
    s_branch L_lw_16
L_lw_16_2:
    ds_read_b64_tr_b16 v[224:225], v80 offset:32768
    ds_read_b64_tr_b16 v[226:227], v80 offset:33792
    ds_read_b64_tr_b16 v[228:229], v80 offset:40960
    ds_read_b64_tr_b16 v[230:231], v80 offset:41984
    ds_read_b64_tr_b16 v[232:233], v81 offset:32768
    ds_read_b64_tr_b16 v[234:235], v81 offset:33792
    ds_read_b64_tr_b16 v[236:237], v81 offset:40960
    ds_read_b64_tr_b16 v[238:239], v81 offset:41984
L_lw_16:
    s_waitcnt lgkmcnt(0)
    s_waitcnt vmcnt(12)
    s_barrier
    s_add_u32 s79, s41, 0
    s_and_b32 s79, s79, 3
    s_lshl_b32 s79, s79, 19
    s_add_u32 s79, s79, s47
    s_add_u32 s46, s79, 0x0
    s_add_u32 m0, s48, 32768
    s_nop 0
    buffer_load_dwordx4 v82, s[28:31], s46 offen  lds
    s_add_u32 s46, s79, 0x20000
    s_add_u32 m0, s48, 36864
    s_nop 0
    buffer_load_dwordx4 v82, s[28:31], s46 offen  lds
    s_add_u32 s46, s79, 0x40000
    s_add_u32 m0, s48, 40960
    s_nop 0
    buffer_load_dwordx4 v82, s[28:31], s46 offen  lds
    s_add_u32 s46, s79, 0x60000
    s_add_u32 m0, s48, 45056
    s_nop 0
    buffer_load_dwordx4 v82, s[28:31], s46 offen  lds
    s_cmp_lg_u32 s44, 0
    s_cbranch_scc1 L_lw_17_0
    ds_read_b64_tr_b16 v[128:129], v80 offset:49152
    ds_read_b64_tr_b16 v[130:131], v80 offset:50176
    ds_read_b64_tr_b16 v[132:133], v80 offset:57344
    ds_read_b64_tr_b16 v[134:135], v80 offset:58368
    ds_read_b64_tr_b16 v[136:137], v81 offset:49152
    ds_read_b64_tr_b16 v[138:139], v81 offset:50176
    ds_read_b64_tr_b16 v[140:141], v81 offset:57344
    ds_read_b64_tr_b16 v[142:143], v81 offset:58368
    s_branch L_lw_17
L_lw_17_0:
    s_cmp_lg_u32 s44, 1
    s_cbranch_scc1 L_lw_17_1
    ds_read_b64_tr_b16 a[192:193], v80 offset:49152
    ds_read_b64_tr_b16 a[194:195], v80 offset:50176
    ds_read_b64_tr_b16 a[196:197], v80 offset:57344
    ds_read_b64_tr_b16 a[198:199], v80 offset:58368
    ds_read_b64_tr_b16 v[56:57], v81 offset:49152
    ds_read_b64_tr_b16 v[58:59], v81 offset:50176
    ds_read_b64_tr_b16 v[60:61], v81 offset:57344
    ds_read_b64_tr_b16 v[62:63], v81 offset:58368
    s_waitcnt lgkmcnt(0)
    ds_write_b128 v5, v[56:59] offset:0
    ds_write_b128 v5, v[60:63] offset:1024
    s_branch L_lw_17
L_lw_17_1:
    s_cmp_lg_u32 s44, 2
    s_cbranch_scc1 L_lw_17_2
    ds_read_b64_tr_b16 a[96:97], v80 offset:49152
    ds_read_b64_tr_b16 a[98:99], v80 offset:50176
    ds_read_b64_tr_b16 a[100:101], v80 offset:57344
    ds_read_b64_tr_b16 a[102:103], v80 offset:58368
    ds_read_b64_tr_b16 v[56:57], v81 offset:49152
    ds_read_b64_tr_b16 v[58:59], v81 offset:50176
    ds_read_b64_tr_b16 v[60:61], v81 offset:57344
    ds_read_b64_tr_b16 v[62:63], v81 offset:58368
    s_waitcnt lgkmcnt(0)
    ds_write_b128 v5, v[56:59] offset:2048
    ds_write_b128 v5, v[60:63] offset:3072
    s_branch L_lw_17
L_lw_17_2:
    ds_read_b64_tr_b16 a[0:1], v80 offset:49152
    ds_read_b64_tr_b16 a[2:3], v80 offset:50176
    ds_read_b64_tr_b16 a[4:5], v80 offset:57344
    ds_read_b64_tr_b16 a[6:7], v80 offset:58368
    ds_read_b64_tr_b16 a[8:9], v81 offset:49152
    ds_read_b64_tr_b16 a[10:11], v81 offset:50176
    ds_read_b64_tr_b16 a[12:13], v81 offset:57344
    ds_read_b64_tr_b16 a[14:15], v81 offset:58368
L_lw_17:
    s_waitcnt lgkmcnt(0)
    s_waitcnt vmcnt(12)
    s_barrier
    s_add_u32 s79, s41, 1
    s_and_b32 s79, s79, 3
    s_lshl_b32 s79, s79, 19
    s_add_u32 s79, s79, s47
    s_add_u32 s46, s79, 0x0
    s_add_u32 m0, s48, 49152
    s_nop 0
    buffer_load_dwordx4 v82, s[28:31], s46 offen  lds
    s_add_u32 s46, s79, 0x20000
    s_add_u32 m0, s48, 53248
    s_nop 0
    buffer_load_dwordx4 v82, s[28:31], s46 offen  lds
    s_add_u32 s46, s79, 0x40000
    s_add_u32 m0, s48, 57344
    s_nop 0
    buffer_load_dwordx4 v82, s[28:31], s46 offen  lds
    s_add_u32 s46, s79, 0x60000
    s_add_u32 m0, s48, 61440
    s_nop 0
    buffer_load_dwordx4 v82, s[28:31], s46 offen  lds
    s_cmp_lg_u32 s44, 0
    s_cbranch_scc1 L_lw_18_0
    ds_read_b64_tr_b16 v[160:161], v84 offset:20480
    ds_read_b64_tr_b16 v[162:163], v84 offset:21504
    ds_read_b64_tr_b16 v[164:165], v86 offset:20480
    ds_read_b64_tr_b16 v[166:167], v86 offset:21504
    ds_read_b64_tr_b16 v[168:169], v85 offset:20480
    ds_read_b64_tr_b16 v[170:171], v85 offset:21504
    ds_read_b64_tr_b16 v[172:173], v87 offset:20480
    ds_read_b64_tr_b16 v[174:175], v87 offset:21504
    s_branch L_lw_18
L_lw_18_0:
    s_cmp_lg_u32 s44, 1
    s_cbranch_scc1 L_lw_18_1
    ds_read_b64_tr_b16 a[216:217], v84 offset:20480
    ds_read_b64_tr_b16 a[218:219], v84 offset:21504
    ds_read_b64_tr_b16 a[220:221], v86 offset:20480
    ds_read_b64_tr_b16 a[222:223], v86 offset:21504
    ds_read_b64_tr_b16 v[56:57], v85 offset:20480
    ds_read_b64_tr_b16 v[58:59], v85 offset:21504
    ds_read_b64_tr_b16 v[60:61], v87 offset:20480
    ds_read_b64_tr_b16 v[62:63], v87 offset:21504
    s_waitcnt lgkmcnt(0)
    ds_write_b128 v5, v[56:59] offset:4096
    ds_write_b128 v5, v[60:63] offset:5120
    s_branch L_lw_18
L_lw_18_1:
    s_cmp_lg_u32 s44, 2
    s_cbranch_scc1 L_lw_18_2
    ds_read_b64_tr_b16 a[120:121], v84 offset:20480
    ds_read_b64_tr_b16 a[122:123], v84 offset:21504
    ds_read_b64_tr_b16 a[124:125], v86 offset:20480
    ds_read_b64_tr_b16 a[126:127], v86 offset:21504
    ds_read_b64_tr_b16 v[56:57], v85 offset:20480
    ds_read_b64_tr_b16 v[58:59], v85 offset:21504
    ds_read_b64_tr_b16 v[60:61], v87 offset:20480
    ds_read_b64_tr_b16 v[62:63], v87 offset:21504
    s_waitcnt lgkmcnt(0)
    ds_write_b128 v5, v[56:59] offset:6144
    ds_write_b128 v5, v[60:63] offset:7168
    s_branch L_lw_18
L_lw_18_2:
    ds_read_b64_tr_b16 a[32:33], v84 offset:20480
    ds_read_b64_tr_b16 a[34:35], v84 offset:21504
    ds_read_b64_tr_b16 a[36:37], v86 offset:20480
    ds_read_b64_tr_b16 a[38:39], v86 offset:21504
    ds_read_b64_tr_b16 a[40:41], v85 offset:20480
    ds_read_b64_tr_b16 a[42:43], v85 offset:21504
    ds_read_b64_tr_b16 a[44:45], v87 offset:20480
    ds_read_b64_tr_b16 a[46:47], v87 offset:21504
L_lw_18:
    s_waitcnt lgkmcnt(0)
    s_waitcnt vmcnt(12)
    s_barrier
    s_cmp_lg_u32 s44, 0
    s_cbranch_scc1 L_lw_19_0
    ds_read_b64_tr_b16 v[192:193], v80 offset:0
    ds_read_b64_tr_b16 v[194:195], v80 offset:1024
    ds_read_b64_tr_b16 v[196:197], v80 offset:8192
    ds_read_b64_tr_b16 v[198:199], v80 offset:9216
    ds_read_b64_tr_b16 v[200:201], v81 offset:0
    ds_read_b64_tr_b16 v[202:203], v81 offset:1024
    ds_read_b64_tr_b16 v[204:205], v81 offset:8192
    ds_read_b64_tr_b16 v[206:207], v81 offset:9216
    s_branch L_lw_19
L_lw_19_0:
    s_cmp_lg_u32 s44, 1
    s_cbranch_scc1 L_lw_19_1
    ds_read_b64_tr_b16 a[240:241], v80 offset:0
    ds_read_b64_tr_b16 a[242:243], v80 offset:1024
    ds_read_b64_tr_b16 a[244:245], v80 offset:8192
    ds_read_b64_tr_b16 a[246:247], v80 offset:9216
    ds_read_b64_tr_b16 v[56:57], v81 offset:0
    ds_read_b64_tr_b16 v[58:59], v81 offset:1024
    ds_read_b64_tr_b16 v[60:61], v81 offset:8192
    ds_read_b64_tr_b16 v[62:63], v81 offset:9216
    s_waitcnt lgkmcnt(0)
    ds_write_b128 v5, v[56:59] offset:10240
    ds_write_b128 v5, v[60:63] offset:11264
    s_branch L_lw_19
L_lw_19_1:
    s_cmp_lg_u32 s44, 2
    s_cbranch_scc1 L_lw_19_2
    ds_read_b64_tr_b16 a[144:145], v80 offset:0
    ds_read_b64_tr_b16 a[146:147], v80 offset:1024
    ds_read_b64_tr_b16 a[148:149], v80 offset:8192
    ds_read_b64_tr_b16 a[150:151], v80 offset:9216
    ds_read_b64_tr_b16 v[56:57], v81 offset:0
    ds_read_b64_tr_b16 v[58:59], v81 offset:1024
    ds_read_b64_tr_b16 v[60:61], v81 offset:8192
    ds_read_b64_tr_b16 v[62:63], v81 offset:9216
    s_waitcnt lgkmcnt(0)
    ds_write_b128 v5, v[56:59] offset:12288
    ds_write_b128 v5, v[60:63] offset:13312
    s_branch L_lw_19
L_lw_19_2:
    ds_read_b64_tr_b16 a[64:65], v80 offset:0
    ds_read_b64_tr_b16 a[66:67], v80 offset:1024
    ds_read_b64_tr_b16 a[68:69], v80 offset:8192
    ds_read_b64_tr_b16 a[70:71], v80 offset:9216
    ds_read_b64_tr_b16 v[56:57], v81 offset:0
    ds_read_b64_tr_b16 v[58:59], v81 offset:1024
    ds_read_b64_tr_b16 v[60:61], v81 offset:8192
    ds_read_b64_tr_b16 v[62:63], v81 offset:9216
    s_waitcnt lgkmcnt(0)
    ds_write_b128 v5, v[56:59] offset:8192
    ds_write_b128 v5, v[60:63] offset:9216
L_lw_19:
    s_waitcnt lgkmcnt(0)
    s_waitcnt vmcnt(8)
    s_barrier
    s_add_u32 s79, s41, 2
    s_and_b32 s79, s79, 3
    s_lshl_b32 s79, s79, 19
    s_add_u32 s79, s79, s47
    s_add_u32 s46, s79, 0x0
    s_add_u32 m0, s48, 0
    s_nop 0
    buffer_load_dwordx4 v82, s[28:31], s46 offen  lds
    s_add_u32 s46, s79, 0x20000
    s_add_u32 m0, s48, 4096
    s_nop 0
    buffer_load_dwordx4 v82, s[28:31], s46 offen  lds
    s_add_u32 s46, s79, 0x40000
    s_add_u32 m0, s48, 8192
    s_nop 0
    buffer_load_dwordx4 v82, s[28:31], s46 offen  lds
    s_add_u32 s46, s79, 0x60000
    s_add_u32 m0, s48, 12288
    s_nop 0
    buffer_load_dwordx4 v82, s[28:31], s46 offen  lds
    s_cmp_lg_u32 s44, 0
    s_cbranch_scc1 L_lw_20_0
    ds_read_b64_tr_b16 v[224:225], v80 offset:16384
    ds_read_b64_tr_b16 v[226:227], v80 offset:17408
    ds_read_b64_tr_b16 v[228:229], v80 offset:24576
    ds_read_b64_tr_b16 v[230:231], v80 offset:25600
    ds_read_b64_tr_b16 v[232:233], v81 offset:16384
    ds_read_b64_tr_b16 v[234:235], v81 offset:17408
    ds_read_b64_tr_b16 v[236:237], v81 offset:24576
    ds_read_b64_tr_b16 v[238:239], v81 offset:25600
    s_branch L_lw_20
L_lw_20_0:
    s_cmp_lg_u32 s44, 1
    s_cbranch_scc1 L_lw_20_1
    ds_read_b64_tr_b16 v[104:105], v80 offset:16384
    ds_read_b64_tr_b16 v[106:107], v80 offset:17408
    ds_read_b64_tr_b16 v[108:109], v80 offset:24576
    ds_read_b64_tr_b16 v[110:111], v80 offset:25600
    ds_read_b64_tr_b16 v[56:57], v81 offset:16384
    ds_read_b64_tr_b16 v[58:59], v81 offset:17408
    ds_read_b64_tr_b16 v[60:61], v81 offset:24576
    ds_read_b64_tr_b16 v[62:63], v81 offset:25600
    s_waitcnt lgkmcnt(0)
    ds_write_b128 v5, v[56:59] offset:16384
    ds_write_b128 v5, v[60:63] offset:17408
    s_branch L_lw_20
L_lw_20_1:
    s_cmp_lg_u32 s44, 2
    s_cbranch_scc1 L_lw_20_2
    ds_read_b64_tr_b16 a[168:169], v80 offset:16384
    ds_read_b64_tr_b16 a[170:171], v80 offset:17408
    ds_read_b64_tr_b16 a[172:173], v80 offset:24576
    ds_read_b64_tr_b16 a[174:175], v80 offset:25600
    ds_read_b64_tr_b16 v[56:57], v81 offset:16384
    ds_read_b64_tr_b16 v[58:59], v81 offset:17408
    ds_read_b64_tr_b16 v[60:61], v81 offset:24576
    ds_read_b64_tr_b16 v[62:63], v81 offset:25600
    s_waitcnt lgkmcnt(0)
    ds_write_b128 v5, v[56:59] offset:18432
    ds_write_b128 v5, v[60:63] offset:19456
    s_branch L_lw_20
L_lw_20_2:
    ds_read_b64_tr_b16 a[80:81], v80 offset:16384
    ds_read_b64_tr_b16 a[82:83], v80 offset:17408
    ds_read_b64_tr_b16 a[84:85], v80 offset:24576
    ds_read_b64_tr_b16 a[86:87], v80 offset:25600
    ds_read_b64_tr_b16 v[56:57], v81 offset:16384
    ds_read_b64_tr_b16 v[58:59], v81 offset:17408
    ds_read_b64_tr_b16 v[60:61], v81 offset:24576
    ds_read_b64_tr_b16 v[62:63], v81 offset:25600
    s_waitcnt lgkmcnt(0)
    ds_write_b128 v5, v[56:59] offset:14336
    ds_write_b128 v5, v[60:63] offset:15360
L_lw_20:
    s_waitcnt lgkmcnt(0)
    s_waitcnt vmcnt(8)
    s_barrier
    s_add_u32 s79, s41, 3
    s_and_b32 s79, s79, 3
    s_lshl_b32 s79, s79, 19
    s_add_u32 s79, s79, s47
    s_add_u32 s46, s79, 0x0
    s_add_u32 m0, s48, 16384
    s_nop 0
    buffer_load_dwordx4 v82, s[28:31], s46 offen  lds
    s_add_u32 s46, s79, 0x20000
    s_add_u32 m0, s48, 20480
    s_nop 0
    buffer_load_dwordx4 v82, s[28:31], s46 offen  lds
    s_add_u32 s46, s79, 0x40000
    s_add_u32 m0, s48, 24576
    s_nop 0
    buffer_load_dwordx4 v82, s[28:31], s46 offen  lds
    s_add_u32 s46, s79, 0x60000
    s_add_u32 m0, s48, 28672
    s_nop 0
    buffer_load_dwordx4 v82, s[28:31], s46 offen  lds
    s_cmp_lg_u32 s44, 0
    s_cbranch_scc1 L_lw_21_0
    ds_read_b64_tr_b16 a[16:17], v80 offset:32768
    ds_read_b64_tr_b16 a[18:19], v80 offset:33792
    ds_read_b64_tr_b16 a[20:21], v80 offset:40960
    ds_read_b64_tr_b16 a[22:23], v80 offset:41984
    ds_read_b64_tr_b16 a[24:25], v81 offset:32768
    ds_read_b64_tr_b16 a[26:27], v81 offset:33792
    ds_read_b64_tr_b16 a[28:29], v81 offset:40960
    ds_read_b64_tr_b16 a[30:31], v81 offset:41984
    s_branch L_lw_21
L_lw_21_0:
    s_cmp_lg_u32 s44, 1
    s_cbranch_scc1 L_lw_21_1
    ds_read_b64_tr_b16 v[144:145], v80 offset:32768
    ds_read_b64_tr_b16 v[146:147], v80 offset:33792
    ds_read_b64_tr_b16 v[148:149], v80 offset:40960
    ds_read_b64_tr_b16 v[150:151], v80 offset:41984
    ds_read_b64_tr_b16 v[152:153], v81 offset:32768
    ds_read_b64_tr_b16 v[154:155], v81 offset:33792
    ds_read_b64_tr_b16 v[156:157], v81 offset:40960
    ds_read_b64_tr_b16 v[158:159], v81 offset:41984
    s_branch L_lw_21
L_lw_21_1:
    s_cmp_lg_u32 s44, 2
    s_cbranch_scc1 L_lw_21_2
    ds_read_b64_tr_b16 a[200:201], v80 offset:32768
    ds_read_b64_tr_b16 a[202:203], v80 offset:33792
    ds_read_b64_tr_b16 a[204:205], v80 offset:40960
    ds_read_b64_tr_b16 a[206:207], v80 offset:41984
    ds_read_b64_tr_b16 a[208:209], v81 offset:32768
    ds_read_b64_tr_b16 a[210:211], v81 offset:33792
    ds_read_b64_tr_b16 a[212:213], v81 offset:40960
    ds_read_b64_tr_b16 a[214:215], v81 offset:41984
    s_branch L_lw_21
L_lw_21_2:
    ds_read_b64_tr_b16 a[104:105], v80 offset:32768
    ds_read_b64_tr_b16 a[106:107], v80 offset:33792
    ds_read_b64_tr_b16 a[108:109], v80 offset:40960
    ds_read_b64_tr_b16 a[110:111], v80 offset:41984
    ds_read_b64_tr_b16 a[112:113], v81 offset:32768
    ds_read_b64_tr_b16 a[114:115], v81 offset:33792
    ds_read_b64_tr_b16 a[116:117], v81 offset:40960
    ds_read_b64_tr_b16 a[118:119], v81 offset:41984
L_lw_21:
    s_waitcnt lgkmcnt(0)
    s_waitcnt vmcnt(8)
    s_barrier
    s_add_u32 s79, s41, 4
    s_and_b32 s79, s79, 3
    s_lshl_b32 s79, s79, 19
    s_add_u32 s79, s79, s47
    s_add_u32 s46, s79, 0x200000
    s_add_u32 m0, s48, 32768
    s_nop 0
    buffer_load_dwordx4 v82, s[28:31], s46 offen  lds
    s_add_u32 s46, s79, 0x220000
    s_add_u32 m0, s48, 36864
    s_nop 0
    buffer_load_dwordx4 v82, s[28:31], s46 offen  lds
    s_add_u32 s46, s79, 0x240000
    s_add_u32 m0, s48, 40960
    s_nop 0
    buffer_load_dwordx4 v82, s[28:31], s46 offen  lds
    s_add_u32 s46, s79, 0x260000
    s_add_u32 m0, s48, 45056
    s_nop 0
    buffer_load_dwordx4 v82, s[28:31], s46 offen  lds
    s_cmp_lg_u32 s44, 0
    s_cbranch_scc1 L_lw_22_0
    ds_read_b64_tr_b16 a[48:49], v80 offset:49152
    ds_read_b64_tr_b16 a[50:51], v80 offset:50176
    ds_read_b64_tr_b16 a[52:53], v80 offset:57344
    ds_read_b64_tr_b16 a[54:55], v80 offset:58368
    ds_read_b64_tr_b16 a[56:57], v81 offset:49152
    ds_read_b64_tr_b16 a[58:59], v81 offset:50176
    ds_read_b64_tr_b16 a[60:61], v81 offset:57344
    ds_read_b64_tr_b16 a[62:63], v81 offset:58368
    s_branch L_lw_22
L_lw_22_0:
    s_cmp_lg_u32 s44, 1
    s_cbranch_scc1 L_lw_22_1
    ds_read_b64_tr_b16 v[176:177], v80 offset:49152
    ds_read_b64_tr_b16 v[178:179], v80 offset:50176
    ds_read_b64_tr_b16 v[180:181], v80 offset:57344
    ds_read_b64_tr_b16 v[182:183], v80 offset:58368
    ds_read_b64_tr_b16 v[184:185], v81 offset:49152
    ds_read_b64_tr_b16 v[186:187], v81 offset:50176
    ds_read_b64_tr_b16 v[188:189], v81 offset:57344
    ds_read_b64_tr_b16 v[190:191], v81 offset:58368
    s_branch L_lw_22
L_lw_22_1:
    s_cmp_lg_u32 s44, 2
    s_cbranch_scc1 L_lw_22_2
    ds_read_b64_tr_b16 a[224:225], v80 offset:49152
    ds_read_b64_tr_b16 a[226:227], v80 offset:50176
    ds_read_b64_tr_b16 a[228:229], v80 offset:57344
    ds_read_b64_tr_b16 a[230:231], v80 offset:58368
    ds_read_b64_tr_b16 a[232:233], v81 offset:49152
    ds_read_b64_tr_b16 a[234:235], v81 offset:50176
    ds_read_b64_tr_b16 a[236:237], v81 offset:57344
    ds_read_b64_tr_b16 a[238:239], v81 offset:58368
    s_branch L_lw_22
L_lw_22_2:
    ds_read_b64_tr_b16 a[128:129], v80 offset:49152
    ds_read_b64_tr_b16 a[130:131], v80 offset:50176
    ds_read_b64_tr_b16 a[132:133], v80 offset:57344
    ds_read_b64_tr_b16 a[134:135], v80 offset:58368
    ds_read_b64_tr_b16 a[136:137], v81 offset:49152
    ds_read_b64_tr_b16 a[138:139], v81 offset:50176
    ds_read_b64_tr_b16 a[140:141], v81 offset:57344
    ds_read_b64_tr_b16 a[142:143], v81 offset:58368
L_lw_22:
    s_waitcnt lgkmcnt(0)
    s_waitcnt vmcnt(8)
    s_barrier
    s_add_u32 s79, s41, 5
    s_and_b32 s79, s79, 3
    s_lshl_b32 s79, s79, 19
    s_add_u32 s79, s79, s47
    s_add_u32 s46, s79, 0x200000
    s_add_u32 m0, s48, 49152
    s_nop 0
    buffer_load_dwordx4 v82, s[28:31], s46 offen  lds
    s_add_u32 s46, s79, 0x220000
    s_add_u32 m0, s48, 53248
    s_nop 0
    buffer_load_dwordx4 v82, s[28:31], s46 offen  lds
    s_add_u32 s46, s79, 0x240000
    s_add_u32 m0, s48, 57344
    s_nop 0
    buffer_load_dwordx4 v82, s[28:31], s46 offen  lds
    s_add_u32 s46, s79, 0x260000
    s_add_u32 m0, s48, 61440
    s_nop 0
    buffer_load_dwordx4 v82, s[28:31], s46 offen  lds
    s_cmp_lg_u32 s44, 0
    s_cbranch_scc1 L_lw_23_0
    ds_read_b64_tr_b16 a[72:73], v80 offset:0
    ds_read_b64_tr_b16 a[74:75], v80 offset:1024
    ds_read_b64_tr_b16 a[76:77], v80 offset:8192
    ds_read_b64_tr_b16 a[78:79], v80 offset:9216
    ds_read_b64_tr_b16 v[56:57], v81 offset:0
    ds_read_b64_tr_b16 v[58:59], v81 offset:1024
    ds_read_b64_tr_b16 v[60:61], v81 offset:8192
    ds_read_b64_tr_b16 v[62:63], v81 offset:9216
    s_waitcnt lgkmcnt(0)
    ds_write_b128 v5, v[56:59] offset:20480
    ds_write_b128 v5, v[60:63] offset:21504
    s_branch L_lw_23
L_lw_23_0:
    s_cmp_lg_u32 s44, 1
    s_cbranch_scc1 L_lw_23_1
    ds_read_b64_tr_b16 v[208:209], v80 offset:0
    ds_read_b64_tr_b16 v[210:211], v80 offset:1024
    ds_read_b64_tr_b16 v[212:213], v80 offset:8192
    ds_read_b64_tr_b16 v[214:215], v80 offset:9216
    ds_read_b64_tr_b16 v[216:217], v81 offset:0
    ds_read_b64_tr_b16 v[218:219], v81 offset:1024
    ds_read_b64_tr_b16 v[220:221], v81 offset:8192
    ds_read_b64_tr_b16 v[222:223], v81 offset:9216
    s_branch L_lw_23
L_lw_23_1:
    s_cmp_lg_u32 s44, 2
    s_cbranch_scc1 L_lw_23_2
    ds_read_b64_tr_b16 a[248:249], v80 offset:0
    ds_read_b64_tr_b16 a[250:251], v80 offset:1024
    ds_read_b64_tr_b16 a[252:253], v80 offset:8192
    ds_read_b64_tr_b16 a[254:255], v80 offset:9216
    ds_read_b64_tr_b16 v[96:97], v81 offset:0
    ds_read_b64_tr_b16 v[98:99], v81 offset:1024
    ds_read_b64_tr_b16 v[100:101], v81 offset:8192
    ds_read_b64_tr_b16 v[102:103], v81 offset:9216
    s_branch L_lw_23
L_lw_23_2:
    ds_read_b64_tr_b16 a[152:153], v80 offset:0
    ds_read_b64_tr_b16 a[154:155], v80 offset:1024
    ds_read_b64_tr_b16 a[156:157], v80 offset:8192
    ds_read_b64_tr_b16 a[158:159], v80 offset:9216
    ds_read_b64_tr_b16 a[160:161], v81 offset:0
    ds_read_b64_tr_b16 a[162:163], v81 offset:1024
    ds_read_b64_tr_b16 a[164:165], v81 offset:8192
    ds_read_b64_tr_b16 a[166:167], v81 offset:9216
L_lw_23:
    s_waitcnt lgkmcnt(0)
    s_waitcnt vmcnt(8)
    s_barrier
    s_add_u32 s79, s41, 6
    s_and_b32 s79, s79, 3
    s_lshl_b32 s79, s79, 19
    s_add_u32 s79, s79, s47
    s_add_u32 s46, s79, 0x200000
    s_add_u32 m0, s48, 0
    s_nop 0
    buffer_load_dwordx4 v82, s[28:31], s46 offen  lds
    s_add_u32 s46, s79, 0x220000
    s_add_u32 m0, s48, 4096
    s_nop 0
    buffer_load_dwordx4 v82, s[28:31], s46 offen  lds
    s_add_u32 s46, s79, 0x240000
    s_add_u32 m0, s48, 8192
    s_nop 0
    buffer_load_dwordx4 v82, s[28:31], s46 offen  lds
    s_add_u32 s46, s79, 0x260000
    s_add_u32 m0, s48, 12288
    s_nop 0
    buffer_load_dwordx4 v82, s[28:31], s46 offen  lds
    s_cmp_lg_u32 s44, 0
    s_cbranch_scc1 L_lw_24_0
    ds_read_b64_tr_b16 a[88:89], v80 offset:16384
    ds_read_b64_tr_b16 a[90:91], v80 offset:17408
    ds_read_b64_tr_b16 a[92:93], v80 offset:24576
    ds_read_b64_tr_b16 a[94:95], v80 offset:25600
    ds_read_b64_tr_b16 v[56:57], v81 offset:16384
    ds_read_b64_tr_b16 v[58:59], v81 offset:17408
    ds_read_b64_tr_b16 v[60:61], v81 offset:24576
    ds_read_b64_tr_b16 v[62:63], v81 offset:25600
    s_waitcnt lgkmcnt(0)
    ds_write_b128 v5, v[56:59] offset:22528
    ds_write_b128 v5, v[60:63] offset:23552
    s_branch L_lw_24
L_lw_24_0:
    s_cmp_lg_u32 s44, 1
    s_cbranch_scc1 L_lw_24_1
    ds_read_b64_tr_b16 v[240:241], v80 offset:16384
    ds_read_b64_tr_b16 v[242:243], v80 offset:17408
    ds_read_b64_tr_b16 v[244:245], v80 offset:24576
    ds_read_b64_tr_b16 v[246:247], v80 offset:25600
    ds_read_b64_tr_b16 v[248:249], v81 offset:16384
    ds_read_b64_tr_b16 v[250:251], v81 offset:17408
    ds_read_b64_tr_b16 v[252:253], v81 offset:24576
    ds_read_b64_tr_b16 v[254:255], v81 offset:25600
    s_branch L_lw_24
L_lw_24_1:
    s_cmp_lg_u32 s44, 2
    s_cbranch_scc1 L_lw_24_2
    ds_read_b64_tr_b16 v[112:113], v80 offset:16384
    ds_read_b64_tr_b16 v[114:115], v80 offset:17408
    ds_read_b64_tr_b16 v[116:117], v80 offset:24576
    ds_read_b64_tr_b16 v[118:119], v80 offset:25600
    ds_read_b64_tr_b16 v[120:121], v81 offset:16384
    ds_read_b64_tr_b16 v[122:123], v81 offset:17408
    ds_read_b64_tr_b16 v[124:125], v81 offset:24576
    ds_read_b64_tr_b16 v[126:127], v81 offset:25600
    s_branch L_lw_24
L_lw_24_2:
    ds_read_b64_tr_b16 a[176:177], v80 offset:16384
    ds_read_b64_tr_b16 a[178:179], v80 offset:17408
    ds_read_b64_tr_b16 a[180:181], v80 offset:24576
    ds_read_b64_tr_b16 a[182:183], v80 offset:25600
    ds_read_b64_tr_b16 a[184:185], v81 offset:16384
    ds_read_b64_tr_b16 a[186:187], v81 offset:17408
    ds_read_b64_tr_b16 a[188:189], v81 offset:24576
    ds_read_b64_tr_b16 a[190:191], v81 offset:25600
L_lw_24:
    s_waitcnt lgkmcnt(0)
    s_waitcnt vmcnt(8)
    s_barrier
    s_add_u32 s79, s41, 7
    s_and_b32 s79, s79, 3
    s_lshl_b32 s79, s79, 19
    s_add_u32 s79, s79, s47
    s_add_u32 s46, s79, 0x200000
    s_add_u32 m0, s48, 16384
    s_nop 0
    buffer_load_dwordx4 v82, s[28:31], s46 offen  lds
    s_add_u32 s46, s79, 0x220000
    s_add_u32 m0, s48, 20480
    s_nop 0
    buffer_load_dwordx4 v82, s[28:31], s46 offen  lds
    s_add_u32 s46, s79, 0x240000
    s_add_u32 m0, s48, 24576
    s_nop 0
    buffer_load_dwordx4 v82, s[28:31], s46 offen  lds
    s_add_u32 s46, s79, 0x260000
    s_add_u32 m0, s48, 28672
    s_nop 0
    buffer_load_dwordx4 v82, s[28:31], s46 offen  lds
    s_cmp_lg_u32 s44, 0
    s_cbranch_scc1 L_lw_25_0
    ds_read_b64_tr_b16 a[104:105], v80 offset:32768
    ds_read_b64_tr_b16 a[106:107], v80 offset:33792
    ds_read_b64_tr_b16 a[108:109], v80 offset:40960
    ds_read_b64_tr_b16 a[110:111], v80 offset:41984
    ds_read_b64_tr_b16 a[112:113], v81 offset:32768
    ds_read_b64_tr_b16 a[114:115], v81 offset:33792
    ds_read_b64_tr_b16 a[116:117], v81 offset:40960
    ds_read_b64_tr_b16 a[118:119], v81 offset:41984
    s_branch L_lw_25
L_lw_25_0:
    s_cmp_lg_u32 s44, 1
    s_cbranch_scc1 L_lw_25_1
    ds_read_b64_tr_b16 a[16:17], v80 offset:32768
    ds_read_b64_tr_b16 a[18:19], v80 offset:33792
    ds_read_b64_tr_b16 a[20:21], v80 offset:40960
    ds_read_b64_tr_b16 a[22:23], v80 offset:41984
    ds_read_b64_tr_b16 a[24:25], v81 offset:32768
    ds_read_b64_tr_b16 a[26:27], v81 offset:33792
    ds_read_b64_tr_b16 a[28:29], v81 offset:40960
    ds_read_b64_tr_b16 a[30:31], v81 offset:41984
    s_branch L_lw_25
L_lw_25_1:
    s_cmp_lg_u32 s44, 2
    s_cbranch_scc1 L_lw_25_2
    ds_read_b64_tr_b16 v[144:145], v80 offset:32768
    ds_read_b64_tr_b16 v[146:147], v80 offset:33792
    ds_read_b64_tr_b16 v[148:149], v80 offset:40960
    ds_read_b64_tr_b16 v[150:151], v80 offset:41984
    ds_read_b64_tr_b16 v[152:153], v81 offset:32768
    ds_read_b64_tr_b16 v[154:155], v81 offset:33792
    ds_read_b64_tr_b16 v[156:157], v81 offset:40960
    ds_read_b64_tr_b16 v[158:159], v81 offset:41984
    s_branch L_lw_25
L_lw_25_2:
    ds_read_b64_tr_b16 a[200:201], v80 offset:32768
    ds_read_b64_tr_b16 a[202:203], v80 offset:33792
    ds_read_b64_tr_b16 a[204:205], v80 offset:40960
    ds_read_b64_tr_b16 a[206:207], v80 offset:41984
    ds_read_b64_tr_b16 a[208:209], v81 offset:32768
    ds_read_b64_tr_b16 a[210:211], v81 offset:33792
    ds_read_b64_tr_b16 a[212:213], v81 offset:40960
    ds_read_b64_tr_b16 a[214:215], v81 offset:41984
L_lw_25:
    s_waitcnt lgkmcnt(0)
    s_waitcnt vmcnt(8)
    s_barrier
    s_add_u32 s79, s41, 8
    s_and_b32 s79, s79, 3
    s_lshl_b32 s79, s79, 19
    s_add_u32 s79, s79, s47
    s_add_u32 s46, s79, 0x400000
    s_add_u32 m0, s48, 32768
    s_nop 0
    buffer_load_dwordx4 v82, s[28:31], s46 offen  lds
    s_add_u32 s46, s79, 0x420000
    s_add_u32 m0, s48, 36864
    s_nop 0
    buffer_load_dwordx4 v82, s[28:31], s46 offen  lds
    s_add_u32 s46, s79, 0x440000
    s_add_u32 m0, s48, 40960
    s_nop 0
    buffer_load_dwordx4 v82, s[28:31], s46 offen  lds
    s_add_u32 s46, s79, 0x460000
    s_add_u32 m0, s48, 45056
    s_nop 0
    buffer_load_dwordx4 v82, s[28:31], s46 offen  lds
    s_cmp_lg_u32 s44, 0
    s_cbranch_scc1 L_lw_26_0
    ds_read_b64_tr_b16 a[128:129], v80 offset:49152
    ds_read_b64_tr_b16 a[130:131], v80 offset:50176
    ds_read_b64_tr_b16 a[132:133], v80 offset:57344
    ds_read_b64_tr_b16 a[134:135], v80 offset:58368
    ds_read_b64_tr_b16 a[136:137], v81 offset:49152
    ds_read_b64_tr_b16 a[138:139], v81 offset:50176
    ds_read_b64_tr_b16 a[140:141], v81 offset:57344
    ds_read_b64_tr_b16 a[142:143], v81 offset:58368
    s_branch L_lw_26
L_lw_26_0:
    s_cmp_lg_u32 s44, 1
    s_cbranch_scc1 L_lw_26_1
    ds_read_b64_tr_b16 a[48:49], v80 offset:49152
    ds_read_b64_tr_b16 a[50:51], v80 offset:50176
    ds_read_b64_tr_b16 a[52:53], v80 offset:57344
    ds_read_b64_tr_b16 a[54:55], v80 offset:58368
    ds_read_b64_tr_b16 a[56:57], v81 offset:49152
    ds_read_b64_tr_b16 a[58:59], v81 offset:50176
    ds_read_b64_tr_b16 a[60:61], v81 offset:57344
    ds_read_b64_tr_b16 a[62:63], v81 offset:58368
    s_branch L_lw_26
L_lw_26_1:
    s_cmp_lg_u32 s44, 2
    s_cbranch_scc1 L_lw_26_2
    ds_read_b64_tr_b16 v[176:177], v80 offset:49152
    ds_read_b64_tr_b16 v[178:179], v80 offset:50176
    ds_read_b64_tr_b16 v[180:181], v80 offset:57344
    ds_read_b64_tr_b16 v[182:183], v80 offset:58368
    ds_read_b64_tr_b16 v[184:185], v81 offset:49152
    ds_read_b64_tr_b16 v[186:187], v81 offset:50176
    ds_read_b64_tr_b16 v[188:189], v81 offset:57344
    ds_read_b64_tr_b16 v[190:191], v81 offset:58368
    s_branch L_lw_26
L_lw_26_2:
    ds_read_b64_tr_b16 a[224:225], v80 offset:49152
    ds_read_b64_tr_b16 a[226:227], v80 offset:50176
    ds_read_b64_tr_b16 a[228:229], v80 offset:57344
    ds_read_b64_tr_b16 a[230:231], v80 offset:58368
    ds_read_b64_tr_b16 a[232:233], v81 offset:49152
    ds_read_b64_tr_b16 a[234:235], v81 offset:50176
    ds_read_b64_tr_b16 a[236:237], v81 offset:57344
    ds_read_b64_tr_b16 a[238:239], v81 offset:58368
L_lw_26:
    s_waitcnt lgkmcnt(0)
    s_waitcnt vmcnt(8)
    s_barrier
    s_add_u32 s79, s41, 9
    s_and_b32 s79, s79, 3
    s_lshl_b32 s79, s79, 19
    s_add_u32 s79, s79, s47
    s_add_u32 s46, s79, 0x400000
    s_add_u32 m0, s48, 49152
    s_nop 0
    buffer_load_dwordx4 v82, s[28:31], s46 offen  lds
    s_add_u32 s46, s79, 0x420000
    s_add_u32 m0, s48, 53248
    s_nop 0
    buffer_load_dwordx4 v82, s[28:31], s46 offen  lds
    s_add_u32 s46, s79, 0x440000
    s_add_u32 m0, s48, 57344
    s_nop 0
    buffer_load_dwordx4 v82, s[28:31], s46 offen  lds
    s_add_u32 s46, s79, 0x460000
    s_add_u32 m0, s48, 61440
    s_nop 0
    buffer_load_dwordx4 v82, s[28:31], s46 offen  lds
    s_cmp_lg_u32 s44, 0
    s_cbranch_scc1 L_lw_27_0
    ds_read_b64_tr_b16 a[152:153], v80 offset:0
    ds_read_b64_tr_b16 a[154:155], v80 offset:1024
    ds_read_b64_tr_b16 a[156:157], v80 offset:8192
    ds_read_b64_tr_b16 a[158:159], v80 offset:9216
    ds_read_b64_tr_b16 a[160:161], v81 offset:0
    ds_read_b64_tr_b16 a[162:163], v81 offset:1024
    ds_read_b64_tr_b16 a[164:165], v81 offset:8192
    ds_read_b64_tr_b16 a[166:167], v81 offset:9216
    s_branch L_lw_27
L_lw_27_0:
    s_cmp_lg_u32 s44, 1
    s_cbranch_scc1 L_lw_27_1
    ds_read_b64_tr_b16 a[72:73], v80 offset:0
    ds_read_b64_tr_b16 a[74:75], v80 offset:1024
    ds_read_b64_tr_b16 a[76:77], v80 offset:8192
    ds_read_b64_tr_b16 a[78:79], v80 offset:9216
    ds_read_b64_tr_b16 v[56:57], v81 offset:0
    ds_read_b64_tr_b16 v[58:59], v81 offset:1024
    ds_read_b64_tr_b16 v[60:61], v81 offset:8192
    ds_read_b64_tr_b16 v[62:63], v81 offset:9216
    s_waitcnt lgkmcnt(0)
    ds_write_b128 v5, v[56:59] offset:20480
    ds_write_b128 v5, v[60:63] offset:21504
    s_branch L_lw_27
L_lw_27_1:
    s_cmp_lg_u32 s44, 2
    s_cbranch_scc1 L_lw_27_2
    ds_read_b64_tr_b16 v[208:209], v80 offset:0
    ds_read_b64_tr_b16 v[210:211], v80 offset:1024
    ds_read_b64_tr_b16 v[212:213], v80 offset:8192
    ds_read_b64_tr_b16 v[214:215], v80 offset:9216
    ds_read_b64_tr_b16 v[216:217], v81 offset:0
    ds_read_b64_tr_b16 v[218:219], v81 offset:1024
    ds_read_b64_tr_b16 v[220:221], v81 offset:8192
    ds_read_b64_tr_b16 v[222:223], v81 offset:9216
    s_branch L_lw_27
L_lw_27_2:
    ds_read_b64_tr_b16 a[248:249], v80 offset:0
    ds_read_b64_tr_b16 a[250:251], v80 offset:1024
    ds_read_b64_tr_b16 a[252:253], v80 offset:8192
    ds_read_b64_tr_b16 a[254:255], v80 offset:9216
    ds_read_b64_tr_b16 v[96:97], v81 offset:0
    ds_read_b64_tr_b16 v[98:99], v81 offset:1024
    ds_read_b64_tr_b16 v[100:101], v81 offset:8192
    ds_read_b64_tr_b16 v[102:103], v81 offset:9216
L_lw_27:
    s_waitcnt lgkmcnt(0)
    s_waitcnt vmcnt(8)
    s_barrier
    s_add_u32 s79, s41, 10
    s_and_b32 s79, s79, 3
    s_lshl_b32 s79, s79, 19
    s_add_u32 s79, s79, s47
    s_add_u32 s46, s79, 0x400000
    s_add_u32 m0, s48, 0
    s_nop 0
    buffer_load_dwordx4 v82, s[28:31], s46 offen  lds
    s_add_u32 s46, s79, 0x420000
    s_add_u32 m0, s48, 4096
    s_nop 0
    buffer_load_dwordx4 v82, s[28:31], s46 offen  lds
    s_add_u32 s46, s79, 0x440000
    s_add_u32 m0, s48, 8192
    s_nop 0
    buffer_load_dwordx4 v82, s[28:31], s46 offen  lds
    s_add_u32 s46, s79, 0x460000
    s_add_u32 m0, s48, 12288
    s_nop 0
    buffer_load_dwordx4 v82, s[28:31], s46 offen  lds
    s_cmp_lg_u32 s44, 0
    s_cbranch_scc1 L_lw_28_0
    ds_read_b64_tr_b16 a[176:177], v80 offset:16384
    ds_read_b64_tr_b16 a[178:179], v80 offset:17408
    ds_read_b64_tr_b16 a[180:181], v80 offset:24576
    ds_read_b64_tr_b16 a[182:183], v80 offset:25600
    ds_read_b64_tr_b16 a[184:185], v81 offset:16384
    ds_read_b64_tr_b16 a[186:187], v81 offset:17408
    ds_read_b64_tr_b16 a[188:189], v81 offset:24576
    ds_read_b64_tr_b16 a[190:191], v81 offset:25600
    s_branch L_lw_28
L_lw_28_0:
    s_cmp_lg_u32 s44, 1
    s_cbranch_scc1 L_lw_28_1
    ds_read_b64_tr_b16 a[88:89], v80 offset:16384
    ds_read_b64_tr_b16 a[90:91], v80 offset:17408
    ds_read_b64_tr_b16 a[92:93], v80 offset:24576
    ds_read_b64_tr_b16 a[94:95], v80 offset:25600
    ds_read_b64_tr_b16 v[56:57], v81 offset:16384
    ds_read_b64_tr_b16 v[58:59], v81 offset:17408
    ds_read_b64_tr_b16 v[60:61], v81 offset:24576
    ds_read_b64_tr_b16 v[62:63], v81 offset:25600
    s_waitcnt lgkmcnt(0)
    ds_write_b128 v5, v[56:59] offset:22528
    ds_write_b128 v5, v[60:63] offset:23552
    s_branch L_lw_28
L_lw_28_1:
    s_cmp_lg_u32 s44, 2
    s_cbranch_scc1 L_lw_28_2
    ds_read_b64_tr_b16 v[240:241], v80 offset:16384
    ds_read_b64_tr_b16 v[242:243], v80 offset:17408
    ds_read_b64_tr_b16 v[244:245], v80 offset:24576
    ds_read_b64_tr_b16 v[246:247], v80 offset:25600
    ds_read_b64_tr_b16 v[248:249], v81 offset:16384
    ds_read_b64_tr_b16 v[250:251], v81 offset:17408
    ds_read_b64_tr_b16 v[252:253], v81 offset:24576
    ds_read_b64_tr_b16 v[254:255], v81 offset:25600
    s_branch L_lw_28
L_lw_28_2:
    ds_read_b64_tr_b16 v[112:113], v80 offset:16384
    ds_read_b64_tr_b16 v[114:115], v80 offset:17408
    ds_read_b64_tr_b16 v[116:117], v80 offset:24576
    ds_read_b64_tr_b16 v[118:119], v80 offset:25600
    ds_read_b64_tr_b16 v[120:121], v81 offset:16384
    ds_read_b64_tr_b16 v[122:123], v81 offset:17408
    ds_read_b64_tr_b16 v[124:125], v81 offset:24576
    ds_read_b64_tr_b16 v[126:127], v81 offset:25600
L_lw_28:
    s_waitcnt lgkmcnt(0)
    s_waitcnt vmcnt(8)
    s_barrier
    s_add_u32 s79, s41, 11
    s_and_b32 s79, s79, 3
    s_lshl_b32 s79, s79, 19
    s_add_u32 s79, s79, s47
    s_add_u32 s46, s79, 0x400000
    s_add_u32 m0, s48, 16384
    s_nop 0
    buffer_load_dwordx4 v82, s[28:31], s46 offen  lds
    s_add_u32 s46, s79, 0x420000
    s_add_u32 m0, s48, 20480
    s_nop 0
    buffer_load_dwordx4 v82, s[28:31], s46 offen  lds
    s_add_u32 s46, s79, 0x440000
    s_add_u32 m0, s48, 24576
    s_nop 0
    buffer_load_dwordx4 v82, s[28:31], s46 offen  lds
    s_add_u32 s46, s79, 0x460000
    s_add_u32 m0, s48, 28672
    s_nop 0
    buffer_load_dwordx4 v82, s[28:31], s46 offen  lds
    s_cmp_lg_u32 s44, 0
    s_cbranch_scc1 L_lw_29_0
    ds_read_b64_tr_b16 a[200:201], v80 offset:32768
    ds_read_b64_tr_b16 a[202:203], v80 offset:33792
    ds_read_b64_tr_b16 a[204:205], v80 offset:40960
    ds_read_b64_tr_b16 a[206:207], v80 offset:41984
    ds_read_b64_tr_b16 a[208:209], v81 offset:32768
    ds_read_b64_tr_b16 a[210:211], v81 offset:33792
    ds_read_b64_tr_b16 a[212:213], v81 offset:40960
    ds_read_b64_tr_b16 a[214:215], v81 offset:41984
    s_branch L_lw_29
L_lw_29_0:
    s_cmp_lg_u32 s44, 1
    s_cbranch_scc1 L_lw_29_1
    ds_read_b64_tr_b16 a[104:105], v80 offset:32768
    ds_read_b64_tr_b16 a[106:107], v80 offset:33792
    ds_read_b64_tr_b16 a[108:109], v80 offset:40960
    ds_read_b64_tr_b16 a[110:111], v80 offset:41984
    ds_read_b64_tr_b16 a[112:113], v81 offset:32768
    ds_read_b64_tr_b16 a[114:115], v81 offset:33792
    ds_read_b64_tr_b16 a[116:117], v81 offset:40960
    ds_read_b64_tr_b16 a[118:119], v81 offset:41984
    s_branch L_lw_29
L_lw_29_1:
    s_cmp_lg_u32 s44, 2
    s_cbranch_scc1 L_lw_29_2
    ds_read_b64_tr_b16 a[16:17], v80 offset:32768
    ds_read_b64_tr_b16 a[18:19], v80 offset:33792
    ds_read_b64_tr_b16 a[20:21], v80 offset:40960
    ds_read_b64_tr_b16 a[22:23], v80 offset:41984
    ds_read_b64_tr_b16 a[24:25], v81 offset:32768
    ds_read_b64_tr_b16 a[26:27], v81 offset:33792
    ds_read_b64_tr_b16 a[28:29], v81 offset:40960
    ds_read_b64_tr_b16 a[30:31], v81 offset:41984
    s_branch L_lw_29
L_lw_29_2:
    ds_read_b64_tr_b16 v[144:145], v80 offset:32768
    ds_read_b64_tr_b16 v[146:147], v80 offset:33792
    ds_read_b64_tr_b16 v[148:149], v80 offset:40960
    ds_read_b64_tr_b16 v[150:151], v80 offset:41984
    ds_read_b64_tr_b16 v[152:153], v81 offset:32768
    ds_read_b64_tr_b16 v[154:155], v81 offset:33792
    ds_read_b64_tr_b16 v[156:157], v81 offset:40960
    ds_read_b64_tr_b16 v[158:159], v81 offset:41984
L_lw_29:
    s_waitcnt lgkmcnt(0)
    s_waitcnt vmcnt(8)
    s_barrier
    s_add_u32 s79, s41, 12
    s_and_b32 s79, s79, 3
    s_lshl_b32 s79, s79, 19
    s_add_u32 s79, s79, s47
    s_add_u32 s46, s79, 0x600000
    s_add_u32 m0, s48, 32768
    s_nop 0
    buffer_load_dwordx4 v82, s[28:31], s46 offen  lds
    s_add_u32 s46, s79, 0x620000
    s_add_u32 m0, s48, 36864
    s_nop 0
    buffer_load_dwordx4 v82, s[28:31], s46 offen  lds
    s_add_u32 s46, s79, 0x640000
    s_add_u32 m0, s48, 40960
    s_nop 0
    buffer_load_dwordx4 v82, s[28:31], s46 offen  lds
    s_add_u32 s46, s79, 0x660000
    s_add_u32 m0, s48, 45056
    s_nop 0
    buffer_load_dwordx4 v82, s[28:31], s46 offen  lds
    s_cmp_lg_u32 s44, 0
    s_cbranch_scc1 L_lw_30_0
    ds_read_b64_tr_b16 a[224:225], v80 offset:49152
    ds_read_b64_tr_b16 a[226:227], v80 offset:50176
    ds_read_b64_tr_b16 a[228:229], v80 offset:57344
    ds_read_b64_tr_b16 a[230:231], v80 offset:58368
    ds_read_b64_tr_b16 a[232:233], v81 offset:49152
    ds_read_b64_tr_b16 a[234:235], v81 offset:50176
    ds_read_b64_tr_b16 a[236:237], v81 offset:57344
    ds_read_b64_tr_b16 a[238:239], v81 offset:58368
    s_branch L_lw_30
L_lw_30_0:
    s_cmp_lg_u32 s44, 1
    s_cbranch_scc1 L_lw_30_1
    ds_read_b64_tr_b16 a[128:129], v80 offset:49152
    ds_read_b64_tr_b16 a[130:131], v80 offset:50176
    ds_read_b64_tr_b16 a[132:133], v80 offset:57344
    ds_read_b64_tr_b16 a[134:135], v80 offset:58368
    ds_read_b64_tr_b16 a[136:137], v81 offset:49152
    ds_read_b64_tr_b16 a[138:139], v81 offset:50176
    ds_read_b64_tr_b16 a[140:141], v81 offset:57344
    ds_read_b64_tr_b16 a[142:143], v81 offset:58368
    s_branch L_lw_30
L_lw_30_1:
    s_cmp_lg_u32 s44, 2
    s_cbranch_scc1 L_lw_30_2
    ds_read_b64_tr_b16 a[48:49], v80 offset:49152
    ds_read_b64_tr_b16 a[50:51], v80 offset:50176
    ds_read_b64_tr_b16 a[52:53], v80 offset:57344
    ds_read_b64_tr_b16 a[54:55], v80 offset:58368
    ds_read_b64_tr_b16 a[56:57], v81 offset:49152
    ds_read_b64_tr_b16 a[58:59], v81 offset:50176
    ds_read_b64_tr_b16 a[60:61], v81 offset:57344
    ds_read_b64_tr_b16 a[62:63], v81 offset:58368
    s_branch L_lw_30
L_lw_30_2:
    ds_read_b64_tr_b16 v[176:177], v80 offset:49152
    ds_read_b64_tr_b16 v[178:179], v80 offset:50176
    ds_read_b64_tr_b16 v[180:181], v80 offset:57344
    ds_read_b64_tr_b16 v[182:183], v80 offset:58368
    ds_read_b64_tr_b16 v[184:185], v81 offset:49152
    ds_read_b64_tr_b16 v[186:187], v81 offset:50176
    ds_read_b64_tr_b16 v[188:189], v81 offset:57344
    ds_read_b64_tr_b16 v[190:191], v81 offset:58368
L_lw_30:
    s_waitcnt lgkmcnt(0)
    s_waitcnt vmcnt(8)
    s_barrier
    s_add_u32 s79, s41, 13
    s_and_b32 s79, s79, 3
    s_lshl_b32 s79, s79, 19
    s_add_u32 s79, s79, s47
    s_add_u32 s46, s79, 0x600000
    s_add_u32 m0, s48, 49152
    s_nop 0
    buffer_load_dwordx4 v82, s[28:31], s46 offen  lds
    s_add_u32 s46, s79, 0x620000
    s_add_u32 m0, s48, 53248
    s_nop 0
    buffer_load_dwordx4 v82, s[28:31], s46 offen  lds
    s_add_u32 s46, s79, 0x640000
    s_add_u32 m0, s48, 57344
    s_nop 0
    buffer_load_dwordx4 v82, s[28:31], s46 offen  lds
    s_add_u32 s46, s79, 0x660000
    s_add_u32 m0, s48, 61440
    s_nop 0
    buffer_load_dwordx4 v82, s[28:31], s46 offen  lds
    s_cmp_lg_u32 s44, 0
    s_cbranch_scc1 L_lw_31_0
    ds_read_b64_tr_b16 a[248:249], v80 offset:0
    ds_read_b64_tr_b16 a[250:251], v80 offset:1024
    ds_read_b64_tr_b16 a[252:253], v80 offset:8192
    ds_read_b64_tr_b16 a[254:255], v80 offset:9216
    ds_read_b64_tr_b16 v[96:97], v81 offset:0
    ds_read_b64_tr_b16 v[98:99], v81 offset:1024
    ds_read_b64_tr_b16 v[100:101], v81 offset:8192
    ds_read_b64_tr_b16 v[102:103], v81 offset:9216
    s_branch L_lw_31
L_lw_31_0:
    s_cmp_lg_u32 s44, 1
    s_cbranch_scc1 L_lw_31_1
    ds_read_b64_tr_b16 a[152:153], v80 offset:0
    ds_read_b64_tr_b16 a[154:155], v80 offset:1024
    ds_read_b64_tr_b16 a[156:157], v80 offset:8192
    ds_read_b64_tr_b16 a[158:159], v80 offset:9216
    ds_read_b64_tr_b16 a[160:161], v81 offset:0
    ds_read_b64_tr_b16 a[162:163], v81 offset:1024
    ds_read_b64_tr_b16 a[164:165], v81 offset:8192
    ds_read_b64_tr_b16 a[166:167], v81 offset:9216
    s_branch L_lw_31
L_lw_31_1:
    s_cmp_lg_u32 s44, 2
    s_cbranch_scc1 L_lw_31_2
    ds_read_b64_tr_b16 a[72:73], v80 offset:0
    ds_read_b64_tr_b16 a[74:75], v80 offset:1024
    ds_read_b64_tr_b16 a[76:77], v80 offset:8192
    ds_read_b64_tr_b16 a[78:79], v80 offset:9216
    ds_read_b64_tr_b16 v[56:57], v81 offset:0
    ds_read_b64_tr_b16 v[58:59], v81 offset:1024
    ds_read_b64_tr_b16 v[60:61], v81 offset:8192
    ds_read_b64_tr_b16 v[62:63], v81 offset:9216
    s_waitcnt lgkmcnt(0)
    ds_write_b128 v5, v[56:59] offset:20480
    ds_write_b128 v5, v[60:63] offset:21504
    s_branch L_lw_31
L_lw_31_2:
    ds_read_b64_tr_b16 v[208:209], v80 offset:0
    ds_read_b64_tr_b16 v[210:211], v80 offset:1024
    ds_read_b64_tr_b16 v[212:213], v80 offset:8192
    ds_read_b64_tr_b16 v[214:215], v80 offset:9216
    ds_read_b64_tr_b16 v[216:217], v81 offset:0
    ds_read_b64_tr_b16 v[218:219], v81 offset:1024
    ds_read_b64_tr_b16 v[220:221], v81 offset:8192
    ds_read_b64_tr_b16 v[222:223], v81 offset:9216
L_lw_31:
    s_waitcnt lgkmcnt(0)
    s_waitcnt vmcnt(8)
    s_barrier
    s_add_u32 s79, s41, 14
    s_and_b32 s79, s79, 3
    s_lshl_b32 s79, s79, 19
    s_add_u32 s79, s79, s47
    s_add_u32 s46, s79, 0x600000
    s_add_u32 m0, s48, 0
    s_nop 0
    buffer_load_dwordx4 v82, s[28:31], s46 offen  lds
    s_add_u32 s46, s79, 0x620000
    s_add_u32 m0, s48, 4096
    s_nop 0
    buffer_load_dwordx4 v82, s[28:31], s46 offen  lds
    s_add_u32 s46, s79, 0x640000
    s_add_u32 m0, s48, 8192
    s_nop 0
    buffer_load_dwordx4 v82, s[28:31], s46 offen  lds
    s_add_u32 s46, s79, 0x660000
    s_add_u32 m0, s48, 12288
    s_nop 0
    buffer_load_dwordx4 v82, s[28:31], s46 offen  lds
    s_cmp_lg_u32 s44, 0
    s_cbranch_scc1 L_lw_32_0
    ds_read_b64_tr_b16 v[112:113], v80 offset:16384
    ds_read_b64_tr_b16 v[114:115], v80 offset:17408
    ds_read_b64_tr_b16 v[116:117], v80 offset:24576
    ds_read_b64_tr_b16 v[118:119], v80 offset:25600
    ds_read_b64_tr_b16 v[120:121], v81 offset:16384
    ds_read_b64_tr_b16 v[122:123], v81 offset:17408
    ds_read_b64_tr_b16 v[124:125], v81 offset:24576
    ds_read_b64_tr_b16 v[126:127], v81 offset:25600
    s_branch L_lw_32
L_lw_32_0:
    s_cmp_lg_u32 s44, 1
    s_cbranch_scc1 L_lw_32_1
    ds_read_b64_tr_b16 a[176:177], v80 offset:16384
    ds_read_b64_tr_b16 a[178:179], v80 offset:17408
    ds_read_b64_tr_b16 a[180:181], v80 offset:24576
    ds_read_b64_tr_b16 a[182:183], v80 offset:25600
    ds_read_b64_tr_b16 a[184:185], v81 offset:16384
    ds_read_b64_tr_b16 a[186:187], v81 offset:17408
    ds_read_b64_tr_b16 a[188:189], v81 offset:24576
    ds_read_b64_tr_b16 a[190:191], v81 offset:25600
    s_branch L_lw_32
L_lw_32_1:
    s_cmp_lg_u32 s44, 2
    s_cbranch_scc1 L_lw_32_2
    ds_read_b64_tr_b16 a[88:89], v80 offset:16384
    ds_read_b64_tr_b16 a[90:91], v80 offset:17408
    ds_read_b64_tr_b16 a[92:93], v80 offset:24576
    ds_read_b64_tr_b16 a[94:95], v80 offset:25600
    ds_read_b64_tr_b16 v[56:57], v81 offset:16384
    ds_read_b64_tr_b16 v[58:59], v81 offset:17408
    ds_read_b64_tr_b16 v[60:61], v81 offset:24576
    ds_read_b64_tr_b16 v[62:63], v81 offset:25600
    s_waitcnt lgkmcnt(0)
    ds_write_b128 v5, v[56:59] offset:22528
    ds_write_b128 v5, v[60:63] offset:23552
    s_branch L_lw_32
L_lw_32_2:
    ds_read_b64_tr_b16 v[240:241], v80 offset:16384
    ds_read_b64_tr_b16 v[242:243], v80 offset:17408
    ds_read_b64_tr_b16 v[244:245], v80 offset:24576
    ds_read_b64_tr_b16 v[246:247], v80 offset:25600
    ds_read_b64_tr_b16 v[248:249], v81 offset:16384
    ds_read_b64_tr_b16 v[250:251], v81 offset:17408
    ds_read_b64_tr_b16 v[252:253], v81 offset:24576
    ds_read_b64_tr_b16 v[254:255], v81 offset:25600
L_lw_32:
    s_waitcnt lgkmcnt(0)
    s_waitcnt vmcnt(8)
    s_barrier
    s_add_u32 s79, s41, 15
    s_and_b32 s79, s79, 3
    s_lshl_b32 s79, s79, 19
    s_add_u32 s79, s79, s47
    s_add_u32 s46, s79, 0x600000
    s_add_u32 m0, s48, 16384
    s_nop 0
    buffer_load_dwordx4 v82, s[28:31], s46 offen  lds
    s_add_u32 s46, s79, 0x620000
    s_add_u32 m0, s48, 20480
    s_nop 0
    buffer_load_dwordx4 v82, s[28:31], s46 offen  lds
    s_add_u32 s46, s79, 0x640000
    s_add_u32 m0, s48, 24576
    s_nop 0
    buffer_load_dwordx4 v82, s[28:31], s46 offen  lds
    s_add_u32 s46, s79, 0x660000
    s_add_u32 m0, s48, 28672
    s_nop 0
    buffer_load_dwordx4 v82, s[28:31], s46 offen  lds
    v_mov_b32 v46, 0
    buffer_load_dwordx2 v[44:45], v46, s[16:19], 0 offen sc1
    s_cmp_lg_u32 s44, 0
    s_cbranch_scc1 L_lw_33_0
    ds_read_b64_tr_b16 v[144:145], v80 offset:32768
    ds_read_b64_tr_b16 v[146:147], v80 offset:33792
    ds_read_b64_tr_b16 v[148:149], v80 offset:40960
    ds_read_b64_tr_b16 v[150:151], v80 offset:41984
    ds_read_b64_tr_b16 v[152:153], v81 offset:32768
    ds_read_b64_tr_b16 v[154:155], v81 offset:33792
    ds_read_b64_tr_b16 v[156:157], v81 offset:40960
    ds_read_b64_tr_b16 v[158:159], v81 offset:41984
    s_branch L_lw_33
L_lw_33_0:
    s_cmp_lg_u32 s44, 1
    s_cbranch_scc1 L_lw_33_1
    ds_read_b64_tr_b16 a[200:201], v80 offset:32768
    ds_read_b64_tr_b16 a[202:203], v80 offset:33792
    ds_read_b64_tr_b16 a[204:205], v80 offset:40960
    ds_read_b64_tr_b16 a[206:207], v80 offset:41984
    ds_read_b64_tr_b16 a[208:209], v81 offset:32768
    ds_read_b64_tr_b16 a[210:211], v81 offset:33792
    ds_read_b64_tr_b16 a[212:213], v81 offset:40960
    ds_read_b64_tr_b16 a[214:215], v81 offset:41984
    s_branch L_lw_33
L_lw_33_1:
    s_cmp_lg_u32 s44, 2
    s_cbranch_scc1 L_lw_33_2
    ds_read_b64_tr_b16 a[104:105], v80 offset:32768
    ds_read_b64_tr_b16 a[106:107], v80 offset:33792
    ds_read_b64_tr_b16 a[108:109], v80 offset:40960
    ds_read_b64_tr_b16 a[110:111], v80 offset:41984
    ds_read_b64_tr_b16 a[112:113], v81 offset:32768
    ds_read_b64_tr_b16 a[114:115], v81 offset:33792
    ds_read_b64_tr_b16 a[116:117], v81 offset:40960
    ds_read_b64_tr_b16 a[118:119], v81 offset:41984
    s_branch L_lw_33
L_lw_33_2:
    ds_read_b64_tr_b16 a[16:17], v80 offset:32768
    ds_read_b64_tr_b16 a[18:19], v80 offset:33792
    ds_read_b64_tr_b16 a[20:21], v80 offset:40960
    ds_read_b64_tr_b16 a[22:23], v80 offset:41984
    ds_read_b64_tr_b16 a[24:25], v81 offset:32768
    ds_read_b64_tr_b16 a[26:27], v81 offset:33792
    ds_read_b64_tr_b16 a[28:29], v81 offset:40960
    ds_read_b64_tr_b16 a[30:31], v81 offset:41984
L_lw_33:
    s_waitcnt lgkmcnt(0)
    s_waitcnt vmcnt(8)
    s_barrier
    s_cmp_lg_u32 s44, 0
    s_cbranch_scc1 L_lw_34_0
    ds_read_b64_tr_b16 v[176:177], v80 offset:49152
    ds_read_b64_tr_b16 v[178:179], v80 offset:50176
    ds_read_b64_tr_b16 v[180:181], v80 offset:57344
    ds_read_b64_tr_b16 v[182:183], v80 offset:58368
    ds_read_b64_tr_b16 v[184:185], v81 offset:49152
    ds_read_b64_tr_b16 v[186:187], v81 offset:50176
    ds_read_b64_tr_b16 v[188:189], v81 offset:57344
    ds_read_b64_tr_b16 v[190:191], v81 offset:58368
    s_branch L_lw_34
L_lw_34_0:
    s_cmp_lg_u32 s44, 1
    s_cbranch_scc1 L_lw_34_1
    ds_read_b64_tr_b16 a[224:225], v80 offset:49152
    ds_read_b64_tr_b16 a[226:227], v80 offset:50176
    ds_read_b64_tr_b16 a[228:229], v80 offset:57344
    ds_read_b64_tr_b16 a[230:231], v80 offset:58368
    ds_read_b64_tr_b16 a[232:233], v81 offset:49152
    ds_read_b64_tr_b16 a[234:235], v81 offset:50176
    ds_read_b64_tr_b16 a[236:237], v81 offset:57344
    ds_read_b64_tr_b16 a[238:239], v81 offset:58368
    s_branch L_lw_34
L_lw_34_1:
    s_cmp_lg_u32 s44, 2
    s_cbranch_scc1 L_lw_34_2
    ds_read_b64_tr_b16 a[128:129], v80 offset:49152
    ds_read_b64_tr_b16 a[130:131], v80 offset:50176
    ds_read_b64_tr_b16 a[132:133], v80 offset:57344
    ds_read_b64_tr_b16 a[134:135], v80 offset:58368
    ds_read_b64_tr_b16 a[136:137], v81 offset:49152
    ds_read_b64_tr_b16 a[138:139], v81 offset:50176
    ds_read_b64_tr_b16 a[140:141], v81 offset:57344
    ds_read_b64_tr_b16 a[142:143], v81 offset:58368
    s_branch L_lw_34
L_lw_34_2:
    ds_read_b64_tr_b16 a[48:49], v80 offset:49152
    ds_read_b64_tr_b16 a[50:51], v80 offset:50176
    ds_read_b64_tr_b16 a[52:53], v80 offset:57344
    ds_read_b64_tr_b16 a[54:55], v80 offset:58368
    ds_read_b64_tr_b16 a[56:57], v81 offset:49152
    ds_read_b64_tr_b16 a[58:59], v81 offset:50176
    ds_read_b64_tr_b16 a[60:61], v81 offset:57344
    ds_read_b64_tr_b16 a[62:63], v81 offset:58368
L_lw_34:
    s_waitcnt lgkmcnt(0)
    s_waitcnt vmcnt(4)
    s_barrier
    s_cmp_lg_u32 s44, 0
    s_cbranch_scc1 L_lw_35_0
    ds_read_b64_tr_b16 v[208:209], v80 offset:0
    ds_read_b64_tr_b16 v[210:211], v80 offset:1024
    ds_read_b64_tr_b16 v[212:213], v80 offset:8192
    ds_read_b64_tr_b16 v[214:215], v80 offset:9216
    ds_read_b64_tr_b16 v[216:217], v81 offset:0
    ds_read_b64_tr_b16 v[218:219], v81 offset:1024
    ds_read_b64_tr_b16 v[220:221], v81 offset:8192
    ds_read_b64_tr_b16 v[222:223], v81 offset:9216
    s_branch L_lw_35
L_lw_35_0:
    s_cmp_lg_u32 s44, 1
    s_cbranch_scc1 L_lw_35_1
    ds_read_b64_tr_b16 a[248:249], v80 offset:0
    ds_read_b64_tr_b16 a[250:251], v80 offset:1024
    ds_read_b64_tr_b16 a[252:253], v80 offset:8192
    ds_read_b64_tr_b16 a[254:255], v80 offset:9216
    ds_read_b64_tr_b16 v[96:97], v81 offset:0
    ds_read_b64_tr_b16 v[98:99], v81 offset:1024
    ds_read_b64_tr_b16 v[100:101], v81 offset:8192
    ds_read_b64_tr_b16 v[102:103], v81 offset:9216
    s_branch L_lw_35
L_lw_35_1:
    s_cmp_lg_u32 s44, 2
    s_cbranch_scc1 L_lw_35_2
    ds_read_b64_tr_b16 a[152:153], v80 offset:0
    ds_read_b64_tr_b16 a[154:155], v80 offset:1024
    ds_read_b64_tr_b16 a[156:157], v80 offset:8192
    ds_read_b64_tr_b16 a[158:159], v80 offset:9216
    ds_read_b64_tr_b16 a[160:161], v81 offset:0
    ds_read_b64_tr_b16 a[162:163], v81 offset:1024
    ds_read_b64_tr_b16 a[164:165], v81 offset:8192
    ds_read_b64_tr_b16 a[166:167], v81 offset:9216
    s_branch L_lw_35
L_lw_35_2:
    ds_read_b64_tr_b16 a[72:73], v80 offset:0
    ds_read_b64_tr_b16 a[74:75], v80 offset:1024
    ds_read_b64_tr_b16 a[76:77], v80 offset:8192
    ds_read_b64_tr_b16 a[78:79], v80 offset:9216
    ds_read_b64_tr_b16 v[56:57], v81 offset:0
    ds_read_b64_tr_b16 v[58:59], v81 offset:1024
    ds_read_b64_tr_b16 v[60:61], v81 offset:8192
    ds_read_b64_tr_b16 v[62:63], v81 offset:9216
    s_waitcnt lgkmcnt(0)
    ds_write_b128 v5, v[56:59] offset:20480
    ds_write_b128 v5, v[60:63] offset:21504
L_lw_35:
    s_waitcnt lgkmcnt(0)
    s_waitcnt vmcnt(0)
    s_barrier
    s_add_u32 s63, s62, 0
    buffer_load_dword v47, v17, s[12:15], s63 offen sc1
    s_add_u32 s63, s62, 32768
    buffer_load_dword v47, v17, s[12:15], s63 offen sc1
    s_add_u32 s63, s62, 65536
    buffer_load_dword v47, v17, s[12:15], s63 offen sc1
    s_add_u32 s63, s62, 98304
    buffer_load_dword v47, v17, s[12:15], s63 offen sc1
    buffer_load_dword v47, v20, s[12:15], 0 offen sc1
    s_cmp_lg_u32 s44, 0
    s_cbranch_scc1 L_lw_36_0
    ds_read_b64_tr_b16 v[240:241], v80 offset:16384
    ds_read_b64_tr_b16 v[242:243], v80 offset:17408
    ds_read_b64_tr_b16 v[244:245], v80 offset:24576
    ds_read_b64_tr_b16 v[246:247], v80 offset:25600
    ds_read_b64_tr_b16 v[248:249], v81 offset:16384
    ds_read_b64_tr_b16 v[250:251], v81 offset:17408
    ds_read_b64_tr_b16 v[252:253], v81 offset:24576
    ds_read_b64_tr_b16 v[254:255], v81 offset:25600
    s_branch L_lw_36
L_lw_36_0:
    s_cmp_lg_u32 s44, 1
    s_cbranch_scc1 L_lw_36_1
    ds_read_b64_tr_b16 v[112:113], v80 offset:16384
    ds_read_b64_tr_b16 v[114:115], v80 offset:17408
    ds_read_b64_tr_b16 v[116:117], v80 offset:24576
    ds_read_b64_tr_b16 v[118:119], v80 offset:25600
    ds_read_b64_tr_b16 v[120:121], v81 offset:16384
    ds_read_b64_tr_b16 v[122:123], v81 offset:17408
    ds_read_b64_tr_b16 v[124:125], v81 offset:24576
    ds_read_b64_tr_b16 v[126:127], v81 offset:25600
    s_branch L_lw_36
L_lw_36_1:
    s_cmp_lg_u32 s44, 2
    s_cbranch_scc1 L_lw_36_2
    ds_read_b64_tr_b16 a[176:177], v80 offset:16384
    ds_read_b64_tr_b16 a[178:179], v80 offset:17408
    ds_read_b64_tr_b16 a[180:181], v80 offset:24576
    ds_read_b64_tr_b16 a[182:183], v80 offset:25600
    ds_read_b64_tr_b16 a[184:185], v81 offset:16384
    ds_read_b64_tr_b16 a[186:187], v81 offset:17408
    ds_read_b64_tr_b16 a[188:189], v81 offset:24576
    ds_read_b64_tr_b16 a[190:191], v81 offset:25600
    s_branch L_lw_36
L_lw_36_2:
    ds_read_b64_tr_b16 a[88:89], v80 offset:16384
    ds_read_b64_tr_b16 a[90:91], v80 offset:17408
    ds_read_b64_tr_b16 a[92:93], v80 offset:24576
    ds_read_b64_tr_b16 a[94:95], v80 offset:25600
    ds_read_b64_tr_b16 v[56:57], v81 offset:16384
    ds_read_b64_tr_b16 v[58:59], v81 offset:17408
    ds_read_b64_tr_b16 v[60:61], v81 offset:24576
    ds_read_b64_tr_b16 v[62:63], v81 offset:25600
    s_waitcnt lgkmcnt(0)
    ds_write_b128 v5, v[56:59] offset:22528
    ds_write_b128 v5, v[60:63] offset:23552
L_lw_36:
    s_waitcnt lgkmcnt(0)
    s_barrier
    v_and_b32 v63, 15, v1
    v_lshrrev_b32 v64, 4, v1
    v_lshrrev_b32 v65, 5, v1
    v_lshlrev_b32 v65, 4, v65
    v_add_u32 v65, v65, v63
    v_lshlrev_b32 v65, 4, v65
    v_and_b32 v66, 1, v64
    v_lshlrev_b32 v66, 3, v66
    s_lshl_b32 s45, s44, 9
    s_add_u32 s45, s45, 53248
    v_add3_u32 v6, v65, v66, s45
    v_bfe_u32 v65, v1, 2, 2
    v_lshlrev_b32 v66, 3, v64
    v_add_u32 v65, v65, v66
    v_lshlrev_b32 v65, 4, v65
    v_and_b32 v66, 1, v1
    v_lshlrev_b32 v66, 3, v66
    v_add_u32 v65, v65, v66
    v_add_u32 v7, 53248, v65
    v_bfe_u32 v65, v1, 2, 1
    v_mul_u32_u24 v65, 520, v65
    v_bfe_u32 v66, v1, 3, 1
    v_lshlrev_b32 v14, 7, v66
    v_and_b32 v67, 3, v1
    v_lshlrev_b32 v67, 5, v67
    v_add3_u32 v65, v65, v14, v67
    v_lshlrev_b32 v66, 1, v66
    v_xor_b32 v66, v66, v64
    v_lshlrev_b32 v66, 3, v66
    s_mul_i32 s45, s44, 1040
    s_add_u32 s45, s45, 55296
    v_add3_u32 v18, v65, v66, s45
    v_lshlrev_b32 v14, 3, v1
    v_and_b32 v65, 16, v1
    v_xor_b32 v14, v14, v65
    v_lshlrev_b32 v16, 3, v1
    v_lshlrev_b32 v8, 4, v1
    v_lshrrev_b32 v65, 2, v1
    v_lshlrev_b32 v65, 4, v65
    v_and_b32 v66, 1, v1
    v_lshlrev_b32 v66, 3, v66
    s_lshl_b32 s45, s44, 11
    v_add3_u32 v65, v65, v66, s45
    v_and_b32 v66, 2, v1
    v_lshlrev_b32 v66, 7, v66
    v_add_u32 v9, v65, v66
    s_lshl_b32 s45, s43, 11
    s_lshl_b32 s46, s44, 9
    s_add_u32 s45, s45, s46
    s_add_u32 s51, s45, 0x7020000
    s_lshl_b32 s63, s43, 19
    s_add_u32 s63, s63, 0x3000000
    s_mov_b32 s50, 0
    s_lshl_b32 s64, s44, 11
    s_sub_u32 s63, s63, s64
    s_add_u32 s64, s64, 16384
    s_add_u32 s65, s64, 8192
    s_lshl_b32 s66, s43, 12
    s_add_u32 s66, s66, 0x1000000
    s_mov_b32 s69, 16384
    s_mov_b32 s52, 0x3e0293ee
    s_mov_b32 s53, 0x41800000
    s_lshl_b32 s45, s40, 5
    s_add_u32 s45, s45, s41
    s_lshl_b32 s45, s45, 8
    s_lshl_b32 s46, s44, 6
    s_add_u32 s45, s45, s46
    s_add_u32 s45, s45, 0x7084000
    v_and_b32 v19, 15, v1
    v_lshlrev_b32 v19, 2, v19
    v_add_u32 v19, s45, v19
    s_mov_b32 s70, 0
    v_mov_b32 v41, 0
    s_branch L_hw_37_c
L_hw_37:
    buffer_load_dwordx2 v[44:45], v41, s[16:19], 0 offen sc1
    s_add_u32 s70, s70, 1
    s_cmp_ge_u32 s70, 0x100000
    s_cbranch_scc1 L_c_done_1
L_hw_37_c:
    s_waitcnt vmcnt(0)
    v_readfirstlane_b32 s45, v44
    v_readfirstlane_b32 s46, v45
    s_nop 3
    s_lshr_b32 s47, s46, 24
    s_cmp_lg_u32 s47, 64
    s_cbranch_scc1 L_hw_37
    s_lshr_b32 s68, s45, 24
    s_and_b32 s47, s45, 511
    s_mul_i32 s47, s47, s47
    s_bfe_u32 s45, s45, 0xf0009
    s_lshl_b32 s45, s45, 5
    s_sub_u32 s45, s45, s47
    s_and_b32 s47, s46, 511
    s_mul_i32 s47, s47, s47
    s_bfe_u32 s46, s46, 0xf0009
    s_lshl_b32 s46, s46, 5
    s_sub_u32 s46, s46, s47
    s_or_b32 s45, s45, s46
    s_cmp_eq_u32 s45, 0
    s_cselect_b32 s67, 1, 0
    s_mov_b32 s24, s12
    s_mov_b32 s25, s13
    s_mov_b32 s28, s12
    s_mov_b32 s29, s13
    s_cmp_eq_u32 s67, 1
    s_cselect_b32 s26, s14, 0
    s_cselect_b32 s30, 0, s14
    s_cmp_ge_u32 s68, 16
    s_cselect_b32 s68, 8192, 0
    s_mov_b32 s6, 0x11111111
    s_mov_b32 s7, 0xffaaa491
    s_mov_b32 s60, 0
    s_lshl_b32 s58, s40, 16
    s_add_u32 s58, s58, 0x7000000
    s_mov_b32 s61, s58
    s_lshl_b32 s59, s40, 17
    s_add_u32 s59, s59, 0x7040000
    s_mov_b32 s62, s59
    s_add_u32 s32, s41, 0
    s_and_b32 s32, s32, 3
    s_lshl_b32 s32, s32, 10
    s_add_u32 s33, s41, 1
    s_and_b32 s33, s33, 3
    s_lshl_b32 s33, s33, 10
    s_add_u32 s34, s41, 2
    s_and_b32 s34, s34, 3
    s_lshl_b32 s34, s34, 10
    s_add_u32 s35, s41, 3
    s_and_b32 s35, s35, 3
    s_lshl_b32 s35, s35, 10
    s_mov_b32 s47, 0
    s_cmp_lt_u32 s47, s50
    s_cbranch_scc1 L_kv_rdy_38
    s_lshl_b32 s45, s43, 7
    s_add_u32 s45, s45, 0x10014
    v_mov_b32 v0, 0
    s_mov_b32 s70, 0
L_kv_rdy_38_p:
    buffer_load_dwordx2 v[10:11], v0, s[12:15], s45 offen sc1
    s_add_u32 s70, s70, 1
    s_cmp_ge_u32 s70, 0x200000
    s_cbranch_scc1 L_c_done_1
    s_waitcnt vmcnt(0)
    v_min_u32 v10, v10, v11
    s_nop 0
    v_readfirstlane_b32 s50, v10
    s_nop 3
    s_cmp_lt_u32 s47, s50
    s_cbranch_scc1 L_kv_rdy_38
    s_sleep 2
    s_branch L_kv_rdy_38_p
L_kv_rdy_38:
    s_mov_b32 m0, s64
    s_add_u32 s46, s63, 0x1000000
    buffer_load_dwordx4 v3, s[12:15], s63 offen sc1 lds
    buffer_load_dwordx4 v3, s[12:15], s63 offen offset:1024 sc1 lds
    s_mov_b32 m0, s65
    s_add_u32 s63, s63, 8192
    buffer_load_dwordx4 v3, s[12:15], s46 offen sc1 lds
    buffer_load_dwordx4 v3, s[12:15], s46 offen offset:1024 sc1 lds
    s_add_u32 s64, s64, 16384
    s_add_u32 s65, s65, 16384
    s_cmp_lg_u32 s44, 0
    s_cbranch_scc1 L_ld_39
    v_mov_b32 v40, 1
    v_mov_b32 v41, 127360
    s_mov_b64 exec, 1
    buffer_atomic_add v40, v41, s[12:15], 0 offen sc1
    s_mov_b64 exec, -1
L_ld_39:
L_q_loop_40:
    ds_read_b128 v[56:59], v5 offset:8192
    ds_read_b128 v[60:63], v5 offset:9216
    ds_read_b128 v[64:67], v5 offset:20480
    ds_read_b128 v[68:71], v5 offset:21504
    ds_read_b128 v[72:75], v5 offset:14336
    ds_read_b128 v[76:79], v5 offset:15360
    ds_read_b128 v[80:83], v5 offset:22528
    ds_read_b128 v[84:87], v5 offset:23552
    ds_read_b128 v[88:91], v5 offset:2048
    ds_read_b128 v[92:95], v5 offset:3072
    s_add_u32 s46, s60, 1
    v_mov_b32 v15, s46
    v_mov_b32 v0, -1
    v_mov_b32 v24, 0
    v_mov_b32 v25, 0
    v_mov_b32 v26, 0
    v_mov_b32 v27, 0
    v_mov_b32 v28, 0
    v_mov_b32 v29, 0
    v_mov_b32 v30, 0
    v_mov_b32 v31, 0
    v_mov_b32 v32, 0
    v_mov_b32 v33, 0
    v_mov_b32 v34, 0
    v_mov_b32 v35, 0
    v_mov_b32 v36, 0
    v_mov_b32 v37, 0
    v_mov_b32 v38, 0
    v_mov_b32 v39, 0
    s_add_u32 s8, s61, s32
    s_add_u32 s9, s61, s33
    s_add_u32 s10, s61, s34
    s_add_u32 s11, s61, s35
    s_cmp_eq_u32 s60, 0
    s_cbranch_scc1 L_q_first_41
    s_sleep 16
    s_waitcnt vmcnt(0)
    s_mov_b64 exec, 65535
    buffer_load_dword v10, v19, s[12:15], 0 offen sc1
    s_nop 15
    buffer_load_dword v11, v19, s[12:15], 0 offen sc1
    s_nop 15
    buffer_load_dword v12, v19, s[12:15], 0 offen sc1
    s_nop 15
    buffer_load_dword v13, v19, s[12:15], 0 offen sc1
    s_mov_b32 s70, 0
L_pp_42:
    s_waitcnt vmcnt(3)
    v_cmp_gt_u32 vcc, s60, v10
    s_add_u32 s70, s70, 1
    s_nop 0
    s_cbranch_vccz L_ppd_43
    buffer_load_dword v10, v19, s[12:15], 0 offen sc1
    s_waitcnt vmcnt(3)
    v_cmp_gt_u32 vcc, s60, v11
    s_add_u32 s70, s70, 1
    s_nop 0
    s_cbranch_vccz L_ppd_43
    buffer_load_dword v11, v19, s[12:15], 0 offen sc1
    s_waitcnt vmcnt(3)
    v_cmp_gt_u32 vcc, s60, v12
    s_add_u32 s70, s70, 1
    s_nop 0
    s_cbranch_vccz L_ppd_43
    buffer_load_dword v12, v19, s[12:15], 0 offen sc1
    s_waitcnt vmcnt(3)
    v_cmp_gt_u32 vcc, s60, v13
    s_add_u32 s70, s70, 1
    s_nop 0
    s_cbranch_vccz L_ppd_43
    buffer_load_dword v13, v19, s[12:15], 0 offen sc1
    s_cmp_lt_u32 s70, 0x400000
    s_cbranch_scc1 L_pp_42
    s_branch L_c_done_1
L_ppd_43:
    s_mov_b64 exec, -1
L_q_first_41:
    s_waitcnt lgkmcnt(0)
    buffer_load_dwordx4 v[40:43], v3, s[12:15], s8 offen sc1
    s_nop 4
    buffer_load_dwordx4 v[44:47], v3, s[12:15], s9 offen sc1
    s_nop 4
    buffer_load_dwordx4 v[48:51], v3, s[12:15], s10 offen sc1
    s_nop 4
    buffer_load_dwordx4 v[52:55], v3, s[12:15], s11 offen sc1
    s_mov_b32 s70, 0
L_mg_44_p:
    s_waitcnt vmcnt(3)
    ds_write_b128 v3, v[40:43] offset:0
    v_smfmac_f32_16x16x64_bf16 v[24:27], v[40:43], a[0:7], v2
    s_waitcnt vmcnt(2)
    ds_write_b128 v3, v[44:47] offset:1024
    v_smfmac_f32_16x16x64_bf16 v[28:31], v[40:43], a[8:15], v2
    s_waitcnt vmcnt(1)
    ds_write_b128 v3, v[48:51] offset:2048
    v_smfmac_f32_16x16x64_bf16 v[32:35], v[40:43], a[16:23], v2
    s_waitcnt vmcnt(0)
    ds_write_b128 v3, v[52:55] offset:3072
    v_smfmac_f32_16x16x64_bf16 v[36:39], v[40:43], a[24:31], v2
    v_max3_u32 v22, v40, v41, v42
    v_max3_u32 v22, v22, v43, v44
    v_max3_u32 v22, v22, v45, v46
    v_smfmac_f32_16x16x64_bf16 v[24:27], v[44:47], a[32:39], v2
    v_max3_u32 v22, v22, v47, v48
    v_max3_u32 v22, v22, v49, v50
    v_smfmac_f32_16x16x64_bf16 v[28:31], v[44:47], a[40:47], v2
    v_max3_u32 v22, v22, v51, v52
    v_max3_u32 v22, v22, v53, v54
    v_smfmac_f32_16x16x64_bf16 v[32:35], v[44:47], a[48:55], v2
    v_max_u32 v22, v22, v55
    v_cmp_eq_u32 vcc, -1, v22
    v_smfmac_f32_16x16x64_bf16 v[36:39], v[44:47], a[56:63], v2
    s_waitcnt lgkmcnt(0)
    s_cbranch_vccnz L_mg_44_r
    s_barrier
    ds_read_b128 v[40:43], v4 offset:0
    ds_read_b128 v[44:47], v4 offset:1024
    v_smfmac_f32_16x16x64_bf16 v[24:27], v[48:51], a[64:71], v2
    v_smfmac_f32_16x16x64_bf16 v[28:31], v[48:51], v[56:63], v2
    ds_read_b128 v[56:59], v5 offset:6144
    v_smfmac_f32_16x16x64_bf16 v[32:35], v[48:51], a[72:79], v2
    ds_read_b128 v[60:63], v5 offset:7168
    v_smfmac_f32_16x16x64_bf16 v[36:39], v[48:51], v[64:71], v2
    ds_read_b128 v[48:51], v4 offset:2048
    v_smfmac_f32_16x16x64_bf16 v[24:27], v[52:55], a[80:87], v2
    ds_read_b128 v[64:67], v5 offset:12288
    v_smfmac_f32_16x16x64_bf16 v[28:31], v[52:55], v[72:79], v2
    ds_read_b128 v[68:71], v5 offset:13312
    v_smfmac_f32_16x16x64_bf16 v[32:35], v[52:55], a[88:95], v2
    ds_read_b128 v[72:75], v5 offset:18432
    v_smfmac_f32_16x16x64_bf16 v[36:39], v[52:55], v[80:87], v2
    ds_read_b128 v[52:55], v4 offset:3072
    s_waitcnt lgkmcnt(4)
    v_smfmac_f32_16x16x64_bf16 v[24:27], v[40:43], a[96:103], v2
    ds_read_b128 v[76:79], v5 offset:19456
    v_smfmac_f32_16x16x64_bf16 v[28:31], v[40:43], v[88:95], v2
    ds_read_b128 v[80:83], v5 offset:0
    v_smfmac_f32_16x16x64_bf16 v[32:35], v[40:43], a[104:111], v2
    ds_read_b128 v[84:87], v5 offset:1024
    v_smfmac_f32_16x16x64_bf16 v[36:39], v[40:43], a[112:119], v2
    ds_read_b128 v[40:43], v21 offset:0
    v_smfmac_f32_16x16x64_bf16 v[24:27], v[44:47], a[120:127], v2
    ds_read_b128 v[88:91], v5 offset:4096
    v_smfmac_f32_16x16x64_bf16 v[28:31], v[44:47], v[56:63], v2
    ds_read_b128 v[92:95], v5 offset:5120
    v_smfmac_f32_16x16x64_bf16 v[32:35], v[44:47], a[128:135], v2
    ds_read_b128 v[56:59], v5 offset:10240
    v_smfmac_f32_16x16x64_bf16 v[36:39], v[44:47], a[136:143], v2
    ds_read_b128 v[44:47], v21 offset:1024
    v_smfmac_f32_16x16x64_bf16 v[24:27], v[48:51], a[144:151], v2
    ds_read_b128 v[60:63], v5 offset:11264
    s_waitcnt lgkmcnt(4)
    v_smfmac_f32_16x16x64_bf16 v[28:31], v[48:51], v[64:71], v2
    ds_read_b128 v[48:51], v21 offset:2048
    v_smfmac_f32_16x16x64_bf16 v[24:27], v[52:55], a[168:175], v2
    ds_read_b128 v[64:67], v5 offset:16384
    v_smfmac_f32_16x16x64_bf16 v[28:31], v[52:55], v[72:79], v2
    ds_read_b128 v[52:55], v21 offset:3072
    v_smfmac_f32_16x16x64_bf16 v[24:27], v[40:43], a[192:199], v2
    ds_read_b128 v[68:71], v5 offset:17408
    v_smfmac_f32_16x16x64_bf16 v[28:31], v[40:43], v[80:87], v2
    ds_read_b128 v[40:43], v23 offset:0
    s_waitcnt lgkmcnt(4)
    v_smfmac_f32_16x16x64_bf16 v[24:27], v[44:47], a[216:223], v2
    v_smfmac_f32_16x16x64_bf16 v[28:31], v[44:47], v[88:95], v2
    ds_read_b128 v[44:47], v23 offset:1024
    v_smfmac_f32_16x16x64_bf16 v[24:27], v[48:51], a[240:247], v2
    v_smfmac_f32_16x16x64_bf16 v[28:31], v[48:51], v[56:63], v2
    ds_read_b128 v[48:51], v23 offset:2048
    s_waitcnt lgkmcnt(2)
    v_smfmac_f32_16x16x64_bf16 v[24:27], v[52:55], v[104:111], v2
    v_smfmac_f32_16x16x64_bf16 v[28:31], v[52:55], v[64:71], v2
    ds_read_b128 v[52:55], v23 offset:3072
    v_smfmac_f32_16x16x64_bf16 v[24:27], v[40:43], v[128:135], v2
    v_smfmac_f32_16x16x64_bf16 v[28:31], v[40:43], v[136:143], v2
    s_waitcnt lgkmcnt(1)
    v_smfmac_f32_16x16x64_bf16 v[24:27], v[44:47], v[160:167], v2
    v_smfmac_f32_16x16x64_bf16 v[28:31], v[44:47], v[168:175], v2
    ds_read_b128 v[72:75], v8 offset:20480
    v_smfmac_f32_16x16x64_bf16 v[24:27], v[48:51], v[192:199], v2
    ds_read_b128 v[76:79], v8 offset:21504
    v_smfmac_f32_16x16x64_bf16 v[28:31], v[48:51], v[200:207], v2
    ds_read_b128 v[56:59], v8 offset:16384
    s_waitcnt lgkmcnt(3)
    v_smfmac_f32_16x16x64_bf16 v[24:27], v[52:55], v[224:231], v2
    ds_read_b128 v[60:63], v8 offset:17408
    v_smfmac_f32_16x16x64_bf16 v[28:31], v[52:55], v[232:239], v2
    ds_read_b128 v[64:67], v8 offset:18432
    v_smfmac_f32_16x16x64_bf16 v[32:35], v[52:55], v[240:247], v2
    ds_read_b128 v[68:71], v8 offset:19456
    v_smfmac_f32_16x16x64_bf16 v[36:39], v[52:55], v[248:255], v2
    ds_read_b128 v[52:55], v21 offset:3072
    v_smfmac_f32_16x16x64_bf16 v[32:35], v[48:51], v[208:215], v2
    s_nop 1
    v_permlane32_swap_b32 v24, v28
    v_permlane32_swap_b32 v25, v29
    v_smfmac_f32_16x16x64_bf16 v[36:39], v[48:51], v[216:223], v2
    ds_read_b128 v[48:51], v21 offset:2048
    v_permlane32_swap_b32 v26, v30
    v_smfmac_f32_16x16x64_bf16 v[32:35], v[44:47], v[176:183], v2
    v_permlane32_swap_b32 v27, v31
    v_add_f32 v24, v24, v28
    v_smfmac_f32_16x16x64_bf16 v[36:39], v[44:47], v[184:191], v2
    ds_read_b128 v[44:47], v21 offset:1024
    v_add_f32 v25, v25, v29
    v_smfmac_f32_16x16x64_bf16 v[32:35], v[40:43], v[144:151], v2
    v_add_f32 v26, v26, v30
    v_add_f32 v27, v27, v31
    v_smfmac_f32_16x16x64_bf16 v[36:39], v[40:43], v[152:159], v2
    ds_read_b128 v[40:43], v21 offset:0
    v_cvt_pk_bf16_f32 v24, v24, v25
    s_waitcnt lgkmcnt(2)
    v_smfmac_f32_16x16x64_bf16 v[32:35], v[52:55], v[112:119], v2
    v_cvt_pk_bf16_f32 v25, v26, v27
    v_smfmac_f32_16x16x64_bf16 v[36:39], v[52:55], v[120:127], v2
    ds_read_b128 v[52:55], v4 offset:3072
    v_smfmac_f32_16x16x64_bf16 v[32:35], v[48:51], a[248:255], v2
    ds_write_b64 v6, v[24:25]
    v_smfmac_f32_16x16x64_bf16 v[36:39], v[48:51], v[96:103], v2
    ds_read_b128 v[48:51], v4 offset:2048
    s_waitcnt lgkmcnt(3)
    v_smfmac_f32_16x16x64_bf16 v[32:35], v[44:47], a[224:231], v2
    v_smfmac_f32_16x16x64_bf16 v[36:39], v[44:47], a[232:239], v2
    v_smfmac_f32_16x16x64_bf16 v[32:35], v[40:43], a[200:207], v2
    s_waitcnt lgkmcnt(1)
    s_barrier
    ds_read_b64_tr_b16 v[80:81], v7 offset:0
    v_smfmac_f32_16x16x64_bf16 v[36:39], v[40:43], a[208:215], v2
    ds_read_b64_tr_b16 v[82:83], v7 offset:64
    ds_read_b64_tr_b16 v[84:85], v7 offset:512
    v_smfmac_f32_16x16x64_bf16 v[32:35], v[52:55], a[176:183], v2
    ds_read_b64_tr_b16 v[86:87], v7 offset:576
    v_smfmac_f32_16x16x64_bf16 v[36:39], v[52:55], a[184:191], v2
    ds_read_b64_tr_b16 v[88:89], v7 offset:1024
    s_waitcnt lgkmcnt(5)
    v_smfmac_f32_16x16x64_bf16 v[32:35], v[48:51], a[152:159], v2
    ds_read_b64_tr_b16 v[90:91], v7 offset:1088
    v_smfmac_f32_16x16x64_bf16 v[36:39], v[48:51], a[160:167], v2
    ds_read_b64_tr_b16 v[92:93], v7 offset:1536
    ds_read_b64_tr_b16 v[94:95], v7 offset:1600
    s_waitcnt lgkmcnt(5)
    v_mfma_f32_16x16x32_bf16 v[24:27], v[56:59], v[80:83], 0
    ds_read_b128 v[56:59], v8 offset:22528
    v_mfma_f32_16x16x32_bf16 v[28:31], v[60:63], v[80:83], 0
    ds_read_b128 v[60:63], v8 offset:23552
    s_waitcnt lgkmcnt(5)
    v_mfma_f32_16x16x32_bf16 v[24:27], v[64:67], v[84:87], v[24:27]
    v_cvt_pk_bf16_f32 v32, v32, v33
    v_cvt_pk_bf16_f32 v33, v34, v35
    v_cvt_pk_bf16_f32 v34, v36, v37
    v_cvt_pk_bf16_f32 v35, v38, v39
    ds_write2_b64 v18, v[32:33], v[34:35] offset1:32
    v_mfma_f32_16x16x32_bf16 v[28:31], v[68:71], v[84:87], v[28:31]
    s_waitcnt lgkmcnt(3)
    v_mfma_f32_16x16x32_bf16 v[24:27], v[72:75], v[88:91], v[24:27]
    s_cmp_eq_u32 s60, 63
    v_mfma_f32_16x16x32_bf16 v[28:31], v[76:79], v[88:91], v[28:31]
    s_waitcnt lgkmcnt(0)
    s_barrier
    v_mfma_f32_16x16x32_bf16 v[24:27], v[56:59], v[92:95], v[24:27]
    ds_read_b64_tr_b16 v[40:41], v14 offset:55296
    ds_read_b64_tr_b16 v[42:43], v14 offset:55816
    v_mfma_f32_16x16x32_bf16 v[28:31], v[60:63], v[92:95], v[28:31]
    buffer_load_dwordx2 v[0:1], v16, s[12:15], s51 offen sc1
    ds_read_b64_tr_b16 v[44:45], v14 offset:56336
    ds_read_b64_tr_b16 v[46:47], v14 offset:56856
    ds_read_b64_tr_b16 v[48:49], v14 offset:57376
    ds_read_b64_tr_b16 v[50:51], v14 offset:57896
    v_mov_b32 v32, 0x3f803f80
    ds_read_b64_tr_b16 v[52:53], v14 offset:58416
    ds_read_b64_tr_b16 v[54:55], v14 offset:58936
    s_cbranch_scc1 L_q_last_45
    v_cndmask_b32 v24, v28, v24, s[56:57]
    v_cndmask_b32 v25, v29, v25, s[56:57]
    v_cndmask_b32 v26, v30, v26, s[56:57]
    v_cndmask_b32 v27, v31, v27, s[56:57]
    v_max3_f32 v11, v24, v25, v26
    v_max_f32 v11, v11, v27
    s_waitcnt lgkmcnt(0)
    v_mfma_f32_16x16x32_bf16 v[36:39], v[40:43], v[80:83], 0
    ds_read_b64_tr_b16 v[64:65], v9 offset:24576
    v_max_f32_dpp v12, v11, v11 row_ror:8 row_mask:0xf bank_mask:0xf
    v_max_f32_dpp v13, v11, v11 row_ror:8 row_mask:0xf bank_mask:0xf
    v_mfma_f32_16x16x32_bf16 v[36:39], v[44:47], v[84:87], v[36:39]
    ds_read_b64_tr_b16 v[66:67], v9 offset:25600
    v_permlane32_swap_b32 v12, v13
    v_max_f32 v22, v12, v13
    v_max_f32 v13, v12, v13
    v_mfma_f32_16x16x32_bf16 v[36:39], v[48:51], v[88:91], v[36:39]
    ds_read_b64_tr_b16 v[68:69], v9 offset:25088
    v_permlane16_swap_b32 v22, v13
    v_mfma_f32_16x16x32_bf16 v[36:39], v[52:55], v[92:95], v[36:39]
    ds_read_b64_tr_b16 v[70:71], v9 offset:26112
    v_max_f32 v11, v22, v13
    v_mul_f32 v10, s52, v11
    v_fma_f32 v24, v24, s52, -v10
    v_fma_f32 v25, v25, s52, -v10
    v_fma_f32 v26, v26, s52, -v10
    v_fma_f32 v27, v27, s52, -v10
    v_exp_f32 v24, v24
    v_exp_f32 v25, v25
    v_exp_f32 v26, v26
    v_exp_f32 v27, v27
    v_permlane32_swap_b32 v36, v38
    v_cvt_pk_bf16_f32 v60, v24, v25
    v_cvt_pk_bf16_f32 v61, v26, v27
    v_permlane32_swap_b32 v37, v39
    v_mov_b32_dpp v62, v60 row_ror:8 row_mask:0xf bank_mask:0xf
    v_mov_b32_dpp v63, v61 row_ror:8 row_mask:0xf bank_mask:0xf
    v_add_f32 v36, v36, v38
    v_add_f32 v37, v37, v39
    s_waitcnt lgkmcnt(0)
    v_mfma_f32_16x16x32_bf16 v[72:75], v[64:67], v[60:63], 0
    buffer_store_dword v15, v20, s[24:27], 0 offen
    v_fma_f32 v12, v36, s52, -v10
    v_fma_f32 v13, v37, s52, -v10
    v_mov_b32 v33, 0x3f803f80
    v_mfma_f32_16x16x32_bf16 v[76:79], v[68:71], v[60:63], 0
    v_mov_b32 v34, 0x3f803f80
    v_mov_b32 v35, 0x3f803f80
    v_max_f32 v11, v12, v13
    v_exp_f32 v36, v12
    v_mfma_f32_16x16x32_bf16 v[24:27], v[32:35], v[60:63], 0
    s_waitcnt vmcnt(1)
    v_max_u32 v22, v0, v1
    v_cmp_lt_f32 s[8:9], s53, v11
    v_cmp_eq_u32 vcc, -1, v22
    v_exp_f32 v37, v13
    v_mov_b32 v57, 0
    v_cvt_pk_bf16_f32 v56, v36, v37
    s_or_b64 s[10:11], vcc, s[8:9]
    s_cbranch_scc1 L_q_vm_46_s
L_q_vm_46_j:
    v_mfma_f32_16x16x16_bf16 v[24:27], v[32:33], v[56:57], v[24:27]
    s_nop 0
    v_mov_b32 v58, 0
    v_mov_b32 v59, v56
    v_mfma_f32_16x16x16_bf16 v[72:75], v[0:1], v[56:57], v[72:75]
    s_nop 2
    v_mfma_f32_16x16x16_bf16 v[76:79], v[0:1], v[58:59], v[76:79]
    v_rcp_f32 v12, v24
    s_nop 2
    v_pk_mul_f32 v[72:73], v[72:73], v[12:13] op_sel_hi:[1,0]
    v_pk_mul_f32 v[74:75], v[74:75], v[12:13] op_sel_hi:[1,0]
    v_cvt_pk_bf16_f32 v72, v72, v73
    v_cvt_pk_bf16_f32 v73, v74, v75
    v_pk_mul_f32 v[76:77], v[76:77], v[12:13] op_sel_hi:[1,0]
    v_pk_mul_f32 v[78:79], v[78:79], v[12:13] op_sel_hi:[1,0]
    v_cvt_pk_bf16_f32 v74, v76, v77
    v_cvt_pk_bf16_f32 v75, v78, v79
    buffer_store_dwordx4 v[72:75], v17, s[24:27], s62 offen
    buffer_store_dwordx4 v[72:75], v17, s[28:31], s62 offen sc1
    buffer_store_dword v15, v20, s[28:31], 0 offen sc1
    v_mov_b32 v60, -1
    v_mov_b32 v61, -1
    v_mov_b32 v62, -1
    v_mov_b32 v63, -1
    s_add_u32 s45, s60, 3
    s_and_b32 s45, s45, 3
    s_lshl_b32 s45, s45, 15
    s_add_u32 s45, s45, s59
    buffer_store_dwordx4 v[60:63], v17, s[24:27], s45 offen
    buffer_store_dwordx4 v[60:63], v17, s[28:31], s45 offen sc1
    s_barrier
    s_and_b32 s45, s51, 0xffff
    s_lshl_b32 s46, s60, 16
    s_add_u32 s45, s45, s46
    s_add_u32 s45, s45, 0x1800000
    buffer_store_dwordx2 v[0:1], v16, s[12:15], s45 offen sc1
L_q_last_45:
    s_waitcnt lgkmcnt(0)
    v_lshlrev_b32 v22, 1, v16
    s_cmp_lg_u32 s44, 0
    s_cbranch_scc1 L_q_km_47_0
    buffer_store_dwordx4 v[40:43], v22, s[12:15], s66 offen offset:0 sc1
L_q_km_47_0:
    s_cmp_lg_u32 s44, 1
    s_cbranch_scc1 L_q_km_47_1
    buffer_store_dwordx4 v[44:47], v22, s[12:15], s66 offen offset:1024 sc1
L_q_km_47_1:
    s_cmp_lg_u32 s44, 2
    s_cbranch_scc1 L_q_km_47_2
    buffer_store_dwordx4 v[48:51], v22, s[12:15], s66 offen offset:2048 sc1
L_q_km_47_2:
    s_cmp_lg_u32 s44, 3
    s_cbranch_scc1 L_q_km_47_3
    buffer_store_dwordx4 v[52:55], v22, s[12:15], s66 offen offset:3072 sc1
L_q_km_47_3:
    s_cmp_eq_u32 s60, 63
    s_cbranch_scc1 L_q_fin_48
    s_cmp_eq_u32 s60, 62
    s_cbranch_scc1 L_q_fin_48_n
    s_add_u32 s47, s60, 1
    s_cmp_lt_u32 s47, s50
    s_cbranch_scc1 L_kv_rdy_49
    s_lshl_b32 s45, s43, 7
    s_add_u32 s45, s45, 0x10014
    v_mov_b32 v0, 0
    s_mov_b32 s70, 0
L_kv_rdy_49_p:
    buffer_load_dwordx2 v[10:11], v0, s[12:15], s45 offen sc1
    s_add_u32 s70, s70, 1
    s_cmp_ge_u32 s70, 0x200000
    s_cbranch_scc1 L_c_done_1
    s_waitcnt vmcnt(0)
    v_min_u32 v10, v10, v11
    s_nop 0
    v_readfirstlane_b32 s50, v10
    s_nop 3
    s_cmp_lt_u32 s47, s50
    s_cbranch_scc1 L_kv_rdy_49
    s_sleep 2
    s_branch L_kv_rdy_49_p
L_kv_rdy_49:
    s_mov_b32 m0, s64
    s_add_u32 s46, s63, 0x1000000
    buffer_load_dwordx4 v3, s[12:15], s63 offen sc1 lds
    buffer_load_dwordx4 v3, s[12:15], s63 offen offset:1024 sc1 lds
    s_mov_b32 m0, s65
    s_add_u32 s63, s63, 8192
    buffer_load_dwordx4 v3, s[12:15], s46 offen sc1 lds
    buffer_load_dwordx4 v3, s[12:15], s46 offen offset:1024 sc1 lds
    s_branch L_q_fin_48_k
L_q_fin_48_n:
    s_waitcnt vmcnt(0)
L_q_fin_48_k:
    s_add_u32 s47, s60, 1
    s_bitcmp1_b64 s[6:7], s47
    s_cselect_b32 s47, s47, s60
    s_cbranch_scc0 L_q_fin_48_m
    s_waitcnt vmcnt(4)
L_q_fin_48_m:
    v_mov_b32 v22, s47
    v_mov_b32 v0, 0
    s_mov_b64 exec, 1
    buffer_store_dword v22, v0, s[12:15], s3 offen sc1
    s_mov_b64 exec, -1
    s_mov_b64 exec, -1
    v_add_u32 v8, s69, v8
    v_add_u32 v9, s69, v9
    s_sub_u32 s64, s64, s69
    s_sub_u32 s65, s65, s69
    s_sub_u32 s69, 0, s69
    s_add_u32 s66, s66, 131072
    s_xor_b32 s51, s51, 65536
    s_add_u32 s60, s60, 1
    s_and_b32 s45, s60, 3
    s_lshl_b32 s46, s45, 14
    s_add_u32 s61, s58, s46
    s_lshl_b32 s46, s45, 15
    s_add_u32 s62, s59, s46
    s_branch L_q_loop_40
L_q_fin_48:
    s_waitcnt vmcnt(0)
    v_mov_b32 v22, 64
    v_mov_b32 v0, 0
    s_mov_b64 exec, 1
    buffer_store_dword v22, v0, s[12:15], s3 offen sc1
    s_mov_b64 exec, -1
    s_endpgm
L_mg_44_r:
    buffer_load_dwordx4 v[40:43], v3, s[12:15], s8 offen sc1
    buffer_load_dwordx4 v[44:47], v3, s[12:15], s9 offen sc1
    buffer_load_dwordx4 v[48:51], v3, s[12:15], s10 offen sc1
    buffer_load_dwordx4 v[52:55], v3, s[12:15], s11 offen sc1
    s_add_u32 s70, s70, 1
    s_cmp_ge_u32 s70, 0x100000
    s_cbranch_scc1 L_c_done_1
    s_nop 1
    v_mov_b32 v24, 0
    v_mov_b32 v25, 0
    v_mov_b32 v26, 0
    v_mov_b32 v27, 0
    v_mov_b32 v28, 0
    v_mov_b32 v29, 0
    v_mov_b32 v30, 0
    v_mov_b32 v31, 0
    v_mov_b32 v32, 0
    v_mov_b32 v33, 0
    v_mov_b32 v34, 0
    v_mov_b32 v35, 0
    v_mov_b32 v36, 0
    v_mov_b32 v37, 0
    v_mov_b32 v38, 0
    v_mov_b32 v39, 0
    s_branch L_mg_44_p
L_q_vm_46_s:
    s_cbranch_vccz L_q_vm_46_t
    buffer_load_dwordx2 v[0:1], v16, s[12:15], s51 offen sc1
    s_add_u32 s70, s70, 1
    s_nop 0
    s_cmp_ge_u32 s70, 0x100000
    s_cbranch_scc1 L_c_done_1
    s_waitcnt vmcnt(0)
    v_max_u32 v22, v0, v1
    v_cmp_eq_u32 vcc, -1, v22
    s_nop 1
    s_branch L_q_vm_46_s
L_q_vm_46_t:
    s_cmp_eq_u64 s[8:9], 0
    s_cbranch_scc1 L_q_vm_46_j
    v_max_f32 v11, 0, v11
    v_mov_b32 v22, v11
    s_nop 1
    v_permlane32_swap_b32 v11, v22
    v_max_f32 v11, v11, v22
    v_mov_b32 v22, v11
    s_nop 1
    v_permlane16_swap_b32 v11, v22
    v_max_f32 v11, v11, v22
    v_sub_f32 v12, v12, v11
    v_sub_f32 v13, v13, v11
    v_sub_f32 v11, 0, v11
    v_exp_f32 v36, v12
    v_exp_f32 v37, v13
    v_exp_f32 v11, v11
    s_nop 7
    v_mul_f32 v72, v72, v11
    v_mul_f32 v73, v73, v11
    v_mul_f32 v74, v74, v11
    v_mul_f32 v75, v75, v11
    v_mul_f32 v76, v76, v11
    v_mul_f32 v77, v77, v11
    v_mul_f32 v78, v78, v11
    v_mul_f32 v79, v79, v11
    v_mul_f32 v24, v24, v11
    v_cvt_pk_bf16_f32 v56, v36, v37
    v_cvt_pk_bf16_f32 v59, v36, v37
    s_nop 1
    s_branch L_q_vm_46_j
L_c_vo_2:
    s_lshl_b32 s45, s43, 11
    s_lshl_b32 s46, s44, 9
    s_add_u32 s45, s45, s46
    v_lshlrev_b32 v10, 3, v1
    v_add_u32 v10, s45, v10
    v_lshlrev_b32 v11, 3, v0
    v_bfe_u32 v69, v1, 4, 1
    v_lshlrev_b32 v69, 2, v69
    v_lshrrev_b32 v63, 5, v1
    v_lshlrev_b32 v63, 1, v63
    v_and_b32 v64, 1, v1
    v_add3_u32 v69, v69, v63, v64
    v_bfe_u32 v63, v1, 1, 1
    v_lshlrev_b32 v63, 3, v63
    v_add_u32 v63, v63, v69
    v_lshlrev_b32 v63, 4, v63
    v_bfe_u32 v64, v1, 2, 2
    v_lshlrev_b32 v64, 2, v64
    s_lshl_b32 s45, s42, 10
    s_lshl_b32 s46, s44, 8
    s_add_u32 s45, s45, s46
    v_add3_u32 v12, v63, v64, s45
    v_and_b32 v64, 1, v1
    v_cmp_eq_u32 vcc, 0, v64
    v_mov_b32 v9, 0x07060302
    v_mov_b32 v63, 0x01000504
    v_cndmask_b32 v9, v9, v63, vcc
    s_lshl_b32 s63, s40, 19
    s_lshl_b32 s45, s42, 15
    s_add_u32 s63, s63, s45
    s_add_u32 s63, s63, 0x7100000
    s_xor_b32 s64, s63, 524288
    s_lshl_b32 s45, s40, 13
    s_lshl_b32 s46, s44, 2
    s_add_u32 s45, s45, s46
    s_lshl_b32 s46, s42, 4
    s_add_u32 s45, s45, s46
    s_add_u32 s45, s45, 0x7084000
    v_lshlrev_b32 v20, 8, v1
    v_add_u32 v20, s45, v20
    v_mov_b32 v63, 0x20000000
    v_cmp_gt_u32 vcc, 16, v1
    s_nop 1
    v_cndmask_b32 v20, v63, v20, vcc
    buffer_store_dword v44, v20, s[12:15], 0 offen sc1
    s_mov_b32 s45, 0x7020000
    buffer_store_dwordx2 v[40:41], v10, s[12:15], s45 offen sc1
    s_mov_b32 s45, 0x7030000
    buffer_store_dwordx2 v[40:41], v10, s[12:15], s45 offen sc1
    s_add_u32 s45, s63, 0
    buffer_store_dwordx2 v[40:41], v11, s[12:15], s45 offen sc1
    s_add_u32 s45, s63, 4096
    buffer_store_dwordx2 v[40:41], v11, s[12:15], s45 offen sc1
    s_add_u32 s45, s63, 8192
    buffer_store_dwordx2 v[40:41], v11, s[12:15], s45 offen sc1
    s_add_u32 s45, s63, 12288
    buffer_store_dwordx2 v[40:41], v11, s[12:15], s45 offen sc1
    s_add_u32 s45, s63, 16384
    buffer_store_dwordx2 v[40:41], v11, s[12:15], s45 offen sc1
    s_add_u32 s45, s63, 20480
    buffer_store_dwordx2 v[40:41], v11, s[12:15], s45 offen sc1
    s_add_u32 s45, s63, 24576
    buffer_store_dwordx2 v[40:41], v11, s[12:15], s45 offen sc1
    s_add_u32 s45, s63, 28672
    buffer_store_dwordx2 v[40:41], v11, s[12:15], s45 offen sc1
    s_lshl_b32 s61, s40, 16
    s_add_u32 s61, s61, 0x7000000
    s_add_u32 s45, s61, 16384
    buffer_store_dword v40, v12, s[12:15], s45 offen sc1
    s_add_u32 s45, s61, 32768
    buffer_store_dword v40, v12, s[12:15], s45 offen sc1
    s_add_u32 s45, s61, 49152
    buffer_store_dword v40, v12, s[12:15], s45 offen sc1
    v_lshlrev_b32 v63, 11, v69
    v_and_b32 v64, 14, v1
    v_lshlrev_b32 v64, 1, v64
    v_add_u32 v63, v63, v64
    s_lshl_b32 s45, s42, 7
    s_lshl_b32 s46, s44, 5
    s_add_u32 s45, s45, s46
    buffer_load_dword v45, v63, s[52:55], s45 offen
    s_mov_b32 s76, -1
    s_mov_b32 s77, -1
    v_lshrrev_b32 v63, 3, v1
    v_lshlrev_b32 v63, 11, v63
    v_bfe_u32 v64, v1, 1, 2
    v_and_b32 v65, 1, v1
    v_lshlrev_b32 v65, 4, v65
    v_add_u32 v63, v63, v65
    v_xor_b32 v66, 0, v64
    v_lshlrev_b32 v66, 5, v66
    v_add_u32 v70, v63, v66
    v_xor_b32 v66, 1, v64
    v_lshlrev_b32 v66, 5, v66
    v_add_u32 v71, v63, v66
    v_xor_b32 v66, 2, v64
    v_lshlrev_b32 v66, 5, v66
    v_add_u32 v72, v63, v66
    v_xor_b32 v66, 3, v64
    v_lshlrev_b32 v66, 5, v66
    v_add_u32 v73, v63, v66
    v_bfe_u32 v63, v1, 3, 1
    v_lshlrev_b32 v63, 1, v63
    v_bfe_u32 v64, v1, 4, 1
    v_add_u32 v63, v63, v64
    v_lshlrev_b32 v64, 3, v63
    v_lshrrev_b32 v65, 5, v1
    v_lshlrev_b32 v65, 2, v65
    v_add_u32 v64, v64, v65
    v_bfe_u32 v65, v1, 2, 1
    v_add_u32 v64, v64, v65
    v_lshlrev_b32 v64, 7, v64
    v_and_b32 v65, 3, v1
    v_lshlrev_b32 v65, 3, v65
    v_add_u32 v64, v64, v65
    s_lshl_b32 s45, s44, 12
    v_add_u32 v64, s45, v64
    s_add_u32 s45, s44, 1
    s_and_b32 s45, s45, 3
    v_xor_b32 v65, s45, v63
    v_lshlrev_b32 v65, 5, v65
    v_add_u32 v74, v64, v65
    s_mul_i32 s45, s44, 20480
    s_add_u32 s45, s45, 65536
    v_add_u32 v88, s45, v74
    s_add_u32 s45, s44, 2
    s_and_b32 s45, s45, 3
    v_xor_b32 v65, s45, v63
    v_lshlrev_b32 v65, 5, v65
    v_add_u32 v75, v64, v65
    s_mul_i32 s45, s44, 20480
    s_add_u32 s45, s45, 65536
    v_add_u32 v89, s45, v75
    s_add_u32 s45, s44, 3
    s_and_b32 s45, s45, 3
    v_xor_b32 v65, s45, v63
    v_lshlrev_b32 v65, 5, v65
    v_add_u32 v76, v64, v65
    s_mul_i32 s45, s44, 20480
    s_add_u32 s45, s45, 65536
    v_add_u32 v90, s45, v76
    s_add_u32 s45, s44, 4
    s_and_b32 s45, s45, 3
    v_xor_b32 v65, s45, v63
    v_lshlrev_b32 v65, 5, v65
    v_add_u32 v77, v64, v65
    s_mul_i32 s45, s44, 20480
    s_add_u32 s45, s45, 65536
    v_add_u32 v91, s45, v77
    s_mul_i32 s65, s44, 24576
    s_lshl_b32 s49, s40, 22
    s_lshl_b32 s45, s44, 20
    s_add_u32 s49, s49, s45
    s_lshl_b32 s45, s42, 7
    s_add_u32 s49, s49, s45
    s_lshl_b32 s50, s44, 12
    s_mul_i32 s69, s42, 1
    s_add_u32 s51, s69, 0
    s_and_b32 s51, s51, 7
    s_lshl_b32 s51, s51, 17
    s_add_u32 s51, s51, s49
    s_add_u32 s46, s51, 0x0
    s_add_u32 m0, s65, 65536
    s_nop 0
    buffer_load_dwordx4 v70, s[36:39], s46 offen  lds
    s_add_u32 s46, s51, 0x8000
    s_add_u32 m0, s65, 66560
    s_nop 0
    buffer_load_dwordx4 v71, s[36:39], s46 offen  lds
    s_add_u32 s46, s51, 0x10000
    s_add_u32 m0, s65, 67584
    s_nop 0
    buffer_load_dwordx4 v72, s[36:39], s46 offen  lds
    s_add_u32 s46, s51, 0x18000
    s_add_u32 m0, s65, 68608
    s_nop 0
    buffer_load_dwordx4 v73, s[36:39], s46 offen  lds
    s_add_u32 s51, s69, 0
    s_and_b32 s51, s51, 7
    s_lshl_b32 s51, s51, 17
    s_add_u32 s51, s51, s49
    s_add_u32 s46, s51, 0x4000
    s_add_u32 m0, s65, 69632
    s_nop 0
    buffer_load_dwordx4 v70, s[36:39], s46 offen  lds
    s_add_u32 s46, s51, 0xc000
    s_add_u32 m0, s65, 70656
    s_nop 0
    buffer_load_dwordx4 v71, s[36:39], s46 offen  lds
    s_add_u32 s46, s51, 0x14000
    s_add_u32 m0, s65, 71680
    s_nop 0
    buffer_load_dwordx4 v72, s[36:39], s46 offen  lds
    s_add_u32 s46, s51, 0x1c000
    s_add_u32 m0, s65, 72704
    s_nop 0
    buffer_load_dwordx4 v73, s[36:39], s46 offen  lds
    s_add_u32 s51, s69, 1
    s_and_b32 s51, s51, 7
    s_lshl_b32 s51, s51, 17
    s_add_u32 s51, s51, s49
    s_add_u32 s46, s51, 0x0
    s_add_u32 m0, s65, 73728
    s_nop 0
    buffer_load_dwordx4 v70, s[36:39], s46 offen  lds
    s_add_u32 s46, s51, 0x8000
    s_add_u32 m0, s65, 74752
    s_nop 0
    buffer_load_dwordx4 v71, s[36:39], s46 offen  lds
    s_add_u32 s46, s51, 0x10000
    s_add_u32 m0, s65, 75776
    s_nop 0
    buffer_load_dwordx4 v72, s[36:39], s46 offen  lds
    s_add_u32 s46, s51, 0x18000
    s_add_u32 m0, s65, 76800
    s_nop 0
    buffer_load_dwordx4 v73, s[36:39], s46 offen  lds
    s_add_u32 s51, s69, 1
    s_and_b32 s51, s51, 7
    s_lshl_b32 s51, s51, 17
    s_add_u32 s51, s51, s49
    s_add_u32 s46, s51, 0x4000
    s_add_u32 m0, s65, 77824
    s_nop 0
    buffer_load_dwordx4 v70, s[36:39], s46 offen  lds
    s_add_u32 s46, s51, 0xc000
    s_add_u32 m0, s65, 78848
    s_nop 0
    buffer_load_dwordx4 v71, s[36:39], s46 offen  lds
    s_add_u32 s46, s51, 0x14000
    s_add_u32 m0, s65, 79872
    s_nop 0
    buffer_load_dwordx4 v72, s[36:39], s46 offen  lds
    s_add_u32 s46, s51, 0x1c000
    s_add_u32 m0, s65, 80896
    s_nop 0
    buffer_load_dwordx4 v73, s[36:39], s46 offen  lds
    s_add_u32 s51, s69, 2
    s_and_b32 s51, s51, 7
    s_lshl_b32 s51, s51, 17
    s_add_u32 s51, s51, s49
    s_add_u32 s46, s51, 0x0
    s_add_u32 m0, s65, 81920
    s_nop 0
    buffer_load_dwordx4 v70, s[36:39], s46 offen  lds
    s_add_u32 s46, s51, 0x8000
    s_add_u32 m0, s65, 82944
    s_nop 0
    buffer_load_dwordx4 v71, s[36:39], s46 offen  lds
    s_add_u32 s46, s51, 0x10000
    s_add_u32 m0, s65, 83968
    s_nop 0
    buffer_load_dwordx4 v72, s[36:39], s46 offen  lds
    s_add_u32 s46, s51, 0x18000
    s_add_u32 m0, s65, 84992
    s_nop 0
    buffer_load_dwordx4 v73, s[36:39], s46 offen  lds
    s_add_u32 s51, s69, 2
    s_and_b32 s51, s51, 7
    s_lshl_b32 s51, s51, 17
    s_add_u32 s51, s51, s49
    s_add_u32 s46, s51, 0x4000
    s_add_u32 m0, s65, 86016
    s_nop 0
    buffer_load_dwordx4 v70, s[36:39], s46 offen  lds
    s_add_u32 s46, s51, 0xc000
    s_add_u32 m0, s65, 87040
    s_nop 0
    buffer_load_dwordx4 v71, s[36:39], s46 offen  lds
    s_add_u32 s46, s51, 0x14000
    s_add_u32 m0, s65, 88064
    s_nop 0
    buffer_load_dwordx4 v72, s[36:39], s46 offen  lds
    s_add_u32 s46, s51, 0x1c000
    s_add_u32 m0, s65, 89088
    s_nop 0
    buffer_load_dwordx4 v73, s[36:39], s46 offen  lds
    s_add_u32 s51, s69, 3
    s_and_b32 s51, s51, 7
    s_lshl_b32 s51, s51, 17
    s_add_u32 s51, s51, s49
    s_add_u32 s46, s51, 0x0
    s_add_u32 m0, s50, 0
    s_nop 0
    buffer_load_dwordx4 v70, s[36:39], s46 offen  lds
    s_add_u32 s46, s51, 0x8000
    s_add_u32 m0, s50, 1024
    s_nop 0
    buffer_load_dwordx4 v71, s[36:39], s46 offen  lds
    s_add_u32 s46, s51, 0x10000
    s_add_u32 m0, s50, 2048
    s_nop 0
    buffer_load_dwordx4 v72, s[36:39], s46 offen  lds
    s_add_u32 s46, s51, 0x18000
    s_add_u32 m0, s50, 3072
    s_nop 0
    buffer_load_dwordx4 v73, s[36:39], s46 offen  lds
    s_add_u32 s51, s69, 3
    s_and_b32 s51, s51, 7
    s_lshl_b32 s51, s51, 17
    s_add_u32 s51, s51, s49
    s_add_u32 s46, s51, 0x4000
    s_add_u32 m0, s50, 16384
    s_nop 0
    buffer_load_dwordx4 v70, s[36:39], s46 offen  lds
    s_add_u32 s46, s51, 0xc000
    s_add_u32 m0, s50, 17408
    s_nop 0
    buffer_load_dwordx4 v71, s[36:39], s46 offen  lds
    s_add_u32 s46, s51, 0x14000
    s_add_u32 m0, s50, 18432
    s_nop 0
    buffer_load_dwordx4 v72, s[36:39], s46 offen  lds
    s_add_u32 s46, s51, 0x1c000
    s_add_u32 m0, s50, 19456
    s_nop 0
    buffer_load_dwordx4 v73, s[36:39], s46 offen  lds
    s_add_u32 s51, s69, 4
    s_and_b32 s51, s51, 7
    s_lshl_b32 s51, s51, 17
    s_add_u32 s51, s51, s49
    s_add_u32 s46, s51, 0x0
    s_add_u32 m0, s50, 32768
    s_nop 0
    buffer_load_dwordx4 v70, s[36:39], s46 offen  lds
    s_add_u32 s46, s51, 0x8000
    s_add_u32 m0, s50, 33792
    s_nop 0
    buffer_load_dwordx4 v71, s[36:39], s46 offen  lds
    s_add_u32 s46, s51, 0x10000
    s_add_u32 m0, s50, 34816
    s_nop 0
    buffer_load_dwordx4 v72, s[36:39], s46 offen  lds
    s_add_u32 s46, s51, 0x18000
    s_add_u32 m0, s50, 35840
    s_nop 0
    buffer_load_dwordx4 v73, s[36:39], s46 offen  lds
    s_add_u32 s51, s69, 4
    s_and_b32 s51, s51, 7
    s_lshl_b32 s51, s51, 17
    s_add_u32 s51, s51, s49
    s_add_u32 s46, s51, 0x4000
    s_add_u32 m0, s50, 49152
    s_nop 0
    buffer_load_dwordx4 v70, s[36:39], s46 offen  lds
    s_add_u32 s46, s51, 0xc000
    s_add_u32 m0, s50, 50176
    s_nop 0
    buffer_load_dwordx4 v71, s[36:39], s46 offen  lds
    s_add_u32 s46, s51, 0x14000
    s_add_u32 m0, s50, 51200
    s_nop 0
    buffer_load_dwordx4 v72, s[36:39], s46 offen  lds
    s_add_u32 s46, s51, 0x1c000
    s_add_u32 m0, s50, 52224
    s_nop 0
    buffer_load_dwordx4 v73, s[36:39], s46 offen  lds
    s_waitcnt vmcnt(40)
    v_min_u32 v45, -2, v45
    buffer_store_dword v45, v12, s[12:15], s61 offen sc1
    s_waitcnt vmcnt(36)
    s_barrier
    ds_read_b64_tr_b16 a[160:161], v88 offset:0
    ds_read_b64_tr_b16 a[162:163], v88 offset:256
    ds_read_b64_tr_b16 a[168:169], v89 offset:0
    ds_read_b64_tr_b16 a[170:171], v89 offset:256
    ds_read_b64_tr_b16 a[176:177], v90 offset:0
    ds_read_b64_tr_b16 a[178:179], v90 offset:256
    ds_read_b64_tr_b16 a[184:185], v91 offset:0
    ds_read_b64_tr_b16 a[186:187], v91 offset:256
L_lw_50:
    s_waitcnt lgkmcnt(0)
    s_cmp_lg_u32 s44, 0
    s_cbranch_scc1 L_v_probe_51
    s_add_u32 s45, s63, 0
    s_memtime s[72:73]
    s_waitcnt lgkmcnt(0)
    s_load_dword s78, s[20:21], s45
    s_waitcnt lgkmcnt(0)
    s_memtime s[74:75]
    s_waitcnt lgkmcnt(0)
    s_sub_u32 s45, s74, s72
    s_min_u32 s76, s76, s45
    s_cmp_lt_u32 s77, s76
    s_cselect_b32 s68, 1, 0
L_v_probe_51:
    s_waitcnt vmcnt(32)
    s_barrier
    s_add_u32 s51, s69, 5
    s_and_b32 s51, s51, 7
    s_lshl_b32 s51, s51, 17
    s_add_u32 s51, s51, s49
    s_add_u32 s46, s51, 0x0
    s_add_u32 m0, s65, 65536
    s_nop 0
    buffer_load_dwordx4 v70, s[36:39], s46 offen  lds
    s_add_u32 s46, s51, 0x8000
    s_add_u32 m0, s65, 66560
    s_nop 0
    buffer_load_dwordx4 v71, s[36:39], s46 offen  lds
    s_add_u32 s46, s51, 0x10000
    s_add_u32 m0, s65, 67584
    s_nop 0
    buffer_load_dwordx4 v72, s[36:39], s46 offen  lds
    s_add_u32 s46, s51, 0x18000
    s_add_u32 m0, s65, 68608
    s_nop 0
    buffer_load_dwordx4 v73, s[36:39], s46 offen  lds
    ds_read_b64_tr_b16 a[164:165], v88 offset:4096
    ds_read_b64_tr_b16 a[166:167], v88 offset:4352
    ds_read_b64_tr_b16 a[172:173], v89 offset:4096
    ds_read_b64_tr_b16 a[174:175], v89 offset:4352
    ds_read_b64_tr_b16 a[180:181], v90 offset:4096
    ds_read_b64_tr_b16 a[182:183], v90 offset:4352
    ds_read_b64_tr_b16 a[188:189], v91 offset:4096
    ds_read_b64_tr_b16 a[190:191], v91 offset:4352
L_lw_52:
    s_waitcnt lgkmcnt(0)
    s_cmp_lg_u32 s44, 0
    s_cbranch_scc1 L_v_probe_53
    s_add_u32 s45, s63, 8192
    s_memtime s[72:73]
    s_waitcnt lgkmcnt(0)
    s_load_dword s78, s[20:21], s45
    s_waitcnt lgkmcnt(0)
    s_memtime s[74:75]
    s_waitcnt lgkmcnt(0)
    s_sub_u32 s45, s74, s72
    s_min_u32 s77, s77, s45
    s_cmp_lt_u32 s77, s76
    s_cselect_b32 s68, 1, 0
L_v_probe_53:
    s_waitcnt vmcnt(32)
    s_barrier
    s_add_u32 s51, s69, 5
    s_and_b32 s51, s51, 7
    s_lshl_b32 s51, s51, 17
    s_add_u32 s51, s51, s49
    s_add_u32 s46, s51, 0x4000
    s_add_u32 m0, s65, 69632
    s_nop 0
    buffer_load_dwordx4 v70, s[36:39], s46 offen  lds
    s_add_u32 s46, s51, 0xc000
    s_add_u32 m0, s65, 70656
    s_nop 0
    buffer_load_dwordx4 v71, s[36:39], s46 offen  lds
    s_add_u32 s46, s51, 0x14000
    s_add_u32 m0, s65, 71680
    s_nop 0
    buffer_load_dwordx4 v72, s[36:39], s46 offen  lds
    s_add_u32 s46, s51, 0x1c000
    s_add_u32 m0, s65, 72704
    s_nop 0
    buffer_load_dwordx4 v73, s[36:39], s46 offen  lds
    ds_read_b64_tr_b16 a[192:193], v88 offset:8192
    ds_read_b64_tr_b16 a[194:195], v88 offset:8448
    ds_read_b64_tr_b16 a[200:201], v89 offset:8192
    ds_read_b64_tr_b16 a[202:203], v89 offset:8448
    ds_read_b64_tr_b16 a[208:209], v90 offset:8192
    ds_read_b64_tr_b16 a[210:211], v90 offset:8448
    ds_read_b64_tr_b16 a[216:217], v91 offset:8192
    ds_read_b64_tr_b16 a[218:219], v91 offset:8448
L_lw_54:
    s_waitcnt lgkmcnt(0)
    s_cmp_lg_u32 s44, 0
    s_cbranch_scc1 L_v_probe_55
    s_add_u32 s45, s63, 128
    s_memtime s[72:73]
    s_waitcnt lgkmcnt(0)
    s_load_dword s78, s[20:21], s45
    s_waitcnt lgkmcnt(0)
    s_memtime s[74:75]
    s_waitcnt lgkmcnt(0)
    s_sub_u32 s45, s74, s72
    s_min_u32 s76, s76, s45
    s_cmp_lt_u32 s77, s76
    s_cselect_b32 s68, 1, 0
L_v_probe_55:
    s_waitcnt vmcnt(32)
    s_barrier
    s_add_u32 s51, s69, 6
    s_and_b32 s51, s51, 7
    s_lshl_b32 s51, s51, 17
    s_add_u32 s51, s51, s49
    s_add_u32 s46, s51, 0x0
    s_add_u32 m0, s65, 73728
    s_nop 0
    buffer_load_dwordx4 v70, s[36:39], s46 offen  lds
    s_add_u32 s46, s51, 0x8000
    s_add_u32 m0, s65, 74752
    s_nop 0
    buffer_load_dwordx4 v71, s[36:39], s46 offen  lds
    s_add_u32 s46, s51, 0x10000
    s_add_u32 m0, s65, 75776
    s_nop 0
    buffer_load_dwordx4 v72, s[36:39], s46 offen  lds
    s_add_u32 s46, s51, 0x18000
    s_add_u32 m0, s65, 76800
    s_nop 0
    buffer_load_dwordx4 v73, s[36:39], s46 offen  lds
    ds_read_b64_tr_b16 a[196:197], v88 offset:12288
    ds_read_b64_tr_b16 a[198:199], v88 offset:12544
    ds_read_b64_tr_b16 a[204:205], v89 offset:12288
    ds_read_b64_tr_b16 a[206:207], v89 offset:12544
    ds_read_b64_tr_b16 a[212:213], v90 offset:12288
    ds_read_b64_tr_b16 a[214:215], v90 offset:12544
    ds_read_b64_tr_b16 a[220:221], v91 offset:12288
    ds_read_b64_tr_b16 a[222:223], v91 offset:12544
L_lw_56:
    s_waitcnt lgkmcnt(0)
    s_cmp_lg_u32 s44, 0
    s_cbranch_scc1 L_v_probe_57
    s_add_u32 s45, s63, 8320
    s_memtime s[72:73]
    s_waitcnt lgkmcnt(0)
    s_load_dword s78, s[20:21], s45
    s_waitcnt lgkmcnt(0)
    s_memtime s[74:75]
    s_waitcnt lgkmcnt(0)
    s_sub_u32 s45, s74, s72
    s_min_u32 s77, s77, s45
    s_cmp_lt_u32 s77, s76
    s_cselect_b32 s68, 1, 0
L_v_probe_57:
    s_waitcnt vmcnt(32)
    s_barrier
    s_add_u32 s51, s69, 6
    s_and_b32 s51, s51, 7
    s_lshl_b32 s51, s51, 17
    s_add_u32 s51, s51, s49
    s_add_u32 s46, s51, 0x4000
    s_add_u32 m0, s65, 77824
    s_nop 0
    buffer_load_dwordx4 v70, s[36:39], s46 offen  lds
    s_add_u32 s46, s51, 0xc000
    s_add_u32 m0, s65, 78848
    s_nop 0
    buffer_load_dwordx4 v71, s[36:39], s46 offen  lds
    s_add_u32 s46, s51, 0x14000
    s_add_u32 m0, s65, 79872
    s_nop 0
    buffer_load_dwordx4 v72, s[36:39], s46 offen  lds
    s_add_u32 s46, s51, 0x1c000
    s_add_u32 m0, s65, 80896
    s_nop 0
    buffer_load_dwordx4 v73, s[36:39], s46 offen  lds
    ds_read_b64_tr_b16 a[224:225], v88 offset:16384
    ds_read_b64_tr_b16 a[226:227], v88 offset:16640
    ds_read_b64_tr_b16 a[232:233], v89 offset:16384
    ds_read_b64_tr_b16 a[234:235], v89 offset:16640
    ds_read_b64_tr_b16 a[240:241], v90 offset:16384
    ds_read_b64_tr_b16 a[242:243], v90 offset:16640
    ds_read_b64_tr_b16 a[248:249], v91 offset:16384
    ds_read_b64_tr_b16 a[250:251], v91 offset:16640
L_lw_58:
    s_waitcnt lgkmcnt(0)
    s_cmp_lg_u32 s44, 0
    s_cbranch_scc1 L_v_probe_59
    s_add_u32 s45, s63, 256
    s_memtime s[72:73]
    s_waitcnt lgkmcnt(0)
    s_load_dword s78, s[20:21], s45
    s_waitcnt lgkmcnt(0)
    s_memtime s[74:75]
    s_waitcnt lgkmcnt(0)
    s_sub_u32 s45, s74, s72
    s_min_u32 s76, s76, s45
    s_cmp_lt_u32 s77, s76
    s_cselect_b32 s68, 1, 0
L_v_probe_59:
    s_waitcnt vmcnt(32)
    s_barrier
    s_add_u32 s51, s69, 7
    s_and_b32 s51, s51, 7
    s_lshl_b32 s51, s51, 17
    s_add_u32 s51, s51, s49
    s_add_u32 s46, s51, 0x0
    s_add_u32 m0, s65, 81920
    s_nop 0
    buffer_load_dwordx4 v70, s[36:39], s46 offen  lds
    s_add_u32 s46, s51, 0x8000
    s_add_u32 m0, s65, 82944
    s_nop 0
    buffer_load_dwordx4 v71, s[36:39], s46 offen  lds
    s_add_u32 s46, s51, 0x10000
    s_add_u32 m0, s65, 83968
    s_nop 0
    buffer_load_dwordx4 v72, s[36:39], s46 offen  lds
    s_add_u32 s46, s51, 0x18000
    s_add_u32 m0, s65, 84992
    s_nop 0
    buffer_load_dwordx4 v73, s[36:39], s46 offen  lds
    ds_read_b64_tr_b16 a[228:229], v88 offset:20480
    ds_read_b64_tr_b16 a[230:231], v88 offset:20736
    ds_read_b64_tr_b16 a[236:237], v89 offset:20480
    ds_read_b64_tr_b16 a[238:239], v89 offset:20736
    ds_read_b64_tr_b16 a[244:245], v90 offset:20480
    ds_read_b64_tr_b16 a[246:247], v90 offset:20736
    ds_read_b64_tr_b16 a[252:253], v91 offset:20480
    ds_read_b64_tr_b16 a[254:255], v91 offset:20736
L_lw_60:
    s_waitcnt lgkmcnt(0)
    s_cmp_lg_u32 s44, 0
    s_cbranch_scc1 L_v_probe_61
    s_add_u32 s45, s63, 8448
    s_memtime s[72:73]
    s_waitcnt lgkmcnt(0)
    s_load_dword s78, s[20:21], s45
    s_waitcnt lgkmcnt(0)
    s_memtime s[74:75]
    s_waitcnt lgkmcnt(0)
    s_sub_u32 s45, s74, s72
    s_min_u32 s77, s77, s45
    s_cmp_lt_u32 s77, s76
    s_cselect_b32 s68, 1, 0
L_v_probe_61:
    s_waitcnt vmcnt(32)
    s_barrier
    s_add_u32 s51, s69, 7
    s_and_b32 s51, s51, 7
    s_lshl_b32 s51, s51, 17
    s_add_u32 s51, s51, s49
    s_add_u32 s46, s51, 0x4000
    s_add_u32 m0, s65, 86016
    s_nop 0
    buffer_load_dwordx4 v70, s[36:39], s46 offen  lds
    s_add_u32 s46, s51, 0xc000
    s_add_u32 m0, s65, 87040
    s_nop 0
    buffer_load_dwordx4 v71, s[36:39], s46 offen  lds
    s_add_u32 s46, s51, 0x14000
    s_add_u32 m0, s65, 88064
    s_nop 0
    buffer_load_dwordx4 v72, s[36:39], s46 offen  lds
    s_add_u32 s46, s51, 0x1c000
    s_add_u32 m0, s65, 89088
    s_nop 0
    buffer_load_dwordx4 v73, s[36:39], s46 offen  lds
    ds_read_b64_tr_b16 v[96:97], v74 offset:0
    ds_read_b64_tr_b16 v[98:99], v74 offset:256
    ds_read_b64_tr_b16 v[104:105], v75 offset:0
    ds_read_b64_tr_b16 v[106:107], v75 offset:256
    ds_read_b64_tr_b16 v[112:113], v76 offset:0
    ds_read_b64_tr_b16 v[114:115], v76 offset:256
    ds_read_b64_tr_b16 v[120:121], v77 offset:0
    ds_read_b64_tr_b16 v[122:123], v77 offset:256
L_lw_62:
    s_waitcnt lgkmcnt(0)
    s_waitcnt vmcnt(32)
    s_barrier
    s_add_u32 s79, s41, 0
    s_and_b32 s79, s79, 3
    s_lshl_b32 s79, s79, 19
    s_add_u32 s79, s79, s47
    s_add_u32 s46, s79, 0x0
    s_add_u32 m0, s48, 0
    s_nop 0
    buffer_load_dwordx4 v82, s[32:35], s46 offen  lds
    s_add_u32 s46, s79, 0x20000
    s_add_u32 m0, s48, 4096
    s_nop 0
    buffer_load_dwordx4 v82, s[32:35], s46 offen  lds
    s_add_u32 s46, s79, 0x40000
    s_add_u32 m0, s48, 8192
    s_nop 0
    buffer_load_dwordx4 v82, s[32:35], s46 offen  lds
    s_add_u32 s46, s79, 0x60000
    s_add_u32 m0, s48, 12288
    s_nop 0
    buffer_load_dwordx4 v82, s[32:35], s46 offen  lds
    ds_read_b64_tr_b16 v[100:101], v74 offset:16384
    ds_read_b64_tr_b16 v[102:103], v74 offset:16640
    ds_read_b64_tr_b16 v[108:109], v75 offset:16384
    ds_read_b64_tr_b16 v[110:111], v75 offset:16640
    ds_read_b64_tr_b16 v[116:117], v76 offset:16384
    ds_read_b64_tr_b16 v[118:119], v76 offset:16640
    ds_read_b64_tr_b16 v[124:125], v77 offset:16384
    ds_read_b64_tr_b16 v[126:127], v77 offset:16640
L_lw_63:
    s_waitcnt lgkmcnt(0)
    s_waitcnt vmcnt(32)
    s_barrier
    s_add_u32 s79, s41, 1
    s_and_b32 s79, s79, 3
    s_lshl_b32 s79, s79, 19
    s_add_u32 s79, s79, s47
    s_add_u32 s46, s79, 0x0
    s_add_u32 m0, s48, 16384
    s_nop 0
    buffer_load_dwordx4 v82, s[32:35], s46 offen  lds
    s_add_u32 s46, s79, 0x20000
    s_add_u32 m0, s48, 20480
    s_nop 0
    buffer_load_dwordx4 v82, s[32:35], s46 offen  lds
    s_add_u32 s46, s79, 0x40000
    s_add_u32 m0, s48, 24576
    s_nop 0
    buffer_load_dwordx4 v82, s[32:35], s46 offen  lds
    s_add_u32 s46, s79, 0x60000
    s_add_u32 m0, s48, 28672
    s_nop 0
    buffer_load_dwordx4 v82, s[32:35], s46 offen  lds
    ds_read_b64_tr_b16 v[128:129], v74 offset:32768
    ds_read_b64_tr_b16 v[130:131], v74 offset:33024
    ds_read_b64_tr_b16 v[136:137], v75 offset:32768
    ds_read_b64_tr_b16 v[138:139], v75 offset:33024
    ds_read_b64_tr_b16 v[144:145], v76 offset:32768
    ds_read_b64_tr_b16 v[146:147], v76 offset:33024
    ds_read_b64_tr_b16 v[152:153], v77 offset:32768
    ds_read_b64_tr_b16 v[154:155], v77 offset:33024
L_lw_64:
    s_waitcnt lgkmcnt(0)
    s_waitcnt vmcnt(32)
    s_barrier
    s_add_u32 s79, s41, 2
    s_and_b32 s79, s79, 3
    s_lshl_b32 s79, s79, 19
    s_add_u32 s79, s79, s47
    s_add_u32 s46, s79, 0x0
    s_add_u32 m0, s48, 32768
    s_nop 0
    buffer_load_dwordx4 v82, s[32:35], s46 offen  lds
    s_add_u32 s46, s79, 0x20000
    s_add_u32 m0, s48, 36864
    s_nop 0
    buffer_load_dwordx4 v82, s[32:35], s46 offen  lds
    s_add_u32 s46, s79, 0x40000
    s_add_u32 m0, s48, 40960
    s_nop 0
    buffer_load_dwordx4 v82, s[32:35], s46 offen  lds
    s_add_u32 s46, s79, 0x60000
    s_add_u32 m0, s48, 45056
    s_nop 0
    buffer_load_dwordx4 v82, s[32:35], s46 offen  lds
    ds_read_b64_tr_b16 v[132:133], v74 offset:49152
    ds_read_b64_tr_b16 v[134:135], v74 offset:49408
    ds_read_b64_tr_b16 v[140:141], v75 offset:49152
    ds_read_b64_tr_b16 v[142:143], v75 offset:49408
    ds_read_b64_tr_b16 v[148:149], v76 offset:49152
    ds_read_b64_tr_b16 v[150:151], v76 offset:49408
    ds_read_b64_tr_b16 v[156:157], v77 offset:49152
    ds_read_b64_tr_b16 v[158:159], v77 offset:49408
L_lw_65:
    s_waitcnt lgkmcnt(0)
    s_waitcnt vmcnt(32)
    s_barrier
    s_add_u32 s79, s41, 3
    s_and_b32 s79, s79, 3
    s_lshl_b32 s79, s79, 19
    s_add_u32 s79, s79, s47
    s_add_u32 s46, s79, 0x0
    s_add_u32 m0, s48, 49152
    s_nop 0
    buffer_load_dwordx4 v82, s[32:35], s46 offen  lds
    s_add_u32 s46, s79, 0x20000
    s_add_u32 m0, s48, 53248
    s_nop 0
    buffer_load_dwordx4 v82, s[32:35], s46 offen  lds
    s_add_u32 s46, s79, 0x40000
    s_add_u32 m0, s48, 57344
    s_nop 0
    buffer_load_dwordx4 v82, s[32:35], s46 offen  lds
    s_add_u32 s46, s79, 0x60000
    s_add_u32 m0, s48, 61440
    s_nop 0
    buffer_load_dwordx4 v82, s[32:35], s46 offen  lds
    ds_read_b64_tr_b16 v[160:161], v88 offset:0
    ds_read_b64_tr_b16 v[162:163], v88 offset:256
    ds_read_b64_tr_b16 v[168:169], v89 offset:0
    ds_read_b64_tr_b16 v[170:171], v89 offset:256
    ds_read_b64_tr_b16 v[176:177], v90 offset:0
    ds_read_b64_tr_b16 v[178:179], v90 offset:256
    ds_read_b64_tr_b16 v[184:185], v91 offset:0
    ds_read_b64_tr_b16 v[186:187], v91 offset:256
L_lw_66:
    s_waitcnt lgkmcnt(0)
    s_waitcnt vmcnt(32)
    s_barrier
    s_cmp_lg_u32 s44, 0
    s_cbranch_scc1 L_hs_67
    s_getreg_b32 s45, hwreg(HW_REG_XCC_ID)
    s_and_b32 s45, s45, 15
    s_mul_i32 s46, s45, s45
    s_lshl_b32 s46, s46, 9
    s_add_u32 s45, s45, s46
    s_cmp_eq_u32 s40, 0
    s_cselect_b32 s46, s45, 0
    s_cselect_b32 s45, 0, s45
    s_lshl_b32 s68, s68, 24
    s_add_u32 s46, s46, s68
    s_add_u32 s45, s45, 16777216
    v_mov_b32 v40, s46
    v_mov_b32 v41, s45
    v_mov_b32 v42, 0
    s_mov_b64 exec, 1
    buffer_atomic_add_x2 v[40:41], v42, s[16:19], 0 offen sc1
    s_mov_b64 exec, -1
L_hs_67:
    ds_read_b64_tr_b16 v[164:165], v88 offset:4096
    ds_read_b64_tr_b16 v[166:167], v88 offset:4352
    ds_read_b64_tr_b16 v[172:173], v89 offset:4096
    ds_read_b64_tr_b16 v[174:175], v89 offset:4352
    ds_read_b64_tr_b16 v[180:181], v90 offset:4096
    ds_read_b64_tr_b16 v[182:183], v90 offset:4352
    ds_read_b64_tr_b16 v[188:189], v91 offset:4096
    ds_read_b64_tr_b16 v[190:191], v91 offset:4352
L_lw_68:
    s_waitcnt lgkmcnt(0)
    s_waitcnt vmcnt(28)
    s_barrier
    ds_read_b64_tr_b16 v[192:193], v88 offset:8192
    ds_read_b64_tr_b16 v[194:195], v88 offset:8448
    ds_read_b64_tr_b16 v[200:201], v89 offset:8192
    ds_read_b64_tr_b16 v[202:203], v89 offset:8448
    ds_read_b64_tr_b16 v[208:209], v90 offset:8192
    ds_read_b64_tr_b16 v[210:211], v90 offset:8448
    ds_read_b64_tr_b16 v[216:217], v91 offset:8192
    ds_read_b64_tr_b16 v[218:219], v91 offset:8448
L_lw_69:
    s_waitcnt lgkmcnt(0)
    s_waitcnt vmcnt(24)
    s_barrier
    ds_read_b64_tr_b16 v[196:197], v88 offset:12288
    ds_read_b64_tr_b16 v[198:199], v88 offset:12544
    ds_read_b64_tr_b16 v[204:205], v89 offset:12288
    ds_read_b64_tr_b16 v[206:207], v89 offset:12544
    ds_read_b64_tr_b16 v[212:213], v90 offset:12288
    ds_read_b64_tr_b16 v[214:215], v90 offset:12544
    ds_read_b64_tr_b16 v[220:221], v91 offset:12288
    ds_read_b64_tr_b16 v[222:223], v91 offset:12544
L_lw_70:
    s_waitcnt lgkmcnt(0)
    s_waitcnt vmcnt(20)
    s_barrier
    ds_read_b64_tr_b16 v[224:225], v88 offset:16384
    ds_read_b64_tr_b16 v[226:227], v88 offset:16640
    ds_read_b64_tr_b16 v[232:233], v89 offset:16384
    ds_read_b64_tr_b16 v[234:235], v89 offset:16640
    ds_read_b64_tr_b16 v[240:241], v90 offset:16384
    ds_read_b64_tr_b16 v[242:243], v90 offset:16640
    ds_read_b64_tr_b16 v[248:249], v91 offset:16384
    ds_read_b64_tr_b16 v[250:251], v91 offset:16640
L_lw_71:
    s_waitcnt lgkmcnt(0)
    s_waitcnt vmcnt(16)
    s_barrier
    ds_read_b64_tr_b16 v[228:229], v88 offset:20480
    ds_read_b64_tr_b16 v[230:231], v88 offset:20736
    ds_read_b64_tr_b16 v[236:237], v89 offset:20480
    ds_read_b64_tr_b16 v[238:239], v89 offset:20736
    ds_read_b64_tr_b16 v[244:245], v90 offset:20480
    ds_read_b64_tr_b16 v[246:247], v90 offset:20736
    ds_read_b64_tr_b16 v[252:253], v91 offset:20480
    ds_read_b64_tr_b16 v[254:255], v91 offset:20736
L_lw_72:
    s_waitcnt lgkmcnt(0)
    s_waitcnt vmcnt(12)
    s_barrier
    s_cmp_lg_u32 s44, 0
    s_cbranch_scc1 L_lw_73_0
    ds_read_b64_tr_b16 a[0:1], v80 offset:0
    ds_read_b64_tr_b16 a[2:3], v80 offset:1024
    ds_read_b64_tr_b16 a[4:5], v80 offset:8192
    ds_read_b64_tr_b16 a[6:7], v80 offset:9216
    ds_read_b64_tr_b16 a[8:9], v81 offset:0
    ds_read_b64_tr_b16 a[10:11], v81 offset:1024
    ds_read_b64_tr_b16 a[12:13], v81 offset:8192
    ds_read_b64_tr_b16 a[14:15], v81 offset:9216
    s_branch L_lw_73
L_lw_73_0:
    s_cmp_lg_u32 s44, 1
    s_cbranch_scc1 L_lw_73_1
    ds_read_b64_tr_b16 a[120:121], v80 offset:0
    ds_read_b64_tr_b16 a[122:123], v80 offset:1024
    ds_read_b64_tr_b16 a[124:125], v80 offset:8192
    ds_read_b64_tr_b16 a[126:127], v80 offset:9216
    ds_read_b64_tr_b16 v[56:57], v81 offset:0
    ds_read_b64_tr_b16 v[58:59], v81 offset:1024
    ds_read_b64_tr_b16 v[60:61], v81 offset:8192
    ds_read_b64_tr_b16 v[62:63], v81 offset:9216
    s_waitcnt lgkmcnt(0)
    ds_write_b128 v5, v[56:59] offset:0
    ds_write_b128 v5, v[60:63] offset:1024
    s_branch L_lw_73
L_lw_73_1:
    s_cmp_lg_u32 s44, 2
    s_cbranch_scc1 L_lw_73_2
    ds_read_b64_tr_b16 a[80:81], v80 offset:0
    ds_read_b64_tr_b16 a[82:83], v80 offset:1024
    ds_read_b64_tr_b16 a[84:85], v80 offset:8192
    ds_read_b64_tr_b16 a[86:87], v80 offset:9216
    ds_read_b64_tr_b16 v[56:57], v81 offset:0
    ds_read_b64_tr_b16 v[58:59], v81 offset:1024
    ds_read_b64_tr_b16 v[60:61], v81 offset:8192
    ds_read_b64_tr_b16 v[62:63], v81 offset:9216
    s_waitcnt lgkmcnt(0)
    ds_write_b128 v5, v[56:59] offset:2048
    ds_write_b128 v5, v[60:63] offset:3072
    s_branch L_lw_73
L_lw_73_2:
    ds_read_b64_tr_b16 a[48:49], v80 offset:0
    ds_read_b64_tr_b16 a[50:51], v80 offset:1024
    ds_read_b64_tr_b16 a[52:53], v80 offset:8192
    ds_read_b64_tr_b16 a[54:55], v80 offset:9216
    ds_read_b64_tr_b16 v[56:57], v81 offset:0
    ds_read_b64_tr_b16 v[58:59], v81 offset:1024
    ds_read_b64_tr_b16 v[60:61], v81 offset:8192
    ds_read_b64_tr_b16 v[62:63], v81 offset:9216
    s_waitcnt lgkmcnt(0)
    ds_write_b128 v5, v[56:59] offset:4096
    ds_write_b128 v5, v[60:63] offset:5120
L_lw_73:
    s_waitcnt lgkmcnt(0)
    s_waitcnt vmcnt(8)
    s_barrier
    s_add_u32 s79, s41, 4
    s_and_b32 s79, s79, 3
    s_lshl_b32 s79, s79, 19
    s_add_u32 s79, s79, s47
    s_add_u32 s46, s79, 0x200000
    s_add_u32 m0, s48, 0
    s_nop 0
    buffer_load_dwordx4 v82, s[32:35], s46 offen  lds
    s_add_u32 s46, s79, 0x220000
    s_add_u32 m0, s48, 4096
    s_nop 0
    buffer_load_dwordx4 v82, s[32:35], s46 offen  lds
    s_add_u32 s46, s79, 0x240000
    s_add_u32 m0, s48, 8192
    s_nop 0
    buffer_load_dwordx4 v82, s[32:35], s46 offen  lds
    s_add_u32 s46, s79, 0x260000
    s_add_u32 m0, s48, 12288
    s_nop 0
    buffer_load_dwordx4 v82, s[32:35], s46 offen  lds
    s_cmp_lg_u32 s44, 0
    s_cbranch_scc1 L_lw_74_0
    ds_read_b64_tr_b16 a[16:17], v80 offset:16384
    ds_read_b64_tr_b16 a[18:19], v80 offset:17408
    ds_read_b64_tr_b16 a[20:21], v80 offset:24576
    ds_read_b64_tr_b16 a[22:23], v80 offset:25600
    ds_read_b64_tr_b16 a[24:25], v81 offset:16384
    ds_read_b64_tr_b16 a[26:27], v81 offset:17408
    ds_read_b64_tr_b16 a[28:29], v81 offset:24576
    ds_read_b64_tr_b16 a[30:31], v81 offset:25600
    s_branch L_lw_74
L_lw_74_0:
    s_cmp_lg_u32 s44, 1
    s_cbranch_scc1 L_lw_74_1
    ds_read_b64_tr_b16 a[128:129], v80 offset:16384
    ds_read_b64_tr_b16 a[130:131], v80 offset:17408
    ds_read_b64_tr_b16 a[132:133], v80 offset:24576
    ds_read_b64_tr_b16 a[134:135], v80 offset:25600
    ds_read_b64_tr_b16 a[136:137], v81 offset:16384
    ds_read_b64_tr_b16 a[138:139], v81 offset:17408
    ds_read_b64_tr_b16 a[140:141], v81 offset:24576
    ds_read_b64_tr_b16 a[142:143], v81 offset:25600
    s_branch L_lw_74
L_lw_74_1:
    s_cmp_lg_u32 s44, 2
    s_cbranch_scc1 L_lw_74_2
    ds_read_b64_tr_b16 a[88:89], v80 offset:16384
    ds_read_b64_tr_b16 a[90:91], v80 offset:17408
    ds_read_b64_tr_b16 a[92:93], v80 offset:24576
    ds_read_b64_tr_b16 a[94:95], v80 offset:25600
    ds_read_b64_tr_b16 a[96:97], v81 offset:16384
    ds_read_b64_tr_b16 a[98:99], v81 offset:17408
    ds_read_b64_tr_b16 a[100:101], v81 offset:24576
    ds_read_b64_tr_b16 a[102:103], v81 offset:25600
    s_branch L_lw_74
L_lw_74_2:
    ds_read_b64_tr_b16 a[56:57], v80 offset:16384
    ds_read_b64_tr_b16 a[58:59], v80 offset:17408
    ds_read_b64_tr_b16 a[60:61], v80 offset:24576
    ds_read_b64_tr_b16 a[62:63], v80 offset:25600
    ds_read_b64_tr_b16 v[56:57], v81 offset:16384
    ds_read_b64_tr_b16 v[58:59], v81 offset:17408
    ds_read_b64_tr_b16 v[60:61], v81 offset:24576
    ds_read_b64_tr_b16 v[62:63], v81 offset:25600
    s_waitcnt lgkmcnt(0)
    ds_write_b128 v5, v[56:59] offset:6144
    ds_write_b128 v5, v[60:63] offset:7168
L_lw_74:
    s_waitcnt lgkmcnt(0)
    s_waitcnt vmcnt(8)
    s_barrier
    s_add_u32 s79, s41, 5
    s_and_b32 s79, s79, 3
    s_lshl_b32 s79, s79, 19
    s_add_u32 s79, s79, s47
    s_add_u32 s46, s79, 0x200000
    s_add_u32 m0, s48, 16384
    s_nop 0
    buffer_load_dwordx4 v82, s[32:35], s46 offen  lds
    s_add_u32 s46, s79, 0x220000
    s_add_u32 m0, s48, 20480
    s_nop 0
    buffer_load_dwordx4 v82, s[32:35], s46 offen  lds
    s_add_u32 s46, s79, 0x240000
    s_add_u32 m0, s48, 24576
    s_nop 0
    buffer_load_dwordx4 v82, s[32:35], s46 offen  lds
    s_add_u32 s46, s79, 0x260000
    s_add_u32 m0, s48, 28672
    s_nop 0
    buffer_load_dwordx4 v82, s[32:35], s46 offen  lds
    s_cmp_lg_u32 s44, 0
    s_cbranch_scc1 L_lw_75_0
    ds_read_b64_tr_b16 a[32:33], v80 offset:32768
    ds_read_b64_tr_b16 a[34:35], v80 offset:33792
    ds_read_b64_tr_b16 a[36:37], v80 offset:40960
    ds_read_b64_tr_b16 a[38:39], v80 offset:41984
    ds_read_b64_tr_b16 v[56:57], v81 offset:32768
    ds_read_b64_tr_b16 v[58:59], v81 offset:33792
    ds_read_b64_tr_b16 v[60:61], v81 offset:40960
    ds_read_b64_tr_b16 v[62:63], v81 offset:41984
    s_waitcnt lgkmcnt(0)
    ds_write_b128 v5, v[56:59] offset:8192
    ds_write_b128 v5, v[60:63] offset:9216
    s_branch L_lw_75
L_lw_75_0:
    s_cmp_lg_u32 s44, 1
    s_cbranch_scc1 L_lw_75_1
    ds_read_b64_tr_b16 a[144:145], v80 offset:32768
    ds_read_b64_tr_b16 a[146:147], v80 offset:33792
    ds_read_b64_tr_b16 a[148:149], v80 offset:40960
    ds_read_b64_tr_b16 a[150:151], v80 offset:41984
    ds_read_b64_tr_b16 v[56:57], v81 offset:32768
    ds_read_b64_tr_b16 v[58:59], v81 offset:33792
    ds_read_b64_tr_b16 v[60:61], v81 offset:40960
    ds_read_b64_tr_b16 v[62:63], v81 offset:41984
    s_waitcnt lgkmcnt(0)
    ds_write_b128 v5, v[56:59] offset:10240
    ds_write_b128 v5, v[60:63] offset:11264
    s_branch L_lw_75
L_lw_75_1:
    s_cmp_lg_u32 s44, 2
    s_cbranch_scc1 L_lw_75_2
    ds_read_b64_tr_b16 a[104:105], v80 offset:32768
    ds_read_b64_tr_b16 a[106:107], v80 offset:33792
    ds_read_b64_tr_b16 a[108:109], v80 offset:40960
    ds_read_b64_tr_b16 a[110:111], v80 offset:41984
    ds_read_b64_tr_b16 v[56:57], v81 offset:32768
    ds_read_b64_tr_b16 v[58:59], v81 offset:33792
    ds_read_b64_tr_b16 v[60:61], v81 offset:40960
    ds_read_b64_tr_b16 v[62:63], v81 offset:41984
    s_waitcnt lgkmcnt(0)
    ds_write_b128 v5, v[56:59] offset:12288
    ds_write_b128 v5, v[60:63] offset:13312
    s_branch L_lw_75
L_lw_75_2:
    ds_read_b64_tr_b16 a[64:65], v80 offset:32768
    ds_read_b64_tr_b16 a[66:67], v80 offset:33792
    ds_read_b64_tr_b16 a[68:69], v80 offset:40960
    ds_read_b64_tr_b16 a[70:71], v80 offset:41984
    ds_read_b64_tr_b16 v[56:57], v81 offset:32768
    ds_read_b64_tr_b16 v[58:59], v81 offset:33792
    ds_read_b64_tr_b16 v[60:61], v81 offset:40960
    ds_read_b64_tr_b16 v[62:63], v81 offset:41984
    s_waitcnt lgkmcnt(0)
    ds_write_b128 v5, v[56:59] offset:14336
    ds_write_b128 v5, v[60:63] offset:15360
L_lw_75:
    s_waitcnt lgkmcnt(0)
    s_waitcnt vmcnt(8)
    s_barrier
    s_add_u32 s79, s41, 6
    s_and_b32 s79, s79, 3
    s_lshl_b32 s79, s79, 19
    s_add_u32 s79, s79, s47
    s_add_u32 s46, s79, 0x200000
    s_add_u32 m0, s48, 32768
    s_nop 0
    buffer_load_dwordx4 v82, s[32:35], s46 offen  lds
    s_add_u32 s46, s79, 0x220000
    s_add_u32 m0, s48, 36864
    s_nop 0
    buffer_load_dwordx4 v82, s[32:35], s46 offen  lds
    s_add_u32 s46, s79, 0x240000
    s_add_u32 m0, s48, 40960
    s_nop 0
    buffer_load_dwordx4 v82, s[32:35], s46 offen  lds
    s_add_u32 s46, s79, 0x260000
    s_add_u32 m0, s48, 45056
    s_nop 0
    buffer_load_dwordx4 v82, s[32:35], s46 offen  lds
    s_cmp_lg_u32 s44, 0
    s_cbranch_scc1 L_lw_76_0
    ds_read_b64_tr_b16 a[40:41], v80 offset:49152
    ds_read_b64_tr_b16 a[42:43], v80 offset:50176
    ds_read_b64_tr_b16 a[44:45], v80 offset:57344
    ds_read_b64_tr_b16 a[46:47], v80 offset:58368
    ds_read_b64_tr_b16 v[56:57], v81 offset:49152
    ds_read_b64_tr_b16 v[58:59], v81 offset:50176
    ds_read_b64_tr_b16 v[60:61], v81 offset:57344
    ds_read_b64_tr_b16 v[62:63], v81 offset:58368
    s_waitcnt lgkmcnt(0)
    ds_write_b128 v5, v[56:59] offset:16384
    ds_write_b128 v5, v[60:63] offset:17408
    s_branch L_lw_76
L_lw_76_0:
    s_cmp_lg_u32 s44, 1
    s_cbranch_scc1 L_lw_76_1
    ds_read_b64_tr_b16 a[152:153], v80 offset:49152
    ds_read_b64_tr_b16 a[154:155], v80 offset:50176
    ds_read_b64_tr_b16 a[156:157], v80 offset:57344
    ds_read_b64_tr_b16 a[158:159], v80 offset:58368
    ds_read_b64_tr_b16 v[56:57], v81 offset:49152
    ds_read_b64_tr_b16 v[58:59], v81 offset:50176
    ds_read_b64_tr_b16 v[60:61], v81 offset:57344
    ds_read_b64_tr_b16 v[62:63], v81 offset:58368
    s_waitcnt lgkmcnt(0)
    ds_write_b128 v5, v[56:59] offset:18432
    ds_write_b128 v5, v[60:63] offset:19456
    s_branch L_lw_76
L_lw_76_1:
    s_cmp_lg_u32 s44, 2
    s_cbranch_scc1 L_lw_76_2
    ds_read_b64_tr_b16 a[112:113], v80 offset:49152
    ds_read_b64_tr_b16 a[114:115], v80 offset:50176
    ds_read_b64_tr_b16 a[116:117], v80 offset:57344
    ds_read_b64_tr_b16 a[118:119], v80 offset:58368
    ds_read_b64_tr_b16 v[56:57], v81 offset:49152
    ds_read_b64_tr_b16 v[58:59], v81 offset:50176
    ds_read_b64_tr_b16 v[60:61], v81 offset:57344
    ds_read_b64_tr_b16 v[62:63], v81 offset:58368
    s_waitcnt lgkmcnt(0)
    ds_write_b128 v5, v[56:59] offset:20480
    ds_write_b128 v5, v[60:63] offset:21504
    s_branch L_lw_76
L_lw_76_2:
    ds_read_b64_tr_b16 a[72:73], v80 offset:49152
    ds_read_b64_tr_b16 a[74:75], v80 offset:50176
    ds_read_b64_tr_b16 a[76:77], v80 offset:57344
    ds_read_b64_tr_b16 a[78:79], v80 offset:58368
    ds_read_b64_tr_b16 v[56:57], v81 offset:49152
    ds_read_b64_tr_b16 v[58:59], v81 offset:50176
    ds_read_b64_tr_b16 v[60:61], v81 offset:57344
    ds_read_b64_tr_b16 v[62:63], v81 offset:58368
    s_waitcnt lgkmcnt(0)
    ds_write_b128 v5, v[56:59] offset:22528
    ds_write_b128 v5, v[60:63] offset:23552
L_lw_76:
    s_waitcnt lgkmcnt(0)
    s_waitcnt vmcnt(8)
    s_barrier
    s_add_u32 s79, s41, 7
    s_and_b32 s79, s79, 3
    s_lshl_b32 s79, s79, 19
    s_add_u32 s79, s79, s47
    s_add_u32 s46, s79, 0x200000
    s_add_u32 m0, s48, 49152
    s_nop 0
    buffer_load_dwordx4 v82, s[32:35], s46 offen  lds
    s_add_u32 s46, s79, 0x220000
    s_add_u32 m0, s48, 53248
    s_nop 0
    buffer_load_dwordx4 v82, s[32:35], s46 offen  lds
    s_add_u32 s46, s79, 0x240000
    s_add_u32 m0, s48, 57344
    s_nop 0
    buffer_load_dwordx4 v82, s[32:35], s46 offen  lds
    s_add_u32 s46, s79, 0x260000
    s_add_u32 m0, s48, 61440
    s_nop 0
    buffer_load_dwordx4 v82, s[32:35], s46 offen  lds
    s_cmp_lg_u32 s44, 0
    s_cbranch_scc1 L_lw_77_0
    ds_read_b64_tr_b16 a[48:49], v80 offset:0
    ds_read_b64_tr_b16 a[50:51], v80 offset:1024
    ds_read_b64_tr_b16 a[52:53], v80 offset:8192
    ds_read_b64_tr_b16 a[54:55], v80 offset:9216
    ds_read_b64_tr_b16 v[56:57], v81 offset:0
    ds_read_b64_tr_b16 v[58:59], v81 offset:1024
    ds_read_b64_tr_b16 v[60:61], v81 offset:8192
    ds_read_b64_tr_b16 v[62:63], v81 offset:9216
    s_waitcnt lgkmcnt(0)
    ds_write_b128 v5, v[56:59] offset:4096
    ds_write_b128 v5, v[60:63] offset:5120
    s_branch L_lw_77
L_lw_77_0:
    s_cmp_lg_u32 s44, 1
    s_cbranch_scc1 L_lw_77_1
    ds_read_b64_tr_b16 a[0:1], v80 offset:0
    ds_read_b64_tr_b16 a[2:3], v80 offset:1024
    ds_read_b64_tr_b16 a[4:5], v80 offset:8192
    ds_read_b64_tr_b16 a[6:7], v80 offset:9216
    ds_read_b64_tr_b16 a[8:9], v81 offset:0
    ds_read_b64_tr_b16 a[10:11], v81 offset:1024
    ds_read_b64_tr_b16 a[12:13], v81 offset:8192
    ds_read_b64_tr_b16 a[14:15], v81 offset:9216
    s_branch L_lw_77
L_lw_77_1:
    s_cmp_lg_u32 s44, 2
    s_cbranch_scc1 L_lw_77_2
    ds_read_b64_tr_b16 a[120:121], v80 offset:0
    ds_read_b64_tr_b16 a[122:123], v80 offset:1024
    ds_read_b64_tr_b16 a[124:125], v80 offset:8192
    ds_read_b64_tr_b16 a[126:127], v80 offset:9216
    ds_read_b64_tr_b16 v[56:57], v81 offset:0
    ds_read_b64_tr_b16 v[58:59], v81 offset:1024
    ds_read_b64_tr_b16 v[60:61], v81 offset:8192
    ds_read_b64_tr_b16 v[62:63], v81 offset:9216
    s_waitcnt lgkmcnt(0)
    ds_write_b128 v5, v[56:59] offset:0
    ds_write_b128 v5, v[60:63] offset:1024
    s_branch L_lw_77
L_lw_77_2:
    ds_read_b64_tr_b16 a[80:81], v80 offset:0
    ds_read_b64_tr_b16 a[82:83], v80 offset:1024
    ds_read_b64_tr_b16 a[84:85], v80 offset:8192
    ds_read_b64_tr_b16 a[86:87], v80 offset:9216
    ds_read_b64_tr_b16 v[56:57], v81 offset:0
    ds_read_b64_tr_b16 v[58:59], v81 offset:1024
    ds_read_b64_tr_b16 v[60:61], v81 offset:8192
    ds_read_b64_tr_b16 v[62:63], v81 offset:9216
    s_waitcnt lgkmcnt(0)
    ds_write_b128 v5, v[56:59] offset:2048
    ds_write_b128 v5, v[60:63] offset:3072
L_lw_77:
    s_waitcnt lgkmcnt(0)
    s_waitcnt vmcnt(8)
    s_barrier
    s_add_u32 s79, s41, 8
    s_and_b32 s79, s79, 3
    s_lshl_b32 s79, s79, 19
    s_add_u32 s79, s79, s47
    s_add_u32 s46, s79, 0x400000
    s_add_u32 m0, s48, 0
    s_nop 0
    buffer_load_dwordx4 v82, s[32:35], s46 offen  lds
    s_add_u32 s46, s79, 0x420000
    s_add_u32 m0, s48, 4096
    s_nop 0
    buffer_load_dwordx4 v82, s[32:35], s46 offen  lds
    s_add_u32 s46, s79, 0x440000
    s_add_u32 m0, s48, 8192
    s_nop 0
    buffer_load_dwordx4 v82, s[32:35], s46 offen  lds
    s_add_u32 s46, s79, 0x460000
    s_add_u32 m0, s48, 12288
    s_nop 0
    buffer_load_dwordx4 v82, s[32:35], s46 offen  lds
    s_cmp_lg_u32 s44, 0
    s_cbranch_scc1 L_lw_78_0
    ds_read_b64_tr_b16 a[56:57], v80 offset:16384
    ds_read_b64_tr_b16 a[58:59], v80 offset:17408
    ds_read_b64_tr_b16 a[60:61], v80 offset:24576
    ds_read_b64_tr_b16 a[62:63], v80 offset:25600
    ds_read_b64_tr_b16 v[56:57], v81 offset:16384
    ds_read_b64_tr_b16 v[58:59], v81 offset:17408
    ds_read_b64_tr_b16 v[60:61], v81 offset:24576
    ds_read_b64_tr_b16 v[62:63], v81 offset:25600
    s_waitcnt lgkmcnt(0)
    ds_write_b128 v5, v[56:59] offset:6144
    ds_write_b128 v5, v[60:63] offset:7168
    s_branch L_lw_78
L_lw_78_0:
    s_cmp_lg_u32 s44, 1
    s_cbranch_scc1 L_lw_78_1
    ds_read_b64_tr_b16 a[16:17], v80 offset:16384
    ds_read_b64_tr_b16 a[18:19], v80 offset:17408
    ds_read_b64_tr_b16 a[20:21], v80 offset:24576
    ds_read_b64_tr_b16 a[22:23], v80 offset:25600
    ds_read_b64_tr_b16 a[24:25], v81 offset:16384
    ds_read_b64_tr_b16 a[26:27], v81 offset:17408
    ds_read_b64_tr_b16 a[28:29], v81 offset:24576
    ds_read_b64_tr_b16 a[30:31], v81 offset:25600
    s_branch L_lw_78
L_lw_78_1:
    s_cmp_lg_u32 s44, 2
    s_cbranch_scc1 L_lw_78_2
    ds_read_b64_tr_b16 a[128:129], v80 offset:16384
    ds_read_b64_tr_b16 a[130:131], v80 offset:17408
    ds_read_b64_tr_b16 a[132:133], v80 offset:24576
    ds_read_b64_tr_b16 a[134:135], v80 offset:25600
    ds_read_b64_tr_b16 a[136:137], v81 offset:16384
    ds_read_b64_tr_b16 a[138:139], v81 offset:17408
    ds_read_b64_tr_b16 a[140:141], v81 offset:24576
    ds_read_b64_tr_b16 a[142:143], v81 offset:25600
    s_branch L_lw_78
L_lw_78_2:
    ds_read_b64_tr_b16 a[88:89], v80 offset:16384
    ds_read_b64_tr_b16 a[90:91], v80 offset:17408
    ds_read_b64_tr_b16 a[92:93], v80 offset:24576
    ds_read_b64_tr_b16 a[94:95], v80 offset:25600
    ds_read_b64_tr_b16 a[96:97], v81 offset:16384
    ds_read_b64_tr_b16 a[98:99], v81 offset:17408
    ds_read_b64_tr_b16 a[100:101], v81 offset:24576
    ds_read_b64_tr_b16 a[102:103], v81 offset:25600
L_lw_78:
    s_waitcnt lgkmcnt(0)
    s_waitcnt vmcnt(8)
    s_barrier
    s_add_u32 s79, s41, 9
    s_and_b32 s79, s79, 3
    s_lshl_b32 s79, s79, 19
    s_add_u32 s79, s79, s47
    s_add_u32 s46, s79, 0x400000
    s_add_u32 m0, s48, 16384
    s_nop 0
    buffer_load_dwordx4 v82, s[32:35], s46 offen  lds
    s_add_u32 s46, s79, 0x420000
    s_add_u32 m0, s48, 20480
    s_nop 0
    buffer_load_dwordx4 v82, s[32:35], s46 offen  lds
    s_add_u32 s46, s79, 0x440000
    s_add_u32 m0, s48, 24576
    s_nop 0
    buffer_load_dwordx4 v82, s[32:35], s46 offen  lds
    s_add_u32 s46, s79, 0x460000
    s_add_u32 m0, s48, 28672
    s_nop 0
    buffer_load_dwordx4 v82, s[32:35], s46 offen  lds
    s_cmp_lg_u32 s44, 0
    s_cbranch_scc1 L_lw_79_0
    ds_read_b64_tr_b16 a[64:65], v80 offset:32768
    ds_read_b64_tr_b16 a[66:67], v80 offset:33792
    ds_read_b64_tr_b16 a[68:69], v80 offset:40960
    ds_read_b64_tr_b16 a[70:71], v80 offset:41984
    ds_read_b64_tr_b16 v[56:57], v81 offset:32768
    ds_read_b64_tr_b16 v[58:59], v81 offset:33792
    ds_read_b64_tr_b16 v[60:61], v81 offset:40960
    ds_read_b64_tr_b16 v[62:63], v81 offset:41984
    s_waitcnt lgkmcnt(0)
    ds_write_b128 v5, v[56:59] offset:14336
    ds_write_b128 v5, v[60:63] offset:15360
    s_branch L_lw_79
L_lw_79_0:
    s_cmp_lg_u32 s44, 1
    s_cbranch_scc1 L_lw_79_1
    ds_read_b64_tr_b16 a[32:33], v80 offset:32768
    ds_read_b64_tr_b16 a[34:35], v80 offset:33792
    ds_read_b64_tr_b16 a[36:37], v80 offset:40960
    ds_read_b64_tr_b16 a[38:39], v80 offset:41984
    ds_read_b64_tr_b16 v[56:57], v81 offset:32768
    ds_read_b64_tr_b16 v[58:59], v81 offset:33792
    ds_read_b64_tr_b16 v[60:61], v81 offset:40960
    ds_read_b64_tr_b16 v[62:63], v81 offset:41984
    s_waitcnt lgkmcnt(0)
    ds_write_b128 v5, v[56:59] offset:8192
    ds_write_b128 v5, v[60:63] offset:9216
    s_branch L_lw_79
L_lw_79_1:
    s_cmp_lg_u32 s44, 2
    s_cbranch_scc1 L_lw_79_2
    ds_read_b64_tr_b16 a[144:145], v80 offset:32768
    ds_read_b64_tr_b16 a[146:147], v80 offset:33792
    ds_read_b64_tr_b16 a[148:149], v80 offset:40960
    ds_read_b64_tr_b16 a[150:151], v80 offset:41984
    ds_read_b64_tr_b16 v[56:57], v81 offset:32768
    ds_read_b64_tr_b16 v[58:59], v81 offset:33792
    ds_read_b64_tr_b16 v[60:61], v81 offset:40960
    ds_read_b64_tr_b16 v[62:63], v81 offset:41984
    s_waitcnt lgkmcnt(0)
    ds_write_b128 v5, v[56:59] offset:10240
    ds_write_b128 v5, v[60:63] offset:11264
    s_branch L_lw_79
L_lw_79_2:
    ds_read_b64_tr_b16 a[104:105], v80 offset:32768
    ds_read_b64_tr_b16 a[106:107], v80 offset:33792
    ds_read_b64_tr_b16 a[108:109], v80 offset:40960
    ds_read_b64_tr_b16 a[110:111], v80 offset:41984
    ds_read_b64_tr_b16 v[56:57], v81 offset:32768
    ds_read_b64_tr_b16 v[58:59], v81 offset:33792
    ds_read_b64_tr_b16 v[60:61], v81 offset:40960
    ds_read_b64_tr_b16 v[62:63], v81 offset:41984
    s_waitcnt lgkmcnt(0)
    ds_write_b128 v5, v[56:59] offset:12288
    ds_write_b128 v5, v[60:63] offset:13312
L_lw_79:
    s_waitcnt lgkmcnt(0)
    s_waitcnt vmcnt(8)
    s_barrier
    s_add_u32 s79, s41, 10
    s_and_b32 s79, s79, 3
    s_lshl_b32 s79, s79, 19
    s_add_u32 s79, s79, s47
    s_add_u32 s46, s79, 0x400000
    s_add_u32 m0, s48, 32768
    s_nop 0
    buffer_load_dwordx4 v82, s[32:35], s46 offen  lds
    s_add_u32 s46, s79, 0x420000
    s_add_u32 m0, s48, 36864
    s_nop 0
    buffer_load_dwordx4 v82, s[32:35], s46 offen  lds
    s_add_u32 s46, s79, 0x440000
    s_add_u32 m0, s48, 40960
    s_nop 0
    buffer_load_dwordx4 v82, s[32:35], s46 offen  lds
    s_add_u32 s46, s79, 0x460000
    s_add_u32 m0, s48, 45056
    s_nop 0
    buffer_load_dwordx4 v82, s[32:35], s46 offen  lds
    s_cmp_lg_u32 s44, 0
    s_cbranch_scc1 L_lw_80_0
    ds_read_b64_tr_b16 a[72:73], v80 offset:49152
    ds_read_b64_tr_b16 a[74:75], v80 offset:50176
    ds_read_b64_tr_b16 a[76:77], v80 offset:57344
    ds_read_b64_tr_b16 a[78:79], v80 offset:58368
    ds_read_b64_tr_b16 v[56:57], v81 offset:49152
    ds_read_b64_tr_b16 v[58:59], v81 offset:50176
    ds_read_b64_tr_b16 v[60:61], v81 offset:57344
    ds_read_b64_tr_b16 v[62:63], v81 offset:58368
    s_waitcnt lgkmcnt(0)
    ds_write_b128 v5, v[56:59] offset:22528
    ds_write_b128 v5, v[60:63] offset:23552
    s_branch L_lw_80
L_lw_80_0:
    s_cmp_lg_u32 s44, 1
    s_cbranch_scc1 L_lw_80_1
    ds_read_b64_tr_b16 a[40:41], v80 offset:49152
    ds_read_b64_tr_b16 a[42:43], v80 offset:50176
    ds_read_b64_tr_b16 a[44:45], v80 offset:57344
    ds_read_b64_tr_b16 a[46:47], v80 offset:58368
    ds_read_b64_tr_b16 v[56:57], v81 offset:49152
    ds_read_b64_tr_b16 v[58:59], v81 offset:50176
    ds_read_b64_tr_b16 v[60:61], v81 offset:57344
    ds_read_b64_tr_b16 v[62:63], v81 offset:58368
    s_waitcnt lgkmcnt(0)
    ds_write_b128 v5, v[56:59] offset:16384
    ds_write_b128 v5, v[60:63] offset:17408
    s_branch L_lw_80
L_lw_80_1:
    s_cmp_lg_u32 s44, 2
    s_cbranch_scc1 L_lw_80_2
    ds_read_b64_tr_b16 a[152:153], v80 offset:49152
    ds_read_b64_tr_b16 a[154:155], v80 offset:50176
    ds_read_b64_tr_b16 a[156:157], v80 offset:57344
    ds_read_b64_tr_b16 a[158:159], v80 offset:58368
    ds_read_b64_tr_b16 v[56:57], v81 offset:49152
    ds_read_b64_tr_b16 v[58:59], v81 offset:50176
    ds_read_b64_tr_b16 v[60:61], v81 offset:57344
    ds_read_b64_tr_b16 v[62:63], v81 offset:58368
    s_waitcnt lgkmcnt(0)
    ds_write_b128 v5, v[56:59] offset:18432
    ds_write_b128 v5, v[60:63] offset:19456
    s_branch L_lw_80
L_lw_80_2:
    ds_read_b64_tr_b16 a[112:113], v80 offset:49152
    ds_read_b64_tr_b16 a[114:115], v80 offset:50176
    ds_read_b64_tr_b16 a[116:117], v80 offset:57344
    ds_read_b64_tr_b16 a[118:119], v80 offset:58368
    ds_read_b64_tr_b16 v[56:57], v81 offset:49152
    ds_read_b64_tr_b16 v[58:59], v81 offset:50176
    ds_read_b64_tr_b16 v[60:61], v81 offset:57344
    ds_read_b64_tr_b16 v[62:63], v81 offset:58368
    s_waitcnt lgkmcnt(0)
    ds_write_b128 v5, v[56:59] offset:20480
    ds_write_b128 v5, v[60:63] offset:21504
L_lw_80:
    s_waitcnt lgkmcnt(0)
    s_waitcnt vmcnt(8)
    s_barrier
    s_add_u32 s79, s41, 11
    s_and_b32 s79, s79, 3
    s_lshl_b32 s79, s79, 19
    s_add_u32 s79, s79, s47
    s_add_u32 s46, s79, 0x400000
    s_add_u32 m0, s48, 49152
    s_nop 0
    buffer_load_dwordx4 v82, s[32:35], s46 offen  lds
    s_add_u32 s46, s79, 0x420000
    s_add_u32 m0, s48, 53248
    s_nop 0
    buffer_load_dwordx4 v82, s[32:35], s46 offen  lds
    s_add_u32 s46, s79, 0x440000
    s_add_u32 m0, s48, 57344
    s_nop 0
    buffer_load_dwordx4 v82, s[32:35], s46 offen  lds
    s_add_u32 s46, s79, 0x460000
    s_add_u32 m0, s48, 61440
    s_nop 0
    buffer_load_dwordx4 v82, s[32:35], s46 offen  lds
    s_cmp_lg_u32 s44, 0
    s_cbranch_scc1 L_lw_81_0
    ds_read_b64_tr_b16 a[80:81], v80 offset:0
    ds_read_b64_tr_b16 a[82:83], v80 offset:1024
    ds_read_b64_tr_b16 a[84:85], v80 offset:8192
    ds_read_b64_tr_b16 a[86:87], v80 offset:9216
    ds_read_b64_tr_b16 v[56:57], v81 offset:0
    ds_read_b64_tr_b16 v[58:59], v81 offset:1024
    ds_read_b64_tr_b16 v[60:61], v81 offset:8192
    ds_read_b64_tr_b16 v[62:63], v81 offset:9216
    s_waitcnt lgkmcnt(0)
    ds_write_b128 v5, v[56:59] offset:2048
    ds_write_b128 v5, v[60:63] offset:3072
    s_branch L_lw_81
L_lw_81_0:
    s_cmp_lg_u32 s44, 1
    s_cbranch_scc1 L_lw_81_1
    ds_read_b64_tr_b16 a[48:49], v80 offset:0
    ds_read_b64_tr_b16 a[50:51], v80 offset:1024
    ds_read_b64_tr_b16 a[52:53], v80 offset:8192
    ds_read_b64_tr_b16 a[54:55], v80 offset:9216
    ds_read_b64_tr_b16 v[56:57], v81 offset:0
    ds_read_b64_tr_b16 v[58:59], v81 offset:1024
    ds_read_b64_tr_b16 v[60:61], v81 offset:8192
    ds_read_b64_tr_b16 v[62:63], v81 offset:9216
    s_waitcnt lgkmcnt(0)
    ds_write_b128 v5, v[56:59] offset:4096
    ds_write_b128 v5, v[60:63] offset:5120
    s_branch L_lw_81
L_lw_81_1:
    s_cmp_lg_u32 s44, 2
    s_cbranch_scc1 L_lw_81_2
    ds_read_b64_tr_b16 a[0:1], v80 offset:0
    ds_read_b64_tr_b16 a[2:3], v80 offset:1024
    ds_read_b64_tr_b16 a[4:5], v80 offset:8192
    ds_read_b64_tr_b16 a[6:7], v80 offset:9216
    ds_read_b64_tr_b16 a[8:9], v81 offset:0
    ds_read_b64_tr_b16 a[10:11], v81 offset:1024
    ds_read_b64_tr_b16 a[12:13], v81 offset:8192
    ds_read_b64_tr_b16 a[14:15], v81 offset:9216
    s_branch L_lw_81
L_lw_81_2:
    ds_read_b64_tr_b16 a[120:121], v80 offset:0
    ds_read_b64_tr_b16 a[122:123], v80 offset:1024
    ds_read_b64_tr_b16 a[124:125], v80 offset:8192
    ds_read_b64_tr_b16 a[126:127], v80 offset:9216
    ds_read_b64_tr_b16 v[56:57], v81 offset:0
    ds_read_b64_tr_b16 v[58:59], v81 offset:1024
    ds_read_b64_tr_b16 v[60:61], v81 offset:8192
    ds_read_b64_tr_b16 v[62:63], v81 offset:9216
    s_waitcnt lgkmcnt(0)
    ds_write_b128 v5, v[56:59] offset:0
    ds_write_b128 v5, v[60:63] offset:1024
L_lw_81:
    s_waitcnt lgkmcnt(0)
    s_waitcnt vmcnt(8)
    s_barrier
    s_add_u32 s79, s41, 12
    s_and_b32 s79, s79, 3
    s_lshl_b32 s79, s79, 19
    s_add_u32 s79, s79, s47
    s_add_u32 s46, s79, 0x600000
    s_add_u32 m0, s48, 0
    s_nop 0
    buffer_load_dwordx4 v82, s[32:35], s46 offen  lds
    s_add_u32 s46, s79, 0x620000
    s_add_u32 m0, s48, 4096
    s_nop 0
    buffer_load_dwordx4 v82, s[32:35], s46 offen  lds
    s_add_u32 s46, s79, 0x640000
    s_add_u32 m0, s48, 8192
    s_nop 0
    buffer_load_dwordx4 v82, s[32:35], s46 offen  lds
    s_add_u32 s46, s79, 0x660000
    s_add_u32 m0, s48, 12288
    s_nop 0
    buffer_load_dwordx4 v82, s[32:35], s46 offen  lds
    s_cmp_lg_u32 s44, 0
    s_cbranch_scc1 L_lw_82_0
    ds_read_b64_tr_b16 a[88:89], v80 offset:16384
    ds_read_b64_tr_b16 a[90:91], v80 offset:17408
    ds_read_b64_tr_b16 a[92:93], v80 offset:24576
    ds_read_b64_tr_b16 a[94:95], v80 offset:25600
    ds_read_b64_tr_b16 a[96:97], v81 offset:16384
    ds_read_b64_tr_b16 a[98:99], v81 offset:17408
    ds_read_b64_tr_b16 a[100:101], v81 offset:24576
    ds_read_b64_tr_b16 a[102:103], v81 offset:25600
    s_branch L_lw_82
L_lw_82_0:
    s_cmp_lg_u32 s44, 1
    s_cbranch_scc1 L_lw_82_1
    ds_read_b64_tr_b16 a[56:57], v80 offset:16384
    ds_read_b64_tr_b16 a[58:59], v80 offset:17408
    ds_read_b64_tr_b16 a[60:61], v80 offset:24576
    ds_read_b64_tr_b16 a[62:63], v80 offset:25600
    ds_read_b64_tr_b16 v[56:57], v81 offset:16384
    ds_read_b64_tr_b16 v[58:59], v81 offset:17408
    ds_read_b64_tr_b16 v[60:61], v81 offset:24576
    ds_read_b64_tr_b16 v[62:63], v81 offset:25600
    s_waitcnt lgkmcnt(0)
    ds_write_b128 v5, v[56:59] offset:6144
    ds_write_b128 v5, v[60:63] offset:7168
    s_branch L_lw_82
L_lw_82_1:
    s_cmp_lg_u32 s44, 2
    s_cbranch_scc1 L_lw_82_2
    ds_read_b64_tr_b16 a[16:17], v80 offset:16384
    ds_read_b64_tr_b16 a[18:19], v80 offset:17408
    ds_read_b64_tr_b16 a[20:21], v80 offset:24576
    ds_read_b64_tr_b16 a[22:23], v80 offset:25600
    ds_read_b64_tr_b16 a[24:25], v81 offset:16384
    ds_read_b64_tr_b16 a[26:27], v81 offset:17408
    ds_read_b64_tr_b16 a[28:29], v81 offset:24576
    ds_read_b64_tr_b16 a[30:31], v81 offset:25600
    s_branch L_lw_82
L_lw_82_2:
    ds_read_b64_tr_b16 a[128:129], v80 offset:16384
    ds_read_b64_tr_b16 a[130:131], v80 offset:17408
    ds_read_b64_tr_b16 a[132:133], v80 offset:24576
    ds_read_b64_tr_b16 a[134:135], v80 offset:25600
    ds_read_b64_tr_b16 a[136:137], v81 offset:16384
    ds_read_b64_tr_b16 a[138:139], v81 offset:17408
    ds_read_b64_tr_b16 a[140:141], v81 offset:24576
    ds_read_b64_tr_b16 a[142:143], v81 offset:25600
L_lw_82:
    s_waitcnt lgkmcnt(0)
    s_waitcnt vmcnt(8)
    s_barrier
    s_add_u32 s79, s41, 13
    s_and_b32 s79, s79, 3
    s_lshl_b32 s79, s79, 19
    s_add_u32 s79, s79, s47
    s_add_u32 s46, s79, 0x600000
    s_add_u32 m0, s48, 16384
    s_nop 0
    buffer_load_dwordx4 v82, s[32:35], s46 offen  lds
    s_add_u32 s46, s79, 0x620000
    s_add_u32 m0, s48, 20480
    s_nop 0
    buffer_load_dwordx4 v82, s[32:35], s46 offen  lds
    s_add_u32 s46, s79, 0x640000
    s_add_u32 m0, s48, 24576
    s_nop 0
    buffer_load_dwordx4 v82, s[32:35], s46 offen  lds
    s_add_u32 s46, s79, 0x660000
    s_add_u32 m0, s48, 28672
    s_nop 0
    buffer_load_dwordx4 v82, s[32:35], s46 offen  lds
    s_cmp_lg_u32 s44, 0
    s_cbranch_scc1 L_lw_83_0
    ds_read_b64_tr_b16 a[104:105], v80 offset:32768
    ds_read_b64_tr_b16 a[106:107], v80 offset:33792
    ds_read_b64_tr_b16 a[108:109], v80 offset:40960
    ds_read_b64_tr_b16 a[110:111], v80 offset:41984
    ds_read_b64_tr_b16 v[56:57], v81 offset:32768
    ds_read_b64_tr_b16 v[58:59], v81 offset:33792
    ds_read_b64_tr_b16 v[60:61], v81 offset:40960
    ds_read_b64_tr_b16 v[62:63], v81 offset:41984
    s_waitcnt lgkmcnt(0)
    ds_write_b128 v5, v[56:59] offset:12288
    ds_write_b128 v5, v[60:63] offset:13312
    s_branch L_lw_83
L_lw_83_0:
    s_cmp_lg_u32 s44, 1
    s_cbranch_scc1 L_lw_83_1
    ds_read_b64_tr_b16 a[64:65], v80 offset:32768
    ds_read_b64_tr_b16 a[66:67], v80 offset:33792
    ds_read_b64_tr_b16 a[68:69], v80 offset:40960
    ds_read_b64_tr_b16 a[70:71], v80 offset:41984
    ds_read_b64_tr_b16 v[56:57], v81 offset:32768
    ds_read_b64_tr_b16 v[58:59], v81 offset:33792
    ds_read_b64_tr_b16 v[60:61], v81 offset:40960
    ds_read_b64_tr_b16 v[62:63], v81 offset:41984
    s_waitcnt lgkmcnt(0)
    ds_write_b128 v5, v[56:59] offset:14336
    ds_write_b128 v5, v[60:63] offset:15360
    s_branch L_lw_83
L_lw_83_1:
    s_cmp_lg_u32 s44, 2
    s_cbranch_scc1 L_lw_83_2
    ds_read_b64_tr_b16 a[32:33], v80 offset:32768
    ds_read_b64_tr_b16 a[34:35], v80 offset:33792
    ds_read_b64_tr_b16 a[36:37], v80 offset:40960
    ds_read_b64_tr_b16 a[38:39], v80 offset:41984
    ds_read_b64_tr_b16 v[56:57], v81 offset:32768
    ds_read_b64_tr_b16 v[58:59], v81 offset:33792
    ds_read_b64_tr_b16 v[60:61], v81 offset:40960
    ds_read_b64_tr_b16 v[62:63], v81 offset:41984
    s_waitcnt lgkmcnt(0)
    ds_write_b128 v5, v[56:59] offset:8192
    ds_write_b128 v5, v[60:63] offset:9216
    s_branch L_lw_83
L_lw_83_2:
    ds_read_b64_tr_b16 a[144:145], v80 offset:32768
    ds_read_b64_tr_b16 a[146:147], v80 offset:33792
    ds_read_b64_tr_b16 a[148:149], v80 offset:40960
    ds_read_b64_tr_b16 a[150:151], v80 offset:41984
    ds_read_b64_tr_b16 v[56:57], v81 offset:32768
    ds_read_b64_tr_b16 v[58:59], v81 offset:33792
    ds_read_b64_tr_b16 v[60:61], v81 offset:40960
    ds_read_b64_tr_b16 v[62:63], v81 offset:41984
    s_waitcnt lgkmcnt(0)
    ds_write_b128 v5, v[56:59] offset:10240
    ds_write_b128 v5, v[60:63] offset:11264
L_lw_83:
    s_waitcnt lgkmcnt(0)
    s_waitcnt vmcnt(8)
    s_barrier
    s_add_u32 s79, s41, 14
    s_and_b32 s79, s79, 3
    s_lshl_b32 s79, s79, 19
    s_add_u32 s79, s79, s47
    s_add_u32 s46, s79, 0x600000
    s_add_u32 m0, s48, 32768
    s_nop 0
    buffer_load_dwordx4 v82, s[32:35], s46 offen  lds
    s_add_u32 s46, s79, 0x620000
    s_add_u32 m0, s48, 36864
    s_nop 0
    buffer_load_dwordx4 v82, s[32:35], s46 offen  lds
    s_add_u32 s46, s79, 0x640000
    s_add_u32 m0, s48, 40960
    s_nop 0
    buffer_load_dwordx4 v82, s[32:35], s46 offen  lds
    s_add_u32 s46, s79, 0x660000
    s_add_u32 m0, s48, 45056
    s_nop 0
    buffer_load_dwordx4 v82, s[32:35], s46 offen  lds
    s_cmp_lg_u32 s44, 0
    s_cbranch_scc1 L_lw_84_0
    ds_read_b64_tr_b16 a[112:113], v80 offset:49152
    ds_read_b64_tr_b16 a[114:115], v80 offset:50176
    ds_read_b64_tr_b16 a[116:117], v80 offset:57344
    ds_read_b64_tr_b16 a[118:119], v80 offset:58368
    ds_read_b64_tr_b16 v[56:57], v81 offset:49152
    ds_read_b64_tr_b16 v[58:59], v81 offset:50176
    ds_read_b64_tr_b16 v[60:61], v81 offset:57344
    ds_read_b64_tr_b16 v[62:63], v81 offset:58368
    s_waitcnt lgkmcnt(0)
    ds_write_b128 v5, v[56:59] offset:20480
    ds_write_b128 v5, v[60:63] offset:21504
    s_branch L_lw_84
L_lw_84_0:
    s_cmp_lg_u32 s44, 1
    s_cbranch_scc1 L_lw_84_1
    ds_read_b64_tr_b16 a[72:73], v80 offset:49152
    ds_read_b64_tr_b16 a[74:75], v80 offset:50176
    ds_read_b64_tr_b16 a[76:77], v80 offset:57344
    ds_read_b64_tr_b16 a[78:79], v80 offset:58368
    ds_read_b64_tr_b16 v[56:57], v81 offset:49152
    ds_read_b64_tr_b16 v[58:59], v81 offset:50176
    ds_read_b64_tr_b16 v[60:61], v81 offset:57344
    ds_read_b64_tr_b16 v[62:63], v81 offset:58368
    s_waitcnt lgkmcnt(0)
    ds_write_b128 v5, v[56:59] offset:22528
    ds_write_b128 v5, v[60:63] offset:23552
    s_branch L_lw_84
L_lw_84_1:
    s_cmp_lg_u32 s44, 2
    s_cbranch_scc1 L_lw_84_2
    ds_read_b64_tr_b16 a[40:41], v80 offset:49152
    ds_read_b64_tr_b16 a[42:43], v80 offset:50176
    ds_read_b64_tr_b16 a[44:45], v80 offset:57344
    ds_read_b64_tr_b16 a[46:47], v80 offset:58368
    ds_read_b64_tr_b16 v[56:57], v81 offset:49152
    ds_read_b64_tr_b16 v[58:59], v81 offset:50176
    ds_read_b64_tr_b16 v[60:61], v81 offset:57344
    ds_read_b64_tr_b16 v[62:63], v81 offset:58368
    s_waitcnt lgkmcnt(0)
    ds_write_b128 v5, v[56:59] offset:16384
    ds_write_b128 v5, v[60:63] offset:17408
    s_branch L_lw_84
L_lw_84_2:
    ds_read_b64_tr_b16 a[152:153], v80 offset:49152
    ds_read_b64_tr_b16 a[154:155], v80 offset:50176
    ds_read_b64_tr_b16 a[156:157], v80 offset:57344
    ds_read_b64_tr_b16 a[158:159], v80 offset:58368
    ds_read_b64_tr_b16 v[56:57], v81 offset:49152
    ds_read_b64_tr_b16 v[58:59], v81 offset:50176
    ds_read_b64_tr_b16 v[60:61], v81 offset:57344
    ds_read_b64_tr_b16 v[62:63], v81 offset:58368
    s_waitcnt lgkmcnt(0)
    ds_write_b128 v5, v[56:59] offset:18432
    ds_write_b128 v5, v[60:63] offset:19456
L_lw_84:
    s_waitcnt lgkmcnt(0)
    s_waitcnt vmcnt(8)
    s_barrier
    s_add_u32 s79, s41, 15
    s_and_b32 s79, s79, 3
    s_lshl_b32 s79, s79, 19
    s_add_u32 s79, s79, s47
    s_add_u32 s46, s79, 0x600000
    s_add_u32 m0, s48, 49152
    s_nop 0
    buffer_load_dwordx4 v82, s[32:35], s46 offen  lds
    s_add_u32 s46, s79, 0x620000
    s_add_u32 m0, s48, 53248
    s_nop 0
    buffer_load_dwordx4 v82, s[32:35], s46 offen  lds
    s_add_u32 s46, s79, 0x640000
    s_add_u32 m0, s48, 57344
    s_nop 0
    buffer_load_dwordx4 v82, s[32:35], s46 offen  lds
    s_add_u32 s46, s79, 0x660000
    s_add_u32 m0, s48, 61440
    s_nop 0
    buffer_load_dwordx4 v82, s[32:35], s46 offen  lds
    v_mov_b32 v46, 0
    buffer_load_dwordx2 v[44:45], v46, s[16:19], 0 offen sc1
    s_cmp_lg_u32 s44, 0
    s_cbranch_scc1 L_lw_85_0
    ds_read_b64_tr_b16 a[120:121], v80 offset:0
    ds_read_b64_tr_b16 a[122:123], v80 offset:1024
    ds_read_b64_tr_b16 a[124:125], v80 offset:8192
    ds_read_b64_tr_b16 a[126:127], v80 offset:9216
    ds_read_b64_tr_b16 v[56:57], v81 offset:0
    ds_read_b64_tr_b16 v[58:59], v81 offset:1024
    ds_read_b64_tr_b16 v[60:61], v81 offset:8192
    ds_read_b64_tr_b16 v[62:63], v81 offset:9216
    s_waitcnt lgkmcnt(0)
    ds_write_b128 v5, v[56:59] offset:0
    ds_write_b128 v5, v[60:63] offset:1024
    s_branch L_lw_85
L_lw_85_0:
    s_cmp_lg_u32 s44, 1
    s_cbranch_scc1 L_lw_85_1
    ds_read_b64_tr_b16 a[80:81], v80 offset:0
    ds_read_b64_tr_b16 a[82:83], v80 offset:1024
    ds_read_b64_tr_b16 a[84:85], v80 offset:8192
    ds_read_b64_tr_b16 a[86:87], v80 offset:9216
    ds_read_b64_tr_b16 v[56:57], v81 offset:0
    ds_read_b64_tr_b16 v[58:59], v81 offset:1024
    ds_read_b64_tr_b16 v[60:61], v81 offset:8192
    ds_read_b64_tr_b16 v[62:63], v81 offset:9216
    s_waitcnt lgkmcnt(0)
    ds_write_b128 v5, v[56:59] offset:2048
    ds_write_b128 v5, v[60:63] offset:3072
    s_branch L_lw_85
L_lw_85_1:
    s_cmp_lg_u32 s44, 2
    s_cbranch_scc1 L_lw_85_2
    ds_read_b64_tr_b16 a[48:49], v80 offset:0
    ds_read_b64_tr_b16 a[50:51], v80 offset:1024
    ds_read_b64_tr_b16 a[52:53], v80 offset:8192
    ds_read_b64_tr_b16 a[54:55], v80 offset:9216
    ds_read_b64_tr_b16 v[56:57], v81 offset:0
    ds_read_b64_tr_b16 v[58:59], v81 offset:1024
    ds_read_b64_tr_b16 v[60:61], v81 offset:8192
    ds_read_b64_tr_b16 v[62:63], v81 offset:9216
    s_waitcnt lgkmcnt(0)
    ds_write_b128 v5, v[56:59] offset:4096
    ds_write_b128 v5, v[60:63] offset:5120
    s_branch L_lw_85
L_lw_85_2:
    ds_read_b64_tr_b16 a[0:1], v80 offset:0
    ds_read_b64_tr_b16 a[2:3], v80 offset:1024
    ds_read_b64_tr_b16 a[4:5], v80 offset:8192
    ds_read_b64_tr_b16 a[6:7], v80 offset:9216
    ds_read_b64_tr_b16 a[8:9], v81 offset:0
    ds_read_b64_tr_b16 a[10:11], v81 offset:1024
    ds_read_b64_tr_b16 a[12:13], v81 offset:8192
    ds_read_b64_tr_b16 a[14:15], v81 offset:9216
L_lw_85:
    s_waitcnt lgkmcnt(0)
    s_waitcnt vmcnt(8)
    s_barrier
    s_cmp_lg_u32 s44, 0
    s_cbranch_scc1 L_lw_86_0
    ds_read_b64_tr_b16 a[128:129], v80 offset:16384
    ds_read_b64_tr_b16 a[130:131], v80 offset:17408
    ds_read_b64_tr_b16 a[132:133], v80 offset:24576
    ds_read_b64_tr_b16 a[134:135], v80 offset:25600
    ds_read_b64_tr_b16 a[136:137], v81 offset:16384
    ds_read_b64_tr_b16 a[138:139], v81 offset:17408
    ds_read_b64_tr_b16 a[140:141], v81 offset:24576
    ds_read_b64_tr_b16 a[142:143], v81 offset:25600
    s_branch L_lw_86
L_lw_86_0:
    s_cmp_lg_u32 s44, 1
    s_cbranch_scc1 L_lw_86_1
    ds_read_b64_tr_b16 a[88:89], v80 offset:16384
    ds_read_b64_tr_b16 a[90:91], v80 offset:17408
    ds_read_b64_tr_b16 a[92:93], v80 offset:24576
    ds_read_b64_tr_b16 a[94:95], v80 offset:25600
    ds_read_b64_tr_b16 a[96:97], v81 offset:16384
    ds_read_b64_tr_b16 a[98:99], v81 offset:17408
    ds_read_b64_tr_b16 a[100:101], v81 offset:24576
    ds_read_b64_tr_b16 a[102:103], v81 offset:25600
    s_branch L_lw_86
L_lw_86_1:
    s_cmp_lg_u32 s44, 2
    s_cbranch_scc1 L_lw_86_2
    ds_read_b64_tr_b16 a[56:57], v80 offset:16384
    ds_read_b64_tr_b16 a[58:59], v80 offset:17408
    ds_read_b64_tr_b16 a[60:61], v80 offset:24576
    ds_read_b64_tr_b16 a[62:63], v80 offset:25600
    ds_read_b64_tr_b16 v[56:57], v81 offset:16384
    ds_read_b64_tr_b16 v[58:59], v81 offset:17408
    ds_read_b64_tr_b16 v[60:61], v81 offset:24576
    ds_read_b64_tr_b16 v[62:63], v81 offset:25600
    s_waitcnt lgkmcnt(0)
    ds_write_b128 v5, v[56:59] offset:6144
    ds_write_b128 v5, v[60:63] offset:7168
    s_branch L_lw_86
L_lw_86_2:
    ds_read_b64_tr_b16 a[16:17], v80 offset:16384
    ds_read_b64_tr_b16 a[18:19], v80 offset:17408
    ds_read_b64_tr_b16 a[20:21], v80 offset:24576
    ds_read_b64_tr_b16 a[22:23], v80 offset:25600
    ds_read_b64_tr_b16 a[24:25], v81 offset:16384
    ds_read_b64_tr_b16 a[26:27], v81 offset:17408
    ds_read_b64_tr_b16 a[28:29], v81 offset:24576
    ds_read_b64_tr_b16 a[30:31], v81 offset:25600
L_lw_86:
    s_waitcnt lgkmcnt(0)
    s_waitcnt vmcnt(4)
    s_barrier
    s_cmp_lg_u32 s44, 0
    s_cbranch_scc1 L_lw_87_0
    ds_read_b64_tr_b16 a[144:145], v80 offset:32768
    ds_read_b64_tr_b16 a[146:147], v80 offset:33792
    ds_read_b64_tr_b16 a[148:149], v80 offset:40960
    ds_read_b64_tr_b16 a[150:151], v80 offset:41984
    ds_read_b64_tr_b16 v[56:57], v81 offset:32768
    ds_read_b64_tr_b16 v[58:59], v81 offset:33792
    ds_read_b64_tr_b16 v[60:61], v81 offset:40960
    ds_read_b64_tr_b16 v[62:63], v81 offset:41984
    s_waitcnt lgkmcnt(0)
    ds_write_b128 v5, v[56:59] offset:10240
    ds_write_b128 v5, v[60:63] offset:11264
    s_branch L_lw_87
L_lw_87_0:
    s_cmp_lg_u32 s44, 1
    s_cbranch_scc1 L_lw_87_1
    ds_read_b64_tr_b16 a[104:105], v80 offset:32768
    ds_read_b64_tr_b16 a[106:107], v80 offset:33792
    ds_read_b64_tr_b16 a[108:109], v80 offset:40960
    ds_read_b64_tr_b16 a[110:111], v80 offset:41984
    ds_read_b64_tr_b16 v[56:57], v81 offset:32768
    ds_read_b64_tr_b16 v[58:59], v81 offset:33792
    ds_read_b64_tr_b16 v[60:61], v81 offset:40960
    ds_read_b64_tr_b16 v[62:63], v81 offset:41984
    s_waitcnt lgkmcnt(0)
    ds_write_b128 v5, v[56:59] offset:12288
    ds_write_b128 v5, v[60:63] offset:13312
    s_branch L_lw_87
L_lw_87_1:
    s_cmp_lg_u32 s44, 2
    s_cbranch_scc1 L_lw_87_2
    ds_read_b64_tr_b16 a[64:65], v80 offset:32768
    ds_read_b64_tr_b16 a[66:67], v80 offset:33792
    ds_read_b64_tr_b16 a[68:69], v80 offset:40960
    ds_read_b64_tr_b16 a[70:71], v80 offset:41984
    ds_read_b64_tr_b16 v[56:57], v81 offset:32768
    ds_read_b64_tr_b16 v[58:59], v81 offset:33792
    ds_read_b64_tr_b16 v[60:61], v81 offset:40960
    ds_read_b64_tr_b16 v[62:63], v81 offset:41984
    s_waitcnt lgkmcnt(0)
    ds_write_b128 v5, v[56:59] offset:14336
    ds_write_b128 v5, v[60:63] offset:15360
    s_branch L_lw_87
L_lw_87_2:
    ds_read_b64_tr_b16 a[32:33], v80 offset:32768
    ds_read_b64_tr_b16 a[34:35], v80 offset:33792
    ds_read_b64_tr_b16 a[36:37], v80 offset:40960
    ds_read_b64_tr_b16 a[38:39], v80 offset:41984
    ds_read_b64_tr_b16 v[56:57], v81 offset:32768
    ds_read_b64_tr_b16 v[58:59], v81 offset:33792
    ds_read_b64_tr_b16 v[60:61], v81 offset:40960
    ds_read_b64_tr_b16 v[62:63], v81 offset:41984
    s_waitcnt lgkmcnt(0)
    ds_write_b128 v5, v[56:59] offset:8192
    ds_write_b128 v5, v[60:63] offset:9216
L_lw_87:
    s_waitcnt lgkmcnt(0)
    s_waitcnt vmcnt(0)
    s_barrier
    s_add_u32 s45, s61, 0
    buffer_load_dword v47, v12, s[12:15], s45 offen sc1
    s_add_u32 s45, s61, 16384
    buffer_load_dword v47, v12, s[12:15], s45 offen sc1
    s_add_u32 s45, s61, 32768
    buffer_load_dword v47, v12, s[12:15], s45 offen sc1
    s_add_u32 s45, s61, 49152
    buffer_load_dword v47, v12, s[12:15], s45 offen sc1
    s_mov_b32 s45, 0x7020000
    buffer_load_dword v47, v10, s[12:15], s45 offen sc1
    s_mov_b32 s45, 0x7030000
    buffer_load_dword v47, v10, s[12:15], s45 offen sc1
    buffer_load_dword v47, v20, s[12:15], 0 offen sc1
    s_cmp_lg_u32 s44, 0
    s_cbranch_scc1 L_lw_88_0
    ds_read_b64_tr_b16 a[152:153], v80 offset:49152
    ds_read_b64_tr_b16 a[154:155], v80 offset:50176
    ds_read_b64_tr_b16 a[156:157], v80 offset:57344
    ds_read_b64_tr_b16 a[158:159], v80 offset:58368
    ds_read_b64_tr_b16 v[56:57], v81 offset:49152
    ds_read_b64_tr_b16 v[58:59], v81 offset:50176
    ds_read_b64_tr_b16 v[60:61], v81 offset:57344
    ds_read_b64_tr_b16 v[62:63], v81 offset:58368
    s_waitcnt lgkmcnt(0)
    ds_write_b128 v5, v[56:59] offset:18432
    ds_write_b128 v5, v[60:63] offset:19456
    s_branch L_lw_88
L_lw_88_0:
    s_cmp_lg_u32 s44, 1
    s_cbranch_scc1 L_lw_88_1
    ds_read_b64_tr_b16 a[112:113], v80 offset:49152
    ds_read_b64_tr_b16 a[114:115], v80 offset:50176
    ds_read_b64_tr_b16 a[116:117], v80 offset:57344
    ds_read_b64_tr_b16 a[118:119], v80 offset:58368
    ds_read_b64_tr_b16 v[56:57], v81 offset:49152
    ds_read_b64_tr_b16 v[58:59], v81 offset:50176
    ds_read_b64_tr_b16 v[60:61], v81 offset:57344
    ds_read_b64_tr_b16 v[62:63], v81 offset:58368
    s_waitcnt lgkmcnt(0)
    ds_write_b128 v5, v[56:59] offset:20480
    ds_write_b128 v5, v[60:63] offset:21504
    s_branch L_lw_88
L_lw_88_1:
    s_cmp_lg_u32 s44, 2
    s_cbranch_scc1 L_lw_88_2
    ds_read_b64_tr_b16 a[72:73], v80 offset:49152
    ds_read_b64_tr_b16 a[74:75], v80 offset:50176
    ds_read_b64_tr_b16 a[76:77], v80 offset:57344
    ds_read_b64_tr_b16 a[78:79], v80 offset:58368
    ds_read_b64_tr_b16 v[56:57], v81 offset:49152
    ds_read_b64_tr_b16 v[58:59], v81 offset:50176
    ds_read_b64_tr_b16 v[60:61], v81 offset:57344
    ds_read_b64_tr_b16 v[62:63], v81 offset:58368
    s_waitcnt lgkmcnt(0)
    ds_write_b128 v5, v[56:59] offset:22528
    ds_write_b128 v5, v[60:63] offset:23552
    s_branch L_lw_88
L_lw_88_2:
    ds_read_b64_tr_b16 a[40:41], v80 offset:49152
    ds_read_b64_tr_b16 a[42:43], v80 offset:50176
    ds_read_b64_tr_b16 a[44:45], v80 offset:57344
    ds_read_b64_tr_b16 a[46:47], v80 offset:58368
    ds_read_b64_tr_b16 v[56:57], v81 offset:49152
    ds_read_b64_tr_b16 v[58:59], v81 offset:50176
    ds_read_b64_tr_b16 v[60:61], v81 offset:57344
    ds_read_b64_tr_b16 v[62:63], v81 offset:58368
    s_waitcnt lgkmcnt(0)
    ds_write_b128 v5, v[56:59] offset:16384
    ds_write_b128 v5, v[60:63] offset:17408
L_lw_88:
    s_waitcnt lgkmcnt(0)
    s_barrier
    v_lshlrev_b32 v68, 4, v1
    s_mul_i32 s45, s44, 3072
    s_add_u32 s45, s45, 53248
    v_add_u32 v6, s45, v68
    s_sub_u32 s45, s44, 1
    s_and_b32 s45, s45, 3
    s_mul_i32 s45, s45, 3072
    s_add_u32 s45, s45, 53248
    v_add_u32 v7, s45, v68
    s_sub_u32 s45, s44, 2
    s_and_b32 s45, s45, 3
    s_mul_i32 s45, s45, 3072
    s_add_u32 s45, s45, 54272
    v_add_u32 v8, s45, v68
    s_sub_u32 s45, s44, 3
    s_and_b32 s45, s45, 3
    s_mul_i32 s45, s45, 3072
    s_add_u32 s45, s45, 55296
    v_add_u32 v18, s45, v68
    v_lshlrev_b32 v68, 4, v1
    s_add_u32 s45, s69, 0
    s_and_b32 s45, s45, 7
    s_lshl_b32 s45, s45, 10
    s_lshl_b32 s46, s44, 13
    s_add_u32 s45, s45, s46
    v_add_u32 v80, s45, v68
    s_add_u32 s45, s69, 1
    s_and_b32 s45, s45, 7
    s_lshl_b32 s45, s45, 10
    s_lshl_b32 s46, s44, 13
    s_add_u32 s45, s45, s46
    v_add_u32 v81, s45, v68
    s_add_u32 s45, s69, 2
    s_and_b32 s45, s45, 7
    s_lshl_b32 s45, s45, 10
    s_lshl_b32 s46, s44, 13
    s_add_u32 s45, s45, s46
    v_add_u32 v82, s45, v68
    s_add_u32 s45, s69, 3
    s_and_b32 s45, s45, 7
    s_lshl_b32 s45, s45, 10
    s_lshl_b32 s46, s44, 13
    s_add_u32 s45, s45, s46
    v_add_u32 v83, s45, v68
    s_add_u32 s45, s69, 4
    s_and_b32 s45, s45, 7
    s_lshl_b32 s45, s45, 10
    s_lshl_b32 s46, s44, 13
    s_add_u32 s45, s45, s46
    v_add_u32 v84, s45, v68
    s_add_u32 s45, s69, 5
    s_and_b32 s45, s45, 7
    s_lshl_b32 s45, s45, 10
    s_lshl_b32 s46, s44, 13
    s_add_u32 s45, s45, s46
    v_add_u32 v85, s45, v68
    s_add_u32 s45, s69, 6
    s_and_b32 s45, s45, 7
    s_lshl_b32 s45, s45, 10
    s_lshl_b32 s46, s44, 13
    s_add_u32 s45, s45, s46
    v_add_u32 v86, s45, v68
    s_add_u32 s45, s69, 7
    s_and_b32 s45, s45, 7
    s_lshl_b32 s45, s45, 10
    s_lshl_b32 s46, s44, 13
    s_add_u32 s45, s45, s46
    v_add_u32 v87, s45, v68
    s_lshl_b32 s45, s40, 4
    s_add_u32 s45, s45, s42
    s_lshl_b32 s45, s45, 8
    s_lshl_b32 s46, s44, 6
    s_add_u32 s45, s45, s46
    s_add_u32 s45, s45, 0x7080000
    v_and_b32 v13, 15, v1
    v_lshlrev_b32 v13, 2, v13
    v_add_u32 v13, s45, v13
    s_mov_b32 s66, 0x1800000
    v_mov_b32 v14, -1
    v_mov_b32 v15, -1
    s_mov_b32 s70, 0
    v_mov_b32 v41, 0
    s_branch L_hw_89_c
L_hw_89:
    buffer_load_dwordx2 v[44:45], v41, s[16:19], 0 offen sc1
    s_add_u32 s70, s70, 1
    s_cmp_ge_u32 s70, 0x100000
    s_cbranch_scc1 L_c_done_1
L_hw_89_c:
    s_waitcnt vmcnt(0)
    v_readfirstlane_b32 s45, v44
    v_readfirstlane_b32 s46, v45
    s_nop 3
    s_lshr_b32 s47, s46, 24
    s_cmp_lg_u32 s47, 64
    s_cbranch_scc1 L_hw_89
    s_lshr_b32 s68, s45, 24
    s_and_b32 s47, s45, 511
    s_mul_i32 s47, s47, s47
    s_bfe_u32 s45, s45, 0xf0009
    s_lshl_b32 s45, s45, 5
    s_sub_u32 s45, s45, s47
    s_and_b32 s47, s46, 511
    s_mul_i32 s47, s47, s47
    s_bfe_u32 s46, s46, 0xf0009
    s_lshl_b32 s46, s46, 5
    s_sub_u32 s46, s46, s47
    s_or_b32 s45, s45, s46
    s_cmp_eq_u32 s45, 0
    s_cselect_b32 s67, 1, 0
    s_mov_b32 s24, s12
    s_mov_b32 s25, s13
    s_mov_b32 s28, s12
    s_mov_b32 s29, s13
    s_cmp_eq_u32 s67, 1
    s_cselect_b32 s26, s14, 0
    s_cselect_b32 s30, 0, s14
    s_cmp_ge_u32 s68, 16
    s_cselect_b32 s68, 8192, 0
    s_mov_b32 s6, 0x11111111
    s_mov_b32 s7, 0xffaaa491
    s_mov_b32 s60, 0
    s_lshl_b32 s58, s40, 16
    s_add_u32 s58, s58, 0x7000000
    s_mov_b32 s61, s58
    s_lshl_b32 s59, s40, 17
    s_add_u32 s59, s59, 0x7040000
    s_mov_b32 s62, s59
    s_add_u32 s32, s41, 0
    s_and_b32 s32, s32, 3
    s_lshl_b32 s32, s32, 10
    s_add_u32 s33, s41, 1
    s_and_b32 s33, s33, 3
    s_lshl_b32 s33, s33, 10
    s_add_u32 s34, s41, 2
    s_and_b32 s34, s34, 3
    s_lshl_b32 s34, s34, 10
    s_add_u32 s35, s41, 3
    s_and_b32 s35, s35, 3
    s_lshl_b32 s35, s35, 10
    s_cmp_lg_u32 s44, 0
    s_cbranch_scc1 L_ld_90
    v_mov_b32 v40, 1
    v_mov_b32 v41, 127360
    s_mov_b64 exec, 1
    buffer_atomic_add v40, v41, s[12:15], 0 offen sc1
    s_mov_b64 exec, -1
L_ld_90:
    s_add_u32 s63, s63, s68
    s_add_u32 s64, s64, s68
    s_lshl_b32 s36, s40, 12
    s_add_u32 s36, s36, 0x5000
    ds_read_b128 v[56:59], v5 offset:8192
    ds_read_b128 v[60:63], v5 offset:9216
    ds_read_b128 v[64:67], v5 offset:16384
    ds_read_b128 v[68:71], v5 offset:17408
    ds_read_b128 v[72:75], v5 offset:4096
    ds_read_b128 v[76:79], v5 offset:5120
    ds_read_b128 v[88:91], v5 offset:6144
    ds_read_b128 v[92:95], v5 offset:7168
    ds_read_b128 v[32:35], v5 offset:14336
    ds_read_b128 v[36:39], v5 offset:15360
L_v_loop_91:
    s_add_u32 s8, s61, s32
    s_add_u32 s9, s61, s33
    s_add_u32 s10, s61, s34
    s_add_u32 s11, s61, s35
    v_mov_b32 v24, 0
    v_mov_b32 v25, 0
    v_mov_b32 v26, 0
    v_mov_b32 v27, 0
    v_mov_b32 v28, 0
    v_mov_b32 v29, 0
    v_mov_b32 v30, 0
    v_mov_b32 v31, 0
    s_and_b32 s37, s60, 1
    s_lshl_b32 s37, s37, 16
    s_add_u32 s37, s37, 0x7020000
    s_xor_b32 s38, s37, 65536
    s_add_u32 s39, s60, 3
    s_and_b32 s39, s39, 3
    s_lshl_b32 s39, s39, 14
    s_add_u32 s39, s39, s58
    s_nop 15
    s_waitcnt lgkmcnt(0)
    buffer_load_dwordx4 v[40:43], v3, s[12:15], s8 offen sc1
    s_nop 4
    buffer_load_dwordx4 v[44:47], v3, s[12:15], s9 offen sc1
    s_nop 4
    buffer_load_dwordx4 v[48:51], v3, s[12:15], s10 offen sc1
    s_nop 4
    buffer_load_dwordx4 v[52:55], v3, s[12:15], s11 offen sc1
    s_mov_b32 s70, 0
    s_waitcnt vmcnt(3)
    v_max3_u32 v22, v40, v41, v42
    ds_write_b128 v3, v[40:43] offset:0
    v_max_u32 v22, v22, v43
    v_cmp_eq_u32 vcc, -1, v22
    s_nop 0
    s_nop 0
    s_cbranch_vccnz L_mg_92_r0
L_mg_92_c0:
    v_smfmac_f32_16x16x64_bf16 v[24:27], v[40:43], a[0:7], v2
    s_waitcnt vmcnt(2)
    v_max3_u32 v22, v44, v45, v46
    ds_write_b128 v3, v[44:47] offset:1024
    v_max_u32 v22, v22, v47
    v_cmp_eq_u32 vcc, -1, v22
    v_smfmac_f32_16x16x64_bf16 v[28:31], v[40:43], a[8:15], v2
    s_nop 0
    s_cbranch_vccnz L_mg_92_r1
L_mg_92_c1:
    v_smfmac_f32_16x16x64_bf16 v[24:27], v[44:47], a[16:23], v2
    s_waitcnt vmcnt(1)
    v_max3_u32 v22, v48, v49, v50
    ds_write_b128 v3, v[48:51] offset:2048
    v_max_u32 v22, v22, v51
    v_cmp_eq_u32 vcc, -1, v22
    v_smfmac_f32_16x16x64_bf16 v[28:31], v[44:47], a[24:31], v2
    s_nop 0
    s_cbranch_vccnz L_mg_92_r2
L_mg_92_c2:
    s_waitcnt vmcnt(0)
    v_max3_u32 v22, v52, v53, v54
    ds_write_b128 v3, v[52:55] offset:3072
    v_max_u32 v22, v22, v55
    v_cmp_eq_u32 vcc, -1, v22
    s_waitcnt lgkmcnt(0)
    s_nop 0
    s_cbranch_vccnz L_mg_92_r3
L_mg_92_c3:
    s_barrier
    ds_read_b128 v[40:43], v4 offset:0
    ds_read_b128 v[44:47], v4 offset:1024
    v_smfmac_f32_16x16x64_bf16 v[24:27], v[48:51], a[32:39], v2
    v_smfmac_f32_16x16x64_bf16 v[28:31], v[48:51], v[56:63], v2
    ds_read_b128 v[48:51], v4 offset:2048
    v_smfmac_f32_16x16x64_bf16 v[24:27], v[52:55], a[40:47], v2
    ds_read_b128 v[56:59], v5 offset:22528
    v_smfmac_f32_16x16x64_bf16 v[28:31], v[52:55], v[64:71], v2
    ds_read_b128 v[52:55], v4 offset:3072
    s_waitcnt lgkmcnt(3)
    v_smfmac_f32_16x16x64_bf16 v[24:27], v[40:43], a[48:55], v2
    ds_read_b128 v[60:63], v5 offset:23552
    v_smfmac_f32_16x16x64_bf16 v[28:31], v[40:43], v[72:79], v2
    ds_read_b128 v[40:43], v21 offset:0
    v_smfmac_f32_16x16x64_bf16 v[24:27], v[44:47], a[56:63], v2
    ds_read_b128 v[64:67], v5 offset:2048
    v_smfmac_f32_16x16x64_bf16 v[28:31], v[44:47], v[88:95], v2
    ds_read_b128 v[44:47], v21 offset:1024
    ds_read_b128 v[68:71], v5 offset:3072
    s_waitcnt lgkmcnt(5)
    v_smfmac_f32_16x16x64_bf16 v[24:27], v[48:51], a[64:71], v2
    ds_read_b128 v[72:75], v5 offset:12288
    v_smfmac_f32_16x16x64_bf16 v[28:31], v[48:51], v[32:39], v2
    ds_read_b128 v[48:51], v21 offset:2048
    ds_read_b128 v[76:79], v5 offset:13312
    v_smfmac_f32_16x16x64_bf16 v[24:27], v[52:55], a[72:79], v2
    ds_read_b128 v[88:91], v5 offset:20480
    s_waitcnt lgkmcnt(6)
    v_smfmac_f32_16x16x64_bf16 v[28:31], v[52:55], v[56:63], v2
    ds_read_b128 v[52:55], v21 offset:3072
    ds_read_b128 v[92:95], v5 offset:21504
    v_smfmac_f32_16x16x64_bf16 v[24:27], v[40:43], a[80:87], v2
    ds_read_b128 v[32:35], v5 offset:0
    s_waitcnt lgkmcnt(6)
    v_smfmac_f32_16x16x64_bf16 v[28:31], v[40:43], v[64:71], v2
    ds_read_b128 v[40:43], v23 offset:0
    ds_read_b128 v[36:39], v5 offset:1024
    v_smfmac_f32_16x16x64_bf16 v[24:27], v[44:47], a[88:95], v2
    ds_read_b128 v[56:59], v5 offset:10240
    v_smfmac_f32_16x16x64_bf16 v[28:31], v[44:47], a[96:103], v2
    ds_read_b128 v[44:47], v23 offset:1024
    s_waitcnt lgkmcnt(5)
    v_smfmac_f32_16x16x64_bf16 v[24:27], v[48:51], a[104:111], v2
    ds_read_b128 v[60:63], v5 offset:11264
    v_smfmac_f32_16x16x64_bf16 v[28:31], v[48:51], v[72:79], v2
    ds_read_b128 v[48:51], v23 offset:2048
    v_smfmac_f32_16x16x64_bf16 v[24:27], v[52:55], a[112:119], v2
    ds_read_b128 v[64:67], v5 offset:18432
    v_smfmac_f32_16x16x64_bf16 v[28:31], v[52:55], v[88:95], v2
    ds_read_b128 v[52:55], v23 offset:3072
    s_waitcnt lgkmcnt(4)
    v_smfmac_f32_16x16x64_bf16 v[24:27], v[40:43], a[120:127], v2
    ds_read_b128 v[68:71], v5 offset:19456
    v_smfmac_f32_16x16x64_bf16 v[28:31], v[40:43], v[32:39], v2
    v_smfmac_f32_16x16x64_bf16 v[24:27], v[44:47], a[128:135], v2
    v_smfmac_f32_16x16x64_bf16 v[28:31], v[44:47], a[136:143], v2
    s_waitcnt lgkmcnt(1)
    v_smfmac_f32_16x16x64_bf16 v[24:27], v[48:51], a[144:151], v2
    v_smfmac_f32_16x16x64_bf16 v[28:31], v[48:51], v[56:63], v2
    v_smfmac_f32_16x16x64_bf16 v[24:27], v[52:55], a[152:159], v2
    s_waitcnt lgkmcnt(0)
    v_smfmac_f32_16x16x64_bf16 v[28:31], v[52:55], v[64:71], v2
    s_nop 5
    v_permlane32_swap_b32 v24, v26
    v_permlane32_swap_b32 v25, v27
    v_permlane32_swap_b32 v28, v30
    v_permlane32_swap_b32 v29, v31
    v_pk_add_f32 v[24:25], v[24:25], v[26:27]
    v_pk_add_f32 v[28:29], v[28:29], v[30:31]
    v_cvt_pk_bf16_f32 v16, v24, v25
    v_cvt_pk_bf16_f32 v17, v28, v29
    buffer_store_dwordx2 v[16:17], v10, s[24:27], s37 offen
    buffer_store_dwordx2 v[14:15], v10, s[24:27], s38 offen
    buffer_store_dword v14, v12, s[24:27], s39 offen
    buffer_store_dwordx2 v[16:17], v10, s[28:31], s37 offen sc1
    buffer_store_dwordx2 v[14:15], v10, s[28:31], s38 offen sc1
    buffer_store_dword v14, v12, s[28:31], s39 offen sc1
    s_barrier
    s_cmp_eq_u32 s60, 63
    s_cbranch_scc1 L_v_fin_93
    s_and_b32 s65, s60, 1
    s_lshl_b32 s65, s65, 12
    s_and_b32 s45, s60, 2
    s_lshl_b32 s45, s45, 13
    s_add_u32 s65, s65, s45
    s_xor_b32 s45, s65, 16384
    s_add_u32 s45, s45, s63
    buffer_store_dwordx2 v[14:15], v11, s[12:15], s45 offen sc1
    s_add_u32 s48, s63, s65
    s_add_u32 s49, s64, s65
    v_mov_b32 v24, 0
    v_mov_b32 v25, 0
    v_mov_b32 v26, 0
    v_mov_b32 v27, 0
    v_mov_b32 v28, 0
    v_mov_b32 v29, 0
    v_mov_b32 v30, 0
    v_mov_b32 v31, 0
    v_mov_b32 v32, 0
    v_mov_b32 v33, 0
    v_mov_b32 v34, 0
    v_mov_b32 v35, 0
    v_mov_b32 v36, 0
    v_mov_b32 v37, 0
    v_mov_b32 v38, 0
    v_mov_b32 v39, 0
    s_sleep 4
    s_waitcnt vmcnt(0)
    s_mov_b64 exec, 65535
    buffer_load_dword v88, v13, s[12:15], 0 offen sc1
    s_nop 15
    buffer_load_dword v89, v13, s[12:15], 0 offen sc1
    s_nop 15
    buffer_load_dword v90, v13, s[12:15], 0 offen sc1
    s_nop 15
    buffer_load_dword v91, v13, s[12:15], 0 offen sc1
    s_mov_b32 s70, 0
L_pp_94:
    s_waitcnt vmcnt(3)
    v_cmp_ge_u32 vcc, s60, v88
    s_add_u32 s70, s70, 1
    s_nop 0
    s_cbranch_vccz L_ppd_95
    buffer_load_dword v88, v13, s[12:15], 0 offen sc1
    s_waitcnt vmcnt(3)
    v_cmp_ge_u32 vcc, s60, v89
    s_add_u32 s70, s70, 1
    s_nop 0
    s_cbranch_vccz L_ppd_95
    buffer_load_dword v89, v13, s[12:15], 0 offen sc1
    s_waitcnt vmcnt(3)
    v_cmp_ge_u32 vcc, s60, v90
    s_add_u32 s70, s70, 1
    s_nop 0
    s_cbranch_vccz L_ppd_95
    buffer_load_dword v90, v13, s[12:15], 0 offen sc1
    s_waitcnt vmcnt(3)
    v_cmp_ge_u32 vcc, s60, v91
    s_add_u32 s70, s70, 1
    s_nop 0
    s_cbranch_vccz L_ppd_95
    buffer_load_dword v91, v13, s[12:15], 0 offen sc1
    s_cmp_lt_u32 s70, 0x400000
    s_cbranch_scc1 L_pp_94
    s_branch L_c_done_1
L_ppd_95:
    s_mov_b64 exec, -1
    s_nop 3
    s_mov_b32 s70, 0
    buffer_load_dwordx4 v[40:43], v80, s[12:15], s62 offen sc1
    s_nop 7
    buffer_load_dwordx4 v[44:47], v81, s[12:15], s62 offen sc1
    s_nop 7
    buffer_load_dwordx4 v[48:51], v82, s[12:15], s62 offen sc1
    s_nop 7
    buffer_load_dwordx4 v[52:55], v83, s[12:15], s62 offen sc1
    s_nop 7
    buffer_load_dwordx4 v[56:59], v84, s[12:15], s62 offen sc1
    s_nop 7
    buffer_load_dwordx4 v[60:63], v85, s[12:15], s62 offen sc1
    s_waitcnt vmcnt(5)
    v_cmp_eq_u32 vcc, -1, v43
    s_nop 1
    s_cbranch_vccnz L_v_og_96_r0
L_v_og_96_c0:
    v_smfmac_f32_16x16x64_bf16 v[24:27], v[40:43], a[160:167], v2
    s_waitcnt vmcnt(4)
    v_smfmac_f32_16x16x64_bf16 v[28:31], v[40:43], a[168:175], v2
    v_cmp_eq_u32 vcc, -1, v47
    v_smfmac_f32_16x16x64_bf16 v[32:35], v[40:43], a[176:183], v2
    buffer_load_dwordx4 v[64:67], v86, s[12:15], s62 offen sc1
    v_smfmac_f32_16x16x64_bf16 v[36:39], v[40:43], a[184:191], v2
    s_cbranch_vccnz L_v_og_96_r1
L_v_og_96_c1:
    v_smfmac_f32_16x16x64_bf16 v[24:27], v[44:47], a[192:199], v2
    s_waitcnt vmcnt(4)
    v_smfmac_f32_16x16x64_bf16 v[28:31], v[44:47], a[200:207], v2
    v_cmp_eq_u32 vcc, -1, v51
    v_smfmac_f32_16x16x64_bf16 v[32:35], v[44:47], a[208:215], v2
    buffer_load_dwordx4 v[68:71], v87, s[12:15], s62 offen sc1
    v_smfmac_f32_16x16x64_bf16 v[36:39], v[44:47], a[216:223], v2
    s_cbranch_vccnz L_v_og_96_r2
L_v_og_96_c2:
    v_smfmac_f32_16x16x64_bf16 v[24:27], v[48:51], a[224:231], v2
    s_waitcnt vmcnt(4)
    v_smfmac_f32_16x16x64_bf16 v[28:31], v[48:51], a[232:239], v2
    v_cmp_eq_u32 vcc, -1, v55
    v_smfmac_f32_16x16x64_bf16 v[32:35], v[48:51], a[240:247], v2
    v_smfmac_f32_16x16x64_bf16 v[36:39], v[48:51], a[248:255], v2
    s_cbranch_vccnz L_v_og_96_r3
L_v_og_96_c3:
    v_smfmac_f32_16x16x64_bf16 v[24:27], v[52:55], v[96:103], v2
    s_waitcnt vmcnt(3)
    v_cmp_eq_u32 vcc, -1, v59
    v_smfmac_f32_16x16x64_bf16 v[28:31], v[52:55], v[104:111], v2
    v_smfmac_f32_16x16x64_bf16 v[32:35], v[52:55], v[112:119], v2
    s_cbranch_vccnz L_v_og_96_r4
L_v_og_96_c4:
    v_smfmac_f32_16x16x64_bf16 v[24:27], v[56:59], v[128:135], v2
    s_waitcnt vmcnt(2)
    v_cmp_eq_u32 vcc, -1, v63
    v_smfmac_f32_16x16x64_bf16 v[28:31], v[56:59], v[136:143], v2
    v_smfmac_f32_16x16x64_bf16 v[32:35], v[56:59], v[144:151], v2
    s_cbranch_vccnz L_v_og_96_r5
L_v_og_96_c5:
    v_smfmac_f32_16x16x64_bf16 v[24:27], v[60:63], v[160:167], v2
    s_waitcnt vmcnt(1)
    v_cmp_eq_u32 vcc, -1, v67
    v_smfmac_f32_16x16x64_bf16 v[28:31], v[60:63], v[168:175], v2
    v_smfmac_f32_16x16x64_bf16 v[32:35], v[60:63], v[176:183], v2
    s_cbranch_vccnz L_v_og_96_r6
L_v_og_96_c6:
    v_smfmac_f32_16x16x64_bf16 v[24:27], v[64:67], v[192:199], v2
    s_waitcnt vmcnt(0)
    v_cmp_eq_u32 vcc, -1, v71
    v_smfmac_f32_16x16x64_bf16 v[28:31], v[64:67], v[200:207], v2
    v_smfmac_f32_16x16x64_bf16 v[32:35], v[64:67], v[208:215], v2
    s_cbranch_vccnz L_v_og_96_r7
L_v_og_96_c7:
    v_smfmac_f32_16x16x64_bf16 v[24:27], v[68:71], v[224:231], v2
    v_smfmac_f32_16x16x64_bf16 v[28:31], v[68:71], v[232:239], v2
    v_smfmac_f32_16x16x64_bf16 v[32:35], v[68:71], v[240:247], v2
    v_smfmac_f32_16x16x64_bf16 v[36:39], v[52:55], v[120:127], v2
    s_add_u32 s46, s60, 1
    v_smfmac_f32_16x16x64_bf16 v[36:39], v[56:59], v[152:159], v2
    s_and_b32 s45, s46, 3
    v_smfmac_f32_16x16x64_bf16 v[36:39], v[60:63], v[184:191], v2
    s_mov_b32 s60, s46
    ds_write_b128 v6, v[24:27] offset:0
    v_smfmac_f32_16x16x64_bf16 v[36:39], v[64:67], v[216:223], v2
    ds_write_b128 v6, v[28:31] offset:1024
    v_smfmac_f32_16x16x64_bf16 v[36:39], v[68:71], v[248:255], v2
    ds_write_b128 v6, v[32:35] offset:2048
    s_lshl_b32 s46, s45, 14
    s_add_u32 s61, s58, s46
    s_lshl_b32 s46, s45, 15
    s_add_u32 s62, s59, s46
    s_waitcnt lgkmcnt(0)
    s_barrier
    ds_read_b128 v[40:43], v7
    ds_read_b128 v[44:47], v8
    ds_read_b128 v[48:51], v18
    v_mov_b32 v19, s60
    s_waitcnt lgkmcnt(2)
    v_pk_add_f32 v[36:37], v[36:37], v[40:41]
    v_pk_add_f32 v[38:39], v[38:39], v[42:43]
    s_waitcnt lgkmcnt(1)
    v_pk_add_f32 v[36:37], v[36:37], v[44:45]
    v_pk_add_f32 v[38:39], v[38:39], v[46:47]
    s_waitcnt lgkmcnt(0)
    v_pk_add_f32 v[36:37], v[36:37], v[48:49]
    v_pk_add_f32 v[38:39], v[38:39], v[50:51]
    s_nop 1
    v_permlane32_swap_b32 v36, v38
    v_permlane32_swap_b32 v37, v39
    v_pk_add_f32 v[24:25], v[36:37], v[38:39]
    buffer_store_dwordx2 v[24:25], v11, s[12:15], s48 offen sc1
    ds_read_b128 v[56:59], v5 offset:8192
    ds_read_b128 v[60:63], v5 offset:9216
    ds_read_b128 v[64:67], v5 offset:16384
    ds_read_b128 v[68:71], v5 offset:17408
    ds_read_b128 v[72:75], v5 offset:4096
    ds_read_b128 v[76:79], v5 offset:5120
    ds_read_b128 v[88:91], v5 offset:6144
    ds_read_b128 v[92:95], v5 offset:7168
    ds_read_b128 v[32:35], v5 offset:14336
    ds_read_b128 v[36:39], v5 offset:15360
    s_sleep 4
    buffer_load_dwordx2 v[40:41], v11, s[12:15], s49 offen sc1
    s_mov_b32 s70, 0
L_v_xp_97:
    s_waitcnt vmcnt(0)
    v_max_u32 v22, v40, v41
    v_cmp_eq_u32 vcc, -1, v22
    v_pk_add_f32 v[28:29], v[24:25], v[40:41]
    v_cvt_pk_bf16_f32 v28, v28, v29
    s_cbranch_vccnz L_v_xp_97_r
L_v_xp_97_ok:
    buffer_store_dword v19, v20, s[24:27], 0 offen
    v_mov_b32_dpp v29, v28 quad_perm:[1,0,3,2] row_mask:0xf bank_mask:0xf
    v_perm_b32 v28, v28, v29, v9
    buffer_store_dword v28, v12, s[24:27], s61 offen
    buffer_store_dword v28, v12, s[28:31], s61 offen sc1
    buffer_store_dword v19, v20, s[28:31], 0 offen sc1
    s_add_u32 s66, s66, 65536
    s_branch L_v_loop_91
L_v_fin_93:
    buffer_store_dwordx2 v[16:17], v10, s[12:15], s66 offen sc1
    s_waitcnt vmcnt(0)
    v_mov_b32 v22, 64
    v_mov_b32 v0, 0
    s_mov_b64 exec, 1
    buffer_store_dword v22, v0, s[12:15], s3 offen sc1
    s_mov_b64 exec, -1
L_c_done_1:
    s_endpgm
L_v_og_96_r0:
    buffer_load_dwordx4 v[40:43], v80, s[12:15], s62 offen sc1
    buffer_load_dwordx4 v[44:47], v81, s[12:15], s62 offen sc1
    buffer_load_dwordx4 v[48:51], v82, s[12:15], s62 offen sc1
    buffer_load_dwordx4 v[52:55], v83, s[12:15], s62 offen sc1
    buffer_load_dwordx4 v[56:59], v84, s[12:15], s62 offen sc1
    buffer_load_dwordx4 v[60:63], v85, s[12:15], s62 offen sc1
    s_add_u32 s70, s70, 1
    s_cmp_ge_u32 s70, 0x100000
    s_cbranch_scc1 L_c_done_1
    s_waitcnt vmcnt(5)
    v_cmp_eq_u32 vcc, -1, v43
    s_nop 1
    s_cbranch_vccnz L_v_og_96_r0
    s_branch L_v_og_96_c0
L_v_og_96_r1:
    buffer_load_dwordx4 v[44:47], v81, s[12:15], s62 offen sc1
    buffer_load_dwordx4 v[48:51], v82, s[12:15], s62 offen sc1
    buffer_load_dwordx4 v[52:55], v83, s[12:15], s62 offen sc1
    buffer_load_dwordx4 v[56:59], v84, s[12:15], s62 offen sc1
    buffer_load_dwordx4 v[60:63], v85, s[12:15], s62 offen sc1
    buffer_load_dwordx4 v[64:67], v86, s[12:15], s62 offen sc1
    s_add_u32 s70, s70, 1
    s_cmp_ge_u32 s70, 0x100000
    s_cbranch_scc1 L_c_done_1
    s_waitcnt vmcnt(5)
    v_cmp_eq_u32 vcc, -1, v47
    s_nop 1
    s_cbranch_vccnz L_v_og_96_r1
    s_branch L_v_og_96_c1
L_v_og_96_r2:
    buffer_load_dwordx4 v[48:51], v82, s[12:15], s62 offen sc1
    buffer_load_dwordx4 v[52:55], v83, s[12:15], s62 offen sc1
    buffer_load_dwordx4 v[56:59], v84, s[12:15], s62 offen sc1
    buffer_load_dwordx4 v[60:63], v85, s[12:15], s62 offen sc1
    buffer_load_dwordx4 v[64:67], v86, s[12:15], s62 offen sc1
    buffer_load_dwordx4 v[68:71], v87, s[12:15], s62 offen sc1
    s_add_u32 s70, s70, 1
    s_cmp_ge_u32 s70, 0x100000
    s_cbranch_scc1 L_c_done_1
    s_waitcnt vmcnt(5)
    v_cmp_eq_u32 vcc, -1, v51
    s_nop 1
    s_cbranch_vccnz L_v_og_96_r2
    s_branch L_v_og_96_c2
L_v_og_96_r3:
    buffer_load_dwordx4 v[52:55], v83, s[12:15], s62 offen sc1
    buffer_load_dwordx4 v[56:59], v84, s[12:15], s62 offen sc1
    buffer_load_dwordx4 v[60:63], v85, s[12:15], s62 offen sc1
    buffer_load_dwordx4 v[64:67], v86, s[12:15], s62 offen sc1
    buffer_load_dwordx4 v[68:71], v87, s[12:15], s62 offen sc1
    s_add_u32 s70, s70, 1
    s_cmp_ge_u32 s70, 0x100000
    s_cbranch_scc1 L_c_done_1
    s_waitcnt vmcnt(4)
    v_cmp_eq_u32 vcc, -1, v55
    s_nop 1
    s_cbranch_vccnz L_v_og_96_r3
    s_branch L_v_og_96_c3
L_v_og_96_r4:
    buffer_load_dwordx4 v[56:59], v84, s[12:15], s62 offen sc1
    buffer_load_dwordx4 v[60:63], v85, s[12:15], s62 offen sc1
    buffer_load_dwordx4 v[64:67], v86, s[12:15], s62 offen sc1
    buffer_load_dwordx4 v[68:71], v87, s[12:15], s62 offen sc1
    s_add_u32 s70, s70, 1
    s_cmp_ge_u32 s70, 0x100000
    s_cbranch_scc1 L_c_done_1
    s_waitcnt vmcnt(3)
    v_cmp_eq_u32 vcc, -1, v59
    s_nop 1
    s_cbranch_vccnz L_v_og_96_r4
    s_branch L_v_og_96_c4
L_v_og_96_r5:
    buffer_load_dwordx4 v[60:63], v85, s[12:15], s62 offen sc1
    buffer_load_dwordx4 v[64:67], v86, s[12:15], s62 offen sc1
    buffer_load_dwordx4 v[68:71], v87, s[12:15], s62 offen sc1
    s_add_u32 s70, s70, 1
    s_cmp_ge_u32 s70, 0x100000
    s_cbranch_scc1 L_c_done_1
    s_waitcnt vmcnt(2)
    v_cmp_eq_u32 vcc, -1, v63
    s_nop 1
    s_cbranch_vccnz L_v_og_96_r5
    s_branch L_v_og_96_c5
L_v_og_96_r6:
    buffer_load_dwordx4 v[64:67], v86, s[12:15], s62 offen sc1
    buffer_load_dwordx4 v[68:71], v87, s[12:15], s62 offen sc1
    s_add_u32 s70, s70, 1
    s_cmp_ge_u32 s70, 0x100000
    s_cbranch_scc1 L_c_done_1
    s_waitcnt vmcnt(1)
    v_cmp_eq_u32 vcc, -1, v67
    s_nop 1
    s_cbranch_vccnz L_v_og_96_r6
    s_branch L_v_og_96_c6
L_v_og_96_r7:
    buffer_load_dwordx4 v[68:71], v87, s[12:15], s62 offen sc1
    s_add_u32 s70, s70, 1
    s_cmp_ge_u32 s70, 0x100000
    s_cbranch_scc1 L_c_done_1
    s_waitcnt vmcnt(0)
    v_cmp_eq_u32 vcc, -1, v71
    s_nop 1
    s_cbranch_vccnz L_v_og_96_r7
    s_branch L_v_og_96_c7
L_mg_92_r0:
    buffer_load_dwordx4 v[40:43], v3, s[12:15], s8 offen sc1
    buffer_load_dwordx4 v[44:47], v3, s[12:15], s9 offen sc1
    buffer_load_dwordx4 v[48:51], v3, s[12:15], s10 offen sc1
    buffer_load_dwordx4 v[52:55], v3, s[12:15], s11 offen sc1
    s_add_u32 s70, s70, 1
    s_cmp_ge_u32 s70, 0x100000
    s_cbranch_scc1 L_c_done_1
    s_waitcnt vmcnt(3)
    ds_write_b128 v3, v[40:43] offset:0
    v_max3_u32 v22, v40, v41, v42
    v_max_u32 v22, v22, v43
    v_cmp_eq_u32 vcc, -1, v22
    s_waitcnt lgkmcnt(0)
    s_nop 0
    s_cbranch_vccnz L_mg_92_r0
    s_branch L_mg_92_c0
L_mg_92_r1:
    buffer_load_dwordx4 v[44:47], v3, s[12:15], s9 offen sc1
    buffer_load_dwordx4 v[48:51], v3, s[12:15], s10 offen sc1
    buffer_load_dwordx4 v[52:55], v3, s[12:15], s11 offen sc1
    s_add_u32 s70, s70, 1
    s_cmp_ge_u32 s70, 0x100000
    s_cbranch_scc1 L_c_done_1
    s_waitcnt vmcnt(2)
    ds_write_b128 v3, v[44:47] offset:1024
    v_max3_u32 v22, v44, v45, v46
    v_max_u32 v22, v22, v47
    v_cmp_eq_u32 vcc, -1, v22
    s_waitcnt lgkmcnt(0)
    s_nop 0
    s_cbranch_vccnz L_mg_92_r1
    s_branch L_mg_92_c1
L_mg_92_r2:
    buffer_load_dwordx4 v[48:51], v3, s[12:15], s10 offen sc1
    buffer_load_dwordx4 v[52:55], v3, s[12:15], s11 offen sc1
    s_add_u32 s70, s70, 1
    s_cmp_ge_u32 s70, 0x100000
    s_cbranch_scc1 L_c_done_1
    s_waitcnt vmcnt(1)
    ds_write_b128 v3, v[48:51] offset:2048
    v_max3_u32 v22, v48, v49, v50
    v_max_u32 v22, v22, v51
    v_cmp_eq_u32 vcc, -1, v22
    s_waitcnt lgkmcnt(0)
    s_nop 0
    s_cbranch_vccnz L_mg_92_r2
    s_branch L_mg_92_c2
L_mg_92_r3:
    buffer_load_dwordx4 v[52:55], v3, s[12:15], s11 offen sc1
    s_add_u32 s70, s70, 1
    s_cmp_ge_u32 s70, 0x100000
    s_cbranch_scc1 L_c_done_1
    s_waitcnt vmcnt(0)
    ds_write_b128 v3, v[52:55] offset:3072
    v_max3_u32 v22, v52, v53, v54
    v_max_u32 v22, v22, v55
    v_cmp_eq_u32 vcc, -1, v22
    s_waitcnt lgkmcnt(0)
    s_nop 0
    s_cbranch_vccnz L_mg_92_r3
    s_branch L_mg_92_c3
L_v_xp_97_r:
    buffer_load_dwordx2 v[40:41], v11, s[12:15], s49 offen sc1
    s_add_u32 s70, s70, 1
    s_cmp_lt_u32 s70, 0x100000
    s_cbranch_scc1 L_v_xp_97
    s_endpgm
L_worker_3:
    s_lshr_b32 s41, s2, 3
    s_and_b32 s42, s40, 1
    s_lshr_b32 s43, s40, 1
    s_lshl_b32 s39, s43, 5
    s_add_u32 s39, s39, s41
    s_load_dwordx2 s[4:5], s[0:1], 0
    s_waitcnt lgkmcnt(0)
    s_mov_b32 s28, s4
    s_and_b32 s29, s5, 0xffff
    s_mov_b32 s30, 0x400000
    s_mov_b32 s31, 0x00020000
    v_lshrrev_b32 v2, 4, v1
    v_and_b32 v4, 15, v1
    v_lshrrev_b32 v3, 1, v4
    v_xor_b32 v3, v3, v2
    v_lshlrev_b32 v3, 4, v3
    v_lshlrev_b32 v6, 7, v4
    v_add_u32 v3, v3, v6
    v_mul_u32_u24 v7, 144, v4
    v_lshlrev_b32 v6, 4, v2
    s_mul_i32 s45, s44, 4608
    s_add_u32 s45, s45, 131072
    v_add3_u32 v7, v7, v6, s45
    v_lshrrev_b32 v9, 3, v1
    v_mul_u32_u24 v8, 144, v9
    v_and_b32 v6, 7, v1
    v_lshlrev_b32 v6, 4, v6
    v_add3_u32 v8, v8, v6, s45
    v_lshlrev_b32 v11, 12, v9
    v_add_u32 v11, v11, v6
    v_lshlrev_b32 v2, 13, v2
    v_lshlrev_b32 v6, 4, v4
    v_add_u32 v2, v2, v6
    v_lshrrev_b32 v6, 3, v1
    v_lshrrev_b32 v9, 4, v1
    v_and_b32 v4, 7, v1
    v_xor_b32 v9, v9, v4
    v_lshlrev_b32 v9, 4, v9
    v_lshlrev_b32 v6, 8, v6
    v_add_u32 v6, v6, v9
    v_xor_b32 v9, 64, v6
    v_add_u32 v9, 2048, v9
    v_lshlrev_b32 v10, 4, v1
    v_lshlrev_b32 v12, 2, v1
    v_lshlrev_b32 v5, 7, v1
    s_lshl_b32 s61, s41, 7
    s_lshl_b32 s45, s43, 2
    s_add_u32 s61, s61, s45
    s_add_u32 s61, s61, 0x10010
    s_mul_i32 s64, s42, 24576
    s_add_u32 s64, s64, 0x12000
    s_lshl_b32 s45, s41, 7
    s_add_u32 s65, s64, s45
    s_lshl_b32 s45, s43, 13
    s_add_u32 s65, s65, s45
    s_add_u32 s67, s65, 4096
    s_cmp_lg_u32 s42, 0
    s_cbranch_scc1 L_w_kv_99
    v_mov_b32 v30, 0
    v_mov_b32 v31, 0
    v_mov_b32 v29, 24576
    s_mov_b64 exec, 1
    buffer_store_dword v30, v31, s[12:15], s65 offen sc1
    buffer_store_dword v30, v31, s[12:15], s67 offen sc1
    buffer_store_dword v30, v29, s[12:15], s65 offen sc1
    buffer_store_dword v30, v29, s[12:15], s67 offen sc1
    s_mov_b64 exec, -1
    s_lshl_b32 s63, s39, 2
    s_add_u32 s63, s63, s44
    s_load_dwordx2 s[4:5], s[0:1], 96
    s_load_dwordx2 s[6:7], s[0:1], 104
    v_and_b32 v14, 7, v0
    v_lshrrev_b32 v15, 3, v0
    s_waitcnt lgkmcnt(0)
    s_mov_b32 s32, s4
    s_and_b32 s33, s5, 0xffff
    s_mov_b32 s34, 0x800
    s_mov_b32 s35, 0x00020000
    s_mov_b32 s24, s6
    s_and_b32 s25, s7, 0xffff
    s_mov_b32 s26, 0xc00000
    s_mov_b32 s27, 0x00020000
    s_and_b32 s47, s39, 1
    s_lshl_b32 s45, s47, 10
    v_lshlrev_b32 v16, 5, v15
    buffer_load_dwordx4 v[104:107], v16, s[32:35], s45 offen
    buffer_load_dwordx4 v[108:111], v16, s[32:35], s45 offen offset:16
    s_mov_b32 s45, 196608
    v_mul_lo_u32 v17, v15, s45
    v_lshlrev_b32 v18, 4, v14
    v_add_u32 v17, v17, v18
    s_lshr_b32 s46, s39, 1
    s_lshl_b32 s46, s46, 7
    s_mul_i32 s45, s47, 6291456
    s_add_u32 s46, s46, s45
    buffer_load_dwordx4 v[32:35], v17, s[24:27], s46 offen
    v_add_u32 v17, 12288, v17
    buffer_load_dwordx4 v[36:39], v17, s[24:27], s46 offen
    v_add_u32 v17, 12288, v17
    buffer_load_dwordx4 v[40:43], v17, s[24:27], s46 offen
    v_add_u32 v17, 12288, v17
    buffer_load_dwordx4 v[44:47], v17, s[24:27], s46 offen
    v_add_u32 v17, 12288, v17
    buffer_load_dwordx4 v[48:51], v17, s[24:27], s46 offen
    v_add_u32 v17, 12288, v17
    buffer_load_dwordx4 v[52:55], v17, s[24:27], s46 offen
    v_add_u32 v17, 12288, v17
    buffer_load_dwordx4 v[56:59], v17, s[24:27], s46 offen
    v_add_u32 v17, 12288, v17
    buffer_load_dwordx4 v[60:63], v17, s[24:27], s46 offen
    v_add_u32 v17, 12288, v17
    buffer_load_dwordx4 v[64:67], v17, s[24:27], s46 offen
    v_add_u32 v17, 12288, v17
    buffer_load_dwordx4 v[68:71], v17, s[24:27], s46 offen
    v_add_u32 v17, 12288, v17
    buffer_load_dwordx4 v[72:75], v17, s[24:27], s46 offen
    v_add_u32 v17, 12288, v17
    buffer_load_dwordx4 v[76:79], v17, s[24:27], s46 offen
    v_add_u32 v17, 12288, v17
    buffer_load_dwordx4 v[80:83], v17, s[24:27], s46 offen
    v_add_u32 v17, 12288, v17
    buffer_load_dwordx4 v[84:87], v17, s[24:27], s46 offen
    v_add_u32 v17, 12288, v17
    buffer_load_dwordx4 v[88:91], v17, s[24:27], s46 offen
    v_add_u32 v17, 12288, v17
    buffer_load_dwordx4 v[92:95], v17, s[24:27], s46 offen
    s_add_u32 s45, s63, 0
    s_lshl_b32 s45, s45, 11
    buffer_load_dwordx4 v[128:131], v10, s[28:31], s45 offen
    buffer_load_dwordx4 v[132:135], v10, s[28:31], s45 offen offset:1024
    s_add_u32 s45, s63, 384
    s_lshl_b32 s45, s45, 11
    buffer_load_dwordx4 v[136:139], v10, s[28:31], s45 offen
    buffer_load_dwordx4 v[140:143], v10, s[28:31], s45 offen offset:1024
    s_add_u32 s45, s63, 768
    s_lshl_b32 s45, s45, 11
    buffer_load_dwordx4 v[144:147], v10, s[28:31], s45 offen
    buffer_load_dwordx4 v[148:151], v10, s[28:31], s45 offen offset:1024
    s_add_u32 s45, s63, 1152
    s_lshl_b32 s45, s45, 11
    buffer_load_dwordx4 v[152:155], v10, s[28:31], s45 offen
    buffer_load_dwordx4 v[156:159], v10, s[28:31], s45 offen offset:1024
    s_add_u32 s45, s63, 1536
    s_lshl_b32 s45, s45, 11
    buffer_load_dwordx4 v[160:163], v10, s[28:31], s45 offen
    buffer_load_dwordx4 v[164:167], v10, s[28:31], s45 offen offset:1024
    s_add_u32 s45, s63, 1920
    s_lshl_b32 s45, s45, 11
    buffer_load_dwordx4 v[168:171], v10, s[28:31], s45 offen
    buffer_load_dwordx4 v[172:175], v10, s[28:31], s45 offen offset:1024
    s_waitcnt vmcnt(28)
    v_lshlrev_b32 v112, 16, v104
    v_and_b32 v113, 0xffff0000, v104
    v_lshlrev_b32 v114, 16, v105
    v_and_b32 v115, 0xffff0000, v105
    v_lshlrev_b32 v116, 16, v106
    v_and_b32 v117, 0xffff0000, v106
    v_lshlrev_b32 v118, 16, v107
    v_and_b32 v119, 0xffff0000, v107
    v_lshlrev_b32 v120, 16, v108
    v_and_b32 v121, 0xffff0000, v108
    v_lshlrev_b32 v122, 16, v109
    v_and_b32 v123, 0xffff0000, v109
    v_lshlrev_b32 v124, 16, v110
    v_and_b32 v125, 0xffff0000, v110
    v_lshlrev_b32 v126, 16, v111
    v_and_b32 v127, 0xffff0000, v111
    v_mul_f32 v18, 0xbfb8aa3b, v112
    v_exp_f32 v18, v18
    s_nop 0
    v_add_f32 v18, 1.0, v18
    v_rcp_f32 v18, v18
    s_nop 0
    v_mul_f32 v112, v112, v18
    v_cvt_pk_bf16_f32 v112, v112, v112
    v_lshlrev_b32 v112, 16, v112
    v_mul_f32 v18, 0xbfb8aa3b, v113
    v_exp_f32 v18, v18
    s_nop 0
    v_add_f32 v18, 1.0, v18
    v_rcp_f32 v18, v18
    s_nop 0
    v_mul_f32 v113, v113, v18
    v_cvt_pk_bf16_f32 v113, v113, v113
    v_lshlrev_b32 v113, 16, v113
    v_mul_f32 v18, 0xbfb8aa3b, v114
    v_exp_f32 v18, v18
    s_nop 0
    v_add_f32 v18, 1.0, v18
    v_rcp_f32 v18, v18
    s_nop 0
    v_mul_f32 v114, v114, v18
    v_cvt_pk_bf16_f32 v114, v114, v114
    v_lshlrev_b32 v114, 16, v114
    v_mul_f32 v18, 0xbfb8aa3b, v115
    v_exp_f32 v18, v18
    s_nop 0
    v_add_f32 v18, 1.0, v18
    v_rcp_f32 v18, v18
    s_nop 0
    v_mul_f32 v115, v115, v18
    v_cvt_pk_bf16_f32 v115, v115, v115
    v_lshlrev_b32 v115, 16, v115
    v_mul_f32 v18, 0xbfb8aa3b, v116
    v_exp_f32 v18, v18
    s_nop 0
    v_add_f32 v18, 1.0, v18
    v_rcp_f32 v18, v18
    s_nop 0
    v_mul_f32 v116, v116, v18
    v_cvt_pk_bf16_f32 v116, v116, v116
    v_lshlrev_b32 v116, 16, v116
    v_mul_f32 v18, 0xbfb8aa3b, v117
    v_exp_f32 v18, v18
    s_nop 0
    v_add_f32 v18, 1.0, v18
    v_rcp_f32 v18, v18
    s_nop 0
    v_mul_f32 v117, v117, v18
    v_cvt_pk_bf16_f32 v117, v117, v117
    v_lshlrev_b32 v117, 16, v117
    v_mul_f32 v18, 0xbfb8aa3b, v118
    v_exp_f32 v18, v18
    s_nop 0
    v_add_f32 v18, 1.0, v18
    v_rcp_f32 v18, v18
    s_nop 0
    v_mul_f32 v118, v118, v18
    v_cvt_pk_bf16_f32 v118, v118, v118
    v_lshlrev_b32 v118, 16, v118
    v_mul_f32 v18, 0xbfb8aa3b, v119
    v_exp_f32 v18, v18
    s_nop 0
    v_add_f32 v18, 1.0, v18
    v_rcp_f32 v18, v18
    s_nop 0
    v_mul_f32 v119, v119, v18
    v_cvt_pk_bf16_f32 v119, v119, v119
    v_lshlrev_b32 v119, 16, v119
    v_mul_f32 v18, 0xbfb8aa3b, v120
    v_exp_f32 v18, v18
    s_nop 0
    v_add_f32 v18, 1.0, v18
    v_rcp_f32 v18, v18
    s_nop 0
    v_mul_f32 v120, v120, v18
    v_cvt_pk_bf16_f32 v120, v120, v120
    v_lshlrev_b32 v120, 16, v120
    v_mul_f32 v18, 0xbfb8aa3b, v121
    v_exp_f32 v18, v18
    s_nop 0
    v_add_f32 v18, 1.0, v18
    v_rcp_f32 v18, v18
    s_nop 0
    v_mul_f32 v121, v121, v18
    v_cvt_pk_bf16_f32 v121, v121, v121
    v_lshlrev_b32 v121, 16, v121
    v_mul_f32 v18, 0xbfb8aa3b, v122
    v_exp_f32 v18, v18
    s_nop 0
    v_add_f32 v18, 1.0, v18
    v_rcp_f32 v18, v18
    s_nop 0
    v_mul_f32 v122, v122, v18
    v_cvt_pk_bf16_f32 v122, v122, v122
    v_lshlrev_b32 v122, 16, v122
    v_mul_f32 v18, 0xbfb8aa3b, v123
    v_exp_f32 v18, v18
    s_nop 0
    v_add_f32 v18, 1.0, v18
    v_rcp_f32 v18, v18
    s_nop 0
    v_mul_f32 v123, v123, v18
    v_cvt_pk_bf16_f32 v123, v123, v123
    v_lshlrev_b32 v123, 16, v123
    v_mul_f32 v18, 0xbfb8aa3b, v124
    v_exp_f32 v18, v18
    s_nop 0
    v_add_f32 v18, 1.0, v18
    v_rcp_f32 v18, v18
    s_nop 0
    v_mul_f32 v124, v124, v18
    v_cvt_pk_bf16_f32 v124, v124, v124
    v_lshlrev_b32 v124, 16, v124
    v_mul_f32 v18, 0xbfb8aa3b, v125
    v_exp_f32 v18, v18
    s_nop 0
    v_add_f32 v18, 1.0, v18
    v_rcp_f32 v18, v18
    s_nop 0
    v_mul_f32 v125, v125, v18
    v_cvt_pk_bf16_f32 v125, v125, v125
    v_lshlrev_b32 v125, 16, v125
    v_mul_f32 v18, 0xbfb8aa3b, v126
    v_exp_f32 v18, v18
    s_nop 0
    v_add_f32 v18, 1.0, v18
    v_rcp_f32 v18, v18
    s_nop 0
    v_mul_f32 v126, v126, v18
    v_cvt_pk_bf16_f32 v126, v126, v126
    v_lshlrev_b32 v126, 16, v126
    v_mul_f32 v18, 0xbfb8aa3b, v127
    v_exp_f32 v18, v18
    s_nop 0
    v_add_f32 v18, 1.0, v18
    v_rcp_f32 v18, v18
    s_nop 0
    v_mul_f32 v127, v127, v18
    v_cvt_pk_bf16_f32 v127, v127, v127
    v_lshlrev_b32 v127, 16, v127
    v_mov_b32 v96, 0
    v_mov_b32 v97, 0
    v_mov_b32 v98, 0
    v_mov_b32 v99, 0
    v_mov_b32 v100, 0
    v_mov_b32 v101, 0
    v_mov_b32 v102, 0
    v_mov_b32 v103, 0
    s_waitcnt vmcnt(27)
    v_lshlrev_b32 v18, 16, v32
    v_and_b32 v19, 0xffff0000, v32
    v_fmac_f32 v96, v18, v112
    v_fmac_f32 v97, v19, v112
    v_lshlrev_b32 v18, 16, v33
    v_and_b32 v19, 0xffff0000, v33
    v_fmac_f32 v98, v18, v112
    v_fmac_f32 v99, v19, v112
    v_lshlrev_b32 v18, 16, v34
    v_and_b32 v19, 0xffff0000, v34
    v_fmac_f32 v100, v18, v112
    v_fmac_f32 v101, v19, v112
    v_lshlrev_b32 v18, 16, v35
    v_and_b32 v19, 0xffff0000, v35
    v_fmac_f32 v102, v18, v112
    v_fmac_f32 v103, v19, v112
    s_waitcnt vmcnt(26)
    v_lshlrev_b32 v18, 16, v36
    v_and_b32 v19, 0xffff0000, v36
    v_fmac_f32 v96, v18, v113
    v_fmac_f32 v97, v19, v113
    v_lshlrev_b32 v18, 16, v37
    v_and_b32 v19, 0xffff0000, v37
    v_fmac_f32 v98, v18, v113
    v_fmac_f32 v99, v19, v113
    v_lshlrev_b32 v18, 16, v38
    v_and_b32 v19, 0xffff0000, v38
    v_fmac_f32 v100, v18, v113
    v_fmac_f32 v101, v19, v113
    v_lshlrev_b32 v18, 16, v39
    v_and_b32 v19, 0xffff0000, v39
    v_fmac_f32 v102, v18, v113
    v_fmac_f32 v103, v19, v113
    s_waitcnt vmcnt(25)
    v_lshlrev_b32 v18, 16, v40
    v_and_b32 v19, 0xffff0000, v40
    v_fmac_f32 v96, v18, v114
    v_fmac_f32 v97, v19, v114
    v_lshlrev_b32 v18, 16, v41
    v_and_b32 v19, 0xffff0000, v41
    v_fmac_f32 v98, v18, v114
    v_fmac_f32 v99, v19, v114
    v_lshlrev_b32 v18, 16, v42
    v_and_b32 v19, 0xffff0000, v42
    v_fmac_f32 v100, v18, v114
    v_fmac_f32 v101, v19, v114
    v_lshlrev_b32 v18, 16, v43
    v_and_b32 v19, 0xffff0000, v43
    v_fmac_f32 v102, v18, v114
    v_fmac_f32 v103, v19, v114
    s_waitcnt vmcnt(24)
    v_lshlrev_b32 v18, 16, v44
    v_and_b32 v19, 0xffff0000, v44
    v_fmac_f32 v96, v18, v115
    v_fmac_f32 v97, v19, v115
    v_lshlrev_b32 v18, 16, v45
    v_and_b32 v19, 0xffff0000, v45
    v_fmac_f32 v98, v18, v115
    v_fmac_f32 v99, v19, v115
    v_lshlrev_b32 v18, 16, v46
    v_and_b32 v19, 0xffff0000, v46
    v_fmac_f32 v100, v18, v115
    v_fmac_f32 v101, v19, v115
    v_lshlrev_b32 v18, 16, v47
    v_and_b32 v19, 0xffff0000, v47
    v_fmac_f32 v102, v18, v115
    v_fmac_f32 v103, v19, v115
    s_waitcnt vmcnt(23)
    v_lshlrev_b32 v18, 16, v48
    v_and_b32 v19, 0xffff0000, v48
    v_fmac_f32 v96, v18, v116
    v_fmac_f32 v97, v19, v116
    v_lshlrev_b32 v18, 16, v49
    v_and_b32 v19, 0xffff0000, v49
    v_fmac_f32 v98, v18, v116
    v_fmac_f32 v99, v19, v116
    v_lshlrev_b32 v18, 16, v50
    v_and_b32 v19, 0xffff0000, v50
    v_fmac_f32 v100, v18, v116
    v_fmac_f32 v101, v19, v116
    v_lshlrev_b32 v18, 16, v51
    v_and_b32 v19, 0xffff0000, v51
    v_fmac_f32 v102, v18, v116
    v_fmac_f32 v103, v19, v116
    s_waitcnt vmcnt(22)
    v_lshlrev_b32 v18, 16, v52
    v_and_b32 v19, 0xffff0000, v52
    v_fmac_f32 v96, v18, v117
    v_fmac_f32 v97, v19, v117
    v_lshlrev_b32 v18, 16, v53
    v_and_b32 v19, 0xffff0000, v53
    v_fmac_f32 v98, v18, v117
    v_fmac_f32 v99, v19, v117
    v_lshlrev_b32 v18, 16, v54
    v_and_b32 v19, 0xffff0000, v54
    v_fmac_f32 v100, v18, v117
    v_fmac_f32 v101, v19, v117
    v_lshlrev_b32 v18, 16, v55
    v_and_b32 v19, 0xffff0000, v55
    v_fmac_f32 v102, v18, v117
    v_fmac_f32 v103, v19, v117
    s_waitcnt vmcnt(21)
    v_lshlrev_b32 v18, 16, v56
    v_and_b32 v19, 0xffff0000, v56
    v_fmac_f32 v96, v18, v118
    v_fmac_f32 v97, v19, v118
    v_lshlrev_b32 v18, 16, v57
    v_and_b32 v19, 0xffff0000, v57
    v_fmac_f32 v98, v18, v118
    v_fmac_f32 v99, v19, v118
    v_lshlrev_b32 v18, 16, v58
    v_and_b32 v19, 0xffff0000, v58
    v_fmac_f32 v100, v18, v118
    v_fmac_f32 v101, v19, v118
    v_lshlrev_b32 v18, 16, v59
    v_and_b32 v19, 0xffff0000, v59
    v_fmac_f32 v102, v18, v118
    v_fmac_f32 v103, v19, v118
    s_waitcnt vmcnt(20)
    v_lshlrev_b32 v18, 16, v60
    v_and_b32 v19, 0xffff0000, v60
    v_fmac_f32 v96, v18, v119
    v_fmac_f32 v97, v19, v119
    v_lshlrev_b32 v18, 16, v61
    v_and_b32 v19, 0xffff0000, v61
    v_fmac_f32 v98, v18, v119
    v_fmac_f32 v99, v19, v119
    v_lshlrev_b32 v18, 16, v62
    v_and_b32 v19, 0xffff0000, v62
    v_fmac_f32 v100, v18, v119
    v_fmac_f32 v101, v19, v119
    v_lshlrev_b32 v18, 16, v63
    v_and_b32 v19, 0xffff0000, v63
    v_fmac_f32 v102, v18, v119
    v_fmac_f32 v103, v19, v119
    s_waitcnt vmcnt(19)
    v_lshlrev_b32 v18, 16, v64
    v_and_b32 v19, 0xffff0000, v64
    v_fmac_f32 v96, v18, v120
    v_fmac_f32 v97, v19, v120
    v_lshlrev_b32 v18, 16, v65
    v_and_b32 v19, 0xffff0000, v65
    v_fmac_f32 v98, v18, v120
    v_fmac_f32 v99, v19, v120
    v_lshlrev_b32 v18, 16, v66
    v_and_b32 v19, 0xffff0000, v66
    v_fmac_f32 v100, v18, v120
    v_fmac_f32 v101, v19, v120
    v_lshlrev_b32 v18, 16, v67
    v_and_b32 v19, 0xffff0000, v67
    v_fmac_f32 v102, v18, v120
    v_fmac_f32 v103, v19, v120
    s_waitcnt vmcnt(18)
    v_lshlrev_b32 v18, 16, v68
    v_and_b32 v19, 0xffff0000, v68
    v_fmac_f32 v96, v18, v121
    v_fmac_f32 v97, v19, v121
    v_lshlrev_b32 v18, 16, v69
    v_and_b32 v19, 0xffff0000, v69
    v_fmac_f32 v98, v18, v121
    v_fmac_f32 v99, v19, v121
    v_lshlrev_b32 v18, 16, v70
    v_and_b32 v19, 0xffff0000, v70
    v_fmac_f32 v100, v18, v121
    v_fmac_f32 v101, v19, v121
    v_lshlrev_b32 v18, 16, v71
    v_and_b32 v19, 0xffff0000, v71
    v_fmac_f32 v102, v18, v121
    v_fmac_f32 v103, v19, v121
    s_waitcnt vmcnt(17)
    v_lshlrev_b32 v18, 16, v72
    v_and_b32 v19, 0xffff0000, v72
    v_fmac_f32 v96, v18, v122
    v_fmac_f32 v97, v19, v122
    v_lshlrev_b32 v18, 16, v73
    v_and_b32 v19, 0xffff0000, v73
    v_fmac_f32 v98, v18, v122
    v_fmac_f32 v99, v19, v122
    v_lshlrev_b32 v18, 16, v74
    v_and_b32 v19, 0xffff0000, v74
    v_fmac_f32 v100, v18, v122
    v_fmac_f32 v101, v19, v122
    v_lshlrev_b32 v18, 16, v75
    v_and_b32 v19, 0xffff0000, v75
    v_fmac_f32 v102, v18, v122
    v_fmac_f32 v103, v19, v122
    s_waitcnt vmcnt(16)
    v_lshlrev_b32 v18, 16, v76
    v_and_b32 v19, 0xffff0000, v76
    v_fmac_f32 v96, v18, v123
    v_fmac_f32 v97, v19, v123
    v_lshlrev_b32 v18, 16, v77
    v_and_b32 v19, 0xffff0000, v77
    v_fmac_f32 v98, v18, v123
    v_fmac_f32 v99, v19, v123
    v_lshlrev_b32 v18, 16, v78
    v_and_b32 v19, 0xffff0000, v78
    v_fmac_f32 v100, v18, v123
    v_fmac_f32 v101, v19, v123
    v_lshlrev_b32 v18, 16, v79
    v_and_b32 v19, 0xffff0000, v79
    v_fmac_f32 v102, v18, v123
    v_fmac_f32 v103, v19, v123
    s_waitcnt vmcnt(15)
    v_lshlrev_b32 v18, 16, v80
    v_and_b32 v19, 0xffff0000, v80
    v_fmac_f32 v96, v18, v124
    v_fmac_f32 v97, v19, v124
    v_lshlrev_b32 v18, 16, v81
    v_and_b32 v19, 0xffff0000, v81
    v_fmac_f32 v98, v18, v124
    v_fmac_f32 v99, v19, v124
    v_lshlrev_b32 v18, 16, v82
    v_and_b32 v19, 0xffff0000, v82
    v_fmac_f32 v100, v18, v124
    v_fmac_f32 v101, v19, v124
    v_lshlrev_b32 v18, 16, v83
    v_and_b32 v19, 0xffff0000, v83
    v_fmac_f32 v102, v18, v124
    v_fmac_f32 v103, v19, v124
    s_waitcnt vmcnt(14)
    v_lshlrev_b32 v18, 16, v84
    v_and_b32 v19, 0xffff0000, v84
    v_fmac_f32 v96, v18, v125
    v_fmac_f32 v97, v19, v125
    v_lshlrev_b32 v18, 16, v85
    v_and_b32 v19, 0xffff0000, v85
    v_fmac_f32 v98, v18, v125
    v_fmac_f32 v99, v19, v125
    v_lshlrev_b32 v18, 16, v86
    v_and_b32 v19, 0xffff0000, v86
    v_fmac_f32 v100, v18, v125
    v_fmac_f32 v101, v19, v125
    v_lshlrev_b32 v18, 16, v87
    v_and_b32 v19, 0xffff0000, v87
    v_fmac_f32 v102, v18, v125
    v_fmac_f32 v103, v19, v125
    s_waitcnt vmcnt(13)
    v_lshlrev_b32 v18, 16, v88
    v_and_b32 v19, 0xffff0000, v88
    v_fmac_f32 v96, v18, v126
    v_fmac_f32 v97, v19, v126
    v_lshlrev_b32 v18, 16, v89
    v_and_b32 v19, 0xffff0000, v89
    v_fmac_f32 v98, v18, v126
    v_fmac_f32 v99, v19, v126
    v_lshlrev_b32 v18, 16, v90
    v_and_b32 v19, 0xffff0000, v90
    v_fmac_f32 v100, v18, v126
    v_fmac_f32 v101, v19, v126
    v_lshlrev_b32 v18, 16, v91
    v_and_b32 v19, 0xffff0000, v91
    v_fmac_f32 v102, v18, v126
    v_fmac_f32 v103, v19, v126
    s_waitcnt vmcnt(12)
    v_lshlrev_b32 v18, 16, v92
    v_and_b32 v19, 0xffff0000, v92
    v_fmac_f32 v96, v18, v127
    v_fmac_f32 v97, v19, v127
    v_lshlrev_b32 v18, 16, v93
    v_and_b32 v19, 0xffff0000, v93
    v_fmac_f32 v98, v18, v127
    v_fmac_f32 v99, v19, v127
    v_lshlrev_b32 v18, 16, v94
    v_and_b32 v19, 0xffff0000, v94
    v_fmac_f32 v100, v18, v127
    v_fmac_f32 v101, v19, v127
    v_lshlrev_b32 v18, 16, v95
    v_and_b32 v19, 0xffff0000, v95
    v_fmac_f32 v102, v18, v127
    v_fmac_f32 v103, v19, v127
    v_lshlrev_b32 v16, 5, v0
    ds_write_b128 v16, v[96:99]
    ds_write_b128 v16, v[100:103] offset:16
    s_waitcnt lgkmcnt(0)
    s_barrier
    s_cmp_lg_u32 s44, 0
    s_cbranch_scc1 L_mod_fin_101
    v_mov_b32 v18, 0
    ds_read_b32 v32, v12 offset:0
    ds_read_b32 v33, v12 offset:256
    ds_read_b32 v34, v12 offset:512
    ds_read_b32 v35, v12 offset:768
    ds_read_b32 v36, v12 offset:1024
    ds_read_b32 v37, v12 offset:1280
    ds_read_b32 v38, v12 offset:1536
    ds_read_b32 v39, v12 offset:1792
    ds_read_b32 v40, v12 offset:2048
    ds_read_b32 v41, v12 offset:2304
    ds_read_b32 v42, v12 offset:2560
    ds_read_b32 v43, v12 offset:2816
    ds_read_b32 v44, v12 offset:3072
    ds_read_b32 v45, v12 offset:3328
    ds_read_b32 v46, v12 offset:3584
    ds_read_b32 v47, v12 offset:3840
    s_waitcnt lgkmcnt(0)
    v_add_f32 v18, v18, v32
    v_add_f32 v18, v18, v33
    v_add_f32 v18, v18, v34
    v_add_f32 v18, v18, v35
    v_add_f32 v18, v18, v36
    v_add_f32 v18, v18, v37
    v_add_f32 v18, v18, v38
    v_add_f32 v18, v18, v39
    v_add_f32 v18, v18, v40
    v_add_f32 v18, v18, v41
    v_add_f32 v18, v18, v42
    v_add_f32 v18, v18, v43
    v_add_f32 v18, v18, v44
    v_add_f32 v18, v18, v45
    v_add_f32 v18, v18, v46
    v_add_f32 v18, v18, v47
    ds_read_b32 v32, v12 offset:4096
    ds_read_b32 v33, v12 offset:4352
    ds_read_b32 v34, v12 offset:4608
    ds_read_b32 v35, v12 offset:4864
    ds_read_b32 v36, v12 offset:5120
    ds_read_b32 v37, v12 offset:5376
    ds_read_b32 v38, v12 offset:5632
    ds_read_b32 v39, v12 offset:5888
    ds_read_b32 v40, v12 offset:6144
    ds_read_b32 v41, v12 offset:6400
    ds_read_b32 v42, v12 offset:6656
    ds_read_b32 v43, v12 offset:6912
    ds_read_b32 v44, v12 offset:7168
    ds_read_b32 v45, v12 offset:7424
    ds_read_b32 v46, v12 offset:7680
    ds_read_b32 v47, v12 offset:7936
    s_waitcnt lgkmcnt(0)
    v_add_f32 v18, v18, v32
    v_add_f32 v18, v18, v33
    v_add_f32 v18, v18, v34
    v_add_f32 v18, v18, v35
    v_add_f32 v18, v18, v36
    v_add_f32 v18, v18, v37
    v_add_f32 v18, v18, v38
    v_add_f32 v18, v18, v39
    v_add_f32 v18, v18, v40
    v_add_f32 v18, v18, v41
    v_add_f32 v18, v18, v42
    v_add_f32 v18, v18, v43
    v_add_f32 v18, v18, v44
    v_add_f32 v18, v18, v45
    v_add_f32 v18, v18, v46
    v_add_f32 v18, v18, v47
    s_lshr_b32 s45, s39, 1
    s_lshl_b32 s45, s45, 8
    s_mul_i32 s46, s47, 24576
    s_add_u32 s45, s45, s46
    buffer_store_dword v18, v12, s[12:15], s45 offen sc1
L_mod_fin_101:
    s_waitcnt vmcnt(0)
    s_barrier
    s_cmp_lg_u32 s44, 0
    s_cbranch_scc1 L_cnt_102
    v_mov_b32 v30, 1
    v_mov_b32 v31, 128
    s_mov_b64 exec, 1
    buffer_atomic_add v30, v31, s[16:19], 0 offen sc1
    s_mov_b64 exec, -1
L_cnt_102:
    v_lshlrev_b32 v192, 16, v128
    v_and_b32 v193, 0xffff0000, v128
    v_lshlrev_b32 v194, 16, v129
    v_and_b32 v195, 0xffff0000, v129
    v_lshlrev_b32 v196, 16, v130
    v_and_b32 v197, 0xffff0000, v130
    v_lshlrev_b32 v198, 16, v131
    v_and_b32 v199, 0xffff0000, v131
    v_lshlrev_b32 v200, 16, v132
    v_and_b32 v201, 0xffff0000, v132
    v_lshlrev_b32 v202, 16, v133
    v_and_b32 v203, 0xffff0000, v133
    v_lshlrev_b32 v204, 16, v134
    v_and_b32 v205, 0xffff0000, v134
    v_lshlrev_b32 v206, 16, v135
    v_and_b32 v207, 0xffff0000, v135
    v_add_f32 v26, v192, v193
    v_add_f32 v26, v26, v194
    v_add_f32 v26, v26, v195
    v_add_f32 v26, v26, v196
    v_add_f32 v26, v26, v197
    v_add_f32 v26, v26, v198
    v_add_f32 v26, v26, v199
    v_add_f32 v26, v26, v200
    v_add_f32 v26, v26, v201
    v_add_f32 v26, v26, v202
    v_add_f32 v26, v26, v203
    v_add_f32 v26, v26, v204
    v_add_f32 v26, v26, v205
    v_add_f32 v26, v26, v206
    v_add_f32 v26, v26, v207
    s_nop 1
    v_add_f32_dpp v26, v26, v26 row_shr:1 row_mask:0xf bank_mask:0xf bound_ctrl:0
    s_nop 1
    v_add_f32_dpp v26, v26, v26 row_shr:2 row_mask:0xf bank_mask:0xf bound_ctrl:0
    s_nop 1
    v_add_f32_dpp v26, v26, v26 row_shr:4 row_mask:0xf bank_mask:0xf bound_ctrl:0
    s_nop 1
    v_add_f32_dpp v26, v26, v26 row_shr:8 row_mask:0xf bank_mask:0xf bound_ctrl:0
    s_nop 1
    v_add_f32_dpp v26, v26, v26 row_bcast:15 row_mask:0xa bank_mask:0xf
    s_nop 1
    v_add_f32_dpp v26, v26, v26 row_bcast:31 row_mask:0xc bank_mask:0xf
    s_nop 1
    v_readlane_b32 s66, v26, 63
    s_nop 1
    v_mov_b32 v27, s66
    v_mul_f32 v27, 0x3a800000, v27
    v_mov_b32 v26, 0
    v_sub_f32 v28, v192, v27
    v_fmac_f32 v26, v28, v28
    v_sub_f32 v28, v193, v27
    v_fmac_f32 v26, v28, v28
    v_sub_f32 v28, v194, v27
    v_fmac_f32 v26, v28, v28
    v_sub_f32 v28, v195, v27
    v_fmac_f32 v26, v28, v28
    v_sub_f32 v28, v196, v27
    v_fmac_f32 v26, v28, v28
    v_sub_f32 v28, v197, v27
    v_fmac_f32 v26, v28, v28
    v_sub_f32 v28, v198, v27
    v_fmac_f32 v26, v28, v28
    v_sub_f32 v28, v199, v27
    v_fmac_f32 v26, v28, v28
    v_sub_f32 v28, v200, v27
    v_fmac_f32 v26, v28, v28
    v_sub_f32 v28, v201, v27
    v_fmac_f32 v26, v28, v28
    v_sub_f32 v28, v202, v27
    v_fmac_f32 v26, v28, v28
    v_sub_f32 v28, v203, v27
    v_fmac_f32 v26, v28, v28
    v_sub_f32 v28, v204, v27
    v_fmac_f32 v26, v28, v28
    v_sub_f32 v28, v205, v27
    v_fmac_f32 v26, v28, v28
    v_sub_f32 v28, v206, v27
    v_fmac_f32 v26, v28, v28
    v_sub_f32 v28, v207, v27
    v_fmac_f32 v26, v28, v28
    s_nop 1
    v_add_f32_dpp v26, v26, v26 row_shr:1 row_mask:0xf bank_mask:0xf bound_ctrl:0
    s_nop 1
    v_add_f32_dpp v26, v26, v26 row_shr:2 row_mask:0xf bank_mask:0xf bound_ctrl:0
    s_nop 1
    v_add_f32_dpp v26, v26, v26 row_shr:4 row_mask:0xf bank_mask:0xf bound_ctrl:0
    s_nop 1
    v_add_f32_dpp v26, v26, v26 row_shr:8 row_mask:0xf bank_mask:0xf bound_ctrl:0
    s_nop 1
    v_add_f32_dpp v26, v26, v26 row_bcast:15 row_mask:0xa bank_mask:0xf
    s_nop 1
    v_add_f32_dpp v26, v26, v26 row_bcast:31 row_mask:0xc bank_mask:0xf
    s_nop 1
    v_readlane_b32 s66, v26, 63
    s_nop 1
    v_mov_b32 v26, s66
    v_mul_f32 v26, 0x3a800000, v26
    v_cvt_pk_bf16_f32 v26, v26, v26
    v_lshlrev_b32 v26, 16, v26
    v_cvt_pk_bf16_f32 v27, v27, v27
    v_lshlrev_b32 v27, 16, v27
    v_add_f32 v26, 0x3727c5ac, v26
    v_cvt_pk_bf16_f32 v26, v26, v26
    v_lshlrev_b32 v26, 16, v26
    v_sqrt_f32 v26, v26
    s_nop 0
    v_cvt_pk_bf16_f32 v26, v26, v26
    v_lshlrev_b32 v26, 16, v26
    v_rcp_f32 v26, v26
    s_nop 0
    v_sub_f32 v192, v192, v27
    v_cvt_pk_bf16_f32 v192, v192, v192
    v_lshlrev_b32 v192, 16, v192
    v_mul_f32 v192, v192, v26
    v_cvt_pk_bf16_f32 v192, v192, v192
    v_lshlrev_b32 v192, 16, v192
    v_sub_f32 v193, v193, v27
    v_cvt_pk_bf16_f32 v193, v193, v193
    v_lshlrev_b32 v193, 16, v193
    v_mul_f32 v193, v193, v26
    v_cvt_pk_bf16_f32 v193, v193, v193
    v_lshlrev_b32 v193, 16, v193
    v_sub_f32 v194, v194, v27
    v_cvt_pk_bf16_f32 v194, v194, v194
    v_lshlrev_b32 v194, 16, v194
    v_mul_f32 v194, v194, v26
    v_cvt_pk_bf16_f32 v194, v194, v194
    v_lshlrev_b32 v194, 16, v194
    v_sub_f32 v195, v195, v27
    v_cvt_pk_bf16_f32 v195, v195, v195
    v_lshlrev_b32 v195, 16, v195
    v_mul_f32 v195, v195, v26
    v_cvt_pk_bf16_f32 v195, v195, v195
    v_lshlrev_b32 v195, 16, v195
    v_sub_f32 v196, v196, v27
    v_cvt_pk_bf16_f32 v196, v196, v196
    v_lshlrev_b32 v196, 16, v196
    v_mul_f32 v196, v196, v26
    v_cvt_pk_bf16_f32 v196, v196, v196
    v_lshlrev_b32 v196, 16, v196
    v_sub_f32 v197, v197, v27
    v_cvt_pk_bf16_f32 v197, v197, v197
    v_lshlrev_b32 v197, 16, v197
    v_mul_f32 v197, v197, v26
    v_cvt_pk_bf16_f32 v197, v197, v197
    v_lshlrev_b32 v197, 16, v197
    v_sub_f32 v198, v198, v27
    v_cvt_pk_bf16_f32 v198, v198, v198
    v_lshlrev_b32 v198, 16, v198
    v_mul_f32 v198, v198, v26
    v_cvt_pk_bf16_f32 v198, v198, v198
    v_lshlrev_b32 v198, 16, v198
    v_sub_f32 v199, v199, v27
    v_cvt_pk_bf16_f32 v199, v199, v199
    v_lshlrev_b32 v199, 16, v199
    v_mul_f32 v199, v199, v26
    v_cvt_pk_bf16_f32 v199, v199, v199
    v_lshlrev_b32 v199, 16, v199
    v_sub_f32 v200, v200, v27
    v_cvt_pk_bf16_f32 v200, v200, v200
    v_lshlrev_b32 v200, 16, v200
    v_mul_f32 v200, v200, v26
    v_cvt_pk_bf16_f32 v200, v200, v200
    v_lshlrev_b32 v200, 16, v200
    v_sub_f32 v201, v201, v27
    v_cvt_pk_bf16_f32 v201, v201, v201
    v_lshlrev_b32 v201, 16, v201
    v_mul_f32 v201, v201, v26
    v_cvt_pk_bf16_f32 v201, v201, v201
    v_lshlrev_b32 v201, 16, v201
    v_sub_f32 v202, v202, v27
    v_cvt_pk_bf16_f32 v202, v202, v202
    v_lshlrev_b32 v202, 16, v202
    v_mul_f32 v202, v202, v26
    v_cvt_pk_bf16_f32 v202, v202, v202
    v_lshlrev_b32 v202, 16, v202
    v_sub_f32 v203, v203, v27
    v_cvt_pk_bf16_f32 v203, v203, v203
    v_lshlrev_b32 v203, 16, v203
    v_mul_f32 v203, v203, v26
    v_cvt_pk_bf16_f32 v203, v203, v203
    v_lshlrev_b32 v203, 16, v203
    v_sub_f32 v204, v204, v27
    v_cvt_pk_bf16_f32 v204, v204, v204
    v_lshlrev_b32 v204, 16, v204
    v_mul_f32 v204, v204, v26
    v_cvt_pk_bf16_f32 v204, v204, v204
    v_lshlrev_b32 v204, 16, v204
    v_sub_f32 v205, v205, v27
    v_cvt_pk_bf16_f32 v205, v205, v205
    v_lshlrev_b32 v205, 16, v205
    v_mul_f32 v205, v205, v26
    v_cvt_pk_bf16_f32 v205, v205, v205
    v_lshlrev_b32 v205, 16, v205
    v_sub_f32 v206, v206, v27
    v_cvt_pk_bf16_f32 v206, v206, v206
    v_lshlrev_b32 v206, 16, v206
    v_mul_f32 v206, v206, v26
    v_cvt_pk_bf16_f32 v206, v206, v206
    v_lshlrev_b32 v206, 16, v206
    v_sub_f32 v207, v207, v27
    v_cvt_pk_bf16_f32 v207, v207, v207
    v_lshlrev_b32 v207, 16, v207
    v_mul_f32 v207, v207, v26
    v_cvt_pk_bf16_f32 v207, v207, v207
    v_lshlrev_b32 v207, 16, v207
    v_lshlrev_b32 v208, 16, v136
    v_and_b32 v209, 0xffff0000, v136
    v_lshlrev_b32 v210, 16, v137
    v_and_b32 v211, 0xffff0000, v137
    v_lshlrev_b32 v212, 16, v138
    v_and_b32 v213, 0xffff0000, v138
    v_lshlrev_b32 v214, 16, v139
    v_and_b32 v215, 0xffff0000, v139
    v_lshlrev_b32 v216, 16, v140
    v_and_b32 v217, 0xffff0000, v140
    v_lshlrev_b32 v218, 16, v141
    v_and_b32 v219, 0xffff0000, v141
    v_lshlrev_b32 v220, 16, v142
    v_and_b32 v221, 0xffff0000, v142
    v_lshlrev_b32 v222, 16, v143
    v_and_b32 v223, 0xffff0000, v143
    v_add_f32 v26, v208, v209
    v_add_f32 v26, v26, v210
    v_add_f32 v26, v26, v211
    v_add_f32 v26, v26, v212
    v_add_f32 v26, v26, v213
    v_add_f32 v26, v26, v214
    v_add_f32 v26, v26, v215
    v_add_f32 v26, v26, v216
    v_add_f32 v26, v26, v217
    v_add_f32 v26, v26, v218
    v_add_f32 v26, v26, v219
    v_add_f32 v26, v26, v220
    v_add_f32 v26, v26, v221
    v_add_f32 v26, v26, v222
    v_add_f32 v26, v26, v223
    s_nop 1
    v_add_f32_dpp v26, v26, v26 row_shr:1 row_mask:0xf bank_mask:0xf bound_ctrl:0
    s_nop 1
    v_add_f32_dpp v26, v26, v26 row_shr:2 row_mask:0xf bank_mask:0xf bound_ctrl:0
    s_nop 1
    v_add_f32_dpp v26, v26, v26 row_shr:4 row_mask:0xf bank_mask:0xf bound_ctrl:0
    s_nop 1
    v_add_f32_dpp v26, v26, v26 row_shr:8 row_mask:0xf bank_mask:0xf bound_ctrl:0
    s_nop 1
    v_add_f32_dpp v26, v26, v26 row_bcast:15 row_mask:0xa bank_mask:0xf
    s_nop 1
    v_add_f32_dpp v26, v26, v26 row_bcast:31 row_mask:0xc bank_mask:0xf
    s_nop 1
    v_readlane_b32 s66, v26, 63
    s_nop 1
    v_mov_b32 v27, s66
    v_mul_f32 v27, 0x3a800000, v27
    v_mov_b32 v26, 0
    v_sub_f32 v28, v208, v27
    v_fmac_f32 v26, v28, v28
    v_sub_f32 v28, v209, v27
    v_fmac_f32 v26, v28, v28
    v_sub_f32 v28, v210, v27
    v_fmac_f32 v26, v28, v28
    v_sub_f32 v28, v211, v27
    v_fmac_f32 v26, v28, v28
    v_sub_f32 v28, v212, v27
    v_fmac_f32 v26, v28, v28
    v_sub_f32 v28, v213, v27
    v_fmac_f32 v26, v28, v28
    v_sub_f32 v28, v214, v27
    v_fmac_f32 v26, v28, v28
    v_sub_f32 v28, v215, v27
    v_fmac_f32 v26, v28, v28
    v_sub_f32 v28, v216, v27
    v_fmac_f32 v26, v28, v28
    v_sub_f32 v28, v217, v27
    v_fmac_f32 v26, v28, v28
    v_sub_f32 v28, v218, v27
    v_fmac_f32 v26, v28, v28
    v_sub_f32 v28, v219, v27
    v_fmac_f32 v26, v28, v28
    v_sub_f32 v28, v220, v27
    v_fmac_f32 v26, v28, v28
    v_sub_f32 v28, v221, v27
    v_fmac_f32 v26, v28, v28
    v_sub_f32 v28, v222, v27
    v_fmac_f32 v26, v28, v28
    v_sub_f32 v28, v223, v27
    v_fmac_f32 v26, v28, v28
    s_nop 1
    v_add_f32_dpp v26, v26, v26 row_shr:1 row_mask:0xf bank_mask:0xf bound_ctrl:0
    s_nop 1
    v_add_f32_dpp v26, v26, v26 row_shr:2 row_mask:0xf bank_mask:0xf bound_ctrl:0
    s_nop 1
    v_add_f32_dpp v26, v26, v26 row_shr:4 row_mask:0xf bank_mask:0xf bound_ctrl:0
    s_nop 1
    v_add_f32_dpp v26, v26, v26 row_shr:8 row_mask:0xf bank_mask:0xf bound_ctrl:0
    s_nop 1
    v_add_f32_dpp v26, v26, v26 row_bcast:15 row_mask:0xa bank_mask:0xf
    s_nop 1
    v_add_f32_dpp v26, v26, v26 row_bcast:31 row_mask:0xc bank_mask:0xf
    s_nop 1
    v_readlane_b32 s66, v26, 63
    s_nop 1
    v_mov_b32 v26, s66
    v_mul_f32 v26, 0x3a800000, v26
    v_cvt_pk_bf16_f32 v26, v26, v26
    v_lshlrev_b32 v26, 16, v26
    v_cvt_pk_bf16_f32 v27, v27, v27
    v_lshlrev_b32 v27, 16, v27
    v_add_f32 v26, 0x3727c5ac, v26
    v_cvt_pk_bf16_f32 v26, v26, v26
    v_lshlrev_b32 v26, 16, v26
    v_sqrt_f32 v26, v26
    s_nop 0
    v_cvt_pk_bf16_f32 v26, v26, v26
    v_lshlrev_b32 v26, 16, v26
    v_rcp_f32 v26, v26
    s_nop 0
    v_sub_f32 v208, v208, v27
    v_cvt_pk_bf16_f32 v208, v208, v208
    v_lshlrev_b32 v208, 16, v208
    v_mul_f32 v208, v208, v26
    v_cvt_pk_bf16_f32 v208, v208, v208
    v_lshlrev_b32 v208, 16, v208
    v_sub_f32 v209, v209, v27
    v_cvt_pk_bf16_f32 v209, v209, v209
    v_lshlrev_b32 v209, 16, v209
    v_mul_f32 v209, v209, v26
    v_cvt_pk_bf16_f32 v209, v209, v209
    v_lshlrev_b32 v209, 16, v209
    v_sub_f32 v210, v210, v27
    v_cvt_pk_bf16_f32 v210, v210, v210
    v_lshlrev_b32 v210, 16, v210
    v_mul_f32 v210, v210, v26
    v_cvt_pk_bf16_f32 v210, v210, v210
    v_lshlrev_b32 v210, 16, v210
    v_sub_f32 v211, v211, v27
    v_cvt_pk_bf16_f32 v211, v211, v211
    v_lshlrev_b32 v211, 16, v211
    v_mul_f32 v211, v211, v26
    v_cvt_pk_bf16_f32 v211, v211, v211
    v_lshlrev_b32 v211, 16, v211
    v_sub_f32 v212, v212, v27
    v_cvt_pk_bf16_f32 v212, v212, v212
    v_lshlrev_b32 v212, 16, v212
    v_mul_f32 v212, v212, v26
    v_cvt_pk_bf16_f32 v212, v212, v212
    v_lshlrev_b32 v212, 16, v212
    v_sub_f32 v213, v213, v27
    v_cvt_pk_bf16_f32 v213, v213, v213
    v_lshlrev_b32 v213, 16, v213
    v_mul_f32 v213, v213, v26
    v_cvt_pk_bf16_f32 v213, v213, v213
    v_lshlrev_b32 v213, 16, v213
    v_sub_f32 v214, v214, v27
    v_cvt_pk_bf16_f32 v214, v214, v214
    v_lshlrev_b32 v214, 16, v214
    v_mul_f32 v214, v214, v26
    v_cvt_pk_bf16_f32 v214, v214, v214
    v_lshlrev_b32 v214, 16, v214
    v_sub_f32 v215, v215, v27
    v_cvt_pk_bf16_f32 v215, v215, v215
    v_lshlrev_b32 v215, 16, v215
    v_mul_f32 v215, v215, v26
    v_cvt_pk_bf16_f32 v215, v215, v215
    v_lshlrev_b32 v215, 16, v215
    v_sub_f32 v216, v216, v27
    v_cvt_pk_bf16_f32 v216, v216, v216
    v_lshlrev_b32 v216, 16, v216
    v_mul_f32 v216, v216, v26
    v_cvt_pk_bf16_f32 v216, v216, v216
    v_lshlrev_b32 v216, 16, v216
    v_sub_f32 v217, v217, v27
    v_cvt_pk_bf16_f32 v217, v217, v217
    v_lshlrev_b32 v217, 16, v217
    v_mul_f32 v217, v217, v26
    v_cvt_pk_bf16_f32 v217, v217, v217
    v_lshlrev_b32 v217, 16, v217
    v_sub_f32 v218, v218, v27
    v_cvt_pk_bf16_f32 v218, v218, v218
    v_lshlrev_b32 v218, 16, v218
    v_mul_f32 v218, v218, v26
    v_cvt_pk_bf16_f32 v218, v218, v218
    v_lshlrev_b32 v218, 16, v218
    v_sub_f32 v219, v219, v27
    v_cvt_pk_bf16_f32 v219, v219, v219
    v_lshlrev_b32 v219, 16, v219
    v_mul_f32 v219, v219, v26
    v_cvt_pk_bf16_f32 v219, v219, v219
    v_lshlrev_b32 v219, 16, v219
    v_sub_f32 v220, v220, v27
    v_cvt_pk_bf16_f32 v220, v220, v220
    v_lshlrev_b32 v220, 16, v220
    v_mul_f32 v220, v220, v26
    v_cvt_pk_bf16_f32 v220, v220, v220
    v_lshlrev_b32 v220, 16, v220
    v_sub_f32 v221, v221, v27
    v_cvt_pk_bf16_f32 v221, v221, v221
    v_lshlrev_b32 v221, 16, v221
    v_mul_f32 v221, v221, v26
    v_cvt_pk_bf16_f32 v221, v221, v221
    v_lshlrev_b32 v221, 16, v221
    v_sub_f32 v222, v222, v27
    v_cvt_pk_bf16_f32 v222, v222, v222
    v_lshlrev_b32 v222, 16, v222
    v_mul_f32 v222, v222, v26
    v_cvt_pk_bf16_f32 v222, v222, v222
    v_lshlrev_b32 v222, 16, v222
    v_sub_f32 v223, v223, v27
    v_cvt_pk_bf16_f32 v223, v223, v223
    v_lshlrev_b32 v223, 16, v223
    v_mul_f32 v223, v223, v26
    v_cvt_pk_bf16_f32 v223, v223, v223
    v_lshlrev_b32 v223, 16, v223
    s_cmp_lg_u32 s44, 0
    s_cbranch_scc1 L_pd_103
    v_mov_b32 v29, 8
    s_mov_b32 s46, 32
    s_mov_b64 exec, 1
    s_mov_b32 s70, 0
L_wp_104:
    buffer_load_dword v31, v29, s[16:19], 0 offen sc1
    s_add_u32 s70, s70, 1
    s_cmp_ge_u32 s70, 0x200000
    s_cbranch_scc1 L_w_done_98
    s_waitcnt vmcnt(0)
    v_cmp_gt_u32 vcc, s46, v31
    s_nop 1
    s_cbranch_vccz L_wp_104_ok
    s_sleep 3
    s_branch L_wp_104
L_wp_104_ok:
    s_mov_b64 exec, -1
L_pd_103:
    s_barrier
    s_cmp_lg_u32 s44, 0
    s_cbranch_scc1 L_pd_105
    v_mov_b32 v29, 128
    s_mov_b32 s46, 96
    s_mov_b64 exec, 1
    s_mov_b32 s70, 0
L_wp_106:
    buffer_load_dword v31, v29, s[16:19], 0 offen sc1
    s_add_u32 s70, s70, 1
    s_cmp_ge_u32 s70, 0x200000
    s_cbranch_scc1 L_w_done_98
    s_waitcnt vmcnt(0)
    v_cmp_gt_u32 vcc, s46, v31
    s_nop 1
    s_cbranch_vccz L_wp_106_ok
    s_sleep 1
    s_branch L_wp_106
L_wp_106_ok:
    s_mov_b64 exec, -1
L_pd_105:
    s_barrier
    v_lshlrev_b32 v29, 5, v1
    s_mov_b32 s45, 0
    buffer_load_dwordx4 v[96:99], v29, s[12:15], s45 offen offset:0 sc1
    buffer_load_dwordx4 v[100:103], v29, s[12:15], s45 offen offset:16 sc1
    buffer_load_dwordx4 v[104:107], v29, s[12:15], s45 offen offset:2048 sc1
    buffer_load_dwordx4 v[108:111], v29, s[12:15], s45 offen offset:2064 sc1
    s_mov_b32 s45, 24576
    buffer_load_dwordx4 v[32:35], v29, s[12:15], s45 offen offset:0 sc1
    buffer_load_dwordx4 v[36:39], v29, s[12:15], s45 offen offset:16 sc1
    buffer_load_dwordx4 v[40:43], v29, s[12:15], s45 offen offset:2048 sc1
    buffer_load_dwordx4 v[44:47], v29, s[12:15], s45 offen offset:2064 sc1
    s_mov_b32 s45, 4096
    buffer_load_dwordx4 v[112:115], v29, s[12:15], s45 offen offset:0 sc1
    buffer_load_dwordx4 v[116:119], v29, s[12:15], s45 offen offset:16 sc1
    buffer_load_dwordx4 v[120:123], v29, s[12:15], s45 offen offset:2048 sc1
    buffer_load_dwordx4 v[124:127], v29, s[12:15], s45 offen offset:2064 sc1
    s_mov_b32 s45, 28672
    buffer_load_dwordx4 v[48:51], v29, s[12:15], s45 offen offset:0 sc1
    buffer_load_dwordx4 v[52:55], v29, s[12:15], s45 offen offset:16 sc1
    buffer_load_dwordx4 v[56:59], v29, s[12:15], s45 offen offset:2048 sc1
    buffer_load_dwordx4 v[60:63], v29, s[12:15], s45 offen offset:2064 sc1
    s_waitcnt vmcnt(0)
    v_add_f32 v96, v96, v32
    v_cvt_pk_bf16_f32 v96, v96, v96
    v_lshlrev_b32 v96, 16, v96
    v_add_f32 v97, v97, v33
    v_cvt_pk_bf16_f32 v97, v97, v97
    v_lshlrev_b32 v97, 16, v97
    v_add_f32 v98, v98, v34
    v_cvt_pk_bf16_f32 v98, v98, v98
    v_lshlrev_b32 v98, 16, v98
    v_add_f32 v99, v99, v35
    v_cvt_pk_bf16_f32 v99, v99, v99
    v_lshlrev_b32 v99, 16, v99
    v_add_f32 v100, v100, v36
    v_cvt_pk_bf16_f32 v100, v100, v100
    v_lshlrev_b32 v100, 16, v100
    v_add_f32 v101, v101, v37
    v_cvt_pk_bf16_f32 v101, v101, v101
    v_lshlrev_b32 v101, 16, v101
    v_add_f32 v102, v102, v38
    v_cvt_pk_bf16_f32 v102, v102, v102
    v_lshlrev_b32 v102, 16, v102
    v_add_f32 v103, v103, v39
    v_cvt_pk_bf16_f32 v103, v103, v103
    v_lshlrev_b32 v103, 16, v103
    v_add_f32 v104, v104, v40
    v_cvt_pk_bf16_f32 v104, v104, v104
    v_lshlrev_b32 v104, 16, v104
    v_add_f32 v105, v105, v41
    v_cvt_pk_bf16_f32 v105, v105, v105
    v_lshlrev_b32 v105, 16, v105
    v_add_f32 v106, v106, v42
    v_cvt_pk_bf16_f32 v106, v106, v106
    v_lshlrev_b32 v106, 16, v106
    v_add_f32 v107, v107, v43
    v_cvt_pk_bf16_f32 v107, v107, v107
    v_lshlrev_b32 v107, 16, v107
    v_add_f32 v108, v108, v44
    v_cvt_pk_bf16_f32 v108, v108, v108
    v_lshlrev_b32 v108, 16, v108
    v_add_f32 v109, v109, v45
    v_cvt_pk_bf16_f32 v109, v109, v109
    v_lshlrev_b32 v109, 16, v109
    v_add_f32 v110, v110, v46
    v_cvt_pk_bf16_f32 v110, v110, v110
    v_lshlrev_b32 v110, 16, v110
    v_add_f32 v111, v111, v47
    v_cvt_pk_bf16_f32 v111, v111, v111
    v_lshlrev_b32 v111, 16, v111
    v_add_f32 v112, v112, v48
    v_cvt_pk_bf16_f32 v112, v112, v112
    v_lshlrev_b32 v112, 16, v112
    v_add_f32 v112, 1.0, v112
    v_cvt_pk_bf16_f32 v112, v112, v112
    v_lshlrev_b32 v112, 16, v112
    v_add_f32 v113, v113, v49
    v_cvt_pk_bf16_f32 v113, v113, v113
    v_lshlrev_b32 v113, 16, v113
    v_add_f32 v113, 1.0, v113
    v_cvt_pk_bf16_f32 v113, v113, v113
    v_lshlrev_b32 v113, 16, v113
    v_add_f32 v114, v114, v50
    v_cvt_pk_bf16_f32 v114, v114, v114
    v_lshlrev_b32 v114, 16, v114
    v_add_f32 v114, 1.0, v114
    v_cvt_pk_bf16_f32 v114, v114, v114
    v_lshlrev_b32 v114, 16, v114
    v_add_f32 v115, v115, v51
    v_cvt_pk_bf16_f32 v115, v115, v115
    v_lshlrev_b32 v115, 16, v115
    v_add_f32 v115, 1.0, v115
    v_cvt_pk_bf16_f32 v115, v115, v115
    v_lshlrev_b32 v115, 16, v115
    v_add_f32 v116, v116, v52
    v_cvt_pk_bf16_f32 v116, v116, v116
    v_lshlrev_b32 v116, 16, v116
    v_add_f32 v116, 1.0, v116
    v_cvt_pk_bf16_f32 v116, v116, v116
    v_lshlrev_b32 v116, 16, v116
    v_add_f32 v117, v117, v53
    v_cvt_pk_bf16_f32 v117, v117, v117
    v_lshlrev_b32 v117, 16, v117
    v_add_f32 v117, 1.0, v117
    v_cvt_pk_bf16_f32 v117, v117, v117
    v_lshlrev_b32 v117, 16, v117
    v_add_f32 v118, v118, v54
    v_cvt_pk_bf16_f32 v118, v118, v118
    v_lshlrev_b32 v118, 16, v118
    v_add_f32 v118, 1.0, v118
    v_cvt_pk_bf16_f32 v118, v118, v118
    v_lshlrev_b32 v118, 16, v118
    v_add_f32 v119, v119, v55
    v_cvt_pk_bf16_f32 v119, v119, v119
    v_lshlrev_b32 v119, 16, v119
    v_add_f32 v119, 1.0, v119
    v_cvt_pk_bf16_f32 v119, v119, v119
    v_lshlrev_b32 v119, 16, v119
    v_add_f32 v120, v120, v56
    v_cvt_pk_bf16_f32 v120, v120, v120
    v_lshlrev_b32 v120, 16, v120
    v_add_f32 v120, 1.0, v120
    v_cvt_pk_bf16_f32 v120, v120, v120
    v_lshlrev_b32 v120, 16, v120
    v_add_f32 v121, v121, v57
    v_cvt_pk_bf16_f32 v121, v121, v121
    v_lshlrev_b32 v121, 16, v121
    v_add_f32 v121, 1.0, v121
    v_cvt_pk_bf16_f32 v121, v121, v121
    v_lshlrev_b32 v121, 16, v121
    v_add_f32 v122, v122, v58
    v_cvt_pk_bf16_f32 v122, v122, v122
    v_lshlrev_b32 v122, 16, v122
    v_add_f32 v122, 1.0, v122
    v_cvt_pk_bf16_f32 v122, v122, v122
    v_lshlrev_b32 v122, 16, v122
    v_add_f32 v123, v123, v59
    v_cvt_pk_bf16_f32 v123, v123, v123
    v_lshlrev_b32 v123, 16, v123
    v_add_f32 v123, 1.0, v123
    v_cvt_pk_bf16_f32 v123, v123, v123
    v_lshlrev_b32 v123, 16, v123
    v_add_f32 v124, v124, v60
    v_cvt_pk_bf16_f32 v124, v124, v124
    v_lshlrev_b32 v124, 16, v124
    v_add_f32 v124, 1.0, v124
    v_cvt_pk_bf16_f32 v124, v124, v124
    v_lshlrev_b32 v124, 16, v124
    v_add_f32 v125, v125, v61
    v_cvt_pk_bf16_f32 v125, v125, v125
    v_lshlrev_b32 v125, 16, v125
    v_add_f32 v125, 1.0, v125
    v_cvt_pk_bf16_f32 v125, v125, v125
    v_lshlrev_b32 v125, 16, v125
    v_add_f32 v126, v126, v62
    v_cvt_pk_bf16_f32 v126, v126, v126
    v_lshlrev_b32 v126, 16, v126
    v_add_f32 v126, 1.0, v126
    v_cvt_pk_bf16_f32 v126, v126, v126
    v_lshlrev_b32 v126, 16, v126
    v_add_f32 v127, v127, v63
    v_cvt_pk_bf16_f32 v127, v127, v127
    v_lshlrev_b32 v127, 16, v127
    v_add_f32 v127, 1.0, v127
    v_cvt_pk_bf16_f32 v127, v127, v127
    v_lshlrev_b32 v127, 16, v127
    v_mul_f32 v192, v192, v112
    v_cvt_pk_bf16_f32 v192, v192, v192
    v_lshlrev_b32 v192, 16, v192
    v_add_f32 v192, v192, v96
    v_mul_f32 v193, v193, v113
    v_cvt_pk_bf16_f32 v193, v193, v193
    v_lshlrev_b32 v193, 16, v193
    v_add_f32 v193, v193, v97
    v_mul_f32 v194, v194, v114
    v_cvt_pk_bf16_f32 v194, v194, v194
    v_lshlrev_b32 v194, 16, v194
    v_add_f32 v194, v194, v98
    v_mul_f32 v195, v195, v115
    v_cvt_pk_bf16_f32 v195, v195, v195
    v_lshlrev_b32 v195, 16, v195
    v_add_f32 v195, v195, v99
    v_mul_f32 v196, v196, v116
    v_cvt_pk_bf16_f32 v196, v196, v196
    v_lshlrev_b32 v196, 16, v196
    v_add_f32 v196, v196, v100
    v_mul_f32 v197, v197, v117
    v_cvt_pk_bf16_f32 v197, v197, v197
    v_lshlrev_b32 v197, 16, v197
    v_add_f32 v197, v197, v101
    v_mul_f32 v198, v198, v118
    v_cvt_pk_bf16_f32 v198, v198, v198
    v_lshlrev_b32 v198, 16, v198
    v_add_f32 v198, v198, v102
    v_mul_f32 v199, v199, v119
    v_cvt_pk_bf16_f32 v199, v199, v199
    v_lshlrev_b32 v199, 16, v199
    v_add_f32 v199, v199, v103
    v_mul_f32 v200, v200, v120
    v_cvt_pk_bf16_f32 v200, v200, v200
    v_lshlrev_b32 v200, 16, v200
    v_add_f32 v200, v200, v104
    v_mul_f32 v201, v201, v121
    v_cvt_pk_bf16_f32 v201, v201, v201
    v_lshlrev_b32 v201, 16, v201
    v_add_f32 v201, v201, v105
    v_mul_f32 v202, v202, v122
    v_cvt_pk_bf16_f32 v202, v202, v202
    v_lshlrev_b32 v202, 16, v202
    v_add_f32 v202, v202, v106
    v_mul_f32 v203, v203, v123
    v_cvt_pk_bf16_f32 v203, v203, v203
    v_lshlrev_b32 v203, 16, v203
    v_add_f32 v203, v203, v107
    v_mul_f32 v204, v204, v124
    v_cvt_pk_bf16_f32 v204, v204, v204
    v_lshlrev_b32 v204, 16, v204
    v_add_f32 v204, v204, v108
    v_mul_f32 v205, v205, v125
    v_cvt_pk_bf16_f32 v205, v205, v205
    v_lshlrev_b32 v205, 16, v205
    v_add_f32 v205, v205, v109
    v_mul_f32 v206, v206, v126
    v_cvt_pk_bf16_f32 v206, v206, v206
    v_lshlrev_b32 v206, 16, v206
    v_add_f32 v206, v206, v110
    v_mul_f32 v207, v207, v127
    v_cvt_pk_bf16_f32 v207, v207, v207
    v_lshlrev_b32 v207, 16, v207
    v_add_f32 v207, v207, v111
    v_cvt_pk_bf16_f32 v80, v192, v193
    v_cvt_pk_bf16_f32 v81, v194, v195
    v_cvt_pk_bf16_f32 v82, v196, v197
    v_cvt_pk_bf16_f32 v83, v198, v199
    v_cvt_pk_bf16_f32 v84, v200, v201
    v_cvt_pk_bf16_f32 v85, v202, v203
    v_cvt_pk_bf16_f32 v86, v204, v205
    v_cvt_pk_bf16_f32 v87, v206, v207
    s_lshr_b32 s45, s63, 5
    s_lshl_b32 s45, s45, 16
    s_and_b32 s46, s63, 31
    s_lshl_b32 s46, s46, 8
    s_add_u32 s45, s45, s46
    s_add_u32 s45, s45, 0x400000
    s_add_u32 s46, s45, 32768
    buffer_store_dwordx4 v[80:83], v2, s[12:15], s45 offen sc1
    buffer_store_dwordx4 v[84:87], v2, s[12:15], s46 offen sc1
    s_add_u32 s63, s63, 384
    v_mul_f32 v208, v208, v112
    v_cvt_pk_bf16_f32 v208, v208, v208
    v_lshlrev_b32 v208, 16, v208
    v_add_f32 v208, v208, v96
    v_mul_f32 v209, v209, v113
    v_cvt_pk_bf16_f32 v209, v209, v209
    v_lshlrev_b32 v209, 16, v209
    v_add_f32 v209, v209, v97
    v_mul_f32 v210, v210, v114
    v_cvt_pk_bf16_f32 v210, v210, v210
    v_lshlrev_b32 v210, 16, v210
    v_add_f32 v210, v210, v98
    v_mul_f32 v211, v211, v115
    v_cvt_pk_bf16_f32 v211, v211, v211
    v_lshlrev_b32 v211, 16, v211
    v_add_f32 v211, v211, v99
    v_mul_f32 v212, v212, v116
    v_cvt_pk_bf16_f32 v212, v212, v212
    v_lshlrev_b32 v212, 16, v212
    v_add_f32 v212, v212, v100
    v_mul_f32 v213, v213, v117
    v_cvt_pk_bf16_f32 v213, v213, v213
    v_lshlrev_b32 v213, 16, v213
    v_add_f32 v213, v213, v101
    v_mul_f32 v214, v214, v118
    v_cvt_pk_bf16_f32 v214, v214, v214
    v_lshlrev_b32 v214, 16, v214
    v_add_f32 v214, v214, v102
    v_mul_f32 v215, v215, v119
    v_cvt_pk_bf16_f32 v215, v215, v215
    v_lshlrev_b32 v215, 16, v215
    v_add_f32 v215, v215, v103
    v_mul_f32 v216, v216, v120
    v_cvt_pk_bf16_f32 v216, v216, v216
    v_lshlrev_b32 v216, 16, v216
    v_add_f32 v216, v216, v104
    v_mul_f32 v217, v217, v121
    v_cvt_pk_bf16_f32 v217, v217, v217
    v_lshlrev_b32 v217, 16, v217
    v_add_f32 v217, v217, v105
    v_mul_f32 v218, v218, v122
    v_cvt_pk_bf16_f32 v218, v218, v218
    v_lshlrev_b32 v218, 16, v218
    v_add_f32 v218, v218, v106
    v_mul_f32 v219, v219, v123
    v_cvt_pk_bf16_f32 v219, v219, v219
    v_lshlrev_b32 v219, 16, v219
    v_add_f32 v219, v219, v107
    v_mul_f32 v220, v220, v124
    v_cvt_pk_bf16_f32 v220, v220, v220
    v_lshlrev_b32 v220, 16, v220
    v_add_f32 v220, v220, v108
    v_mul_f32 v221, v221, v125
    v_cvt_pk_bf16_f32 v221, v221, v221
    v_lshlrev_b32 v221, 16, v221
    v_add_f32 v221, v221, v109
    v_mul_f32 v222, v222, v126
    v_cvt_pk_bf16_f32 v222, v222, v222
    v_lshlrev_b32 v222, 16, v222
    v_add_f32 v222, v222, v110
    v_mul_f32 v223, v223, v127
    v_cvt_pk_bf16_f32 v223, v223, v223
    v_lshlrev_b32 v223, 16, v223
    v_add_f32 v223, v223, v111
    v_cvt_pk_bf16_f32 v88, v208, v209
    v_cvt_pk_bf16_f32 v89, v210, v211
    v_cvt_pk_bf16_f32 v90, v212, v213
    v_cvt_pk_bf16_f32 v91, v214, v215
    v_cvt_pk_bf16_f32 v92, v216, v217
    v_cvt_pk_bf16_f32 v93, v218, v219
    v_cvt_pk_bf16_f32 v94, v220, v221
    v_cvt_pk_bf16_f32 v95, v222, v223
    s_lshr_b32 s45, s63, 5
    s_lshl_b32 s45, s45, 16
    s_and_b32 s46, s63, 31
    s_lshl_b32 s46, s46, 8
    s_add_u32 s45, s45, s46
    s_add_u32 s45, s45, 0x400000
    s_add_u32 s46, s45, 32768
    buffer_store_dwordx4 v[88:91], v2, s[12:15], s45 offen sc1
    buffer_store_dwordx4 v[92:95], v2, s[12:15], s46 offen sc1
    s_waitcnt vmcnt(2)
    s_barrier
    s_cmp_lg_u32 s44, 0
    s_cbranch_scc1 L_cnt_108
    v_mov_b32 v30, 1
    v_mov_b32 v31, 126976
    s_mov_b64 exec, 1
    buffer_atomic_add v30, v31, s[12:15], 0 offen sc1
    s_mov_b64 exec, -1
L_cnt_108:
    s_add_u32 s63, s63, 384
    v_lshlrev_b32 v64, 16, v144
    v_and_b32 v65, 0xffff0000, v144
    v_lshlrev_b32 v66, 16, v145
    v_and_b32 v67, 0xffff0000, v145
    v_lshlrev_b32 v68, 16, v146
    v_and_b32 v69, 0xffff0000, v146
    v_lshlrev_b32 v70, 16, v147
    v_and_b32 v71, 0xffff0000, v147
    v_lshlrev_b32 v72, 16, v148
    v_and_b32 v73, 0xffff0000, v148
    v_lshlrev_b32 v74, 16, v149
    v_and_b32 v75, 0xffff0000, v149
    v_lshlrev_b32 v76, 16, v150
    v_and_b32 v77, 0xffff0000, v150
    v_lshlrev_b32 v78, 16, v151
    v_and_b32 v79, 0xffff0000, v151
    v_add_f32 v26, v64, v65
    v_add_f32 v26, v26, v66
    v_add_f32 v26, v26, v67
    v_add_f32 v26, v26, v68
    v_add_f32 v26, v26, v69
    v_add_f32 v26, v26, v70
    v_add_f32 v26, v26, v71
    v_add_f32 v26, v26, v72
    v_add_f32 v26, v26, v73
    v_add_f32 v26, v26, v74
    v_add_f32 v26, v26, v75
    v_add_f32 v26, v26, v76
    v_add_f32 v26, v26, v77
    v_add_f32 v26, v26, v78
    v_add_f32 v26, v26, v79
    s_nop 1
    v_add_f32_dpp v26, v26, v26 row_shr:1 row_mask:0xf bank_mask:0xf bound_ctrl:0
    s_nop 1
    v_add_f32_dpp v26, v26, v26 row_shr:2 row_mask:0xf bank_mask:0xf bound_ctrl:0
    s_nop 1
    v_add_f32_dpp v26, v26, v26 row_shr:4 row_mask:0xf bank_mask:0xf bound_ctrl:0
    s_nop 1
    v_add_f32_dpp v26, v26, v26 row_shr:8 row_mask:0xf bank_mask:0xf bound_ctrl:0
    s_nop 1
    v_add_f32_dpp v26, v26, v26 row_bcast:15 row_mask:0xa bank_mask:0xf
    s_nop 1
    v_add_f32_dpp v26, v26, v26 row_bcast:31 row_mask:0xc bank_mask:0xf
    s_nop 1
    v_readlane_b32 s66, v26, 63
    s_nop 1
    v_mov_b32 v27, s66
    v_mul_f32 v27, 0x3a800000, v27
    v_mov_b32 v26, 0
    v_sub_f32 v28, v64, v27
    v_fmac_f32 v26, v28, v28
    v_sub_f32 v28, v65, v27
    v_fmac_f32 v26, v28, v28
    v_sub_f32 v28, v66, v27
    v_fmac_f32 v26, v28, v28
    v_sub_f32 v28, v67, v27
    v_fmac_f32 v26, v28, v28
    v_sub_f32 v28, v68, v27
    v_fmac_f32 v26, v28, v28
    v_sub_f32 v28, v69, v27
    v_fmac_f32 v26, v28, v28
    v_sub_f32 v28, v70, v27
    v_fmac_f32 v26, v28, v28
    v_sub_f32 v28, v71, v27
    v_fmac_f32 v26, v28, v28
    v_sub_f32 v28, v72, v27
    v_fmac_f32 v26, v28, v28
    v_sub_f32 v28, v73, v27
    v_fmac_f32 v26, v28, v28
    v_sub_f32 v28, v74, v27
    v_fmac_f32 v26, v28, v28
    v_sub_f32 v28, v75, v27
    v_fmac_f32 v26, v28, v28
    v_sub_f32 v28, v76, v27
    v_fmac_f32 v26, v28, v28
    v_sub_f32 v28, v77, v27
    v_fmac_f32 v26, v28, v28
    v_sub_f32 v28, v78, v27
    v_fmac_f32 v26, v28, v28
    v_sub_f32 v28, v79, v27
    v_fmac_f32 v26, v28, v28
    s_nop 1
    v_add_f32_dpp v26, v26, v26 row_shr:1 row_mask:0xf bank_mask:0xf bound_ctrl:0
    s_nop 1
    v_add_f32_dpp v26, v26, v26 row_shr:2 row_mask:0xf bank_mask:0xf bound_ctrl:0
    s_nop 1
    v_add_f32_dpp v26, v26, v26 row_shr:4 row_mask:0xf bank_mask:0xf bound_ctrl:0
    s_nop 1
    v_add_f32_dpp v26, v26, v26 row_shr:8 row_mask:0xf bank_mask:0xf bound_ctrl:0
    s_nop 1
    v_add_f32_dpp v26, v26, v26 row_bcast:15 row_mask:0xa bank_mask:0xf
    s_nop 1
    v_add_f32_dpp v26, v26, v26 row_bcast:31 row_mask:0xc bank_mask:0xf
    s_nop 1
    v_readlane_b32 s66, v26, 63
    s_nop 1
    v_mov_b32 v26, s66
    v_mul_f32 v26, 0x3a800000, v26
    v_cvt_pk_bf16_f32 v26, v26, v26
    v_lshlrev_b32 v26, 16, v26
    v_cvt_pk_bf16_f32 v27, v27, v27
    v_lshlrev_b32 v27, 16, v27
    v_add_f32 v26, 0x3727c5ac, v26
    v_cvt_pk_bf16_f32 v26, v26, v26
    v_lshlrev_b32 v26, 16, v26
    v_sqrt_f32 v26, v26
    s_nop 0
    v_cvt_pk_bf16_f32 v26, v26, v26
    v_lshlrev_b32 v26, 16, v26
    v_rcp_f32 v26, v26
    s_nop 0
    v_sub_f32 v64, v64, v27
    v_cvt_pk_bf16_f32 v64, v64, v64
    v_lshlrev_b32 v64, 16, v64
    v_mul_f32 v64, v64, v26
    v_cvt_pk_bf16_f32 v64, v64, v64
    v_lshlrev_b32 v64, 16, v64
    v_sub_f32 v65, v65, v27
    v_cvt_pk_bf16_f32 v65, v65, v65
    v_lshlrev_b32 v65, 16, v65
    v_mul_f32 v65, v65, v26
    v_cvt_pk_bf16_f32 v65, v65, v65
    v_lshlrev_b32 v65, 16, v65
    v_sub_f32 v66, v66, v27
    v_cvt_pk_bf16_f32 v66, v66, v66
    v_lshlrev_b32 v66, 16, v66
    v_mul_f32 v66, v66, v26
    v_cvt_pk_bf16_f32 v66, v66, v66
    v_lshlrev_b32 v66, 16, v66
    v_sub_f32 v67, v67, v27
    v_cvt_pk_bf16_f32 v67, v67, v67
    v_lshlrev_b32 v67, 16, v67
    v_mul_f32 v67, v67, v26
    v_cvt_pk_bf16_f32 v67, v67, v67
    v_lshlrev_b32 v67, 16, v67
    v_sub_f32 v68, v68, v27
    v_cvt_pk_bf16_f32 v68, v68, v68
    v_lshlrev_b32 v68, 16, v68
    v_mul_f32 v68, v68, v26
    v_cvt_pk_bf16_f32 v68, v68, v68
    v_lshlrev_b32 v68, 16, v68
    v_sub_f32 v69, v69, v27
    v_cvt_pk_bf16_f32 v69, v69, v69
    v_lshlrev_b32 v69, 16, v69
    v_mul_f32 v69, v69, v26
    v_cvt_pk_bf16_f32 v69, v69, v69
    v_lshlrev_b32 v69, 16, v69
    v_sub_f32 v70, v70, v27
    v_cvt_pk_bf16_f32 v70, v70, v70
    v_lshlrev_b32 v70, 16, v70
    v_mul_f32 v70, v70, v26
    v_cvt_pk_bf16_f32 v70, v70, v70
    v_lshlrev_b32 v70, 16, v70
    v_sub_f32 v71, v71, v27
    v_cvt_pk_bf16_f32 v71, v71, v71
    v_lshlrev_b32 v71, 16, v71
    v_mul_f32 v71, v71, v26
    v_cvt_pk_bf16_f32 v71, v71, v71
    v_lshlrev_b32 v71, 16, v71
    v_sub_f32 v72, v72, v27
    v_cvt_pk_bf16_f32 v72, v72, v72
    v_lshlrev_b32 v72, 16, v72
    v_mul_f32 v72, v72, v26
    v_cvt_pk_bf16_f32 v72, v72, v72
    v_lshlrev_b32 v72, 16, v72
    v_sub_f32 v73, v73, v27
    v_cvt_pk_bf16_f32 v73, v73, v73
    v_lshlrev_b32 v73, 16, v73
    v_mul_f32 v73, v73, v26
    v_cvt_pk_bf16_f32 v73, v73, v73
    v_lshlrev_b32 v73, 16, v73
    v_sub_f32 v74, v74, v27
    v_cvt_pk_bf16_f32 v74, v74, v74
    v_lshlrev_b32 v74, 16, v74
    v_mul_f32 v74, v74, v26
    v_cvt_pk_bf16_f32 v74, v74, v74
    v_lshlrev_b32 v74, 16, v74
    v_sub_f32 v75, v75, v27
    v_cvt_pk_bf16_f32 v75, v75, v75
    v_lshlrev_b32 v75, 16, v75
    v_mul_f32 v75, v75, v26
    v_cvt_pk_bf16_f32 v75, v75, v75
    v_lshlrev_b32 v75, 16, v75
    v_sub_f32 v76, v76, v27
    v_cvt_pk_bf16_f32 v76, v76, v76
    v_lshlrev_b32 v76, 16, v76
    v_mul_f32 v76, v76, v26
    v_cvt_pk_bf16_f32 v76, v76, v76
    v_lshlrev_b32 v76, 16, v76
    v_sub_f32 v77, v77, v27
    v_cvt_pk_bf16_f32 v77, v77, v77
    v_lshlrev_b32 v77, 16, v77
    v_mul_f32 v77, v77, v26
    v_cvt_pk_bf16_f32 v77, v77, v77
    v_lshlrev_b32 v77, 16, v77
    v_sub_f32 v78, v78, v27
    v_cvt_pk_bf16_f32 v78, v78, v78
    v_lshlrev_b32 v78, 16, v78
    v_mul_f32 v78, v78, v26
    v_cvt_pk_bf16_f32 v78, v78, v78
    v_lshlrev_b32 v78, 16, v78
    v_sub_f32 v79, v79, v27
    v_cvt_pk_bf16_f32 v79, v79, v79
    v_lshlrev_b32 v79, 16, v79
    v_mul_f32 v79, v79, v26
    v_cvt_pk_bf16_f32 v79, v79, v79
    v_lshlrev_b32 v79, 16, v79
    v_mul_f32 v64, v64, v112
    v_cvt_pk_bf16_f32 v64, v64, v64
    v_lshlrev_b32 v64, 16, v64
    v_add_f32 v64, v64, v96
    v_mul_f32 v65, v65, v113
    v_cvt_pk_bf16_f32 v65, v65, v65
    v_lshlrev_b32 v65, 16, v65
    v_add_f32 v65, v65, v97
    v_mul_f32 v66, v66, v114
    v_cvt_pk_bf16_f32 v66, v66, v66
    v_lshlrev_b32 v66, 16, v66
    v_add_f32 v66, v66, v98
    v_mul_f32 v67, v67, v115
    v_cvt_pk_bf16_f32 v67, v67, v67
    v_lshlrev_b32 v67, 16, v67
    v_add_f32 v67, v67, v99
    v_mul_f32 v68, v68, v116
    v_cvt_pk_bf16_f32 v68, v68, v68
    v_lshlrev_b32 v68, 16, v68
    v_add_f32 v68, v68, v100
    v_mul_f32 v69, v69, v117
    v_cvt_pk_bf16_f32 v69, v69, v69
    v_lshlrev_b32 v69, 16, v69
    v_add_f32 v69, v69, v101
    v_mul_f32 v70, v70, v118
    v_cvt_pk_bf16_f32 v70, v70, v70
    v_lshlrev_b32 v70, 16, v70
    v_add_f32 v70, v70, v102
    v_mul_f32 v71, v71, v119
    v_cvt_pk_bf16_f32 v71, v71, v71
    v_lshlrev_b32 v71, 16, v71
    v_add_f32 v71, v71, v103
    v_mul_f32 v72, v72, v120
    v_cvt_pk_bf16_f32 v72, v72, v72
    v_lshlrev_b32 v72, 16, v72
    v_add_f32 v72, v72, v104
    v_mul_f32 v73, v73, v121
    v_cvt_pk_bf16_f32 v73, v73, v73
    v_lshlrev_b32 v73, 16, v73
    v_add_f32 v73, v73, v105
    v_mul_f32 v74, v74, v122
    v_cvt_pk_bf16_f32 v74, v74, v74
    v_lshlrev_b32 v74, 16, v74
    v_add_f32 v74, v74, v106
    v_mul_f32 v75, v75, v123
    v_cvt_pk_bf16_f32 v75, v75, v75
    v_lshlrev_b32 v75, 16, v75
    v_add_f32 v75, v75, v107
    v_mul_f32 v76, v76, v124
    v_cvt_pk_bf16_f32 v76, v76, v76
    v_lshlrev_b32 v76, 16, v76
    v_add_f32 v76, v76, v108
    v_mul_f32 v77, v77, v125
    v_cvt_pk_bf16_f32 v77, v77, v77
    v_lshlrev_b32 v77, 16, v77
    v_add_f32 v77, v77, v109
    v_mul_f32 v78, v78, v126
    v_cvt_pk_bf16_f32 v78, v78, v78
    v_lshlrev_b32 v78, 16, v78
    v_add_f32 v78, v78, v110
    v_mul_f32 v79, v79, v127
    v_cvt_pk_bf16_f32 v79, v79, v79
    v_lshlrev_b32 v79, 16, v79
    v_add_f32 v79, v79, v111
    v_cvt_pk_bf16_f32 v80, v64, v65
    v_cvt_pk_bf16_f32 v81, v66, v67
    v_cvt_pk_bf16_f32 v82, v68, v69
    v_cvt_pk_bf16_f32 v83, v70, v71
    v_cvt_pk_bf16_f32 v84, v72, v73
    v_cvt_pk_bf16_f32 v85, v74, v75
    v_cvt_pk_bf16_f32 v86, v76, v77
    v_cvt_pk_bf16_f32 v87, v78, v79
    s_lshr_b32 s45, s63, 5
    s_lshl_b32 s45, s45, 16
    s_and_b32 s46, s63, 31
    s_lshl_b32 s46, s46, 8
    s_add_u32 s45, s45, s46
    s_add_u32 s45, s45, 0x400000
    s_add_u32 s46, s45, 32768
    buffer_store_dwordx4 v[80:83], v2, s[12:15], s45 offen sc1
    buffer_store_dwordx4 v[84:87], v2, s[12:15], s46 offen sc1
    s_add_u32 s63, s63, 384
    v_lshlrev_b32 v64, 16, v152
    v_and_b32 v65, 0xffff0000, v152
    v_lshlrev_b32 v66, 16, v153
    v_and_b32 v67, 0xffff0000, v153
    v_lshlrev_b32 v68, 16, v154
    v_and_b32 v69, 0xffff0000, v154
    v_lshlrev_b32 v70, 16, v155
    v_and_b32 v71, 0xffff0000, v155
    v_lshlrev_b32 v72, 16, v156
    v_and_b32 v73, 0xffff0000, v156
    v_lshlrev_b32 v74, 16, v157
    v_and_b32 v75, 0xffff0000, v157
    v_lshlrev_b32 v76, 16, v158
    v_and_b32 v77, 0xffff0000, v158
    v_lshlrev_b32 v78, 16, v159
    v_and_b32 v79, 0xffff0000, v159
    v_add_f32 v26, v64, v65
    v_add_f32 v26, v26, v66
    v_add_f32 v26, v26, v67
    v_add_f32 v26, v26, v68
    v_add_f32 v26, v26, v69
    v_add_f32 v26, v26, v70
    v_add_f32 v26, v26, v71
    v_add_f32 v26, v26, v72
    v_add_f32 v26, v26, v73
    v_add_f32 v26, v26, v74
    v_add_f32 v26, v26, v75
    v_add_f32 v26, v26, v76
    v_add_f32 v26, v26, v77
    v_add_f32 v26, v26, v78
    v_add_f32 v26, v26, v79
    s_nop 1
    v_add_f32_dpp v26, v26, v26 row_shr:1 row_mask:0xf bank_mask:0xf bound_ctrl:0
    s_nop 1
    v_add_f32_dpp v26, v26, v26 row_shr:2 row_mask:0xf bank_mask:0xf bound_ctrl:0
    s_nop 1
    v_add_f32_dpp v26, v26, v26 row_shr:4 row_mask:0xf bank_mask:0xf bound_ctrl:0
    s_nop 1
    v_add_f32_dpp v26, v26, v26 row_shr:8 row_mask:0xf bank_mask:0xf bound_ctrl:0
    s_nop 1
    v_add_f32_dpp v26, v26, v26 row_bcast:15 row_mask:0xa bank_mask:0xf
    s_nop 1
    v_add_f32_dpp v26, v26, v26 row_bcast:31 row_mask:0xc bank_mask:0xf
    s_nop 1
    v_readlane_b32 s66, v26, 63
    s_nop 1
    v_mov_b32 v27, s66
    v_mul_f32 v27, 0x3a800000, v27
    v_mov_b32 v26, 0
    v_sub_f32 v28, v64, v27
    v_fmac_f32 v26, v28, v28
    v_sub_f32 v28, v65, v27
    v_fmac_f32 v26, v28, v28
    v_sub_f32 v28, v66, v27
    v_fmac_f32 v26, v28, v28
    v_sub_f32 v28, v67, v27
    v_fmac_f32 v26, v28, v28
    v_sub_f32 v28, v68, v27
    v_fmac_f32 v26, v28, v28
    v_sub_f32 v28, v69, v27
    v_fmac_f32 v26, v28, v28
    v_sub_f32 v28, v70, v27
    v_fmac_f32 v26, v28, v28
    v_sub_f32 v28, v71, v27
    v_fmac_f32 v26, v28, v28
    v_sub_f32 v28, v72, v27
    v_fmac_f32 v26, v28, v28
    v_sub_f32 v28, v73, v27
    v_fmac_f32 v26, v28, v28
    v_sub_f32 v28, v74, v27
    v_fmac_f32 v26, v28, v28
    v_sub_f32 v28, v75, v27
    v_fmac_f32 v26, v28, v28
    v_sub_f32 v28, v76, v27
    v_fmac_f32 v26, v28, v28
    v_sub_f32 v28, v77, v27
    v_fmac_f32 v26, v28, v28
    v_sub_f32 v28, v78, v27
    v_fmac_f32 v26, v28, v28
    v_sub_f32 v28, v79, v27
    v_fmac_f32 v26, v28, v28
    s_nop 1
    v_add_f32_dpp v26, v26, v26 row_shr:1 row_mask:0xf bank_mask:0xf bound_ctrl:0
    s_nop 1
    v_add_f32_dpp v26, v26, v26 row_shr:2 row_mask:0xf bank_mask:0xf bound_ctrl:0
    s_nop 1
    v_add_f32_dpp v26, v26, v26 row_shr:4 row_mask:0xf bank_mask:0xf bound_ctrl:0
    s_nop 1
    v_add_f32_dpp v26, v26, v26 row_shr:8 row_mask:0xf bank_mask:0xf bound_ctrl:0
    s_nop 1
    v_add_f32_dpp v26, v26, v26 row_bcast:15 row_mask:0xa bank_mask:0xf
    s_nop 1
    v_add_f32_dpp v26, v26, v26 row_bcast:31 row_mask:0xc bank_mask:0xf
    s_nop 1
    v_readlane_b32 s66, v26, 63
    s_nop 1
    v_mov_b32 v26, s66
    v_mul_f32 v26, 0x3a800000, v26
    v_cvt_pk_bf16_f32 v26, v26, v26
    v_lshlrev_b32 v26, 16, v26
    v_cvt_pk_bf16_f32 v27, v27, v27
    v_lshlrev_b32 v27, 16, v27
    v_add_f32 v26, 0x3727c5ac, v26
    v_cvt_pk_bf16_f32 v26, v26, v26
    v_lshlrev_b32 v26, 16, v26
    v_sqrt_f32 v26, v26
    s_nop 0
    v_cvt_pk_bf16_f32 v26, v26, v26
    v_lshlrev_b32 v26, 16, v26
    v_rcp_f32 v26, v26
    s_nop 0
    v_sub_f32 v64, v64, v27
    v_cvt_pk_bf16_f32 v64, v64, v64
    v_lshlrev_b32 v64, 16, v64
    v_mul_f32 v64, v64, v26
    v_cvt_pk_bf16_f32 v64, v64, v64
    v_lshlrev_b32 v64, 16, v64
    v_sub_f32 v65, v65, v27
    v_cvt_pk_bf16_f32 v65, v65, v65
    v_lshlrev_b32 v65, 16, v65
    v_mul_f32 v65, v65, v26
    v_cvt_pk_bf16_f32 v65, v65, v65
    v_lshlrev_b32 v65, 16, v65
    v_sub_f32 v66, v66, v27
    v_cvt_pk_bf16_f32 v66, v66, v66
    v_lshlrev_b32 v66, 16, v66
    v_mul_f32 v66, v66, v26
    v_cvt_pk_bf16_f32 v66, v66, v66
    v_lshlrev_b32 v66, 16, v66
    v_sub_f32 v67, v67, v27
    v_cvt_pk_bf16_f32 v67, v67, v67
    v_lshlrev_b32 v67, 16, v67
    v_mul_f32 v67, v67, v26
    v_cvt_pk_bf16_f32 v67, v67, v67
    v_lshlrev_b32 v67, 16, v67
    v_sub_f32 v68, v68, v27
    v_cvt_pk_bf16_f32 v68, v68, v68
    v_lshlrev_b32 v68, 16, v68
    v_mul_f32 v68, v68, v26
    v_cvt_pk_bf16_f32 v68, v68, v68
    v_lshlrev_b32 v68, 16, v68
    v_sub_f32 v69, v69, v27
    v_cvt_pk_bf16_f32 v69, v69, v69
    v_lshlrev_b32 v69, 16, v69
    v_mul_f32 v69, v69, v26
    v_cvt_pk_bf16_f32 v69, v69, v69
    v_lshlrev_b32 v69, 16, v69
    v_sub_f32 v70, v70, v27
    v_cvt_pk_bf16_f32 v70, v70, v70
    v_lshlrev_b32 v70, 16, v70
    v_mul_f32 v70, v70, v26
    v_cvt_pk_bf16_f32 v70, v70, v70
    v_lshlrev_b32 v70, 16, v70
    v_sub_f32 v71, v71, v27
    v_cvt_pk_bf16_f32 v71, v71, v71
    v_lshlrev_b32 v71, 16, v71
    v_mul_f32 v71, v71, v26
    v_cvt_pk_bf16_f32 v71, v71, v71
    v_lshlrev_b32 v71, 16, v71
    v_sub_f32 v72, v72, v27
    v_cvt_pk_bf16_f32 v72, v72, v72
    v_lshlrev_b32 v72, 16, v72
    v_mul_f32 v72, v72, v26
    v_cvt_pk_bf16_f32 v72, v72, v72
    v_lshlrev_b32 v72, 16, v72
    v_sub_f32 v73, v73, v27
    v_cvt_pk_bf16_f32 v73, v73, v73
    v_lshlrev_b32 v73, 16, v73
    v_mul_f32 v73, v73, v26
    v_cvt_pk_bf16_f32 v73, v73, v73
    v_lshlrev_b32 v73, 16, v73
    v_sub_f32 v74, v74, v27
    v_cvt_pk_bf16_f32 v74, v74, v74
    v_lshlrev_b32 v74, 16, v74
    v_mul_f32 v74, v74, v26
    v_cvt_pk_bf16_f32 v74, v74, v74
    v_lshlrev_b32 v74, 16, v74
    v_sub_f32 v75, v75, v27
    v_cvt_pk_bf16_f32 v75, v75, v75
    v_lshlrev_b32 v75, 16, v75
    v_mul_f32 v75, v75, v26
    v_cvt_pk_bf16_f32 v75, v75, v75
    v_lshlrev_b32 v75, 16, v75
    v_sub_f32 v76, v76, v27
    v_cvt_pk_bf16_f32 v76, v76, v76
    v_lshlrev_b32 v76, 16, v76
    v_mul_f32 v76, v76, v26
    v_cvt_pk_bf16_f32 v76, v76, v76
    v_lshlrev_b32 v76, 16, v76
    v_sub_f32 v77, v77, v27
    v_cvt_pk_bf16_f32 v77, v77, v77
    v_lshlrev_b32 v77, 16, v77
    v_mul_f32 v77, v77, v26
    v_cvt_pk_bf16_f32 v77, v77, v77
    v_lshlrev_b32 v77, 16, v77
    v_sub_f32 v78, v78, v27
    v_cvt_pk_bf16_f32 v78, v78, v78
    v_lshlrev_b32 v78, 16, v78
    v_mul_f32 v78, v78, v26
    v_cvt_pk_bf16_f32 v78, v78, v78
    v_lshlrev_b32 v78, 16, v78
    v_sub_f32 v79, v79, v27
    v_cvt_pk_bf16_f32 v79, v79, v79
    v_lshlrev_b32 v79, 16, v79
    v_mul_f32 v79, v79, v26
    v_cvt_pk_bf16_f32 v79, v79, v79
    v_lshlrev_b32 v79, 16, v79
    v_mul_f32 v64, v64, v112
    v_cvt_pk_bf16_f32 v64, v64, v64
    v_lshlrev_b32 v64, 16, v64
    v_add_f32 v64, v64, v96
    v_mul_f32 v65, v65, v113
    v_cvt_pk_bf16_f32 v65, v65, v65
    v_lshlrev_b32 v65, 16, v65
    v_add_f32 v65, v65, v97
    v_mul_f32 v66, v66, v114
    v_cvt_pk_bf16_f32 v66, v66, v66
    v_lshlrev_b32 v66, 16, v66
    v_add_f32 v66, v66, v98
    v_mul_f32 v67, v67, v115
    v_cvt_pk_bf16_f32 v67, v67, v67
    v_lshlrev_b32 v67, 16, v67
    v_add_f32 v67, v67, v99
    v_mul_f32 v68, v68, v116
    v_cvt_pk_bf16_f32 v68, v68, v68
    v_lshlrev_b32 v68, 16, v68
    v_add_f32 v68, v68, v100
    v_mul_f32 v69, v69, v117
    v_cvt_pk_bf16_f32 v69, v69, v69
    v_lshlrev_b32 v69, 16, v69
    v_add_f32 v69, v69, v101
    v_mul_f32 v70, v70, v118
    v_cvt_pk_bf16_f32 v70, v70, v70
    v_lshlrev_b32 v70, 16, v70
    v_add_f32 v70, v70, v102
    v_mul_f32 v71, v71, v119
    v_cvt_pk_bf16_f32 v71, v71, v71
    v_lshlrev_b32 v71, 16, v71
    v_add_f32 v71, v71, v103
    v_mul_f32 v72, v72, v120
    v_cvt_pk_bf16_f32 v72, v72, v72
    v_lshlrev_b32 v72, 16, v72
    v_add_f32 v72, v72, v104
    v_mul_f32 v73, v73, v121
    v_cvt_pk_bf16_f32 v73, v73, v73
    v_lshlrev_b32 v73, 16, v73
    v_add_f32 v73, v73, v105
    v_mul_f32 v74, v74, v122
    v_cvt_pk_bf16_f32 v74, v74, v74
    v_lshlrev_b32 v74, 16, v74
    v_add_f32 v74, v74, v106
    v_mul_f32 v75, v75, v123
    v_cvt_pk_bf16_f32 v75, v75, v75
    v_lshlrev_b32 v75, 16, v75
    v_add_f32 v75, v75, v107
    v_mul_f32 v76, v76, v124
    v_cvt_pk_bf16_f32 v76, v76, v76
    v_lshlrev_b32 v76, 16, v76
    v_add_f32 v76, v76, v108
    v_mul_f32 v77, v77, v125
    v_cvt_pk_bf16_f32 v77, v77, v77
    v_lshlrev_b32 v77, 16, v77
    v_add_f32 v77, v77, v109
    v_mul_f32 v78, v78, v126
    v_cvt_pk_bf16_f32 v78, v78, v78
    v_lshlrev_b32 v78, 16, v78
    v_add_f32 v78, v78, v110
    v_mul_f32 v79, v79, v127
    v_cvt_pk_bf16_f32 v79, v79, v79
    v_lshlrev_b32 v79, 16, v79
    v_add_f32 v79, v79, v111
    v_cvt_pk_bf16_f32 v80, v64, v65
    v_cvt_pk_bf16_f32 v81, v66, v67
    v_cvt_pk_bf16_f32 v82, v68, v69
    v_cvt_pk_bf16_f32 v83, v70, v71
    v_cvt_pk_bf16_f32 v84, v72, v73
    v_cvt_pk_bf16_f32 v85, v74, v75
    v_cvt_pk_bf16_f32 v86, v76, v77
    v_cvt_pk_bf16_f32 v87, v78, v79
    s_lshr_b32 s45, s63, 5
    s_lshl_b32 s45, s45, 16
    s_and_b32 s46, s63, 31
    s_lshl_b32 s46, s46, 8
    s_add_u32 s45, s45, s46
    s_add_u32 s45, s45, 0x400000
    s_add_u32 s46, s45, 32768
    buffer_store_dwordx4 v[80:83], v2, s[12:15], s45 offen sc1
    buffer_store_dwordx4 v[84:87], v2, s[12:15], s46 offen sc1
    s_add_u32 s63, s63, 384
    v_lshlrev_b32 v64, 16, v160
    v_and_b32 v65, 0xffff0000, v160
    v_lshlrev_b32 v66, 16, v161
    v_and_b32 v67, 0xffff0000, v161
    v_lshlrev_b32 v68, 16, v162
    v_and_b32 v69, 0xffff0000, v162
    v_lshlrev_b32 v70, 16, v163
    v_and_b32 v71, 0xffff0000, v163
    v_lshlrev_b32 v72, 16, v164
    v_and_b32 v73, 0xffff0000, v164
    v_lshlrev_b32 v74, 16, v165
    v_and_b32 v75, 0xffff0000, v165
    v_lshlrev_b32 v76, 16, v166
    v_and_b32 v77, 0xffff0000, v166
    v_lshlrev_b32 v78, 16, v167
    v_and_b32 v79, 0xffff0000, v167
    v_add_f32 v26, v64, v65
    v_add_f32 v26, v26, v66
    v_add_f32 v26, v26, v67
    v_add_f32 v26, v26, v68
    v_add_f32 v26, v26, v69
    v_add_f32 v26, v26, v70
    v_add_f32 v26, v26, v71
    v_add_f32 v26, v26, v72
    v_add_f32 v26, v26, v73
    v_add_f32 v26, v26, v74
    v_add_f32 v26, v26, v75
    v_add_f32 v26, v26, v76
    v_add_f32 v26, v26, v77
    v_add_f32 v26, v26, v78
    v_add_f32 v26, v26, v79
    s_nop 1
    v_add_f32_dpp v26, v26, v26 row_shr:1 row_mask:0xf bank_mask:0xf bound_ctrl:0
    s_nop 1
    v_add_f32_dpp v26, v26, v26 row_shr:2 row_mask:0xf bank_mask:0xf bound_ctrl:0
    s_nop 1
    v_add_f32_dpp v26, v26, v26 row_shr:4 row_mask:0xf bank_mask:0xf bound_ctrl:0
    s_nop 1
    v_add_f32_dpp v26, v26, v26 row_shr:8 row_mask:0xf bank_mask:0xf bound_ctrl:0
    s_nop 1
    v_add_f32_dpp v26, v26, v26 row_bcast:15 row_mask:0xa bank_mask:0xf
    s_nop 1
    v_add_f32_dpp v26, v26, v26 row_bcast:31 row_mask:0xc bank_mask:0xf
    s_nop 1
    v_readlane_b32 s66, v26, 63
    s_nop 1
    v_mov_b32 v27, s66
    v_mul_f32 v27, 0x3a800000, v27
    v_mov_b32 v26, 0
    v_sub_f32 v28, v64, v27
    v_fmac_f32 v26, v28, v28
    v_sub_f32 v28, v65, v27
    v_fmac_f32 v26, v28, v28
    v_sub_f32 v28, v66, v27
    v_fmac_f32 v26, v28, v28
    v_sub_f32 v28, v67, v27
    v_fmac_f32 v26, v28, v28
    v_sub_f32 v28, v68, v27
    v_fmac_f32 v26, v28, v28
    v_sub_f32 v28, v69, v27
    v_fmac_f32 v26, v28, v28
    v_sub_f32 v28, v70, v27
    v_fmac_f32 v26, v28, v28
    v_sub_f32 v28, v71, v27
    v_fmac_f32 v26, v28, v28
    v_sub_f32 v28, v72, v27
    v_fmac_f32 v26, v28, v28
    v_sub_f32 v28, v73, v27
    v_fmac_f32 v26, v28, v28
    v_sub_f32 v28, v74, v27
    v_fmac_f32 v26, v28, v28
    v_sub_f32 v28, v75, v27
    v_fmac_f32 v26, v28, v28
    v_sub_f32 v28, v76, v27
    v_fmac_f32 v26, v28, v28
    v_sub_f32 v28, v77, v27
    v_fmac_f32 v26, v28, v28
    v_sub_f32 v28, v78, v27
    v_fmac_f32 v26, v28, v28
    v_sub_f32 v28, v79, v27
    v_fmac_f32 v26, v28, v28
    s_nop 1
    v_add_f32_dpp v26, v26, v26 row_shr:1 row_mask:0xf bank_mask:0xf bound_ctrl:0
    s_nop 1
    v_add_f32_dpp v26, v26, v26 row_shr:2 row_mask:0xf bank_mask:0xf bound_ctrl:0
    s_nop 1
    v_add_f32_dpp v26, v26, v26 row_shr:4 row_mask:0xf bank_mask:0xf bound_ctrl:0
    s_nop 1
    v_add_f32_dpp v26, v26, v26 row_shr:8 row_mask:0xf bank_mask:0xf bound_ctrl:0
    s_nop 1
    v_add_f32_dpp v26, v26, v26 row_bcast:15 row_mask:0xa bank_mask:0xf
    s_nop 1
    v_add_f32_dpp v26, v26, v26 row_bcast:31 row_mask:0xc bank_mask:0xf
    s_nop 1
    v_readlane_b32 s66, v26, 63
    s_nop 1
    v_mov_b32 v26, s66
    v_mul_f32 v26, 0x3a800000, v26
    v_cvt_pk_bf16_f32 v26, v26, v26
    v_lshlrev_b32 v26, 16, v26
    v_cvt_pk_bf16_f32 v27, v27, v27
    v_lshlrev_b32 v27, 16, v27
    v_add_f32 v26, 0x3727c5ac, v26
    v_cvt_pk_bf16_f32 v26, v26, v26
    v_lshlrev_b32 v26, 16, v26
    v_sqrt_f32 v26, v26
    s_nop 0
    v_cvt_pk_bf16_f32 v26, v26, v26
    v_lshlrev_b32 v26, 16, v26
    v_rcp_f32 v26, v26
    s_nop 0
    v_sub_f32 v64, v64, v27
    v_cvt_pk_bf16_f32 v64, v64, v64
    v_lshlrev_b32 v64, 16, v64
    v_mul_f32 v64, v64, v26
    v_cvt_pk_bf16_f32 v64, v64, v64
    v_lshlrev_b32 v64, 16, v64
    v_sub_f32 v65, v65, v27
    v_cvt_pk_bf16_f32 v65, v65, v65
    v_lshlrev_b32 v65, 16, v65
    v_mul_f32 v65, v65, v26
    v_cvt_pk_bf16_f32 v65, v65, v65
    v_lshlrev_b32 v65, 16, v65
    v_sub_f32 v66, v66, v27
    v_cvt_pk_bf16_f32 v66, v66, v66
    v_lshlrev_b32 v66, 16, v66
    v_mul_f32 v66, v66, v26
    v_cvt_pk_bf16_f32 v66, v66, v66
    v_lshlrev_b32 v66, 16, v66
    v_sub_f32 v67, v67, v27
    v_cvt_pk_bf16_f32 v67, v67, v67
    v_lshlrev_b32 v67, 16, v67
    v_mul_f32 v67, v67, v26
    v_cvt_pk_bf16_f32 v67, v67, v67
    v_lshlrev_b32 v67, 16, v67
    v_sub_f32 v68, v68, v27
    v_cvt_pk_bf16_f32 v68, v68, v68
    v_lshlrev_b32 v68, 16, v68
    v_mul_f32 v68, v68, v26
    v_cvt_pk_bf16_f32 v68, v68, v68
    v_lshlrev_b32 v68, 16, v68
    v_sub_f32 v69, v69, v27
    v_cvt_pk_bf16_f32 v69, v69, v69
    v_lshlrev_b32 v69, 16, v69
    v_mul_f32 v69, v69, v26
    v_cvt_pk_bf16_f32 v69, v69, v69
    v_lshlrev_b32 v69, 16, v69
    v_sub_f32 v70, v70, v27
    v_cvt_pk_bf16_f32 v70, v70, v70
    v_lshlrev_b32 v70, 16, v70
    v_mul_f32 v70, v70, v26
    v_cvt_pk_bf16_f32 v70, v70, v70
    v_lshlrev_b32 v70, 16, v70
    v_sub_f32 v71, v71, v27
    v_cvt_pk_bf16_f32 v71, v71, v71
    v_lshlrev_b32 v71, 16, v71
    v_mul_f32 v71, v71, v26
    v_cvt_pk_bf16_f32 v71, v71, v71
    v_lshlrev_b32 v71, 16, v71
    v_sub_f32 v72, v72, v27
    v_cvt_pk_bf16_f32 v72, v72, v72
    v_lshlrev_b32 v72, 16, v72
    v_mul_f32 v72, v72, v26
    v_cvt_pk_bf16_f32 v72, v72, v72
    v_lshlrev_b32 v72, 16, v72
    v_sub_f32 v73, v73, v27
    v_cvt_pk_bf16_f32 v73, v73, v73
    v_lshlrev_b32 v73, 16, v73
    v_mul_f32 v73, v73, v26
    v_cvt_pk_bf16_f32 v73, v73, v73
    v_lshlrev_b32 v73, 16, v73
    v_sub_f32 v74, v74, v27
    v_cvt_pk_bf16_f32 v74, v74, v74
    v_lshlrev_b32 v74, 16, v74
    v_mul_f32 v74, v74, v26
    v_cvt_pk_bf16_f32 v74, v74, v74
    v_lshlrev_b32 v74, 16, v74
    v_sub_f32 v75, v75, v27
    v_cvt_pk_bf16_f32 v75, v75, v75
    v_lshlrev_b32 v75, 16, v75
    v_mul_f32 v75, v75, v26
    v_cvt_pk_bf16_f32 v75, v75, v75
    v_lshlrev_b32 v75, 16, v75
    v_sub_f32 v76, v76, v27
    v_cvt_pk_bf16_f32 v76, v76, v76
    v_lshlrev_b32 v76, 16, v76
    v_mul_f32 v76, v76, v26
    v_cvt_pk_bf16_f32 v76, v76, v76
    v_lshlrev_b32 v76, 16, v76
    v_sub_f32 v77, v77, v27
    v_cvt_pk_bf16_f32 v77, v77, v77
    v_lshlrev_b32 v77, 16, v77
    v_mul_f32 v77, v77, v26
    v_cvt_pk_bf16_f32 v77, v77, v77
    v_lshlrev_b32 v77, 16, v77
    v_sub_f32 v78, v78, v27
    v_cvt_pk_bf16_f32 v78, v78, v78
    v_lshlrev_b32 v78, 16, v78
    v_mul_f32 v78, v78, v26
    v_cvt_pk_bf16_f32 v78, v78, v78
    v_lshlrev_b32 v78, 16, v78
    v_sub_f32 v79, v79, v27
    v_cvt_pk_bf16_f32 v79, v79, v79
    v_lshlrev_b32 v79, 16, v79
    v_mul_f32 v79, v79, v26
    v_cvt_pk_bf16_f32 v79, v79, v79
    v_lshlrev_b32 v79, 16, v79
    v_mul_f32 v64, v64, v112
    v_cvt_pk_bf16_f32 v64, v64, v64
    v_lshlrev_b32 v64, 16, v64
    v_add_f32 v64, v64, v96
    v_mul_f32 v65, v65, v113
    v_cvt_pk_bf16_f32 v65, v65, v65
    v_lshlrev_b32 v65, 16, v65
    v_add_f32 v65, v65, v97
    v_mul_f32 v66, v66, v114
    v_cvt_pk_bf16_f32 v66, v66, v66
    v_lshlrev_b32 v66, 16, v66
    v_add_f32 v66, v66, v98
    v_mul_f32 v67, v67, v115
    v_cvt_pk_bf16_f32 v67, v67, v67
    v_lshlrev_b32 v67, 16, v67
    v_add_f32 v67, v67, v99
    v_mul_f32 v68, v68, v116
    v_cvt_pk_bf16_f32 v68, v68, v68
    v_lshlrev_b32 v68, 16, v68
    v_add_f32 v68, v68, v100
    v_mul_f32 v69, v69, v117
    v_cvt_pk_bf16_f32 v69, v69, v69
    v_lshlrev_b32 v69, 16, v69
    v_add_f32 v69, v69, v101
    v_mul_f32 v70, v70, v118
    v_cvt_pk_bf16_f32 v70, v70, v70
    v_lshlrev_b32 v70, 16, v70
    v_add_f32 v70, v70, v102
    v_mul_f32 v71, v71, v119
    v_cvt_pk_bf16_f32 v71, v71, v71
    v_lshlrev_b32 v71, 16, v71
    v_add_f32 v71, v71, v103
    v_mul_f32 v72, v72, v120
    v_cvt_pk_bf16_f32 v72, v72, v72
    v_lshlrev_b32 v72, 16, v72
    v_add_f32 v72, v72, v104
    v_mul_f32 v73, v73, v121
    v_cvt_pk_bf16_f32 v73, v73, v73
    v_lshlrev_b32 v73, 16, v73
    v_add_f32 v73, v73, v105
    v_mul_f32 v74, v74, v122
    v_cvt_pk_bf16_f32 v74, v74, v74
    v_lshlrev_b32 v74, 16, v74
    v_add_f32 v74, v74, v106
    v_mul_f32 v75, v75, v123
    v_cvt_pk_bf16_f32 v75, v75, v75
    v_lshlrev_b32 v75, 16, v75
    v_add_f32 v75, v75, v107
    v_mul_f32 v76, v76, v124
    v_cvt_pk_bf16_f32 v76, v76, v76
    v_lshlrev_b32 v76, 16, v76
    v_add_f32 v76, v76, v108
    v_mul_f32 v77, v77, v125
    v_cvt_pk_bf16_f32 v77, v77, v77
    v_lshlrev_b32 v77, 16, v77
    v_add_f32 v77, v77, v109
    v_mul_f32 v78, v78, v126
    v_cvt_pk_bf16_f32 v78, v78, v78
    v_lshlrev_b32 v78, 16, v78
    v_add_f32 v78, v78, v110
    v_mul_f32 v79, v79, v127
    v_cvt_pk_bf16_f32 v79, v79, v79
    v_lshlrev_b32 v79, 16, v79
    v_add_f32 v79, v79, v111
    v_cvt_pk_bf16_f32 v80, v64, v65
    v_cvt_pk_bf16_f32 v81, v66, v67
    v_cvt_pk_bf16_f32 v82, v68, v69
    v_cvt_pk_bf16_f32 v83, v70, v71
    v_cvt_pk_bf16_f32 v84, v72, v73
    v_cvt_pk_bf16_f32 v85, v74, v75
    v_cvt_pk_bf16_f32 v86, v76, v77
    v_cvt_pk_bf16_f32 v87, v78, v79
    s_lshr_b32 s45, s63, 5
    s_lshl_b32 s45, s45, 16
    s_and_b32 s46, s63, 31
    s_lshl_b32 s46, s46, 8
    s_add_u32 s45, s45, s46
    s_add_u32 s45, s45, 0x400000
    s_add_u32 s46, s45, 32768
    buffer_store_dwordx4 v[80:83], v2, s[12:15], s45 offen sc1
    buffer_store_dwordx4 v[84:87], v2, s[12:15], s46 offen sc1
    s_add_u32 s63, s63, 384
    s_cmp_ge_u32 s63, 2048
    s_cbranch_scc1 L_ln_done_107
    v_lshlrev_b32 v64, 16, v168
    v_and_b32 v65, 0xffff0000, v168
    v_lshlrev_b32 v66, 16, v169
    v_and_b32 v67, 0xffff0000, v169
    v_lshlrev_b32 v68, 16, v170
    v_and_b32 v69, 0xffff0000, v170
    v_lshlrev_b32 v70, 16, v171
    v_and_b32 v71, 0xffff0000, v171
    v_lshlrev_b32 v72, 16, v172
    v_and_b32 v73, 0xffff0000, v172
    v_lshlrev_b32 v74, 16, v173
    v_and_b32 v75, 0xffff0000, v173
    v_lshlrev_b32 v76, 16, v174
    v_and_b32 v77, 0xffff0000, v174
    v_lshlrev_b32 v78, 16, v175
    v_and_b32 v79, 0xffff0000, v175
    v_add_f32 v26, v64, v65
    v_add_f32 v26, v26, v66
    v_add_f32 v26, v26, v67
    v_add_f32 v26, v26, v68
    v_add_f32 v26, v26, v69
    v_add_f32 v26, v26, v70
    v_add_f32 v26, v26, v71
    v_add_f32 v26, v26, v72
    v_add_f32 v26, v26, v73
    v_add_f32 v26, v26, v74
    v_add_f32 v26, v26, v75
    v_add_f32 v26, v26, v76
    v_add_f32 v26, v26, v77
    v_add_f32 v26, v26, v78
    v_add_f32 v26, v26, v79
    s_nop 1
    v_add_f32_dpp v26, v26, v26 row_shr:1 row_mask:0xf bank_mask:0xf bound_ctrl:0
    s_nop 1
    v_add_f32_dpp v26, v26, v26 row_shr:2 row_mask:0xf bank_mask:0xf bound_ctrl:0
    s_nop 1
    v_add_f32_dpp v26, v26, v26 row_shr:4 row_mask:0xf bank_mask:0xf bound_ctrl:0
    s_nop 1
    v_add_f32_dpp v26, v26, v26 row_shr:8 row_mask:0xf bank_mask:0xf bound_ctrl:0
    s_nop 1
    v_add_f32_dpp v26, v26, v26 row_bcast:15 row_mask:0xa bank_mask:0xf
    s_nop 1
    v_add_f32_dpp v26, v26, v26 row_bcast:31 row_mask:0xc bank_mask:0xf
    s_nop 1
    v_readlane_b32 s66, v26, 63
    s_nop 1
    v_mov_b32 v27, s66
    v_mul_f32 v27, 0x3a800000, v27
    v_mov_b32 v26, 0
    v_sub_f32 v28, v64, v27
    v_fmac_f32 v26, v28, v28
    v_sub_f32 v28, v65, v27
    v_fmac_f32 v26, v28, v28
    v_sub_f32 v28, v66, v27
    v_fmac_f32 v26, v28, v28
    v_sub_f32 v28, v67, v27
    v_fmac_f32 v26, v28, v28
    v_sub_f32 v28, v68, v27
    v_fmac_f32 v26, v28, v28
    v_sub_f32 v28, v69, v27
    v_fmac_f32 v26, v28, v28
    v_sub_f32 v28, v70, v27
    v_fmac_f32 v26, v28, v28
    v_sub_f32 v28, v71, v27
    v_fmac_f32 v26, v28, v28
    v_sub_f32 v28, v72, v27
    v_fmac_f32 v26, v28, v28
    v_sub_f32 v28, v73, v27
    v_fmac_f32 v26, v28, v28
    v_sub_f32 v28, v74, v27
    v_fmac_f32 v26, v28, v28
    v_sub_f32 v28, v75, v27
    v_fmac_f32 v26, v28, v28
    v_sub_f32 v28, v76, v27
    v_fmac_f32 v26, v28, v28
    v_sub_f32 v28, v77, v27
    v_fmac_f32 v26, v28, v28
    v_sub_f32 v28, v78, v27
    v_fmac_f32 v26, v28, v28
    v_sub_f32 v28, v79, v27
    v_fmac_f32 v26, v28, v28
    s_nop 1
    v_add_f32_dpp v26, v26, v26 row_shr:1 row_mask:0xf bank_mask:0xf bound_ctrl:0
    s_nop 1
    v_add_f32_dpp v26, v26, v26 row_shr:2 row_mask:0xf bank_mask:0xf bound_ctrl:0
    s_nop 1
    v_add_f32_dpp v26, v26, v26 row_shr:4 row_mask:0xf bank_mask:0xf bound_ctrl:0
    s_nop 1
    v_add_f32_dpp v26, v26, v26 row_shr:8 row_mask:0xf bank_mask:0xf bound_ctrl:0
    s_nop 1
    v_add_f32_dpp v26, v26, v26 row_bcast:15 row_mask:0xa bank_mask:0xf
    s_nop 1
    v_add_f32_dpp v26, v26, v26 row_bcast:31 row_mask:0xc bank_mask:0xf
    s_nop 1
    v_readlane_b32 s66, v26, 63
    s_nop 1
    v_mov_b32 v26, s66
    v_mul_f32 v26, 0x3a800000, v26
    v_cvt_pk_bf16_f32 v26, v26, v26
    v_lshlrev_b32 v26, 16, v26
    v_cvt_pk_bf16_f32 v27, v27, v27
    v_lshlrev_b32 v27, 16, v27
    v_add_f32 v26, 0x3727c5ac, v26
    v_cvt_pk_bf16_f32 v26, v26, v26
    v_lshlrev_b32 v26, 16, v26
    v_sqrt_f32 v26, v26
    s_nop 0
    v_cvt_pk_bf16_f32 v26, v26, v26
    v_lshlrev_b32 v26, 16, v26
    v_rcp_f32 v26, v26
    s_nop 0
    v_sub_f32 v64, v64, v27
    v_cvt_pk_bf16_f32 v64, v64, v64
    v_lshlrev_b32 v64, 16, v64
    v_mul_f32 v64, v64, v26
    v_cvt_pk_bf16_f32 v64, v64, v64
    v_lshlrev_b32 v64, 16, v64
    v_sub_f32 v65, v65, v27
    v_cvt_pk_bf16_f32 v65, v65, v65
    v_lshlrev_b32 v65, 16, v65
    v_mul_f32 v65, v65, v26
    v_cvt_pk_bf16_f32 v65, v65, v65
    v_lshlrev_b32 v65, 16, v65
    v_sub_f32 v66, v66, v27
    v_cvt_pk_bf16_f32 v66, v66, v66
    v_lshlrev_b32 v66, 16, v66
    v_mul_f32 v66, v66, v26
    v_cvt_pk_bf16_f32 v66, v66, v66
    v_lshlrev_b32 v66, 16, v66
    v_sub_f32 v67, v67, v27
    v_cvt_pk_bf16_f32 v67, v67, v67
    v_lshlrev_b32 v67, 16, v67
    v_mul_f32 v67, v67, v26
    v_cvt_pk_bf16_f32 v67, v67, v67
    v_lshlrev_b32 v67, 16, v67
    v_sub_f32 v68, v68, v27
    v_cvt_pk_bf16_f32 v68, v68, v68
    v_lshlrev_b32 v68, 16, v68
    v_mul_f32 v68, v68, v26
    v_cvt_pk_bf16_f32 v68, v68, v68
    v_lshlrev_b32 v68, 16, v68
    v_sub_f32 v69, v69, v27
    v_cvt_pk_bf16_f32 v69, v69, v69
    v_lshlrev_b32 v69, 16, v69
    v_mul_f32 v69, v69, v26
    v_cvt_pk_bf16_f32 v69, v69, v69
    v_lshlrev_b32 v69, 16, v69
    v_sub_f32 v70, v70, v27
    v_cvt_pk_bf16_f32 v70, v70, v70
    v_lshlrev_b32 v70, 16, v70
    v_mul_f32 v70, v70, v26
    v_cvt_pk_bf16_f32 v70, v70, v70
    v_lshlrev_b32 v70, 16, v70
    v_sub_f32 v71, v71, v27
    v_cvt_pk_bf16_f32 v71, v71, v71
    v_lshlrev_b32 v71, 16, v71
    v_mul_f32 v71, v71, v26
    v_cvt_pk_bf16_f32 v71, v71, v71
    v_lshlrev_b32 v71, 16, v71
    v_sub_f32 v72, v72, v27
    v_cvt_pk_bf16_f32 v72, v72, v72
    v_lshlrev_b32 v72, 16, v72
    v_mul_f32 v72, v72, v26
    v_cvt_pk_bf16_f32 v72, v72, v72
    v_lshlrev_b32 v72, 16, v72
    v_sub_f32 v73, v73, v27
    v_cvt_pk_bf16_f32 v73, v73, v73
    v_lshlrev_b32 v73, 16, v73
    v_mul_f32 v73, v73, v26
    v_cvt_pk_bf16_f32 v73, v73, v73
    v_lshlrev_b32 v73, 16, v73
    v_sub_f32 v74, v74, v27
    v_cvt_pk_bf16_f32 v74, v74, v74
    v_lshlrev_b32 v74, 16, v74
    v_mul_f32 v74, v74, v26
    v_cvt_pk_bf16_f32 v74, v74, v74
    v_lshlrev_b32 v74, 16, v74
    v_sub_f32 v75, v75, v27
    v_cvt_pk_bf16_f32 v75, v75, v75
    v_lshlrev_b32 v75, 16, v75
    v_mul_f32 v75, v75, v26
    v_cvt_pk_bf16_f32 v75, v75, v75
    v_lshlrev_b32 v75, 16, v75
    v_sub_f32 v76, v76, v27
    v_cvt_pk_bf16_f32 v76, v76, v76
    v_lshlrev_b32 v76, 16, v76
    v_mul_f32 v76, v76, v26
    v_cvt_pk_bf16_f32 v76, v76, v76
    v_lshlrev_b32 v76, 16, v76
    v_sub_f32 v77, v77, v27
    v_cvt_pk_bf16_f32 v77, v77, v77
    v_lshlrev_b32 v77, 16, v77
    v_mul_f32 v77, v77, v26
    v_cvt_pk_bf16_f32 v77, v77, v77
    v_lshlrev_b32 v77, 16, v77
    v_sub_f32 v78, v78, v27
    v_cvt_pk_bf16_f32 v78, v78, v78
    v_lshlrev_b32 v78, 16, v78
    v_mul_f32 v78, v78, v26
    v_cvt_pk_bf16_f32 v78, v78, v78
    v_lshlrev_b32 v78, 16, v78
    v_sub_f32 v79, v79, v27
    v_cvt_pk_bf16_f32 v79, v79, v79
    v_lshlrev_b32 v79, 16, v79
    v_mul_f32 v79, v79, v26
    v_cvt_pk_bf16_f32 v79, v79, v79
    v_lshlrev_b32 v79, 16, v79
    v_mul_f32 v64, v64, v112
    v_cvt_pk_bf16_f32 v64, v64, v64
    v_lshlrev_b32 v64, 16, v64
    v_add_f32 v64, v64, v96
    v_mul_f32 v65, v65, v113
    v_cvt_pk_bf16_f32 v65, v65, v65
    v_lshlrev_b32 v65, 16, v65
    v_add_f32 v65, v65, v97
    v_mul_f32 v66, v66, v114
    v_cvt_pk_bf16_f32 v66, v66, v66
    v_lshlrev_b32 v66, 16, v66
    v_add_f32 v66, v66, v98
    v_mul_f32 v67, v67, v115
    v_cvt_pk_bf16_f32 v67, v67, v67
    v_lshlrev_b32 v67, 16, v67
    v_add_f32 v67, v67, v99
    v_mul_f32 v68, v68, v116
    v_cvt_pk_bf16_f32 v68, v68, v68
    v_lshlrev_b32 v68, 16, v68
    v_add_f32 v68, v68, v100
    v_mul_f32 v69, v69, v117
    v_cvt_pk_bf16_f32 v69, v69, v69
    v_lshlrev_b32 v69, 16, v69
    v_add_f32 v69, v69, v101
    v_mul_f32 v70, v70, v118
    v_cvt_pk_bf16_f32 v70, v70, v70
    v_lshlrev_b32 v70, 16, v70
    v_add_f32 v70, v70, v102
    v_mul_f32 v71, v71, v119
    v_cvt_pk_bf16_f32 v71, v71, v71
    v_lshlrev_b32 v71, 16, v71
    v_add_f32 v71, v71, v103
    v_mul_f32 v72, v72, v120
    v_cvt_pk_bf16_f32 v72, v72, v72
    v_lshlrev_b32 v72, 16, v72
    v_add_f32 v72, v72, v104
    v_mul_f32 v73, v73, v121
    v_cvt_pk_bf16_f32 v73, v73, v73
    v_lshlrev_b32 v73, 16, v73
    v_add_f32 v73, v73, v105
    v_mul_f32 v74, v74, v122
    v_cvt_pk_bf16_f32 v74, v74, v74
    v_lshlrev_b32 v74, 16, v74
    v_add_f32 v74, v74, v106
    v_mul_f32 v75, v75, v123
    v_cvt_pk_bf16_f32 v75, v75, v75
    v_lshlrev_b32 v75, 16, v75
    v_add_f32 v75, v75, v107
    v_mul_f32 v76, v76, v124
    v_cvt_pk_bf16_f32 v76, v76, v76
    v_lshlrev_b32 v76, 16, v76
    v_add_f32 v76, v76, v108
    v_mul_f32 v77, v77, v125
    v_cvt_pk_bf16_f32 v77, v77, v77
    v_lshlrev_b32 v77, 16, v77
    v_add_f32 v77, v77, v109
    v_mul_f32 v78, v78, v126
    v_cvt_pk_bf16_f32 v78, v78, v78
    v_lshlrev_b32 v78, 16, v78
    v_add_f32 v78, v78, v110
    v_mul_f32 v79, v79, v127
    v_cvt_pk_bf16_f32 v79, v79, v79
    v_lshlrev_b32 v79, 16, v79
    v_add_f32 v79, v79, v111
    v_cvt_pk_bf16_f32 v80, v64, v65
    v_cvt_pk_bf16_f32 v81, v66, v67
    v_cvt_pk_bf16_f32 v82, v68, v69
    v_cvt_pk_bf16_f32 v83, v70, v71
    v_cvt_pk_bf16_f32 v84, v72, v73
    v_cvt_pk_bf16_f32 v85, v74, v75
    v_cvt_pk_bf16_f32 v86, v76, v77
    v_cvt_pk_bf16_f32 v87, v78, v79
    s_lshr_b32 s45, s63, 5
    s_lshl_b32 s45, s45, 16
    s_and_b32 s46, s63, 31
    s_lshl_b32 s46, s46, 8
    s_add_u32 s45, s45, s46
    s_add_u32 s45, s45, 0x400000
    s_add_u32 s46, s45, 32768
    buffer_store_dwordx4 v[80:83], v2, s[12:15], s45 offen sc1
    buffer_store_dwordx4 v[84:87], v2, s[12:15], s46 offen sc1
    s_add_u32 s63, s63, 384
L_ln_done_107:
    s_waitcnt vmcnt(0)
    s_barrier
    s_cmp_lg_u32 s44, 0
    s_cbranch_scc1 L_cnt_109
    v_mov_b32 v30, 1
    v_mov_b32 v31, 127104
    s_mov_b64 exec, 1
    buffer_atomic_add v30, v31, s[12:15], 0 offen sc1
    s_mov_b64 exec, -1
L_cnt_109:
    s_cmp_lg_u32 s44, 0
    s_cbranch_scc1 L_pd_110
    v_mov_b32 v29, 127360
    s_mov_b32 s46, 64
    s_mov_b64 exec, 1
    s_mov_b32 s70, 0
L_wp_111:
    buffer_load_dword v31, v29, s[12:15], 0 offen sc1
    s_add_u32 s70, s70, 1
    s_cmp_ge_u32 s70, 0x200000
    s_cbranch_scc1 L_w_done_98
    s_waitcnt vmcnt(0)
    v_cmp_gt_u32 vcc, s46, v31
    s_nop 1
    s_cbranch_vccz L_wp_111_ok
    s_sleep 8
    s_branch L_wp_111
L_wp_111_ok:
    s_mov_b64 exec, -1
L_pd_110:
    s_barrier
    s_add_u32 s39, s39, 96
    s_load_dwordx2 s[4:5], s[0:1], 96
    s_load_dwordx2 s[6:7], s[0:1], 104
    v_and_b32 v14, 7, v0
    v_lshrrev_b32 v15, 3, v0
    s_waitcnt lgkmcnt(0)
    s_mov_b32 s32, s4
    s_and_b32 s33, s5, 0xffff
    s_mov_b32 s34, 0x800
    s_mov_b32 s35, 0x00020000
    s_mov_b32 s24, s6
    s_and_b32 s25, s7, 0xffff
    s_mov_b32 s26, 0xc00000
    s_mov_b32 s27, 0x00020000
    s_and_b32 s47, s39, 1
    s_lshl_b32 s45, s47, 10
    v_lshlrev_b32 v16, 5, v15
    buffer_load_dwordx4 v[104:107], v16, s[32:35], s45 offen
    buffer_load_dwordx4 v[108:111], v16, s[32:35], s45 offen offset:16
    s_mov_b32 s45, 196608
    v_mul_lo_u32 v17, v15, s45
    v_lshlrev_b32 v18, 4, v14
    v_add_u32 v17, v17, v18
    s_lshr_b32 s46, s39, 1
    s_lshl_b32 s46, s46, 7
    s_mul_i32 s45, s47, 6291456
    s_add_u32 s46, s46, s45
    buffer_load_dwordx4 v[32:35], v17, s[24:27], s46 offen
    v_add_u32 v17, 12288, v17
    buffer_load_dwordx4 v[36:39], v17, s[24:27], s46 offen
    v_add_u32 v17, 12288, v17
    buffer_load_dwordx4 v[40:43], v17, s[24:27], s46 offen
    v_add_u32 v17, 12288, v17
    buffer_load_dwordx4 v[44:47], v17, s[24:27], s46 offen
    v_add_u32 v17, 12288, v17
    buffer_load_dwordx4 v[48:51], v17, s[24:27], s46 offen
    v_add_u32 v17, 12288, v17
    buffer_load_dwordx4 v[52:55], v17, s[24:27], s46 offen
    v_add_u32 v17, 12288, v17
    buffer_load_dwordx4 v[56:59], v17, s[24:27], s46 offen
    v_add_u32 v17, 12288, v17
    buffer_load_dwordx4 v[60:63], v17, s[24:27], s46 offen
    v_add_u32 v17, 12288, v17
    buffer_load_dwordx4 v[64:67], v17, s[24:27], s46 offen
    v_add_u32 v17, 12288, v17
    buffer_load_dwordx4 v[68:71], v17, s[24:27], s46 offen
    v_add_u32 v17, 12288, v17
    buffer_load_dwordx4 v[72:75], v17, s[24:27], s46 offen
    v_add_u32 v17, 12288, v17
    buffer_load_dwordx4 v[76:79], v17, s[24:27], s46 offen
    v_add_u32 v17, 12288, v17
    buffer_load_dwordx4 v[80:83], v17, s[24:27], s46 offen
    v_add_u32 v17, 12288, v17
    buffer_load_dwordx4 v[84:87], v17, s[24:27], s46 offen
    v_add_u32 v17, 12288, v17
    buffer_load_dwordx4 v[88:91], v17, s[24:27], s46 offen
    v_add_u32 v17, 12288, v17
    buffer_load_dwordx4 v[92:95], v17, s[24:27], s46 offen
    s_waitcnt vmcnt(16)
    v_lshlrev_b32 v112, 16, v104
    v_and_b32 v113, 0xffff0000, v104
    v_lshlrev_b32 v114, 16, v105
    v_and_b32 v115, 0xffff0000, v105
    v_lshlrev_b32 v116, 16, v106
    v_and_b32 v117, 0xffff0000, v106
    v_lshlrev_b32 v118, 16, v107
    v_and_b32 v119, 0xffff0000, v107
    v_lshlrev_b32 v120, 16, v108
    v_and_b32 v121, 0xffff0000, v108
    v_lshlrev_b32 v122, 16, v109
    v_and_b32 v123, 0xffff0000, v109
    v_lshlrev_b32 v124, 16, v110
    v_and_b32 v125, 0xffff0000, v110
    v_lshlrev_b32 v126, 16, v111
    v_and_b32 v127, 0xffff0000, v111
    v_mul_f32 v18, 0xbfb8aa3b, v112
    v_exp_f32 v18, v18
    s_nop 0
    v_add_f32 v18, 1.0, v18
    v_rcp_f32 v18, v18
    s_nop 0
    v_mul_f32 v112, v112, v18
    v_cvt_pk_bf16_f32 v112, v112, v112
    v_lshlrev_b32 v112, 16, v112
    v_mul_f32 v18, 0xbfb8aa3b, v113
    v_exp_f32 v18, v18
    s_nop 0
    v_add_f32 v18, 1.0, v18
    v_rcp_f32 v18, v18
    s_nop 0
    v_mul_f32 v113, v113, v18
    v_cvt_pk_bf16_f32 v113, v113, v113
    v_lshlrev_b32 v113, 16, v113
    v_mul_f32 v18, 0xbfb8aa3b, v114
    v_exp_f32 v18, v18
    s_nop 0
    v_add_f32 v18, 1.0, v18
    v_rcp_f32 v18, v18
    s_nop 0
    v_mul_f32 v114, v114, v18
    v_cvt_pk_bf16_f32 v114, v114, v114
    v_lshlrev_b32 v114, 16, v114
    v_mul_f32 v18, 0xbfb8aa3b, v115
    v_exp_f32 v18, v18
    s_nop 0
    v_add_f32 v18, 1.0, v18
    v_rcp_f32 v18, v18
    s_nop 0
    v_mul_f32 v115, v115, v18
    v_cvt_pk_bf16_f32 v115, v115, v115
    v_lshlrev_b32 v115, 16, v115
    v_mul_f32 v18, 0xbfb8aa3b, v116
    v_exp_f32 v18, v18
    s_nop 0
    v_add_f32 v18, 1.0, v18
    v_rcp_f32 v18, v18
    s_nop 0
    v_mul_f32 v116, v116, v18
    v_cvt_pk_bf16_f32 v116, v116, v116
    v_lshlrev_b32 v116, 16, v116
    v_mul_f32 v18, 0xbfb8aa3b, v117
    v_exp_f32 v18, v18
    s_nop 0
    v_add_f32 v18, 1.0, v18
    v_rcp_f32 v18, v18
    s_nop 0
    v_mul_f32 v117, v117, v18
    v_cvt_pk_bf16_f32 v117, v117, v117
    v_lshlrev_b32 v117, 16, v117
    v_mul_f32 v18, 0xbfb8aa3b, v118
    v_exp_f32 v18, v18
    s_nop 0
    v_add_f32 v18, 1.0, v18
    v_rcp_f32 v18, v18
    s_nop 0
    v_mul_f32 v118, v118, v18
    v_cvt_pk_bf16_f32 v118, v118, v118
    v_lshlrev_b32 v118, 16, v118
    v_mul_f32 v18, 0xbfb8aa3b, v119
    v_exp_f32 v18, v18
    s_nop 0
    v_add_f32 v18, 1.0, v18
    v_rcp_f32 v18, v18
    s_nop 0
    v_mul_f32 v119, v119, v18
    v_cvt_pk_bf16_f32 v119, v119, v119
    v_lshlrev_b32 v119, 16, v119
    v_mul_f32 v18, 0xbfb8aa3b, v120
    v_exp_f32 v18, v18
    s_nop 0
    v_add_f32 v18, 1.0, v18
    v_rcp_f32 v18, v18
    s_nop 0
    v_mul_f32 v120, v120, v18
    v_cvt_pk_bf16_f32 v120, v120, v120
    v_lshlrev_b32 v120, 16, v120
    v_mul_f32 v18, 0xbfb8aa3b, v121
    v_exp_f32 v18, v18
    s_nop 0
    v_add_f32 v18, 1.0, v18
    v_rcp_f32 v18, v18
    s_nop 0
    v_mul_f32 v121, v121, v18
    v_cvt_pk_bf16_f32 v121, v121, v121
    v_lshlrev_b32 v121, 16, v121
    v_mul_f32 v18, 0xbfb8aa3b, v122
    v_exp_f32 v18, v18
    s_nop 0
    v_add_f32 v18, 1.0, v18
    v_rcp_f32 v18, v18
    s_nop 0
    v_mul_f32 v122, v122, v18
    v_cvt_pk_bf16_f32 v122, v122, v122
    v_lshlrev_b32 v122, 16, v122
    v_mul_f32 v18, 0xbfb8aa3b, v123
    v_exp_f32 v18, v18
    s_nop 0
    v_add_f32 v18, 1.0, v18
    v_rcp_f32 v18, v18
    s_nop 0
    v_mul_f32 v123, v123, v18
    v_cvt_pk_bf16_f32 v123, v123, v123
    v_lshlrev_b32 v123, 16, v123
    v_mul_f32 v18, 0xbfb8aa3b, v124
    v_exp_f32 v18, v18
    s_nop 0
    v_add_f32 v18, 1.0, v18
    v_rcp_f32 v18, v18
    s_nop 0
    v_mul_f32 v124, v124, v18
    v_cvt_pk_bf16_f32 v124, v124, v124
    v_lshlrev_b32 v124, 16, v124
    v_mul_f32 v18, 0xbfb8aa3b, v125
    v_exp_f32 v18, v18
    s_nop 0
    v_add_f32 v18, 1.0, v18
    v_rcp_f32 v18, v18
    s_nop 0
    v_mul_f32 v125, v125, v18
    v_cvt_pk_bf16_f32 v125, v125, v125
    v_lshlrev_b32 v125, 16, v125
    v_mul_f32 v18, 0xbfb8aa3b, v126
    v_exp_f32 v18, v18
    s_nop 0
    v_add_f32 v18, 1.0, v18
    v_rcp_f32 v18, v18
    s_nop 0
    v_mul_f32 v126, v126, v18
    v_cvt_pk_bf16_f32 v126, v126, v126
    v_lshlrev_b32 v126, 16, v126
    v_mul_f32 v18, 0xbfb8aa3b, v127
    v_exp_f32 v18, v18
    s_nop 0
    v_add_f32 v18, 1.0, v18
    v_rcp_f32 v18, v18
    s_nop 0
    v_mul_f32 v127, v127, v18
    v_cvt_pk_bf16_f32 v127, v127, v127
    v_lshlrev_b32 v127, 16, v127
    v_mov_b32 v96, 0
    v_mov_b32 v97, 0
    v_mov_b32 v98, 0
    v_mov_b32 v99, 0
    v_mov_b32 v100, 0
    v_mov_b32 v101, 0
    v_mov_b32 v102, 0
    v_mov_b32 v103, 0
    s_waitcnt vmcnt(15)
    v_lshlrev_b32 v18, 16, v32
    v_and_b32 v19, 0xffff0000, v32
    v_fmac_f32 v96, v18, v112
    v_fmac_f32 v97, v19, v112
    v_lshlrev_b32 v18, 16, v33
    v_and_b32 v19, 0xffff0000, v33
    v_fmac_f32 v98, v18, v112
    v_fmac_f32 v99, v19, v112
    v_lshlrev_b32 v18, 16, v34
    v_and_b32 v19, 0xffff0000, v34
    v_fmac_f32 v100, v18, v112
    v_fmac_f32 v101, v19, v112
    v_lshlrev_b32 v18, 16, v35
    v_and_b32 v19, 0xffff0000, v35
    v_fmac_f32 v102, v18, v112
    v_fmac_f32 v103, v19, v112
    s_waitcnt vmcnt(14)
    v_lshlrev_b32 v18, 16, v36
    v_and_b32 v19, 0xffff0000, v36
    v_fmac_f32 v96, v18, v113
    v_fmac_f32 v97, v19, v113
    v_lshlrev_b32 v18, 16, v37
    v_and_b32 v19, 0xffff0000, v37
    v_fmac_f32 v98, v18, v113
    v_fmac_f32 v99, v19, v113
    v_lshlrev_b32 v18, 16, v38
    v_and_b32 v19, 0xffff0000, v38
    v_fmac_f32 v100, v18, v113
    v_fmac_f32 v101, v19, v113
    v_lshlrev_b32 v18, 16, v39
    v_and_b32 v19, 0xffff0000, v39
    v_fmac_f32 v102, v18, v113
    v_fmac_f32 v103, v19, v113
    s_waitcnt vmcnt(13)
    v_lshlrev_b32 v18, 16, v40
    v_and_b32 v19, 0xffff0000, v40
    v_fmac_f32 v96, v18, v114
    v_fmac_f32 v97, v19, v114
    v_lshlrev_b32 v18, 16, v41
    v_and_b32 v19, 0xffff0000, v41
    v_fmac_f32 v98, v18, v114
    v_fmac_f32 v99, v19, v114
    v_lshlrev_b32 v18, 16, v42
    v_and_b32 v19, 0xffff0000, v42
    v_fmac_f32 v100, v18, v114
    v_fmac_f32 v101, v19, v114
    v_lshlrev_b32 v18, 16, v43
    v_and_b32 v19, 0xffff0000, v43
    v_fmac_f32 v102, v18, v114
    v_fmac_f32 v103, v19, v114
    s_waitcnt vmcnt(12)
    v_lshlrev_b32 v18, 16, v44
    v_and_b32 v19, 0xffff0000, v44
    v_fmac_f32 v96, v18, v115
    v_fmac_f32 v97, v19, v115
    v_lshlrev_b32 v18, 16, v45
    v_and_b32 v19, 0xffff0000, v45
    v_fmac_f32 v98, v18, v115
    v_fmac_f32 v99, v19, v115
    v_lshlrev_b32 v18, 16, v46
    v_and_b32 v19, 0xffff0000, v46
    v_fmac_f32 v100, v18, v115
    v_fmac_f32 v101, v19, v115
    v_lshlrev_b32 v18, 16, v47
    v_and_b32 v19, 0xffff0000, v47
    v_fmac_f32 v102, v18, v115
    v_fmac_f32 v103, v19, v115
    s_waitcnt vmcnt(11)
    v_lshlrev_b32 v18, 16, v48
    v_and_b32 v19, 0xffff0000, v48
    v_fmac_f32 v96, v18, v116
    v_fmac_f32 v97, v19, v116
    v_lshlrev_b32 v18, 16, v49
    v_and_b32 v19, 0xffff0000, v49
    v_fmac_f32 v98, v18, v116
    v_fmac_f32 v99, v19, v116
    v_lshlrev_b32 v18, 16, v50
    v_and_b32 v19, 0xffff0000, v50
    v_fmac_f32 v100, v18, v116
    v_fmac_f32 v101, v19, v116
    v_lshlrev_b32 v18, 16, v51
    v_and_b32 v19, 0xffff0000, v51
    v_fmac_f32 v102, v18, v116
    v_fmac_f32 v103, v19, v116
    s_waitcnt vmcnt(10)
    v_lshlrev_b32 v18, 16, v52
    v_and_b32 v19, 0xffff0000, v52
    v_fmac_f32 v96, v18, v117
    v_fmac_f32 v97, v19, v117
    v_lshlrev_b32 v18, 16, v53
    v_and_b32 v19, 0xffff0000, v53
    v_fmac_f32 v98, v18, v117
    v_fmac_f32 v99, v19, v117
    v_lshlrev_b32 v18, 16, v54
    v_and_b32 v19, 0xffff0000, v54
    v_fmac_f32 v100, v18, v117
    v_fmac_f32 v101, v19, v117
    v_lshlrev_b32 v18, 16, v55
    v_and_b32 v19, 0xffff0000, v55
    v_fmac_f32 v102, v18, v117
    v_fmac_f32 v103, v19, v117
    s_waitcnt vmcnt(9)
    v_lshlrev_b32 v18, 16, v56
    v_and_b32 v19, 0xffff0000, v56
    v_fmac_f32 v96, v18, v118
    v_fmac_f32 v97, v19, v118
    v_lshlrev_b32 v18, 16, v57
    v_and_b32 v19, 0xffff0000, v57
    v_fmac_f32 v98, v18, v118
    v_fmac_f32 v99, v19, v118
    v_lshlrev_b32 v18, 16, v58
    v_and_b32 v19, 0xffff0000, v58
    v_fmac_f32 v100, v18, v118
    v_fmac_f32 v101, v19, v118
    v_lshlrev_b32 v18, 16, v59
    v_and_b32 v19, 0xffff0000, v59
    v_fmac_f32 v102, v18, v118
    v_fmac_f32 v103, v19, v118
    s_waitcnt vmcnt(8)
    v_lshlrev_b32 v18, 16, v60
    v_and_b32 v19, 0xffff0000, v60
    v_fmac_f32 v96, v18, v119
    v_fmac_f32 v97, v19, v119
    v_lshlrev_b32 v18, 16, v61
    v_and_b32 v19, 0xffff0000, v61
    v_fmac_f32 v98, v18, v119
    v_fmac_f32 v99, v19, v119
    v_lshlrev_b32 v18, 16, v62
    v_and_b32 v19, 0xffff0000, v62
    v_fmac_f32 v100, v18, v119
    v_fmac_f32 v101, v19, v119
    v_lshlrev_b32 v18, 16, v63
    v_and_b32 v19, 0xffff0000, v63
    v_fmac_f32 v102, v18, v119
    v_fmac_f32 v103, v19, v119
    s_waitcnt vmcnt(7)
    v_lshlrev_b32 v18, 16, v64
    v_and_b32 v19, 0xffff0000, v64
    v_fmac_f32 v96, v18, v120
    v_fmac_f32 v97, v19, v120
    v_lshlrev_b32 v18, 16, v65
    v_and_b32 v19, 0xffff0000, v65
    v_fmac_f32 v98, v18, v120
    v_fmac_f32 v99, v19, v120
    v_lshlrev_b32 v18, 16, v66
    v_and_b32 v19, 0xffff0000, v66
    v_fmac_f32 v100, v18, v120
    v_fmac_f32 v101, v19, v120
    v_lshlrev_b32 v18, 16, v67
    v_and_b32 v19, 0xffff0000, v67
    v_fmac_f32 v102, v18, v120
    v_fmac_f32 v103, v19, v120
    s_waitcnt vmcnt(6)
    v_lshlrev_b32 v18, 16, v68
    v_and_b32 v19, 0xffff0000, v68
    v_fmac_f32 v96, v18, v121
    v_fmac_f32 v97, v19, v121
    v_lshlrev_b32 v18, 16, v69
    v_and_b32 v19, 0xffff0000, v69
    v_fmac_f32 v98, v18, v121
    v_fmac_f32 v99, v19, v121
    v_lshlrev_b32 v18, 16, v70
    v_and_b32 v19, 0xffff0000, v70
    v_fmac_f32 v100, v18, v121
    v_fmac_f32 v101, v19, v121
    v_lshlrev_b32 v18, 16, v71
    v_and_b32 v19, 0xffff0000, v71
    v_fmac_f32 v102, v18, v121
    v_fmac_f32 v103, v19, v121
    s_waitcnt vmcnt(5)
    v_lshlrev_b32 v18, 16, v72
    v_and_b32 v19, 0xffff0000, v72
    v_fmac_f32 v96, v18, v122
    v_fmac_f32 v97, v19, v122
    v_lshlrev_b32 v18, 16, v73
    v_and_b32 v19, 0xffff0000, v73
    v_fmac_f32 v98, v18, v122
    v_fmac_f32 v99, v19, v122
    v_lshlrev_b32 v18, 16, v74
    v_and_b32 v19, 0xffff0000, v74
    v_fmac_f32 v100, v18, v122
    v_fmac_f32 v101, v19, v122
    v_lshlrev_b32 v18, 16, v75
    v_and_b32 v19, 0xffff0000, v75
    v_fmac_f32 v102, v18, v122
    v_fmac_f32 v103, v19, v122
    s_waitcnt vmcnt(4)
    v_lshlrev_b32 v18, 16, v76
    v_and_b32 v19, 0xffff0000, v76
    v_fmac_f32 v96, v18, v123
    v_fmac_f32 v97, v19, v123
    v_lshlrev_b32 v18, 16, v77
    v_and_b32 v19, 0xffff0000, v77
    v_fmac_f32 v98, v18, v123
    v_fmac_f32 v99, v19, v123
    v_lshlrev_b32 v18, 16, v78
    v_and_b32 v19, 0xffff0000, v78
    v_fmac_f32 v100, v18, v123
    v_fmac_f32 v101, v19, v123
    v_lshlrev_b32 v18, 16, v79
    v_and_b32 v19, 0xffff0000, v79
    v_fmac_f32 v102, v18, v123
    v_fmac_f32 v103, v19, v123
    s_waitcnt vmcnt(3)
    v_lshlrev_b32 v18, 16, v80
    v_and_b32 v19, 0xffff0000, v80
    v_fmac_f32 v96, v18, v124
    v_fmac_f32 v97, v19, v124
    v_lshlrev_b32 v18, 16, v81
    v_and_b32 v19, 0xffff0000, v81
    v_fmac_f32 v98, v18, v124
    v_fmac_f32 v99, v19, v124
    v_lshlrev_b32 v18, 16, v82
    v_and_b32 v19, 0xffff0000, v82
    v_fmac_f32 v100, v18, v124
    v_fmac_f32 v101, v19, v124
    v_lshlrev_b32 v18, 16, v83
    v_and_b32 v19, 0xffff0000, v83
    v_fmac_f32 v102, v18, v124
    v_fmac_f32 v103, v19, v124
    s_waitcnt vmcnt(2)
    v_lshlrev_b32 v18, 16, v84
    v_and_b32 v19, 0xffff0000, v84
    v_fmac_f32 v96, v18, v125
    v_fmac_f32 v97, v19, v125
    v_lshlrev_b32 v18, 16, v85
    v_and_b32 v19, 0xffff0000, v85
    v_fmac_f32 v98, v18, v125
    v_fmac_f32 v99, v19, v125
    v_lshlrev_b32 v18, 16, v86
    v_and_b32 v19, 0xffff0000, v86
    v_fmac_f32 v100, v18, v125
    v_fmac_f32 v101, v19, v125
    v_lshlrev_b32 v18, 16, v87
    v_and_b32 v19, 0xffff0000, v87
    v_fmac_f32 v102, v18, v125
    v_fmac_f32 v103, v19, v125
    s_waitcnt vmcnt(1)
    v_lshlrev_b32 v18, 16, v88
    v_and_b32 v19, 0xffff0000, v88
    v_fmac_f32 v96, v18, v126
    v_fmac_f32 v97, v19, v126
    v_lshlrev_b32 v18, 16, v89
    v_and_b32 v19, 0xffff0000, v89
    v_fmac_f32 v98, v18, v126
    v_fmac_f32 v99, v19, v126
    v_lshlrev_b32 v18, 16, v90
    v_and_b32 v19, 0xffff0000, v90
    v_fmac_f32 v100, v18, v126
    v_fmac_f32 v101, v19, v126
    v_lshlrev_b32 v18, 16, v91
    v_and_b32 v19, 0xffff0000, v91
    v_fmac_f32 v102, v18, v126
    v_fmac_f32 v103, v19, v126
    s_waitcnt vmcnt(0)
    v_lshlrev_b32 v18, 16, v92
    v_and_b32 v19, 0xffff0000, v92
    v_fmac_f32 v96, v18, v127
    v_fmac_f32 v97, v19, v127
    v_lshlrev_b32 v18, 16, v93
    v_and_b32 v19, 0xffff0000, v93
    v_fmac_f32 v98, v18, v127
    v_fmac_f32 v99, v19, v127
    v_lshlrev_b32 v18, 16, v94
    v_and_b32 v19, 0xffff0000, v94
    v_fmac_f32 v100, v18, v127
    v_fmac_f32 v101, v19, v127
    v_lshlrev_b32 v18, 16, v95
    v_and_b32 v19, 0xffff0000, v95
    v_fmac_f32 v102, v18, v127
    v_fmac_f32 v103, v19, v127
    v_lshlrev_b32 v16, 5, v0
    ds_write_b128 v16, v[96:99]
    ds_write_b128 v16, v[100:103] offset:16
    s_waitcnt lgkmcnt(0)
    s_barrier
    s_cmp_lg_u32 s44, 0
    s_cbranch_scc1 L_mod_fin_112
    v_mov_b32 v18, 0
    ds_read_b32 v32, v12 offset:0
    ds_read_b32 v33, v12 offset:256
    ds_read_b32 v34, v12 offset:512
    ds_read_b32 v35, v12 offset:768
    ds_read_b32 v36, v12 offset:1024
    ds_read_b32 v37, v12 offset:1280
    ds_read_b32 v38, v12 offset:1536
    ds_read_b32 v39, v12 offset:1792
    ds_read_b32 v40, v12 offset:2048
    ds_read_b32 v41, v12 offset:2304
    ds_read_b32 v42, v12 offset:2560
    ds_read_b32 v43, v12 offset:2816
    ds_read_b32 v44, v12 offset:3072
    ds_read_b32 v45, v12 offset:3328
    ds_read_b32 v46, v12 offset:3584
    ds_read_b32 v47, v12 offset:3840
    s_waitcnt lgkmcnt(0)
    v_add_f32 v18, v18, v32
    v_add_f32 v18, v18, v33
    v_add_f32 v18, v18, v34
    v_add_f32 v18, v18, v35
    v_add_f32 v18, v18, v36
    v_add_f32 v18, v18, v37
    v_add_f32 v18, v18, v38
    v_add_f32 v18, v18, v39
    v_add_f32 v18, v18, v40
    v_add_f32 v18, v18, v41
    v_add_f32 v18, v18, v42
    v_add_f32 v18, v18, v43
    v_add_f32 v18, v18, v44
    v_add_f32 v18, v18, v45
    v_add_f32 v18, v18, v46
    v_add_f32 v18, v18, v47
    ds_read_b32 v32, v12 offset:4096
    ds_read_b32 v33, v12 offset:4352
    ds_read_b32 v34, v12 offset:4608
    ds_read_b32 v35, v12 offset:4864
    ds_read_b32 v36, v12 offset:5120
    ds_read_b32 v37, v12 offset:5376
    ds_read_b32 v38, v12 offset:5632
    ds_read_b32 v39, v12 offset:5888
    ds_read_b32 v40, v12 offset:6144
    ds_read_b32 v41, v12 offset:6400
    ds_read_b32 v42, v12 offset:6656
    ds_read_b32 v43, v12 offset:6912
    ds_read_b32 v44, v12 offset:7168
    ds_read_b32 v45, v12 offset:7424
    ds_read_b32 v46, v12 offset:7680
    ds_read_b32 v47, v12 offset:7936
    s_waitcnt lgkmcnt(0)
    v_add_f32 v18, v18, v32
    v_add_f32 v18, v18, v33
    v_add_f32 v18, v18, v34
    v_add_f32 v18, v18, v35
    v_add_f32 v18, v18, v36
    v_add_f32 v18, v18, v37
    v_add_f32 v18, v18, v38
    v_add_f32 v18, v18, v39
    v_add_f32 v18, v18, v40
    v_add_f32 v18, v18, v41
    v_add_f32 v18, v18, v42
    v_add_f32 v18, v18, v43
    v_add_f32 v18, v18, v44
    v_add_f32 v18, v18, v45
    v_add_f32 v18, v18, v46
    v_add_f32 v18, v18, v47
    s_lshr_b32 s45, s39, 1
    s_lshl_b32 s45, s45, 8
    s_mul_i32 s46, s47, 24576
    s_add_u32 s45, s45, s46
    buffer_store_dword v18, v12, s[12:15], s45 offen sc1
L_mod_fin_112:
    s_waitcnt vmcnt(0)
    s_barrier
    s_cmp_lg_u32 s44, 0
    s_cbranch_scc1 L_cnt_113
    v_mov_b32 v30, 1
    v_mov_b32 v31, 127232
    s_mov_b64 exec, 1
    buffer_atomic_add v30, v31, s[12:15], 0 offen sc1
    s_mov_b64 exec, -1
L_cnt_113:
    s_branch L_w_roles_100
L_w_kv_99:
    s_lshl_b32 s45, s43, 3
    s_add_u32 s45, s45, 16
    s_load_dwordx2 s[6:7], s[0:1], s45
    s_waitcnt lgkmcnt(0)
    s_mov_b32 s24, s6
    s_and_b32 s25, s7, 0xffff
    s_mov_b32 s26, 0x800000
    s_mov_b32 s27, 0x00020000
    s_lshl_b32 s46, s41, 8
    s_barrier
    v_lshrrev_b32 v20, 4, v1
    s_lshl_b32 s45, s44, 2
    v_add_u32 v21, s45, v20
    s_mov_b32 s45, 8192
    v_mul_lo_u32 v21, v21, s45
    v_lshlrev_b32 v22, 2, v20
    v_and_b32 v23, 15, v1
    v_xor_b32 v22, v22, v23
    v_lshlrev_b32 v22, 4, v22
    v_add_u32 v21, v21, v22
    v_bfe_u32 v22, v1, 2, 2
    v_lshlrev_b32 v23, 3, v20
    v_add_u32 v23, v23, v22
    v_lshlrev_b32 v23, 8, v23
    v_xor_b32 v22, s44, v22
    v_lshlrev_b32 v22, 6, v22
    v_add_u32 v23, v23, v22
    v_and_b32 v22, 3, v1
    v_lshlrev_b32 v22, 4, v22
    v_add_u32 v23, v23, v22
    v_add_u32 v24, 65536, v23
    v_add_u32 v25, 131072, v23
    s_lshl_b32 s47, s44, 10
    s_add_u32 s45, s46, 0x0
    s_add_u32 m0, s47, 0
    s_nop 0
    buffer_load_dwordx4 v21, s[24:27], s45 offen  lds
    s_add_u32 s45, s46, 0x20000
    s_add_u32 m0, s47, 4096
    s_nop 0
    buffer_load_dwordx4 v21, s[24:27], s45 offen  lds
    s_add_u32 s45, s46, 0x40000
    s_add_u32 m0, s47, 8192
    s_nop 0
    buffer_load_dwordx4 v21, s[24:27], s45 offen  lds
    s_add_u32 s45, s46, 0x60000
    s_add_u32 m0, s47, 12288
    s_nop 0
    buffer_load_dwordx4 v21, s[24:27], s45 offen  lds
    s_add_u32 s45, s46, 0x80000
    s_add_u32 m0, s47, 16384
    s_nop 0
    buffer_load_dwordx4 v21, s[24:27], s45 offen  lds
    s_add_u32 s45, s46, 0xa0000
    s_add_u32 m0, s47, 20480
    s_nop 0
    buffer_load_dwordx4 v21, s[24:27], s45 offen  lds
    s_add_u32 s45, s46, 0xc0000
    s_add_u32 m0, s47, 24576
    s_nop 0
    buffer_load_dwordx4 v21, s[24:27], s45 offen  lds
    s_add_u32 s45, s46, 0xe0000
    s_add_u32 m0, s47, 28672
    s_nop 0
    buffer_load_dwordx4 v21, s[24:27], s45 offen  lds
    s_add_u32 s45, s46, 0x100000
    s_add_u32 m0, s47, 32768
    s_nop 0
    buffer_load_dwordx4 v21, s[24:27], s45 offen  lds
    s_add_u32 s45, s46, 0x120000
    s_add_u32 m0, s47, 36864
    s_nop 0
    buffer_load_dwordx4 v21, s[24:27], s45 offen  lds
    s_add_u32 s45, s46, 0x140000
    s_add_u32 m0, s47, 40960
    s_nop 0
    buffer_load_dwordx4 v21, s[24:27], s45 offen  lds
    s_add_u32 s45, s46, 0x160000
    s_add_u32 m0, s47, 45056
    s_nop 0
    buffer_load_dwordx4 v21, s[24:27], s45 offen  lds
    s_add_u32 s45, s46, 0x180000
    s_add_u32 m0, s47, 49152
    s_nop 0
    buffer_load_dwordx4 v21, s[24:27], s45 offen  lds
    s_add_u32 s45, s46, 0x1a0000
    s_add_u32 m0, s47, 53248
    s_nop 0
    buffer_load_dwordx4 v21, s[24:27], s45 offen  lds
    s_add_u32 s45, s46, 0x1c0000
    s_add_u32 m0, s47, 57344
    s_nop 0
    buffer_load_dwordx4 v21, s[24:27], s45 offen  lds
    s_add_u32 s45, s46, 0x1e0000
    s_add_u32 m0, s47, 61440
    s_nop 0
    buffer_load_dwordx4 v21, s[24:27], s45 offen  lds
    s_add_u32 s45, s46, 0x200000
    s_add_u32 m0, s47, 65536
    s_nop 0
    buffer_load_dwordx4 v21, s[24:27], s45 offen  lds
    s_add_u32 s45, s46, 0x220000
    s_add_u32 m0, s47, 69632
    s_nop 0
    buffer_load_dwordx4 v21, s[24:27], s45 offen  lds
    s_add_u32 s45, s46, 0x240000
    s_add_u32 m0, s47, 73728
    s_nop 0
    buffer_load_dwordx4 v21, s[24:27], s45 offen  lds
    s_add_u32 s45, s46, 0x260000
    s_add_u32 m0, s47, 77824
    s_nop 0
    buffer_load_dwordx4 v21, s[24:27], s45 offen  lds
    s_add_u32 s45, s46, 0x280000
    s_add_u32 m0, s47, 81920
    s_nop 0
    buffer_load_dwordx4 v21, s[24:27], s45 offen  lds
    s_add_u32 s45, s46, 0x2a0000
    s_add_u32 m0, s47, 86016
    s_nop 0
    buffer_load_dwordx4 v21, s[24:27], s45 offen  lds
    s_add_u32 s45, s46, 0x2c0000
    s_add_u32 m0, s47, 90112
    s_nop 0
    buffer_load_dwordx4 v21, s[24:27], s45 offen  lds
    s_add_u32 s45, s46, 0x2e0000
    s_add_u32 m0, s47, 94208
    s_nop 0
    buffer_load_dwordx4 v21, s[24:27], s45 offen  lds
    s_add_u32 s45, s46, 0x300000
    s_add_u32 m0, s47, 98304
    s_nop 0
    buffer_load_dwordx4 v21, s[24:27], s45 offen  lds
    s_add_u32 s45, s46, 0x320000
    s_add_u32 m0, s47, 102400
    s_nop 0
    buffer_load_dwordx4 v21, s[24:27], s45 offen  lds
    s_add_u32 s45, s46, 0x340000
    s_add_u32 m0, s47, 106496
    s_nop 0
    buffer_load_dwordx4 v21, s[24:27], s45 offen  lds
    s_add_u32 s45, s46, 0x360000
    s_add_u32 m0, s47, 110592
    s_nop 0
    buffer_load_dwordx4 v21, s[24:27], s45 offen  lds
    s_add_u32 s45, s46, 0x380000
    s_add_u32 m0, s47, 114688
    s_nop 0
    buffer_load_dwordx4 v21, s[24:27], s45 offen  lds
    s_add_u32 s45, s46, 0x3a0000
    s_add_u32 m0, s47, 118784
    s_nop 0
    buffer_load_dwordx4 v21, s[24:27], s45 offen  lds
    s_add_u32 s45, s46, 0x3c0000
    s_add_u32 m0, s47, 122880
    s_nop 0
    buffer_load_dwordx4 v21, s[24:27], s45 offen  lds
    s_add_u32 s45, s46, 0x3e0000
    s_add_u32 m0, s47, 126976
    s_nop 0
    buffer_load_dwordx4 v21, s[24:27], s45 offen  lds
    s_waitcnt vmcnt(28)
    s_barrier
    s_add_u32 s45, s46, 0x400000
    s_add_u32 m0, s47, 131072
    s_nop 0
    buffer_load_dwordx4 v21, s[24:27], s45 offen  lds
    s_add_u32 s45, s46, 0x420000
    s_add_u32 m0, s47, 135168
    s_nop 0
    buffer_load_dwordx4 v21, s[24:27], s45 offen  lds
    s_add_u32 s45, s46, 0x440000
    s_add_u32 m0, s47, 139264
    s_nop 0
    buffer_load_dwordx4 v21, s[24:27], s45 offen  lds
    s_add_u32 s45, s46, 0x460000
    s_add_u32 m0, s47, 143360
    s_nop 0
    buffer_load_dwordx4 v21, s[24:27], s45 offen  lds
    ds_read_b64_tr_b16 a[0:1], v23 offset:0
    ds_read_b64_tr_b16 a[2:3], v23 offset:1024
    ds_read_b64_tr_b16 a[4:5], v23 offset:8
    ds_read_b64_tr_b16 a[6:7], v23 offset:1032
    ds_read_b64_tr_b16 a[8:9], v23 offset:8192
    ds_read_b64_tr_b16 a[10:11], v23 offset:9216
    ds_read_b64_tr_b16 a[12:13], v23 offset:8200
    ds_read_b64_tr_b16 a[14:15], v23 offset:9224
    s_waitcnt lgkmcnt(0)
    s_waitcnt vmcnt(28)
    s_barrier
    s_add_u32 s45, s46, 0x480000
    s_add_u32 m0, s47, 0
    s_nop 0
    buffer_load_dwordx4 v21, s[24:27], s45 offen  lds
    s_add_u32 s45, s46, 0x4a0000
    s_add_u32 m0, s47, 4096
    s_nop 0
    buffer_load_dwordx4 v21, s[24:27], s45 offen  lds
    s_add_u32 s45, s46, 0x4c0000
    s_add_u32 m0, s47, 8192
    s_nop 0
    buffer_load_dwordx4 v21, s[24:27], s45 offen  lds
    s_add_u32 s45, s46, 0x4e0000
    s_add_u32 m0, s47, 12288
    s_nop 0
    buffer_load_dwordx4 v21, s[24:27], s45 offen  lds
    ds_read_b64_tr_b16 a[16:17], v23 offset:16384
    ds_read_b64_tr_b16 a[18:19], v23 offset:17408
    ds_read_b64_tr_b16 a[20:21], v23 offset:16392
    ds_read_b64_tr_b16 a[22:23], v23 offset:17416
    ds_read_b64_tr_b16 a[24:25], v23 offset:24576
    ds_read_b64_tr_b16 a[26:27], v23 offset:25600
    ds_read_b64_tr_b16 a[28:29], v23 offset:24584
    ds_read_b64_tr_b16 a[30:31], v23 offset:25608
    s_waitcnt lgkmcnt(0)
    s_waitcnt vmcnt(28)
    s_barrier
    s_add_u32 s45, s46, 0x500000
    s_add_u32 m0, s47, 16384
    s_nop 0
    buffer_load_dwordx4 v21, s[24:27], s45 offen  lds
    s_add_u32 s45, s46, 0x520000
    s_add_u32 m0, s47, 20480
    s_nop 0
    buffer_load_dwordx4 v21, s[24:27], s45 offen  lds
    s_add_u32 s45, s46, 0x540000
    s_add_u32 m0, s47, 24576
    s_nop 0
    buffer_load_dwordx4 v21, s[24:27], s45 offen  lds
    s_add_u32 s45, s46, 0x560000
    s_add_u32 m0, s47, 28672
    s_nop 0
    buffer_load_dwordx4 v21, s[24:27], s45 offen  lds
    ds_read_b64_tr_b16 a[32:33], v23 offset:32768
    ds_read_b64_tr_b16 a[34:35], v23 offset:33792
    ds_read_b64_tr_b16 a[36:37], v23 offset:32776
    ds_read_b64_tr_b16 a[38:39], v23 offset:33800
    ds_read_b64_tr_b16 a[40:41], v23 offset:40960
    ds_read_b64_tr_b16 a[42:43], v23 offset:41984
    ds_read_b64_tr_b16 a[44:45], v23 offset:40968
    ds_read_b64_tr_b16 a[46:47], v23 offset:41992
    s_waitcnt lgkmcnt(0)
    s_waitcnt vmcnt(28)
    s_barrier
    s_add_u32 s45, s46, 0x580000
    s_add_u32 m0, s47, 32768
    s_nop 0
    buffer_load_dwordx4 v21, s[24:27], s45 offen  lds
    s_add_u32 s45, s46, 0x5a0000
    s_add_u32 m0, s47, 36864
    s_nop 0
    buffer_load_dwordx4 v21, s[24:27], s45 offen  lds
    s_add_u32 s45, s46, 0x5c0000
    s_add_u32 m0, s47, 40960
    s_nop 0
    buffer_load_dwordx4 v21, s[24:27], s45 offen  lds
    s_add_u32 s45, s46, 0x5e0000
    s_add_u32 m0, s47, 45056
    s_nop 0
    buffer_load_dwordx4 v21, s[24:27], s45 offen  lds
    ds_read_b64_tr_b16 a[48:49], v23 offset:49152
    ds_read_b64_tr_b16 a[50:51], v23 offset:50176
    ds_read_b64_tr_b16 a[52:53], v23 offset:49160
    ds_read_b64_tr_b16 a[54:55], v23 offset:50184
    ds_read_b64_tr_b16 a[56:57], v23 offset:57344
    ds_read_b64_tr_b16 a[58:59], v23 offset:58368
    ds_read_b64_tr_b16 a[60:61], v23 offset:57352
    ds_read_b64_tr_b16 a[62:63], v23 offset:58376
    s_waitcnt lgkmcnt(0)
    s_waitcnt vmcnt(28)
    s_barrier
    s_add_u32 s45, s46, 0x600000
    s_add_u32 m0, s47, 49152
    s_nop 0
    buffer_load_dwordx4 v21, s[24:27], s45 offen  lds
    s_add_u32 s45, s46, 0x620000
    s_add_u32 m0, s47, 53248
    s_nop 0
    buffer_load_dwordx4 v21, s[24:27], s45 offen  lds
    s_add_u32 s45, s46, 0x640000
    s_add_u32 m0, s47, 57344
    s_nop 0
    buffer_load_dwordx4 v21, s[24:27], s45 offen  lds
    s_add_u32 s45, s46, 0x660000
    s_add_u32 m0, s47, 61440
    s_nop 0
    buffer_load_dwordx4 v21, s[24:27], s45 offen  lds
    ds_read_b64_tr_b16 a[64:65], v24 offset:0
    ds_read_b64_tr_b16 a[66:67], v24 offset:1024
    ds_read_b64_tr_b16 a[68:69], v24 offset:8
    ds_read_b64_tr_b16 a[70:71], v24 offset:1032
    ds_read_b64_tr_b16 a[72:73], v24 offset:8192
    ds_read_b64_tr_b16 a[74:75], v24 offset:9216
    ds_read_b64_tr_b16 a[76:77], v24 offset:8200
    ds_read_b64_tr_b16 a[78:79], v24 offset:9224
    s_waitcnt lgkmcnt(0)
    s_waitcnt vmcnt(28)
    s_barrier
    s_add_u32 s45, s46, 0x680000
    s_add_u32 m0, s47, 65536
    s_nop 0
    buffer_load_dwordx4 v21, s[24:27], s45 offen  lds
    s_add_u32 s45, s46, 0x6a0000
    s_add_u32 m0, s47, 69632
    s_nop 0
    buffer_load_dwordx4 v21, s[24:27], s45 offen  lds
    s_add_u32 s45, s46, 0x6c0000
    s_add_u32 m0, s47, 73728
    s_nop 0
    buffer_load_dwordx4 v21, s[24:27], s45 offen  lds
    s_add_u32 s45, s46, 0x6e0000
    s_add_u32 m0, s47, 77824
    s_nop 0
    buffer_load_dwordx4 v21, s[24:27], s45 offen  lds
    ds_read_b64_tr_b16 a[80:81], v24 offset:16384
    ds_read_b64_tr_b16 a[82:83], v24 offset:17408
    ds_read_b64_tr_b16 a[84:85], v24 offset:16392
    ds_read_b64_tr_b16 a[86:87], v24 offset:17416
    ds_read_b64_tr_b16 a[88:89], v24 offset:24576
    ds_read_b64_tr_b16 a[90:91], v24 offset:25600
    ds_read_b64_tr_b16 a[92:93], v24 offset:24584
    ds_read_b64_tr_b16 a[94:95], v24 offset:25608
    s_waitcnt lgkmcnt(0)
    s_waitcnt vmcnt(28)
    s_barrier
    s_add_u32 s45, s46, 0x700000
    s_add_u32 m0, s47, 81920
    s_nop 0
    buffer_load_dwordx4 v21, s[24:27], s45 offen  lds
    s_add_u32 s45, s46, 0x720000
    s_add_u32 m0, s47, 86016
    s_nop 0
    buffer_load_dwordx4 v21, s[24:27], s45 offen  lds
    s_add_u32 s45, s46, 0x740000
    s_add_u32 m0, s47, 90112
    s_nop 0
    buffer_load_dwordx4 v21, s[24:27], s45 offen  lds
    s_add_u32 s45, s46, 0x760000
    s_add_u32 m0, s47, 94208
    s_nop 0
    buffer_load_dwordx4 v21, s[24:27], s45 offen  lds
    ds_read_b64_tr_b16 a[96:97], v24 offset:32768
    ds_read_b64_tr_b16 a[98:99], v24 offset:33792
    ds_read_b64_tr_b16 a[100:101], v24 offset:32776
    ds_read_b64_tr_b16 a[102:103], v24 offset:33800
    ds_read_b64_tr_b16 a[104:105], v24 offset:40960
    ds_read_b64_tr_b16 a[106:107], v24 offset:41984
    ds_read_b64_tr_b16 a[108:109], v24 offset:40968
    ds_read_b64_tr_b16 a[110:111], v24 offset:41992
    s_waitcnt lgkmcnt(0)
    s_waitcnt vmcnt(28)
    s_barrier
    s_add_u32 s45, s46, 0x780000
    s_add_u32 m0, s47, 98304
    s_nop 0
    buffer_load_dwordx4 v21, s[24:27], s45 offen  lds
    s_add_u32 s45, s46, 0x7a0000
    s_add_u32 m0, s47, 102400
    s_nop 0
    buffer_load_dwordx4 v21, s[24:27], s45 offen  lds
    s_add_u32 s45, s46, 0x7c0000
    s_add_u32 m0, s47, 106496
    s_nop 0
    buffer_load_dwordx4 v21, s[24:27], s45 offen  lds
    s_add_u32 s45, s46, 0x7e0000
    s_add_u32 m0, s47, 110592
    s_nop 0
    buffer_load_dwordx4 v21, s[24:27], s45 offen  lds
    ds_read_b64_tr_b16 a[112:113], v24 offset:49152
    ds_read_b64_tr_b16 a[114:115], v24 offset:50176
    ds_read_b64_tr_b16 a[116:117], v24 offset:49160
    ds_read_b64_tr_b16 a[118:119], v24 offset:50184
    ds_read_b64_tr_b16 a[120:121], v24 offset:57344
    ds_read_b64_tr_b16 a[122:123], v24 offset:58368
    ds_read_b64_tr_b16 a[124:125], v24 offset:57352
    ds_read_b64_tr_b16 a[126:127], v24 offset:58376
    s_waitcnt lgkmcnt(0)
    s_waitcnt vmcnt(28)
    s_barrier
    ds_read_b64_tr_b16 a[128:129], v25 offset:0
    ds_read_b64_tr_b16 a[130:131], v25 offset:1024
    ds_read_b64_tr_b16 a[132:133], v25 offset:8
    ds_read_b64_tr_b16 a[134:135], v25 offset:1032
    ds_read_b64_tr_b16 a[136:137], v25 offset:8192
    ds_read_b64_tr_b16 a[138:139], v25 offset:9216
    ds_read_b64_tr_b16 a[140:141], v25 offset:8200
    ds_read_b64_tr_b16 a[142:143], v25 offset:9224
    s_waitcnt lgkmcnt(0)
    s_waitcnt vmcnt(24)
    s_barrier
    ds_read_b64_tr_b16 a[144:145], v23 offset:0
    ds_read_b64_tr_b16 a[146:147], v23 offset:1024
    ds_read_b64_tr_b16 a[148:149], v23 offset:8
    ds_read_b64_tr_b16 a[150:151], v23 offset:1032
    ds_read_b64_tr_b16 a[152:153], v23 offset:8192
    ds_read_b64_tr_b16 a[154:155], v23 offset:9216
    ds_read_b64_tr_b16 a[156:157], v23 offset:8200
    ds_read_b64_tr_b16 a[158:159], v23 offset:9224
    s_waitcnt lgkmcnt(0)
    s_waitcnt vmcnt(20)
    s_barrier
    ds_read_b64_tr_b16 a[160:161], v23 offset:16384
    ds_read_b64_tr_b16 a[162:163], v23 offset:17408
    ds_read_b64_tr_b16 a[164:165], v23 offset:16392
    ds_read_b64_tr_b16 a[166:167], v23 offset:17416
    ds_read_b64_tr_b16 a[168:169], v23 offset:24576
    ds_read_b64_tr_b16 a[170:171], v23 offset:25600
    ds_read_b64_tr_b16 a[172:173], v23 offset:24584
    ds_read_b64_tr_b16 a[174:175], v23 offset:25608
    s_waitcnt lgkmcnt(0)
    s_waitcnt vmcnt(16)
    s_barrier
    ds_read_b64_tr_b16 a[176:177], v23 offset:32768
    ds_read_b64_tr_b16 a[178:179], v23 offset:33792
    ds_read_b64_tr_b16 a[180:181], v23 offset:32776
    ds_read_b64_tr_b16 a[182:183], v23 offset:33800
    ds_read_b64_tr_b16 a[184:185], v23 offset:40960
    ds_read_b64_tr_b16 a[186:187], v23 offset:41984
    ds_read_b64_tr_b16 a[188:189], v23 offset:40968
    ds_read_b64_tr_b16 a[190:191], v23 offset:41992
    s_waitcnt lgkmcnt(0)
    s_waitcnt vmcnt(12)
    s_barrier
    ds_read_b64_tr_b16 a[192:193], v23 offset:49152
    ds_read_b64_tr_b16 a[194:195], v23 offset:50176
    ds_read_b64_tr_b16 a[196:197], v23 offset:49160
    ds_read_b64_tr_b16 a[198:199], v23 offset:50184
    ds_read_b64_tr_b16 a[200:201], v23 offset:57344
    ds_read_b64_tr_b16 a[202:203], v23 offset:58368
    ds_read_b64_tr_b16 a[204:205], v23 offset:57352
    ds_read_b64_tr_b16 a[206:207], v23 offset:58376
    s_waitcnt lgkmcnt(0)
    s_waitcnt vmcnt(8)
    s_barrier
    ds_read_b64_tr_b16 a[208:209], v24 offset:0
    ds_read_b64_tr_b16 a[210:211], v24 offset:1024
    ds_read_b64_tr_b16 a[212:213], v24 offset:8
    ds_read_b64_tr_b16 a[214:215], v24 offset:1032
    ds_read_b64_tr_b16 a[216:217], v24 offset:8192
    ds_read_b64_tr_b16 a[218:219], v24 offset:9216
    ds_read_b64_tr_b16 a[220:221], v24 offset:8200
    ds_read_b64_tr_b16 a[222:223], v24 offset:9224
    s_waitcnt lgkmcnt(0)
    s_waitcnt vmcnt(4)
    s_barrier
    ds_read_b64_tr_b16 a[224:225], v24 offset:16384
    ds_read_b64_tr_b16 a[226:227], v24 offset:17408
    ds_read_b64_tr_b16 a[228:229], v24 offset:16392
    ds_read_b64_tr_b16 a[230:231], v24 offset:17416
    ds_read_b64_tr_b16 a[232:233], v24 offset:24576
    ds_read_b64_tr_b16 a[234:235], v24 offset:25600
    ds_read_b64_tr_b16 a[236:237], v24 offset:24584
    ds_read_b64_tr_b16 a[238:239], v24 offset:25608
    s_waitcnt lgkmcnt(0)
    s_waitcnt vmcnt(0)
    s_barrier
    ds_read_b64_tr_b16 a[240:241], v24 offset:32768
    ds_read_b64_tr_b16 a[242:243], v24 offset:33792
    ds_read_b64_tr_b16 a[244:245], v24 offset:32776
    ds_read_b64_tr_b16 a[246:247], v24 offset:33800
    ds_read_b64_tr_b16 a[248:249], v24 offset:40960
    ds_read_b64_tr_b16 a[250:251], v24 offset:41984
    ds_read_b64_tr_b16 a[252:253], v24 offset:40968
    ds_read_b64_tr_b16 a[254:255], v24 offset:41992
    s_waitcnt lgkmcnt(0)
    s_barrier
    s_cmp_lg_u32 s44, 0
    s_cbranch_scc1 L_pd_114
    v_mov_b32 v29, 8
    s_mov_b32 s46, 32
    s_mov_b64 exec, 1
    s_mov_b32 s70, 0
L_wp_115:
    buffer_load_dword v31, v29, s[16:19], 0 offen sc1
    s_add_u32 s70, s70, 1
    s_cmp_ge_u32 s70, 0x200000
    s_cbranch_scc1 L_w_done_98
    s_waitcnt vmcnt(0)
    v_cmp_gt_u32 vcc, s46, v31
    s_nop 1
    s_cbranch_vccz L_wp_115_ok
    s_sleep 3
    s_branch L_wp_115
L_wp_115_ok:
    s_mov_b64 exec, -1
L_pd_114:
    s_barrier
    s_mov_b32 s60, 0
    s_mov_b32 s51, 1
    s_mov_b32 s71, 126976
    s_mov_b32 s52, 0x400000
    s_lshl_b32 s56, s39, 19
    s_add_u32 s56, s56, 0x2000000
L_w_qkv_116:
    s_cmp_lg_u32 s44, 0
    s_cbranch_scc1 L_pd_117
    v_mov_b32 v29, s71
    s_mov_b32 s46, 96
    s_mov_b64 exec, 1
    s_mov_b32 s70, 0
L_wp_118:
    buffer_load_dword v31, v29, s[12:15], 0 offen sc1
    s_add_u32 s70, s70, 1
    s_cmp_ge_u32 s70, 0x200000
    s_cbranch_scc1 L_w_done_98
    s_waitcnt vmcnt(0)
    v_cmp_gt_u32 vcc, s46, v31
    s_nop 1
    s_cbranch_vccz L_wp_118_ok
    s_sleep 2
    s_branch L_wp_118
L_wp_118_ok:
    s_mov_b64 exec, -1
L_pd_117:
    s_barrier
L_w_qkv_116_n:
    s_mov_b32 s50, s60
    s_mul_i32 s53, s50, 65536
    s_add_u32 s53, s53, s52
    s_lshl_b32 s54, s44, 13
    s_add_u32 s53, s53, s54
    s_mul_i32 s57, s50, 8192
    s_add_u32 s57, s57, s56
    s_lshl_b32 s45, s44, 11
    s_add_u32 s57, s57, s45
    s_add_u32 s55, s54, 65536
    s_mov_b32 s58, 0
    v_mov_b32 v13, v3
    v_add_u32 v14, 65536, v13
    v_xor_b32 v15, 64, v13
    v_xor_b32 v16, 64, v14
    s_mov_b32 s76, 0x20000000
    s_add_u32 s48, s53, 0
    s_add_u32 s49, s48, 4096
    s_add_u32 m0, s54, 0
    s_nop 0
    buffer_load_dwordx4 v6, s[12:15], s48 offen offset:0 sc1 lds
    s_add_u32 m0, s54, 1024
    s_nop 0
    buffer_load_dwordx4 v9, s[12:15], s48 offen offset:0 sc1 lds
    s_add_u32 m0, s54, 2048
    s_nop 0
    buffer_load_dwordx4 v6, s[12:15], s49 offen offset:0 sc1 lds
    s_add_u32 m0, s54, 3072
    s_nop 0
    buffer_load_dwordx4 v9, s[12:15], s49 offen offset:0 sc1 lds
    s_add_u32 m0, s54, 3968
    s_nop 0
    buffer_load_dwordx4 v6, s[12:15], s48 offen offset:128 sc1 lds
    s_add_u32 m0, s54, 4992
    s_nop 0
    buffer_load_dwordx4 v9, s[12:15], s48 offen offset:128 sc1 lds
    s_add_u32 m0, s54, 6016
    s_nop 0
    buffer_load_dwordx4 v6, s[12:15], s49 offen offset:128 sc1 lds
    s_add_u32 m0, s54, 7040
    s_nop 0
    buffer_load_dwordx4 v9, s[12:15], s49 offen offset:128 sc1 lds
    s_add_u32 s48, s53, 32768
    s_add_u32 s49, s48, 4096
    s_add_u32 s46, s54, 32768
    s_add_u32 m0, s46, 0
    s_nop 0
    buffer_load_dwordx4 v6, s[12:15], s48 offen offset:0 sc1 lds
    s_add_u32 m0, s46, 1024
    s_nop 0
    buffer_load_dwordx4 v9, s[12:15], s48 offen offset:0 sc1 lds
    s_add_u32 m0, s46, 2048
    s_nop 0
    buffer_load_dwordx4 v6, s[12:15], s49 offen offset:0 sc1 lds
    s_add_u32 m0, s46, 3072
    s_nop 0
    buffer_load_dwordx4 v9, s[12:15], s49 offen offset:0 sc1 lds
    s_add_u32 m0, s46, 3968
    s_nop 0
    buffer_load_dwordx4 v6, s[12:15], s48 offen offset:128 sc1 lds
    s_add_u32 m0, s46, 4992
    s_nop 0
    buffer_load_dwordx4 v9, s[12:15], s48 offen offset:128 sc1 lds
    s_add_u32 m0, s46, 6016
    s_nop 0
    buffer_load_dwordx4 v6, s[12:15], s49 offen offset:128 sc1 lds
    s_add_u32 m0, s46, 7040
    s_nop 0
    buffer_load_dwordx4 v9, s[12:15], s49 offen offset:128 sc1 lds
    s_cmp_eq_u32 s51, 1
    s_cbranch_scc1 L_e_one_120
    s_add_u32 s48, s53, 65536
    s_add_u32 s49, s48, 4096
    s_add_u32 m0, s55, 0
    s_nop 0
    buffer_load_dwordx4 v6, s[12:15], s48 offen offset:0 sc1 lds
    s_add_u32 m0, s55, 1024
    s_nop 0
    buffer_load_dwordx4 v9, s[12:15], s48 offen offset:0 sc1 lds
    s_add_u32 m0, s55, 2048
    s_nop 0
    buffer_load_dwordx4 v6, s[12:15], s49 offen offset:0 sc1 lds
    s_add_u32 m0, s55, 3072
    s_nop 0
    buffer_load_dwordx4 v9, s[12:15], s49 offen offset:0 sc1 lds
    s_add_u32 m0, s55, 3968
    s_nop 0
    buffer_load_dwordx4 v6, s[12:15], s48 offen offset:128 sc1 lds
    s_add_u32 m0, s55, 4992
    s_nop 0
    buffer_load_dwordx4 v9, s[12:15], s48 offen offset:128 sc1 lds
    s_add_u32 m0, s55, 6016
    s_nop 0
    buffer_load_dwordx4 v6, s[12:15], s49 offen offset:128 sc1 lds
    s_add_u32 m0, s55, 7040
    s_nop 0
    buffer_load_dwordx4 v9, s[12:15], s49 offen offset:128 sc1 lds
    s_waitcnt vmcnt(16)
    s_barrier
    ds_read_b128 v[32:35], v13 offset:0
    ds_read_b128 v[36:39], v13 offset:2048
    ds_read_b128 v[40:43], v15 offset:0
    ds_read_b128 v[44:47], v15 offset:2048
L_e_loop_119:
    s_add_u32 s48, s53, 98304
    s_add_u32 s46, s58, 1
    s_cmp_lt_u32 s46, s51
    s_cselect_b32 s48, s48, 0x20000000
    s_add_u32 s49, s48, 4096
    s_add_u32 s59, s55, 32768
    s_waitcnt lgkmcnt(2)
    v_mfma_f32_16x16x32_bf16 v[80:83], a[0:3], v[32:35], 0
    ds_read_b128 v[48:51], v13 offset:4096
    ds_read_b128 v[52:55], v13 offset:6144
    v_mfma_f32_16x16x32_bf16 v[84:87], a[4:7], v[32:35], 0
    ds_read_b128 v[56:59], v15 offset:4096
    ds_read_b128 v[60:63], v15 offset:6144
    s_add_u32 m0, s59, 0
    v_mfma_f32_16x16x32_bf16 v[88:91], a[0:3], v[36:39], 0
    buffer_load_dwordx4 v6, s[12:15], s48 offen offset:0 sc1 lds
    v_mfma_f32_16x16x32_bf16 v[92:95], a[4:7], v[36:39], 0
    s_waitcnt lgkmcnt(4)
    v_mfma_f32_16x16x32_bf16 v[80:83], a[8:11], v[40:43], v[80:83]
    ds_read_b128 v[32:35], v13 offset:8192
    ds_read_b128 v[36:39], v13 offset:10240
    v_mfma_f32_16x16x32_bf16 v[84:87], a[12:15], v[40:43], v[84:87]
    s_add_u32 m0, s59, 1024
    v_mfma_f32_16x16x32_bf16 v[88:91], a[8:11], v[44:47], v[88:91]
    buffer_load_dwordx4 v9, s[12:15], s48 offen offset:0 sc1 lds
    v_mfma_f32_16x16x32_bf16 v[92:95], a[12:15], v[44:47], v[92:95]
    s_waitcnt lgkmcnt(4)
    v_mfma_f32_16x16x32_bf16 v[80:83], a[16:19], v[48:51], v[80:83]
    ds_read_b128 v[40:43], v15 offset:8192
    ds_read_b128 v[44:47], v15 offset:10240
    v_mfma_f32_16x16x32_bf16 v[84:87], a[20:23], v[48:51], v[84:87]
    s_add_u32 m0, s59, 2048
    v_mfma_f32_16x16x32_bf16 v[88:91], a[16:19], v[52:55], v[88:91]
    buffer_load_dwordx4 v6, s[12:15], s49 offen offset:0 sc1 lds
    v_mfma_f32_16x16x32_bf16 v[92:95], a[20:23], v[52:55], v[92:95]
    s_waitcnt lgkmcnt(4)
    v_mfma_f32_16x16x32_bf16 v[80:83], a[24:27], v[56:59], v[80:83]
    ds_read_b128 v[48:51], v13 offset:12288
    ds_read_b128 v[52:55], v13 offset:14336
    v_mfma_f32_16x16x32_bf16 v[84:87], a[28:31], v[56:59], v[84:87]
    s_add_u32 m0, s59, 3072
    v_mfma_f32_16x16x32_bf16 v[88:91], a[24:27], v[60:63], v[88:91]
    buffer_load_dwordx4 v9, s[12:15], s49 offen offset:0 sc1 lds
    v_mfma_f32_16x16x32_bf16 v[92:95], a[28:31], v[60:63], v[92:95]
    s_waitcnt lgkmcnt(4)
    v_mfma_f32_16x16x32_bf16 v[80:83], a[32:35], v[32:35], v[80:83]
    ds_read_b128 v[56:59], v15 offset:12288
    ds_read_b128 v[60:63], v15 offset:14336
    v_mfma_f32_16x16x32_bf16 v[84:87], a[36:39], v[32:35], v[84:87]
    s_add_u32 m0, s59, 3968
    v_mfma_f32_16x16x32_bf16 v[88:91], a[32:35], v[36:39], v[88:91]
    buffer_load_dwordx4 v6, s[12:15], s48 offen offset:128 sc1 lds
    v_mfma_f32_16x16x32_bf16 v[92:95], a[36:39], v[36:39], v[92:95]
    s_waitcnt lgkmcnt(4)
    v_mfma_f32_16x16x32_bf16 v[80:83], a[40:43], v[40:43], v[80:83]
    ds_read_b128 v[32:35], v13 offset:16384
    ds_read_b128 v[36:39], v13 offset:18432
    v_mfma_f32_16x16x32_bf16 v[84:87], a[44:47], v[40:43], v[84:87]
    s_add_u32 m0, s59, 4992
    v_mfma_f32_16x16x32_bf16 v[88:91], a[40:43], v[44:47], v[88:91]
    buffer_load_dwordx4 v9, s[12:15], s48 offen offset:128 sc1 lds
    v_mfma_f32_16x16x32_bf16 v[92:95], a[44:47], v[44:47], v[92:95]
    s_waitcnt lgkmcnt(4)
    v_mfma_f32_16x16x32_bf16 v[80:83], a[48:51], v[48:51], v[80:83]
    ds_read_b128 v[40:43], v15 offset:16384
    ds_read_b128 v[44:47], v15 offset:18432
    v_mfma_f32_16x16x32_bf16 v[84:87], a[52:55], v[48:51], v[84:87]
    s_add_u32 m0, s59, 6016
    v_mfma_f32_16x16x32_bf16 v[88:91], a[48:51], v[52:55], v[88:91]
    buffer_load_dwordx4 v6, s[12:15], s49 offen offset:128 sc1 lds
    v_mfma_f32_16x16x32_bf16 v[92:95], a[52:55], v[52:55], v[92:95]
    s_waitcnt lgkmcnt(4)
    v_mfma_f32_16x16x32_bf16 v[80:83], a[56:59], v[56:59], v[80:83]
    ds_read_b128 v[48:51], v13 offset:20480
    ds_read_b128 v[52:55], v13 offset:22528
    v_mfma_f32_16x16x32_bf16 v[84:87], a[60:63], v[56:59], v[84:87]
    s_add_u32 m0, s59, 7040
    v_mfma_f32_16x16x32_bf16 v[88:91], a[56:59], v[60:63], v[88:91]
    buffer_load_dwordx4 v9, s[12:15], s49 offen offset:128 sc1 lds
    v_mfma_f32_16x16x32_bf16 v[92:95], a[60:63], v[60:63], v[92:95]
    s_waitcnt lgkmcnt(4)
    v_mfma_f32_16x16x32_bf16 v[80:83], a[64:67], v[32:35], v[80:83]
    ds_read_b128 v[56:59], v15 offset:20480
    ds_read_b128 v[60:63], v15 offset:22528
    v_mfma_f32_16x16x32_bf16 v[84:87], a[68:71], v[32:35], v[84:87]
    v_mfma_f32_16x16x32_bf16 v[88:91], a[64:67], v[36:39], v[88:91]
    v_mfma_f32_16x16x32_bf16 v[92:95], a[68:71], v[36:39], v[92:95]
    s_waitcnt lgkmcnt(4)
    v_mfma_f32_16x16x32_bf16 v[80:83], a[72:75], v[40:43], v[80:83]
    ds_read_b128 v[32:35], v13 offset:24576
    ds_read_b128 v[36:39], v13 offset:26624
    v_mfma_f32_16x16x32_bf16 v[84:87], a[76:79], v[40:43], v[84:87]
    v_mfma_f32_16x16x32_bf16 v[88:91], a[72:75], v[44:47], v[88:91]
    v_mfma_f32_16x16x32_bf16 v[92:95], a[76:79], v[44:47], v[92:95]
    s_waitcnt lgkmcnt(4)
    v_mfma_f32_16x16x32_bf16 v[80:83], a[80:83], v[48:51], v[80:83]
    ds_read_b128 v[40:43], v15 offset:24576
    ds_read_b128 v[44:47], v15 offset:26624
    v_mfma_f32_16x16x32_bf16 v[84:87], a[84:87], v[48:51], v[84:87]
    v_mfma_f32_16x16x32_bf16 v[88:91], a[80:83], v[52:55], v[88:91]
    v_mfma_f32_16x16x32_bf16 v[92:95], a[84:87], v[52:55], v[92:95]
    s_waitcnt lgkmcnt(4)
    v_mfma_f32_16x16x32_bf16 v[80:83], a[88:91], v[56:59], v[80:83]
    ds_read_b128 v[48:51], v13 offset:28672
    ds_read_b128 v[52:55], v13 offset:30720
    v_mfma_f32_16x16x32_bf16 v[84:87], a[92:95], v[56:59], v[84:87]
    v_mfma_f32_16x16x32_bf16 v[88:91], a[88:91], v[60:63], v[88:91]
    v_mfma_f32_16x16x32_bf16 v[92:95], a[92:95], v[60:63], v[92:95]
    s_waitcnt lgkmcnt(4)
    v_mfma_f32_16x16x32_bf16 v[80:83], a[96:99], v[32:35], v[80:83]
    ds_read_b128 v[56:59], v15 offset:28672
    ds_read_b128 v[60:63], v15 offset:30720
    v_mfma_f32_16x16x32_bf16 v[84:87], a[100:103], v[32:35], v[84:87]
    v_mfma_f32_16x16x32_bf16 v[88:91], a[96:99], v[36:39], v[88:91]
    v_mfma_f32_16x16x32_bf16 v[92:95], a[100:103], v[36:39], v[92:95]
    s_waitcnt lgkmcnt(4)
    v_mfma_f32_16x16x32_bf16 v[80:83], a[104:107], v[40:43], v[80:83]
    v_mfma_f32_16x16x32_bf16 v[84:87], a[108:111], v[40:43], v[84:87]
    v_mfma_f32_16x16x32_bf16 v[88:91], a[104:107], v[44:47], v[88:91]
    v_mfma_f32_16x16x32_bf16 v[92:95], a[108:111], v[44:47], v[92:95]
    s_waitcnt vmcnt(16) lgkmcnt(0)
    s_barrier
    v_mfma_f32_16x16x32_bf16 v[80:83], a[112:115], v[48:51], v[80:83]
    ds_read_b128 v[32:35], v13 offset:32768
    ds_read_b128 v[36:39], v13 offset:34816
    v_mfma_f32_16x16x32_bf16 v[84:87], a[116:119], v[48:51], v[84:87]
    v_mfma_f32_16x16x32_bf16 v[88:91], a[112:115], v[52:55], v[88:91]
    v_mfma_f32_16x16x32_bf16 v[92:95], a[116:119], v[52:55], v[92:95]
    v_mfma_f32_16x16x32_bf16 v[80:83], a[120:123], v[56:59], v[80:83]
    ds_read_b128 v[40:43], v15 offset:32768
    ds_read_b128 v[44:47], v15 offset:34816
    v_mfma_f32_16x16x32_bf16 v[84:87], a[124:127], v[56:59], v[84:87]
    v_mfma_f32_16x16x32_bf16 v[88:91], a[120:123], v[60:63], v[88:91]
    v_mfma_f32_16x16x32_bf16 v[92:95], a[124:127], v[60:63], v[92:95]
    s_add_u32 s48, s53, 131072
    s_add_u32 s46, s58, 2
    s_cmp_lt_u32 s46, s51
    s_cselect_b32 s48, s48, 0x20000000
    s_add_u32 s49, s48, 4096
    s_mov_b32 s59, s54
    s_waitcnt lgkmcnt(2)
    v_mfma_f32_16x16x32_bf16 v[80:83], a[128:131], v[32:35], v[80:83]
    ds_read_b128 v[48:51], v13 offset:36864
    ds_read_b128 v[52:55], v13 offset:38912
    v_mfma_f32_16x16x32_bf16 v[84:87], a[132:135], v[32:35], v[84:87]
    ds_read_b128 v[56:59], v15 offset:36864
    ds_read_b128 v[60:63], v15 offset:38912
    s_add_u32 m0, s59, 0
    v_mfma_f32_16x16x32_bf16 v[88:91], a[128:131], v[36:39], v[88:91]
    buffer_load_dwordx4 v6, s[12:15], s48 offen offset:0 sc1 lds
    v_mfma_f32_16x16x32_bf16 v[92:95], a[132:135], v[36:39], v[92:95]
    s_waitcnt lgkmcnt(4)
    v_mfma_f32_16x16x32_bf16 v[80:83], a[136:139], v[40:43], v[80:83]
    ds_read_b128 v[32:35], v13 offset:40960
    ds_read_b128 v[36:39], v13 offset:43008
    v_mfma_f32_16x16x32_bf16 v[84:87], a[140:143], v[40:43], v[84:87]
    s_add_u32 m0, s59, 1024
    v_mfma_f32_16x16x32_bf16 v[88:91], a[136:139], v[44:47], v[88:91]
    buffer_load_dwordx4 v9, s[12:15], s48 offen offset:0 sc1 lds
    v_mfma_f32_16x16x32_bf16 v[92:95], a[140:143], v[44:47], v[92:95]
    s_waitcnt lgkmcnt(4)
    v_mfma_f32_16x16x32_bf16 v[80:83], a[144:147], v[48:51], v[80:83]
    ds_read_b128 v[40:43], v15 offset:40960
    ds_read_b128 v[44:47], v15 offset:43008
    v_mfma_f32_16x16x32_bf16 v[84:87], a[148:151], v[48:51], v[84:87]
    s_add_u32 m0, s59, 2048
    v_mfma_f32_16x16x32_bf16 v[88:91], a[144:147], v[52:55], v[88:91]
    buffer_load_dwordx4 v6, s[12:15], s49 offen offset:0 sc1 lds
    v_mfma_f32_16x16x32_bf16 v[92:95], a[148:151], v[52:55], v[92:95]
    s_waitcnt lgkmcnt(4)
    v_mfma_f32_16x16x32_bf16 v[80:83], a[152:155], v[56:59], v[80:83]
    ds_read_b128 v[48:51], v13 offset:45056
    ds_read_b128 v[52:55], v13 offset:47104
    v_mfma_f32_16x16x32_bf16 v[84:87], a[156:159], v[56:59], v[84:87]
    s_add_u32 m0, s59, 3072
    v_mfma_f32_16x16x32_bf16 v[88:91], a[152:155], v[60:63], v[88:91]
    buffer_load_dwordx4 v9, s[12:15], s49 offen offset:0 sc1 lds
    v_mfma_f32_16x16x32_bf16 v[92:95], a[156:159], v[60:63], v[92:95]
    s_waitcnt lgkmcnt(4)
    v_mfma_f32_16x16x32_bf16 v[80:83], a[160:163], v[32:35], v[80:83]
    ds_read_b128 v[56:59], v15 offset:45056
    ds_read_b128 v[60:63], v15 offset:47104
    v_mfma_f32_16x16x32_bf16 v[84:87], a[164:167], v[32:35], v[84:87]
    s_add_u32 m0, s59, 3968
    v_mfma_f32_16x16x32_bf16 v[88:91], a[160:163], v[36:39], v[88:91]
    buffer_load_dwordx4 v6, s[12:15], s48 offen offset:128 sc1 lds
    v_mfma_f32_16x16x32_bf16 v[92:95], a[164:167], v[36:39], v[92:95]
    s_waitcnt lgkmcnt(4)
    v_mfma_f32_16x16x32_bf16 v[80:83], a[168:171], v[40:43], v[80:83]
    ds_read_b128 v[32:35], v13 offset:49152
    ds_read_b128 v[36:39], v13 offset:51200
    v_mfma_f32_16x16x32_bf16 v[84:87], a[172:175], v[40:43], v[84:87]
    s_add_u32 m0, s59, 4992
    v_mfma_f32_16x16x32_bf16 v[88:91], a[168:171], v[44:47], v[88:91]
    buffer_load_dwordx4 v9, s[12:15], s48 offen offset:128 sc1 lds
    v_mfma_f32_16x16x32_bf16 v[92:95], a[172:175], v[44:47], v[92:95]
    s_waitcnt lgkmcnt(4)
    v_mfma_f32_16x16x32_bf16 v[80:83], a[176:179], v[48:51], v[80:83]
    ds_read_b128 v[40:43], v15 offset:49152
    ds_read_b128 v[44:47], v15 offset:51200
    v_mfma_f32_16x16x32_bf16 v[84:87], a[180:183], v[48:51], v[84:87]
    s_add_u32 m0, s59, 6016
    v_mfma_f32_16x16x32_bf16 v[88:91], a[176:179], v[52:55], v[88:91]
    buffer_load_dwordx4 v6, s[12:15], s49 offen offset:128 sc1 lds
    v_mfma_f32_16x16x32_bf16 v[92:95], a[180:183], v[52:55], v[92:95]
    s_waitcnt lgkmcnt(4)
    v_mfma_f32_16x16x32_bf16 v[80:83], a[184:187], v[56:59], v[80:83]
    ds_read_b128 v[48:51], v13 offset:53248
    ds_read_b128 v[52:55], v13 offset:55296
    v_mfma_f32_16x16x32_bf16 v[84:87], a[188:191], v[56:59], v[84:87]
    s_add_u32 m0, s59, 7040
    v_mfma_f32_16x16x32_bf16 v[88:91], a[184:187], v[60:63], v[88:91]
    buffer_load_dwordx4 v9, s[12:15], s49 offen offset:128 sc1 lds
    v_mfma_f32_16x16x32_bf16 v[92:95], a[188:191], v[60:63], v[92:95]
    s_waitcnt lgkmcnt(4)
    v_mfma_f32_16x16x32_bf16 v[80:83], a[192:195], v[32:35], v[80:83]
    ds_read_b128 v[56:59], v15 offset:53248
    ds_read_b128 v[60:63], v15 offset:55296
    v_mfma_f32_16x16x32_bf16 v[84:87], a[196:199], v[32:35], v[84:87]
    v_mfma_f32_16x16x32_bf16 v[88:91], a[192:195], v[36:39], v[88:91]
    v_mfma_f32_16x16x32_bf16 v[92:95], a[196:199], v[36:39], v[92:95]
    s_waitcnt lgkmcnt(4)
    v_mfma_f32_16x16x32_bf16 v[80:83], a[200:203], v[40:43], v[80:83]
    ds_read_b128 v[32:35], v13 offset:57344
    ds_read_b128 v[36:39], v13 offset:59392
    v_mfma_f32_16x16x32_bf16 v[84:87], a[204:207], v[40:43], v[84:87]
    v_mfma_f32_16x16x32_bf16 v[88:91], a[200:203], v[44:47], v[88:91]
    v_mfma_f32_16x16x32_bf16 v[92:95], a[204:207], v[44:47], v[92:95]
    s_waitcnt lgkmcnt(4)
    v_mfma_f32_16x16x32_bf16 v[80:83], a[208:211], v[48:51], v[80:83]
    ds_read_b128 v[40:43], v15 offset:57344
    ds_read_b128 v[44:47], v15 offset:59392
    v_mfma_f32_16x16x32_bf16 v[84:87], a[212:215], v[48:51], v[84:87]
    v_mfma_f32_16x16x32_bf16 v[88:91], a[208:211], v[52:55], v[88:91]
    v_mfma_f32_16x16x32_bf16 v[92:95], a[212:215], v[52:55], v[92:95]
    s_waitcnt lgkmcnt(4)
    v_mfma_f32_16x16x32_bf16 v[80:83], a[216:219], v[56:59], v[80:83]
    ds_read_b128 v[48:51], v13 offset:61440
    ds_read_b128 v[52:55], v13 offset:63488
    v_mfma_f32_16x16x32_bf16 v[84:87], a[220:223], v[56:59], v[84:87]
    v_mfma_f32_16x16x32_bf16 v[88:91], a[216:219], v[60:63], v[88:91]
    v_mfma_f32_16x16x32_bf16 v[92:95], a[220:223], v[60:63], v[92:95]
    s_waitcnt lgkmcnt(4)
    v_mfma_f32_16x16x32_bf16 v[80:83], a[224:227], v[32:35], v[80:83]
    ds_read_b128 v[56:59], v15 offset:61440
    ds_read_b128 v[60:63], v15 offset:63488
    v_mfma_f32_16x16x32_bf16 v[84:87], a[228:231], v[32:35], v[84:87]
    v_mfma_f32_16x16x32_bf16 v[88:91], a[224:227], v[36:39], v[88:91]
    v_mfma_f32_16x16x32_bf16 v[92:95], a[228:231], v[36:39], v[92:95]
    s_waitcnt lgkmcnt(4)
    v_mfma_f32_16x16x32_bf16 v[80:83], a[232:235], v[40:43], v[80:83]
    v_mfma_f32_16x16x32_bf16 v[84:87], a[236:239], v[40:43], v[84:87]
    v_mfma_f32_16x16x32_bf16 v[88:91], a[232:235], v[44:47], v[88:91]
    v_mfma_f32_16x16x32_bf16 v[92:95], a[236:239], v[44:47], v[92:95]
    s_waitcnt vmcnt(16) lgkmcnt(0)
    s_barrier
    s_cmp_lg_u32 s44, 0
    s_cbranch_scc1 L_e_pr_122
    s_add_u32 s45, s58, s60
    v_mov_b32 v30, s45
    v_mov_b32 v31, 0
    s_mov_b64 exec, 1
    buffer_store_dword v30, v31, s[12:15], s61 offen sc1
    s_mov_b64 exec, -1
L_e_pr_122:
    v_mfma_f32_16x16x32_bf16 v[80:83], a[240:243], v[48:51], v[80:83]
    ds_read_b128 v[32:35], v14 offset:0
    ds_read_b128 v[36:39], v14 offset:2048
    v_mfma_f32_16x16x32_bf16 v[84:87], a[244:247], v[48:51], v[84:87]
    v_mfma_f32_16x16x32_bf16 v[88:91], a[240:243], v[52:55], v[88:91]
    v_mfma_f32_16x16x32_bf16 v[92:95], a[244:247], v[52:55], v[92:95]
    v_mfma_f32_16x16x32_bf16 v[80:83], a[248:251], v[56:59], v[80:83]
    ds_read_b128 v[40:43], v16 offset:0
    ds_read_b128 v[44:47], v16 offset:2048
    v_mfma_f32_16x16x32_bf16 v[84:87], a[252:255], v[56:59], v[84:87]
    v_mfma_f32_16x16x32_bf16 v[88:91], a[248:251], v[60:63], v[88:91]
    v_mfma_f32_16x16x32_bf16 v[92:95], a[252:255], v[60:63], v[92:95]
    s_add_u32 s53, s53, 65536
    s_add_u32 s58, s58, 1
    v_swap_b32 v13, v14
    s_xor_b32 s54, s54, 65536
    s_xor_b32 s55, s55, 65536
    s_mov_b32 s76, s57
    v_swap_b32 v15, v16
    s_add_u32 s57, s57, 8192
    v_cvt_pk_bf16_f32 v216, v80, v81
    v_cvt_pk_bf16_f32 v217, v82, v83
    v_cvt_pk_bf16_f32 v218, v84, v85
    v_cvt_pk_bf16_f32 v219, v86, v87
    v_cvt_pk_bf16_f32 v220, v88, v89
    v_cvt_pk_bf16_f32 v221, v90, v91
    v_cvt_pk_bf16_f32 v222, v92, v93
    v_cvt_pk_bf16_f32 v223, v94, v95
    buffer_store_dwordx4 v[216:219], v10, s[12:15], s76 offen sc1
    buffer_store_dwordx4 v[220:223], v10, s[12:15], s76 offen offset:1024 sc1
    s_cmp_lt_u32 s58, s51
    s_cbranch_scc1 L_e_loop_119
    s_branch L_e_fin_121
L_e_one_120:
    s_waitcnt vmcnt(8)
    s_barrier
    ds_read_b128 v[32:35], v13 offset:0
    ds_read_b128 v[36:39], v13 offset:2048
    ds_read_b128 v[40:43], v15 offset:0
    ds_read_b128 v[44:47], v15 offset:2048
    s_waitcnt lgkmcnt(2)
    v_mfma_f32_16x16x32_bf16 v[80:83], a[0:3], v[32:35], 0
    ds_read_b128 v[48:51], v13 offset:4096
    ds_read_b128 v[52:55], v13 offset:6144
    v_mfma_f32_16x16x32_bf16 v[84:87], a[4:7], v[32:35], 0
    ds_read_b128 v[56:59], v15 offset:4096
    ds_read_b128 v[60:63], v15 offset:6144
    v_mfma_f32_16x16x32_bf16 v[88:91], a[0:3], v[36:39], 0
    v_mfma_f32_16x16x32_bf16 v[92:95], a[4:7], v[36:39], 0
    s_waitcnt lgkmcnt(4)
    v_mfma_f32_16x16x32_bf16 v[80:83], a[8:11], v[40:43], v[80:83]
    ds_read_b128 v[32:35], v13 offset:8192
    ds_read_b128 v[36:39], v13 offset:10240
    v_mfma_f32_16x16x32_bf16 v[84:87], a[12:15], v[40:43], v[84:87]
    v_mfma_f32_16x16x32_bf16 v[88:91], a[8:11], v[44:47], v[88:91]
    v_mfma_f32_16x16x32_bf16 v[92:95], a[12:15], v[44:47], v[92:95]
    s_waitcnt lgkmcnt(4)
    v_mfma_f32_16x16x32_bf16 v[80:83], a[16:19], v[48:51], v[80:83]
    ds_read_b128 v[40:43], v15 offset:8192
    ds_read_b128 v[44:47], v15 offset:10240
    v_mfma_f32_16x16x32_bf16 v[84:87], a[20:23], v[48:51], v[84:87]
    v_mfma_f32_16x16x32_bf16 v[88:91], a[16:19], v[52:55], v[88:91]
    v_mfma_f32_16x16x32_bf16 v[92:95], a[20:23], v[52:55], v[92:95]
    s_waitcnt lgkmcnt(4)
    v_mfma_f32_16x16x32_bf16 v[80:83], a[24:27], v[56:59], v[80:83]
    ds_read_b128 v[48:51], v13 offset:12288
    ds_read_b128 v[52:55], v13 offset:14336
    v_mfma_f32_16x16x32_bf16 v[84:87], a[28:31], v[56:59], v[84:87]
    v_mfma_f32_16x16x32_bf16 v[88:91], a[24:27], v[60:63], v[88:91]
    v_mfma_f32_16x16x32_bf16 v[92:95], a[28:31], v[60:63], v[92:95]
    s_waitcnt lgkmcnt(4)
    v_mfma_f32_16x16x32_bf16 v[80:83], a[32:35], v[32:35], v[80:83]
    ds_read_b128 v[56:59], v15 offset:12288
    ds_read_b128 v[60:63], v15 offset:14336
    v_mfma_f32_16x16x32_bf16 v[84:87], a[36:39], v[32:35], v[84:87]
    v_mfma_f32_16x16x32_bf16 v[88:91], a[32:35], v[36:39], v[88:91]
    v_mfma_f32_16x16x32_bf16 v[92:95], a[36:39], v[36:39], v[92:95]
    s_waitcnt lgkmcnt(4)
    v_mfma_f32_16x16x32_bf16 v[80:83], a[40:43], v[40:43], v[80:83]
    ds_read_b128 v[32:35], v13 offset:16384
    ds_read_b128 v[36:39], v13 offset:18432
    v_mfma_f32_16x16x32_bf16 v[84:87], a[44:47], v[40:43], v[84:87]
    v_mfma_f32_16x16x32_bf16 v[88:91], a[40:43], v[44:47], v[88:91]
    v_mfma_f32_16x16x32_bf16 v[92:95], a[44:47], v[44:47], v[92:95]
    s_waitcnt lgkmcnt(4)
    v_mfma_f32_16x16x32_bf16 v[80:83], a[48:51], v[48:51], v[80:83]
    ds_read_b128 v[40:43], v15 offset:16384
    ds_read_b128 v[44:47], v15 offset:18432
    v_mfma_f32_16x16x32_bf16 v[84:87], a[52:55], v[48:51], v[84:87]
    v_mfma_f32_16x16x32_bf16 v[88:91], a[48:51], v[52:55], v[88:91]
    v_mfma_f32_16x16x32_bf16 v[92:95], a[52:55], v[52:55], v[92:95]
    s_waitcnt lgkmcnt(4)
    v_mfma_f32_16x16x32_bf16 v[80:83], a[56:59], v[56:59], v[80:83]
    ds_read_b128 v[48:51], v13 offset:20480
    ds_read_b128 v[52:55], v13 offset:22528
    v_mfma_f32_16x16x32_bf16 v[84:87], a[60:63], v[56:59], v[84:87]
    v_mfma_f32_16x16x32_bf16 v[88:91], a[56:59], v[60:63], v[88:91]
    v_mfma_f32_16x16x32_bf16 v[92:95], a[60:63], v[60:63], v[92:95]
    s_waitcnt lgkmcnt(4)
    v_mfma_f32_16x16x32_bf16 v[80:83], a[64:67], v[32:35], v[80:83]
    ds_read_b128 v[56:59], v15 offset:20480
    ds_read_b128 v[60:63], v15 offset:22528
    v_mfma_f32_16x16x32_bf16 v[84:87], a[68:71], v[32:35], v[84:87]
    v_mfma_f32_16x16x32_bf16 v[88:91], a[64:67], v[36:39], v[88:91]
    v_mfma_f32_16x16x32_bf16 v[92:95], a[68:71], v[36:39], v[92:95]
    s_waitcnt lgkmcnt(4)
    v_mfma_f32_16x16x32_bf16 v[80:83], a[72:75], v[40:43], v[80:83]
    ds_read_b128 v[32:35], v13 offset:24576
    ds_read_b128 v[36:39], v13 offset:26624
    v_mfma_f32_16x16x32_bf16 v[84:87], a[76:79], v[40:43], v[84:87]
    v_mfma_f32_16x16x32_bf16 v[88:91], a[72:75], v[44:47], v[88:91]
    v_mfma_f32_16x16x32_bf16 v[92:95], a[76:79], v[44:47], v[92:95]
    s_waitcnt lgkmcnt(4)
    v_mfma_f32_16x16x32_bf16 v[80:83], a[80:83], v[48:51], v[80:83]
    ds_read_b128 v[40:43], v15 offset:24576
    ds_read_b128 v[44:47], v15 offset:26624
    v_mfma_f32_16x16x32_bf16 v[84:87], a[84:87], v[48:51], v[84:87]
    v_mfma_f32_16x16x32_bf16 v[88:91], a[80:83], v[52:55], v[88:91]
    v_mfma_f32_16x16x32_bf16 v[92:95], a[84:87], v[52:55], v[92:95]
    s_waitcnt lgkmcnt(4)
    v_mfma_f32_16x16x32_bf16 v[80:83], a[88:91], v[56:59], v[80:83]
    ds_read_b128 v[48:51], v13 offset:28672
    ds_read_b128 v[52:55], v13 offset:30720
    v_mfma_f32_16x16x32_bf16 v[84:87], a[92:95], v[56:59], v[84:87]
    v_mfma_f32_16x16x32_bf16 v[88:91], a[88:91], v[60:63], v[88:91]
    v_mfma_f32_16x16x32_bf16 v[92:95], a[92:95], v[60:63], v[92:95]
    s_waitcnt lgkmcnt(4)
    v_mfma_f32_16x16x32_bf16 v[80:83], a[96:99], v[32:35], v[80:83]
    ds_read_b128 v[56:59], v15 offset:28672
    ds_read_b128 v[60:63], v15 offset:30720
    v_mfma_f32_16x16x32_bf16 v[84:87], a[100:103], v[32:35], v[84:87]
    v_mfma_f32_16x16x32_bf16 v[88:91], a[96:99], v[36:39], v[88:91]
    v_mfma_f32_16x16x32_bf16 v[92:95], a[100:103], v[36:39], v[92:95]
    s_waitcnt lgkmcnt(4)
    v_mfma_f32_16x16x32_bf16 v[80:83], a[104:107], v[40:43], v[80:83]
    v_mfma_f32_16x16x32_bf16 v[84:87], a[108:111], v[40:43], v[84:87]
    v_mfma_f32_16x16x32_bf16 v[88:91], a[104:107], v[44:47], v[88:91]
    v_mfma_f32_16x16x32_bf16 v[92:95], a[108:111], v[44:47], v[92:95]
    s_waitcnt vmcnt(0) lgkmcnt(0)
    s_barrier
    v_mfma_f32_16x16x32_bf16 v[80:83], a[112:115], v[48:51], v[80:83]
    ds_read_b128 v[32:35], v13 offset:32768
    ds_read_b128 v[36:39], v13 offset:34816
    v_mfma_f32_16x16x32_bf16 v[84:87], a[116:119], v[48:51], v[84:87]
    v_mfma_f32_16x16x32_bf16 v[88:91], a[112:115], v[52:55], v[88:91]
    v_mfma_f32_16x16x32_bf16 v[92:95], a[116:119], v[52:55], v[92:95]
    v_mfma_f32_16x16x32_bf16 v[80:83], a[120:123], v[56:59], v[80:83]
    ds_read_b128 v[40:43], v15 offset:32768
    ds_read_b128 v[44:47], v15 offset:34816
    v_mfma_f32_16x16x32_bf16 v[84:87], a[124:127], v[56:59], v[84:87]
    v_mfma_f32_16x16x32_bf16 v[88:91], a[120:123], v[60:63], v[88:91]
    v_mfma_f32_16x16x32_bf16 v[92:95], a[124:127], v[60:63], v[92:95]
    s_waitcnt lgkmcnt(2)
    v_mfma_f32_16x16x32_bf16 v[80:83], a[128:131], v[32:35], v[80:83]
    ds_read_b128 v[48:51], v13 offset:36864
    ds_read_b128 v[52:55], v13 offset:38912
    v_mfma_f32_16x16x32_bf16 v[84:87], a[132:135], v[32:35], v[84:87]
    ds_read_b128 v[56:59], v15 offset:36864
    ds_read_b128 v[60:63], v15 offset:38912
    v_mfma_f32_16x16x32_bf16 v[88:91], a[128:131], v[36:39], v[88:91]
    v_mfma_f32_16x16x32_bf16 v[92:95], a[132:135], v[36:39], v[92:95]
    s_waitcnt lgkmcnt(4)
    v_mfma_f32_16x16x32_bf16 v[80:83], a[136:139], v[40:43], v[80:83]
    ds_read_b128 v[32:35], v13 offset:40960
    ds_read_b128 v[36:39], v13 offset:43008
    v_mfma_f32_16x16x32_bf16 v[84:87], a[140:143], v[40:43], v[84:87]
    v_mfma_f32_16x16x32_bf16 v[88:91], a[136:139], v[44:47], v[88:91]
    v_mfma_f32_16x16x32_bf16 v[92:95], a[140:143], v[44:47], v[92:95]
    s_waitcnt lgkmcnt(4)
    v_mfma_f32_16x16x32_bf16 v[80:83], a[144:147], v[48:51], v[80:83]
    ds_read_b128 v[40:43], v15 offset:40960
    ds_read_b128 v[44:47], v15 offset:43008
    v_mfma_f32_16x16x32_bf16 v[84:87], a[148:151], v[48:51], v[84:87]
    v_mfma_f32_16x16x32_bf16 v[88:91], a[144:147], v[52:55], v[88:91]
    v_mfma_f32_16x16x32_bf16 v[92:95], a[148:151], v[52:55], v[92:95]
    s_waitcnt lgkmcnt(4)
    v_mfma_f32_16x16x32_bf16 v[80:83], a[152:155], v[56:59], v[80:83]
    ds_read_b128 v[48:51], v13 offset:45056
    ds_read_b128 v[52:55], v13 offset:47104
    v_mfma_f32_16x16x32_bf16 v[84:87], a[156:159], v[56:59], v[84:87]
    v_mfma_f32_16x16x32_bf16 v[88:91], a[152:155], v[60:63], v[88:91]
    v_mfma_f32_16x16x32_bf16 v[92:95], a[156:159], v[60:63], v[92:95]
    s_waitcnt lgkmcnt(4)
    v_mfma_f32_16x16x32_bf16 v[80:83], a[160:163], v[32:35], v[80:83]
    ds_read_b128 v[56:59], v15 offset:45056
    ds_read_b128 v[60:63], v15 offset:47104
    v_mfma_f32_16x16x32_bf16 v[84:87], a[164:167], v[32:35], v[84:87]
    v_mfma_f32_16x16x32_bf16 v[88:91], a[160:163], v[36:39], v[88:91]
    v_mfma_f32_16x16x32_bf16 v[92:95], a[164:167], v[36:39], v[92:95]
    s_waitcnt lgkmcnt(4)
    v_mfma_f32_16x16x32_bf16 v[80:83], a[168:171], v[40:43], v[80:83]
    ds_read_b128 v[32:35], v13 offset:49152
    ds_read_b128 v[36:39], v13 offset:51200
    v_mfma_f32_16x16x32_bf16 v[84:87], a[172:175], v[40:43], v[84:87]
    v_mfma_f32_16x16x32_bf16 v[88:91], a[168:171], v[44:47], v[88:91]
    v_mfma_f32_16x16x32_bf16 v[92:95], a[172:175], v[44:47], v[92:95]
    s_waitcnt lgkmcnt(4)
    v_mfma_f32_16x16x32_bf16 v[80:83], a[176:179], v[48:51], v[80:83]
    ds_read_b128 v[40:43], v15 offset:49152
    ds_read_b128 v[44:47], v15 offset:51200
    v_mfma_f32_16x16x32_bf16 v[84:87], a[180:183], v[48:51], v[84:87]
    v_mfma_f32_16x16x32_bf16 v[88:91], a[176:179], v[52:55], v[88:91]
    v_mfma_f32_16x16x32_bf16 v[92:95], a[180:183], v[52:55], v[92:95]
    s_waitcnt lgkmcnt(4)
    v_mfma_f32_16x16x32_bf16 v[80:83], a[184:187], v[56:59], v[80:83]
    ds_read_b128 v[48:51], v13 offset:53248
    ds_read_b128 v[52:55], v13 offset:55296
    v_mfma_f32_16x16x32_bf16 v[84:87], a[188:191], v[56:59], v[84:87]
    v_mfma_f32_16x16x32_bf16 v[88:91], a[184:187], v[60:63], v[88:91]
    v_mfma_f32_16x16x32_bf16 v[92:95], a[188:191], v[60:63], v[92:95]
    s_waitcnt lgkmcnt(4)
    v_mfma_f32_16x16x32_bf16 v[80:83], a[192:195], v[32:35], v[80:83]
    ds_read_b128 v[56:59], v15 offset:53248
    ds_read_b128 v[60:63], v15 offset:55296
    v_mfma_f32_16x16x32_bf16 v[84:87], a[196:199], v[32:35], v[84:87]
    v_mfma_f32_16x16x32_bf16 v[88:91], a[192:195], v[36:39], v[88:91]
    v_mfma_f32_16x16x32_bf16 v[92:95], a[196:199], v[36:39], v[92:95]
    s_waitcnt lgkmcnt(4)
    v_mfma_f32_16x16x32_bf16 v[80:83], a[200:203], v[40:43], v[80:83]
    ds_read_b128 v[32:35], v13 offset:57344
    ds_read_b128 v[36:39], v13 offset:59392
    v_mfma_f32_16x16x32_bf16 v[84:87], a[204:207], v[40:43], v[84:87]
    v_mfma_f32_16x16x32_bf16 v[88:91], a[200:203], v[44:47], v[88:91]
    v_mfma_f32_16x16x32_bf16 v[92:95], a[204:207], v[44:47], v[92:95]
    s_waitcnt lgkmcnt(4)
    v_mfma_f32_16x16x32_bf16 v[80:83], a[208:211], v[48:51], v[80:83]
    ds_read_b128 v[40:43], v15 offset:57344
    ds_read_b128 v[44:47], v15 offset:59392
    v_mfma_f32_16x16x32_bf16 v[84:87], a[212:215], v[48:51], v[84:87]
    v_mfma_f32_16x16x32_bf16 v[88:91], a[208:211], v[52:55], v[88:91]
    v_mfma_f32_16x16x32_bf16 v[92:95], a[212:215], v[52:55], v[92:95]
    s_waitcnt lgkmcnt(4)
    v_mfma_f32_16x16x32_bf16 v[80:83], a[216:219], v[56:59], v[80:83]
    ds_read_b128 v[48:51], v13 offset:61440
    ds_read_b128 v[52:55], v13 offset:63488
    v_mfma_f32_16x16x32_bf16 v[84:87], a[220:223], v[56:59], v[84:87]
    v_mfma_f32_16x16x32_bf16 v[88:91], a[216:219], v[60:63], v[88:91]
    v_mfma_f32_16x16x32_bf16 v[92:95], a[220:223], v[60:63], v[92:95]
    s_waitcnt lgkmcnt(4)
    v_mfma_f32_16x16x32_bf16 v[80:83], a[224:227], v[32:35], v[80:83]
    ds_read_b128 v[56:59], v15 offset:61440
    ds_read_b128 v[60:63], v15 offset:63488
    v_mfma_f32_16x16x32_bf16 v[84:87], a[228:231], v[32:35], v[84:87]
    v_mfma_f32_16x16x32_bf16 v[88:91], a[224:227], v[36:39], v[88:91]
    v_mfma_f32_16x16x32_bf16 v[92:95], a[228:231], v[36:39], v[92:95]
    s_waitcnt lgkmcnt(4)
    v_mfma_f32_16x16x32_bf16 v[80:83], a[232:235], v[40:43], v[80:83]
    v_mfma_f32_16x16x32_bf16 v[84:87], a[236:239], v[40:43], v[84:87]
    v_mfma_f32_16x16x32_bf16 v[88:91], a[232:235], v[44:47], v[88:91]
    v_mfma_f32_16x16x32_bf16 v[92:95], a[236:239], v[44:47], v[92:95]
    s_waitcnt lgkmcnt(0)
    v_mfma_f32_16x16x32_bf16 v[80:83], a[240:243], v[48:51], v[80:83]
    v_mfma_f32_16x16x32_bf16 v[84:87], a[244:247], v[48:51], v[84:87]
    v_mfma_f32_16x16x32_bf16 v[88:91], a[240:243], v[52:55], v[88:91]
    v_mfma_f32_16x16x32_bf16 v[92:95], a[244:247], v[52:55], v[92:95]
    v_mfma_f32_16x16x32_bf16 v[80:83], a[248:251], v[56:59], v[80:83]
    v_mfma_f32_16x16x32_bf16 v[84:87], a[252:255], v[56:59], v[84:87]
    v_mfma_f32_16x16x32_bf16 v[88:91], a[248:251], v[60:63], v[88:91]
    v_mfma_f32_16x16x32_bf16 v[92:95], a[252:255], v[60:63], v[92:95]
    s_mov_b32 s76, s57
    s_nop 6
    v_cvt_pk_bf16_f32 v216, v80, v81
    v_cvt_pk_bf16_f32 v217, v82, v83
    v_cvt_pk_bf16_f32 v218, v84, v85
    v_cvt_pk_bf16_f32 v219, v86, v87
    v_cvt_pk_bf16_f32 v220, v88, v89
    v_cvt_pk_bf16_f32 v221, v90, v91
    v_cvt_pk_bf16_f32 v222, v92, v93
    v_cvt_pk_bf16_f32 v223, v94, v95
    buffer_store_dwordx4 v[216:219], v10, s[12:15], s76 offen sc1
    buffer_store_dwordx4 v[220:223], v10, s[12:15], s76 offen offset:1024 sc1
L_e_fin_121:
    s_waitcnt lgkmcnt(0)
    s_add_u32 s60, s60, s51
    s_waitcnt vmcnt(0)
    s_barrier
    s_cmp_lg_u32 s44, 0
    s_cbranch_scc1 L_pub_123
    v_mov_b32 v30, s60
    v_mov_b32 v31, 0
    s_mov_b64 exec, 1
    buffer_store_dword v30, v31, s[12:15], s61 offen sc1
    s_mov_b64 exec, -1
L_pub_123:
    s_cmp_eq_u32 s60, 2
    s_cselect_b32 s51, 10, s51
    s_cmp_eq_u32 s60, 12
    s_cselect_b32 s51, 52, s51
    s_cselect_b32 s71, 127104, s71
    s_cbranch_scc1 L_w_qkv_116
    s_cmp_lt_u32 s60, 64
    s_cbranch_scc1 L_w_qkv_116_n
L_w_roles_100:
    s_cmp_lg_u32 s44, 0
    s_cbranch_scc1 L_gj_124
    s_getreg_b32 s45, hwreg(HW_REG_XCC_ID)
    s_and_b32 s45, s45, 15
    s_mul_i32 s46, s45, s45
    s_lshl_b32 s46, s46, 9
    s_add_u32 s45, s45, s46
    s_add_u32 s45, s45, 16777216
    v_mov_b32 v30, s45
    s_lshl_b32 s45, s40, 7
    v_mov_b32 v31, 127488
    s_mov_b64 exec, 1
    buffer_atomic_add v30, v31, s[12:15], s45 offen sc1
    s_mov_b64 exec, -1
L_gj_124:
    s_mov_b32 s36, 0x1111111
    s_mov_b32 s37, 0x55222081
    s_cmp_eq_u32 s42, 0
    s_cselect_b32 s36, s36, 0x10000000
    s_cselect_b32 s37, s37, 0xaa888410
    s_mov_b32 s72, 0x88888888
    s_mov_b32 s73, 0xffd55248
    s_lshr_b32 s38, s41, 3
    s_and_b32 s68, s41, 7
    s_cmp_eq_u32 s43, 1
    s_cbranch_scc1 L_role_b_125
    s_cmp_eq_u32 s43, 2
    s_cbranch_scc1 L_role_c_126
    s_load_dwordx2 s[6:7], s[0:1], 40
    s_waitcnt lgkmcnt(0)
    s_mov_b32 s24, s6
    s_and_b32 s25, s7, 0xffff
    s_mov_b32 s26, 0x800000
    s_mov_b32 s27, 0x00020000
    s_lshl_b32 s46, s38, 21
    s_lshl_b32 s45, s68, 8
    s_add_u32 s46, s46, s45
    s_waitcnt vmcnt(0)
    s_barrier
    v_lshrrev_b32 v20, 4, v1
    s_lshl_b32 s45, s44, 2
    v_add_u32 v21, s45, v20
    s_mov_b32 s45, 2048
    v_mul_lo_u32 v21, v21, s45
    v_lshlrev_b32 v22, 2, v20
    v_and_b32 v23, 15, v1
    v_xor_b32 v22, v22, v23
    v_lshlrev_b32 v22, 4, v22
    v_add_u32 v21, v21, v22
    v_bfe_u32 v22, v1, 2, 2
    v_lshlrev_b32 v23, 2, v20
    v_add_u32 v23, v23, v22
    v_lshlrev_b32 v23, 8, v23
    v_xor_b32 v22, s44, v22
    v_lshlrev_b32 v22, 6, v22
    v_add_u32 v23, v23, v22
    v_and_b32 v22, 3, v1
    v_lshlrev_b32 v22, 3, v22
    v_add_u32 v23, v23, v22
    v_add_u32 v24, 65536, v23
    v_add_u32 v25, 131072, v23
    s_lshl_b32 s47, s44, 10
    s_add_u32 s45, s46, 0x0
    s_add_u32 m0, s47, 0
    s_nop 0
    buffer_load_dwordx4 v21, s[24:27], s45 offen  lds
    s_add_u32 s45, s46, 0x8000
    s_add_u32 m0, s47, 4096
    s_nop 0
    buffer_load_dwordx4 v21, s[24:27], s45 offen  lds
    s_add_u32 s45, s46, 0x10000
    s_add_u32 m0, s47, 8192
    s_nop 0
    buffer_load_dwordx4 v21, s[24:27], s45 offen  lds
    s_add_u32 s45, s46, 0x18000
    s_add_u32 m0, s47, 12288
    s_nop 0
    buffer_load_dwordx4 v21, s[24:27], s45 offen  lds
    s_add_u32 s45, s46, 0x20000
    s_add_u32 m0, s47, 16384
    s_nop 0
    buffer_load_dwordx4 v21, s[24:27], s45 offen  lds
    s_add_u32 s45, s46, 0x28000
    s_add_u32 m0, s47, 20480
    s_nop 0
    buffer_load_dwordx4 v21, s[24:27], s45 offen  lds
    s_add_u32 s45, s46, 0x30000
    s_add_u32 m0, s47, 24576
    s_nop 0
    buffer_load_dwordx4 v21, s[24:27], s45 offen  lds
    s_add_u32 s45, s46, 0x38000
    s_add_u32 m0, s47, 28672
    s_nop 0
    buffer_load_dwordx4 v21, s[24:27], s45 offen  lds
    s_add_u32 s45, s46, 0x40000
    s_add_u32 m0, s47, 32768
    s_nop 0
    buffer_load_dwordx4 v21, s[24:27], s45 offen  lds
    s_add_u32 s45, s46, 0x48000
    s_add_u32 m0, s47, 36864
    s_nop 0
    buffer_load_dwordx4 v21, s[24:27], s45 offen  lds
    s_add_u32 s45, s46, 0x50000
    s_add_u32 m0, s47, 40960
    s_nop 0
    buffer_load_dwordx4 v21, s[24:27], s45 offen  lds
    s_add_u32 s45, s46, 0x58000
    s_add_u32 m0, s47, 45056
    s_nop 0
    buffer_load_dwordx4 v21, s[24:27], s45 offen  lds
    s_add_u32 s45, s46, 0x60000
    s_add_u32 m0, s47, 49152
    s_nop 0
    buffer_load_dwordx4 v21, s[24:27], s45 offen  lds
    s_add_u32 s45, s46, 0x68000
    s_add_u32 m0, s47, 53248
    s_nop 0
    buffer_load_dwordx4 v21, s[24:27], s45 offen  lds
    s_add_u32 s45, s46, 0x70000
    s_add_u32 m0, s47, 57344
    s_nop 0
    buffer_load_dwordx4 v21, s[24:27], s45 offen  lds
    s_add_u32 s45, s46, 0x78000
    s_add_u32 m0, s47, 61440
    s_nop 0
    buffer_load_dwordx4 v21, s[24:27], s45 offen  lds
    s_add_u32 s45, s46, 0x80000
    s_add_u32 m0, s47, 65536
    s_nop 0
    buffer_load_dwordx4 v21, s[24:27], s45 offen  lds
    s_add_u32 s45, s46, 0x88000
    s_add_u32 m0, s47, 69632
    s_nop 0
    buffer_load_dwordx4 v21, s[24:27], s45 offen  lds
    s_add_u32 s45, s46, 0x90000
    s_add_u32 m0, s47, 73728
    s_nop 0
    buffer_load_dwordx4 v21, s[24:27], s45 offen  lds
    s_add_u32 s45, s46, 0x98000
    s_add_u32 m0, s47, 77824
    s_nop 0
    buffer_load_dwordx4 v21, s[24:27], s45 offen  lds
    s_add_u32 s45, s46, 0xa0000
    s_add_u32 m0, s47, 81920
    s_nop 0
    buffer_load_dwordx4 v21, s[24:27], s45 offen  lds
    s_add_u32 s45, s46, 0xa8000
    s_add_u32 m0, s47, 86016
    s_nop 0
    buffer_load_dwordx4 v21, s[24:27], s45 offen  lds
    s_add_u32 s45, s46, 0xb0000
    s_add_u32 m0, s47, 90112
    s_nop 0
    buffer_load_dwordx4 v21, s[24:27], s45 offen  lds
    s_add_u32 s45, s46, 0xb8000
    s_add_u32 m0, s47, 94208
    s_nop 0
    buffer_load_dwordx4 v21, s[24:27], s45 offen  lds
    s_add_u32 s45, s46, 0xc0000
    s_add_u32 m0, s47, 98304
    s_nop 0
    buffer_load_dwordx4 v21, s[24:27], s45 offen  lds
    s_add_u32 s45, s46, 0xc8000
    s_add_u32 m0, s47, 102400
    s_nop 0
    buffer_load_dwordx4 v21, s[24:27], s45 offen  lds
    s_add_u32 s45, s46, 0xd0000
    s_add_u32 m0, s47, 106496
    s_nop 0
    buffer_load_dwordx4 v21, s[24:27], s45 offen  lds
    s_add_u32 s45, s46, 0xd8000
    s_add_u32 m0, s47, 110592
    s_nop 0
    buffer_load_dwordx4 v21, s[24:27], s45 offen  lds
    s_add_u32 s45, s46, 0xe0000
    s_add_u32 m0, s47, 114688
    s_nop 0
    buffer_load_dwordx4 v21, s[24:27], s45 offen  lds
    s_add_u32 s45, s46, 0xe8000
    s_add_u32 m0, s47, 118784
    s_nop 0
    buffer_load_dwordx4 v21, s[24:27], s45 offen  lds
    s_add_u32 s45, s46, 0xf0000
    s_add_u32 m0, s47, 122880
    s_nop 0
    buffer_load_dwordx4 v21, s[24:27], s45 offen  lds
    s_add_u32 s45, s46, 0xf8000
    s_add_u32 m0, s47, 126976
    s_nop 0
    buffer_load_dwordx4 v21, s[24:27], s45 offen  lds
    s_waitcnt vmcnt(28)
    s_barrier
    s_add_u32 s45, s46, 0x100000
    s_add_u32 m0, s47, 131072
    s_nop 0
    buffer_load_dwordx4 v21, s[24:27], s45 offen  lds
    s_add_u32 s45, s46, 0x108000
    s_add_u32 m0, s47, 135168
    s_nop 0
    buffer_load_dwordx4 v21, s[24:27], s45 offen  lds
    s_add_u32 s45, s46, 0x110000
    s_add_u32 m0, s47, 139264
    s_nop 0
    buffer_load_dwordx4 v21, s[24:27], s45 offen  lds
    s_add_u32 s45, s46, 0x118000
    s_add_u32 m0, s47, 143360
    s_nop 0
    buffer_load_dwordx4 v21, s[24:27], s45 offen  lds
    ds_read_b64_tr_b16 a[0:1], v23 offset:0
    ds_read_b64_tr_b16 a[2:3], v23 offset:4096
    ds_read_b64_tr_b16 a[4:5], v23 offset:32
    ds_read_b64_tr_b16 a[6:7], v23 offset:4128
    ds_read_b64_tr_b16 a[8:9], v23 offset:8192
    ds_read_b64_tr_b16 a[10:11], v23 offset:12288
    ds_read_b64_tr_b16 a[12:13], v23 offset:8224
    ds_read_b64_tr_b16 a[14:15], v23 offset:12320
    s_waitcnt lgkmcnt(0)
    s_waitcnt vmcnt(28)
    s_barrier
    s_add_u32 s45, s46, 0x120000
    s_add_u32 m0, s47, 0
    s_nop 0
    buffer_load_dwordx4 v21, s[24:27], s45 offen  lds
    s_add_u32 s45, s46, 0x128000
    s_add_u32 m0, s47, 4096
    s_nop 0
    buffer_load_dwordx4 v21, s[24:27], s45 offen  lds
    s_add_u32 s45, s46, 0x130000
    s_add_u32 m0, s47, 8192
    s_nop 0
    buffer_load_dwordx4 v21, s[24:27], s45 offen  lds
    s_add_u32 s45, s46, 0x138000
    s_add_u32 m0, s47, 12288
    s_nop 0
    buffer_load_dwordx4 v21, s[24:27], s45 offen  lds
    ds_read_b64_tr_b16 a[16:17], v23 offset:16384
    ds_read_b64_tr_b16 a[18:19], v23 offset:20480
    ds_read_b64_tr_b16 a[20:21], v23 offset:16416
    ds_read_b64_tr_b16 a[22:23], v23 offset:20512
    ds_read_b64_tr_b16 a[24:25], v23 offset:24576
    ds_read_b64_tr_b16 a[26:27], v23 offset:28672
    ds_read_b64_tr_b16 a[28:29], v23 offset:24608
    ds_read_b64_tr_b16 a[30:31], v23 offset:28704
    s_waitcnt lgkmcnt(0)
    s_waitcnt vmcnt(28)
    s_barrier
    s_add_u32 s45, s46, 0x140000
    s_add_u32 m0, s47, 16384
    s_nop 0
    buffer_load_dwordx4 v21, s[24:27], s45 offen  lds
    s_add_u32 s45, s46, 0x148000
    s_add_u32 m0, s47, 20480
    s_nop 0
    buffer_load_dwordx4 v21, s[24:27], s45 offen  lds
    s_add_u32 s45, s46, 0x150000
    s_add_u32 m0, s47, 24576
    s_nop 0
    buffer_load_dwordx4 v21, s[24:27], s45 offen  lds
    s_add_u32 s45, s46, 0x158000
    s_add_u32 m0, s47, 28672
    s_nop 0
    buffer_load_dwordx4 v21, s[24:27], s45 offen  lds
    ds_read_b64_tr_b16 a[32:33], v23 offset:32768
    ds_read_b64_tr_b16 a[34:35], v23 offset:36864
    ds_read_b64_tr_b16 a[36:37], v23 offset:32800
    ds_read_b64_tr_b16 a[38:39], v23 offset:36896
    ds_read_b64_tr_b16 a[40:41], v23 offset:40960
    ds_read_b64_tr_b16 a[42:43], v23 offset:45056
    ds_read_b64_tr_b16 a[44:45], v23 offset:40992
    ds_read_b64_tr_b16 a[46:47], v23 offset:45088
    s_waitcnt lgkmcnt(0)
    s_waitcnt vmcnt(28)
    s_barrier
    s_add_u32 s45, s46, 0x160000
    s_add_u32 m0, s47, 32768
    s_nop 0
    buffer_load_dwordx4 v21, s[24:27], s45 offen  lds
    s_add_u32 s45, s46, 0x168000
    s_add_u32 m0, s47, 36864
    s_nop 0
    buffer_load_dwordx4 v21, s[24:27], s45 offen  lds
    s_add_u32 s45, s46, 0x170000
    s_add_u32 m0, s47, 40960
    s_nop 0
    buffer_load_dwordx4 v21, s[24:27], s45 offen  lds
    s_add_u32 s45, s46, 0x178000
    s_add_u32 m0, s47, 45056
    s_nop 0
    buffer_load_dwordx4 v21, s[24:27], s45 offen  lds
    ds_read_b64_tr_b16 a[48:49], v23 offset:49152
    ds_read_b64_tr_b16 a[50:51], v23 offset:53248
    ds_read_b64_tr_b16 a[52:53], v23 offset:49184
    ds_read_b64_tr_b16 a[54:55], v23 offset:53280
    ds_read_b64_tr_b16 a[56:57], v23 offset:57344
    ds_read_b64_tr_b16 a[58:59], v23 offset:61440
    ds_read_b64_tr_b16 a[60:61], v23 offset:57376
    ds_read_b64_tr_b16 a[62:63], v23 offset:61472
    s_waitcnt lgkmcnt(0)
    s_waitcnt vmcnt(28)
    s_barrier
    s_add_u32 s45, s46, 0x180000
    s_add_u32 m0, s47, 49152
    s_nop 0
    buffer_load_dwordx4 v21, s[24:27], s45 offen  lds
    s_add_u32 s45, s46, 0x188000
    s_add_u32 m0, s47, 53248
    s_nop 0
    buffer_load_dwordx4 v21, s[24:27], s45 offen  lds
    s_add_u32 s45, s46, 0x190000
    s_add_u32 m0, s47, 57344
    s_nop 0
    buffer_load_dwordx4 v21, s[24:27], s45 offen  lds
    s_add_u32 s45, s46, 0x198000
    s_add_u32 m0, s47, 61440
    s_nop 0
    buffer_load_dwordx4 v21, s[24:27], s45 offen  lds
    ds_read_b64_tr_b16 a[64:65], v24 offset:0
    ds_read_b64_tr_b16 a[66:67], v24 offset:4096
    ds_read_b64_tr_b16 a[68:69], v24 offset:32
    ds_read_b64_tr_b16 a[70:71], v24 offset:4128
    ds_read_b64_tr_b16 a[72:73], v24 offset:8192
    ds_read_b64_tr_b16 a[74:75], v24 offset:12288
    ds_read_b64_tr_b16 a[76:77], v24 offset:8224
    ds_read_b64_tr_b16 a[78:79], v24 offset:12320
    s_waitcnt lgkmcnt(0)
    s_waitcnt vmcnt(28)
    s_barrier
    s_add_u32 s45, s46, 0x1a0000
    s_add_u32 m0, s47, 65536
    s_nop 0
    buffer_load_dwordx4 v21, s[24:27], s45 offen  lds
    s_add_u32 s45, s46, 0x1a8000
    s_add_u32 m0, s47, 69632
    s_nop 0
    buffer_load_dwordx4 v21, s[24:27], s45 offen  lds
    s_add_u32 s45, s46, 0x1b0000
    s_add_u32 m0, s47, 73728
    s_nop 0
    buffer_load_dwordx4 v21, s[24:27], s45 offen  lds
    s_add_u32 s45, s46, 0x1b8000
    s_add_u32 m0, s47, 77824
    s_nop 0
    buffer_load_dwordx4 v21, s[24:27], s45 offen  lds
    ds_read_b64_tr_b16 a[80:81], v24 offset:16384
    ds_read_b64_tr_b16 a[82:83], v24 offset:20480
    ds_read_b64_tr_b16 a[84:85], v24 offset:16416
    ds_read_b64_tr_b16 a[86:87], v24 offset:20512
    ds_read_b64_tr_b16 a[88:89], v24 offset:24576
    ds_read_b64_tr_b16 a[90:91], v24 offset:28672
    ds_read_b64_tr_b16 a[92:93], v24 offset:24608
    ds_read_b64_tr_b16 a[94:95], v24 offset:28704
    s_waitcnt lgkmcnt(0)
    s_waitcnt vmcnt(28)
    s_barrier
    s_add_u32 s45, s46, 0x1c0000
    s_add_u32 m0, s47, 81920
    s_nop 0
    buffer_load_dwordx4 v21, s[24:27], s45 offen  lds
    s_add_u32 s45, s46, 0x1c8000
    s_add_u32 m0, s47, 86016
    s_nop 0
    buffer_load_dwordx4 v21, s[24:27], s45 offen  lds
    s_add_u32 s45, s46, 0x1d0000
    s_add_u32 m0, s47, 90112
    s_nop 0
    buffer_load_dwordx4 v21, s[24:27], s45 offen  lds
    s_add_u32 s45, s46, 0x1d8000
    s_add_u32 m0, s47, 94208
    s_nop 0
    buffer_load_dwordx4 v21, s[24:27], s45 offen  lds
    ds_read_b64_tr_b16 a[96:97], v24 offset:32768
    ds_read_b64_tr_b16 a[98:99], v24 offset:36864
    ds_read_b64_tr_b16 a[100:101], v24 offset:32800
    ds_read_b64_tr_b16 a[102:103], v24 offset:36896
    ds_read_b64_tr_b16 a[104:105], v24 offset:40960
    ds_read_b64_tr_b16 a[106:107], v24 offset:45056
    ds_read_b64_tr_b16 a[108:109], v24 offset:40992
    ds_read_b64_tr_b16 a[110:111], v24 offset:45088
    s_waitcnt lgkmcnt(0)
    s_waitcnt vmcnt(28)
    s_barrier
    s_add_u32 s45, s46, 0x1e0000
    s_add_u32 m0, s47, 98304
    s_nop 0
    buffer_load_dwordx4 v21, s[24:27], s45 offen  lds
    s_add_u32 s45, s46, 0x1e8000
    s_add_u32 m0, s47, 102400
    s_nop 0
    buffer_load_dwordx4 v21, s[24:27], s45 offen  lds
    s_add_u32 s45, s46, 0x1f0000
    s_add_u32 m0, s47, 106496
    s_nop 0
    buffer_load_dwordx4 v21, s[24:27], s45 offen  lds
    s_add_u32 s45, s46, 0x1f8000
    s_add_u32 m0, s47, 110592
    s_nop 0
    buffer_load_dwordx4 v21, s[24:27], s45 offen  lds
    ds_read_b64_tr_b16 a[112:113], v24 offset:49152
    ds_read_b64_tr_b16 a[114:115], v24 offset:53248
    ds_read_b64_tr_b16 a[116:117], v24 offset:49184
    ds_read_b64_tr_b16 a[118:119], v24 offset:53280
    ds_read_b64_tr_b16 a[120:121], v24 offset:57344
    ds_read_b64_tr_b16 a[122:123], v24 offset:61440
    ds_read_b64_tr_b16 a[124:125], v24 offset:57376
    ds_read_b64_tr_b16 a[126:127], v24 offset:61472
    s_waitcnt lgkmcnt(0)
    s_waitcnt vmcnt(28)
    s_barrier
    ds_read_b64_tr_b16 a[128:129], v25 offset:0
    ds_read_b64_tr_b16 a[130:131], v25 offset:4096
    ds_read_b64_tr_b16 a[132:133], v25 offset:32
    ds_read_b64_tr_b16 a[134:135], v25 offset:4128
    ds_read_b64_tr_b16 a[136:137], v25 offset:8192
    ds_read_b64_tr_b16 a[138:139], v25 offset:12288
    ds_read_b64_tr_b16 a[140:141], v25 offset:8224
    ds_read_b64_tr_b16 a[142:143], v25 offset:12320
    s_waitcnt lgkmcnt(0)
    s_waitcnt vmcnt(24)
    s_barrier
    ds_read_b64_tr_b16 a[144:145], v23 offset:0
    ds_read_b64_tr_b16 a[146:147], v23 offset:4096
    ds_read_b64_tr_b16 a[148:149], v23 offset:32
    ds_read_b64_tr_b16 a[150:151], v23 offset:4128
    ds_read_b64_tr_b16 a[152:153], v23 offset:8192
    ds_read_b64_tr_b16 a[154:155], v23 offset:12288
    ds_read_b64_tr_b16 a[156:157], v23 offset:8224
    ds_read_b64_tr_b16 a[158:159], v23 offset:12320
    s_waitcnt lgkmcnt(0)
    s_waitcnt vmcnt(20)
    s_barrier
    ds_read_b64_tr_b16 a[160:161], v23 offset:16384
    ds_read_b64_tr_b16 a[162:163], v23 offset:20480
    ds_read_b64_tr_b16 a[164:165], v23 offset:16416
    ds_read_b64_tr_b16 a[166:167], v23 offset:20512
    ds_read_b64_tr_b16 a[168:169], v23 offset:24576
    ds_read_b64_tr_b16 a[170:171], v23 offset:28672
    ds_read_b64_tr_b16 a[172:173], v23 offset:24608
    ds_read_b64_tr_b16 a[174:175], v23 offset:28704
    s_waitcnt lgkmcnt(0)
    s_waitcnt vmcnt(16)
    s_barrier
    ds_read_b64_tr_b16 a[176:177], v23 offset:32768
    ds_read_b64_tr_b16 a[178:179], v23 offset:36864
    ds_read_b64_tr_b16 a[180:181], v23 offset:32800
    ds_read_b64_tr_b16 a[182:183], v23 offset:36896
    ds_read_b64_tr_b16 a[184:185], v23 offset:40960
    ds_read_b64_tr_b16 a[186:187], v23 offset:45056
    ds_read_b64_tr_b16 a[188:189], v23 offset:40992
    ds_read_b64_tr_b16 a[190:191], v23 offset:45088
    s_waitcnt lgkmcnt(0)
    s_waitcnt vmcnt(12)
    s_barrier
    ds_read_b64_tr_b16 a[192:193], v23 offset:49152
    ds_read_b64_tr_b16 a[194:195], v23 offset:53248
    ds_read_b64_tr_b16 a[196:197], v23 offset:49184
    ds_read_b64_tr_b16 a[198:199], v23 offset:53280
    ds_read_b64_tr_b16 a[200:201], v23 offset:57344
    ds_read_b64_tr_b16 a[202:203], v23 offset:61440
    ds_read_b64_tr_b16 a[204:205], v23 offset:57376
    ds_read_b64_tr_b16 a[206:207], v23 offset:61472
    s_waitcnt lgkmcnt(0)
    s_waitcnt vmcnt(8)
    s_barrier
    ds_read_b64_tr_b16 a[208:209], v24 offset:0
    ds_read_b64_tr_b16 a[210:211], v24 offset:4096
    ds_read_b64_tr_b16 a[212:213], v24 offset:32
    ds_read_b64_tr_b16 a[214:215], v24 offset:4128
    ds_read_b64_tr_b16 a[216:217], v24 offset:8192
    ds_read_b64_tr_b16 a[218:219], v24 offset:12288
    ds_read_b64_tr_b16 a[220:221], v24 offset:8224
    ds_read_b64_tr_b16 a[222:223], v24 offset:12320
    s_waitcnt lgkmcnt(0)
    s_waitcnt vmcnt(4)
    s_barrier
    ds_read_b64_tr_b16 a[224:225], v24 offset:16384
    ds_read_b64_tr_b16 a[226:227], v24 offset:20480
    ds_read_b64_tr_b16 a[228:229], v24 offset:16416
    ds_read_b64_tr_b16 a[230:231], v24 offset:20512
    ds_read_b64_tr_b16 a[232:233], v24 offset:24576
    ds_read_b64_tr_b16 a[234:235], v24 offset:28672
    ds_read_b64_tr_b16 a[236:237], v24 offset:24608
    ds_read_b64_tr_b16 a[238:239], v24 offset:28704
    s_waitcnt lgkmcnt(0)
    s_waitcnt vmcnt(0)
    s_barrier
    ds_read_b64_tr_b16 a[240:241], v24 offset:32768
    ds_read_b64_tr_b16 a[242:243], v24 offset:36864
    ds_read_b64_tr_b16 a[244:245], v24 offset:32800
    ds_read_b64_tr_b16 a[246:247], v24 offset:36896
    ds_read_b64_tr_b16 a[248:249], v24 offset:40960
    ds_read_b64_tr_b16 a[250:251], v24 offset:45056
    ds_read_b64_tr_b16 a[252:253], v24 offset:40992
    ds_read_b64_tr_b16 a[254:255], v24 offset:45088
    s_waitcnt lgkmcnt(0)
    s_barrier
    s_lshl_b32 s52, s38, 16
    s_add_u32 s52, s52, 0x5000000
    s_lshl_b32 s56, s38, 23
    s_lshl_b32 s45, s68, 9
    s_add_u32 s56, s56, s45
    s_add_u32 s56, s56, 0x8000000
    s_lshl_b32 s45, s40, 7
    s_add_u32 s45, s45, 127488
    v_mov_b32 v29, s45
    s_mov_b32 s46, 536870912
    s_mov_b64 exec, 1
    s_mov_b32 s70, 0
L_wp_129:
    buffer_load_dword v31, v29, s[12:15], 0 offen sc1
    s_add_u32 s70, s70, 1
    s_cmp_ge_u32 s70, 0x200000
    s_cbranch_scc1 L_w_done_98
    s_waitcnt vmcnt(0)
    v_cmp_gt_u32 vcc, s46, v31
    s_nop 1
    s_cbranch_vccz L_wp_129_ok
    s_sleep 2
    s_branch L_wp_129
L_wp_129_ok:
    s_mov_b64 exec, -1
    v_readfirstlane_b32 s45, v31
    s_nop 3
    s_and_b32 s46, s45, 511
    s_mul_i32 s46, s46, s46
    s_bfe_u32 s45, s45, 0xf0009
    s_lshl_b32 s45, s45, 5
    s_mov_b32 s80, s12
    s_mov_b32 s81, s13
    s_mov_b32 s83, 0x00020000
    s_mov_b32 s84, s12
    s_mov_b32 s85, s13
    s_mov_b32 s87, 0x00020000
    s_cmp_eq_u32 s45, s46
    s_cselect_b32 s82, s14, 0
    s_cselect_b32 s86, 0, s14
    s_sub_u32 s79, 3, s44
    s_mov_b32 s78, 0
    s_cmp_eq_u64 s[36:37], 0
    s_cbranch_scc1 L_xl_130
    s_ff1_i32_b64 s47, s[36:37]
    s_lshr_b64 s[74:75], s[72:73], s47
    s_ff1_i32_b64 s48, s[74:75]
    s_cmp_gt_u32 s79, s48
    s_cbranch_scc1 L_xl_130
    s_add_u32 s47, s47, s79
    s_cmp_lt_u32 s47, s78
    s_cbranch_scc1 L_xl_130_go
    s_lshl_b32 s45, s41, 7
    s_add_u32 s45, s45, 0x10010
    s_add_u32 s46, s47, 1
    s_mov_b64 exec, 7
    s_mov_b32 s70, 0
L_wp_131:
    buffer_load_dword v31, v12, s[12:15], s45 offen sc1
    s_add_u32 s70, s70, 1
    s_cmp_ge_u32 s70, 0x200000
    s_cbranch_scc1 L_w_done_98
    s_waitcnt vmcnt(0)
    v_cmp_gt_u32 vcc, s46, v31
    s_nop 1
    s_cbranch_vccz L_wp_131_ok
    s_sleep 2
    s_branch L_wp_131
L_wp_131_ok:
    s_mov_b64 exec, -1
    v_readlane_b32 s78, v31, 0
    v_readlane_b32 s45, v31, 1
    v_readlane_b32 s46, v31, 2
    s_nop 3
    s_min_u32 s78, s78, s45
    s_min_u32 s78, s78, s46
L_xl_130_go:
    s_lshl_b32 s45, s41, 19
    s_lshl_b32 s46, s47, 13
    s_add_u32 s45, s45, s46
    s_add_u32 s45, s45, 0x2000000
    s_add_u32 s46, s45, 4096
    s_add_u32 s48, s45, 16777216
    s_add_u32 s49, s48, 4096
    s_add_u32 s76, s48, 16777216
    s_add_u32 s77, s76, 4096
    buffer_load_dwordx4 v[96:99], v10, s[12:15], s76 offen offset:0 sc1
    buffer_load_dwordx4 v[128:131], v10, s[12:15], s45 offen offset:0 sc1
    buffer_load_dwordx4 v[160:163], v10, s[12:15], s48 offen offset:0 sc1
    buffer_load_dwordx4 v[100:103], v10, s[12:15], s76 offen offset:1024 sc1
    buffer_load_dwordx4 v[144:147], v10, s[12:15], s45 offen offset:1024 sc1
    buffer_load_dwordx4 v[176:179], v10, s[12:15], s48 offen offset:1024 sc1
    buffer_load_dwordx4 v[104:107], v10, s[12:15], s76 offen offset:2048 sc1
    buffer_load_dwordx4 v[132:135], v10, s[12:15], s45 offen offset:2048 sc1
    buffer_load_dwordx4 v[164:167], v10, s[12:15], s48 offen offset:2048 sc1
    buffer_load_dwordx4 v[108:111], v10, s[12:15], s76 offen offset:3072 sc1
    buffer_load_dwordx4 v[148:151], v10, s[12:15], s45 offen offset:3072 sc1
    buffer_load_dwordx4 v[180:183], v10, s[12:15], s48 offen offset:3072 sc1
    buffer_load_dwordx4 v[112:115], v10, s[12:15], s77 offen offset:0 sc1
    buffer_load_dwordx4 v[136:139], v10, s[12:15], s46 offen offset:0 sc1
    buffer_load_dwordx4 v[168:171], v10, s[12:15], s49 offen offset:0 sc1
    buffer_load_dwordx4 v[116:119], v10, s[12:15], s77 offen offset:1024 sc1
    buffer_load_dwordx4 v[152:155], v10, s[12:15], s46 offen offset:1024 sc1
    buffer_load_dwordx4 v[184:187], v10, s[12:15], s49 offen offset:1024 sc1
    buffer_load_dwordx4 v[120:123], v10, s[12:15], s77 offen offset:2048 sc1
    buffer_load_dwordx4 v[140:143], v10, s[12:15], s46 offen offset:2048 sc1
    buffer_load_dwordx4 v[172:175], v10, s[12:15], s49 offen offset:2048 sc1
    buffer_load_dwordx4 v[124:127], v10, s[12:15], s77 offen offset:3072 sc1
    buffer_load_dwordx4 v[156:159], v10, s[12:15], s46 offen offset:3072 sc1
    buffer_load_dwordx4 v[188:191], v10, s[12:15], s49 offen offset:3072 sc1
L_xl_130:
L_a_loop_127:
    s_cmp_eq_u64 s[36:37], 0
    s_cbranch_scc1 L_w_done_98
    s_ff1_i32_b64 s50, s[36:37]
    s_bitset0_b64 s[36:37], s50
    s_lshr_b64 s[74:75], s[72:73], s50
    s_ff1_i32_b64 s51, s[74:75]
    s_add_u32 s51, s51, 1
    s_add_u32 s62, s50, s51
    s_add_u32 s63, s50, s79
    s_cmp_ge_u32 s79, s51
    s_cbranch_scc1 L_xs1_132
    s_lshl_b32 s47, s44, 13
    v_add_u32 v18, s47, v10
    v_and_b32 v14, 15, v1
    v_lshrrev_b32 v16, 4, v1
    s_waitcnt vmcnt(0)
    ds_write_b128 v18, v[96:99] offset:0
    ds_write_b128 v18, v[100:103] offset:1024
    ds_write_b128 v18, v[104:107] offset:2048
    ds_write_b128 v18, v[108:111] offset:3072
    ds_write_b128 v18, v[112:115] offset:4096
    ds_write_b128 v18, v[116:119] offset:5120
    ds_write_b128 v18, v[120:123] offset:6144
    ds_write_b128 v18, v[124:127] offset:7168
    v_mfma_f32_16x16x32_bf16 v[32:35], v[160:163], v[128:131], 0
    v_mfma_f32_16x16x32_bf16 v[36:39], v[160:163], v[144:147], 0
    v_mfma_f32_16x16x32_bf16 v[44:47], v[176:179], v[144:147], 0
    v_mfma_f32_16x16x32_bf16 v[32:35], v[164:167], v[132:135], v[32:35]
    v_mfma_f32_16x16x32_bf16 v[36:39], v[164:167], v[148:151], v[36:39]
    v_mfma_f32_16x16x32_bf16 v[44:47], v[180:183], v[148:151], v[44:47]
    v_mfma_f32_16x16x32_bf16 v[32:35], v[168:171], v[136:139], v[32:35]
    v_mfma_f32_16x16x32_bf16 v[36:39], v[168:171], v[152:155], v[36:39]
    v_mfma_f32_16x16x32_bf16 v[44:47], v[184:187], v[152:155], v[44:47]
    v_mfma_f32_16x16x32_bf16 v[32:35], v[172:175], v[140:143], v[32:35]
    v_mfma_f32_16x16x32_bf16 v[36:39], v[172:175], v[156:159], v[36:39]
    v_mfma_f32_16x16x32_bf16 v[44:47], v[188:191], v[156:159], v[44:47]
    v_lshlrev_b32 v19, 2, v16
    v_lshrrev_b32 v20, 2, v1
    v_lshlrev_b32 v20, 4, v20
    v_and_b32 v21, 1, v1
    v_lshlrev_b32 v21, 3, v21
    v_add3_u32 v20, v20, v21, s47
    v_and_b32 v21, 2, v1
    v_lshlrev_b32 v21, 7, v21
    v_add_u32 v20, v20, v21
    v_mov_b32 v22, 0xff800000
    s_waitcnt lgkmcnt(0)
    ds_read_b64_tr_b16 v[208:209], v20 offset:0
    ds_read_b64_tr_b16 v[210:211], v20 offset:1024
    ds_read_b64_tr_b16 v[212:213], v20 offset:512
    ds_read_b64_tr_b16 v[214:215], v20 offset:1536
    ds_read_b64_tr_b16 v[216:217], v20 offset:2048
    ds_read_b64_tr_b16 v[218:219], v20 offset:3072
    ds_read_b64_tr_b16 v[220:221], v20 offset:2560
    ds_read_b64_tr_b16 v[222:223], v20 offset:3584
    ds_read_b64_tr_b16 v[224:225], v20 offset:4096
    ds_read_b64_tr_b16 v[226:227], v20 offset:5120
    ds_read_b64_tr_b16 v[228:229], v20 offset:4608
    ds_read_b64_tr_b16 v[230:231], v20 offset:5632
    ds_read_b64_tr_b16 v[232:233], v20 offset:6144
    ds_read_b64_tr_b16 v[234:235], v20 offset:7168
    ds_read_b64_tr_b16 v[236:237], v20 offset:6656
    ds_read_b64_tr_b16 v[238:239], v20 offset:7680
    v_add_u32 v21, 0, v19
    v_cmp_gt_u32 vcc, v21, v14
    s_nop 1
    v_cndmask_b32 v32, v32, v22, vcc
    v_cndmask_b32 v44, v44, v22, vcc
    v_add_u32 v21, 1, v19
    v_cmp_gt_u32 vcc, v21, v14
    s_nop 1
    v_cndmask_b32 v33, v33, v22, vcc
    v_cndmask_b32 v45, v45, v22, vcc
    v_add_u32 v21, 2, v19
    v_cmp_gt_u32 vcc, v21, v14
    s_nop 1
    v_cndmask_b32 v34, v34, v22, vcc
    v_cndmask_b32 v46, v46, v22, vcc
    v_add_u32 v21, 3, v19
    v_cmp_gt_u32 vcc, v21, v14
    s_nop 1
    v_cndmask_b32 v35, v35, v22, vcc
    v_cndmask_b32 v47, v47, v22, vcc
L_xs1_132:
    s_lshl_b32 s45, s41, 7
    s_add_u32 s45, s45, 0x11000
    s_cmp_lg_u32 s44, 0
    s_cbranch_scc1 L_pw_134
    s_mov_b64 exec, 255
    s_mov_b32 s70, 0
L_wp_135:
    buffer_load_dword v31, v12, s[12:15], s45 offen sc1
    s_add_u32 s70, s70, 1
    s_cmp_ge_u32 s70, 0x200000
    s_cbranch_scc1 L_w_done_98
    s_waitcnt vmcnt(0)
    v_cmp_gt_u32 vcc, s62, v31
    s_nop 1
    s_cbranch_vccz L_wp_135_ok
    s_sleep 2
    s_branch L_wp_135
L_wp_135_ok:
    s_mov_b64 exec, -1
L_pw_134:
    s_barrier
    s_cmp_ge_u32 s79, s51
    s_cbranch_scc1 L_xs2_133
    s_lshl_b32 s45, s63, 17
    s_lshl_b32 s46, s41, 12
    s_add_u32 s45, s45, s46
    s_lshr_b32 s46, s45, 1
    s_add_u32 s45, s45, 0x1000000
    s_add_u32 s46, s46, 0x1800000
    v_lshlrev_b32 v21, 3, v1
    buffer_load_dwordx4 v[192:195], v10, s[12:15], s45 offen offset:0 sc1
    buffer_load_dwordx4 v[196:199], v10, s[12:15], s45 offen offset:1024 sc1
    buffer_load_dwordx4 v[200:203], v10, s[12:15], s45 offen offset:2048 sc1
    buffer_load_dwordx4 v[204:207], v10, s[12:15], s45 offen offset:3072 sc1
    buffer_load_dwordx2 v[240:241], v21, s[12:15], s46 offen offset:0 sc1
    buffer_load_dwordx2 v[242:243], v21, s[12:15], s46 offen offset:512 sc1
    buffer_load_dwordx2 v[244:245], v21, s[12:15], s46 offen offset:1024 sc1
    buffer_load_dwordx2 v[246:247], v21, s[12:15], s46 offen offset:1536 sc1
    s_waitcnt vmcnt(4)
    v_mfma_f32_16x16x32_bf16 v[48:51], v[192:195], v[128:131], 0
    v_mfma_f32_16x16x32_bf16 v[52:55], v[192:195], v[144:147], 0
    v_mfma_f32_16x16x32_bf16 v[48:51], v[196:199], v[132:135], v[48:51]
    v_mfma_f32_16x16x32_bf16 v[52:55], v[196:199], v[148:151], v[52:55]
    v_mfma_f32_16x16x32_bf16 v[48:51], v[200:203], v[136:139], v[48:51]
    v_mfma_f32_16x16x32_bf16 v[52:55], v[200:203], v[152:155], v[52:55]
    v_mfma_f32_16x16x32_bf16 v[48:51], v[204:207], v[140:143], v[48:51]
    v_mfma_f32_16x16x32_bf16 v[52:55], v[204:207], v[156:159], v[52:55]
    s_mov_b32 s45, 0x3e0293ee
    s_nop 6
    v_permlane32_swap_b32 v48, v50
    v_permlane32_swap_b32 v49, v51
    v_pk_add_f32 v[48:49], v[48:49], v[50:51]
    v_permlane32_swap_b32 v52, v54
    v_permlane32_swap_b32 v53, v55
    v_pk_add_f32 v[52:53], v[52:53], v[54:55]
    v_max_f32 v22, v32, v33
    v_max3_f32 v22, v22, v34, v35
    v_max3_f32 v22, v22, v48, v49
    v_max_f32 v23, v36, v37
    v_max3_f32 v23, v23, v38, v39
    v_max3_f32 v23, v23, v44, v45
    v_max3_f32 v23, v23, v46, v47
    v_max3_f32 v23, v23, v52, v53
    v_mov_b32 v24, v22
    v_mov_b32 v25, v23
    s_nop 0
    v_permlane32_swap_b32 v22, v24
    v_permlane32_swap_b32 v23, v25
    v_max_f32 v22, v22, v24
    v_max_f32 v23, v23, v25
    v_mov_b32 v24, v22
    v_mov_b32 v25, v23
    s_nop 0
    v_permlane16_swap_b32 v22, v24
    v_permlane16_swap_b32 v23, v25
    v_max_f32 v22, v22, v24
    v_max_f32 v23, v23, v25
    v_mul_f32 v22, s45, v22
    v_mul_f32 v23, s45, v23
    v_fma_f32 v32, v32, s45, -v22
    v_fma_f32 v33, v33, s45, -v22
    v_fma_f32 v34, v34, s45, -v22
    v_fma_f32 v35, v35, s45, -v22
    v_fma_f32 v48, v48, s45, -v22
    v_fma_f32 v49, v49, s45, -v22
    v_exp_f32 v32, v32
    v_exp_f32 v33, v33
    v_exp_f32 v34, v34
    v_exp_f32 v35, v35
    v_exp_f32 v48, v48
    v_exp_f32 v49, v49
    v_fma_f32 v36, v36, s45, -v23
    v_fma_f32 v37, v37, s45, -v23
    v_fma_f32 v38, v38, s45, -v23
    v_fma_f32 v39, v39, s45, -v23
    v_fma_f32 v44, v44, s45, -v23
    v_fma_f32 v45, v45, s45, -v23
    v_fma_f32 v46, v46, s45, -v23
    v_fma_f32 v47, v47, s45, -v23
    v_fma_f32 v52, v52, s45, -v23
    v_fma_f32 v53, v53, s45, -v23
    v_exp_f32 v36, v36
    v_exp_f32 v37, v37
    v_exp_f32 v38, v38
    v_exp_f32 v39, v39
    v_exp_f32 v44, v44
    v_exp_f32 v45, v45
    v_exp_f32 v46, v46
    v_exp_f32 v47, v47
    v_exp_f32 v52, v52
    v_exp_f32 v53, v53
    v_add_f32 v22, v32, v33
    v_add_f32 v22, v22, v34
    v_add_f32 v22, v22, v35
    v_add_f32 v22, v22, v48
    v_add_f32 v22, v22, v49
    v_add_f32 v23, v36, v37
    v_add_f32 v23, v23, v38
    v_add_f32 v23, v23, v39
    v_add_f32 v23, v23, v44
    v_add_f32 v23, v23, v45
    v_add_f32 v23, v23, v46
    v_add_f32 v23, v23, v47
    v_add_f32 v23, v23, v52
    v_add_f32 v23, v23, v53
    v_mov_b32 v24, v22
    v_mov_b32 v25, v23
    s_nop 0
    v_permlane32_swap_b32 v22, v24
    v_permlane32_swap_b32 v23, v25
    v_add_f32 v22, v22, v24
    v_add_f32 v23, v23, v25
    v_mov_b32 v24, v22
    v_mov_b32 v25, v23
    s_nop 0
    v_permlane16_swap_b32 v22, v24
    v_permlane16_swap_b32 v23, v25
    v_add_f32 v22, v22, v24
    v_add_f32 v23, v23, v25
    v_rcp_f32 v22, v22
    v_rcp_f32 v23, v23
    s_nop 0
    v_mul_f32 v32, v32, v22
    v_mul_f32 v33, v33, v22
    v_mul_f32 v34, v34, v22
    v_mul_f32 v35, v35, v22
    v_mul_f32 v48, v48, v22
    v_mul_f32 v49, v49, v22
    v_mul_f32 v36, v36, v23
    v_mul_f32 v37, v37, v23
    v_mul_f32 v38, v38, v23
    v_mul_f32 v39, v39, v23
    v_mul_f32 v44, v44, v23
    v_mul_f32 v45, v45, v23
    v_mul_f32 v46, v46, v23
    v_mul_f32 v47, v47, v23
    v_mul_f32 v52, v52, v23
    v_mul_f32 v53, v53, v23
    v_cvt_pk_bf16_f32 v128, v32, v33
    v_cvt_pk_bf16_f32 v129, v34, v35
    v_mov_b32 v130, 0
    v_mov_b32 v131, 0
    v_cvt_pk_bf16_f32 v132, v48, v49
    v_mov_b32 v133, 0
    v_mov_b32 v134, 0
    v_cvt_pk_bf16_f32 v135, v48, v49
    v_cvt_pk_bf16_f32 v136, v36, v37
    v_cvt_pk_bf16_f32 v137, v38, v39
    v_cvt_pk_bf16_f32 v138, v44, v45
    v_cvt_pk_bf16_f32 v139, v46, v47
    v_cvt_pk_bf16_f32 v140, v52, v53
    v_mov_b32 v141, 0
    v_mov_b32 v142, 0
    v_cvt_pk_bf16_f32 v143, v52, v53
    s_waitcnt vmcnt(0) lgkmcnt(0)
    s_nop 0
    v_mfma_f32_16x16x32_bf16 v[64:67], v[208:211], v[128:131], 0
    v_mfma_f32_16x16x32_bf16 v[68:71], v[212:215], v[128:131], 0
    v_mfma_f32_16x16x32_bf16 v[72:75], v[216:219], v[128:131], 0
    v_mfma_f32_16x16x32_bf16 v[76:79], v[220:223], v[128:131], 0
    v_mfma_f32_16x16x32_bf16 v[80:83], v[224:227], v[128:131], 0
    v_mfma_f32_16x16x32_bf16 v[84:87], v[228:231], v[128:131], 0
    v_mfma_f32_16x16x32_bf16 v[88:91], v[232:235], v[128:131], 0
    v_mfma_f32_16x16x32_bf16 v[92:95], v[236:239], v[128:131], 0
    v_mfma_f32_16x16x16_bf16 v[64:67], v[240:241], v[132:133], v[64:67]
    v_mfma_f32_16x16x16_bf16 v[68:71], v[240:241], v[134:135], v[68:71]
    v_mfma_f32_16x16x16_bf16 v[72:75], v[242:243], v[132:133], v[72:75]
    v_mfma_f32_16x16x16_bf16 v[76:79], v[242:243], v[134:135], v[76:79]
    v_mfma_f32_16x16x16_bf16 v[80:83], v[244:245], v[132:133], v[80:83]
    v_mfma_f32_16x16x16_bf16 v[84:87], v[244:245], v[134:135], v[84:87]
    v_mfma_f32_16x16x16_bf16 v[88:91], v[246:247], v[132:133], v[88:91]
    v_mfma_f32_16x16x16_bf16 v[92:95], v[246:247], v[134:135], v[92:95]
    v_mfma_f32_16x16x32_bf16 v[96:99], v[208:211], v[136:139], 0
    v_mfma_f32_16x16x32_bf16 v[100:103], v[212:215], v[136:139], 0
    v_mfma_f32_16x16x32_bf16 v[104:107], v[216:219], v[136:139], 0
    v_mfma_f32_16x16x32_bf16 v[108:111], v[220:223], v[136:139], 0
    v_mfma_f32_16x16x32_bf16 v[112:115], v[224:227], v[136:139], 0
    v_mfma_f32_16x16x32_bf16 v[116:119], v[228:231], v[136:139], 0
    v_mfma_f32_16x16x32_bf16 v[120:123], v[232:235], v[136:139], 0
    v_mfma_f32_16x16x32_bf16 v[124:127], v[236:239], v[136:139], 0
    v_mfma_f32_16x16x16_bf16 v[96:99], v[240:241], v[140:141], v[96:99]
    v_mfma_f32_16x16x16_bf16 v[100:103], v[240:241], v[142:143], v[100:103]
    v_mfma_f32_16x16x16_bf16 v[104:107], v[242:243], v[140:141], v[104:107]
    v_mfma_f32_16x16x16_bf16 v[108:111], v[242:243], v[142:143], v[108:111]
    v_mfma_f32_16x16x16_bf16 v[112:115], v[244:245], v[140:141], v[112:115]
    v_mfma_f32_16x16x16_bf16 v[116:119], v[244:245], v[142:143], v[116:119]
    v_mfma_f32_16x16x16_bf16 v[120:123], v[246:247], v[140:141], v[120:123]
    v_mfma_f32_16x16x16_bf16 v[124:127], v[246:247], v[142:143], v[124:127]
    s_lshl_b32 s45, s63, 18
    s_lshl_b32 s46, s41, 13
    s_add_u32 s45, s45, s46
    s_add_u32 s45, s45, 0x5000000
    s_add_u32 s46, s45, 4096
    v_cvt_pk_bf16_f32 v64, v64, v65
    v_cvt_pk_bf16_f32 v65, v66, v67
    v_cvt_pk_bf16_f32 v66, v68, v69
    v_cvt_pk_bf16_f32 v67, v70, v71
    buffer_store_dwordx4 v[64:67], v10, s[12:15], s45 offen offset:0 sc1
    v_cvt_pk_bf16_f32 v72, v72, v73
    v_cvt_pk_bf16_f32 v73, v74, v75
    v_cvt_pk_bf16_f32 v74, v76, v77
    v_cvt_pk_bf16_f32 v75, v78, v79
    buffer_store_dwordx4 v[72:75], v10, s[12:15], s45 offen offset:2048 sc1
    v_cvt_pk_bf16_f32 v80, v80, v81
    v_cvt_pk_bf16_f32 v81, v82, v83
    v_cvt_pk_bf16_f32 v82, v84, v85
    v_cvt_pk_bf16_f32 v83, v86, v87
    buffer_store_dwordx4 v[80:83], v10, s[12:15], s46 offen offset:0 sc1
    v_cvt_pk_bf16_f32 v88, v88, v89
    v_cvt_pk_bf16_f32 v89, v90, v91
    v_cvt_pk_bf16_f32 v90, v92, v93
    v_cvt_pk_bf16_f32 v91, v94, v95
    buffer_store_dwordx4 v[88:91], v10, s[12:15], s46 offen offset:2048 sc1
    v_cvt_pk_bf16_f32 v96, v96, v97
    v_cvt_pk_bf16_f32 v97, v98, v99
    v_cvt_pk_bf16_f32 v98, v100, v101
    v_cvt_pk_bf16_f32 v99, v102, v103
    buffer_store_dwordx4 v[96:99], v10, s[12:15], s45 offen offset:1024 sc1
    v_cvt_pk_bf16_f32 v104, v104, v105
    v_cvt_pk_bf16_f32 v105, v106, v107
    v_cvt_pk_bf16_f32 v106, v108, v109
    v_cvt_pk_bf16_f32 v107, v110, v111
    buffer_store_dwordx4 v[104:107], v10, s[12:15], s45 offen offset:3072 sc1
    v_cvt_pk_bf16_f32 v112, v112, v113
    v_cvt_pk_bf16_f32 v113, v114, v115
    v_cvt_pk_bf16_f32 v114, v116, v117
    v_cvt_pk_bf16_f32 v115, v118, v119
    buffer_store_dwordx4 v[112:115], v10, s[12:15], s46 offen offset:1024 sc1
    v_cvt_pk_bf16_f32 v120, v120, v121
    v_cvt_pk_bf16_f32 v121, v122, v123
    v_cvt_pk_bf16_f32 v122, v124, v125
    v_cvt_pk_bf16_f32 v123, v126, v127
    buffer_store_dwordx4 v[120:123], v10, s[12:15], s46 offen offset:3072 sc1
L_xs2_133:
    s_waitcnt vmcnt(0)
    s_barrier
    s_cmp_lg_u32 s44, 0
    s_cbranch_scc1 L_pub_136
    v_mov_b32 v30, s62
    v_mov_b32 v31, 0
    s_mov_b64 exec, 1
    buffer_store_dword v30, v31, s[80:83], s65 offen
    buffer_store_dword v30, v31, s[84:87], s65 offen sc1
    s_mov_b64 exec, -1
L_pub_136:
    s_cmp_eq_u64 s[36:37], 0
    s_cbranch_scc1 L_xl_137
    s_ff1_i32_b64 s47, s[36:37]
    s_lshr_b64 s[74:75], s[72:73], s47
    s_ff1_i32_b64 s48, s[74:75]
    s_cmp_gt_u32 s79, s48
    s_cbranch_scc1 L_xl_137
    s_add_u32 s47, s47, s79
    s_cmp_lt_u32 s47, s78
    s_cbranch_scc1 L_xl_137_go
    s_lshl_b32 s45, s41, 7
    s_add_u32 s45, s45, 0x10010
    s_add_u32 s46, s47, 1
    s_mov_b64 exec, 7
    s_mov_b32 s70, 0
L_wp_138:
    buffer_load_dword v31, v12, s[12:15], s45 offen sc1
    s_add_u32 s70, s70, 1
    s_cmp_ge_u32 s70, 0x200000
    s_cbranch_scc1 L_w_done_98
    s_waitcnt vmcnt(0)
    v_cmp_gt_u32 vcc, s46, v31
    s_nop 1
    s_cbranch_vccz L_wp_138_ok
    s_sleep 2
    s_branch L_wp_138
L_wp_138_ok:
    s_mov_b64 exec, -1
    v_readlane_b32 s78, v31, 0
    v_readlane_b32 s45, v31, 1
    v_readlane_b32 s46, v31, 2
    s_nop 3
    s_min_u32 s78, s78, s45
    s_min_u32 s78, s78, s46
L_xl_137_go:
    s_lshl_b32 s45, s41, 19
    s_lshl_b32 s46, s47, 13
    s_add_u32 s45, s45, s46
    s_add_u32 s45, s45, 0x2000000
    s_add_u32 s46, s45, 4096
    s_add_u32 s48, s45, 16777216
    s_add_u32 s49, s48, 4096
    s_add_u32 s76, s48, 16777216
    s_add_u32 s77, s76, 4096
    buffer_load_dwordx4 v[96:99], v10, s[12:15], s76 offen offset:0 sc1
    buffer_load_dwordx4 v[128:131], v10, s[12:15], s45 offen offset:0 sc1
    buffer_load_dwordx4 v[160:163], v10, s[12:15], s48 offen offset:0 sc1
    buffer_load_dwordx4 v[100:103], v10, s[12:15], s76 offen offset:1024 sc1
    buffer_load_dwordx4 v[144:147], v10, s[12:15], s45 offen offset:1024 sc1
    buffer_load_dwordx4 v[176:179], v10, s[12:15], s48 offen offset:1024 sc1
    buffer_load_dwordx4 v[104:107], v10, s[12:15], s76 offen offset:2048 sc1
    buffer_load_dwordx4 v[132:135], v10, s[12:15], s45 offen offset:2048 sc1
    buffer_load_dwordx4 v[164:167], v10, s[12:15], s48 offen offset:2048 sc1
    buffer_load_dwordx4 v[108:111], v10, s[12:15], s76 offen offset:3072 sc1
    buffer_load_dwordx4 v[148:151], v10, s[12:15], s45 offen offset:3072 sc1
    buffer_load_dwordx4 v[180:183], v10, s[12:15], s48 offen offset:3072 sc1
    buffer_load_dwordx4 v[112:115], v10, s[12:15], s77 offen offset:0 sc1
    buffer_load_dwordx4 v[136:139], v10, s[12:15], s46 offen offset:0 sc1
    buffer_load_dwordx4 v[168:171], v10, s[12:15], s49 offen offset:0 sc1
    buffer_load_dwordx4 v[116:119], v10, s[12:15], s77 offen offset:1024 sc1
    buffer_load_dwordx4 v[152:155], v10, s[12:15], s46 offen offset:1024 sc1
    buffer_load_dwordx4 v[184:187], v10, s[12:15], s49 offen offset:1024 sc1
    buffer_load_dwordx4 v[120:123], v10, s[12:15], s77 offen offset:2048 sc1
    buffer_load_dwordx4 v[140:143], v10, s[12:15], s46 offen offset:2048 sc1
    buffer_load_dwordx4 v[172:175], v10, s[12:15], s49 offen offset:2048 sc1
    buffer_load_dwordx4 v[124:127], v10, s[12:15], s77 offen offset:3072 sc1
    buffer_load_dwordx4 v[156:159], v10, s[12:15], s46 offen offset:3072 sc1
    buffer_load_dwordx4 v[188:191], v10, s[12:15], s49 offen offset:3072 sc1
L_xl_137:
    s_lshl_b32 s45, s38, 10
    s_add_u32 s45, s45, s64
    s_cmp_lg_u32 s44, 0
    s_cbranch_scc1 L_pw_139
    s_mov_b64 exec, 255
    s_mov_b32 s70, 0
L_wp_140:
    buffer_load_dword v31, v5, s[12:15], s45 offen sc1
    s_add_u32 s70, s70, 1
    s_cmp_ge_u32 s70, 0x200000
    s_cbranch_scc1 L_w_done_98
    s_waitcnt vmcnt(0)
    v_cmp_gt_u32 vcc, s62, v31
    s_nop 1
    s_cbranch_vccz L_wp_140_ok
    s_sleep 1
    s_branch L_wp_140
L_wp_140_ok:
    s_mov_b64 exec, -1
L_pw_139:
    s_barrier
    s_mul_i32 s53, s50, 262144
    s_add_u32 s53, s53, s52
    s_lshl_b32 s54, s44, 13
    s_add_u32 s53, s53, s54
    s_mul_i32 s57, s50, 131072
    s_add_u32 s57, s57, s56
    s_lshl_b32 s45, s44, 7
    s_add_u32 s57, s57, s45
    s_add_u32 s55, s54, 65536
    s_mov_b32 s58, 0
    v_mov_b32 v13, v10
    v_add_u32 v14, 65536, v13
    v_xor_b32 v15, 64, v13
    v_xor_b32 v16, 64, v14
    s_mov_b32 s76, 0x20000000
    s_add_u32 s48, s53, 0
    s_add_u32 s49, s48, 4096
    s_add_u32 m0, s54, 0
    s_nop 0
    buffer_load_dwordx4 v10, s[12:15], s48 offen offset:0 sc1 lds
    buffer_load_dwordx4 v10, s[12:15], s48 offen offset:1024 sc1 lds
    buffer_load_dwordx4 v10, s[12:15], s48 offen offset:2048 sc1 lds
    buffer_load_dwordx4 v10, s[12:15], s48 offen offset:3072 sc1 lds
    s_add_u32 m0, s54, 4096
    s_nop 0
    buffer_load_dwordx4 v10, s[12:15], s49 offen offset:0 sc1 lds
    buffer_load_dwordx4 v10, s[12:15], s49 offen offset:1024 sc1 lds
    buffer_load_dwordx4 v10, s[12:15], s49 offen offset:2048 sc1 lds
    buffer_load_dwordx4 v10, s[12:15], s49 offen offset:3072 sc1 lds
    s_add_u32 s48, s53, 32768
    s_add_u32 s49, s48, 4096
    s_add_u32 s46, s54, 32768
    s_add_u32 m0, s46, 0
    s_nop 0
    buffer_load_dwordx4 v10, s[12:15], s48 offen offset:0 sc1 lds
    buffer_load_dwordx4 v10, s[12:15], s48 offen offset:1024 sc1 lds
    buffer_load_dwordx4 v10, s[12:15], s48 offen offset:2048 sc1 lds
    buffer_load_dwordx4 v10, s[12:15], s48 offen offset:3072 sc1 lds
    s_add_u32 m0, s46, 4096
    s_nop 0
    buffer_load_dwordx4 v10, s[12:15], s49 offen offset:0 sc1 lds
    buffer_load_dwordx4 v10, s[12:15], s49 offen offset:1024 sc1 lds
    buffer_load_dwordx4 v10, s[12:15], s49 offen offset:2048 sc1 lds
    buffer_load_dwordx4 v10, s[12:15], s49 offen offset:3072 sc1 lds
    s_cmp_eq_u32 s51, 1
    s_cbranch_scc1 L_e_one_142
    s_add_u32 s48, s53, 262144
    s_add_u32 s49, s48, 4096
    s_add_u32 m0, s55, 0
    s_nop 0
    buffer_load_dwordx4 v10, s[12:15], s48 offen offset:0 sc1 lds
    buffer_load_dwordx4 v10, s[12:15], s48 offen offset:1024 sc1 lds
    buffer_load_dwordx4 v10, s[12:15], s48 offen offset:2048 sc1 lds
    buffer_load_dwordx4 v10, s[12:15], s48 offen offset:3072 sc1 lds
    s_add_u32 m0, s55, 4096
    s_nop 0
    buffer_load_dwordx4 v10, s[12:15], s49 offen offset:0 sc1 lds
    buffer_load_dwordx4 v10, s[12:15], s49 offen offset:1024 sc1 lds
    buffer_load_dwordx4 v10, s[12:15], s49 offen offset:2048 sc1 lds
    buffer_load_dwordx4 v10, s[12:15], s49 offen offset:3072 sc1 lds
    s_waitcnt vmcnt(16)
    s_barrier
    ds_read_b128 v[32:35], v13 offset:0
    ds_read_b128 v[36:39], v13 offset:1024
    ds_read_b128 v[40:43], v13 offset:2048
    ds_read_b128 v[44:47], v13 offset:3072
L_e_loop_141:
    s_add_u32 s48, s53, 294912
    s_add_u32 s46, s58, 1
    s_cmp_lt_u32 s46, s51
    s_cselect_b32 s48, s48, 0x20000000
    s_add_u32 s49, s48, 4096
    s_add_u32 s59, s55, 32768
    s_waitcnt lgkmcnt(2)
    v_mfma_f32_16x16x32_bf16 v[80:83], a[0:3], v[32:35], 0
    ds_read_b128 v[48:51], v13 offset:4096
    ds_read_b128 v[52:55], v13 offset:5120
    v_mfma_f32_16x16x32_bf16 v[84:87], a[4:7], v[32:35], 0
    ds_read_b128 v[56:59], v13 offset:6144
    ds_read_b128 v[60:63], v13 offset:7168
    s_add_u32 m0, s59, 0
    v_mfma_f32_16x16x32_bf16 v[88:91], a[0:3], v[36:39], 0
    buffer_load_dwordx4 v10, s[12:15], s48 offen offset:0 sc1 lds
    v_mfma_f32_16x16x32_bf16 v[92:95], a[4:7], v[36:39], 0
    s_waitcnt lgkmcnt(4)
    v_mfma_f32_16x16x32_bf16 v[80:83], a[8:11], v[40:43], v[80:83]
    ds_read_b128 v[32:35], v13 offset:8192
    ds_read_b128 v[36:39], v13 offset:9216
    v_mfma_f32_16x16x32_bf16 v[84:87], a[12:15], v[40:43], v[84:87]
    v_mfma_f32_16x16x32_bf16 v[88:91], a[8:11], v[44:47], v[88:91]
    buffer_load_dwordx4 v10, s[12:15], s48 offen offset:1024 sc1 lds
    v_mfma_f32_16x16x32_bf16 v[92:95], a[12:15], v[44:47], v[92:95]
    s_waitcnt lgkmcnt(4)
    v_mfma_f32_16x16x32_bf16 v[80:83], a[16:19], v[48:51], v[80:83]
    ds_read_b128 v[40:43], v13 offset:10240
    ds_read_b128 v[44:47], v13 offset:11264
    v_mfma_f32_16x16x32_bf16 v[84:87], a[20:23], v[48:51], v[84:87]
    v_mfma_f32_16x16x32_bf16 v[88:91], a[16:19], v[52:55], v[88:91]
    buffer_load_dwordx4 v10, s[12:15], s48 offen offset:2048 sc1 lds
    v_mfma_f32_16x16x32_bf16 v[92:95], a[20:23], v[52:55], v[92:95]
    s_waitcnt lgkmcnt(4)
    v_mfma_f32_16x16x32_bf16 v[80:83], a[24:27], v[56:59], v[80:83]
    ds_read_b128 v[48:51], v13 offset:12288
    ds_read_b128 v[52:55], v13 offset:13312
    v_mfma_f32_16x16x32_bf16 v[84:87], a[28:31], v[56:59], v[84:87]
    v_mfma_f32_16x16x32_bf16 v[88:91], a[24:27], v[60:63], v[88:91]
    buffer_load_dwordx4 v10, s[12:15], s48 offen offset:3072 sc1 lds
    v_mfma_f32_16x16x32_bf16 v[92:95], a[28:31], v[60:63], v[92:95]
    s_waitcnt lgkmcnt(4)
    v_mfma_f32_16x16x32_bf16 v[80:83], a[32:35], v[32:35], v[80:83]
    ds_read_b128 v[56:59], v13 offset:14336
    ds_read_b128 v[60:63], v13 offset:15360
    v_mfma_f32_16x16x32_bf16 v[84:87], a[36:39], v[32:35], v[84:87]
    s_add_u32 m0, s59, 4096
    v_mfma_f32_16x16x32_bf16 v[88:91], a[32:35], v[36:39], v[88:91]
    buffer_load_dwordx4 v10, s[12:15], s49 offen offset:0 sc1 lds
    v_mfma_f32_16x16x32_bf16 v[92:95], a[36:39], v[36:39], v[92:95]
    s_waitcnt lgkmcnt(4)
    v_mfma_f32_16x16x32_bf16 v[80:83], a[40:43], v[40:43], v[80:83]
    ds_read_b128 v[32:35], v13 offset:16384
    ds_read_b128 v[36:39], v13 offset:17408
    v_mfma_f32_16x16x32_bf16 v[84:87], a[44:47], v[40:43], v[84:87]
    v_mfma_f32_16x16x32_bf16 v[88:91], a[40:43], v[44:47], v[88:91]
    buffer_load_dwordx4 v10, s[12:15], s49 offen offset:1024 sc1 lds
    v_mfma_f32_16x16x32_bf16 v[92:95], a[44:47], v[44:47], v[92:95]
    s_waitcnt lgkmcnt(4)
    v_mfma_f32_16x16x32_bf16 v[80:83], a[48:51], v[48:51], v[80:83]
    ds_read_b128 v[40:43], v13 offset:18432
    ds_read_b128 v[44:47], v13 offset:19456
    v_mfma_f32_16x16x32_bf16 v[84:87], a[52:55], v[48:51], v[84:87]
    v_mfma_f32_16x16x32_bf16 v[88:91], a[48:51], v[52:55], v[88:91]
    buffer_load_dwordx4 v10, s[12:15], s49 offen offset:2048 sc1 lds
    v_mfma_f32_16x16x32_bf16 v[92:95], a[52:55], v[52:55], v[92:95]
    s_waitcnt lgkmcnt(4)
    v_mfma_f32_16x16x32_bf16 v[80:83], a[56:59], v[56:59], v[80:83]
    ds_read_b128 v[48:51], v13 offset:20480
    ds_read_b128 v[52:55], v13 offset:21504
    v_mfma_f32_16x16x32_bf16 v[84:87], a[60:63], v[56:59], v[84:87]
    v_mfma_f32_16x16x32_bf16 v[88:91], a[56:59], v[60:63], v[88:91]
    buffer_load_dwordx4 v10, s[12:15], s49 offen offset:3072 sc1 lds
    v_mfma_f32_16x16x32_bf16 v[92:95], a[60:63], v[60:63], v[92:95]
    s_waitcnt lgkmcnt(4)
    v_mfma_f32_16x16x32_bf16 v[80:83], a[64:67], v[32:35], v[80:83]
    ds_read_b128 v[56:59], v13 offset:22528
    ds_read_b128 v[60:63], v13 offset:23552
    v_mfma_f32_16x16x32_bf16 v[84:87], a[68:71], v[32:35], v[84:87]
    v_mfma_f32_16x16x32_bf16 v[88:91], a[64:67], v[36:39], v[88:91]
    v_mfma_f32_16x16x32_bf16 v[92:95], a[68:71], v[36:39], v[92:95]
    s_waitcnt lgkmcnt(4)
    v_mfma_f32_16x16x32_bf16 v[80:83], a[72:75], v[40:43], v[80:83]
    ds_read_b128 v[32:35], v13 offset:24576
    ds_read_b128 v[36:39], v13 offset:25600
    v_mfma_f32_16x16x32_bf16 v[84:87], a[76:79], v[40:43], v[84:87]
    v_mfma_f32_16x16x32_bf16 v[88:91], a[72:75], v[44:47], v[88:91]
    v_mfma_f32_16x16x32_bf16 v[92:95], a[76:79], v[44:47], v[92:95]
    s_waitcnt lgkmcnt(4)
    v_mfma_f32_16x16x32_bf16 v[80:83], a[80:83], v[48:51], v[80:83]
    ds_read_b128 v[40:43], v13 offset:26624
    ds_read_b128 v[44:47], v13 offset:27648
    v_mfma_f32_16x16x32_bf16 v[84:87], a[84:87], v[48:51], v[84:87]
    v_mfma_f32_16x16x32_bf16 v[88:91], a[80:83], v[52:55], v[88:91]
    v_mfma_f32_16x16x32_bf16 v[92:95], a[84:87], v[52:55], v[92:95]
    s_waitcnt lgkmcnt(4)
    v_mfma_f32_16x16x32_bf16 v[80:83], a[88:91], v[56:59], v[80:83]
    ds_read_b128 v[48:51], v13 offset:28672
    ds_read_b128 v[52:55], v13 offset:29696
    v_mfma_f32_16x16x32_bf16 v[84:87], a[92:95], v[56:59], v[84:87]
    v_mfma_f32_16x16x32_bf16 v[88:91], a[88:91], v[60:63], v[88:91]
    v_mfma_f32_16x16x32_bf16 v[92:95], a[92:95], v[60:63], v[92:95]
    s_waitcnt lgkmcnt(4)
    v_mfma_f32_16x16x32_bf16 v[80:83], a[96:99], v[32:35], v[80:83]
    ds_read_b128 v[56:59], v13 offset:30720
    ds_read_b128 v[60:63], v13 offset:31744
    v_mfma_f32_16x16x32_bf16 v[84:87], a[100:103], v[32:35], v[84:87]
    v_mfma_f32_16x16x32_bf16 v[88:91], a[96:99], v[36:39], v[88:91]
    v_mfma_f32_16x16x32_bf16 v[92:95], a[100:103], v[36:39], v[92:95]
    s_waitcnt lgkmcnt(4)
    v_mfma_f32_16x16x32_bf16 v[80:83], a[104:107], v[40:43], v[80:83]
    ds_read_b128 v[216:219], v8 offset:0
    ds_read_b128 v[220:223], v8 offset:1152
    v_mfma_f32_16x16x32_bf16 v[84:87], a[108:111], v[40:43], v[84:87]
    ds_read_b128 v[224:227], v8 offset:2304
    ds_read_b128 v[228:231], v8 offset:3456
    v_mfma_f32_16x16x32_bf16 v[88:91], a[104:107], v[44:47], v[88:91]
    v_mfma_f32_16x16x32_bf16 v[92:95], a[108:111], v[44:47], v[92:95]
    s_waitcnt vmcnt(16) lgkmcnt(0)
    s_barrier
    v_mfma_f32_16x16x32_bf16 v[80:83], a[112:115], v[48:51], v[80:83]
    ds_read_b128 v[32:35], v13 offset:32768
    ds_read_b128 v[36:39], v13 offset:33792
    v_mfma_f32_16x16x32_bf16 v[84:87], a[116:119], v[48:51], v[84:87]
    buffer_store_dwordx4 v[216:219], v11, s[12:15], s76 offen sc1
    s_add_u32 s76, s76, 32768
    v_mfma_f32_16x16x32_bf16 v[88:91], a[112:115], v[52:55], v[88:91]
    buffer_store_dwordx4 v[220:223], v11, s[12:15], s76 offen sc1
    s_add_u32 s76, s76, 32768
    v_mfma_f32_16x16x32_bf16 v[92:95], a[116:119], v[52:55], v[92:95]
    buffer_store_dwordx4 v[224:227], v11, s[12:15], s76 offen sc1
    s_add_u32 s76, s76, 32768
    v_mfma_f32_16x16x32_bf16 v[80:83], a[120:123], v[56:59], v[80:83]
    ds_read_b128 v[40:43], v13 offset:34816
    ds_read_b128 v[44:47], v13 offset:35840
    v_mfma_f32_16x16x32_bf16 v[84:87], a[124:127], v[56:59], v[84:87]
    buffer_store_dwordx4 v[228:231], v11, s[12:15], s76 offen sc1
    v_mfma_f32_16x16x32_bf16 v[88:91], a[120:123], v[60:63], v[88:91]
    v_mfma_f32_16x16x32_bf16 v[92:95], a[124:127], v[60:63], v[92:95]
    s_add_u32 s48, s53, 524288
    s_add_u32 s46, s58, 2
    s_cmp_lt_u32 s46, s51
    s_cselect_b32 s48, s48, 0x20000000
    s_add_u32 s49, s48, 4096
    s_mov_b32 s59, s54
    s_waitcnt lgkmcnt(2)
    v_mfma_f32_16x16x32_bf16 v[80:83], a[128:131], v[32:35], v[80:83]
    ds_read_b128 v[48:51], v13 offset:36864
    ds_read_b128 v[52:55], v13 offset:37888
    v_mfma_f32_16x16x32_bf16 v[84:87], a[132:135], v[32:35], v[84:87]
    ds_read_b128 v[56:59], v13 offset:38912
    ds_read_b128 v[60:63], v13 offset:39936
    s_add_u32 m0, s59, 0
    v_mfma_f32_16x16x32_bf16 v[88:91], a[128:131], v[36:39], v[88:91]
    buffer_load_dwordx4 v10, s[12:15], s48 offen offset:0 sc1 lds
    v_mfma_f32_16x16x32_bf16 v[92:95], a[132:135], v[36:39], v[92:95]
    s_waitcnt lgkmcnt(4)
    v_mfma_f32_16x16x32_bf16 v[80:83], a[136:139], v[40:43], v[80:83]
    ds_read_b128 v[32:35], v13 offset:40960
    ds_read_b128 v[36:39], v13 offset:41984
    v_mfma_f32_16x16x32_bf16 v[84:87], a[140:143], v[40:43], v[84:87]
    v_mfma_f32_16x16x32_bf16 v[88:91], a[136:139], v[44:47], v[88:91]
    buffer_load_dwordx4 v10, s[12:15], s48 offen offset:1024 sc1 lds
    v_mfma_f32_16x16x32_bf16 v[92:95], a[140:143], v[44:47], v[92:95]
    s_waitcnt lgkmcnt(4)
    v_mfma_f32_16x16x32_bf16 v[80:83], a[144:147], v[48:51], v[80:83]
    ds_read_b128 v[40:43], v13 offset:43008
    ds_read_b128 v[44:47], v13 offset:44032
    v_mfma_f32_16x16x32_bf16 v[84:87], a[148:151], v[48:51], v[84:87]
    v_mfma_f32_16x16x32_bf16 v[88:91], a[144:147], v[52:55], v[88:91]
    buffer_load_dwordx4 v10, s[12:15], s48 offen offset:2048 sc1 lds
    v_mfma_f32_16x16x32_bf16 v[92:95], a[148:151], v[52:55], v[92:95]
    s_waitcnt lgkmcnt(4)
    v_mfma_f32_16x16x32_bf16 v[80:83], a[152:155], v[56:59], v[80:83]
    ds_read_b128 v[48:51], v13 offset:45056
    ds_read_b128 v[52:55], v13 offset:46080
    v_mfma_f32_16x16x32_bf16 v[84:87], a[156:159], v[56:59], v[84:87]
    v_mfma_f32_16x16x32_bf16 v[88:91], a[152:155], v[60:63], v[88:91]
    buffer_load_dwordx4 v10, s[12:15], s48 offen offset:3072 sc1 lds
    v_mfma_f32_16x16x32_bf16 v[92:95], a[156:159], v[60:63], v[92:95]
    s_waitcnt lgkmcnt(4)
    v_mfma_f32_16x16x32_bf16 v[80:83], a[160:163], v[32:35], v[80:83]
    ds_read_b128 v[56:59], v13 offset:47104
    ds_read_b128 v[60:63], v13 offset:48128
    v_mfma_f32_16x16x32_bf16 v[84:87], a[164:167], v[32:35], v[84:87]
    s_add_u32 m0, s59, 4096
    v_mfma_f32_16x16x32_bf16 v[88:91], a[160:163], v[36:39], v[88:91]
    buffer_load_dwordx4 v10, s[12:15], s49 offen offset:0 sc1 lds
    v_mfma_f32_16x16x32_bf16 v[92:95], a[164:167], v[36:39], v[92:95]
    s_waitcnt lgkmcnt(4)
    v_mfma_f32_16x16x32_bf16 v[80:83], a[168:171], v[40:43], v[80:83]
    ds_read_b128 v[32:35], v13 offset:49152
    ds_read_b128 v[36:39], v13 offset:50176
    v_mfma_f32_16x16x32_bf16 v[84:87], a[172:175], v[40:43], v[84:87]
    v_mfma_f32_16x16x32_bf16 v[88:91], a[168:171], v[44:47], v[88:91]
    buffer_load_dwordx4 v10, s[12:15], s49 offen offset:1024 sc1 lds
    v_mfma_f32_16x16x32_bf16 v[92:95], a[172:175], v[44:47], v[92:95]
    s_waitcnt lgkmcnt(4)
    v_mfma_f32_16x16x32_bf16 v[80:83], a[176:179], v[48:51], v[80:83]
    ds_read_b128 v[40:43], v13 offset:51200
    ds_read_b128 v[44:47], v13 offset:52224
    v_mfma_f32_16x16x32_bf16 v[84:87], a[180:183], v[48:51], v[84:87]
    v_mfma_f32_16x16x32_bf16 v[88:91], a[176:179], v[52:55], v[88:91]
    buffer_load_dwordx4 v10, s[12:15], s49 offen offset:2048 sc1 lds
    v_mfma_f32_16x16x32_bf16 v[92:95], a[180:183], v[52:55], v[92:95]
    s_waitcnt lgkmcnt(4)
    v_mfma_f32_16x16x32_bf16 v[80:83], a[184:187], v[56:59], v[80:83]
    ds_read_b128 v[48:51], v13 offset:53248
    ds_read_b128 v[52:55], v13 offset:54272
    v_mfma_f32_16x16x32_bf16 v[84:87], a[188:191], v[56:59], v[84:87]
    v_mfma_f32_16x16x32_bf16 v[88:91], a[184:187], v[60:63], v[88:91]
    buffer_load_dwordx4 v10, s[12:15], s49 offen offset:3072 sc1 lds
    v_mfma_f32_16x16x32_bf16 v[92:95], a[188:191], v[60:63], v[92:95]
    s_waitcnt lgkmcnt(4)
    v_mfma_f32_16x16x32_bf16 v[80:83], a[192:195], v[32:35], v[80:83]
    ds_read_b128 v[56:59], v13 offset:55296
    ds_read_b128 v[60:63], v13 offset:56320
    v_mfma_f32_16x16x32_bf16 v[84:87], a[196:199], v[32:35], v[84:87]
    v_mfma_f32_16x16x32_bf16 v[88:91], a[192:195], v[36:39], v[88:91]
    v_mfma_f32_16x16x32_bf16 v[92:95], a[196:199], v[36:39], v[92:95]
    s_waitcnt lgkmcnt(4)
    v_mfma_f32_16x16x32_bf16 v[80:83], a[200:203], v[40:43], v[80:83]
    ds_read_b128 v[32:35], v13 offset:57344
    ds_read_b128 v[36:39], v13 offset:58368
    v_mfma_f32_16x16x32_bf16 v[84:87], a[204:207], v[40:43], v[84:87]
    v_mfma_f32_16x16x32_bf16 v[88:91], a[200:203], v[44:47], v[88:91]
    v_mfma_f32_16x16x32_bf16 v[92:95], a[204:207], v[44:47], v[92:95]
    s_waitcnt lgkmcnt(4)
    v_mfma_f32_16x16x32_bf16 v[80:83], a[208:211], v[48:51], v[80:83]
    ds_read_b128 v[40:43], v13 offset:59392
    ds_read_b128 v[44:47], v13 offset:60416
    v_mfma_f32_16x16x32_bf16 v[84:87], a[212:215], v[48:51], v[84:87]
    v_mfma_f32_16x16x32_bf16 v[88:91], a[208:211], v[52:55], v[88:91]
    v_mfma_f32_16x16x32_bf16 v[92:95], a[212:215], v[52:55], v[92:95]
    s_waitcnt lgkmcnt(4)
    v_mfma_f32_16x16x32_bf16 v[80:83], a[216:219], v[56:59], v[80:83]
    ds_read_b128 v[48:51], v13 offset:61440
    ds_read_b128 v[52:55], v13 offset:62464
    v_mfma_f32_16x16x32_bf16 v[84:87], a[220:223], v[56:59], v[84:87]
    v_mfma_f32_16x16x32_bf16 v[88:91], a[216:219], v[60:63], v[88:91]
    v_mfma_f32_16x16x32_bf16 v[92:95], a[220:223], v[60:63], v[92:95]
    s_waitcnt lgkmcnt(4)
    v_mfma_f32_16x16x32_bf16 v[80:83], a[224:227], v[32:35], v[80:83]
    ds_read_b128 v[56:59], v13 offset:63488
    ds_read_b128 v[60:63], v13 offset:64512
    v_mfma_f32_16x16x32_bf16 v[84:87], a[228:231], v[32:35], v[84:87]
    v_mfma_f32_16x16x32_bf16 v[88:91], a[224:227], v[36:39], v[88:91]
    v_mfma_f32_16x16x32_bf16 v[92:95], a[228:231], v[36:39], v[92:95]
    s_waitcnt lgkmcnt(4)
    v_mfma_f32_16x16x32_bf16 v[80:83], a[232:235], v[40:43], v[80:83]
    v_mfma_f32_16x16x32_bf16 v[84:87], a[236:239], v[40:43], v[84:87]
    v_mfma_f32_16x16x32_bf16 v[88:91], a[232:235], v[44:47], v[88:91]
    v_mfma_f32_16x16x32_bf16 v[92:95], a[236:239], v[44:47], v[92:95]
    s_waitcnt vmcnt(16) lgkmcnt(0)
    s_barrier
    v_mfma_f32_16x16x32_bf16 v[80:83], a[240:243], v[48:51], v[80:83]
    ds_read_b128 v[32:35], v14 offset:0
    ds_read_b128 v[36:39], v14 offset:1024
    v_mfma_f32_16x16x32_bf16 v[84:87], a[244:247], v[48:51], v[84:87]
    v_mfma_f32_16x16x32_bf16 v[88:91], a[240:243], v[52:55], v[88:91]
    v_mfma_f32_16x16x32_bf16 v[92:95], a[244:247], v[52:55], v[92:95]
    v_mfma_f32_16x16x32_bf16 v[80:83], a[248:251], v[56:59], v[80:83]
    ds_read_b128 v[40:43], v14 offset:2048
    ds_read_b128 v[44:47], v14 offset:3072
    v_mfma_f32_16x16x32_bf16 v[84:87], a[252:255], v[56:59], v[84:87]
    v_mfma_f32_16x16x32_bf16 v[88:91], a[248:251], v[60:63], v[88:91]
    v_mfma_f32_16x16x32_bf16 v[92:95], a[252:255], v[60:63], v[92:95]
    s_add_u32 s53, s53, 262144
    s_add_u32 s58, s58, 1
    v_swap_b32 v13, v14
    s_xor_b32 s54, s54, 65536
    s_xor_b32 s55, s55, 65536
    s_mov_b32 s76, s57
    v_swap_b32 v15, v16
    s_add_u32 s57, s57, 131072
    ds_write_b128 v7, v[80:83] offset:0
    ds_write_b128 v7, v[84:87] offset:64
    ds_write_b128 v7, v[88:91] offset:2304
    ds_write_b128 v7, v[92:95] offset:2368
    s_cmp_lt_u32 s58, s51
    s_cbranch_scc1 L_e_loop_141
    s_branch L_e_fin_143
L_e_one_142:
    s_waitcnt vmcnt(8)
    s_barrier
    ds_read_b128 v[32:35], v13 offset:0
    ds_read_b128 v[36:39], v13 offset:1024
    ds_read_b128 v[40:43], v13 offset:2048
    ds_read_b128 v[44:47], v13 offset:3072
    s_waitcnt lgkmcnt(2)
    v_mfma_f32_16x16x32_bf16 v[80:83], a[0:3], v[32:35], 0
    ds_read_b128 v[48:51], v13 offset:4096
    ds_read_b128 v[52:55], v13 offset:5120
    v_mfma_f32_16x16x32_bf16 v[84:87], a[4:7], v[32:35], 0
    ds_read_b128 v[56:59], v13 offset:6144
    ds_read_b128 v[60:63], v13 offset:7168
    v_mfma_f32_16x16x32_bf16 v[88:91], a[0:3], v[36:39], 0
    v_mfma_f32_16x16x32_bf16 v[92:95], a[4:7], v[36:39], 0
    s_waitcnt lgkmcnt(4)
    v_mfma_f32_16x16x32_bf16 v[80:83], a[8:11], v[40:43], v[80:83]
    ds_read_b128 v[32:35], v13 offset:8192
    ds_read_b128 v[36:39], v13 offset:9216
    v_mfma_f32_16x16x32_bf16 v[84:87], a[12:15], v[40:43], v[84:87]
    v_mfma_f32_16x16x32_bf16 v[88:91], a[8:11], v[44:47], v[88:91]
    v_mfma_f32_16x16x32_bf16 v[92:95], a[12:15], v[44:47], v[92:95]
    s_waitcnt lgkmcnt(4)
    v_mfma_f32_16x16x32_bf16 v[80:83], a[16:19], v[48:51], v[80:83]
    ds_read_b128 v[40:43], v13 offset:10240
    ds_read_b128 v[44:47], v13 offset:11264
    v_mfma_f32_16x16x32_bf16 v[84:87], a[20:23], v[48:51], v[84:87]
    v_mfma_f32_16x16x32_bf16 v[88:91], a[16:19], v[52:55], v[88:91]
    v_mfma_f32_16x16x32_bf16 v[92:95], a[20:23], v[52:55], v[92:95]
    s_waitcnt lgkmcnt(4)
    v_mfma_f32_16x16x32_bf16 v[80:83], a[24:27], v[56:59], v[80:83]
    ds_read_b128 v[48:51], v13 offset:12288
    ds_read_b128 v[52:55], v13 offset:13312
    v_mfma_f32_16x16x32_bf16 v[84:87], a[28:31], v[56:59], v[84:87]
    v_mfma_f32_16x16x32_bf16 v[88:91], a[24:27], v[60:63], v[88:91]
    v_mfma_f32_16x16x32_bf16 v[92:95], a[28:31], v[60:63], v[92:95]
    s_waitcnt lgkmcnt(4)
    v_mfma_f32_16x16x32_bf16 v[80:83], a[32:35], v[32:35], v[80:83]
    ds_read_b128 v[56:59], v13 offset:14336
    ds_read_b128 v[60:63], v13 offset:15360
    v_mfma_f32_16x16x32_bf16 v[84:87], a[36:39], v[32:35], v[84:87]
    v_mfma_f32_16x16x32_bf16 v[88:91], a[32:35], v[36:39], v[88:91]
    v_mfma_f32_16x16x32_bf16 v[92:95], a[36:39], v[36:39], v[92:95]
    s_waitcnt lgkmcnt(4)
    v_mfma_f32_16x16x32_bf16 v[80:83], a[40:43], v[40:43], v[80:83]
    ds_read_b128 v[32:35], v13 offset:16384
    ds_read_b128 v[36:39], v13 offset:17408
    v_mfma_f32_16x16x32_bf16 v[84:87], a[44:47], v[40:43], v[84:87]
    v_mfma_f32_16x16x32_bf16 v[88:91], a[40:43], v[44:47], v[88:91]
    v_mfma_f32_16x16x32_bf16 v[92:95], a[44:47], v[44:47], v[92:95]
    s_waitcnt lgkmcnt(4)
    v_mfma_f32_16x16x32_bf16 v[80:83], a[48:51], v[48:51], v[80:83]
    ds_read_b128 v[40:43], v13 offset:18432
    ds_read_b128 v[44:47], v13 offset:19456
    v_mfma_f32_16x16x32_bf16 v[84:87], a[52:55], v[48:51], v[84:87]
    v_mfma_f32_16x16x32_bf16 v[88:91], a[48:51], v[52:55], v[88:91]
    v_mfma_f32_16x16x32_bf16 v[92:95], a[52:55], v[52:55], v[92:95]
    s_waitcnt lgkmcnt(4)
    v_mfma_f32_16x16x32_bf16 v[80:83], a[56:59], v[56:59], v[80:83]
    ds_read_b128 v[48:51], v13 offset:20480
    ds_read_b128 v[52:55], v13 offset:21504
    v_mfma_f32_16x16x32_bf16 v[84:87], a[60:63], v[56:59], v[84:87]
    v_mfma_f32_16x16x32_bf16 v[88:91], a[56:59], v[60:63], v[88:91]
    v_mfma_f32_16x16x32_bf16 v[92:95], a[60:63], v[60:63], v[92:95]
    s_waitcnt lgkmcnt(4)
    v_mfma_f32_16x16x32_bf16 v[80:83], a[64:67], v[32:35], v[80:83]
    ds_read_b128 v[56:59], v13 offset:22528
    ds_read_b128 v[60:63], v13 offset:23552
    v_mfma_f32_16x16x32_bf16 v[84:87], a[68:71], v[32:35], v[84:87]
    v_mfma_f32_16x16x32_bf16 v[88:91], a[64:67], v[36:39], v[88:91]
    v_mfma_f32_16x16x32_bf16 v[92:95], a[68:71], v[36:39], v[92:95]
    s_waitcnt lgkmcnt(4)
    v_mfma_f32_16x16x32_bf16 v[80:83], a[72:75], v[40:43], v[80:83]
    ds_read_b128 v[32:35], v13 offset:24576
    ds_read_b128 v[36:39], v13 offset:25600
    v_mfma_f32_16x16x32_bf16 v[84:87], a[76:79], v[40:43], v[84:87]
    v_mfma_f32_16x16x32_bf16 v[88:91], a[72:75], v[44:47], v[88:91]
    v_mfma_f32_16x16x32_bf16 v[92:95], a[76:79], v[44:47], v[92:95]
    s_waitcnt lgkmcnt(4)
    v_mfma_f32_16x16x32_bf16 v[80:83], a[80:83], v[48:51], v[80:83]
    ds_read_b128 v[40:43], v13 offset:26624
    ds_read_b128 v[44:47], v13 offset:27648
    v_mfma_f32_16x16x32_bf16 v[84:87], a[84:87], v[48:51], v[84:87]
    v_mfma_f32_16x16x32_bf16 v[88:91], a[80:83], v[52:55], v[88:91]
    v_mfma_f32_16x16x32_bf16 v[92:95], a[84:87], v[52:55], v[92:95]
    s_waitcnt lgkmcnt(4)
    v_mfma_f32_16x16x32_bf16 v[80:83], a[88:91], v[56:59], v[80:83]
    ds_read_b128 v[48:51], v13 offset:28672
    ds_read_b128 v[52:55], v13 offset:29696
    v_mfma_f32_16x16x32_bf16 v[84:87], a[92:95], v[56:59], v[84:87]
    v_mfma_f32_16x16x32_bf16 v[88:91], a[88:91], v[60:63], v[88:91]
    v_mfma_f32_16x16x32_bf16 v[92:95], a[92:95], v[60:63], v[92:95]
    s_waitcnt lgkmcnt(4)
    v_mfma_f32_16x16x32_bf16 v[80:83], a[96:99], v[32:35], v[80:83]
    ds_read_b128 v[56:59], v13 offset:30720
    ds_read_b128 v[60:63], v13 offset:31744
    v_mfma_f32_16x16x32_bf16 v[84:87], a[100:103], v[32:35], v[84:87]
    v_mfma_f32_16x16x32_bf16 v[88:91], a[96:99], v[36:39], v[88:91]
    v_mfma_f32_16x16x32_bf16 v[92:95], a[100:103], v[36:39], v[92:95]
    s_waitcnt lgkmcnt(4)
    v_mfma_f32_16x16x32_bf16 v[80:83], a[104:107], v[40:43], v[80:83]
    v_mfma_f32_16x16x32_bf16 v[84:87], a[108:111], v[40:43], v[84:87]
    v_mfma_f32_16x16x32_bf16 v[88:91], a[104:107], v[44:47], v[88:91]
    v_mfma_f32_16x16x32_bf16 v[92:95], a[108:111], v[44:47], v[92:95]
    s_waitcnt vmcnt(0) lgkmcnt(0)
    s_barrier
    v_mfma_f32_16x16x32_bf16 v[80:83], a[112:115], v[48:51], v[80:83]
    ds_read_b128 v[32:35], v13 offset:32768
    ds_read_b128 v[36:39], v13 offset:33792
    v_mfma_f32_16x16x32_bf16 v[84:87], a[116:119], v[48:51], v[84:87]
    v_mfma_f32_16x16x32_bf16 v[88:91], a[112:115], v[52:55], v[88:91]
    v_mfma_f32_16x16x32_bf16 v[92:95], a[116:119], v[52:55], v[92:95]
    v_mfma_f32_16x16x32_bf16 v[80:83], a[120:123], v[56:59], v[80:83]
    ds_read_b128 v[40:43], v13 offset:34816
    ds_read_b128 v[44:47], v13 offset:35840
    v_mfma_f32_16x16x32_bf16 v[84:87], a[124:127], v[56:59], v[84:87]
    v_mfma_f32_16x16x32_bf16 v[88:91], a[120:123], v[60:63], v[88:91]
    v_mfma_f32_16x16x32_bf16 v[92:95], a[124:127], v[60:63], v[92:95]
    s_waitcnt lgkmcnt(2)
    v_mfma_f32_16x16x32_bf16 v[80:83], a[128:131], v[32:35], v[80:83]
    ds_read_b128 v[48:51], v13 offset:36864
    ds_read_b128 v[52:55], v13 offset:37888
    v_mfma_f32_16x16x32_bf16 v[84:87], a[132:135], v[32:35], v[84:87]
    ds_read_b128 v[56:59], v13 offset:38912
    ds_read_b128 v[60:63], v13 offset:39936
    v_mfma_f32_16x16x32_bf16 v[88:91], a[128:131], v[36:39], v[88:91]
    v_mfma_f32_16x16x32_bf16 v[92:95], a[132:135], v[36:39], v[92:95]
    s_waitcnt lgkmcnt(4)
    v_mfma_f32_16x16x32_bf16 v[80:83], a[136:139], v[40:43], v[80:83]
    ds_read_b128 v[32:35], v13 offset:40960
    ds_read_b128 v[36:39], v13 offset:41984
    v_mfma_f32_16x16x32_bf16 v[84:87], a[140:143], v[40:43], v[84:87]
    v_mfma_f32_16x16x32_bf16 v[88:91], a[136:139], v[44:47], v[88:91]
    v_mfma_f32_16x16x32_bf16 v[92:95], a[140:143], v[44:47], v[92:95]
    s_waitcnt lgkmcnt(4)
    v_mfma_f32_16x16x32_bf16 v[80:83], a[144:147], v[48:51], v[80:83]
    ds_read_b128 v[40:43], v13 offset:43008
    ds_read_b128 v[44:47], v13 offset:44032
    v_mfma_f32_16x16x32_bf16 v[84:87], a[148:151], v[48:51], v[84:87]
    v_mfma_f32_16x16x32_bf16 v[88:91], a[144:147], v[52:55], v[88:91]
    v_mfma_f32_16x16x32_bf16 v[92:95], a[148:151], v[52:55], v[92:95]
    s_waitcnt lgkmcnt(4)
    v_mfma_f32_16x16x32_bf16 v[80:83], a[152:155], v[56:59], v[80:83]
    ds_read_b128 v[48:51], v13 offset:45056
    ds_read_b128 v[52:55], v13 offset:46080
    v_mfma_f32_16x16x32_bf16 v[84:87], a[156:159], v[56:59], v[84:87]
    v_mfma_f32_16x16x32_bf16 v[88:91], a[152:155], v[60:63], v[88:91]
    v_mfma_f32_16x16x32_bf16 v[92:95], a[156:159], v[60:63], v[92:95]
    s_waitcnt lgkmcnt(4)
    v_mfma_f32_16x16x32_bf16 v[80:83], a[160:163], v[32:35], v[80:83]
    ds_read_b128 v[56:59], v13 offset:47104
    ds_read_b128 v[60:63], v13 offset:48128
    v_mfma_f32_16x16x32_bf16 v[84:87], a[164:167], v[32:35], v[84:87]
    v_mfma_f32_16x16x32_bf16 v[88:91], a[160:163], v[36:39], v[88:91]
    v_mfma_f32_16x16x32_bf16 v[92:95], a[164:167], v[36:39], v[92:95]
    s_waitcnt lgkmcnt(4)
    v_mfma_f32_16x16x32_bf16 v[80:83], a[168:171], v[40:43], v[80:83]
    ds_read_b128 v[32:35], v13 offset:49152
    ds_read_b128 v[36:39], v13 offset:50176
    v_mfma_f32_16x16x32_bf16 v[84:87], a[172:175], v[40:43], v[84:87]
    v_mfma_f32_16x16x32_bf16 v[88:91], a[168:171], v[44:47], v[88:91]
    v_mfma_f32_16x16x32_bf16 v[92:95], a[172:175], v[44:47], v[92:95]
    s_waitcnt lgkmcnt(4)
    v_mfma_f32_16x16x32_bf16 v[80:83], a[176:179], v[48:51], v[80:83]
    ds_read_b128 v[40:43], v13 offset:51200
    ds_read_b128 v[44:47], v13 offset:52224
    v_mfma_f32_16x16x32_bf16 v[84:87], a[180:183], v[48:51], v[84:87]
    v_mfma_f32_16x16x32_bf16 v[88:91], a[176:179], v[52:55], v[88:91]
    v_mfma_f32_16x16x32_bf16 v[92:95], a[180:183], v[52:55], v[92:95]
    s_waitcnt lgkmcnt(4)
    v_mfma_f32_16x16x32_bf16 v[80:83], a[184:187], v[56:59], v[80:83]
    ds_read_b128 v[48:51], v13 offset:53248
    ds_read_b128 v[52:55], v13 offset:54272
    v_mfma_f32_16x16x32_bf16 v[84:87], a[188:191], v[56:59], v[84:87]
    v_mfma_f32_16x16x32_bf16 v[88:91], a[184:187], v[60:63], v[88:91]
    v_mfma_f32_16x16x32_bf16 v[92:95], a[188:191], v[60:63], v[92:95]
    s_waitcnt lgkmcnt(4)
    v_mfma_f32_16x16x32_bf16 v[80:83], a[192:195], v[32:35], v[80:83]
    ds_read_b128 v[56:59], v13 offset:55296
    ds_read_b128 v[60:63], v13 offset:56320
    v_mfma_f32_16x16x32_bf16 v[84:87], a[196:199], v[32:35], v[84:87]
    v_mfma_f32_16x16x32_bf16 v[88:91], a[192:195], v[36:39], v[88:91]
    v_mfma_f32_16x16x32_bf16 v[92:95], a[196:199], v[36:39], v[92:95]
    s_waitcnt lgkmcnt(4)
    v_mfma_f32_16x16x32_bf16 v[80:83], a[200:203], v[40:43], v[80:83]
    ds_read_b128 v[32:35], v13 offset:57344
    ds_read_b128 v[36:39], v13 offset:58368
    v_mfma_f32_16x16x32_bf16 v[84:87], a[204:207], v[40:43], v[84:87]
    v_mfma_f32_16x16x32_bf16 v[88:91], a[200:203], v[44:47], v[88:91]
    v_mfma_f32_16x16x32_bf16 v[92:95], a[204:207], v[44:47], v[92:95]
    s_waitcnt lgkmcnt(4)
    v_mfma_f32_16x16x32_bf16 v[80:83], a[208:211], v[48:51], v[80:83]
    ds_read_b128 v[40:43], v13 offset:59392
    ds_read_b128 v[44:47], v13 offset:60416
    v_mfma_f32_16x16x32_bf16 v[84:87], a[212:215], v[48:51], v[84:87]
    v_mfma_f32_16x16x32_bf16 v[88:91], a[208:211], v[52:55], v[88:91]
    v_mfma_f32_16x16x32_bf16 v[92:95], a[212:215], v[52:55], v[92:95]
    s_waitcnt lgkmcnt(4)
    v_mfma_f32_16x16x32_bf16 v[80:83], a[216:219], v[56:59], v[80:83]
    ds_read_b128 v[48:51], v13 offset:61440
    ds_read_b128 v[52:55], v13 offset:62464
    v_mfma_f32_16x16x32_bf16 v[84:87], a[220:223], v[56:59], v[84:87]
    v_mfma_f32_16x16x32_bf16 v[88:91], a[216:219], v[60:63], v[88:91]
    v_mfma_f32_16x16x32_bf16 v[92:95], a[220:223], v[60:63], v[92:95]
    s_waitcnt lgkmcnt(4)
    v_mfma_f32_16x16x32_bf16 v[80:83], a[224:227], v[32:35], v[80:83]
    ds_read_b128 v[56:59], v13 offset:63488
    ds_read_b128 v[60:63], v13 offset:64512
    v_mfma_f32_16x16x32_bf16 v[84:87], a[228:231], v[32:35], v[84:87]
    v_mfma_f32_16x16x32_bf16 v[88:91], a[224:227], v[36:39], v[88:91]
    v_mfma_f32_16x16x32_bf16 v[92:95], a[228:231], v[36:39], v[92:95]
    s_waitcnt lgkmcnt(4)
    v_mfma_f32_16x16x32_bf16 v[80:83], a[232:235], v[40:43], v[80:83]
    v_mfma_f32_16x16x32_bf16 v[84:87], a[236:239], v[40:43], v[84:87]
    v_mfma_f32_16x16x32_bf16 v[88:91], a[232:235], v[44:47], v[88:91]
    v_mfma_f32_16x16x32_bf16 v[92:95], a[236:239], v[44:47], v[92:95]
    s_waitcnt lgkmcnt(0)
    v_mfma_f32_16x16x32_bf16 v[80:83], a[240:243], v[48:51], v[80:83]
    v_mfma_f32_16x16x32_bf16 v[84:87], a[244:247], v[48:51], v[84:87]
    v_mfma_f32_16x16x32_bf16 v[88:91], a[240:243], v[52:55], v[88:91]
    v_mfma_f32_16x16x32_bf16 v[92:95], a[244:247], v[52:55], v[92:95]
    v_mfma_f32_16x16x32_bf16 v[80:83], a[248:251], v[56:59], v[80:83]
    v_mfma_f32_16x16x32_bf16 v[84:87], a[252:255], v[56:59], v[84:87]
    v_mfma_f32_16x16x32_bf16 v[88:91], a[248:251], v[60:63], v[88:91]
    v_mfma_f32_16x16x32_bf16 v[92:95], a[252:255], v[60:63], v[92:95]
    s_mov_b32 s76, s57
    s_nop 6
    ds_write_b128 v7, v[80:83] offset:0
    ds_write_b128 v7, v[84:87] offset:64
    ds_write_b128 v7, v[88:91] offset:2304
    ds_write_b128 v7, v[92:95] offset:2368
L_e_fin_143:
    s_waitcnt lgkmcnt(0)
    ds_read_b128 v[216:219], v8 offset:0
    ds_read_b128 v[220:223], v8 offset:1152
    ds_read_b128 v[224:227], v8 offset:2304
    ds_read_b128 v[228:231], v8 offset:3456
    s_waitcnt lgkmcnt(0)
    buffer_store_dwordx4 v[216:219], v11, s[12:15], s76 offen sc1
    s_add_u32 s76, s76, 32768
    buffer_store_dwordx4 v[220:223], v11, s[12:15], s76 offen sc1
    s_add_u32 s76, s76, 32768
    buffer_store_dwordx4 v[224:227], v11, s[12:15], s76 offen sc1
    s_add_u32 s76, s76, 32768
    buffer_store_dwordx4 v[228:231], v11, s[12:15], s76 offen sc1
    s_waitcnt vmcnt(0)
    s_barrier
    s_cmp_lg_u32 s44, 0
    s_cbranch_scc1 L_pub_144
    v_mov_b32 v30, s62
    v_mov_b32 v31, 0
    s_mov_b64 exec, 1
    buffer_store_dword v30, v31, s[12:15], s67 offen sc1
    s_mov_b64 exec, -1
L_pub_144:
    s_branch L_a_loop_127
L_role_b_125:
    s_load_dwordx2 s[6:7], s[0:1], 64
    s_load_dwordx2 s[8:9], s[0:1], 72
    s_waitcnt lgkmcnt(0)
    s_mov_b32 s24, s6
    s_and_b32 s25, s7, 0xffff
    s_mov_b32 s26, 0x700000
    s_mov_b32 s27, 0x00020000
    s_mov_b32 s32, s8
    s_and_b32 s33, s9, 0xffff
    s_mov_b32 s34, 0x1c00
    s_mov_b32 s35, 0x00020000
    s_min_u32 s45, s41, 27
    s_lshl_b32 s46, s45, 8
    s_waitcnt vmcnt(0)
    s_barrier
    v_lshrrev_b32 v20, 4, v1
    s_lshl_b32 s45, s44, 2
    v_add_u32 v21, s45, v20
    s_mov_b32 s45, 7168
    v_mul_lo_u32 v21, v21, s45
    v_lshlrev_b32 v22, 2, v20
    v_and_b32 v23, 15, v1
    v_xor_b32 v22, v22, v23
    v_lshlrev_b32 v22, 4, v22
    v_add_u32 v21, v21, v22
    v_bfe_u32 v22, v1, 2, 2
    v_lshlrev_b32 v23, 3, v20
    v_add_u32 v23, v23, v22
    v_lshlrev_b32 v23, 8, v23
    v_xor_b32 v22, s44, v22
    v_lshlrev_b32 v22, 6, v22
    v_add_u32 v23, v23, v22
    v_and_b32 v22, 3, v1
    v_lshlrev_b32 v22, 4, v22
    v_add_u32 v23, v23, v22
    v_add_u32 v24, 65536, v23
    v_add_u32 v25, 131072, v23
    s_lshl_b32 s47, s44, 10
    s_add_u32 s45, s46, 0x0
    s_add_u32 m0, s47, 0
    s_nop 0
    buffer_load_dwordx4 v21, s[24:27], s45 offen  lds
    s_add_u32 s45, s46, 0x1c000
    s_add_u32 m0, s47, 4096
    s_nop 0
    buffer_load_dwordx4 v21, s[24:27], s45 offen  lds
    s_add_u32 s45, s46, 0x38000
    s_add_u32 m0, s47, 8192
    s_nop 0
    buffer_load_dwordx4 v21, s[24:27], s45 offen  lds
    s_add_u32 s45, s46, 0x54000
    s_add_u32 m0, s47, 12288
    s_nop 0
    buffer_load_dwordx4 v21, s[24:27], s45 offen  lds
    s_add_u32 s45, s46, 0x70000
    s_add_u32 m0, s47, 16384
    s_nop 0
    buffer_load_dwordx4 v21, s[24:27], s45 offen  lds
    s_add_u32 s45, s46, 0x8c000
    s_add_u32 m0, s47, 20480
    s_nop 0
    buffer_load_dwordx4 v21, s[24:27], s45 offen  lds
    s_add_u32 s45, s46, 0xa8000
    s_add_u32 m0, s47, 24576
    s_nop 0
    buffer_load_dwordx4 v21, s[24:27], s45 offen  lds
    s_add_u32 s45, s46, 0xc4000
    s_add_u32 m0, s47, 28672
    s_nop 0
    buffer_load_dwordx4 v21, s[24:27], s45 offen  lds
    s_add_u32 s45, s46, 0xe0000
    s_add_u32 m0, s47, 32768
    s_nop 0
    buffer_load_dwordx4 v21, s[24:27], s45 offen  lds
    s_add_u32 s45, s46, 0xfc000
    s_add_u32 m0, s47, 36864
    s_nop 0
    buffer_load_dwordx4 v21, s[24:27], s45 offen  lds
    s_add_u32 s45, s46, 0x118000
    s_add_u32 m0, s47, 40960
    s_nop 0
    buffer_load_dwordx4 v21, s[24:27], s45 offen  lds
    s_add_u32 s45, s46, 0x134000
    s_add_u32 m0, s47, 45056
    s_nop 0
    buffer_load_dwordx4 v21, s[24:27], s45 offen  lds
    s_add_u32 s45, s46, 0x150000
    s_add_u32 m0, s47, 49152
    s_nop 0
    buffer_load_dwordx4 v21, s[24:27], s45 offen  lds
    s_add_u32 s45, s46, 0x16c000
    s_add_u32 m0, s47, 53248
    s_nop 0
    buffer_load_dwordx4 v21, s[24:27], s45 offen  lds
    s_add_u32 s45, s46, 0x188000
    s_add_u32 m0, s47, 57344
    s_nop 0
    buffer_load_dwordx4 v21, s[24:27], s45 offen  lds
    s_add_u32 s45, s46, 0x1a4000
    s_add_u32 m0, s47, 61440
    s_nop 0
    buffer_load_dwordx4 v21, s[24:27], s45 offen  lds
    s_add_u32 s45, s46, 0x1c0000
    s_add_u32 m0, s47, 65536
    s_nop 0
    buffer_load_dwordx4 v21, s[24:27], s45 offen  lds
    s_add_u32 s45, s46, 0x1dc000
    s_add_u32 m0, s47, 69632
    s_nop 0
    buffer_load_dwordx4 v21, s[24:27], s45 offen  lds
    s_add_u32 s45, s46, 0x1f8000
    s_add_u32 m0, s47, 73728
    s_nop 0
    buffer_load_dwordx4 v21, s[24:27], s45 offen  lds
    s_add_u32 s45, s46, 0x214000
    s_add_u32 m0, s47, 77824
    s_nop 0
    buffer_load_dwordx4 v21, s[24:27], s45 offen  lds
    s_add_u32 s45, s46, 0x230000
    s_add_u32 m0, s47, 81920
    s_nop 0
    buffer_load_dwordx4 v21, s[24:27], s45 offen  lds
    s_add_u32 s45, s46, 0x24c000
    s_add_u32 m0, s47, 86016
    s_nop 0
    buffer_load_dwordx4 v21, s[24:27], s45 offen  lds
    s_add_u32 s45, s46, 0x268000
    s_add_u32 m0, s47, 90112
    s_nop 0
    buffer_load_dwordx4 v21, s[24:27], s45 offen  lds
    s_add_u32 s45, s46, 0x284000
    s_add_u32 m0, s47, 94208
    s_nop 0
    buffer_load_dwordx4 v21, s[24:27], s45 offen  lds
    s_add_u32 s45, s46, 0x2a0000
    s_add_u32 m0, s47, 98304
    s_nop 0
    buffer_load_dwordx4 v21, s[24:27], s45 offen  lds
    s_add_u32 s45, s46, 0x2bc000
    s_add_u32 m0, s47, 102400
    s_nop 0
    buffer_load_dwordx4 v21, s[24:27], s45 offen  lds
    s_add_u32 s45, s46, 0x2d8000
    s_add_u32 m0, s47, 106496
    s_nop 0
    buffer_load_dwordx4 v21, s[24:27], s45 offen  lds
    s_add_u32 s45, s46, 0x2f4000
    s_add_u32 m0, s47, 110592
    s_nop 0
    buffer_load_dwordx4 v21, s[24:27], s45 offen  lds
    s_add_u32 s45, s46, 0x310000
    s_add_u32 m0, s47, 114688
    s_nop 0
    buffer_load_dwordx4 v21, s[24:27], s45 offen  lds
    s_add_u32 s45, s46, 0x32c000
    s_add_u32 m0, s47, 118784
    s_nop 0
    buffer_load_dwordx4 v21, s[24:27], s45 offen  lds
    s_add_u32 s45, s46, 0x348000
    s_add_u32 m0, s47, 122880
    s_nop 0
    buffer_load_dwordx4 v21, s[24:27], s45 offen  lds
    s_add_u32 s45, s46, 0x364000
    s_add_u32 m0, s47, 126976
    s_nop 0
    buffer_load_dwordx4 v21, s[24:27], s45 offen  lds
    s_waitcnt vmcnt(28)
    s_barrier
    s_add_u32 s45, s46, 0x380000
    s_add_u32 m0, s47, 131072
    s_nop 0
    buffer_load_dwordx4 v21, s[24:27], s45 offen  lds
    s_add_u32 s45, s46, 0x39c000
    s_add_u32 m0, s47, 135168
    s_nop 0
    buffer_load_dwordx4 v21, s[24:27], s45 offen  lds
    s_add_u32 s45, s46, 0x3b8000
    s_add_u32 m0, s47, 139264
    s_nop 0
    buffer_load_dwordx4 v21, s[24:27], s45 offen  lds
    s_add_u32 s45, s46, 0x3d4000
    s_add_u32 m0, s47, 143360
    s_nop 0
    buffer_load_dwordx4 v21, s[24:27], s45 offen  lds
    ds_read_b64_tr_b16 a[0:1], v23 offset:0
    ds_read_b64_tr_b16 a[2:3], v23 offset:1024
    ds_read_b64_tr_b16 a[4:5], v23 offset:8
    ds_read_b64_tr_b16 a[6:7], v23 offset:1032
    ds_read_b64_tr_b16 a[8:9], v23 offset:8192
    ds_read_b64_tr_b16 a[10:11], v23 offset:9216
    ds_read_b64_tr_b16 a[12:13], v23 offset:8200
    ds_read_b64_tr_b16 a[14:15], v23 offset:9224
    s_waitcnt lgkmcnt(0)
    s_waitcnt vmcnt(28)
    s_barrier
    s_add_u32 s45, s46, 0x3f0000
    s_add_u32 m0, s47, 0
    s_nop 0
    buffer_load_dwordx4 v21, s[24:27], s45 offen  lds
    s_add_u32 s45, s46, 0x40c000
    s_add_u32 m0, s47, 4096
    s_nop 0
    buffer_load_dwordx4 v21, s[24:27], s45 offen  lds
    s_add_u32 s45, s46, 0x428000
    s_add_u32 m0, s47, 8192
    s_nop 0
    buffer_load_dwordx4 v21, s[24:27], s45 offen  lds
    s_add_u32 s45, s46, 0x444000
    s_add_u32 m0, s47, 12288
    s_nop 0
    buffer_load_dwordx4 v21, s[24:27], s45 offen  lds
    ds_read_b64_tr_b16 a[16:17], v23 offset:16384
    ds_read_b64_tr_b16 a[18:19], v23 offset:17408
    ds_read_b64_tr_b16 a[20:21], v23 offset:16392
    ds_read_b64_tr_b16 a[22:23], v23 offset:17416
    ds_read_b64_tr_b16 a[24:25], v23 offset:24576
    ds_read_b64_tr_b16 a[26:27], v23 offset:25600
    ds_read_b64_tr_b16 a[28:29], v23 offset:24584
    ds_read_b64_tr_b16 a[30:31], v23 offset:25608
    s_waitcnt lgkmcnt(0)
    s_waitcnt vmcnt(28)
    s_barrier
    s_add_u32 s45, s46, 0x460000
    s_add_u32 m0, s47, 16384
    s_nop 0
    buffer_load_dwordx4 v21, s[24:27], s45 offen  lds
    s_add_u32 s45, s46, 0x47c000
    s_add_u32 m0, s47, 20480
    s_nop 0
    buffer_load_dwordx4 v21, s[24:27], s45 offen  lds
    s_add_u32 s45, s46, 0x498000
    s_add_u32 m0, s47, 24576
    s_nop 0
    buffer_load_dwordx4 v21, s[24:27], s45 offen  lds
    s_add_u32 s45, s46, 0x4b4000
    s_add_u32 m0, s47, 28672
    s_nop 0
    buffer_load_dwordx4 v21, s[24:27], s45 offen  lds
    ds_read_b64_tr_b16 a[32:33], v23 offset:32768
    ds_read_b64_tr_b16 a[34:35], v23 offset:33792
    ds_read_b64_tr_b16 a[36:37], v23 offset:32776
    ds_read_b64_tr_b16 a[38:39], v23 offset:33800
    ds_read_b64_tr_b16 a[40:41], v23 offset:40960
    ds_read_b64_tr_b16 a[42:43], v23 offset:41984
    ds_read_b64_tr_b16 a[44:45], v23 offset:40968
    ds_read_b64_tr_b16 a[46:47], v23 offset:41992
    s_waitcnt lgkmcnt(0)
    s_waitcnt vmcnt(28)
    s_barrier
    s_add_u32 s45, s46, 0x4d0000
    s_add_u32 m0, s47, 32768
    s_nop 0
    buffer_load_dwordx4 v21, s[24:27], s45 offen  lds
    s_add_u32 s45, s46, 0x4ec000
    s_add_u32 m0, s47, 36864
    s_nop 0
    buffer_load_dwordx4 v21, s[24:27], s45 offen  lds
    s_add_u32 s45, s46, 0x508000
    s_add_u32 m0, s47, 40960
    s_nop 0
    buffer_load_dwordx4 v21, s[24:27], s45 offen  lds
    s_add_u32 s45, s46, 0x524000
    s_add_u32 m0, s47, 45056
    s_nop 0
    buffer_load_dwordx4 v21, s[24:27], s45 offen  lds
    ds_read_b64_tr_b16 a[48:49], v23 offset:49152
    ds_read_b64_tr_b16 a[50:51], v23 offset:50176
    ds_read_b64_tr_b16 a[52:53], v23 offset:49160
    ds_read_b64_tr_b16 a[54:55], v23 offset:50184
    ds_read_b64_tr_b16 a[56:57], v23 offset:57344
    ds_read_b64_tr_b16 a[58:59], v23 offset:58368
    ds_read_b64_tr_b16 a[60:61], v23 offset:57352
    ds_read_b64_tr_b16 a[62:63], v23 offset:58376
    s_waitcnt lgkmcnt(0)
    s_waitcnt vmcnt(28)
    s_barrier
    s_add_u32 s45, s46, 0x540000
    s_add_u32 m0, s47, 49152
    s_nop 0
    buffer_load_dwordx4 v21, s[24:27], s45 offen  lds
    s_add_u32 s45, s46, 0x55c000
    s_add_u32 m0, s47, 53248
    s_nop 0
    buffer_load_dwordx4 v21, s[24:27], s45 offen  lds
    s_add_u32 s45, s46, 0x578000
    s_add_u32 m0, s47, 57344
    s_nop 0
    buffer_load_dwordx4 v21, s[24:27], s45 offen  lds
    s_add_u32 s45, s46, 0x594000
    s_add_u32 m0, s47, 61440
    s_nop 0
    buffer_load_dwordx4 v21, s[24:27], s45 offen  lds
    ds_read_b64_tr_b16 a[64:65], v24 offset:0
    ds_read_b64_tr_b16 a[66:67], v24 offset:1024
    ds_read_b64_tr_b16 a[68:69], v24 offset:8
    ds_read_b64_tr_b16 a[70:71], v24 offset:1032
    ds_read_b64_tr_b16 a[72:73], v24 offset:8192
    ds_read_b64_tr_b16 a[74:75], v24 offset:9216
    ds_read_b64_tr_b16 a[76:77], v24 offset:8200
    ds_read_b64_tr_b16 a[78:79], v24 offset:9224
    s_waitcnt lgkmcnt(0)
    s_waitcnt vmcnt(28)
    s_barrier
    s_add_u32 s45, s46, 0x5b0000
    s_add_u32 m0, s47, 65536
    s_nop 0
    buffer_load_dwordx4 v21, s[24:27], s45 offen  lds
    s_add_u32 s45, s46, 0x5cc000
    s_add_u32 m0, s47, 69632
    s_nop 0
    buffer_load_dwordx4 v21, s[24:27], s45 offen  lds
    s_add_u32 s45, s46, 0x5e8000
    s_add_u32 m0, s47, 73728
    s_nop 0
    buffer_load_dwordx4 v21, s[24:27], s45 offen  lds
    s_add_u32 s45, s46, 0x604000
    s_add_u32 m0, s47, 77824
    s_nop 0
    buffer_load_dwordx4 v21, s[24:27], s45 offen  lds
    ds_read_b64_tr_b16 a[80:81], v24 offset:16384
    ds_read_b64_tr_b16 a[82:83], v24 offset:17408
    ds_read_b64_tr_b16 a[84:85], v24 offset:16392
    ds_read_b64_tr_b16 a[86:87], v24 offset:17416
    ds_read_b64_tr_b16 a[88:89], v24 offset:24576
    ds_read_b64_tr_b16 a[90:91], v24 offset:25600
    ds_read_b64_tr_b16 a[92:93], v24 offset:24584
    ds_read_b64_tr_b16 a[94:95], v24 offset:25608
    s_waitcnt lgkmcnt(0)
    s_waitcnt vmcnt(28)
    s_barrier
    s_add_u32 s45, s46, 0x620000
    s_add_u32 m0, s47, 81920
    s_nop 0
    buffer_load_dwordx4 v21, s[24:27], s45 offen  lds
    s_add_u32 s45, s46, 0x63c000
    s_add_u32 m0, s47, 86016
    s_nop 0
    buffer_load_dwordx4 v21, s[24:27], s45 offen  lds
    s_add_u32 s45, s46, 0x658000
    s_add_u32 m0, s47, 90112
    s_nop 0
    buffer_load_dwordx4 v21, s[24:27], s45 offen  lds
    s_add_u32 s45, s46, 0x674000
    s_add_u32 m0, s47, 94208
    s_nop 0
    buffer_load_dwordx4 v21, s[24:27], s45 offen  lds
    ds_read_b64_tr_b16 a[96:97], v24 offset:32768
    ds_read_b64_tr_b16 a[98:99], v24 offset:33792
    ds_read_b64_tr_b16 a[100:101], v24 offset:32776
    ds_read_b64_tr_b16 a[102:103], v24 offset:33800
    ds_read_b64_tr_b16 a[104:105], v24 offset:40960
    ds_read_b64_tr_b16 a[106:107], v24 offset:41984
    ds_read_b64_tr_b16 a[108:109], v24 offset:40968
    ds_read_b64_tr_b16 a[110:111], v24 offset:41992
    s_waitcnt lgkmcnt(0)
    s_waitcnt vmcnt(28)
    s_barrier
    s_add_u32 s45, s46, 0x690000
    s_add_u32 m0, s47, 98304
    s_nop 0
    buffer_load_dwordx4 v21, s[24:27], s45 offen  lds
    s_add_u32 s45, s46, 0x6ac000
    s_add_u32 m0, s47, 102400
    s_nop 0
    buffer_load_dwordx4 v21, s[24:27], s45 offen  lds
    s_add_u32 s45, s46, 0x6c8000
    s_add_u32 m0, s47, 106496
    s_nop 0
    buffer_load_dwordx4 v21, s[24:27], s45 offen  lds
    s_add_u32 s45, s46, 0x6e4000
    s_add_u32 m0, s47, 110592
    s_nop 0
    buffer_load_dwordx4 v21, s[24:27], s45 offen  lds
    ds_read_b64_tr_b16 a[112:113], v24 offset:49152
    ds_read_b64_tr_b16 a[114:115], v24 offset:50176
    ds_read_b64_tr_b16 a[116:117], v24 offset:49160
    ds_read_b64_tr_b16 a[118:119], v24 offset:50184
    ds_read_b64_tr_b16 a[120:121], v24 offset:57344
    ds_read_b64_tr_b16 a[122:123], v24 offset:58368
    ds_read_b64_tr_b16 a[124:125], v24 offset:57352
    ds_read_b64_tr_b16 a[126:127], v24 offset:58376
    s_waitcnt lgkmcnt(0)
    s_waitcnt vmcnt(28)
    s_barrier
    ds_read_b64_tr_b16 a[128:129], v25 offset:0
    ds_read_b64_tr_b16 a[130:131], v25 offset:1024
    ds_read_b64_tr_b16 a[132:133], v25 offset:8
    ds_read_b64_tr_b16 a[134:135], v25 offset:1032
    ds_read_b64_tr_b16 a[136:137], v25 offset:8192
    ds_read_b64_tr_b16 a[138:139], v25 offset:9216
    ds_read_b64_tr_b16 a[140:141], v25 offset:8200
    ds_read_b64_tr_b16 a[142:143], v25 offset:9224
    s_waitcnt lgkmcnt(0)
    s_waitcnt vmcnt(24)
    s_barrier
    ds_read_b64_tr_b16 a[144:145], v23 offset:0
    ds_read_b64_tr_b16 a[146:147], v23 offset:1024
    ds_read_b64_tr_b16 a[148:149], v23 offset:8
    ds_read_b64_tr_b16 a[150:151], v23 offset:1032
    ds_read_b64_tr_b16 a[152:153], v23 offset:8192
    ds_read_b64_tr_b16 a[154:155], v23 offset:9216
    ds_read_b64_tr_b16 a[156:157], v23 offset:8200
    ds_read_b64_tr_b16 a[158:159], v23 offset:9224
    s_waitcnt lgkmcnt(0)
    s_waitcnt vmcnt(20)
    s_barrier
    ds_read_b64_tr_b16 a[160:161], v23 offset:16384
    ds_read_b64_tr_b16 a[162:163], v23 offset:17408
    ds_read_b64_tr_b16 a[164:165], v23 offset:16392
    ds_read_b64_tr_b16 a[166:167], v23 offset:17416
    ds_read_b64_tr_b16 a[168:169], v23 offset:24576
    ds_read_b64_tr_b16 a[170:171], v23 offset:25600
    ds_read_b64_tr_b16 a[172:173], v23 offset:24584
    ds_read_b64_tr_b16 a[174:175], v23 offset:25608
    s_waitcnt lgkmcnt(0)
    s_waitcnt vmcnt(16)
    s_barrier
    ds_read_b64_tr_b16 a[176:177], v23 offset:32768
    ds_read_b64_tr_b16 a[178:179], v23 offset:33792
    ds_read_b64_tr_b16 a[180:181], v23 offset:32776
    ds_read_b64_tr_b16 a[182:183], v23 offset:33800
    ds_read_b64_tr_b16 a[184:185], v23 offset:40960
    ds_read_b64_tr_b16 a[186:187], v23 offset:41984
    ds_read_b64_tr_b16 a[188:189], v23 offset:40968
    ds_read_b64_tr_b16 a[190:191], v23 offset:41992
    s_waitcnt lgkmcnt(0)
    s_waitcnt vmcnt(12)
    s_barrier
    ds_read_b64_tr_b16 a[192:193], v23 offset:49152
    ds_read_b64_tr_b16 a[194:195], v23 offset:50176
    ds_read_b64_tr_b16 a[196:197], v23 offset:49160
    ds_read_b64_tr_b16 a[198:199], v23 offset:50184
    ds_read_b64_tr_b16 a[200:201], v23 offset:57344
    ds_read_b64_tr_b16 a[202:203], v23 offset:58368
    ds_read_b64_tr_b16 a[204:205], v23 offset:57352
    ds_read_b64_tr_b16 a[206:207], v23 offset:58376
    s_waitcnt lgkmcnt(0)
    s_waitcnt vmcnt(8)
    s_barrier
    ds_read_b64_tr_b16 a[208:209], v24 offset:0
    ds_read_b64_tr_b16 a[210:211], v24 offset:1024
    ds_read_b64_tr_b16 a[212:213], v24 offset:8
    ds_read_b64_tr_b16 a[214:215], v24 offset:1032
    ds_read_b64_tr_b16 a[216:217], v24 offset:8192
    ds_read_b64_tr_b16 a[218:219], v24 offset:9216
    ds_read_b64_tr_b16 a[220:221], v24 offset:8200
    ds_read_b64_tr_b16 a[222:223], v24 offset:9224
    s_waitcnt lgkmcnt(0)
    s_waitcnt vmcnt(4)
    s_barrier
    ds_read_b64_tr_b16 a[224:225], v24 offset:16384
    ds_read_b64_tr_b16 a[226:227], v24 offset:17408
    ds_read_b64_tr_b16 a[228:229], v24 offset:16392
    ds_read_b64_tr_b16 a[230:231], v24 offset:17416
    ds_read_b64_tr_b16 a[232:233], v24 offset:24576
    ds_read_b64_tr_b16 a[234:235], v24 offset:25600
    ds_read_b64_tr_b16 a[236:237], v24 offset:24584
    ds_read_b64_tr_b16 a[238:239], v24 offset:25608
    s_waitcnt lgkmcnt(0)
    s_waitcnt vmcnt(0)
    s_barrier
    ds_read_b64_tr_b16 a[240:241], v24 offset:32768
    ds_read_b64_tr_b16 a[242:243], v24 offset:33792
    ds_read_b64_tr_b16 a[244:245], v24 offset:32776
    ds_read_b64_tr_b16 a[246:247], v24 offset:33800
    ds_read_b64_tr_b16 a[248:249], v24 offset:40960
    ds_read_b64_tr_b16 a[250:251], v24 offset:41984
    ds_read_b64_tr_b16 a[252:253], v24 offset:40968
    ds_read_b64_tr_b16 a[254:255], v24 offset:41992
    s_waitcnt lgkmcnt(0)
    s_barrier
    s_min_u32 s45, s41, 27
    s_lshl_b32 s45, s45, 8
    s_lshl_b32 s46, s44, 6
    s_add_u32 s45, s45, s46
    v_lshrrev_b32 v29, 4, v1
    v_lshlrev_b32 v29, 4, v29
    buffer_load_dwordx4 v[80:83], v29, s[32:35], s45 offen
    s_waitcnt vmcnt(0)
    v_lshlrev_b32 v96, 16, v80
    v_and_b32 v97, 0xffff0000, v80
    v_lshlrev_b32 v98, 16, v81
    v_and_b32 v99, 0xffff0000, v81
    v_lshlrev_b32 v100, 16, v82
    v_and_b32 v101, 0xffff0000, v82
    v_lshlrev_b32 v102, 16, v83
    v_and_b32 v103, 0xffff0000, v83
    v_mov_b32 v104, 0xbdd2d3e8
    v_mov_b32 v105, v104
    v_mov_b32 v106, 0xc0135761
    v_mov_b32 v107, v106
    s_cmp_lg_u32 s44, 0
    s_cbranch_scc1 L_pd_145
    v_mov_b32 v29, 127232
    s_mov_b32 s46, 96
    s_mov_b64 exec, 1
    s_mov_b32 s70, 0
L_wp_146:
    buffer_load_dword v31, v29, s[12:15], 0 offen sc1
    s_add_u32 s70, s70, 1
    s_cmp_ge_u32 s70, 0x200000
    s_cbranch_scc1 L_w_done_98
    s_waitcnt vmcnt(0)
    v_cmp_gt_u32 vcc, s46, v31
    s_nop 1
    s_cbranch_vccz L_wp_146_ok
    s_sleep 3
    s_branch L_wp_146
L_wp_146_ok:
    s_mov_b64 exec, -1
L_pd_145:
    s_barrier
    v_lshlrev_b32 v29, 5, v1
    s_mov_b32 s45, 8192
    buffer_load_dwordx4 v[112:115], v29, s[12:15], s45 offen offset:0 sc1
    buffer_load_dwordx4 v[116:119], v29, s[12:15], s45 offen offset:16 sc1
    buffer_load_dwordx4 v[120:123], v29, s[12:15], s45 offen offset:2048 sc1
    buffer_load_dwordx4 v[124:127], v29, s[12:15], s45 offen offset:2064 sc1
    s_mov_b32 s45, 32768
    buffer_load_dwordx4 v[32:35], v29, s[12:15], s45 offen offset:0 sc1
    buffer_load_dwordx4 v[36:39], v29, s[12:15], s45 offen offset:16 sc1
    buffer_load_dwordx4 v[40:43], v29, s[12:15], s45 offen offset:2048 sc1
    buffer_load_dwordx4 v[44:47], v29, s[12:15], s45 offen offset:2064 sc1
    s_mov_b32 s45, 12288
    buffer_load_dwordx4 v[128:131], v29, s[12:15], s45 offen offset:0 sc1
    buffer_load_dwordx4 v[132:135], v29, s[12:15], s45 offen offset:16 sc1
    buffer_load_dwordx4 v[136:139], v29, s[12:15], s45 offen offset:2048 sc1
    buffer_load_dwordx4 v[140:143], v29, s[12:15], s45 offen offset:2064 sc1
    s_mov_b32 s45, 36864
    buffer_load_dwordx4 v[48:51], v29, s[12:15], s45 offen offset:0 sc1
    buffer_load_dwordx4 v[52:55], v29, s[12:15], s45 offen offset:16 sc1
    buffer_load_dwordx4 v[56:59], v29, s[12:15], s45 offen offset:2048 sc1
    buffer_load_dwordx4 v[60:63], v29, s[12:15], s45 offen offset:2064 sc1
    s_mov_b32 s45, 16384
    buffer_load_dwordx4 v[144:147], v29, s[12:15], s45 offen offset:0 sc1
    buffer_load_dwordx4 v[148:151], v29, s[12:15], s45 offen offset:16 sc1
    buffer_load_dwordx4 v[152:155], v29, s[12:15], s45 offen offset:2048 sc1
    buffer_load_dwordx4 v[156:159], v29, s[12:15], s45 offen offset:2064 sc1
    s_mov_b32 s45, 40960
    buffer_load_dwordx4 v[64:67], v29, s[12:15], s45 offen offset:0 sc1
    buffer_load_dwordx4 v[68:71], v29, s[12:15], s45 offen offset:16 sc1
    buffer_load_dwordx4 v[72:75], v29, s[12:15], s45 offen offset:2048 sc1
    buffer_load_dwordx4 v[76:79], v29, s[12:15], s45 offen offset:2064 sc1
    s_waitcnt vmcnt(0)
    v_add_f32 v112, v112, v32
    v_cvt_pk_bf16_f32 v112, v112, v112
    v_lshlrev_b32 v112, 16, v112
    v_add_f32 v113, v113, v33
    v_cvt_pk_bf16_f32 v113, v113, v113
    v_lshlrev_b32 v113, 16, v113
    v_add_f32 v114, v114, v34
    v_cvt_pk_bf16_f32 v114, v114, v114
    v_lshlrev_b32 v114, 16, v114
    v_add_f32 v115, v115, v35
    v_cvt_pk_bf16_f32 v115, v115, v115
    v_lshlrev_b32 v115, 16, v115
    v_add_f32 v116, v116, v36
    v_cvt_pk_bf16_f32 v116, v116, v116
    v_lshlrev_b32 v116, 16, v116
    v_add_f32 v117, v117, v37
    v_cvt_pk_bf16_f32 v117, v117, v117
    v_lshlrev_b32 v117, 16, v117
    v_add_f32 v118, v118, v38
    v_cvt_pk_bf16_f32 v118, v118, v118
    v_lshlrev_b32 v118, 16, v118
    v_add_f32 v119, v119, v39
    v_cvt_pk_bf16_f32 v119, v119, v119
    v_lshlrev_b32 v119, 16, v119
    v_add_f32 v120, v120, v40
    v_cvt_pk_bf16_f32 v120, v120, v120
    v_lshlrev_b32 v120, 16, v120
    v_add_f32 v121, v121, v41
    v_cvt_pk_bf16_f32 v121, v121, v121
    v_lshlrev_b32 v121, 16, v121
    v_add_f32 v122, v122, v42
    v_cvt_pk_bf16_f32 v122, v122, v122
    v_lshlrev_b32 v122, 16, v122
    v_add_f32 v123, v123, v43
    v_cvt_pk_bf16_f32 v123, v123, v123
    v_lshlrev_b32 v123, 16, v123
    v_add_f32 v124, v124, v44
    v_cvt_pk_bf16_f32 v124, v124, v124
    v_lshlrev_b32 v124, 16, v124
    v_add_f32 v125, v125, v45
    v_cvt_pk_bf16_f32 v125, v125, v125
    v_lshlrev_b32 v125, 16, v125
    v_add_f32 v126, v126, v46
    v_cvt_pk_bf16_f32 v126, v126, v126
    v_lshlrev_b32 v126, 16, v126
    v_add_f32 v127, v127, v47
    v_cvt_pk_bf16_f32 v127, v127, v127
    v_lshlrev_b32 v127, 16, v127
    v_add_f32 v128, v128, v48
    v_cvt_pk_bf16_f32 v128, v128, v128
    v_lshlrev_b32 v128, 16, v128
    v_add_f32 v129, v129, v49
    v_cvt_pk_bf16_f32 v129, v129, v129
    v_lshlrev_b32 v129, 16, v129
    v_add_f32 v130, v130, v50
    v_cvt_pk_bf16_f32 v130, v130, v130
    v_lshlrev_b32 v130, 16, v130
    v_add_f32 v131, v131, v51
    v_cvt_pk_bf16_f32 v131, v131, v131
    v_lshlrev_b32 v131, 16, v131
    v_add_f32 v132, v132, v52
    v_cvt_pk_bf16_f32 v132, v132, v132
    v_lshlrev_b32 v132, 16, v132
    v_add_f32 v133, v133, v53
    v_cvt_pk_bf16_f32 v133, v133, v133
    v_lshlrev_b32 v133, 16, v133
    v_add_f32 v134, v134, v54
    v_cvt_pk_bf16_f32 v134, v134, v134
    v_lshlrev_b32 v134, 16, v134
    v_add_f32 v135, v135, v55
    v_cvt_pk_bf16_f32 v135, v135, v135
    v_lshlrev_b32 v135, 16, v135
    v_add_f32 v136, v136, v56
    v_cvt_pk_bf16_f32 v136, v136, v136
    v_lshlrev_b32 v136, 16, v136
    v_add_f32 v137, v137, v57
    v_cvt_pk_bf16_f32 v137, v137, v137
    v_lshlrev_b32 v137, 16, v137
    v_add_f32 v138, v138, v58
    v_cvt_pk_bf16_f32 v138, v138, v138
    v_lshlrev_b32 v138, 16, v138
    v_add_f32 v139, v139, v59
    v_cvt_pk_bf16_f32 v139, v139, v139
    v_lshlrev_b32 v139, 16, v139
    v_add_f32 v140, v140, v60
    v_cvt_pk_bf16_f32 v140, v140, v140
    v_lshlrev_b32 v140, 16, v140
    v_add_f32 v141, v141, v61
    v_cvt_pk_bf16_f32 v141, v141, v141
    v_lshlrev_b32 v141, 16, v141
    v_add_f32 v142, v142, v62
    v_cvt_pk_bf16_f32 v142, v142, v142
    v_lshlrev_b32 v142, 16, v142
    v_add_f32 v143, v143, v63
    v_cvt_pk_bf16_f32 v143, v143, v143
    v_lshlrev_b32 v143, 16, v143
    v_add_f32 v144, v144, v64
    v_cvt_pk_bf16_f32 v144, v144, v144
    v_lshlrev_b32 v144, 16, v144
    v_add_f32 v144, 1.0, v144
    v_cvt_pk_bf16_f32 v144, v144, v144
    v_lshlrev_b32 v144, 16, v144
    v_add_f32 v145, v145, v65
    v_cvt_pk_bf16_f32 v145, v145, v145
    v_lshlrev_b32 v145, 16, v145
    v_add_f32 v145, 1.0, v145
    v_cvt_pk_bf16_f32 v145, v145, v145
    v_lshlrev_b32 v145, 16, v145
    v_add_f32 v146, v146, v66
    v_cvt_pk_bf16_f32 v146, v146, v146
    v_lshlrev_b32 v146, 16, v146
    v_add_f32 v146, 1.0, v146
    v_cvt_pk_bf16_f32 v146, v146, v146
    v_lshlrev_b32 v146, 16, v146
    v_add_f32 v147, v147, v67
    v_cvt_pk_bf16_f32 v147, v147, v147
    v_lshlrev_b32 v147, 16, v147
    v_add_f32 v147, 1.0, v147
    v_cvt_pk_bf16_f32 v147, v147, v147
    v_lshlrev_b32 v147, 16, v147
    v_add_f32 v148, v148, v68
    v_cvt_pk_bf16_f32 v148, v148, v148
    v_lshlrev_b32 v148, 16, v148
    v_add_f32 v148, 1.0, v148
    v_cvt_pk_bf16_f32 v148, v148, v148
    v_lshlrev_b32 v148, 16, v148
    v_add_f32 v149, v149, v69
    v_cvt_pk_bf16_f32 v149, v149, v149
    v_lshlrev_b32 v149, 16, v149
    v_add_f32 v149, 1.0, v149
    v_cvt_pk_bf16_f32 v149, v149, v149
    v_lshlrev_b32 v149, 16, v149
    v_add_f32 v150, v150, v70
    v_cvt_pk_bf16_f32 v150, v150, v150
    v_lshlrev_b32 v150, 16, v150
    v_add_f32 v150, 1.0, v150
    v_cvt_pk_bf16_f32 v150, v150, v150
    v_lshlrev_b32 v150, 16, v150
    v_add_f32 v151, v151, v71
    v_cvt_pk_bf16_f32 v151, v151, v151
    v_lshlrev_b32 v151, 16, v151
    v_add_f32 v151, 1.0, v151
    v_cvt_pk_bf16_f32 v151, v151, v151
    v_lshlrev_b32 v151, 16, v151
    v_add_f32 v152, v152, v72
    v_cvt_pk_bf16_f32 v152, v152, v152
    v_lshlrev_b32 v152, 16, v152
    v_add_f32 v152, 1.0, v152
    v_cvt_pk_bf16_f32 v152, v152, v152
    v_lshlrev_b32 v152, 16, v152
    v_add_f32 v153, v153, v73
    v_cvt_pk_bf16_f32 v153, v153, v153
    v_lshlrev_b32 v153, 16, v153
    v_add_f32 v153, 1.0, v153
    v_cvt_pk_bf16_f32 v153, v153, v153
    v_lshlrev_b32 v153, 16, v153
    v_add_f32 v154, v154, v74
    v_cvt_pk_bf16_f32 v154, v154, v154
    v_lshlrev_b32 v154, 16, v154
    v_add_f32 v154, 1.0, v154
    v_cvt_pk_bf16_f32 v154, v154, v154
    v_lshlrev_b32 v154, 16, v154
    v_add_f32 v155, v155, v75
    v_cvt_pk_bf16_f32 v155, v155, v155
    v_lshlrev_b32 v155, 16, v155
    v_add_f32 v155, 1.0, v155
    v_cvt_pk_bf16_f32 v155, v155, v155
    v_lshlrev_b32 v155, 16, v155
    v_add_f32 v156, v156, v76
    v_cvt_pk_bf16_f32 v156, v156, v156
    v_lshlrev_b32 v156, 16, v156
    v_add_f32 v156, 1.0, v156
    v_cvt_pk_bf16_f32 v156, v156, v156
    v_lshlrev_b32 v156, 16, v156
    v_add_f32 v157, v157, v77
    v_cvt_pk_bf16_f32 v157, v157, v157
    v_lshlrev_b32 v157, 16, v157
    v_add_f32 v157, 1.0, v157
    v_cvt_pk_bf16_f32 v157, v157, v157
    v_lshlrev_b32 v157, 16, v157
    v_add_f32 v158, v158, v78
    v_cvt_pk_bf16_f32 v158, v158, v158
    v_lshlrev_b32 v158, 16, v158
    v_add_f32 v158, 1.0, v158
    v_cvt_pk_bf16_f32 v158, v158, v158
    v_lshlrev_b32 v158, 16, v158
    v_add_f32 v159, v159, v79
    v_cvt_pk_bf16_f32 v159, v159, v159
    v_lshlrev_b32 v159, 16, v159
    v_add_f32 v159, 1.0, v159
    v_cvt_pk_bf16_f32 v159, v159, v159
    v_lshlrev_b32 v159, 16, v159
    s_lshl_b32 s46, s44, 10
    s_add_u32 s45, s46, 8192
    buffer_load_dwordx4 v[18:21], v10, s[12:15], s45 offen sc1
    s_add_u32 s45, s46, 32768
    buffer_load_dwordx4 v[32:35], v10, s[12:15], s45 offen sc1
    s_add_u32 s45, s46, 12288
    buffer_load_dwordx4 v[22:25], v10, s[12:15], s45 offen sc1
    s_add_u32 s45, s46, 36864
    buffer_load_dwordx4 v[36:39], v10, s[12:15], s45 offen sc1
    s_add_u32 s45, s46, 16384
    buffer_load_dwordx4 v[108:111], v10, s[12:15], s45 offen sc1
    s_add_u32 s45, s46, 40960
    buffer_load_dwordx4 v[40:43], v10, s[12:15], s45 offen sc1
    s_waitcnt vmcnt(0)
    v_add_f32 v18, v18, v32
    v_cvt_pk_bf16_f32 v18, v18, v18
    v_lshlrev_b32 v18, 16, v18
    v_add_f32 v19, v19, v33
    v_cvt_pk_bf16_f32 v19, v19, v19
    v_lshlrev_b32 v19, 16, v19
    v_add_f32 v20, v20, v34
    v_cvt_pk_bf16_f32 v20, v20, v20
    v_lshlrev_b32 v20, 16, v20
    v_add_f32 v21, v21, v35
    v_cvt_pk_bf16_f32 v21, v21, v21
    v_lshlrev_b32 v21, 16, v21
    v_add_f32 v22, v22, v36
    v_cvt_pk_bf16_f32 v22, v22, v22
    v_lshlrev_b32 v22, 16, v22
    v_add_f32 v23, v23, v37
    v_cvt_pk_bf16_f32 v23, v23, v23
    v_lshlrev_b32 v23, 16, v23
    v_add_f32 v24, v24, v38
    v_cvt_pk_bf16_f32 v24, v24, v24
    v_lshlrev_b32 v24, 16, v24
    v_add_f32 v25, v25, v39
    v_cvt_pk_bf16_f32 v25, v25, v25
    v_lshlrev_b32 v25, 16, v25
    v_add_f32 v108, v108, v40
    v_cvt_pk_bf16_f32 v108, v108, v108
    v_lshlrev_b32 v108, 16, v108
    v_add_f32 v108, 1.0, v108
    v_cvt_pk_bf16_f32 v108, v108, v108
    v_lshlrev_b32 v108, 16, v108
    v_add_f32 v109, v109, v41
    v_cvt_pk_bf16_f32 v109, v109, v109
    v_lshlrev_b32 v109, 16, v109
    v_add_f32 v109, 1.0, v109
    v_cvt_pk_bf16_f32 v109, v109, v109
    v_lshlrev_b32 v109, 16, v109
    v_add_f32 v110, v110, v42
    v_cvt_pk_bf16_f32 v110, v110, v110
    v_lshlrev_b32 v110, 16, v110
    v_add_f32 v110, 1.0, v110
    v_cvt_pk_bf16_f32 v110, v110, v110
    v_lshlrev_b32 v110, 16, v110
    v_add_f32 v111, v111, v43
    v_cvt_pk_bf16_f32 v111, v111, v111
    v_lshlrev_b32 v111, 16, v111
    v_add_f32 v111, 1.0, v111
    v_cvt_pk_bf16_f32 v111, v111, v111
    v_lshlrev_b32 v111, 16, v111
    s_mov_b32 s52, 0xc00000
    s_lshl_b32 s56, s41, 13
    s_add_u32 s56, s56, 0x6000000
    s_lshl_b32 s45, s40, 7
    s_add_u32 s45, s45, 127488
    v_mov_b32 v29, s45
    s_mov_b32 s46, 536870912
    s_mov_b64 exec, 1
    s_mov_b32 s70, 0
L_wp_150:
    buffer_load_dword v31, v29, s[12:15], 0 offen sc1
    s_add_u32 s70, s70, 1
    s_cmp_ge_u32 s70, 0x200000
    s_cbranch_scc1 L_w_done_98
    s_waitcnt vmcnt(0)
    v_cmp_gt_u32 vcc, s46, v31
    s_nop 1
    s_cbranch_vccz L_wp_150_ok
    s_sleep 2
    s_branch L_wp_150
L_wp_150_ok:
    s_mov_b64 exec, -1
    v_readfirstlane_b32 s45, v31
    s_nop 3
    s_and_b32 s46, s45, 511
    s_mul_i32 s46, s46, s46
    s_bfe_u32 s45, s45, 0xf0009
    s_lshl_b32 s45, s45, 5
    s_mov_b32 s80, s12
    s_mov_b32 s81, s13
    s_mov_b32 s83, 0x00020000
    s_mov_b32 s84, s12
    s_mov_b32 s85, s13
    s_mov_b32 s87, 0x00020000
    s_cmp_eq_u32 s45, s46
    s_cselect_b32 s82, s14, 0
    s_cselect_b32 s86, 0, s14
L_b_loop_147:
    s_cmp_eq_u64 s[36:37], 0
    s_cbranch_scc1 L_w_done_98
    s_ff1_i32_b64 s50, s[36:37]
    s_bitset0_b64 s[36:37], s50
    s_lshr_b64 s[74:75], s[72:73], s50
    s_ff1_i32_b64 s51, s[74:75]
    s_add_u32 s51, s51, 1
    s_add_u32 s62, s50, s51
    s_cmp_lg_u32 s51, 1
    s_cbranch_scc1 L_b_skip2_149
    s_lshl_b32 s63, s50, 5
    s_add_u32 s63, s63, s41
    s_lshl_b32 s47, s63, 11
    s_lshl_b32 s45, s44, 9
    s_add_u32 s47, s47, s45
    v_lshlrev_b32 v17, 3, v1
    buffer_load_dwordx2 v[208:209], v17, s[28:31], s47 offen
    s_add_u32 s45, s64, 4096
    s_waitcnt vmcnt(0)
    s_cmp_lg_u32 s44, 0
    s_cbranch_scc1 L_pw_151
    s_mov_b32 exec_hi, 0
    s_mov_b32 s70, 0
L_wp_152:
    buffer_load_dword v31, v5, s[12:15], s45 offen sc1
    s_add_u32 s70, s70, 1
    s_cmp_ge_u32 s70, 0x200000
    s_cbranch_scc1 L_w_done_98
    s_waitcnt vmcnt(0)
    v_cmp_gt_u32 vcc, s62, v31
    s_nop 1
    s_cbranch_vccz L_wp_152_ok
    s_sleep 1
    s_branch L_wp_152
L_wp_152_ok:
    s_mov_b64 exec, -1
L_pw_151:
    s_barrier
    s_lshl_b32 s45, s63, 12
    s_lshl_b32 s46, s44, 10
    s_add_u32 s45, s45, s46
    s_add_u32 s45, s45, 0x8000000
    buffer_load_dwordx4 v[64:67], v10, s[12:15], s45 offen sc1
    s_add_u32 s45, s45, 0x800000
    buffer_load_dwordx4 v[68:71], v10, s[12:15], s45 offen sc1
    s_add_u32 s45, s45, 0x800000
    buffer_load_dwordx4 v[72:75], v10, s[12:15], s45 offen sc1
    s_add_u32 s45, s45, 0x800000
    buffer_load_dwordx4 v[76:79], v10, s[12:15], s45 offen sc1
    v_lshlrev_b32 v160, 16, v208
    v_and_b32 v161, 0xffff0000, v208
    v_lshlrev_b32 v162, 16, v209
    v_and_b32 v163, 0xffff0000, v209
    s_waitcnt vmcnt(0)
    v_pk_add_f32 v[64:65], v[64:65], v[68:69]
    v_pk_add_f32 v[72:73], v[72:73], v[76:77]
    v_pk_add_f32 v[66:67], v[66:67], v[70:71]
    v_pk_add_f32 v[74:75], v[74:75], v[78:79]
    v_pk_add_f32 v[64:65], v[64:65], v[72:73]
    v_pk_add_f32 v[66:67], v[66:67], v[74:75]
    v_cvt_pk_bf16_f32 v64, v64, v64
    v_lshlrev_b32 v64, 16, v64
    v_cvt_pk_bf16_f32 v65, v65, v65
    v_lshlrev_b32 v65, 16, v65
    v_cvt_pk_bf16_f32 v66, v66, v66
    v_lshlrev_b32 v66, 16, v66
    v_cvt_pk_bf16_f32 v67, v67, v67
    v_lshlrev_b32 v67, 16, v67
    v_mul_f32 v64, v64, v18
    v_cvt_pk_bf16_f32 v64, v64, v64
    v_lshlrev_b32 v64, 16, v64
    v_add_f32 v64, v64, v160
    v_mul_f32 v65, v65, v19
    v_cvt_pk_bf16_f32 v65, v65, v65
    v_lshlrev_b32 v65, 16, v65
    v_add_f32 v65, v65, v161
    v_mul_f32 v66, v66, v20
    v_cvt_pk_bf16_f32 v66, v66, v66
    v_lshlrev_b32 v66, 16, v66
    v_add_f32 v66, v66, v162
    v_mul_f32 v67, v67, v21
    v_cvt_pk_bf16_f32 v67, v67, v67
    v_lshlrev_b32 v67, 16, v67
    v_add_f32 v67, v67, v163
    v_cvt_pk_bf16_f32 v208, v64, v65
    v_cvt_pk_bf16_f32 v209, v66, v67
    s_add_u32 s47, s47, 0x800000
    buffer_store_dwordx2 v[208:209], v17, s[12:15], s47 offen sc1
    v_lshlrev_b32 v64, 16, v208
    v_and_b32 v65, 0xffff0000, v208
    v_lshlrev_b32 v66, 16, v209
    v_and_b32 v67, 0xffff0000, v209
    v_add_f32 v26, v64, v65
    v_add_f32 v27, v66, v67
    v_add_f32 v26, v26, v27
    s_nop 1
    v_add_f32_dpp v26, v26, v26 row_shr:1 row_mask:0xf bank_mask:0xf bound_ctrl:0
    s_nop 1
    v_add_f32_dpp v26, v26, v26 row_shr:2 row_mask:0xf bank_mask:0xf bound_ctrl:0
    s_nop 1
    v_add_f32_dpp v26, v26, v26 row_shr:4 row_mask:0xf bank_mask:0xf bound_ctrl:0
    s_nop 1
    v_add_f32_dpp v26, v26, v26 row_shr:8 row_mask:0xf bank_mask:0xf bound_ctrl:0
    s_nop 1
    v_add_f32_dpp v26, v26, v26 row_bcast:15 row_mask:0xa bank_mask:0xf
    s_nop 1
    v_add_f32_dpp v26, v26, v26 row_bcast:31 row_mask:0xc bank_mask:0xf
    s_nop 1
    v_readlane_b32 s66, v26, 63
    s_nop 1
    v_mov_b32 v28, s66
    v_mul_f32 v28, 0x3b800000, v28
    v_mov_b32 v26, 0
    v_sub_f32 v27, v64, v28
    v_fmac_f32 v26, v27, v27
    v_sub_f32 v27, v65, v28
    v_fmac_f32 v26, v27, v27
    v_sub_f32 v27, v66, v28
    v_fmac_f32 v26, v27, v27
    v_sub_f32 v27, v67, v28
    v_fmac_f32 v26, v27, v27
    s_nop 1
    v_add_f32_dpp v26, v26, v26 row_shr:1 row_mask:0xf bank_mask:0xf bound_ctrl:0
    s_nop 1
    v_add_f32_dpp v26, v26, v26 row_shr:2 row_mask:0xf bank_mask:0xf bound_ctrl:0
    s_nop 1
    v_add_f32_dpp v26, v26, v26 row_shr:4 row_mask:0xf bank_mask:0xf bound_ctrl:0
    s_nop 1
    v_add_f32_dpp v26, v26, v26 row_shr:8 row_mask:0xf bank_mask:0xf bound_ctrl:0
    s_nop 1
    v_add_f32_dpp v26, v26, v26 row_bcast:15 row_mask:0xa bank_mask:0xf
    s_nop 1
    v_add_f32_dpp v26, v26, v26 row_bcast:31 row_mask:0xc bank_mask:0xf
    s_nop 1
    v_readlane_b32 s66, v26, 63
    s_lshl_b32 s45, s44, 3
    s_add_u32 s45, s45, 131072
    v_mov_b32 v29, s66
    v_mov_b32 v27, s45
    ds_write_b64 v27, v[28:29]
    v_mov_b32 v27, 131072
    s_waitcnt lgkmcnt(0)
    s_barrier
    ds_read_b128 v[68:71], v27
    ds_read_b128 v[72:75], v27 offset:16
    s_waitcnt lgkmcnt(0)
    v_add_f32 v27, v68, v70
    v_add_f32 v26, v72, v74
    v_add_f32 v27, v27, v26
    v_mul_f32 v27, 0x3e800000, v27
    v_add_f32 v26, v69, v71
    v_add_f32 v28, v73, v75
    v_add_f32 v26, v26, v28
    v_mov_b32 v28, 0
    v_sub_f32 v68, v68, v27
    v_fmac_f32 v28, v68, v68
    v_sub_f32 v70, v70, v27
    v_fmac_f32 v28, v70, v70
    v_sub_f32 v72, v72, v27
    v_fmac_f32 v28, v72, v72
    v_sub_f32 v74, v74, v27
    v_fmac_f32 v28, v74, v74
    v_mul_f32 v28, 0x43800000, v28
    v_add_f32 v26, v26, v28
    v_mul_f32 v26, 0x3a800000, v26
    v_cvt_pk_bf16_f32 v26, v26, v26
    v_lshlrev_b32 v26, 16, v26
    v_cvt_pk_bf16_f32 v27, v27, v27
    v_lshlrev_b32 v27, 16, v27
    v_add_f32 v26, 0x3727c5ac, v26
    v_cvt_pk_bf16_f32 v26, v26, v26
    v_lshlrev_b32 v26, 16, v26
    v_sqrt_f32 v26, v26
    s_nop 0
    v_cvt_pk_bf16_f32 v26, v26, v26
    v_lshlrev_b32 v26, 16, v26
    v_rcp_f32 v26, v26
    s_nop 0
    v_sub_f32 v64, v64, v27
    v_cvt_pk_bf16_f32 v64, v64, v64
    v_lshlrev_b32 v64, 16, v64
    v_mul_f32 v64, v64, v26
    v_cvt_pk_bf16_f32 v64, v64, v64
    v_lshlrev_b32 v64, 16, v64
    v_mul_f32 v64, v64, v108
    v_cvt_pk_bf16_f32 v64, v64, v64
    v_lshlrev_b32 v64, 16, v64
    v_add_f32 v64, v64, v22
    v_sub_f32 v65, v65, v27
    v_cvt_pk_bf16_f32 v65, v65, v65
    v_lshlrev_b32 v65, 16, v65
    v_mul_f32 v65, v65, v26
    v_cvt_pk_bf16_f32 v65, v65, v65
    v_lshlrev_b32 v65, 16, v65
    v_mul_f32 v65, v65, v109
    v_cvt_pk_bf16_f32 v65, v65, v65
    v_lshlrev_b32 v65, 16, v65
    v_add_f32 v65, v65, v23
    v_sub_f32 v66, v66, v27
    v_cvt_pk_bf16_f32 v66, v66, v66
    v_lshlrev_b32 v66, 16, v66
    v_mul_f32 v66, v66, v26
    v_cvt_pk_bf16_f32 v66, v66, v66
    v_lshlrev_b32 v66, 16, v66
    v_mul_f32 v66, v66, v110
    v_cvt_pk_bf16_f32 v66, v66, v66
    v_lshlrev_b32 v66, 16, v66
    v_add_f32 v66, v66, v24
    v_sub_f32 v67, v67, v27
    v_cvt_pk_bf16_f32 v67, v67, v67
    v_lshlrev_b32 v67, 16, v67
    v_mul_f32 v67, v67, v26
    v_cvt_pk_bf16_f32 v67, v67, v67
    v_lshlrev_b32 v67, 16, v67
    v_mul_f32 v67, v67, v111
    v_cvt_pk_bf16_f32 v67, v67, v67
    v_lshlrev_b32 v67, 16, v67
    v_add_f32 v67, v67, v25
    v_cvt_pk_bf16_f32 v64, v64, v65
    v_cvt_pk_bf16_f32 v65, v66, v67
    v_lshrrev_b32 v26, 5, v1
    v_lshlrev_b32 v26, 13, v26
    v_and_b32 v27, 255, v17
    v_add_u32 v26, v26, v27
    s_lshl_b32 s45, s50, 16
    s_lshl_b32 s46, s41, 8
    s_add_u32 s45, s45, s46
    s_lshl_b32 s46, s44, 14
    s_add_u32 s45, s45, s46
    s_add_u32 s45, s45, 0xc00000
    buffer_store_dwordx2 v[64:65], v26, s[12:15], s45 offen sc1
    s_branch L_b_skip_148
L_b_skip2_149:
    s_add_u32 s63, s50, s44
    s_lshl_b32 s63, s63, 5
    s_add_u32 s63, s63, s41
    s_lshl_b32 s47, s63, 11
    buffer_load_dwordx4 v[208:211], v10, s[28:31], s47 offen
    buffer_load_dwordx4 v[212:215], v10, s[28:31], s47 offen offset:1024
    s_add_u32 s45, s64, 4096
    s_cmp_lg_u32 s44, 0
    s_cbranch_scc1 L_pw_153
    s_mov_b32 exec_hi, 0
    s_mov_b32 s70, 0
L_wp_154:
    buffer_load_dword v31, v5, s[12:15], s45 offen sc1
    s_add_u32 s70, s70, 1
    s_cmp_ge_u32 s70, 0x200000
    s_cbranch_scc1 L_w_done_98
    s_waitcnt vmcnt(0)
    v_cmp_gt_u32 vcc, s62, v31
    s_nop 1
    s_cbranch_vccz L_wp_154_ok
    s_sleep 2
    s_branch L_wp_154
L_wp_154_ok:
    s_mov_b64 exec, -1
L_pw_153:
    s_barrier
    s_cmp_ge_u32 s44, s51
    s_cbranch_scc1 L_b_skip_148
    s_lshl_b32 s45, s63, 12
    s_add_u32 s45, s45, 0x8000000
    v_lshlrev_b32 v29, 5, v1
    buffer_load_dwordx4 v[64:67], v29, s[12:15], s45 offen offset:0 sc1
    buffer_load_dwordx4 v[68:71], v29, s[12:15], s45 offen offset:16 sc1
    buffer_load_dwordx4 v[72:75], v29, s[12:15], s45 offen offset:2048 sc1
    buffer_load_dwordx4 v[76:79], v29, s[12:15], s45 offen offset:2064 sc1
    s_add_u32 s45, s45, 0x800000
    buffer_load_dwordx4 v[160:163], v29, s[12:15], s45 offen offset:0 sc1
    buffer_load_dwordx4 v[164:167], v29, s[12:15], s45 offen offset:16 sc1
    buffer_load_dwordx4 v[168:171], v29, s[12:15], s45 offen offset:2048 sc1
    buffer_load_dwordx4 v[172:175], v29, s[12:15], s45 offen offset:2064 sc1
    s_add_u32 s45, s45, 0x800000
    buffer_load_dwordx4 v[176:179], v29, s[12:15], s45 offen offset:0 sc1
    buffer_load_dwordx4 v[180:183], v29, s[12:15], s45 offen offset:16 sc1
    buffer_load_dwordx4 v[184:187], v29, s[12:15], s45 offen offset:2048 sc1
    buffer_load_dwordx4 v[188:191], v29, s[12:15], s45 offen offset:2064 sc1
    s_add_u32 s45, s45, 0x800000
    buffer_load_dwordx4 v[192:195], v29, s[12:15], s45 offen offset:0 sc1
    buffer_load_dwordx4 v[196:199], v29, s[12:15], s45 offen offset:16 sc1
    buffer_load_dwordx4 v[200:203], v29, s[12:15], s45 offen offset:2048 sc1
    buffer_load_dwordx4 v[204:207], v29, s[12:15], s45 offen offset:2064 sc1
    s_waitcnt vmcnt(0)
    v_pk_add_f32 v[64:65], v[64:65], v[160:161]
    v_pk_add_f32 v[176:177], v[176:177], v[192:193]
    v_pk_add_f32 v[66:67], v[66:67], v[162:163]
    v_pk_add_f32 v[178:179], v[178:179], v[194:195]
    v_pk_add_f32 v[68:69], v[68:69], v[164:165]
    v_pk_add_f32 v[180:181], v[180:181], v[196:197]
    v_pk_add_f32 v[70:71], v[70:71], v[166:167]
    v_pk_add_f32 v[182:183], v[182:183], v[198:199]
    v_pk_add_f32 v[72:73], v[72:73], v[168:169]
    v_pk_add_f32 v[184:185], v[184:185], v[200:201]
    v_pk_add_f32 v[74:75], v[74:75], v[170:171]
    v_pk_add_f32 v[186:187], v[186:187], v[202:203]
    v_pk_add_f32 v[76:77], v[76:77], v[172:173]
    v_pk_add_f32 v[188:189], v[188:189], v[204:205]
    v_pk_add_f32 v[78:79], v[78:79], v[174:175]
    v_pk_add_f32 v[190:191], v[190:191], v[206:207]
    v_pk_add_f32 v[64:65], v[64:65], v[176:177]
    v_pk_add_f32 v[66:67], v[66:67], v[178:179]
    v_pk_add_f32 v[68:69], v[68:69], v[180:181]
    v_pk_add_f32 v[70:71], v[70:71], v[182:183]
    v_pk_add_f32 v[72:73], v[72:73], v[184:185]
    v_pk_add_f32 v[74:75], v[74:75], v[186:187]
    v_pk_add_f32 v[76:77], v[76:77], v[188:189]
    v_pk_add_f32 v[78:79], v[78:79], v[190:191]
    v_cvt_pk_bf16_f32 v64, v64, v64
    v_lshlrev_b32 v64, 16, v64
    v_cvt_pk_bf16_f32 v65, v65, v65
    v_lshlrev_b32 v65, 16, v65
    v_cvt_pk_bf16_f32 v66, v66, v66
    v_lshlrev_b32 v66, 16, v66
    v_cvt_pk_bf16_f32 v67, v67, v67
    v_lshlrev_b32 v67, 16, v67
    v_cvt_pk_bf16_f32 v68, v68, v68
    v_lshlrev_b32 v68, 16, v68
    v_cvt_pk_bf16_f32 v69, v69, v69
    v_lshlrev_b32 v69, 16, v69
    v_cvt_pk_bf16_f32 v70, v70, v70
    v_lshlrev_b32 v70, 16, v70
    v_cvt_pk_bf16_f32 v71, v71, v71
    v_lshlrev_b32 v71, 16, v71
    v_cvt_pk_bf16_f32 v72, v72, v72
    v_lshlrev_b32 v72, 16, v72
    v_cvt_pk_bf16_f32 v73, v73, v73
    v_lshlrev_b32 v73, 16, v73
    v_cvt_pk_bf16_f32 v74, v74, v74
    v_lshlrev_b32 v74, 16, v74
    v_cvt_pk_bf16_f32 v75, v75, v75
    v_lshlrev_b32 v75, 16, v75
    v_cvt_pk_bf16_f32 v76, v76, v76
    v_lshlrev_b32 v76, 16, v76
    v_cvt_pk_bf16_f32 v77, v77, v77
    v_lshlrev_b32 v77, 16, v77
    v_cvt_pk_bf16_f32 v78, v78, v78
    v_lshlrev_b32 v78, 16, v78
    v_cvt_pk_bf16_f32 v79, v79, v79
    v_lshlrev_b32 v79, 16, v79
    v_lshlrev_b32 v160, 16, v208
    v_and_b32 v161, 0xffff0000, v208
    v_lshlrev_b32 v162, 16, v209
    v_and_b32 v163, 0xffff0000, v209
    v_lshlrev_b32 v164, 16, v210
    v_and_b32 v165, 0xffff0000, v210
    v_lshlrev_b32 v166, 16, v211
    v_and_b32 v167, 0xffff0000, v211
    v_lshlrev_b32 v168, 16, v212
    v_and_b32 v169, 0xffff0000, v212
    v_lshlrev_b32 v170, 16, v213
    v_and_b32 v171, 0xffff0000, v213
    v_lshlrev_b32 v172, 16, v214
    v_and_b32 v173, 0xffff0000, v214
    v_lshlrev_b32 v174, 16, v215
    v_and_b32 v175, 0xffff0000, v215
    v_mul_f32 v64, v64, v112
    v_cvt_pk_bf16_f32 v64, v64, v64
    v_lshlrev_b32 v64, 16, v64
    v_add_f32 v64, v64, v160
    v_mul_f32 v65, v65, v113
    v_cvt_pk_bf16_f32 v65, v65, v65
    v_lshlrev_b32 v65, 16, v65
    v_add_f32 v65, v65, v161
    v_mul_f32 v66, v66, v114
    v_cvt_pk_bf16_f32 v66, v66, v66
    v_lshlrev_b32 v66, 16, v66
    v_add_f32 v66, v66, v162
    v_mul_f32 v67, v67, v115
    v_cvt_pk_bf16_f32 v67, v67, v67
    v_lshlrev_b32 v67, 16, v67
    v_add_f32 v67, v67, v163
    v_mul_f32 v68, v68, v116
    v_cvt_pk_bf16_f32 v68, v68, v68
    v_lshlrev_b32 v68, 16, v68
    v_add_f32 v68, v68, v164
    v_mul_f32 v69, v69, v117
    v_cvt_pk_bf16_f32 v69, v69, v69
    v_lshlrev_b32 v69, 16, v69
    v_add_f32 v69, v69, v165
    v_mul_f32 v70, v70, v118
    v_cvt_pk_bf16_f32 v70, v70, v70
    v_lshlrev_b32 v70, 16, v70
    v_add_f32 v70, v70, v166
    v_mul_f32 v71, v71, v119
    v_cvt_pk_bf16_f32 v71, v71, v71
    v_lshlrev_b32 v71, 16, v71
    v_add_f32 v71, v71, v167
    v_mul_f32 v72, v72, v120
    v_cvt_pk_bf16_f32 v72, v72, v72
    v_lshlrev_b32 v72, 16, v72
    v_add_f32 v72, v72, v168
    v_mul_f32 v73, v73, v121
    v_cvt_pk_bf16_f32 v73, v73, v73
    v_lshlrev_b32 v73, 16, v73
    v_add_f32 v73, v73, v169
    v_mul_f32 v74, v74, v122
    v_cvt_pk_bf16_f32 v74, v74, v74
    v_lshlrev_b32 v74, 16, v74
    v_add_f32 v74, v74, v170
    v_mul_f32 v75, v75, v123
    v_cvt_pk_bf16_f32 v75, v75, v75
    v_lshlrev_b32 v75, 16, v75
    v_add_f32 v75, v75, v171
    v_mul_f32 v76, v76, v124
    v_cvt_pk_bf16_f32 v76, v76, v76
    v_lshlrev_b32 v76, 16, v76
    v_add_f32 v76, v76, v172
    v_mul_f32 v77, v77, v125
    v_cvt_pk_bf16_f32 v77, v77, v77
    v_lshlrev_b32 v77, 16, v77
    v_add_f32 v77, v77, v173
    v_mul_f32 v78, v78, v126
    v_cvt_pk_bf16_f32 v78, v78, v78
    v_lshlrev_b32 v78, 16, v78
    v_add_f32 v78, v78, v174
    v_mul_f32 v79, v79, v127
    v_cvt_pk_bf16_f32 v79, v79, v79
    v_lshlrev_b32 v79, 16, v79
    v_add_f32 v79, v79, v175
    v_cvt_pk_bf16_f32 v208, v64, v65
    v_cvt_pk_bf16_f32 v209, v66, v67
    v_cvt_pk_bf16_f32 v210, v68, v69
    v_cvt_pk_bf16_f32 v211, v70, v71
    v_cvt_pk_bf16_f32 v212, v72, v73
    v_cvt_pk_bf16_f32 v213, v74, v75
    v_cvt_pk_bf16_f32 v214, v76, v77
    v_cvt_pk_bf16_f32 v215, v78, v79
    s_add_u32 s47, s47, 0x800000
    buffer_store_dwordx4 v[208:211], v10, s[12:15], s47 offen sc1
    buffer_store_dwordx4 v[212:215], v10, s[12:15], s47 offen offset:1024 sc1
    v_lshlrev_b32 v64, 16, v208
    v_and_b32 v65, 0xffff0000, v208
    v_lshlrev_b32 v66, 16, v209
    v_and_b32 v67, 0xffff0000, v209
    v_lshlrev_b32 v68, 16, v210
    v_and_b32 v69, 0xffff0000, v210
    v_lshlrev_b32 v70, 16, v211
    v_and_b32 v71, 0xffff0000, v211
    v_lshlrev_b32 v72, 16, v212
    v_and_b32 v73, 0xffff0000, v212
    v_lshlrev_b32 v74, 16, v213
    v_and_b32 v75, 0xffff0000, v213
    v_lshlrev_b32 v76, 16, v214
    v_and_b32 v77, 0xffff0000, v214
    v_lshlrev_b32 v78, 16, v215
    v_and_b32 v79, 0xffff0000, v215
    v_add_f32 v26, v64, v65
    v_add_f32 v26, v26, v66
    v_add_f32 v26, v26, v67
    v_add_f32 v26, v26, v68
    v_add_f32 v26, v26, v69
    v_add_f32 v26, v26, v70
    v_add_f32 v26, v26, v71
    v_add_f32 v26, v26, v72
    v_add_f32 v26, v26, v73
    v_add_f32 v26, v26, v74
    v_add_f32 v26, v26, v75
    v_add_f32 v26, v26, v76
    v_add_f32 v26, v26, v77
    v_add_f32 v26, v26, v78
    v_add_f32 v26, v26, v79
    s_nop 1
    v_add_f32_dpp v26, v26, v26 row_shr:1 row_mask:0xf bank_mask:0xf bound_ctrl:0
    s_nop 1
    v_add_f32_dpp v26, v26, v26 row_shr:2 row_mask:0xf bank_mask:0xf bound_ctrl:0
    s_nop 1
    v_add_f32_dpp v26, v26, v26 row_shr:4 row_mask:0xf bank_mask:0xf bound_ctrl:0
    s_nop 1
    v_add_f32_dpp v26, v26, v26 row_shr:8 row_mask:0xf bank_mask:0xf bound_ctrl:0
    s_nop 1
    v_add_f32_dpp v26, v26, v26 row_bcast:15 row_mask:0xa bank_mask:0xf
    s_nop 1
    v_add_f32_dpp v26, v26, v26 row_bcast:31 row_mask:0xc bank_mask:0xf
    s_nop 1
    v_readlane_b32 s66, v26, 63
    s_nop 1
    v_mov_b32 v27, s66
    v_mul_f32 v27, 0x3a800000, v27
    v_mov_b32 v26, 0
    v_sub_f32 v28, v64, v27
    v_fmac_f32 v26, v28, v28
    v_sub_f32 v28, v65, v27
    v_fmac_f32 v26, v28, v28
    v_sub_f32 v28, v66, v27
    v_fmac_f32 v26, v28, v28
    v_sub_f32 v28, v67, v27
    v_fmac_f32 v26, v28, v28
    v_sub_f32 v28, v68, v27
    v_fmac_f32 v26, v28, v28
    v_sub_f32 v28, v69, v27
    v_fmac_f32 v26, v28, v28
    v_sub_f32 v28, v70, v27
    v_fmac_f32 v26, v28, v28
    v_sub_f32 v28, v71, v27
    v_fmac_f32 v26, v28, v28
    v_sub_f32 v28, v72, v27
    v_fmac_f32 v26, v28, v28
    v_sub_f32 v28, v73, v27
    v_fmac_f32 v26, v28, v28
    v_sub_f32 v28, v74, v27
    v_fmac_f32 v26, v28, v28
    v_sub_f32 v28, v75, v27
    v_fmac_f32 v26, v28, v28
    v_sub_f32 v28, v76, v27
    v_fmac_f32 v26, v28, v28
    v_sub_f32 v28, v77, v27
    v_fmac_f32 v26, v28, v28
    v_sub_f32 v28, v78, v27
    v_fmac_f32 v26, v28, v28
    v_sub_f32 v28, v79, v27
    v_fmac_f32 v26, v28, v28
    s_nop 1
    v_add_f32_dpp v26, v26, v26 row_shr:1 row_mask:0xf bank_mask:0xf bound_ctrl:0
    s_nop 1
    v_add_f32_dpp v26, v26, v26 row_shr:2 row_mask:0xf bank_mask:0xf bound_ctrl:0
    s_nop 1
    v_add_f32_dpp v26, v26, v26 row_shr:4 row_mask:0xf bank_mask:0xf bound_ctrl:0
    s_nop 1
    v_add_f32_dpp v26, v26, v26 row_shr:8 row_mask:0xf bank_mask:0xf bound_ctrl:0
    s_nop 1
    v_add_f32_dpp v26, v26, v26 row_bcast:15 row_mask:0xa bank_mask:0xf
    s_nop 1
    v_add_f32_dpp v26, v26, v26 row_bcast:31 row_mask:0xc bank_mask:0xf
    s_nop 1
    v_readlane_b32 s66, v26, 63
    s_nop 1
    v_mov_b32 v26, s66
    v_mul_f32 v26, 0x3a800000, v26
    v_cvt_pk_bf16_f32 v26, v26, v26
    v_lshlrev_b32 v26, 16, v26
    v_cvt_pk_bf16_f32 v27, v27, v27
    v_lshlrev_b32 v27, 16, v27
    v_add_f32 v26, 0x3727c5ac, v26
    v_cvt_pk_bf16_f32 v26, v26, v26
    v_lshlrev_b32 v26, 16, v26
    v_sqrt_f32 v26, v26
    s_nop 0
    v_cvt_pk_bf16_f32 v26, v26, v26
    v_lshlrev_b32 v26, 16, v26
    v_rcp_f32 v26, v26
    s_nop 0
    v_sub_f32 v64, v64, v27
    v_cvt_pk_bf16_f32 v64, v64, v64
    v_lshlrev_b32 v64, 16, v64
    v_mul_f32 v64, v64, v26
    v_cvt_pk_bf16_f32 v64, v64, v64
    v_lshlrev_b32 v64, 16, v64
    v_sub_f32 v65, v65, v27
    v_cvt_pk_bf16_f32 v65, v65, v65
    v_lshlrev_b32 v65, 16, v65
    v_mul_f32 v65, v65, v26
    v_cvt_pk_bf16_f32 v65, v65, v65
    v_lshlrev_b32 v65, 16, v65
    v_sub_f32 v66, v66, v27
    v_cvt_pk_bf16_f32 v66, v66, v66
    v_lshlrev_b32 v66, 16, v66
    v_mul_f32 v66, v66, v26
    v_cvt_pk_bf16_f32 v66, v66, v66
    v_lshlrev_b32 v66, 16, v66
    v_sub_f32 v67, v67, v27
    v_cvt_pk_bf16_f32 v67, v67, v67
    v_lshlrev_b32 v67, 16, v67
    v_mul_f32 v67, v67, v26
    v_cvt_pk_bf16_f32 v67, v67, v67
    v_lshlrev_b32 v67, 16, v67
    v_sub_f32 v68, v68, v27
    v_cvt_pk_bf16_f32 v68, v68, v68
    v_lshlrev_b32 v68, 16, v68
    v_mul_f32 v68, v68, v26
    v_cvt_pk_bf16_f32 v68, v68, v68
    v_lshlrev_b32 v68, 16, v68
    v_sub_f32 v69, v69, v27
    v_cvt_pk_bf16_f32 v69, v69, v69
    v_lshlrev_b32 v69, 16, v69
    v_mul_f32 v69, v69, v26
    v_cvt_pk_bf16_f32 v69, v69, v69
    v_lshlrev_b32 v69, 16, v69
    v_sub_f32 v70, v70, v27
    v_cvt_pk_bf16_f32 v70, v70, v70
    v_lshlrev_b32 v70, 16, v70
    v_mul_f32 v70, v70, v26
    v_cvt_pk_bf16_f32 v70, v70, v70
    v_lshlrev_b32 v70, 16, v70
    v_sub_f32 v71, v71, v27
    v_cvt_pk_bf16_f32 v71, v71, v71
    v_lshlrev_b32 v71, 16, v71
    v_mul_f32 v71, v71, v26
    v_cvt_pk_bf16_f32 v71, v71, v71
    v_lshlrev_b32 v71, 16, v71
    v_sub_f32 v72, v72, v27
    v_cvt_pk_bf16_f32 v72, v72, v72
    v_lshlrev_b32 v72, 16, v72
    v_mul_f32 v72, v72, v26
    v_cvt_pk_bf16_f32 v72, v72, v72
    v_lshlrev_b32 v72, 16, v72
    v_sub_f32 v73, v73, v27
    v_cvt_pk_bf16_f32 v73, v73, v73
    v_lshlrev_b32 v73, 16, v73
    v_mul_f32 v73, v73, v26
    v_cvt_pk_bf16_f32 v73, v73, v73
    v_lshlrev_b32 v73, 16, v73
    v_sub_f32 v74, v74, v27
    v_cvt_pk_bf16_f32 v74, v74, v74
    v_lshlrev_b32 v74, 16, v74
    v_mul_f32 v74, v74, v26
    v_cvt_pk_bf16_f32 v74, v74, v74
    v_lshlrev_b32 v74, 16, v74
    v_sub_f32 v75, v75, v27
    v_cvt_pk_bf16_f32 v75, v75, v75
    v_lshlrev_b32 v75, 16, v75
    v_mul_f32 v75, v75, v26
    v_cvt_pk_bf16_f32 v75, v75, v75
    v_lshlrev_b32 v75, 16, v75
    v_sub_f32 v76, v76, v27
    v_cvt_pk_bf16_f32 v76, v76, v76
    v_lshlrev_b32 v76, 16, v76
    v_mul_f32 v76, v76, v26
    v_cvt_pk_bf16_f32 v76, v76, v76
    v_lshlrev_b32 v76, 16, v76
    v_sub_f32 v77, v77, v27
    v_cvt_pk_bf16_f32 v77, v77, v77
    v_lshlrev_b32 v77, 16, v77
    v_mul_f32 v77, v77, v26
    v_cvt_pk_bf16_f32 v77, v77, v77
    v_lshlrev_b32 v77, 16, v77
    v_sub_f32 v78, v78, v27
    v_cvt_pk_bf16_f32 v78, v78, v78
    v_lshlrev_b32 v78, 16, v78
    v_mul_f32 v78, v78, v26
    v_cvt_pk_bf16_f32 v78, v78, v78
    v_lshlrev_b32 v78, 16, v78
    v_sub_f32 v79, v79, v27
    v_cvt_pk_bf16_f32 v79, v79, v79
    v_lshlrev_b32 v79, 16, v79
    v_mul_f32 v79, v79, v26
    v_cvt_pk_bf16_f32 v79, v79, v79
    v_lshlrev_b32 v79, 16, v79
    v_mul_f32 v64, v64, v144
    v_cvt_pk_bf16_f32 v64, v64, v64
    v_lshlrev_b32 v64, 16, v64
    v_add_f32 v64, v64, v128
    v_mul_f32 v65, v65, v145
    v_cvt_pk_bf16_f32 v65, v65, v65
    v_lshlrev_b32 v65, 16, v65
    v_add_f32 v65, v65, v129
    v_mul_f32 v66, v66, v146
    v_cvt_pk_bf16_f32 v66, v66, v66
    v_lshlrev_b32 v66, 16, v66
    v_add_f32 v66, v66, v130
    v_mul_f32 v67, v67, v147
    v_cvt_pk_bf16_f32 v67, v67, v67
    v_lshlrev_b32 v67, 16, v67
    v_add_f32 v67, v67, v131
    v_mul_f32 v68, v68, v148
    v_cvt_pk_bf16_f32 v68, v68, v68
    v_lshlrev_b32 v68, 16, v68
    v_add_f32 v68, v68, v132
    v_mul_f32 v69, v69, v149
    v_cvt_pk_bf16_f32 v69, v69, v69
    v_lshlrev_b32 v69, 16, v69
    v_add_f32 v69, v69, v133
    v_mul_f32 v70, v70, v150
    v_cvt_pk_bf16_f32 v70, v70, v70
    v_lshlrev_b32 v70, 16, v70
    v_add_f32 v70, v70, v134
    v_mul_f32 v71, v71, v151
    v_cvt_pk_bf16_f32 v71, v71, v71
    v_lshlrev_b32 v71, 16, v71
    v_add_f32 v71, v71, v135
    v_mul_f32 v72, v72, v152
    v_cvt_pk_bf16_f32 v72, v72, v72
    v_lshlrev_b32 v72, 16, v72
    v_add_f32 v72, v72, v136
    v_mul_f32 v73, v73, v153
    v_cvt_pk_bf16_f32 v73, v73, v73
    v_lshlrev_b32 v73, 16, v73
    v_add_f32 v73, v73, v137
    v_mul_f32 v74, v74, v154
    v_cvt_pk_bf16_f32 v74, v74, v74
    v_lshlrev_b32 v74, 16, v74
    v_add_f32 v74, v74, v138
    v_mul_f32 v75, v75, v155
    v_cvt_pk_bf16_f32 v75, v75, v75
    v_lshlrev_b32 v75, 16, v75
    v_add_f32 v75, v75, v139
    v_mul_f32 v76, v76, v156
    v_cvt_pk_bf16_f32 v76, v76, v76
    v_lshlrev_b32 v76, 16, v76
    v_add_f32 v76, v76, v140
    v_mul_f32 v77, v77, v157
    v_cvt_pk_bf16_f32 v77, v77, v77
    v_lshlrev_b32 v77, 16, v77
    v_add_f32 v77, v77, v141
    v_mul_f32 v78, v78, v158
    v_cvt_pk_bf16_f32 v78, v78, v78
    v_lshlrev_b32 v78, 16, v78
    v_add_f32 v78, v78, v142
    v_mul_f32 v79, v79, v159
    v_cvt_pk_bf16_f32 v79, v79, v79
    v_lshlrev_b32 v79, 16, v79
    v_add_f32 v79, v79, v143
    v_cvt_pk_bf16_f32 v80, v64, v65
    v_cvt_pk_bf16_f32 v81, v66, v67
    v_cvt_pk_bf16_f32 v82, v68, v69
    v_cvt_pk_bf16_f32 v83, v70, v71
    v_cvt_pk_bf16_f32 v84, v72, v73
    v_cvt_pk_bf16_f32 v85, v74, v75
    v_cvt_pk_bf16_f32 v86, v76, v77
    v_cvt_pk_bf16_f32 v87, v78, v79
    s_lshr_b32 s45, s63, 5
    s_lshl_b32 s45, s45, 16
    s_and_b32 s46, s63, 31
    s_lshl_b32 s46, s46, 8
    s_add_u32 s45, s45, s46
    s_add_u32 s45, s45, 0xc00000
    s_add_u32 s46, s45, 32768
    buffer_store_dwordx4 v[80:83], v2, s[12:15], s45 offen sc1
    buffer_store_dwordx4 v[84:87], v2, s[12:15], s46 offen sc1
L_b_skip_148:
    s_waitcnt vmcnt(0)
    s_barrier
    s_cmp_lg_u32 s44, 0
    s_cbranch_scc1 L_pub_155
    v_mov_b32 v30, s62
    v_mov_b32 v31, 0
    s_mov_b64 exec, 1
    buffer_store_dword v30, v31, s[80:83], s65 offen
    buffer_store_dword v30, v31, s[84:87], s65 offen sc1
    s_mov_b64 exec, -1
L_pub_155:
    s_cmp_ge_u32 s41, 28
    s_cbranch_scc1 L_b_loop_147
    s_add_u32 s45, s64, 8192
    s_cmp_lg_u32 s44, 0
    s_cbranch_scc1 L_pw_156
    s_mov_b32 exec_hi, 0
    s_mov_b32 s70, 0
L_wp_157:
    buffer_load_dword v31, v5, s[12:15], s45 offen sc1
    s_add_u32 s70, s70, 1
    s_cmp_ge_u32 s70, 0x200000
    s_cbranch_scc1 L_w_done_98
    s_waitcnt vmcnt(0)
    v_cmp_gt_u32 vcc, s62, v31
    s_nop 1
    s_cbranch_vccz L_wp_157_ok
    s_sleep 1
    s_branch L_wp_157
L_wp_157_ok:
    s_mov_b64 exec, -1
L_pw_156:
    s_barrier
    s_mul_i32 s53, s50, 65536
    s_add_u32 s53, s53, s52
    s_lshl_b32 s54, s44, 13
    s_add_u32 s53, s53, s54
    s_mul_i32 s57, s50, 229376
    s_add_u32 s57, s57, s56
    s_lshl_b32 s45, s44, 11
    s_add_u32 s57, s57, s45
    s_add_u32 s55, s54, 65536
    s_mov_b32 s58, 0
    v_mov_b32 v13, v3
    v_add_u32 v14, 65536, v13
    v_xor_b32 v15, 64, v13
    v_xor_b32 v16, 64, v14
    s_mov_b32 s76, 0x20000000
    s_add_u32 s48, s53, 0
    s_add_u32 s49, s48, 4096
    s_add_u32 m0, s54, 0
    s_nop 0
    buffer_load_dwordx4 v6, s[12:15], s48 offen offset:0 sc1 lds
    s_add_u32 m0, s54, 1024
    s_nop 0
    buffer_load_dwordx4 v9, s[12:15], s48 offen offset:0 sc1 lds
    s_add_u32 m0, s54, 2048
    s_nop 0
    buffer_load_dwordx4 v6, s[12:15], s49 offen offset:0 sc1 lds
    s_add_u32 m0, s54, 3072
    s_nop 0
    buffer_load_dwordx4 v9, s[12:15], s49 offen offset:0 sc1 lds
    s_add_u32 m0, s54, 3968
    s_nop 0
    buffer_load_dwordx4 v6, s[12:15], s48 offen offset:128 sc1 lds
    s_add_u32 m0, s54, 4992
    s_nop 0
    buffer_load_dwordx4 v9, s[12:15], s48 offen offset:128 sc1 lds
    s_add_u32 m0, s54, 6016
    s_nop 0
    buffer_load_dwordx4 v6, s[12:15], s49 offen offset:128 sc1 lds
    s_add_u32 m0, s54, 7040
    s_nop 0
    buffer_load_dwordx4 v9, s[12:15], s49 offen offset:128 sc1 lds
    s_add_u32 s48, s53, 32768
    s_add_u32 s49, s48, 4096
    s_add_u32 s46, s54, 32768
    s_add_u32 m0, s46, 0
    s_nop 0
    buffer_load_dwordx4 v6, s[12:15], s48 offen offset:0 sc1 lds
    s_add_u32 m0, s46, 1024
    s_nop 0
    buffer_load_dwordx4 v9, s[12:15], s48 offen offset:0 sc1 lds
    s_add_u32 m0, s46, 2048
    s_nop 0
    buffer_load_dwordx4 v6, s[12:15], s49 offen offset:0 sc1 lds
    s_add_u32 m0, s46, 3072
    s_nop 0
    buffer_load_dwordx4 v9, s[12:15], s49 offen offset:0 sc1 lds
    s_add_u32 m0, s46, 3968
    s_nop 0
    buffer_load_dwordx4 v6, s[12:15], s48 offen offset:128 sc1 lds
    s_add_u32 m0, s46, 4992
    s_nop 0
    buffer_load_dwordx4 v9, s[12:15], s48 offen offset:128 sc1 lds
    s_add_u32 m0, s46, 6016
    s_nop 0
    buffer_load_dwordx4 v6, s[12:15], s49 offen offset:128 sc1 lds
    s_add_u32 m0, s46, 7040
    s_nop 0
    buffer_load_dwordx4 v9, s[12:15], s49 offen offset:128 sc1 lds
    s_cmp_eq_u32 s51, 1
    s_cbranch_scc1 L_e_one_159
    s_add_u32 s48, s53, 65536
    s_add_u32 s49, s48, 4096
    s_add_u32 m0, s55, 0
    s_nop 0
    buffer_load_dwordx4 v6, s[12:15], s48 offen offset:0 sc1 lds
    s_add_u32 m0, s55, 1024
    s_nop 0
    buffer_load_dwordx4 v9, s[12:15], s48 offen offset:0 sc1 lds
    s_add_u32 m0, s55, 2048
    s_nop 0
    buffer_load_dwordx4 v6, s[12:15], s49 offen offset:0 sc1 lds
    s_add_u32 m0, s55, 3072
    s_nop 0
    buffer_load_dwordx4 v9, s[12:15], s49 offen offset:0 sc1 lds
    s_add_u32 m0, s55, 3968
    s_nop 0
    buffer_load_dwordx4 v6, s[12:15], s48 offen offset:128 sc1 lds
    s_add_u32 m0, s55, 4992
    s_nop 0
    buffer_load_dwordx4 v9, s[12:15], s48 offen offset:128 sc1 lds
    s_add_u32 m0, s55, 6016
    s_nop 0
    buffer_load_dwordx4 v6, s[12:15], s49 offen offset:128 sc1 lds
    s_add_u32 m0, s55, 7040
    s_nop 0
    buffer_load_dwordx4 v9, s[12:15], s49 offen offset:128 sc1 lds
    s_waitcnt vmcnt(16)
    s_barrier
    ds_read_b128 v[32:35], v13 offset:0
    ds_read_b128 v[36:39], v13 offset:2048
    ds_read_b128 v[40:43], v15 offset:0
    ds_read_b128 v[44:47], v15 offset:2048
L_e_loop_158:
    s_add_u32 s48, s53, 98304
    s_add_u32 s46, s58, 1
    s_cmp_lt_u32 s46, s51
    s_cselect_b32 s48, s48, 0x20000000
    s_add_u32 s49, s48, 4096
    s_add_u32 s59, s55, 32768
    s_waitcnt lgkmcnt(2)
    v_mfma_f32_16x16x32_bf16 v[80:83], a[0:3], v[32:35], 0
    ds_read_b128 v[48:51], v13 offset:4096
    ds_read_b128 v[52:55], v13 offset:6144
    v_mfma_f32_16x16x32_bf16 v[84:87], a[4:7], v[32:35], 0
    ds_read_b128 v[56:59], v15 offset:4096
    ds_read_b128 v[60:63], v15 offset:6144
    s_add_u32 m0, s59, 0
    v_mfma_f32_16x16x32_bf16 v[88:91], a[0:3], v[36:39], 0
    buffer_load_dwordx4 v6, s[12:15], s48 offen offset:0 sc1 lds
    v_mfma_f32_16x16x32_bf16 v[92:95], a[4:7], v[36:39], 0
    v_mul_f32 v240, v224, v224
    v_mul_f32 v241, v225, v225
    s_waitcnt lgkmcnt(4)
    v_mfma_f32_16x16x32_bf16 v[80:83], a[8:11], v[40:43], v[80:83]
    ds_read_b128 v[32:35], v13 offset:8192
    ds_read_b128 v[36:39], v13 offset:10240
    v_mfma_f32_16x16x32_bf16 v[84:87], a[12:15], v[40:43], v[84:87]
    s_add_u32 m0, s59, 1024
    v_mul_f32 v242, v226, v226
    v_mfma_f32_16x16x32_bf16 v[88:91], a[8:11], v[44:47], v[88:91]
    buffer_load_dwordx4 v9, s[12:15], s48 offen offset:0 sc1 lds
    v_mfma_f32_16x16x32_bf16 v[92:95], a[12:15], v[44:47], v[92:95]
    v_mul_f32 v243, v227, v227
    v_mul_f32 v244, v228, v228
    s_waitcnt lgkmcnt(4)
    v_mfma_f32_16x16x32_bf16 v[80:83], a[16:19], v[48:51], v[80:83]
    ds_read_b128 v[40:43], v15 offset:8192
    ds_read_b128 v[44:47], v15 offset:10240
    v_mfma_f32_16x16x32_bf16 v[84:87], a[20:23], v[48:51], v[84:87]
    s_add_u32 m0, s59, 2048
    v_mul_f32 v245, v229, v229
    v_mfma_f32_16x16x32_bf16 v[88:91], a[16:19], v[52:55], v[88:91]
    buffer_load_dwordx4 v6, s[12:15], s49 offen offset:0 sc1 lds
    v_mfma_f32_16x16x32_bf16 v[92:95], a[20:23], v[52:55], v[92:95]
    v_mul_f32 v246, v230, v230
    v_mul_f32 v247, v231, v231
    s_waitcnt lgkmcnt(4)
    v_mfma_f32_16x16x32_bf16 v[80:83], a[24:27], v[56:59], v[80:83]
    ds_read_b128 v[48:51], v13 offset:12288
    ds_read_b128 v[52:55], v13 offset:14336
    v_mfma_f32_16x16x32_bf16 v[84:87], a[28:31], v[56:59], v[84:87]
    s_add_u32 m0, s59, 3072
    v_mul_f32 v248, v232, v232
    v_mfma_f32_16x16x32_bf16 v[88:91], a[24:27], v[60:63], v[88:91]
    buffer_load_dwordx4 v9, s[12:15], s49 offen offset:0 sc1 lds
    v_mfma_f32_16x16x32_bf16 v[92:95], a[28:31], v[60:63], v[92:95]
    v_mul_f32 v249, v233, v233
    v_mul_f32 v250, v234, v234
    s_waitcnt lgkmcnt(4)
    v_mfma_f32_16x16x32_bf16 v[80:83], a[32:35], v[32:35], v[80:83]
    ds_read_b128 v[56:59], v15 offset:12288
    ds_read_b128 v[60:63], v15 offset:14336
    v_mfma_f32_16x16x32_bf16 v[84:87], a[36:39], v[32:35], v[84:87]
    s_add_u32 m0, s59, 3968
    v_mul_f32 v251, v235, v235
    v_mfma_f32_16x16x32_bf16 v[88:91], a[32:35], v[36:39], v[88:91]
    buffer_load_dwordx4 v6, s[12:15], s48 offen offset:128 sc1 lds
    v_mfma_f32_16x16x32_bf16 v[92:95], a[36:39], v[36:39], v[92:95]
    v_mul_f32 v252, v236, v236
    v_mul_f32 v253, v237, v237
    v_mul_f32 v254, v238, v238
    s_waitcnt lgkmcnt(4)
    v_mfma_f32_16x16x32_bf16 v[80:83], a[40:43], v[40:43], v[80:83]
    ds_read_b128 v[32:35], v13 offset:16384
    ds_read_b128 v[36:39], v13 offset:18432
    v_mfma_f32_16x16x32_bf16 v[84:87], a[44:47], v[40:43], v[84:87]
    s_add_u32 m0, s59, 4992
    v_mul_f32 v255, v239, v239
    v_fma_f32 v240, v240, v104, v106
    v_mfma_f32_16x16x32_bf16 v[88:91], a[40:43], v[44:47], v[88:91]
    buffer_load_dwordx4 v9, s[12:15], s48 offen offset:128 sc1 lds
    v_mfma_f32_16x16x32_bf16 v[92:95], a[44:47], v[44:47], v[92:95]
    v_fma_f32 v241, v241, v105, v107
    v_fma_f32 v242, v242, v104, v106
    v_fma_f32 v243, v243, v105, v107
    s_waitcnt lgkmcnt(4)
    v_mfma_f32_16x16x32_bf16 v[80:83], a[48:51], v[48:51], v[80:83]
    ds_read_b128 v[40:43], v15 offset:16384
    ds_read_b128 v[44:47], v15 offset:18432
    v_mfma_f32_16x16x32_bf16 v[84:87], a[52:55], v[48:51], v[84:87]
    s_add_u32 m0, s59, 6016
    v_fma_f32 v244, v244, v104, v106
    v_fma_f32 v245, v245, v105, v107
    v_mfma_f32_16x16x32_bf16 v[88:91], a[48:51], v[52:55], v[88:91]
    buffer_load_dwordx4 v6, s[12:15], s49 offen offset:128 sc1 lds
    v_mfma_f32_16x16x32_bf16 v[92:95], a[52:55], v[52:55], v[92:95]
    v_fma_f32 v246, v246, v104, v106
    v_fma_f32 v247, v247, v105, v107
    v_fma_f32 v248, v248, v104, v106
    s_waitcnt lgkmcnt(4)
    v_mfma_f32_16x16x32_bf16 v[80:83], a[56:59], v[56:59], v[80:83]
    ds_read_b128 v[48:51], v13 offset:20480
    ds_read_b128 v[52:55], v13 offset:22528
    v_mfma_f32_16x16x32_bf16 v[84:87], a[60:63], v[56:59], v[84:87]
    s_add_u32 m0, s59, 7040
    v_fma_f32 v249, v249, v105, v107
    v_fma_f32 v250, v250, v104, v106
    v_mfma_f32_16x16x32_bf16 v[88:91], a[56:59], v[60:63], v[88:91]
    buffer_load_dwordx4 v9, s[12:15], s49 offen offset:128 sc1 lds
    v_mfma_f32_16x16x32_bf16 v[92:95], a[60:63], v[60:63], v[92:95]
    v_fma_f32 v251, v251, v105, v107
    v_fma_f32 v252, v252, v104, v106
    v_fma_f32 v253, v253, v105, v107
    s_waitcnt lgkmcnt(4)
    v_mfma_f32_16x16x32_bf16 v[80:83], a[64:67], v[32:35], v[80:83]
    ds_read_b128 v[56:59], v15 offset:20480
    ds_read_b128 v[60:63], v15 offset:22528
    v_mfma_f32_16x16x32_bf16 v[84:87], a[68:71], v[32:35], v[84:87]
    v_fma_f32 v254, v254, v104, v106
    v_fma_f32 v255, v255, v105, v107
    v_mul_f32 v240, v240, v224
    v_mfma_f32_16x16x32_bf16 v[88:91], a[64:67], v[36:39], v[88:91]
    v_mul_f32 v241, v241, v225
    v_mul_f32 v242, v242, v226
    v_mul_f32 v243, v243, v227
    v_mfma_f32_16x16x32_bf16 v[92:95], a[68:71], v[36:39], v[92:95]
    v_mul_f32 v244, v244, v228
    v_mul_f32 v245, v245, v229
    s_waitcnt lgkmcnt(4)
    v_mfma_f32_16x16x32_bf16 v[80:83], a[72:75], v[40:43], v[80:83]
    ds_read_b128 v[32:35], v13 offset:24576
    ds_read_b128 v[36:39], v13 offset:26624
    v_mfma_f32_16x16x32_bf16 v[84:87], a[76:79], v[40:43], v[84:87]
    v_mul_f32 v246, v246, v230
    v_mul_f32 v247, v247, v231
    v_mfma_f32_16x16x32_bf16 v[88:91], a[72:75], v[44:47], v[88:91]
    v_mul_f32 v248, v248, v232
    v_mul_f32 v249, v249, v233
    v_mfma_f32_16x16x32_bf16 v[92:95], a[76:79], v[44:47], v[92:95]
    v_mul_f32 v250, v250, v234
    v_mul_f32 v251, v251, v235
    s_waitcnt lgkmcnt(4)
    v_mfma_f32_16x16x32_bf16 v[80:83], a[80:83], v[48:51], v[80:83]
    ds_read_b128 v[40:43], v15 offset:24576
    ds_read_b128 v[44:47], v15 offset:26624
    v_mfma_f32_16x16x32_bf16 v[84:87], a[84:87], v[48:51], v[84:87]
    v_mul_f32 v252, v252, v236
    v_mul_f32 v253, v253, v237
    v_mfma_f32_16x16x32_bf16 v[88:91], a[80:83], v[52:55], v[88:91]
    v_mul_f32 v254, v254, v238
    v_mul_f32 v255, v255, v239
    v_mfma_f32_16x16x32_bf16 v[92:95], a[84:87], v[52:55], v[92:95]
    v_exp_f32 v240, v240
    s_waitcnt lgkmcnt(4)
    v_mfma_f32_16x16x32_bf16 v[80:83], a[88:91], v[56:59], v[80:83]
    ds_read_b128 v[48:51], v13 offset:28672
    ds_read_b128 v[52:55], v13 offset:30720
    v_mfma_f32_16x16x32_bf16 v[84:87], a[92:95], v[56:59], v[84:87]
    v_exp_f32 v241, v241
    v_mfma_f32_16x16x32_bf16 v[88:91], a[88:91], v[60:63], v[88:91]
    v_exp_f32 v242, v242
    v_mfma_f32_16x16x32_bf16 v[92:95], a[92:95], v[60:63], v[92:95]
    v_exp_f32 v243, v243
    s_waitcnt lgkmcnt(4)
    v_mfma_f32_16x16x32_bf16 v[80:83], a[96:99], v[32:35], v[80:83]
    ds_read_b128 v[56:59], v15 offset:28672
    ds_read_b128 v[60:63], v15 offset:30720
    v_mfma_f32_16x16x32_bf16 v[84:87], a[100:103], v[32:35], v[84:87]
    v_exp_f32 v244, v244
    v_mfma_f32_16x16x32_bf16 v[88:91], a[96:99], v[36:39], v[88:91]
    v_exp_f32 v245, v245
    v_mfma_f32_16x16x32_bf16 v[92:95], a[100:103], v[36:39], v[92:95]
    v_exp_f32 v246, v246
    s_waitcnt lgkmcnt(4)
    v_mfma_f32_16x16x32_bf16 v[80:83], a[104:107], v[40:43], v[80:83]
    v_exp_f32 v247, v247
    v_mfma_f32_16x16x32_bf16 v[84:87], a[108:111], v[40:43], v[84:87]
    v_exp_f32 v248, v248
    v_mfma_f32_16x16x32_bf16 v[88:91], a[104:107], v[44:47], v[88:91]
    v_exp_f32 v249, v249
    v_mfma_f32_16x16x32_bf16 v[92:95], a[108:111], v[44:47], v[92:95]
    v_exp_f32 v250, v250
    s_waitcnt vmcnt(16) lgkmcnt(0)
    s_barrier
    v_mfma_f32_16x16x32_bf16 v[80:83], a[112:115], v[48:51], v[80:83]
    ds_read_b128 v[32:35], v13 offset:32768
    ds_read_b128 v[36:39], v13 offset:34816
    v_mfma_f32_16x16x32_bf16 v[84:87], a[116:119], v[48:51], v[84:87]
    v_exp_f32 v251, v251
    v_mfma_f32_16x16x32_bf16 v[88:91], a[112:115], v[52:55], v[88:91]
    v_exp_f32 v252, v252
    v_mfma_f32_16x16x32_bf16 v[92:95], a[116:119], v[52:55], v[92:95]
    v_exp_f32 v253, v253
    v_mfma_f32_16x16x32_bf16 v[80:83], a[120:123], v[56:59], v[80:83]
    ds_read_b128 v[40:43], v15 offset:32768
    ds_read_b128 v[44:47], v15 offset:34816
    v_mfma_f32_16x16x32_bf16 v[84:87], a[124:127], v[56:59], v[84:87]
    v_exp_f32 v254, v254
    v_mfma_f32_16x16x32_bf16 v[88:91], a[120:123], v[60:63], v[88:91]
    v_exp_f32 v255, v255
    v_mfma_f32_16x16x32_bf16 v[92:95], a[124:127], v[60:63], v[92:95]
    v_add_f32 v240, 1.0, v240
    v_add_f32 v241, 1.0, v241
    s_add_u32 s48, s53, 131072
    s_add_u32 s46, s58, 2
    s_cmp_lt_u32 s46, s51
    s_cselect_b32 s48, s48, 0x20000000
    s_add_u32 s49, s48, 4096
    s_mov_b32 s59, s54
    s_waitcnt lgkmcnt(2)
    v_mfma_f32_16x16x32_bf16 v[80:83], a[128:131], v[32:35], v[80:83]
    ds_read_b128 v[48:51], v13 offset:36864
    ds_read_b128 v[52:55], v13 offset:38912
    v_mfma_f32_16x16x32_bf16 v[84:87], a[132:135], v[32:35], v[84:87]
    ds_read_b128 v[56:59], v15 offset:36864
    ds_read_b128 v[60:63], v15 offset:38912
    s_add_u32 m0, s59, 0
    v_mfma_f32_16x16x32_bf16 v[88:91], a[128:131], v[36:39], v[88:91]
    buffer_load_dwordx4 v6, s[12:15], s48 offen offset:0 sc1 lds
    v_mfma_f32_16x16x32_bf16 v[92:95], a[132:135], v[36:39], v[92:95]
    v_add_f32 v242, 1.0, v242
    v_add_f32 v243, 1.0, v243
    s_waitcnt lgkmcnt(4)
    v_mfma_f32_16x16x32_bf16 v[80:83], a[136:139], v[40:43], v[80:83]
    ds_read_b128 v[32:35], v13 offset:40960
    ds_read_b128 v[36:39], v13 offset:43008
    v_mfma_f32_16x16x32_bf16 v[84:87], a[140:143], v[40:43], v[84:87]
    s_add_u32 m0, s59, 1024
    v_add_f32 v244, 1.0, v244
    v_mfma_f32_16x16x32_bf16 v[88:91], a[136:139], v[44:47], v[88:91]
    buffer_load_dwordx4 v9, s[12:15], s48 offen offset:0 sc1 lds
    v_mfma_f32_16x16x32_bf16 v[92:95], a[140:143], v[44:47], v[92:95]
    v_add_f32 v245, 1.0, v245
    v_add_f32 v246, 1.0, v246
    s_waitcnt lgkmcnt(4)
    v_mfma_f32_16x16x32_bf16 v[80:83], a[144:147], v[48:51], v[80:83]
    ds_read_b128 v[40:43], v15 offset:40960
    ds_read_b128 v[44:47], v15 offset:43008
    v_mfma_f32_16x16x32_bf16 v[84:87], a[148:151], v[48:51], v[84:87]
    s_add_u32 m0, s59, 2048
    v_add_f32 v247, 1.0, v247
    v_mfma_f32_16x16x32_bf16 v[88:91], a[144:147], v[52:55], v[88:91]
    buffer_load_dwordx4 v6, s[12:15], s49 offen offset:0 sc1 lds
    v_mfma_f32_16x16x32_bf16 v[92:95], a[148:151], v[52:55], v[92:95]
    v_add_f32 v248, 1.0, v248
    v_add_f32 v249, 1.0, v249
    s_waitcnt lgkmcnt(4)
    v_mfma_f32_16x16x32_bf16 v[80:83], a[152:155], v[56:59], v[80:83]
    ds_read_b128 v[48:51], v13 offset:45056
    ds_read_b128 v[52:55], v13 offset:47104
    v_mfma_f32_16x16x32_bf16 v[84:87], a[156:159], v[56:59], v[84:87]
    s_add_u32 m0, s59, 3072
    v_add_f32 v250, 1.0, v250
    v_mfma_f32_16x16x32_bf16 v[88:91], a[152:155], v[60:63], v[88:91]
    buffer_load_dwordx4 v9, s[12:15], s49 offen offset:0 sc1 lds
    v_mfma_f32_16x16x32_bf16 v[92:95], a[156:159], v[60:63], v[92:95]
    v_add_f32 v251, 1.0, v251
    v_add_f32 v252, 1.0, v252
    v_add_f32 v253, 1.0, v253
    s_waitcnt lgkmcnt(4)
    v_mfma_f32_16x16x32_bf16 v[80:83], a[160:163], v[32:35], v[80:83]
    ds_read_b128 v[56:59], v15 offset:45056
    ds_read_b128 v[60:63], v15 offset:47104
    v_mfma_f32_16x16x32_bf16 v[84:87], a[164:167], v[32:35], v[84:87]
    s_add_u32 m0, s59, 3968
    v_add_f32 v254, 1.0, v254
    v_add_f32 v255, 1.0, v255
    v_mfma_f32_16x16x32_bf16 v[88:91], a[160:163], v[36:39], v[88:91]
    buffer_load_dwordx4 v6, s[12:15], s48 offen offset:128 sc1 lds
    v_mfma_f32_16x16x32_bf16 v[92:95], a[164:167], v[36:39], v[92:95]
    v_rcp_f32 v240, v240
    v_rcp_f32 v241, v241
    s_waitcnt lgkmcnt(4)
    v_mfma_f32_16x16x32_bf16 v[80:83], a[168:171], v[40:43], v[80:83]
    ds_read_b128 v[32:35], v13 offset:49152
    ds_read_b128 v[36:39], v13 offset:51200
    v_mfma_f32_16x16x32_bf16 v[84:87], a[172:175], v[40:43], v[84:87]
    s_add_u32 m0, s59, 4992
    v_rcp_f32 v242, v242
    v_mfma_f32_16x16x32_bf16 v[88:91], a[168:171], v[44:47], v[88:91]
    buffer_load_dwordx4 v9, s[12:15], s48 offen offset:128 sc1 lds
    v_mfma_f32_16x16x32_bf16 v[92:95], a[172:175], v[44:47], v[92:95]
    v_rcp_f32 v243, v243
    s_waitcnt lgkmcnt(4)
    v_mfma_f32_16x16x32_bf16 v[80:83], a[176:179], v[48:51], v[80:83]
    ds_read_b128 v[40:43], v15 offset:49152
    ds_read_b128 v[44:47], v15 offset:51200
    v_mfma_f32_16x16x32_bf16 v[84:87], a[180:183], v[48:51], v[84:87]
    s_add_u32 m0, s59, 6016
    v_rcp_f32 v244, v244
    v_mfma_f32_16x16x32_bf16 v[88:91], a[176:179], v[52:55], v[88:91]
    buffer_load_dwordx4 v6, s[12:15], s49 offen offset:128 sc1 lds
    v_mfma_f32_16x16x32_bf16 v[92:95], a[180:183], v[52:55], v[92:95]
    v_rcp_f32 v245, v245
    v_rcp_f32 v246, v246
    s_waitcnt lgkmcnt(4)
    v_mfma_f32_16x16x32_bf16 v[80:83], a[184:187], v[56:59], v[80:83]
    ds_read_b128 v[48:51], v13 offset:53248
    ds_read_b128 v[52:55], v13 offset:55296
    v_mfma_f32_16x16x32_bf16 v[84:87], a[188:191], v[56:59], v[84:87]
    s_add_u32 m0, s59, 7040
    v_rcp_f32 v247, v247
    v_mfma_f32_16x16x32_bf16 v[88:91], a[184:187], v[60:63], v[88:91]
    buffer_load_dwordx4 v9, s[12:15], s49 offen offset:128 sc1 lds
    v_mfma_f32_16x16x32_bf16 v[92:95], a[188:191], v[60:63], v[92:95]
    v_rcp_f32 v248, v248
    v_rcp_f32 v249, v249
    s_waitcnt lgkmcnt(4)
    v_mfma_f32_16x16x32_bf16 v[80:83], a[192:195], v[32:35], v[80:83]
    ds_read_b128 v[56:59], v15 offset:53248
    ds_read_b128 v[60:63], v15 offset:55296
    v_mfma_f32_16x16x32_bf16 v[84:87], a[196:199], v[32:35], v[84:87]
    v_rcp_f32 v250, v250
    v_mfma_f32_16x16x32_bf16 v[88:91], a[192:195], v[36:39], v[88:91]
    v_rcp_f32 v251, v251
    v_mfma_f32_16x16x32_bf16 v[92:95], a[196:199], v[36:39], v[92:95]
    v_rcp_f32 v252, v252
    s_waitcnt lgkmcnt(4)
    v_mfma_f32_16x16x32_bf16 v[80:83], a[200:203], v[40:43], v[80:83]
    ds_read_b128 v[32:35], v13 offset:57344
    ds_read_b128 v[36:39], v13 offset:59392
    v_mfma_f32_16x16x32_bf16 v[84:87], a[204:207], v[40:43], v[84:87]
    v_rcp_f32 v253, v253
    v_mfma_f32_16x16x32_bf16 v[88:91], a[200:203], v[44:47], v[88:91]
    v_rcp_f32 v254, v254
    v_mfma_f32_16x16x32_bf16 v[92:95], a[204:207], v[44:47], v[92:95]
    v_rcp_f32 v255, v255
    s_waitcnt lgkmcnt(4)
    v_mfma_f32_16x16x32_bf16 v[80:83], a[208:211], v[48:51], v[80:83]
    ds_read_b128 v[40:43], v15 offset:57344
    ds_read_b128 v[44:47], v15 offset:59392
    v_mfma_f32_16x16x32_bf16 v[84:87], a[212:215], v[48:51], v[84:87]
    v_mul_f32 v224, v224, v240
    v_mul_f32 v225, v225, v241
    v_mfma_f32_16x16x32_bf16 v[88:91], a[208:211], v[52:55], v[88:91]
    v_mul_f32 v226, v226, v242
    v_mul_f32 v227, v227, v243
    v_mfma_f32_16x16x32_bf16 v[92:95], a[212:215], v[52:55], v[92:95]
    v_mul_f32 v228, v228, v244
    v_mul_f32 v229, v229, v245
    s_waitcnt lgkmcnt(4)
    v_mfma_f32_16x16x32_bf16 v[80:83], a[216:219], v[56:59], v[80:83]
    ds_read_b128 v[48:51], v13 offset:61440
    ds_read_b128 v[52:55], v13 offset:63488
    v_mfma_f32_16x16x32_bf16 v[84:87], a[220:223], v[56:59], v[84:87]
    v_mul_f32 v230, v230, v246
    v_mul_f32 v231, v231, v247
    v_mfma_f32_16x16x32_bf16 v[88:91], a[216:219], v[60:63], v[88:91]
    v_mul_f32 v232, v232, v248
    v_mul_f32 v233, v233, v249
    v_mfma_f32_16x16x32_bf16 v[92:95], a[220:223], v[60:63], v[92:95]
    v_mul_f32 v234, v234, v250
    v_mul_f32 v235, v235, v251
    s_waitcnt lgkmcnt(4)
    v_mfma_f32_16x16x32_bf16 v[80:83], a[224:227], v[32:35], v[80:83]
    ds_read_b128 v[56:59], v15 offset:61440
    ds_read_b128 v[60:63], v15 offset:63488
    v_mfma_f32_16x16x32_bf16 v[84:87], a[228:231], v[32:35], v[84:87]
    v_mul_f32 v236, v236, v252
    v_mul_f32 v237, v237, v253
    v_mfma_f32_16x16x32_bf16 v[88:91], a[224:227], v[36:39], v[88:91]
    v_mul_f32 v238, v238, v254
    v_mul_f32 v239, v239, v255
    v_mfma_f32_16x16x32_bf16 v[92:95], a[228:231], v[36:39], v[92:95]
    v_cvt_pk_bf16_f32 v240, v224, v225
    v_cvt_pk_bf16_f32 v241, v226, v227
    s_waitcnt lgkmcnt(4)
    v_mfma_f32_16x16x32_bf16 v[80:83], a[232:235], v[40:43], v[80:83]
    v_cvt_pk_bf16_f32 v242, v228, v229
    v_cvt_pk_bf16_f32 v243, v230, v231
    v_mfma_f32_16x16x32_bf16 v[84:87], a[236:239], v[40:43], v[84:87]
    v_cvt_pk_bf16_f32 v244, v232, v233
    v_cvt_pk_bf16_f32 v245, v234, v235
    v_mfma_f32_16x16x32_bf16 v[88:91], a[232:235], v[44:47], v[88:91]
    v_cvt_pk_bf16_f32 v246, v236, v237
    v_cvt_pk_bf16_f32 v247, v238, v239
    v_mfma_f32_16x16x32_bf16 v[92:95], a[236:239], v[44:47], v[92:95]
    buffer_store_dwordx4 v[240:243], v10, s[12:15], s76 offen sc1
    buffer_store_dwordx4 v[244:247], v10, s[12:15], s76 offen offset:1024 sc1
    s_waitcnt vmcnt(16) lgkmcnt(0)
    s_barrier
    v_mfma_f32_16x16x32_bf16 v[80:83], a[240:243], v[48:51], v[80:83]
    ds_read_b128 v[32:35], v14 offset:0
    ds_read_b128 v[36:39], v14 offset:2048
    v_mfma_f32_16x16x32_bf16 v[84:87], a[244:247], v[48:51], v[84:87]
    v_mfma_f32_16x16x32_bf16 v[88:91], a[240:243], v[52:55], v[88:91]
    v_mfma_f32_16x16x32_bf16 v[92:95], a[244:247], v[52:55], v[92:95]
    v_mfma_f32_16x16x32_bf16 v[80:83], a[248:251], v[56:59], v[80:83]
    ds_read_b128 v[40:43], v16 offset:0
    ds_read_b128 v[44:47], v16 offset:2048
    v_mfma_f32_16x16x32_bf16 v[84:87], a[252:255], v[56:59], v[84:87]
    v_mfma_f32_16x16x32_bf16 v[88:91], a[248:251], v[60:63], v[88:91]
    v_mfma_f32_16x16x32_bf16 v[92:95], a[252:255], v[60:63], v[92:95]
    s_add_u32 s53, s53, 65536
    s_add_u32 s58, s58, 1
    v_swap_b32 v13, v14
    s_xor_b32 s54, s54, 65536
    s_xor_b32 s55, s55, 65536
    s_mov_b32 s76, s57
    v_swap_b32 v15, v16
    s_add_u32 s57, s57, 229376
    v_pk_add_f32 v[224:225], v[80:81], v[96:97]
    v_pk_add_f32 v[226:227], v[82:83], v[98:99]
    v_pk_add_f32 v[228:229], v[84:85], v[100:101]
    v_pk_add_f32 v[230:231], v[86:87], v[102:103]
    v_pk_add_f32 v[232:233], v[88:89], v[96:97]
    v_pk_add_f32 v[234:235], v[90:91], v[98:99]
    v_pk_add_f32 v[236:237], v[92:93], v[100:101]
    v_pk_add_f32 v[238:239], v[94:95], v[102:103]
    s_cmp_lt_u32 s58, s51
    s_cbranch_scc1 L_e_loop_158
    s_branch L_e_fin_160
L_e_one_159:
    s_waitcnt vmcnt(8)
    s_barrier
    ds_read_b128 v[32:35], v13 offset:0
    ds_read_b128 v[36:39], v13 offset:2048
    ds_read_b128 v[40:43], v15 offset:0
    ds_read_b128 v[44:47], v15 offset:2048
    s_waitcnt lgkmcnt(2)
    v_mfma_f32_16x16x32_bf16 v[80:83], a[0:3], v[32:35], 0
    ds_read_b128 v[48:51], v13 offset:4096
    ds_read_b128 v[52:55], v13 offset:6144
    v_mfma_f32_16x16x32_bf16 v[84:87], a[4:7], v[32:35], 0
    ds_read_b128 v[56:59], v15 offset:4096
    ds_read_b128 v[60:63], v15 offset:6144
    v_mfma_f32_16x16x32_bf16 v[88:91], a[0:3], v[36:39], 0
    v_mfma_f32_16x16x32_bf16 v[92:95], a[4:7], v[36:39], 0
    s_waitcnt lgkmcnt(4)
    v_mfma_f32_16x16x32_bf16 v[80:83], a[8:11], v[40:43], v[80:83]
    ds_read_b128 v[32:35], v13 offset:8192
    ds_read_b128 v[36:39], v13 offset:10240
    v_mfma_f32_16x16x32_bf16 v[84:87], a[12:15], v[40:43], v[84:87]
    v_mfma_f32_16x16x32_bf16 v[88:91], a[8:11], v[44:47], v[88:91]
    v_mfma_f32_16x16x32_bf16 v[92:95], a[12:15], v[44:47], v[92:95]
    s_waitcnt lgkmcnt(4)
    v_mfma_f32_16x16x32_bf16 v[80:83], a[16:19], v[48:51], v[80:83]
    ds_read_b128 v[40:43], v15 offset:8192
    ds_read_b128 v[44:47], v15 offset:10240
    v_mfma_f32_16x16x32_bf16 v[84:87], a[20:23], v[48:51], v[84:87]
    v_mfma_f32_16x16x32_bf16 v[88:91], a[16:19], v[52:55], v[88:91]
    v_mfma_f32_16x16x32_bf16 v[92:95], a[20:23], v[52:55], v[92:95]
    s_waitcnt lgkmcnt(4)
    v_mfma_f32_16x16x32_bf16 v[80:83], a[24:27], v[56:59], v[80:83]
    ds_read_b128 v[48:51], v13 offset:12288
    ds_read_b128 v[52:55], v13 offset:14336
    v_mfma_f32_16x16x32_bf16 v[84:87], a[28:31], v[56:59], v[84:87]
    v_mfma_f32_16x16x32_bf16 v[88:91], a[24:27], v[60:63], v[88:91]
    v_mfma_f32_16x16x32_bf16 v[92:95], a[28:31], v[60:63], v[92:95]
    s_waitcnt lgkmcnt(4)
    v_mfma_f32_16x16x32_bf16 v[80:83], a[32:35], v[32:35], v[80:83]
    ds_read_b128 v[56:59], v15 offset:12288
    ds_read_b128 v[60:63], v15 offset:14336
    v_mfma_f32_16x16x32_bf16 v[84:87], a[36:39], v[32:35], v[84:87]
    v_mfma_f32_16x16x32_bf16 v[88:91], a[32:35], v[36:39], v[88:91]
    v_mfma_f32_16x16x32_bf16 v[92:95], a[36:39], v[36:39], v[92:95]
    s_waitcnt lgkmcnt(4)
    v_mfma_f32_16x16x32_bf16 v[80:83], a[40:43], v[40:43], v[80:83]
    ds_read_b128 v[32:35], v13 offset:16384
    ds_read_b128 v[36:39], v13 offset:18432
    v_mfma_f32_16x16x32_bf16 v[84:87], a[44:47], v[40:43], v[84:87]
    v_mfma_f32_16x16x32_bf16 v[88:91], a[40:43], v[44:47], v[88:91]
    v_mfma_f32_16x16x32_bf16 v[92:95], a[44:47], v[44:47], v[92:95]
    s_waitcnt lgkmcnt(4)
    v_mfma_f32_16x16x32_bf16 v[80:83], a[48:51], v[48:51], v[80:83]
    ds_read_b128 v[40:43], v15 offset:16384
    ds_read_b128 v[44:47], v15 offset:18432
    v_mfma_f32_16x16x32_bf16 v[84:87], a[52:55], v[48:51], v[84:87]
    v_mfma_f32_16x16x32_bf16 v[88:91], a[48:51], v[52:55], v[88:91]
    v_mfma_f32_16x16x32_bf16 v[92:95], a[52:55], v[52:55], v[92:95]
    s_waitcnt lgkmcnt(4)
    v_mfma_f32_16x16x32_bf16 v[80:83], a[56:59], v[56:59], v[80:83]
    ds_read_b128 v[48:51], v13 offset:20480
    ds_read_b128 v[52:55], v13 offset:22528
    v_mfma_f32_16x16x32_bf16 v[84:87], a[60:63], v[56:59], v[84:87]
    v_mfma_f32_16x16x32_bf16 v[88:91], a[56:59], v[60:63], v[88:91]
    v_mfma_f32_16x16x32_bf16 v[92:95], a[60:63], v[60:63], v[92:95]
    s_waitcnt lgkmcnt(4)
    v_mfma_f32_16x16x32_bf16 v[80:83], a[64:67], v[32:35], v[80:83]
    ds_read_b128 v[56:59], v15 offset:20480
    ds_read_b128 v[60:63], v15 offset:22528
    v_mfma_f32_16x16x32_bf16 v[84:87], a[68:71], v[32:35], v[84:87]
    v_mfma_f32_16x16x32_bf16 v[88:91], a[64:67], v[36:39], v[88:91]
    v_mfma_f32_16x16x32_bf16 v[92:95], a[68:71], v[36:39], v[92:95]
    s_waitcnt lgkmcnt(4)
    v_mfma_f32_16x16x32_bf16 v[80:83], a[72:75], v[40:43], v[80:83]
    ds_read_b128 v[32:35], v13 offset:24576
    ds_read_b128 v[36:39], v13 offset:26624
    v_mfma_f32_16x16x32_bf16 v[84:87], a[76:79], v[40:43], v[84:87]
    v_mfma_f32_16x16x32_bf16 v[88:91], a[72:75], v[44:47], v[88:91]
    v_mfma_f32_16x16x32_bf16 v[92:95], a[76:79], v[44:47], v[92:95]
    s_waitcnt lgkmcnt(4)
    v_mfma_f32_16x16x32_bf16 v[80:83], a[80:83], v[48:51], v[80:83]
    ds_read_b128 v[40:43], v15 offset:24576
    ds_read_b128 v[44:47], v15 offset:26624
    v_mfma_f32_16x16x32_bf16 v[84:87], a[84:87], v[48:51], v[84:87]
    v_mfma_f32_16x16x32_bf16 v[88:91], a[80:83], v[52:55], v[88:91]
    v_mfma_f32_16x16x32_bf16 v[92:95], a[84:87], v[52:55], v[92:95]
    s_waitcnt lgkmcnt(4)
    v_mfma_f32_16x16x32_bf16 v[80:83], a[88:91], v[56:59], v[80:83]
    ds_read_b128 v[48:51], v13 offset:28672
    ds_read_b128 v[52:55], v13 offset:30720
    v_mfma_f32_16x16x32_bf16 v[84:87], a[92:95], v[56:59], v[84:87]
    v_mfma_f32_16x16x32_bf16 v[88:91], a[88:91], v[60:63], v[88:91]
    v_mfma_f32_16x16x32_bf16 v[92:95], a[92:95], v[60:63], v[92:95]
    s_waitcnt lgkmcnt(4)
    v_mfma_f32_16x16x32_bf16 v[80:83], a[96:99], v[32:35], v[80:83]
    ds_read_b128 v[56:59], v15 offset:28672
    ds_read_b128 v[60:63], v15 offset:30720
    v_mfma_f32_16x16x32_bf16 v[84:87], a[100:103], v[32:35], v[84:87]
    v_mfma_f32_16x16x32_bf16 v[88:91], a[96:99], v[36:39], v[88:91]
    v_mfma_f32_16x16x32_bf16 v[92:95], a[100:103], v[36:39], v[92:95]
    s_waitcnt lgkmcnt(4)
    v_mfma_f32_16x16x32_bf16 v[80:83], a[104:107], v[40:43], v[80:83]
    v_mfma_f32_16x16x32_bf16 v[84:87], a[108:111], v[40:43], v[84:87]
    v_mfma_f32_16x16x32_bf16 v[88:91], a[104:107], v[44:47], v[88:91]
    v_mfma_f32_16x16x32_bf16 v[92:95], a[108:111], v[44:47], v[92:95]
    s_waitcnt vmcnt(0) lgkmcnt(0)
    s_barrier
    v_mfma_f32_16x16x32_bf16 v[80:83], a[112:115], v[48:51], v[80:83]
    ds_read_b128 v[32:35], v13 offset:32768
    ds_read_b128 v[36:39], v13 offset:34816
    v_mfma_f32_16x16x32_bf16 v[84:87], a[116:119], v[48:51], v[84:87]
    v_mfma_f32_16x16x32_bf16 v[88:91], a[112:115], v[52:55], v[88:91]
    v_mfma_f32_16x16x32_bf16 v[92:95], a[116:119], v[52:55], v[92:95]
    v_mfma_f32_16x16x32_bf16 v[80:83], a[120:123], v[56:59], v[80:83]
    ds_read_b128 v[40:43], v15 offset:32768
    ds_read_b128 v[44:47], v15 offset:34816
    v_mfma_f32_16x16x32_bf16 v[84:87], a[124:127], v[56:59], v[84:87]
    v_mfma_f32_16x16x32_bf16 v[88:91], a[120:123], v[60:63], v[88:91]
    v_mfma_f32_16x16x32_bf16 v[92:95], a[124:127], v[60:63], v[92:95]
    s_waitcnt lgkmcnt(2)
    v_mfma_f32_16x16x32_bf16 v[80:83], a[128:131], v[32:35], v[80:83]
    ds_read_b128 v[48:51], v13 offset:36864
    ds_read_b128 v[52:55], v13 offset:38912
    v_mfma_f32_16x16x32_bf16 v[84:87], a[132:135], v[32:35], v[84:87]
    ds_read_b128 v[56:59], v15 offset:36864
    ds_read_b128 v[60:63], v15 offset:38912
    v_mfma_f32_16x16x32_bf16 v[88:91], a[128:131], v[36:39], v[88:91]
    v_mfma_f32_16x16x32_bf16 v[92:95], a[132:135], v[36:39], v[92:95]
    s_waitcnt lgkmcnt(4)
    v_mfma_f32_16x16x32_bf16 v[80:83], a[136:139], v[40:43], v[80:83]
    ds_read_b128 v[32:35], v13 offset:40960
    ds_read_b128 v[36:39], v13 offset:43008
    v_mfma_f32_16x16x32_bf16 v[84:87], a[140:143], v[40:43], v[84:87]
    v_mfma_f32_16x16x32_bf16 v[88:91], a[136:139], v[44:47], v[88:91]
    v_mfma_f32_16x16x32_bf16 v[92:95], a[140:143], v[44:47], v[92:95]
    s_waitcnt lgkmcnt(4)
    v_mfma_f32_16x16x32_bf16 v[80:83], a[144:147], v[48:51], v[80:83]
    ds_read_b128 v[40:43], v15 offset:40960
    ds_read_b128 v[44:47], v15 offset:43008
    v_mfma_f32_16x16x32_bf16 v[84:87], a[148:151], v[48:51], v[84:87]
    v_mfma_f32_16x16x32_bf16 v[88:91], a[144:147], v[52:55], v[88:91]
    v_mfma_f32_16x16x32_bf16 v[92:95], a[148:151], v[52:55], v[92:95]
    s_waitcnt lgkmcnt(4)
    v_mfma_f32_16x16x32_bf16 v[80:83], a[152:155], v[56:59], v[80:83]
    ds_read_b128 v[48:51], v13 offset:45056
    ds_read_b128 v[52:55], v13 offset:47104
    v_mfma_f32_16x16x32_bf16 v[84:87], a[156:159], v[56:59], v[84:87]
    v_mfma_f32_16x16x32_bf16 v[88:91], a[152:155], v[60:63], v[88:91]
    v_mfma_f32_16x16x32_bf16 v[92:95], a[156:159], v[60:63], v[92:95]
    s_waitcnt lgkmcnt(4)
    v_mfma_f32_16x16x32_bf16 v[80:83], a[160:163], v[32:35], v[80:83]
    ds_read_b128 v[56:59], v15 offset:45056
    ds_read_b128 v[60:63], v15 offset:47104
    v_mfma_f32_16x16x32_bf16 v[84:87], a[164:167], v[32:35], v[84:87]
    v_mfma_f32_16x16x32_bf16 v[88:91], a[160:163], v[36:39], v[88:91]
    v_mfma_f32_16x16x32_bf16 v[92:95], a[164:167], v[36:39], v[92:95]
    s_waitcnt lgkmcnt(4)
    v_mfma_f32_16x16x32_bf16 v[80:83], a[168:171], v[40:43], v[80:83]
    ds_read_b128 v[32:35], v13 offset:49152
    ds_read_b128 v[36:39], v13 offset:51200
    v_mfma_f32_16x16x32_bf16 v[84:87], a[172:175], v[40:43], v[84:87]
    v_mfma_f32_16x16x32_bf16 v[88:91], a[168:171], v[44:47], v[88:91]
    v_mfma_f32_16x16x32_bf16 v[92:95], a[172:175], v[44:47], v[92:95]
    s_waitcnt lgkmcnt(4)
    v_mfma_f32_16x16x32_bf16 v[80:83], a[176:179], v[48:51], v[80:83]
    ds_read_b128 v[40:43], v15 offset:49152
    ds_read_b128 v[44:47], v15 offset:51200
    v_mfma_f32_16x16x32_bf16 v[84:87], a[180:183], v[48:51], v[84:87]
    v_mfma_f32_16x16x32_bf16 v[88:91], a[176:179], v[52:55], v[88:91]
    v_mfma_f32_16x16x32_bf16 v[92:95], a[180:183], v[52:55], v[92:95]
    s_waitcnt lgkmcnt(4)
    v_mfma_f32_16x16x32_bf16 v[80:83], a[184:187], v[56:59], v[80:83]
    ds_read_b128 v[48:51], v13 offset:53248
    ds_read_b128 v[52:55], v13 offset:55296
    v_mfma_f32_16x16x32_bf16 v[84:87], a[188:191], v[56:59], v[84:87]
    v_mfma_f32_16x16x32_bf16 v[88:91], a[184:187], v[60:63], v[88:91]
    v_mfma_f32_16x16x32_bf16 v[92:95], a[188:191], v[60:63], v[92:95]
    s_waitcnt lgkmcnt(4)
    v_mfma_f32_16x16x32_bf16 v[80:83], a[192:195], v[32:35], v[80:83]
    ds_read_b128 v[56:59], v15 offset:53248
    ds_read_b128 v[60:63], v15 offset:55296
    v_mfma_f32_16x16x32_bf16 v[84:87], a[196:199], v[32:35], v[84:87]
    v_mfma_f32_16x16x32_bf16 v[88:91], a[192:195], v[36:39], v[88:91]
    v_mfma_f32_16x16x32_bf16 v[92:95], a[196:199], v[36:39], v[92:95]
    s_waitcnt lgkmcnt(4)
    v_mfma_f32_16x16x32_bf16 v[80:83], a[200:203], v[40:43], v[80:83]
    ds_read_b128 v[32:35], v13 offset:57344
    ds_read_b128 v[36:39], v13 offset:59392
    v_mfma_f32_16x16x32_bf16 v[84:87], a[204:207], v[40:43], v[84:87]
    v_mfma_f32_16x16x32_bf16 v[88:91], a[200:203], v[44:47], v[88:91]
    v_mfma_f32_16x16x32_bf16 v[92:95], a[204:207], v[44:47], v[92:95]
    s_waitcnt lgkmcnt(4)
    v_mfma_f32_16x16x32_bf16 v[80:83], a[208:211], v[48:51], v[80:83]
    ds_read_b128 v[40:43], v15 offset:57344
    ds_read_b128 v[44:47], v15 offset:59392
    v_mfma_f32_16x16x32_bf16 v[84:87], a[212:215], v[48:51], v[84:87]
    v_mfma_f32_16x16x32_bf16 v[88:91], a[208:211], v[52:55], v[88:91]
    v_mfma_f32_16x16x32_bf16 v[92:95], a[212:215], v[52:55], v[92:95]
    s_waitcnt lgkmcnt(4)
    v_mfma_f32_16x16x32_bf16 v[80:83], a[216:219], v[56:59], v[80:83]
    ds_read_b128 v[48:51], v13 offset:61440
    ds_read_b128 v[52:55], v13 offset:63488
    v_mfma_f32_16x16x32_bf16 v[84:87], a[220:223], v[56:59], v[84:87]
    v_mfma_f32_16x16x32_bf16 v[88:91], a[216:219], v[60:63], v[88:91]
    v_mfma_f32_16x16x32_bf16 v[92:95], a[220:223], v[60:63], v[92:95]
    s_waitcnt lgkmcnt(4)
    v_mfma_f32_16x16x32_bf16 v[80:83], a[224:227], v[32:35], v[80:83]
    ds_read_b128 v[56:59], v15 offset:61440
    ds_read_b128 v[60:63], v15 offset:63488
    v_mfma_f32_16x16x32_bf16 v[84:87], a[228:231], v[32:35], v[84:87]
    v_mfma_f32_16x16x32_bf16 v[88:91], a[224:227], v[36:39], v[88:91]
    v_mfma_f32_16x16x32_bf16 v[92:95], a[228:231], v[36:39], v[92:95]
    s_waitcnt lgkmcnt(4)
    v_mfma_f32_16x16x32_bf16 v[80:83], a[232:235], v[40:43], v[80:83]
    v_mfma_f32_16x16x32_bf16 v[84:87], a[236:239], v[40:43], v[84:87]
    v_mfma_f32_16x16x32_bf16 v[88:91], a[232:235], v[44:47], v[88:91]
    v_mfma_f32_16x16x32_bf16 v[92:95], a[236:239], v[44:47], v[92:95]
    s_waitcnt lgkmcnt(0)
    v_mfma_f32_16x16x32_bf16 v[80:83], a[240:243], v[48:51], v[80:83]
    v_mfma_f32_16x16x32_bf16 v[84:87], a[244:247], v[48:51], v[84:87]
    v_mfma_f32_16x16x32_bf16 v[88:91], a[240:243], v[52:55], v[88:91]
    v_mfma_f32_16x16x32_bf16 v[92:95], a[244:247], v[52:55], v[92:95]
    v_mfma_f32_16x16x32_bf16 v[80:83], a[248:251], v[56:59], v[80:83]
    v_mfma_f32_16x16x32_bf16 v[84:87], a[252:255], v[56:59], v[84:87]
    v_mfma_f32_16x16x32_bf16 v[88:91], a[248:251], v[60:63], v[88:91]
    v_mfma_f32_16x16x32_bf16 v[92:95], a[252:255], v[60:63], v[92:95]
    s_mov_b32 s76, s57
    s_nop 6
    v_pk_add_f32 v[224:225], v[80:81], v[96:97]
    v_pk_add_f32 v[226:227], v[82:83], v[98:99]
    v_pk_add_f32 v[228:229], v[84:85], v[100:101]
    v_pk_add_f32 v[230:231], v[86:87], v[102:103]
    v_pk_add_f32 v[232:233], v[88:89], v[96:97]
    v_pk_add_f32 v[234:235], v[90:91], v[98:99]
    v_pk_add_f32 v[236:237], v[92:93], v[100:101]
    v_pk_add_f32 v[238:239], v[94:95], v[102:103]
L_e_fin_160:
    v_pk_mul_f32 v[240:241], v[224:225], v[224:225]
    v_pk_mul_f32 v[242:243], v[226:227], v[226:227]
    v_pk_mul_f32 v[244:245], v[228:229], v[228:229]
    v_pk_mul_f32 v[246:247], v[230:231], v[230:231]
    v_pk_mul_f32 v[248:249], v[232:233], v[232:233]
    v_pk_mul_f32 v[250:251], v[234:235], v[234:235]
    v_pk_mul_f32 v[252:253], v[236:237], v[236:237]
    v_pk_mul_f32 v[254:255], v[238:239], v[238:239]
    v_pk_fma_f32 v[240:241], v[240:241], v[104:105], v[106:107]
    v_pk_fma_f32 v[242:243], v[242:243], v[104:105], v[106:107]
    v_pk_fma_f32 v[244:245], v[244:245], v[104:105], v[106:107]
    v_pk_fma_f32 v[246:247], v[246:247], v[104:105], v[106:107]
    v_pk_fma_f32 v[248:249], v[248:249], v[104:105], v[106:107]
    v_pk_fma_f32 v[250:251], v[250:251], v[104:105], v[106:107]
    v_pk_fma_f32 v[252:253], v[252:253], v[104:105], v[106:107]
    v_pk_fma_f32 v[254:255], v[254:255], v[104:105], v[106:107]
    v_pk_mul_f32 v[240:241], v[240:241], v[224:225]
    v_pk_mul_f32 v[242:243], v[242:243], v[226:227]
    v_pk_mul_f32 v[244:245], v[244:245], v[228:229]
    v_pk_mul_f32 v[246:247], v[246:247], v[230:231]
    v_pk_mul_f32 v[248:249], v[248:249], v[232:233]
    v_pk_mul_f32 v[250:251], v[250:251], v[234:235]
    v_pk_mul_f32 v[252:253], v[252:253], v[236:237]
    v_pk_mul_f32 v[254:255], v[254:255], v[238:239]
    v_exp_f32 v240, v240
    v_exp_f32 v241, v241
    v_exp_f32 v242, v242
    v_exp_f32 v243, v243
    v_exp_f32 v244, v244
    v_exp_f32 v245, v245
    v_exp_f32 v246, v246
    v_exp_f32 v247, v247
    v_exp_f32 v248, v248
    v_exp_f32 v249, v249
    v_exp_f32 v250, v250
    v_exp_f32 v251, v251
    v_exp_f32 v252, v252
    v_exp_f32 v253, v253
    v_exp_f32 v254, v254
    v_exp_f32 v255, v255
    v_add_f32 v240, 1.0, v240
    v_add_f32 v241, 1.0, v241
    v_add_f32 v242, 1.0, v242
    v_add_f32 v243, 1.0, v243
    v_add_f32 v244, 1.0, v244
    v_add_f32 v245, 1.0, v245
    v_add_f32 v246, 1.0, v246
    v_add_f32 v247, 1.0, v247
    v_add_f32 v248, 1.0, v248
    v_add_f32 v249, 1.0, v249
    v_add_f32 v250, 1.0, v250
    v_add_f32 v251, 1.0, v251
    v_add_f32 v252, 1.0, v252
    v_add_f32 v253, 1.0, v253
    v_add_f32 v254, 1.0, v254
    v_add_f32 v255, 1.0, v255
    v_rcp_f32 v240, v240
    v_rcp_f32 v241, v241
    v_rcp_f32 v242, v242
    v_rcp_f32 v243, v243
    v_rcp_f32 v244, v244
    v_rcp_f32 v245, v245
    v_rcp_f32 v246, v246
    v_rcp_f32 v247, v247
    v_rcp_f32 v248, v248
    v_rcp_f32 v249, v249
    v_rcp_f32 v250, v250
    v_rcp_f32 v251, v251
    v_rcp_f32 v252, v252
    v_rcp_f32 v253, v253
    v_rcp_f32 v254, v254
    v_rcp_f32 v255, v255
    v_pk_mul_f32 v[224:225], v[224:225], v[240:241]
    v_pk_mul_f32 v[226:227], v[226:227], v[242:243]
    v_pk_mul_f32 v[228:229], v[228:229], v[244:245]
    v_pk_mul_f32 v[230:231], v[230:231], v[246:247]
    v_pk_mul_f32 v[232:233], v[232:233], v[248:249]
    v_pk_mul_f32 v[234:235], v[234:235], v[250:251]
    v_pk_mul_f32 v[236:237], v[236:237], v[252:253]
    v_pk_mul_f32 v[238:239], v[238:239], v[254:255]
    v_cvt_pk_bf16_f32 v240, v224, v225
    v_cvt_pk_bf16_f32 v241, v226, v227
    v_cvt_pk_bf16_f32 v242, v228, v229
    v_cvt_pk_bf16_f32 v243, v230, v231
    v_cvt_pk_bf16_f32 v244, v232, v233
    v_cvt_pk_bf16_f32 v245, v234, v235
    v_cvt_pk_bf16_f32 v246, v236, v237
    v_cvt_pk_bf16_f32 v247, v238, v239
    buffer_store_dwordx4 v[240:243], v10, s[12:15], s76 offen sc1
    buffer_store_dwordx4 v[244:247], v10, s[12:15], s76 offen offset:1024 sc1
    s_waitcnt lgkmcnt(0)
    s_waitcnt vmcnt(0)
    s_barrier
    s_cmp_lg_u32 s44, 0
    s_cbranch_scc1 L_pub_161
    v_mov_b32 v30, s62
    v_mov_b32 v31, 0
    s_mov_b64 exec, 1
    buffer_store_dword v30, v31, s[12:15], s67 offen sc1
    s_mov_b64 exec, -1
L_pub_161:
    s_branch L_b_loop_147
L_role_c_126:
    s_load_dwordx2 s[6:7], s[0:1], 80
    s_load_dwordx2 s[8:9], s[0:1], 88
    s_load_dwordx2 s[10:11], s[0:1], 112
    s_waitcnt lgkmcnt(0)
    s_mov_b32 s24, s6
    s_and_b32 s25, s7, 0xffff
    s_mov_b32 s26, 0x700000
    s_mov_b32 s27, 0x00020000
    s_mov_b32 s28, s8
    s_and_b32 s29, s9, 0xffff
    s_mov_b32 s30, 0x800
    s_mov_b32 s31, 0x00020000
    s_mov_b32 s32, s10
    s_and_b32 s33, s11, 0xffff
    s_mov_b32 s34, 0x400000
    s_mov_b32 s35, 0x00020000
    s_mul_i32 s46, s38, 1835008
    s_lshl_b32 s45, s68, 8
    s_add_u32 s46, s46, s45
    s_waitcnt vmcnt(0)
    s_barrier
    v_lshrrev_b32 v20, 4, v1
    s_lshl_b32 s45, s44, 2
    v_add_u32 v21, s45, v20
    s_mov_b32 s45, 2048
    v_mul_lo_u32 v21, v21, s45
    v_lshlrev_b32 v22, 2, v20
    v_and_b32 v23, 15, v1
    v_xor_b32 v22, v22, v23
    v_lshlrev_b32 v22, 4, v22
    v_add_u32 v21, v21, v22
    v_bfe_u32 v22, v1, 2, 2
    v_lshlrev_b32 v23, 3, v20
    v_add_u32 v23, v23, v22
    v_lshlrev_b32 v23, 8, v23
    v_xor_b32 v22, s44, v22
    v_lshlrev_b32 v22, 6, v22
    v_add_u32 v23, v23, v22
    v_and_b32 v22, 3, v1
    v_lshlrev_b32 v22, 3, v22
    v_add_u32 v23, v23, v22
    v_add_u32 v24, 65536, v23
    v_add_u32 v25, 131072, v23
    s_lshl_b32 s47, s44, 10
    s_add_u32 s45, s46, 0x0
    s_add_u32 m0, s47, 0
    s_nop 0
    buffer_load_dwordx4 v21, s[24:27], s45 offen  lds
    s_add_u32 s45, s46, 0x8000
    s_add_u32 m0, s47, 4096
    s_nop 0
    buffer_load_dwordx4 v21, s[24:27], s45 offen  lds
    s_add_u32 s45, s46, 0x10000
    s_add_u32 m0, s47, 8192
    s_nop 0
    buffer_load_dwordx4 v21, s[24:27], s45 offen  lds
    s_add_u32 s45, s46, 0x18000
    s_add_u32 m0, s47, 12288
    s_nop 0
    buffer_load_dwordx4 v21, s[24:27], s45 offen  lds
    s_add_u32 s45, s46, 0x20000
    s_add_u32 m0, s47, 16384
    s_nop 0
    buffer_load_dwordx4 v21, s[24:27], s45 offen  lds
    s_add_u32 s45, s46, 0x28000
    s_add_u32 m0, s47, 20480
    s_nop 0
    buffer_load_dwordx4 v21, s[24:27], s45 offen  lds
    s_add_u32 s45, s46, 0x30000
    s_add_u32 m0, s47, 24576
    s_nop 0
    buffer_load_dwordx4 v21, s[24:27], s45 offen  lds
    s_add_u32 s45, s46, 0x38000
    s_add_u32 m0, s47, 28672
    s_nop 0
    buffer_load_dwordx4 v21, s[24:27], s45 offen  lds
    s_add_u32 s45, s46, 0x40000
    s_add_u32 m0, s47, 32768
    s_nop 0
    buffer_load_dwordx4 v21, s[24:27], s45 offen  lds
    s_add_u32 s45, s46, 0x48000
    s_add_u32 m0, s47, 36864
    s_nop 0
    buffer_load_dwordx4 v21, s[24:27], s45 offen  lds
    s_add_u32 s45, s46, 0x50000
    s_add_u32 m0, s47, 40960
    s_nop 0
    buffer_load_dwordx4 v21, s[24:27], s45 offen  lds
    s_add_u32 s45, s46, 0x58000
    s_add_u32 m0, s47, 45056
    s_nop 0
    buffer_load_dwordx4 v21, s[24:27], s45 offen  lds
    s_add_u32 s45, s46, 0x60000
    s_add_u32 m0, s47, 49152
    s_nop 0
    buffer_load_dwordx4 v21, s[24:27], s45 offen  lds
    s_add_u32 s45, s46, 0x68000
    s_add_u32 m0, s47, 53248
    s_nop 0
    buffer_load_dwordx4 v21, s[24:27], s45 offen  lds
    s_add_u32 s45, s46, 0x70000
    s_add_u32 m0, s47, 57344
    s_nop 0
    buffer_load_dwordx4 v21, s[24:27], s45 offen  lds
    s_add_u32 s45, s46, 0x78000
    s_add_u32 m0, s47, 61440
    s_nop 0
    buffer_load_dwordx4 v21, s[24:27], s45 offen  lds
    s_add_u32 s45, s46, 0x80000
    s_add_u32 m0, s47, 65536
    s_nop 0
    buffer_load_dwordx4 v21, s[24:27], s45 offen  lds
    s_add_u32 s45, s46, 0x88000
    s_add_u32 m0, s47, 69632
    s_nop 0
    buffer_load_dwordx4 v21, s[24:27], s45 offen  lds
    s_add_u32 s45, s46, 0x90000
    s_add_u32 m0, s47, 73728
    s_nop 0
    buffer_load_dwordx4 v21, s[24:27], s45 offen  lds
    s_add_u32 s45, s46, 0x98000
    s_add_u32 m0, s47, 77824
    s_nop 0
    buffer_load_dwordx4 v21, s[24:27], s45 offen  lds
    s_add_u32 s45, s46, 0xa0000
    s_add_u32 m0, s47, 81920
    s_nop 0
    buffer_load_dwordx4 v21, s[24:27], s45 offen  lds
    s_add_u32 s45, s46, 0xa8000
    s_add_u32 m0, s47, 86016
    s_nop 0
    buffer_load_dwordx4 v21, s[24:27], s45 offen  lds
    s_add_u32 s45, s46, 0xb0000
    s_add_u32 m0, s47, 90112
    s_nop 0
    buffer_load_dwordx4 v21, s[24:27], s45 offen  lds
    s_add_u32 s45, s46, 0xb8000
    s_add_u32 m0, s47, 94208
    s_nop 0
    buffer_load_dwordx4 v21, s[24:27], s45 offen  lds
    s_add_u32 s45, s46, 0xc0000
    s_add_u32 m0, s47, 98304
    s_nop 0
    buffer_load_dwordx4 v21, s[24:27], s45 offen  lds
    s_add_u32 s45, s46, 0xc8000
    s_add_u32 m0, s47, 102400
    s_nop 0
    buffer_load_dwordx4 v21, s[24:27], s45 offen  lds
    s_add_u32 s45, s46, 0xd0000
    s_add_u32 m0, s47, 106496
    s_nop 0
    buffer_load_dwordx4 v21, s[24:27], s45 offen  lds
    s_add_u32 s45, s46, 0xd8000
    s_add_u32 m0, s47, 110592
    s_nop 0
    buffer_load_dwordx4 v21, s[24:27], s45 offen  lds
    s_add_u32 s45, s46, 0xe0000
    s_add_u32 m0, s47, 114688
    s_nop 0
    buffer_load_dwordx4 v21, s[24:27], s45 offen  lds
    s_add_u32 s45, s46, 0xe8000
    s_add_u32 m0, s47, 118784
    s_nop 0
    buffer_load_dwordx4 v21, s[24:27], s45 offen  lds
    s_add_u32 s45, s46, 0xf0000
    s_add_u32 m0, s47, 122880
    s_nop 0
    buffer_load_dwordx4 v21, s[24:27], s45 offen  lds
    s_add_u32 s45, s46, 0xf8000
    s_add_u32 m0, s47, 126976
    s_nop 0
    buffer_load_dwordx4 v21, s[24:27], s45 offen  lds
    s_waitcnt vmcnt(28)
    s_barrier
    s_add_u32 s45, s46, 0x100000
    s_add_u32 m0, s47, 131072
    s_nop 0
    buffer_load_dwordx4 v21, s[24:27], s45 offen  lds
    s_add_u32 s45, s46, 0x108000
    s_add_u32 m0, s47, 135168
    s_nop 0
    buffer_load_dwordx4 v21, s[24:27], s45 offen  lds
    s_add_u32 s45, s46, 0x110000
    s_add_u32 m0, s47, 139264
    s_nop 0
    buffer_load_dwordx4 v21, s[24:27], s45 offen  lds
    s_add_u32 s45, s46, 0x118000
    s_add_u32 m0, s47, 143360
    s_nop 0
    buffer_load_dwordx4 v21, s[24:27], s45 offen  lds
    ds_read_b64_tr_b16 a[0:1], v23 offset:0
    ds_read_b64_tr_b16 a[2:3], v23 offset:1024
    ds_read_b64_tr_b16 a[4:5], v23 offset:32
    ds_read_b64_tr_b16 a[6:7], v23 offset:1056
    ds_read_b64_tr_b16 a[8:9], v23 offset:8192
    ds_read_b64_tr_b16 a[10:11], v23 offset:9216
    ds_read_b64_tr_b16 a[12:13], v23 offset:8224
    ds_read_b64_tr_b16 a[14:15], v23 offset:9248
    s_waitcnt lgkmcnt(0)
    s_waitcnt vmcnt(28)
    s_barrier
    s_add_u32 s45, s46, 0x120000
    s_add_u32 m0, s47, 0
    s_nop 0
    buffer_load_dwordx4 v21, s[24:27], s45 offen  lds
    s_add_u32 s45, s46, 0x128000
    s_add_u32 m0, s47, 4096
    s_nop 0
    buffer_load_dwordx4 v21, s[24:27], s45 offen  lds
    s_add_u32 s45, s46, 0x130000
    s_add_u32 m0, s47, 8192
    s_nop 0
    buffer_load_dwordx4 v21, s[24:27], s45 offen  lds
    s_add_u32 s45, s46, 0x138000
    s_add_u32 m0, s47, 12288
    s_nop 0
    buffer_load_dwordx4 v21, s[24:27], s45 offen  lds
    ds_read_b64_tr_b16 a[16:17], v23 offset:16384
    ds_read_b64_tr_b16 a[18:19], v23 offset:17408
    ds_read_b64_tr_b16 a[20:21], v23 offset:16416
    ds_read_b64_tr_b16 a[22:23], v23 offset:17440
    ds_read_b64_tr_b16 a[24:25], v23 offset:24576
    ds_read_b64_tr_b16 a[26:27], v23 offset:25600
    ds_read_b64_tr_b16 a[28:29], v23 offset:24608
    ds_read_b64_tr_b16 a[30:31], v23 offset:25632
    s_waitcnt lgkmcnt(0)
    s_waitcnt vmcnt(28)
    s_barrier
    s_add_u32 s45, s46, 0x140000
    s_add_u32 m0, s47, 16384
    s_nop 0
    buffer_load_dwordx4 v21, s[24:27], s45 offen  lds
    s_add_u32 s45, s46, 0x148000
    s_add_u32 m0, s47, 20480
    s_nop 0
    buffer_load_dwordx4 v21, s[24:27], s45 offen  lds
    s_add_u32 s45, s46, 0x150000
    s_add_u32 m0, s47, 24576
    s_nop 0
    buffer_load_dwordx4 v21, s[24:27], s45 offen  lds
    s_add_u32 s45, s46, 0x158000
    s_add_u32 m0, s47, 28672
    s_nop 0
    buffer_load_dwordx4 v21, s[24:27], s45 offen  lds
    ds_read_b64_tr_b16 a[32:33], v23 offset:32768
    ds_read_b64_tr_b16 a[34:35], v23 offset:33792
    ds_read_b64_tr_b16 a[36:37], v23 offset:32800
    ds_read_b64_tr_b16 a[38:39], v23 offset:33824
    ds_read_b64_tr_b16 a[40:41], v23 offset:40960
    ds_read_b64_tr_b16 a[42:43], v23 offset:41984
    ds_read_b64_tr_b16 a[44:45], v23 offset:40992
    ds_read_b64_tr_b16 a[46:47], v23 offset:42016
    s_waitcnt lgkmcnt(0)
    s_waitcnt vmcnt(28)
    s_barrier
    s_add_u32 s45, s46, 0x160000
    s_add_u32 m0, s47, 32768
    s_nop 0
    buffer_load_dwordx4 v21, s[24:27], s45 offen  lds
    s_add_u32 s45, s46, 0x168000
    s_add_u32 m0, s47, 36864
    s_nop 0
    buffer_load_dwordx4 v21, s[24:27], s45 offen  lds
    s_add_u32 s45, s46, 0x170000
    s_add_u32 m0, s47, 40960
    s_nop 0
    buffer_load_dwordx4 v21, s[24:27], s45 offen  lds
    s_add_u32 s45, s46, 0x178000
    s_add_u32 m0, s47, 45056
    s_nop 0
    buffer_load_dwordx4 v21, s[24:27], s45 offen  lds
    ds_read_b64_tr_b16 a[48:49], v23 offset:49152
    ds_read_b64_tr_b16 a[50:51], v23 offset:50176
    ds_read_b64_tr_b16 a[52:53], v23 offset:49184
    ds_read_b64_tr_b16 a[54:55], v23 offset:50208
    ds_read_b64_tr_b16 a[56:57], v23 offset:57344
    ds_read_b64_tr_b16 a[58:59], v23 offset:58368
    ds_read_b64_tr_b16 a[60:61], v23 offset:57376
    ds_read_b64_tr_b16 a[62:63], v23 offset:58400
    s_waitcnt lgkmcnt(0)
    s_waitcnt vmcnt(28)
    s_barrier
    s_add_u32 s45, s46, 0x180000
    s_add_u32 m0, s47, 49152
    s_nop 0
    buffer_load_dwordx4 v21, s[24:27], s45 offen  lds
    s_add_u32 s45, s46, 0x188000
    s_add_u32 m0, s47, 53248
    s_nop 0
    buffer_load_dwordx4 v21, s[24:27], s45 offen  lds
    s_add_u32 s45, s46, 0x190000
    s_add_u32 m0, s47, 57344
    s_nop 0
    buffer_load_dwordx4 v21, s[24:27], s45 offen  lds
    s_add_u32 s45, s46, 0x198000
    s_add_u32 m0, s47, 61440
    s_nop 0
    buffer_load_dwordx4 v21, s[24:27], s45 offen  lds
    ds_read_b64_tr_b16 a[64:65], v24 offset:0
    ds_read_b64_tr_b16 a[66:67], v24 offset:1024
    ds_read_b64_tr_b16 a[68:69], v24 offset:32
    ds_read_b64_tr_b16 a[70:71], v24 offset:1056
    ds_read_b64_tr_b16 a[72:73], v24 offset:8192
    ds_read_b64_tr_b16 a[74:75], v24 offset:9216
    ds_read_b64_tr_b16 a[76:77], v24 offset:8224
    ds_read_b64_tr_b16 a[78:79], v24 offset:9248
    s_waitcnt lgkmcnt(0)
    s_waitcnt vmcnt(28)
    s_barrier
    s_add_u32 s45, s46, 0x1a0000
    s_add_u32 m0, s47, 65536
    s_nop 0
    buffer_load_dwordx4 v21, s[24:27], s45 offen  lds
    s_add_u32 s45, s46, 0x1a8000
    s_add_u32 m0, s47, 69632
    s_nop 0
    buffer_load_dwordx4 v21, s[24:27], s45 offen  lds
    s_add_u32 s45, s46, 0x1b0000
    s_add_u32 m0, s47, 73728
    s_nop 0
    buffer_load_dwordx4 v21, s[24:27], s45 offen  lds
    s_add_u32 s45, s46, 0x1b8000
    s_add_u32 m0, s47, 77824
    s_nop 0
    buffer_load_dwordx4 v21, s[24:27], s45 offen  lds
    ds_read_b64_tr_b16 a[80:81], v24 offset:16384
    ds_read_b64_tr_b16 a[82:83], v24 offset:17408
    ds_read_b64_tr_b16 a[84:85], v24 offset:16416
    ds_read_b64_tr_b16 a[86:87], v24 offset:17440
    ds_read_b64_tr_b16 a[88:89], v24 offset:24576
    ds_read_b64_tr_b16 a[90:91], v24 offset:25600
    ds_read_b64_tr_b16 a[92:93], v24 offset:24608
    ds_read_b64_tr_b16 a[94:95], v24 offset:25632
    s_waitcnt lgkmcnt(0)
    s_waitcnt vmcnt(28)
    s_barrier
    ds_read_b64_tr_b16 a[96:97], v24 offset:32768
    ds_read_b64_tr_b16 a[98:99], v24 offset:33792
    ds_read_b64_tr_b16 a[100:101], v24 offset:32800
    ds_read_b64_tr_b16 a[102:103], v24 offset:33824
    ds_read_b64_tr_b16 a[104:105], v24 offset:40960
    ds_read_b64_tr_b16 a[106:107], v24 offset:41984
    ds_read_b64_tr_b16 a[108:109], v24 offset:40992
    ds_read_b64_tr_b16 a[110:111], v24 offset:42016
    s_waitcnt lgkmcnt(0)
    s_waitcnt vmcnt(24)
    s_barrier
    ds_read_b64_tr_b16 a[112:113], v24 offset:49152
    ds_read_b64_tr_b16 a[114:115], v24 offset:50176
    ds_read_b64_tr_b16 a[116:117], v24 offset:49184
    ds_read_b64_tr_b16 a[118:119], v24 offset:50208
    ds_read_b64_tr_b16 a[120:121], v24 offset:57344
    ds_read_b64_tr_b16 a[122:123], v24 offset:58368
    ds_read_b64_tr_b16 a[124:125], v24 offset:57376
    ds_read_b64_tr_b16 a[126:127], v24 offset:58400
    s_waitcnt lgkmcnt(0)
    s_waitcnt vmcnt(20)
    s_barrier
    ds_read_b64_tr_b16 a[128:129], v25 offset:0
    ds_read_b64_tr_b16 a[130:131], v25 offset:1024
    ds_read_b64_tr_b16 a[132:133], v25 offset:32
    ds_read_b64_tr_b16 a[134:135], v25 offset:1056
    ds_read_b64_tr_b16 a[136:137], v25 offset:8192
    ds_read_b64_tr_b16 a[138:139], v25 offset:9216
    ds_read_b64_tr_b16 a[140:141], v25 offset:8224
    ds_read_b64_tr_b16 a[142:143], v25 offset:9248
    s_waitcnt lgkmcnt(0)
    s_waitcnt vmcnt(16)
    s_barrier
    ds_read_b64_tr_b16 a[144:145], v23 offset:0
    ds_read_b64_tr_b16 a[146:147], v23 offset:1024
    ds_read_b64_tr_b16 a[148:149], v23 offset:32
    ds_read_b64_tr_b16 a[150:151], v23 offset:1056
    ds_read_b64_tr_b16 a[152:153], v23 offset:8192
    ds_read_b64_tr_b16 a[154:155], v23 offset:9216
    ds_read_b64_tr_b16 a[156:157], v23 offset:8224
    ds_read_b64_tr_b16 a[158:159], v23 offset:9248
    s_waitcnt lgkmcnt(0)
    s_waitcnt vmcnt(12)
    s_barrier
    ds_read_b64_tr_b16 a[160:161], v23 offset:16384
    ds_read_b64_tr_b16 a[162:163], v23 offset:17408
    ds_read_b64_tr_b16 a[164:165], v23 offset:16416
    ds_read_b64_tr_b16 a[166:167], v23 offset:17440
    ds_read_b64_tr_b16 a[168:169], v23 offset:24576
    ds_read_b64_tr_b16 a[170:171], v23 offset:25600
    ds_read_b64_tr_b16 a[172:173], v23 offset:24608
    ds_read_b64_tr_b16 a[174:175], v23 offset:25632
    s_waitcnt lgkmcnt(0)
    s_waitcnt vmcnt(8)
    s_barrier
    ds_read_b64_tr_b16 a[176:177], v23 offset:32768
    ds_read_b64_tr_b16 a[178:179], v23 offset:33792
    ds_read_b64_tr_b16 a[180:181], v23 offset:32800
    ds_read_b64_tr_b16 a[182:183], v23 offset:33824
    ds_read_b64_tr_b16 a[184:185], v23 offset:40960
    ds_read_b64_tr_b16 a[186:187], v23 offset:41984
    ds_read_b64_tr_b16 a[188:189], v23 offset:40992
    ds_read_b64_tr_b16 a[190:191], v23 offset:42016
    s_waitcnt lgkmcnt(0)
    s_waitcnt vmcnt(4)
    s_barrier
    ds_read_b64_tr_b16 a[192:193], v23 offset:49152
    ds_read_b64_tr_b16 a[194:195], v23 offset:50176
    ds_read_b64_tr_b16 a[196:197], v23 offset:49184
    ds_read_b64_tr_b16 a[198:199], v23 offset:50208
    ds_read_b64_tr_b16 a[200:201], v23 offset:57344
    ds_read_b64_tr_b16 a[202:203], v23 offset:58368
    ds_read_b64_tr_b16 a[204:205], v23 offset:57376
    ds_read_b64_tr_b16 a[206:207], v23 offset:58400
    s_waitcnt lgkmcnt(0)
    s_waitcnt vmcnt(0)
    s_barrier
    ds_read_b64_tr_b16 a[208:209], v24 offset:0
    ds_read_b64_tr_b16 a[210:211], v24 offset:1024
    ds_read_b64_tr_b16 a[212:213], v24 offset:32
    ds_read_b64_tr_b16 a[214:215], v24 offset:1056
    ds_read_b64_tr_b16 a[216:217], v24 offset:8192
    ds_read_b64_tr_b16 a[218:219], v24 offset:9216
    ds_read_b64_tr_b16 a[220:221], v24 offset:8224
    ds_read_b64_tr_b16 a[222:223], v24 offset:9248
    s_waitcnt lgkmcnt(0)
    s_barrier
    buffer_load_dwordx4 v[80:83], v10, s[28:31], 0 offen
    buffer_load_dwordx4 v[84:87], v10, s[28:31], 0 offen offset:1024
    s_waitcnt vmcnt(0)
    v_lshlrev_b32 v96, 16, v80
    v_and_b32 v97, 0xffff0000, v80
    v_lshlrev_b32 v98, 16, v81
    v_and_b32 v99, 0xffff0000, v81
    v_lshlrev_b32 v100, 16, v82
    v_and_b32 v101, 0xffff0000, v82
    v_lshlrev_b32 v102, 16, v83
    v_and_b32 v103, 0xffff0000, v83
    v_lshlrev_b32 v104, 16, v84
    v_and_b32 v105, 0xffff0000, v84
    v_lshlrev_b32 v106, 16, v85
    v_and_b32 v107, 0xffff0000, v85
    v_lshlrev_b32 v108, 16, v86
    v_and_b32 v109, 0xffff0000, v86
    v_lshlrev_b32 v110, 16, v87
    v_and_b32 v111, 0xffff0000, v87
    s_cmp_lg_u32 s44, 0
    s_cbranch_scc1 L_pd_162
    v_mov_b32 v29, 127232
    s_mov_b32 s46, 96
    s_mov_b64 exec, 1
    s_mov_b32 s70, 0
L_wp_163:
    buffer_load_dword v31, v29, s[12:15], 0 offen sc1
    s_add_u32 s70, s70, 1
    s_cmp_ge_u32 s70, 0x200000
    s_cbranch_scc1 L_w_done_98
    s_waitcnt vmcnt(0)
    v_cmp_gt_u32 vcc, s46, v31
    s_nop 1
    s_cbranch_vccz L_wp_163_ok
    s_sleep 3
    s_branch L_wp_163
L_wp_163_ok:
    s_mov_b64 exec, -1
L_pd_162:
    s_barrier
    v_lshlrev_b32 v29, 5, v1
    s_mov_b32 s45, 20480
    buffer_load_dwordx4 v[112:115], v29, s[12:15], s45 offen offset:0 sc1
    buffer_load_dwordx4 v[116:119], v29, s[12:15], s45 offen offset:16 sc1
    buffer_load_dwordx4 v[120:123], v29, s[12:15], s45 offen offset:2048 sc1
    buffer_load_dwordx4 v[124:127], v29, s[12:15], s45 offen offset:2064 sc1
    s_mov_b32 s45, 45056
    buffer_load_dwordx4 v[32:35], v29, s[12:15], s45 offen offset:0 sc1
    buffer_load_dwordx4 v[36:39], v29, s[12:15], s45 offen offset:16 sc1
    buffer_load_dwordx4 v[40:43], v29, s[12:15], s45 offen offset:2048 sc1
    buffer_load_dwordx4 v[44:47], v29, s[12:15], s45 offen offset:2064 sc1
    s_waitcnt vmcnt(0)
    v_add_f32 v112, v112, v32
    v_cvt_pk_bf16_f32 v112, v112, v112
    v_lshlrev_b32 v112, 16, v112
    v_add_f32 v113, v113, v33
    v_cvt_pk_bf16_f32 v113, v113, v113
    v_lshlrev_b32 v113, 16, v113
    v_add_f32 v114, v114, v34
    v_cvt_pk_bf16_f32 v114, v114, v114
    v_lshlrev_b32 v114, 16, v114
    v_add_f32 v115, v115, v35
    v_cvt_pk_bf16_f32 v115, v115, v115
    v_lshlrev_b32 v115, 16, v115
    v_add_f32 v116, v116, v36
    v_cvt_pk_bf16_f32 v116, v116, v116
    v_lshlrev_b32 v116, 16, v116
    v_add_f32 v117, v117, v37
    v_cvt_pk_bf16_f32 v117, v117, v117
    v_lshlrev_b32 v117, 16, v117
    v_add_f32 v118, v118, v38
    v_cvt_pk_bf16_f32 v118, v118, v118
    v_lshlrev_b32 v118, 16, v118
    v_add_f32 v119, v119, v39
    v_cvt_pk_bf16_f32 v119, v119, v119
    v_lshlrev_b32 v119, 16, v119
    v_add_f32 v120, v120, v40
    v_cvt_pk_bf16_f32 v120, v120, v120
    v_lshlrev_b32 v120, 16, v120
    v_add_f32 v121, v121, v41
    v_cvt_pk_bf16_f32 v121, v121, v121
    v_lshlrev_b32 v121, 16, v121
    v_add_f32 v122, v122, v42
    v_cvt_pk_bf16_f32 v122, v122, v122
    v_lshlrev_b32 v122, 16, v122
    v_add_f32 v123, v123, v43
    v_cvt_pk_bf16_f32 v123, v123, v123
    v_lshlrev_b32 v123, 16, v123
    v_add_f32 v124, v124, v44
    v_cvt_pk_bf16_f32 v124, v124, v124
    v_lshlrev_b32 v124, 16, v124
    v_add_f32 v125, v125, v45
    v_cvt_pk_bf16_f32 v125, v125, v125
    v_lshlrev_b32 v125, 16, v125
    v_add_f32 v126, v126, v46
    v_cvt_pk_bf16_f32 v126, v126, v126
    v_lshlrev_b32 v126, 16, v126
    v_add_f32 v127, v127, v47
    v_cvt_pk_bf16_f32 v127, v127, v127
    v_lshlrev_b32 v127, 16, v127
    s_lshl_b32 s46, s44, 10
    s_add_u32 s45, s46, 20480
    buffer_load_dwordx4 v[22:25], v10, s[12:15], s45 offen sc1
    s_add_u32 s45, s46, 45056
    buffer_load_dwordx4 v[32:35], v10, s[12:15], s45 offen sc1
    s_waitcnt vmcnt(0)
    v_add_f32 v22, v22, v32
    v_cvt_pk_bf16_f32 v22, v22, v22
    v_lshlrev_b32 v22, 16, v22
    v_add_f32 v23, v23, v33
    v_cvt_pk_bf16_f32 v23, v23, v23
    v_lshlrev_b32 v23, 16, v23
    v_add_f32 v24, v24, v34
    v_cvt_pk_bf16_f32 v24, v24, v24
    v_lshlrev_b32 v24, 16, v24
    v_add_f32 v25, v25, v35
    v_cvt_pk_bf16_f32 v25, v25, v25
    v_lshlrev_b32 v25, 16, v25
    v_lshlrev_b32 v17, 3, v1
    s_lshl_b32 s45, s44, 9
    buffer_load_dwordx2 v[80:81], v17, s[28:31], s45 offen
    s_waitcnt vmcnt(0)
    v_lshlrev_b32 v18, 16, v80
    v_and_b32 v19, 0xffff0000, v80
    v_lshlrev_b32 v20, 16, v81
    v_and_b32 v21, 0xffff0000, v81
    s_mul_i32 s52, s38, 57344
    s_add_u32 s52, s52, 0x6000000
    s_lshl_b32 s56, s38, 23
    s_lshl_b32 s45, s68, 9
    s_add_u32 s56, s56, s45
    s_add_u32 s56, s56, 0xc000000
    s_lshl_b32 s45, s40, 7
    s_add_u32 s45, s45, 127488
    v_mov_b32 v29, s45
    s_mov_b32 s46, 536870912
    s_mov_b64 exec, 1
    s_mov_b32 s70, 0
L_wp_166:
    buffer_load_dword v31, v29, s[12:15], 0 offen sc1
    s_add_u32 s70, s70, 1
    s_cmp_ge_u32 s70, 0x200000
    s_cbranch_scc1 L_w_done_98
    s_waitcnt vmcnt(0)
    v_cmp_gt_u32 vcc, s46, v31
    s_nop 1
    s_cbranch_vccz L_wp_166_ok
    s_sleep 2
    s_branch L_wp_166
L_wp_166_ok:
    s_mov_b64 exec, -1
    v_readfirstlane_b32 s45, v31
    s_nop 3
    s_and_b32 s46, s45, 511
    s_mul_i32 s46, s46, s46
    s_bfe_u32 s45, s45, 0xf0009
    s_lshl_b32 s45, s45, 5
    s_mov_b32 s80, s12
    s_mov_b32 s81, s13
    s_mov_b32 s83, 0x00020000
    s_mov_b32 s84, s12
    s_mov_b32 s85, s13
    s_mov_b32 s87, 0x00020000
    s_cmp_eq_u32 s45, s46
    s_cselect_b32 s82, s14, 0
    s_cselect_b32 s86, 0, s14
L_c_loop_164:
    s_cmp_eq_u64 s[36:37], 0
    s_cbranch_scc1 L_w_done_98
    s_ff1_i32_b64 s50, s[36:37]
    s_bitset0_b64 s[36:37], s50
    s_lshr_b64 s[74:75], s[72:73], s50
    s_ff1_i32_b64 s51, s[74:75]
    s_add_u32 s51, s51, 1
    s_add_u32 s62, s50, s51
    s_mul_i32 s45, s38, 896
    s_add_u32 s45, s45, s64
    s_add_u32 s45, s45, 12288
    s_cmp_lg_u32 s44, 0
    s_cbranch_scc1 L_pw_167
    s_mov_b64 exec, 127
    s_mov_b32 s70, 0
L_wp_168:
    buffer_load_dword v31, v5, s[12:15], s45 offen sc1
    s_add_u32 s70, s70, 1
    s_cmp_ge_u32 s70, 0x200000
    s_cbranch_scc1 L_w_done_98
    s_waitcnt vmcnt(0)
    v_cmp_gt_u32 vcc, s62, v31
    s_nop 1
    s_cbranch_vccz L_wp_168_ok
    s_sleep 2
    s_branch L_wp_168
L_wp_168_ok:
    s_mov_b64 exec, -1
L_pw_167:
    s_barrier
    s_mul_i32 s53, s50, 229376
    s_add_u32 s53, s53, s52
    s_lshl_b32 s54, s44, 13
    s_add_u32 s53, s53, s54
    s_mul_i32 s57, s50, 131072
    s_add_u32 s57, s57, s56
    s_lshl_b32 s45, s44, 7
    s_add_u32 s57, s57, s45
    s_add_u32 s55, s54, 65536
    s_mov_b32 s58, 0
    v_mov_b32 v13, v10
    v_add_u32 v14, 65536, v13
    v_xor_b32 v15, 64, v13
    v_xor_b32 v16, 64, v14
    s_mov_b32 s76, 0x20000000
    s_add_u32 s48, s53, 0
    s_add_u32 s49, s48, 4096
    s_add_u32 m0, s54, 0
    s_nop 0
    buffer_load_dwordx4 v10, s[12:15], s48 offen offset:0 sc1 lds
    buffer_load_dwordx4 v10, s[12:15], s48 offen offset:1024 sc1 lds
    buffer_load_dwordx4 v10, s[12:15], s48 offen offset:2048 sc1 lds
    buffer_load_dwordx4 v10, s[12:15], s48 offen offset:3072 sc1 lds
    s_add_u32 m0, s54, 4096
    s_nop 0
    buffer_load_dwordx4 v10, s[12:15], s49 offen offset:0 sc1 lds
    buffer_load_dwordx4 v10, s[12:15], s49 offen offset:1024 sc1 lds
    buffer_load_dwordx4 v10, s[12:15], s49 offen offset:2048 sc1 lds
    buffer_load_dwordx4 v10, s[12:15], s49 offen offset:3072 sc1 lds
    s_add_u32 s48, s53, 32768
    s_cmp_lt_u32 s44, 3
    s_cselect_b32 s48, s48, 0x20000000
    s_add_u32 s49, s48, 4096
    s_add_u32 s46, s54, 32768
    s_add_u32 m0, s46, 0
    s_nop 0
    buffer_load_dwordx4 v10, s[12:15], s48 offen offset:0 sc1 lds
    buffer_load_dwordx4 v10, s[12:15], s48 offen offset:1024 sc1 lds
    buffer_load_dwordx4 v10, s[12:15], s48 offen offset:2048 sc1 lds
    buffer_load_dwordx4 v10, s[12:15], s48 offen offset:3072 sc1 lds
    s_add_u32 m0, s46, 4096
    s_nop 0
    buffer_load_dwordx4 v10, s[12:15], s49 offen offset:0 sc1 lds
    buffer_load_dwordx4 v10, s[12:15], s49 offen offset:1024 sc1 lds
    buffer_load_dwordx4 v10, s[12:15], s49 offen offset:2048 sc1 lds
    buffer_load_dwordx4 v10, s[12:15], s49 offen offset:3072 sc1 lds
    s_cmp_eq_u32 s51, 1
    s_cbranch_scc1 L_e_one_170
    s_add_u32 s48, s53, 229376
    s_add_u32 s49, s48, 4096
    s_add_u32 m0, s55, 0
    s_nop 0
    buffer_load_dwordx4 v10, s[12:15], s48 offen offset:0 sc1 lds
    buffer_load_dwordx4 v10, s[12:15], s48 offen offset:1024 sc1 lds
    buffer_load_dwordx4 v10, s[12:15], s48 offen offset:2048 sc1 lds
    buffer_load_dwordx4 v10, s[12:15], s48 offen offset:3072 sc1 lds
    s_add_u32 m0, s55, 4096
    s_nop 0
    buffer_load_dwordx4 v10, s[12:15], s49 offen offset:0 sc1 lds
    buffer_load_dwordx4 v10, s[12:15], s49 offen offset:1024 sc1 lds
    buffer_load_dwordx4 v10, s[12:15], s49 offen offset:2048 sc1 lds
    buffer_load_dwordx4 v10, s[12:15], s49 offen offset:3072 sc1 lds
    s_waitcnt vmcnt(16)
    s_barrier
    ds_read_b128 v[32:35], v13 offset:0
    ds_read_b128 v[36:39], v13 offset:1024
    ds_read_b128 v[40:43], v13 offset:2048
    ds_read_b128 v[44:47], v13 offset:3072
L_e_loop_169:
    s_add_u32 s48, s53, 262144
    s_add_u32 s46, s58, 1
    s_cmp_lt_u32 s46, s51
    s_cselect_b32 s48, s48, 0x20000000
    s_cmp_lt_u32 s44, 3
    s_cselect_b32 s48, s48, 0x20000000
    s_add_u32 s49, s48, 4096
    s_add_u32 s59, s55, 32768
    s_waitcnt lgkmcnt(2)
    v_mfma_f32_16x16x32_bf16 v[80:83], a[0:3], v[32:35], 0
    ds_read_b128 v[48:51], v13 offset:4096
    ds_read_b128 v[52:55], v13 offset:5120
    v_mfma_f32_16x16x32_bf16 v[84:87], a[4:7], v[32:35], 0
    ds_read_b128 v[56:59], v13 offset:6144
    ds_read_b128 v[60:63], v13 offset:7168
    s_add_u32 m0, s59, 0
    v_mfma_f32_16x16x32_bf16 v[88:91], a[0:3], v[36:39], 0
    buffer_load_dwordx4 v10, s[12:15], s48 offen offset:0 sc1 lds
    v_mfma_f32_16x16x32_bf16 v[92:95], a[4:7], v[36:39], 0
    s_waitcnt lgkmcnt(4)
    v_mfma_f32_16x16x32_bf16 v[80:83], a[8:11], v[40:43], v[80:83]
    ds_read_b128 v[32:35], v13 offset:8192
    ds_read_b128 v[36:39], v13 offset:9216
    v_mfma_f32_16x16x32_bf16 v[84:87], a[12:15], v[40:43], v[84:87]
    v_mfma_f32_16x16x32_bf16 v[88:91], a[8:11], v[44:47], v[88:91]
    buffer_load_dwordx4 v10, s[12:15], s48 offen offset:1024 sc1 lds
    v_mfma_f32_16x16x32_bf16 v[92:95], a[12:15], v[44:47], v[92:95]
    s_waitcnt lgkmcnt(4)
    v_mfma_f32_16x16x32_bf16 v[80:83], a[16:19], v[48:51], v[80:83]
    ds_read_b128 v[40:43], v13 offset:10240
    ds_read_b128 v[44:47], v13 offset:11264
    v_mfma_f32_16x16x32_bf16 v[84:87], a[20:23], v[48:51], v[84:87]
    v_mfma_f32_16x16x32_bf16 v[88:91], a[16:19], v[52:55], v[88:91]
    buffer_load_dwordx4 v10, s[12:15], s48 offen offset:2048 sc1 lds
    v_mfma_f32_16x16x32_bf16 v[92:95], a[20:23], v[52:55], v[92:95]
    s_waitcnt lgkmcnt(4)
    v_mfma_f32_16x16x32_bf16 v[80:83], a[24:27], v[56:59], v[80:83]
    ds_read_b128 v[48:51], v13 offset:12288
    ds_read_b128 v[52:55], v13 offset:13312
    v_mfma_f32_16x16x32_bf16 v[84:87], a[28:31], v[56:59], v[84:87]
    v_mfma_f32_16x16x32_bf16 v[88:91], a[24:27], v[60:63], v[88:91]
    buffer_load_dwordx4 v10, s[12:15], s48 offen offset:3072 sc1 lds
    v_mfma_f32_16x16x32_bf16 v[92:95], a[28:31], v[60:63], v[92:95]
    s_waitcnt lgkmcnt(4)
    v_mfma_f32_16x16x32_bf16 v[80:83], a[32:35], v[32:35], v[80:83]
    ds_read_b128 v[56:59], v13 offset:14336
    ds_read_b128 v[60:63], v13 offset:15360
    v_mfma_f32_16x16x32_bf16 v[84:87], a[36:39], v[32:35], v[84:87]
    s_add_u32 m0, s59, 4096
    v_mfma_f32_16x16x32_bf16 v[88:91], a[32:35], v[36:39], v[88:91]
    buffer_load_dwordx4 v10, s[12:15], s49 offen offset:0 sc1 lds
    v_mfma_f32_16x16x32_bf16 v[92:95], a[36:39], v[36:39], v[92:95]
    s_waitcnt lgkmcnt(4)
    v_mfma_f32_16x16x32_bf16 v[80:83], a[40:43], v[40:43], v[80:83]
    ds_read_b128 v[32:35], v13 offset:16384
    ds_read_b128 v[36:39], v13 offset:17408
    v_mfma_f32_16x16x32_bf16 v[84:87], a[44:47], v[40:43], v[84:87]
    v_mfma_f32_16x16x32_bf16 v[88:91], a[40:43], v[44:47], v[88:91]
    buffer_load_dwordx4 v10, s[12:15], s49 offen offset:1024 sc1 lds
    v_mfma_f32_16x16x32_bf16 v[92:95], a[44:47], v[44:47], v[92:95]
    s_waitcnt lgkmcnt(4)
    v_mfma_f32_16x16x32_bf16 v[80:83], a[48:51], v[48:51], v[80:83]
    ds_read_b128 v[40:43], v13 offset:18432
    ds_read_b128 v[44:47], v13 offset:19456
    v_mfma_f32_16x16x32_bf16 v[84:87], a[52:55], v[48:51], v[84:87]
    v_mfma_f32_16x16x32_bf16 v[88:91], a[48:51], v[52:55], v[88:91]
    buffer_load_dwordx4 v10, s[12:15], s49 offen offset:2048 sc1 lds
    v_mfma_f32_16x16x32_bf16 v[92:95], a[52:55], v[52:55], v[92:95]
    s_waitcnt lgkmcnt(4)
    v_mfma_f32_16x16x32_bf16 v[80:83], a[56:59], v[56:59], v[80:83]
    ds_read_b128 v[48:51], v13 offset:20480
    ds_read_b128 v[52:55], v13 offset:21504
    v_mfma_f32_16x16x32_bf16 v[84:87], a[60:63], v[56:59], v[84:87]
    v_mfma_f32_16x16x32_bf16 v[88:91], a[56:59], v[60:63], v[88:91]
    buffer_load_dwordx4 v10, s[12:15], s49 offen offset:3072 sc1 lds
    v_mfma_f32_16x16x32_bf16 v[92:95], a[60:63], v[60:63], v[92:95]
    s_waitcnt lgkmcnt(4)
    v_mfma_f32_16x16x32_bf16 v[80:83], a[64:67], v[32:35], v[80:83]
    ds_read_b128 v[56:59], v13 offset:22528
    ds_read_b128 v[60:63], v13 offset:23552
    v_mfma_f32_16x16x32_bf16 v[84:87], a[68:71], v[32:35], v[84:87]
    v_mfma_f32_16x16x32_bf16 v[88:91], a[64:67], v[36:39], v[88:91]
    v_mfma_f32_16x16x32_bf16 v[92:95], a[68:71], v[36:39], v[92:95]
    s_waitcnt lgkmcnt(4)
    v_mfma_f32_16x16x32_bf16 v[80:83], a[72:75], v[40:43], v[80:83]
    ds_read_b128 v[32:35], v13 offset:24576
    ds_read_b128 v[36:39], v13 offset:25600
    v_mfma_f32_16x16x32_bf16 v[84:87], a[76:79], v[40:43], v[84:87]
    v_mfma_f32_16x16x32_bf16 v[88:91], a[72:75], v[44:47], v[88:91]
    v_mfma_f32_16x16x32_bf16 v[92:95], a[76:79], v[44:47], v[92:95]
    s_waitcnt lgkmcnt(4)
    v_mfma_f32_16x16x32_bf16 v[80:83], a[80:83], v[48:51], v[80:83]
    ds_read_b128 v[40:43], v13 offset:26624
    ds_read_b128 v[44:47], v13 offset:27648
    v_mfma_f32_16x16x32_bf16 v[84:87], a[84:87], v[48:51], v[84:87]
    v_mfma_f32_16x16x32_bf16 v[88:91], a[80:83], v[52:55], v[88:91]
    v_mfma_f32_16x16x32_bf16 v[92:95], a[84:87], v[52:55], v[92:95]
    s_waitcnt lgkmcnt(4)
    v_mfma_f32_16x16x32_bf16 v[80:83], a[88:91], v[56:59], v[80:83]
    ds_read_b128 v[48:51], v13 offset:28672
    ds_read_b128 v[52:55], v13 offset:29696
    v_mfma_f32_16x16x32_bf16 v[84:87], a[92:95], v[56:59], v[84:87]
    v_mfma_f32_16x16x32_bf16 v[88:91], a[88:91], v[60:63], v[88:91]
    v_mfma_f32_16x16x32_bf16 v[92:95], a[92:95], v[60:63], v[92:95]
    s_waitcnt lgkmcnt(4)
    v_mfma_f32_16x16x32_bf16 v[80:83], a[96:99], v[32:35], v[80:83]
    ds_read_b128 v[56:59], v13 offset:30720
    ds_read_b128 v[60:63], v13 offset:31744
    v_mfma_f32_16x16x32_bf16 v[84:87], a[100:103], v[32:35], v[84:87]
    v_mfma_f32_16x16x32_bf16 v[88:91], a[96:99], v[36:39], v[88:91]
    v_mfma_f32_16x16x32_bf16 v[92:95], a[100:103], v[36:39], v[92:95]
    s_waitcnt lgkmcnt(4)
    v_mfma_f32_16x16x32_bf16 v[80:83], a[104:107], v[40:43], v[80:83]
    ds_read_b128 v[216:219], v8 offset:0
    ds_read_b128 v[220:223], v8 offset:1152
    v_mfma_f32_16x16x32_bf16 v[84:87], a[108:111], v[40:43], v[84:87]
    ds_read_b128 v[224:227], v8 offset:2304
    ds_read_b128 v[228:231], v8 offset:3456
    v_mfma_f32_16x16x32_bf16 v[88:91], a[104:107], v[44:47], v[88:91]
    v_mfma_f32_16x16x32_bf16 v[92:95], a[108:111], v[44:47], v[92:95]
    s_waitcnt vmcnt(16) lgkmcnt(0)
    s_barrier
    v_mfma_f32_16x16x32_bf16 v[80:83], a[112:115], v[48:51], v[80:83]
    ds_read_b128 v[32:35], v13 offset:32768
    ds_read_b128 v[36:39], v13 offset:33792
    v_mfma_f32_16x16x32_bf16 v[84:87], a[116:119], v[48:51], v[84:87]
    buffer_store_dwordx4 v[216:219], v11, s[12:15], s76 offen sc1
    s_add_u32 s76, s76, 32768
    v_mfma_f32_16x16x32_bf16 v[88:91], a[112:115], v[52:55], v[88:91]
    buffer_store_dwordx4 v[220:223], v11, s[12:15], s76 offen sc1
    s_add_u32 s76, s76, 32768
    v_mfma_f32_16x16x32_bf16 v[92:95], a[116:119], v[52:55], v[92:95]
    buffer_store_dwordx4 v[224:227], v11, s[12:15], s76 offen sc1
    s_add_u32 s76, s76, 32768
    v_mfma_f32_16x16x32_bf16 v[80:83], a[120:123], v[56:59], v[80:83]
    ds_read_b128 v[40:43], v13 offset:34816
    ds_read_b128 v[44:47], v13 offset:35840
    v_mfma_f32_16x16x32_bf16 v[84:87], a[124:127], v[56:59], v[84:87]
    buffer_store_dwordx4 v[228:231], v11, s[12:15], s76 offen sc1
    v_mfma_f32_16x16x32_bf16 v[88:91], a[120:123], v[60:63], v[88:91]
    v_mfma_f32_16x16x32_bf16 v[92:95], a[124:127], v[60:63], v[92:95]
    s_add_u32 s48, s53, 458752
    s_add_u32 s46, s58, 2
    s_cmp_lt_u32 s46, s51
    s_cselect_b32 s48, s48, 0x20000000
    s_add_u32 s49, s48, 4096
    s_mov_b32 s59, s54
    s_waitcnt lgkmcnt(2)
    v_mfma_f32_16x16x32_bf16 v[80:83], a[128:131], v[32:35], v[80:83]
    ds_read_b128 v[48:51], v13 offset:36864
    ds_read_b128 v[52:55], v13 offset:37888
    v_mfma_f32_16x16x32_bf16 v[84:87], a[132:135], v[32:35], v[84:87]
    ds_read_b128 v[56:59], v13 offset:38912
    ds_read_b128 v[60:63], v13 offset:39936
    s_add_u32 m0, s59, 0
    v_mfma_f32_16x16x32_bf16 v[88:91], a[128:131], v[36:39], v[88:91]
    buffer_load_dwordx4 v10, s[12:15], s48 offen offset:0 sc1 lds
    v_mfma_f32_16x16x32_bf16 v[92:95], a[132:135], v[36:39], v[92:95]
    s_waitcnt lgkmcnt(4)
    v_mfma_f32_16x16x32_bf16 v[80:83], a[136:139], v[40:43], v[80:83]
    ds_read_b128 v[32:35], v13 offset:40960
    ds_read_b128 v[36:39], v13 offset:41984
    v_mfma_f32_16x16x32_bf16 v[84:87], a[140:143], v[40:43], v[84:87]
    v_mfma_f32_16x16x32_bf16 v[88:91], a[136:139], v[44:47], v[88:91]
    buffer_load_dwordx4 v10, s[12:15], s48 offen offset:1024 sc1 lds
    v_mfma_f32_16x16x32_bf16 v[92:95], a[140:143], v[44:47], v[92:95]
    s_waitcnt lgkmcnt(4)
    v_mfma_f32_16x16x32_bf16 v[80:83], a[144:147], v[48:51], v[80:83]
    ds_read_b128 v[40:43], v13 offset:43008
    ds_read_b128 v[44:47], v13 offset:44032
    v_mfma_f32_16x16x32_bf16 v[84:87], a[148:151], v[48:51], v[84:87]
    v_mfma_f32_16x16x32_bf16 v[88:91], a[144:147], v[52:55], v[88:91]
    buffer_load_dwordx4 v10, s[12:15], s48 offen offset:2048 sc1 lds
    v_mfma_f32_16x16x32_bf16 v[92:95], a[148:151], v[52:55], v[92:95]
    s_waitcnt lgkmcnt(4)
    v_mfma_f32_16x16x32_bf16 v[80:83], a[152:155], v[56:59], v[80:83]
    ds_read_b128 v[48:51], v13 offset:45056
    ds_read_b128 v[52:55], v13 offset:46080
    v_mfma_f32_16x16x32_bf16 v[84:87], a[156:159], v[56:59], v[84:87]
    v_mfma_f32_16x16x32_bf16 v[88:91], a[152:155], v[60:63], v[88:91]
    buffer_load_dwordx4 v10, s[12:15], s48 offen offset:3072 sc1 lds
    v_mfma_f32_16x16x32_bf16 v[92:95], a[156:159], v[60:63], v[92:95]
    s_waitcnt lgkmcnt(4)
    v_mfma_f32_16x16x32_bf16 v[80:83], a[160:163], v[32:35], v[80:83]
    ds_read_b128 v[56:59], v13 offset:47104
    ds_read_b128 v[60:63], v13 offset:48128
    v_mfma_f32_16x16x32_bf16 v[84:87], a[164:167], v[32:35], v[84:87]
    s_add_u32 m0, s59, 4096
    v_mfma_f32_16x16x32_bf16 v[88:91], a[160:163], v[36:39], v[88:91]
    buffer_load_dwordx4 v10, s[12:15], s49 offen offset:0 sc1 lds
    v_mfma_f32_16x16x32_bf16 v[92:95], a[164:167], v[36:39], v[92:95]
    s_waitcnt lgkmcnt(4)
    v_mfma_f32_16x16x32_bf16 v[80:83], a[168:171], v[40:43], v[80:83]
    ds_read_b128 v[32:35], v13 offset:49152
    ds_read_b128 v[36:39], v13 offset:50176
    v_mfma_f32_16x16x32_bf16 v[84:87], a[172:175], v[40:43], v[84:87]
    v_mfma_f32_16x16x32_bf16 v[88:91], a[168:171], v[44:47], v[88:91]
    buffer_load_dwordx4 v10, s[12:15], s49 offen offset:1024 sc1 lds
    v_mfma_f32_16x16x32_bf16 v[92:95], a[172:175], v[44:47], v[92:95]
    s_waitcnt lgkmcnt(4)
    v_mfma_f32_16x16x32_bf16 v[80:83], a[176:179], v[48:51], v[80:83]
    ds_read_b128 v[40:43], v13 offset:51200
    ds_read_b128 v[44:47], v13 offset:52224
    v_mfma_f32_16x16x32_bf16 v[84:87], a[180:183], v[48:51], v[84:87]
    v_mfma_f32_16x16x32_bf16 v[88:91], a[176:179], v[52:55], v[88:91]
    buffer_load_dwordx4 v10, s[12:15], s49 offen offset:2048 sc1 lds
    v_mfma_f32_16x16x32_bf16 v[92:95], a[180:183], v[52:55], v[92:95]
    s_waitcnt lgkmcnt(4)
    v_mfma_f32_16x16x32_bf16 v[80:83], a[184:187], v[56:59], v[80:83]
    ds_read_b128 v[48:51], v13 offset:53248
    ds_read_b128 v[52:55], v13 offset:54272
    v_mfma_f32_16x16x32_bf16 v[84:87], a[188:191], v[56:59], v[84:87]
    v_mfma_f32_16x16x32_bf16 v[88:91], a[184:187], v[60:63], v[88:91]
    buffer_load_dwordx4 v10, s[12:15], s49 offen offset:3072 sc1 lds
    v_mfma_f32_16x16x32_bf16 v[92:95], a[188:191], v[60:63], v[92:95]
    s_waitcnt lgkmcnt(4)
    v_mfma_f32_16x16x32_bf16 v[80:83], a[192:195], v[32:35], v[80:83]
    ds_read_b128 v[56:59], v13 offset:55296
    ds_read_b128 v[60:63], v13 offset:56320
    v_mfma_f32_16x16x32_bf16 v[84:87], a[196:199], v[32:35], v[84:87]
    v_mfma_f32_16x16x32_bf16 v[88:91], a[192:195], v[36:39], v[88:91]
    v_mfma_f32_16x16x32_bf16 v[92:95], a[196:199], v[36:39], v[92:95]
    s_waitcnt lgkmcnt(4)
    v_mfma_f32_16x16x32_bf16 v[80:83], a[200:203], v[40:43], v[80:83]
    v_mfma_f32_16x16x32_bf16 v[84:87], a[204:207], v[40:43], v[84:87]
    v_mfma_f32_16x16x32_bf16 v[88:91], a[200:203], v[44:47], v[88:91]
    v_mfma_f32_16x16x32_bf16 v[92:95], a[204:207], v[44:47], v[92:95]
    s_waitcnt vmcnt(16) lgkmcnt(0)
    s_barrier
    v_mfma_f32_16x16x32_bf16 v[80:83], a[208:211], v[48:51], v[80:83]
    ds_read_b128 v[32:35], v14 offset:0
    ds_read_b128 v[36:39], v14 offset:1024
    v_mfma_f32_16x16x32_bf16 v[84:87], a[212:215], v[48:51], v[84:87]
    v_mfma_f32_16x16x32_bf16 v[88:91], a[208:211], v[52:55], v[88:91]
    v_mfma_f32_16x16x32_bf16 v[92:95], a[212:215], v[52:55], v[92:95]
    v_mfma_f32_16x16x32_bf16 v[80:83], a[216:219], v[56:59], v[80:83]
    ds_read_b128 v[40:43], v14 offset:2048
    ds_read_b128 v[44:47], v14 offset:3072
    v_mfma_f32_16x16x32_bf16 v[84:87], a[220:223], v[56:59], v[84:87]
    v_mfma_f32_16x16x32_bf16 v[88:91], a[216:219], v[60:63], v[88:91]
    v_mfma_f32_16x16x32_bf16 v[92:95], a[220:223], v[60:63], v[92:95]
    s_add_u32 s53, s53, 229376
    s_add_u32 s58, s58, 1
    v_swap_b32 v13, v14
    s_xor_b32 s54, s54, 65536
    s_xor_b32 s55, s55, 65536
    s_mov_b32 s76, s57
    v_swap_b32 v15, v16
    s_add_u32 s57, s57, 131072
    ds_write_b128 v7, v[80:83] offset:0
    ds_write_b128 v7, v[84:87] offset:64
    ds_write_b128 v7, v[88:91] offset:2304
    ds_write_b128 v7, v[92:95] offset:2368
    s_cmp_lt_u32 s58, s51
    s_cbranch_scc1 L_e_loop_169
    s_branch L_e_fin_171
L_e_one_170:
    s_waitcnt vmcnt(8)
    s_barrier
    ds_read_b128 v[32:35], v13 offset:0
    ds_read_b128 v[36:39], v13 offset:1024
    ds_read_b128 v[40:43], v13 offset:2048
    ds_read_b128 v[44:47], v13 offset:3072
    s_waitcnt lgkmcnt(2)
    v_mfma_f32_16x16x32_bf16 v[80:83], a[0:3], v[32:35], 0
    ds_read_b128 v[48:51], v13 offset:4096
    ds_read_b128 v[52:55], v13 offset:5120
    v_mfma_f32_16x16x32_bf16 v[84:87], a[4:7], v[32:35], 0
    ds_read_b128 v[56:59], v13 offset:6144
    ds_read_b128 v[60:63], v13 offset:7168
    v_mfma_f32_16x16x32_bf16 v[88:91], a[0:3], v[36:39], 0
    v_mfma_f32_16x16x32_bf16 v[92:95], a[4:7], v[36:39], 0
    s_waitcnt lgkmcnt(4)
    v_mfma_f32_16x16x32_bf16 v[80:83], a[8:11], v[40:43], v[80:83]
    ds_read_b128 v[32:35], v13 offset:8192
    ds_read_b128 v[36:39], v13 offset:9216
    v_mfma_f32_16x16x32_bf16 v[84:87], a[12:15], v[40:43], v[84:87]
    v_mfma_f32_16x16x32_bf16 v[88:91], a[8:11], v[44:47], v[88:91]
    v_mfma_f32_16x16x32_bf16 v[92:95], a[12:15], v[44:47], v[92:95]
    s_waitcnt lgkmcnt(4)
    v_mfma_f32_16x16x32_bf16 v[80:83], a[16:19], v[48:51], v[80:83]
    ds_read_b128 v[40:43], v13 offset:10240
    ds_read_b128 v[44:47], v13 offset:11264
    v_mfma_f32_16x16x32_bf16 v[84:87], a[20:23], v[48:51], v[84:87]
    v_mfma_f32_16x16x32_bf16 v[88:91], a[16:19], v[52:55], v[88:91]
    v_mfma_f32_16x16x32_bf16 v[92:95], a[20:23], v[52:55], v[92:95]
    s_waitcnt lgkmcnt(4)
    v_mfma_f32_16x16x32_bf16 v[80:83], a[24:27], v[56:59], v[80:83]
    ds_read_b128 v[48:51], v13 offset:12288
    ds_read_b128 v[52:55], v13 offset:13312
    v_mfma_f32_16x16x32_bf16 v[84:87], a[28:31], v[56:59], v[84:87]
    v_mfma_f32_16x16x32_bf16 v[88:91], a[24:27], v[60:63], v[88:91]
    v_mfma_f32_16x16x32_bf16 v[92:95], a[28:31], v[60:63], v[92:95]
    s_waitcnt lgkmcnt(4)
    v_mfma_f32_16x16x32_bf16 v[80:83], a[32:35], v[32:35], v[80:83]
    ds_read_b128 v[56:59], v13 offset:14336
    ds_read_b128 v[60:63], v13 offset:15360
    v_mfma_f32_16x16x32_bf16 v[84:87], a[36:39], v[32:35], v[84:87]
    v_mfma_f32_16x16x32_bf16 v[88:91], a[32:35], v[36:39], v[88:91]
    v_mfma_f32_16x16x32_bf16 v[92:95], a[36:39], v[36:39], v[92:95]
    s_waitcnt lgkmcnt(4)
    v_mfma_f32_16x16x32_bf16 v[80:83], a[40:43], v[40:43], v[80:83]
    ds_read_b128 v[32:35], v13 offset:16384
    ds_read_b128 v[36:39], v13 offset:17408
    v_mfma_f32_16x16x32_bf16 v[84:87], a[44:47], v[40:43], v[84:87]
    v_mfma_f32_16x16x32_bf16 v[88:91], a[40:43], v[44:47], v[88:91]
    v_mfma_f32_16x16x32_bf16 v[92:95], a[44:47], v[44:47], v[92:95]
    s_waitcnt lgkmcnt(4)
    v_mfma_f32_16x16x32_bf16 v[80:83], a[48:51], v[48:51], v[80:83]
    ds_read_b128 v[40:43], v13 offset:18432
    ds_read_b128 v[44:47], v13 offset:19456
    v_mfma_f32_16x16x32_bf16 v[84:87], a[52:55], v[48:51], v[84:87]
    v_mfma_f32_16x16x32_bf16 v[88:91], a[48:51], v[52:55], v[88:91]
    v_mfma_f32_16x16x32_bf16 v[92:95], a[52:55], v[52:55], v[92:95]
    s_waitcnt lgkmcnt(4)
    v_mfma_f32_16x16x32_bf16 v[80:83], a[56:59], v[56:59], v[80:83]
    ds_read_b128 v[48:51], v13 offset:20480
    ds_read_b128 v[52:55], v13 offset:21504
    v_mfma_f32_16x16x32_bf16 v[84:87], a[60:63], v[56:59], v[84:87]
    v_mfma_f32_16x16x32_bf16 v[88:91], a[56:59], v[60:63], v[88:91]
    v_mfma_f32_16x16x32_bf16 v[92:95], a[60:63], v[60:63], v[92:95]
    s_waitcnt lgkmcnt(4)
    v_mfma_f32_16x16x32_bf16 v[80:83], a[64:67], v[32:35], v[80:83]
    ds_read_b128 v[56:59], v13 offset:22528
    ds_read_b128 v[60:63], v13 offset:23552
    v_mfma_f32_16x16x32_bf16 v[84:87], a[68:71], v[32:35], v[84:87]
    v_mfma_f32_16x16x32_bf16 v[88:91], a[64:67], v[36:39], v[88:91]
    v_mfma_f32_16x16x32_bf16 v[92:95], a[68:71], v[36:39], v[92:95]
    s_waitcnt lgkmcnt(4)
    v_mfma_f32_16x16x32_bf16 v[80:83], a[72:75], v[40:43], v[80:83]
    ds_read_b128 v[32:35], v13 offset:24576
    ds_read_b128 v[36:39], v13 offset:25600
    v_mfma_f32_16x16x32_bf16 v[84:87], a[76:79], v[40:43], v[84:87]
    v_mfma_f32_16x16x32_bf16 v[88:91], a[72:75], v[44:47], v[88:91]
    v_mfma_f32_16x16x32_bf16 v[92:95], a[76:79], v[44:47], v[92:95]
    s_waitcnt lgkmcnt(4)
    v_mfma_f32_16x16x32_bf16 v[80:83], a[80:83], v[48:51], v[80:83]
    ds_read_b128 v[40:43], v13 offset:26624
    ds_read_b128 v[44:47], v13 offset:27648
    v_mfma_f32_16x16x32_bf16 v[84:87], a[84:87], v[48:51], v[84:87]
    v_mfma_f32_16x16x32_bf16 v[88:91], a[80:83], v[52:55], v[88:91]
    v_mfma_f32_16x16x32_bf16 v[92:95], a[84:87], v[52:55], v[92:95]
    s_waitcnt lgkmcnt(4)
    v_mfma_f32_16x16x32_bf16 v[80:83], a[88:91], v[56:59], v[80:83]
    ds_read_b128 v[48:51], v13 offset:28672
    ds_read_b128 v[52:55], v13 offset:29696
    v_mfma_f32_16x16x32_bf16 v[84:87], a[92:95], v[56:59], v[84:87]
    v_mfma_f32_16x16x32_bf16 v[88:91], a[88:91], v[60:63], v[88:91]
    v_mfma_f32_16x16x32_bf16 v[92:95], a[92:95], v[60:63], v[92:95]
    s_waitcnt lgkmcnt(4)
    v_mfma_f32_16x16x32_bf16 v[80:83], a[96:99], v[32:35], v[80:83]
    ds_read_b128 v[56:59], v13 offset:30720
    ds_read_b128 v[60:63], v13 offset:31744
    v_mfma_f32_16x16x32_bf16 v[84:87], a[100:103], v[32:35], v[84:87]
    v_mfma_f32_16x16x32_bf16 v[88:91], a[96:99], v[36:39], v[88:91]
    v_mfma_f32_16x16x32_bf16 v[92:95], a[100:103], v[36:39], v[92:95]
    s_waitcnt lgkmcnt(4)
    v_mfma_f32_16x16x32_bf16 v[80:83], a[104:107], v[40:43], v[80:83]
    v_mfma_f32_16x16x32_bf16 v[84:87], a[108:111], v[40:43], v[84:87]
    v_mfma_f32_16x16x32_bf16 v[88:91], a[104:107], v[44:47], v[88:91]
    v_mfma_f32_16x16x32_bf16 v[92:95], a[108:111], v[44:47], v[92:95]
    s_waitcnt vmcnt(0) lgkmcnt(0)
    s_barrier
    v_mfma_f32_16x16x32_bf16 v[80:83], a[112:115], v[48:51], v[80:83]
    ds_read_b128 v[32:35], v13 offset:32768
    ds_read_b128 v[36:39], v13 offset:33792
    v_mfma_f32_16x16x32_bf16 v[84:87], a[116:119], v[48:51], v[84:87]
    v_mfma_f32_16x16x32_bf16 v[88:91], a[112:115], v[52:55], v[88:91]
    v_mfma_f32_16x16x32_bf16 v[92:95], a[116:119], v[52:55], v[92:95]
    v_mfma_f32_16x16x32_bf16 v[80:83], a[120:123], v[56:59], v[80:83]
    ds_read_b128 v[40:43], v13 offset:34816
    ds_read_b128 v[44:47], v13 offset:35840
    v_mfma_f32_16x16x32_bf16 v[84:87], a[124:127], v[56:59], v[84:87]
    v_mfma_f32_16x16x32_bf16 v[88:91], a[120:123], v[60:63], v[88:91]
    v_mfma_f32_16x16x32_bf16 v[92:95], a[124:127], v[60:63], v[92:95]
    s_waitcnt lgkmcnt(2)
    v_mfma_f32_16x16x32_bf16 v[80:83], a[128:131], v[32:35], v[80:83]
    ds_read_b128 v[48:51], v13 offset:36864
    ds_read_b128 v[52:55], v13 offset:37888
    v_mfma_f32_16x16x32_bf16 v[84:87], a[132:135], v[32:35], v[84:87]
    ds_read_b128 v[56:59], v13 offset:38912
    ds_read_b128 v[60:63], v13 offset:39936
    v_mfma_f32_16x16x32_bf16 v[88:91], a[128:131], v[36:39], v[88:91]
    v_mfma_f32_16x16x32_bf16 v[92:95], a[132:135], v[36:39], v[92:95]
    s_waitcnt lgkmcnt(4)
    v_mfma_f32_16x16x32_bf16 v[80:83], a[136:139], v[40:43], v[80:83]
    ds_read_b128 v[32:35], v13 offset:40960
    ds_read_b128 v[36:39], v13 offset:41984
    v_mfma_f32_16x16x32_bf16 v[84:87], a[140:143], v[40:43], v[84:87]
    v_mfma_f32_16x16x32_bf16 v[88:91], a[136:139], v[44:47], v[88:91]
    v_mfma_f32_16x16x32_bf16 v[92:95], a[140:143], v[44:47], v[92:95]
    s_waitcnt lgkmcnt(4)
    v_mfma_f32_16x16x32_bf16 v[80:83], a[144:147], v[48:51], v[80:83]
    ds_read_b128 v[40:43], v13 offset:43008
    ds_read_b128 v[44:47], v13 offset:44032
    v_mfma_f32_16x16x32_bf16 v[84:87], a[148:151], v[48:51], v[84:87]
    v_mfma_f32_16x16x32_bf16 v[88:91], a[144:147], v[52:55], v[88:91]
    v_mfma_f32_16x16x32_bf16 v[92:95], a[148:151], v[52:55], v[92:95]
    s_waitcnt lgkmcnt(4)
    v_mfma_f32_16x16x32_bf16 v[80:83], a[152:155], v[56:59], v[80:83]
    ds_read_b128 v[48:51], v13 offset:45056
    ds_read_b128 v[52:55], v13 offset:46080
    v_mfma_f32_16x16x32_bf16 v[84:87], a[156:159], v[56:59], v[84:87]
    v_mfma_f32_16x16x32_bf16 v[88:91], a[152:155], v[60:63], v[88:91]
    v_mfma_f32_16x16x32_bf16 v[92:95], a[156:159], v[60:63], v[92:95]
    s_waitcnt lgkmcnt(4)
    v_mfma_f32_16x16x32_bf16 v[80:83], a[160:163], v[32:35], v[80:83]
    ds_read_b128 v[56:59], v13 offset:47104
    ds_read_b128 v[60:63], v13 offset:48128
    v_mfma_f32_16x16x32_bf16 v[84:87], a[164:167], v[32:35], v[84:87]
    v_mfma_f32_16x16x32_bf16 v[88:91], a[160:163], v[36:39], v[88:91]
    v_mfma_f32_16x16x32_bf16 v[92:95], a[164:167], v[36:39], v[92:95]
    s_waitcnt lgkmcnt(4)
    v_mfma_f32_16x16x32_bf16 v[80:83], a[168:171], v[40:43], v[80:83]
    ds_read_b128 v[32:35], v13 offset:49152
    ds_read_b128 v[36:39], v13 offset:50176
    v_mfma_f32_16x16x32_bf16 v[84:87], a[172:175], v[40:43], v[84:87]
    v_mfma_f32_16x16x32_bf16 v[88:91], a[168:171], v[44:47], v[88:91]
    v_mfma_f32_16x16x32_bf16 v[92:95], a[172:175], v[44:47], v[92:95]
    s_waitcnt lgkmcnt(4)
    v_mfma_f32_16x16x32_bf16 v[80:83], a[176:179], v[48:51], v[80:83]
    ds_read_b128 v[40:43], v13 offset:51200
    ds_read_b128 v[44:47], v13 offset:52224
    v_mfma_f32_16x16x32_bf16 v[84:87], a[180:183], v[48:51], v[84:87]
    v_mfma_f32_16x16x32_bf16 v[88:91], a[176:179], v[52:55], v[88:91]
    v_mfma_f32_16x16x32_bf16 v[92:95], a[180:183], v[52:55], v[92:95]
    s_waitcnt lgkmcnt(4)
    v_mfma_f32_16x16x32_bf16 v[80:83], a[184:187], v[56:59], v[80:83]
    ds_read_b128 v[48:51], v13 offset:53248
    ds_read_b128 v[52:55], v13 offset:54272
    v_mfma_f32_16x16x32_bf16 v[84:87], a[188:191], v[56:59], v[84:87]
    v_mfma_f32_16x16x32_bf16 v[88:91], a[184:187], v[60:63], v[88:91]
    v_mfma_f32_16x16x32_bf16 v[92:95], a[188:191], v[60:63], v[92:95]
    s_waitcnt lgkmcnt(4)
    v_mfma_f32_16x16x32_bf16 v[80:83], a[192:195], v[32:35], v[80:83]
    ds_read_b128 v[56:59], v13 offset:55296
    ds_read_b128 v[60:63], v13 offset:56320
    v_mfma_f32_16x16x32_bf16 v[84:87], a[196:199], v[32:35], v[84:87]
    v_mfma_f32_16x16x32_bf16 v[88:91], a[192:195], v[36:39], v[88:91]
    v_mfma_f32_16x16x32_bf16 v[92:95], a[196:199], v[36:39], v[92:95]
    s_waitcnt lgkmcnt(4)
    v_mfma_f32_16x16x32_bf16 v[80:83], a[200:203], v[40:43], v[80:83]
    v_mfma_f32_16x16x32_bf16 v[84:87], a[204:207], v[40:43], v[84:87]
    v_mfma_f32_16x16x32_bf16 v[88:91], a[200:203], v[44:47], v[88:91]
    v_mfma_f32_16x16x32_bf16 v[92:95], a[204:207], v[44:47], v[92:95]
    s_waitcnt lgkmcnt(0)
    v_mfma_f32_16x16x32_bf16 v[80:83], a[208:211], v[48:51], v[80:83]
    v_mfma_f32_16x16x32_bf16 v[84:87], a[212:215], v[48:51], v[84:87]
    v_mfma_f32_16x16x32_bf16 v[88:91], a[208:211], v[52:55], v[88:91]
    v_mfma_f32_16x16x32_bf16 v[92:95], a[212:215], v[52:55], v[92:95]
    v_mfma_f32_16x16x32_bf16 v[80:83], a[216:219], v[56:59], v[80:83]
    v_mfma_f32_16x16x32_bf16 v[84:87], a[220:223], v[56:59], v[84:87]
    v_mfma_f32_16x16x32_bf16 v[88:91], a[216:219], v[60:63], v[88:91]
    v_mfma_f32_16x16x32_bf16 v[92:95], a[220:223], v[60:63], v[92:95]
    s_mov_b32 s76, s57
    s_nop 6
    ds_write_b128 v7, v[80:83] offset:0
    ds_write_b128 v7, v[84:87] offset:64
    ds_write_b128 v7, v[88:91] offset:2304
    ds_write_b128 v7, v[92:95] offset:2368
L_e_fin_171:
    s_waitcnt lgkmcnt(0)
    ds_read_b128 v[216:219], v8 offset:0
    ds_read_b128 v[220:223], v8 offset:1152
    ds_read_b128 v[224:227], v8 offset:2304
    ds_read_b128 v[228:231], v8 offset:3456
    s_waitcnt lgkmcnt(0)
    buffer_store_dwordx4 v[216:219], v11, s[12:15], s76 offen sc1
    s_add_u32 s76, s76, 32768
    buffer_store_dwordx4 v[220:223], v11, s[12:15], s76 offen sc1
    s_add_u32 s76, s76, 32768
    buffer_store_dwordx4 v[224:227], v11, s[12:15], s76 offen sc1
    s_add_u32 s76, s76, 32768
    buffer_store_dwordx4 v[228:231], v11, s[12:15], s76 offen sc1
    s_waitcnt vmcnt(0)
    s_barrier
    s_cmp_lg_u32 s44, 0
    s_cbranch_scc1 L_pub_172
    v_mov_b32 v30, s62
    v_mov_b32 v31, 0
    s_mov_b64 exec, 1
    buffer_store_dword v30, v31, s[80:83], s65 offen
    buffer_store_dword v30, v31, s[84:87], s65 offen sc1
    s_mov_b64 exec, -1
L_pub_172:
    s_cmp_lg_u32 s51, 1
    s_cbranch_scc1 L_c_skip_165
    s_lshl_b32 s63, s50, 5
    s_add_u32 s63, s63, s41
    s_lshl_b32 s47, s63, 11
    s_lshl_b32 s45, s44, 9
    s_add_u32 s47, s47, s45
    s_add_u32 s46, s47, 0x800000
    v_lshlrev_b32 v17, 3, v1
    buffer_load_dwordx2 v[208:209], v17, s[12:15], s46 offen sc1
    s_add_u32 s45, s64, 16384
    s_cmp_lg_u32 s44, 0
    s_cbranch_scc1 L_pw_173
    s_mov_b32 exec_hi, 0
    s_mov_b32 s70, 0
L_wp_174:
    buffer_load_dword v31, v5, s[12:15], s45 offen sc1
    s_add_u32 s70, s70, 1
    s_cmp_ge_u32 s70, 0x200000
    s_cbranch_scc1 L_w_done_98
    s_waitcnt vmcnt(0)
    v_cmp_gt_u32 vcc, s62, v31
    s_nop 1
    s_cbranch_vccz L_wp_174_ok
    s_sleep 1
    s_branch L_wp_174
L_wp_174_ok:
    s_mov_b64 exec, -1
L_pw_173:
    s_barrier
    s_waitcnt vmcnt(0)
    s_lshl_b32 s45, s63, 12
    s_lshl_b32 s46, s44, 10
    s_add_u32 s45, s45, s46
    s_add_u32 s45, s45, 0xc000000
    buffer_load_dwordx4 v[64:67], v10, s[12:15], s45 offen sc1
    s_add_u32 s45, s45, 0x800000
    buffer_load_dwordx4 v[68:71], v10, s[12:15], s45 offen sc1
    s_add_u32 s45, s45, 0x800000
    buffer_load_dwordx4 v[72:75], v10, s[12:15], s45 offen sc1
    s_add_u32 s45, s45, 0x800000
    buffer_load_dwordx4 v[76:79], v10, s[12:15], s45 offen sc1
    v_lshlrev_b32 v160, 16, v208
    v_and_b32 v161, 0xffff0000, v208
    v_lshlrev_b32 v162, 16, v209
    v_and_b32 v163, 0xffff0000, v209
    s_waitcnt vmcnt(0)
    v_pk_add_f32 v[64:65], v[64:65], v[68:69]
    v_pk_add_f32 v[72:73], v[72:73], v[76:77]
    v_pk_add_f32 v[66:67], v[66:67], v[70:71]
    v_pk_add_f32 v[74:75], v[74:75], v[78:79]
    v_pk_add_f32 v[64:65], v[64:65], v[72:73]
    v_pk_add_f32 v[66:67], v[66:67], v[74:75]
    v_cvt_pk_bf16_f32 v64, v64, v64
    v_lshlrev_b32 v64, 16, v64
    v_cvt_pk_bf16_f32 v65, v65, v65
    v_lshlrev_b32 v65, 16, v65
    v_cvt_pk_bf16_f32 v66, v66, v66
    v_lshlrev_b32 v66, 16, v66
    v_cvt_pk_bf16_f32 v67, v67, v67
    v_lshlrev_b32 v67, 16, v67
    v_add_f32 v64, v64, v18
    v_cvt_pk_bf16_f32 v64, v64, v64
    v_lshlrev_b32 v64, 16, v64
    v_mul_f32 v64, v64, v22
    v_cvt_pk_bf16_f32 v64, v64, v64
    v_lshlrev_b32 v64, 16, v64
    v_add_f32 v64, v64, v160
    v_add_f32 v65, v65, v19
    v_cvt_pk_bf16_f32 v65, v65, v65
    v_lshlrev_b32 v65, 16, v65
    v_mul_f32 v65, v65, v23
    v_cvt_pk_bf16_f32 v65, v65, v65
    v_lshlrev_b32 v65, 16, v65
    v_add_f32 v65, v65, v161
    v_add_f32 v66, v66, v20
    v_cvt_pk_bf16_f32 v66, v66, v66
    v_lshlrev_b32 v66, 16, v66
    v_mul_f32 v66, v66, v24
    v_cvt_pk_bf16_f32 v66, v66, v66
    v_lshlrev_b32 v66, 16, v66
    v_add_f32 v66, v66, v162
    v_add_f32 v67, v67, v21
    v_cvt_pk_bf16_f32 v67, v67, v67
    v_lshlrev_b32 v67, 16, v67
    v_mul_f32 v67, v67, v25
    v_cvt_pk_bf16_f32 v67, v67, v67
    v_lshlrev_b32 v67, 16, v67
    v_add_f32 v67, v67, v163
    v_cvt_pk_bf16_f32 v208, v64, v65
    v_cvt_pk_bf16_f32 v209, v66, v67
    buffer_store_dwordx2 v[208:209], v17, s[32:35], s47 offen
    s_branch L_c_loop_164
L_c_skip_165:
    s_add_u32 s63, s50, s44
    s_lshl_b32 s63, s63, 5
    s_add_u32 s63, s63, s41
    s_lshl_b32 s47, s63, 11
    s_add_u32 s46, s47, 0x800000
    s_cmp_lt_u32 s44, s51
    s_cselect_b32 s46, s46, 0x20000000
    buffer_load_dwordx4 v[208:211], v10, s[12:15], s46 offen sc1
    buffer_load_dwordx4 v[212:215], v10, s[12:15], s46 offen offset:1024 sc1
    s_add_u32 s45, s64, 16384
    s_cmp_lg_u32 s44, 0
    s_cbranch_scc1 L_pw_175
    s_mov_b32 exec_hi, 0
    s_mov_b32 s70, 0
L_wp_176:
    buffer_load_dword v31, v5, s[12:15], s45 offen sc1
    s_add_u32 s70, s70, 1
    s_cmp_ge_u32 s70, 0x200000
    s_cbranch_scc1 L_w_done_98
    s_waitcnt vmcnt(0)
    v_cmp_gt_u32 vcc, s62, v31
    s_nop 1
    s_cbranch_vccz L_wp_176_ok
    s_sleep 1
    s_branch L_wp_176
L_wp_176_ok:
    s_mov_b64 exec, -1
L_pw_175:
    s_barrier
    s_cmp_ge_u32 s44, s51
    s_cbranch_scc1 L_c_loop_164
    s_lshl_b32 s45, s63, 12
    s_add_u32 s45, s45, 0xc000000
    v_lshlrev_b32 v29, 5, v1
    buffer_load_dwordx4 v[64:67], v29, s[12:15], s45 offen offset:0 sc1
    buffer_load_dwordx4 v[68:71], v29, s[12:15], s45 offen offset:16 sc1
    buffer_load_dwordx4 v[72:75], v29, s[12:15], s45 offen offset:2048 sc1
    buffer_load_dwordx4 v[76:79], v29, s[12:15], s45 offen offset:2064 sc1
    s_add_u32 s45, s45, 0x800000
    buffer_load_dwordx4 v[160:163], v29, s[12:15], s45 offen offset:0 sc1
    buffer_load_dwordx4 v[164:167], v29, s[12:15], s45 offen offset:16 sc1
    buffer_load_dwordx4 v[168:171], v29, s[12:15], s45 offen offset:2048 sc1
    buffer_load_dwordx4 v[172:175], v29, s[12:15], s45 offen offset:2064 sc1
    s_add_u32 s45, s45, 0x800000
    buffer_load_dwordx4 v[176:179], v29, s[12:15], s45 offen offset:0 sc1
    buffer_load_dwordx4 v[180:183], v29, s[12:15], s45 offen offset:16 sc1
    buffer_load_dwordx4 v[184:187], v29, s[12:15], s45 offen offset:2048 sc1
    buffer_load_dwordx4 v[188:191], v29, s[12:15], s45 offen offset:2064 sc1
    s_add_u32 s45, s45, 0x800000
    buffer_load_dwordx4 v[192:195], v29, s[12:15], s45 offen offset:0 sc1
    buffer_load_dwordx4 v[196:199], v29, s[12:15], s45 offen offset:16 sc1
    buffer_load_dwordx4 v[200:203], v29, s[12:15], s45 offen offset:2048 sc1
    buffer_load_dwordx4 v[204:207], v29, s[12:15], s45 offen offset:2064 sc1
    s_waitcnt vmcnt(0)
    v_pk_add_f32 v[64:65], v[64:65], v[160:161]
    v_pk_add_f32 v[176:177], v[176:177], v[192:193]
    v_pk_add_f32 v[66:67], v[66:67], v[162:163]
    v_pk_add_f32 v[178:179], v[178:179], v[194:195]
    v_pk_add_f32 v[68:69], v[68:69], v[164:165]
    v_pk_add_f32 v[180:181], v[180:181], v[196:197]
    v_pk_add_f32 v[70:71], v[70:71], v[166:167]
    v_pk_add_f32 v[182:183], v[182:183], v[198:199]
    v_pk_add_f32 v[72:73], v[72:73], v[168:169]
    v_pk_add_f32 v[184:185], v[184:185], v[200:201]
    v_pk_add_f32 v[74:75], v[74:75], v[170:171]
    v_pk_add_f32 v[186:187], v[186:187], v[202:203]
    v_pk_add_f32 v[76:77], v[76:77], v[172:173]
    v_pk_add_f32 v[188:189], v[188:189], v[204:205]
    v_pk_add_f32 v[78:79], v[78:79], v[174:175]
    v_pk_add_f32 v[190:191], v[190:191], v[206:207]
    v_pk_add_f32 v[64:65], v[64:65], v[176:177]
    v_pk_add_f32 v[66:67], v[66:67], v[178:179]
    v_pk_add_f32 v[68:69], v[68:69], v[180:181]
    v_pk_add_f32 v[70:71], v[70:71], v[182:183]
    v_pk_add_f32 v[72:73], v[72:73], v[184:185]
    v_pk_add_f32 v[74:75], v[74:75], v[186:187]
    v_pk_add_f32 v[76:77], v[76:77], v[188:189]
    v_pk_add_f32 v[78:79], v[78:79], v[190:191]
    v_cvt_pk_bf16_f32 v64, v64, v64
    v_lshlrev_b32 v64, 16, v64
    v_cvt_pk_bf16_f32 v65, v65, v65
    v_lshlrev_b32 v65, 16, v65
    v_cvt_pk_bf16_f32 v66, v66, v66
    v_lshlrev_b32 v66, 16, v66
    v_cvt_pk_bf16_f32 v67, v67, v67
    v_lshlrev_b32 v67, 16, v67
    v_cvt_pk_bf16_f32 v68, v68, v68
    v_lshlrev_b32 v68, 16, v68
    v_cvt_pk_bf16_f32 v69, v69, v69
    v_lshlrev_b32 v69, 16, v69
    v_cvt_pk_bf16_f32 v70, v70, v70
    v_lshlrev_b32 v70, 16, v70
    v_cvt_pk_bf16_f32 v71, v71, v71
    v_lshlrev_b32 v71, 16, v71
    v_cvt_pk_bf16_f32 v72, v72, v72
    v_lshlrev_b32 v72, 16, v72
    v_cvt_pk_bf16_f32 v73, v73, v73
    v_lshlrev_b32 v73, 16, v73
    v_cvt_pk_bf16_f32 v74, v74, v74
    v_lshlrev_b32 v74, 16, v74
    v_cvt_pk_bf16_f32 v75, v75, v75
    v_lshlrev_b32 v75, 16, v75
    v_cvt_pk_bf16_f32 v76, v76, v76
    v_lshlrev_b32 v76, 16, v76
    v_cvt_pk_bf16_f32 v77, v77, v77
    v_lshlrev_b32 v77, 16, v77
    v_cvt_pk_bf16_f32 v78, v78, v78
    v_lshlrev_b32 v78, 16, v78
    v_cvt_pk_bf16_f32 v79, v79, v79
    v_lshlrev_b32 v79, 16, v79
    v_lshlrev_b32 v160, 16, v208
    v_and_b32 v161, 0xffff0000, v208
    v_lshlrev_b32 v162, 16, v209
    v_and_b32 v163, 0xffff0000, v209
    v_lshlrev_b32 v164, 16, v210
    v_and_b32 v165, 0xffff0000, v210
    v_lshlrev_b32 v166, 16, v211
    v_and_b32 v167, 0xffff0000, v211
    v_lshlrev_b32 v168, 16, v212
    v_and_b32 v169, 0xffff0000, v212
    v_lshlrev_b32 v170, 16, v213
    v_and_b32 v171, 0xffff0000, v213
    v_lshlrev_b32 v172, 16, v214
    v_and_b32 v173, 0xffff0000, v214
    v_lshlrev_b32 v174, 16, v215
    v_and_b32 v175, 0xffff0000, v215
    v_add_f32 v64, v64, v96
    v_cvt_pk_bf16_f32 v64, v64, v64
    v_lshlrev_b32 v64, 16, v64
    v_mul_f32 v64, v64, v112
    v_cvt_pk_bf16_f32 v64, v64, v64
    v_lshlrev_b32 v64, 16, v64
    v_add_f32 v64, v64, v160
    v_add_f32 v65, v65, v97
    v_cvt_pk_bf16_f32 v65, v65, v65
    v_lshlrev_b32 v65, 16, v65
    v_mul_f32 v65, v65, v113
    v_cvt_pk_bf16_f32 v65, v65, v65
    v_lshlrev_b32 v65, 16, v65
    v_add_f32 v65, v65, v161
    v_add_f32 v66, v66, v98
    v_cvt_pk_bf16_f32 v66, v66, v66
    v_lshlrev_b32 v66, 16, v66
    v_mul_f32 v66, v66, v114
    v_cvt_pk_bf16_f32 v66, v66, v66
    v_lshlrev_b32 v66, 16, v66
    v_add_f32 v66, v66, v162
    v_add_f32 v67, v67, v99
    v_cvt_pk_bf16_f32 v67, v67, v67
    v_lshlrev_b32 v67, 16, v67
    v_mul_f32 v67, v67, v115
    v_cvt_pk_bf16_f32 v67, v67, v67
    v_lshlrev_b32 v67, 16, v67
    v_add_f32 v67, v67, v163
    v_add_f32 v68, v68, v100
    v_cvt_pk_bf16_f32 v68, v68, v68
    v_lshlrev_b32 v68, 16, v68
    v_mul_f32 v68, v68, v116
    v_cvt_pk_bf16_f32 v68, v68, v68
    v_lshlrev_b32 v68, 16, v68
    v_add_f32 v68, v68, v164
    v_add_f32 v69, v69, v101
    v_cvt_pk_bf16_f32 v69, v69, v69
    v_lshlrev_b32 v69, 16, v69
    v_mul_f32 v69, v69, v117
    v_cvt_pk_bf16_f32 v69, v69, v69
    v_lshlrev_b32 v69, 16, v69
    v_add_f32 v69, v69, v165
    v_add_f32 v70, v70, v102
    v_cvt_pk_bf16_f32 v70, v70, v70
    v_lshlrev_b32 v70, 16, v70
    v_mul_f32 v70, v70, v118
    v_cvt_pk_bf16_f32 v70, v70, v70
    v_lshlrev_b32 v70, 16, v70
    v_add_f32 v70, v70, v166
    v_add_f32 v71, v71, v103
    v_cvt_pk_bf16_f32 v71, v71, v71
    v_lshlrev_b32 v71, 16, v71
    v_mul_f32 v71, v71, v119
    v_cvt_pk_bf16_f32 v71, v71, v71
    v_lshlrev_b32 v71, 16, v71
    v_add_f32 v71, v71, v167
    v_add_f32 v72, v72, v104
    v_cvt_pk_bf16_f32 v72, v72, v72
    v_lshlrev_b32 v72, 16, v72
    v_mul_f32 v72, v72, v120
    v_cvt_pk_bf16_f32 v72, v72, v72
    v_lshlrev_b32 v72, 16, v72
    v_add_f32 v72, v72, v168
    v_add_f32 v73, v73, v105
    v_cvt_pk_bf16_f32 v73, v73, v73
    v_lshlrev_b32 v73, 16, v73
    v_mul_f32 v73, v73, v121
    v_cvt_pk_bf16_f32 v73, v73, v73
    v_lshlrev_b32 v73, 16, v73
    v_add_f32 v73, v73, v169
    v_add_f32 v74, v74, v106
    v_cvt_pk_bf16_f32 v74, v74, v74
    v_lshlrev_b32 v74, 16, v74
    v_mul_f32 v74, v74, v122
    v_cvt_pk_bf16_f32 v74, v74, v74
    v_lshlrev_b32 v74, 16, v74
    v_add_f32 v74, v74, v170
    v_add_f32 v75, v75, v107
    v_cvt_pk_bf16_f32 v75, v75, v75
    v_lshlrev_b32 v75, 16, v75
    v_mul_f32 v75, v75, v123
    v_cvt_pk_bf16_f32 v75, v75, v75
    v_lshlrev_b32 v75, 16, v75
    v_add_f32 v75, v75, v171
    v_add_f32 v76, v76, v108
    v_cvt_pk_bf16_f32 v76, v76, v76
    v_lshlrev_b32 v76, 16, v76
    v_mul_f32 v76, v76, v124
    v_cvt_pk_bf16_f32 v76, v76, v76
    v_lshlrev_b32 v76, 16, v76
    v_add_f32 v76, v76, v172
    v_add_f32 v77, v77, v109
    v_cvt_pk_bf16_f32 v77, v77, v77
    v_lshlrev_b32 v77, 16, v77
    v_mul_f32 v77, v77, v125
    v_cvt_pk_bf16_f32 v77, v77, v77
    v_lshlrev_b32 v77, 16, v77
    v_add_f32 v77, v77, v173
    v_add_f32 v78, v78, v110
    v_cvt_pk_bf16_f32 v78, v78, v78
    v_lshlrev_b32 v78, 16, v78
    v_mul_f32 v78, v78, v126
    v_cvt_pk_bf16_f32 v78, v78, v78
    v_lshlrev_b32 v78, 16, v78
    v_add_f32 v78, v78, v174
    v_add_f32 v79, v79, v111
    v_cvt_pk_bf16_f32 v79, v79, v79
    v_lshlrev_b32 v79, 16, v79
    v_mul_f32 v79, v79, v127
    v_cvt_pk_bf16_f32 v79, v79, v79
    v_lshlrev_b32 v79, 16, v79
    v_add_f32 v79, v79, v175
    v_cvt_pk_bf16_f32 v208, v64, v65
    v_cvt_pk_bf16_f32 v209, v66, v67
    v_cvt_pk_bf16_f32 v210, v68, v69
    v_cvt_pk_bf16_f32 v211, v70, v71
    v_cvt_pk_bf16_f32 v212, v72, v73
    v_cvt_pk_bf16_f32 v213, v74, v75
    v_cvt_pk_bf16_f32 v214, v76, v77
    v_cvt_pk_bf16_f32 v215, v78, v79
    buffer_store_dwordx4 v[208:211], v10, s[32:35], s47 offen
    buffer_store_dwordx4 v[212:215], v10, s[32:35], s47 offen offset:1024
    s_branch L_c_loop_164
L_w_done_98:
    s_endpgm
.section .rodata,"a"
.p2align 6
.amdhsa_kernel adaLN_cond__memory_aug_recurrent_mem_tr__dense_activation_gelu__prompt_kernel
  .amdhsa_next_free_vgpr 512
  .amdhsa_next_free_sgpr 102
  .amdhsa_accum_offset 256
  .amdhsa_group_segment_fixed_size 0
  .amdhsa_kernarg_size 136
  .amdhsa_user_sgpr_count 2
  .amdhsa_user_sgpr_kernarg_segment_ptr 1
  .amdhsa_system_sgpr_workgroup_id_x 1
.end_amdhsa_kernel
```

```asm
; @launch kernel=adaLN_cond__memory_aug_recurrent_mem_tr__dense_activation_gelu__prompt_kernel grid=(256,1,1) block=(256,1,1) lds=163840
.amdgcn_target "amdgcn-amd-amdhsa--gfx950"
.text
.globl adaLN_cond__memory_aug_recurrent_mem_tr__dense_activation_gelu__prompt_kernel
.p2align 8
.type adaLN_cond__memory_aug_recurrent_mem_tr__dense_activation_gelu__prompt_kernel,@function
adaLN_cond__memory_aug_recurrent_mem_tr__dense_activation_gelu__prompt_kernel:
    s_cmp_lt_u32 s2, 256
    s_cbranch_scc1 L_c_done_1_go
    s_endpgm
L_c_done_1_go:
    s_and_b32 s40, s2, 7
    s_load_dwordx4 s[4:7], s[0:1], 16
    s_load_dwordx4 s[8:11], s[0:1], 32
    s_load_dwordx2 s[20:21], s[0:1], 128
    s_load_dwordx2 s[22:23], s[0:1], 120
    s_load_dwordx2 s[50:51], s[0:1], 8
    s_lshr_b32 s41, s2, 3
    s_and_b32 s42, s41, 15
    v_and_b32 v1, 63, v0
    v_lshrrev_b32 v2, 6, v0
    s_nop 0
    v_readfirstlane_b32 s44, v2
    s_waitcnt lgkmcnt(0)
    s_mov_b32 s24, s4
    s_and_b32 s25, s5, 0xffff
    s_mov_b32 s26, 0x800000
    s_mov_b32 s27, 0x00020000
    s_mov_b32 s28, s6
    s_and_b32 s29, s7, 0xffff
    s_mov_b32 s30, 0x800000
    s_mov_b32 s31, 0x00020000
    s_mov_b32 s32, s8
    s_and_b32 s33, s9, 0xffff
    s_mov_b32 s34, 0x800000
    s_mov_b32 s35, 0x00020000
    s_mov_b32 s36, s10
    s_and_b32 s37, s11, 0xffff
    s_mov_b32 s38, 0x800000
    s_mov_b32 s39, 0x00020000
    s_mov_b32 s12, s20
    s_and_b32 s13, s21, 0xffff
    s_mov_b32 s14, 0x10000000
    s_mov_b32 s15, 0x00020000
    s_mov_b32 s16, s22
    s_and_b32 s17, s23, 0xffff
    s_mov_b32 s18, 0x100
    s_mov_b32 s19, 0x00020000
    s_mov_b32 s52, s50
    s_and_b32 s53, s51, 0xffff
    s_mov_b32 s54, 0x4000
    s_mov_b32 s55, 0x00020000
    v_mov_b32 v41, 0
    s_cmp_lg_u32 s2, 1
    s_cbranch_scc1 L_worker_3_a
    s_getreg_b32 s45, hwreg(HW_REG_XCC_ID)
    s_and_b32 s45, s45, 1
    s_add_u32 s45, s45, 1
    v_mov_b32 v40, s45
    buffer_store_dword v40, v41, s[16:19], 0 offen offset:24 sc1
L_worker_3_a:
    s_cmp_eq_u32 s40, 1
    s_cbranch_scc1 L_worker_3_g0
    s_cmp_lt_u32 s40, 3
    s_cbranch_scc1 L_worker_3_q
    s_sub_u32 s40, s40, 2
    s_branch L_worker_3
L_worker_3_q:
    s_mov_b32 s70, 0
L_worker_3_p:
    buffer_load_dword v40, v41, s[16:19], 0 offen offset:24 sc1
    s_add_u32 s70, s70, 1
    s_cmp_ge_u32 s70, 0x200000
    s_cbranch_scc1 L_c_done_1
    s_waitcnt vmcnt(0)
    v_readfirstlane_b32 s45, v40
    s_nop 3
    s_cmp_eq_u32 s45, 0
    s_cbranch_scc1 L_worker_3_p
    s_and_b32 s45, s45, 2
    s_cmp_lg_u32 s45, s40
    s_mov_b32 s40, 1
    s_cbranch_scc1 L_worker_3_no
    s_mov_b32 s40, 0
    s_branch L_worker_3
L_worker_3_g0:
    s_mov_b32 s40, 0
L_worker_3_no:
    s_lshl_b32 s43, s40, 4
    s_add_u32 s43, s43, s42
    s_lshl_b32 s3, s43, 7
    s_lshr_b32 s45, s41, 4
    s_lshl_b32 s45, s45, 4
    s_add_u32 s3, s3, s45
    s_lshl_b32 s45, s44, 2
    s_add_u32 s3, s3, s45
    s_add_u32 s3, s3, 0x11000
    v_and_b32 v21, 8, v1
    v_cmp_eq_u32 s[56:57], 0, v21
    v_mov_b32 v2, 0xeeee
    v_mov_b32 v3, 0x4444
    v_cndmask_b32 v2, v2, v3, s[56:57]
    v_lshlrev_b32 v68, 4, v1
    s_lshl_b32 s45, s44, 12
    v_add_u32 v3, s45, v68
    v_add_u32 v4, 4096, v3
    v_and_b32 v4, 16383, v4
    v_add_u32 v21, 8192, v3
    v_and_b32 v21, 16383, v21
    v_add_u32 v23, 12288, v3
    v_and_b32 v23, 16383, v23
    s_mul_i32 s45, s44, 24576
    s_add_u32 s45, s45, 65536
    v_add_u32 v5, s45, v68
    v_lshrrev_b32 v63, 4, v1
    s_lshl_b32 s45, s44, 2
    v_add_u32 v64, s45, v63
    s_lshr_b32 s45, s44, 1
    s_lshl_b32 s45, s45, 2
    v_add_u32 v65, s45, v63
    v_bfe_u32 v66, v1, 1, 3
    v_xor_b32 v66, v66, v65
    v_lshlrev_b32 v66, 5, v66
    v_and_b32 v67, 1, v1
    v_lshlrev_b32 v67, 4, v67
    v_add_u32 v66, v66, v67
    v_lshlrev_b32 v64, 13, v64
    v_add_u32 v82, v64, v66
    s_lshl_b32 s47, s43, 8
    s_lshl_b32 s48, s44, 10
    v_bfe_u32 v64, v1, 2, 2
    v_bfe_u32 v65, v1, 4, 1
    v_lshlrev_b32 v65, 2, v65
    v_add_u32 v65, v65, v64
    v_lshlrev_b32 v66, 3, v63
    v_add_u32 v66, v66, v64
    v_lshlrev_b32 v66, 8, v66
    v_and_b32 v67, 3, v1
    v_lshlrev_b32 v67, 3, v67
    v_add_u32 v66, v66, v67
    s_lshl_b32 s45, s44, 1
    v_xor_b32 v65, s45, v65
    v_lshlrev_b32 v65, 5, v65
    v_add_u32 v80, v66, v65
    v_xor_b32 v81, 32, v80
    v_lshrrev_b32 v64, 5, v1
    v_mul_u32_u24 v64, 20480, v64
    v_add_u32 v64, 65536, v64
    v_add_u32 v84, v64, v80
    v_add_u32 v85, v64, v81
    v_add_u32 v86, 49152, v84
    v_add_u32 v87, 49152, v85
    v_mov_b32 v40, -1
    v_mov_b32 v41, -1
    v_mov_b32 v42, -1
    v_mov_b32 v43, -1
    v_mov_b32 v44, 0
    s_mov_b32 s68, 0
    s_cmp_ge_u32 s41, 16
    s_cbranch_scc1 L_c_vo_2
    s_lshl_b32 s45, s42, 11
    s_lshr_b32 s46, s44, 1
    s_lshl_b32 s46, s46, 10
    s_add_u32 s45, s45, s46
    s_and_b32 s46, s44, 1
    s_lshl_b32 s46, s46, 7
    s_add_u32 s45, s45, s46
    v_add_u32 v17, s45, v68
    v_mov_b32 v63, 0x20000000
    v_cndmask_b32 v17, v63, v17, s[56:57]
    s_lshl_b32 s62, s40, 17
    s_add_u32 s62, s62, 0x7040000
    s_add_u32 s63, s62, 0
    buffer_store_dwordx4 v[40:43], v17, s[12:15], s63 offen sc1
    s_add_u32 s63, s62, 32768
    buffer_store_dwordx4 v[40:43], v17, s[12:15], s63 offen sc1
    s_add_u32 s63, s62, 65536
    buffer_store_dwordx4 v[40:43], v17, s[12:15], s63 offen sc1
    s_add_u32 s63, s62, 98304
    buffer_store_dwordx4 v[40:43], v17, s[12:15], s63 offen sc1
    s_mov_b64 exec, -1
    s_lshl_b32 s45, s40, 12
    s_lshl_b32 s46, s42, 4
    s_add_u32 s45, s45, s46
    s_add_u32 s45, s45, 0x7080000
    s_lshl_b32 s46, s44, 2
    s_add_u32 s45, s45, s46
    v_lshlrev_b32 v20, 8, v1
    v_add_u32 v20, s45, v20
    v_cmp_gt_u32 vcc, 16, v1
    s_nop 1
    v_cndmask_b32 v20, v63, v20, vcc
    buffer_store_dword v44, v20, s[12:15], 0 offen sc1
    s_lshl_b32 s45, s43, 7
    s_add_u32 s45, s45, 0x10010
    v_lshlrev_b32 v64, 2, v1
    s_mov_b64 exec, 0xff
    buffer_store_dword v44, v64, s[12:15], s45 offen sc1
    s_mov_b64 exec, 1
    v_mov_b32 v65, 63
    buffer_store_dword v44, v64, s[12:15], s3 offen sc1
    buffer_store_dword v65, v64, s[12:15], s3 offen offset:16 sc1
    s_mov_b64 exec, 0xffff
    v_lshlrev_b32 v64, 7, v1
    s_cmp_eq_u32 s2, 1
    s_mov_b32 s45, 0x1f000
    s_cselect_b32 s45, s45, 0x20000000
    buffer_store_dword v44, v64, s[12:15], s45 offen sc1
    s_mov_b64 exec, -1
    s_add_u32 s79, s41, 0
    s_and_b32 s79, s79, 3
    s_lshl_b32 s79, s79, 19
    s_add_u32 s79, s79, s47
    s_add_u32 s46, s79, 0x0
    s_add_u32 m0, s48, 69632
    s_nop 0
    buffer_load_dwordx4 v82, s[24:27], s46 offen  lds
    s_add_u32 s46, s79, 0x20000
    s_add_u32 m0, s48, 94208
    s_nop 0
    buffer_load_dwordx4 v82, s[24:27], s46 offen  lds
    s_add_u32 s46, s79, 0x40000
    s_add_u32 m0, s48, 118784
    s_nop 0
    buffer_load_dwordx4 v82, s[24:27], s46 offen  lds
    s_add_u32 s46, s79, 0x60000
    s_add_u32 m0, s48, 143360
    s_nop 0
    buffer_load_dwordx4 v82, s[24:27], s46 offen  lds
    s_add_u32 s79, s41, 1
    s_and_b32 s79, s79, 3
    s_lshl_b32 s79, s79, 19
    s_add_u32 s79, s79, s47
    s_add_u32 s46, s79, 0x0
    s_add_u32 m0, s48, 73728
    s_nop 0
    buffer_load_dwordx4 v82, s[24:27], s46 offen  lds
    s_add_u32 s46, s79, 0x20000
    s_add_u32 m0, s48, 98304
    s_nop 0
    buffer_load_dwordx4 v82, s[24:27], s46 offen  lds
    s_add_u32 s46, s79, 0x40000
    s_add_u32 m0, s48, 122880
    s_nop 0
    buffer_load_dwordx4 v82, s[24:27], s46 offen  lds
    s_add_u32 s46, s79, 0x60000
    s_add_u32 m0, s48, 147456
    s_nop 0
    buffer_load_dwordx4 v82, s[24:27], s46 offen  lds
    s_add_u32 s79, s41, 2
    s_and_b32 s79, s79, 3
    s_lshl_b32 s79, s79, 19
    s_add_u32 s79, s79, s47
    s_add_u32 s46, s79, 0x0
    s_add_u32 m0, s48, 81920
    s_nop 0
    buffer_load_dwordx4 v82, s[24:27], s46 offen  lds
    s_add_u32 s46, s79, 0x20000
    s_add_u32 m0, s48, 106496
    s_nop 0
    buffer_load_dwordx4 v82, s[24:27], s46 offen  lds
    s_add_u32 s46, s79, 0x40000
    s_add_u32 m0, s48, 131072
    s_nop 0
    buffer_load_dwordx4 v82, s[24:27], s46 offen  lds
    s_add_u32 s46, s79, 0x60000
    s_add_u32 m0, s48, 155648
    s_nop 0
    buffer_load_dwordx4 v82, s[24:27], s46 offen  lds
    s_add_u32 s79, s41, 3
    s_and_b32 s79, s79, 3
    s_lshl_b32 s79, s79, 19
    s_add_u32 s79, s79, s47
    s_add_u32 s46, s79, 0x0
    s_add_u32 m0, s48, 86016
    s_nop 0
    buffer_load_dwordx4 v82, s[24:27], s46 offen  lds
    s_add_u32 s46, s79, 0x20000
    s_add_u32 m0, s48, 110592
    s_nop 0
    buffer_load_dwordx4 v82, s[24:27], s46 offen  lds
    s_add_u32 s46, s79, 0x40000
    s_add_u32 m0, s48, 135168
    s_nop 0
    buffer_load_dwordx4 v82, s[24:27], s46 offen  lds
    s_add_u32 s46, s79, 0x60000
    s_add_u32 m0, s48, 159744
    s_nop 0
    buffer_load_dwordx4 v82, s[24:27], s46 offen  lds
    s_add_u32 s79, s41, 4
    s_and_b32 s79, s79, 3
    s_lshl_b32 s79, s79, 19
    s_add_u32 s79, s79, s47
    s_add_u32 s46, s79, 0x200000
    s_add_u32 m0, s48, 0
    s_nop 0
    buffer_load_dwordx4 v82, s[24:27], s46 offen  lds
    s_add_u32 s46, s79, 0x220000
    s_add_u32 m0, s48, 4096
    s_nop 0
    buffer_load_dwordx4 v82, s[24:27], s46 offen  lds
    s_add_u32 s46, s79, 0x240000
    s_add_u32 m0, s48, 8192
    s_nop 0
    buffer_load_dwordx4 v82, s[24:27], s46 offen  lds
    s_add_u32 s46, s79, 0x260000
    s_add_u32 m0, s48, 12288
    s_nop 0
    buffer_load_dwordx4 v82, s[24:27], s46 offen  lds
    s_add_u32 s79, s41, 5
    s_and_b32 s79, s79, 3
    s_lshl_b32 s79, s79, 19
    s_add_u32 s79, s79, s47
    s_add_u32 s46, s79, 0x200000
    s_add_u32 m0, s48, 16384
    s_nop 0
    buffer_load_dwordx4 v82, s[24:27], s46 offen  lds
    s_add_u32 s46, s79, 0x220000
    s_add_u32 m0, s48, 20480
    s_nop 0
    buffer_load_dwordx4 v82, s[24:27], s46 offen  lds
    s_add_u32 s46, s79, 0x240000
    s_add_u32 m0, s48, 24576
    s_nop 0
    buffer_load_dwordx4 v82, s[24:27], s46 offen  lds
    s_add_u32 s46, s79, 0x260000
    s_add_u32 m0, s48, 28672
    s_nop 0
    buffer_load_dwordx4 v82, s[24:27], s46 offen  lds
    s_add_u32 s79, s41, 6
    s_and_b32 s79, s79, 3
    s_lshl_b32 s79, s79, 19
    s_add_u32 s79, s79, s47
    s_add_u32 s46, s79, 0x200000
    s_add_u32 m0, s48, 32768
    s_nop 0
    buffer_load_dwordx4 v82, s[24:27], s46 offen  lds
    s_add_u32 s46, s79, 0x220000
    s_add_u32 m0, s48, 36864
    s_nop 0
    buffer_load_dwordx4 v82, s[24:27], s46 offen  lds
    s_add_u32 s46, s79, 0x240000
    s_add_u32 m0, s48, 40960
    s_nop 0
    buffer_load_dwordx4 v82, s[24:27], s46 offen  lds
    s_add_u32 s46, s79, 0x260000
    s_add_u32 m0, s48, 45056
    s_nop 0
    buffer_load_dwordx4 v82, s[24:27], s46 offen  lds
    s_add_u32 s79, s41, 7
    s_and_b32 s79, s79, 3
    s_lshl_b32 s79, s79, 19
    s_add_u32 s79, s79, s47
    s_add_u32 s46, s79, 0x200000
    s_add_u32 m0, s48, 49152
    s_nop 0
    buffer_load_dwordx4 v82, s[24:27], s46 offen  lds
    s_add_u32 s46, s79, 0x220000
    s_add_u32 m0, s48, 53248
    s_nop 0
    buffer_load_dwordx4 v82, s[24:27], s46 offen  lds
    s_add_u32 s46, s79, 0x240000
    s_add_u32 m0, s48, 57344
    s_nop 0
    buffer_load_dwordx4 v82, s[24:27], s46 offen  lds
    s_add_u32 s46, s79, 0x260000
    s_add_u32 m0, s48, 61440
    s_nop 0
    buffer_load_dwordx4 v82, s[24:27], s46 offen  lds
    s_waitcnt vmcnt(28)
    s_barrier
    s_cmp_lg_u32 s44, 0
    s_cbranch_scc1 L_lw_4_0
    ds_read_b64_tr_b16 a[0:1], v84 offset:4096
    ds_read_b64_tr_b16 a[2:3], v84 offset:5120
    ds_read_b64_tr_b16 a[4:5], v86 offset:4096
    ds_read_b64_tr_b16 a[6:7], v86 offset:5120
    ds_read_b64_tr_b16 a[8:9], v85 offset:4096
    ds_read_b64_tr_b16 a[10:11], v85 offset:5120
    ds_read_b64_tr_b16 a[12:13], v87 offset:4096
    ds_read_b64_tr_b16 a[14:15], v87 offset:5120
    s_branch L_lw_4
L_lw_4_0:
    s_cmp_lg_u32 s44, 1
    s_cbranch_scc1 L_lw_4_1
    ds_read_b64_tr_b16 v[128:129], v84 offset:4096
    ds_read_b64_tr_b16 v[130:131], v84 offset:5120
    ds_read_b64_tr_b16 v[132:133], v86 offset:4096
    ds_read_b64_tr_b16 v[134:135], v86 offset:5120
    ds_read_b64_tr_b16 v[136:137], v85 offset:4096
    ds_read_b64_tr_b16 v[138:139], v85 offset:5120
    ds_read_b64_tr_b16 v[140:141], v87 offset:4096
    ds_read_b64_tr_b16 v[142:143], v87 offset:5120
    s_branch L_lw_4
L_lw_4_1:
    s_cmp_lg_u32 s44, 2
    s_cbranch_scc1 L_lw_4_2
    ds_read_b64_tr_b16 a[192:193], v84 offset:4096
    ds_read_b64_tr_b16 a[194:195], v84 offset:5120
    ds_read_b64_tr_b16 a[196:197], v86 offset:4096
    ds_read_b64_tr_b16 a[198:199], v86 offset:5120
    ds_read_b64_tr_b16 v[56:57], v85 offset:4096
    ds_read_b64_tr_b16 v[58:59], v85 offset:5120
    ds_read_b64_tr_b16 v[60:61], v87 offset:4096
    ds_read_b64_tr_b16 v[62:63], v87 offset:5120
    s_waitcnt lgkmcnt(0)
    ds_write_b128 v5, v[56:59] offset:0
    ds_write_b128 v5, v[60:63] offset:1024
    s_branch L_lw_4
L_lw_4_2:
    ds_read_b64_tr_b16 a[96:97], v84 offset:4096
    ds_read_b64_tr_b16 a[98:99], v84 offset:5120
    ds_read_b64_tr_b16 a[100:101], v86 offset:4096
    ds_read_b64_tr_b16 a[102:103], v86 offset:5120
    ds_read_b64_tr_b16 v[56:57], v85 offset:4096
    ds_read_b64_tr_b16 v[58:59], v85 offset:5120
    ds_read_b64_tr_b16 v[60:61], v87 offset:4096
    ds_read_b64_tr_b16 v[62:63], v87 offset:5120
    s_waitcnt lgkmcnt(0)
    ds_write_b128 v5, v[56:59] offset:2048
    ds_write_b128 v5, v[60:63] offset:3072
L_lw_4:
    s_waitcnt lgkmcnt(0)
    s_waitcnt vmcnt(24)
    s_barrier
    s_cmp_lg_u32 s44, 0
    s_cbranch_scc1 L_hs_5
    s_getreg_b32 s45, hwreg(HW_REG_XCC_ID)
    s_and_b32 s45, s45, 15
    s_mul_i32 s46, s45, s45
    s_lshl_b32 s46, s46, 9
    s_add_u32 s45, s45, s46
    s_cmp_eq_u32 s40, 0
    s_cselect_b32 s46, s45, 0
    s_cselect_b32 s45, 0, s45
    s_lshl_b32 s68, s68, 24
    s_add_u32 s46, s46, s68
    s_add_u32 s45, s45, 16777216
    v_mov_b32 v40, s46
    v_mov_b32 v41, s45
    v_mov_b32 v42, 0
    s_mov_b64 exec, 1
    buffer_atomic_add_x2 v[40:41], v42, s[16:19], 0 offen sc1
    v_mov_b32 v43, 1
    buffer_atomic_add v43, v42, s[16:19], 0 offen offset:8 sc1
    s_mov_b64 exec, -1
L_hs_5:
    s_cmp_lg_u32 s44, 0
    s_cbranch_scc1 L_lw_6_0
    ds_read_b64_tr_b16 a[32:33], v84 offset:8192
    ds_read_b64_tr_b16 a[34:35], v84 offset:9216
    ds_read_b64_tr_b16 a[36:37], v86 offset:8192
    ds_read_b64_tr_b16 a[38:39], v86 offset:9216
    ds_read_b64_tr_b16 a[40:41], v85 offset:8192
    ds_read_b64_tr_b16 a[42:43], v85 offset:9216
    ds_read_b64_tr_b16 a[44:45], v87 offset:8192
    ds_read_b64_tr_b16 a[46:47], v87 offset:9216
    s_branch L_lw_6
L_lw_6_0:
    s_cmp_lg_u32 s44, 1
    s_cbranch_scc1 L_lw_6_1
    ds_read_b64_tr_b16 v[160:161], v84 offset:8192
    ds_read_b64_tr_b16 v[162:163], v84 offset:9216
    ds_read_b64_tr_b16 v[164:165], v86 offset:8192
    ds_read_b64_tr_b16 v[166:167], v86 offset:9216
    ds_read_b64_tr_b16 v[168:169], v85 offset:8192
    ds_read_b64_tr_b16 v[170:171], v85 offset:9216
    ds_read_b64_tr_b16 v[172:173], v87 offset:8192
    ds_read_b64_tr_b16 v[174:175], v87 offset:9216
    s_branch L_lw_6
L_lw_6_1:
    s_cmp_lg_u32 s44, 2
    s_cbranch_scc1 L_lw_6_2
    ds_read_b64_tr_b16 a[216:217], v84 offset:8192
    ds_read_b64_tr_b16 a[218:219], v84 offset:9216
    ds_read_b64_tr_b16 a[220:221], v86 offset:8192
    ds_read_b64_tr_b16 a[222:223], v86 offset:9216
    ds_read_b64_tr_b16 v[56:57], v85 offset:8192
    ds_read_b64_tr_b16 v[58:59], v85 offset:9216
    ds_read_b64_tr_b16 v[60:61], v87 offset:8192
    ds_read_b64_tr_b16 v[62:63], v87 offset:9216
    s_waitcnt lgkmcnt(0)
    ds_write_b128 v5, v[56:59] offset:4096
    ds_write_b128 v5, v[60:63] offset:5120
    s_branch L_lw_6
L_lw_6_2:
    ds_read_b64_tr_b16 a[120:121], v84 offset:8192
    ds_read_b64_tr_b16 a[122:123], v84 offset:9216
    ds_read_b64_tr_b16 a[124:125], v86 offset:8192
    ds_read_b64_tr_b16 a[126:127], v86 offset:9216
    ds_read_b64_tr_b16 v[56:57], v85 offset:8192
    ds_read_b64_tr_b16 v[58:59], v85 offset:9216
    ds_read_b64_tr_b16 v[60:61], v87 offset:8192
    ds_read_b64_tr_b16 v[62:63], v87 offset:9216
    s_waitcnt lgkmcnt(0)
    ds_write_b128 v5, v[56:59] offset:6144
    ds_write_b128 v5, v[60:63] offset:7168
L_lw_6:
    s_waitcnt lgkmcnt(0)
    s_waitcnt vmcnt(20)
    s_barrier
    s_cmp_lg_u32 s44, 0
    s_cbranch_scc1 L_lw_7_0
    ds_read_b64_tr_b16 a[64:65], v84 offset:16384
    ds_read_b64_tr_b16 a[66:67], v84 offset:17408
    ds_read_b64_tr_b16 a[68:69], v86 offset:16384
    ds_read_b64_tr_b16 a[70:71], v86 offset:17408
    ds_read_b64_tr_b16 v[56:57], v85 offset:16384
    ds_read_b64_tr_b16 v[58:59], v85 offset:17408
    ds_read_b64_tr_b16 v[60:61], v87 offset:16384
    ds_read_b64_tr_b16 v[62:63], v87 offset:17408
    s_waitcnt lgkmcnt(0)
    ds_write_b128 v5, v[56:59] offset:8192
    ds_write_b128 v5, v[60:63] offset:9216
    s_branch L_lw_7
L_lw_7_0:
    s_cmp_lg_u32 s44, 1
    s_cbranch_scc1 L_lw_7_1
    ds_read_b64_tr_b16 v[192:193], v84 offset:16384
    ds_read_b64_tr_b16 v[194:195], v84 offset:17408
    ds_read_b64_tr_b16 v[196:197], v86 offset:16384
    ds_read_b64_tr_b16 v[198:199], v86 offset:17408
    ds_read_b64_tr_b16 v[200:201], v85 offset:16384
    ds_read_b64_tr_b16 v[202:203], v85 offset:17408
    ds_read_b64_tr_b16 v[204:205], v87 offset:16384
    ds_read_b64_tr_b16 v[206:207], v87 offset:17408
    s_branch L_lw_7
L_lw_7_1:
    s_cmp_lg_u32 s44, 2
    s_cbranch_scc1 L_lw_7_2
    ds_read_b64_tr_b16 a[240:241], v84 offset:16384
    ds_read_b64_tr_b16 a[242:243], v84 offset:17408
    ds_read_b64_tr_b16 a[244:245], v86 offset:16384
    ds_read_b64_tr_b16 a[246:247], v86 offset:17408
    ds_read_b64_tr_b16 v[56:57], v85 offset:16384
    ds_read_b64_tr_b16 v[58:59], v85 offset:17408
    ds_read_b64_tr_b16 v[60:61], v87 offset:16384
    ds_read_b64_tr_b16 v[62:63], v87 offset:17408
    s_waitcnt lgkmcnt(0)
    ds_write_b128 v5, v[56:59] offset:10240
    ds_write_b128 v5, v[60:63] offset:11264
    s_branch L_lw_7
L_lw_7_2:
    ds_read_b64_tr_b16 a[144:145], v84 offset:16384
    ds_read_b64_tr_b16 a[146:147], v84 offset:17408
    ds_read_b64_tr_b16 a[148:149], v86 offset:16384
    ds_read_b64_tr_b16 a[150:151], v86 offset:17408
    ds_read_b64_tr_b16 v[56:57], v85 offset:16384
    ds_read_b64_tr_b16 v[58:59], v85 offset:17408
    ds_read_b64_tr_b16 v[60:61], v87 offset:16384
    ds_read_b64_tr_b16 v[62:63], v87 offset:17408
    s_waitcnt lgkmcnt(0)
    ds_write_b128 v5, v[56:59] offset:12288
    ds_write_b128 v5, v[60:63] offset:13312
L_lw_7:
    s_waitcnt lgkmcnt(0)
    s_waitcnt vmcnt(16)
    s_barrier
    s_cmp_lg_u32 s44, 0
    s_cbranch_scc1 L_lw_8_0
    ds_read_b64_tr_b16 a[80:81], v84 offset:20480
    ds_read_b64_tr_b16 a[82:83], v84 offset:21504
    ds_read_b64_tr_b16 a[84:85], v86 offset:20480
    ds_read_b64_tr_b16 a[86:87], v86 offset:21504
    ds_read_b64_tr_b16 v[56:57], v85 offset:20480
    ds_read_b64_tr_b16 v[58:59], v85 offset:21504
    ds_read_b64_tr_b16 v[60:61], v87 offset:20480
    ds_read_b64_tr_b16 v[62:63], v87 offset:21504
    s_waitcnt lgkmcnt(0)
    ds_write_b128 v5, v[56:59] offset:14336
    ds_write_b128 v5, v[60:63] offset:15360
    s_branch L_lw_8
L_lw_8_0:
    s_cmp_lg_u32 s44, 1
    s_cbranch_scc1 L_lw_8_1
    ds_read_b64_tr_b16 v[224:225], v84 offset:20480
    ds_read_b64_tr_b16 v[226:227], v84 offset:21504
    ds_read_b64_tr_b16 v[228:229], v86 offset:20480
    ds_read_b64_tr_b16 v[230:231], v86 offset:21504
    ds_read_b64_tr_b16 v[232:233], v85 offset:20480
    ds_read_b64_tr_b16 v[234:235], v85 offset:21504
    ds_read_b64_tr_b16 v[236:237], v87 offset:20480
    ds_read_b64_tr_b16 v[238:239], v87 offset:21504
    s_branch L_lw_8
L_lw_8_1:
    s_cmp_lg_u32 s44, 2
    s_cbranch_scc1 L_lw_8_2
    ds_read_b64_tr_b16 v[104:105], v84 offset:20480
    ds_read_b64_tr_b16 v[106:107], v84 offset:21504
    ds_read_b64_tr_b16 v[108:109], v86 offset:20480
    ds_read_b64_tr_b16 v[110:111], v86 offset:21504
    ds_read_b64_tr_b16 v[56:57], v85 offset:20480
    ds_read_b64_tr_b16 v[58:59], v85 offset:21504
    ds_read_b64_tr_b16 v[60:61], v87 offset:20480
    ds_read_b64_tr_b16 v[62:63], v87 offset:21504
    s_waitcnt lgkmcnt(0)
    ds_write_b128 v5, v[56:59] offset:16384
    ds_write_b128 v5, v[60:63] offset:17408
    s_branch L_lw_8
L_lw_8_2:
    ds_read_b64_tr_b16 a[168:169], v84 offset:20480
    ds_read_b64_tr_b16 a[170:171], v84 offset:21504
    ds_read_b64_tr_b16 a[172:173], v86 offset:20480
    ds_read_b64_tr_b16 a[174:175], v86 offset:21504
    ds_read_b64_tr_b16 v[56:57], v85 offset:20480
    ds_read_b64_tr_b16 v[58:59], v85 offset:21504
    ds_read_b64_tr_b16 v[60:61], v87 offset:20480
    ds_read_b64_tr_b16 v[62:63], v87 offset:21504
    s_waitcnt lgkmcnt(0)
    ds_write_b128 v5, v[56:59] offset:18432
    ds_write_b128 v5, v[60:63] offset:19456
L_lw_8:
    s_waitcnt lgkmcnt(0)
    s_waitcnt vmcnt(12)
    s_barrier
    s_add_u32 s79, s41, 8
    s_and_b32 s79, s79, 3
    s_lshl_b32 s79, s79, 19
    s_add_u32 s79, s79, s47
    s_add_u32 s46, s79, 0x400000
    s_add_u32 m0, s48, 86016
    s_nop 0
    buffer_load_dwordx4 v82, s[24:27], s46 offen  lds
    s_add_u32 s46, s79, 0x420000
    s_add_u32 m0, s48, 110592
    s_nop 0
    buffer_load_dwordx4 v82, s[24:27], s46 offen  lds
    s_add_u32 s46, s79, 0x440000
    s_add_u32 m0, s48, 135168
    s_nop 0
    buffer_load_dwordx4 v82, s[24:27], s46 offen  lds
    s_add_u32 s46, s79, 0x460000
    s_add_u32 m0, s48, 159744
    s_nop 0
    buffer_load_dwordx4 v82, s[24:27], s46 offen  lds
    s_cmp_lg_u32 s44, 0
    s_cbranch_scc1 L_lw_9_0
    ds_read_b64_tr_b16 a[96:97], v80 offset:0
    ds_read_b64_tr_b16 a[98:99], v80 offset:1024
    ds_read_b64_tr_b16 a[100:101], v80 offset:8192
    ds_read_b64_tr_b16 a[102:103], v80 offset:9216
    ds_read_b64_tr_b16 v[56:57], v81 offset:0
    ds_read_b64_tr_b16 v[58:59], v81 offset:1024
    ds_read_b64_tr_b16 v[60:61], v81 offset:8192
    ds_read_b64_tr_b16 v[62:63], v81 offset:9216
    s_waitcnt lgkmcnt(0)
    ds_write_b128 v5, v[56:59] offset:2048
    ds_write_b128 v5, v[60:63] offset:3072
    s_branch L_lw_9
L_lw_9_0:
    s_cmp_lg_u32 s44, 1
    s_cbranch_scc1 L_lw_9_1
    ds_read_b64_tr_b16 a[0:1], v80 offset:0
    ds_read_b64_tr_b16 a[2:3], v80 offset:1024
    ds_read_b64_tr_b16 a[4:5], v80 offset:8192
    ds_read_b64_tr_b16 a[6:7], v80 offset:9216
    ds_read_b64_tr_b16 a[8:9], v81 offset:0
    ds_read_b64_tr_b16 a[10:11], v81 offset:1024
    ds_read_b64_tr_b16 a[12:13], v81 offset:8192
    ds_read_b64_tr_b16 a[14:15], v81 offset:9216
    s_branch L_lw_9
L_lw_9_1:
    s_cmp_lg_u32 s44, 2
    s_cbranch_scc1 L_lw_9_2
    ds_read_b64_tr_b16 v[128:129], v80 offset:0
    ds_read_b64_tr_b16 v[130:131], v80 offset:1024
    ds_read_b64_tr_b16 v[132:133], v80 offset:8192
    ds_read_b64_tr_b16 v[134:135], v80 offset:9216
    ds_read_b64_tr_b16 v[136:137], v81 offset:0
    ds_read_b64_tr_b16 v[138:139], v81 offset:1024
    ds_read_b64_tr_b16 v[140:141], v81 offset:8192
    ds_read_b64_tr_b16 v[142:143], v81 offset:9216
    s_branch L_lw_9
L_lw_9_2:
    ds_read_b64_tr_b16 a[192:193], v80 offset:0
    ds_read_b64_tr_b16 a[194:195], v80 offset:1024
    ds_read_b64_tr_b16 a[196:197], v80 offset:8192
    ds_read_b64_tr_b16 a[198:199], v80 offset:9216
    ds_read_b64_tr_b16 v[56:57], v81 offset:0
    ds_read_b64_tr_b16 v[58:59], v81 offset:1024
    ds_read_b64_tr_b16 v[60:61], v81 offset:8192
    ds_read_b64_tr_b16 v[62:63], v81 offset:9216
    s_waitcnt lgkmcnt(0)
    ds_write_b128 v5, v[56:59] offset:0
    ds_write_b128 v5, v[60:63] offset:1024
L_lw_9:
    s_waitcnt lgkmcnt(0)
    s_waitcnt vmcnt(12)
    s_barrier
    s_add_u32 s79, s41, 9
    s_and_b32 s79, s79, 3
    s_lshl_b32 s79, s79, 19
    s_add_u32 s79, s79, s47
    s_add_u32 s46, s79, 0x400000
    s_add_u32 m0, s48, 0
    s_nop 0
    buffer_load_dwordx4 v82, s[24:27], s46 offen  lds
    s_add_u32 s46, s79, 0x420000
    s_add_u32 m0, s48, 4096
    s_nop 0
    buffer_load_dwordx4 v82, s[24:27], s46 offen  lds
    s_add_u32 s46, s79, 0x440000
    s_add_u32 m0, s48, 8192
    s_nop 0
    buffer_load_dwordx4 v82, s[24:27], s46 offen  lds
    s_add_u32 s46, s79, 0x460000
    s_add_u32 m0, s48, 12288
    s_nop 0
    buffer_load_dwordx4 v82, s[24:27], s46 offen  lds
    s_cmp_lg_u32 s44, 0
    s_cbranch_scc1 L_lw_10_0
    ds_read_b64_tr_b16 a[120:121], v80 offset:16384
    ds_read_b64_tr_b16 a[122:123], v80 offset:17408
    ds_read_b64_tr_b16 a[124:125], v80 offset:24576
    ds_read_b64_tr_b16 a[126:127], v80 offset:25600
    ds_read_b64_tr_b16 v[56:57], v81 offset:16384
    ds_read_b64_tr_b16 v[58:59], v81 offset:17408
    ds_read_b64_tr_b16 v[60:61], v81 offset:24576
    ds_read_b64_tr_b16 v[62:63], v81 offset:25600
    s_waitcnt lgkmcnt(0)
    ds_write_b128 v5, v[56:59] offset:6144
    ds_write_b128 v5, v[60:63] offset:7168
    s_branch L_lw_10
L_lw_10_0:
    s_cmp_lg_u32 s44, 1
    s_cbranch_scc1 L_lw_10_1
    ds_read_b64_tr_b16 a[32:33], v80 offset:16384
    ds_read_b64_tr_b16 a[34:35], v80 offset:17408
    ds_read_b64_tr_b16 a[36:37], v80 offset:24576
    ds_read_b64_tr_b16 a[38:39], v80 offset:25600
    ds_read_b64_tr_b16 a[40:41], v81 offset:16384
    ds_read_b64_tr_b16 a[42:43], v81 offset:17408
    ds_read_b64_tr_b16 a[44:45], v81 offset:24576
    ds_read_b64_tr_b16 a[46:47], v81 offset:25600
    s_branch L_lw_10
L_lw_10_1:
    s_cmp_lg_u32 s44, 2
    s_cbranch_scc1 L_lw_10_2
    ds_read_b64_tr_b16 v[160:161], v80 offset:16384
    ds_read_b64_tr_b16 v[162:163], v80 offset:17408
    ds_read_b64_tr_b16 v[164:165], v80 offset:24576
    ds_read_b64_tr_b16 v[166:167], v80 offset:25600
    ds_read_b64_tr_b16 v[168:169], v81 offset:16384
    ds_read_b64_tr_b16 v[170:171], v81 offset:17408
    ds_read_b64_tr_b16 v[172:173], v81 offset:24576
    ds_read_b64_tr_b16 v[174:175], v81 offset:25600
    s_branch L_lw_10
L_lw_10_2:
    ds_read_b64_tr_b16 a[216:217], v80 offset:16384
    ds_read_b64_tr_b16 a[218:219], v80 offset:17408
    ds_read_b64_tr_b16 a[220:221], v80 offset:24576
    ds_read_b64_tr_b16 a[222:223], v80 offset:25600
    ds_read_b64_tr_b16 v[56:57], v81 offset:16384
    ds_read_b64_tr_b16 v[58:59], v81 offset:17408
    ds_read_b64_tr_b16 v[60:61], v81 offset:24576
    ds_read_b64_tr_b16 v[62:63], v81 offset:25600
    s_waitcnt lgkmcnt(0)
    ds_write_b128 v5, v[56:59] offset:4096
    ds_write_b128 v5, v[60:63] offset:5120
L_lw_10:
    s_waitcnt lgkmcnt(0)
    s_waitcnt vmcnt(12)
    s_barrier
    s_add_u32 s79, s41, 10
    s_and_b32 s79, s79, 3
    s_lshl_b32 s79, s79, 19
    s_add_u32 s79, s79, s47
    s_add_u32 s46, s79, 0x400000
    s_add_u32 m0, s48, 16384
    s_nop 0
    buffer_load_dwordx4 v82, s[24:27], s46 offen  lds
    s_add_u32 s46, s79, 0x420000
    s_add_u32 m0, s48, 20480
    s_nop 0
    buffer_load_dwordx4 v82, s[24:27], s46 offen  lds
    s_add_u32 s46, s79, 0x440000
    s_add_u32 m0, s48, 24576
    s_nop 0
    buffer_load_dwordx4 v82, s[24:27], s46 offen  lds
    s_add_u32 s46, s79, 0x460000
    s_add_u32 m0, s48, 28672
    s_nop 0
    buffer_load_dwordx4 v82, s[24:27], s46 offen  lds
    s_cmp_lg_u32 s44, 0
    s_cbranch_scc1 L_lw_11_0
    ds_read_b64_tr_b16 a[144:145], v80 offset:32768
    ds_read_b64_tr_b16 a[146:147], v80 offset:33792
    ds_read_b64_tr_b16 a[148:149], v80 offset:40960
    ds_read_b64_tr_b16 a[150:151], v80 offset:41984
    ds_read_b64_tr_b16 v[56:57], v81 offset:32768
    ds_read_b64_tr_b16 v[58:59], v81 offset:33792
    ds_read_b64_tr_b16 v[60:61], v81 offset:40960
    ds_read_b64_tr_b16 v[62:63], v81 offset:41984
    s_waitcnt lgkmcnt(0)
    ds_write_b128 v5, v[56:59] offset:12288
    ds_write_b128 v5, v[60:63] offset:13312
    s_branch L_lw_11
L_lw_11_0:
    s_cmp_lg_u32 s44, 1
    s_cbranch_scc1 L_lw_11_1
    ds_read_b64_tr_b16 a[64:65], v80 offset:32768
    ds_read_b64_tr_b16 a[66:67], v80 offset:33792
    ds_read_b64_tr_b16 a[68:69], v80 offset:40960
    ds_read_b64_tr_b16 a[70:71], v80 offset:41984
    ds_read_b64_tr_b16 v[56:57], v81 offset:32768
    ds_read_b64_tr_b16 v[58:59], v81 offset:33792
    ds_read_b64_tr_b16 v[60:61], v81 offset:40960
    ds_read_b64_tr_b16 v[62:63], v81 offset:41984
    s_waitcnt lgkmcnt(0)
    ds_write_b128 v5, v[56:59] offset:8192
    ds_write_b128 v5, v[60:63] offset:9216
    s_branch L_lw_11
L_lw_11_1:
    s_cmp_lg_u32 s44, 2
    s_cbranch_scc1 L_lw_11_2
    ds_read_b64_tr_b16 v[192:193], v80 offset:32768
    ds_read_b64_tr_b16 v[194:195], v80 offset:33792
    ds_read_b64_tr_b16 v[196:197], v80 offset:40960
    ds_read_b64_tr_b16 v[198:199], v80 offset:41984
    ds_read_b64_tr_b16 v[200:201], v81 offset:32768
    ds_read_b64_tr_b16 v[202:203], v81 offset:33792
    ds_read_b64_tr_b16 v[204:205], v81 offset:40960
    ds_read_b64_tr_b16 v[206:207], v81 offset:41984
    s_branch L_lw_11
L_lw_11_2:
    ds_read_b64_tr_b16 a[240:241], v80 offset:32768
    ds_read_b64_tr_b16 a[242:243], v80 offset:33792
    ds_read_b64_tr_b16 a[244:245], v80 offset:40960
    ds_read_b64_tr_b16 a[246:247], v80 offset:41984
    ds_read_b64_tr_b16 v[56:57], v81 offset:32768
    ds_read_b64_tr_b16 v[58:59], v81 offset:33792
    ds_read_b64_tr_b16 v[60:61], v81 offset:40960
    ds_read_b64_tr_b16 v[62:63], v81 offset:41984
    s_waitcnt lgkmcnt(0)
    ds_write_b128 v5, v[56:59] offset:10240
    ds_write_b128 v5, v[60:63] offset:11264
L_lw_11:
    s_waitcnt lgkmcnt(0)
    s_waitcnt vmcnt(12)
    s_barrier
    s_add_u32 s79, s41, 11
    s_and_b32 s79, s79, 3
    s_lshl_b32 s79, s79, 19
    s_add_u32 s79, s79, s47
    s_add_u32 s46, s79, 0x400000
    s_add_u32 m0, s48, 32768
    s_nop 0
    buffer_load_dwordx4 v82, s[24:27], s46 offen  lds
    s_add_u32 s46, s79, 0x420000
    s_add_u32 m0, s48, 36864
    s_nop 0
    buffer_load_dwordx4 v82, s[24:27], s46 offen  lds
    s_add_u32 s46, s79, 0x440000
    s_add_u32 m0, s48, 40960
    s_nop 0
    buffer_load_dwordx4 v82, s[24:27], s46 offen  lds
    s_add_u32 s46, s79, 0x460000
    s_add_u32 m0, s48, 45056
    s_nop 0
    buffer_load_dwordx4 v82, s[24:27], s46 offen  lds
    s_cmp_lg_u32 s44, 0
    s_cbranch_scc1 L_lw_12_0
    ds_read_b64_tr_b16 a[168:169], v80 offset:49152
    ds_read_b64_tr_b16 a[170:171], v80 offset:50176
    ds_read_b64_tr_b16 a[172:173], v80 offset:57344
    ds_read_b64_tr_b16 a[174:175], v80 offset:58368
    ds_read_b64_tr_b16 v[56:57], v81 offset:49152
    ds_read_b64_tr_b16 v[58:59], v81 offset:50176
    ds_read_b64_tr_b16 v[60:61], v81 offset:57344
    ds_read_b64_tr_b16 v[62:63], v81 offset:58368
    s_waitcnt lgkmcnt(0)
    ds_write_b128 v5, v[56:59] offset:18432
    ds_write_b128 v5, v[60:63] offset:19456
    s_branch L_lw_12
L_lw_12_0:
    s_cmp_lg_u32 s44, 1
    s_cbranch_scc1 L_lw_12_1
    ds_read_b64_tr_b16 a[80:81], v80 offset:49152
    ds_read_b64_tr_b16 a[82:83], v80 offset:50176
    ds_read_b64_tr_b16 a[84:85], v80 offset:57344
    ds_read_b64_tr_b16 a[86:87], v80 offset:58368
    ds_read_b64_tr_b16 v[56:57], v81 offset:49152
    ds_read_b64_tr_b16 v[58:59], v81 offset:50176
    ds_read_b64_tr_b16 v[60:61], v81 offset:57344
    ds_read_b64_tr_b16 v[62:63], v81 offset:58368
    s_waitcnt lgkmcnt(0)
    ds_write_b128 v5, v[56:59] offset:14336
    ds_write_b128 v5, v[60:63] offset:15360
    s_branch L_lw_12
L_lw_12_1:
    s_cmp_lg_u32 s44, 2
    s_cbranch_scc1 L_lw_12_2
    ds_read_b64_tr_b16 v[224:225], v80 offset:49152
    ds_read_b64_tr_b16 v[226:227], v80 offset:50176
    ds_read_b64_tr_b16 v[228:229], v80 offset:57344
    ds_read_b64_tr_b16 v[230:231], v80 offset:58368
    ds_read_b64_tr_b16 v[232:233], v81 offset:49152
    ds_read_b64_tr_b16 v[234:235], v81 offset:50176
    ds_read_b64_tr_b16 v[236:237], v81 offset:57344
    ds_read_b64_tr_b16 v[238:239], v81 offset:58368
    s_branch L_lw_12
L_lw_12_2:
    ds_read_b64_tr_b16 v[104:105], v80 offset:49152
    ds_read_b64_tr_b16 v[106:107], v80 offset:50176
    ds_read_b64_tr_b16 v[108:109], v80 offset:57344
    ds_read_b64_tr_b16 v[110:111], v80 offset:58368
    ds_read_b64_tr_b16 v[56:57], v81 offset:49152
    ds_read_b64_tr_b16 v[58:59], v81 offset:50176
    ds_read_b64_tr_b16 v[60:61], v81 offset:57344
    ds_read_b64_tr_b16 v[62:63], v81 offset:58368
    s_waitcnt lgkmcnt(0)
    ds_write_b128 v5, v[56:59] offset:16384
    ds_write_b128 v5, v[60:63] offset:17408
L_lw_12:
    s_waitcnt lgkmcnt(0)
    s_waitcnt vmcnt(12)
    s_barrier
    s_add_u32 s79, s41, 12
    s_and_b32 s79, s79, 3
    s_lshl_b32 s79, s79, 19
    s_add_u32 s79, s79, s47
    s_add_u32 s46, s79, 0x600000
    s_add_u32 m0, s48, 49152
    s_nop 0
    buffer_load_dwordx4 v82, s[24:27], s46 offen  lds
    s_add_u32 s46, s79, 0x620000
    s_add_u32 m0, s48, 53248
    s_nop 0
    buffer_load_dwordx4 v82, s[24:27], s46 offen  lds
    s_add_u32 s46, s79, 0x640000
    s_add_u32 m0, s48, 57344
    s_nop 0
    buffer_load_dwordx4 v82, s[24:27], s46 offen  lds
    s_add_u32 s46, s79, 0x660000
    s_add_u32 m0, s48, 61440
    s_nop 0
    buffer_load_dwordx4 v82, s[24:27], s46 offen  lds
    s_cmp_lg_u32 s44, 0
    s_cbranch_scc1 L_lw_13_0
    ds_read_b64_tr_b16 a[192:193], v84 offset:20480
    ds_read_b64_tr_b16 a[194:195], v84 offset:21504
    ds_read_b64_tr_b16 a[196:197], v86 offset:20480
    ds_read_b64_tr_b16 a[198:199], v86 offset:21504
    ds_read_b64_tr_b16 v[56:57], v85 offset:20480
    ds_read_b64_tr_b16 v[58:59], v85 offset:21504
    ds_read_b64_tr_b16 v[60:61], v87 offset:20480
    ds_read_b64_tr_b16 v[62:63], v87 offset:21504
    s_waitcnt lgkmcnt(0)
    ds_write_b128 v5, v[56:59] offset:0
    ds_write_b128 v5, v[60:63] offset:1024
    s_branch L_lw_13
L_lw_13_0:
    s_cmp_lg_u32 s44, 1
    s_cbranch_scc1 L_lw_13_1
    ds_read_b64_tr_b16 a[96:97], v84 offset:20480
    ds_read_b64_tr_b16 a[98:99], v84 offset:21504
    ds_read_b64_tr_b16 a[100:101], v86 offset:20480
    ds_read_b64_tr_b16 a[102:103], v86 offset:21504
    ds_read_b64_tr_b16 v[56:57], v85 offset:20480
    ds_read_b64_tr_b16 v[58:59], v85 offset:21504
    ds_read_b64_tr_b16 v[60:61], v87 offset:20480
    ds_read_b64_tr_b16 v[62:63], v87 offset:21504
    s_waitcnt lgkmcnt(0)
    ds_write_b128 v5, v[56:59] offset:2048
    ds_write_b128 v5, v[60:63] offset:3072
    s_branch L_lw_13
L_lw_13_1:
    s_cmp_lg_u32 s44, 2
    s_cbranch_scc1 L_lw_13_2
    ds_read_b64_tr_b16 a[0:1], v84 offset:20480
    ds_read_b64_tr_b16 a[2:3], v84 offset:21504
    ds_read_b64_tr_b16 a[4:5], v86 offset:20480
    ds_read_b64_tr_b16 a[6:7], v86 offset:21504
    ds_read_b64_tr_b16 a[8:9], v85 offset:20480
    ds_read_b64_tr_b16 a[10:11], v85 offset:21504
    ds_read_b64_tr_b16 a[12:13], v87 offset:20480
    ds_read_b64_tr_b16 a[14:15], v87 offset:21504
    s_branch L_lw_13
L_lw_13_2:
    ds_read_b64_tr_b16 v[128:129], v84 offset:20480
    ds_read_b64_tr_b16 v[130:131], v84 offset:21504
    ds_read_b64_tr_b16 v[132:133], v86 offset:20480
    ds_read_b64_tr_b16 v[134:135], v86 offset:21504
    ds_read_b64_tr_b16 v[136:137], v85 offset:20480
    ds_read_b64_tr_b16 v[138:139], v85 offset:21504
    ds_read_b64_tr_b16 v[140:141], v87 offset:20480
    ds_read_b64_tr_b16 v[142:143], v87 offset:21504
L_lw_13:
    s_waitcnt lgkmcnt(0)
    s_waitcnt vmcnt(12)
    s_barrier
    s_add_u32 s79, s41, 13
    s_and_b32 s79, s79, 3
    s_lshl_b32 s79, s79, 19
    s_add_u32 s79, s79, s47
    s_add_u32 s46, s79, 0x600000
    s_add_u32 m0, s48, 86016
    s_nop 0
    buffer_load_dwordx4 v82, s[24:27], s46 offen  lds
    s_add_u32 s46, s79, 0x620000
    s_add_u32 m0, s48, 110592
    s_nop 0
    buffer_load_dwordx4 v82, s[24:27], s46 offen  lds
    s_add_u32 s46, s79, 0x640000
    s_add_u32 m0, s48, 135168
    s_nop 0
    buffer_load_dwordx4 v82, s[24:27], s46 offen  lds
    s_add_u32 s46, s79, 0x660000
    s_add_u32 m0, s48, 159744
    s_nop 0
    buffer_load_dwordx4 v82, s[24:27], s46 offen  lds
    s_cmp_lg_u32 s44, 0
    s_cbranch_scc1 L_lw_14_0
    ds_read_b64_tr_b16 a[216:217], v80 offset:0
    ds_read_b64_tr_b16 a[218:219], v80 offset:1024
    ds_read_b64_tr_b16 a[220:221], v80 offset:8192
    ds_read_b64_tr_b16 a[222:223], v80 offset:9216
    ds_read_b64_tr_b16 v[56:57], v81 offset:0
    ds_read_b64_tr_b16 v[58:59], v81 offset:1024
    ds_read_b64_tr_b16 v[60:61], v81 offset:8192
    ds_read_b64_tr_b16 v[62:63], v81 offset:9216
    s_waitcnt lgkmcnt(0)
    ds_write_b128 v5, v[56:59] offset:4096
    ds_write_b128 v5, v[60:63] offset:5120
    s_branch L_lw_14
L_lw_14_0:
    s_cmp_lg_u32 s44, 1
    s_cbranch_scc1 L_lw_14_1
    ds_read_b64_tr_b16 a[120:121], v80 offset:0
    ds_read_b64_tr_b16 a[122:123], v80 offset:1024
    ds_read_b64_tr_b16 a[124:125], v80 offset:8192
    ds_read_b64_tr_b16 a[126:127], v80 offset:9216
    ds_read_b64_tr_b16 v[56:57], v81 offset:0
    ds_read_b64_tr_b16 v[58:59], v81 offset:1024
    ds_read_b64_tr_b16 v[60:61], v81 offset:8192
    ds_read_b64_tr_b16 v[62:63], v81 offset:9216
    s_waitcnt lgkmcnt(0)
    ds_write_b128 v5, v[56:59] offset:6144
    ds_write_b128 v5, v[60:63] offset:7168
    s_branch L_lw_14
L_lw_14_1:
    s_cmp_lg_u32 s44, 2
    s_cbranch_scc1 L_lw_14_2
    ds_read_b64_tr_b16 a[32:33], v80 offset:0
    ds_read_b64_tr_b16 a[34:35], v80 offset:1024
    ds_read_b64_tr_b16 a[36:37], v80 offset:8192
    ds_read_b64_tr_b16 a[38:39], v80 offset:9216
    ds_read_b64_tr_b16 a[40:41], v81 offset:0
    ds_read_b64_tr_b16 a[42:43], v81 offset:1024
    ds_read_b64_tr_b16 a[44:45], v81 offset:8192
    ds_read_b64_tr_b16 a[46:47], v81 offset:9216
    s_branch L_lw_14
L_lw_14_2:
    ds_read_b64_tr_b16 v[160:161], v80 offset:0
    ds_read_b64_tr_b16 v[162:163], v80 offset:1024
    ds_read_b64_tr_b16 v[164:165], v80 offset:8192
    ds_read_b64_tr_b16 v[166:167], v80 offset:9216
    ds_read_b64_tr_b16 v[168:169], v81 offset:0
    ds_read_b64_tr_b16 v[170:171], v81 offset:1024
    ds_read_b64_tr_b16 v[172:173], v81 offset:8192
    ds_read_b64_tr_b16 v[174:175], v81 offset:9216
L_lw_14:
    s_waitcnt lgkmcnt(0)
    s_waitcnt vmcnt(12)
    s_barrier
    s_add_u32 s79, s41, 14
    s_and_b32 s79, s79, 3
    s_lshl_b32 s79, s79, 19
    s_add_u32 s79, s79, s47
    s_add_u32 s46, s79, 0x600000
    s_add_u32 m0, s48, 0
    s_nop 0
    buffer_load_dwordx4 v82, s[24:27], s46 offen  lds
    s_add_u32 s46, s79, 0x620000
    s_add_u32 m0, s48, 4096
    s_nop 0
    buffer_load_dwordx4 v82, s[24:27], s46 offen  lds
    s_add_u32 s46, s79, 0x640000
    s_add_u32 m0, s48, 8192
    s_nop 0
    buffer_load_dwordx4 v82, s[24:27], s46 offen  lds
    s_add_u32 s46, s79, 0x660000
    s_add_u32 m0, s48, 12288
    s_nop 0
    buffer_load_dwordx4 v82, s[24:27], s46 offen  lds
    s_cmp_lg_u32 s44, 0
    s_cbranch_scc1 L_lw_15_0
    ds_read_b64_tr_b16 a[240:241], v80 offset:16384
    ds_read_b64_tr_b16 a[242:243], v80 offset:17408
    ds_read_b64_tr_b16 a[244:245], v80 offset:24576
    ds_read_b64_tr_b16 a[246:247], v80 offset:25600
    ds_read_b64_tr_b16 v[56:57], v81 offset:16384
    ds_read_b64_tr_b16 v[58:59], v81 offset:17408
    ds_read_b64_tr_b16 v[60:61], v81 offset:24576
    ds_read_b64_tr_b16 v[62:63], v81 offset:25600
    s_waitcnt lgkmcnt(0)
    ds_write_b128 v5, v[56:59] offset:10240
    ds_write_b128 v5, v[60:63] offset:11264
    s_branch L_lw_15
L_lw_15_0:
    s_cmp_lg_u32 s44, 1
    s_cbranch_scc1 L_lw_15_1
    ds_read_b64_tr_b16 a[144:145], v80 offset:16384
    ds_read_b64_tr_b16 a[146:147], v80 offset:17408
    ds_read_b64_tr_b16 a[148:149], v80 offset:24576
    ds_read_b64_tr_b16 a[150:151], v80 offset:25600
    ds_read_b64_tr_b16 v[56:57], v81 offset:16384
    ds_read_b64_tr_b16 v[58:59], v81 offset:17408
    ds_read_b64_tr_b16 v[60:61], v81 offset:24576
    ds_read_b64_tr_b16 v[62:63], v81 offset:25600
    s_waitcnt lgkmcnt(0)
    ds_write_b128 v5, v[56:59] offset:12288
    ds_write_b128 v5, v[60:63] offset:13312
    s_branch L_lw_15
L_lw_15_1:
    s_cmp_lg_u32 s44, 2
    s_cbranch_scc1 L_lw_15_2
    ds_read_b64_tr_b16 a[64:65], v80 offset:16384
    ds_read_b64_tr_b16 a[66:67], v80 offset:17408
    ds_read_b64_tr_b16 a[68:69], v80 offset:24576
    ds_read_b64_tr_b16 a[70:71], v80 offset:25600
    ds_read_b64_tr_b16 v[56:57], v81 offset:16384
    ds_read_b64_tr_b16 v[58:59], v81 offset:17408
    ds_read_b64_tr_b16 v[60:61], v81 offset:24576
    ds_read_b64_tr_b16 v[62:63], v81 offset:25600
    s_waitcnt lgkmcnt(0)
    ds_write_b128 v5, v[56:59] offset:8192
    ds_write_b128 v5, v[60:63] offset:9216
    s_branch L_lw_15
L_lw_15_2:
    ds_read_b64_tr_b16 v[192:193], v80 offset:16384
    ds_read_b64_tr_b16 v[194:195], v80 offset:17408
    ds_read_b64_tr_b16 v[196:197], v80 offset:24576
    ds_read_b64_tr_b16 v[198:199], v80 offset:25600
    ds_read_b64_tr_b16 v[200:201], v81 offset:16384
    ds_read_b64_tr_b16 v[202:203], v81 offset:17408
    ds_read_b64_tr_b16 v[204:205], v81 offset:24576
    ds_read_b64_tr_b16 v[206:207], v81 offset:25600
L_lw_15:
    s_waitcnt lgkmcnt(0)
    s_waitcnt vmcnt(12)
    s_barrier
    s_add_u32 s79, s41, 15
    s_and_b32 s79, s79, 3
    s_lshl_b32 s79, s79, 19
    s_add_u32 s79, s79, s47
    s_add_u32 s46, s79, 0x600000
    s_add_u32 m0, s48, 16384
    s_nop 0
    buffer_load_dwordx4 v82, s[24:27], s46 offen  lds
    s_add_u32 s46, s79, 0x620000
    s_add_u32 m0, s48, 20480
    s_nop 0
    buffer_load_dwordx4 v82, s[24:27], s46 offen  lds
    s_add_u32 s46, s79, 0x640000
    s_add_u32 m0, s48, 24576
    s_nop 0
    buffer_load_dwordx4 v82, s[24:27], s46 offen  lds
    s_add_u32 s46, s79, 0x660000
    s_add_u32 m0, s48, 28672
    s_nop 0
    buffer_load_dwordx4 v82, s[24:27], s46 offen  lds
    s_cmp_lg_u32 s44, 0
    s_cbranch_scc1 L_lw_16_0
    ds_read_b64_tr_b16 v[104:105], v80 offset:32768
    ds_read_b64_tr_b16 v[106:107], v80 offset:33792
    ds_read_b64_tr_b16 v[108:109], v80 offset:40960
    ds_read_b64_tr_b16 v[110:111], v80 offset:41984
    ds_read_b64_tr_b16 v[56:57], v81 offset:32768
    ds_read_b64_tr_b16 v[58:59], v81 offset:33792
    ds_read_b64_tr_b16 v[60:61], v81 offset:40960
    ds_read_b64_tr_b16 v[62:63], v81 offset:41984
    s_waitcnt lgkmcnt(0)
    ds_write_b128 v5, v[56:59] offset:16384
    ds_write_b128 v5, v[60:63] offset:17408
    s_branch L_lw_16
L_lw_16_0:
    s_cmp_lg_u32 s44, 1
    s_cbranch_scc1 L_lw_16_1
    ds_read_b64_tr_b16 a[168:169], v80 offset:32768
    ds_read_b64_tr_b16 a[170:171], v80 offset:33792
    ds_read_b64_tr_b16 a[172:173], v80 offset:40960
    ds_read_b64_tr_b16 a[174:175], v80 offset:41984
    ds_read_b64_tr_b16 v[56:57], v81 offset:32768
    ds_read_b64_tr_b16 v[58:59], v81 offset:33792
    ds_read_b64_tr_b16 v[60:61], v81 offset:40960
    ds_read_b64_tr_b16 v[62:63], v81 offset:41984
    s_waitcnt lgkmcnt(0)
    ds_write_b128 v5, v[56:59] offset:18432
    ds_write_b128 v5, v[60:63] offset:19456
    s_branch L_lw_16
L_lw_16_1:
    s_cmp_lg_u32 s44, 2
    s_cbranch_scc1 L_lw_16_2
    ds_read_b64_tr_b16 a[80:81], v80 offset:32768
    ds_read_b64_tr_b16 a[82:83], v80 offset:33792
    ds_read_b64_tr_b16 a[84:85], v80 offset:40960
    ds_read_b64_tr_b16 a[86:87], v80 offset:41984
    ds_read_b64_tr_b16 v[56:57], v81 offset:32768
    ds_read_b64_tr_b16 v[58:59], v81 offset:33792
    ds_read_b64_tr_b16 v[60:61], v81 offset:40960
    ds_read_b64_tr_b16 v[62:63], v81 offset:41984
    s_waitcnt lgkmcnt(0)
    ds_write_b128 v5, v[56:59] offset:14336
    ds_write_b128 v5, v[60:63] offset:15360
    s_branch L_lw_16
L_lw_16_2:
    ds_read_b64_tr_b16 v[224:225], v80 offset:32768
    ds_read_b64_tr_b16 v[226:227], v80 offset:33792
    ds_read_b64_tr_b16 v[228:229], v80 offset:40960
    ds_read_b64_tr_b16 v[230:231], v80 offset:41984
    ds_read_b64_tr_b16 v[232:233], v81 offset:32768
    ds_read_b64_tr_b16 v[234:235], v81 offset:33792
    ds_read_b64_tr_b16 v[236:237], v81 offset:40960
    ds_read_b64_tr_b16 v[238:239], v81 offset:41984
L_lw_16:
    s_waitcnt lgkmcnt(0)
    s_waitcnt vmcnt(12)
    s_barrier
    s_add_u32 s79, s41, 0
    s_and_b32 s79, s79, 3
    s_lshl_b32 s79, s79, 19
    s_add_u32 s79, s79, s47
    s_add_u32 s46, s79, 0x0
    s_add_u32 m0, s48, 32768
    s_nop 0
    buffer_load_dwordx4 v82, s[28:31], s46 offen  lds
    s_add_u32 s46, s79, 0x20000
    s_add_u32 m0, s48, 36864
    s_nop 0
    buffer_load_dwordx4 v82, s[28:31], s46 offen  lds
    s_add_u32 s46, s79, 0x40000
    s_add_u32 m0, s48, 40960
    s_nop 0
    buffer_load_dwordx4 v82, s[28:31], s46 offen  lds
    s_add_u32 s46, s79, 0x60000
    s_add_u32 m0, s48, 45056
    s_nop 0
    buffer_load_dwordx4 v82, s[28:31], s46 offen  lds
    s_cmp_lg_u32 s44, 0
    s_cbranch_scc1 L_lw_17_0
    ds_read_b64_tr_b16 v[128:129], v80 offset:49152
    ds_read_b64_tr_b16 v[130:131], v80 offset:50176
    ds_read_b64_tr_b16 v[132:133], v80 offset:57344
    ds_read_b64_tr_b16 v[134:135], v80 offset:58368
    ds_read_b64_tr_b16 v[136:137], v81 offset:49152
    ds_read_b64_tr_b16 v[138:139], v81 offset:50176
    ds_read_b64_tr_b16 v[140:141], v81 offset:57344
    ds_read_b64_tr_b16 v[142:143], v81 offset:58368
    s_branch L_lw_17
L_lw_17_0:
    s_cmp_lg_u32 s44, 1
    s_cbranch_scc1 L_lw_17_1
    ds_read_b64_tr_b16 a[192:193], v80 offset:49152
    ds_read_b64_tr_b16 a[194:195], v80 offset:50176
    ds_read_b64_tr_b16 a[196:197], v80 offset:57344
    ds_read_b64_tr_b16 a[198:199], v80 offset:58368
    ds_read_b64_tr_b16 v[56:57], v81 offset:49152
    ds_read_b64_tr_b16 v[58:59], v81 offset:50176
    ds_read_b64_tr_b16 v[60:61], v81 offset:57344
    ds_read_b64_tr_b16 v[62:63], v81 offset:58368
    s_waitcnt lgkmcnt(0)
    ds_write_b128 v5, v[56:59] offset:0
    ds_write_b128 v5, v[60:63] offset:1024
    s_branch L_lw_17
L_lw_17_1:
    s_cmp_lg_u32 s44, 2
    s_cbranch_scc1 L_lw_17_2
    ds_read_b64_tr_b16 a[96:97], v80 offset:49152
    ds_read_b64_tr_b16 a[98:99], v80 offset:50176
    ds_read_b64_tr_b16 a[100:101], v80 offset:57344
    ds_read_b64_tr_b16 a[102:103], v80 offset:58368
    ds_read_b64_tr_b16 v[56:57], v81 offset:49152
    ds_read_b64_tr_b16 v[58:59], v81 offset:50176
    ds_read_b64_tr_b16 v[60:61], v81 offset:57344
    ds_read_b64_tr_b16 v[62:63], v81 offset:58368
    s_waitcnt lgkmcnt(0)
    ds_write_b128 v5, v[56:59] offset:2048
    ds_write_b128 v5, v[60:63] offset:3072
    s_branch L_lw_17
L_lw_17_2:
    ds_read_b64_tr_b16 a[0:1], v80 offset:49152
    ds_read_b64_tr_b16 a[2:3], v80 offset:50176
    ds_read_b64_tr_b16 a[4:5], v80 offset:57344
    ds_read_b64_tr_b16 a[6:7], v80 offset:58368
    ds_read_b64_tr_b16 a[8:9], v81 offset:49152
    ds_read_b64_tr_b16 a[10:11], v81 offset:50176
    ds_read_b64_tr_b16 a[12:13], v81 offset:57344
    ds_read_b64_tr_b16 a[14:15], v81 offset:58368
L_lw_17:
    s_waitcnt lgkmcnt(0)
    s_waitcnt vmcnt(12)
    s_barrier
    s_add_u32 s79, s41, 1
    s_and_b32 s79, s79, 3
    s_lshl_b32 s79, s79, 19
    s_add_u32 s79, s79, s47
    s_add_u32 s46, s79, 0x0
    s_add_u32 m0, s48, 49152
    s_nop 0
    buffer_load_dwordx4 v82, s[28:31], s46 offen  lds
    s_add_u32 s46, s79, 0x20000
    s_add_u32 m0, s48, 53248
    s_nop 0
    buffer_load_dwordx4 v82, s[28:31], s46 offen  lds
    s_add_u32 s46, s79, 0x40000
    s_add_u32 m0, s48, 57344
    s_nop 0
    buffer_load_dwordx4 v82, s[28:31], s46 offen  lds
    s_add_u32 s46, s79, 0x60000
    s_add_u32 m0, s48, 61440
    s_nop 0
    buffer_load_dwordx4 v82, s[28:31], s46 offen  lds
    s_cmp_lg_u32 s44, 0
    s_cbranch_scc1 L_lw_18_0
    ds_read_b64_tr_b16 v[160:161], v84 offset:20480
    ds_read_b64_tr_b16 v[162:163], v84 offset:21504
    ds_read_b64_tr_b16 v[164:165], v86 offset:20480
    ds_read_b64_tr_b16 v[166:167], v86 offset:21504
    ds_read_b64_tr_b16 v[168:169], v85 offset:20480
    ds_read_b64_tr_b16 v[170:171], v85 offset:21504
    ds_read_b64_tr_b16 v[172:173], v87 offset:20480
    ds_read_b64_tr_b16 v[174:175], v87 offset:21504
    s_branch L_lw_18
L_lw_18_0:
    s_cmp_lg_u32 s44, 1
    s_cbranch_scc1 L_lw_18_1
    ds_read_b64_tr_b16 a[216:217], v84 offset:20480
    ds_read_b64_tr_b16 a[218:219], v84 offset:21504
    ds_read_b64_tr_b16 a[220:221], v86 offset:20480
    ds_read_b64_tr_b16 a[222:223], v86 offset:21504
    ds_read_b64_tr_b16 v[56:57], v85 offset:20480
    ds_read_b64_tr_b16 v[58:59], v85 offset:21504
    ds_read_b64_tr_b16 v[60:61], v87 offset:20480
    ds_read_b64_tr_b16 v[62:63], v87 offset:21504
    s_waitcnt lgkmcnt(0)
    ds_write_b128 v5, v[56:59] offset:4096
    ds_write_b128 v5, v[60:63] offset:5120
    s_branch L_lw_18
L_lw_18_1:
    s_cmp_lg_u32 s44, 2
    s_cbranch_scc1 L_lw_18_2
    ds_read_b64_tr_b16 a[120:121], v84 offset:20480
    ds_read_b64_tr_b16 a[122:123], v84 offset:21504
    ds_read_b64_tr_b16 a[124:125], v86 offset:20480
    ds_read_b64_tr_b16 a[126:127], v86 offset:21504
    ds_read_b64_tr_b16 v[56:57], v85 offset:20480
    ds_read_b64_tr_b16 v[58:59], v85 offset:21504
    ds_read_b64_tr_b16 v[60:61], v87 offset:20480
    ds_read_b64_tr_b16 v[62:63], v87 offset:21504
    s_waitcnt lgkmcnt(0)
    ds_write_b128 v5, v[56:59] offset:6144
    ds_write_b128 v5, v[60:63] offset:7168
    s_branch L_lw_18
L_lw_18_2:
    ds_read_b64_tr_b16 a[32:33], v84 offset:20480
    ds_read_b64_tr_b16 a[34:35], v84 offset:21504
    ds_read_b64_tr_b16 a[36:37], v86 offset:20480
    ds_read_b64_tr_b16 a[38:39], v86 offset:21504
    ds_read_b64_tr_b16 a[40:41], v85 offset:20480
    ds_read_b64_tr_b16 a[42:43], v85 offset:21504
    ds_read_b64_tr_b16 a[44:45], v87 offset:20480
    ds_read_b64_tr_b16 a[46:47], v87 offset:21504
L_lw_18:
    s_waitcnt lgkmcnt(0)
    s_waitcnt vmcnt(12)
    s_barrier
    s_cmp_lg_u32 s44, 0
    s_cbranch_scc1 L_lw_19_0
    ds_read_b64_tr_b16 v[192:193], v80 offset:0
    ds_read_b64_tr_b16 v[194:195], v80 offset:1024
    ds_read_b64_tr_b16 v[196:197], v80 offset:8192
    ds_read_b64_tr_b16 v[198:199], v80 offset:9216
    ds_read_b64_tr_b16 v[200:201], v81 offset:0
    ds_read_b64_tr_b16 v[202:203], v81 offset:1024
    ds_read_b64_tr_b16 v[204:205], v81 offset:8192
    ds_read_b64_tr_b16 v[206:207], v81 offset:9216
    s_branch L_lw_19
L_lw_19_0:
    s_cmp_lg_u32 s44, 1
    s_cbranch_scc1 L_lw_19_1
    ds_read_b64_tr_b16 a[240:241], v80 offset:0
    ds_read_b64_tr_b16 a[242:243], v80 offset:1024
    ds_read_b64_tr_b16 a[244:245], v80 offset:8192
    ds_read_b64_tr_b16 a[246:247], v80 offset:9216
    ds_read_b64_tr_b16 v[56:57], v81 offset:0
    ds_read_b64_tr_b16 v[58:59], v81 offset:1024
    ds_read_b64_tr_b16 v[60:61], v81 offset:8192
    ds_read_b64_tr_b16 v[62:63], v81 offset:9216
    s_waitcnt lgkmcnt(0)
    ds_write_b128 v5, v[56:59] offset:10240
    ds_write_b128 v5, v[60:63] offset:11264
    s_branch L_lw_19
L_lw_19_1:
    s_cmp_lg_u32 s44, 2
    s_cbranch_scc1 L_lw_19_2
    ds_read_b64_tr_b16 a[144:145], v80 offset:0
    ds_read_b64_tr_b16 a[146:147], v80 offset:1024
    ds_read_b64_tr_b16 a[148:149], v80 offset:8192
    ds_read_b64_tr_b16 a[150:151], v80 offset:9216
    ds_read_b64_tr_b16 v[56:57], v81 offset:0
    ds_read_b64_tr_b16 v[58:59], v81 offset:1024
    ds_read_b64_tr_b16 v[60:61], v81 offset:8192
    ds_read_b64_tr_b16 v[62:63], v81 offset:9216
    s_waitcnt lgkmcnt(0)
    ds_write_b128 v5, v[56:59] offset:12288
    ds_write_b128 v5, v[60:63] offset:13312
    s_branch L_lw_19
L_lw_19_2:
    ds_read_b64_tr_b16 a[64:65], v80 offset:0
    ds_read_b64_tr_b16 a[66:67], v80 offset:1024
    ds_read_b64_tr_b16 a[68:69], v80 offset:8192
    ds_read_b64_tr_b16 a[70:71], v80 offset:9216
    ds_read_b64_tr_b16 v[56:57], v81 offset:0
    ds_read_b64_tr_b16 v[58:59], v81 offset:1024
    ds_read_b64_tr_b16 v[60:61], v81 offset:8192
    ds_read_b64_tr_b16 v[62:63], v81 offset:9216
    s_waitcnt lgkmcnt(0)
    ds_write_b128 v5, v[56:59] offset:8192
    ds_write_b128 v5, v[60:63] offset:9216
L_lw_19:
    s_waitcnt lgkmcnt(0)
    s_waitcnt vmcnt(8)
    s_barrier
    s_add_u32 s79, s41, 2
    s_and_b32 s79, s79, 3
    s_lshl_b32 s79, s79, 19
    s_add_u32 s79, s79, s47
    s_add_u32 s46, s79, 0x0
    s_add_u32 m0, s48, 0
    s_nop 0
    buffer_load_dwordx4 v82, s[28:31], s46 offen  lds
    s_add_u32 s46, s79, 0x20000
    s_add_u32 m0, s48, 4096
    s_nop 0
    buffer_load_dwordx4 v82, s[28:31], s46 offen  lds
    s_add_u32 s46, s79, 0x40000
    s_add_u32 m0, s48, 8192
    s_nop 0
    buffer_load_dwordx4 v82, s[28:31], s46 offen  lds
    s_add_u32 s46, s79, 0x60000
    s_add_u32 m0, s48, 12288
    s_nop 0
    buffer_load_dwordx4 v82, s[28:31], s46 offen  lds
    s_cmp_lg_u32 s44, 0
    s_cbranch_scc1 L_lw_20_0
    ds_read_b64_tr_b16 v[224:225], v80 offset:16384
    ds_read_b64_tr_b16 v[226:227], v80 offset:17408
    ds_read_b64_tr_b16 v[228:229], v80 offset:24576
    ds_read_b64_tr_b16 v[230:231], v80 offset:25600
    ds_read_b64_tr_b16 v[232:233], v81 offset:16384
    ds_read_b64_tr_b16 v[234:235], v81 offset:17408
    ds_read_b64_tr_b16 v[236:237], v81 offset:24576
    ds_read_b64_tr_b16 v[238:239], v81 offset:25600
    s_branch L_lw_20
L_lw_20_0:
    s_cmp_lg_u32 s44, 1
    s_cbranch_scc1 L_lw_20_1
    ds_read_b64_tr_b16 v[104:105], v80 offset:16384
    ds_read_b64_tr_b16 v[106:107], v80 offset:17408
    ds_read_b64_tr_b16 v[108:109], v80 offset:24576
    ds_read_b64_tr_b16 v[110:111], v80 offset:25600
    ds_read_b64_tr_b16 v[56:57], v81 offset:16384
    ds_read_b64_tr_b16 v[58:59], v81 offset:17408
    ds_read_b64_tr_b16 v[60:61], v81 offset:24576
    ds_read_b64_tr_b16 v[62:63], v81 offset:25600
    s_waitcnt lgkmcnt(0)
    ds_write_b128 v5, v[56:59] offset:16384
    ds_write_b128 v5, v[60:63] offset:17408
    s_branch L_lw_20
L_lw_20_1:
    s_cmp_lg_u32 s44, 2
    s_cbranch_scc1 L_lw_20_2
    ds_read_b64_tr_b16 a[168:169], v80 offset:16384
    ds_read_b64_tr_b16 a[170:171], v80 offset:17408
    ds_read_b64_tr_b16 a[172:173], v80 offset:24576
    ds_read_b64_tr_b16 a[174:175], v80 offset:25600
    ds_read_b64_tr_b16 v[56:57], v81 offset:16384
    ds_read_b64_tr_b16 v[58:59], v81 offset:17408
    ds_read_b64_tr_b16 v[60:61], v81 offset:24576
    ds_read_b64_tr_b16 v[62:63], v81 offset:25600
    s_waitcnt lgkmcnt(0)
    ds_write_b128 v5, v[56:59] offset:18432
    ds_write_b128 v5, v[60:63] offset:19456
    s_branch L_lw_20
L_lw_20_2:
    ds_read_b64_tr_b16 a[80:81], v80 offset:16384
    ds_read_b64_tr_b16 a[82:83], v80 offset:17408
    ds_read_b64_tr_b16 a[84:85], v80 offset:24576
    ds_read_b64_tr_b16 a[86:87], v80 offset:25600
    ds_read_b64_tr_b16 v[56:57], v81 offset:16384
    ds_read_b64_tr_b16 v[58:59], v81 offset:17408
    ds_read_b64_tr_b16 v[60:61], v81 offset:24576
    ds_read_b64_tr_b16 v[62:63], v81 offset:25600
    s_waitcnt lgkmcnt(0)
    ds_write_b128 v5, v[56:59] offset:14336
    ds_write_b128 v5, v[60:63] offset:15360
L_lw_20:
    s_waitcnt lgkmcnt(0)
    s_waitcnt vmcnt(8)
    s_barrier
    s_add_u32 s79, s41, 3
    s_and_b32 s79, s79, 3
    s_lshl_b32 s79, s79, 19
    s_add_u32 s79, s79, s47
    s_add_u32 s46, s79, 0x0
    s_add_u32 m0, s48, 16384
    s_nop 0
    buffer_load_dwordx4 v82, s[28:31], s46 offen  lds
    s_add_u32 s46, s79, 0x20000
    s_add_u32 m0, s48, 20480
    s_nop 0
    buffer_load_dwordx4 v82, s[28:31], s46 offen  lds
    s_add_u32 s46, s79, 0x40000
    s_add_u32 m0, s48, 24576
    s_nop 0
    buffer_load_dwordx4 v82, s[28:31], s46 offen  lds
    s_add_u32 s46, s79, 0x60000
    s_add_u32 m0, s48, 28672
    s_nop 0
    buffer_load_dwordx4 v82, s[28:31], s46 offen  lds
    s_cmp_lg_u32 s44, 0
    s_cbranch_scc1 L_lw_21_0
    ds_read_b64_tr_b16 a[16:17], v80 offset:32768
    ds_read_b64_tr_b16 a[18:19], v80 offset:33792
    ds_read_b64_tr_b16 a[20:21], v80 offset:40960
    ds_read_b64_tr_b16 a[22:23], v80 offset:41984
    ds_read_b64_tr_b16 a[24:25], v81 offset:32768
    ds_read_b64_tr_b16 a[26:27], v81 offset:33792
    ds_read_b64_tr_b16 a[28:29], v81 offset:40960
    ds_read_b64_tr_b16 a[30:31], v81 offset:41984
    s_branch L_lw_21
L_lw_21_0:
    s_cmp_lg_u32 s44, 1
    s_cbranch_scc1 L_lw_21_1
    ds_read_b64_tr_b16 v[144:145], v80 offset:32768
    ds_read_b64_tr_b16 v[146:147], v80 offset:33792
    ds_read_b64_tr_b16 v[148:149], v80 offset:40960
    ds_read_b64_tr_b16 v[150:151], v80 offset:41984
    ds_read_b64_tr_b16 v[152:153], v81 offset:32768
    ds_read_b64_tr_b16 v[154:155], v81 offset:33792
    ds_read_b64_tr_b16 v[156:157], v81 offset:40960
    ds_read_b64_tr_b16 v[158:159], v81 offset:41984
    s_branch L_lw_21
L_lw_21_1:
    s_cmp_lg_u32 s44, 2
    s_cbranch_scc1 L_lw_21_2
    ds_read_b64_tr_b16 a[200:201], v80 offset:32768
    ds_read_b64_tr_b16 a[202:203], v80 offset:33792
    ds_read_b64_tr_b16 a[204:205], v80 offset:40960
    ds_read_b64_tr_b16 a[206:207], v80 offset:41984
    ds_read_b64_tr_b16 a[208:209], v81 offset:32768
    ds_read_b64_tr_b16 a[210:211], v81 offset:33792
    ds_read_b64_tr_b16 a[212:213], v81 offset:40960
    ds_read_b64_tr_b16 a[214:215], v81 offset:41984
    s_branch L_lw_21
L_lw_21_2:
    ds_read_b64_tr_b16 a[104:105], v80 offset:32768
    ds_read_b64_tr_b16 a[106:107], v80 offset:33792
    ds_read_b64_tr_b16 a[108:109], v80 offset:40960
    ds_read_b64_tr_b16 a[110:111], v80 offset:41984
    ds_read_b64_tr_b16 a[112:113], v81 offset:32768
    ds_read_b64_tr_b16 a[114:115], v81 offset:33792
    ds_read_b64_tr_b16 a[116:117], v81 offset:40960
    ds_read_b64_tr_b16 a[118:119], v81 offset:41984
L_lw_21:
    s_waitcnt lgkmcnt(0)
    s_waitcnt vmcnt(8)
    s_barrier
    s_add_u32 s79, s41, 4
    s_and_b32 s79, s79, 3
    s_lshl_b32 s79, s79, 19
    s_add_u32 s79, s79, s47
    s_add_u32 s46, s79, 0x200000
    s_add_u32 m0, s48, 32768
    s_nop 0
    buffer_load_dwordx4 v82, s[28:31], s46 offen  lds
    s_add_u32 s46, s79, 0x220000
    s_add_u32 m0, s48, 36864
    s_nop 0
    buffer_load_dwordx4 v82, s[28:31], s46 offen  lds
    s_add_u32 s46, s79, 0x240000
    s_add_u32 m0, s48, 40960
    s_nop 0
    buffer_load_dwordx4 v82, s[28:31], s46 offen  lds
    s_add_u32 s46, s79, 0x260000
    s_add_u32 m0, s48, 45056
    s_nop 0
    buffer_load_dwordx4 v82, s[28:31], s46 offen  lds
    s_cmp_lg_u32 s44, 0
    s_cbranch_scc1 L_lw_22_0
    ds_read_b64_tr_b16 a[48:49], v80 offset:49152
    ds_read_b64_tr_b16 a[50:51], v80 offset:50176
    ds_read_b64_tr_b16 a[52:53], v80 offset:57344
    ds_read_b64_tr_b16 a[54:55], v80 offset:58368
    ds_read_b64_tr_b16 a[56:57], v81 offset:49152
    ds_read_b64_tr_b16 a[58:59], v81 offset:50176
    ds_read_b64_tr_b16 a[60:61], v81 offset:57344
    ds_read_b64_tr_b16 a[62:63], v81 offset:58368
    s_branch L_lw_22
L_lw_22_0:
    s_cmp_lg_u32 s44, 1
    s_cbranch_scc1 L_lw_22_1
    ds_read_b64_tr_b16 v[176:177], v80 offset:49152
    ds_read_b64_tr_b16 v[178:179], v80 offset:50176
    ds_read_b64_tr_b16 v[180:181], v80 offset:57344
    ds_read_b64_tr_b16 v[182:183], v80 offset:58368
    ds_read_b64_tr_b16 v[184:185], v81 offset:49152
    ds_read_b64_tr_b16 v[186:187], v81 offset:50176
    ds_read_b64_tr_b16 v[188:189], v81 offset:57344
    ds_read_b64_tr_b16 v[190:191], v81 offset:58368
    s_branch L_lw_22
L_lw_22_1:
    s_cmp_lg_u32 s44, 2
    s_cbranch_scc1 L_lw_22_2
    ds_read_b64_tr_b16 a[224:225], v80 offset:49152
    ds_read_b64_tr_b16 a[226:227], v80 offset:50176
    ds_read_b64_tr_b16 a[228:229], v80 offset:57344
    ds_read_b64_tr_b16 a[230:231], v80 offset:58368
    ds_read_b64_tr_b16 a[232:233], v81 offset:49152
    ds_read_b64_tr_b16 a[234:235], v81 offset:50176
    ds_read_b64_tr_b16 a[236:237], v81 offset:57344
    ds_read_b64_tr_b16 a[238:239], v81 offset:58368
    s_branch L_lw_22
L_lw_22_2:
    ds_read_b64_tr_b16 a[128:129], v80 offset:49152
    ds_read_b64_tr_b16 a[130:131], v80 offset:50176
    ds_read_b64_tr_b16 a[132:133], v80 offset:57344
    ds_read_b64_tr_b16 a[134:135], v80 offset:58368
    ds_read_b64_tr_b16 a[136:137], v81 offset:49152
    ds_read_b64_tr_b16 a[138:139], v81 offset:50176
    ds_read_b64_tr_b16 a[140:141], v81 offset:57344
    ds_read_b64_tr_b16 a[142:143], v81 offset:58368
L_lw_22:
    s_waitcnt lgkmcnt(0)
    s_waitcnt vmcnt(8)
    s_barrier
    s_add_u32 s79, s41, 5
    s_and_b32 s79, s79, 3
    s_lshl_b32 s79, s79, 19
    s_add_u32 s79, s79, s47
    s_add_u32 s46, s79, 0x200000
    s_add_u32 m0, s48, 49152
    s_nop 0
    buffer_load_dwordx4 v82, s[28:31], s46 offen  lds
    s_add_u32 s46, s79, 0x220000
    s_add_u32 m0, s48, 53248
    s_nop 0
    buffer_load_dwordx4 v82, s[28:31], s46 offen  lds
    s_add_u32 s46, s79, 0x240000
    s_add_u32 m0, s48, 57344
    s_nop 0
    buffer_load_dwordx4 v82, s[28:31], s46 offen  lds
    s_add_u32 s46, s79, 0x260000
    s_add_u32 m0, s48, 61440
    s_nop 0
    buffer_load_dwordx4 v82, s[28:31], s46 offen  lds
    s_cmp_lg_u32 s44, 0
    s_cbranch_scc1 L_lw_23_0
    ds_read_b64_tr_b16 a[72:73], v80 offset:0
    ds_read_b64_tr_b16 a[74:75], v80 offset:1024
    ds_read_b64_tr_b16 a[76:77], v80 offset:8192
    ds_read_b64_tr_b16 a[78:79], v80 offset:9216
    ds_read_b64_tr_b16 v[56:57], v81 offset:0
    ds_read_b64_tr_b16 v[58:59], v81 offset:1024
    ds_read_b64_tr_b16 v[60:61], v81 offset:8192
    ds_read_b64_tr_b16 v[62:63], v81 offset:9216
    s_waitcnt lgkmcnt(0)
    ds_write_b128 v5, v[56:59] offset:20480
    ds_write_b128 v5, v[60:63] offset:21504
    s_branch L_lw_23
L_lw_23_0:
    s_cmp_lg_u32 s44, 1
    s_cbranch_scc1 L_lw_23_1
    ds_read_b64_tr_b16 v[208:209], v80 offset:0
    ds_read_b64_tr_b16 v[210:211], v80 offset:1024
    ds_read_b64_tr_b16 v[212:213], v80 offset:8192
    ds_read_b64_tr_b16 v[214:215], v80 offset:9216
    ds_read_b64_tr_b16 v[216:217], v81 offset:0
    ds_read_b64_tr_b16 v[218:219], v81 offset:1024
    ds_read_b64_tr_b16 v[220:221], v81 offset:8192
    ds_read_b64_tr_b16 v[222:223], v81 offset:9216
    s_branch L_lw_23
L_lw_23_1:
    s_cmp_lg_u32 s44, 2
    s_cbranch_scc1 L_lw_23_2
    ds_read_b64_tr_b16 a[248:249], v80 offset:0
    ds_read_b64_tr_b16 a[250:251], v80 offset:1024
    ds_read_b64_tr_b16 a[252:253], v80 offset:8192
    ds_read_b64_tr_b16 a[254:255], v80 offset:9216
    ds_read_b64_tr_b16 v[96:97], v81 offset:0
    ds_read_b64_tr_b16 v[98:99], v81 offset:1024
    ds_read_b64_tr_b16 v[100:101], v81 offset:8192
    ds_read_b64_tr_b16 v[102:103], v81 offset:9216
    s_branch L_lw_23
L_lw_23_2:
    ds_read_b64_tr_b16 a[152:153], v80 offset:0
    ds_read_b64_tr_b16 a[154:155], v80 offset:1024
    ds_read_b64_tr_b16 a[156:157], v80 offset:8192
    ds_read_b64_tr_b16 a[158:159], v80 offset:9216
    ds_read_b64_tr_b16 a[160:161], v81 offset:0
    ds_read_b64_tr_b16 a[162:163], v81 offset:1024
    ds_read_b64_tr_b16 a[164:165], v81 offset:8192
    ds_read_b64_tr_b16 a[166:167], v81 offset:9216
L_lw_23:
    s_waitcnt lgkmcnt(0)
    s_waitcnt vmcnt(8)
    s_barrier
    s_add_u32 s79, s41, 6
    s_and_b32 s79, s79, 3
    s_lshl_b32 s79, s79, 19
    s_add_u32 s79, s79, s47
    s_add_u32 s46, s79, 0x200000
    s_add_u32 m0, s48, 0
    s_nop 0
    buffer_load_dwordx4 v82, s[28:31], s46 offen  lds
    s_add_u32 s46, s79, 0x220000
    s_add_u32 m0, s48, 4096
    s_nop 0
    buffer_load_dwordx4 v82, s[28:31], s46 offen  lds
    s_add_u32 s46, s79, 0x240000
    s_add_u32 m0, s48, 8192
    s_nop 0
    buffer_load_dwordx4 v82, s[28:31], s46 offen  lds
    s_add_u32 s46, s79, 0x260000
    s_add_u32 m0, s48, 12288
    s_nop 0
    buffer_load_dwordx4 v82, s[28:31], s46 offen  lds
    s_cmp_lg_u32 s44, 0
    s_cbranch_scc1 L_lw_24_0
    ds_read_b64_tr_b16 a[88:89], v80 offset:16384
    ds_read_b64_tr_b16 a[90:91], v80 offset:17408
    ds_read_b64_tr_b16 a[92:93], v80 offset:24576
    ds_read_b64_tr_b16 a[94:95], v80 offset:25600
    ds_read_b64_tr_b16 v[56:57], v81 offset:16384
    ds_read_b64_tr_b16 v[58:59], v81 offset:17408
    ds_read_b64_tr_b16 v[60:61], v81 offset:24576
    ds_read_b64_tr_b16 v[62:63], v81 offset:25600
    s_waitcnt lgkmcnt(0)
    ds_write_b128 v5, v[56:59] offset:22528
    ds_write_b128 v5, v[60:63] offset:23552
    s_branch L_lw_24
L_lw_24_0:
    s_cmp_lg_u32 s44, 1
    s_cbranch_scc1 L_lw_24_1
    ds_read_b64_tr_b16 v[240:241], v80 offset:16384
    ds_read_b64_tr_b16 v[242:243], v80 offset:17408
    ds_read_b64_tr_b16 v[244:245], v80 offset:24576
    ds_read_b64_tr_b16 v[246:247], v80 offset:25600
    ds_read_b64_tr_b16 v[248:249], v81 offset:16384
    ds_read_b64_tr_b16 v[250:251], v81 offset:17408
    ds_read_b64_tr_b16 v[252:253], v81 offset:24576
    ds_read_b64_tr_b16 v[254:255], v81 offset:25600
    s_branch L_lw_24
L_lw_24_1:
    s_cmp_lg_u32 s44, 2
    s_cbranch_scc1 L_lw_24_2
    ds_read_b64_tr_b16 v[112:113], v80 offset:16384
    ds_read_b64_tr_b16 v[114:115], v80 offset:17408
    ds_read_b64_tr_b16 v[116:117], v80 offset:24576
    ds_read_b64_tr_b16 v[118:119], v80 offset:25600
    ds_read_b64_tr_b16 v[120:121], v81 offset:16384
    ds_read_b64_tr_b16 v[122:123], v81 offset:17408
    ds_read_b64_tr_b16 v[124:125], v81 offset:24576
    ds_read_b64_tr_b16 v[126:127], v81 offset:25600
    s_branch L_lw_24
L_lw_24_2:
    ds_read_b64_tr_b16 a[176:177], v80 offset:16384
    ds_read_b64_tr_b16 a[178:179], v80 offset:17408
    ds_read_b64_tr_b16 a[180:181], v80 offset:24576
    ds_read_b64_tr_b16 a[182:183], v80 offset:25600
    ds_read_b64_tr_b16 a[184:185], v81 offset:16384
    ds_read_b64_tr_b16 a[186:187], v81 offset:17408
    ds_read_b64_tr_b16 a[188:189], v81 offset:24576
    ds_read_b64_tr_b16 a[190:191], v81 offset:25600
L_lw_24:
    s_waitcnt lgkmcnt(0)
    s_waitcnt vmcnt(8)
    s_barrier
    s_add_u32 s79, s41, 7
    s_and_b32 s79, s79, 3
    s_lshl_b32 s79, s79, 19
    s_add_u32 s79, s79, s47
    s_add_u32 s46, s79, 0x200000
    s_add_u32 m0, s48, 16384
    s_nop 0
    buffer_load_dwordx4 v82, s[28:31], s46 offen  lds
    s_add_u32 s46, s79, 0x220000
    s_add_u32 m0, s48, 20480
    s_nop 0
    buffer_load_dwordx4 v82, s[28:31], s46 offen  lds
    s_add_u32 s46, s79, 0x240000
    s_add_u32 m0, s48, 24576
    s_nop 0
    buffer_load_dwordx4 v82, s[28:31], s46 offen  lds
    s_add_u32 s46, s79, 0x260000
    s_add_u32 m0, s48, 28672
    s_nop 0
    buffer_load_dwordx4 v82, s[28:31], s46 offen  lds
    s_cmp_lg_u32 s44, 0
    s_cbranch_scc1 L_lw_25_0
    ds_read_b64_tr_b16 a[104:105], v80 offset:32768
    ds_read_b64_tr_b16 a[106:107], v80 offset:33792
    ds_read_b64_tr_b16 a[108:109], v80 offset:40960
    ds_read_b64_tr_b16 a[110:111], v80 offset:41984
    ds_read_b64_tr_b16 a[112:113], v81 offset:32768
    ds_read_b64_tr_b16 a[114:115], v81 offset:33792
    ds_read_b64_tr_b16 a[116:117], v81 offset:40960
    ds_read_b64_tr_b16 a[118:119], v81 offset:41984
    s_branch L_lw_25
L_lw_25_0:
    s_cmp_lg_u32 s44, 1
    s_cbranch_scc1 L_lw_25_1
    ds_read_b64_tr_b16 a[16:17], v80 offset:32768
    ds_read_b64_tr_b16 a[18:19], v80 offset:33792
    ds_read_b64_tr_b16 a[20:21], v80 offset:40960
    ds_read_b64_tr_b16 a[22:23], v80 offset:41984
    ds_read_b64_tr_b16 a[24:25], v81 offset:32768
    ds_read_b64_tr_b16 a[26:27], v81 offset:33792
    ds_read_b64_tr_b16 a[28:29], v81 offset:40960
    ds_read_b64_tr_b16 a[30:31], v81 offset:41984
    s_branch L_lw_25
L_lw_25_1:
    s_cmp_lg_u32 s44, 2
    s_cbranch_scc1 L_lw_25_2
    ds_read_b64_tr_b16 v[144:145], v80 offset:32768
    ds_read_b64_tr_b16 v[146:147], v80 offset:33792
    ds_read_b64_tr_b16 v[148:149], v80 offset:40960
    ds_read_b64_tr_b16 v[150:151], v80 offset:41984
    ds_read_b64_tr_b16 v[152:153], v81 offset:32768
    ds_read_b64_tr_b16 v[154:155], v81 offset:33792
    ds_read_b64_tr_b16 v[156:157], v81 offset:40960
    ds_read_b64_tr_b16 v[158:159], v81 offset:41984
    s_branch L_lw_25
L_lw_25_2:
    ds_read_b64_tr_b16 a[200:201], v80 offset:32768
    ds_read_b64_tr_b16 a[202:203], v80 offset:33792
    ds_read_b64_tr_b16 a[204:205], v80 offset:40960
    ds_read_b64_tr_b16 a[206:207], v80 offset:41984
    ds_read_b64_tr_b16 a[208:209], v81 offset:32768
    ds_read_b64_tr_b16 a[210:211], v81 offset:33792
    ds_read_b64_tr_b16 a[212:213], v81 offset:40960
    ds_read_b64_tr_b16 a[214:215], v81 offset:41984
L_lw_25:
    s_waitcnt lgkmcnt(0)
    s_waitcnt vmcnt(8)
    s_barrier
    s_add_u32 s79, s41, 8
    s_and_b32 s79, s79, 3
    s_lshl_b32 s79, s79, 19
    s_add_u32 s79, s79, s47
    s_add_u32 s46, s79, 0x400000
    s_add_u32 m0, s48, 32768
    s_nop 0
    buffer_load_dwordx4 v82, s[28:31], s46 offen  lds
    s_add_u32 s46, s79, 0x420000
    s_add_u32 m0, s48, 36864
    s_nop 0
    buffer_load_dwordx4 v82, s[28:31], s46 offen  lds
    s_add_u32 s46, s79, 0x440000
    s_add_u32 m0, s48, 40960
    s_nop 0
    buffer_load_dwordx4 v82, s[28:31], s46 offen  lds
    s_add_u32 s46, s79, 0x460000
    s_add_u32 m0, s48, 45056
    s_nop 0
    buffer_load_dwordx4 v82, s[28:31], s46 offen  lds
    s_cmp_lg_u32 s44, 0
    s_cbranch_scc1 L_lw_26_0
    ds_read_b64_tr_b16 a[128:129], v80 offset:49152
    ds_read_b64_tr_b16 a[130:131], v80 offset:50176
    ds_read_b64_tr_b16 a[132:133], v80 offset:57344
    ds_read_b64_tr_b16 a[134:135], v80 offset:58368
    ds_read_b64_tr_b16 a[136:137], v81 offset:49152
    ds_read_b64_tr_b16 a[138:139], v81 offset:50176
    ds_read_b64_tr_b16 a[140:141], v81 offset:57344
    ds_read_b64_tr_b16 a[142:143], v81 offset:58368
    s_branch L_lw_26
L_lw_26_0:
    s_cmp_lg_u32 s44, 1
    s_cbranch_scc1 L_lw_26_1
    ds_read_b64_tr_b16 a[48:49], v80 offset:49152
    ds_read_b64_tr_b16 a[50:51], v80 offset:50176
    ds_read_b64_tr_b16 a[52:53], v80 offset:57344
    ds_read_b64_tr_b16 a[54:55], v80 offset:58368
    ds_read_b64_tr_b16 a[56:57], v81 offset:49152
    ds_read_b64_tr_b16 a[58:59], v81 offset:50176
    ds_read_b64_tr_b16 a[60:61], v81 offset:57344
    ds_read_b64_tr_b16 a[62:63], v81 offset:58368
    s_branch L_lw_26
L_lw_26_1:
    s_cmp_lg_u32 s44, 2
    s_cbranch_scc1 L_lw_26_2
    ds_read_b64_tr_b16 v[176:177], v80 offset:49152
    ds_read_b64_tr_b16 v[178:179], v80 offset:50176
    ds_read_b64_tr_b16 v[180:181], v80 offset:57344
    ds_read_b64_tr_b16 v[182:183], v80 offset:58368
    ds_read_b64_tr_b16 v[184:185], v81 offset:49152
    ds_read_b64_tr_b16 v[186:187], v81 offset:50176
    ds_read_b64_tr_b16 v[188:189], v81 offset:57344
    ds_read_b64_tr_b16 v[190:191], v81 offset:58368
    s_branch L_lw_26
L_lw_26_2:
    ds_read_b64_tr_b16 a[224:225], v80 offset:49152
    ds_read_b64_tr_b16 a[226:227], v80 offset:50176
    ds_read_b64_tr_b16 a[228:229], v80 offset:57344
    ds_read_b64_tr_b16 a[230:231], v80 offset:58368
    ds_read_b64_tr_b16 a[232:233], v81 offset:49152
    ds_read_b64_tr_b16 a[234:235], v81 offset:50176
    ds_read_b64_tr_b16 a[236:237], v81 offset:57344
    ds_read_b64_tr_b16 a[238:239], v81 offset:58368
L_lw_26:
    s_waitcnt lgkmcnt(0)
    s_waitcnt vmcnt(8)
    s_barrier
    s_add_u32 s79, s41, 9
    s_and_b32 s79, s79, 3
    s_lshl_b32 s79, s79, 19
    s_add_u32 s79, s79, s47
    s_add_u32 s46, s79, 0x400000
    s_add_u32 m0, s48, 49152
    s_nop 0
    buffer_load_dwordx4 v82, s[28:31], s46 offen  lds
    s_add_u32 s46, s79, 0x420000
    s_add_u32 m0, s48, 53248
    s_nop 0
    buffer_load_dwordx4 v82, s[28:31], s46 offen  lds
    s_add_u32 s46, s79, 0x440000
    s_add_u32 m0, s48, 57344
    s_nop 0
    buffer_load_dwordx4 v82, s[28:31], s46 offen  lds
    s_add_u32 s46, s79, 0x460000
    s_add_u32 m0, s48, 61440
    s_nop 0
    buffer_load_dwordx4 v82, s[28:31], s46 offen  lds
    s_cmp_lg_u32 s44, 0
    s_cbranch_scc1 L_lw_27_0
    ds_read_b64_tr_b16 a[152:153], v80 offset:0
    ds_read_b64_tr_b16 a[154:155], v80 offset:1024
    ds_read_b64_tr_b16 a[156:157], v80 offset:8192
    ds_read_b64_tr_b16 a[158:159], v80 offset:9216
    ds_read_b64_tr_b16 a[160:161], v81 offset:0
    ds_read_b64_tr_b16 a[162:163], v81 offset:1024
    ds_read_b64_tr_b16 a[164:165], v81 offset:8192
    ds_read_b64_tr_b16 a[166:167], v81 offset:9216
    s_branch L_lw_27
L_lw_27_0:
    s_cmp_lg_u32 s44, 1
    s_cbranch_scc1 L_lw_27_1
    ds_read_b64_tr_b16 a[72:73], v80 offset:0
    ds_read_b64_tr_b16 a[74:75], v80 offset:1024
    ds_read_b64_tr_b16 a[76:77], v80 offset:8192
    ds_read_b64_tr_b16 a[78:79], v80 offset:9216
    ds_read_b64_tr_b16 v[56:57], v81 offset:0
    ds_read_b64_tr_b16 v[58:59], v81 offset:1024
    ds_read_b64_tr_b16 v[60:61], v81 offset:8192
    ds_read_b64_tr_b16 v[62:63], v81 offset:9216
    s_waitcnt lgkmcnt(0)
    ds_write_b128 v5, v[56:59] offset:20480
    ds_write_b128 v5, v[60:63] offset:21504
    s_branch L_lw_27
L_lw_27_1:
    s_cmp_lg_u32 s44, 2
    s_cbranch_scc1 L_lw_27_2
    ds_read_b64_tr_b16 v[208:209], v80 offset:0
    ds_read_b64_tr_b16 v[210:211], v80 offset:1024
    ds_read_b64_tr_b16 v[212:213], v80 offset:8192
    ds_read_b64_tr_b16 v[214:215], v80 offset:9216
    ds_read_b64_tr_b16 v[216:217], v81 offset:0
    ds_read_b64_tr_b16 v[218:219], v81 offset:1024
    ds_read_b64_tr_b16 v[220:221], v81 offset:8192
    ds_read_b64_tr_b16 v[222:223], v81 offset:9216
    s_branch L_lw_27
L_lw_27_2:
    ds_read_b64_tr_b16 a[248:249], v80 offset:0
    ds_read_b64_tr_b16 a[250:251], v80 offset:1024
    ds_read_b64_tr_b16 a[252:253], v80 offset:8192
    ds_read_b64_tr_b16 a[254:255], v80 offset:9216
    ds_read_b64_tr_b16 v[96:97], v81 offset:0
    ds_read_b64_tr_b16 v[98:99], v81 offset:1024
    ds_read_b64_tr_b16 v[100:101], v81 offset:8192
    ds_read_b64_tr_b16 v[102:103], v81 offset:9216
L_lw_27:
    s_waitcnt lgkmcnt(0)
    s_waitcnt vmcnt(8)
    s_barrier
    s_add_u32 s79, s41, 10
    s_and_b32 s79, s79, 3
    s_lshl_b32 s79, s79, 19
    s_add_u32 s79, s79, s47
    s_add_u32 s46, s79, 0x400000
    s_add_u32 m0, s48, 0
    s_nop 0
    buffer_load_dwordx4 v82, s[28:31], s46 offen  lds
    s_add_u32 s46, s79, 0x420000
    s_add_u32 m0, s48, 4096
    s_nop 0
    buffer_load_dwordx4 v82, s[28:31], s46 offen  lds
    s_add_u32 s46, s79, 0x440000
    s_add_u32 m0, s48, 8192
    s_nop 0
    buffer_load_dwordx4 v82, s[28:31], s46 offen  lds
    s_add_u32 s46, s79, 0x460000
    s_add_u32 m0, s48, 12288
    s_nop 0
    buffer_load_dwordx4 v82, s[28:31], s46 offen  lds
    s_cmp_lg_u32 s44, 0
    s_cbranch_scc1 L_lw_28_0
    ds_read_b64_tr_b16 a[176:177], v80 offset:16384
    ds_read_b64_tr_b16 a[178:179], v80 offset:17408
    ds_read_b64_tr_b16 a[180:181], v80 offset:24576
    ds_read_b64_tr_b16 a[182:183], v80 offset:25600
    ds_read_b64_tr_b16 a[184:185], v81 offset:16384
    ds_read_b64_tr_b16 a[186:187], v81 offset:17408
    ds_read_b64_tr_b16 a[188:189], v81 offset:24576
    ds_read_b64_tr_b16 a[190:191], v81 offset:25600
    s_branch L_lw_28
L_lw_28_0:
    s_cmp_lg_u32 s44, 1
    s_cbranch_scc1 L_lw_28_1
    ds_read_b64_tr_b16 a[88:89], v80 offset:16384
    ds_read_b64_tr_b16 a[90:91], v80 offset:17408
    ds_read_b64_tr_b16 a[92:93], v80 offset:24576
    ds_read_b64_tr_b16 a[94:95], v80 offset:25600
    ds_read_b64_tr_b16 v[56:57], v81 offset:16384
    ds_read_b64_tr_b16 v[58:59], v81 offset:17408
    ds_read_b64_tr_b16 v[60:61], v81 offset:24576
    ds_read_b64_tr_b16 v[62:63], v81 offset:25600
    s_waitcnt lgkmcnt(0)
    ds_write_b128 v5, v[56:59] offset:22528
    ds_write_b128 v5, v[60:63] offset:23552
    s_branch L_lw_28
L_lw_28_1:
    s_cmp_lg_u32 s44, 2
    s_cbranch_scc1 L_lw_28_2
    ds_read_b64_tr_b16 v[240:241], v80 offset:16384
    ds_read_b64_tr_b16 v[242:243], v80 offset:17408
    ds_read_b64_tr_b16 v[244:245], v80 offset:24576
    ds_read_b64_tr_b16 v[246:247], v80 offset:25600
    ds_read_b64_tr_b16 v[248:249], v81 offset:16384
    ds_read_b64_tr_b16 v[250:251], v81 offset:17408
    ds_read_b64_tr_b16 v[252:253], v81 offset:24576
    ds_read_b64_tr_b16 v[254:255], v81 offset:25600
    s_branch L_lw_28
L_lw_28_2:
    ds_read_b64_tr_b16 v[112:113], v80 offset:16384
    ds_read_b64_tr_b16 v[114:115], v80 offset:17408
    ds_read_b64_tr_b16 v[116:117], v80 offset:24576
    ds_read_b64_tr_b16 v[118:119], v80 offset:25600
    ds_read_b64_tr_b16 v[120:121], v81 offset:16384
    ds_read_b64_tr_b16 v[122:123], v81 offset:17408
    ds_read_b64_tr_b16 v[124:125], v81 offset:24576
    ds_read_b64_tr_b16 v[126:127], v81 offset:25600
L_lw_28:
    s_waitcnt lgkmcnt(0)
    s_waitcnt vmcnt(8)
    s_barrier
    s_add_u32 s79, s41, 11
    s_and_b32 s79, s79, 3
    s_lshl_b32 s79, s79, 19
    s_add_u32 s79, s79, s47
    s_add_u32 s46, s79, 0x400000
    s_add_u32 m0, s48, 16384
    s_nop 0
    buffer_load_dwordx4 v82, s[28:31], s46 offen  lds
    s_add_u32 s46, s79, 0x420000
    s_add_u32 m0, s48, 20480
    s_nop 0
    buffer_load_dwordx4 v82, s[28:31], s46 offen  lds
    s_add_u32 s46, s79, 0x440000
    s_add_u32 m0, s48, 24576
    s_nop 0
    buffer_load_dwordx4 v82, s[28:31], s46 offen  lds
    s_add_u32 s46, s79, 0x460000
    s_add_u32 m0, s48, 28672
    s_nop 0
    buffer_load_dwordx4 v82, s[28:31], s46 offen  lds
    s_cmp_lg_u32 s44, 0
    s_cbranch_scc1 L_lw_29_0
    ds_read_b64_tr_b16 a[200:201], v80 offset:32768
    ds_read_b64_tr_b16 a[202:203], v80 offset:33792
    ds_read_b64_tr_b16 a[204:205], v80 offset:40960
    ds_read_b64_tr_b16 a[206:207], v80 offset:41984
    ds_read_b64_tr_b16 a[208:209], v81 offset:32768
    ds_read_b64_tr_b16 a[210:211], v81 offset:33792
    ds_read_b64_tr_b16 a[212:213], v81 offset:40960
    ds_read_b64_tr_b16 a[214:215], v81 offset:41984
    s_branch L_lw_29
L_lw_29_0:
    s_cmp_lg_u32 s44, 1
    s_cbranch_scc1 L_lw_29_1
    ds_read_b64_tr_b16 a[104:105], v80 offset:32768
    ds_read_b64_tr_b16 a[106:107], v80 offset:33792
    ds_read_b64_tr_b16 a[108:109], v80 offset:40960
    ds_read_b64_tr_b16 a[110:111], v80 offset:41984
    ds_read_b64_tr_b16 a[112:113], v81 offset:32768
    ds_read_b64_tr_b16 a[114:115], v81 offset:33792
    ds_read_b64_tr_b16 a[116:117], v81 offset:40960
    ds_read_b64_tr_b16 a[118:119], v81 offset:41984
    s_branch L_lw_29
L_lw_29_1:
    s_cmp_lg_u32 s44, 2
    s_cbranch_scc1 L_lw_29_2
    ds_read_b64_tr_b16 a[16:17], v80 offset:32768
    ds_read_b64_tr_b16 a[18:19], v80 offset:33792
    ds_read_b64_tr_b16 a[20:21], v80 offset:40960
    ds_read_b64_tr_b16 a[22:23], v80 offset:41984
    ds_read_b64_tr_b16 a[24:25], v81 offset:32768
    ds_read_b64_tr_b16 a[26:27], v81 offset:33792
    ds_read_b64_tr_b16 a[28:29], v81 offset:40960
    ds_read_b64_tr_b16 a[30:31], v81 offset:41984
    s_branch L_lw_29
L_lw_29_2:
    ds_read_b64_tr_b16 v[144:145], v80 offset:32768
    ds_read_b64_tr_b16 v[146:147], v80 offset:33792
    ds_read_b64_tr_b16 v[148:149], v80 offset:40960
    ds_read_b64_tr_b16 v[150:151], v80 offset:41984
    ds_read_b64_tr_b16 v[152:153], v81 offset:32768
    ds_read_b64_tr_b16 v[154:155], v81 offset:33792
    ds_read_b64_tr_b16 v[156:157], v81 offset:40960
    ds_read_b64_tr_b16 v[158:159], v81 offset:41984
L_lw_29:
    s_waitcnt lgkmcnt(0)
    s_waitcnt vmcnt(8)
    s_barrier
    s_add_u32 s79, s41, 12
    s_and_b32 s79, s79, 3
    s_lshl_b32 s79, s79, 19
    s_add_u32 s79, s79, s47
    s_add_u32 s46, s79, 0x600000
    s_add_u32 m0, s48, 32768
    s_nop 0
    buffer_load_dwordx4 v82, s[28:31], s46 offen  lds
    s_add_u32 s46, s79, 0x620000
    s_add_u32 m0, s48, 36864
    s_nop 0
    buffer_load_dwordx4 v82, s[28:31], s46 offen  lds
    s_add_u32 s46, s79, 0x640000
    s_add_u32 m0, s48, 40960
    s_nop 0
    buffer_load_dwordx4 v82, s[28:31], s46 offen  lds
    s_add_u32 s46, s79, 0x660000
    s_add_u32 m0, s48, 45056
    s_nop 0
    buffer_load_dwordx4 v82, s[28:31], s46 offen  lds
    s_cmp_lg_u32 s44, 0
    s_cbranch_scc1 L_lw_30_0
    ds_read_b64_tr_b16 a[224:225], v80 offset:49152
    ds_read_b64_tr_b16 a[226:227], v80 offset:50176
    ds_read_b64_tr_b16 a[228:229], v80 offset:57344
    ds_read_b64_tr_b16 a[230:231], v80 offset:58368
    ds_read_b64_tr_b16 a[232:233], v81 offset:49152
    ds_read_b64_tr_b16 a[234:235], v81 offset:50176
    ds_read_b64_tr_b16 a[236:237], v81 offset:57344
    ds_read_b64_tr_b16 a[238:239], v81 offset:58368
    s_branch L_lw_30
L_lw_30_0:
    s_cmp_lg_u32 s44, 1
    s_cbranch_scc1 L_lw_30_1
    ds_read_b64_tr_b16 a[128:129], v80 offset:49152
    ds_read_b64_tr_b16 a[130:131], v80 offset:50176
    ds_read_b64_tr_b16 a[132:133], v80 offset:57344
    ds_read_b64_tr_b16 a[134:135], v80 offset:58368
    ds_read_b64_tr_b16 a[136:137], v81 offset:49152
    ds_read_b64_tr_b16 a[138:139], v81 offset:50176
    ds_read_b64_tr_b16 a[140:141], v81 offset:57344
    ds_read_b64_tr_b16 a[142:143], v81 offset:58368
    s_branch L_lw_30
L_lw_30_1:
    s_cmp_lg_u32 s44, 2
    s_cbranch_scc1 L_lw_30_2
    ds_read_b64_tr_b16 a[48:49], v80 offset:49152
    ds_read_b64_tr_b16 a[50:51], v80 offset:50176
    ds_read_b64_tr_b16 a[52:53], v80 offset:57344
    ds_read_b64_tr_b16 a[54:55], v80 offset:58368
    ds_read_b64_tr_b16 a[56:57], v81 offset:49152
    ds_read_b64_tr_b16 a[58:59], v81 offset:50176
    ds_read_b64_tr_b16 a[60:61], v81 offset:57344
    ds_read_b64_tr_b16 a[62:63], v81 offset:58368
    s_branch L_lw_30
L_lw_30_2:
    ds_read_b64_tr_b16 v[176:177], v80 offset:49152
    ds_read_b64_tr_b16 v[178:179], v80 offset:50176
    ds_read_b64_tr_b16 v[180:181], v80 offset:57344
    ds_read_b64_tr_b16 v[182:183], v80 offset:58368
    ds_read_b64_tr_b16 v[184:185], v81 offset:49152
    ds_read_b64_tr_b16 v[186:187], v81 offset:50176
    ds_read_b64_tr_b16 v[188:189], v81 offset:57344
    ds_read_b64_tr_b16 v[190:191], v81 offset:58368
L_lw_30:
    s_waitcnt lgkmcnt(0)
    s_waitcnt vmcnt(8)
    s_barrier
    s_add_u32 s79, s41, 13
    s_and_b32 s79, s79, 3
    s_lshl_b32 s79, s79, 19
    s_add_u32 s79, s79, s47
    s_add_u32 s46, s79, 0x600000
    s_add_u32 m0, s48, 49152
    s_nop 0
    buffer_load_dwordx4 v82, s[28:31], s46 offen  lds
    s_add_u32 s46, s79, 0x620000
    s_add_u32 m0, s48, 53248
    s_nop 0
    buffer_load_dwordx4 v82, s[28:31], s46 offen  lds
    s_add_u32 s46, s79, 0x640000
    s_add_u32 m0, s48, 57344
    s_nop 0
    buffer_load_dwordx4 v82, s[28:31], s46 offen  lds
    s_add_u32 s46, s79, 0x660000
    s_add_u32 m0, s48, 61440
    s_nop 0
    buffer_load_dwordx4 v82, s[28:31], s46 offen  lds
    s_cmp_lg_u32 s44, 0
    s_cbranch_scc1 L_lw_31_0
    ds_read_b64_tr_b16 a[248:249], v80 offset:0
    ds_read_b64_tr_b16 a[250:251], v80 offset:1024
    ds_read_b64_tr_b16 a[252:253], v80 offset:8192
    ds_read_b64_tr_b16 a[254:255], v80 offset:9216
    ds_read_b64_tr_b16 v[96:97], v81 offset:0
    ds_read_b64_tr_b16 v[98:99], v81 offset:1024
    ds_read_b64_tr_b16 v[100:101], v81 offset:8192
    ds_read_b64_tr_b16 v[102:103], v81 offset:9216
    s_branch L_lw_31
L_lw_31_0:
    s_cmp_lg_u32 s44, 1
    s_cbranch_scc1 L_lw_31_1
    ds_read_b64_tr_b16 a[152:153], v80 offset:0
    ds_read_b64_tr_b16 a[154:155], v80 offset:1024
    ds_read_b64_tr_b16 a[156:157], v80 offset:8192
    ds_read_b64_tr_b16 a[158:159], v80 offset:9216
    ds_read_b64_tr_b16 a[160:161], v81 offset:0
    ds_read_b64_tr_b16 a[162:163], v81 offset:1024
    ds_read_b64_tr_b16 a[164:165], v81 offset:8192
    ds_read_b64_tr_b16 a[166:167], v81 offset:9216
    s_branch L_lw_31
L_lw_31_1:
    s_cmp_lg_u32 s44, 2
    s_cbranch_scc1 L_lw_31_2
    ds_read_b64_tr_b16 a[72:73], v80 offset:0
    ds_read_b64_tr_b16 a[74:75], v80 offset:1024
    ds_read_b64_tr_b16 a[76:77], v80 offset:8192
    ds_read_b64_tr_b16 a[78:79], v80 offset:9216
    ds_read_b64_tr_b16 v[56:57], v81 offset:0
    ds_read_b64_tr_b16 v[58:59], v81 offset:1024
    ds_read_b64_tr_b16 v[60:61], v81 offset:8192
    ds_read_b64_tr_b16 v[62:63], v81 offset:9216
    s_waitcnt lgkmcnt(0)
    ds_write_b128 v5, v[56:59] offset:20480
    ds_write_b128 v5, v[60:63] offset:21504
    s_branch L_lw_31
L_lw_31_2:
    ds_read_b64_tr_b16 v[208:209], v80 offset:0
    ds_read_b64_tr_b16 v[210:211], v80 offset:1024
    ds_read_b64_tr_b16 v[212:213], v80 offset:8192
    ds_read_b64_tr_b16 v[214:215], v80 offset:9216
    ds_read_b64_tr_b16 v[216:217], v81 offset:0
    ds_read_b64_tr_b16 v[218:219], v81 offset:1024
    ds_read_b64_tr_b16 v[220:221], v81 offset:8192
    ds_read_b64_tr_b16 v[222:223], v81 offset:9216
L_lw_31:
    s_waitcnt lgkmcnt(0)
    s_waitcnt vmcnt(8)
    s_barrier
    s_add_u32 s79, s41, 14
    s_and_b32 s79, s79, 3
    s_lshl_b32 s79, s79, 19
    s_add_u32 s79, s79, s47
    s_add_u32 s46, s79, 0x600000
    s_add_u32 m0, s48, 0
    s_nop 0
    buffer_load_dwordx4 v82, s[28:31], s46 offen  lds
    s_add_u32 s46, s79, 0x620000
    s_add_u32 m0, s48, 4096
    s_nop 0
    buffer_load_dwordx4 v82, s[28:31], s46 offen  lds
    s_add_u32 s46, s79, 0x640000
    s_add_u32 m0, s48, 8192
    s_nop 0
    buffer_load_dwordx4 v82, s[28:31], s46 offen  lds
    s_add_u32 s46, s79, 0x660000
    s_add_u32 m0, s48, 12288
    s_nop 0
    buffer_load_dwordx4 v82, s[28:31], s46 offen  lds
    s_cmp_lg_u32 s44, 0
    s_cbranch_scc1 L_lw_32_0
    ds_read_b64_tr_b16 v[112:113], v80 offset:16384
    ds_read_b64_tr_b16 v[114:115], v80 offset:17408
    ds_read_b64_tr_b16 v[116:117], v80 offset:24576
    ds_read_b64_tr_b16 v[118:119], v80 offset:25600
    ds_read_b64_tr_b16 v[120:121], v81 offset:16384
    ds_read_b64_tr_b16 v[122:123], v81 offset:17408
    ds_read_b64_tr_b16 v[124:125], v81 offset:24576
    ds_read_b64_tr_b16 v[126:127], v81 offset:25600
    s_branch L_lw_32
L_lw_32_0:
    s_cmp_lg_u32 s44, 1
    s_cbranch_scc1 L_lw_32_1
    ds_read_b64_tr_b16 a[176:177], v80 offset:16384
    ds_read_b64_tr_b16 a[178:179], v80 offset:17408
    ds_read_b64_tr_b16 a[180:181], v80 offset:24576
    ds_read_b64_tr_b16 a[182:183], v80 offset:25600
    ds_read_b64_tr_b16 a[184:185], v81 offset:16384
    ds_read_b64_tr_b16 a[186:187], v81 offset:17408
    ds_read_b64_tr_b16 a[188:189], v81 offset:24576
    ds_read_b64_tr_b16 a[190:191], v81 offset:25600
    s_branch L_lw_32
L_lw_32_1:
    s_cmp_lg_u32 s44, 2
    s_cbranch_scc1 L_lw_32_2
    ds_read_b64_tr_b16 a[88:89], v80 offset:16384
    ds_read_b64_tr_b16 a[90:91], v80 offset:17408
    ds_read_b64_tr_b16 a[92:93], v80 offset:24576
    ds_read_b64_tr_b16 a[94:95], v80 offset:25600
    ds_read_b64_tr_b16 v[56:57], v81 offset:16384
    ds_read_b64_tr_b16 v[58:59], v81 offset:17408
    ds_read_b64_tr_b16 v[60:61], v81 offset:24576
    ds_read_b64_tr_b16 v[62:63], v81 offset:25600
    s_waitcnt lgkmcnt(0)
    ds_write_b128 v5, v[56:59] offset:22528
    ds_write_b128 v5, v[60:63] offset:23552
    s_branch L_lw_32
L_lw_32_2:
    ds_read_b64_tr_b16 v[240:241], v80 offset:16384
    ds_read_b64_tr_b16 v[242:243], v80 offset:17408
    ds_read_b64_tr_b16 v[244:245], v80 offset:24576
    ds_read_b64_tr_b16 v[246:247], v80 offset:25600
    ds_read_b64_tr_b16 v[248:249], v81 offset:16384
    ds_read_b64_tr_b16 v[250:251], v81 offset:17408
    ds_read_b64_tr_b16 v[252:253], v81 offset:24576
    ds_read_b64_tr_b16 v[254:255], v81 offset:25600
L_lw_32:
    s_waitcnt lgkmcnt(0)
    s_waitcnt vmcnt(8)
    s_barrier
    s_add_u32 s79, s41, 15
    s_and_b32 s79, s79, 3
    s_lshl_b32 s79, s79, 19
    s_add_u32 s79, s79, s47
    s_add_u32 s46, s79, 0x600000
    s_add_u32 m0, s48, 16384
    s_nop 0
    buffer_load_dwordx4 v82, s[28:31], s46 offen  lds
    s_add_u32 s46, s79, 0x620000
    s_add_u32 m0, s48, 20480
    s_nop 0
    buffer_load_dwordx4 v82, s[28:31], s46 offen  lds
    s_add_u32 s46, s79, 0x640000
    s_add_u32 m0, s48, 24576
    s_nop 0
    buffer_load_dwordx4 v82, s[28:31], s46 offen  lds
    s_add_u32 s46, s79, 0x660000
    s_add_u32 m0, s48, 28672
    s_nop 0
    buffer_load_dwordx4 v82, s[28:31], s46 offen  lds
    v_mov_b32 v46, 0
    buffer_load_dwordx2 v[44:45], v46, s[16:19], 0 offen sc1
    s_cmp_lg_u32 s44, 0
    s_cbranch_scc1 L_lw_33_0
    ds_read_b64_tr_b16 v[144:145], v80 offset:32768
    ds_read_b64_tr_b16 v[146:147], v80 offset:33792
    ds_read_b64_tr_b16 v[148:149], v80 offset:40960
    ds_read_b64_tr_b16 v[150:151], v80 offset:41984
    ds_read_b64_tr_b16 v[152:153], v81 offset:32768
    ds_read_b64_tr_b16 v[154:155], v81 offset:33792
    ds_read_b64_tr_b16 v[156:157], v81 offset:40960
    ds_read_b64_tr_b16 v[158:159], v81 offset:41984
    s_branch L_lw_33
L_lw_33_0:
    s_cmp_lg_u32 s44, 1
    s_cbranch_scc1 L_lw_33_1
    ds_read_b64_tr_b16 a[200:201], v80 offset:32768
    ds_read_b64_tr_b16 a[202:203], v80 offset:33792
    ds_read_b64_tr_b16 a[204:205], v80 offset:40960
    ds_read_b64_tr_b16 a[206:207], v80 offset:41984
    ds_read_b64_tr_b16 a[208:209], v81 offset:32768
    ds_read_b64_tr_b16 a[210:211], v81 offset:33792
    ds_read_b64_tr_b16 a[212:213], v81 offset:40960
    ds_read_b64_tr_b16 a[214:215], v81 offset:41984
    s_branch L_lw_33
L_lw_33_1:
    s_cmp_lg_u32 s44, 2
    s_cbranch_scc1 L_lw_33_2
    ds_read_b64_tr_b16 a[104:105], v80 offset:32768
    ds_read_b64_tr_b16 a[106:107], v80 offset:33792
    ds_read_b64_tr_b16 a[108:109], v80 offset:40960
    ds_read_b64_tr_b16 a[110:111], v80 offset:41984
    ds_read_b64_tr_b16 a[112:113], v81 offset:32768
    ds_read_b64_tr_b16 a[114:115], v81 offset:33792
    ds_read_b64_tr_b16 a[116:117], v81 offset:40960
    ds_read_b64_tr_b16 a[118:119], v81 offset:41984
    s_branch L_lw_33
L_lw_33_2:
    ds_read_b64_tr_b16 a[16:17], v80 offset:32768
    ds_read_b64_tr_b16 a[18:19], v80 offset:33792
    ds_read_b64_tr_b16 a[20:21], v80 offset:40960
    ds_read_b64_tr_b16 a[22:23], v80 offset:41984
    ds_read_b64_tr_b16 a[24:25], v81 offset:32768
    ds_read_b64_tr_b16 a[26:27], v81 offset:33792
    ds_read_b64_tr_b16 a[28:29], v81 offset:40960
    ds_read_b64_tr_b16 a[30:31], v81 offset:41984
L_lw_33:
    s_waitcnt lgkmcnt(0)
    s_waitcnt vmcnt(8)
    s_barrier
    s_cmp_lg_u32 s44, 0
    s_cbranch_scc1 L_lw_34_0
    ds_read_b64_tr_b16 v[176:177], v80 offset:49152
    ds_read_b64_tr_b16 v[178:179], v80 offset:50176
    ds_read_b64_tr_b16 v[180:181], v80 offset:57344
    ds_read_b64_tr_b16 v[182:183], v80 offset:58368
    ds_read_b64_tr_b16 v[184:185], v81 offset:49152
    ds_read_b64_tr_b16 v[186:187], v81 offset:50176
    ds_read_b64_tr_b16 v[188:189], v81 offset:57344
    ds_read_b64_tr_b16 v[190:191], v81 offset:58368
    s_branch L_lw_34
L_lw_34_0:
    s_cmp_lg_u32 s44, 1
    s_cbranch_scc1 L_lw_34_1
    ds_read_b64_tr_b16 a[224:225], v80 offset:49152
    ds_read_b64_tr_b16 a[226:227], v80 offset:50176
    ds_read_b64_tr_b16 a[228:229], v80 offset:57344
    ds_read_b64_tr_b16 a[230:231], v80 offset:58368
    ds_read_b64_tr_b16 a[232:233], v81 offset:49152
    ds_read_b64_tr_b16 a[234:235], v81 offset:50176
    ds_read_b64_tr_b16 a[236:237], v81 offset:57344
    ds_read_b64_tr_b16 a[238:239], v81 offset:58368
    s_branch L_lw_34
L_lw_34_1:
    s_cmp_lg_u32 s44, 2
    s_cbranch_scc1 L_lw_34_2
    ds_read_b64_tr_b16 a[128:129], v80 offset:49152
    ds_read_b64_tr_b16 a[130:131], v80 offset:50176
    ds_read_b64_tr_b16 a[132:133], v80 offset:57344
    ds_read_b64_tr_b16 a[134:135], v80 offset:58368
    ds_read_b64_tr_b16 a[136:137], v81 offset:49152
    ds_read_b64_tr_b16 a[138:139], v81 offset:50176
    ds_read_b64_tr_b16 a[140:141], v81 offset:57344
    ds_read_b64_tr_b16 a[142:143], v81 offset:58368
    s_branch L_lw_34
L_lw_34_2:
    ds_read_b64_tr_b16 a[48:49], v80 offset:49152
    ds_read_b64_tr_b16 a[50:51], v80 offset:50176
    ds_read_b64_tr_b16 a[52:53], v80 offset:57344
    ds_read_b64_tr_b16 a[54:55], v80 offset:58368
    ds_read_b64_tr_b16 a[56:57], v81 offset:49152
    ds_read_b64_tr_b16 a[58:59], v81 offset:50176
    ds_read_b64_tr_b16 a[60:61], v81 offset:57344
    ds_read_b64_tr_b16 a[62:63], v81 offset:58368
L_lw_34:
    s_waitcnt lgkmcnt(0)
    s_waitcnt vmcnt(4)
    s_barrier
    s_cmp_lg_u32 s44, 0
    s_cbranch_scc1 L_lw_35_0
    ds_read_b64_tr_b16 v[208:209], v80 offset:0
    ds_read_b64_tr_b16 v[210:211], v80 offset:1024
    ds_read_b64_tr_b16 v[212:213], v80 offset:8192
    ds_read_b64_tr_b16 v[214:215], v80 offset:9216
    ds_read_b64_tr_b16 v[216:217], v81 offset:0
    ds_read_b64_tr_b16 v[218:219], v81 offset:1024
    ds_read_b64_tr_b16 v[220:221], v81 offset:8192
    ds_read_b64_tr_b16 v[222:223], v81 offset:9216
    s_branch L_lw_35
L_lw_35_0:
    s_cmp_lg_u32 s44, 1
    s_cbranch_scc1 L_lw_35_1
    ds_read_b64_tr_b16 a[248:249], v80 offset:0
    ds_read_b64_tr_b16 a[250:251], v80 offset:1024
    ds_read_b64_tr_b16 a[252:253], v80 offset:8192
    ds_read_b64_tr_b16 a[254:255], v80 offset:9216
    ds_read_b64_tr_b16 v[96:97], v81 offset:0
    ds_read_b64_tr_b16 v[98:99], v81 offset:1024
    ds_read_b64_tr_b16 v[100:101], v81 offset:8192
    ds_read_b64_tr_b16 v[102:103], v81 offset:9216
    s_branch L_lw_35
L_lw_35_1:
    s_cmp_lg_u32 s44, 2
    s_cbranch_scc1 L_lw_35_2
    ds_read_b64_tr_b16 a[152:153], v80 offset:0
    ds_read_b64_tr_b16 a[154:155], v80 offset:1024
    ds_read_b64_tr_b16 a[156:157], v80 offset:8192
    ds_read_b64_tr_b16 a[158:159], v80 offset:9216
    ds_read_b64_tr_b16 a[160:161], v81 offset:0
    ds_read_b64_tr_b16 a[162:163], v81 offset:1024
    ds_read_b64_tr_b16 a[164:165], v81 offset:8192
    ds_read_b64_tr_b16 a[166:167], v81 offset:9216
    s_branch L_lw_35
L_lw_35_2:
    ds_read_b64_tr_b16 a[72:73], v80 offset:0
    ds_read_b64_tr_b16 a[74:75], v80 offset:1024
    ds_read_b64_tr_b16 a[76:77], v80 offset:8192
    ds_read_b64_tr_b16 a[78:79], v80 offset:9216
    ds_read_b64_tr_b16 v[56:57], v81 offset:0
    ds_read_b64_tr_b16 v[58:59], v81 offset:1024
    ds_read_b64_tr_b16 v[60:61], v81 offset:8192
    ds_read_b64_tr_b16 v[62:63], v81 offset:9216
    s_waitcnt lgkmcnt(0)
    ds_write_b128 v5, v[56:59] offset:20480
    ds_write_b128 v5, v[60:63] offset:21504
L_lw_35:
    s_waitcnt lgkmcnt(0)
    s_waitcnt vmcnt(0)
    s_barrier
    s_add_u32 s63, s62, 0
    buffer_load_dword v47, v17, s[12:15], s63 offen sc1
    s_add_u32 s63, s62, 32768
    buffer_load_dword v47, v17, s[12:15], s63 offen sc1
    s_add_u32 s63, s62, 65536
    buffer_load_dword v47, v17, s[12:15], s63 offen sc1
    s_add_u32 s63, s62, 98304
    buffer_load_dword v47, v17, s[12:15], s63 offen sc1
    buffer_load_dword v47, v20, s[12:15], 0 offen sc1
    s_cmp_lg_u32 s44, 0
    s_cbranch_scc1 L_lw_36_0
    ds_read_b64_tr_b16 v[240:241], v80 offset:16384
    ds_read_b64_tr_b16 v[242:243], v80 offset:17408
    ds_read_b64_tr_b16 v[244:245], v80 offset:24576
    ds_read_b64_tr_b16 v[246:247], v80 offset:25600
    ds_read_b64_tr_b16 v[248:249], v81 offset:16384
    ds_read_b64_tr_b16 v[250:251], v81 offset:17408
    ds_read_b64_tr_b16 v[252:253], v81 offset:24576
    ds_read_b64_tr_b16 v[254:255], v81 offset:25600
    s_branch L_lw_36
L_lw_36_0:
    s_cmp_lg_u32 s44, 1
    s_cbranch_scc1 L_lw_36_1
    ds_read_b64_tr_b16 v[112:113], v80 offset:16384
    ds_read_b64_tr_b16 v[114:115], v80 offset:17408
    ds_read_b64_tr_b16 v[116:117], v80 offset:24576
    ds_read_b64_tr_b16 v[118:119], v80 offset:25600
    ds_read_b64_tr_b16 v[120:121], v81 offset:16384
    ds_read_b64_tr_b16 v[122:123], v81 offset:17408
    ds_read_b64_tr_b16 v[124:125], v81 offset:24576
    ds_read_b64_tr_b16 v[126:127], v81 offset:25600
    s_branch L_lw_36
L_lw_36_1:
    s_cmp_lg_u32 s44, 2
    s_cbranch_scc1 L_lw_36_2
    ds_read_b64_tr_b16 a[176:177], v80 offset:16384
    ds_read_b64_tr_b16 a[178:179], v80 offset:17408
    ds_read_b64_tr_b16 a[180:181], v80 offset:24576
    ds_read_b64_tr_b16 a[182:183], v80 offset:25600
    ds_read_b64_tr_b16 a[184:185], v81 offset:16384
    ds_read_b64_tr_b16 a[186:187], v81 offset:17408
    ds_read_b64_tr_b16 a[188:189], v81 offset:24576
    ds_read_b64_tr_b16 a[190:191], v81 offset:25600
    s_branch L_lw_36
L_lw_36_2:
    ds_read_b64_tr_b16 a[88:89], v80 offset:16384
    ds_read_b64_tr_b16 a[90:91], v80 offset:17408
    ds_read_b64_tr_b16 a[92:93], v80 offset:24576
    ds_read_b64_tr_b16 a[94:95], v80 offset:25600
    ds_read_b64_tr_b16 v[56:57], v81 offset:16384
    ds_read_b64_tr_b16 v[58:59], v81 offset:17408
    ds_read_b64_tr_b16 v[60:61], v81 offset:24576
    ds_read_b64_tr_b16 v[62:63], v81 offset:25600
    s_waitcnt lgkmcnt(0)
    ds_write_b128 v5, v[56:59] offset:22528
    ds_write_b128 v5, v[60:63] offset:23552
L_lw_36:
    s_waitcnt lgkmcnt(0)
    s_barrier
    v_and_b32 v63, 15, v1
    v_lshrrev_b32 v64, 4, v1
    v_lshrrev_b32 v65, 5, v1
    v_lshlrev_b32 v65, 4, v65
    v_add_u32 v65, v65, v63
    v_lshlrev_b32 v65, 4, v65
    v_and_b32 v66, 1, v64
    v_lshlrev_b32 v66, 3, v66
    s_lshl_b32 s45, s44, 9
    s_add_u32 s45, s45, 53248
    v_add3_u32 v6, v65, v66, s45
    v_bfe_u32 v65, v1, 2, 2
    v_lshlrev_b32 v66, 3, v64
    v_add_u32 v65, v65, v66
    v_lshlrev_b32 v65, 4, v65
    v_and_b32 v66, 1, v1
    v_lshlrev_b32 v66, 3, v66
    v_add_u32 v65, v65, v66
    v_add_u32 v7, 53248, v65
    v_bfe_u32 v65, v1, 2, 1
    v_mul_u32_u24 v65, 520, v65
    v_bfe_u32 v66, v1, 3, 1
    v_lshlrev_b32 v14, 7, v66
    v_and_b32 v67, 3, v1
    v_lshlrev_b32 v67, 5, v67
    v_add3_u32 v65, v65, v14, v67
    v_lshlrev_b32 v66, 1, v66
    v_xor_b32 v66, v66, v64
    v_lshlrev_b32 v66, 3, v66
    s_mul_i32 s45, s44, 1040
    s_add_u32 s45, s45, 55296
    v_add3_u32 v18, v65, v66, s45
    v_lshlrev_b32 v14, 3, v1
    v_and_b32 v65, 16, v1
    v_xor_b32 v14, v14, v65
    v_lshlrev_b32 v16, 3, v1
    v_lshlrev_b32 v8, 4, v1
    v_lshrrev_b32 v65, 2, v1
    v_lshlrev_b32 v65, 4, v65
    v_and_b32 v66, 1, v1
    v_lshlrev_b32 v66, 3, v66
    s_lshl_b32 s45, s44, 11
    v_add3_u32 v65, v65, v66, s45
    v_and_b32 v66, 2, v1
    v_lshlrev_b32 v66, 7, v66
    v_add_u32 v9, v65, v66
    s_lshl_b32 s45, s43, 11
    s_lshl_b32 s46, s44, 9
    s_add_u32 s45, s45, s46
    s_add_u32 s51, s45, 0x7020000
    s_lshl_b32 s63, s43, 19
    s_add_u32 s63, s63, 0x3000000
    s_mov_b32 s50, 0
    s_lshl_b32 s64, s44, 11
    s_sub_u32 s63, s63, s64
    s_add_u32 s64, s64, 16384
    s_add_u32 s65, s64, 8192
    s_lshl_b32 s66, s43, 12
    s_add_u32 s66, s66, 0x1000000
    s_mov_b32 s69, 16384
    s_mov_b32 s52, 0x3e0293ee
    s_mov_b32 s53, 0x41800000
    s_lshl_b32 s45, s40, 5
    s_add_u32 s45, s45, s41
    s_lshl_b32 s45, s45, 8
    s_lshl_b32 s46, s44, 6
    s_add_u32 s45, s45, s46
    s_add_u32 s45, s45, 0x7084000
    v_and_b32 v19, 15, v1
    v_lshlrev_b32 v19, 2, v19
    v_add_u32 v19, s45, v19
    s_mov_b32 s70, 0
    v_mov_b32 v41, 0
    s_branch L_hw_37_c
L_hw_37:
    buffer_load_dwordx2 v[44:45], v41, s[16:19], 0 offen sc1
    s_add_u32 s70, s70, 1
    s_cmp_ge_u32 s70, 0x100000
    s_cbranch_scc1 L_c_done_1
L_hw_37_c:
    s_waitcnt vmcnt(0)
    v_readfirstlane_b32 s45, v44
    v_readfirstlane_b32 s46, v45
    s_nop 3
    s_lshr_b32 s47, s46, 24
    s_cmp_lg_u32 s47, 64
    s_cbranch_scc1 L_hw_37
    s_lshr_b32 s68, s45, 24
    s_and_b32 s47, s45, 511
    s_mul_i32 s47, s47, s47
    s_bfe_u32 s45, s45, 0xf0009
    s_lshl_b32 s45, s45, 5
    s_sub_u32 s45, s45, s47
    s_and_b32 s47, s46, 511
    s_mul_i32 s47, s47, s47
    s_bfe_u32 s46, s46, 0xf0009
    s_lshl_b32 s46, s46, 5
    s_sub_u32 s46, s46, s47
    s_or_b32 s45, s45, s46
    s_cmp_eq_u32 s45, 0
    s_cselect_b32 s67, 1, 0
    s_mov_b32 s24, s12
    s_mov_b32 s25, s13
    s_mov_b32 s28, s12
    s_mov_b32 s29, s13
    s_cmp_eq_u32 s67, 1
    s_cselect_b32 s26, s14, 0
    s_cselect_b32 s30, 0, s14
    s_cmp_ge_u32 s68, 16
    s_cselect_b32 s68, 8192, 0
    s_mov_b32 s6, 0x11111111
    s_mov_b32 s7, 0xffaaa491
    s_mov_b32 s60, 0
    s_lshl_b32 s58, s40, 16
    s_add_u32 s58, s58, 0x7000000
    s_mov_b32 s61, s58
    s_lshl_b32 s59, s40, 17
    s_add_u32 s59, s59, 0x7040000
    s_mov_b32 s62, s59
    s_add_u32 s32, s41, 0
    s_and_b32 s32, s32, 3
    s_lshl_b32 s32, s32, 10
    s_add_u32 s33, s41, 1
    s_and_b32 s33, s33, 3
    s_lshl_b32 s33, s33, 10
    s_add_u32 s34, s41, 2
    s_and_b32 s34, s34, 3
    s_lshl_b32 s34, s34, 10
    s_add_u32 s35, s41, 3
    s_and_b32 s35, s35, 3
    s_lshl_b32 s35, s35, 10
    s_mov_b32 s47, 0
    s_cmp_lt_u32 s47, s50
    s_cbranch_scc1 L_kv_rdy_38
    s_lshl_b32 s45, s43, 7
    s_add_u32 s45, s45, 0x10014
    v_mov_b32 v0, 0
    s_mov_b32 s70, 0
L_kv_rdy_38_p:
    buffer_load_dwordx2 v[10:11], v0, s[12:15], s45 offen sc1
    s_add_u32 s70, s70, 1
    s_cmp_ge_u32 s70, 0x200000
    s_cbranch_scc1 L_c_done_1
    s_waitcnt vmcnt(0)
    v_min_u32 v10, v10, v11
    s_nop 0
    v_readfirstlane_b32 s50, v10
    s_nop 3
    s_cmp_lt_u32 s47, s50
    s_cbranch_scc1 L_kv_rdy_38
    s_sleep 2
    s_branch L_kv_rdy_38_p
L_kv_rdy_38:
    s_mov_b32 m0, s64
    s_add_u32 s46, s63, 0x1000000
    buffer_load_dwordx4 v3, s[12:15], s63 offen sc1 lds
    buffer_load_dwordx4 v3, s[12:15], s63 offen offset:1024 sc1 lds
    s_mov_b32 m0, s65
    s_add_u32 s63, s63, 8192
    buffer_load_dwordx4 v3, s[12:15], s46 offen sc1 lds
    buffer_load_dwordx4 v3, s[12:15], s46 offen offset:1024 sc1 lds
    s_add_u32 s64, s64, 16384
    s_add_u32 s65, s65, 16384
    s_cmp_lg_u32 s44, 0
    s_cbranch_scc1 L_ld_39
    v_mov_b32 v40, 1
    v_mov_b32 v41, 127360
    s_mov_b64 exec, 1
    buffer_atomic_add v40, v41, s[12:15], 0 offen sc1
    s_mov_b64 exec, -1
L_ld_39:
L_q_loop_40:
    ds_read_b128 v[56:59], v5 offset:8192
    ds_read_b128 v[60:63], v5 offset:9216
    ds_read_b128 v[64:67], v5 offset:20480
    ds_read_b128 v[68:71], v5 offset:21504
    ds_read_b128 v[72:75], v5 offset:14336
    ds_read_b128 v[76:79], v5 offset:15360
    ds_read_b128 v[80:83], v5 offset:22528
    ds_read_b128 v[84:87], v5 offset:23552
    ds_read_b128 v[88:91], v5 offset:2048
    ds_read_b128 v[92:95], v5 offset:3072
    s_add_u32 s46, s60, 1
    v_mov_b32 v15, s46
    v_mov_b32 v0, -1
    v_mov_b32 v24, 0
    v_mov_b32 v25, 0
    v_mov_b32 v26, 0
    v_mov_b32 v27, 0
    v_mov_b32 v28, 0
    v_mov_b32 v29, 0
    v_mov_b32 v30, 0
    v_mov_b32 v31, 0
    v_mov_b32 v32, 0
    v_mov_b32 v33, 0
    v_mov_b32 v34, 0
    v_mov_b32 v35, 0
    v_mov_b32 v36, 0
    v_mov_b32 v37, 0
    v_mov_b32 v38, 0
    v_mov_b32 v39, 0
    s_add_u32 s8, s61, s32
    s_add_u32 s9, s61, s33
    s_add_u32 s10, s61, s34
    s_add_u32 s11, s61, s35
    s_cmp_eq_u32 s60, 0
    s_cbranch_scc1 L_q_first_41
    s_sleep 16
    s_waitcnt vmcnt(0)
    s_mov_b64 exec, 65535
    buffer_load_dword v10, v19, s[12:15], 0 offen sc1
    s_nop 15
    buffer_load_dword v11, v19, s[12:15], 0 offen sc1
    s_nop 15
    buffer_load_dword v12, v19, s[12:15], 0 offen sc1
    s_nop 15
    buffer_load_dword v13, v19, s[12:15], 0 offen sc1
    s_mov_b32 s70, 0
L_pp_42:
    s_waitcnt vmcnt(3)
    v_cmp_gt_u32 vcc, s60, v10
    s_add_u32 s70, s70, 1
    s_nop 0
    s_cbranch_vccz L_ppd_43
    buffer_load_dword v10, v19, s[12:15], 0 offen sc1
    s_waitcnt vmcnt(3)
    v_cmp_gt_u32 vcc, s60, v11
    s_add_u32 s70, s70, 1
    s_nop 0
    s_cbranch_vccz L_ppd_43
    buffer_load_dword v11, v19, s[12:15], 0 offen sc1
    s_waitcnt vmcnt(3)
    v_cmp_gt_u32 vcc, s60, v12
    s_add_u32 s70, s70, 1
    s_nop 0
    s_cbranch_vccz L_ppd_43
    buffer_load_dword v12, v19, s[12:15], 0 offen sc1
    s_waitcnt vmcnt(3)
    v_cmp_gt_u32 vcc, s60, v13
    s_add_u32 s70, s70, 1
    s_nop 0
    s_cbranch_vccz L_ppd_43
    buffer_load_dword v13, v19, s[12:15], 0 offen sc1
    s_cmp_lt_u32 s70, 0x400000
    s_cbranch_scc1 L_pp_42
    s_branch L_c_done_1
L_ppd_43:
    s_mov_b64 exec, -1
L_q_first_41:
    s_waitcnt lgkmcnt(0)
    buffer_load_dwordx4 v[40:43], v3, s[12:15], s8 offen sc1
    s_nop 4
    buffer_load_dwordx4 v[44:47], v3, s[12:15], s9 offen sc1
    s_nop 4
    buffer_load_dwordx4 v[48:51], v3, s[12:15], s10 offen sc1
    s_nop 4
    buffer_load_dwordx4 v[52:55], v3, s[12:15], s11 offen sc1
    s_mov_b32 s70, 0
L_mg_44_p:
    s_waitcnt vmcnt(3)
    ds_write_b128 v3, v[40:43] offset:0
    v_smfmac_f32_16x16x64_bf16 v[24:27], v[40:43], a[0:7], v2
    v_max3_u32 v22, v40, v41, v42
    v_smfmac_f32_16x16x64_bf16 v[28:31], v[40:43], a[8:15], v2
    v_max_u32 v22, v22, v43
    v_smfmac_f32_16x16x64_bf16 v[32:35], v[40:43], a[16:23], v2
    v_smfmac_f32_16x16x64_bf16 v[36:39], v[40:43], a[24:31], v2
    s_waitcnt vmcnt(2)
    ds_write_b128 v3, v[44:47] offset:1024
    v_smfmac_f32_16x16x64_bf16 v[24:27], v[44:47], a[32:39], v2
    v_max3_u32 v22, v22, v44, v45
    v_smfmac_f32_16x16x64_bf16 v[28:31], v[44:47], a[40:47], v2
    v_max3_u32 v22, v22, v46, v47
    v_smfmac_f32_16x16x64_bf16 v[32:35], v[44:47], a[48:55], v2
    v_smfmac_f32_16x16x64_bf16 v[36:39], v[44:47], a[56:63], v2
    s_waitcnt vmcnt(1)
    ds_write_b128 v3, v[48:51] offset:2048
    v_smfmac_f32_16x16x64_bf16 v[24:27], v[48:51], a[64:71], v2
    v_max3_u32 v22, v22, v48, v49
    v_smfmac_f32_16x16x64_bf16 v[28:31], v[48:51], v[56:63], v2
    v_max3_u32 v22, v22, v50, v51
    s_waitcnt vmcnt(0)
    ds_write_b128 v3, v[52:55] offset:3072
    v_smfmac_f32_16x16x64_bf16 v[32:35], v[48:51], a[72:79], v2
    v_max3_u32 v22, v22, v52, v53
    v_smfmac_f32_16x16x64_bf16 v[36:39], v[48:51], v[64:71], v2
    v_max3_u32 v22, v22, v54, v55
    v_cmp_eq_u32 vcc, -1, v22
    s_nop 0
    s_waitcnt lgkmcnt(0)
    s_cbranch_vccnz L_mg_44_r
    s_barrier
    ds_read_b128 v[40:43], v4 offset:0
    ds_read_b128 v[44:47], v4 offset:1024
    ds_read_b128 v[48:51], v4 offset:2048
    ds_read_b128 v[56:59], v5 offset:6144
    v_smfmac_f32_16x16x64_bf16 v[24:27], v[52:55], a[80:87], v2
    ds_read_b128 v[60:63], v5 offset:7168
    v_smfmac_f32_16x16x64_bf16 v[28:31], v[52:55], v[72:79], v2
    ds_read_b128 v[64:67], v5 offset:12288
    v_smfmac_f32_16x16x64_bf16 v[32:35], v[52:55], a[88:95], v2
    ds_read_b128 v[68:71], v5 offset:13312
    v_smfmac_f32_16x16x64_bf16 v[36:39], v[52:55], v[80:87], v2
    ds_read_b128 v[52:55], v4 offset:3072
    s_waitcnt lgkmcnt(4)
    v_smfmac_f32_16x16x64_bf16 v[24:27], v[40:43], a[96:103], v2
    ds_read_b128 v[72:75], v5 offset:18432
    v_smfmac_f32_16x16x64_bf16 v[28:31], v[40:43], v[88:95], v2
    ds_read_b128 v[76:79], v5 offset:19456
    v_smfmac_f32_16x16x64_bf16 v[32:35], v[40:43], a[104:111], v2
    ds_read_b128 v[80:83], v5 offset:0
    v_smfmac_f32_16x16x64_bf16 v[36:39], v[40:43], a[112:119], v2
    ds_read_b128 v[40:43], v21 offset:0
    v_smfmac_f32_16x16x64_bf16 v[24:27], v[44:47], a[120:127], v2
    ds_read_b128 v[84:87], v5 offset:1024
    s_waitcnt lgkmcnt(4)
    v_smfmac_f32_16x16x64_bf16 v[28:31], v[44:47], v[56:63], v2
    ds_read_b128 v[88:91], v5 offset:4096
    v_smfmac_f32_16x16x64_bf16 v[32:35], v[44:47], a[128:135], v2
    ds_read_b128 v[92:95], v5 offset:5120
    v_smfmac_f32_16x16x64_bf16 v[36:39], v[44:47], a[136:143], v2
    ds_read_b128 v[44:47], v21 offset:1024
    v_smfmac_f32_16x16x64_bf16 v[24:27], v[48:51], a[144:151], v2
    ds_read_b128 v[56:59], v5 offset:10240
    v_smfmac_f32_16x16x64_bf16 v[28:31], v[48:51], v[64:71], v2
    ds_read_b128 v[48:51], v21 offset:2048
    v_smfmac_f32_16x16x64_bf16 v[24:27], v[52:55], a[168:175], v2
    ds_read_b128 v[60:63], v5 offset:11264
    s_waitcnt lgkmcnt(4)
    v_smfmac_f32_16x16x64_bf16 v[28:31], v[52:55], v[72:79], v2
    ds_read_b128 v[52:55], v21 offset:3072
    v_smfmac_f32_16x16x64_bf16 v[24:27], v[40:43], a[192:199], v2
    ds_read_b128 v[64:67], v5 offset:16384
    v_smfmac_f32_16x16x64_bf16 v[28:31], v[40:43], v[80:87], v2
    ds_read_b128 v[40:43], v23 offset:0
    s_waitcnt lgkmcnt(4)
    v_smfmac_f32_16x16x64_bf16 v[24:27], v[44:47], a[216:223], v2
    ds_read_b128 v[68:71], v5 offset:17408
    v_smfmac_f32_16x16x64_bf16 v[28:31], v[44:47], v[88:95], v2
    ds_read_b128 v[44:47], v23 offset:1024
    v_smfmac_f32_16x16x64_bf16 v[24:27], v[48:51], a[240:247], v2
    s_waitcnt lgkmcnt(3)
    v_smfmac_f32_16x16x64_bf16 v[28:31], v[48:51], v[56:63], v2
    ds_read_b128 v[48:51], v23 offset:2048
    v_smfmac_f32_16x16x64_bf16 v[24:27], v[52:55], v[104:111], v2
    s_waitcnt lgkmcnt(2)
    v_smfmac_f32_16x16x64_bf16 v[28:31], v[52:55], v[64:71], v2
    ds_read_b128 v[52:55], v23 offset:3072
    v_smfmac_f32_16x16x64_bf16 v[24:27], v[40:43], v[128:135], v2
    v_smfmac_f32_16x16x64_bf16 v[28:31], v[40:43], v[136:143], v2
    s_waitcnt lgkmcnt(1)
    v_smfmac_f32_16x16x64_bf16 v[24:27], v[44:47], v[160:167], v2
    v_smfmac_f32_16x16x64_bf16 v[28:31], v[44:47], v[168:175], v2
    ds_read_b128 v[72:75], v8 offset:20480
    v_smfmac_f32_16x16x64_bf16 v[24:27], v[48:51], v[192:199], v2
    ds_read_b128 v[76:79], v8 offset:21504
    v_smfmac_f32_16x16x64_bf16 v[28:31], v[48:51], v[200:207], v2
    ds_read_b128 v[56:59], v8 offset:16384
    s_waitcnt lgkmcnt(3)
    v_smfmac_f32_16x16x64_bf16 v[24:27], v[52:55], v[224:231], v2
    ds_read_b128 v[60:63], v8 offset:17408
    v_smfmac_f32_16x16x64_bf16 v[28:31], v[52:55], v[232:239], v2
    ds_read_b128 v[64:67], v8 offset:18432
    v_smfmac_f32_16x16x64_bf16 v[32:35], v[52:55], v[240:247], v2
    ds_read_b128 v[68:71], v8 offset:19456
    v_smfmac_f32_16x16x64_bf16 v[36:39], v[52:55], v[248:255], v2
    ds_read_b128 v[52:55], v21 offset:3072
    v_smfmac_f32_16x16x64_bf16 v[32:35], v[48:51], v[208:215], v2
    s_nop 1
    v_permlane32_swap_b32 v24, v28
    v_permlane32_swap_b32 v25, v29
    v_smfmac_f32_16x16x64_bf16 v[36:39], v[48:51], v[216:223], v2
    ds_read_b128 v[48:51], v21 offset:2048
    v_permlane32_swap_b32 v26, v30
    v_smfmac_f32_16x16x64_bf16 v[32:35], v[44:47], v[176:183], v2
    v_permlane32_swap_b32 v27, v31
    v_add_f32 v24, v24, v28
    v_smfmac_f32_16x16x64_bf16 v[36:39], v[44:47], v[184:191], v2
    ds_read_b128 v[44:47], v21 offset:1024
    v_add_f32 v25, v25, v29
    v_smfmac_f32_16x16x64_bf16 v[32:35], v[40:43], v[144:151], v2
    v_add_f32 v26, v26, v30
    v_add_f32 v27, v27, v31
    v_smfmac_f32_16x16x64_bf16 v[36:39], v[40:43], v[152:159], v2
    ds_read_b128 v[40:43], v21 offset:0
    v_cvt_pk_bf16_f32 v24, v24, v25
    s_waitcnt lgkmcnt(2)
    v_smfmac_f32_16x16x64_bf16 v[32:35], v[52:55], v[112:119], v2
    v_cvt_pk_bf16_f32 v25, v26, v27
    v_smfmac_f32_16x16x64_bf16 v[36:39], v[52:55], v[120:127], v2
    ds_read_b128 v[52:55], v4 offset:3072
    v_smfmac_f32_16x16x64_bf16 v[32:35], v[48:51], a[248:255], v2
    ds_write_b64 v6, v[24:25]
    v_smfmac_f32_16x16x64_bf16 v[36:39], v[48:51], v[96:103], v2
    ds_read_b128 v[48:51], v4 offset:2048
    s_waitcnt lgkmcnt(3)
    v_smfmac_f32_16x16x64_bf16 v[32:35], v[44:47], a[224:231], v2
    v_smfmac_f32_16x16x64_bf16 v[36:39], v[44:47], a[232:239], v2
    v_smfmac_f32_16x16x64_bf16 v[32:35], v[40:43], a[200:207], v2
    s_waitcnt lgkmcnt(1)
    s_barrier
    ds_read_b64_tr_b16 v[80:81], v7 offset:0
    v_smfmac_f32_16x16x64_bf16 v[36:39], v[40:43], a[208:215], v2
    ds_read_b64_tr_b16 v[82:83], v7 offset:64
    ds_read_b64_tr_b16 v[84:85], v7 offset:512
    v_smfmac_f32_16x16x64_bf16 v[32:35], v[52:55], a[176:183], v2
    ds_read_b64_tr_b16 v[86:87], v7 offset:576
    v_smfmac_f32_16x16x64_bf16 v[36:39], v[52:55], a[184:191], v2
    ds_read_b64_tr_b16 v[88:89], v7 offset:1024
    s_waitcnt lgkmcnt(5)
    v_smfmac_f32_16x16x64_bf16 v[32:35], v[48:51], a[152:159], v2
    ds_read_b64_tr_b16 v[90:91], v7 offset:1088
    v_smfmac_f32_16x16x64_bf16 v[36:39], v[48:51], a[160:167], v2
    ds_read_b64_tr_b16 v[92:93], v7 offset:1536
    ds_read_b64_tr_b16 v[94:95], v7 offset:1600
    s_waitcnt lgkmcnt(5)
    v_mfma_f32_16x16x32_bf16 v[24:27], v[56:59], v[80:83], 0
    ds_read_b128 v[56:59], v8 offset:22528
    v_mfma_f32_16x16x32_bf16 v[28:31], v[60:63], v[80:83], 0
    ds_read_b128 v[60:63], v8 offset:23552
    s_waitcnt lgkmcnt(5)
    v_mfma_f32_16x16x32_bf16 v[24:27], v[64:67], v[84:87], v[24:27]
    v_cvt_pk_bf16_f32 v32, v32, v33
    v_cvt_pk_bf16_f32 v33, v34, v35
    v_cvt_pk_bf16_f32 v34, v36, v37
    v_cvt_pk_bf16_f32 v35, v38, v39
    ds_write2_b64 v18, v[32:33], v[34:35] offset1:32
    v_mfma_f32_16x16x32_bf16 v[28:31], v[68:71], v[84:87], v[28:31]
    s_waitcnt lgkmcnt(3)
    v_mfma_f32_16x16x32_bf16 v[24:27], v[72:75], v[88:91], v[24:27]
    s_cmp_eq_u32 s60, 63
    v_mfma_f32_16x16x32_bf16 v[28:31], v[76:79], v[88:91], v[28:31]
    s_waitcnt lgkmcnt(0)
    s_barrier
    v_mfma_f32_16x16x32_bf16 v[24:27], v[56:59], v[92:95], v[24:27]
    ds_read_b64_tr_b16 v[40:41], v14 offset:55296
    ds_read_b64_tr_b16 v[42:43], v14 offset:55816
    v_mfma_f32_16x16x32_bf16 v[28:31], v[60:63], v[92:95], v[28:31]
    buffer_load_dwordx2 v[0:1], v16, s[12:15], s51 offen sc1
    ds_read_b64_tr_b16 v[44:45], v14 offset:56336
    ds_read_b64_tr_b16 v[46:47], v14 offset:56856
    ds_read_b64_tr_b16 v[48:49], v14 offset:57376
    ds_read_b64_tr_b16 v[50:51], v14 offset:57896
    v_mov_b32 v32, 0x3f803f80
    ds_read_b64_tr_b16 v[52:53], v14 offset:58416
    ds_read_b64_tr_b16 v[54:55], v14 offset:58936
    s_cbranch_scc1 L_q_last_45
    v_cndmask_b32 v24, v28, v24, s[56:57]
    v_cndmask_b32 v25, v29, v25, s[56:57]
    v_cndmask_b32 v26, v30, v26, s[56:57]
    v_cndmask_b32 v27, v31, v27, s[56:57]
    v_max3_f32 v11, v24, v25, v26
    v_max_f32 v11, v11, v27
    s_waitcnt lgkmcnt(0)
    v_mfma_f32_16x16x32_bf16 v[36:39], v[40:43], v[80:83], 0
    ds_read_b64_tr_b16 v[64:65], v9 offset:24576
    v_max_f32_dpp v12, v11, v11 row_ror:8 row_mask:0xf bank_mask:0xf
    v_max_f32_dpp v13, v11, v11 row_ror:8 row_mask:0xf bank_mask:0xf
    v_mfma_f32_16x16x32_bf16 v[36:39], v[44:47], v[84:87], v[36:39]
    ds_read_b64_tr_b16 v[66:67], v9 offset:25600
    v_permlane32_swap_b32 v12, v13
    v_max_f32 v22, v12, v13
    v_max_f32 v13, v12, v13
    v_mfma_f32_16x16x32_bf16 v[36:39], v[48:51], v[88:91], v[36:39]
    ds_read_b64_tr_b16 v[68:69], v9 offset:25088
    v_permlane16_swap_b32 v22, v13
    v_mfma_f32_16x16x32_bf16 v[36:39], v[52:55], v[92:95], v[36:39]
    ds_read_b64_tr_b16 v[70:71], v9 offset:26112
    v_max_f32 v11, v22, v13
    v_mul_f32 v10, s52, v11
    v_fma_f32 v24, v24, s52, -v10
    v_fma_f32 v25, v25, s52, -v10
    v_fma_f32 v26, v26, s52, -v10
    v_fma_f32 v27, v27, s52, -v10
    v_exp_f32 v24, v24
    v_exp_f32 v25, v25
    v_exp_f32 v26, v26
    v_exp_f32 v27, v27
    v_permlane32_swap_b32 v36, v38
    v_cvt_pk_bf16_f32 v60, v24, v25
    v_cvt_pk_bf16_f32 v61, v26, v27
    v_permlane32_swap_b32 v37, v39
    v_mov_b32_dpp v62, v60 row_ror:8 row_mask:0xf bank_mask:0xf
    v_mov_b32_dpp v63, v61 row_ror:8 row_mask:0xf bank_mask:0xf
    v_add_f32 v36, v36, v38
    v_add_f32 v37, v37, v39
    s_waitcnt lgkmcnt(0)
    v_mfma_f32_16x16x32_bf16 v[72:75], v[64:67], v[60:63], 0
    buffer_store_dword v15, v20, s[24:27], 0 offen
    v_fma_f32 v12, v36, s52, -v10
    v_fma_f32 v13, v37, s52, -v10
    v_mov_b32 v33, 0x3f803f80
    v_mfma_f32_16x16x32_bf16 v[76:79], v[68:71], v[60:63], 0
    v_mov_b32 v34, 0x3f803f80
    v_mov_b32 v35, 0x3f803f80
    v_max_f32 v11, v12, v13
    v_exp_f32 v36, v12
    v_mfma_f32_16x16x32_bf16 v[24:27], v[32:35], v[60:63], 0
    s_waitcnt vmcnt(1)
    v_max_u32 v22, v0, v1
    v_cmp_lt_f32 s[8:9], s53, v11
    v_cmp_eq_u32 vcc, -1, v22
    v_exp_f32 v37, v13
    v_mov_b32 v57, 0
    v_cvt_pk_bf16_f32 v56, v36, v37
    s_or_b64 s[10:11], vcc, s[8:9]
    s_cbranch_scc1 L_q_vm_46_s
L_q_vm_46_j:
    v_mfma_f32_16x16x16_bf16 v[24:27], v[32:33], v[56:57], v[24:27]
    s_nop 0
    v_mov_b32 v58, 0
    v_mov_b32 v59, v56
    v_mfma_f32_16x16x16_bf16 v[72:75], v[0:1], v[56:57], v[72:75]
    s_nop 2
    v_mfma_f32_16x16x16_bf16 v[76:79], v[0:1], v[58:59], v[76:79]
    v_rcp_f32 v12, v24
    s_nop 2
    v_pk_mul_f32 v[72:73], v[72:73], v[12:13] op_sel_hi:[1,0]
    v_pk_mul_f32 v[74:75], v[74:75], v[12:13] op_sel_hi:[1,0]
    v_cvt_pk_bf16_f32 v72, v72, v73
    v_cvt_pk_bf16_f32 v73, v74, v75
    v_pk_mul_f32 v[76:77], v[76:77], v[12:13] op_sel_hi:[1,0]
    v_pk_mul_f32 v[78:79], v[78:79], v[12:13] op_sel_hi:[1,0]
    v_cvt_pk_bf16_f32 v74, v76, v77
    v_cvt_pk_bf16_f32 v75, v78, v79
    buffer_store_dwordx4 v[72:75], v17, s[24:27], s62 offen
    buffer_store_dwordx4 v[72:75], v17, s[28:31], s62 offen sc1
    buffer_store_dword v15, v20, s[28:31], 0 offen sc1
    v_mov_b32 v60, -1
    v_mov_b32 v61, -1
    v_mov_b32 v62, -1
    v_mov_b32 v63, -1
    s_add_u32 s45, s60, 3
    s_and_b32 s45, s45, 3
    s_lshl_b32 s45, s45, 15
    s_add_u32 s45, s45, s59
    buffer_store_dwordx4 v[60:63], v17, s[24:27], s45 offen
    buffer_store_dwordx4 v[60:63], v17, s[28:31], s45 offen sc1
    s_barrier
    s_and_b32 s45, s51, 0xffff
    s_lshl_b32 s46, s60, 16
    s_add_u32 s45, s45, s46
    s_add_u32 s45, s45, 0x1800000
    buffer_store_dwordx2 v[0:1], v16, s[12:15], s45 offen sc1
L_q_last_45:
    s_waitcnt lgkmcnt(0)
    v_lshlrev_b32 v22, 1, v16
    s_cmp_lg_u32 s44, 0
    s_cbranch_scc1 L_q_km_47_0
    buffer_store_dwordx4 v[40:43], v22, s[12:15], s66 offen offset:0 sc1
L_q_km_47_0:
    s_cmp_lg_u32 s44, 1
    s_cbranch_scc1 L_q_km_47_1
    buffer_store_dwordx4 v[44:47], v22, s[12:15], s66 offen offset:1024 sc1
L_q_km_47_1:
    s_cmp_lg_u32 s44, 2
    s_cbranch_scc1 L_q_km_47_2
    buffer_store_dwordx4 v[48:51], v22, s[12:15], s66 offen offset:2048 sc1
L_q_km_47_2:
    s_cmp_lg_u32 s44, 3
    s_cbranch_scc1 L_q_km_47_3
    buffer_store_dwordx4 v[52:55], v22, s[12:15], s66 offen offset:3072 sc1
L_q_km_47_3:
    s_cmp_eq_u32 s60, 63
    s_cbranch_scc1 L_q_fin_48
    s_cmp_eq_u32 s60, 62
    s_cbranch_scc1 L_q_fin_48_n
    s_add_u32 s47, s60, 1
    s_cmp_lt_u32 s47, s50
    s_cbranch_scc1 L_kv_rdy_49
    s_lshl_b32 s45, s43, 7
    s_add_u32 s45, s45, 0x10014
    v_mov_b32 v0, 0
    s_mov_b32 s70, 0
L_kv_rdy_49_p:
    buffer_load_dwordx2 v[10:11], v0, s[12:15], s45 offen sc1
    s_add_u32 s70, s70, 1
    s_cmp_ge_u32 s70, 0x200000
    s_cbranch_scc1 L_c_done_1
    s_waitcnt vmcnt(0)
    v_min_u32 v10, v10, v11
    s_nop 0
    v_readfirstlane_b32 s50, v10
    s_nop 3
    s_cmp_lt_u32 s47, s50
    s_cbranch_scc1 L_kv_rdy_49
    s_sleep 2
    s_branch L_kv_rdy_49_p
L_kv_rdy_49:
    s_mov_b32 m0, s64
    s_add_u32 s46, s63, 0x1000000
    buffer_load_dwordx4 v3, s[12:15], s63 offen sc1 lds
    buffer_load_dwordx4 v3, s[12:15], s63 offen offset:1024 sc1 lds
    s_mov_b32 m0, s65
    s_add_u32 s63, s63, 8192
    buffer_load_dwordx4 v3, s[12:15], s46 offen sc1 lds
    buffer_load_dwordx4 v3, s[12:15], s46 offen offset:1024 sc1 lds
    s_branch L_q_fin_48_k
L_q_fin_48_n:
    s_waitcnt vmcnt(0)
L_q_fin_48_k:
    s_add_u32 s47, s60, 1
    s_bitcmp1_b64 s[6:7], s47
    s_cselect_b32 s47, s47, s60
    s_cbranch_scc0 L_q_fin_48_m
    s_waitcnt vmcnt(4)
L_q_fin_48_m:
    v_mov_b32 v22, s47
    v_mov_b32 v0, 0
    s_mov_b64 exec, 1
    buffer_store_dword v22, v0, s[12:15], s3 offen sc1
    s_mov_b64 exec, -1
    s_mov_b64 exec, -1
    v_add_u32 v8, s69, v8
    v_add_u32 v9, s69, v9
    s_sub_u32 s64, s64, s69
    s_sub_u32 s65, s65, s69
    s_sub_u32 s69, 0, s69
    s_add_u32 s66, s66, 131072
    s_xor_b32 s51, s51, 65536
    s_add_u32 s60, s60, 1
    s_and_b32 s45, s60, 3
    s_lshl_b32 s46, s45, 14
    s_add_u32 s61, s58, s46
    s_lshl_b32 s46, s45, 15
    s_add_u32 s62, s59, s46
    s_branch L_q_loop_40
L_q_fin_48:
    s_waitcnt vmcnt(0)
    v_mov_b32 v22, 64
    v_mov_b32 v0, 0
    s_mov_b64 exec, 1
    buffer_store_dword v22, v0, s[12:15], s3 offen sc1
    s_mov_b64 exec, -1
    s_endpgm
L_mg_44_r:
    buffer_load_dwordx4 v[40:43], v3, s[12:15], s8 offen sc1
    buffer_load_dwordx4 v[44:47], v3, s[12:15], s9 offen sc1
    buffer_load_dwordx4 v[48:51], v3, s[12:15], s10 offen sc1
    buffer_load_dwordx4 v[52:55], v3, s[12:15], s11 offen sc1
    s_add_u32 s70, s70, 1
    s_cmp_ge_u32 s70, 0x100000
    s_cbranch_scc1 L_c_done_1
    s_nop 1
    v_mov_b32 v24, 0
    v_mov_b32 v25, 0
    v_mov_b32 v26, 0
    v_mov_b32 v27, 0
    v_mov_b32 v28, 0
    v_mov_b32 v29, 0
    v_mov_b32 v30, 0
    v_mov_b32 v31, 0
    v_mov_b32 v32, 0
    v_mov_b32 v33, 0
    v_mov_b32 v34, 0
    v_mov_b32 v35, 0
    v_mov_b32 v36, 0
    v_mov_b32 v37, 0
    v_mov_b32 v38, 0
    v_mov_b32 v39, 0
    s_branch L_mg_44_p
L_q_vm_46_s:
    s_cbranch_vccz L_q_vm_46_t
    buffer_load_dwordx2 v[0:1], v16, s[12:15], s51 offen sc1
    s_add_u32 s70, s70, 1
    s_nop 0
    s_cmp_ge_u32 s70, 0x100000
    s_cbranch_scc1 L_c_done_1
    s_waitcnt vmcnt(0)
    v_max_u32 v22, v0, v1
    v_cmp_eq_u32 vcc, -1, v22
    s_nop 1
    s_branch L_q_vm_46_s
L_q_vm_46_t:
    s_cmp_eq_u64 s[8:9], 0
    s_cbranch_scc1 L_q_vm_46_j
    v_max_f32 v11, 0, v11
    v_mov_b32 v22, v11
    s_nop 1
    v_permlane32_swap_b32 v11, v22
    v_max_f32 v11, v11, v22
    v_mov_b32 v22, v11
    s_nop 1
    v_permlane16_swap_b32 v11, v22
    v_max_f32 v11, v11, v22
    v_sub_f32 v12, v12, v11
    v_sub_f32 v13, v13, v11
    v_sub_f32 v11, 0, v11
    v_exp_f32 v36, v12
    v_exp_f32 v37, v13
    v_exp_f32 v11, v11
    s_nop 7
    v_mul_f32 v72, v72, v11
    v_mul_f32 v73, v73, v11
    v_mul_f32 v74, v74, v11
    v_mul_f32 v75, v75, v11
    v_mul_f32 v76, v76, v11
    v_mul_f32 v77, v77, v11
    v_mul_f32 v78, v78, v11
    v_mul_f32 v79, v79, v11
    v_mul_f32 v24, v24, v11
    v_cvt_pk_bf16_f32 v56, v36, v37
    v_cvt_pk_bf16_f32 v59, v36, v37
    s_nop 1
    s_branch L_q_vm_46_j
L_c_vo_2:
    s_lshl_b32 s45, s43, 11
    s_lshl_b32 s46, s44, 9
    s_add_u32 s45, s45, s46
    v_lshlrev_b32 v10, 3, v1
    v_add_u32 v10, s45, v10
    v_lshlrev_b32 v11, 3, v0
    v_bfe_u32 v69, v1, 4, 1
    v_lshlrev_b32 v69, 2, v69
    v_lshrrev_b32 v63, 5, v1
    v_lshlrev_b32 v63, 1, v63
    v_and_b32 v64, 1, v1
    v_add3_u32 v69, v69, v63, v64
    v_bfe_u32 v63, v1, 1, 1
    v_lshlrev_b32 v63, 3, v63
    v_add_u32 v63, v63, v69
    v_lshlrev_b32 v63, 4, v63
    v_bfe_u32 v64, v1, 2, 2
    v_lshlrev_b32 v64, 2, v64
    s_lshl_b32 s45, s42, 10
    s_lshl_b32 s46, s44, 8
    s_add_u32 s45, s45, s46
    v_add3_u32 v12, v63, v64, s45
    v_and_b32 v64, 1, v1
    v_cmp_eq_u32 vcc, 0, v64
    v_mov_b32 v9, 0x07060302
    v_mov_b32 v63, 0x01000504
    v_cndmask_b32 v9, v9, v63, vcc
    s_lshl_b32 s63, s40, 19
    s_lshl_b32 s45, s42, 15
    s_add_u32 s63, s63, s45
    s_add_u32 s63, s63, 0x7100000
    s_xor_b32 s64, s63, 524288
    s_lshl_b32 s45, s40, 13
    s_lshl_b32 s46, s44, 2
    s_add_u32 s45, s45, s46
    s_lshl_b32 s46, s42, 4
    s_add_u32 s45, s45, s46
    s_add_u32 s45, s45, 0x7084000
    v_lshlrev_b32 v20, 8, v1
    v_add_u32 v20, s45, v20
    v_mov_b32 v63, 0x20000000
    v_cmp_gt_u32 vcc, 16, v1
    s_nop 1
    v_cndmask_b32 v20, v63, v20, vcc
    buffer_store_dword v44, v20, s[12:15], 0 offen sc1
    s_mov_b32 s45, 0x7020000
    buffer_store_dwordx2 v[40:41], v10, s[12:15], s45 offen sc1
    s_mov_b32 s45, 0x7030000
    buffer_store_dwordx2 v[40:41], v10, s[12:15], s45 offen sc1
    s_add_u32 s45, s63, 0
    buffer_store_dwordx2 v[40:41], v11, s[12:15], s45 offen sc1
    s_add_u32 s45, s63, 4096
    buffer_store_dwordx2 v[40:41], v11, s[12:15], s45 offen sc1
    s_add_u32 s45, s63, 8192
    buffer_store_dwordx2 v[40:41], v11, s[12:15], s45 offen sc1
    s_add_u32 s45, s63, 12288
    buffer_store_dwordx2 v[40:41], v11, s[12:15], s45 offen sc1
    s_add_u32 s45, s63, 16384
    buffer_store_dwordx2 v[40:41], v11, s[12:15], s45 offen sc1
    s_add_u32 s45, s63, 20480
    buffer_store_dwordx2 v[40:41], v11, s[12:15], s45 offen sc1
    s_add_u32 s45, s63, 24576
    buffer_store_dwordx2 v[40:41], v11, s[12:15], s45 offen sc1
    s_add_u32 s45, s63, 28672
    buffer_store_dwordx2 v[40:41], v11, s[12:15], s45 offen sc1
    s_lshl_b32 s61, s40, 16
    s_add_u32 s61, s61, 0x7000000
    s_add_u32 s45, s61, 16384
    buffer_store_dword v40, v12, s[12:15], s45 offen sc1
    s_add_u32 s45, s61, 32768
    buffer_store_dword v40, v12, s[12:15], s45 offen sc1
    s_add_u32 s45, s61, 49152
    buffer_store_dword v40, v12, s[12:15], s45 offen sc1
    v_lshlrev_b32 v63, 11, v69
    v_and_b32 v64, 14, v1
    v_lshlrev_b32 v64, 1, v64
    v_add_u32 v63, v63, v64
    s_lshl_b32 s45, s42, 7
    s_lshl_b32 s46, s44, 5
    s_add_u32 s45, s45, s46
    buffer_load_dword v45, v63, s[52:55], s45 offen
    s_mov_b32 s76, -1
    s_mov_b32 s77, -1
    v_lshrrev_b32 v63, 3, v1
    v_lshlrev_b32 v63, 11, v63
    v_bfe_u32 v64, v1, 1, 2
    v_and_b32 v65, 1, v1
    v_lshlrev_b32 v65, 4, v65
    v_add_u32 v63, v63, v65
    v_xor_b32 v66, 0, v64
    v_lshlrev_b32 v66, 5, v66
    v_add_u32 v70, v63, v66
    v_xor_b32 v66, 1, v64
    v_lshlrev_b32 v66, 5, v66
    v_add_u32 v71, v63, v66
    v_xor_b32 v66, 2, v64
    v_lshlrev_b32 v66, 5, v66
    v_add_u32 v72, v63, v66
    v_xor_b32 v66, 3, v64
    v_lshlrev_b32 v66, 5, v66
    v_add_u32 v73, v63, v66
    v_bfe_u32 v63, v1, 3, 1
    v_lshlrev_b32 v63, 1, v63
    v_bfe_u32 v64, v1, 4, 1
    v_add_u32 v63, v63, v64
    v_lshlrev_b32 v64, 3, v63
    v_lshrrev_b32 v65, 5, v1
    v_lshlrev_b32 v65, 2, v65
    v_add_u32 v64, v64, v65
    v_bfe_u32 v65, v1, 2, 1
    v_add_u32 v64, v64, v65
    v_lshlrev_b32 v64, 7, v64
    v_and_b32 v65, 3, v1
    v_lshlrev_b32 v65, 3, v65
    v_add_u32 v64, v64, v65
    s_lshl_b32 s45, s44, 12
    v_add_u32 v64, s45, v64
    s_add_u32 s45, s44, 1
    s_and_b32 s45, s45, 3
    v_xor_b32 v65, s45, v63
    v_lshlrev_b32 v65, 5, v65
    v_add_u32 v74, v64, v65
    s_mul_i32 s45, s44, 20480
    s_add_u32 s45, s45, 65536
    v_add_u32 v88, s45, v74
    s_add_u32 s45, s44, 2
    s_and_b32 s45, s45, 3
    v_xor_b32 v65, s45, v63
    v_lshlrev_b32 v65, 5, v65
    v_add_u32 v75, v64, v65
    s_mul_i32 s45, s44, 20480
    s_add_u32 s45, s45, 65536
    v_add_u32 v89, s45, v75
    s_add_u32 s45, s44, 3
    s_and_b32 s45, s45, 3
    v_xor_b32 v65, s45, v63
    v_lshlrev_b32 v65, 5, v65
    v_add_u32 v76, v64, v65
    s_mul_i32 s45, s44, 20480
    s_add_u32 s45, s45, 65536
    v_add_u32 v90, s45, v76
    s_add_u32 s45, s44, 4
    s_and_b32 s45, s45, 3
    v_xor_b32 v65, s45, v63
    v_lshlrev_b32 v65, 5, v65
    v_add_u32 v77, v64, v65
    s_mul_i32 s45, s44, 20480
    s_add_u32 s45, s45, 65536
    v_add_u32 v91, s45, v77
    s_mul_i32 s65, s44, 24576
    s_lshl_b32 s49, s40, 22
    s_lshl_b32 s45, s44, 20
    s_add_u32 s49, s49, s45
    s_lshl_b32 s45, s42, 7
    s_add_u32 s49, s49, s45
    s_lshl_b32 s50, s44, 12
    s_mul_i32 s69, s42, 1
    s_add_u32 s51, s69, 0
    s_and_b32 s51, s51, 7
    s_lshl_b32 s51, s51, 17
    s_add_u32 s51, s51, s49
    s_add_u32 s46, s51, 0x0
    s_add_u32 m0, s65, 65536
    s_nop 0
    buffer_load_dwordx4 v70, s[36:39], s46 offen  lds
    s_add_u32 s46, s51, 0x8000
    s_add_u32 m0, s65, 66560
    s_nop 0
    buffer_load_dwordx4 v71, s[36:39], s46 offen  lds
    s_add_u32 s46, s51, 0x10000
    s_add_u32 m0, s65, 67584
    s_nop 0
    buffer_load_dwordx4 v72, s[36:39], s46 offen  lds
    s_add_u32 s46, s51, 0x18000
    s_add_u32 m0, s65, 68608
    s_nop 0
    buffer_load_dwordx4 v73, s[36:39], s46 offen  lds
    s_add_u32 s51, s69, 0
    s_and_b32 s51, s51, 7
    s_lshl_b32 s51, s51, 17
    s_add_u32 s51, s51, s49
    s_add_u32 s46, s51, 0x4000
    s_add_u32 m0, s65, 69632
    s_nop 0
    buffer_load_dwordx4 v70, s[36:39], s46 offen  lds
    s_add_u32 s46, s51, 0xc000
    s_add_u32 m0, s65, 70656
    s_nop 0
    buffer_load_dwordx4 v71, s[36:39], s46 offen  lds
    s_add_u32 s46, s51, 0x14000
    s_add_u32 m0, s65, 71680
    s_nop 0
    buffer_load_dwordx4 v72, s[36:39], s46 offen  lds
    s_add_u32 s46, s51, 0x1c000
    s_add_u32 m0, s65, 72704
    s_nop 0
    buffer_load_dwordx4 v73, s[36:39], s46 offen  lds
    s_add_u32 s51, s69, 1
    s_and_b32 s51, s51, 7
    s_lshl_b32 s51, s51, 17
    s_add_u32 s51, s51, s49
    s_add_u32 s46, s51, 0x0
    s_add_u32 m0, s65, 73728
    s_nop 0
    buffer_load_dwordx4 v70, s[36:39], s46 offen  lds
    s_add_u32 s46, s51, 0x8000
    s_add_u32 m0, s65, 74752
    s_nop 0
    buffer_load_dwordx4 v71, s[36:39], s46 offen  lds
    s_add_u32 s46, s51, 0x10000
    s_add_u32 m0, s65, 75776
    s_nop 0
    buffer_load_dwordx4 v72, s[36:39], s46 offen  lds
    s_add_u32 s46, s51, 0x18000
    s_add_u32 m0, s65, 76800
    s_nop 0
    buffer_load_dwordx4 v73, s[36:39], s46 offen  lds
    s_add_u32 s51, s69, 1
    s_and_b32 s51, s51, 7
    s_lshl_b32 s51, s51, 17
    s_add_u32 s51, s51, s49
    s_add_u32 s46, s51, 0x4000
    s_add_u32 m0, s65, 77824
    s_nop 0
    buffer_load_dwordx4 v70, s[36:39], s46 offen  lds
    s_add_u32 s46, s51, 0xc000
    s_add_u32 m0, s65, 78848
    s_nop 0
    buffer_load_dwordx4 v71, s[36:39], s46 offen  lds
    s_add_u32 s46, s51, 0x14000
    s_add_u32 m0, s65, 79872
    s_nop 0
    buffer_load_dwordx4 v72, s[36:39], s46 offen  lds
    s_add_u32 s46, s51, 0x1c000
    s_add_u32 m0, s65, 80896
    s_nop 0
    buffer_load_dwordx4 v73, s[36:39], s46 offen  lds
    s_add_u32 s51, s69, 2
    s_and_b32 s51, s51, 7
    s_lshl_b32 s51, s51, 17
    s_add_u32 s51, s51, s49
    s_add_u32 s46, s51, 0x0
    s_add_u32 m0, s65, 81920
    s_nop 0
    buffer_load_dwordx4 v70, s[36:39], s46 offen  lds
    s_add_u32 s46, s51, 0x8000
    s_add_u32 m0, s65, 82944
    s_nop 0
    buffer_load_dwordx4 v71, s[36:39], s46 offen  lds
    s_add_u32 s46, s51, 0x10000
    s_add_u32 m0, s65, 83968
    s_nop 0
    buffer_load_dwordx4 v72, s[36:39], s46 offen  lds
    s_add_u32 s46, s51, 0x18000
    s_add_u32 m0, s65, 84992
    s_nop 0
    buffer_load_dwordx4 v73, s[36:39], s46 offen  lds
    s_add_u32 s51, s69, 2
    s_and_b32 s51, s51, 7
    s_lshl_b32 s51, s51, 17
    s_add_u32 s51, s51, s49
    s_add_u32 s46, s51, 0x4000
    s_add_u32 m0, s65, 86016
    s_nop 0
    buffer_load_dwordx4 v70, s[36:39], s46 offen  lds
    s_add_u32 s46, s51, 0xc000
    s_add_u32 m0, s65, 87040
    s_nop 0
    buffer_load_dwordx4 v71, s[36:39], s46 offen  lds
    s_add_u32 s46, s51, 0x14000
    s_add_u32 m0, s65, 88064
    s_nop 0
    buffer_load_dwordx4 v72, s[36:39], s46 offen  lds
    s_add_u32 s46, s51, 0x1c000
    s_add_u32 m0, s65, 89088
    s_nop 0
    buffer_load_dwordx4 v73, s[36:39], s46 offen  lds
    s_add_u32 s51, s69, 3
    s_and_b32 s51, s51, 7
    s_lshl_b32 s51, s51, 17
    s_add_u32 s51, s51, s49
    s_add_u32 s46, s51, 0x0
    s_add_u32 m0, s50, 0
    s_nop 0
    buffer_load_dwordx4 v70, s[36:39], s46 offen  lds
    s_add_u32 s46, s51, 0x8000
    s_add_u32 m0, s50, 1024
    s_nop 0
    buffer_load_dwordx4 v71, s[36:39], s46 offen  lds
    s_add_u32 s46, s51, 0x10000
    s_add_u32 m0, s50, 2048
    s_nop 0
    buffer_load_dwordx4 v72, s[36:39], s46 offen  lds
    s_add_u32 s46, s51, 0x18000
    s_add_u32 m0, s50, 3072
    s_nop 0
    buffer_load_dwordx4 v73, s[36:39], s46 offen  lds
    s_add_u32 s51, s69, 3
    s_and_b32 s51, s51, 7
    s_lshl_b32 s51, s51, 17
    s_add_u32 s51, s51, s49
    s_add_u32 s46, s51, 0x4000
    s_add_u32 m0, s50, 16384
    s_nop 0
    buffer_load_dwordx4 v70, s[36:39], s46 offen  lds
    s_add_u32 s46, s51, 0xc000
    s_add_u32 m0, s50, 17408
    s_nop 0
    buffer_load_dwordx4 v71, s[36:39], s46 offen  lds
    s_add_u32 s46, s51, 0x14000
    s_add_u32 m0, s50, 18432
    s_nop 0
    buffer_load_dwordx4 v72, s[36:39], s46 offen  lds
    s_add_u32 s46, s51, 0x1c000
    s_add_u32 m0, s50, 19456
    s_nop 0
    buffer_load_dwordx4 v73, s[36:39], s46 offen  lds
    s_add_u32 s51, s69, 4
    s_and_b32 s51, s51, 7
    s_lshl_b32 s51, s51, 17
    s_add_u32 s51, s51, s49
    s_add_u32 s46, s51, 0x0
    s_add_u32 m0, s50, 32768
    s_nop 0
    buffer_load_dwordx4 v70, s[36:39], s46 offen  lds
    s_add_u32 s46, s51, 0x8000
    s_add_u32 m0, s50, 33792
    s_nop 0
    buffer_load_dwordx4 v71, s[36:39], s46 offen  lds
    s_add_u32 s46, s51, 0x10000
    s_add_u32 m0, s50, 34816
    s_nop 0
    buffer_load_dwordx4 v72, s[36:39], s46 offen  lds
    s_add_u32 s46, s51, 0x18000
    s_add_u32 m0, s50, 35840
    s_nop 0
    buffer_load_dwordx4 v73, s[36:39], s46 offen  lds
    s_add_u32 s51, s69, 4
    s_and_b32 s51, s51, 7
    s_lshl_b32 s51, s51, 17
    s_add_u32 s51, s51, s49
    s_add_u32 s46, s51, 0x4000
    s_add_u32 m0, s50, 49152
    s_nop 0
    buffer_load_dwordx4 v70, s[36:39], s46 offen  lds
    s_add_u32 s46, s51, 0xc000
    s_add_u32 m0, s50, 50176
    s_nop 0
    buffer_load_dwordx4 v71, s[36:39], s46 offen  lds
    s_add_u32 s46, s51, 0x14000
    s_add_u32 m0, s50, 51200
    s_nop 0
    buffer_load_dwordx4 v72, s[36:39], s46 offen  lds
    s_add_u32 s46, s51, 0x1c000
    s_add_u32 m0, s50, 52224
    s_nop 0
    buffer_load_dwordx4 v73, s[36:39], s46 offen  lds
    s_waitcnt vmcnt(40)
    v_min_u32 v45, -2, v45
    buffer_store_dword v45, v12, s[12:15], s61 offen sc1
    s_waitcnt vmcnt(36)
    s_barrier
    ds_read_b64_tr_b16 a[160:161], v88 offset:0
    ds_read_b64_tr_b16 a[162:163], v88 offset:256
    ds_read_b64_tr_b16 a[168:169], v89 offset:0
    ds_read_b64_tr_b16 a[170:171], v89 offset:256
    ds_read_b64_tr_b16 a[176:177], v90 offset:0
    ds_read_b64_tr_b16 a[178:179], v90 offset:256
    ds_read_b64_tr_b16 a[184:185], v91 offset:0
    ds_read_b64_tr_b16 a[186:187], v91 offset:256
L_lw_50:
    s_waitcnt lgkmcnt(0)
    s_cmp_lg_u32 s44, 0
    s_cbranch_scc1 L_v_probe_51
    s_add_u32 s45, s63, 0
    s_memtime s[72:73]
    s_waitcnt lgkmcnt(0)
    s_load_dword s78, s[20:21], s45
    s_waitcnt lgkmcnt(0)
    s_memtime s[74:75]
    s_waitcnt lgkmcnt(0)
    s_sub_u32 s45, s74, s72
    s_min_u32 s76, s76, s45
    s_cmp_lt_u32 s77, s76
    s_cselect_b32 s68, 1, 0
L_v_probe_51:
    s_waitcnt vmcnt(32)
    s_barrier
    s_add_u32 s51, s69, 5
    s_and_b32 s51, s51, 7
    s_lshl_b32 s51, s51, 17
    s_add_u32 s51, s51, s49
    s_add_u32 s46, s51, 0x0
    s_add_u32 m0, s65, 65536
    s_nop 0
    buffer_load_dwordx4 v70, s[36:39], s46 offen  lds
    s_add_u32 s46, s51, 0x8000
    s_add_u32 m0, s65, 66560
    s_nop 0
    buffer_load_dwordx4 v71, s[36:39], s46 offen  lds
    s_add_u32 s46, s51, 0x10000
    s_add_u32 m0, s65, 67584
    s_nop 0
    buffer_load_dwordx4 v72, s[36:39], s46 offen  lds
    s_add_u32 s46, s51, 0x18000
    s_add_u32 m0, s65, 68608
    s_nop 0
    buffer_load_dwordx4 v73, s[36:39], s46 offen  lds
    ds_read_b64_tr_b16 a[164:165], v88 offset:4096
    ds_read_b64_tr_b16 a[166:167], v88 offset:4352
    ds_read_b64_tr_b16 a[172:173], v89 offset:4096
    ds_read_b64_tr_b16 a[174:175], v89 offset:4352
    ds_read_b64_tr_b16 a[180:181], v90 offset:4096
    ds_read_b64_tr_b16 a[182:183], v90 offset:4352
    ds_read_b64_tr_b16 a[188:189], v91 offset:4096
    ds_read_b64_tr_b16 a[190:191], v91 offset:4352
L_lw_52:
    s_waitcnt lgkmcnt(0)
    s_cmp_lg_u32 s44, 0
    s_cbranch_scc1 L_v_probe_53
    s_add_u32 s45, s63, 8192
    s_memtime s[72:73]
    s_waitcnt lgkmcnt(0)
    s_load_dword s78, s[20:21], s45
    s_waitcnt lgkmcnt(0)
    s_memtime s[74:75]
    s_waitcnt lgkmcnt(0)
    s_sub_u32 s45, s74, s72
    s_min_u32 s77, s77, s45
    s_cmp_lt_u32 s77, s76
    s_cselect_b32 s68, 1, 0
L_v_probe_53:
    s_waitcnt vmcnt(32)
    s_barrier
    s_add_u32 s51, s69, 5
    s_and_b32 s51, s51, 7
    s_lshl_b32 s51, s51, 17
    s_add_u32 s51, s51, s49
    s_add_u32 s46, s51, 0x4000
    s_add_u32 m0, s65, 69632
    s_nop 0
    buffer_load_dwordx4 v70, s[36:39], s46 offen  lds
    s_add_u32 s46, s51, 0xc000
    s_add_u32 m0, s65, 70656
    s_nop 0
    buffer_load_dwordx4 v71, s[36:39], s46 offen  lds
    s_add_u32 s46, s51, 0x14000
    s_add_u32 m0, s65, 71680
    s_nop 0
    buffer_load_dwordx4 v72, s[36:39], s46 offen  lds
    s_add_u32 s46, s51, 0x1c000
    s_add_u32 m0, s65, 72704
    s_nop 0
    buffer_load_dwordx4 v73, s[36:39], s46 offen  lds
    ds_read_b64_tr_b16 a[192:193], v88 offset:8192
    ds_read_b64_tr_b16 a[194:195], v88 offset:8448
    ds_read_b64_tr_b16 a[200:201], v89 offset:8192
    ds_read_b64_tr_b16 a[202:203], v89 offset:8448
    ds_read_b64_tr_b16 a[208:209], v90 offset:8192
    ds_read_b64_tr_b16 a[210:211], v90 offset:8448
    ds_read_b64_tr_b16 a[216:217], v91 offset:8192
    ds_read_b64_tr_b16 a[218:219], v91 offset:8448
L_lw_54:
    s_waitcnt lgkmcnt(0)
    s_cmp_lg_u32 s44, 0
    s_cbranch_scc1 L_v_probe_55
    s_add_u32 s45, s63, 128
    s_memtime s[72:73]
    s_waitcnt lgkmcnt(0)
    s_load_dword s78, s[20:21], s45
    s_waitcnt lgkmcnt(0)
    s_memtime s[74:75]
    s_waitcnt lgkmcnt(0)
    s_sub_u32 s45, s74, s72
    s_min_u32 s76, s76, s45
    s_cmp_lt_u32 s77, s76
    s_cselect_b32 s68, 1, 0
L_v_probe_55:
    s_waitcnt vmcnt(32)
    s_barrier
    s_add_u32 s51, s69, 6
    s_and_b32 s51, s51, 7
    s_lshl_b32 s51, s51, 17
    s_add_u32 s51, s51, s49
    s_add_u32 s46, s51, 0x0
    s_add_u32 m0, s65, 73728
    s_nop 0
    buffer_load_dwordx4 v70, s[36:39], s46 offen  lds
    s_add_u32 s46, s51, 0x8000
    s_add_u32 m0, s65, 74752
    s_nop 0
    buffer_load_dwordx4 v71, s[36:39], s46 offen  lds
    s_add_u32 s46, s51, 0x10000
    s_add_u32 m0, s65, 75776
    s_nop 0
    buffer_load_dwordx4 v72, s[36:39], s46 offen  lds
    s_add_u32 s46, s51, 0x18000
    s_add_u32 m0, s65, 76800
    s_nop 0
    buffer_load_dwordx4 v73, s[36:39], s46 offen  lds
    ds_read_b64_tr_b16 a[196:197], v88 offset:12288
    ds_read_b64_tr_b16 a[198:199], v88 offset:12544
    ds_read_b64_tr_b16 a[204:205], v89 offset:12288
    ds_read_b64_tr_b16 a[206:207], v89 offset:12544
    ds_read_b64_tr_b16 a[212:213], v90 offset:12288
    ds_read_b64_tr_b16 a[214:215], v90 offset:12544
    ds_read_b64_tr_b16 a[220:221], v91 offset:12288
    ds_read_b64_tr_b16 a[222:223], v91 offset:12544
L_lw_56:
    s_waitcnt lgkmcnt(0)
    s_cmp_lg_u32 s44, 0
    s_cbranch_scc1 L_v_probe_57
    s_add_u32 s45, s63, 8320
    s_memtime s[72:73]
    s_waitcnt lgkmcnt(0)
    s_load_dword s78, s[20:21], s45
    s_waitcnt lgkmcnt(0)
    s_memtime s[74:75]
    s_waitcnt lgkmcnt(0)
    s_sub_u32 s45, s74, s72
    s_min_u32 s77, s77, s45
    s_cmp_lt_u32 s77, s76
    s_cselect_b32 s68, 1, 0
L_v_probe_57:
    s_waitcnt vmcnt(32)
    s_barrier
    s_add_u32 s51, s69, 6
    s_and_b32 s51, s51, 7
    s_lshl_b32 s51, s51, 17
    s_add_u32 s51, s51, s49
    s_add_u32 s46, s51, 0x4000
    s_add_u32 m0, s65, 77824
    s_nop 0
    buffer_load_dwordx4 v70, s[36:39], s46 offen  lds
    s_add_u32 s46, s51, 0xc000
    s_add_u32 m0, s65, 78848
    s_nop 0
    buffer_load_dwordx4 v71, s[36:39], s46 offen  lds
    s_add_u32 s46, s51, 0x14000
    s_add_u32 m0, s65, 79872
    s_nop 0
    buffer_load_dwordx4 v72, s[36:39], s46 offen  lds
    s_add_u32 s46, s51, 0x1c000
    s_add_u32 m0, s65, 80896
    s_nop 0
    buffer_load_dwordx4 v73, s[36:39], s46 offen  lds
    ds_read_b64_tr_b16 a[224:225], v88 offset:16384
    ds_read_b64_tr_b16 a[226:227], v88 offset:16640
    ds_read_b64_tr_b16 a[232:233], v89 offset:16384
    ds_read_b64_tr_b16 a[234:235], v89 offset:16640
    ds_read_b64_tr_b16 a[240:241], v90 offset:16384
    ds_read_b64_tr_b16 a[242:243], v90 offset:16640
    ds_read_b64_tr_b16 a[248:249], v91 offset:16384
    ds_read_b64_tr_b16 a[250:251], v91 offset:16640
L_lw_58:
    s_waitcnt lgkmcnt(0)
    s_cmp_lg_u32 s44, 0
    s_cbranch_scc1 L_v_probe_59
    s_add_u32 s45, s63, 256
    s_memtime s[72:73]
    s_waitcnt lgkmcnt(0)
    s_load_dword s78, s[20:21], s45
    s_waitcnt lgkmcnt(0)
    s_memtime s[74:75]
    s_waitcnt lgkmcnt(0)
    s_sub_u32 s45, s74, s72
    s_min_u32 s76, s76, s45
    s_cmp_lt_u32 s77, s76
    s_cselect_b32 s68, 1, 0
L_v_probe_59:
    s_waitcnt vmcnt(32)
    s_barrier
    s_add_u32 s51, s69, 7
    s_and_b32 s51, s51, 7
    s_lshl_b32 s51, s51, 17
    s_add_u32 s51, s51, s49
    s_add_u32 s46, s51, 0x0
    s_add_u32 m0, s65, 81920
    s_nop 0
    buffer_load_dwordx4 v70, s[36:39], s46 offen  lds
    s_add_u32 s46, s51, 0x8000
    s_add_u32 m0, s65, 82944
    s_nop 0
    buffer_load_dwordx4 v71, s[36:39], s46 offen  lds
    s_add_u32 s46, s51, 0x10000
    s_add_u32 m0, s65, 83968
    s_nop 0
    buffer_load_dwordx4 v72, s[36:39], s46 offen  lds
    s_add_u32 s46, s51, 0x18000
    s_add_u32 m0, s65, 84992
    s_nop 0
    buffer_load_dwordx4 v73, s[36:39], s46 offen  lds
    ds_read_b64_tr_b16 a[228:229], v88 offset:20480
    ds_read_b64_tr_b16 a[230:231], v88 offset:20736
    ds_read_b64_tr_b16 a[236:237], v89 offset:20480
    ds_read_b64_tr_b16 a[238:239], v89 offset:20736
    ds_read_b64_tr_b16 a[244:245], v90 offset:20480
    ds_read_b64_tr_b16 a[246:247], v90 offset:20736
    ds_read_b64_tr_b16 a[252:253], v91 offset:20480
    ds_read_b64_tr_b16 a[254:255], v91 offset:20736
L_lw_60:
    s_waitcnt lgkmcnt(0)
    s_cmp_lg_u32 s44, 0
    s_cbranch_scc1 L_v_probe_61
    s_add_u32 s45, s63, 8448
    s_memtime s[72:73]
    s_waitcnt lgkmcnt(0)
    s_load_dword s78, s[20:21], s45
    s_waitcnt lgkmcnt(0)
    s_memtime s[74:75]
    s_waitcnt lgkmcnt(0)
    s_sub_u32 s45, s74, s72
    s_min_u32 s77, s77, s45
    s_cmp_lt_u32 s77, s76
    s_cselect_b32 s68, 1, 0
L_v_probe_61:
    s_waitcnt vmcnt(32)
    s_barrier
    s_add_u32 s51, s69, 7
    s_and_b32 s51, s51, 7
    s_lshl_b32 s51, s51, 17
    s_add_u32 s51, s51, s49
    s_add_u32 s46, s51, 0x4000
    s_add_u32 m0, s65, 86016
    s_nop 0
    buffer_load_dwordx4 v70, s[36:39], s46 offen  lds
    s_add_u32 s46, s51, 0xc000
    s_add_u32 m0, s65, 87040
    s_nop 0
    buffer_load_dwordx4 v71, s[36:39], s46 offen  lds
    s_add_u32 s46, s51, 0x14000
    s_add_u32 m0, s65, 88064
    s_nop 0
    buffer_load_dwordx4 v72, s[36:39], s46 offen  lds
    s_add_u32 s46, s51, 0x1c000
    s_add_u32 m0, s65, 89088
    s_nop 0
    buffer_load_dwordx4 v73, s[36:39], s46 offen  lds
    ds_read_b64_tr_b16 v[96:97], v74 offset:0
    ds_read_b64_tr_b16 v[98:99], v74 offset:256
    ds_read_b64_tr_b16 v[104:105], v75 offset:0
    ds_read_b64_tr_b16 v[106:107], v75 offset:256
    ds_read_b64_tr_b16 v[112:113], v76 offset:0
    ds_read_b64_tr_b16 v[114:115], v76 offset:256
    ds_read_b64_tr_b16 v[120:121], v77 offset:0
    ds_read_b64_tr_b16 v[122:123], v77 offset:256
L_lw_62:
    s_waitcnt lgkmcnt(0)
    s_waitcnt vmcnt(32)
    s_barrier
    s_add_u32 s79, s41, 0
    s_and_b32 s79, s79, 3
    s_lshl_b32 s79, s79, 19
    s_add_u32 s79, s79, s47
    s_add_u32 s46, s79, 0x0
    s_add_u32 m0, s48, 0
    s_nop 0
    buffer_load_dwordx4 v82, s[32:35], s46 offen  lds
    s_add_u32 s46, s79, 0x20000
    s_add_u32 m0, s48, 4096
    s_nop 0
    buffer_load_dwordx4 v82, s[32:35], s46 offen  lds
    s_add_u32 s46, s79, 0x40000
    s_add_u32 m0, s48, 8192
    s_nop 0
    buffer_load_dwordx4 v82, s[32:35], s46 offen  lds
    s_add_u32 s46, s79, 0x60000
    s_add_u32 m0, s48, 12288
    s_nop 0
    buffer_load_dwordx4 v82, s[32:35], s46 offen  lds
    ds_read_b64_tr_b16 v[100:101], v74 offset:16384
    ds_read_b64_tr_b16 v[102:103], v74 offset:16640
    ds_read_b64_tr_b16 v[108:109], v75 offset:16384
    ds_read_b64_tr_b16 v[110:111], v75 offset:16640
    ds_read_b64_tr_b16 v[116:117], v76 offset:16384
    ds_read_b64_tr_b16 v[118:119], v76 offset:16640
    ds_read_b64_tr_b16 v[124:125], v77 offset:16384
    ds_read_b64_tr_b16 v[126:127], v77 offset:16640
L_lw_63:
    s_waitcnt lgkmcnt(0)
    s_waitcnt vmcnt(32)
    s_barrier
    s_add_u32 s79, s41, 1
    s_and_b32 s79, s79, 3
    s_lshl_b32 s79, s79, 19
    s_add_u32 s79, s79, s47
    s_add_u32 s46, s79, 0x0
    s_add_u32 m0, s48, 16384
    s_nop 0
    buffer_load_dwordx4 v82, s[32:35], s46 offen  lds
    s_add_u32 s46, s79, 0x20000
    s_add_u32 m0, s48, 20480
    s_nop 0
    buffer_load_dwordx4 v82, s[32:35], s46 offen  lds
    s_add_u32 s46, s79, 0x40000
    s_add_u32 m0, s48, 24576
    s_nop 0
    buffer_load_dwordx4 v82, s[32:35], s46 offen  lds
    s_add_u32 s46, s79, 0x60000
    s_add_u32 m0, s48, 28672
    s_nop 0
    buffer_load_dwordx4 v82, s[32:35], s46 offen  lds
    ds_read_b64_tr_b16 v[128:129], v74 offset:32768
    ds_read_b64_tr_b16 v[130:131], v74 offset:33024
    ds_read_b64_tr_b16 v[136:137], v75 offset:32768
    ds_read_b64_tr_b16 v[138:139], v75 offset:33024
    ds_read_b64_tr_b16 v[144:145], v76 offset:32768
    ds_read_b64_tr_b16 v[146:147], v76 offset:33024
    ds_read_b64_tr_b16 v[152:153], v77 offset:32768
    ds_read_b64_tr_b16 v[154:155], v77 offset:33024
L_lw_64:
    s_waitcnt lgkmcnt(0)
    s_waitcnt vmcnt(32)
    s_barrier
    s_add_u32 s79, s41, 2
    s_and_b32 s79, s79, 3
    s_lshl_b32 s79, s79, 19
    s_add_u32 s79, s79, s47
    s_add_u32 s46, s79, 0x0
    s_add_u32 m0, s48, 32768
    s_nop 0
    buffer_load_dwordx4 v82, s[32:35], s46 offen  lds
    s_add_u32 s46, s79, 0x20000
    s_add_u32 m0, s48, 36864
    s_nop 0
    buffer_load_dwordx4 v82, s[32:35], s46 offen  lds
    s_add_u32 s46, s79, 0x40000
    s_add_u32 m0, s48, 40960
    s_nop 0
    buffer_load_dwordx4 v82, s[32:35], s46 offen  lds
    s_add_u32 s46, s79, 0x60000
    s_add_u32 m0, s48, 45056
    s_nop 0
    buffer_load_dwordx4 v82, s[32:35], s46 offen  lds
    ds_read_b64_tr_b16 v[132:133], v74 offset:49152
    ds_read_b64_tr_b16 v[134:135], v74 offset:49408
    ds_read_b64_tr_b16 v[140:141], v75 offset:49152
    ds_read_b64_tr_b16 v[142:143], v75 offset:49408
    ds_read_b64_tr_b16 v[148:149], v76 offset:49152
    ds_read_b64_tr_b16 v[150:151], v76 offset:49408
    ds_read_b64_tr_b16 v[156:157], v77 offset:49152
    ds_read_b64_tr_b16 v[158:159], v77 offset:49408
L_lw_65:
    s_waitcnt lgkmcnt(0)
    s_waitcnt vmcnt(32)
    s_barrier
    s_add_u32 s79, s41, 3
    s_and_b32 s79, s79, 3
    s_lshl_b32 s79, s79, 19
    s_add_u32 s79, s79, s47
    s_add_u32 s46, s79, 0x0
    s_add_u32 m0, s48, 49152
    s_nop 0
    buffer_load_dwordx4 v82, s[32:35], s46 offen  lds
    s_add_u32 s46, s79, 0x20000
    s_add_u32 m0, s48, 53248
    s_nop 0
    buffer_load_dwordx4 v82, s[32:35], s46 offen  lds
    s_add_u32 s46, s79, 0x40000
    s_add_u32 m0, s48, 57344
    s_nop 0
    buffer_load_dwordx4 v82, s[32:35], s46 offen  lds
    s_add_u32 s46, s79, 0x60000
    s_add_u32 m0, s48, 61440
    s_nop 0
    buffer_load_dwordx4 v82, s[32:35], s46 offen  lds
    ds_read_b64_tr_b16 v[160:161], v88 offset:0
    ds_read_b64_tr_b16 v[162:163], v88 offset:256
    ds_read_b64_tr_b16 v[168:169], v89 offset:0
    ds_read_b64_tr_b16 v[170:171], v89 offset:256
    ds_read_b64_tr_b16 v[176:177], v90 offset:0
    ds_read_b64_tr_b16 v[178:179], v90 offset:256
    ds_read_b64_tr_b16 v[184:185], v91 offset:0
    ds_read_b64_tr_b16 v[186:187], v91 offset:256
L_lw_66:
    s_waitcnt lgkmcnt(0)
    s_waitcnt vmcnt(32)
    s_barrier
    s_cmp_lg_u32 s44, 0
    s_cbranch_scc1 L_hs_67
    s_getreg_b32 s45, hwreg(HW_REG_XCC_ID)
    s_and_b32 s45, s45, 15
    s_mul_i32 s46, s45, s45
    s_lshl_b32 s46, s46, 9
    s_add_u32 s45, s45, s46
    s_cmp_eq_u32 s40, 0
    s_cselect_b32 s46, s45, 0
    s_cselect_b32 s45, 0, s45
    s_lshl_b32 s68, s68, 24
    s_add_u32 s46, s46, s68
    s_add_u32 s45, s45, 16777216
    v_mov_b32 v40, s46
    v_mov_b32 v41, s45
    v_mov_b32 v42, 0
    s_mov_b64 exec, 1
    buffer_atomic_add_x2 v[40:41], v42, s[16:19], 0 offen sc1
    s_mov_b64 exec, -1
L_hs_67:
    ds_read_b64_tr_b16 v[164:165], v88 offset:4096
    ds_read_b64_tr_b16 v[166:167], v88 offset:4352
    ds_read_b64_tr_b16 v[172:173], v89 offset:4096
    ds_read_b64_tr_b16 v[174:175], v89 offset:4352
    ds_read_b64_tr_b16 v[180:181], v90 offset:4096
    ds_read_b64_tr_b16 v[182:183], v90 offset:4352
    ds_read_b64_tr_b16 v[188:189], v91 offset:4096
    ds_read_b64_tr_b16 v[190:191], v91 offset:4352
L_lw_68:
    s_waitcnt lgkmcnt(0)
    s_waitcnt vmcnt(28)
    s_barrier
    ds_read_b64_tr_b16 v[192:193], v88 offset:8192
    ds_read_b64_tr_b16 v[194:195], v88 offset:8448
    ds_read_b64_tr_b16 v[200:201], v89 offset:8192
    ds_read_b64_tr_b16 v[202:203], v89 offset:8448
    ds_read_b64_tr_b16 v[208:209], v90 offset:8192
    ds_read_b64_tr_b16 v[210:211], v90 offset:8448
    ds_read_b64_tr_b16 v[216:217], v91 offset:8192
    ds_read_b64_tr_b16 v[218:219], v91 offset:8448
L_lw_69:
    s_waitcnt lgkmcnt(0)
    s_waitcnt vmcnt(24)
    s_barrier
    ds_read_b64_tr_b16 v[196:197], v88 offset:12288
    ds_read_b64_tr_b16 v[198:199], v88 offset:12544
    ds_read_b64_tr_b16 v[204:205], v89 offset:12288
    ds_read_b64_tr_b16 v[206:207], v89 offset:12544
    ds_read_b64_tr_b16 v[212:213], v90 offset:12288
    ds_read_b64_tr_b16 v[214:215], v90 offset:12544
    ds_read_b64_tr_b16 v[220:221], v91 offset:12288
    ds_read_b64_tr_b16 v[222:223], v91 offset:12544
L_lw_70:
    s_waitcnt lgkmcnt(0)
    s_waitcnt vmcnt(20)
    s_barrier
    ds_read_b64_tr_b16 v[224:225], v88 offset:16384
    ds_read_b64_tr_b16 v[226:227], v88 offset:16640
    ds_read_b64_tr_b16 v[232:233], v89 offset:16384
    ds_read_b64_tr_b16 v[234:235], v89 offset:16640
    ds_read_b64_tr_b16 v[240:241], v90 offset:16384
    ds_read_b64_tr_b16 v[242:243], v90 offset:16640
    ds_read_b64_tr_b16 v[248:249], v91 offset:16384
    ds_read_b64_tr_b16 v[250:251], v91 offset:16640
L_lw_71:
    s_waitcnt lgkmcnt(0)
    s_waitcnt vmcnt(16)
    s_barrier
    ds_read_b64_tr_b16 v[228:229], v88 offset:20480
    ds_read_b64_tr_b16 v[230:231], v88 offset:20736
    ds_read_b64_tr_b16 v[236:237], v89 offset:20480
    ds_read_b64_tr_b16 v[238:239], v89 offset:20736
    ds_read_b64_tr_b16 v[244:245], v90 offset:20480
    ds_read_b64_tr_b16 v[246:247], v90 offset:20736
    ds_read_b64_tr_b16 v[252:253], v91 offset:20480
    ds_read_b64_tr_b16 v[254:255], v91 offset:20736
L_lw_72:
    s_waitcnt lgkmcnt(0)
    s_waitcnt vmcnt(12)
    s_barrier
    s_cmp_lg_u32 s44, 0
    s_cbranch_scc1 L_lw_73_0
    ds_read_b64_tr_b16 a[0:1], v80 offset:0
    ds_read_b64_tr_b16 a[2:3], v80 offset:1024
    ds_read_b64_tr_b16 a[4:5], v80 offset:8192
    ds_read_b64_tr_b16 a[6:7], v80 offset:9216
    ds_read_b64_tr_b16 a[8:9], v81 offset:0
    ds_read_b64_tr_b16 a[10:11], v81 offset:1024
    ds_read_b64_tr_b16 a[12:13], v81 offset:8192
    ds_read_b64_tr_b16 a[14:15], v81 offset:9216
    s_branch L_lw_73
L_lw_73_0:
    s_cmp_lg_u32 s44, 1
    s_cbranch_scc1 L_lw_73_1
    ds_read_b64_tr_b16 a[120:121], v80 offset:0
    ds_read_b64_tr_b16 a[122:123], v80 offset:1024
    ds_read_b64_tr_b16 a[124:125], v80 offset:8192
    ds_read_b64_tr_b16 a[126:127], v80 offset:9216
    ds_read_b64_tr_b16 v[56:57], v81 offset:0
    ds_read_b64_tr_b16 v[58:59], v81 offset:1024
    ds_read_b64_tr_b16 v[60:61], v81 offset:8192
    ds_read_b64_tr_b16 v[62:63], v81 offset:9216
    s_waitcnt lgkmcnt(0)
    ds_write_b128 v5, v[56:59] offset:0
    ds_write_b128 v5, v[60:63] offset:1024
    s_branch L_lw_73
L_lw_73_1:
    s_cmp_lg_u32 s44, 2
    s_cbranch_scc1 L_lw_73_2
    ds_read_b64_tr_b16 a[80:81], v80 offset:0
    ds_read_b64_tr_b16 a[82:83], v80 offset:1024
    ds_read_b64_tr_b16 a[84:85], v80 offset:8192
    ds_read_b64_tr_b16 a[86:87], v80 offset:9216
    ds_read_b64_tr_b16 v[56:57], v81 offset:0
    ds_read_b64_tr_b16 v[58:59], v81 offset:1024
    ds_read_b64_tr_b16 v[60:61], v81 offset:8192
    ds_read_b64_tr_b16 v[62:63], v81 offset:9216
    s_waitcnt lgkmcnt(0)
    ds_write_b128 v5, v[56:59] offset:2048
    ds_write_b128 v5, v[60:63] offset:3072
    s_branch L_lw_73
L_lw_73_2:
    ds_read_b64_tr_b16 a[48:49], v80 offset:0
    ds_read_b64_tr_b16 a[50:51], v80 offset:1024
    ds_read_b64_tr_b16 a[52:53], v80 offset:8192
    ds_read_b64_tr_b16 a[54:55], v80 offset:9216
    ds_read_b64_tr_b16 v[56:57], v81 offset:0
    ds_read_b64_tr_b16 v[58:59], v81 offset:1024
    ds_read_b64_tr_b16 v[60:61], v81 offset:8192
    ds_read_b64_tr_b16 v[62:63], v81 offset:9216
    s_waitcnt lgkmcnt(0)
    ds_write_b128 v5, v[56:59] offset:4096
    ds_write_b128 v5, v[60:63] offset:5120
L_lw_73:
    s_waitcnt lgkmcnt(0)
    s_waitcnt vmcnt(8)
    s_barrier
    s_add_u32 s79, s41, 4
    s_and_b32 s79, s79, 3
    s_lshl_b32 s79, s79, 19
    s_add_u32 s79, s79, s47
    s_add_u32 s46, s79, 0x200000
    s_add_u32 m0, s48, 0
    s_nop 0
    buffer_load_dwordx4 v82, s[32:35], s46 offen  lds
    s_add_u32 s46, s79, 0x220000
    s_add_u32 m0, s48, 4096
    s_nop 0
    buffer_load_dwordx4 v82, s[32:35], s46 offen  lds
    s_add_u32 s46, s79, 0x240000
    s_add_u32 m0, s48, 8192
    s_nop 0
    buffer_load_dwordx4 v82, s[32:35], s46 offen  lds
    s_add_u32 s46, s79, 0x260000
    s_add_u32 m0, s48, 12288
    s_nop 0
    buffer_load_dwordx4 v82, s[32:35], s46 offen  lds
    s_cmp_lg_u32 s44, 0
    s_cbranch_scc1 L_lw_74_0
    ds_read_b64_tr_b16 a[16:17], v80 offset:16384
    ds_read_b64_tr_b16 a[18:19], v80 offset:17408
    ds_read_b64_tr_b16 a[20:21], v80 offset:24576
    ds_read_b64_tr_b16 a[22:23], v80 offset:25600
    ds_read_b64_tr_b16 a[24:25], v81 offset:16384
    ds_read_b64_tr_b16 a[26:27], v81 offset:17408
    ds_read_b64_tr_b16 a[28:29], v81 offset:24576
    ds_read_b64_tr_b16 a[30:31], v81 offset:25600
    s_branch L_lw_74
L_lw_74_0:
    s_cmp_lg_u32 s44, 1
    s_cbranch_scc1 L_lw_74_1
    ds_read_b64_tr_b16 a[128:129], v80 offset:16384
    ds_read_b64_tr_b16 a[130:131], v80 offset:17408
    ds_read_b64_tr_b16 a[132:133], v80 offset:24576
    ds_read_b64_tr_b16 a[134:135], v80 offset:25600
    ds_read_b64_tr_b16 a[136:137], v81 offset:16384
    ds_read_b64_tr_b16 a[138:139], v81 offset:17408
    ds_read_b64_tr_b16 a[140:141], v81 offset:24576
    ds_read_b64_tr_b16 a[142:143], v81 offset:25600
    s_branch L_lw_74
L_lw_74_1:
    s_cmp_lg_u32 s44, 2
    s_cbranch_scc1 L_lw_74_2
    ds_read_b64_tr_b16 a[88:89], v80 offset:16384
    ds_read_b64_tr_b16 a[90:91], v80 offset:17408
    ds_read_b64_tr_b16 a[92:93], v80 offset:24576
    ds_read_b64_tr_b16 a[94:95], v80 offset:25600
    ds_read_b64_tr_b16 a[96:97], v81 offset:16384
    ds_read_b64_tr_b16 a[98:99], v81 offset:17408
    ds_read_b64_tr_b16 a[100:101], v81 offset:24576
    ds_read_b64_tr_b16 a[102:103], v81 offset:25600
    s_branch L_lw_74
L_lw_74_2:
    ds_read_b64_tr_b16 a[56:57], v80 offset:16384
    ds_read_b64_tr_b16 a[58:59], v80 offset:17408
    ds_read_b64_tr_b16 a[60:61], v80 offset:24576
    ds_read_b64_tr_b16 a[62:63], v80 offset:25600
    ds_read_b64_tr_b16 v[56:57], v81 offset:16384
    ds_read_b64_tr_b16 v[58:59], v81 offset:17408
    ds_read_b64_tr_b16 v[60:61], v81 offset:24576
    ds_read_b64_tr_b16 v[62:63], v81 offset:25600
    s_waitcnt lgkmcnt(0)
    ds_write_b128 v5, v[56:59] offset:6144
    ds_write_b128 v5, v[60:63] offset:7168
L_lw_74:
    s_waitcnt lgkmcnt(0)
    s_waitcnt vmcnt(8)
    s_barrier
    s_add_u32 s79, s41, 5
    s_and_b32 s79, s79, 3
    s_lshl_b32 s79, s79, 19
    s_add_u32 s79, s79, s47
    s_add_u32 s46, s79, 0x200000
    s_add_u32 m0, s48, 16384
    s_nop 0
    buffer_load_dwordx4 v82, s[32:35], s46 offen  lds
    s_add_u32 s46, s79, 0x220000
    s_add_u32 m0, s48, 20480
    s_nop 0
    buffer_load_dwordx4 v82, s[32:35], s46 offen  lds
    s_add_u32 s46, s79, 0x240000
    s_add_u32 m0, s48, 24576
    s_nop 0
    buffer_load_dwordx4 v82, s[32:35], s46 offen  lds
    s_add_u32 s46, s79, 0x260000
    s_add_u32 m0, s48, 28672
    s_nop 0
    buffer_load_dwordx4 v82, s[32:35], s46 offen  lds
    s_cmp_lg_u32 s44, 0
    s_cbranch_scc1 L_lw_75_0
    ds_read_b64_tr_b16 a[32:33], v80 offset:32768
    ds_read_b64_tr_b16 a[34:35], v80 offset:33792
    ds_read_b64_tr_b16 a[36:37], v80 offset:40960
    ds_read_b64_tr_b16 a[38:39], v80 offset:41984
    ds_read_b64_tr_b16 v[56:57], v81 offset:32768
    ds_read_b64_tr_b16 v[58:59], v81 offset:33792
    ds_read_b64_tr_b16 v[60:61], v81 offset:40960
    ds_read_b64_tr_b16 v[62:63], v81 offset:41984
    s_waitcnt lgkmcnt(0)
    ds_write_b128 v5, v[56:59] offset:8192
    ds_write_b128 v5, v[60:63] offset:9216
    s_branch L_lw_75
L_lw_75_0:
    s_cmp_lg_u32 s44, 1
    s_cbranch_scc1 L_lw_75_1
    ds_read_b64_tr_b16 a[144:145], v80 offset:32768
    ds_read_b64_tr_b16 a[146:147], v80 offset:33792
    ds_read_b64_tr_b16 a[148:149], v80 offset:40960
    ds_read_b64_tr_b16 a[150:151], v80 offset:41984
    ds_read_b64_tr_b16 v[56:57], v81 offset:32768
    ds_read_b64_tr_b16 v[58:59], v81 offset:33792
    ds_read_b64_tr_b16 v[60:61], v81 offset:40960
    ds_read_b64_tr_b16 v[62:63], v81 offset:41984
    s_waitcnt lgkmcnt(0)
    ds_write_b128 v5, v[56:59] offset:10240
    ds_write_b128 v5, v[60:63] offset:11264
    s_branch L_lw_75
L_lw_75_1:
    s_cmp_lg_u32 s44, 2
    s_cbranch_scc1 L_lw_75_2
    ds_read_b64_tr_b16 a[104:105], v80 offset:32768
    ds_read_b64_tr_b16 a[106:107], v80 offset:33792
    ds_read_b64_tr_b16 a[108:109], v80 offset:40960
    ds_read_b64_tr_b16 a[110:111], v80 offset:41984
    ds_read_b64_tr_b16 v[56:57], v81 offset:32768
    ds_read_b64_tr_b16 v[58:59], v81 offset:33792
    ds_read_b64_tr_b16 v[60:61], v81 offset:40960
    ds_read_b64_tr_b16 v[62:63], v81 offset:41984
    s_waitcnt lgkmcnt(0)
    ds_write_b128 v5, v[56:59] offset:12288
    ds_write_b128 v5, v[60:63] offset:13312
    s_branch L_lw_75
L_lw_75_2:
    ds_read_b64_tr_b16 a[64:65], v80 offset:32768
    ds_read_b64_tr_b16 a[66:67], v80 offset:33792
    ds_read_b64_tr_b16 a[68:69], v80 offset:40960
    ds_read_b64_tr_b16 a[70:71], v80 offset:41984
    ds_read_b64_tr_b16 v[56:57], v81 offset:32768
    ds_read_b64_tr_b16 v[58:59], v81 offset:33792
    ds_read_b64_tr_b16 v[60:61], v81 offset:40960
    ds_read_b64_tr_b16 v[62:63], v81 offset:41984
    s_waitcnt lgkmcnt(0)
    ds_write_b128 v5, v[56:59] offset:14336
    ds_write_b128 v5, v[60:63] offset:15360
L_lw_75:
    s_waitcnt lgkmcnt(0)
    s_waitcnt vmcnt(8)
    s_barrier
    s_add_u32 s79, s41, 6
    s_and_b32 s79, s79, 3
    s_lshl_b32 s79, s79, 19
    s_add_u32 s79, s79, s47
    s_add_u32 s46, s79, 0x200000
    s_add_u32 m0, s48, 32768
    s_nop 0
    buffer_load_dwordx4 v82, s[32:35], s46 offen  lds
    s_add_u32 s46, s79, 0x220000
    s_add_u32 m0, s48, 36864
    s_nop 0
    buffer_load_dwordx4 v82, s[32:35], s46 offen  lds
    s_add_u32 s46, s79, 0x240000
    s_add_u32 m0, s48, 40960
    s_nop 0
    buffer_load_dwordx4 v82, s[32:35], s46 offen  lds
    s_add_u32 s46, s79, 0x260000
    s_add_u32 m0, s48, 45056
    s_nop 0
    buffer_load_dwordx4 v82, s[32:35], s46 offen  lds
    s_cmp_lg_u32 s44, 0
    s_cbranch_scc1 L_lw_76_0
    ds_read_b64_tr_b16 a[40:41], v80 offset:49152
    ds_read_b64_tr_b16 a[42:43], v80 offset:50176
    ds_read_b64_tr_b16 a[44:45], v80 offset:57344
    ds_read_b64_tr_b16 a[46:47], v80 offset:58368
    ds_read_b64_tr_b16 v[56:57], v81 offset:49152
    ds_read_b64_tr_b16 v[58:59], v81 offset:50176
    ds_read_b64_tr_b16 v[60:61], v81 offset:57344
    ds_read_b64_tr_b16 v[62:63], v81 offset:58368
    s_waitcnt lgkmcnt(0)
    ds_write_b128 v5, v[56:59] offset:16384
    ds_write_b128 v5, v[60:63] offset:17408
    s_branch L_lw_76
L_lw_76_0:
    s_cmp_lg_u32 s44, 1
    s_cbranch_scc1 L_lw_76_1
    ds_read_b64_tr_b16 a[152:153], v80 offset:49152
    ds_read_b64_tr_b16 a[154:155], v80 offset:50176
    ds_read_b64_tr_b16 a[156:157], v80 offset:57344
    ds_read_b64_tr_b16 a[158:159], v80 offset:58368
    ds_read_b64_tr_b16 v[56:57], v81 offset:49152
    ds_read_b64_tr_b16 v[58:59], v81 offset:50176
    ds_read_b64_tr_b16 v[60:61], v81 offset:57344
    ds_read_b64_tr_b16 v[62:63], v81 offset:58368
    s_waitcnt lgkmcnt(0)
    ds_write_b128 v5, v[56:59] offset:18432
    ds_write_b128 v5, v[60:63] offset:19456
    s_branch L_lw_76
L_lw_76_1:
    s_cmp_lg_u32 s44, 2
    s_cbranch_scc1 L_lw_76_2
    ds_read_b64_tr_b16 a[112:113], v80 offset:49152
    ds_read_b64_tr_b16 a[114:115], v80 offset:50176
    ds_read_b64_tr_b16 a[116:117], v80 offset:57344
    ds_read_b64_tr_b16 a[118:119], v80 offset:58368
    ds_read_b64_tr_b16 v[56:57], v81 offset:49152
    ds_read_b64_tr_b16 v[58:59], v81 offset:50176
    ds_read_b64_tr_b16 v[60:61], v81 offset:57344
    ds_read_b64_tr_b16 v[62:63], v81 offset:58368
    s_waitcnt lgkmcnt(0)
    ds_write_b128 v5, v[56:59] offset:20480
    ds_write_b128 v5, v[60:63] offset:21504
    s_branch L_lw_76
L_lw_76_2:
    ds_read_b64_tr_b16 a[72:73], v80 offset:49152
    ds_read_b64_tr_b16 a[74:75], v80 offset:50176
    ds_read_b64_tr_b16 a[76:77], v80 offset:57344
    ds_read_b64_tr_b16 a[78:79], v80 offset:58368
    ds_read_b64_tr_b16 v[56:57], v81 offset:49152
    ds_read_b64_tr_b16 v[58:59], v81 offset:50176
    ds_read_b64_tr_b16 v[60:61], v81 offset:57344
    ds_read_b64_tr_b16 v[62:63], v81 offset:58368
    s_waitcnt lgkmcnt(0)
    ds_write_b128 v5, v[56:59] offset:22528
    ds_write_b128 v5, v[60:63] offset:23552
L_lw_76:
    s_waitcnt lgkmcnt(0)
    s_waitcnt vmcnt(8)
    s_barrier
    s_add_u32 s79, s41, 7
    s_and_b32 s79, s79, 3
    s_lshl_b32 s79, s79, 19
    s_add_u32 s79, s79, s47
    s_add_u32 s46, s79, 0x200000
    s_add_u32 m0, s48, 49152
    s_nop 0
    buffer_load_dwordx4 v82, s[32:35], s46 offen  lds
    s_add_u32 s46, s79, 0x220000
    s_add_u32 m0, s48, 53248
    s_nop 0
    buffer_load_dwordx4 v82, s[32:35], s46 offen  lds
    s_add_u32 s46, s79, 0x240000
    s_add_u32 m0, s48, 57344
    s_nop 0
    buffer_load_dwordx4 v82, s[32:35], s46 offen  lds
    s_add_u32 s46, s79, 0x260000
    s_add_u32 m0, s48, 61440
    s_nop 0
    buffer_load_dwordx4 v82, s[32:35], s46 offen  lds
    s_cmp_lg_u32 s44, 0
    s_cbranch_scc1 L_lw_77_0
    ds_read_b64_tr_b16 a[48:49], v80 offset:0
    ds_read_b64_tr_b16 a[50:51], v80 offset:1024
    ds_read_b64_tr_b16 a[52:53], v80 offset:8192
    ds_read_b64_tr_b16 a[54:55], v80 offset:9216
    ds_read_b64_tr_b16 v[56:57], v81 offset:0
    ds_read_b64_tr_b16 v[58:59], v81 offset:1024
    ds_read_b64_tr_b16 v[60:61], v81 offset:8192
    ds_read_b64_tr_b16 v[62:63], v81 offset:9216
    s_waitcnt lgkmcnt(0)
    ds_write_b128 v5, v[56:59] offset:4096
    ds_write_b128 v5, v[60:63] offset:5120
    s_branch L_lw_77
L_lw_77_0:
    s_cmp_lg_u32 s44, 1
    s_cbranch_scc1 L_lw_77_1
    ds_read_b64_tr_b16 a[0:1], v80 offset:0
    ds_read_b64_tr_b16 a[2:3], v80 offset:1024
    ds_read_b64_tr_b16 a[4:5], v80 offset:8192
    ds_read_b64_tr_b16 a[6:7], v80 offset:9216
    ds_read_b64_tr_b16 a[8:9], v81 offset:0
    ds_read_b64_tr_b16 a[10:11], v81 offset:1024
    ds_read_b64_tr_b16 a[12:13], v81 offset:8192
    ds_read_b64_tr_b16 a[14:15], v81 offset:9216
    s_branch L_lw_77
L_lw_77_1:
    s_cmp_lg_u32 s44, 2
    s_cbranch_scc1 L_lw_77_2
    ds_read_b64_tr_b16 a[120:121], v80 offset:0
    ds_read_b64_tr_b16 a[122:123], v80 offset:1024
    ds_read_b64_tr_b16 a[124:125], v80 offset:8192
    ds_read_b64_tr_b16 a[126:127], v80 offset:9216
    ds_read_b64_tr_b16 v[56:57], v81 offset:0
    ds_read_b64_tr_b16 v[58:59], v81 offset:1024
    ds_read_b64_tr_b16 v[60:61], v81 offset:8192
    ds_read_b64_tr_b16 v[62:63], v81 offset:9216
    s_waitcnt lgkmcnt(0)
    ds_write_b128 v5, v[56:59] offset:0
    ds_write_b128 v5, v[60:63] offset:1024
    s_branch L_lw_77
L_lw_77_2:
    ds_read_b64_tr_b16 a[80:81], v80 offset:0
    ds_read_b64_tr_b16 a[82:83], v80 offset:1024
    ds_read_b64_tr_b16 a[84:85], v80 offset:8192
    ds_read_b64_tr_b16 a[86:87], v80 offset:9216
    ds_read_b64_tr_b16 v[56:57], v81 offset:0
    ds_read_b64_tr_b16 v[58:59], v81 offset:1024
    ds_read_b64_tr_b16 v[60:61], v81 offset:8192
    ds_read_b64_tr_b16 v[62:63], v81 offset:9216
    s_waitcnt lgkmcnt(0)
    ds_write_b128 v5, v[56:59] offset:2048
    ds_write_b128 v5, v[60:63] offset:3072
L_lw_77:
    s_waitcnt lgkmcnt(0)
    s_waitcnt vmcnt(8)
    s_barrier
    s_add_u32 s79, s41, 8
    s_and_b32 s79, s79, 3
    s_lshl_b32 s79, s79, 19
    s_add_u32 s79, s79, s47
    s_add_u32 s46, s79, 0x400000
    s_add_u32 m0, s48, 0
    s_nop 0
    buffer_load_dwordx4 v82, s[32:35], s46 offen  lds
    s_add_u32 s46, s79, 0x420000
    s_add_u32 m0, s48, 4096
    s_nop 0
    buffer_load_dwordx4 v82, s[32:35], s46 offen  lds
    s_add_u32 s46, s79, 0x440000
    s_add_u32 m0, s48, 8192
    s_nop 0
    buffer_load_dwordx4 v82, s[32:35], s46 offen  lds
    s_add_u32 s46, s79, 0x460000
    s_add_u32 m0, s48, 12288
    s_nop 0
    buffer_load_dwordx4 v82, s[32:35], s46 offen  lds
    s_cmp_lg_u32 s44, 0
    s_cbranch_scc1 L_lw_78_0
    ds_read_b64_tr_b16 a[56:57], v80 offset:16384
    ds_read_b64_tr_b16 a[58:59], v80 offset:17408
    ds_read_b64_tr_b16 a[60:61], v80 offset:24576
    ds_read_b64_tr_b16 a[62:63], v80 offset:25600
    ds_read_b64_tr_b16 v[56:57], v81 offset:16384
    ds_read_b64_tr_b16 v[58:59], v81 offset:17408
    ds_read_b64_tr_b16 v[60:61], v81 offset:24576
    ds_read_b64_tr_b16 v[62:63], v81 offset:25600
    s_waitcnt lgkmcnt(0)
    ds_write_b128 v5, v[56:59] offset:6144
    ds_write_b128 v5, v[60:63] offset:7168
    s_branch L_lw_78
L_lw_78_0:
    s_cmp_lg_u32 s44, 1
    s_cbranch_scc1 L_lw_78_1
    ds_read_b64_tr_b16 a[16:17], v80 offset:16384
    ds_read_b64_tr_b16 a[18:19], v80 offset:17408
    ds_read_b64_tr_b16 a[20:21], v80 offset:24576
    ds_read_b64_tr_b16 a[22:23], v80 offset:25600
    ds_read_b64_tr_b16 a[24:25], v81 offset:16384
    ds_read_b64_tr_b16 a[26:27], v81 offset:17408
    ds_read_b64_tr_b16 a[28:29], v81 offset:24576
    ds_read_b64_tr_b16 a[30:31], v81 offset:25600
    s_branch L_lw_78
L_lw_78_1:
    s_cmp_lg_u32 s44, 2
    s_cbranch_scc1 L_lw_78_2
    ds_read_b64_tr_b16 a[128:129], v80 offset:16384
    ds_read_b64_tr_b16 a[130:131], v80 offset:17408
    ds_read_b64_tr_b16 a[132:133], v80 offset:24576
    ds_read_b64_tr_b16 a[134:135], v80 offset:25600
    ds_read_b64_tr_b16 a[136:137], v81 offset:16384
    ds_read_b64_tr_b16 a[138:139], v81 offset:17408
    ds_read_b64_tr_b16 a[140:141], v81 offset:24576
    ds_read_b64_tr_b16 a[142:143], v81 offset:25600
    s_branch L_lw_78
L_lw_78_2:
    ds_read_b64_tr_b16 a[88:89], v80 offset:16384
    ds_read_b64_tr_b16 a[90:91], v80 offset:17408
    ds_read_b64_tr_b16 a[92:93], v80 offset:24576
    ds_read_b64_tr_b16 a[94:95], v80 offset:25600
    ds_read_b64_tr_b16 a[96:97], v81 offset:16384
    ds_read_b64_tr_b16 a[98:99], v81 offset:17408
    ds_read_b64_tr_b16 a[100:101], v81 offset:24576
    ds_read_b64_tr_b16 a[102:103], v81 offset:25600
L_lw_78:
    s_waitcnt lgkmcnt(0)
    s_waitcnt vmcnt(8)
    s_barrier
    s_add_u32 s79, s41, 9
    s_and_b32 s79, s79, 3
    s_lshl_b32 s79, s79, 19
    s_add_u32 s79, s79, s47
    s_add_u32 s46, s79, 0x400000
    s_add_u32 m0, s48, 16384
    s_nop 0
    buffer_load_dwordx4 v82, s[32:35], s46 offen  lds
    s_add_u32 s46, s79, 0x420000
    s_add_u32 m0, s48, 20480
    s_nop 0
    buffer_load_dwordx4 v82, s[32:35], s46 offen  lds
    s_add_u32 s46, s79, 0x440000
    s_add_u32 m0, s48, 24576
    s_nop 0
    buffer_load_dwordx4 v82, s[32:35], s46 offen  lds
    s_add_u32 s46, s79, 0x460000
    s_add_u32 m0, s48, 28672
    s_nop 0
    buffer_load_dwordx4 v82, s[32:35], s46 offen  lds
    s_cmp_lg_u32 s44, 0
    s_cbranch_scc1 L_lw_79_0
    ds_read_b64_tr_b16 a[64:65], v80 offset:32768
    ds_read_b64_tr_b16 a[66:67], v80 offset:33792
    ds_read_b64_tr_b16 a[68:69], v80 offset:40960
    ds_read_b64_tr_b16 a[70:71], v80 offset:41984
    ds_read_b64_tr_b16 v[56:57], v81 offset:32768
    ds_read_b64_tr_b16 v[58:59], v81 offset:33792
    ds_read_b64_tr_b16 v[60:61], v81 offset:40960
    ds_read_b64_tr_b16 v[62:63], v81 offset:41984
    s_waitcnt lgkmcnt(0)
    ds_write_b128 v5, v[56:59] offset:14336
    ds_write_b128 v5, v[60:63] offset:15360
    s_branch L_lw_79
L_lw_79_0:
    s_cmp_lg_u32 s44, 1
    s_cbranch_scc1 L_lw_79_1
    ds_read_b64_tr_b16 a[32:33], v80 offset:32768
    ds_read_b64_tr_b16 a[34:35], v80 offset:33792
    ds_read_b64_tr_b16 a[36:37], v80 offset:40960
    ds_read_b64_tr_b16 a[38:39], v80 offset:41984
    ds_read_b64_tr_b16 v[56:57], v81 offset:32768
    ds_read_b64_tr_b16 v[58:59], v81 offset:33792
    ds_read_b64_tr_b16 v[60:61], v81 offset:40960
    ds_read_b64_tr_b16 v[62:63], v81 offset:41984
    s_waitcnt lgkmcnt(0)
    ds_write_b128 v5, v[56:59] offset:8192
    ds_write_b128 v5, v[60:63] offset:9216
    s_branch L_lw_79
L_lw_79_1:
    s_cmp_lg_u32 s44, 2
    s_cbranch_scc1 L_lw_79_2
    ds_read_b64_tr_b16 a[144:145], v80 offset:32768
    ds_read_b64_tr_b16 a[146:147], v80 offset:33792
    ds_read_b64_tr_b16 a[148:149], v80 offset:40960
    ds_read_b64_tr_b16 a[150:151], v80 offset:41984
    ds_read_b64_tr_b16 v[56:57], v81 offset:32768
    ds_read_b64_tr_b16 v[58:59], v81 offset:33792
    ds_read_b64_tr_b16 v[60:61], v81 offset:40960
    ds_read_b64_tr_b16 v[62:63], v81 offset:41984
    s_waitcnt lgkmcnt(0)
    ds_write_b128 v5, v[56:59] offset:10240
    ds_write_b128 v5, v[60:63] offset:11264
    s_branch L_lw_79
L_lw_79_2:
    ds_read_b64_tr_b16 a[104:105], v80 offset:32768
    ds_read_b64_tr_b16 a[106:107], v80 offset:33792
    ds_read_b64_tr_b16 a[108:109], v80 offset:40960
    ds_read_b64_tr_b16 a[110:111], v80 offset:41984
    ds_read_b64_tr_b16 v[56:57], v81 offset:32768
    ds_read_b64_tr_b16 v[58:59], v81 offset:33792
    ds_read_b64_tr_b16 v[60:61], v81 offset:40960
    ds_read_b64_tr_b16 v[62:63], v81 offset:41984
    s_waitcnt lgkmcnt(0)
    ds_write_b128 v5, v[56:59] offset:12288
    ds_write_b128 v5, v[60:63] offset:13312
L_lw_79:
    s_waitcnt lgkmcnt(0)
    s_waitcnt vmcnt(8)
    s_barrier
    s_add_u32 s79, s41, 10
    s_and_b32 s79, s79, 3
    s_lshl_b32 s79, s79, 19
    s_add_u32 s79, s79, s47
    s_add_u32 s46, s79, 0x400000
    s_add_u32 m0, s48, 32768
    s_nop 0
    buffer_load_dwordx4 v82, s[32:35], s46 offen  lds
    s_add_u32 s46, s79, 0x420000
    s_add_u32 m0, s48, 36864
    s_nop 0
    buffer_load_dwordx4 v82, s[32:35], s46 offen  lds
    s_add_u32 s46, s79, 0x440000
    s_add_u32 m0, s48, 40960
    s_nop 0
    buffer_load_dwordx4 v82, s[32:35], s46 offen  lds
    s_add_u32 s46, s79, 0x460000
    s_add_u32 m0, s48, 45056
    s_nop 0
    buffer_load_dwordx4 v82, s[32:35], s46 offen  lds
    s_cmp_lg_u32 s44, 0
    s_cbranch_scc1 L_lw_80_0
    ds_read_b64_tr_b16 a[72:73], v80 offset:49152
    ds_read_b64_tr_b16 a[74:75], v80 offset:50176
    ds_read_b64_tr_b16 a[76:77], v80 offset:57344
    ds_read_b64_tr_b16 a[78:79], v80 offset:58368
    ds_read_b64_tr_b16 v[56:57], v81 offset:49152
    ds_read_b64_tr_b16 v[58:59], v81 offset:50176
    ds_read_b64_tr_b16 v[60:61], v81 offset:57344
    ds_read_b64_tr_b16 v[62:63], v81 offset:58368
    s_waitcnt lgkmcnt(0)
    ds_write_b128 v5, v[56:59] offset:22528
    ds_write_b128 v5, v[60:63] offset:23552
    s_branch L_lw_80
L_lw_80_0:
    s_cmp_lg_u32 s44, 1
    s_cbranch_scc1 L_lw_80_1
    ds_read_b64_tr_b16 a[40:41], v80 offset:49152
    ds_read_b64_tr_b16 a[42:43], v80 offset:50176
    ds_read_b64_tr_b16 a[44:45], v80 offset:57344
    ds_read_b64_tr_b16 a[46:47], v80 offset:58368
    ds_read_b64_tr_b16 v[56:57], v81 offset:49152
    ds_read_b64_tr_b16 v[58:59], v81 offset:50176
    ds_read_b64_tr_b16 v[60:61], v81 offset:57344
    ds_read_b64_tr_b16 v[62:63], v81 offset:58368
    s_waitcnt lgkmcnt(0)
    ds_write_b128 v5, v[56:59] offset:16384
    ds_write_b128 v5, v[60:63] offset:17408
    s_branch L_lw_80
L_lw_80_1:
    s_cmp_lg_u32 s44, 2
    s_cbranch_scc1 L_lw_80_2
    ds_read_b64_tr_b16 a[152:153], v80 offset:49152
    ds_read_b64_tr_b16 a[154:155], v80 offset:50176
    ds_read_b64_tr_b16 a[156:157], v80 offset:57344
    ds_read_b64_tr_b16 a[158:159], v80 offset:58368
    ds_read_b64_tr_b16 v[56:57], v81 offset:49152
    ds_read_b64_tr_b16 v[58:59], v81 offset:50176
    ds_read_b64_tr_b16 v[60:61], v81 offset:57344
    ds_read_b64_tr_b16 v[62:63], v81 offset:58368
    s_waitcnt lgkmcnt(0)
    ds_write_b128 v5, v[56:59] offset:18432
    ds_write_b128 v5, v[60:63] offset:19456
    s_branch L_lw_80
L_lw_80_2:
    ds_read_b64_tr_b16 a[112:113], v80 offset:49152
    ds_read_b64_tr_b16 a[114:115], v80 offset:50176
    ds_read_b64_tr_b16 a[116:117], v80 offset:57344
    ds_read_b64_tr_b16 a[118:119], v80 offset:58368
    ds_read_b64_tr_b16 v[56:57], v81 offset:49152
    ds_read_b64_tr_b16 v[58:59], v81 offset:50176
    ds_read_b64_tr_b16 v[60:61], v81 offset:57344
    ds_read_b64_tr_b16 v[62:63], v81 offset:58368
    s_waitcnt lgkmcnt(0)
    ds_write_b128 v5, v[56:59] offset:20480
    ds_write_b128 v5, v[60:63] offset:21504
L_lw_80:
    s_waitcnt lgkmcnt(0)
    s_waitcnt vmcnt(8)
    s_barrier
    s_add_u32 s79, s41, 11
    s_and_b32 s79, s79, 3
    s_lshl_b32 s79, s79, 19
    s_add_u32 s79, s79, s47
    s_add_u32 s46, s79, 0x400000
    s_add_u32 m0, s48, 49152
    s_nop 0
    buffer_load_dwordx4 v82, s[32:35], s46 offen  lds
    s_add_u32 s46, s79, 0x420000
    s_add_u32 m0, s48, 53248
    s_nop 0
    buffer_load_dwordx4 v82, s[32:35], s46 offen  lds
    s_add_u32 s46, s79, 0x440000
    s_add_u32 m0, s48, 57344
    s_nop 0
    buffer_load_dwordx4 v82, s[32:35], s46 offen  lds
    s_add_u32 s46, s79, 0x460000
    s_add_u32 m0, s48, 61440
    s_nop 0
    buffer_load_dwordx4 v82, s[32:35], s46 offen  lds
    s_cmp_lg_u32 s44, 0
    s_cbranch_scc1 L_lw_81_0
    ds_read_b64_tr_b16 a[80:81], v80 offset:0
    ds_read_b64_tr_b16 a[82:83], v80 offset:1024
    ds_read_b64_tr_b16 a[84:85], v80 offset:8192
    ds_read_b64_tr_b16 a[86:87], v80 offset:9216
    ds_read_b64_tr_b16 v[56:57], v81 offset:0
    ds_read_b64_tr_b16 v[58:59], v81 offset:1024
    ds_read_b64_tr_b16 v[60:61], v81 offset:8192
    ds_read_b64_tr_b16 v[62:63], v81 offset:9216
    s_waitcnt lgkmcnt(0)
    ds_write_b128 v5, v[56:59] offset:2048
    ds_write_b128 v5, v[60:63] offset:3072
    s_branch L_lw_81
L_lw_81_0:
    s_cmp_lg_u32 s44, 1
    s_cbranch_scc1 L_lw_81_1
    ds_read_b64_tr_b16 a[48:49], v80 offset:0
    ds_read_b64_tr_b16 a[50:51], v80 offset:1024
    ds_read_b64_tr_b16 a[52:53], v80 offset:8192
    ds_read_b64_tr_b16 a[54:55], v80 offset:9216
    ds_read_b64_tr_b16 v[56:57], v81 offset:0
    ds_read_b64_tr_b16 v[58:59], v81 offset:1024
    ds_read_b64_tr_b16 v[60:61], v81 offset:8192
    ds_read_b64_tr_b16 v[62:63], v81 offset:9216
    s_waitcnt lgkmcnt(0)
    ds_write_b128 v5, v[56:59] offset:4096
    ds_write_b128 v5, v[60:63] offset:5120
    s_branch L_lw_81
L_lw_81_1:
    s_cmp_lg_u32 s44, 2
    s_cbranch_scc1 L_lw_81_2
    ds_read_b64_tr_b16 a[0:1], v80 offset:0
    ds_read_b64_tr_b16 a[2:3], v80 offset:1024
    ds_read_b64_tr_b16 a[4:5], v80 offset:8192
    ds_read_b64_tr_b16 a[6:7], v80 offset:9216
    ds_read_b64_tr_b16 a[8:9], v81 offset:0
    ds_read_b64_tr_b16 a[10:11], v81 offset:1024
    ds_read_b64_tr_b16 a[12:13], v81 offset:8192
    ds_read_b64_tr_b16 a[14:15], v81 offset:9216
    s_branch L_lw_81
L_lw_81_2:
    ds_read_b64_tr_b16 a[120:121], v80 offset:0
    ds_read_b64_tr_b16 a[122:123], v80 offset:1024
    ds_read_b64_tr_b16 a[124:125], v80 offset:8192
    ds_read_b64_tr_b16 a[126:127], v80 offset:9216
    ds_read_b64_tr_b16 v[56:57], v81 offset:0
    ds_read_b64_tr_b16 v[58:59], v81 offset:1024
    ds_read_b64_tr_b16 v[60:61], v81 offset:8192
    ds_read_b64_tr_b16 v[62:63], v81 offset:9216
    s_waitcnt lgkmcnt(0)
    ds_write_b128 v5, v[56:59] offset:0
    ds_write_b128 v5, v[60:63] offset:1024
L_lw_81:
    s_waitcnt lgkmcnt(0)
    s_waitcnt vmcnt(8)
    s_barrier
    s_add_u32 s79, s41, 12
    s_and_b32 s79, s79, 3
    s_lshl_b32 s79, s79, 19
    s_add_u32 s79, s79, s47
    s_add_u32 s46, s79, 0x600000
    s_add_u32 m0, s48, 0
    s_nop 0
    buffer_load_dwordx4 v82, s[32:35], s46 offen  lds
    s_add_u32 s46, s79, 0x620000
    s_add_u32 m0, s48, 4096
    s_nop 0
    buffer_load_dwordx4 v82, s[32:35], s46 offen  lds
    s_add_u32 s46, s79, 0x640000
    s_add_u32 m0, s48, 8192
    s_nop 0
    buffer_load_dwordx4 v82, s[32:35], s46 offen  lds
    s_add_u32 s46, s79, 0x660000
    s_add_u32 m0, s48, 12288
    s_nop 0
    buffer_load_dwordx4 v82, s[32:35], s46 offen  lds
    s_cmp_lg_u32 s44, 0
    s_cbranch_scc1 L_lw_82_0
    ds_read_b64_tr_b16 a[88:89], v80 offset:16384
    ds_read_b64_tr_b16 a[90:91], v80 offset:17408
    ds_read_b64_tr_b16 a[92:93], v80 offset:24576
    ds_read_b64_tr_b16 a[94:95], v80 offset:25600
    ds_read_b64_tr_b16 a[96:97], v81 offset:16384
    ds_read_b64_tr_b16 a[98:99], v81 offset:17408
    ds_read_b64_tr_b16 a[100:101], v81 offset:24576
    ds_read_b64_tr_b16 a[102:103], v81 offset:25600
    s_branch L_lw_82
L_lw_82_0:
    s_cmp_lg_u32 s44, 1
    s_cbranch_scc1 L_lw_82_1
    ds_read_b64_tr_b16 a[56:57], v80 offset:16384
    ds_read_b64_tr_b16 a[58:59], v80 offset:17408
    ds_read_b64_tr_b16 a[60:61], v80 offset:24576
    ds_read_b64_tr_b16 a[62:63], v80 offset:25600
    ds_read_b64_tr_b16 v[56:57], v81 offset:16384
    ds_read_b64_tr_b16 v[58:59], v81 offset:17408
    ds_read_b64_tr_b16 v[60:61], v81 offset:24576
    ds_read_b64_tr_b16 v[62:63], v81 offset:25600
    s_waitcnt lgkmcnt(0)
    ds_write_b128 v5, v[56:59] offset:6144
    ds_write_b128 v5, v[60:63] offset:7168
    s_branch L_lw_82
L_lw_82_1:
    s_cmp_lg_u32 s44, 2
    s_cbranch_scc1 L_lw_82_2
    ds_read_b64_tr_b16 a[16:17], v80 offset:16384
    ds_read_b64_tr_b16 a[18:19], v80 offset:17408
    ds_read_b64_tr_b16 a[20:21], v80 offset:24576
    ds_read_b64_tr_b16 a[22:23], v80 offset:25600
    ds_read_b64_tr_b16 a[24:25], v81 offset:16384
    ds_read_b64_tr_b16 a[26:27], v81 offset:17408
    ds_read_b64_tr_b16 a[28:29], v81 offset:24576
    ds_read_b64_tr_b16 a[30:31], v81 offset:25600
    s_branch L_lw_82
L_lw_82_2:
    ds_read_b64_tr_b16 a[128:129], v80 offset:16384
    ds_read_b64_tr_b16 a[130:131], v80 offset:17408
    ds_read_b64_tr_b16 a[132:133], v80 offset:24576
    ds_read_b64_tr_b16 a[134:135], v80 offset:25600
    ds_read_b64_tr_b16 a[136:137], v81 offset:16384
    ds_read_b64_tr_b16 a[138:139], v81 offset:17408
    ds_read_b64_tr_b16 a[140:141], v81 offset:24576
    ds_read_b64_tr_b16 a[142:143], v81 offset:25600
L_lw_82:
    s_waitcnt lgkmcnt(0)
    s_waitcnt vmcnt(8)
    s_barrier
    s_add_u32 s79, s41, 13
    s_and_b32 s79, s79, 3
    s_lshl_b32 s79, s79, 19
    s_add_u32 s79, s79, s47
    s_add_u32 s46, s79, 0x600000
    s_add_u32 m0, s48, 16384
    s_nop 0
    buffer_load_dwordx4 v82, s[32:35], s46 offen  lds
    s_add_u32 s46, s79, 0x620000
    s_add_u32 m0, s48, 20480
    s_nop 0
    buffer_load_dwordx4 v82, s[32:35], s46 offen  lds
    s_add_u32 s46, s79, 0x640000
    s_add_u32 m0, s48, 24576
    s_nop 0
    buffer_load_dwordx4 v82, s[32:35], s46 offen  lds
    s_add_u32 s46, s79, 0x660000
    s_add_u32 m0, s48, 28672
    s_nop 0
    buffer_load_dwordx4 v82, s[32:35], s46 offen  lds
    s_cmp_lg_u32 s44, 0
    s_cbranch_scc1 L_lw_83_0
    ds_read_b64_tr_b16 a[104:105], v80 offset:32768
    ds_read_b64_tr_b16 a[106:107], v80 offset:33792
    ds_read_b64_tr_b16 a[108:109], v80 offset:40960
    ds_read_b64_tr_b16 a[110:111], v80 offset:41984
    ds_read_b64_tr_b16 v[56:57], v81 offset:32768
    ds_read_b64_tr_b16 v[58:59], v81 offset:33792
    ds_read_b64_tr_b16 v[60:61], v81 offset:40960
    ds_read_b64_tr_b16 v[62:63], v81 offset:41984
    s_waitcnt lgkmcnt(0)
    ds_write_b128 v5, v[56:59] offset:12288
    ds_write_b128 v5, v[60:63] offset:13312
    s_branch L_lw_83
L_lw_83_0:
    s_cmp_lg_u32 s44, 1
    s_cbranch_scc1 L_lw_83_1
    ds_read_b64_tr_b16 a[64:65], v80 offset:32768
    ds_read_b64_tr_b16 a[66:67], v80 offset:33792
    ds_read_b64_tr_b16 a[68:69], v80 offset:40960
    ds_read_b64_tr_b16 a[70:71], v80 offset:41984
    ds_read_b64_tr_b16 v[56:57], v81 offset:32768
    ds_read_b64_tr_b16 v[58:59], v81 offset:33792
    ds_read_b64_tr_b16 v[60:61], v81 offset:40960
    ds_read_b64_tr_b16 v[62:63], v81 offset:41984
    s_waitcnt lgkmcnt(0)
    ds_write_b128 v5, v[56:59] offset:14336
    ds_write_b128 v5, v[60:63] offset:15360
    s_branch L_lw_83
L_lw_83_1:
    s_cmp_lg_u32 s44, 2
    s_cbranch_scc1 L_lw_83_2
    ds_read_b64_tr_b16 a[32:33], v80 offset:32768
    ds_read_b64_tr_b16 a[34:35], v80 offset:33792
    ds_read_b64_tr_b16 a[36:37], v80 offset:40960
    ds_read_b64_tr_b16 a[38:39], v80 offset:41984
    ds_read_b64_tr_b16 v[56:57], v81 offset:32768
    ds_read_b64_tr_b16 v[58:59], v81 offset:33792
    ds_read_b64_tr_b16 v[60:61], v81 offset:40960
    ds_read_b64_tr_b16 v[62:63], v81 offset:41984
    s_waitcnt lgkmcnt(0)
    ds_write_b128 v5, v[56:59] offset:8192
    ds_write_b128 v5, v[60:63] offset:9216
    s_branch L_lw_83
L_lw_83_2:
    ds_read_b64_tr_b16 a[144:145], v80 offset:32768
    ds_read_b64_tr_b16 a[146:147], v80 offset:33792
    ds_read_b64_tr_b16 a[148:149], v80 offset:40960
    ds_read_b64_tr_b16 a[150:151], v80 offset:41984
    ds_read_b64_tr_b16 v[56:57], v81 offset:32768
    ds_read_b64_tr_b16 v[58:59], v81 offset:33792
    ds_read_b64_tr_b16 v[60:61], v81 offset:40960
    ds_read_b64_tr_b16 v[62:63], v81 offset:41984
    s_waitcnt lgkmcnt(0)
    ds_write_b128 v5, v[56:59] offset:10240
    ds_write_b128 v5, v[60:63] offset:11264
L_lw_83:
    s_waitcnt lgkmcnt(0)
    s_waitcnt vmcnt(8)
    s_barrier
    s_add_u32 s79, s41, 14
    s_and_b32 s79, s79, 3
    s_lshl_b32 s79, s79, 19
    s_add_u32 s79, s79, s47
    s_add_u32 s46, s79, 0x600000
    s_add_u32 m0, s48, 32768
    s_nop 0
    buffer_load_dwordx4 v82, s[32:35], s46 offen  lds
    s_add_u32 s46, s79, 0x620000
    s_add_u32 m0, s48, 36864
    s_nop 0
    buffer_load_dwordx4 v82, s[32:35], s46 offen  lds
    s_add_u32 s46, s79, 0x640000
    s_add_u32 m0, s48, 40960
    s_nop 0
    buffer_load_dwordx4 v82, s[32:35], s46 offen  lds
    s_add_u32 s46, s79, 0x660000
    s_add_u32 m0, s48, 45056
    s_nop 0
    buffer_load_dwordx4 v82, s[32:35], s46 offen  lds
    s_cmp_lg_u32 s44, 0
    s_cbranch_scc1 L_lw_84_0
    ds_read_b64_tr_b16 a[112:113], v80 offset:49152
    ds_read_b64_tr_b16 a[114:115], v80 offset:50176
    ds_read_b64_tr_b16 a[116:117], v80 offset:57344
    ds_read_b64_tr_b16 a[118:119], v80 offset:58368
    ds_read_b64_tr_b16 v[56:57], v81 offset:49152
    ds_read_b64_tr_b16 v[58:59], v81 offset:50176
    ds_read_b64_tr_b16 v[60:61], v81 offset:57344
    ds_read_b64_tr_b16 v[62:63], v81 offset:58368
    s_waitcnt lgkmcnt(0)
    ds_write_b128 v5, v[56:59] offset:20480
    ds_write_b128 v5, v[60:63] offset:21504
    s_branch L_lw_84
L_lw_84_0:
    s_cmp_lg_u32 s44, 1
    s_cbranch_scc1 L_lw_84_1
    ds_read_b64_tr_b16 a[72:73], v80 offset:49152
    ds_read_b64_tr_b16 a[74:75], v80 offset:50176
    ds_read_b64_tr_b16 a[76:77], v80 offset:57344
    ds_read_b64_tr_b16 a[78:79], v80 offset:58368
    ds_read_b64_tr_b16 v[56:57], v81 offset:49152
    ds_read_b64_tr_b16 v[58:59], v81 offset:50176
    ds_read_b64_tr_b16 v[60:61], v81 offset:57344
    ds_read_b64_tr_b16 v[62:63], v81 offset:58368
    s_waitcnt lgkmcnt(0)
    ds_write_b128 v5, v[56:59] offset:22528
    ds_write_b128 v5, v[60:63] offset:23552
    s_branch L_lw_84
L_lw_84_1:
    s_cmp_lg_u32 s44, 2
    s_cbranch_scc1 L_lw_84_2
    ds_read_b64_tr_b16 a[40:41], v80 offset:49152
    ds_read_b64_tr_b16 a[42:43], v80 offset:50176
    ds_read_b64_tr_b16 a[44:45], v80 offset:57344
    ds_read_b64_tr_b16 a[46:47], v80 offset:58368
    ds_read_b64_tr_b16 v[56:57], v81 offset:49152
    ds_read_b64_tr_b16 v[58:59], v81 offset:50176
    ds_read_b64_tr_b16 v[60:61], v81 offset:57344
    ds_read_b64_tr_b16 v[62:63], v81 offset:58368
    s_waitcnt lgkmcnt(0)
    ds_write_b128 v5, v[56:59] offset:16384
    ds_write_b128 v5, v[60:63] offset:17408
    s_branch L_lw_84
L_lw_84_2:
    ds_read_b64_tr_b16 a[152:153], v80 offset:49152
    ds_read_b64_tr_b16 a[154:155], v80 offset:50176
    ds_read_b64_tr_b16 a[156:157], v80 offset:57344
    ds_read_b64_tr_b16 a[158:159], v80 offset:58368
    ds_read_b64_tr_b16 v[56:57], v81 offset:49152
    ds_read_b64_tr_b16 v[58:59], v81 offset:50176
    ds_read_b64_tr_b16 v[60:61], v81 offset:57344
    ds_read_b64_tr_b16 v[62:63], v81 offset:58368
    s_waitcnt lgkmcnt(0)
    ds_write_b128 v5, v[56:59] offset:18432
    ds_write_b128 v5, v[60:63] offset:19456
L_lw_84:
    s_waitcnt lgkmcnt(0)
    s_waitcnt vmcnt(8)
    s_barrier
    s_add_u32 s79, s41, 15
    s_and_b32 s79, s79, 3
    s_lshl_b32 s79, s79, 19
    s_add_u32 s79, s79, s47
    s_add_u32 s46, s79, 0x600000
    s_add_u32 m0, s48, 49152
    s_nop 0
    buffer_load_dwordx4 v82, s[32:35], s46 offen  lds
    s_add_u32 s46, s79, 0x620000
    s_add_u32 m0, s48, 53248
    s_nop 0
    buffer_load_dwordx4 v82, s[32:35], s46 offen  lds
    s_add_u32 s46, s79, 0x640000
    s_add_u32 m0, s48, 57344
    s_nop 0
    buffer_load_dwordx4 v82, s[32:35], s46 offen  lds
    s_add_u32 s46, s79, 0x660000
    s_add_u32 m0, s48, 61440
    s_nop 0
    buffer_load_dwordx4 v82, s[32:35], s46 offen  lds
    v_mov_b32 v46, 0
    buffer_load_dwordx2 v[44:45], v46, s[16:19], 0 offen sc1
    s_cmp_lg_u32 s44, 0
    s_cbranch_scc1 L_lw_85_0
    ds_read_b64_tr_b16 a[120:121], v80 offset:0
    ds_read_b64_tr_b16 a[122:123], v80 offset:1024
    ds_read_b64_tr_b16 a[124:125], v80 offset:8192
    ds_read_b64_tr_b16 a[126:127], v80 offset:9216
    ds_read_b64_tr_b16 v[56:57], v81 offset:0
    ds_read_b64_tr_b16 v[58:59], v81 offset:1024
    ds_read_b64_tr_b16 v[60:61], v81 offset:8192
    ds_read_b64_tr_b16 v[62:63], v81 offset:9216
    s_waitcnt lgkmcnt(0)
    ds_write_b128 v5, v[56:59] offset:0
    ds_write_b128 v5, v[60:63] offset:1024
    s_branch L_lw_85
L_lw_85_0:
    s_cmp_lg_u32 s44, 1
    s_cbranch_scc1 L_lw_85_1
    ds_read_b64_tr_b16 a[80:81], v80 offset:0
    ds_read_b64_tr_b16 a[82:83], v80 offset:1024
    ds_read_b64_tr_b16 a[84:85], v80 offset:8192
    ds_read_b64_tr_b16 a[86:87], v80 offset:9216
    ds_read_b64_tr_b16 v[56:57], v81 offset:0
    ds_read_b64_tr_b16 v[58:59], v81 offset:1024
    ds_read_b64_tr_b16 v[60:61], v81 offset:8192
    ds_read_b64_tr_b16 v[62:63], v81 offset:9216
    s_waitcnt lgkmcnt(0)
    ds_write_b128 v5, v[56:59] offset:2048
    ds_write_b128 v5, v[60:63] offset:3072
    s_branch L_lw_85
L_lw_85_1:
    s_cmp_lg_u32 s44, 2
    s_cbranch_scc1 L_lw_85_2
    ds_read_b64_tr_b16 a[48:49], v80 offset:0
    ds_read_b64_tr_b16 a[50:51], v80 offset:1024
    ds_read_b64_tr_b16 a[52:53], v80 offset:8192
    ds_read_b64_tr_b16 a[54:55], v80 offset:9216
    ds_read_b64_tr_b16 v[56:57], v81 offset:0
    ds_read_b64_tr_b16 v[58:59], v81 offset:1024
    ds_read_b64_tr_b16 v[60:61], v81 offset:8192
    ds_read_b64_tr_b16 v[62:63], v81 offset:9216
    s_waitcnt lgkmcnt(0)
    ds_write_b128 v5, v[56:59] offset:4096
    ds_write_b128 v5, v[60:63] offset:5120
    s_branch L_lw_85
L_lw_85_2:
    ds_read_b64_tr_b16 a[0:1], v80 offset:0
    ds_read_b64_tr_b16 a[2:3], v80 offset:1024
    ds_read_b64_tr_b16 a[4:5], v80 offset:8192
    ds_read_b64_tr_b16 a[6:7], v80 offset:9216
    ds_read_b64_tr_b16 a[8:9], v81 offset:0
    ds_read_b64_tr_b16 a[10:11], v81 offset:1024
    ds_read_b64_tr_b16 a[12:13], v81 offset:8192
    ds_read_b64_tr_b16 a[14:15], v81 offset:9216
L_lw_85:
    s_waitcnt lgkmcnt(0)
    s_waitcnt vmcnt(8)
    s_barrier
    s_cmp_lg_u32 s44, 0
    s_cbranch_scc1 L_lw_86_0
    ds_read_b64_tr_b16 a[128:129], v80 offset:16384
    ds_read_b64_tr_b16 a[130:131], v80 offset:17408
    ds_read_b64_tr_b16 a[132:133], v80 offset:24576
    ds_read_b64_tr_b16 a[134:135], v80 offset:25600
    ds_read_b64_tr_b16 a[136:137], v81 offset:16384
    ds_read_b64_tr_b16 a[138:139], v81 offset:17408
    ds_read_b64_tr_b16 a[140:141], v81 offset:24576
    ds_read_b64_tr_b16 a[142:143], v81 offset:25600
    s_branch L_lw_86
L_lw_86_0:
    s_cmp_lg_u32 s44, 1
    s_cbranch_scc1 L_lw_86_1
    ds_read_b64_tr_b16 a[88:89], v80 offset:16384
    ds_read_b64_tr_b16 a[90:91], v80 offset:17408
    ds_read_b64_tr_b16 a[92:93], v80 offset:24576
    ds_read_b64_tr_b16 a[94:95], v80 offset:25600
    ds_read_b64_tr_b16 a[96:97], v81 offset:16384
    ds_read_b64_tr_b16 a[98:99], v81 offset:17408
    ds_read_b64_tr_b16 a[100:101], v81 offset:24576
    ds_read_b64_tr_b16 a[102:103], v81 offset:25600
    s_branch L_lw_86
L_lw_86_1:
    s_cmp_lg_u32 s44, 2
    s_cbranch_scc1 L_lw_86_2
    ds_read_b64_tr_b16 a[56:57], v80 offset:16384
    ds_read_b64_tr_b16 a[58:59], v80 offset:17408
    ds_read_b64_tr_b16 a[60:61], v80 offset:24576
    ds_read_b64_tr_b16 a[62:63], v80 offset:25600
    ds_read_b64_tr_b16 v[56:57], v81 offset:16384
    ds_read_b64_tr_b16 v[58:59], v81 offset:17408
    ds_read_b64_tr_b16 v[60:61], v81 offset:24576
    ds_read_b64_tr_b16 v[62:63], v81 offset:25600
    s_waitcnt lgkmcnt(0)
    ds_write_b128 v5, v[56:59] offset:6144
    ds_write_b128 v5, v[60:63] offset:7168
    s_branch L_lw_86
L_lw_86_2:
    ds_read_b64_tr_b16 a[16:17], v80 offset:16384
    ds_read_b64_tr_b16 a[18:19], v80 offset:17408
    ds_read_b64_tr_b16 a[20:21], v80 offset:24576
    ds_read_b64_tr_b16 a[22:23], v80 offset:25600
    ds_read_b64_tr_b16 a[24:25], v81 offset:16384
    ds_read_b64_tr_b16 a[26:27], v81 offset:17408
    ds_read_b64_tr_b16 a[28:29], v81 offset:24576
    ds_read_b64_tr_b16 a[30:31], v81 offset:25600
L_lw_86:
    s_waitcnt lgkmcnt(0)
    s_waitcnt vmcnt(4)
    s_barrier
    s_cmp_lg_u32 s44, 0
    s_cbranch_scc1 L_lw_87_0
    ds_read_b64_tr_b16 a[144:145], v80 offset:32768
    ds_read_b64_tr_b16 a[146:147], v80 offset:33792
    ds_read_b64_tr_b16 a[148:149], v80 offset:40960
    ds_read_b64_tr_b16 a[150:151], v80 offset:41984
    ds_read_b64_tr_b16 v[56:57], v81 offset:32768
    ds_read_b64_tr_b16 v[58:59], v81 offset:33792
    ds_read_b64_tr_b16 v[60:61], v81 offset:40960
    ds_read_b64_tr_b16 v[62:63], v81 offset:41984
    s_waitcnt lgkmcnt(0)
    ds_write_b128 v5, v[56:59] offset:10240
    ds_write_b128 v5, v[60:63] offset:11264
    s_branch L_lw_87
L_lw_87_0:
    s_cmp_lg_u32 s44, 1
    s_cbranch_scc1 L_lw_87_1
    ds_read_b64_tr_b16 a[104:105], v80 offset:32768
    ds_read_b64_tr_b16 a[106:107], v80 offset:33792
    ds_read_b64_tr_b16 a[108:109], v80 offset:40960
    ds_read_b64_tr_b16 a[110:111], v80 offset:41984
    ds_read_b64_tr_b16 v[56:57], v81 offset:32768
    ds_read_b64_tr_b16 v[58:59], v81 offset:33792
    ds_read_b64_tr_b16 v[60:61], v81 offset:40960
    ds_read_b64_tr_b16 v[62:63], v81 offset:41984
    s_waitcnt lgkmcnt(0)
    ds_write_b128 v5, v[56:59] offset:12288
    ds_write_b128 v5, v[60:63] offset:13312
    s_branch L_lw_87
L_lw_87_1:
    s_cmp_lg_u32 s44, 2
    s_cbranch_scc1 L_lw_87_2
    ds_read_b64_tr_b16 a[64:65], v80 offset:32768
    ds_read_b64_tr_b16 a[66:67], v80 offset:33792
    ds_read_b64_tr_b16 a[68:69], v80 offset:40960
    ds_read_b64_tr_b16 a[70:71], v80 offset:41984
    ds_read_b64_tr_b16 v[56:57], v81 offset:32768
    ds_read_b64_tr_b16 v[58:59], v81 offset:33792
    ds_read_b64_tr_b16 v[60:61], v81 offset:40960
    ds_read_b64_tr_b16 v[62:63], v81 offset:41984
    s_waitcnt lgkmcnt(0)
    ds_write_b128 v5, v[56:59] offset:14336
    ds_write_b128 v5, v[60:63] offset:15360
    s_branch L_lw_87
L_lw_87_2:
    ds_read_b64_tr_b16 a[32:33], v80 offset:32768
    ds_read_b64_tr_b16 a[34:35], v80 offset:33792
    ds_read_b64_tr_b16 a[36:37], v80 offset:40960
    ds_read_b64_tr_b16 a[38:39], v80 offset:41984
    ds_read_b64_tr_b16 v[56:57], v81 offset:32768
    ds_read_b64_tr_b16 v[58:59], v81 offset:33792
    ds_read_b64_tr_b16 v[60:61], v81 offset:40960
    ds_read_b64_tr_b16 v[62:63], v81 offset:41984
    s_waitcnt lgkmcnt(0)
    ds_write_b128 v5, v[56:59] offset:8192
    ds_write_b128 v5, v[60:63] offset:9216
L_lw_87:
    s_waitcnt lgkmcnt(0)
    s_waitcnt vmcnt(0)
    s_barrier
    s_add_u32 s45, s61, 0
    buffer_load_dword v47, v12, s[12:15], s45 offen sc1
    s_add_u32 s45, s61, 16384
    buffer_load_dword v47, v12, s[12:15], s45 offen sc1
    s_add_u32 s45, s61, 32768
    buffer_load_dword v47, v12, s[12:15], s45 offen sc1
    s_add_u32 s45, s61, 49152
    buffer_load_dword v47, v12, s[12:15], s45 offen sc1
    s_mov_b32 s45, 0x7020000
    buffer_load_dword v47, v10, s[12:15], s45 offen sc1
    s_mov_b32 s45, 0x7030000
    buffer_load_dword v47, v10, s[12:15], s45 offen sc1
    buffer_load_dword v47, v20, s[12:15], 0 offen sc1
    s_cmp_lg_u32 s44, 0
    s_cbranch_scc1 L_lw_88_0
    ds_read_b64_tr_b16 a[152:153], v80 offset:49152
    ds_read_b64_tr_b16 a[154:155], v80 offset:50176
    ds_read_b64_tr_b16 a[156:157], v80 offset:57344
    ds_read_b64_tr_b16 a[158:159], v80 offset:58368
    ds_read_b64_tr_b16 v[56:57], v81 offset:49152
    ds_read_b64_tr_b16 v[58:59], v81 offset:50176
    ds_read_b64_tr_b16 v[60:61], v81 offset:57344
    ds_read_b64_tr_b16 v[62:63], v81 offset:58368
    s_waitcnt lgkmcnt(0)
    ds_write_b128 v5, v[56:59] offset:18432
    ds_write_b128 v5, v[60:63] offset:19456
    s_branch L_lw_88
L_lw_88_0:
    s_cmp_lg_u32 s44, 1
    s_cbranch_scc1 L_lw_88_1
    ds_read_b64_tr_b16 a[112:113], v80 offset:49152
    ds_read_b64_tr_b16 a[114:115], v80 offset:50176
    ds_read_b64_tr_b16 a[116:117], v80 offset:57344
    ds_read_b64_tr_b16 a[118:119], v80 offset:58368
    ds_read_b64_tr_b16 v[56:57], v81 offset:49152
    ds_read_b64_tr_b16 v[58:59], v81 offset:50176
    ds_read_b64_tr_b16 v[60:61], v81 offset:57344
    ds_read_b64_tr_b16 v[62:63], v81 offset:58368
    s_waitcnt lgkmcnt(0)
    ds_write_b128 v5, v[56:59] offset:20480
    ds_write_b128 v5, v[60:63] offset:21504
    s_branch L_lw_88
L_lw_88_1:
    s_cmp_lg_u32 s44, 2
    s_cbranch_scc1 L_lw_88_2
    ds_read_b64_tr_b16 a[72:73], v80 offset:49152
    ds_read_b64_tr_b16 a[74:75], v80 offset:50176
    ds_read_b64_tr_b16 a[76:77], v80 offset:57344
    ds_read_b64_tr_b16 a[78:79], v80 offset:58368
    ds_read_b64_tr_b16 v[56:57], v81 offset:49152
    ds_read_b64_tr_b16 v[58:59], v81 offset:50176
    ds_read_b64_tr_b16 v[60:61], v81 offset:57344
    ds_read_b64_tr_b16 v[62:63], v81 offset:58368
    s_waitcnt lgkmcnt(0)
    ds_write_b128 v5, v[56:59] offset:22528
    ds_write_b128 v5, v[60:63] offset:23552
    s_branch L_lw_88
L_lw_88_2:
    ds_read_b64_tr_b16 a[40:41], v80 offset:49152
    ds_read_b64_tr_b16 a[42:43], v80 offset:50176
    ds_read_b64_tr_b16 a[44:45], v80 offset:57344
    ds_read_b64_tr_b16 a[46:47], v80 offset:58368
    ds_read_b64_tr_b16 v[56:57], v81 offset:49152
    ds_read_b64_tr_b16 v[58:59], v81 offset:50176
    ds_read_b64_tr_b16 v[60:61], v81 offset:57344
    ds_read_b64_tr_b16 v[62:63], v81 offset:58368
    s_waitcnt lgkmcnt(0)
    ds_write_b128 v5, v[56:59] offset:16384
    ds_write_b128 v5, v[60:63] offset:17408
L_lw_88:
    s_waitcnt lgkmcnt(0)
    s_barrier
    v_lshlrev_b32 v68, 3, v1
    s_mul_i32 s45, s44, 3072
    s_add_u32 s45, s45, 53248
    v_add_u32 v6, s45, v68
    s_sub_u32 s45, s44, 1
    s_and_b32 s45, s45, 3
    s_mul_i32 s45, s45, 3072
    s_add_u32 s45, s45, 53248
    v_add_u32 v7, s45, v68
    s_sub_u32 s45, s44, 2
    s_and_b32 s45, s45, 3
    s_mul_i32 s45, s45, 3072
    s_add_u32 s45, s45, 54272
    v_add_u32 v8, s45, v68
    s_sub_u32 s45, s44, 3
    s_and_b32 s45, s45, 3
    s_mul_i32 s45, s45, 3072
    s_add_u32 s45, s45, 55296
    v_add_u32 v18, s45, v68
    v_lshlrev_b32 v68, 4, v1
    s_add_u32 s45, s69, 0
    s_and_b32 s45, s45, 7
    s_lshl_b32 s45, s45, 10
    s_lshl_b32 s46, s44, 13
    s_add_u32 s45, s45, s46
    v_add_u32 v80, s45, v68
    s_add_u32 s45, s69, 1
    s_and_b32 s45, s45, 7
    s_lshl_b32 s45, s45, 10
    s_lshl_b32 s46, s44, 13
    s_add_u32 s45, s45, s46
    v_add_u32 v81, s45, v68
    s_add_u32 s45, s69, 2
    s_and_b32 s45, s45, 7
    s_lshl_b32 s45, s45, 10
    s_lshl_b32 s46, s44, 13
    s_add_u32 s45, s45, s46
    v_add_u32 v82, s45, v68
    s_add_u32 s45, s69, 3
    s_and_b32 s45, s45, 7
    s_lshl_b32 s45, s45, 10
    s_lshl_b32 s46, s44, 13
    s_add_u32 s45, s45, s46
    v_add_u32 v83, s45, v68
    s_add_u32 s45, s69, 4
    s_and_b32 s45, s45, 7
    s_lshl_b32 s45, s45, 10
    s_lshl_b32 s46, s44, 13
    s_add_u32 s45, s45, s46
    v_add_u32 v84, s45, v68
    s_add_u32 s45, s69, 5
    s_and_b32 s45, s45, 7
    s_lshl_b32 s45, s45, 10
    s_lshl_b32 s46, s44, 13
    s_add_u32 s45, s45, s46
    v_add_u32 v85, s45, v68
    s_add_u32 s45, s69, 6
    s_and_b32 s45, s45, 7
    s_lshl_b32 s45, s45, 10
    s_lshl_b32 s46, s44, 13
    s_add_u32 s45, s45, s46
    v_add_u32 v86, s45, v68
    s_add_u32 s45, s69, 7
    s_and_b32 s45, s45, 7
    s_lshl_b32 s45, s45, 10
    s_lshl_b32 s46, s44, 13
    s_add_u32 s45, s45, s46
    v_add_u32 v87, s45, v68
    s_lshl_b32 s45, s40, 4
    s_add_u32 s45, s45, s42
    s_lshl_b32 s45, s45, 8
    s_lshl_b32 s46, s44, 6
    s_add_u32 s45, s45, s46
    s_add_u32 s45, s45, 0x7080000
    v_and_b32 v13, 15, v1
    v_lshlrev_b32 v13, 2, v13
    v_add_u32 v13, s45, v13
    s_mov_b32 s66, 0x1800000
    v_mov_b32 v14, -1
    v_mov_b32 v15, -1
    s_mov_b32 s70, 0
    v_mov_b32 v41, 0
    s_branch L_hw_89_c
L_hw_89:
    buffer_load_dwordx2 v[44:45], v41, s[16:19], 0 offen sc1
    s_add_u32 s70, s70, 1
    s_cmp_ge_u32 s70, 0x100000
    s_cbranch_scc1 L_c_done_1
L_hw_89_c:
    s_waitcnt vmcnt(0)
    v_readfirstlane_b32 s45, v44
    v_readfirstlane_b32 s46, v45
    s_nop 3
    s_lshr_b32 s47, s46, 24
    s_cmp_lg_u32 s47, 64
    s_cbranch_scc1 L_hw_89
    s_lshr_b32 s68, s45, 24
    s_and_b32 s47, s45, 511
    s_mul_i32 s47, s47, s47
    s_bfe_u32 s45, s45, 0xf0009
    s_lshl_b32 s45, s45, 5
    s_sub_u32 s45, s45, s47
    s_and_b32 s47, s46, 511
    s_mul_i32 s47, s47, s47
    s_bfe_u32 s46, s46, 0xf0009
    s_lshl_b32 s46, s46, 5
    s_sub_u32 s46, s46, s47
    s_or_b32 s45, s45, s46
    s_cmp_eq_u32 s45, 0
    s_cselect_b32 s67, 1, 0
    s_mov_b32 s24, s12
    s_mov_b32 s25, s13
    s_mov_b32 s28, s12
    s_mov_b32 s29, s13
    s_cmp_eq_u32 s67, 1
    s_cselect_b32 s26, s14, 0
    s_cselect_b32 s30, 0, s14
    s_cmp_ge_u32 s68, 16
    s_cselect_b32 s68, 8192, 0
    s_mov_b32 s6, 0x11111111
    s_mov_b32 s7, 0xffaaa491
    s_mov_b32 s60, 0
    s_lshl_b32 s58, s40, 16
    s_add_u32 s58, s58, 0x7000000
    s_mov_b32 s61, s58
    s_lshl_b32 s59, s40, 17
    s_add_u32 s59, s59, 0x7040000
    s_mov_b32 s62, s59
    s_add_u32 s32, s41, 0
    s_and_b32 s32, s32, 3
    s_lshl_b32 s32, s32, 10
    s_add_u32 s33, s41, 1
    s_and_b32 s33, s33, 3
    s_lshl_b32 s33, s33, 10
    s_add_u32 s34, s41, 2
    s_and_b32 s34, s34, 3
    s_lshl_b32 s34, s34, 10
    s_add_u32 s35, s41, 3
    s_and_b32 s35, s35, 3
    s_lshl_b32 s35, s35, 10
    s_cmp_lg_u32 s44, 0
    s_cbranch_scc1 L_ld_90
    v_mov_b32 v40, 1
    v_mov_b32 v41, 127360
    s_mov_b64 exec, 1
    buffer_atomic_add v40, v41, s[12:15], 0 offen sc1
    s_mov_b64 exec, -1
L_ld_90:
    s_add_u32 s63, s63, s68
    s_add_u32 s64, s64, s68
    s_lshl_b32 s36, s40, 12
    s_add_u32 s36, s36, 0x5000
    ds_read_b128 v[56:59], v5 offset:8192
    ds_read_b128 v[60:63], v5 offset:9216
    ds_read_b128 v[64:67], v5 offset:16384
    ds_read_b128 v[68:71], v5 offset:17408
    ds_read_b128 v[72:75], v5 offset:4096
    ds_read_b128 v[76:79], v5 offset:5120
    ds_read_b128 v[88:91], v5 offset:6144
    ds_read_b128 v[92:95], v5 offset:7168
    ds_read_b128 v[32:35], v5 offset:14336
    ds_read_b128 v[36:39], v5 offset:15360
L_v_loop_91:
    s_add_u32 s8, s61, s32
    s_add_u32 s9, s61, s33
    s_add_u32 s10, s61, s34
    s_add_u32 s11, s61, s35
    v_mov_b32 v24, 0
    v_mov_b32 v25, 0
    v_mov_b32 v26, 0
    v_mov_b32 v27, 0
    v_mov_b32 v28, 0
    v_mov_b32 v29, 0
    v_mov_b32 v30, 0
    v_mov_b32 v31, 0
    s_and_b32 s37, s60, 1
    s_lshl_b32 s37, s37, 16
    s_add_u32 s37, s37, 0x7020000
    s_xor_b32 s38, s37, 65536
    s_add_u32 s39, s60, 3
    s_and_b32 s39, s39, 3
    s_lshl_b32 s39, s39, 14
    s_add_u32 s39, s39, s58
    s_nop 15
    s_waitcnt lgkmcnt(0)
    buffer_load_dwordx4 v[40:43], v3, s[12:15], s8 offen sc1
    s_nop 4
    buffer_load_dwordx4 v[44:47], v3, s[12:15], s9 offen sc1
    s_nop 4
    buffer_load_dwordx4 v[48:51], v3, s[12:15], s10 offen sc1
    s_nop 4
    buffer_load_dwordx4 v[52:55], v3, s[12:15], s11 offen sc1
    s_mov_b32 s70, 0
    s_waitcnt vmcnt(3)
    v_max3_u32 v22, v40, v41, v42
    ds_write_b128 v3, v[40:43] offset:0
    v_max_u32 v22, v22, v43
    v_cmp_eq_u32 vcc, -1, v22
    s_nop 0
    s_nop 0
    s_cbranch_vccnz L_mg_92_r0
L_mg_92_c0:
    v_smfmac_f32_16x16x64_bf16 v[24:27], v[40:43], a[0:7], v2
    s_waitcnt vmcnt(2)
    v_max3_u32 v22, v44, v45, v46
    ds_write_b128 v3, v[44:47] offset:1024
    v_max_u32 v22, v22, v47
    v_cmp_eq_u32 vcc, -1, v22
    v_smfmac_f32_16x16x64_bf16 v[28:31], v[40:43], a[8:15], v2
    s_nop 0
    s_cbranch_vccnz L_mg_92_r1
L_mg_92_c1:
    v_smfmac_f32_16x16x64_bf16 v[24:27], v[44:47], a[16:23], v2
    s_waitcnt vmcnt(1)
    v_max3_u32 v22, v48, v49, v50
    ds_write_b128 v3, v[48:51] offset:2048
    v_max_u32 v22, v22, v51
    v_cmp_eq_u32 vcc, -1, v22
    v_smfmac_f32_16x16x64_bf16 v[28:31], v[44:47], a[24:31], v2
    s_nop 0
    s_cbranch_vccnz L_mg_92_r2
L_mg_92_c2:
    s_waitcnt vmcnt(0)
    v_max3_u32 v22, v52, v53, v54
    ds_write_b128 v3, v[52:55] offset:3072
    v_max_u32 v22, v22, v55
    v_cmp_eq_u32 vcc, -1, v22
    s_waitcnt lgkmcnt(0)
    s_nop 0
    s_cbranch_vccnz L_mg_92_r3
L_mg_92_c3:
    s_barrier
    ds_read_b128 v[40:43], v4 offset:0
    ds_read_b128 v[44:47], v4 offset:1024
    v_smfmac_f32_16x16x64_bf16 v[24:27], v[48:51], a[32:39], v2
    v_smfmac_f32_16x16x64_bf16 v[28:31], v[48:51], v[56:63], v2
    ds_read_b128 v[48:51], v4 offset:2048
    v_smfmac_f32_16x16x64_bf16 v[24:27], v[52:55], a[40:47], v2
    ds_read_b128 v[56:59], v5 offset:22528
    v_smfmac_f32_16x16x64_bf16 v[28:31], v[52:55], v[64:71], v2
    ds_read_b128 v[52:55], v4 offset:3072
    s_waitcnt lgkmcnt(3)
    v_smfmac_f32_16x16x64_bf16 v[24:27], v[40:43], a[48:55], v2
    ds_read_b128 v[60:63], v5 offset:23552
    v_smfmac_f32_16x16x64_bf16 v[28:31], v[40:43], v[72:79], v2
    ds_read_b128 v[40:43], v21 offset:0
    v_smfmac_f32_16x16x64_bf16 v[24:27], v[44:47], a[56:63], v2
    ds_read_b128 v[64:67], v5 offset:2048
    v_smfmac_f32_16x16x64_bf16 v[28:31], v[44:47], v[88:95], v2
    ds_read_b128 v[44:47], v21 offset:1024
    ds_read_b128 v[68:71], v5 offset:3072
    s_waitcnt lgkmcnt(5)
    v_smfmac_f32_16x16x64_bf16 v[24:27], v[48:51], a[64:71], v2
    ds_read_b128 v[72:75], v5 offset:12288
    v_smfmac_f32_16x16x64_bf16 v[28:31], v[48:51], v[32:39], v2
    ds_read_b128 v[48:51], v21 offset:2048
    ds_read_b128 v[76:79], v5 offset:13312
    v_smfmac_f32_16x16x64_bf16 v[24:27], v[52:55], a[72:79], v2
    ds_read_b128 v[88:91], v5 offset:20480
    s_waitcnt lgkmcnt(6)
    v_smfmac_f32_16x16x64_bf16 v[28:31], v[52:55], v[56:63], v2
    ds_read_b128 v[52:55], v21 offset:3072
    ds_read_b128 v[92:95], v5 offset:21504
    v_smfmac_f32_16x16x64_bf16 v[24:27], v[40:43], a[80:87], v2
    ds_read_b128 v[32:35], v5 offset:0
    s_waitcnt lgkmcnt(6)
    v_smfmac_f32_16x16x64_bf16 v[28:31], v[40:43], v[64:71], v2
    ds_read_b128 v[40:43], v23 offset:0
    ds_read_b128 v[36:39], v5 offset:1024
    v_smfmac_f32_16x16x64_bf16 v[24:27], v[44:47], a[88:95], v2
    ds_read_b128 v[56:59], v5 offset:10240
    v_smfmac_f32_16x16x64_bf16 v[28:31], v[44:47], a[96:103], v2
    ds_read_b128 v[44:47], v23 offset:1024
    s_waitcnt lgkmcnt(5)
    v_smfmac_f32_16x16x64_bf16 v[24:27], v[48:51], a[104:111], v2
    ds_read_b128 v[60:63], v5 offset:11264
    v_smfmac_f32_16x16x64_bf16 v[28:31], v[48:51], v[72:79], v2
    ds_read_b128 v[48:51], v23 offset:2048
    v_smfmac_f32_16x16x64_bf16 v[24:27], v[52:55], a[112:119], v2
    ds_read_b128 v[64:67], v5 offset:18432
    v_smfmac_f32_16x16x64_bf16 v[28:31], v[52:55], v[88:95], v2
    ds_read_b128 v[52:55], v23 offset:3072
    s_waitcnt lgkmcnt(4)
    v_smfmac_f32_16x16x64_bf16 v[24:27], v[40:43], a[120:127], v2
    ds_read_b128 v[68:71], v5 offset:19456
    v_smfmac_f32_16x16x64_bf16 v[28:31], v[40:43], v[32:39], v2
    v_smfmac_f32_16x16x64_bf16 v[24:27], v[44:47], a[128:135], v2
    v_smfmac_f32_16x16x64_bf16 v[28:31], v[44:47], a[136:143], v2
    s_waitcnt lgkmcnt(1)
    v_smfmac_f32_16x16x64_bf16 v[24:27], v[48:51], a[144:151], v2
    v_smfmac_f32_16x16x64_bf16 v[28:31], v[48:51], v[56:63], v2
    v_smfmac_f32_16x16x64_bf16 v[24:27], v[52:55], a[152:159], v2
    s_waitcnt lgkmcnt(0)
    v_smfmac_f32_16x16x64_bf16 v[28:31], v[52:55], v[64:71], v2
    s_nop 5
    v_permlane32_swap_b32 v24, v26
    v_permlane32_swap_b32 v25, v27
    v_permlane32_swap_b32 v28, v30
    v_permlane32_swap_b32 v29, v31
    v_pk_add_f32 v[24:25], v[24:25], v[26:27]
    v_pk_add_f32 v[28:29], v[28:29], v[30:31]
    v_cvt_pk_bf16_f32 v16, v24, v25
    v_cvt_pk_bf16_f32 v17, v28, v29
    buffer_store_dwordx2 v[16:17], v10, s[24:27], s37 offen
    buffer_store_dwordx2 v[14:15], v10, s[24:27], s38 offen
    buffer_store_dword v14, v12, s[24:27], s39 offen
    buffer_store_dwordx2 v[16:17], v10, s[28:31], s37 offen sc1
    buffer_store_dwordx2 v[14:15], v10, s[28:31], s38 offen sc1
    buffer_store_dword v14, v12, s[28:31], s39 offen sc1
    s_barrier
    s_cmp_eq_u32 s60, 63
    s_cbranch_scc1 L_v_fin_93
    s_and_b32 s65, s60, 1
    s_lshl_b32 s65, s65, 12
    s_and_b32 s45, s60, 2
    s_lshl_b32 s45, s45, 13
    s_add_u32 s65, s65, s45
    s_xor_b32 s45, s65, 16384
    s_add_u32 s45, s45, s63
    buffer_store_dwordx2 v[14:15], v11, s[12:15], s45 offen sc1
    s_add_u32 s48, s63, s65
    s_add_u32 s49, s64, s65
    v_mov_b32 v24, 0
    v_mov_b32 v25, 0
    v_mov_b32 v26, 0
    v_mov_b32 v27, 0
    v_mov_b32 v28, 0
    v_mov_b32 v29, 0
    v_mov_b32 v30, 0
    v_mov_b32 v31, 0
    v_mov_b32 v32, 0
    v_mov_b32 v33, 0
    v_mov_b32 v34, 0
    v_mov_b32 v35, 0
    v_mov_b32 v36, 0
    v_mov_b32 v37, 0
    v_mov_b32 v38, 0
    v_mov_b32 v39, 0
    s_sleep 4
    s_waitcnt vmcnt(0)
    s_mov_b64 exec, 65535
    buffer_load_dword v88, v13, s[12:15], 0 offen sc1
    s_nop 15
    buffer_load_dword v89, v13, s[12:15], 0 offen sc1
    s_nop 15
    buffer_load_dword v90, v13, s[12:15], 0 offen sc1
    s_nop 15
    buffer_load_dword v91, v13, s[12:15], 0 offen sc1
    s_mov_b32 s70, 0
L_pp_94:
    s_waitcnt vmcnt(3)
    v_cmp_ge_u32 vcc, s60, v88
    s_add_u32 s70, s70, 1
    s_nop 0
    s_cbranch_vccz L_ppd_95
    buffer_load_dword v88, v13, s[12:15], 0 offen sc1
    s_waitcnt vmcnt(3)
    v_cmp_ge_u32 vcc, s60, v89
    s_add_u32 s70, s70, 1
    s_nop 0
    s_cbranch_vccz L_ppd_95
    buffer_load_dword v89, v13, s[12:15], 0 offen sc1
    s_waitcnt vmcnt(3)
    v_cmp_ge_u32 vcc, s60, v90
    s_add_u32 s70, s70, 1
    s_nop 0
    s_cbranch_vccz L_ppd_95
    buffer_load_dword v90, v13, s[12:15], 0 offen sc1
    s_waitcnt vmcnt(3)
    v_cmp_ge_u32 vcc, s60, v91
    s_add_u32 s70, s70, 1
    s_nop 0
    s_cbranch_vccz L_ppd_95
    buffer_load_dword v91, v13, s[12:15], 0 offen sc1
    s_cmp_lt_u32 s70, 0x400000
    s_cbranch_scc1 L_pp_94
    s_branch L_c_done_1
L_ppd_95:
    s_mov_b64 exec, -1
    s_nop 3
    s_mov_b32 s70, 0
    buffer_load_dwordx4 v[40:43], v80, s[12:15], s62 offen sc1
    s_nop 7
    buffer_load_dwordx4 v[44:47], v81, s[12:15], s62 offen sc1
    s_nop 7
    buffer_load_dwordx4 v[48:51], v82, s[12:15], s62 offen sc1
    s_nop 7
    buffer_load_dwordx4 v[52:55], v83, s[12:15], s62 offen sc1
    s_nop 7
    buffer_load_dwordx4 v[56:59], v84, s[12:15], s62 offen sc1
    s_nop 7
    buffer_load_dwordx4 v[60:63], v85, s[12:15], s62 offen sc1
    s_waitcnt vmcnt(5)
    v_cmp_eq_u32 vcc, -1, v43
    s_nop 1
    s_cbranch_vccnz L_v_og_96_r0
L_v_og_96_c0:
    v_smfmac_f32_16x16x64_bf16 v[24:27], v[40:43], a[160:167], v2
    buffer_load_dwordx4 v[64:67], v86, s[12:15], s62 offen sc1
    v_smfmac_f32_16x16x64_bf16 v[28:31], v[40:43], a[168:175], v2
    s_waitcnt vmcnt(5)
    v_cmp_eq_u32 vcc, -1, v47
    v_smfmac_f32_16x16x64_bf16 v[32:35], v[40:43], a[176:183], v2
    v_smfmac_f32_16x16x64_bf16 v[36:39], v[40:43], a[184:191], v2
    s_cbranch_vccnz L_v_og_96_r1
L_v_og_96_c1:
    v_smfmac_f32_16x16x64_bf16 v[24:27], v[44:47], a[192:199], v2
    buffer_load_dwordx4 v[68:71], v87, s[12:15], s62 offen sc1
    v_smfmac_f32_16x16x64_bf16 v[28:31], v[44:47], a[200:207], v2
    s_waitcnt vmcnt(5)
    v_cmp_eq_u32 vcc, -1, v51
    v_smfmac_f32_16x16x64_bf16 v[32:35], v[44:47], a[208:215], v2
    v_smfmac_f32_16x16x64_bf16 v[36:39], v[44:47], a[216:223], v2
    s_cbranch_vccnz L_v_og_96_r2
L_v_og_96_c2:
    v_smfmac_f32_16x16x64_bf16 v[24:27], v[48:51], a[224:231], v2
    s_waitcnt vmcnt(4)
    v_cmp_eq_u32 vcc, -1, v55
    v_smfmac_f32_16x16x64_bf16 v[28:31], v[48:51], a[232:239], v2
    v_smfmac_f32_16x16x64_bf16 v[32:35], v[48:51], a[240:247], v2
    s_cbranch_vccnz L_v_og_96_r3
L_v_og_96_c3:
    v_smfmac_f32_16x16x64_bf16 v[24:27], v[52:55], v[96:103], v2
    s_add_u32 s46, s60, 1
    s_and_b32 s45, s46, 3
    v_smfmac_f32_16x16x64_bf16 v[28:31], v[52:55], v[104:111], v2
    s_waitcnt vmcnt(3)
    v_cmp_eq_u32 vcc, -1, v59
    v_smfmac_f32_16x16x64_bf16 v[32:35], v[52:55], v[112:119], v2
    v_smfmac_f32_16x16x64_bf16 v[36:39], v[52:55], v[120:127], v2
    s_cbranch_vccnz L_v_og_96_r4
L_v_og_96_c4:
    v_smfmac_f32_16x16x64_bf16 v[24:27], v[56:59], v[128:135], v2
    s_waitcnt vmcnt(2)
    v_cmp_eq_u32 vcc, -1, v63
    v_smfmac_f32_16x16x64_bf16 v[28:31], v[56:59], v[136:143], v2
    v_smfmac_f32_16x16x64_bf16 v[32:35], v[56:59], v[144:151], v2
    s_cbranch_vccnz L_v_og_96_r5
L_v_og_96_c5:
    v_smfmac_f32_16x16x64_bf16 v[24:27], v[60:63], v[160:167], v2
    s_mov_b32 s60, s46
    s_lshl_b32 s46, s45, 14
    v_smfmac_f32_16x16x64_bf16 v[28:31], v[60:63], v[168:175], v2
    s_waitcnt vmcnt(1)
    v_cmp_eq_u32 vcc, -1, v67
    v_smfmac_f32_16x16x64_bf16 v[32:35], v[60:63], v[176:183], v2
    v_smfmac_f32_16x16x64_bf16 v[36:39], v[60:63], v[184:191], v2
    s_cbranch_vccnz L_v_og_96_r6
L_v_og_96_c6:
    v_smfmac_f32_16x16x64_bf16 v[24:27], v[64:67], v[192:199], v2
    s_add_u32 s61, s58, s46
    v_smfmac_f32_16x16x64_bf16 v[28:31], v[64:67], v[200:207], v2
    v_smfmac_f32_16x16x64_bf16 v[32:35], v[64:67], v[208:215], v2
    s_waitcnt vmcnt(0)
    v_cmp_eq_u32 vcc, -1, v71
    v_smfmac_f32_16x16x64_bf16 v[36:39], v[64:67], v[216:223], v2
    s_nop 0
    s_cbranch_vccnz L_v_og_96_r7
L_v_og_96_c7:
    v_smfmac_f32_16x16x64_bf16 v[24:27], v[68:71], v[224:231], v2
    s_lshl_b32 s46, s45, 15
    s_add_u32 s62, s59, s46
    v_smfmac_f32_16x16x64_bf16 v[28:31], v[68:71], v[232:239], v2
    s_nop 0
    s_nop 0
    v_smfmac_f32_16x16x64_bf16 v[32:35], v[68:71], v[240:247], v2
    s_nop 0
    s_nop 0
    v_permlane32_swap_b32 v24, v26
    v_permlane32_swap_b32 v25, v27
    v_pk_add_f32 v[24:25], v[24:25], v[26:27]
    v_smfmac_f32_16x16x64_bf16 v[36:39], v[48:51], a[248:255], v2
    ds_write_b64 v6, v[24:25] offset:0
    v_permlane32_swap_b32 v28, v30
    v_permlane32_swap_b32 v29, v31
    v_pk_add_f32 v[28:29], v[28:29], v[30:31]
    v_smfmac_f32_16x16x64_bf16 v[36:39], v[56:59], v[152:159], v2
    ds_write_b64 v6, v[28:29] offset:1024
    v_permlane32_swap_b32 v32, v34
    v_permlane32_swap_b32 v33, v35
    v_pk_add_f32 v[32:33], v[32:33], v[34:35]
    v_smfmac_f32_16x16x64_bf16 v[36:39], v[68:71], v[248:255], v2
    ds_write_b64 v6, v[32:33] offset:2048
    v_mov_b32 v19, s60
    s_nop 5
    v_permlane32_swap_b32 v36, v38
    v_permlane32_swap_b32 v37, v39
    v_pk_add_f32 v[36:37], v[36:37], v[38:39]
    s_waitcnt lgkmcnt(0)
    s_barrier
    ds_read_b64 v[40:41], v7
    ds_read_b64 v[42:43], v8
    ds_read_b64 v[44:45], v18
    s_waitcnt lgkmcnt(2)
    v_pk_add_f32 v[36:37], v[36:37], v[40:41]
    s_waitcnt lgkmcnt(0)
    v_pk_add_f32 v[42:43], v[42:43], v[44:45]
    v_pk_add_f32 v[24:25], v[36:37], v[42:43]
    buffer_store_dwordx2 v[24:25], v11, s[12:15], s48 offen sc1
    ds_read_b128 v[56:59], v5 offset:8192
    ds_read_b128 v[60:63], v5 offset:9216
    ds_read_b128 v[64:67], v5 offset:16384
    ds_read_b128 v[68:71], v5 offset:17408
    ds_read_b128 v[72:75], v5 offset:4096
    ds_read_b128 v[76:79], v5 offset:5120
    ds_read_b128 v[88:91], v5 offset:6144
    ds_read_b128 v[92:95], v5 offset:7168
    ds_read_b128 v[32:35], v5 offset:14336
    ds_read_b128 v[36:39], v5 offset:15360
    s_sleep 4
    buffer_load_dwordx2 v[40:41], v11, s[12:15], s49 offen sc1
    s_mov_b32 s70, 0
L_v_xp_97:
    s_waitcnt vmcnt(0)
    v_max_u32 v22, v40, v41
    v_cmp_eq_u32 vcc, -1, v22
    v_pk_add_f32 v[28:29], v[24:25], v[40:41]
    v_cvt_pk_bf16_f32 v28, v28, v29
    s_cbranch_vccnz L_v_xp_97_r
L_v_xp_97_ok:
    buffer_store_dword v19, v20, s[24:27], 0 offen
    v_mov_b32_dpp v29, v28 quad_perm:[1,0,3,2] row_mask:0xf bank_mask:0xf
    v_perm_b32 v28, v28, v29, v9
    buffer_store_dword v28, v12, s[24:27], s61 offen
    buffer_store_dword v28, v12, s[28:31], s61 offen sc1
    buffer_store_dword v19, v20, s[28:31], 0 offen sc1
    s_add_u32 s66, s66, 65536
    s_branch L_v_loop_91
L_v_fin_93:
    buffer_store_dwordx2 v[16:17], v10, s[12:15], s66 offen sc1
    s_waitcnt vmcnt(0)
    v_mov_b32 v22, 64
    v_mov_b32 v0, 0
    s_mov_b64 exec, 1
    buffer_store_dword v22, v0, s[12:15], s3 offen sc1
    s_mov_b64 exec, -1
L_c_done_1:
    s_endpgm
L_v_og_96_r0:
    buffer_load_dwordx4 v[40:43], v80, s[12:15], s62 offen sc1
    buffer_load_dwordx4 v[44:47], v81, s[12:15], s62 offen sc1
    buffer_load_dwordx4 v[48:51], v82, s[12:15], s62 offen sc1
    buffer_load_dwordx4 v[52:55], v83, s[12:15], s62 offen sc1
    buffer_load_dwordx4 v[56:59], v84, s[12:15], s62 offen sc1
    buffer_load_dwordx4 v[60:63], v85, s[12:15], s62 offen sc1
    s_add_u32 s70, s70, 1
    s_cmp_ge_u32 s70, 0x100000
    s_cbranch_scc1 L_c_done_1
    s_waitcnt vmcnt(5)
    v_cmp_eq_u32 vcc, -1, v43
    s_nop 1
    s_cbranch_vccnz L_v_og_96_r0
    s_branch L_v_og_96_c0
L_v_og_96_r1:
    buffer_load_dwordx4 v[44:47], v81, s[12:15], s62 offen sc1
    buffer_load_dwordx4 v[48:51], v82, s[12:15], s62 offen sc1
    buffer_load_dwordx4 v[52:55], v83, s[12:15], s62 offen sc1
    buffer_load_dwordx4 v[56:59], v84, s[12:15], s62 offen sc1
    buffer_load_dwordx4 v[60:63], v85, s[12:15], s62 offen sc1
    buffer_load_dwordx4 v[64:67], v86, s[12:15], s62 offen sc1
    s_add_u32 s70, s70, 1
    s_cmp_ge_u32 s70, 0x100000
    s_cbranch_scc1 L_c_done_1
    s_waitcnt vmcnt(5)
    v_cmp_eq_u32 vcc, -1, v47
    s_nop 1
    s_cbranch_vccnz L_v_og_96_r1
    s_branch L_v_og_96_c1
L_v_og_96_r2:
    buffer_load_dwordx4 v[48:51], v82, s[12:15], s62 offen sc1
    buffer_load_dwordx4 v[52:55], v83, s[12:15], s62 offen sc1
    buffer_load_dwordx4 v[56:59], v84, s[12:15], s62 offen sc1
    buffer_load_dwordx4 v[60:63], v85, s[12:15], s62 offen sc1
    buffer_load_dwordx4 v[64:67], v86, s[12:15], s62 offen sc1
    buffer_load_dwordx4 v[68:71], v87, s[12:15], s62 offen sc1
    s_add_u32 s70, s70, 1
    s_cmp_ge_u32 s70, 0x100000
    s_cbranch_scc1 L_c_done_1
    s_waitcnt vmcnt(5)
    v_cmp_eq_u32 vcc, -1, v51
    s_nop 1
    s_cbranch_vccnz L_v_og_96_r2
    s_branch L_v_og_96_c2
L_v_og_96_r3:
    buffer_load_dwordx4 v[52:55], v83, s[12:15], s62 offen sc1
    buffer_load_dwordx4 v[56:59], v84, s[12:15], s62 offen sc1
    buffer_load_dwordx4 v[60:63], v85, s[12:15], s62 offen sc1
    buffer_load_dwordx4 v[64:67], v86, s[12:15], s62 offen sc1
    buffer_load_dwordx4 v[68:71], v87, s[12:15], s62 offen sc1
    s_add_u32 s70, s70, 1
    s_cmp_ge_u32 s70, 0x100000
    s_cbranch_scc1 L_c_done_1
    s_waitcnt vmcnt(4)
    v_cmp_eq_u32 vcc, -1, v55
    s_nop 1
    s_cbranch_vccnz L_v_og_96_r3
    s_branch L_v_og_96_c3
L_v_og_96_r4:
    buffer_load_dwordx4 v[56:59], v84, s[12:15], s62 offen sc1
    buffer_load_dwordx4 v[60:63], v85, s[12:15], s62 offen sc1
    buffer_load_dwordx4 v[64:67], v86, s[12:15], s62 offen sc1
    buffer_load_dwordx4 v[68:71], v87, s[12:15], s62 offen sc1
    s_add_u32 s70, s70, 1
    s_cmp_ge_u32 s70, 0x100000
    s_cbranch_scc1 L_c_done_1
    s_waitcnt vmcnt(3)
    v_cmp_eq_u32 vcc, -1, v59
    s_nop 1
    s_cbranch_vccnz L_v_og_96_r4
    s_branch L_v_og_96_c4
L_v_og_96_r5:
    buffer_load_dwordx4 v[60:63], v85, s[12:15], s62 offen sc1
    buffer_load_dwordx4 v[64:67], v86, s[12:15], s62 offen sc1
    buffer_load_dwordx4 v[68:71], v87, s[12:15], s62 offen sc1
    s_add_u32 s70, s70, 1
    s_cmp_ge_u32 s70, 0x100000
    s_cbranch_scc1 L_c_done_1
    s_waitcnt vmcnt(2)
    v_cmp_eq_u32 vcc, -1, v63
    s_nop 1
    s_cbranch_vccnz L_v_og_96_r5
    s_branch L_v_og_96_c5
L_v_og_96_r6:
    buffer_load_dwordx4 v[64:67], v86, s[12:15], s62 offen sc1
    buffer_load_dwordx4 v[68:71], v87, s[12:15], s62 offen sc1
    s_add_u32 s70, s70, 1
    s_cmp_ge_u32 s70, 0x100000
    s_cbranch_scc1 L_c_done_1
    s_waitcnt vmcnt(1)
    v_cmp_eq_u32 vcc, -1, v67
    s_nop 1
    s_cbranch_vccnz L_v_og_96_r6
    s_branch L_v_og_96_c6
L_v_og_96_r7:
    buffer_load_dwordx4 v[68:71], v87, s[12:15], s62 offen sc1
    s_add_u32 s70, s70, 1
    s_cmp_ge_u32 s70, 0x100000
    s_cbranch_scc1 L_c_done_1
    s_waitcnt vmcnt(0)
    v_cmp_eq_u32 vcc, -1, v71
    s_nop 1
    s_cbranch_vccnz L_v_og_96_r7
    s_branch L_v_og_96_c7
L_mg_92_r0:
    buffer_load_dwordx4 v[40:43], v3, s[12:15], s8 offen sc1
    buffer_load_dwordx4 v[44:47], v3, s[12:15], s9 offen sc1
    buffer_load_dwordx4 v[48:51], v3, s[12:15], s10 offen sc1
    buffer_load_dwordx4 v[52:55], v3, s[12:15], s11 offen sc1
    s_add_u32 s70, s70, 1
    s_cmp_ge_u32 s70, 0x100000
    s_cbranch_scc1 L_c_done_1
    s_waitcnt vmcnt(3)
    ds_write_b128 v3, v[40:43] offset:0
    v_max3_u32 v22, v40, v41, v42
    v_max_u32 v22, v22, v43
    v_cmp_eq_u32 vcc, -1, v22
    s_waitcnt lgkmcnt(0)
    s_nop 0
    s_cbranch_vccnz L_mg_92_r0
    s_branch L_mg_92_c0
L_mg_92_r1:
    buffer_load_dwordx4 v[44:47], v3, s[12:15], s9 offen sc1
    buffer_load_dwordx4 v[48:51], v3, s[12:15], s10 offen sc1
    buffer_load_dwordx4 v[52:55], v3, s[12:15], s11 offen sc1
    s_add_u32 s70, s70, 1
    s_cmp_ge_u32 s70, 0x100000
    s_cbranch_scc1 L_c_done_1
    s_waitcnt vmcnt(2)
    ds_write_b128 v3, v[44:47] offset:1024
    v_max3_u32 v22, v44, v45, v46
    v_max_u32 v22, v22, v47
    v_cmp_eq_u32 vcc, -1, v22
    s_waitcnt lgkmcnt(0)
    s_nop 0
    s_cbranch_vccnz L_mg_92_r1
    s_branch L_mg_92_c1
L_mg_92_r2:
    buffer_load_dwordx4 v[48:51], v3, s[12:15], s10 offen sc1
    buffer_load_dwordx4 v[52:55], v3, s[12:15], s11 offen sc1
    s_add_u32 s70, s70, 1
    s_cmp_ge_u32 s70, 0x100000
    s_cbranch_scc1 L_c_done_1
    s_waitcnt vmcnt(1)
    ds_write_b128 v3, v[48:51] offset:2048
    v_max3_u32 v22, v48, v49, v50
    v_max_u32 v22, v22, v51
    v_cmp_eq_u32 vcc, -1, v22
    s_waitcnt lgkmcnt(0)
    s_nop 0
    s_cbranch_vccnz L_mg_92_r2
    s_branch L_mg_92_c2
L_mg_92_r3:
    buffer_load_dwordx4 v[52:55], v3, s[12:15], s11 offen sc1
    s_add_u32 s70, s70, 1
    s_cmp_ge_u32 s70, 0x100000
    s_cbranch_scc1 L_c_done_1
    s_waitcnt vmcnt(0)
    ds_write_b128 v3, v[52:55] offset:3072
    v_max3_u32 v22, v52, v53, v54
    v_max_u32 v22, v22, v55
    v_cmp_eq_u32 vcc, -1, v22
    s_waitcnt lgkmcnt(0)
    s_nop 0
    s_cbranch_vccnz L_mg_92_r3
    s_branch L_mg_92_c3
L_v_xp_97_r:
    buffer_load_dwordx2 v[40:41], v11, s[12:15], s49 offen sc1
    s_add_u32 s70, s70, 1
    s_cmp_lt_u32 s70, 0x100000
    s_cbranch_scc1 L_v_xp_97
    s_endpgm
L_worker_3:
    s_lshr_b32 s41, s2, 3
    s_and_b32 s42, s40, 1
    s_lshr_b32 s43, s40, 1
    s_lshl_b32 s39, s43, 5
    s_add_u32 s39, s39, s41
    s_load_dwordx2 s[4:5], s[0:1], 0
    s_waitcnt lgkmcnt(0)
    s_mov_b32 s28, s4
    s_and_b32 s29, s5, 0xffff
    s_mov_b32 s30, 0x400000
    s_mov_b32 s31, 0x00020000
    v_lshrrev_b32 v2, 4, v1
    v_and_b32 v4, 15, v1
    v_lshrrev_b32 v3, 1, v4
    v_xor_b32 v3, v3, v2
    v_lshlrev_b32 v3, 4, v3
    v_lshlrev_b32 v6, 7, v4
    v_add_u32 v3, v3, v6
    v_mul_u32_u24 v7, 144, v4
    v_lshlrev_b32 v6, 4, v2
    s_mul_i32 s45, s44, 4608
    s_add_u32 s45, s45, 131072
    v_add3_u32 v7, v7, v6, s45
    v_lshrrev_b32 v9, 3, v1
    v_mul_u32_u24 v8, 144, v9
    v_and_b32 v6, 7, v1
    v_lshlrev_b32 v6, 4, v6
    v_add3_u32 v8, v8, v6, s45
    v_lshlrev_b32 v11, 12, v9
    v_add_u32 v11, v11, v6
    v_lshlrev_b32 v2, 13, v2
    v_lshlrev_b32 v6, 4, v4
    v_add_u32 v2, v2, v6
    v_lshrrev_b32 v6, 3, v1
    v_lshrrev_b32 v9, 4, v1
    v_and_b32 v4, 7, v1
    v_xor_b32 v9, v9, v4
    v_lshlrev_b32 v9, 4, v9
    v_lshlrev_b32 v6, 8, v6
    v_add_u32 v6, v6, v9
    v_xor_b32 v9, 64, v6
    v_add_u32 v9, 2048, v9
    v_lshlrev_b32 v10, 4, v1
    v_lshlrev_b32 v12, 2, v1
    v_lshlrev_b32 v5, 7, v1
    s_lshl_b32 s61, s41, 7
    s_lshl_b32 s45, s43, 2
    s_add_u32 s61, s61, s45
    s_add_u32 s61, s61, 0x10010
    s_mul_i32 s64, s42, 24576
    s_add_u32 s64, s64, 0x12000
    s_lshl_b32 s45, s41, 7
    s_add_u32 s65, s64, s45
    s_lshl_b32 s45, s43, 13
    s_add_u32 s65, s65, s45
    s_add_u32 s67, s65, 4096
    s_cmp_lg_u32 s42, 0
    s_cbranch_scc1 L_w_kv_99
    v_mov_b32 v30, 0
    v_mov_b32 v31, 0
    v_mov_b32 v29, 24576
    s_mov_b64 exec, 1
    buffer_store_dword v30, v31, s[12:15], s65 offen sc1
    buffer_store_dword v30, v31, s[12:15], s67 offen sc1
    buffer_store_dword v30, v29, s[12:15], s65 offen sc1
    buffer_store_dword v30, v29, s[12:15], s67 offen sc1
    s_mov_b64 exec, -1
    s_lshl_b32 s63, s39, 2
    s_add_u32 s63, s63, s44
    s_load_dwordx2 s[4:5], s[0:1], 96
    s_load_dwordx2 s[6:7], s[0:1], 104
    v_and_b32 v14, 7, v0
    v_lshrrev_b32 v15, 3, v0
    s_waitcnt lgkmcnt(0)
    s_mov_b32 s32, s4
    s_and_b32 s33, s5, 0xffff
    s_mov_b32 s34, 0x800
    s_mov_b32 s35, 0x00020000
    s_mov_b32 s24, s6
    s_and_b32 s25, s7, 0xffff
    s_mov_b32 s26, 0xc00000
    s_mov_b32 s27, 0x00020000
    s_and_b32 s47, s39, 1
    s_lshl_b32 s45, s47, 10
    v_lshlrev_b32 v16, 5, v15
    buffer_load_dwordx4 v[104:107], v16, s[32:35], s45 offen
    buffer_load_dwordx4 v[108:111], v16, s[32:35], s45 offen offset:16
    s_mov_b32 s45, 196608
    v_mul_lo_u32 v17, v15, s45
    v_lshlrev_b32 v18, 4, v14
    v_add_u32 v17, v17, v18
    s_lshr_b32 s46, s39, 1
    s_lshl_b32 s46, s46, 7
    s_mul_i32 s45, s47, 6291456
    s_add_u32 s46, s46, s45
    buffer_load_dwordx4 v[32:35], v17, s[24:27], s46 offen
    v_add_u32 v17, 12288, v17
    buffer_load_dwordx4 v[36:39], v17, s[24:27], s46 offen
    v_add_u32 v17, 12288, v17
    buffer_load_dwordx4 v[40:43], v17, s[24:27], s46 offen
    v_add_u32 v17, 12288, v17
    buffer_load_dwordx4 v[44:47], v17, s[24:27], s46 offen
    v_add_u32 v17, 12288, v17
    buffer_load_dwordx4 v[48:51], v17, s[24:27], s46 offen
    v_add_u32 v17, 12288, v17
    buffer_load_dwordx4 v[52:55], v17, s[24:27], s46 offen
    v_add_u32 v17, 12288, v17
    buffer_load_dwordx4 v[56:59], v17, s[24:27], s46 offen
    v_add_u32 v17, 12288, v17
    buffer_load_dwordx4 v[60:63], v17, s[24:27], s46 offen
    v_add_u32 v17, 12288, v17
    buffer_load_dwordx4 v[64:67], v17, s[24:27], s46 offen
    v_add_u32 v17, 12288, v17
    buffer_load_dwordx4 v[68:71], v17, s[24:27], s46 offen
    v_add_u32 v17, 12288, v17
    buffer_load_dwordx4 v[72:75], v17, s[24:27], s46 offen
    v_add_u32 v17, 12288, v17
    buffer_load_dwordx4 v[76:79], v17, s[24:27], s46 offen
    v_add_u32 v17, 12288, v17
    buffer_load_dwordx4 v[80:83], v17, s[24:27], s46 offen
    v_add_u32 v17, 12288, v17
    buffer_load_dwordx4 v[84:87], v17, s[24:27], s46 offen
    v_add_u32 v17, 12288, v17
    buffer_load_dwordx4 v[88:91], v17, s[24:27], s46 offen
    v_add_u32 v17, 12288, v17
    buffer_load_dwordx4 v[92:95], v17, s[24:27], s46 offen
    s_add_u32 s45, s63, 0
    s_lshl_b32 s45, s45, 11
    buffer_load_dwordx4 v[128:131], v10, s[28:31], s45 offen
    buffer_load_dwordx4 v[132:135], v10, s[28:31], s45 offen offset:1024
    s_add_u32 s45, s63, 384
    s_lshl_b32 s45, s45, 11
    buffer_load_dwordx4 v[136:139], v10, s[28:31], s45 offen
    buffer_load_dwordx4 v[140:143], v10, s[28:31], s45 offen offset:1024
    s_add_u32 s45, s63, 768
    s_lshl_b32 s45, s45, 11
    buffer_load_dwordx4 v[144:147], v10, s[28:31], s45 offen
    buffer_load_dwordx4 v[148:151], v10, s[28:31], s45 offen offset:1024
    s_add_u32 s45, s63, 1152
    s_lshl_b32 s45, s45, 11
    buffer_load_dwordx4 v[152:155], v10, s[28:31], s45 offen
    buffer_load_dwordx4 v[156:159], v10, s[28:31], s45 offen offset:1024
    s_add_u32 s45, s63, 1536
    s_lshl_b32 s45, s45, 11
    buffer_load_dwordx4 v[160:163], v10, s[28:31], s45 offen
    buffer_load_dwordx4 v[164:167], v10, s[28:31], s45 offen offset:1024
    s_add_u32 s45, s63, 1920
    s_lshl_b32 s45, s45, 11
    buffer_load_dwordx4 v[168:171], v10, s[28:31], s45 offen
    buffer_load_dwordx4 v[172:175], v10, s[28:31], s45 offen offset:1024
    s_waitcnt vmcnt(28)
    v_lshlrev_b32 v112, 16, v104
    v_and_b32 v113, 0xffff0000, v104
    v_lshlrev_b32 v114, 16, v105
    v_and_b32 v115, 0xffff0000, v105
    v_lshlrev_b32 v116, 16, v106
    v_and_b32 v117, 0xffff0000, v106
    v_lshlrev_b32 v118, 16, v107
    v_and_b32 v119, 0xffff0000, v107
    v_lshlrev_b32 v120, 16, v108
    v_and_b32 v121, 0xffff0000, v108
    v_lshlrev_b32 v122, 16, v109
    v_and_b32 v123, 0xffff0000, v109
    v_lshlrev_b32 v124, 16, v110
    v_and_b32 v125, 0xffff0000, v110
    v_lshlrev_b32 v126, 16, v111
    v_and_b32 v127, 0xffff0000, v111
    v_mul_f32 v18, 0xbfb8aa3b, v112
    v_exp_f32 v18, v18
    s_nop 0
    v_add_f32 v18, 1.0, v18
    v_rcp_f32 v18, v18
    s_nop 0
    v_mul_f32 v112, v112, v18
    v_cvt_pk_bf16_f32 v112, v112, v112
    v_lshlrev_b32 v112, 16, v112
    v_mul_f32 v18, 0xbfb8aa3b, v113
    v_exp_f32 v18, v18
    s_nop 0
    v_add_f32 v18, 1.0, v18
    v_rcp_f32 v18, v18
    s_nop 0
    v_mul_f32 v113, v113, v18
    v_cvt_pk_bf16_f32 v113, v113, v113
    v_lshlrev_b32 v113, 16, v113
    v_mul_f32 v18, 0xbfb8aa3b, v114
    v_exp_f32 v18, v18
    s_nop 0
    v_add_f32 v18, 1.0, v18
    v_rcp_f32 v18, v18
    s_nop 0
    v_mul_f32 v114, v114, v18
    v_cvt_pk_bf16_f32 v114, v114, v114
    v_lshlrev_b32 v114, 16, v114
    v_mul_f32 v18, 0xbfb8aa3b, v115
    v_exp_f32 v18, v18
    s_nop 0
    v_add_f32 v18, 1.0, v18
    v_rcp_f32 v18, v18
    s_nop 0
    v_mul_f32 v115, v115, v18
    v_cvt_pk_bf16_f32 v115, v115, v115
    v_lshlrev_b32 v115, 16, v115
    v_mul_f32 v18, 0xbfb8aa3b, v116
    v_exp_f32 v18, v18
    s_nop 0
    v_add_f32 v18, 1.0, v18
    v_rcp_f32 v18, v18
    s_nop 0
    v_mul_f32 v116, v116, v18
    v_cvt_pk_bf16_f32 v116, v116, v116
    v_lshlrev_b32 v116, 16, v116
    v_mul_f32 v18, 0xbfb8aa3b, v117
    v_exp_f32 v18, v18
    s_nop 0
    v_add_f32 v18, 1.0, v18
    v_rcp_f32 v18, v18
    s_nop 0
    v_mul_f32 v117, v117, v18
    v_cvt_pk_bf16_f32 v117, v117, v117
    v_lshlrev_b32 v117, 16, v117
    v_mul_f32 v18, 0xbfb8aa3b, v118
    v_exp_f32 v18, v18
    s_nop 0
    v_add_f32 v18, 1.0, v18
    v_rcp_f32 v18, v18
    s_nop 0
    v_mul_f32 v118, v118, v18
    v_cvt_pk_bf16_f32 v118, v118, v118
    v_lshlrev_b32 v118, 16, v118
    v_mul_f32 v18, 0xbfb8aa3b, v119
    v_exp_f32 v18, v18
    s_nop 0
    v_add_f32 v18, 1.0, v18
    v_rcp_f32 v18, v18
    s_nop 0
    v_mul_f32 v119, v119, v18
    v_cvt_pk_bf16_f32 v119, v119, v119
    v_lshlrev_b32 v119, 16, v119
    v_mul_f32 v18, 0xbfb8aa3b, v120
    v_exp_f32 v18, v18
    s_nop 0
    v_add_f32 v18, 1.0, v18
    v_rcp_f32 v18, v18
    s_nop 0
    v_mul_f32 v120, v120, v18
    v_cvt_pk_bf16_f32 v120, v120, v120
    v_lshlrev_b32 v120, 16, v120
    v_mul_f32 v18, 0xbfb8aa3b, v121
    v_exp_f32 v18, v18
    s_nop 0
    v_add_f32 v18, 1.0, v18
    v_rcp_f32 v18, v18
    s_nop 0
    v_mul_f32 v121, v121, v18
    v_cvt_pk_bf16_f32 v121, v121, v121
    v_lshlrev_b32 v121, 16, v121
    v_mul_f32 v18, 0xbfb8aa3b, v122
    v_exp_f32 v18, v18
    s_nop 0
    v_add_f32 v18, 1.0, v18
    v_rcp_f32 v18, v18
    s_nop 0
    v_mul_f32 v122, v122, v18
    v_cvt_pk_bf16_f32 v122, v122, v122
    v_lshlrev_b32 v122, 16, v122
    v_mul_f32 v18, 0xbfb8aa3b, v123
    v_exp_f32 v18, v18
    s_nop 0
    v_add_f32 v18, 1.0, v18
    v_rcp_f32 v18, v18
    s_nop 0
    v_mul_f32 v123, v123, v18
    v_cvt_pk_bf16_f32 v123, v123, v123
    v_lshlrev_b32 v123, 16, v123
    v_mul_f32 v18, 0xbfb8aa3b, v124
    v_exp_f32 v18, v18
    s_nop 0
    v_add_f32 v18, 1.0, v18
    v_rcp_f32 v18, v18
    s_nop 0
    v_mul_f32 v124, v124, v18
    v_cvt_pk_bf16_f32 v124, v124, v124
    v_lshlrev_b32 v124, 16, v124
    v_mul_f32 v18, 0xbfb8aa3b, v125
    v_exp_f32 v18, v18
    s_nop 0
    v_add_f32 v18, 1.0, v18
    v_rcp_f32 v18, v18
    s_nop 0
    v_mul_f32 v125, v125, v18
    v_cvt_pk_bf16_f32 v125, v125, v125
    v_lshlrev_b32 v125, 16, v125
    v_mul_f32 v18, 0xbfb8aa3b, v126
    v_exp_f32 v18, v18
    s_nop 0
    v_add_f32 v18, 1.0, v18
    v_rcp_f32 v18, v18
    s_nop 0
    v_mul_f32 v126, v126, v18
    v_cvt_pk_bf16_f32 v126, v126, v126
    v_lshlrev_b32 v126, 16, v126
    v_mul_f32 v18, 0xbfb8aa3b, v127
    v_exp_f32 v18, v18
    s_nop 0
    v_add_f32 v18, 1.0, v18
    v_rcp_f32 v18, v18
    s_nop 0
    v_mul_f32 v127, v127, v18
    v_cvt_pk_bf16_f32 v127, v127, v127
    v_lshlrev_b32 v127, 16, v127
    v_mov_b32 v96, 0
    v_mov_b32 v97, 0
    v_mov_b32 v98, 0
    v_mov_b32 v99, 0
    v_mov_b32 v100, 0
    v_mov_b32 v101, 0
    v_mov_b32 v102, 0
    v_mov_b32 v103, 0
    s_waitcnt vmcnt(27)
    v_lshlrev_b32 v18, 16, v32
    v_and_b32 v19, 0xffff0000, v32
    v_fmac_f32 v96, v18, v112
    v_fmac_f32 v97, v19, v112
    v_lshlrev_b32 v18, 16, v33
    v_and_b32 v19, 0xffff0000, v33
    v_fmac_f32 v98, v18, v112
    v_fmac_f32 v99, v19, v112
    v_lshlrev_b32 v18, 16, v34
    v_and_b32 v19, 0xffff0000, v34
    v_fmac_f32 v100, v18, v112
    v_fmac_f32 v101, v19, v112
    v_lshlrev_b32 v18, 16, v35
    v_and_b32 v19, 0xffff0000, v35
    v_fmac_f32 v102, v18, v112
    v_fmac_f32 v103, v19, v112
    s_waitcnt vmcnt(26)
    v_lshlrev_b32 v18, 16, v36
    v_and_b32 v19, 0xffff0000, v36
    v_fmac_f32 v96, v18, v113
    v_fmac_f32 v97, v19, v113
    v_lshlrev_b32 v18, 16, v37
    v_and_b32 v19, 0xffff0000, v37
    v_fmac_f32 v98, v18, v113
    v_fmac_f32 v99, v19, v113
    v_lshlrev_b32 v18, 16, v38
    v_and_b32 v19, 0xffff0000, v38
    v_fmac_f32 v100, v18, v113
    v_fmac_f32 v101, v19, v113
    v_lshlrev_b32 v18, 16, v39
    v_and_b32 v19, 0xffff0000, v39
    v_fmac_f32 v102, v18, v113
    v_fmac_f32 v103, v19, v113
    s_waitcnt vmcnt(25)
    v_lshlrev_b32 v18, 16, v40
    v_and_b32 v19, 0xffff0000, v40
    v_fmac_f32 v96, v18, v114
    v_fmac_f32 v97, v19, v114
    v_lshlrev_b32 v18, 16, v41
    v_and_b32 v19, 0xffff0000, v41
    v_fmac_f32 v98, v18, v114
    v_fmac_f32 v99, v19, v114
    v_lshlrev_b32 v18, 16, v42
    v_and_b32 v19, 0xffff0000, v42
    v_fmac_f32 v100, v18, v114
    v_fmac_f32 v101, v19, v114
    v_lshlrev_b32 v18, 16, v43
    v_and_b32 v19, 0xffff0000, v43
    v_fmac_f32 v102, v18, v114
    v_fmac_f32 v103, v19, v114
    s_waitcnt vmcnt(24)
    v_lshlrev_b32 v18, 16, v44
    v_and_b32 v19, 0xffff0000, v44
    v_fmac_f32 v96, v18, v115
    v_fmac_f32 v97, v19, v115
    v_lshlrev_b32 v18, 16, v45
    v_and_b32 v19, 0xffff0000, v45
    v_fmac_f32 v98, v18, v115
    v_fmac_f32 v99, v19, v115
    v_lshlrev_b32 v18, 16, v46
    v_and_b32 v19, 0xffff0000, v46
    v_fmac_f32 v100, v18, v115
    v_fmac_f32 v101, v19, v115
    v_lshlrev_b32 v18, 16, v47
    v_and_b32 v19, 0xffff0000, v47
    v_fmac_f32 v102, v18, v115
    v_fmac_f32 v103, v19, v115
    s_waitcnt vmcnt(23)
    v_lshlrev_b32 v18, 16, v48
    v_and_b32 v19, 0xffff0000, v48
    v_fmac_f32 v96, v18, v116
    v_fmac_f32 v97, v19, v116
    v_lshlrev_b32 v18, 16, v49
    v_and_b32 v19, 0xffff0000, v49
    v_fmac_f32 v98, v18, v116
    v_fmac_f32 v99, v19, v116
    v_lshlrev_b32 v18, 16, v50
    v_and_b32 v19, 0xffff0000, v50
    v_fmac_f32 v100, v18, v116
    v_fmac_f32 v101, v19, v116
    v_lshlrev_b32 v18, 16, v51
    v_and_b32 v19, 0xffff0000, v51
    v_fmac_f32 v102, v18, v116
    v_fmac_f32 v103, v19, v116
    s_waitcnt vmcnt(22)
    v_lshlrev_b32 v18, 16, v52
    v_and_b32 v19, 0xffff0000, v52
    v_fmac_f32 v96, v18, v117
    v_fmac_f32 v97, v19, v117
    v_lshlrev_b32 v18, 16, v53
    v_and_b32 v19, 0xffff0000, v53
    v_fmac_f32 v98, v18, v117
    v_fmac_f32 v99, v19, v117
    v_lshlrev_b32 v18, 16, v54
    v_and_b32 v19, 0xffff0000, v54
    v_fmac_f32 v100, v18, v117
    v_fmac_f32 v101, v19, v117
    v_lshlrev_b32 v18, 16, v55
    v_and_b32 v19, 0xffff0000, v55
    v_fmac_f32 v102, v18, v117
    v_fmac_f32 v103, v19, v117
    s_waitcnt vmcnt(21)
    v_lshlrev_b32 v18, 16, v56
    v_and_b32 v19, 0xffff0000, v56
    v_fmac_f32 v96, v18, v118
    v_fmac_f32 v97, v19, v118
    v_lshlrev_b32 v18, 16, v57
    v_and_b32 v19, 0xffff0000, v57
    v_fmac_f32 v98, v18, v118
    v_fmac_f32 v99, v19, v118
    v_lshlrev_b32 v18, 16, v58
    v_and_b32 v19, 0xffff0000, v58
    v_fmac_f32 v100, v18, v118
    v_fmac_f32 v101, v19, v118
    v_lshlrev_b32 v18, 16, v59
    v_and_b32 v19, 0xffff0000, v59
    v_fmac_f32 v102, v18, v118
    v_fmac_f32 v103, v19, v118
    s_waitcnt vmcnt(20)
    v_lshlrev_b32 v18, 16, v60
    v_and_b32 v19, 0xffff0000, v60
    v_fmac_f32 v96, v18, v119
    v_fmac_f32 v97, v19, v119
    v_lshlrev_b32 v18, 16, v61
    v_and_b32 v19, 0xffff0000, v61
    v_fmac_f32 v98, v18, v119
    v_fmac_f32 v99, v19, v119
    v_lshlrev_b32 v18, 16, v62
    v_and_b32 v19, 0xffff0000, v62
    v_fmac_f32 v100, v18, v119
    v_fmac_f32 v101, v19, v119
    v_lshlrev_b32 v18, 16, v63
    v_and_b32 v19, 0xffff0000, v63
    v_fmac_f32 v102, v18, v119
    v_fmac_f32 v103, v19, v119
    s_waitcnt vmcnt(19)
    v_lshlrev_b32 v18, 16, v64
    v_and_b32 v19, 0xffff0000, v64
    v_fmac_f32 v96, v18, v120
    v_fmac_f32 v97, v19, v120
    v_lshlrev_b32 v18, 16, v65
    v_and_b32 v19, 0xffff0000, v65
    v_fmac_f32 v98, v18, v120
    v_fmac_f32 v99, v19, v120
    v_lshlrev_b32 v18, 16, v66
    v_and_b32 v19, 0xffff0000, v66
    v_fmac_f32 v100, v18, v120
    v_fmac_f32 v101, v19, v120
    v_lshlrev_b32 v18, 16, v67
    v_and_b32 v19, 0xffff0000, v67
    v_fmac_f32 v102, v18, v120
    v_fmac_f32 v103, v19, v120
    s_waitcnt vmcnt(18)
    v_lshlrev_b32 v18, 16, v68
    v_and_b32 v19, 0xffff0000, v68
    v_fmac_f32 v96, v18, v121
    v_fmac_f32 v97, v19, v121
    v_lshlrev_b32 v18, 16, v69
    v_and_b32 v19, 0xffff0000, v69
    v_fmac_f32 v98, v18, v121
    v_fmac_f32 v99, v19, v121
    v_lshlrev_b32 v18, 16, v70
    v_and_b32 v19, 0xffff0000, v70
    v_fmac_f32 v100, v18, v121
    v_fmac_f32 v101, v19, v121
    v_lshlrev_b32 v18, 16, v71
    v_and_b32 v19, 0xffff0000, v71
    v_fmac_f32 v102, v18, v121
    v_fmac_f32 v103, v19, v121
    s_waitcnt vmcnt(17)
    v_lshlrev_b32 v18, 16, v72
    v_and_b32 v19, 0xffff0000, v72
    v_fmac_f32 v96, v18, v122
    v_fmac_f32 v97, v19, v122
    v_lshlrev_b32 v18, 16, v73
    v_and_b32 v19, 0xffff0000, v73
    v_fmac_f32 v98, v18, v122
    v_fmac_f32 v99, v19, v122
    v_lshlrev_b32 v18, 16, v74
    v_and_b32 v19, 0xffff0000, v74
    v_fmac_f32 v100, v18, v122
    v_fmac_f32 v101, v19, v122
    v_lshlrev_b32 v18, 16, v75
    v_and_b32 v19, 0xffff0000, v75
    v_fmac_f32 v102, v18, v122
    v_fmac_f32 v103, v19, v122
    s_waitcnt vmcnt(16)
    v_lshlrev_b32 v18, 16, v76
    v_and_b32 v19, 0xffff0000, v76
    v_fmac_f32 v96, v18, v123
    v_fmac_f32 v97, v19, v123
    v_lshlrev_b32 v18, 16, v77
    v_and_b32 v19, 0xffff0000, v77
    v_fmac_f32 v98, v18, v123
    v_fmac_f32 v99, v19, v123
    v_lshlrev_b32 v18, 16, v78
    v_and_b32 v19, 0xffff0000, v78
    v_fmac_f32 v100, v18, v123
    v_fmac_f32 v101, v19, v123
    v_lshlrev_b32 v18, 16, v79
    v_and_b32 v19, 0xffff0000, v79
    v_fmac_f32 v102, v18, v123
    v_fmac_f32 v103, v19, v123
    s_waitcnt vmcnt(15)
    v_lshlrev_b32 v18, 16, v80
    v_and_b32 v19, 0xffff0000, v80
    v_fmac_f32 v96, v18, v124
    v_fmac_f32 v97, v19, v124
    v_lshlrev_b32 v18, 16, v81
    v_and_b32 v19, 0xffff0000, v81
    v_fmac_f32 v98, v18, v124
    v_fmac_f32 v99, v19, v124
    v_lshlrev_b32 v18, 16, v82
    v_and_b32 v19, 0xffff0000, v82
    v_fmac_f32 v100, v18, v124
    v_fmac_f32 v101, v19, v124
    v_lshlrev_b32 v18, 16, v83
    v_and_b32 v19, 0xffff0000, v83
    v_fmac_f32 v102, v18, v124
    v_fmac_f32 v103, v19, v124
    s_waitcnt vmcnt(14)
    v_lshlrev_b32 v18, 16, v84
    v_and_b32 v19, 0xffff0000, v84
    v_fmac_f32 v96, v18, v125
    v_fmac_f32 v97, v19, v125
    v_lshlrev_b32 v18, 16, v85
    v_and_b32 v19, 0xffff0000, v85
    v_fmac_f32 v98, v18, v125
    v_fmac_f32 v99, v19, v125
    v_lshlrev_b32 v18, 16, v86
    v_and_b32 v19, 0xffff0000, v86
    v_fmac_f32 v100, v18, v125
    v_fmac_f32 v101, v19, v125
    v_lshlrev_b32 v18, 16, v87
    v_and_b32 v19, 0xffff0000, v87
    v_fmac_f32 v102, v18, v125
    v_fmac_f32 v103, v19, v125
    s_waitcnt vmcnt(13)
    v_lshlrev_b32 v18, 16, v88
    v_and_b32 v19, 0xffff0000, v88
    v_fmac_f32 v96, v18, v126
    v_fmac_f32 v97, v19, v126
    v_lshlrev_b32 v18, 16, v89
    v_and_b32 v19, 0xffff0000, v89
    v_fmac_f32 v98, v18, v126
    v_fmac_f32 v99, v19, v126
    v_lshlrev_b32 v18, 16, v90
    v_and_b32 v19, 0xffff0000, v90
    v_fmac_f32 v100, v18, v126
    v_fmac_f32 v101, v19, v126
    v_lshlrev_b32 v18, 16, v91
    v_and_b32 v19, 0xffff0000, v91
    v_fmac_f32 v102, v18, v126
    v_fmac_f32 v103, v19, v126
    s_waitcnt vmcnt(12)
    v_lshlrev_b32 v18, 16, v92
    v_and_b32 v19, 0xffff0000, v92
    v_fmac_f32 v96, v18, v127
    v_fmac_f32 v97, v19, v127
    v_lshlrev_b32 v18, 16, v93
    v_and_b32 v19, 0xffff0000, v93
    v_fmac_f32 v98, v18, v127
    v_fmac_f32 v99, v19, v127
    v_lshlrev_b32 v18, 16, v94
    v_and_b32 v19, 0xffff0000, v94
    v_fmac_f32 v100, v18, v127
    v_fmac_f32 v101, v19, v127
    v_lshlrev_b32 v18, 16, v95
    v_and_b32 v19, 0xffff0000, v95
    v_fmac_f32 v102, v18, v127
    v_fmac_f32 v103, v19, v127
    v_lshlrev_b32 v16, 5, v0
    ds_write_b128 v16, v[96:99]
    ds_write_b128 v16, v[100:103] offset:16
    s_waitcnt lgkmcnt(0)
    s_barrier
    s_cmp_lg_u32 s44, 0
    s_cbranch_scc1 L_mod_fin_101
    v_mov_b32 v18, 0
    ds_read_b32 v32, v12 offset:0
    ds_read_b32 v33, v12 offset:256
    ds_read_b32 v34, v12 offset:512
    ds_read_b32 v35, v12 offset:768
    ds_read_b32 v36, v12 offset:1024
    ds_read_b32 v37, v12 offset:1280
    ds_read_b32 v38, v12 offset:1536
    ds_read_b32 v39, v12 offset:1792
    ds_read_b32 v40, v12 offset:2048
    ds_read_b32 v41, v12 offset:2304
    ds_read_b32 v42, v12 offset:2560
    ds_read_b32 v43, v12 offset:2816
    ds_read_b32 v44, v12 offset:3072
    ds_read_b32 v45, v12 offset:3328
    ds_read_b32 v46, v12 offset:3584
    ds_read_b32 v47, v12 offset:3840
    s_waitcnt lgkmcnt(0)
    v_add_f32 v18, v18, v32
    v_add_f32 v18, v18, v33
    v_add_f32 v18, v18, v34
    v_add_f32 v18, v18, v35
    v_add_f32 v18, v18, v36
    v_add_f32 v18, v18, v37
    v_add_f32 v18, v18, v38
    v_add_f32 v18, v18, v39
    v_add_f32 v18, v18, v40
    v_add_f32 v18, v18, v41
    v_add_f32 v18, v18, v42
    v_add_f32 v18, v18, v43
    v_add_f32 v18, v18, v44
    v_add_f32 v18, v18, v45
    v_add_f32 v18, v18, v46
    v_add_f32 v18, v18, v47
    ds_read_b32 v32, v12 offset:4096
    ds_read_b32 v33, v12 offset:4352
    ds_read_b32 v34, v12 offset:4608
    ds_read_b32 v35, v12 offset:4864
    ds_read_b32 v36, v12 offset:5120
    ds_read_b32 v37, v12 offset:5376
    ds_read_b32 v38, v12 offset:5632
    ds_read_b32 v39, v12 offset:5888
    ds_read_b32 v40, v12 offset:6144
    ds_read_b32 v41, v12 offset:6400
    ds_read_b32 v42, v12 offset:6656
    ds_read_b32 v43, v12 offset:6912
    ds_read_b32 v44, v12 offset:7168
    ds_read_b32 v45, v12 offset:7424
    ds_read_b32 v46, v12 offset:7680
    ds_read_b32 v47, v12 offset:7936
    s_waitcnt lgkmcnt(0)
    v_add_f32 v18, v18, v32
    v_add_f32 v18, v18, v33
    v_add_f32 v18, v18, v34
    v_add_f32 v18, v18, v35
    v_add_f32 v18, v18, v36
    v_add_f32 v18, v18, v37
    v_add_f32 v18, v18, v38
    v_add_f32 v18, v18, v39
    v_add_f32 v18, v18, v40
    v_add_f32 v18, v18, v41
    v_add_f32 v18, v18, v42
    v_add_f32 v18, v18, v43
    v_add_f32 v18, v18, v44
    v_add_f32 v18, v18, v45
    v_add_f32 v18, v18, v46
    v_add_f32 v18, v18, v47
    s_lshr_b32 s45, s39, 1
    s_lshl_b32 s45, s45, 8
    s_mul_i32 s46, s47, 24576
    s_add_u32 s45, s45, s46
    buffer_store_dword v18, v12, s[12:15], s45 offen sc1
L_mod_fin_101:
    s_waitcnt vmcnt(0)
    s_barrier
    s_cmp_lg_u32 s44, 0
    s_cbranch_scc1 L_cnt_102
    v_mov_b32 v30, 1
    v_mov_b32 v31, 128
    s_mov_b64 exec, 1
    buffer_atomic_add v30, v31, s[16:19], 0 offen sc1
    s_mov_b64 exec, -1
L_cnt_102:
    v_lshlrev_b32 v192, 16, v128
    v_and_b32 v193, 0xffff0000, v128
    v_lshlrev_b32 v194, 16, v129
    v_and_b32 v195, 0xffff0000, v129
    v_lshlrev_b32 v196, 16, v130
    v_and_b32 v197, 0xffff0000, v130
    v_lshlrev_b32 v198, 16, v131
    v_and_b32 v199, 0xffff0000, v131
    v_lshlrev_b32 v200, 16, v132
    v_and_b32 v201, 0xffff0000, v132
    v_lshlrev_b32 v202, 16, v133
    v_and_b32 v203, 0xffff0000, v133
    v_lshlrev_b32 v204, 16, v134
    v_and_b32 v205, 0xffff0000, v134
    v_lshlrev_b32 v206, 16, v135
    v_and_b32 v207, 0xffff0000, v135
    v_add_f32 v26, v192, v193
    v_add_f32 v26, v26, v194
    v_add_f32 v26, v26, v195
    v_add_f32 v26, v26, v196
    v_add_f32 v26, v26, v197
    v_add_f32 v26, v26, v198
    v_add_f32 v26, v26, v199
    v_add_f32 v26, v26, v200
    v_add_f32 v26, v26, v201
    v_add_f32 v26, v26, v202
    v_add_f32 v26, v26, v203
    v_add_f32 v26, v26, v204
    v_add_f32 v26, v26, v205
    v_add_f32 v26, v26, v206
    v_add_f32 v26, v26, v207
    s_nop 1
    v_add_f32_dpp v26, v26, v26 row_shr:1 row_mask:0xf bank_mask:0xf bound_ctrl:0
    s_nop 1
    v_add_f32_dpp v26, v26, v26 row_shr:2 row_mask:0xf bank_mask:0xf bound_ctrl:0
    s_nop 1
    v_add_f32_dpp v26, v26, v26 row_shr:4 row_mask:0xf bank_mask:0xf bound_ctrl:0
    s_nop 1
    v_add_f32_dpp v26, v26, v26 row_shr:8 row_mask:0xf bank_mask:0xf bound_ctrl:0
    s_nop 1
    v_add_f32_dpp v26, v26, v26 row_bcast:15 row_mask:0xa bank_mask:0xf
    s_nop 1
    v_add_f32_dpp v26, v26, v26 row_bcast:31 row_mask:0xc bank_mask:0xf
    s_nop 1
    v_readlane_b32 s66, v26, 63
    s_nop 1
    v_mov_b32 v27, s66
    v_mul_f32 v27, 0x3a800000, v27
    v_mov_b32 v26, 0
    v_sub_f32 v28, v192, v27
    v_fmac_f32 v26, v28, v28
    v_sub_f32 v28, v193, v27
    v_fmac_f32 v26, v28, v28
    v_sub_f32 v28, v194, v27
    v_fmac_f32 v26, v28, v28
    v_sub_f32 v28, v195, v27
    v_fmac_f32 v26, v28, v28
    v_sub_f32 v28, v196, v27
    v_fmac_f32 v26, v28, v28
    v_sub_f32 v28, v197, v27
    v_fmac_f32 v26, v28, v28
    v_sub_f32 v28, v198, v27
    v_fmac_f32 v26, v28, v28
    v_sub_f32 v28, v199, v27
    v_fmac_f32 v26, v28, v28
    v_sub_f32 v28, v200, v27
    v_fmac_f32 v26, v28, v28
    v_sub_f32 v28, v201, v27
    v_fmac_f32 v26, v28, v28
    v_sub_f32 v28, v202, v27
    v_fmac_f32 v26, v28, v28
    v_sub_f32 v28, v203, v27
    v_fmac_f32 v26, v28, v28
    v_sub_f32 v28, v204, v27
    v_fmac_f32 v26, v28, v28
    v_sub_f32 v28, v205, v27
    v_fmac_f32 v26, v28, v28
    v_sub_f32 v28, v206, v27
    v_fmac_f32 v26, v28, v28
    v_sub_f32 v28, v207, v27
    v_fmac_f32 v26, v28, v28
    s_nop 1
    v_add_f32_dpp v26, v26, v26 row_shr:1 row_mask:0xf bank_mask:0xf bound_ctrl:0
    s_nop 1
    v_add_f32_dpp v26, v26, v26 row_shr:2 row_mask:0xf bank_mask:0xf bound_ctrl:0
    s_nop 1
    v_add_f32_dpp v26, v26, v26 row_shr:4 row_mask:0xf bank_mask:0xf bound_ctrl:0
    s_nop 1
    v_add_f32_dpp v26, v26, v26 row_shr:8 row_mask:0xf bank_mask:0xf bound_ctrl:0
    s_nop 1
    v_add_f32_dpp v26, v26, v26 row_bcast:15 row_mask:0xa bank_mask:0xf
    s_nop 1
    v_add_f32_dpp v26, v26, v26 row_bcast:31 row_mask:0xc bank_mask:0xf
    s_nop 1
    v_readlane_b32 s66, v26, 63
    s_nop 1
    v_mov_b32 v26, s66
    v_mul_f32 v26, 0x3a800000, v26
    v_cvt_pk_bf16_f32 v26, v26, v26
    v_lshlrev_b32 v26, 16, v26
    v_cvt_pk_bf16_f32 v27, v27, v27
    v_lshlrev_b32 v27, 16, v27
    v_add_f32 v26, 0x3727c5ac, v26
    v_cvt_pk_bf16_f32 v26, v26, v26
    v_lshlrev_b32 v26, 16, v26
    v_sqrt_f32 v26, v26
    s_nop 0
    v_cvt_pk_bf16_f32 v26, v26, v26
    v_lshlrev_b32 v26, 16, v26
    v_rcp_f32 v26, v26
    s_nop 0
    v_sub_f32 v192, v192, v27
    v_cvt_pk_bf16_f32 v192, v192, v192
    v_lshlrev_b32 v192, 16, v192
    v_mul_f32 v192, v192, v26
    v_cvt_pk_bf16_f32 v192, v192, v192
    v_lshlrev_b32 v192, 16, v192
    v_sub_f32 v193, v193, v27
    v_cvt_pk_bf16_f32 v193, v193, v193
    v_lshlrev_b32 v193, 16, v193
    v_mul_f32 v193, v193, v26
    v_cvt_pk_bf16_f32 v193, v193, v193
    v_lshlrev_b32 v193, 16, v193
    v_sub_f32 v194, v194, v27
    v_cvt_pk_bf16_f32 v194, v194, v194
    v_lshlrev_b32 v194, 16, v194
    v_mul_f32 v194, v194, v26
    v_cvt_pk_bf16_f32 v194, v194, v194
    v_lshlrev_b32 v194, 16, v194
    v_sub_f32 v195, v195, v27
    v_cvt_pk_bf16_f32 v195, v195, v195
    v_lshlrev_b32 v195, 16, v195
    v_mul_f32 v195, v195, v26
    v_cvt_pk_bf16_f32 v195, v195, v195
    v_lshlrev_b32 v195, 16, v195
    v_sub_f32 v196, v196, v27
    v_cvt_pk_bf16_f32 v196, v196, v196
    v_lshlrev_b32 v196, 16, v196
    v_mul_f32 v196, v196, v26
    v_cvt_pk_bf16_f32 v196, v196, v196
    v_lshlrev_b32 v196, 16, v196
    v_sub_f32 v197, v197, v27
    v_cvt_pk_bf16_f32 v197, v197, v197
    v_lshlrev_b32 v197, 16, v197
    v_mul_f32 v197, v197, v26
    v_cvt_pk_bf16_f32 v197, v197, v197
    v_lshlrev_b32 v197, 16, v197
    v_sub_f32 v198, v198, v27
    v_cvt_pk_bf16_f32 v198, v198, v198
    v_lshlrev_b32 v198, 16, v198
    v_mul_f32 v198, v198, v26
    v_cvt_pk_bf16_f32 v198, v198, v198
    v_lshlrev_b32 v198, 16, v198
    v_sub_f32 v199, v199, v27
    v_cvt_pk_bf16_f32 v199, v199, v199
    v_lshlrev_b32 v199, 16, v199
    v_mul_f32 v199, v199, v26
    v_cvt_pk_bf16_f32 v199, v199, v199
    v_lshlrev_b32 v199, 16, v199
    v_sub_f32 v200, v200, v27
    v_cvt_pk_bf16_f32 v200, v200, v200
    v_lshlrev_b32 v200, 16, v200
    v_mul_f32 v200, v200, v26
    v_cvt_pk_bf16_f32 v200, v200, v200
    v_lshlrev_b32 v200, 16, v200
    v_sub_f32 v201, v201, v27
    v_cvt_pk_bf16_f32 v201, v201, v201
    v_lshlrev_b32 v201, 16, v201
    v_mul_f32 v201, v201, v26
    v_cvt_pk_bf16_f32 v201, v201, v201
    v_lshlrev_b32 v201, 16, v201
    v_sub_f32 v202, v202, v27
    v_cvt_pk_bf16_f32 v202, v202, v202
    v_lshlrev_b32 v202, 16, v202
    v_mul_f32 v202, v202, v26
    v_cvt_pk_bf16_f32 v202, v202, v202
    v_lshlrev_b32 v202, 16, v202
    v_sub_f32 v203, v203, v27
    v_cvt_pk_bf16_f32 v203, v203, v203
    v_lshlrev_b32 v203, 16, v203
    v_mul_f32 v203, v203, v26
    v_cvt_pk_bf16_f32 v203, v203, v203
    v_lshlrev_b32 v203, 16, v203
    v_sub_f32 v204, v204, v27
    v_cvt_pk_bf16_f32 v204, v204, v204
    v_lshlrev_b32 v204, 16, v204
    v_mul_f32 v204, v204, v26
    v_cvt_pk_bf16_f32 v204, v204, v204
    v_lshlrev_b32 v204, 16, v204
    v_sub_f32 v205, v205, v27
    v_cvt_pk_bf16_f32 v205, v205, v205
    v_lshlrev_b32 v205, 16, v205
    v_mul_f32 v205, v205, v26
    v_cvt_pk_bf16_f32 v205, v205, v205
    v_lshlrev_b32 v205, 16, v205
    v_sub_f32 v206, v206, v27
    v_cvt_pk_bf16_f32 v206, v206, v206
    v_lshlrev_b32 v206, 16, v206
    v_mul_f32 v206, v206, v26
    v_cvt_pk_bf16_f32 v206, v206, v206
    v_lshlrev_b32 v206, 16, v206
    v_sub_f32 v207, v207, v27
    v_cvt_pk_bf16_f32 v207, v207, v207
    v_lshlrev_b32 v207, 16, v207
    v_mul_f32 v207, v207, v26
    v_cvt_pk_bf16_f32 v207, v207, v207
    v_lshlrev_b32 v207, 16, v207
    v_lshlrev_b32 v208, 16, v136
    v_and_b32 v209, 0xffff0000, v136
    v_lshlrev_b32 v210, 16, v137
    v_and_b32 v211, 0xffff0000, v137
    v_lshlrev_b32 v212, 16, v138
    v_and_b32 v213, 0xffff0000, v138
    v_lshlrev_b32 v214, 16, v139
    v_and_b32 v215, 0xffff0000, v139
    v_lshlrev_b32 v216, 16, v140
    v_and_b32 v217, 0xffff0000, v140
    v_lshlrev_b32 v218, 16, v141
    v_and_b32 v219, 0xffff0000, v141
    v_lshlrev_b32 v220, 16, v142
    v_and_b32 v221, 0xffff0000, v142
    v_lshlrev_b32 v222, 16, v143
    v_and_b32 v223, 0xffff0000, v143
    v_add_f32 v26, v208, v209
    v_add_f32 v26, v26, v210
    v_add_f32 v26, v26, v211
    v_add_f32 v26, v26, v212
    v_add_f32 v26, v26, v213
    v_add_f32 v26, v26, v214
    v_add_f32 v26, v26, v215
    v_add_f32 v26, v26, v216
    v_add_f32 v26, v26, v217
    v_add_f32 v26, v26, v218
    v_add_f32 v26, v26, v219
    v_add_f32 v26, v26, v220
    v_add_f32 v26, v26, v221
    v_add_f32 v26, v26, v222
    v_add_f32 v26, v26, v223
    s_nop 1
    v_add_f32_dpp v26, v26, v26 row_shr:1 row_mask:0xf bank_mask:0xf bound_ctrl:0
    s_nop 1
    v_add_f32_dpp v26, v26, v26 row_shr:2 row_mask:0xf bank_mask:0xf bound_ctrl:0
    s_nop 1
    v_add_f32_dpp v26, v26, v26 row_shr:4 row_mask:0xf bank_mask:0xf bound_ctrl:0
    s_nop 1
    v_add_f32_dpp v26, v26, v26 row_shr:8 row_mask:0xf bank_mask:0xf bound_ctrl:0
    s_nop 1
    v_add_f32_dpp v26, v26, v26 row_bcast:15 row_mask:0xa bank_mask:0xf
    s_nop 1
    v_add_f32_dpp v26, v26, v26 row_bcast:31 row_mask:0xc bank_mask:0xf
    s_nop 1
    v_readlane_b32 s66, v26, 63
    s_nop 1
    v_mov_b32 v27, s66
    v_mul_f32 v27, 0x3a800000, v27
    v_mov_b32 v26, 0
    v_sub_f32 v28, v208, v27
    v_fmac_f32 v26, v28, v28
    v_sub_f32 v28, v209, v27
    v_fmac_f32 v26, v28, v28
    v_sub_f32 v28, v210, v27
    v_fmac_f32 v26, v28, v28
    v_sub_f32 v28, v211, v27
    v_fmac_f32 v26, v28, v28
    v_sub_f32 v28, v212, v27
    v_fmac_f32 v26, v28, v28
    v_sub_f32 v28, v213, v27
    v_fmac_f32 v26, v28, v28
    v_sub_f32 v28, v214, v27
    v_fmac_f32 v26, v28, v28
    v_sub_f32 v28, v215, v27
    v_fmac_f32 v26, v28, v28
    v_sub_f32 v28, v216, v27
    v_fmac_f32 v26, v28, v28
    v_sub_f32 v28, v217, v27
    v_fmac_f32 v26, v28, v28
    v_sub_f32 v28, v218, v27
    v_fmac_f32 v26, v28, v28
    v_sub_f32 v28, v219, v27
    v_fmac_f32 v26, v28, v28
    v_sub_f32 v28, v220, v27
    v_fmac_f32 v26, v28, v28
    v_sub_f32 v28, v221, v27
    v_fmac_f32 v26, v28, v28
    v_sub_f32 v28, v222, v27
    v_fmac_f32 v26, v28, v28
    v_sub_f32 v28, v223, v27
    v_fmac_f32 v26, v28, v28
    s_nop 1
    v_add_f32_dpp v26, v26, v26 row_shr:1 row_mask:0xf bank_mask:0xf bound_ctrl:0
    s_nop 1
    v_add_f32_dpp v26, v26, v26 row_shr:2 row_mask:0xf bank_mask:0xf bound_ctrl:0
    s_nop 1
    v_add_f32_dpp v26, v26, v26 row_shr:4 row_mask:0xf bank_mask:0xf bound_ctrl:0
    s_nop 1
    v_add_f32_dpp v26, v26, v26 row_shr:8 row_mask:0xf bank_mask:0xf bound_ctrl:0
    s_nop 1
    v_add_f32_dpp v26, v26, v26 row_bcast:15 row_mask:0xa bank_mask:0xf
    s_nop 1
    v_add_f32_dpp v26, v26, v26 row_bcast:31 row_mask:0xc bank_mask:0xf
    s_nop 1
    v_readlane_b32 s66, v26, 63
    s_nop 1
    v_mov_b32 v26, s66
    v_mul_f32 v26, 0x3a800000, v26
    v_cvt_pk_bf16_f32 v26, v26, v26
    v_lshlrev_b32 v26, 16, v26
    v_cvt_pk_bf16_f32 v27, v27, v27
    v_lshlrev_b32 v27, 16, v27
    v_add_f32 v26, 0x3727c5ac, v26
    v_cvt_pk_bf16_f32 v26, v26, v26
    v_lshlrev_b32 v26, 16, v26
    v_sqrt_f32 v26, v26
    s_nop 0
    v_cvt_pk_bf16_f32 v26, v26, v26
    v_lshlrev_b32 v26, 16, v26
    v_rcp_f32 v26, v26
    s_nop 0
    v_sub_f32 v208, v208, v27
    v_cvt_pk_bf16_f32 v208, v208, v208
    v_lshlrev_b32 v208, 16, v208
    v_mul_f32 v208, v208, v26
    v_cvt_pk_bf16_f32 v208, v208, v208
    v_lshlrev_b32 v208, 16, v208
    v_sub_f32 v209, v209, v27
    v_cvt_pk_bf16_f32 v209, v209, v209
    v_lshlrev_b32 v209, 16, v209
    v_mul_f32 v209, v209, v26
    v_cvt_pk_bf16_f32 v209, v209, v209
    v_lshlrev_b32 v209, 16, v209
    v_sub_f32 v210, v210, v27
    v_cvt_pk_bf16_f32 v210, v210, v210
    v_lshlrev_b32 v210, 16, v210
    v_mul_f32 v210, v210, v26
    v_cvt_pk_bf16_f32 v210, v210, v210
    v_lshlrev_b32 v210, 16, v210
    v_sub_f32 v211, v211, v27
    v_cvt_pk_bf16_f32 v211, v211, v211
    v_lshlrev_b32 v211, 16, v211
    v_mul_f32 v211, v211, v26
    v_cvt_pk_bf16_f32 v211, v211, v211
    v_lshlrev_b32 v211, 16, v211
    v_sub_f32 v212, v212, v27
    v_cvt_pk_bf16_f32 v212, v212, v212
    v_lshlrev_b32 v212, 16, v212
    v_mul_f32 v212, v212, v26
    v_cvt_pk_bf16_f32 v212, v212, v212
    v_lshlrev_b32 v212, 16, v212
    v_sub_f32 v213, v213, v27
    v_cvt_pk_bf16_f32 v213, v213, v213
    v_lshlrev_b32 v213, 16, v213
    v_mul_f32 v213, v213, v26
    v_cvt_pk_bf16_f32 v213, v213, v213
    v_lshlrev_b32 v213, 16, v213
    v_sub_f32 v214, v214, v27
    v_cvt_pk_bf16_f32 v214, v214, v214
    v_lshlrev_b32 v214, 16, v214
    v_mul_f32 v214, v214, v26
    v_cvt_pk_bf16_f32 v214, v214, v214
    v_lshlrev_b32 v214, 16, v214
    v_sub_f32 v215, v215, v27
    v_cvt_pk_bf16_f32 v215, v215, v215
    v_lshlrev_b32 v215, 16, v215
    v_mul_f32 v215, v215, v26
    v_cvt_pk_bf16_f32 v215, v215, v215
    v_lshlrev_b32 v215, 16, v215
    v_sub_f32 v216, v216, v27
    v_cvt_pk_bf16_f32 v216, v216, v216
    v_lshlrev_b32 v216, 16, v216
    v_mul_f32 v216, v216, v26
    v_cvt_pk_bf16_f32 v216, v216, v216
    v_lshlrev_b32 v216, 16, v216
    v_sub_f32 v217, v217, v27
    v_cvt_pk_bf16_f32 v217, v217, v217
    v_lshlrev_b32 v217, 16, v217
    v_mul_f32 v217, v217, v26
    v_cvt_pk_bf16_f32 v217, v217, v217
    v_lshlrev_b32 v217, 16, v217
    v_sub_f32 v218, v218, v27
    v_cvt_pk_bf16_f32 v218, v218, v218
    v_lshlrev_b32 v218, 16, v218
    v_mul_f32 v218, v218, v26
    v_cvt_pk_bf16_f32 v218, v218, v218
    v_lshlrev_b32 v218, 16, v218
    v_sub_f32 v219, v219, v27
    v_cvt_pk_bf16_f32 v219, v219, v219
    v_lshlrev_b32 v219, 16, v219
    v_mul_f32 v219, v219, v26
    v_cvt_pk_bf16_f32 v219, v219, v219
    v_lshlrev_b32 v219, 16, v219
    v_sub_f32 v220, v220, v27
    v_cvt_pk_bf16_f32 v220, v220, v220
    v_lshlrev_b32 v220, 16, v220
    v_mul_f32 v220, v220, v26
    v_cvt_pk_bf16_f32 v220, v220, v220
    v_lshlrev_b32 v220, 16, v220
    v_sub_f32 v221, v221, v27
    v_cvt_pk_bf16_f32 v221, v221, v221
    v_lshlrev_b32 v221, 16, v221
    v_mul_f32 v221, v221, v26
    v_cvt_pk_bf16_f32 v221, v221, v221
    v_lshlrev_b32 v221, 16, v221
    v_sub_f32 v222, v222, v27
    v_cvt_pk_bf16_f32 v222, v222, v222
    v_lshlrev_b32 v222, 16, v222
    v_mul_f32 v222, v222, v26
    v_cvt_pk_bf16_f32 v222, v222, v222
    v_lshlrev_b32 v222, 16, v222
    v_sub_f32 v223, v223, v27
    v_cvt_pk_bf16_f32 v223, v223, v223
    v_lshlrev_b32 v223, 16, v223
    v_mul_f32 v223, v223, v26
    v_cvt_pk_bf16_f32 v223, v223, v223
    v_lshlrev_b32 v223, 16, v223
    s_cmp_lg_u32 s44, 0
    s_cbranch_scc1 L_pd_103
    v_mov_b32 v29, 8
    s_mov_b32 s46, 32
    s_mov_b64 exec, 1
    s_mov_b32 s70, 0
L_wp_104:
    buffer_load_dword v31, v29, s[16:19], 0 offen sc1
    s_add_u32 s70, s70, 1
    s_cmp_ge_u32 s70, 0x200000
    s_cbranch_scc1 L_w_done_98
L_wp_104_c:
    s_waitcnt vmcnt(0)
    v_cmp_gt_u32 vcc, s46, v31
    s_nop 1
    s_cbranch_vccz L_wp_104_ok
    s_sleep 3
    s_branch L_wp_104
L_wp_104_ok:
    s_mov_b64 exec, -1
L_pd_103:
    s_barrier
    s_cmp_lg_u32 s44, 0
    s_cbranch_scc1 L_pd_105
    v_mov_b32 v29, 128
    s_mov_b32 s46, 96
    s_mov_b64 exec, 1
    s_mov_b32 s70, 0
L_wp_106:
    buffer_load_dword v31, v29, s[16:19], 0 offen sc1
    s_add_u32 s70, s70, 1
    s_cmp_ge_u32 s70, 0x200000
    s_cbranch_scc1 L_w_done_98
L_wp_106_c:
    s_waitcnt vmcnt(0)
    v_cmp_gt_u32 vcc, s46, v31
    s_nop 1
    s_cbranch_vccz L_wp_106_ok
    s_sleep 1
    s_branch L_wp_106
L_wp_106_ok:
    s_mov_b64 exec, -1
L_pd_105:
    s_barrier
    v_lshlrev_b32 v29, 5, v1
    s_mov_b32 s45, 0
    buffer_load_dwordx4 v[96:99], v29, s[12:15], s45 offen offset:0 sc1
    buffer_load_dwordx4 v[100:103], v29, s[12:15], s45 offen offset:16 sc1
    buffer_load_dwordx4 v[104:107], v29, s[12:15], s45 offen offset:2048 sc1
    buffer_load_dwordx4 v[108:111], v29, s[12:15], s45 offen offset:2064 sc1
    s_mov_b32 s45, 24576
    buffer_load_dwordx4 v[32:35], v29, s[12:15], s45 offen offset:0 sc1
    buffer_load_dwordx4 v[36:39], v29, s[12:15], s45 offen offset:16 sc1
    buffer_load_dwordx4 v[40:43], v29, s[12:15], s45 offen offset:2048 sc1
    buffer_load_dwordx4 v[44:47], v29, s[12:15], s45 offen offset:2064 sc1
    s_mov_b32 s45, 4096
    buffer_load_dwordx4 v[112:115], v29, s[12:15], s45 offen offset:0 sc1
    buffer_load_dwordx4 v[116:119], v29, s[12:15], s45 offen offset:16 sc1
    buffer_load_dwordx4 v[120:123], v29, s[12:15], s45 offen offset:2048 sc1
    buffer_load_dwordx4 v[124:127], v29, s[12:15], s45 offen offset:2064 sc1
    s_mov_b32 s45, 28672
    buffer_load_dwordx4 v[48:51], v29, s[12:15], s45 offen offset:0 sc1
    buffer_load_dwordx4 v[52:55], v29, s[12:15], s45 offen offset:16 sc1
    buffer_load_dwordx4 v[56:59], v29, s[12:15], s45 offen offset:2048 sc1
    buffer_load_dwordx4 v[60:63], v29, s[12:15], s45 offen offset:2064 sc1
    s_waitcnt vmcnt(0)
    v_add_f32 v96, v96, v32
    v_cvt_pk_bf16_f32 v96, v96, v96
    v_lshlrev_b32 v96, 16, v96
    v_add_f32 v97, v97, v33
    v_cvt_pk_bf16_f32 v97, v97, v97
    v_lshlrev_b32 v97, 16, v97
    v_add_f32 v98, v98, v34
    v_cvt_pk_bf16_f32 v98, v98, v98
    v_lshlrev_b32 v98, 16, v98
    v_add_f32 v99, v99, v35
    v_cvt_pk_bf16_f32 v99, v99, v99
    v_lshlrev_b32 v99, 16, v99
    v_add_f32 v100, v100, v36
    v_cvt_pk_bf16_f32 v100, v100, v100
    v_lshlrev_b32 v100, 16, v100
    v_add_f32 v101, v101, v37
    v_cvt_pk_bf16_f32 v101, v101, v101
    v_lshlrev_b32 v101, 16, v101
    v_add_f32 v102, v102, v38
    v_cvt_pk_bf16_f32 v102, v102, v102
    v_lshlrev_b32 v102, 16, v102
    v_add_f32 v103, v103, v39
    v_cvt_pk_bf16_f32 v103, v103, v103
    v_lshlrev_b32 v103, 16, v103
    v_add_f32 v104, v104, v40
    v_cvt_pk_bf16_f32 v104, v104, v104
    v_lshlrev_b32 v104, 16, v104
    v_add_f32 v105, v105, v41
    v_cvt_pk_bf16_f32 v105, v105, v105
    v_lshlrev_b32 v105, 16, v105
    v_add_f32 v106, v106, v42
    v_cvt_pk_bf16_f32 v106, v106, v106
    v_lshlrev_b32 v106, 16, v106
    v_add_f32 v107, v107, v43
    v_cvt_pk_bf16_f32 v107, v107, v107
    v_lshlrev_b32 v107, 16, v107
    v_add_f32 v108, v108, v44
    v_cvt_pk_bf16_f32 v108, v108, v108
    v_lshlrev_b32 v108, 16, v108
    v_add_f32 v109, v109, v45
    v_cvt_pk_bf16_f32 v109, v109, v109
    v_lshlrev_b32 v109, 16, v109
    v_add_f32 v110, v110, v46
    v_cvt_pk_bf16_f32 v110, v110, v110
    v_lshlrev_b32 v110, 16, v110
    v_add_f32 v111, v111, v47
    v_cvt_pk_bf16_f32 v111, v111, v111
    v_lshlrev_b32 v111, 16, v111
    v_add_f32 v112, v112, v48
    v_cvt_pk_bf16_f32 v112, v112, v112
    v_lshlrev_b32 v112, 16, v112
    v_add_f32 v112, 1.0, v112
    v_cvt_pk_bf16_f32 v112, v112, v112
    v_lshlrev_b32 v112, 16, v112
    v_add_f32 v113, v113, v49
    v_cvt_pk_bf16_f32 v113, v113, v113
    v_lshlrev_b32 v113, 16, v113
    v_add_f32 v113, 1.0, v113
    v_cvt_pk_bf16_f32 v113, v113, v113
    v_lshlrev_b32 v113, 16, v113
    v_add_f32 v114, v114, v50
    v_cvt_pk_bf16_f32 v114, v114, v114
    v_lshlrev_b32 v114, 16, v114
    v_add_f32 v114, 1.0, v114
    v_cvt_pk_bf16_f32 v114, v114, v114
    v_lshlrev_b32 v114, 16, v114
    v_add_f32 v115, v115, v51
    v_cvt_pk_bf16_f32 v115, v115, v115
    v_lshlrev_b32 v115, 16, v115
    v_add_f32 v115, 1.0, v115
    v_cvt_pk_bf16_f32 v115, v115, v115
    v_lshlrev_b32 v115, 16, v115
    v_add_f32 v116, v116, v52
    v_cvt_pk_bf16_f32 v116, v116, v116
    v_lshlrev_b32 v116, 16, v116
    v_add_f32 v116, 1.0, v116
    v_cvt_pk_bf16_f32 v116, v116, v116
    v_lshlrev_b32 v116, 16, v116
    v_add_f32 v117, v117, v53
    v_cvt_pk_bf16_f32 v117, v117, v117
    v_lshlrev_b32 v117, 16, v117
    v_add_f32 v117, 1.0, v117
    v_cvt_pk_bf16_f32 v117, v117, v117
    v_lshlrev_b32 v117, 16, v117
    v_add_f32 v118, v118, v54
    v_cvt_pk_bf16_f32 v118, v118, v118
    v_lshlrev_b32 v118, 16, v118
    v_add_f32 v118, 1.0, v118
    v_cvt_pk_bf16_f32 v118, v118, v118
    v_lshlrev_b32 v118, 16, v118
    v_add_f32 v119, v119, v55
    v_cvt_pk_bf16_f32 v119, v119, v119
    v_lshlrev_b32 v119, 16, v119
    v_add_f32 v119, 1.0, v119
    v_cvt_pk_bf16_f32 v119, v119, v119
    v_lshlrev_b32 v119, 16, v119
    v_add_f32 v120, v120, v56
    v_cvt_pk_bf16_f32 v120, v120, v120
    v_lshlrev_b32 v120, 16, v120
    v_add_f32 v120, 1.0, v120
    v_cvt_pk_bf16_f32 v120, v120, v120
    v_lshlrev_b32 v120, 16, v120
    v_add_f32 v121, v121, v57
    v_cvt_pk_bf16_f32 v121, v121, v121
    v_lshlrev_b32 v121, 16, v121
    v_add_f32 v121, 1.0, v121
    v_cvt_pk_bf16_f32 v121, v121, v121
    v_lshlrev_b32 v121, 16, v121
    v_add_f32 v122, v122, v58
    v_cvt_pk_bf16_f32 v122, v122, v122
    v_lshlrev_b32 v122, 16, v122
    v_add_f32 v122, 1.0, v122
    v_cvt_pk_bf16_f32 v122, v122, v122
    v_lshlrev_b32 v122, 16, v122
    v_add_f32 v123, v123, v59
    v_cvt_pk_bf16_f32 v123, v123, v123
    v_lshlrev_b32 v123, 16, v123
    v_add_f32 v123, 1.0, v123
    v_cvt_pk_bf16_f32 v123, v123, v123
    v_lshlrev_b32 v123, 16, v123
    v_add_f32 v124, v124, v60
    v_cvt_pk_bf16_f32 v124, v124, v124
    v_lshlrev_b32 v124, 16, v124
    v_add_f32 v124, 1.0, v124
    v_cvt_pk_bf16_f32 v124, v124, v124
    v_lshlrev_b32 v124, 16, v124
    v_add_f32 v125, v125, v61
    v_cvt_pk_bf16_f32 v125, v125, v125
    v_lshlrev_b32 v125, 16, v125
    v_add_f32 v125, 1.0, v125
    v_cvt_pk_bf16_f32 v125, v125, v125
    v_lshlrev_b32 v125, 16, v125
    v_add_f32 v126, v126, v62
    v_cvt_pk_bf16_f32 v126, v126, v126
    v_lshlrev_b32 v126, 16, v126
    v_add_f32 v126, 1.0, v126
    v_cvt_pk_bf16_f32 v126, v126, v126
    v_lshlrev_b32 v126, 16, v126
    v_add_f32 v127, v127, v63
    v_cvt_pk_bf16_f32 v127, v127, v127
    v_lshlrev_b32 v127, 16, v127
    v_add_f32 v127, 1.0, v127
    v_cvt_pk_bf16_f32 v127, v127, v127
    v_lshlrev_b32 v127, 16, v127
    v_mul_f32 v192, v192, v112
    v_cvt_pk_bf16_f32 v192, v192, v192
    v_lshlrev_b32 v192, 16, v192
    v_add_f32 v192, v192, v96
    v_mul_f32 v193, v193, v113
    v_cvt_pk_bf16_f32 v193, v193, v193
    v_lshlrev_b32 v193, 16, v193
    v_add_f32 v193, v193, v97
    v_mul_f32 v194, v194, v114
    v_cvt_pk_bf16_f32 v194, v194, v194
    v_lshlrev_b32 v194, 16, v194
    v_add_f32 v194, v194, v98
    v_mul_f32 v195, v195, v115
    v_cvt_pk_bf16_f32 v195, v195, v195
    v_lshlrev_b32 v195, 16, v195
    v_add_f32 v195, v195, v99
    v_mul_f32 v196, v196, v116
    v_cvt_pk_bf16_f32 v196, v196, v196
    v_lshlrev_b32 v196, 16, v196
    v_add_f32 v196, v196, v100
    v_mul_f32 v197, v197, v117
    v_cvt_pk_bf16_f32 v197, v197, v197
    v_lshlrev_b32 v197, 16, v197
    v_add_f32 v197, v197, v101
    v_mul_f32 v198, v198, v118
    v_cvt_pk_bf16_f32 v198, v198, v198
    v_lshlrev_b32 v198, 16, v198
    v_add_f32 v198, v198, v102
    v_mul_f32 v199, v199, v119
    v_cvt_pk_bf16_f32 v199, v199, v199
    v_lshlrev_b32 v199, 16, v199
    v_add_f32 v199, v199, v103
    v_mul_f32 v200, v200, v120
    v_cvt_pk_bf16_f32 v200, v200, v200
    v_lshlrev_b32 v200, 16, v200
    v_add_f32 v200, v200, v104
    v_mul_f32 v201, v201, v121
    v_cvt_pk_bf16_f32 v201, v201, v201
    v_lshlrev_b32 v201, 16, v201
    v_add_f32 v201, v201, v105
    v_mul_f32 v202, v202, v122
    v_cvt_pk_bf16_f32 v202, v202, v202
    v_lshlrev_b32 v202, 16, v202
    v_add_f32 v202, v202, v106
    v_mul_f32 v203, v203, v123
    v_cvt_pk_bf16_f32 v203, v203, v203
    v_lshlrev_b32 v203, 16, v203
    v_add_f32 v203, v203, v107
    v_mul_f32 v204, v204, v124
    v_cvt_pk_bf16_f32 v204, v204, v204
    v_lshlrev_b32 v204, 16, v204
    v_add_f32 v204, v204, v108
    v_mul_f32 v205, v205, v125
    v_cvt_pk_bf16_f32 v205, v205, v205
    v_lshlrev_b32 v205, 16, v205
    v_add_f32 v205, v205, v109
    v_mul_f32 v206, v206, v126
    v_cvt_pk_bf16_f32 v206, v206, v206
    v_lshlrev_b32 v206, 16, v206
    v_add_f32 v206, v206, v110
    v_mul_f32 v207, v207, v127
    v_cvt_pk_bf16_f32 v207, v207, v207
    v_lshlrev_b32 v207, 16, v207
    v_add_f32 v207, v207, v111
    v_cvt_pk_bf16_f32 v80, v192, v193
    v_cvt_pk_bf16_f32 v81, v194, v195
    v_cvt_pk_bf16_f32 v82, v196, v197
    v_cvt_pk_bf16_f32 v83, v198, v199
    v_cvt_pk_bf16_f32 v84, v200, v201
    v_cvt_pk_bf16_f32 v85, v202, v203
    v_cvt_pk_bf16_f32 v86, v204, v205
    v_cvt_pk_bf16_f32 v87, v206, v207
    s_lshr_b32 s45, s63, 5
    s_lshl_b32 s45, s45, 16
    s_and_b32 s46, s63, 31
    s_lshl_b32 s46, s46, 8
    s_add_u32 s45, s45, s46
    s_add_u32 s45, s45, 0x400000
    s_add_u32 s46, s45, 32768
    buffer_store_dwordx4 v[80:83], v2, s[12:15], s45 offen sc1
    buffer_store_dwordx4 v[84:87], v2, s[12:15], s46 offen sc1
    s_add_u32 s63, s63, 384
    v_mul_f32 v208, v208, v112
    v_cvt_pk_bf16_f32 v208, v208, v208
    v_lshlrev_b32 v208, 16, v208
    v_add_f32 v208, v208, v96
    v_mul_f32 v209, v209, v113
    v_cvt_pk_bf16_f32 v209, v209, v209
    v_lshlrev_b32 v209, 16, v209
    v_add_f32 v209, v209, v97
    v_mul_f32 v210, v210, v114
    v_cvt_pk_bf16_f32 v210, v210, v210
    v_lshlrev_b32 v210, 16, v210
    v_add_f32 v210, v210, v98
    v_mul_f32 v211, v211, v115
    v_cvt_pk_bf16_f32 v211, v211, v211
    v_lshlrev_b32 v211, 16, v211
    v_add_f32 v211, v211, v99
    v_mul_f32 v212, v212, v116
    v_cvt_pk_bf16_f32 v212, v212, v212
    v_lshlrev_b32 v212, 16, v212
    v_add_f32 v212, v212, v100
    v_mul_f32 v213, v213, v117
    v_cvt_pk_bf16_f32 v213, v213, v213
    v_lshlrev_b32 v213, 16, v213
    v_add_f32 v213, v213, v101
    v_mul_f32 v214, v214, v118
    v_cvt_pk_bf16_f32 v214, v214, v214
    v_lshlrev_b32 v214, 16, v214
    v_add_f32 v214, v214, v102
    v_mul_f32 v215, v215, v119
    v_cvt_pk_bf16_f32 v215, v215, v215
    v_lshlrev_b32 v215, 16, v215
    v_add_f32 v215, v215, v103
    v_mul_f32 v216, v216, v120
    v_cvt_pk_bf16_f32 v216, v216, v216
    v_lshlrev_b32 v216, 16, v216
    v_add_f32 v216, v216, v104
    v_mul_f32 v217, v217, v121
    v_cvt_pk_bf16_f32 v217, v217, v217
    v_lshlrev_b32 v217, 16, v217
    v_add_f32 v217, v217, v105
    v_mul_f32 v218, v218, v122
    v_cvt_pk_bf16_f32 v218, v218, v218
    v_lshlrev_b32 v218, 16, v218
    v_add_f32 v218, v218, v106
    v_mul_f32 v219, v219, v123
    v_cvt_pk_bf16_f32 v219, v219, v219
    v_lshlrev_b32 v219, 16, v219
    v_add_f32 v219, v219, v107
    v_mul_f32 v220, v220, v124
    v_cvt_pk_bf16_f32 v220, v220, v220
    v_lshlrev_b32 v220, 16, v220
    v_add_f32 v220, v220, v108
    v_mul_f32 v221, v221, v125
    v_cvt_pk_bf16_f32 v221, v221, v221
    v_lshlrev_b32 v221, 16, v221
    v_add_f32 v221, v221, v109
    v_mul_f32 v222, v222, v126
    v_cvt_pk_bf16_f32 v222, v222, v222
    v_lshlrev_b32 v222, 16, v222
    v_add_f32 v222, v222, v110
    v_mul_f32 v223, v223, v127
    v_cvt_pk_bf16_f32 v223, v223, v223
    v_lshlrev_b32 v223, 16, v223
    v_add_f32 v223, v223, v111
    v_cvt_pk_bf16_f32 v88, v208, v209
    v_cvt_pk_bf16_f32 v89, v210, v211
    v_cvt_pk_bf16_f32 v90, v212, v213
    v_cvt_pk_bf16_f32 v91, v214, v215
    v_cvt_pk_bf16_f32 v92, v216, v217
    v_cvt_pk_bf16_f32 v93, v218, v219
    v_cvt_pk_bf16_f32 v94, v220, v221
    v_cvt_pk_bf16_f32 v95, v222, v223
    s_lshr_b32 s45, s63, 5
    s_lshl_b32 s45, s45, 16
    s_and_b32 s46, s63, 31
    s_lshl_b32 s46, s46, 8
    s_add_u32 s45, s45, s46
    s_add_u32 s45, s45, 0x400000
    s_add_u32 s46, s45, 32768
    buffer_store_dwordx4 v[88:91], v2, s[12:15], s45 offen sc1
    buffer_store_dwordx4 v[92:95], v2, s[12:15], s46 offen sc1
    s_waitcnt vmcnt(2)
    s_barrier
    s_cmp_lg_u32 s44, 0
    s_cbranch_scc1 L_cnt_108
    v_mov_b32 v30, 1
    v_mov_b32 v31, 126976
    s_mov_b64 exec, 1
    buffer_atomic_add v30, v31, s[12:15], 0 offen sc1
    s_mov_b64 exec, -1
L_cnt_108:
    s_add_u32 s63, s63, 384
    v_lshlrev_b32 v64, 16, v144
    v_and_b32 v65, 0xffff0000, v144
    v_lshlrev_b32 v66, 16, v145
    v_and_b32 v67, 0xffff0000, v145
    v_lshlrev_b32 v68, 16, v146
    v_and_b32 v69, 0xffff0000, v146
    v_lshlrev_b32 v70, 16, v147
    v_and_b32 v71, 0xffff0000, v147
    v_lshlrev_b32 v72, 16, v148
    v_and_b32 v73, 0xffff0000, v148
    v_lshlrev_b32 v74, 16, v149
    v_and_b32 v75, 0xffff0000, v149
    v_lshlrev_b32 v76, 16, v150
    v_and_b32 v77, 0xffff0000, v150
    v_lshlrev_b32 v78, 16, v151
    v_and_b32 v79, 0xffff0000, v151
    v_add_f32 v26, v64, v65
    v_add_f32 v26, v26, v66
    v_add_f32 v26, v26, v67
    v_add_f32 v26, v26, v68
    v_add_f32 v26, v26, v69
    v_add_f32 v26, v26, v70
    v_add_f32 v26, v26, v71
    v_add_f32 v26, v26, v72
    v_add_f32 v26, v26, v73
    v_add_f32 v26, v26, v74
    v_add_f32 v26, v26, v75
    v_add_f32 v26, v26, v76
    v_add_f32 v26, v26, v77
    v_add_f32 v26, v26, v78
    v_add_f32 v26, v26, v79
    s_nop 1
    v_add_f32_dpp v26, v26, v26 row_shr:1 row_mask:0xf bank_mask:0xf bound_ctrl:0
    s_nop 1
    v_add_f32_dpp v26, v26, v26 row_shr:2 row_mask:0xf bank_mask:0xf bound_ctrl:0
    s_nop 1
    v_add_f32_dpp v26, v26, v26 row_shr:4 row_mask:0xf bank_mask:0xf bound_ctrl:0
    s_nop 1
    v_add_f32_dpp v26, v26, v26 row_shr:8 row_mask:0xf bank_mask:0xf bound_ctrl:0
    s_nop 1
    v_add_f32_dpp v26, v26, v26 row_bcast:15 row_mask:0xa bank_mask:0xf
    s_nop 1
    v_add_f32_dpp v26, v26, v26 row_bcast:31 row_mask:0xc bank_mask:0xf
    s_nop 1
    v_readlane_b32 s66, v26, 63
    s_nop 1
    v_mov_b32 v27, s66
    v_mul_f32 v27, 0x3a800000, v27
    v_mov_b32 v26, 0
    v_sub_f32 v28, v64, v27
    v_fmac_f32 v26, v28, v28
    v_sub_f32 v28, v65, v27
    v_fmac_f32 v26, v28, v28
    v_sub_f32 v28, v66, v27
    v_fmac_f32 v26, v28, v28
    v_sub_f32 v28, v67, v27
    v_fmac_f32 v26, v28, v28
    v_sub_f32 v28, v68, v27
    v_fmac_f32 v26, v28, v28
    v_sub_f32 v28, v69, v27
    v_fmac_f32 v26, v28, v28
    v_sub_f32 v28, v70, v27
    v_fmac_f32 v26, v28, v28
    v_sub_f32 v28, v71, v27
    v_fmac_f32 v26, v28, v28
    v_sub_f32 v28, v72, v27
    v_fmac_f32 v26, v28, v28
    v_sub_f32 v28, v73, v27
    v_fmac_f32 v26, v28, v28
    v_sub_f32 v28, v74, v27
    v_fmac_f32 v26, v28, v28
    v_sub_f32 v28, v75, v27
    v_fmac_f32 v26, v28, v28
    v_sub_f32 v28, v76, v27
    v_fmac_f32 v26, v28, v28
    v_sub_f32 v28, v77, v27
    v_fmac_f32 v26, v28, v28
    v_sub_f32 v28, v78, v27
    v_fmac_f32 v26, v28, v28
    v_sub_f32 v28, v79, v27
    v_fmac_f32 v26, v28, v28
    s_nop 1
    v_add_f32_dpp v26, v26, v26 row_shr:1 row_mask:0xf bank_mask:0xf bound_ctrl:0
    s_nop 1
    v_add_f32_dpp v26, v26, v26 row_shr:2 row_mask:0xf bank_mask:0xf bound_ctrl:0
    s_nop 1
    v_add_f32_dpp v26, v26, v26 row_shr:4 row_mask:0xf bank_mask:0xf bound_ctrl:0
    s_nop 1
    v_add_f32_dpp v26, v26, v26 row_shr:8 row_mask:0xf bank_mask:0xf bound_ctrl:0
    s_nop 1
    v_add_f32_dpp v26, v26, v26 row_bcast:15 row_mask:0xa bank_mask:0xf
    s_nop 1
    v_add_f32_dpp v26, v26, v26 row_bcast:31 row_mask:0xc bank_mask:0xf
    s_nop 1
    v_readlane_b32 s66, v26, 63
    s_nop 1
    v_mov_b32 v26, s66
    v_mul_f32 v26, 0x3a800000, v26
    v_cvt_pk_bf16_f32 v26, v26, v26
    v_lshlrev_b32 v26, 16, v26
    v_cvt_pk_bf16_f32 v27, v27, v27
    v_lshlrev_b32 v27, 16, v27
    v_add_f32 v26, 0x3727c5ac, v26
    v_cvt_pk_bf16_f32 v26, v26, v26
    v_lshlrev_b32 v26, 16, v26
    v_sqrt_f32 v26, v26
    s_nop 0
    v_cvt_pk_bf16_f32 v26, v26, v26
    v_lshlrev_b32 v26, 16, v26
    v_rcp_f32 v26, v26
    s_nop 0
    v_sub_f32 v64, v64, v27
    v_cvt_pk_bf16_f32 v64, v64, v64
    v_lshlrev_b32 v64, 16, v64
    v_mul_f32 v64, v64, v26
    v_cvt_pk_bf16_f32 v64, v64, v64
    v_lshlrev_b32 v64, 16, v64
    v_sub_f32 v65, v65, v27
    v_cvt_pk_bf16_f32 v65, v65, v65
    v_lshlrev_b32 v65, 16, v65
    v_mul_f32 v65, v65, v26
    v_cvt_pk_bf16_f32 v65, v65, v65
    v_lshlrev_b32 v65, 16, v65
    v_sub_f32 v66, v66, v27
    v_cvt_pk_bf16_f32 v66, v66, v66
    v_lshlrev_b32 v66, 16, v66
    v_mul_f32 v66, v66, v26
    v_cvt_pk_bf16_f32 v66, v66, v66
    v_lshlrev_b32 v66, 16, v66
    v_sub_f32 v67, v67, v27
    v_cvt_pk_bf16_f32 v67, v67, v67
    v_lshlrev_b32 v67, 16, v67
    v_mul_f32 v67, v67, v26
    v_cvt_pk_bf16_f32 v67, v67, v67
    v_lshlrev_b32 v67, 16, v67
    v_sub_f32 v68, v68, v27
    v_cvt_pk_bf16_f32 v68, v68, v68
    v_lshlrev_b32 v68, 16, v68
    v_mul_f32 v68, v68, v26
    v_cvt_pk_bf16_f32 v68, v68, v68
    v_lshlrev_b32 v68, 16, v68
    v_sub_f32 v69, v69, v27
    v_cvt_pk_bf16_f32 v69, v69, v69
    v_lshlrev_b32 v69, 16, v69
    v_mul_f32 v69, v69, v26
    v_cvt_pk_bf16_f32 v69, v69, v69
    v_lshlrev_b32 v69, 16, v69
    v_sub_f32 v70, v70, v27
    v_cvt_pk_bf16_f32 v70, v70, v70
    v_lshlrev_b32 v70, 16, v70
    v_mul_f32 v70, v70, v26
    v_cvt_pk_bf16_f32 v70, v70, v70
    v_lshlrev_b32 v70, 16, v70
    v_sub_f32 v71, v71, v27
    v_cvt_pk_bf16_f32 v71, v71, v71
    v_lshlrev_b32 v71, 16, v71
    v_mul_f32 v71, v71, v26
    v_cvt_pk_bf16_f32 v71, v71, v71
    v_lshlrev_b32 v71, 16, v71
    v_sub_f32 v72, v72, v27
    v_cvt_pk_bf16_f32 v72, v72, v72
    v_lshlrev_b32 v72, 16, v72
    v_mul_f32 v72, v72, v26
    v_cvt_pk_bf16_f32 v72, v72, v72
    v_lshlrev_b32 v72, 16, v72
    v_sub_f32 v73, v73, v27
    v_cvt_pk_bf16_f32 v73, v73, v73
    v_lshlrev_b32 v73, 16, v73
    v_mul_f32 v73, v73, v26
    v_cvt_pk_bf16_f32 v73, v73, v73
    v_lshlrev_b32 v73, 16, v73
    v_sub_f32 v74, v74, v27
    v_cvt_pk_bf16_f32 v74, v74, v74
    v_lshlrev_b32 v74, 16, v74
    v_mul_f32 v74, v74, v26
    v_cvt_pk_bf16_f32 v74, v74, v74
    v_lshlrev_b32 v74, 16, v74
    v_sub_f32 v75, v75, v27
    v_cvt_pk_bf16_f32 v75, v75, v75
    v_lshlrev_b32 v75, 16, v75
    v_mul_f32 v75, v75, v26
    v_cvt_pk_bf16_f32 v75, v75, v75
    v_lshlrev_b32 v75, 16, v75
    v_sub_f32 v76, v76, v27
    v_cvt_pk_bf16_f32 v76, v76, v76
    v_lshlrev_b32 v76, 16, v76
    v_mul_f32 v76, v76, v26
    v_cvt_pk_bf16_f32 v76, v76, v76
    v_lshlrev_b32 v76, 16, v76
    v_sub_f32 v77, v77, v27
    v_cvt_pk_bf16_f32 v77, v77, v77
    v_lshlrev_b32 v77, 16, v77
    v_mul_f32 v77, v77, v26
    v_cvt_pk_bf16_f32 v77, v77, v77
    v_lshlrev_b32 v77, 16, v77
    v_sub_f32 v78, v78, v27
    v_cvt_pk_bf16_f32 v78, v78, v78
    v_lshlrev_b32 v78, 16, v78
    v_mul_f32 v78, v78, v26
    v_cvt_pk_bf16_f32 v78, v78, v78
    v_lshlrev_b32 v78, 16, v78
    v_sub_f32 v79, v79, v27
    v_cvt_pk_bf16_f32 v79, v79, v79
    v_lshlrev_b32 v79, 16, v79
    v_mul_f32 v79, v79, v26
    v_cvt_pk_bf16_f32 v79, v79, v79
    v_lshlrev_b32 v79, 16, v79
    v_mul_f32 v64, v64, v112
    v_cvt_pk_bf16_f32 v64, v64, v64
    v_lshlrev_b32 v64, 16, v64
    v_add_f32 v64, v64, v96
    v_mul_f32 v65, v65, v113
    v_cvt_pk_bf16_f32 v65, v65, v65
    v_lshlrev_b32 v65, 16, v65
    v_add_f32 v65, v65, v97
    v_mul_f32 v66, v66, v114
    v_cvt_pk_bf16_f32 v66, v66, v66
    v_lshlrev_b32 v66, 16, v66
    v_add_f32 v66, v66, v98
    v_mul_f32 v67, v67, v115
    v_cvt_pk_bf16_f32 v67, v67, v67
    v_lshlrev_b32 v67, 16, v67
    v_add_f32 v67, v67, v99
    v_mul_f32 v68, v68, v116
    v_cvt_pk_bf16_f32 v68, v68, v68
    v_lshlrev_b32 v68, 16, v68
    v_add_f32 v68, v68, v100
    v_mul_f32 v69, v69, v117
    v_cvt_pk_bf16_f32 v69, v69, v69
    v_lshlrev_b32 v69, 16, v69
    v_add_f32 v69, v69, v101
    v_mul_f32 v70, v70, v118
    v_cvt_pk_bf16_f32 v70, v70, v70
    v_lshlrev_b32 v70, 16, v70
    v_add_f32 v70, v70, v102
    v_mul_f32 v71, v71, v119
    v_cvt_pk_bf16_f32 v71, v71, v71
    v_lshlrev_b32 v71, 16, v71
    v_add_f32 v71, v71, v103
    v_mul_f32 v72, v72, v120
    v_cvt_pk_bf16_f32 v72, v72, v72
    v_lshlrev_b32 v72, 16, v72
    v_add_f32 v72, v72, v104
    v_mul_f32 v73, v73, v121
    v_cvt_pk_bf16_f32 v73, v73, v73
    v_lshlrev_b32 v73, 16, v73
    v_add_f32 v73, v73, v105
    v_mul_f32 v74, v74, v122
    v_cvt_pk_bf16_f32 v74, v74, v74
    v_lshlrev_b32 v74, 16, v74
    v_add_f32 v74, v74, v106
    v_mul_f32 v75, v75, v123
    v_cvt_pk_bf16_f32 v75, v75, v75
    v_lshlrev_b32 v75, 16, v75
    v_add_f32 v75, v75, v107
    v_mul_f32 v76, v76, v124
    v_cvt_pk_bf16_f32 v76, v76, v76
    v_lshlrev_b32 v76, 16, v76
    v_add_f32 v76, v76, v108
    v_mul_f32 v77, v77, v125
    v_cvt_pk_bf16_f32 v77, v77, v77
    v_lshlrev_b32 v77, 16, v77
    v_add_f32 v77, v77, v109
    v_mul_f32 v78, v78, v126
    v_cvt_pk_bf16_f32 v78, v78, v78
    v_lshlrev_b32 v78, 16, v78
    v_add_f32 v78, v78, v110
    v_mul_f32 v79, v79, v127
    v_cvt_pk_bf16_f32 v79, v79, v79
    v_lshlrev_b32 v79, 16, v79
    v_add_f32 v79, v79, v111
    v_cvt_pk_bf16_f32 v80, v64, v65
    v_cvt_pk_bf16_f32 v81, v66, v67
    v_cvt_pk_bf16_f32 v82, v68, v69
    v_cvt_pk_bf16_f32 v83, v70, v71
    v_cvt_pk_bf16_f32 v84, v72, v73
    v_cvt_pk_bf16_f32 v85, v74, v75
    v_cvt_pk_bf16_f32 v86, v76, v77
    v_cvt_pk_bf16_f32 v87, v78, v79
    s_lshr_b32 s45, s63, 5
    s_lshl_b32 s45, s45, 16
    s_and_b32 s46, s63, 31
    s_lshl_b32 s46, s46, 8
    s_add_u32 s45, s45, s46
    s_add_u32 s45, s45, 0x400000
    s_add_u32 s46, s45, 32768
    buffer_store_dwordx4 v[80:83], v2, s[12:15], s45 offen sc1
    buffer_store_dwordx4 v[84:87], v2, s[12:15], s46 offen sc1
    s_add_u32 s63, s63, 384
    v_lshlrev_b32 v64, 16, v152
    v_and_b32 v65, 0xffff0000, v152
    v_lshlrev_b32 v66, 16, v153
    v_and_b32 v67, 0xffff0000, v153
    v_lshlrev_b32 v68, 16, v154
    v_and_b32 v69, 0xffff0000, v154
    v_lshlrev_b32 v70, 16, v155
    v_and_b32 v71, 0xffff0000, v155
    v_lshlrev_b32 v72, 16, v156
    v_and_b32 v73, 0xffff0000, v156
    v_lshlrev_b32 v74, 16, v157
    v_and_b32 v75, 0xffff0000, v157
    v_lshlrev_b32 v76, 16, v158
    v_and_b32 v77, 0xffff0000, v158
    v_lshlrev_b32 v78, 16, v159
    v_and_b32 v79, 0xffff0000, v159
    v_add_f32 v26, v64, v65
    v_add_f32 v26, v26, v66
    v_add_f32 v26, v26, v67
    v_add_f32 v26, v26, v68
    v_add_f32 v26, v26, v69
    v_add_f32 v26, v26, v70
    v_add_f32 v26, v26, v71
    v_add_f32 v26, v26, v72
    v_add_f32 v26, v26, v73
    v_add_f32 v26, v26, v74
    v_add_f32 v26, v26, v75
    v_add_f32 v26, v26, v76
    v_add_f32 v26, v26, v77
    v_add_f32 v26, v26, v78
    v_add_f32 v26, v26, v79
    s_nop 1
    v_add_f32_dpp v26, v26, v26 row_shr:1 row_mask:0xf bank_mask:0xf bound_ctrl:0
    s_nop 1
    v_add_f32_dpp v26, v26, v26 row_shr:2 row_mask:0xf bank_mask:0xf bound_ctrl:0
    s_nop 1
    v_add_f32_dpp v26, v26, v26 row_shr:4 row_mask:0xf bank_mask:0xf bound_ctrl:0
    s_nop 1
    v_add_f32_dpp v26, v26, v26 row_shr:8 row_mask:0xf bank_mask:0xf bound_ctrl:0
    s_nop 1
    v_add_f32_dpp v26, v26, v26 row_bcast:15 row_mask:0xa bank_mask:0xf
    s_nop 1
    v_add_f32_dpp v26, v26, v26 row_bcast:31 row_mask:0xc bank_mask:0xf
    s_nop 1
    v_readlane_b32 s66, v26, 63
    s_nop 1
    v_mov_b32 v27, s66
    v_mul_f32 v27, 0x3a800000, v27
    v_mov_b32 v26, 0
    v_sub_f32 v28, v64, v27
    v_fmac_f32 v26, v28, v28
    v_sub_f32 v28, v65, v27
    v_fmac_f32 v26, v28, v28
    v_sub_f32 v28, v66, v27
    v_fmac_f32 v26, v28, v28
    v_sub_f32 v28, v67, v27
    v_fmac_f32 v26, v28, v28
    v_sub_f32 v28, v68, v27
    v_fmac_f32 v26, v28, v28
    v_sub_f32 v28, v69, v27
    v_fmac_f32 v26, v28, v28
    v_sub_f32 v28, v70, v27
    v_fmac_f32 v26, v28, v28
    v_sub_f32 v28, v71, v27
    v_fmac_f32 v26, v28, v28
    v_sub_f32 v28, v72, v27
    v_fmac_f32 v26, v28, v28
    v_sub_f32 v28, v73, v27
    v_fmac_f32 v26, v28, v28
    v_sub_f32 v28, v74, v27
    v_fmac_f32 v26, v28, v28
    v_sub_f32 v28, v75, v27
    v_fmac_f32 v26, v28, v28
    v_sub_f32 v28, v76, v27
    v_fmac_f32 v26, v28, v28
    v_sub_f32 v28, v77, v27
    v_fmac_f32 v26, v28, v28
    v_sub_f32 v28, v78, v27
    v_fmac_f32 v26, v28, v28
    v_sub_f32 v28, v79, v27
    v_fmac_f32 v26, v28, v28
    s_nop 1
    v_add_f32_dpp v26, v26, v26 row_shr:1 row_mask:0xf bank_mask:0xf bound_ctrl:0
    s_nop 1
    v_add_f32_dpp v26, v26, v26 row_shr:2 row_mask:0xf bank_mask:0xf bound_ctrl:0
    s_nop 1
    v_add_f32_dpp v26, v26, v26 row_shr:4 row_mask:0xf bank_mask:0xf bound_ctrl:0
    s_nop 1
    v_add_f32_dpp v26, v26, v26 row_shr:8 row_mask:0xf bank_mask:0xf bound_ctrl:0
    s_nop 1
    v_add_f32_dpp v26, v26, v26 row_bcast:15 row_mask:0xa bank_mask:0xf
    s_nop 1
    v_add_f32_dpp v26, v26, v26 row_bcast:31 row_mask:0xc bank_mask:0xf
    s_nop 1
    v_readlane_b32 s66, v26, 63
    s_nop 1
    v_mov_b32 v26, s66
    v_mul_f32 v26, 0x3a800000, v26
    v_cvt_pk_bf16_f32 v26, v26, v26
    v_lshlrev_b32 v26, 16, v26
    v_cvt_pk_bf16_f32 v27, v27, v27
    v_lshlrev_b32 v27, 16, v27
    v_add_f32 v26, 0x3727c5ac, v26
    v_cvt_pk_bf16_f32 v26, v26, v26
    v_lshlrev_b32 v26, 16, v26
    v_sqrt_f32 v26, v26
    s_nop 0
    v_cvt_pk_bf16_f32 v26, v26, v26
    v_lshlrev_b32 v26, 16, v26
    v_rcp_f32 v26, v26
    s_nop 0
    v_sub_f32 v64, v64, v27
    v_cvt_pk_bf16_f32 v64, v64, v64
    v_lshlrev_b32 v64, 16, v64
    v_mul_f32 v64, v64, v26
    v_cvt_pk_bf16_f32 v64, v64, v64
    v_lshlrev_b32 v64, 16, v64
    v_sub_f32 v65, v65, v27
    v_cvt_pk_bf16_f32 v65, v65, v65
    v_lshlrev_b32 v65, 16, v65
    v_mul_f32 v65, v65, v26
    v_cvt_pk_bf16_f32 v65, v65, v65
    v_lshlrev_b32 v65, 16, v65
    v_sub_f32 v66, v66, v27
    v_cvt_pk_bf16_f32 v66, v66, v66
    v_lshlrev_b32 v66, 16, v66
    v_mul_f32 v66, v66, v26
    v_cvt_pk_bf16_f32 v66, v66, v66
    v_lshlrev_b32 v66, 16, v66
    v_sub_f32 v67, v67, v27
    v_cvt_pk_bf16_f32 v67, v67, v67
    v_lshlrev_b32 v67, 16, v67
    v_mul_f32 v67, v67, v26
    v_cvt_pk_bf16_f32 v67, v67, v67
    v_lshlrev_b32 v67, 16, v67
    v_sub_f32 v68, v68, v27
    v_cvt_pk_bf16_f32 v68, v68, v68
    v_lshlrev_b32 v68, 16, v68
    v_mul_f32 v68, v68, v26
    v_cvt_pk_bf16_f32 v68, v68, v68
    v_lshlrev_b32 v68, 16, v68
    v_sub_f32 v69, v69, v27
    v_cvt_pk_bf16_f32 v69, v69, v69
    v_lshlrev_b32 v69, 16, v69
    v_mul_f32 v69, v69, v26
    v_cvt_pk_bf16_f32 v69, v69, v69
    v_lshlrev_b32 v69, 16, v69
    v_sub_f32 v70, v70, v27
    v_cvt_pk_bf16_f32 v70, v70, v70
    v_lshlrev_b32 v70, 16, v70
    v_mul_f32 v70, v70, v26
    v_cvt_pk_bf16_f32 v70, v70, v70
    v_lshlrev_b32 v70, 16, v70
    v_sub_f32 v71, v71, v27
    v_cvt_pk_bf16_f32 v71, v71, v71
    v_lshlrev_b32 v71, 16, v71
    v_mul_f32 v71, v71, v26
    v_cvt_pk_bf16_f32 v71, v71, v71
    v_lshlrev_b32 v71, 16, v71
    v_sub_f32 v72, v72, v27
    v_cvt_pk_bf16_f32 v72, v72, v72
    v_lshlrev_b32 v72, 16, v72
    v_mul_f32 v72, v72, v26
    v_cvt_pk_bf16_f32 v72, v72, v72
    v_lshlrev_b32 v72, 16, v72
    v_sub_f32 v73, v73, v27
    v_cvt_pk_bf16_f32 v73, v73, v73
    v_lshlrev_b32 v73, 16, v73
    v_mul_f32 v73, v73, v26
    v_cvt_pk_bf16_f32 v73, v73, v73
    v_lshlrev_b32 v73, 16, v73
    v_sub_f32 v74, v74, v27
    v_cvt_pk_bf16_f32 v74, v74, v74
    v_lshlrev_b32 v74, 16, v74
    v_mul_f32 v74, v74, v26
    v_cvt_pk_bf16_f32 v74, v74, v74
    v_lshlrev_b32 v74, 16, v74
    v_sub_f32 v75, v75, v27
    v_cvt_pk_bf16_f32 v75, v75, v75
    v_lshlrev_b32 v75, 16, v75
    v_mul_f32 v75, v75, v26
    v_cvt_pk_bf16_f32 v75, v75, v75
    v_lshlrev_b32 v75, 16, v75
    v_sub_f32 v76, v76, v27
    v_cvt_pk_bf16_f32 v76, v76, v76
    v_lshlrev_b32 v76, 16, v76
    v_mul_f32 v76, v76, v26
    v_cvt_pk_bf16_f32 v76, v76, v76
    v_lshlrev_b32 v76, 16, v76
    v_sub_f32 v77, v77, v27
    v_cvt_pk_bf16_f32 v77, v77, v77
    v_lshlrev_b32 v77, 16, v77
    v_mul_f32 v77, v77, v26
    v_cvt_pk_bf16_f32 v77, v77, v77
    v_lshlrev_b32 v77, 16, v77
    v_sub_f32 v78, v78, v27
    v_cvt_pk_bf16_f32 v78, v78, v78
    v_lshlrev_b32 v78, 16, v78
    v_mul_f32 v78, v78, v26
    v_cvt_pk_bf16_f32 v78, v78, v78
    v_lshlrev_b32 v78, 16, v78
    v_sub_f32 v79, v79, v27
    v_cvt_pk_bf16_f32 v79, v79, v79
    v_lshlrev_b32 v79, 16, v79
    v_mul_f32 v79, v79, v26
    v_cvt_pk_bf16_f32 v79, v79, v79
    v_lshlrev_b32 v79, 16, v79
    v_mul_f32 v64, v64, v112
    v_cvt_pk_bf16_f32 v64, v64, v64
    v_lshlrev_b32 v64, 16, v64
    v_add_f32 v64, v64, v96
    v_mul_f32 v65, v65, v113
    v_cvt_pk_bf16_f32 v65, v65, v65
    v_lshlrev_b32 v65, 16, v65
    v_add_f32 v65, v65, v97
    v_mul_f32 v66, v66, v114
    v_cvt_pk_bf16_f32 v66, v66, v66
    v_lshlrev_b32 v66, 16, v66
    v_add_f32 v66, v66, v98
    v_mul_f32 v67, v67, v115
    v_cvt_pk_bf16_f32 v67, v67, v67
    v_lshlrev_b32 v67, 16, v67
    v_add_f32 v67, v67, v99
    v_mul_f32 v68, v68, v116
    v_cvt_pk_bf16_f32 v68, v68, v68
    v_lshlrev_b32 v68, 16, v68
    v_add_f32 v68, v68, v100
    v_mul_f32 v69, v69, v117
    v_cvt_pk_bf16_f32 v69, v69, v69
    v_lshlrev_b32 v69, 16, v69
    v_add_f32 v69, v69, v101
    v_mul_f32 v70, v70, v118
    v_cvt_pk_bf16_f32 v70, v70, v70
    v_lshlrev_b32 v70, 16, v70
    v_add_f32 v70, v70, v102
    v_mul_f32 v71, v71, v119
    v_cvt_pk_bf16_f32 v71, v71, v71
    v_lshlrev_b32 v71, 16, v71
    v_add_f32 v71, v71, v103
    v_mul_f32 v72, v72, v120
    v_cvt_pk_bf16_f32 v72, v72, v72
    v_lshlrev_b32 v72, 16, v72
    v_add_f32 v72, v72, v104
    v_mul_f32 v73, v73, v121
    v_cvt_pk_bf16_f32 v73, v73, v73
    v_lshlrev_b32 v73, 16, v73
    v_add_f32 v73, v73, v105
    v_mul_f32 v74, v74, v122
    v_cvt_pk_bf16_f32 v74, v74, v74
    v_lshlrev_b32 v74, 16, v74
    v_add_f32 v74, v74, v106
    v_mul_f32 v75, v75, v123
    v_cvt_pk_bf16_f32 v75, v75, v75
    v_lshlrev_b32 v75, 16, v75
    v_add_f32 v75, v75, v107
    v_mul_f32 v76, v76, v124
    v_cvt_pk_bf16_f32 v76, v76, v76
    v_lshlrev_b32 v76, 16, v76
    v_add_f32 v76, v76, v108
    v_mul_f32 v77, v77, v125
    v_cvt_pk_bf16_f32 v77, v77, v77
    v_lshlrev_b32 v77, 16, v77
    v_add_f32 v77, v77, v109
    v_mul_f32 v78, v78, v126
    v_cvt_pk_bf16_f32 v78, v78, v78
    v_lshlrev_b32 v78, 16, v78
    v_add_f32 v78, v78, v110
    v_mul_f32 v79, v79, v127
    v_cvt_pk_bf16_f32 v79, v79, v79
    v_lshlrev_b32 v79, 16, v79
    v_add_f32 v79, v79, v111
    v_cvt_pk_bf16_f32 v80, v64, v65
    v_cvt_pk_bf16_f32 v81, v66, v67
    v_cvt_pk_bf16_f32 v82, v68, v69
    v_cvt_pk_bf16_f32 v83, v70, v71
    v_cvt_pk_bf16_f32 v84, v72, v73
    v_cvt_pk_bf16_f32 v85, v74, v75
    v_cvt_pk_bf16_f32 v86, v76, v77
    v_cvt_pk_bf16_f32 v87, v78, v79
    s_lshr_b32 s45, s63, 5
    s_lshl_b32 s45, s45, 16
    s_and_b32 s46, s63, 31
    s_lshl_b32 s46, s46, 8
    s_add_u32 s45, s45, s46
    s_add_u32 s45, s45, 0x400000
    s_add_u32 s46, s45, 32768
    buffer_store_dwordx4 v[80:83], v2, s[12:15], s45 offen sc1
    buffer_store_dwordx4 v[84:87], v2, s[12:15], s46 offen sc1
    s_add_u32 s63, s63, 384
    v_lshlrev_b32 v64, 16, v160
    v_and_b32 v65, 0xffff0000, v160
    v_lshlrev_b32 v66, 16, v161
    v_and_b32 v67, 0xffff0000, v161
    v_lshlrev_b32 v68, 16, v162
    v_and_b32 v69, 0xffff0000, v162
    v_lshlrev_b32 v70, 16, v163
    v_and_b32 v71, 0xffff0000, v163
    v_lshlrev_b32 v72, 16, v164
    v_and_b32 v73, 0xffff0000, v164
    v_lshlrev_b32 v74, 16, v165
    v_and_b32 v75, 0xffff0000, v165
    v_lshlrev_b32 v76, 16, v166
    v_and_b32 v77, 0xffff0000, v166
    v_lshlrev_b32 v78, 16, v167
    v_and_b32 v79, 0xffff0000, v167
    v_add_f32 v26, v64, v65
    v_add_f32 v26, v26, v66
    v_add_f32 v26, v26, v67
    v_add_f32 v26, v26, v68
    v_add_f32 v26, v26, v69
    v_add_f32 v26, v26, v70
    v_add_f32 v26, v26, v71
    v_add_f32 v26, v26, v72
    v_add_f32 v26, v26, v73
    v_add_f32 v26, v26, v74
    v_add_f32 v26, v26, v75
    v_add_f32 v26, v26, v76
    v_add_f32 v26, v26, v77
    v_add_f32 v26, v26, v78
    v_add_f32 v26, v26, v79
    s_nop 1
    v_add_f32_dpp v26, v26, v26 row_shr:1 row_mask:0xf bank_mask:0xf bound_ctrl:0
    s_nop 1
    v_add_f32_dpp v26, v26, v26 row_shr:2 row_mask:0xf bank_mask:0xf bound_ctrl:0
    s_nop 1
    v_add_f32_dpp v26, v26, v26 row_shr:4 row_mask:0xf bank_mask:0xf bound_ctrl:0
    s_nop 1
    v_add_f32_dpp v26, v26, v26 row_shr:8 row_mask:0xf bank_mask:0xf bound_ctrl:0
    s_nop 1
    v_add_f32_dpp v26, v26, v26 row_bcast:15 row_mask:0xa bank_mask:0xf
    s_nop 1
    v_add_f32_dpp v26, v26, v26 row_bcast:31 row_mask:0xc bank_mask:0xf
    s_nop 1
    v_readlane_b32 s66, v26, 63
    s_nop 1
    v_mov_b32 v27, s66
    v_mul_f32 v27, 0x3a800000, v27
    v_mov_b32 v26, 0
    v_sub_f32 v28, v64, v27
    v_fmac_f32 v26, v28, v28
    v_sub_f32 v28, v65, v27
    v_fmac_f32 v26, v28, v28
    v_sub_f32 v28, v66, v27
    v_fmac_f32 v26, v28, v28
    v_sub_f32 v28, v67, v27
    v_fmac_f32 v26, v28, v28
    v_sub_f32 v28, v68, v27
    v_fmac_f32 v26, v28, v28
    v_sub_f32 v28, v69, v27
    v_fmac_f32 v26, v28, v28
    v_sub_f32 v28, v70, v27
    v_fmac_f32 v26, v28, v28
    v_sub_f32 v28, v71, v27
    v_fmac_f32 v26, v28, v28
    v_sub_f32 v28, v72, v27
    v_fmac_f32 v26, v28, v28
    v_sub_f32 v28, v73, v27
    v_fmac_f32 v26, v28, v28
    v_sub_f32 v28, v74, v27
    v_fmac_f32 v26, v28, v28
    v_sub_f32 v28, v75, v27
    v_fmac_f32 v26, v28, v28
    v_sub_f32 v28, v76, v27
    v_fmac_f32 v26, v28, v28
    v_sub_f32 v28, v77, v27
    v_fmac_f32 v26, v28, v28
    v_sub_f32 v28, v78, v27
    v_fmac_f32 v26, v28, v28
    v_sub_f32 v28, v79, v27
    v_fmac_f32 v26, v28, v28
    s_nop 1
    v_add_f32_dpp v26, v26, v26 row_shr:1 row_mask:0xf bank_mask:0xf bound_ctrl:0
    s_nop 1
    v_add_f32_dpp v26, v26, v26 row_shr:2 row_mask:0xf bank_mask:0xf bound_ctrl:0
    s_nop 1
    v_add_f32_dpp v26, v26, v26 row_shr:4 row_mask:0xf bank_mask:0xf bound_ctrl:0
    s_nop 1
    v_add_f32_dpp v26, v26, v26 row_shr:8 row_mask:0xf bank_mask:0xf bound_ctrl:0
    s_nop 1
    v_add_f32_dpp v26, v26, v26 row_bcast:15 row_mask:0xa bank_mask:0xf
    s_nop 1
    v_add_f32_dpp v26, v26, v26 row_bcast:31 row_mask:0xc bank_mask:0xf
    s_nop 1
    v_readlane_b32 s66, v26, 63
    s_nop 1
    v_mov_b32 v26, s66
    v_mul_f32 v26, 0x3a800000, v26
    v_cvt_pk_bf16_f32 v26, v26, v26
    v_lshlrev_b32 v26, 16, v26
    v_cvt_pk_bf16_f32 v27, v27, v27
    v_lshlrev_b32 v27, 16, v27
    v_add_f32 v26, 0x3727c5ac, v26
    v_cvt_pk_bf16_f32 v26, v26, v26
    v_lshlrev_b32 v26, 16, v26
    v_sqrt_f32 v26, v26
    s_nop 0
    v_cvt_pk_bf16_f32 v26, v26, v26
    v_lshlrev_b32 v26, 16, v26
    v_rcp_f32 v26, v26
    s_nop 0
    v_sub_f32 v64, v64, v27
    v_cvt_pk_bf16_f32 v64, v64, v64
    v_lshlrev_b32 v64, 16, v64
    v_mul_f32 v64, v64, v26
    v_cvt_pk_bf16_f32 v64, v64, v64
    v_lshlrev_b32 v64, 16, v64
    v_sub_f32 v65, v65, v27
    v_cvt_pk_bf16_f32 v65, v65, v65
    v_lshlrev_b32 v65, 16, v65
    v_mul_f32 v65, v65, v26
    v_cvt_pk_bf16_f32 v65, v65, v65
    v_lshlrev_b32 v65, 16, v65
    v_sub_f32 v66, v66, v27
    v_cvt_pk_bf16_f32 v66, v66, v66
    v_lshlrev_b32 v66, 16, v66
    v_mul_f32 v66, v66, v26
    v_cvt_pk_bf16_f32 v66, v66, v66
    v_lshlrev_b32 v66, 16, v66
    v_sub_f32 v67, v67, v27
    v_cvt_pk_bf16_f32 v67, v67, v67
    v_lshlrev_b32 v67, 16, v67
    v_mul_f32 v67, v67, v26
    v_cvt_pk_bf16_f32 v67, v67, v67
    v_lshlrev_b32 v67, 16, v67
    v_sub_f32 v68, v68, v27
    v_cvt_pk_bf16_f32 v68, v68, v68
    v_lshlrev_b32 v68, 16, v68
    v_mul_f32 v68, v68, v26
    v_cvt_pk_bf16_f32 v68, v68, v68
    v_lshlrev_b32 v68, 16, v68
    v_sub_f32 v69, v69, v27
    v_cvt_pk_bf16_f32 v69, v69, v69
    v_lshlrev_b32 v69, 16, v69
    v_mul_f32 v69, v69, v26
    v_cvt_pk_bf16_f32 v69, v69, v69
    v_lshlrev_b32 v69, 16, v69
    v_sub_f32 v70, v70, v27
    v_cvt_pk_bf16_f32 v70, v70, v70
    v_lshlrev_b32 v70, 16, v70
    v_mul_f32 v70, v70, v26
    v_cvt_pk_bf16_f32 v70, v70, v70
    v_lshlrev_b32 v70, 16, v70
    v_sub_f32 v71, v71, v27
    v_cvt_pk_bf16_f32 v71, v71, v71
    v_lshlrev_b32 v71, 16, v71
    v_mul_f32 v71, v71, v26
    v_cvt_pk_bf16_f32 v71, v71, v71
    v_lshlrev_b32 v71, 16, v71
    v_sub_f32 v72, v72, v27
    v_cvt_pk_bf16_f32 v72, v72, v72
    v_lshlrev_b32 v72, 16, v72
    v_mul_f32 v72, v72, v26
    v_cvt_pk_bf16_f32 v72, v72, v72
    v_lshlrev_b32 v72, 16, v72
    v_sub_f32 v73, v73, v27
    v_cvt_pk_bf16_f32 v73, v73, v73
    v_lshlrev_b32 v73, 16, v73
    v_mul_f32 v73, v73, v26
    v_cvt_pk_bf16_f32 v73, v73, v73
    v_lshlrev_b32 v73, 16, v73
    v_sub_f32 v74, v74, v27
    v_cvt_pk_bf16_f32 v74, v74, v74
    v_lshlrev_b32 v74, 16, v74
    v_mul_f32 v74, v74, v26
    v_cvt_pk_bf16_f32 v74, v74, v74
    v_lshlrev_b32 v74, 16, v74
    v_sub_f32 v75, v75, v27
    v_cvt_pk_bf16_f32 v75, v75, v75
    v_lshlrev_b32 v75, 16, v75
    v_mul_f32 v75, v75, v26
    v_cvt_pk_bf16_f32 v75, v75, v75
    v_lshlrev_b32 v75, 16, v75
    v_sub_f32 v76, v76, v27
    v_cvt_pk_bf16_f32 v76, v76, v76
    v_lshlrev_b32 v76, 16, v76
    v_mul_f32 v76, v76, v26
    v_cvt_pk_bf16_f32 v76, v76, v76
    v_lshlrev_b32 v76, 16, v76
    v_sub_f32 v77, v77, v27
    v_cvt_pk_bf16_f32 v77, v77, v77
    v_lshlrev_b32 v77, 16, v77
    v_mul_f32 v77, v77, v26
    v_cvt_pk_bf16_f32 v77, v77, v77
    v_lshlrev_b32 v77, 16, v77
    v_sub_f32 v78, v78, v27
    v_cvt_pk_bf16_f32 v78, v78, v78
    v_lshlrev_b32 v78, 16, v78
    v_mul_f32 v78, v78, v26
    v_cvt_pk_bf16_f32 v78, v78, v78
    v_lshlrev_b32 v78, 16, v78
    v_sub_f32 v79, v79, v27
    v_cvt_pk_bf16_f32 v79, v79, v79
    v_lshlrev_b32 v79, 16, v79
    v_mul_f32 v79, v79, v26
    v_cvt_pk_bf16_f32 v79, v79, v79
    v_lshlrev_b32 v79, 16, v79
    v_mul_f32 v64, v64, v112
    v_cvt_pk_bf16_f32 v64, v64, v64
    v_lshlrev_b32 v64, 16, v64
    v_add_f32 v64, v64, v96
    v_mul_f32 v65, v65, v113
    v_cvt_pk_bf16_f32 v65, v65, v65
    v_lshlrev_b32 v65, 16, v65
    v_add_f32 v65, v65, v97
    v_mul_f32 v66, v66, v114
    v_cvt_pk_bf16_f32 v66, v66, v66
    v_lshlrev_b32 v66, 16, v66
    v_add_f32 v66, v66, v98
    v_mul_f32 v67, v67, v115
    v_cvt_pk_bf16_f32 v67, v67, v67
    v_lshlrev_b32 v67, 16, v67
    v_add_f32 v67, v67, v99
    v_mul_f32 v68, v68, v116
    v_cvt_pk_bf16_f32 v68, v68, v68
    v_lshlrev_b32 v68, 16, v68
    v_add_f32 v68, v68, v100
    v_mul_f32 v69, v69, v117
    v_cvt_pk_bf16_f32 v69, v69, v69
    v_lshlrev_b32 v69, 16, v69
    v_add_f32 v69, v69, v101
    v_mul_f32 v70, v70, v118
    v_cvt_pk_bf16_f32 v70, v70, v70
    v_lshlrev_b32 v70, 16, v70
    v_add_f32 v70, v70, v102
    v_mul_f32 v71, v71, v119
    v_cvt_pk_bf16_f32 v71, v71, v71
    v_lshlrev_b32 v71, 16, v71
    v_add_f32 v71, v71, v103
    v_mul_f32 v72, v72, v120
    v_cvt_pk_bf16_f32 v72, v72, v72
    v_lshlrev_b32 v72, 16, v72
    v_add_f32 v72, v72, v104
    v_mul_f32 v73, v73, v121
    v_cvt_pk_bf16_f32 v73, v73, v73
    v_lshlrev_b32 v73, 16, v73
    v_add_f32 v73, v73, v105
    v_mul_f32 v74, v74, v122
    v_cvt_pk_bf16_f32 v74, v74, v74
    v_lshlrev_b32 v74, 16, v74
    v_add_f32 v74, v74, v106
    v_mul_f32 v75, v75, v123
    v_cvt_pk_bf16_f32 v75, v75, v75
    v_lshlrev_b32 v75, 16, v75
    v_add_f32 v75, v75, v107
    v_mul_f32 v76, v76, v124
    v_cvt_pk_bf16_f32 v76, v76, v76
    v_lshlrev_b32 v76, 16, v76
    v_add_f32 v76, v76, v108
    v_mul_f32 v77, v77, v125
    v_cvt_pk_bf16_f32 v77, v77, v77
    v_lshlrev_b32 v77, 16, v77
    v_add_f32 v77, v77, v109
    v_mul_f32 v78, v78, v126
    v_cvt_pk_bf16_f32 v78, v78, v78
    v_lshlrev_b32 v78, 16, v78
    v_add_f32 v78, v78, v110
    v_mul_f32 v79, v79, v127
    v_cvt_pk_bf16_f32 v79, v79, v79
    v_lshlrev_b32 v79, 16, v79
    v_add_f32 v79, v79, v111
    v_cvt_pk_bf16_f32 v80, v64, v65
    v_cvt_pk_bf16_f32 v81, v66, v67
    v_cvt_pk_bf16_f32 v82, v68, v69
    v_cvt_pk_bf16_f32 v83, v70, v71
    v_cvt_pk_bf16_f32 v84, v72, v73
    v_cvt_pk_bf16_f32 v85, v74, v75
    v_cvt_pk_bf16_f32 v86, v76, v77
    v_cvt_pk_bf16_f32 v87, v78, v79
    s_lshr_b32 s45, s63, 5
    s_lshl_b32 s45, s45, 16
    s_and_b32 s46, s63, 31
    s_lshl_b32 s46, s46, 8
    s_add_u32 s45, s45, s46
    s_add_u32 s45, s45, 0x400000
    s_add_u32 s46, s45, 32768
    buffer_store_dwordx4 v[80:83], v2, s[12:15], s45 offen sc1
    buffer_store_dwordx4 v[84:87], v2, s[12:15], s46 offen sc1
    s_add_u32 s63, s63, 384
    s_cmp_ge_u32 s63, 2048
    s_cbranch_scc1 L_ln_done_107
    v_lshlrev_b32 v64, 16, v168
    v_and_b32 v65, 0xffff0000, v168
    v_lshlrev_b32 v66, 16, v169
    v_and_b32 v67, 0xffff0000, v169
    v_lshlrev_b32 v68, 16, v170
    v_and_b32 v69, 0xffff0000, v170
    v_lshlrev_b32 v70, 16, v171
    v_and_b32 v71, 0xffff0000, v171
    v_lshlrev_b32 v72, 16, v172
    v_and_b32 v73, 0xffff0000, v172
    v_lshlrev_b32 v74, 16, v173
    v_and_b32 v75, 0xffff0000, v173
    v_lshlrev_b32 v76, 16, v174
    v_and_b32 v77, 0xffff0000, v174
    v_lshlrev_b32 v78, 16, v175
    v_and_b32 v79, 0xffff0000, v175
    v_add_f32 v26, v64, v65
    v_add_f32 v26, v26, v66
    v_add_f32 v26, v26, v67
    v_add_f32 v26, v26, v68
    v_add_f32 v26, v26, v69
    v_add_f32 v26, v26, v70
    v_add_f32 v26, v26, v71
    v_add_f32 v26, v26, v72
    v_add_f32 v26, v26, v73
    v_add_f32 v26, v26, v74
    v_add_f32 v26, v26, v75
    v_add_f32 v26, v26, v76
    v_add_f32 v26, v26, v77
    v_add_f32 v26, v26, v78
    v_add_f32 v26, v26, v79
    s_nop 1
    v_add_f32_dpp v26, v26, v26 row_shr:1 row_mask:0xf bank_mask:0xf bound_ctrl:0
    s_nop 1
    v_add_f32_dpp v26, v26, v26 row_shr:2 row_mask:0xf bank_mask:0xf bound_ctrl:0
    s_nop 1
    v_add_f32_dpp v26, v26, v26 row_shr:4 row_mask:0xf bank_mask:0xf bound_ctrl:0
    s_nop 1
    v_add_f32_dpp v26, v26, v26 row_shr:8 row_mask:0xf bank_mask:0xf bound_ctrl:0
    s_nop 1
    v_add_f32_dpp v26, v26, v26 row_bcast:15 row_mask:0xa bank_mask:0xf
    s_nop 1
    v_add_f32_dpp v26, v26, v26 row_bcast:31 row_mask:0xc bank_mask:0xf
    s_nop 1
    v_readlane_b32 s66, v26, 63
    s_nop 1
    v_mov_b32 v27, s66
    v_mul_f32 v27, 0x3a800000, v27
    v_mov_b32 v26, 0
    v_sub_f32 v28, v64, v27
    v_fmac_f32 v26, v28, v28
    v_sub_f32 v28, v65, v27
    v_fmac_f32 v26, v28, v28
    v_sub_f32 v28, v66, v27
    v_fmac_f32 v26, v28, v28
    v_sub_f32 v28, v67, v27
    v_fmac_f32 v26, v28, v28
    v_sub_f32 v28, v68, v27
    v_fmac_f32 v26, v28, v28
    v_sub_f32 v28, v69, v27
    v_fmac_f32 v26, v28, v28
    v_sub_f32 v28, v70, v27
    v_fmac_f32 v26, v28, v28
    v_sub_f32 v28, v71, v27
    v_fmac_f32 v26, v28, v28
    v_sub_f32 v28, v72, v27
    v_fmac_f32 v26, v28, v28
    v_sub_f32 v28, v73, v27
    v_fmac_f32 v26, v28, v28
    v_sub_f32 v28, v74, v27
    v_fmac_f32 v26, v28, v28
    v_sub_f32 v28, v75, v27
    v_fmac_f32 v26, v28, v28
    v_sub_f32 v28, v76, v27
    v_fmac_f32 v26, v28, v28
    v_sub_f32 v28, v77, v27
    v_fmac_f32 v26, v28, v28
    v_sub_f32 v28, v78, v27
    v_fmac_f32 v26, v28, v28
    v_sub_f32 v28, v79, v27
    v_fmac_f32 v26, v28, v28
    s_nop 1
    v_add_f32_dpp v26, v26, v26 row_shr:1 row_mask:0xf bank_mask:0xf bound_ctrl:0
    s_nop 1
    v_add_f32_dpp v26, v26, v26 row_shr:2 row_mask:0xf bank_mask:0xf bound_ctrl:0
    s_nop 1
    v_add_f32_dpp v26, v26, v26 row_shr:4 row_mask:0xf bank_mask:0xf bound_ctrl:0
    s_nop 1
    v_add_f32_dpp v26, v26, v26 row_shr:8 row_mask:0xf bank_mask:0xf bound_ctrl:0
    s_nop 1
    v_add_f32_dpp v26, v26, v26 row_bcast:15 row_mask:0xa bank_mask:0xf
    s_nop 1
    v_add_f32_dpp v26, v26, v26 row_bcast:31 row_mask:0xc bank_mask:0xf
    s_nop 1
    v_readlane_b32 s66, v26, 63
    s_nop 1
    v_mov_b32 v26, s66
    v_mul_f32 v26, 0x3a800000, v26
    v_cvt_pk_bf16_f32 v26, v26, v26
    v_lshlrev_b32 v26, 16, v26
    v_cvt_pk_bf16_f32 v27, v27, v27
    v_lshlrev_b32 v27, 16, v27
    v_add_f32 v26, 0x3727c5ac, v26
    v_cvt_pk_bf16_f32 v26, v26, v26
    v_lshlrev_b32 v26, 16, v26
    v_sqrt_f32 v26, v26
    s_nop 0
    v_cvt_pk_bf16_f32 v26, v26, v26
    v_lshlrev_b32 v26, 16, v26
    v_rcp_f32 v26, v26
    s_nop 0
    v_sub_f32 v64, v64, v27
    v_cvt_pk_bf16_f32 v64, v64, v64
    v_lshlrev_b32 v64, 16, v64
    v_mul_f32 v64, v64, v26
    v_cvt_pk_bf16_f32 v64, v64, v64
    v_lshlrev_b32 v64, 16, v64
    v_sub_f32 v65, v65, v27
    v_cvt_pk_bf16_f32 v65, v65, v65
    v_lshlrev_b32 v65, 16, v65
    v_mul_f32 v65, v65, v26
    v_cvt_pk_bf16_f32 v65, v65, v65
    v_lshlrev_b32 v65, 16, v65
    v_sub_f32 v66, v66, v27
    v_cvt_pk_bf16_f32 v66, v66, v66
    v_lshlrev_b32 v66, 16, v66
    v_mul_f32 v66, v66, v26
    v_cvt_pk_bf16_f32 v66, v66, v66
    v_lshlrev_b32 v66, 16, v66
    v_sub_f32 v67, v67, v27
    v_cvt_pk_bf16_f32 v67, v67, v67
    v_lshlrev_b32 v67, 16, v67
    v_mul_f32 v67, v67, v26
    v_cvt_pk_bf16_f32 v67, v67, v67
    v_lshlrev_b32 v67, 16, v67
    v_sub_f32 v68, v68, v27
    v_cvt_pk_bf16_f32 v68, v68, v68
    v_lshlrev_b32 v68, 16, v68
    v_mul_f32 v68, v68, v26
    v_cvt_pk_bf16_f32 v68, v68, v68
    v_lshlrev_b32 v68, 16, v68
    v_sub_f32 v69, v69, v27
    v_cvt_pk_bf16_f32 v69, v69, v69
    v_lshlrev_b32 v69, 16, v69
    v_mul_f32 v69, v69, v26
    v_cvt_pk_bf16_f32 v69, v69, v69
    v_lshlrev_b32 v69, 16, v69
    v_sub_f32 v70, v70, v27
    v_cvt_pk_bf16_f32 v70, v70, v70
    v_lshlrev_b32 v70, 16, v70
    v_mul_f32 v70, v70, v26
    v_cvt_pk_bf16_f32 v70, v70, v70
    v_lshlrev_b32 v70, 16, v70
    v_sub_f32 v71, v71, v27
    v_cvt_pk_bf16_f32 v71, v71, v71
    v_lshlrev_b32 v71, 16, v71
    v_mul_f32 v71, v71, v26
    v_cvt_pk_bf16_f32 v71, v71, v71
    v_lshlrev_b32 v71, 16, v71
    v_sub_f32 v72, v72, v27
    v_cvt_pk_bf16_f32 v72, v72, v72
    v_lshlrev_b32 v72, 16, v72
    v_mul_f32 v72, v72, v26
    v_cvt_pk_bf16_f32 v72, v72, v72
    v_lshlrev_b32 v72, 16, v72
    v_sub_f32 v73, v73, v27
    v_cvt_pk_bf16_f32 v73, v73, v73
    v_lshlrev_b32 v73, 16, v73
    v_mul_f32 v73, v73, v26
    v_cvt_pk_bf16_f32 v73, v73, v73
    v_lshlrev_b32 v73, 16, v73
    v_sub_f32 v74, v74, v27
    v_cvt_pk_bf16_f32 v74, v74, v74
    v_lshlrev_b32 v74, 16, v74
    v_mul_f32 v74, v74, v26
    v_cvt_pk_bf16_f32 v74, v74, v74
    v_lshlrev_b32 v74, 16, v74
    v_sub_f32 v75, v75, v27
    v_cvt_pk_bf16_f32 v75, v75, v75
    v_lshlrev_b32 v75, 16, v75
    v_mul_f32 v75, v75, v26
    v_cvt_pk_bf16_f32 v75, v75, v75
    v_lshlrev_b32 v75, 16, v75
    v_sub_f32 v76, v76, v27
    v_cvt_pk_bf16_f32 v76, v76, v76
    v_lshlrev_b32 v76, 16, v76
    v_mul_f32 v76, v76, v26
    v_cvt_pk_bf16_f32 v76, v76, v76
    v_lshlrev_b32 v76, 16, v76
    v_sub_f32 v77, v77, v27
    v_cvt_pk_bf16_f32 v77, v77, v77
    v_lshlrev_b32 v77, 16, v77
    v_mul_f32 v77, v77, v26
    v_cvt_pk_bf16_f32 v77, v77, v77
    v_lshlrev_b32 v77, 16, v77
    v_sub_f32 v78, v78, v27
    v_cvt_pk_bf16_f32 v78, v78, v78
    v_lshlrev_b32 v78, 16, v78
    v_mul_f32 v78, v78, v26
    v_cvt_pk_bf16_f32 v78, v78, v78
    v_lshlrev_b32 v78, 16, v78
    v_sub_f32 v79, v79, v27
    v_cvt_pk_bf16_f32 v79, v79, v79
    v_lshlrev_b32 v79, 16, v79
    v_mul_f32 v79, v79, v26
    v_cvt_pk_bf16_f32 v79, v79, v79
    v_lshlrev_b32 v79, 16, v79
    v_mul_f32 v64, v64, v112
    v_cvt_pk_bf16_f32 v64, v64, v64
    v_lshlrev_b32 v64, 16, v64
    v_add_f32 v64, v64, v96
    v_mul_f32 v65, v65, v113
    v_cvt_pk_bf16_f32 v65, v65, v65
    v_lshlrev_b32 v65, 16, v65
    v_add_f32 v65, v65, v97
    v_mul_f32 v66, v66, v114
    v_cvt_pk_bf16_f32 v66, v66, v66
    v_lshlrev_b32 v66, 16, v66
    v_add_f32 v66, v66, v98
    v_mul_f32 v67, v67, v115
    v_cvt_pk_bf16_f32 v67, v67, v67
    v_lshlrev_b32 v67, 16, v67
    v_add_f32 v67, v67, v99
    v_mul_f32 v68, v68, v116
    v_cvt_pk_bf16_f32 v68, v68, v68
    v_lshlrev_b32 v68, 16, v68
    v_add_f32 v68, v68, v100
    v_mul_f32 v69, v69, v117
    v_cvt_pk_bf16_f32 v69, v69, v69
    v_lshlrev_b32 v69, 16, v69
    v_add_f32 v69, v69, v101
    v_mul_f32 v70, v70, v118
    v_cvt_pk_bf16_f32 v70, v70, v70
    v_lshlrev_b32 v70, 16, v70
    v_add_f32 v70, v70, v102
    v_mul_f32 v71, v71, v119
    v_cvt_pk_bf16_f32 v71, v71, v71
    v_lshlrev_b32 v71, 16, v71
    v_add_f32 v71, v71, v103
    v_mul_f32 v72, v72, v120
    v_cvt_pk_bf16_f32 v72, v72, v72
    v_lshlrev_b32 v72, 16, v72
    v_add_f32 v72, v72, v104
    v_mul_f32 v73, v73, v121
    v_cvt_pk_bf16_f32 v73, v73, v73
    v_lshlrev_b32 v73, 16, v73
    v_add_f32 v73, v73, v105
    v_mul_f32 v74, v74, v122
    v_cvt_pk_bf16_f32 v74, v74, v74
    v_lshlrev_b32 v74, 16, v74
    v_add_f32 v74, v74, v106
    v_mul_f32 v75, v75, v123
    v_cvt_pk_bf16_f32 v75, v75, v75
    v_lshlrev_b32 v75, 16, v75
    v_add_f32 v75, v75, v107
    v_mul_f32 v76, v76, v124
    v_cvt_pk_bf16_f32 v76, v76, v76
    v_lshlrev_b32 v76, 16, v76
    v_add_f32 v76, v76, v108
    v_mul_f32 v77, v77, v125
    v_cvt_pk_bf16_f32 v77, v77, v77
    v_lshlrev_b32 v77, 16, v77
    v_add_f32 v77, v77, v109
    v_mul_f32 v78, v78, v126
    v_cvt_pk_bf16_f32 v78, v78, v78
    v_lshlrev_b32 v78, 16, v78
    v_add_f32 v78, v78, v110
    v_mul_f32 v79, v79, v127
    v_cvt_pk_bf16_f32 v79, v79, v79
    v_lshlrev_b32 v79, 16, v79
    v_add_f32 v79, v79, v111
    v_cvt_pk_bf16_f32 v80, v64, v65
    v_cvt_pk_bf16_f32 v81, v66, v67
    v_cvt_pk_bf16_f32 v82, v68, v69
    v_cvt_pk_bf16_f32 v83, v70, v71
    v_cvt_pk_bf16_f32 v84, v72, v73
    v_cvt_pk_bf16_f32 v85, v74, v75
    v_cvt_pk_bf16_f32 v86, v76, v77
    v_cvt_pk_bf16_f32 v87, v78, v79
    s_lshr_b32 s45, s63, 5
    s_lshl_b32 s45, s45, 16
    s_and_b32 s46, s63, 31
    s_lshl_b32 s46, s46, 8
    s_add_u32 s45, s45, s46
    s_add_u32 s45, s45, 0x400000
    s_add_u32 s46, s45, 32768
    buffer_store_dwordx4 v[80:83], v2, s[12:15], s45 offen sc1
    buffer_store_dwordx4 v[84:87], v2, s[12:15], s46 offen sc1
    s_add_u32 s63, s63, 384
L_ln_done_107:
    s_waitcnt vmcnt(0)
    s_barrier
    s_cmp_lg_u32 s44, 0
    s_cbranch_scc1 L_cnt_109
    v_mov_b32 v30, 1
    v_mov_b32 v31, 127104
    s_mov_b64 exec, 1
    buffer_atomic_add v30, v31, s[12:15], 0 offen sc1
    s_mov_b64 exec, -1
L_cnt_109:
    s_add_u32 s39, s39, 96
    s_load_dwordx2 s[4:5], s[0:1], 96
    s_load_dwordx2 s[6:7], s[0:1], 104
    v_and_b32 v14, 7, v0
    v_lshrrev_b32 v15, 3, v0
    s_waitcnt lgkmcnt(0)
    s_mov_b32 s32, s4
    s_and_b32 s33, s5, 0xffff
    s_mov_b32 s34, 0x800
    s_mov_b32 s35, 0x00020000
    s_mov_b32 s24, s6
    s_and_b32 s25, s7, 0xffff
    s_mov_b32 s26, 0xc00000
    s_mov_b32 s27, 0x00020000
    s_and_b32 s47, s39, 1
    s_lshl_b32 s45, s47, 10
    v_lshlrev_b32 v16, 5, v15
    buffer_load_dwordx4 v[104:107], v16, s[32:35], s45 offen
    buffer_load_dwordx4 v[108:111], v16, s[32:35], s45 offen offset:16
    s_mov_b32 s45, 196608
    v_mul_lo_u32 v17, v15, s45
    v_lshlrev_b32 v18, 4, v14
    v_add_u32 v17, v17, v18
    s_lshr_b32 s46, s39, 1
    s_lshl_b32 s46, s46, 7
    s_mul_i32 s45, s47, 6291456
    s_add_u32 s46, s46, s45
    buffer_load_dwordx4 v[32:35], v17, s[24:27], s46 offen
    v_add_u32 v17, 12288, v17
    buffer_load_dwordx4 v[36:39], v17, s[24:27], s46 offen
    v_add_u32 v17, 12288, v17
    buffer_load_dwordx4 v[40:43], v17, s[24:27], s46 offen
    v_add_u32 v17, 12288, v17
    buffer_load_dwordx4 v[44:47], v17, s[24:27], s46 offen
    v_add_u32 v17, 12288, v17
    buffer_load_dwordx4 v[48:51], v17, s[24:27], s46 offen
    v_add_u32 v17, 12288, v17
    buffer_load_dwordx4 v[52:55], v17, s[24:27], s46 offen
    v_add_u32 v17, 12288, v17
    buffer_load_dwordx4 v[56:59], v17, s[24:27], s46 offen
    v_add_u32 v17, 12288, v17
    buffer_load_dwordx4 v[60:63], v17, s[24:27], s46 offen
    v_add_u32 v17, 12288, v17
    buffer_load_dwordx4 v[64:67], v17, s[24:27], s46 offen
    v_add_u32 v17, 12288, v17
    buffer_load_dwordx4 v[68:71], v17, s[24:27], s46 offen
    v_add_u32 v17, 12288, v17
    buffer_load_dwordx4 v[72:75], v17, s[24:27], s46 offen
    v_add_u32 v17, 12288, v17
    buffer_load_dwordx4 v[76:79], v17, s[24:27], s46 offen
    v_add_u32 v17, 12288, v17
    buffer_load_dwordx4 v[80:83], v17, s[24:27], s46 offen
    v_add_u32 v17, 12288, v17
    buffer_load_dwordx4 v[84:87], v17, s[24:27], s46 offen
    v_add_u32 v17, 12288, v17
    buffer_load_dwordx4 v[88:91], v17, s[24:27], s46 offen
    v_add_u32 v17, 12288, v17
    buffer_load_dwordx4 v[92:95], v17, s[24:27], s46 offen
    s_waitcnt vmcnt(16)
    v_lshlrev_b32 v112, 16, v104
    v_and_b32 v113, 0xffff0000, v104
    v_lshlrev_b32 v114, 16, v105
    v_and_b32 v115, 0xffff0000, v105
    v_lshlrev_b32 v116, 16, v106
    v_and_b32 v117, 0xffff0000, v106
    v_lshlrev_b32 v118, 16, v107
    v_and_b32 v119, 0xffff0000, v107
    v_lshlrev_b32 v120, 16, v108
    v_and_b32 v121, 0xffff0000, v108
    v_lshlrev_b32 v122, 16, v109
    v_and_b32 v123, 0xffff0000, v109
    v_lshlrev_b32 v124, 16, v110
    v_and_b32 v125, 0xffff0000, v110
    v_lshlrev_b32 v126, 16, v111
    v_and_b32 v127, 0xffff0000, v111
    v_mul_f32 v18, 0xbfb8aa3b, v112
    v_exp_f32 v18, v18
    s_nop 0
    v_add_f32 v18, 1.0, v18
    v_rcp_f32 v18, v18
    s_nop 0
    v_mul_f32 v112, v112, v18
    v_cvt_pk_bf16_f32 v112, v112, v112
    v_lshlrev_b32 v112, 16, v112
    v_mul_f32 v18, 0xbfb8aa3b, v113
    v_exp_f32 v18, v18
    s_nop 0
    v_add_f32 v18, 1.0, v18
    v_rcp_f32 v18, v18
    s_nop 0
    v_mul_f32 v113, v113, v18
    v_cvt_pk_bf16_f32 v113, v113, v113
    v_lshlrev_b32 v113, 16, v113
    v_mul_f32 v18, 0xbfb8aa3b, v114
    v_exp_f32 v18, v18
    s_nop 0
    v_add_f32 v18, 1.0, v18
    v_rcp_f32 v18, v18
    s_nop 0
    v_mul_f32 v114, v114, v18
    v_cvt_pk_bf16_f32 v114, v114, v114
    v_lshlrev_b32 v114, 16, v114
    v_mul_f32 v18, 0xbfb8aa3b, v115
    v_exp_f32 v18, v18
    s_nop 0
    v_add_f32 v18, 1.0, v18
    v_rcp_f32 v18, v18
    s_nop 0
    v_mul_f32 v115, v115, v18
    v_cvt_pk_bf16_f32 v115, v115, v115
    v_lshlrev_b32 v115, 16, v115
    v_mul_f32 v18, 0xbfb8aa3b, v116
    v_exp_f32 v18, v18
    s_nop 0
    v_add_f32 v18, 1.0, v18
    v_rcp_f32 v18, v18
    s_nop 0
    v_mul_f32 v116, v116, v18
    v_cvt_pk_bf16_f32 v116, v116, v116
    v_lshlrev_b32 v116, 16, v116
    v_mul_f32 v18, 0xbfb8aa3b, v117
    v_exp_f32 v18, v18
    s_nop 0
    v_add_f32 v18, 1.0, v18
    v_rcp_f32 v18, v18
    s_nop 0
    v_mul_f32 v117, v117, v18
    v_cvt_pk_bf16_f32 v117, v117, v117
    v_lshlrev_b32 v117, 16, v117
    v_mul_f32 v18, 0xbfb8aa3b, v118
    v_exp_f32 v18, v18
    s_nop 0
    v_add_f32 v18, 1.0, v18
    v_rcp_f32 v18, v18
    s_nop 0
    v_mul_f32 v118, v118, v18
    v_cvt_pk_bf16_f32 v118, v118, v118
    v_lshlrev_b32 v118, 16, v118
    v_mul_f32 v18, 0xbfb8aa3b, v119
    v_exp_f32 v18, v18
    s_nop 0
    v_add_f32 v18, 1.0, v18
    v_rcp_f32 v18, v18
    s_nop 0
    v_mul_f32 v119, v119, v18
    v_cvt_pk_bf16_f32 v119, v119, v119
    v_lshlrev_b32 v119, 16, v119
    v_mul_f32 v18, 0xbfb8aa3b, v120
    v_exp_f32 v18, v18
    s_nop 0
    v_add_f32 v18, 1.0, v18
    v_rcp_f32 v18, v18
    s_nop 0
    v_mul_f32 v120, v120, v18
    v_cvt_pk_bf16_f32 v120, v120, v120
    v_lshlrev_b32 v120, 16, v120
    v_mul_f32 v18, 0xbfb8aa3b, v121
    v_exp_f32 v18, v18
    s_nop 0
    v_add_f32 v18, 1.0, v18
    v_rcp_f32 v18, v18
    s_nop 0
    v_mul_f32 v121, v121, v18
    v_cvt_pk_bf16_f32 v121, v121, v121
    v_lshlrev_b32 v121, 16, v121
    v_mul_f32 v18, 0xbfb8aa3b, v122
    v_exp_f32 v18, v18
    s_nop 0
    v_add_f32 v18, 1.0, v18
    v_rcp_f32 v18, v18
    s_nop 0
    v_mul_f32 v122, v122, v18
    v_cvt_pk_bf16_f32 v122, v122, v122
    v_lshlrev_b32 v122, 16, v122
    v_mul_f32 v18, 0xbfb8aa3b, v123
    v_exp_f32 v18, v18
    s_nop 0
    v_add_f32 v18, 1.0, v18
    v_rcp_f32 v18, v18
    s_nop 0
    v_mul_f32 v123, v123, v18
    v_cvt_pk_bf16_f32 v123, v123, v123
    v_lshlrev_b32 v123, 16, v123
    v_mul_f32 v18, 0xbfb8aa3b, v124
    v_exp_f32 v18, v18
    s_nop 0
    v_add_f32 v18, 1.0, v18
    v_rcp_f32 v18, v18
    s_nop 0
    v_mul_f32 v124, v124, v18
    v_cvt_pk_bf16_f32 v124, v124, v124
    v_lshlrev_b32 v124, 16, v124
    v_mul_f32 v18, 0xbfb8aa3b, v125
    v_exp_f32 v18, v18
    s_nop 0
    v_add_f32 v18, 1.0, v18
    v_rcp_f32 v18, v18
    s_nop 0
    v_mul_f32 v125, v125, v18
    v_cvt_pk_bf16_f32 v125, v125, v125
    v_lshlrev_b32 v125, 16, v125
    v_mul_f32 v18, 0xbfb8aa3b, v126
    v_exp_f32 v18, v18
    s_nop 0
    v_add_f32 v18, 1.0, v18
    v_rcp_f32 v18, v18
    s_nop 0
    v_mul_f32 v126, v126, v18
    v_cvt_pk_bf16_f32 v126, v126, v126
    v_lshlrev_b32 v126, 16, v126
    v_mul_f32 v18, 0xbfb8aa3b, v127
    v_exp_f32 v18, v18
    s_nop 0
    v_add_f32 v18, 1.0, v18
    v_rcp_f32 v18, v18
    s_nop 0
    v_mul_f32 v127, v127, v18
    v_cvt_pk_bf16_f32 v127, v127, v127
    v_lshlrev_b32 v127, 16, v127
    v_mov_b32 v96, 0
    v_mov_b32 v97, 0
    v_mov_b32 v98, 0
    v_mov_b32 v99, 0
    v_mov_b32 v100, 0
    v_mov_b32 v101, 0
    v_mov_b32 v102, 0
    v_mov_b32 v103, 0
    s_waitcnt vmcnt(15)
    v_lshlrev_b32 v18, 16, v32
    v_and_b32 v19, 0xffff0000, v32
    v_fmac_f32 v96, v18, v112
    v_fmac_f32 v97, v19, v112
    v_lshlrev_b32 v18, 16, v33
    v_and_b32 v19, 0xffff0000, v33
    v_fmac_f32 v98, v18, v112
    v_fmac_f32 v99, v19, v112
    v_lshlrev_b32 v18, 16, v34
    v_and_b32 v19, 0xffff0000, v34
    v_fmac_f32 v100, v18, v112
    v_fmac_f32 v101, v19, v112
    v_lshlrev_b32 v18, 16, v35
    v_and_b32 v19, 0xffff0000, v35
    v_fmac_f32 v102, v18, v112
    v_fmac_f32 v103, v19, v112
    s_waitcnt vmcnt(14)
    v_lshlrev_b32 v18, 16, v36
    v_and_b32 v19, 0xffff0000, v36
    v_fmac_f32 v96, v18, v113
    v_fmac_f32 v97, v19, v113
    v_lshlrev_b32 v18, 16, v37
    v_and_b32 v19, 0xffff0000, v37
    v_fmac_f32 v98, v18, v113
    v_fmac_f32 v99, v19, v113
    v_lshlrev_b32 v18, 16, v38
    v_and_b32 v19, 0xffff0000, v38
    v_fmac_f32 v100, v18, v113
    v_fmac_f32 v101, v19, v113
    v_lshlrev_b32 v18, 16, v39
    v_and_b32 v19, 0xffff0000, v39
    v_fmac_f32 v102, v18, v113
    v_fmac_f32 v103, v19, v113
    s_waitcnt vmcnt(13)
    v_lshlrev_b32 v18, 16, v40
    v_and_b32 v19, 0xffff0000, v40
    v_fmac_f32 v96, v18, v114
    v_fmac_f32 v97, v19, v114
    v_lshlrev_b32 v18, 16, v41
    v_and_b32 v19, 0xffff0000, v41
    v_fmac_f32 v98, v18, v114
    v_fmac_f32 v99, v19, v114
    v_lshlrev_b32 v18, 16, v42
    v_and_b32 v19, 0xffff0000, v42
    v_fmac_f32 v100, v18, v114
    v_fmac_f32 v101, v19, v114
    v_lshlrev_b32 v18, 16, v43
    v_and_b32 v19, 0xffff0000, v43
    v_fmac_f32 v102, v18, v114
    v_fmac_f32 v103, v19, v114
    s_waitcnt vmcnt(12)
    v_lshlrev_b32 v18, 16, v44
    v_and_b32 v19, 0xffff0000, v44
    v_fmac_f32 v96, v18, v115
    v_fmac_f32 v97, v19, v115
    v_lshlrev_b32 v18, 16, v45
    v_and_b32 v19, 0xffff0000, v45
    v_fmac_f32 v98, v18, v115
    v_fmac_f32 v99, v19, v115
    v_lshlrev_b32 v18, 16, v46
    v_and_b32 v19, 0xffff0000, v46
    v_fmac_f32 v100, v18, v115
    v_fmac_f32 v101, v19, v115
    v_lshlrev_b32 v18, 16, v47
    v_and_b32 v19, 0xffff0000, v47
    v_fmac_f32 v102, v18, v115
    v_fmac_f32 v103, v19, v115
    s_waitcnt vmcnt(11)
    v_lshlrev_b32 v18, 16, v48
    v_and_b32 v19, 0xffff0000, v48
    v_fmac_f32 v96, v18, v116
    v_fmac_f32 v97, v19, v116
    v_lshlrev_b32 v18, 16, v49
    v_and_b32 v19, 0xffff0000, v49
    v_fmac_f32 v98, v18, v116
    v_fmac_f32 v99, v19, v116
    v_lshlrev_b32 v18, 16, v50
    v_and_b32 v19, 0xffff0000, v50
    v_fmac_f32 v100, v18, v116
    v_fmac_f32 v101, v19, v116
    v_lshlrev_b32 v18, 16, v51
    v_and_b32 v19, 0xffff0000, v51
    v_fmac_f32 v102, v18, v116
    v_fmac_f32 v103, v19, v116
    s_waitcnt vmcnt(10)
    v_lshlrev_b32 v18, 16, v52
    v_and_b32 v19, 0xffff0000, v52
    v_fmac_f32 v96, v18, v117
    v_fmac_f32 v97, v19, v117
    v_lshlrev_b32 v18, 16, v53
    v_and_b32 v19, 0xffff0000, v53
    v_fmac_f32 v98, v18, v117
    v_fmac_f32 v99, v19, v117
    v_lshlrev_b32 v18, 16, v54
    v_and_b32 v19, 0xffff0000, v54
    v_fmac_f32 v100, v18, v117
    v_fmac_f32 v101, v19, v117
    v_lshlrev_b32 v18, 16, v55
    v_and_b32 v19, 0xffff0000, v55
    v_fmac_f32 v102, v18, v117
    v_fmac_f32 v103, v19, v117
    s_waitcnt vmcnt(9)
    v_lshlrev_b32 v18, 16, v56
    v_and_b32 v19, 0xffff0000, v56
    v_fmac_f32 v96, v18, v118
    v_fmac_f32 v97, v19, v118
    v_lshlrev_b32 v18, 16, v57
    v_and_b32 v19, 0xffff0000, v57
    v_fmac_f32 v98, v18, v118
    v_fmac_f32 v99, v19, v118
    v_lshlrev_b32 v18, 16, v58
    v_and_b32 v19, 0xffff0000, v58
    v_fmac_f32 v100, v18, v118
    v_fmac_f32 v101, v19, v118
    v_lshlrev_b32 v18, 16, v59
    v_and_b32 v19, 0xffff0000, v59
    v_fmac_f32 v102, v18, v118
    v_fmac_f32 v103, v19, v118
    s_waitcnt vmcnt(8)
    v_lshlrev_b32 v18, 16, v60
    v_and_b32 v19, 0xffff0000, v60
    v_fmac_f32 v96, v18, v119
    v_fmac_f32 v97, v19, v119
    v_lshlrev_b32 v18, 16, v61
    v_and_b32 v19, 0xffff0000, v61
    v_fmac_f32 v98, v18, v119
    v_fmac_f32 v99, v19, v119
    v_lshlrev_b32 v18, 16, v62
    v_and_b32 v19, 0xffff0000, v62
    v_fmac_f32 v100, v18, v119
    v_fmac_f32 v101, v19, v119
    v_lshlrev_b32 v18, 16, v63
    v_and_b32 v19, 0xffff0000, v63
    v_fmac_f32 v102, v18, v119
    v_fmac_f32 v103, v19, v119
    s_waitcnt vmcnt(7)
    v_lshlrev_b32 v18, 16, v64
    v_and_b32 v19, 0xffff0000, v64
    v_fmac_f32 v96, v18, v120
    v_fmac_f32 v97, v19, v120
    v_lshlrev_b32 v18, 16, v65
    v_and_b32 v19, 0xffff0000, v65
    v_fmac_f32 v98, v18, v120
    v_fmac_f32 v99, v19, v120
    v_lshlrev_b32 v18, 16, v66
    v_and_b32 v19, 0xffff0000, v66
    v_fmac_f32 v100, v18, v120
    v_fmac_f32 v101, v19, v120
    v_lshlrev_b32 v18, 16, v67
    v_and_b32 v19, 0xffff0000, v67
    v_fmac_f32 v102, v18, v120
    v_fmac_f32 v103, v19, v120
    s_waitcnt vmcnt(6)
    v_lshlrev_b32 v18, 16, v68
    v_and_b32 v19, 0xffff0000, v68
    v_fmac_f32 v96, v18, v121
    v_fmac_f32 v97, v19, v121
    v_lshlrev_b32 v18, 16, v69
    v_and_b32 v19, 0xffff0000, v69
    v_fmac_f32 v98, v18, v121
    v_fmac_f32 v99, v19, v121
    v_lshlrev_b32 v18, 16, v70
    v_and_b32 v19, 0xffff0000, v70
    v_fmac_f32 v100, v18, v121
    v_fmac_f32 v101, v19, v121
    v_lshlrev_b32 v18, 16, v71
    v_and_b32 v19, 0xffff0000, v71
    v_fmac_f32 v102, v18, v121
    v_fmac_f32 v103, v19, v121
    s_waitcnt vmcnt(5)
    v_lshlrev_b32 v18, 16, v72
    v_and_b32 v19, 0xffff0000, v72
    v_fmac_f32 v96, v18, v122
    v_fmac_f32 v97, v19, v122
    v_lshlrev_b32 v18, 16, v73
    v_and_b32 v19, 0xffff0000, v73
    v_fmac_f32 v98, v18, v122
    v_fmac_f32 v99, v19, v122
    v_lshlrev_b32 v18, 16, v74
    v_and_b32 v19, 0xffff0000, v74
    v_fmac_f32 v100, v18, v122
    v_fmac_f32 v101, v19, v122
    v_lshlrev_b32 v18, 16, v75
    v_and_b32 v19, 0xffff0000, v75
    v_fmac_f32 v102, v18, v122
    v_fmac_f32 v103, v19, v122
    s_waitcnt vmcnt(4)
    v_lshlrev_b32 v18, 16, v76
    v_and_b32 v19, 0xffff0000, v76
    v_fmac_f32 v96, v18, v123
    v_fmac_f32 v97, v19, v123
    v_lshlrev_b32 v18, 16, v77
    v_and_b32 v19, 0xffff0000, v77
    v_fmac_f32 v98, v18, v123
    v_fmac_f32 v99, v19, v123
    v_lshlrev_b32 v18, 16, v78
    v_and_b32 v19, 0xffff0000, v78
    v_fmac_f32 v100, v18, v123
    v_fmac_f32 v101, v19, v123
    v_lshlrev_b32 v18, 16, v79
    v_and_b32 v19, 0xffff0000, v79
    v_fmac_f32 v102, v18, v123
    v_fmac_f32 v103, v19, v123
    s_waitcnt vmcnt(3)
    v_lshlrev_b32 v18, 16, v80
    v_and_b32 v19, 0xffff0000, v80
    v_fmac_f32 v96, v18, v124
    v_fmac_f32 v97, v19, v124
    v_lshlrev_b32 v18, 16, v81
    v_and_b32 v19, 0xffff0000, v81
    v_fmac_f32 v98, v18, v124
    v_fmac_f32 v99, v19, v124
    v_lshlrev_b32 v18, 16, v82
    v_and_b32 v19, 0xffff0000, v82
    v_fmac_f32 v100, v18, v124
    v_fmac_f32 v101, v19, v124
    v_lshlrev_b32 v18, 16, v83
    v_and_b32 v19, 0xffff0000, v83
    v_fmac_f32 v102, v18, v124
    v_fmac_f32 v103, v19, v124
    s_waitcnt vmcnt(2)
    v_lshlrev_b32 v18, 16, v84
    v_and_b32 v19, 0xffff0000, v84
    v_fmac_f32 v96, v18, v125
    v_fmac_f32 v97, v19, v125
    v_lshlrev_b32 v18, 16, v85
    v_and_b32 v19, 0xffff0000, v85
    v_fmac_f32 v98, v18, v125
    v_fmac_f32 v99, v19, v125
    v_lshlrev_b32 v18, 16, v86
    v_and_b32 v19, 0xffff0000, v86
    v_fmac_f32 v100, v18, v125
    v_fmac_f32 v101, v19, v125
    v_lshlrev_b32 v18, 16, v87
    v_and_b32 v19, 0xffff0000, v87
    v_fmac_f32 v102, v18, v125
    v_fmac_f32 v103, v19, v125
    s_waitcnt vmcnt(1)
    v_lshlrev_b32 v18, 16, v88
    v_and_b32 v19, 0xffff0000, v88
    v_fmac_f32 v96, v18, v126
    v_fmac_f32 v97, v19, v126
    v_lshlrev_b32 v18, 16, v89
    v_and_b32 v19, 0xffff0000, v89
    v_fmac_f32 v98, v18, v126
    v_fmac_f32 v99, v19, v126
    v_lshlrev_b32 v18, 16, v90
    v_and_b32 v19, 0xffff0000, v90
    v_fmac_f32 v100, v18, v126
    v_fmac_f32 v101, v19, v126
    v_lshlrev_b32 v18, 16, v91
    v_and_b32 v19, 0xffff0000, v91
    v_fmac_f32 v102, v18, v126
    v_fmac_f32 v103, v19, v126
    s_waitcnt vmcnt(0)
    v_lshlrev_b32 v18, 16, v92
    v_and_b32 v19, 0xffff0000, v92
    v_fmac_f32 v96, v18, v127
    v_fmac_f32 v97, v19, v127
    v_lshlrev_b32 v18, 16, v93
    v_and_b32 v19, 0xffff0000, v93
    v_fmac_f32 v98, v18, v127
    v_fmac_f32 v99, v19, v127
    v_lshlrev_b32 v18, 16, v94
    v_and_b32 v19, 0xffff0000, v94
    v_fmac_f32 v100, v18, v127
    v_fmac_f32 v101, v19, v127
    v_lshlrev_b32 v18, 16, v95
    v_and_b32 v19, 0xffff0000, v95
    v_fmac_f32 v102, v18, v127
    v_fmac_f32 v103, v19, v127
    v_lshlrev_b32 v16, 5, v0
    ds_write_b128 v16, v[96:99]
    ds_write_b128 v16, v[100:103] offset:16
    s_waitcnt lgkmcnt(0)
    s_barrier
    s_cmp_lg_u32 s44, 0
    s_cbranch_scc1 L_mod_fin_110
    v_mov_b32 v18, 0
    ds_read_b32 v32, v12 offset:0
    ds_read_b32 v33, v12 offset:256
    ds_read_b32 v34, v12 offset:512
    ds_read_b32 v35, v12 offset:768
    ds_read_b32 v36, v12 offset:1024
    ds_read_b32 v37, v12 offset:1280
    ds_read_b32 v38, v12 offset:1536
    ds_read_b32 v39, v12 offset:1792
    ds_read_b32 v40, v12 offset:2048
    ds_read_b32 v41, v12 offset:2304
    ds_read_b32 v42, v12 offset:2560
    ds_read_b32 v43, v12 offset:2816
    ds_read_b32 v44, v12 offset:3072
    ds_read_b32 v45, v12 offset:3328
    ds_read_b32 v46, v12 offset:3584
    ds_read_b32 v47, v12 offset:3840
    s_waitcnt lgkmcnt(0)
    v_add_f32 v18, v18, v32
    v_add_f32 v18, v18, v33
    v_add_f32 v18, v18, v34
    v_add_f32 v18, v18, v35
    v_add_f32 v18, v18, v36
    v_add_f32 v18, v18, v37
    v_add_f32 v18, v18, v38
    v_add_f32 v18, v18, v39
    v_add_f32 v18, v18, v40
    v_add_f32 v18, v18, v41
    v_add_f32 v18, v18, v42
    v_add_f32 v18, v18, v43
    v_add_f32 v18, v18, v44
    v_add_f32 v18, v18, v45
    v_add_f32 v18, v18, v46
    v_add_f32 v18, v18, v47
    ds_read_b32 v32, v12 offset:4096
    ds_read_b32 v33, v12 offset:4352
    ds_read_b32 v34, v12 offset:4608
    ds_read_b32 v35, v12 offset:4864
    ds_read_b32 v36, v12 offset:5120
    ds_read_b32 v37, v12 offset:5376
    ds_read_b32 v38, v12 offset:5632
    ds_read_b32 v39, v12 offset:5888
    ds_read_b32 v40, v12 offset:6144
    ds_read_b32 v41, v12 offset:6400
    ds_read_b32 v42, v12 offset:6656
    ds_read_b32 v43, v12 offset:6912
    ds_read_b32 v44, v12 offset:7168
    ds_read_b32 v45, v12 offset:7424
    ds_read_b32 v46, v12 offset:7680
    ds_read_b32 v47, v12 offset:7936
    s_waitcnt lgkmcnt(0)
    v_add_f32 v18, v18, v32
    v_add_f32 v18, v18, v33
    v_add_f32 v18, v18, v34
    v_add_f32 v18, v18, v35
    v_add_f32 v18, v18, v36
    v_add_f32 v18, v18, v37
    v_add_f32 v18, v18, v38
    v_add_f32 v18, v18, v39
    v_add_f32 v18, v18, v40
    v_add_f32 v18, v18, v41
    v_add_f32 v18, v18, v42
    v_add_f32 v18, v18, v43
    v_add_f32 v18, v18, v44
    v_add_f32 v18, v18, v45
    v_add_f32 v18, v18, v46
    v_add_f32 v18, v18, v47
    s_lshr_b32 s45, s39, 1
    s_lshl_b32 s45, s45, 8
    s_mul_i32 s46, s47, 24576
    s_add_u32 s45, s45, s46
    buffer_store_dword v18, v12, s[12:15], s45 offen sc1
L_mod_fin_110:
    s_waitcnt vmcnt(0)
    s_barrier
    s_cmp_lg_u32 s44, 0
    s_cbranch_scc1 L_cnt_111
    v_mov_b32 v30, 1
    v_mov_b32 v31, 127232
    s_mov_b64 exec, 1
    buffer_atomic_add v30, v31, s[12:15], 0 offen sc1
    s_mov_b64 exec, -1
L_cnt_111:
    s_sub_u32 s90, 2, s43
    s_cmp_eq_u32 s43, 2
    s_cselect_b32 s51, 22, 10
    s_cmp_eq_u32 s43, 0
    s_cselect_b32 s51, 0, s51
    s_cmp_eq_u32 s51, 0
    s_cbranch_scc1 L_w_roles_100
    s_sub_u32 s60, 64, s51
    s_mov_b32 s91, 64
    s_mov_b32 s71, 127104
    s_lshl_b32 s61, s41, 7
    s_lshl_b32 s45, s90, 2
    s_add_u32 s61, s61, s45
    s_add_u32 s61, s61, 0x10020
    s_branch L_w_kv_99_h
L_w_kv_99:
    s_mov_b32 s90, s43
    s_mov_b32 s60, 0
    s_mov_b32 s51, 1
    s_mov_b32 s71, 126976
    s_cmp_eq_u32 s43, 0
    s_cselect_b32 s91, 42, 54
    s_cmp_eq_u32 s43, 2
    s_cselect_b32 s91, 64, s91
L_w_kv_99_h:
    s_lshl_b32 s45, s90, 3
    s_add_u32 s45, s45, 16
    s_load_dwordx2 s[6:7], s[0:1], s45
    s_waitcnt lgkmcnt(0)
    s_mov_b32 s24, s6
    s_and_b32 s25, s7, 0xffff
    s_mov_b32 s26, 0x800000
    s_mov_b32 s27, 0x00020000
    s_lshl_b32 s46, s41, 8
    s_barrier
    v_lshrrev_b32 v20, 4, v1
    s_lshl_b32 s45, s44, 2
    v_add_u32 v21, s45, v20
    s_mov_b32 s45, 8192
    v_mul_lo_u32 v21, v21, s45
    v_lshlrev_b32 v22, 2, v20
    v_and_b32 v23, 15, v1
    v_xor_b32 v22, v22, v23
    v_lshlrev_b32 v22, 4, v22
    v_add_u32 v21, v21, v22
    v_bfe_u32 v22, v1, 2, 2
    v_lshlrev_b32 v23, 3, v20
    v_add_u32 v23, v23, v22
    v_lshlrev_b32 v23, 8, v23
    v_xor_b32 v22, s44, v22
    v_lshlrev_b32 v22, 6, v22
    v_add_u32 v23, v23, v22
    v_and_b32 v22, 3, v1
    v_lshlrev_b32 v22, 4, v22
    v_add_u32 v23, v23, v22
    v_add_u32 v24, 65536, v23
    v_add_u32 v25, 131072, v23
    s_lshl_b32 s47, s44, 10
    s_add_u32 s45, s46, 0x0
    s_add_u32 m0, s47, 0
    s_nop 0
    buffer_load_dwordx4 v21, s[24:27], s45 offen  lds
    s_add_u32 s45, s46, 0x20000
    s_add_u32 m0, s47, 4096
    s_nop 0
    buffer_load_dwordx4 v21, s[24:27], s45 offen  lds
    s_add_u32 s45, s46, 0x40000
    s_add_u32 m0, s47, 8192
    s_nop 0
    buffer_load_dwordx4 v21, s[24:27], s45 offen  lds
    s_add_u32 s45, s46, 0x60000
    s_add_u32 m0, s47, 12288
    s_nop 0
    buffer_load_dwordx4 v21, s[24:27], s45 offen  lds
    s_add_u32 s45, s46, 0x80000
    s_add_u32 m0, s47, 16384
    s_nop 0
    buffer_load_dwordx4 v21, s[24:27], s45 offen  lds
    s_add_u32 s45, s46, 0xa0000
    s_add_u32 m0, s47, 20480
    s_nop 0
    buffer_load_dwordx4 v21, s[24:27], s45 offen  lds
    s_add_u32 s45, s46, 0xc0000
    s_add_u32 m0, s47, 24576
    s_nop 0
    buffer_load_dwordx4 v21, s[24:27], s45 offen  lds
    s_add_u32 s45, s46, 0xe0000
    s_add_u32 m0, s47, 28672
    s_nop 0
    buffer_load_dwordx4 v21, s[24:27], s45 offen  lds
    s_add_u32 s45, s46, 0x100000
    s_add_u32 m0, s47, 32768
    s_nop 0
    buffer_load_dwordx4 v21, s[24:27], s45 offen  lds
    s_add_u32 s45, s46, 0x120000
    s_add_u32 m0, s47, 36864
    s_nop 0
    buffer_load_dwordx4 v21, s[24:27], s45 offen  lds
    s_add_u32 s45, s46, 0x140000
    s_add_u32 m0, s47, 40960
    s_nop 0
    buffer_load_dwordx4 v21, s[24:27], s45 offen  lds
    s_add_u32 s45, s46, 0x160000
    s_add_u32 m0, s47, 45056
    s_nop 0
    buffer_load_dwordx4 v21, s[24:27], s45 offen  lds
    s_add_u32 s45, s46, 0x180000
    s_add_u32 m0, s47, 49152
    s_nop 0
    buffer_load_dwordx4 v21, s[24:27], s45 offen  lds
    s_add_u32 s45, s46, 0x1a0000
    s_add_u32 m0, s47, 53248
    s_nop 0
    buffer_load_dwordx4 v21, s[24:27], s45 offen  lds
    s_add_u32 s45, s46, 0x1c0000
    s_add_u32 m0, s47, 57344
    s_nop 0
    buffer_load_dwordx4 v21, s[24:27], s45 offen  lds
    s_add_u32 s45, s46, 0x1e0000
    s_add_u32 m0, s47, 61440
    s_nop 0
    buffer_load_dwordx4 v21, s[24:27], s45 offen  lds
    s_add_u32 s45, s46, 0x200000
    s_add_u32 m0, s47, 65536
    s_nop 0
    buffer_load_dwordx4 v21, s[24:27], s45 offen  lds
    s_add_u32 s45, s46, 0x220000
    s_add_u32 m0, s47, 69632
    s_nop 0
    buffer_load_dwordx4 v21, s[24:27], s45 offen  lds
    s_add_u32 s45, s46, 0x240000
    s_add_u32 m0, s47, 73728
    s_nop 0
    buffer_load_dwordx4 v21, s[24:27], s45 offen  lds
    s_add_u32 s45, s46, 0x260000
    s_add_u32 m0, s47, 77824
    s_nop 0
    buffer_load_dwordx4 v21, s[24:27], s45 offen  lds
    s_add_u32 s45, s46, 0x280000
    s_add_u32 m0, s47, 81920
    s_nop 0
    buffer_load_dwordx4 v21, s[24:27], s45 offen  lds
    s_add_u32 s45, s46, 0x2a0000
    s_add_u32 m0, s47, 86016
    s_nop 0
    buffer_load_dwordx4 v21, s[24:27], s45 offen  lds
    s_add_u32 s45, s46, 0x2c0000
    s_add_u32 m0, s47, 90112
    s_nop 0
    buffer_load_dwordx4 v21, s[24:27], s45 offen  lds
    s_add_u32 s45, s46, 0x2e0000
    s_add_u32 m0, s47, 94208
    s_nop 0
    buffer_load_dwordx4 v21, s[24:27], s45 offen  lds
    s_add_u32 s45, s46, 0x300000
    s_add_u32 m0, s47, 98304
    s_nop 0
    buffer_load_dwordx4 v21, s[24:27], s45 offen  lds
    s_add_u32 s45, s46, 0x320000
    s_add_u32 m0, s47, 102400
    s_nop 0
    buffer_load_dwordx4 v21, s[24:27], s45 offen  lds
    s_add_u32 s45, s46, 0x340000
    s_add_u32 m0, s47, 106496
    s_nop 0
    buffer_load_dwordx4 v21, s[24:27], s45 offen  lds
    s_add_u32 s45, s46, 0x360000
    s_add_u32 m0, s47, 110592
    s_nop 0
    buffer_load_dwordx4 v21, s[24:27], s45 offen  lds
    s_add_u32 s45, s46, 0x380000
    s_add_u32 m0, s47, 114688
    s_nop 0
    buffer_load_dwordx4 v21, s[24:27], s45 offen  lds
    s_add_u32 s45, s46, 0x3a0000
    s_add_u32 m0, s47, 118784
    s_nop 0
    buffer_load_dwordx4 v21, s[24:27], s45 offen  lds
    s_add_u32 s45, s46, 0x3c0000
    s_add_u32 m0, s47, 122880
    s_nop 0
    buffer_load_dwordx4 v21, s[24:27], s45 offen  lds
    s_add_u32 s45, s46, 0x3e0000
    s_add_u32 m0, s47, 126976
    s_nop 0
    buffer_load_dwordx4 v21, s[24:27], s45 offen  lds
    s_waitcnt vmcnt(28)
    s_barrier
    s_add_u32 s45, s46, 0x400000
    s_add_u32 m0, s47, 131072
    s_nop 0
    buffer_load_dwordx4 v21, s[24:27], s45 offen  lds
    s_add_u32 s45, s46, 0x420000
    s_add_u32 m0, s47, 135168
    s_nop 0
    buffer_load_dwordx4 v21, s[24:27], s45 offen  lds
    s_add_u32 s45, s46, 0x440000
    s_add_u32 m0, s47, 139264
    s_nop 0
    buffer_load_dwordx4 v21, s[24:27], s45 offen  lds
    s_add_u32 s45, s46, 0x460000
    s_add_u32 m0, s47, 143360
    s_nop 0
    buffer_load_dwordx4 v21, s[24:27], s45 offen  lds
    ds_read_b64_tr_b16 a[0:1], v23 offset:0
    ds_read_b64_tr_b16 a[2:3], v23 offset:1024
    ds_read_b64_tr_b16 a[4:5], v23 offset:8
    ds_read_b64_tr_b16 a[6:7], v23 offset:1032
    ds_read_b64_tr_b16 a[8:9], v23 offset:8192
    ds_read_b64_tr_b16 a[10:11], v23 offset:9216
    ds_read_b64_tr_b16 a[12:13], v23 offset:8200
    ds_read_b64_tr_b16 a[14:15], v23 offset:9224
    s_waitcnt lgkmcnt(0)
    s_waitcnt vmcnt(28)
    s_barrier
    s_add_u32 s45, s46, 0x480000
    s_add_u32 m0, s47, 0
    s_nop 0
    buffer_load_dwordx4 v21, s[24:27], s45 offen  lds
    s_add_u32 s45, s46, 0x4a0000
    s_add_u32 m0, s47, 4096
    s_nop 0
    buffer_load_dwordx4 v21, s[24:27], s45 offen  lds
    s_add_u32 s45, s46, 0x4c0000
    s_add_u32 m0, s47, 8192
    s_nop 0
    buffer_load_dwordx4 v21, s[24:27], s45 offen  lds
    s_add_u32 s45, s46, 0x4e0000
    s_add_u32 m0, s47, 12288
    s_nop 0
    buffer_load_dwordx4 v21, s[24:27], s45 offen  lds
    ds_read_b64_tr_b16 a[16:17], v23 offset:16384
    ds_read_b64_tr_b16 a[18:19], v23 offset:17408
    ds_read_b64_tr_b16 a[20:21], v23 offset:16392
    ds_read_b64_tr_b16 a[22:23], v23 offset:17416
    ds_read_b64_tr_b16 a[24:25], v23 offset:24576
    ds_read_b64_tr_b16 a[26:27], v23 offset:25600
    ds_read_b64_tr_b16 a[28:29], v23 offset:24584
    ds_read_b64_tr_b16 a[30:31], v23 offset:25608
    s_waitcnt lgkmcnt(0)
    s_waitcnt vmcnt(28)
    s_barrier
    s_add_u32 s45, s46, 0x500000
    s_add_u32 m0, s47, 16384
    s_nop 0
    buffer_load_dwordx4 v21, s[24:27], s45 offen  lds
    s_add_u32 s45, s46, 0x520000
    s_add_u32 m0, s47, 20480
    s_nop 0
    buffer_load_dwordx4 v21, s[24:27], s45 offen  lds
    s_add_u32 s45, s46, 0x540000
    s_add_u32 m0, s47, 24576
    s_nop 0
    buffer_load_dwordx4 v21, s[24:27], s45 offen  lds
    s_add_u32 s45, s46, 0x560000
    s_add_u32 m0, s47, 28672
    s_nop 0
    buffer_load_dwordx4 v21, s[24:27], s45 offen  lds
    ds_read_b64_tr_b16 a[32:33], v23 offset:32768
    ds_read_b64_tr_b16 a[34:35], v23 offset:33792
    ds_read_b64_tr_b16 a[36:37], v23 offset:32776
    ds_read_b64_tr_b16 a[38:39], v23 offset:33800
    ds_read_b64_tr_b16 a[40:41], v23 offset:40960
    ds_read_b64_tr_b16 a[42:43], v23 offset:41984
    ds_read_b64_tr_b16 a[44:45], v23 offset:40968
    ds_read_b64_tr_b16 a[46:47], v23 offset:41992
    s_waitcnt lgkmcnt(0)
    s_waitcnt vmcnt(28)
    s_barrier
    s_add_u32 s45, s46, 0x580000
    s_add_u32 m0, s47, 32768
    s_nop 0
    buffer_load_dwordx4 v21, s[24:27], s45 offen  lds
    s_add_u32 s45, s46, 0x5a0000
    s_add_u32 m0, s47, 36864
    s_nop 0
    buffer_load_dwordx4 v21, s[24:27], s45 offen  lds
    s_add_u32 s45, s46, 0x5c0000
    s_add_u32 m0, s47, 40960
    s_nop 0
    buffer_load_dwordx4 v21, s[24:27], s45 offen  lds
    s_add_u32 s45, s46, 0x5e0000
    s_add_u32 m0, s47, 45056
    s_nop 0
    buffer_load_dwordx4 v21, s[24:27], s45 offen  lds
    ds_read_b64_tr_b16 a[48:49], v23 offset:49152
    ds_read_b64_tr_b16 a[50:51], v23 offset:50176
    ds_read_b64_tr_b16 a[52:53], v23 offset:49160
    ds_read_b64_tr_b16 a[54:55], v23 offset:50184
    ds_read_b64_tr_b16 a[56:57], v23 offset:57344
    ds_read_b64_tr_b16 a[58:59], v23 offset:58368
    ds_read_b64_tr_b16 a[60:61], v23 offset:57352
    ds_read_b64_tr_b16 a[62:63], v23 offset:58376
    s_waitcnt lgkmcnt(0)
    s_waitcnt vmcnt(28)
    s_barrier
    s_add_u32 s45, s46, 0x600000
    s_add_u32 m0, s47, 49152
    s_nop 0
    buffer_load_dwordx4 v21, s[24:27], s45 offen  lds
    s_add_u32 s45, s46, 0x620000
    s_add_u32 m0, s47, 53248
    s_nop 0
    buffer_load_dwordx4 v21, s[24:27], s45 offen  lds
    s_add_u32 s45, s46, 0x640000
    s_add_u32 m0, s47, 57344
    s_nop 0
    buffer_load_dwordx4 v21, s[24:27], s45 offen  lds
    s_add_u32 s45, s46, 0x660000
    s_add_u32 m0, s47, 61440
    s_nop 0
    buffer_load_dwordx4 v21, s[24:27], s45 offen  lds
    ds_read_b64_tr_b16 a[64:65], v24 offset:0
    ds_read_b64_tr_b16 a[66:67], v24 offset:1024
    ds_read_b64_tr_b16 a[68:69], v24 offset:8
    ds_read_b64_tr_b16 a[70:71], v24 offset:1032
    ds_read_b64_tr_b16 a[72:73], v24 offset:8192
    ds_read_b64_tr_b16 a[74:75], v24 offset:9216
    ds_read_b64_tr_b16 a[76:77], v24 offset:8200
    ds_read_b64_tr_b16 a[78:79], v24 offset:9224
    s_waitcnt lgkmcnt(0)
    s_waitcnt vmcnt(28)
    s_barrier
    s_add_u32 s45, s46, 0x680000
    s_add_u32 m0, s47, 65536
    s_nop 0
    buffer_load_dwordx4 v21, s[24:27], s45 offen  lds
    s_add_u32 s45, s46, 0x6a0000
    s_add_u32 m0, s47, 69632
    s_nop 0
    buffer_load_dwordx4 v21, s[24:27], s45 offen  lds
    s_add_u32 s45, s46, 0x6c0000
    s_add_u32 m0, s47, 73728
    s_nop 0
    buffer_load_dwordx4 v21, s[24:27], s45 offen  lds
    s_add_u32 s45, s46, 0x6e0000
    s_add_u32 m0, s47, 77824
    s_nop 0
    buffer_load_dwordx4 v21, s[24:27], s45 offen  lds
    ds_read_b64_tr_b16 a[80:81], v24 offset:16384
    ds_read_b64_tr_b16 a[82:83], v24 offset:17408
    ds_read_b64_tr_b16 a[84:85], v24 offset:16392
    ds_read_b64_tr_b16 a[86:87], v24 offset:17416
    ds_read_b64_tr_b16 a[88:89], v24 offset:24576
    ds_read_b64_tr_b16 a[90:91], v24 offset:25600
    ds_read_b64_tr_b16 a[92:93], v24 offset:24584
    ds_read_b64_tr_b16 a[94:95], v24 offset:25608
    s_waitcnt lgkmcnt(0)
    s_waitcnt vmcnt(28)
    s_barrier
    s_add_u32 s45, s46, 0x700000
    s_add_u32 m0, s47, 81920
    s_nop 0
    buffer_load_dwordx4 v21, s[24:27], s45 offen  lds
    s_add_u32 s45, s46, 0x720000
    s_add_u32 m0, s47, 86016
    s_nop 0
    buffer_load_dwordx4 v21, s[24:27], s45 offen  lds
    s_add_u32 s45, s46, 0x740000
    s_add_u32 m0, s47, 90112
    s_nop 0
    buffer_load_dwordx4 v21, s[24:27], s45 offen  lds
    s_add_u32 s45, s46, 0x760000
    s_add_u32 m0, s47, 94208
    s_nop 0
    buffer_load_dwordx4 v21, s[24:27], s45 offen  lds
    ds_read_b64_tr_b16 a[96:97], v24 offset:32768
    ds_read_b64_tr_b16 a[98:99], v24 offset:33792
    ds_read_b64_tr_b16 a[100:101], v24 offset:32776
    ds_read_b64_tr_b16 a[102:103], v24 offset:33800
    ds_read_b64_tr_b16 a[104:105], v24 offset:40960
    ds_read_b64_tr_b16 a[106:107], v24 offset:41984
    ds_read_b64_tr_b16 a[108:109], v24 offset:40968
    ds_read_b64_tr_b16 a[110:111], v24 offset:41992
    s_waitcnt lgkmcnt(0)
    s_waitcnt vmcnt(28)
    s_barrier
    s_add_u32 s45, s46, 0x780000
    s_add_u32 m0, s47, 98304
    s_nop 0
    buffer_load_dwordx4 v21, s[24:27], s45 offen  lds
    s_add_u32 s45, s46, 0x7a0000
    s_add_u32 m0, s47, 102400
    s_nop 0
    buffer_load_dwordx4 v21, s[24:27], s45 offen  lds
    s_add_u32 s45, s46, 0x7c0000
    s_add_u32 m0, s47, 106496
    s_nop 0
    buffer_load_dwordx4 v21, s[24:27], s45 offen  lds
    s_add_u32 s45, s46, 0x7e0000
    s_add_u32 m0, s47, 110592
    s_nop 0
    buffer_load_dwordx4 v21, s[24:27], s45 offen  lds
    ds_read_b64_tr_b16 a[112:113], v24 offset:49152
    ds_read_b64_tr_b16 a[114:115], v24 offset:50176
    ds_read_b64_tr_b16 a[116:117], v24 offset:49160
    ds_read_b64_tr_b16 a[118:119], v24 offset:50184
    ds_read_b64_tr_b16 a[120:121], v24 offset:57344
    ds_read_b64_tr_b16 a[122:123], v24 offset:58368
    ds_read_b64_tr_b16 a[124:125], v24 offset:57352
    ds_read_b64_tr_b16 a[126:127], v24 offset:58376
    s_waitcnt lgkmcnt(0)
    s_waitcnt vmcnt(28)
    s_barrier
    ds_read_b64_tr_b16 a[128:129], v25 offset:0
    ds_read_b64_tr_b16 a[130:131], v25 offset:1024
    ds_read_b64_tr_b16 a[132:133], v25 offset:8
    ds_read_b64_tr_b16 a[134:135], v25 offset:1032
    ds_read_b64_tr_b16 a[136:137], v25 offset:8192
    ds_read_b64_tr_b16 a[138:139], v25 offset:9216
    ds_read_b64_tr_b16 a[140:141], v25 offset:8200
    ds_read_b64_tr_b16 a[142:143], v25 offset:9224
    s_waitcnt lgkmcnt(0)
    s_waitcnt vmcnt(24)
    s_barrier
    ds_read_b64_tr_b16 a[144:145], v23 offset:0
    ds_read_b64_tr_b16 a[146:147], v23 offset:1024
    ds_read_b64_tr_b16 a[148:149], v23 offset:8
    ds_read_b64_tr_b16 a[150:151], v23 offset:1032
    ds_read_b64_tr_b16 a[152:153], v23 offset:8192
    ds_read_b64_tr_b16 a[154:155], v23 offset:9216
    ds_read_b64_tr_b16 a[156:157], v23 offset:8200
    ds_read_b64_tr_b16 a[158:159], v23 offset:9224
    s_waitcnt lgkmcnt(0)
    s_waitcnt vmcnt(20)
    s_barrier
    ds_read_b64_tr_b16 a[160:161], v23 offset:16384
    ds_read_b64_tr_b16 a[162:163], v23 offset:17408
    ds_read_b64_tr_b16 a[164:165], v23 offset:16392
    ds_read_b64_tr_b16 a[166:167], v23 offset:17416
    ds_read_b64_tr_b16 a[168:169], v23 offset:24576
    ds_read_b64_tr_b16 a[170:171], v23 offset:25600
    ds_read_b64_tr_b16 a[172:173], v23 offset:24584
    ds_read_b64_tr_b16 a[174:175], v23 offset:25608
    s_waitcnt lgkmcnt(0)
    s_waitcnt vmcnt(16)
    s_barrier
    ds_read_b64_tr_b16 a[176:177], v23 offset:32768
    ds_read_b64_tr_b16 a[178:179], v23 offset:33792
    ds_read_b64_tr_b16 a[180:181], v23 offset:32776
    ds_read_b64_tr_b16 a[182:183], v23 offset:33800
    ds_read_b64_tr_b16 a[184:185], v23 offset:40960
    ds_read_b64_tr_b16 a[186:187], v23 offset:41984
    ds_read_b64_tr_b16 a[188:189], v23 offset:40968
    ds_read_b64_tr_b16 a[190:191], v23 offset:41992
    s_waitcnt lgkmcnt(0)
    s_waitcnt vmcnt(12)
    s_barrier
    ds_read_b64_tr_b16 a[192:193], v23 offset:49152
    ds_read_b64_tr_b16 a[194:195], v23 offset:50176
    ds_read_b64_tr_b16 a[196:197], v23 offset:49160
    ds_read_b64_tr_b16 a[198:199], v23 offset:50184
    ds_read_b64_tr_b16 a[200:201], v23 offset:57344
    ds_read_b64_tr_b16 a[202:203], v23 offset:58368
    ds_read_b64_tr_b16 a[204:205], v23 offset:57352
    ds_read_b64_tr_b16 a[206:207], v23 offset:58376
    s_waitcnt lgkmcnt(0)
    s_waitcnt vmcnt(8)
    s_barrier
    ds_read_b64_tr_b16 a[208:209], v24 offset:0
    ds_read_b64_tr_b16 a[210:211], v24 offset:1024
    ds_read_b64_tr_b16 a[212:213], v24 offset:8
    ds_read_b64_tr_b16 a[214:215], v24 offset:1032
    ds_read_b64_tr_b16 a[216:217], v24 offset:8192
    ds_read_b64_tr_b16 a[218:219], v24 offset:9216
    ds_read_b64_tr_b16 a[220:221], v24 offset:8200
    ds_read_b64_tr_b16 a[222:223], v24 offset:9224
    s_waitcnt lgkmcnt(0)
    s_waitcnt vmcnt(4)
    s_barrier
    ds_read_b64_tr_b16 a[224:225], v24 offset:16384
    ds_read_b64_tr_b16 a[226:227], v24 offset:17408
    ds_read_b64_tr_b16 a[228:229], v24 offset:16392
    ds_read_b64_tr_b16 a[230:231], v24 offset:17416
    ds_read_b64_tr_b16 a[232:233], v24 offset:24576
    ds_read_b64_tr_b16 a[234:235], v24 offset:25600
    ds_read_b64_tr_b16 a[236:237], v24 offset:24584
    ds_read_b64_tr_b16 a[238:239], v24 offset:25608
    s_waitcnt lgkmcnt(0)
    s_waitcnt vmcnt(0)
    s_barrier
    ds_read_b64_tr_b16 a[240:241], v24 offset:32768
    ds_read_b64_tr_b16 a[242:243], v24 offset:33792
    ds_read_b64_tr_b16 a[244:245], v24 offset:32776
    ds_read_b64_tr_b16 a[246:247], v24 offset:33800
    ds_read_b64_tr_b16 a[248:249], v24 offset:40960
    ds_read_b64_tr_b16 a[250:251], v24 offset:41984
    ds_read_b64_tr_b16 a[252:253], v24 offset:40968
    ds_read_b64_tr_b16 a[254:255], v24 offset:41992
    s_waitcnt lgkmcnt(0)
    s_barrier
    s_cmp_lg_u32 s44, 0
    s_cbranch_scc1 L_pd_112
    v_mov_b32 v29, 8
    s_mov_b32 s46, 32
    s_mov_b64 exec, 1
    s_mov_b32 s70, 0
L_wp_113:
    buffer_load_dword v31, v29, s[16:19], 0 offen sc1
    s_add_u32 s70, s70, 1
    s_cmp_ge_u32 s70, 0x200000
    s_cbranch_scc1 L_w_done_98
L_wp_113_c:
    s_waitcnt vmcnt(0)
    v_cmp_gt_u32 vcc, s46, v31
    s_nop 1
    s_cbranch_vccz L_wp_113_ok
    s_sleep 3
    s_branch L_wp_113
L_wp_113_ok:
    s_mov_b64 exec, -1
L_pd_112:
    s_barrier
    s_mov_b32 s52, 0x400000
    s_lshl_b32 s56, s90, 5
    s_add_u32 s56, s56, s41
    s_lshl_b32 s56, s56, 19
    s_add_u32 s56, s56, 0x2000000
L_w_qkv_114:
    s_cmp_lg_u32 s44, 0
    s_cbranch_scc1 L_pd_115
    v_mov_b32 v29, s71
    s_mov_b32 s46, 96
    s_mov_b64 exec, 1
    s_mov_b32 s70, 0
L_wp_116:
    buffer_load_dword v31, v29, s[12:15], 0 offen sc1
    s_add_u32 s70, s70, 1
    s_cmp_ge_u32 s70, 0x200000
    s_cbranch_scc1 L_w_done_98
L_wp_116_c:
    s_waitcnt vmcnt(0)
    v_cmp_gt_u32 vcc, s46, v31
    s_nop 1
    s_cbranch_vccz L_wp_116_ok
    s_sleep 2
    s_branch L_wp_116
L_wp_116_ok:
    s_mov_b64 exec, -1
L_pd_115:
    s_barrier
L_w_qkv_114_n:
    s_mov_b32 s50, s60
    s_mul_i32 s53, s50, 65536
    s_add_u32 s53, s53, s52
    s_lshl_b32 s54, s44, 13
    s_add_u32 s53, s53, s54
    s_mul_i32 s57, s50, 8192
    s_add_u32 s57, s57, s56
    s_lshl_b32 s45, s44, 11
    s_add_u32 s57, s57, s45
    s_add_u32 s55, s54, 65536
    s_mov_b32 s58, 0
    v_mov_b32 v13, v3
    v_add_u32 v14, 65536, v13
    v_xor_b32 v15, 64, v13
    v_xor_b32 v16, 64, v14
    s_mov_b32 s76, 0x20000000
    s_add_u32 s48, s53, 0
    s_add_u32 s49, s48, 4096
    s_add_u32 m0, s54, 0
    s_nop 0
    buffer_load_dwordx4 v6, s[12:15], s48 offen offset:0 sc1 lds
    s_add_u32 m0, s54, 1024
    s_nop 0
    buffer_load_dwordx4 v9, s[12:15], s48 offen offset:0 sc1 lds
    s_add_u32 m0, s54, 2048
    s_nop 0
    buffer_load_dwordx4 v6, s[12:15], s49 offen offset:0 sc1 lds
    s_add_u32 m0, s54, 3072
    s_nop 0
    buffer_load_dwordx4 v9, s[12:15], s49 offen offset:0 sc1 lds
    s_add_u32 m0, s54, 3968
    s_nop 0
    buffer_load_dwordx4 v6, s[12:15], s48 offen offset:128 sc1 lds
    s_add_u32 m0, s54, 4992
    s_nop 0
    buffer_load_dwordx4 v9, s[12:15], s48 offen offset:128 sc1 lds
    s_add_u32 m0, s54, 6016
    s_nop 0
    buffer_load_dwordx4 v6, s[12:15], s49 offen offset:128 sc1 lds
    s_add_u32 m0, s54, 7040
    s_nop 0
    buffer_load_dwordx4 v9, s[12:15], s49 offen offset:128 sc1 lds
    s_add_u32 s48, s53, 32768
    s_add_u32 s49, s48, 4096
    s_add_u32 s46, s54, 32768
    s_add_u32 m0, s46, 0
    s_nop 0
    buffer_load_dwordx4 v6, s[12:15], s48 offen offset:0 sc1 lds
    s_add_u32 m0, s46, 1024
    s_nop 0
    buffer_load_dwordx4 v9, s[12:15], s48 offen offset:0 sc1 lds
    s_add_u32 m0, s46, 2048
    s_nop 0
    buffer_load_dwordx4 v6, s[12:15], s49 offen offset:0 sc1 lds
    s_add_u32 m0, s46, 3072
    s_nop 0
    buffer_load_dwordx4 v9, s[12:15], s49 offen offset:0 sc1 lds
    s_add_u32 m0, s46, 3968
    s_nop 0
    buffer_load_dwordx4 v6, s[12:15], s48 offen offset:128 sc1 lds
    s_add_u32 m0, s46, 4992
    s_nop 0
    buffer_load_dwordx4 v9, s[12:15], s48 offen offset:128 sc1 lds
    s_add_u32 m0, s46, 6016
    s_nop 0
    buffer_load_dwordx4 v6, s[12:15], s49 offen offset:128 sc1 lds
    s_add_u32 m0, s46, 7040
    s_nop 0
    buffer_load_dwordx4 v9, s[12:15], s49 offen offset:128 sc1 lds
    s_cmp_eq_u32 s51, 1
    s_cbranch_scc1 L_e_one_118
    s_add_u32 s48, s53, 65536
    s_add_u32 s49, s48, 4096
    s_add_u32 m0, s55, 0
    s_nop 0
    buffer_load_dwordx4 v6, s[12:15], s48 offen offset:0 sc1 lds
    s_add_u32 m0, s55, 1024
    s_nop 0
    buffer_load_dwordx4 v9, s[12:15], s48 offen offset:0 sc1 lds
    s_add_u32 m0, s55, 2048
    s_nop 0
    buffer_load_dwordx4 v6, s[12:15], s49 offen offset:0 sc1 lds
    s_add_u32 m0, s55, 3072
    s_nop 0
    buffer_load_dwordx4 v9, s[12:15], s49 offen offset:0 sc1 lds
    s_add_u32 m0, s55, 3968
    s_nop 0
    buffer_load_dwordx4 v6, s[12:15], s48 offen offset:128 sc1 lds
    s_add_u32 m0, s55, 4992
    s_nop 0
    buffer_load_dwordx4 v9, s[12:15], s48 offen offset:128 sc1 lds
    s_add_u32 m0, s55, 6016
    s_nop 0
    buffer_load_dwordx4 v6, s[12:15], s49 offen offset:128 sc1 lds
    s_add_u32 m0, s55, 7040
    s_nop 0
    buffer_load_dwordx4 v9, s[12:15], s49 offen offset:128 sc1 lds
    s_waitcnt vmcnt(16)
    s_barrier
    ds_read_b128 v[32:35], v13 offset:0
    ds_read_b128 v[36:39], v13 offset:2048
    ds_read_b128 v[40:43], v15 offset:0
    ds_read_b128 v[44:47], v15 offset:2048
    s_add_u32 s48, s53, 98304
    s_add_u32 s46, s58, 1
    s_cmp_lt_u32 s46, s51
    s_cselect_b32 s48, s48, 0x20000000
    s_add_u32 s49, s48, 4096
    s_add_u32 s59, s55, 32768
L_e_loop_117:
    s_waitcnt lgkmcnt(2)
    v_mfma_f32_16x16x32_bf16 v[80:83], a[0:3], v[32:35], 0
    ds_read_b128 v[48:51], v13 offset:4096
    v_mfma_f32_16x16x32_bf16 v[84:87], a[4:7], v[32:35], 0
    ds_read_b128 v[52:55], v13 offset:6144
    v_mfma_f32_16x16x32_bf16 v[88:91], a[0:3], v[36:39], 0
    ds_read_b128 v[56:59], v15 offset:4096
    s_add_u32 m0, s59, 0
    v_mfma_f32_16x16x32_bf16 v[92:95], a[4:7], v[36:39], 0
    ds_read_b128 v[60:63], v15 offset:6144
    buffer_load_dwordx4 v6, s[12:15], s48 offen offset:0 sc1 lds
    s_waitcnt lgkmcnt(4)
    v_mfma_f32_16x16x32_bf16 v[80:83], a[8:11], v[40:43], v[80:83]
    ds_read_b128 v[32:35], v13 offset:8192
    v_mfma_f32_16x16x32_bf16 v[84:87], a[12:15], v[40:43], v[84:87]
    ds_read_b128 v[36:39], v13 offset:10240
    v_mfma_f32_16x16x32_bf16 v[88:91], a[8:11], v[44:47], v[88:91]
    s_add_u32 m0, s59, 1024
    v_mfma_f32_16x16x32_bf16 v[92:95], a[12:15], v[44:47], v[92:95]
    buffer_load_dwordx4 v9, s[12:15], s48 offen offset:0 sc1 lds
    s_waitcnt lgkmcnt(4)
    v_mfma_f32_16x16x32_bf16 v[80:83], a[16:19], v[48:51], v[80:83]
    ds_read_b128 v[40:43], v15 offset:8192
    v_mfma_f32_16x16x32_bf16 v[84:87], a[20:23], v[48:51], v[84:87]
    ds_read_b128 v[44:47], v15 offset:10240
    v_mfma_f32_16x16x32_bf16 v[88:91], a[16:19], v[52:55], v[88:91]
    s_add_u32 m0, s59, 2048
    v_mfma_f32_16x16x32_bf16 v[92:95], a[20:23], v[52:55], v[92:95]
    buffer_load_dwordx4 v6, s[12:15], s49 offen offset:0 sc1 lds
    s_waitcnt lgkmcnt(4)
    v_mfma_f32_16x16x32_bf16 v[80:83], a[24:27], v[56:59], v[80:83]
    ds_read_b128 v[48:51], v13 offset:12288
    v_mfma_f32_16x16x32_bf16 v[84:87], a[28:31], v[56:59], v[84:87]
    ds_read_b128 v[52:55], v13 offset:14336
    v_mfma_f32_16x16x32_bf16 v[88:91], a[24:27], v[60:63], v[88:91]
    s_add_u32 m0, s59, 3072
    v_mfma_f32_16x16x32_bf16 v[92:95], a[28:31], v[60:63], v[92:95]
    buffer_load_dwordx4 v9, s[12:15], s49 offen offset:0 sc1 lds
    s_waitcnt lgkmcnt(4)
    v_mfma_f32_16x16x32_bf16 v[80:83], a[32:35], v[32:35], v[80:83]
    ds_read_b128 v[56:59], v15 offset:12288
    v_mfma_f32_16x16x32_bf16 v[84:87], a[36:39], v[32:35], v[84:87]
    ds_read_b128 v[60:63], v15 offset:14336
    v_mfma_f32_16x16x32_bf16 v[88:91], a[32:35], v[36:39], v[88:91]
    s_add_u32 m0, s59, 3968
    v_mfma_f32_16x16x32_bf16 v[92:95], a[36:39], v[36:39], v[92:95]
    buffer_load_dwordx4 v6, s[12:15], s48 offen offset:128 sc1 lds
    s_waitcnt lgkmcnt(4)
    v_mfma_f32_16x16x32_bf16 v[80:83], a[40:43], v[40:43], v[80:83]
    ds_read_b128 v[32:35], v13 offset:16384
    v_mfma_f32_16x16x32_bf16 v[84:87], a[44:47], v[40:43], v[84:87]
    ds_read_b128 v[36:39], v13 offset:18432
    v_mfma_f32_16x16x32_bf16 v[88:91], a[40:43], v[44:47], v[88:91]
    s_add_u32 m0, s59, 4992
    v_mfma_f32_16x16x32_bf16 v[92:95], a[44:47], v[44:47], v[92:95]
    buffer_load_dwordx4 v9, s[12:15], s48 offen offset:128 sc1 lds
    s_waitcnt lgkmcnt(4)
    v_mfma_f32_16x16x32_bf16 v[80:83], a[48:51], v[48:51], v[80:83]
    ds_read_b128 v[40:43], v15 offset:16384
    v_mfma_f32_16x16x32_bf16 v[84:87], a[52:55], v[48:51], v[84:87]
    ds_read_b128 v[44:47], v15 offset:18432
    v_mfma_f32_16x16x32_bf16 v[88:91], a[48:51], v[52:55], v[88:91]
    s_add_u32 m0, s59, 6016
    v_mfma_f32_16x16x32_bf16 v[92:95], a[52:55], v[52:55], v[92:95]
    buffer_load_dwordx4 v6, s[12:15], s49 offen offset:128 sc1 lds
    s_waitcnt lgkmcnt(4)
    v_mfma_f32_16x16x32_bf16 v[80:83], a[56:59], v[56:59], v[80:83]
    ds_read_b128 v[48:51], v13 offset:20480
    v_mfma_f32_16x16x32_bf16 v[84:87], a[60:63], v[56:59], v[84:87]
    ds_read_b128 v[52:55], v13 offset:22528
    v_mfma_f32_16x16x32_bf16 v[88:91], a[56:59], v[60:63], v[88:91]
    s_add_u32 m0, s59, 7040
    v_mfma_f32_16x16x32_bf16 v[92:95], a[60:63], v[60:63], v[92:95]
    buffer_load_dwordx4 v9, s[12:15], s49 offen offset:128 sc1 lds
    s_waitcnt lgkmcnt(4)
    v_mfma_f32_16x16x32_bf16 v[80:83], a[64:67], v[32:35], v[80:83]
    ds_read_b128 v[56:59], v15 offset:20480
    v_mfma_f32_16x16x32_bf16 v[84:87], a[68:71], v[32:35], v[84:87]
    ds_read_b128 v[60:63], v15 offset:22528
    v_mfma_f32_16x16x32_bf16 v[88:91], a[64:67], v[36:39], v[88:91]
    s_add_u32 s48, s53, 131072
    v_mfma_f32_16x16x32_bf16 v[92:95], a[68:71], v[36:39], v[92:95]
    s_add_u32 s46, s58, 2
    s_waitcnt lgkmcnt(4)
    v_mfma_f32_16x16x32_bf16 v[80:83], a[72:75], v[40:43], v[80:83]
    ds_read_b128 v[32:35], v13 offset:24576
    v_mfma_f32_16x16x32_bf16 v[84:87], a[76:79], v[40:43], v[84:87]
    ds_read_b128 v[36:39], v13 offset:26624
    v_mfma_f32_16x16x32_bf16 v[88:91], a[72:75], v[44:47], v[88:91]
    s_cmp_lt_u32 s46, s51
    s_cselect_b32 s48, s48, 0x20000000
    v_mfma_f32_16x16x32_bf16 v[92:95], a[76:79], v[44:47], v[92:95]
    s_add_u32 s49, s48, 4096
    s_waitcnt lgkmcnt(4)
    v_mfma_f32_16x16x32_bf16 v[80:83], a[80:83], v[48:51], v[80:83]
    ds_read_b128 v[40:43], v15 offset:24576
    v_mfma_f32_16x16x32_bf16 v[84:87], a[84:87], v[48:51], v[84:87]
    ds_read_b128 v[44:47], v15 offset:26624
    v_mfma_f32_16x16x32_bf16 v[88:91], a[80:83], v[52:55], v[88:91]
    s_mov_b32 s59, s54
    v_mfma_f32_16x16x32_bf16 v[92:95], a[84:87], v[52:55], v[92:95]
    s_waitcnt lgkmcnt(4)
    v_mfma_f32_16x16x32_bf16 v[80:83], a[88:91], v[56:59], v[80:83]
    ds_read_b128 v[48:51], v13 offset:28672
    v_mfma_f32_16x16x32_bf16 v[84:87], a[92:95], v[56:59], v[84:87]
    ds_read_b128 v[52:55], v13 offset:30720
    v_mfma_f32_16x16x32_bf16 v[88:91], a[88:91], v[60:63], v[88:91]
    v_mfma_f32_16x16x32_bf16 v[92:95], a[92:95], v[60:63], v[92:95]
    s_waitcnt lgkmcnt(4)
    v_mfma_f32_16x16x32_bf16 v[80:83], a[96:99], v[32:35], v[80:83]
    ds_read_b128 v[56:59], v15 offset:28672
    v_mfma_f32_16x16x32_bf16 v[84:87], a[100:103], v[32:35], v[84:87]
    ds_read_b128 v[60:63], v15 offset:30720
    v_mfma_f32_16x16x32_bf16 v[88:91], a[96:99], v[36:39], v[88:91]
    v_mfma_f32_16x16x32_bf16 v[92:95], a[100:103], v[36:39], v[92:95]
    s_waitcnt lgkmcnt(4)
    v_mfma_f32_16x16x32_bf16 v[80:83], a[104:107], v[40:43], v[80:83]
    v_mfma_f32_16x16x32_bf16 v[84:87], a[108:111], v[40:43], v[84:87]
    v_mfma_f32_16x16x32_bf16 v[88:91], a[104:107], v[44:47], v[88:91]
    v_mfma_f32_16x16x32_bf16 v[92:95], a[108:111], v[44:47], v[92:95]
    s_waitcnt vmcnt(16) lgkmcnt(0)
    s_barrier
    v_mfma_f32_16x16x32_bf16 v[80:83], a[112:115], v[48:51], v[80:83]
    ds_read_b128 v[32:35], v13 offset:32768
    v_mfma_f32_16x16x32_bf16 v[84:87], a[116:119], v[48:51], v[84:87]
    ds_read_b128 v[36:39], v13 offset:34816
    v_mfma_f32_16x16x32_bf16 v[88:91], a[112:115], v[52:55], v[88:91]
    v_mfma_f32_16x16x32_bf16 v[92:95], a[116:119], v[52:55], v[92:95]
    v_mfma_f32_16x16x32_bf16 v[80:83], a[120:123], v[56:59], v[80:83]
    ds_read_b128 v[40:43], v15 offset:32768
    v_mfma_f32_16x16x32_bf16 v[84:87], a[124:127], v[56:59], v[84:87]
    ds_read_b128 v[44:47], v15 offset:34816
    v_mfma_f32_16x16x32_bf16 v[88:91], a[120:123], v[60:63], v[88:91]
    v_mfma_f32_16x16x32_bf16 v[92:95], a[124:127], v[60:63], v[92:95]
    s_waitcnt lgkmcnt(2)
    v_mfma_f32_16x16x32_bf16 v[80:83], a[128:131], v[32:35], v[80:83]
    ds_read_b128 v[48:51], v13 offset:36864
    v_mfma_f32_16x16x32_bf16 v[84:87], a[132:135], v[32:35], v[84:87]
    ds_read_b128 v[52:55], v13 offset:38912
    v_mfma_f32_16x16x32_bf16 v[88:91], a[128:131], v[36:39], v[88:91]
    ds_read_b128 v[56:59], v15 offset:36864
    s_add_u32 m0, s59, 0
    v_mfma_f32_16x16x32_bf16 v[92:95], a[132:135], v[36:39], v[92:95]
    ds_read_b128 v[60:63], v15 offset:38912
    buffer_load_dwordx4 v6, s[12:15], s48 offen offset:0 sc1 lds
    s_waitcnt lgkmcnt(4)
    v_mfma_f32_16x16x32_bf16 v[80:83], a[136:139], v[40:43], v[80:83]
    ds_read_b128 v[32:35], v13 offset:40960
    v_mfma_f32_16x16x32_bf16 v[84:87], a[140:143], v[40:43], v[84:87]
    ds_read_b128 v[36:39], v13 offset:43008
    v_mfma_f32_16x16x32_bf16 v[88:91], a[136:139], v[44:47], v[88:91]
    s_add_u32 m0, s59, 1024
    v_mfma_f32_16x16x32_bf16 v[92:95], a[140:143], v[44:47], v[92:95]
    buffer_load_dwordx4 v9, s[12:15], s48 offen offset:0 sc1 lds
    s_waitcnt lgkmcnt(4)
    v_mfma_f32_16x16x32_bf16 v[80:83], a[144:147], v[48:51], v[80:83]
    ds_read_b128 v[40:43], v15 offset:40960
    v_mfma_f32_16x16x32_bf16 v[84:87], a[148:151], v[48:51], v[84:87]
    ds_read_b128 v[44:47], v15 offset:43008
    v_mfma_f32_16x16x32_bf16 v[88:91], a[144:147], v[52:55], v[88:91]
    s_add_u32 m0, s59, 2048
    v_mfma_f32_16x16x32_bf16 v[92:95], a[148:151], v[52:55], v[92:95]
    buffer_load_dwordx4 v6, s[12:15], s49 offen offset:0 sc1 lds
    s_waitcnt lgkmcnt(4)
    v_mfma_f32_16x16x32_bf16 v[80:83], a[152:155], v[56:59], v[80:83]
    ds_read_b128 v[48:51], v13 offset:45056
    v_mfma_f32_16x16x32_bf16 v[84:87], a[156:159], v[56:59], v[84:87]
    ds_read_b128 v[52:55], v13 offset:47104
    v_mfma_f32_16x16x32_bf16 v[88:91], a[152:155], v[60:63], v[88:91]
    s_add_u32 m0, s59, 3072
    v_mfma_f32_16x16x32_bf16 v[92:95], a[156:159], v[60:63], v[92:95]
    buffer_load_dwordx4 v9, s[12:15], s49 offen offset:0 sc1 lds
    s_waitcnt lgkmcnt(4)
    v_mfma_f32_16x16x32_bf16 v[80:83], a[160:163], v[32:35], v[80:83]
    ds_read_b128 v[56:59], v15 offset:45056
    v_mfma_f32_16x16x32_bf16 v[84:87], a[164:167], v[32:35], v[84:87]
    ds_read_b128 v[60:63], v15 offset:47104
    v_mfma_f32_16x16x32_bf16 v[88:91], a[160:163], v[36:39], v[88:91]
    s_add_u32 m0, s59, 3968
    v_mfma_f32_16x16x32_bf16 v[92:95], a[164:167], v[36:39], v[92:95]
    buffer_load_dwordx4 v6, s[12:15], s48 offen offset:128 sc1 lds
    s_waitcnt lgkmcnt(4)
    v_mfma_f32_16x16x32_bf16 v[80:83], a[168:171], v[40:43], v[80:83]
    ds_read_b128 v[32:35], v13 offset:49152
    v_mfma_f32_16x16x32_bf16 v[84:87], a[172:175], v[40:43], v[84:87]
    ds_read_b128 v[36:39], v13 offset:51200
    v_mfma_f32_16x16x32_bf16 v[88:91], a[168:171], v[44:47], v[88:91]
    s_add_u32 m0, s59, 4992
    v_mfma_f32_16x16x32_bf16 v[92:95], a[172:175], v[44:47], v[92:95]
    buffer_load_dwordx4 v9, s[12:15], s48 offen offset:128 sc1 lds
    s_waitcnt lgkmcnt(4)
    v_mfma_f32_16x16x32_bf16 v[80:83], a[176:179], v[48:51], v[80:83]
    ds_read_b128 v[40:43], v15 offset:49152
    v_mfma_f32_16x16x32_bf16 v[84:87], a[180:183], v[48:51], v[84:87]
    ds_read_b128 v[44:47], v15 offset:51200
    v_mfma_f32_16x16x32_bf16 v[88:91], a[176:179], v[52:55], v[88:91]
    s_add_u32 m0, s59, 6016
    v_mfma_f32_16x16x32_bf16 v[92:95], a[180:183], v[52:55], v[92:95]
    buffer_load_dwordx4 v6, s[12:15], s49 offen offset:128 sc1 lds
    s_waitcnt lgkmcnt(4)
    v_mfma_f32_16x16x32_bf16 v[80:83], a[184:187], v[56:59], v[80:83]
    ds_read_b128 v[48:51], v13 offset:53248
    v_mfma_f32_16x16x32_bf16 v[84:87], a[188:191], v[56:59], v[84:87]
    ds_read_b128 v[52:55], v13 offset:55296
    v_mfma_f32_16x16x32_bf16 v[88:91], a[184:187], v[60:63], v[88:91]
    s_add_u32 m0, s59, 7040
    v_mfma_f32_16x16x32_bf16 v[92:95], a[188:191], v[60:63], v[92:95]
    buffer_load_dwordx4 v9, s[12:15], s49 offen offset:128 sc1 lds
    s_waitcnt lgkmcnt(4)
    v_mfma_f32_16x16x32_bf16 v[80:83], a[192:195], v[32:35], v[80:83]
    ds_read_b128 v[56:59], v15 offset:53248
    v_mfma_f32_16x16x32_bf16 v[84:87], a[196:199], v[32:35], v[84:87]
    ds_read_b128 v[60:63], v15 offset:55296
    v_mfma_f32_16x16x32_bf16 v[88:91], a[192:195], v[36:39], v[88:91]
    s_add_u32 s48, s53, 163840
    v_mfma_f32_16x16x32_bf16 v[92:95], a[196:199], v[36:39], v[92:95]
    s_add_u32 s46, s58, 2
    s_waitcnt lgkmcnt(4)
    v_mfma_f32_16x16x32_bf16 v[80:83], a[200:203], v[40:43], v[80:83]
    ds_read_b128 v[32:35], v13 offset:57344
    v_mfma_f32_16x16x32_bf16 v[84:87], a[204:207], v[40:43], v[84:87]
    ds_read_b128 v[36:39], v13 offset:59392
    v_mfma_f32_16x16x32_bf16 v[88:91], a[200:203], v[44:47], v[88:91]
    s_cmp_lt_u32 s46, s51
    s_cselect_b32 s48, s48, 0x20000000
    v_mfma_f32_16x16x32_bf16 v[92:95], a[204:207], v[44:47], v[92:95]
    s_add_u32 s49, s48, 4096
    s_waitcnt lgkmcnt(4)
    v_mfma_f32_16x16x32_bf16 v[80:83], a[208:211], v[48:51], v[80:83]
    ds_read_b128 v[40:43], v15 offset:57344
    v_mfma_f32_16x16x32_bf16 v[84:87], a[212:215], v[48:51], v[84:87]
    ds_read_b128 v[44:47], v15 offset:59392
    v_mfma_f32_16x16x32_bf16 v[88:91], a[208:211], v[52:55], v[88:91]
    s_add_u32 s59, s54, 32768
    v_mfma_f32_16x16x32_bf16 v[92:95], a[212:215], v[52:55], v[92:95]
    s_waitcnt lgkmcnt(4)
    v_mfma_f32_16x16x32_bf16 v[80:83], a[216:219], v[56:59], v[80:83]
    ds_read_b128 v[48:51], v13 offset:61440
    v_mfma_f32_16x16x32_bf16 v[84:87], a[220:223], v[56:59], v[84:87]
    ds_read_b128 v[52:55], v13 offset:63488
    v_mfma_f32_16x16x32_bf16 v[88:91], a[216:219], v[60:63], v[88:91]
    v_mfma_f32_16x16x32_bf16 v[92:95], a[220:223], v[60:63], v[92:95]
    s_waitcnt lgkmcnt(4)
    v_mfma_f32_16x16x32_bf16 v[80:83], a[224:227], v[32:35], v[80:83]
    ds_read_b128 v[56:59], v15 offset:61440
    v_mfma_f32_16x16x32_bf16 v[84:87], a[228:231], v[32:35], v[84:87]
    ds_read_b128 v[60:63], v15 offset:63488
    v_mfma_f32_16x16x32_bf16 v[88:91], a[224:227], v[36:39], v[88:91]
    v_mfma_f32_16x16x32_bf16 v[92:95], a[228:231], v[36:39], v[92:95]
    s_waitcnt lgkmcnt(4)
    v_mfma_f32_16x16x32_bf16 v[80:83], a[232:235], v[40:43], v[80:83]
    v_mfma_f32_16x16x32_bf16 v[84:87], a[236:239], v[40:43], v[84:87]
    v_mfma_f32_16x16x32_bf16 v[88:91], a[232:235], v[44:47], v[88:91]
    v_mfma_f32_16x16x32_bf16 v[92:95], a[236:239], v[44:47], v[92:95]
    s_waitcnt vmcnt(16) lgkmcnt(0)
    s_barrier
    s_cmp_lg_u32 s44, 0
    s_cbranch_scc1 L_e_pr_120
    s_add_u32 s45, s58, s60
    v_mov_b32 v30, s45
    v_mov_b32 v31, 0
    s_mov_b64 exec, 1
    buffer_store_dword v30, v31, s[12:15], s61 offen sc1
    s_mov_b64 exec, -1
L_e_pr_120:
    v_mfma_f32_16x16x32_bf16 v[80:83], a[240:243], v[48:51], v[80:83]
    ds_read_b128 v[32:35], v14 offset:0
    v_mfma_f32_16x16x32_bf16 v[84:87], a[244:247], v[48:51], v[84:87]
    ds_read_b128 v[36:39], v14 offset:2048
    v_mfma_f32_16x16x32_bf16 v[88:91], a[240:243], v[52:55], v[88:91]
    v_mfma_f32_16x16x32_bf16 v[92:95], a[244:247], v[52:55], v[92:95]
    v_mfma_f32_16x16x32_bf16 v[80:83], a[248:251], v[56:59], v[80:83]
    ds_read_b128 v[40:43], v16 offset:0
    v_mfma_f32_16x16x32_bf16 v[84:87], a[252:255], v[56:59], v[84:87]
    ds_read_b128 v[44:47], v16 offset:2048
    v_mfma_f32_16x16x32_bf16 v[88:91], a[248:251], v[60:63], v[88:91]
    v_mfma_f32_16x16x32_bf16 v[92:95], a[252:255], v[60:63], v[92:95]
    s_add_u32 s53, s53, 65536
    s_add_u32 s58, s58, 1
    v_swap_b32 v13, v14
    s_xor_b32 s54, s54, 65536
    s_xor_b32 s55, s55, 65536
    s_mov_b32 s76, s57
    v_swap_b32 v15, v16
    s_add_u32 s57, s57, 8192
    v_cvt_pk_bf16_f32 v216, v80, v81
    v_cvt_pk_bf16_f32 v217, v82, v83
    v_cvt_pk_bf16_f32 v218, v84, v85
    v_cvt_pk_bf16_f32 v219, v86, v87
    v_cvt_pk_bf16_f32 v220, v88, v89
    v_cvt_pk_bf16_f32 v221, v90, v91
    v_cvt_pk_bf16_f32 v222, v92, v93
    v_cvt_pk_bf16_f32 v223, v94, v95
    buffer_store_dwordx4 v[216:219], v10, s[12:15], s76 offen sc1
    buffer_store_dwordx4 v[220:223], v10, s[12:15], s76 offen offset:1024 sc1
    s_cmp_lt_u32 s58, s51
    s_cbranch_scc1 L_e_loop_117
    s_branch L_e_fin_119
L_e_one_118:
    s_waitcnt vmcnt(8)
    s_barrier
    ds_read_b128 v[32:35], v13 offset:0
    ds_read_b128 v[36:39], v13 offset:2048
    ds_read_b128 v[40:43], v15 offset:0
    ds_read_b128 v[44:47], v15 offset:2048
    s_waitcnt lgkmcnt(2)
    v_mfma_f32_16x16x32_bf16 v[80:83], a[0:3], v[32:35], 0
    ds_read_b128 v[48:51], v13 offset:4096
    v_mfma_f32_16x16x32_bf16 v[84:87], a[4:7], v[32:35], 0
    ds_read_b128 v[52:55], v13 offset:6144
    v_mfma_f32_16x16x32_bf16 v[88:91], a[0:3], v[36:39], 0
    ds_read_b128 v[56:59], v15 offset:4096
    v_mfma_f32_16x16x32_bf16 v[92:95], a[4:7], v[36:39], 0
    ds_read_b128 v[60:63], v15 offset:6144
    s_waitcnt lgkmcnt(4)
    v_mfma_f32_16x16x32_bf16 v[80:83], a[8:11], v[40:43], v[80:83]
    ds_read_b128 v[32:35], v13 offset:8192
    v_mfma_f32_16x16x32_bf16 v[84:87], a[12:15], v[40:43], v[84:87]
    ds_read_b128 v[36:39], v13 offset:10240
    v_mfma_f32_16x16x32_bf16 v[88:91], a[8:11], v[44:47], v[88:91]
    v_mfma_f32_16x16x32_bf16 v[92:95], a[12:15], v[44:47], v[92:95]
    s_waitcnt lgkmcnt(4)
    v_mfma_f32_16x16x32_bf16 v[80:83], a[16:19], v[48:51], v[80:83]
    ds_read_b128 v[40:43], v15 offset:8192
    v_mfma_f32_16x16x32_bf16 v[84:87], a[20:23], v[48:51], v[84:87]
    ds_read_b128 v[44:47], v15 offset:10240
    v_mfma_f32_16x16x32_bf16 v[88:91], a[16:19], v[52:55], v[88:91]
    v_mfma_f32_16x16x32_bf16 v[92:95], a[20:23], v[52:55], v[92:95]
    s_waitcnt lgkmcnt(4)
    v_mfma_f32_16x16x32_bf16 v[80:83], a[24:27], v[56:59], v[80:83]
    ds_read_b128 v[48:51], v13 offset:12288
    v_mfma_f32_16x16x32_bf16 v[84:87], a[28:31], v[56:59], v[84:87]
    ds_read_b128 v[52:55], v13 offset:14336
    v_mfma_f32_16x16x32_bf16 v[88:91], a[24:27], v[60:63], v[88:91]
    v_mfma_f32_16x16x32_bf16 v[92:95], a[28:31], v[60:63], v[92:95]
    s_waitcnt lgkmcnt(4)
    v_mfma_f32_16x16x32_bf16 v[80:83], a[32:35], v[32:35], v[80:83]
    ds_read_b128 v[56:59], v15 offset:12288
    v_mfma_f32_16x16x32_bf16 v[84:87], a[36:39], v[32:35], v[84:87]
    ds_read_b128 v[60:63], v15 offset:14336
    v_mfma_f32_16x16x32_bf16 v[88:91], a[32:35], v[36:39], v[88:91]
    v_mfma_f32_16x16x32_bf16 v[92:95], a[36:39], v[36:39], v[92:95]
    s_waitcnt lgkmcnt(4)
    v_mfma_f32_16x16x32_bf16 v[80:83], a[40:43], v[40:43], v[80:83]
    ds_read_b128 v[32:35], v13 offset:16384
    v_mfma_f32_16x16x32_bf16 v[84:87], a[44:47], v[40:43], v[84:87]
    ds_read_b128 v[36:39], v13 offset:18432
    v_mfma_f32_16x16x32_bf16 v[88:91], a[40:43], v[44:47], v[88:91]
    v_mfma_f32_16x16x32_bf16 v[92:95], a[44:47], v[44:47], v[92:95]
    s_waitcnt lgkmcnt(4)
    v_mfma_f32_16x16x32_bf16 v[80:83], a[48:51], v[48:51], v[80:83]
    ds_read_b128 v[40:43], v15 offset:16384
    v_mfma_f32_16x16x32_bf16 v[84:87], a[52:55], v[48:51], v[84:87]
    ds_read_b128 v[44:47], v15 offset:18432
    v_mfma_f32_16x16x32_bf16 v[88:91], a[48:51], v[52:55], v[88:91]
    v_mfma_f32_16x16x32_bf16 v[92:95], a[52:55], v[52:55], v[92:95]
    s_waitcnt lgkmcnt(4)
    v_mfma_f32_16x16x32_bf16 v[80:83], a[56:59], v[56:59], v[80:83]
    ds_read_b128 v[48:51], v13 offset:20480
    v_mfma_f32_16x16x32_bf16 v[84:87], a[60:63], v[56:59], v[84:87]
    ds_read_b128 v[52:55], v13 offset:22528
    v_mfma_f32_16x16x32_bf16 v[88:91], a[56:59], v[60:63], v[88:91]
    v_mfma_f32_16x16x32_bf16 v[92:95], a[60:63], v[60:63], v[92:95]
    s_waitcnt lgkmcnt(4)
    v_mfma_f32_16x16x32_bf16 v[80:83], a[64:67], v[32:35], v[80:83]
    ds_read_b128 v[56:59], v15 offset:20480
    v_mfma_f32_16x16x32_bf16 v[84:87], a[68:71], v[32:35], v[84:87]
    ds_read_b128 v[60:63], v15 offset:22528
    v_mfma_f32_16x16x32_bf16 v[88:91], a[64:67], v[36:39], v[88:91]
    v_mfma_f32_16x16x32_bf16 v[92:95], a[68:71], v[36:39], v[92:95]
    s_waitcnt lgkmcnt(4)
    v_mfma_f32_16x16x32_bf16 v[80:83], a[72:75], v[40:43], v[80:83]
    ds_read_b128 v[32:35], v13 offset:24576
    v_mfma_f32_16x16x32_bf16 v[84:87], a[76:79], v[40:43], v[84:87]
    ds_read_b128 v[36:39], v13 offset:26624
    v_mfma_f32_16x16x32_bf16 v[88:91], a[72:75], v[44:47], v[88:91]
    v_mfma_f32_16x16x32_bf16 v[92:95], a[76:79], v[44:47], v[92:95]
    s_waitcnt lgkmcnt(4)
    v_mfma_f32_16x16x32_bf16 v[80:83], a[80:83], v[48:51], v[80:83]
    ds_read_b128 v[40:43], v15 offset:24576
    v_mfma_f32_16x16x32_bf16 v[84:87], a[84:87], v[48:51], v[84:87]
    ds_read_b128 v[44:47], v15 offset:26624
    v_mfma_f32_16x16x32_bf16 v[88:91], a[80:83], v[52:55], v[88:91]
    v_mfma_f32_16x16x32_bf16 v[92:95], a[84:87], v[52:55], v[92:95]
    s_waitcnt lgkmcnt(4)
    v_mfma_f32_16x16x32_bf16 v[80:83], a[88:91], v[56:59], v[80:83]
    ds_read_b128 v[48:51], v13 offset:28672
    v_mfma_f32_16x16x32_bf16 v[84:87], a[92:95], v[56:59], v[84:87]
    ds_read_b128 v[52:55], v13 offset:30720
    v_mfma_f32_16x16x32_bf16 v[88:91], a[88:91], v[60:63], v[88:91]
    v_mfma_f32_16x16x32_bf16 v[92:95], a[92:95], v[60:63], v[92:95]
    s_waitcnt lgkmcnt(4)
    v_mfma_f32_16x16x32_bf16 v[80:83], a[96:99], v[32:35], v[80:83]
    ds_read_b128 v[56:59], v15 offset:28672
    v_mfma_f32_16x16x32_bf16 v[84:87], a[100:103], v[32:35], v[84:87]
    ds_read_b128 v[60:63], v15 offset:30720
    v_mfma_f32_16x16x32_bf16 v[88:91], a[96:99], v[36:39], v[88:91]
    v_mfma_f32_16x16x32_bf16 v[92:95], a[100:103], v[36:39], v[92:95]
    s_waitcnt lgkmcnt(4)
    v_mfma_f32_16x16x32_bf16 v[80:83], a[104:107], v[40:43], v[80:83]
    v_mfma_f32_16x16x32_bf16 v[84:87], a[108:111], v[40:43], v[84:87]
    v_mfma_f32_16x16x32_bf16 v[88:91], a[104:107], v[44:47], v[88:91]
    v_mfma_f32_16x16x32_bf16 v[92:95], a[108:111], v[44:47], v[92:95]
    s_waitcnt vmcnt(0) lgkmcnt(0)
    s_barrier
    v_mfma_f32_16x16x32_bf16 v[80:83], a[112:115], v[48:51], v[80:83]
    ds_read_b128 v[32:35], v13 offset:32768
    v_mfma_f32_16x16x32_bf16 v[84:87], a[116:119], v[48:51], v[84:87]
    ds_read_b128 v[36:39], v13 offset:34816
    v_mfma_f32_16x16x32_bf16 v[88:91], a[112:115], v[52:55], v[88:91]
    v_mfma_f32_16x16x32_bf16 v[92:95], a[116:119], v[52:55], v[92:95]
    v_mfma_f32_16x16x32_bf16 v[80:83], a[120:123], v[56:59], v[80:83]
    ds_read_b128 v[40:43], v15 offset:32768
    v_mfma_f32_16x16x32_bf16 v[84:87], a[124:127], v[56:59], v[84:87]
    ds_read_b128 v[44:47], v15 offset:34816
    v_mfma_f32_16x16x32_bf16 v[88:91], a[120:123], v[60:63], v[88:91]
    v_mfma_f32_16x16x32_bf16 v[92:95], a[124:127], v[60:63], v[92:95]
    s_waitcnt lgkmcnt(2)
    v_mfma_f32_16x16x32_bf16 v[80:83], a[128:131], v[32:35], v[80:83]
    ds_read_b128 v[48:51], v13 offset:36864
    v_mfma_f32_16x16x32_bf16 v[84:87], a[132:135], v[32:35], v[84:87]
    ds_read_b128 v[52:55], v13 offset:38912
    v_mfma_f32_16x16x32_bf16 v[88:91], a[128:131], v[36:39], v[88:91]
    ds_read_b128 v[56:59], v15 offset:36864
    v_mfma_f32_16x16x32_bf16 v[92:95], a[132:135], v[36:39], v[92:95]
    ds_read_b128 v[60:63], v15 offset:38912
    s_waitcnt lgkmcnt(4)
    v_mfma_f32_16x16x32_bf16 v[80:83], a[136:139], v[40:43], v[80:83]
    ds_read_b128 v[32:35], v13 offset:40960
    v_mfma_f32_16x16x32_bf16 v[84:87], a[140:143], v[40:43], v[84:87]
    ds_read_b128 v[36:39], v13 offset:43008
    v_mfma_f32_16x16x32_bf16 v[88:91], a[136:139], v[44:47], v[88:91]
    v_mfma_f32_16x16x32_bf16 v[92:95], a[140:143], v[44:47], v[92:95]
    s_waitcnt lgkmcnt(4)
    v_mfma_f32_16x16x32_bf16 v[80:83], a[144:147], v[48:51], v[80:83]
    ds_read_b128 v[40:43], v15 offset:40960
    v_mfma_f32_16x16x32_bf16 v[84:87], a[148:151], v[48:51], v[84:87]
    ds_read_b128 v[44:47], v15 offset:43008
    v_mfma_f32_16x16x32_bf16 v[88:91], a[144:147], v[52:55], v[88:91]
    v_mfma_f32_16x16x32_bf16 v[92:95], a[148:151], v[52:55], v[92:95]
    s_waitcnt lgkmcnt(4)
    v_mfma_f32_16x16x32_bf16 v[80:83], a[152:155], v[56:59], v[80:83]
    ds_read_b128 v[48:51], v13 offset:45056
    v_mfma_f32_16x16x32_bf16 v[84:87], a[156:159], v[56:59], v[84:87]
    ds_read_b128 v[52:55], v13 offset:47104
    v_mfma_f32_16x16x32_bf16 v[88:91], a[152:155], v[60:63], v[88:91]
    v_mfma_f32_16x16x32_bf16 v[92:95], a[156:159], v[60:63], v[92:95]
    s_waitcnt lgkmcnt(4)
    v_mfma_f32_16x16x32_bf16 v[80:83], a[160:163], v[32:35], v[80:83]
    ds_read_b128 v[56:59], v15 offset:45056
    v_mfma_f32_16x16x32_bf16 v[84:87], a[164:167], v[32:35], v[84:87]
    ds_read_b128 v[60:63], v15 offset:47104
    v_mfma_f32_16x16x32_bf16 v[88:91], a[160:163], v[36:39], v[88:91]
    v_mfma_f32_16x16x32_bf16 v[92:95], a[164:167], v[36:39], v[92:95]
    s_waitcnt lgkmcnt(4)
    v_mfma_f32_16x16x32_bf16 v[80:83], a[168:171], v[40:43], v[80:83]
    ds_read_b128 v[32:35], v13 offset:49152
    v_mfma_f32_16x16x32_bf16 v[84:87], a[172:175], v[40:43], v[84:87]
    ds_read_b128 v[36:39], v13 offset:51200
    v_mfma_f32_16x16x32_bf16 v[88:91], a[168:171], v[44:47], v[88:91]
    v_mfma_f32_16x16x32_bf16 v[92:95], a[172:175], v[44:47], v[92:95]
    s_waitcnt lgkmcnt(4)
    v_mfma_f32_16x16x32_bf16 v[80:83], a[176:179], v[48:51], v[80:83]
    ds_read_b128 v[40:43], v15 offset:49152
    v_mfma_f32_16x16x32_bf16 v[84:87], a[180:183], v[48:51], v[84:87]
    ds_read_b128 v[44:47], v15 offset:51200
    v_mfma_f32_16x16x32_bf16 v[88:91], a[176:179], v[52:55], v[88:91]
    v_mfma_f32_16x16x32_bf16 v[92:95], a[180:183], v[52:55], v[92:95]
    s_waitcnt lgkmcnt(4)
    v_mfma_f32_16x16x32_bf16 v[80:83], a[184:187], v[56:59], v[80:83]
    ds_read_b128 v[48:51], v13 offset:53248
    v_mfma_f32_16x16x32_bf16 v[84:87], a[188:191], v[56:59], v[84:87]
    ds_read_b128 v[52:55], v13 offset:55296
    v_mfma_f32_16x16x32_bf16 v[88:91], a[184:187], v[60:63], v[88:91]
    v_mfma_f32_16x16x32_bf16 v[92:95], a[188:191], v[60:63], v[92:95]
    s_waitcnt lgkmcnt(4)
    v_mfma_f32_16x16x32_bf16 v[80:83], a[192:195], v[32:35], v[80:83]
    ds_read_b128 v[56:59], v15 offset:53248
    v_mfma_f32_16x16x32_bf16 v[84:87], a[196:199], v[32:35], v[84:87]
    ds_read_b128 v[60:63], v15 offset:55296
    v_mfma_f32_16x16x32_bf16 v[88:91], a[192:195], v[36:39], v[88:91]
    v_mfma_f32_16x16x32_bf16 v[92:95], a[196:199], v[36:39], v[92:95]
    s_waitcnt lgkmcnt(4)
    v_mfma_f32_16x16x32_bf16 v[80:83], a[200:203], v[40:43], v[80:83]
    ds_read_b128 v[32:35], v13 offset:57344
    v_mfma_f32_16x16x32_bf16 v[84:87], a[204:207], v[40:43], v[84:87]
    ds_read_b128 v[36:39], v13 offset:59392
    v_mfma_f32_16x16x32_bf16 v[88:91], a[200:203], v[44:47], v[88:91]
    v_mfma_f32_16x16x32_bf16 v[92:95], a[204:207], v[44:47], v[92:95]
    s_waitcnt lgkmcnt(4)
    v_mfma_f32_16x16x32_bf16 v[80:83], a[208:211], v[48:51], v[80:83]
    ds_read_b128 v[40:43], v15 offset:57344
    v_mfma_f32_16x16x32_bf16 v[84:87], a[212:215], v[48:51], v[84:87]
    ds_read_b128 v[44:47], v15 offset:59392
    v_mfma_f32_16x16x32_bf16 v[88:91], a[208:211], v[52:55], v[88:91]
    v_mfma_f32_16x16x32_bf16 v[92:95], a[212:215], v[52:55], v[92:95]
    s_waitcnt lgkmcnt(4)
    v_mfma_f32_16x16x32_bf16 v[80:83], a[216:219], v[56:59], v[80:83]
    ds_read_b128 v[48:51], v13 offset:61440
    v_mfma_f32_16x16x32_bf16 v[84:87], a[220:223], v[56:59], v[84:87]
    ds_read_b128 v[52:55], v13 offset:63488
    v_mfma_f32_16x16x32_bf16 v[88:91], a[216:219], v[60:63], v[88:91]
    v_mfma_f32_16x16x32_bf16 v[92:95], a[220:223], v[60:63], v[92:95]
    s_waitcnt lgkmcnt(4)
    v_mfma_f32_16x16x32_bf16 v[80:83], a[224:227], v[32:35], v[80:83]
    ds_read_b128 v[56:59], v15 offset:61440
    v_mfma_f32_16x16x32_bf16 v[84:87], a[228:231], v[32:35], v[84:87]
    ds_read_b128 v[60:63], v15 offset:63488
    v_mfma_f32_16x16x32_bf16 v[88:91], a[224:227], v[36:39], v[88:91]
    v_mfma_f32_16x16x32_bf16 v[92:95], a[228:231], v[36:39], v[92:95]
    s_waitcnt lgkmcnt(4)
    v_mfma_f32_16x16x32_bf16 v[80:83], a[232:235], v[40:43], v[80:83]
    v_mfma_f32_16x16x32_bf16 v[84:87], a[236:239], v[40:43], v[84:87]
    v_mfma_f32_16x16x32_bf16 v[88:91], a[232:235], v[44:47], v[88:91]
    v_mfma_f32_16x16x32_bf16 v[92:95], a[236:239], v[44:47], v[92:95]
    s_waitcnt lgkmcnt(0)
    v_mfma_f32_16x16x32_bf16 v[80:83], a[240:243], v[48:51], v[80:83]
    v_mfma_f32_16x16x32_bf16 v[84:87], a[244:247], v[48:51], v[84:87]
    v_mfma_f32_16x16x32_bf16 v[88:91], a[240:243], v[52:55], v[88:91]
    v_mfma_f32_16x16x32_bf16 v[92:95], a[244:247], v[52:55], v[92:95]
    v_mfma_f32_16x16x32_bf16 v[80:83], a[248:251], v[56:59], v[80:83]
    v_mfma_f32_16x16x32_bf16 v[84:87], a[252:255], v[56:59], v[84:87]
    v_mfma_f32_16x16x32_bf16 v[88:91], a[248:251], v[60:63], v[88:91]
    v_mfma_f32_16x16x32_bf16 v[92:95], a[252:255], v[60:63], v[92:95]
    s_mov_b32 s76, s57
    s_nop 6
    v_cvt_pk_bf16_f32 v216, v80, v81
    v_cvt_pk_bf16_f32 v217, v82, v83
    v_cvt_pk_bf16_f32 v218, v84, v85
    v_cvt_pk_bf16_f32 v219, v86, v87
    v_cvt_pk_bf16_f32 v220, v88, v89
    v_cvt_pk_bf16_f32 v221, v90, v91
    v_cvt_pk_bf16_f32 v222, v92, v93
    v_cvt_pk_bf16_f32 v223, v94, v95
    buffer_store_dwordx4 v[216:219], v10, s[12:15], s76 offen sc1
    buffer_store_dwordx4 v[220:223], v10, s[12:15], s76 offen offset:1024 sc1
L_e_fin_119:
    s_waitcnt lgkmcnt(0)
    s_add_u32 s60, s60, s51
    s_waitcnt vmcnt(0)
    s_barrier
    s_cmp_lg_u32 s44, 0
    s_cbranch_scc1 L_pub_121
    v_mov_b32 v30, s60
    v_mov_b32 v31, 0
    s_mov_b64 exec, 1
    buffer_store_dword v30, v31, s[12:15], s61 offen sc1
    s_mov_b64 exec, -1
L_pub_121:
    s_cmp_eq_u32 s60, 2
    s_cselect_b32 s51, 10, s51
    s_sub_u32 s45, s91, 12
    s_cmp_eq_u32 s60, 12
    s_cselect_b32 s51, s45, s51
    s_cselect_b32 s71, 127104, s71
    s_cbranch_scc1 L_w_qkv_114
    s_cmp_lt_u32 s60, s91
    s_cbranch_scc1 L_w_qkv_114_n
    s_cmp_eq_u32 s60, 64
    s_cbranch_scc1 L_w_qkv_114_e
    s_add_u32 s45, s61, 16
    s_mov_b32 s47, 64
    s_cmp_lg_u32 s44, 1
    s_cbranch_scc1 L_pw_122
    s_mov_b64 exec, 1
    s_mov_b32 s70, 0
L_wp_123:
    buffer_load_dword v31, v12, s[12:15], s45 offen sc1
    s_add_u32 s70, s70, 1
    s_cmp_ge_u32 s70, 0x200000
    s_cbranch_scc1 L_w_done_98
L_wp_123_c:
    s_waitcnt vmcnt(0)
    v_cmp_gt_u32 vcc, s47, v31
    s_nop 1
    s_cbranch_vccz L_wp_123_ok
    s_sleep 2
    s_branch L_wp_123
L_wp_123_ok:
    s_mov_b64 exec, -1
L_pw_122:
    s_barrier
    s_waitcnt vmcnt(0)
    s_barrier
    s_cmp_lg_u32 s44, 0
    s_cbranch_scc1 L_pub_124
    v_mov_b32 v30, 64
    v_mov_b32 v31, 0
    s_mov_b64 exec, 1
    buffer_store_dword v30, v31, s[12:15], s61 offen sc1
    s_mov_b64 exec, -1
L_pub_124:
L_w_qkv_114_e:
L_w_roles_100:
    s_cmp_lg_u32 s44, 0
    s_cbranch_scc1 L_gj_125
    s_getreg_b32 s45, hwreg(HW_REG_XCC_ID)
    s_and_b32 s45, s45, 15
    s_mul_i32 s46, s45, s45
    s_lshl_b32 s46, s46, 9
    s_add_u32 s45, s45, s46
    s_add_u32 s45, s45, 16777216
    v_mov_b32 v30, s45
    s_lshl_b32 s45, s40, 7
    v_mov_b32 v31, 127488
    s_mov_b64 exec, 1
    buffer_atomic_add v30, v31, s[12:15], s45 offen sc1
    s_mov_b64 exec, -1
L_gj_125:
    s_mov_b32 s36, 0x1011111
    s_mov_b32 s37, 0x55222081
    s_cmp_eq_u32 s42, 0
    s_cselect_b32 s36, s36, 0x10100000
    s_cselect_b32 s37, s37, 0xaa888410
    s_mov_b32 s72, 0x88888888
    s_mov_b32 s73, 0xffd55248
    s_lshr_b32 s38, s41, 3
    s_and_b32 s68, s41, 7
    s_cmp_eq_u32 s43, 1
    s_cbranch_scc1 L_role_b_126
    s_cmp_eq_u32 s43, 2
    s_cbranch_scc1 L_role_c_127
    s_load_dwordx2 s[6:7], s[0:1], 40
    s_waitcnt lgkmcnt(0)
    s_mov_b32 s24, s6
    s_and_b32 s25, s7, 0xffff
    s_mov_b32 s26, 0x800000
    s_mov_b32 s27, 0x00020000
    s_lshl_b32 s46, s38, 21
    s_lshl_b32 s45, s68, 8
    s_add_u32 s46, s46, s45
    s_waitcnt vmcnt(0)
    s_barrier
    v_lshrrev_b32 v20, 4, v1
    s_lshl_b32 s45, s44, 2
    v_add_u32 v21, s45, v20
    s_mov_b32 s45, 2048
    v_mul_lo_u32 v21, v21, s45
    v_lshlrev_b32 v22, 2, v20
    v_and_b32 v23, 15, v1
    v_xor_b32 v22, v22, v23
    v_lshlrev_b32 v22, 4, v22
    v_add_u32 v21, v21, v22
    v_bfe_u32 v22, v1, 2, 2
    v_lshlrev_b32 v23, 2, v20
    v_add_u32 v23, v23, v22
    v_lshlrev_b32 v23, 8, v23
    v_xor_b32 v22, s44, v22
    v_lshlrev_b32 v22, 6, v22
    v_add_u32 v23, v23, v22
    v_and_b32 v22, 3, v1
    v_lshlrev_b32 v22, 3, v22
    v_add_u32 v23, v23, v22
    v_add_u32 v24, 65536, v23
    v_add_u32 v25, 131072, v23
    s_lshl_b32 s47, s44, 10
    s_add_u32 s45, s46, 0x0
    s_add_u32 m0, s47, 0
    s_nop 0
    buffer_load_dwordx4 v21, s[24:27], s45 offen  lds
    s_add_u32 s45, s46, 0x8000
    s_add_u32 m0, s47, 4096
    s_nop 0
    buffer_load_dwordx4 v21, s[24:27], s45 offen  lds
    s_add_u32 s45, s46, 0x10000
    s_add_u32 m0, s47, 8192
    s_nop 0
    buffer_load_dwordx4 v21, s[24:27], s45 offen  lds
    s_add_u32 s45, s46, 0x18000
    s_add_u32 m0, s47, 12288
    s_nop 0
    buffer_load_dwordx4 v21, s[24:27], s45 offen  lds
    s_add_u32 s45, s46, 0x20000
    s_add_u32 m0, s47, 16384
    s_nop 0
    buffer_load_dwordx4 v21, s[24:27], s45 offen  lds
    s_add_u32 s45, s46, 0x28000
    s_add_u32 m0, s47, 20480
    s_nop 0
    buffer_load_dwordx4 v21, s[24:27], s45 offen  lds
    s_add_u32 s45, s46, 0x30000
    s_add_u32 m0, s47, 24576
    s_nop 0
    buffer_load_dwordx4 v21, s[24:27], s45 offen  lds
    s_add_u32 s45, s46, 0x38000
    s_add_u32 m0, s47, 28672
    s_nop 0
    buffer_load_dwordx4 v21, s[24:27], s45 offen  lds
    s_add_u32 s45, s46, 0x40000
    s_add_u32 m0, s47, 32768
    s_nop 0
    buffer_load_dwordx4 v21, s[24:27], s45 offen  lds
    s_add_u32 s45, s46, 0x48000
    s_add_u32 m0, s47, 36864
    s_nop 0
    buffer_load_dwordx4 v21, s[24:27], s45 offen  lds
    s_add_u32 s45, s46, 0x50000
    s_add_u32 m0, s47, 40960
    s_nop 0
    buffer_load_dwordx4 v21, s[24:27], s45 offen  lds
    s_add_u32 s45, s46, 0x58000
    s_add_u32 m0, s47, 45056
    s_nop 0
    buffer_load_dwordx4 v21, s[24:27], s45 offen  lds
    s_add_u32 s45, s46, 0x60000
    s_add_u32 m0, s47, 49152
    s_nop 0
    buffer_load_dwordx4 v21, s[24:27], s45 offen  lds
    s_add_u32 s45, s46, 0x68000
    s_add_u32 m0, s47, 53248
    s_nop 0
    buffer_load_dwordx4 v21, s[24:27], s45 offen  lds
    s_add_u32 s45, s46, 0x70000
    s_add_u32 m0, s47, 57344
    s_nop 0
    buffer_load_dwordx4 v21, s[24:27], s45 offen  lds
    s_add_u32 s45, s46, 0x78000
    s_add_u32 m0, s47, 61440
    s_nop 0
    buffer_load_dwordx4 v21, s[24:27], s45 offen  lds
    s_add_u32 s45, s46, 0x80000
    s_add_u32 m0, s47, 65536
    s_nop 0
    buffer_load_dwordx4 v21, s[24:27], s45 offen  lds
    s_add_u32 s45, s46, 0x88000
    s_add_u32 m0, s47, 69632
    s_nop 0
    buffer_load_dwordx4 v21, s[24:27], s45 offen  lds
    s_add_u32 s45, s46, 0x90000
    s_add_u32 m0, s47, 73728
    s_nop 0
    buffer_load_dwordx4 v21, s[24:27], s45 offen  lds
    s_add_u32 s45, s46, 0x98000
    s_add_u32 m0, s47, 77824
    s_nop 0
    buffer_load_dwordx4 v21, s[24:27], s45 offen  lds
    s_add_u32 s45, s46, 0xa0000
    s_add_u32 m0, s47, 81920
    s_nop 0
    buffer_load_dwordx4 v21, s[24:27], s45 offen  lds
    s_add_u32 s45, s46, 0xa8000
    s_add_u32 m0, s47, 86016
    s_nop 0
    buffer_load_dwordx4 v21, s[24:27], s45 offen  lds
    s_add_u32 s45, s46, 0xb0000
    s_add_u32 m0, s47, 90112
    s_nop 0
    buffer_load_dwordx4 v21, s[24:27], s45 offen  lds
    s_add_u32 s45, s46, 0xb8000
    s_add_u32 m0, s47, 94208
    s_nop 0
    buffer_load_dwordx4 v21, s[24:27], s45 offen  lds
    s_add_u32 s45, s46, 0xc0000
    s_add_u32 m0, s47, 98304
    s_nop 0
    buffer_load_dwordx4 v21, s[24:27], s45 offen  lds
    s_add_u32 s45, s46, 0xc8000
    s_add_u32 m0, s47, 102400
    s_nop 0
    buffer_load_dwordx4 v21, s[24:27], s45 offen  lds
    s_add_u32 s45, s46, 0xd0000
    s_add_u32 m0, s47, 106496
    s_nop 0
    buffer_load_dwordx4 v21, s[24:27], s45 offen  lds
    s_add_u32 s45, s46, 0xd8000
    s_add_u32 m0, s47, 110592
    s_nop 0
    buffer_load_dwordx4 v21, s[24:27], s45 offen  lds
    s_add_u32 s45, s46, 0xe0000
    s_add_u32 m0, s47, 114688
    s_nop 0
    buffer_load_dwordx4 v21, s[24:27], s45 offen  lds
    s_add_u32 s45, s46, 0xe8000
    s_add_u32 m0, s47, 118784
    s_nop 0
    buffer_load_dwordx4 v21, s[24:27], s45 offen  lds
    s_add_u32 s45, s46, 0xf0000
    s_add_u32 m0, s47, 122880
    s_nop 0
    buffer_load_dwordx4 v21, s[24:27], s45 offen  lds
    s_add_u32 s45, s46, 0xf8000
    s_add_u32 m0, s47, 126976
    s_nop 0
    buffer_load_dwordx4 v21, s[24:27], s45 offen  lds
    s_waitcnt vmcnt(28)
    s_barrier
    s_add_u32 s45, s46, 0x100000
    s_add_u32 m0, s47, 131072
    s_nop 0
    buffer_load_dwordx4 v21, s[24:27], s45 offen  lds
    s_add_u32 s45, s46, 0x108000
    s_add_u32 m0, s47, 135168
    s_nop 0
    buffer_load_dwordx4 v21, s[24:27], s45 offen  lds
    s_add_u32 s45, s46, 0x110000
    s_add_u32 m0, s47, 139264
    s_nop 0
    buffer_load_dwordx4 v21, s[24:27], s45 offen  lds
    s_add_u32 s45, s46, 0x118000
    s_add_u32 m0, s47, 143360
    s_nop 0
    buffer_load_dwordx4 v21, s[24:27], s45 offen  lds
    ds_read_b64_tr_b16 a[0:1], v23 offset:0
    ds_read_b64_tr_b16 a[2:3], v23 offset:4096
    ds_read_b64_tr_b16 a[4:5], v23 offset:32
    ds_read_b64_tr_b16 a[6:7], v23 offset:4128
    ds_read_b64_tr_b16 a[8:9], v23 offset:8192
    ds_read_b64_tr_b16 a[10:11], v23 offset:12288
    ds_read_b64_tr_b16 a[12:13], v23 offset:8224
    ds_read_b64_tr_b16 a[14:15], v23 offset:12320
    s_waitcnt lgkmcnt(0)
    s_waitcnt vmcnt(28)
    s_barrier
    s_add_u32 s45, s46, 0x120000
    s_add_u32 m0, s47, 0
    s_nop 0
    buffer_load_dwordx4 v21, s[24:27], s45 offen  lds
    s_add_u32 s45, s46, 0x128000
    s_add_u32 m0, s47, 4096
    s_nop 0
    buffer_load_dwordx4 v21, s[24:27], s45 offen  lds
    s_add_u32 s45, s46, 0x130000
    s_add_u32 m0, s47, 8192
    s_nop 0
    buffer_load_dwordx4 v21, s[24:27], s45 offen  lds
    s_add_u32 s45, s46, 0x138000
    s_add_u32 m0, s47, 12288
    s_nop 0
    buffer_load_dwordx4 v21, s[24:27], s45 offen  lds
    ds_read_b64_tr_b16 a[16:17], v23 offset:16384
    ds_read_b64_tr_b16 a[18:19], v23 offset:20480
    ds_read_b64_tr_b16 a[20:21], v23 offset:16416
    ds_read_b64_tr_b16 a[22:23], v23 offset:20512
    ds_read_b64_tr_b16 a[24:25], v23 offset:24576
    ds_read_b64_tr_b16 a[26:27], v23 offset:28672
    ds_read_b64_tr_b16 a[28:29], v23 offset:24608
    ds_read_b64_tr_b16 a[30:31], v23 offset:28704
    s_waitcnt lgkmcnt(0)
    s_waitcnt vmcnt(28)
    s_barrier
    s_add_u32 s45, s46, 0x140000
    s_add_u32 m0, s47, 16384
    s_nop 0
    buffer_load_dwordx4 v21, s[24:27], s45 offen  lds
    s_add_u32 s45, s46, 0x148000
    s_add_u32 m0, s47, 20480
    s_nop 0
    buffer_load_dwordx4 v21, s[24:27], s45 offen  lds
    s_add_u32 s45, s46, 0x150000
    s_add_u32 m0, s47, 24576
    s_nop 0
    buffer_load_dwordx4 v21, s[24:27], s45 offen  lds
    s_add_u32 s45, s46, 0x158000
    s_add_u32 m0, s47, 28672
    s_nop 0
    buffer_load_dwordx4 v21, s[24:27], s45 offen  lds
    ds_read_b64_tr_b16 a[32:33], v23 offset:32768
    ds_read_b64_tr_b16 a[34:35], v23 offset:36864
    ds_read_b64_tr_b16 a[36:37], v23 offset:32800
    ds_read_b64_tr_b16 a[38:39], v23 offset:36896
    ds_read_b64_tr_b16 a[40:41], v23 offset:40960
    ds_read_b64_tr_b16 a[42:43], v23 offset:45056
    ds_read_b64_tr_b16 a[44:45], v23 offset:40992
    ds_read_b64_tr_b16 a[46:47], v23 offset:45088
    s_waitcnt lgkmcnt(0)
    s_waitcnt vmcnt(28)
    s_barrier
    s_add_u32 s45, s46, 0x160000
    s_add_u32 m0, s47, 32768
    s_nop 0
    buffer_load_dwordx4 v21, s[24:27], s45 offen  lds
    s_add_u32 s45, s46, 0x168000
    s_add_u32 m0, s47, 36864
    s_nop 0
    buffer_load_dwordx4 v21, s[24:27], s45 offen  lds
    s_add_u32 s45, s46, 0x170000
    s_add_u32 m0, s47, 40960
    s_nop 0
    buffer_load_dwordx4 v21, s[24:27], s45 offen  lds
    s_add_u32 s45, s46, 0x178000
    s_add_u32 m0, s47, 45056
    s_nop 0
    buffer_load_dwordx4 v21, s[24:27], s45 offen  lds
    ds_read_b64_tr_b16 a[48:49], v23 offset:49152
    ds_read_b64_tr_b16 a[50:51], v23 offset:53248
    ds_read_b64_tr_b16 a[52:53], v23 offset:49184
    ds_read_b64_tr_b16 a[54:55], v23 offset:53280
    ds_read_b64_tr_b16 a[56:57], v23 offset:57344
    ds_read_b64_tr_b16 a[58:59], v23 offset:61440
    ds_read_b64_tr_b16 a[60:61], v23 offset:57376
    ds_read_b64_tr_b16 a[62:63], v23 offset:61472
    s_waitcnt lgkmcnt(0)
    s_waitcnt vmcnt(28)
    s_barrier
    s_add_u32 s45, s46, 0x180000
    s_add_u32 m0, s47, 49152
    s_nop 0
    buffer_load_dwordx4 v21, s[24:27], s45 offen  lds
    s_add_u32 s45, s46, 0x188000
    s_add_u32 m0, s47, 53248
    s_nop 0
    buffer_load_dwordx4 v21, s[24:27], s45 offen  lds
    s_add_u32 s45, s46, 0x190000
    s_add_u32 m0, s47, 57344
    s_nop 0
    buffer_load_dwordx4 v21, s[24:27], s45 offen  lds
    s_add_u32 s45, s46, 0x198000
    s_add_u32 m0, s47, 61440
    s_nop 0
    buffer_load_dwordx4 v21, s[24:27], s45 offen  lds
    ds_read_b64_tr_b16 a[64:65], v24 offset:0
    ds_read_b64_tr_b16 a[66:67], v24 offset:4096
    ds_read_b64_tr_b16 a[68:69], v24 offset:32
    ds_read_b64_tr_b16 a[70:71], v24 offset:4128
    ds_read_b64_tr_b16 a[72:73], v24 offset:8192
    ds_read_b64_tr_b16 a[74:75], v24 offset:12288
    ds_read_b64_tr_b16 a[76:77], v24 offset:8224
    ds_read_b64_tr_b16 a[78:79], v24 offset:12320
    s_waitcnt lgkmcnt(0)
    s_waitcnt vmcnt(28)
    s_barrier
    s_add_u32 s45, s46, 0x1a0000
    s_add_u32 m0, s47, 65536
    s_nop 0
    buffer_load_dwordx4 v21, s[24:27], s45 offen  lds
    s_add_u32 s45, s46, 0x1a8000
    s_add_u32 m0, s47, 69632
    s_nop 0
    buffer_load_dwordx4 v21, s[24:27], s45 offen  lds
    s_add_u32 s45, s46, 0x1b0000
    s_add_u32 m0, s47, 73728
    s_nop 0
    buffer_load_dwordx4 v21, s[24:27], s45 offen  lds
    s_add_u32 s45, s46, 0x1b8000
    s_add_u32 m0, s47, 77824
    s_nop 0
    buffer_load_dwordx4 v21, s[24:27], s45 offen  lds
    ds_read_b64_tr_b16 a[80:81], v24 offset:16384
    ds_read_b64_tr_b16 a[82:83], v24 offset:20480
    ds_read_b64_tr_b16 a[84:85], v24 offset:16416
    ds_read_b64_tr_b16 a[86:87], v24 offset:20512
    ds_read_b64_tr_b16 a[88:89], v24 offset:24576
    ds_read_b64_tr_b16 a[90:91], v24 offset:28672
    ds_read_b64_tr_b16 a[92:93], v24 offset:24608
    ds_read_b64_tr_b16 a[94:95], v24 offset:28704
    s_waitcnt lgkmcnt(0)
    s_waitcnt vmcnt(28)
    s_barrier
    s_add_u32 s45, s46, 0x1c0000
    s_add_u32 m0, s47, 81920
    s_nop 0
    buffer_load_dwordx4 v21, s[24:27], s45 offen  lds
    s_add_u32 s45, s46, 0x1c8000
    s_add_u32 m0, s47, 86016
    s_nop 0
    buffer_load_dwordx4 v21, s[24:27], s45 offen  lds
    s_add_u32 s45, s46, 0x1d0000
    s_add_u32 m0, s47, 90112
    s_nop 0
    buffer_load_dwordx4 v21, s[24:27], s45 offen  lds
    s_add_u32 s45, s46, 0x1d8000
    s_add_u32 m0, s47, 94208
    s_nop 0
    buffer_load_dwordx4 v21, s[24:27], s45 offen  lds
    ds_read_b64_tr_b16 a[96:97], v24 offset:32768
    ds_read_b64_tr_b16 a[98:99], v24 offset:36864
    ds_read_b64_tr_b16 a[100:101], v24 offset:32800
    ds_read_b64_tr_b16 a[102:103], v24 offset:36896
    ds_read_b64_tr_b16 a[104:105], v24 offset:40960
    ds_read_b64_tr_b16 a[106:107], v24 offset:45056
    ds_read_b64_tr_b16 a[108:109], v24 offset:40992
    ds_read_b64_tr_b16 a[110:111], v24 offset:45088
    s_waitcnt lgkmcnt(0)
    s_waitcnt vmcnt(28)
    s_barrier
    s_add_u32 s45, s46, 0x1e0000
    s_add_u32 m0, s47, 98304
    s_nop 0
    buffer_load_dwordx4 v21, s[24:27], s45 offen  lds
    s_add_u32 s45, s46, 0x1e8000
    s_add_u32 m0, s47, 102400
    s_nop 0
    buffer_load_dwordx4 v21, s[24:27], s45 offen  lds
    s_add_u32 s45, s46, 0x1f0000
    s_add_u32 m0, s47, 106496
    s_nop 0
    buffer_load_dwordx4 v21, s[24:27], s45 offen  lds
    s_add_u32 s45, s46, 0x1f8000
    s_add_u32 m0, s47, 110592
    s_nop 0
    buffer_load_dwordx4 v21, s[24:27], s45 offen  lds
    ds_read_b64_tr_b16 a[112:113], v24 offset:49152
    ds_read_b64_tr_b16 a[114:115], v24 offset:53248
    ds_read_b64_tr_b16 a[116:117], v24 offset:49184
    ds_read_b64_tr_b16 a[118:119], v24 offset:53280
    ds_read_b64_tr_b16 a[120:121], v24 offset:57344
    ds_read_b64_tr_b16 a[122:123], v24 offset:61440
    ds_read_b64_tr_b16 a[124:125], v24 offset:57376
    ds_read_b64_tr_b16 a[126:127], v24 offset:61472
    s_waitcnt lgkmcnt(0)
    s_waitcnt vmcnt(28)
    s_barrier
    ds_read_b64_tr_b16 a[128:129], v25 offset:0
    ds_read_b64_tr_b16 a[130:131], v25 offset:4096
    ds_read_b64_tr_b16 a[132:133], v25 offset:32
    ds_read_b64_tr_b16 a[134:135], v25 offset:4128
    ds_read_b64_tr_b16 a[136:137], v25 offset:8192
    ds_read_b64_tr_b16 a[138:139], v25 offset:12288
    ds_read_b64_tr_b16 a[140:141], v25 offset:8224
    ds_read_b64_tr_b16 a[142:143], v25 offset:12320
    s_waitcnt lgkmcnt(0)
    s_waitcnt vmcnt(24)
    s_barrier
    ds_read_b64_tr_b16 a[144:145], v23 offset:0
    ds_read_b64_tr_b16 a[146:147], v23 offset:4096
    ds_read_b64_tr_b16 a[148:149], v23 offset:32
    ds_read_b64_tr_b16 a[150:151], v23 offset:4128
    ds_read_b64_tr_b16 a[152:153], v23 offset:8192
    ds_read_b64_tr_b16 a[154:155], v23 offset:12288
    ds_read_b64_tr_b16 a[156:157], v23 offset:8224
    ds_read_b64_tr_b16 a[158:159], v23 offset:12320
    s_waitcnt lgkmcnt(0)
    s_waitcnt vmcnt(20)
    s_barrier
    ds_read_b64_tr_b16 a[160:161], v23 offset:16384
    ds_read_b64_tr_b16 a[162:163], v23 offset:20480
    ds_read_b64_tr_b16 a[164:165], v23 offset:16416
    ds_read_b64_tr_b16 a[166:167], v23 offset:20512
    ds_read_b64_tr_b16 a[168:169], v23 offset:24576
    ds_read_b64_tr_b16 a[170:171], v23 offset:28672
    ds_read_b64_tr_b16 a[172:173], v23 offset:24608
    ds_read_b64_tr_b16 a[174:175], v23 offset:28704
    s_waitcnt lgkmcnt(0)
    s_waitcnt vmcnt(16)
    s_barrier
    ds_read_b64_tr_b16 a[176:177], v23 offset:32768
    ds_read_b64_tr_b16 a[178:179], v23 offset:36864
    ds_read_b64_tr_b16 a[180:181], v23 offset:32800
    ds_read_b64_tr_b16 a[182:183], v23 offset:36896
    ds_read_b64_tr_b16 a[184:185], v23 offset:40960
    ds_read_b64_tr_b16 a[186:187], v23 offset:45056
    ds_read_b64_tr_b16 a[188:189], v23 offset:40992
    ds_read_b64_tr_b16 a[190:191], v23 offset:45088
    s_waitcnt lgkmcnt(0)
    s_waitcnt vmcnt(12)
    s_barrier
    ds_read_b64_tr_b16 a[192:193], v23 offset:49152
    ds_read_b64_tr_b16 a[194:195], v23 offset:53248
    ds_read_b64_tr_b16 a[196:197], v23 offset:49184
    ds_read_b64_tr_b16 a[198:199], v23 offset:53280
    ds_read_b64_tr_b16 a[200:201], v23 offset:57344
    ds_read_b64_tr_b16 a[202:203], v23 offset:61440
    ds_read_b64_tr_b16 a[204:205], v23 offset:57376
    ds_read_b64_tr_b16 a[206:207], v23 offset:61472
    s_waitcnt lgkmcnt(0)
    s_waitcnt vmcnt(8)
    s_barrier
    ds_read_b64_tr_b16 a[208:209], v24 offset:0
    ds_read_b64_tr_b16 a[210:211], v24 offset:4096
    ds_read_b64_tr_b16 a[212:213], v24 offset:32
    ds_read_b64_tr_b16 a[214:215], v24 offset:4128
    ds_read_b64_tr_b16 a[216:217], v24 offset:8192
    ds_read_b64_tr_b16 a[218:219], v24 offset:12288
    ds_read_b64_tr_b16 a[220:221], v24 offset:8224
    ds_read_b64_tr_b16 a[222:223], v24 offset:12320
    s_waitcnt lgkmcnt(0)
    s_waitcnt vmcnt(4)
    s_barrier
    ds_read_b64_tr_b16 a[224:225], v24 offset:16384
    ds_read_b64_tr_b16 a[226:227], v24 offset:20480
    ds_read_b64_tr_b16 a[228:229], v24 offset:16416
    ds_read_b64_tr_b16 a[230:231], v24 offset:20512
    ds_read_b64_tr_b16 a[232:233], v24 offset:24576
    ds_read_b64_tr_b16 a[234:235], v24 offset:28672
    ds_read_b64_tr_b16 a[236:237], v24 offset:24608
    ds_read_b64_tr_b16 a[238:239], v24 offset:28704
    s_waitcnt lgkmcnt(0)
    s_waitcnt vmcnt(0)
    s_barrier
    ds_read_b64_tr_b16 a[240:241], v24 offset:32768
    ds_read_b64_tr_b16 a[242:243], v24 offset:36864
    ds_read_b64_tr_b16 a[244:245], v24 offset:32800
    ds_read_b64_tr_b16 a[246:247], v24 offset:36896
    ds_read_b64_tr_b16 a[248:249], v24 offset:40960
    ds_read_b64_tr_b16 a[250:251], v24 offset:45056
    ds_read_b64_tr_b16 a[252:253], v24 offset:40992
    ds_read_b64_tr_b16 a[254:255], v24 offset:45088
    s_waitcnt lgkmcnt(0)
    s_barrier
    s_lshl_b32 s52, s38, 16
    s_add_u32 s52, s52, 0x5000000
    s_lshl_b32 s56, s38, 23
    s_lshl_b32 s45, s68, 9
    s_add_u32 s56, s56, s45
    s_add_u32 s56, s56, 0x8000000
    s_lshl_b32 s45, s40, 7
    s_add_u32 s45, s45, 127488
    v_mov_b32 v29, s45
    s_mov_b32 s46, 536870912
    s_mov_b64 exec, 1
    s_mov_b32 s70, 0
L_wp_130:
    buffer_load_dword v31, v29, s[12:15], 0 offen sc1
    s_add_u32 s70, s70, 1
    s_cmp_ge_u32 s70, 0x200000
    s_cbranch_scc1 L_w_done_98
L_wp_130_c:
    s_waitcnt vmcnt(0)
    v_cmp_gt_u32 vcc, s46, v31
    s_nop 1
    s_cbranch_vccz L_wp_130_ok
    s_sleep 2
    s_branch L_wp_130
L_wp_130_ok:
    s_mov_b64 exec, -1
    v_readfirstlane_b32 s45, v31
    s_nop 3
    s_and_b32 s46, s45, 511
    s_mul_i32 s46, s46, s46
    s_bfe_u32 s45, s45, 0xf0009
    s_lshl_b32 s45, s45, 5
    s_mov_b32 s80, s12
    s_mov_b32 s81, s13
    s_mov_b32 s83, 0x00020000
    s_mov_b32 s84, s12
    s_mov_b32 s85, s13
    s_mov_b32 s87, 0x00020000
    s_cmp_eq_u32 s45, s46
    s_cselect_b32 s82, s14, 0
    s_cselect_b32 s86, 0, s14
    s_sub_u32 s79, 3, s44
    s_mov_b32 s78, 0
    s_mov_b32 s92, 0
    s_cmp_eq_u64 s[36:37], 0
    s_cbranch_scc1 L_xl_131
    s_ff1_i32_b64 s47, s[36:37]
    s_lshr_b64 s[74:75], s[72:73], s47
    s_ff1_i32_b64 s48, s[74:75]
    s_cmp_gt_u32 s79, s48
    s_cbranch_scc1 L_xl_131
    s_add_u32 s47, s47, s79
    s_cmp_lt_u32 s47, s78
    s_cbranch_scc1 L_xl_131_go
    s_lshl_b32 s45, s41, 7
    s_add_u32 s45, s45, 0x10010
    s_add_u32 s46, s47, 1
    s_mov_b64 exec, 7
    s_mov_b32 s70, 0
L_wp_132:
    buffer_load_dword v31, v12, s[12:15], s45 offen sc1
    s_add_u32 s70, s70, 1
    s_cmp_ge_u32 s70, 0x200000
    s_cbranch_scc1 L_w_done_98
L_wp_132_c:
    s_waitcnt vmcnt(0)
    v_cmp_gt_u32 vcc, s46, v31
    s_nop 1
    s_cbranch_vccz L_wp_132_ok
    s_sleep 2
    s_branch L_wp_132
L_wp_132_ok:
    s_mov_b64 exec, -1
    v_readlane_b32 s78, v31, 0
    v_readlane_b32 s45, v31, 1
    v_readlane_b32 s46, v31, 2
    s_nop 3
    s_min_u32 s78, s78, s45
    s_min_u32 s78, s78, s46
L_xl_131_go:
    s_lshl_b32 s45, s41, 19
    s_lshl_b32 s46, s47, 13
    s_add_u32 s45, s45, s46
    s_add_u32 s45, s45, 0x2000000
    s_add_u32 s46, s45, 4096
    s_add_u32 s48, s45, 16777216
    s_add_u32 s49, s48, 4096
    s_add_u32 s76, s48, 16777216
    s_add_u32 s77, s76, 4096
    buffer_load_dwordx4 v[96:99], v10, s[12:15], s76 offen offset:0 sc1
    buffer_load_dwordx4 v[128:131], v10, s[12:15], s45 offen offset:0 sc1
    buffer_load_dwordx4 v[160:163], v10, s[12:15], s48 offen offset:0 sc1
    buffer_load_dwordx4 v[100:103], v10, s[12:15], s76 offen offset:1024 sc1
    buffer_load_dwordx4 v[144:147], v10, s[12:15], s45 offen offset:1024 sc1
    buffer_load_dwordx4 v[176:179], v10, s[12:15], s48 offen offset:1024 sc1
    buffer_load_dwordx4 v[104:107], v10, s[12:15], s76 offen offset:2048 sc1
    buffer_load_dwordx4 v[132:135], v10, s[12:15], s45 offen offset:2048 sc1
    buffer_load_dwordx4 v[164:167], v10, s[12:15], s48 offen offset:2048 sc1
    buffer_load_dwordx4 v[108:111], v10, s[12:15], s76 offen offset:3072 sc1
    buffer_load_dwordx4 v[148:151], v10, s[12:15], s45 offen offset:3072 sc1
    buffer_load_dwordx4 v[180:183], v10, s[12:15], s48 offen offset:3072 sc1
    buffer_load_dwordx4 v[112:115], v10, s[12:15], s77 offen offset:0 sc1
    buffer_load_dwordx4 v[136:139], v10, s[12:15], s46 offen offset:0 sc1
    buffer_load_dwordx4 v[168:171], v10, s[12:15], s49 offen offset:0 sc1
    buffer_load_dwordx4 v[116:119], v10, s[12:15], s77 offen offset:1024 sc1
    buffer_load_dwordx4 v[152:155], v10, s[12:15], s46 offen offset:1024 sc1
    buffer_load_dwordx4 v[184:187], v10, s[12:15], s49 offen offset:1024 sc1
    buffer_load_dwordx4 v[120:123], v10, s[12:15], s77 offen offset:2048 sc1
    buffer_load_dwordx4 v[140:143], v10, s[12:15], s46 offen offset:2048 sc1
    buffer_load_dwordx4 v[172:175], v10, s[12:15], s49 offen offset:2048 sc1
    buffer_load_dwordx4 v[124:127], v10, s[12:15], s77 offen offset:3072 sc1
    buffer_load_dwordx4 v[156:159], v10, s[12:15], s46 offen offset:3072 sc1
    buffer_load_dwordx4 v[188:191], v10, s[12:15], s49 offen offset:3072 sc1
L_xl_131:
    s_waitcnt vmcnt(0)
L_a_loop_128:
    s_cmp_eq_u64 s[36:37], 0
    s_cbranch_scc1 L_a_fin_133
    s_ff1_i32_b64 s50, s[36:37]
    s_bitset0_b64 s[36:37], s50
    s_lshr_b64 s[74:75], s[72:73], s50
    s_ff1_i32_b64 s51, s[74:75]
    s_add_u32 s51, s51, 1
    s_add_u32 s62, s50, s51
    s_add_u32 s63, s50, s79
    s_cmp_ge_u32 s79, s51
    s_cbranch_scc1 L_xs1_134
    s_lshl_b32 s47, s44, 13
    v_add_u32 v18, s47, v10
    v_and_b32 v14, 15, v1
    v_lshrrev_b32 v16, 4, v1
    ds_write_b128 v18, v[96:99] offset:0
    ds_write_b128 v18, v[100:103] offset:1024
    ds_write_b128 v18, v[104:107] offset:2048
    ds_write_b128 v18, v[108:111] offset:3072
    ds_write_b128 v18, v[112:115] offset:4096
    ds_write_b128 v18, v[116:119] offset:5120
    ds_write_b128 v18, v[120:123] offset:6144
    ds_write_b128 v18, v[124:127] offset:7168
    v_mfma_f32_16x16x32_bf16 v[32:35], v[160:163], v[128:131], 0
    v_mfma_f32_16x16x32_bf16 v[36:39], v[160:163], v[144:147], 0
    v_mfma_f32_16x16x32_bf16 v[44:47], v[176:179], v[144:147], 0
    v_mfma_f32_16x16x32_bf16 v[32:35], v[164:167], v[132:135], v[32:35]
    v_mfma_f32_16x16x32_bf16 v[36:39], v[164:167], v[148:151], v[36:39]
    v_mfma_f32_16x16x32_bf16 v[44:47], v[180:183], v[148:151], v[44:47]
    v_mfma_f32_16x16x32_bf16 v[32:35], v[168:171], v[136:139], v[32:35]
    v_mfma_f32_16x16x32_bf16 v[36:39], v[168:171], v[152:155], v[36:39]
    v_mfma_f32_16x16x32_bf16 v[44:47], v[184:187], v[152:155], v[44:47]
    v_mfma_f32_16x16x32_bf16 v[32:35], v[172:175], v[140:143], v[32:35]
    v_mfma_f32_16x16x32_bf16 v[36:39], v[172:175], v[156:159], v[36:39]
    v_mfma_f32_16x16x32_bf16 v[44:47], v[188:191], v[156:159], v[44:47]
    v_lshlrev_b32 v19, 2, v16
    v_lshrrev_b32 v20, 2, v1
    v_lshlrev_b32 v20, 4, v20
    v_and_b32 v21, 1, v1
    v_lshlrev_b32 v21, 3, v21
    v_add3_u32 v20, v20, v21, s47
    v_and_b32 v21, 2, v1
    v_lshlrev_b32 v21, 7, v21
    v_add_u32 v20, v20, v21
    v_mov_b32 v22, 0xff800000
    s_waitcnt lgkmcnt(0)
    ds_read_b64_tr_b16 v[208:209], v20 offset:0
    ds_read_b64_tr_b16 v[210:211], v20 offset:1024
    ds_read_b64_tr_b16 v[212:213], v20 offset:512
    ds_read_b64_tr_b16 v[214:215], v20 offset:1536
    ds_read_b64_tr_b16 v[216:217], v20 offset:2048
    ds_read_b64_tr_b16 v[218:219], v20 offset:3072
    ds_read_b64_tr_b16 v[220:221], v20 offset:2560
    ds_read_b64_tr_b16 v[222:223], v20 offset:3584
    ds_read_b64_tr_b16 v[224:225], v20 offset:4096
    ds_read_b64_tr_b16 v[226:227], v20 offset:5120
    ds_read_b64_tr_b16 v[228:229], v20 offset:4608
    ds_read_b64_tr_b16 v[230:231], v20 offset:5632
    ds_read_b64_tr_b16 v[232:233], v20 offset:6144
    ds_read_b64_tr_b16 v[234:235], v20 offset:7168
    ds_read_b64_tr_b16 v[236:237], v20 offset:6656
    ds_read_b64_tr_b16 v[238:239], v20 offset:7680
    v_add_u32 v21, 0, v19
    v_cmp_gt_u32 vcc, v21, v14
    s_nop 1
    v_cndmask_b32 v32, v32, v22, vcc
    v_cndmask_b32 v44, v44, v22, vcc
    v_add_u32 v21, 1, v19
    v_cmp_gt_u32 vcc, v21, v14
    s_nop 1
    v_cndmask_b32 v33, v33, v22, vcc
    v_cndmask_b32 v45, v45, v22, vcc
    v_add_u32 v21, 2, v19
    v_cmp_gt_u32 vcc, v21, v14
    s_nop 1
    v_cndmask_b32 v34, v34, v22, vcc
    v_cndmask_b32 v46, v46, v22, vcc
    v_add_u32 v21, 3, v19
    v_cmp_gt_u32 vcc, v21, v14
    s_nop 1
    v_cndmask_b32 v35, v35, v22, vcc
    v_cndmask_b32 v47, v47, v22, vcc
L_xs1_134:
    s_lshl_b32 s45, s41, 7
    s_add_u32 s45, s45, 0x11000
    s_cmp_lg_u32 s44, 1
    s_cbranch_scc1 L_pi_136
    s_mov_b64 exec, 255
    buffer_load_dword v31, v12, s[12:15], s45 offen sc1
    s_mov_b64 exec, -1
L_pi_136:
    s_waitcnt vmcnt(0)
    s_barrier
    s_cmp_lg_u32 s44, 0
    s_cbranch_scc1 L_pub_137
    v_mov_b32 v30, s92
    v_mov_b32 v31, 0
    s_mov_b64 exec, 1
    buffer_store_dword v30, v31, s[12:15], s67 offen sc1
    s_mov_b64 exec, -1
L_pub_137:
    s_cmp_lg_u32 s44, 1
    s_cbranch_scc1 L_pw_138
    s_mov_b64 exec, 255
    s_mov_b32 s70, 0
    s_branch L_wp_139_c
L_wp_139:
    buffer_load_dword v31, v12, s[12:15], s45 offen sc1
    s_add_u32 s70, s70, 1
    s_cmp_ge_u32 s70, 0x200000
    s_cbranch_scc1 L_w_done_98
L_wp_139_c:
    s_waitcnt vmcnt(0)
    v_cmp_gt_u32 vcc, s62, v31
    s_nop 1
    s_cbranch_vccz L_wp_139_ok
    s_sleep 1
    s_branch L_wp_139
L_wp_139_ok:
    s_mov_b64 exec, -1
L_pw_138:
    s_barrier
    s_cmp_ge_u32 s79, s51
    s_cbranch_scc1 L_xs2_135
    s_lshl_b32 s45, s63, 17
    s_lshl_b32 s46, s41, 12
    s_add_u32 s45, s45, s46
    s_lshr_b32 s46, s45, 1
    s_add_u32 s45, s45, 0x1000000
    s_add_u32 s46, s46, 0x1800000
    v_lshlrev_b32 v21, 3, v1
    buffer_load_dwordx4 v[192:195], v10, s[12:15], s45 offen offset:0 sc1
    buffer_load_dwordx4 v[196:199], v10, s[12:15], s45 offen offset:1024 sc1
    buffer_load_dwordx4 v[200:203], v10, s[12:15], s45 offen offset:2048 sc1
    buffer_load_dwordx4 v[204:207], v10, s[12:15], s45 offen offset:3072 sc1
    buffer_load_dwordx2 v[240:241], v21, s[12:15], s46 offen offset:0 sc1
    buffer_load_dwordx2 v[242:243], v21, s[12:15], s46 offen offset:512 sc1
    buffer_load_dwordx2 v[244:245], v21, s[12:15], s46 offen offset:1024 sc1
    buffer_load_dwordx2 v[246:247], v21, s[12:15], s46 offen offset:1536 sc1
    s_waitcnt vmcnt(4)
    v_mfma_f32_16x16x32_bf16 v[48:51], v[192:195], v[128:131], 0
    v_mfma_f32_16x16x32_bf16 v[52:55], v[192:195], v[144:147], 0
    v_mfma_f32_16x16x32_bf16 v[48:51], v[196:199], v[132:135], v[48:51]
    v_mfma_f32_16x16x32_bf16 v[52:55], v[196:199], v[148:151], v[52:55]
    v_mfma_f32_16x16x32_bf16 v[48:51], v[200:203], v[136:139], v[48:51]
    v_mfma_f32_16x16x32_bf16 v[52:55], v[200:203], v[152:155], v[52:55]
    v_mfma_f32_16x16x32_bf16 v[48:51], v[204:207], v[140:143], v[48:51]
    v_mfma_f32_16x16x32_bf16 v[52:55], v[204:207], v[156:159], v[52:55]
    s_mov_b32 s45, 0x3e0293ee
    s_nop 6
    v_permlane32_swap_b32 v48, v50
    v_permlane32_swap_b32 v49, v51
    v_pk_add_f32 v[48:49], v[48:49], v[50:51]
    v_permlane32_swap_b32 v52, v54
    v_permlane32_swap_b32 v53, v55
    v_pk_add_f32 v[52:53], v[52:53], v[54:55]
    v_max_f32 v22, v32, v33
    v_max3_f32 v22, v22, v34, v35
    v_max3_f32 v22, v22, v48, v49
    v_max_f32 v23, v36, v37
    v_max3_f32 v23, v23, v38, v39
    v_max3_f32 v23, v23, v44, v45
    v_max3_f32 v23, v23, v46, v47
    v_max3_f32 v23, v23, v52, v53
    v_mov_b32 v24, v22
    v_mov_b32 v25, v23
    s_nop 0
    v_permlane32_swap_b32 v22, v24
    v_permlane32_swap_b32 v23, v25
    v_max_f32 v22, v22, v24
    v_max_f32 v23, v23, v25
    v_mov_b32 v24, v22
    v_mov_b32 v25, v23
    s_nop 0
    v_permlane16_swap_b32 v22, v24
    v_permlane16_swap_b32 v23, v25
    v_max_f32 v22, v22, v24
    v_max_f32 v23, v23, v25
    v_mul_f32 v22, s45, v22
    v_mul_f32 v23, s45, v23
    v_fma_f32 v32, v32, s45, -v22
    v_fma_f32 v33, v33, s45, -v22
    v_fma_f32 v34, v34, s45, -v22
    v_fma_f32 v35, v35, s45, -v22
    v_fma_f32 v48, v48, s45, -v22
    v_fma_f32 v49, v49, s45, -v22
    v_exp_f32 v32, v32
    v_exp_f32 v33, v33
    v_exp_f32 v34, v34
    v_exp_f32 v35, v35
    v_exp_f32 v48, v48
    v_exp_f32 v49, v49
    v_fma_f32 v36, v36, s45, -v23
    v_fma_f32 v37, v37, s45, -v23
    v_fma_f32 v38, v38, s45, -v23
    v_fma_f32 v39, v39, s45, -v23
    v_fma_f32 v44, v44, s45, -v23
    v_fma_f32 v45, v45, s45, -v23
    v_fma_f32 v46, v46, s45, -v23
    v_fma_f32 v47, v47, s45, -v23
    v_fma_f32 v52, v52, s45, -v23
    v_fma_f32 v53, v53, s45, -v23
    v_exp_f32 v36, v36
    v_exp_f32 v37, v37
    v_exp_f32 v38, v38
    v_exp_f32 v39, v39
    v_exp_f32 v44, v44
    v_exp_f32 v45, v45
    v_exp_f32 v46, v46
    v_exp_f32 v47, v47
    v_exp_f32 v52, v52
    v_exp_f32 v53, v53
    v_add_f32 v22, v32, v33
    v_add_f32 v22, v22, v34
    v_add_f32 v22, v22, v35
    v_add_f32 v22, v22, v48
    v_add_f32 v22, v22, v49
    v_add_f32 v23, v36, v37
    v_add_f32 v23, v23, v38
    v_add_f32 v23, v23, v39
    v_add_f32 v23, v23, v44
    v_add_f32 v23, v23, v45
    v_add_f32 v23, v23, v46
    v_add_f32 v23, v23, v47
    v_add_f32 v23, v23, v52
    v_add_f32 v23, v23, v53
    v_mov_b32 v24, v22
    v_mov_b32 v25, v23
    s_nop 0
    v_permlane32_swap_b32 v22, v24
    v_permlane32_swap_b32 v23, v25
    v_add_f32 v22, v22, v24
    v_add_f32 v23, v23, v25
    v_mov_b32 v24, v22
    v_mov_b32 v25, v23
    s_nop 0
    v_permlane16_swap_b32 v22, v24
    v_permlane16_swap_b32 v23, v25
    v_add_f32 v22, v22, v24
    v_add_f32 v23, v23, v25
    v_rcp_f32 v22, v22
    v_rcp_f32 v23, v23
    s_nop 0
    v_mul_f32 v32, v32, v22
    v_mul_f32 v33, v33, v22
    v_mul_f32 v34, v34, v22
    v_mul_f32 v35, v35, v22
    v_mul_f32 v48, v48, v22
    v_mul_f32 v49, v49, v22
    v_mul_f32 v36, v36, v23
    v_mul_f32 v37, v37, v23
    v_mul_f32 v38, v38, v23
    v_mul_f32 v39, v39, v23
    v_mul_f32 v44, v44, v23
    v_mul_f32 v45, v45, v23
    v_mul_f32 v46, v46, v23
    v_mul_f32 v47, v47, v23
    v_mul_f32 v52, v52, v23
    v_mul_f32 v53, v53, v23
    v_cvt_pk_bf16_f32 v128, v32, v33
    v_cvt_pk_bf16_f32 v129, v34, v35
    v_mov_b32 v130, 0
    v_mov_b32 v131, 0
    v_cvt_pk_bf16_f32 v132, v48, v49
    v_mov_b32 v133, 0
    v_mov_b32 v134, 0
    v_cvt_pk_bf16_f32 v135, v48, v49
    v_cvt_pk_bf16_f32 v136, v36, v37
    v_cvt_pk_bf16_f32 v137, v38, v39
    v_cvt_pk_bf16_f32 v138, v44, v45
    v_cvt_pk_bf16_f32 v139, v46, v47
    v_cvt_pk_bf16_f32 v140, v52, v53
    v_mov_b32 v141, 0
    v_mov_b32 v142, 0
    v_cvt_pk_bf16_f32 v143, v52, v53
    s_waitcnt vmcnt(0) lgkmcnt(0)
    s_nop 0
    v_mfma_f32_16x16x32_bf16 v[64:67], v[208:211], v[128:131], 0
    v_mfma_f32_16x16x32_bf16 v[68:71], v[212:215], v[128:131], 0
    v_mfma_f32_16x16x32_bf16 v[72:75], v[216:219], v[128:131], 0
    v_mfma_f32_16x16x32_bf16 v[76:79], v[220:223], v[128:131], 0
    v_mfma_f32_16x16x32_bf16 v[80:83], v[224:227], v[128:131], 0
    v_mfma_f32_16x16x32_bf16 v[84:87], v[228:231], v[128:131], 0
    v_mfma_f32_16x16x32_bf16 v[88:91], v[232:235], v[128:131], 0
    v_mfma_f32_16x16x32_bf16 v[92:95], v[236:239], v[128:131], 0
    v_mfma_f32_16x16x16_bf16 v[64:67], v[240:241], v[132:133], v[64:67]
    v_mfma_f32_16x16x16_bf16 v[68:71], v[240:241], v[134:135], v[68:71]
    v_mfma_f32_16x16x16_bf16 v[72:75], v[242:243], v[132:133], v[72:75]
    v_mfma_f32_16x16x16_bf16 v[76:79], v[242:243], v[134:135], v[76:79]
    v_mfma_f32_16x16x16_bf16 v[80:83], v[244:245], v[132:133], v[80:83]
    v_mfma_f32_16x16x16_bf16 v[84:87], v[244:245], v[134:135], v[84:87]
    v_mfma_f32_16x16x16_bf16 v[88:91], v[246:247], v[132:133], v[88:91]
    v_mfma_f32_16x16x16_bf16 v[92:95], v[246:247], v[134:135], v[92:95]
    v_mfma_f32_16x16x32_bf16 v[96:99], v[208:211], v[136:139], 0
    v_mfma_f32_16x16x32_bf16 v[100:103], v[212:215], v[136:139], 0
    v_mfma_f32_16x16x32_bf16 v[104:107], v[216:219], v[136:139], 0
    v_mfma_f32_16x16x32_bf16 v[108:111], v[220:223], v[136:139], 0
    v_mfma_f32_16x16x32_bf16 v[112:115], v[224:227], v[136:139], 0
    v_mfma_f32_16x16x32_bf16 v[116:119], v[228:231], v[136:139], 0
    v_mfma_f32_16x16x32_bf16 v[120:123], v[232:235], v[136:139], 0
    v_mfma_f32_16x16x32_bf16 v[124:127], v[236:239], v[136:139], 0
    v_mfma_f32_16x16x16_bf16 v[96:99], v[240:241], v[140:141], v[96:99]
    v_mfma_f32_16x16x16_bf16 v[100:103], v[240:241], v[142:143], v[100:103]
    v_mfma_f32_16x16x16_bf16 v[104:107], v[242:243], v[140:141], v[104:107]
    v_mfma_f32_16x16x16_bf16 v[108:111], v[242:243], v[142:143], v[108:111]
    v_mfma_f32_16x16x16_bf16 v[112:115], v[244:245], v[140:141], v[112:115]
    v_mfma_f32_16x16x16_bf16 v[116:119], v[244:245], v[142:143], v[116:119]
    v_mfma_f32_16x16x16_bf16 v[120:123], v[246:247], v[140:141], v[120:123]
    v_mfma_f32_16x16x16_bf16 v[124:127], v[246:247], v[142:143], v[124:127]
    s_lshl_b32 s45, s63, 18
    s_lshl_b32 s46, s41, 13
    s_add_u32 s45, s45, s46
    s_add_u32 s45, s45, 0x5000000
    s_add_u32 s46, s45, 4096
    v_cvt_pk_bf16_f32 v64, v64, v65
    v_cvt_pk_bf16_f32 v65, v66, v67
    v_cvt_pk_bf16_f32 v66, v68, v69
    v_cvt_pk_bf16_f32 v67, v70, v71
    buffer_store_dwordx4 v[64:67], v10, s[12:15], s45 offen offset:0 sc1
    v_cvt_pk_bf16_f32 v72, v72, v73
    v_cvt_pk_bf16_f32 v73, v74, v75
    v_cvt_pk_bf16_f32 v74, v76, v77
    v_cvt_pk_bf16_f32 v75, v78, v79
    buffer_store_dwordx4 v[72:75], v10, s[12:15], s45 offen offset:2048 sc1
    v_cvt_pk_bf16_f32 v80, v80, v81
    v_cvt_pk_bf16_f32 v81, v82, v83
    v_cvt_pk_bf16_f32 v82, v84, v85
    v_cvt_pk_bf16_f32 v83, v86, v87
    buffer_store_dwordx4 v[80:83], v10, s[12:15], s46 offen offset:0 sc1
    v_cvt_pk_bf16_f32 v88, v88, v89
    v_cvt_pk_bf16_f32 v89, v90, v91
    v_cvt_pk_bf16_f32 v90, v92, v93
    v_cvt_pk_bf16_f32 v91, v94, v95
    buffer_store_dwordx4 v[88:91], v10, s[12:15], s46 offen offset:2048 sc1
    v_cvt_pk_bf16_f32 v96, v96, v97
    v_cvt_pk_bf16_f32 v97, v98, v99
    v_cvt_pk_bf16_f32 v98, v100, v101
    v_cvt_pk_bf16_f32 v99, v102, v103
    buffer_store_dwordx4 v[96:99], v10, s[12:15], s45 offen offset:1024 sc1
    v_cvt_pk_bf16_f32 v104, v104, v105
    v_cvt_pk_bf16_f32 v105, v106, v107
    v_cvt_pk_bf16_f32 v106, v108, v109
    v_cvt_pk_bf16_f32 v107, v110, v111
    buffer_store_dwordx4 v[104:107], v10, s[12:15], s45 offen offset:3072 sc1
    v_cvt_pk_bf16_f32 v112, v112, v113
    v_cvt_pk_bf16_f32 v113, v114, v115
    v_cvt_pk_bf16_f32 v114, v116, v117
    v_cvt_pk_bf16_f32 v115, v118, v119
    buffer_store_dwordx4 v[112:115], v10, s[12:15], s46 offen offset:1024 sc1
    v_cvt_pk_bf16_f32 v120, v120, v121
    v_cvt_pk_bf16_f32 v121, v122, v123
    v_cvt_pk_bf16_f32 v122, v124, v125
    v_cvt_pk_bf16_f32 v123, v126, v127
    buffer_store_dwordx4 v[120:123], v10, s[12:15], s46 offen offset:3072 sc1
L_xs2_135:
    s_waitcnt vmcnt(0)
    s_barrier
    s_cmp_lg_u32 s44, 0
    s_cbranch_scc1 L_pub_140
    v_mov_b32 v30, s62
    v_mov_b32 v31, 0
    s_mov_b64 exec, 1
    buffer_store_dword v30, v31, s[80:83], s65 offen
    buffer_store_dword v30, v31, s[84:87], s65 offen sc1
    s_mov_b64 exec, -1
L_pub_140:
    s_cmp_eq_u64 s[36:37], 0
    s_cbranch_scc1 L_xl_141
    s_ff1_i32_b64 s47, s[36:37]
    s_lshr_b64 s[74:75], s[72:73], s47
    s_ff1_i32_b64 s48, s[74:75]
    s_cmp_gt_u32 s79, s48
    s_cbranch_scc1 L_xl_141
    s_add_u32 s47, s47, s79
    s_cmp_lt_u32 s47, s78
    s_cbranch_scc1 L_xl_141_go
    s_lshl_b32 s45, s41, 7
    s_add_u32 s45, s45, 0x10010
    s_add_u32 s46, s47, 1
    s_mov_b64 exec, 7
    s_mov_b32 s70, 0
L_wp_142:
    buffer_load_dword v31, v12, s[12:15], s45 offen sc1
    s_add_u32 s70, s70, 1
    s_cmp_ge_u32 s70, 0x200000
    s_cbranch_scc1 L_w_done_98
L_wp_142_c:
    s_waitcnt vmcnt(0)
    v_cmp_gt_u32 vcc, s46, v31
    s_nop 1
    s_cbranch_vccz L_wp_142_ok
    s_sleep 2
    s_branch L_wp_142
L_wp_142_ok:
    s_mov_b64 exec, -1
    v_readlane_b32 s78, v31, 0
    v_readlane_b32 s45, v31, 1
    v_readlane_b32 s46, v31, 2
    s_nop 3
    s_min_u32 s78, s78, s45
    s_min_u32 s78, s78, s46
L_xl_141_go:
    s_lshl_b32 s45, s41, 19
    s_lshl_b32 s46, s47, 13
    s_add_u32 s45, s45, s46
    s_add_u32 s45, s45, 0x2000000
    s_add_u32 s46, s45, 4096
    s_add_u32 s48, s45, 16777216
    s_add_u32 s49, s48, 4096
    s_add_u32 s76, s48, 16777216
    s_add_u32 s77, s76, 4096
    buffer_load_dwordx4 v[96:99], v10, s[12:15], s76 offen offset:0 sc1
    buffer_load_dwordx4 v[128:131], v10, s[12:15], s45 offen offset:0 sc1
    buffer_load_dwordx4 v[160:163], v10, s[12:15], s48 offen offset:0 sc1
    buffer_load_dwordx4 v[100:103], v10, s[12:15], s76 offen offset:1024 sc1
    buffer_load_dwordx4 v[144:147], v10, s[12:15], s45 offen offset:1024 sc1
    buffer_load_dwordx4 v[176:179], v10, s[12:15], s48 offen offset:1024 sc1
    buffer_load_dwordx4 v[104:107], v10, s[12:15], s76 offen offset:2048 sc1
    buffer_load_dwordx4 v[132:135], v10, s[12:15], s45 offen offset:2048 sc1
    buffer_load_dwordx4 v[164:167], v10, s[12:15], s48 offen offset:2048 sc1
    buffer_load_dwordx4 v[108:111], v10, s[12:15], s76 offen offset:3072 sc1
    buffer_load_dwordx4 v[148:151], v10, s[12:15], s45 offen offset:3072 sc1
    buffer_load_dwordx4 v[180:183], v10, s[12:15], s48 offen offset:3072 sc1
    buffer_load_dwordx4 v[112:115], v10, s[12:15], s77 offen offset:0 sc1
    buffer_load_dwordx4 v[136:139], v10, s[12:15], s46 offen offset:0 sc1
    buffer_load_dwordx4 v[168:171], v10, s[12:15], s49 offen offset:0 sc1
    buffer_load_dwordx4 v[116:119], v10, s[12:15], s77 offen offset:1024 sc1
    buffer_load_dwordx4 v[152:155], v10, s[12:15], s46 offen offset:1024 sc1
    buffer_load_dwordx4 v[184:187], v10, s[12:15], s49 offen offset:1024 sc1
    buffer_load_dwordx4 v[120:123], v10, s[12:15], s77 offen offset:2048 sc1
    buffer_load_dwordx4 v[140:143], v10, s[12:15], s46 offen offset:2048 sc1
    buffer_load_dwordx4 v[172:175], v10, s[12:15], s49 offen offset:2048 sc1
    buffer_load_dwordx4 v[124:127], v10, s[12:15], s77 offen offset:3072 sc1
    buffer_load_dwordx4 v[156:159], v10, s[12:15], s46 offen offset:3072 sc1
    buffer_load_dwordx4 v[188:191], v10, s[12:15], s49 offen offset:3072 sc1
L_xl_141:
    s_lshl_b32 s45, s38, 10
    s_add_u32 s45, s45, s64
    s_cmp_lg_u32 s44, 0
    s_cbranch_scc1 L_pw_143
    s_mov_b64 exec, 255
    s_mov_b32 s70, 0
L_wp_144:
    buffer_load_dword v31, v5, s[12:15], s45 offen sc1
    s_add_u32 s70, s70, 1
    s_cmp_ge_u32 s70, 0x200000
    s_cbranch_scc1 L_w_done_98
L_wp_144_c:
    s_waitcnt vmcnt(0)
    v_cmp_gt_u32 vcc, s62, v31
    s_nop 1
    s_cbranch_vccz L_wp_144_ok
    s_sleep 1
    s_branch L_wp_144
L_wp_144_ok:
    s_mov_b64 exec, -1
L_pw_143:
    s_barrier
    s_mul_i32 s53, s50, 262144
    s_add_u32 s53, s53, s52
    s_lshl_b32 s54, s44, 13
    s_add_u32 s53, s53, s54
    s_mul_i32 s57, s50, 131072
    s_add_u32 s57, s57, s56
    s_lshl_b32 s45, s44, 7
    s_add_u32 s57, s57, s45
    s_add_u32 s55, s54, 65536
    s_mov_b32 s58, 0
    v_mov_b32 v13, v10
    v_add_u32 v14, 65536, v13
    v_xor_b32 v15, 64, v13
    v_xor_b32 v16, 64, v14
    s_mov_b32 s76, 0x20000000
    s_add_u32 s48, s53, 0
    s_add_u32 s49, s48, 4096
    s_add_u32 m0, s54, 0
    s_nop 0
    buffer_load_dwordx4 v10, s[12:15], s48 offen offset:0 sc1 lds
    buffer_load_dwordx4 v10, s[12:15], s48 offen offset:1024 sc1 lds
    buffer_load_dwordx4 v10, s[12:15], s48 offen offset:2048 sc1 lds
    buffer_load_dwordx4 v10, s[12:15], s48 offen offset:3072 sc1 lds
    s_add_u32 m0, s54, 4096
    s_nop 0
    buffer_load_dwordx4 v10, s[12:15], s49 offen offset:0 sc1 lds
    buffer_load_dwordx4 v10, s[12:15], s49 offen offset:1024 sc1 lds
    buffer_load_dwordx4 v10, s[12:15], s49 offen offset:2048 sc1 lds
    buffer_load_dwordx4 v10, s[12:15], s49 offen offset:3072 sc1 lds
    s_add_u32 s48, s53, 32768
    s_add_u32 s49, s48, 4096
    s_add_u32 s46, s54, 32768
    s_add_u32 m0, s46, 0
    s_nop 0
    buffer_load_dwordx4 v10, s[12:15], s48 offen offset:0 sc1 lds
    buffer_load_dwordx4 v10, s[12:15], s48 offen offset:1024 sc1 lds
    buffer_load_dwordx4 v10, s[12:15], s48 offen offset:2048 sc1 lds
    buffer_load_dwordx4 v10, s[12:15], s48 offen offset:3072 sc1 lds
    s_add_u32 m0, s46, 4096
    s_nop 0
    buffer_load_dwordx4 v10, s[12:15], s49 offen offset:0 sc1 lds
    buffer_load_dwordx4 v10, s[12:15], s49 offen offset:1024 sc1 lds
    buffer_load_dwordx4 v10, s[12:15], s49 offen offset:2048 sc1 lds
    buffer_load_dwordx4 v10, s[12:15], s49 offen offset:3072 sc1 lds
    s_cmp_eq_u32 s51, 1
    s_cbranch_scc1 L_e_one_146
    s_add_u32 s48, s53, 262144
    s_add_u32 s49, s48, 4096
    s_add_u32 m0, s55, 0
    s_nop 0
    buffer_load_dwordx4 v10, s[12:15], s48 offen offset:0 sc1 lds
    buffer_load_dwordx4 v10, s[12:15], s48 offen offset:1024 sc1 lds
    buffer_load_dwordx4 v10, s[12:15], s48 offen offset:2048 sc1 lds
    buffer_load_dwordx4 v10, s[12:15], s48 offen offset:3072 sc1 lds
    s_add_u32 m0, s55, 4096
    s_nop 0
    buffer_load_dwordx4 v10, s[12:15], s49 offen offset:0 sc1 lds
    buffer_load_dwordx4 v10, s[12:15], s49 offen offset:1024 sc1 lds
    buffer_load_dwordx4 v10, s[12:15], s49 offen offset:2048 sc1 lds
    buffer_load_dwordx4 v10, s[12:15], s49 offen offset:3072 sc1 lds
    s_waitcnt vmcnt(16)
    s_barrier
    ds_read_b128 v[32:35], v13 offset:0
    ds_read_b128 v[36:39], v13 offset:1024
    ds_read_b128 v[40:43], v13 offset:2048
    ds_read_b128 v[44:47], v13 offset:3072
    s_add_u32 s48, s53, 294912
    s_add_u32 s46, s58, 1
    s_cmp_lt_u32 s46, s51
    s_cselect_b32 s48, s48, 0x20000000
    s_add_u32 s49, s48, 4096
    s_add_u32 s59, s55, 32768
L_e_loop_145:
    s_waitcnt lgkmcnt(2)
    v_mfma_f32_16x16x32_bf16 v[80:83], a[0:3], v[32:35], 0
    ds_read_b128 v[48:51], v13 offset:4096
    v_mfma_f32_16x16x32_bf16 v[84:87], a[4:7], v[32:35], 0
    ds_read_b128 v[52:55], v13 offset:5120
    v_mfma_f32_16x16x32_bf16 v[88:91], a[0:3], v[36:39], 0
    ds_read_b128 v[56:59], v13 offset:6144
    s_add_u32 m0, s59, 0
    v_mfma_f32_16x16x32_bf16 v[92:95], a[4:7], v[36:39], 0
    ds_read_b128 v[60:63], v13 offset:7168
    buffer_load_dwordx4 v10, s[12:15], s48 offen offset:0 sc1 lds
    s_waitcnt lgkmcnt(4)
    v_mfma_f32_16x16x32_bf16 v[80:83], a[8:11], v[40:43], v[80:83]
    ds_read_b128 v[32:35], v13 offset:8192
    v_mfma_f32_16x16x32_bf16 v[84:87], a[12:15], v[40:43], v[84:87]
    ds_read_b128 v[36:39], v13 offset:9216
    v_mfma_f32_16x16x32_bf16 v[88:91], a[8:11], v[44:47], v[88:91]
    v_mfma_f32_16x16x32_bf16 v[92:95], a[12:15], v[44:47], v[92:95]
    buffer_load_dwordx4 v10, s[12:15], s48 offen offset:1024 sc1 lds
    s_waitcnt lgkmcnt(4)
    v_mfma_f32_16x16x32_bf16 v[80:83], a[16:19], v[48:51], v[80:83]
    ds_read_b128 v[40:43], v13 offset:10240
    v_mfma_f32_16x16x32_bf16 v[84:87], a[20:23], v[48:51], v[84:87]
    ds_read_b128 v[44:47], v13 offset:11264
    v_mfma_f32_16x16x32_bf16 v[88:91], a[16:19], v[52:55], v[88:91]
    v_mfma_f32_16x16x32_bf16 v[92:95], a[20:23], v[52:55], v[92:95]
    buffer_load_dwordx4 v10, s[12:15], s48 offen offset:2048 sc1 lds
    s_waitcnt lgkmcnt(4)
    v_mfma_f32_16x16x32_bf16 v[80:83], a[24:27], v[56:59], v[80:83]
    ds_read_b128 v[48:51], v13 offset:12288
    v_mfma_f32_16x16x32_bf16 v[84:87], a[28:31], v[56:59], v[84:87]
    ds_read_b128 v[52:55], v13 offset:13312
    v_mfma_f32_16x16x32_bf16 v[88:91], a[24:27], v[60:63], v[88:91]
    v_mfma_f32_16x16x32_bf16 v[92:95], a[28:31], v[60:63], v[92:95]
    buffer_load_dwordx4 v10, s[12:15], s48 offen offset:3072 sc1 lds
    s_waitcnt lgkmcnt(4)
    v_mfma_f32_16x16x32_bf16 v[80:83], a[32:35], v[32:35], v[80:83]
    ds_read_b128 v[56:59], v13 offset:14336
    v_mfma_f32_16x16x32_bf16 v[84:87], a[36:39], v[32:35], v[84:87]
    ds_read_b128 v[60:63], v13 offset:15360
    v_mfma_f32_16x16x32_bf16 v[88:91], a[32:35], v[36:39], v[88:91]
    s_add_u32 m0, s59, 4096
    v_mfma_f32_16x16x32_bf16 v[92:95], a[36:39], v[36:39], v[92:95]
    buffer_load_dwordx4 v10, s[12:15], s49 offen offset:0 sc1 lds
    s_waitcnt lgkmcnt(4)
    v_mfma_f32_16x16x32_bf16 v[80:83], a[40:43], v[40:43], v[80:83]
    ds_read_b128 v[32:35], v13 offset:16384
    v_mfma_f32_16x16x32_bf16 v[84:87], a[44:47], v[40:43], v[84:87]
    ds_read_b128 v[36:39], v13 offset:17408
    v_mfma_f32_16x16x32_bf16 v[88:91], a[40:43], v[44:47], v[88:91]
    v_mfma_f32_16x16x32_bf16 v[92:95], a[44:47], v[44:47], v[92:95]
    buffer_load_dwordx4 v10, s[12:15], s49 offen offset:1024 sc1 lds
    s_waitcnt lgkmcnt(4)
    v_mfma_f32_16x16x32_bf16 v[80:83], a[48:51], v[48:51], v[80:83]
    ds_read_b128 v[40:43], v13 offset:18432
    v_mfma_f32_16x16x32_bf16 v[84:87], a[52:55], v[48:51], v[84:87]
    ds_read_b128 v[44:47], v13 offset:19456
    v_mfma_f32_16x16x32_bf16 v[88:91], a[48:51], v[52:55], v[88:91]
    v_mfma_f32_16x16x32_bf16 v[92:95], a[52:55], v[52:55], v[92:95]
    buffer_load_dwordx4 v10, s[12:15], s49 offen offset:2048 sc1 lds
    s_waitcnt lgkmcnt(4)
    v_mfma_f32_16x16x32_bf16 v[80:83], a[56:59], v[56:59], v[80:83]
    ds_read_b128 v[48:51], v13 offset:20480
    v_mfma_f32_16x16x32_bf16 v[84:87], a[60:63], v[56:59], v[84:87]
    ds_read_b128 v[52:55], v13 offset:21504
    v_mfma_f32_16x16x32_bf16 v[88:91], a[56:59], v[60:63], v[88:91]
    v_mfma_f32_16x16x32_bf16 v[92:95], a[60:63], v[60:63], v[92:95]
    buffer_load_dwordx4 v10, s[12:15], s49 offen offset:3072 sc1 lds
    s_waitcnt lgkmcnt(4)
    v_mfma_f32_16x16x32_bf16 v[80:83], a[64:67], v[32:35], v[80:83]
    ds_read_b128 v[56:59], v13 offset:22528
    v_mfma_f32_16x16x32_bf16 v[84:87], a[68:71], v[32:35], v[84:87]
    ds_read_b128 v[60:63], v13 offset:23552
    v_mfma_f32_16x16x32_bf16 v[88:91], a[64:67], v[36:39], v[88:91]
    s_add_u32 s48, s53, 524288
    v_mfma_f32_16x16x32_bf16 v[92:95], a[68:71], v[36:39], v[92:95]
    s_add_u32 s46, s58, 2
    s_waitcnt lgkmcnt(4)
    v_mfma_f32_16x16x32_bf16 v[80:83], a[72:75], v[40:43], v[80:83]
    ds_read_b128 v[32:35], v13 offset:24576
    v_mfma_f32_16x16x32_bf16 v[84:87], a[76:79], v[40:43], v[84:87]
    ds_read_b128 v[36:39], v13 offset:25600
    v_mfma_f32_16x16x32_bf16 v[88:91], a[72:75], v[44:47], v[88:91]
    s_cmp_lt_u32 s46, s51
    s_cselect_b32 s48, s48, 0x20000000
    v_mfma_f32_16x16x32_bf16 v[92:95], a[76:79], v[44:47], v[92:95]
    s_add_u32 s49, s48, 4096
    s_waitcnt lgkmcnt(4)
    v_mfma_f32_16x16x32_bf16 v[80:83], a[80:83], v[48:51], v[80:83]
    ds_read_b128 v[40:43], v13 offset:26624
    v_mfma_f32_16x16x32_bf16 v[84:87], a[84:87], v[48:51], v[84:87]
    ds_read_b128 v[44:47], v13 offset:27648
    v_mfma_f32_16x16x32_bf16 v[88:91], a[80:83], v[52:55], v[88:91]
    s_mov_b32 s59, s54
    v_mfma_f32_16x16x32_bf16 v[92:95], a[84:87], v[52:55], v[92:95]
    s_waitcnt lgkmcnt(4)
    v_mfma_f32_16x16x32_bf16 v[80:83], a[88:91], v[56:59], v[80:83]
    ds_read_b128 v[48:51], v13 offset:28672
    v_mfma_f32_16x16x32_bf16 v[84:87], a[92:95], v[56:59], v[84:87]
    ds_read_b128 v[52:55], v13 offset:29696
    v_mfma_f32_16x16x32_bf16 v[88:91], a[88:91], v[60:63], v[88:91]
    v_mfma_f32_16x16x32_bf16 v[92:95], a[92:95], v[60:63], v[92:95]
    s_waitcnt lgkmcnt(4)
    v_mfma_f32_16x16x32_bf16 v[80:83], a[96:99], v[32:35], v[80:83]
    ds_read_b128 v[56:59], v13 offset:30720
    v_mfma_f32_16x16x32_bf16 v[84:87], a[100:103], v[32:35], v[84:87]
    ds_read_b128 v[60:63], v13 offset:31744
    v_mfma_f32_16x16x32_bf16 v[88:91], a[96:99], v[36:39], v[88:91]
    v_mfma_f32_16x16x32_bf16 v[92:95], a[100:103], v[36:39], v[92:95]
    s_waitcnt lgkmcnt(4)
    v_mfma_f32_16x16x32_bf16 v[80:83], a[104:107], v[40:43], v[80:83]
    ds_read_b128 v[216:219], v8 offset:0
    v_mfma_f32_16x16x32_bf16 v[84:87], a[108:111], v[40:43], v[84:87]
    ds_read_b128 v[220:223], v8 offset:1152
    v_mfma_f32_16x16x32_bf16 v[88:91], a[104:107], v[44:47], v[88:91]
    ds_read_b128 v[224:227], v8 offset:2304
    v_mfma_f32_16x16x32_bf16 v[92:95], a[108:111], v[44:47], v[92:95]
    ds_read_b128 v[228:231], v8 offset:3456
    s_waitcnt vmcnt(16) lgkmcnt(0)
    s_barrier
    v_mfma_f32_16x16x32_bf16 v[80:83], a[112:115], v[48:51], v[80:83]
    ds_read_b128 v[32:35], v13 offset:32768
    buffer_store_dwordx4 v[216:219], v11, s[12:15], s76 offen sc1
    v_mfma_f32_16x16x32_bf16 v[84:87], a[116:119], v[48:51], v[84:87]
    ds_read_b128 v[36:39], v13 offset:33792
    s_add_u32 s76, s76, 32768
    v_mfma_f32_16x16x32_bf16 v[88:91], a[112:115], v[52:55], v[88:91]
    buffer_store_dwordx4 v[220:223], v11, s[12:15], s76 offen sc1
    s_add_u32 s76, s76, 32768
    v_mfma_f32_16x16x32_bf16 v[92:95], a[116:119], v[52:55], v[92:95]
    buffer_store_dwordx4 v[224:227], v11, s[12:15], s76 offen sc1
    v_mfma_f32_16x16x32_bf16 v[80:83], a[120:123], v[56:59], v[80:83]
    ds_read_b128 v[40:43], v13 offset:34816
    s_add_u32 s76, s76, 32768
    v_mfma_f32_16x16x32_bf16 v[84:87], a[124:127], v[56:59], v[84:87]
    ds_read_b128 v[44:47], v13 offset:35840
    buffer_store_dwordx4 v[228:231], v11, s[12:15], s76 offen sc1
    v_mfma_f32_16x16x32_bf16 v[88:91], a[120:123], v[60:63], v[88:91]
    v_mfma_f32_16x16x32_bf16 v[92:95], a[124:127], v[60:63], v[92:95]
    s_waitcnt lgkmcnt(2)
    v_mfma_f32_16x16x32_bf16 v[80:83], a[128:131], v[32:35], v[80:83]
    ds_read_b128 v[48:51], v13 offset:36864
    v_mfma_f32_16x16x32_bf16 v[84:87], a[132:135], v[32:35], v[84:87]
    ds_read_b128 v[52:55], v13 offset:37888
    v_mfma_f32_16x16x32_bf16 v[88:91], a[128:131], v[36:39], v[88:91]
    ds_read_b128 v[56:59], v13 offset:38912
    s_add_u32 m0, s59, 0
    v_mfma_f32_16x16x32_bf16 v[92:95], a[132:135], v[36:39], v[92:95]
    ds_read_b128 v[60:63], v13 offset:39936
    buffer_load_dwordx4 v10, s[12:15], s48 offen offset:0 sc1 lds
    s_waitcnt lgkmcnt(4)
    v_mfma_f32_16x16x32_bf16 v[80:83], a[136:139], v[40:43], v[80:83]
    ds_read_b128 v[32:35], v13 offset:40960
    v_mfma_f32_16x16x32_bf16 v[84:87], a[140:143], v[40:43], v[84:87]
    ds_read_b128 v[36:39], v13 offset:41984
    v_mfma_f32_16x16x32_bf16 v[88:91], a[136:139], v[44:47], v[88:91]
    v_mfma_f32_16x16x32_bf16 v[92:95], a[140:143], v[44:47], v[92:95]
    buffer_load_dwordx4 v10, s[12:15], s48 offen offset:1024 sc1 lds
    s_waitcnt lgkmcnt(4)
    v_mfma_f32_16x16x32_bf16 v[80:83], a[144:147], v[48:51], v[80:83]
    ds_read_b128 v[40:43], v13 offset:43008
    v_mfma_f32_16x16x32_bf16 v[84:87], a[148:151], v[48:51], v[84:87]
    ds_read_b128 v[44:47], v13 offset:44032
    v_mfma_f32_16x16x32_bf16 v[88:91], a[144:147], v[52:55], v[88:91]
    v_mfma_f32_16x16x32_bf16 v[92:95], a[148:151], v[52:55], v[92:95]
    buffer_load_dwordx4 v10, s[12:15], s48 offen offset:2048 sc1 lds
    s_waitcnt lgkmcnt(4)
    v_mfma_f32_16x16x32_bf16 v[80:83], a[152:155], v[56:59], v[80:83]
    ds_read_b128 v[48:51], v13 offset:45056
    v_mfma_f32_16x16x32_bf16 v[84:87], a[156:159], v[56:59], v[84:87]
    ds_read_b128 v[52:55], v13 offset:46080
    v_mfma_f32_16x16x32_bf16 v[88:91], a[152:155], v[60:63], v[88:91]
    v_mfma_f32_16x16x32_bf16 v[92:95], a[156:159], v[60:63], v[92:95]
    buffer_load_dwordx4 v10, s[12:15], s48 offen offset:3072 sc1 lds
    s_waitcnt lgkmcnt(4)
    v_mfma_f32_16x16x32_bf16 v[80:83], a[160:163], v[32:35], v[80:83]
    ds_read_b128 v[56:59], v13 offset:47104
    v_mfma_f32_16x16x32_bf16 v[84:87], a[164:167], v[32:35], v[84:87]
    ds_read_b128 v[60:63], v13 offset:48128
    v_mfma_f32_16x16x32_bf16 v[88:91], a[160:163], v[36:39], v[88:91]
    s_add_u32 m0, s59, 4096
    v_mfma_f32_16x16x32_bf16 v[92:95], a[164:167], v[36:39], v[92:95]
    buffer_load_dwordx4 v10, s[12:15], s49 offen offset:0 sc1 lds
    s_waitcnt lgkmcnt(4)
    v_mfma_f32_16x16x32_bf16 v[80:83], a[168:171], v[40:43], v[80:83]
    ds_read_b128 v[32:35], v13 offset:49152
    v_mfma_f32_16x16x32_bf16 v[84:87], a[172:175], v[40:43], v[84:87]
    ds_read_b128 v[36:39], v13 offset:50176
    v_mfma_f32_16x16x32_bf16 v[88:91], a[168:171], v[44:47], v[88:91]
    v_mfma_f32_16x16x32_bf16 v[92:95], a[172:175], v[44:47], v[92:95]
    buffer_load_dwordx4 v10, s[12:15], s49 offen offset:1024 sc1 lds
    s_waitcnt lgkmcnt(4)
    v_mfma_f32_16x16x32_bf16 v[80:83], a[176:179], v[48:51], v[80:83]
    ds_read_b128 v[40:43], v13 offset:51200
    v_mfma_f32_16x16x32_bf16 v[84:87], a[180:183], v[48:51], v[84:87]
    ds_read_b128 v[44:47], v13 offset:52224
    v_mfma_f32_16x16x32_bf16 v[88:91], a[176:179], v[52:55], v[88:91]
    v_mfma_f32_16x16x32_bf16 v[92:95], a[180:183], v[52:55], v[92:95]
    buffer_load_dwordx4 v10, s[12:15], s49 offen offset:2048 sc1 lds
    s_waitcnt lgkmcnt(4)
    v_mfma_f32_16x16x32_bf16 v[80:83], a[184:187], v[56:59], v[80:83]
    ds_read_b128 v[48:51], v13 offset:53248
    v_mfma_f32_16x16x32_bf16 v[84:87], a[188:191], v[56:59], v[84:87]
    ds_read_b128 v[52:55], v13 offset:54272
    v_mfma_f32_16x16x32_bf16 v[88:91], a[184:187], v[60:63], v[88:91]
    v_mfma_f32_16x16x32_bf16 v[92:95], a[188:191], v[60:63], v[92:95]
    buffer_load_dwordx4 v10, s[12:15], s49 offen offset:3072 sc1 lds
    s_waitcnt lgkmcnt(4)
    v_mfma_f32_16x16x32_bf16 v[80:83], a[192:195], v[32:35], v[80:83]
    ds_read_b128 v[56:59], v13 offset:55296
    v_mfma_f32_16x16x32_bf16 v[84:87], a[196:199], v[32:35], v[84:87]
    ds_read_b128 v[60:63], v13 offset:56320
    v_mfma_f32_16x16x32_bf16 v[88:91], a[192:195], v[36:39], v[88:91]
    s_add_u32 s48, s53, 557056
    v_mfma_f32_16x16x32_bf16 v[92:95], a[196:199], v[36:39], v[92:95]
    s_add_u32 s46, s58, 2
    s_waitcnt lgkmcnt(4)
    v_mfma_f32_16x16x32_bf16 v[80:83], a[200:203], v[40:43], v[80:83]
    ds_read_b128 v[32:35], v13 offset:57344
    v_mfma_f32_16x16x32_bf16 v[84:87], a[204:207], v[40:43], v[84:87]
    ds_read_b128 v[36:39], v13 offset:58368
    v_mfma_f32_16x16x32_bf16 v[88:91], a[200:203], v[44:47], v[88:91]
    s_cmp_lt_u32 s46, s51
    s_cselect_b32 s48, s48, 0x20000000
    v_mfma_f32_16x16x32_bf16 v[92:95], a[204:207], v[44:47], v[92:95]
    s_add_u32 s49, s48, 4096
    s_waitcnt lgkmcnt(4)
    v_mfma_f32_16x16x32_bf16 v[80:83], a[208:211], v[48:51], v[80:83]
    ds_read_b128 v[40:43], v13 offset:59392
    v_mfma_f32_16x16x32_bf16 v[84:87], a[212:215], v[48:51], v[84:87]
    ds_read_b128 v[44:47], v13 offset:60416
    v_mfma_f32_16x16x32_bf16 v[88:91], a[208:211], v[52:55], v[88:91]
    s_add_u32 s59, s54, 32768
    v_mfma_f32_16x16x32_bf16 v[92:95], a[212:215], v[52:55], v[92:95]
    s_waitcnt lgkmcnt(4)
    v_mfma_f32_16x16x32_bf16 v[80:83], a[216:219], v[56:59], v[80:83]
    ds_read_b128 v[48:51], v13 offset:61440
    v_mfma_f32_16x16x32_bf16 v[84:87], a[220:223], v[56:59], v[84:87]
    ds_read_b128 v[52:55], v13 offset:62464
    v_mfma_f32_16x16x32_bf16 v[88:91], a[216:219], v[60:63], v[88:91]
    v_mfma_f32_16x16x32_bf16 v[92:95], a[220:223], v[60:63], v[92:95]
    s_waitcnt lgkmcnt(4)
    v_mfma_f32_16x16x32_bf16 v[80:83], a[224:227], v[32:35], v[80:83]
    ds_read_b128 v[56:59], v13 offset:63488
    v_mfma_f32_16x16x32_bf16 v[84:87], a[228:231], v[32:35], v[84:87]
    ds_read_b128 v[60:63], v13 offset:64512
    v_mfma_f32_16x16x32_bf16 v[88:91], a[224:227], v[36:39], v[88:91]
    v_mfma_f32_16x16x32_bf16 v[92:95], a[228:231], v[36:39], v[92:95]
    s_waitcnt lgkmcnt(4)
    v_mfma_f32_16x16x32_bf16 v[80:83], a[232:235], v[40:43], v[80:83]
    v_mfma_f32_16x16x32_bf16 v[84:87], a[236:239], v[40:43], v[84:87]
    v_mfma_f32_16x16x32_bf16 v[88:91], a[232:235], v[44:47], v[88:91]
    v_mfma_f32_16x16x32_bf16 v[92:95], a[236:239], v[44:47], v[92:95]
    s_waitcnt vmcnt(16) lgkmcnt(0)
    s_barrier
    v_mfma_f32_16x16x32_bf16 v[80:83], a[240:243], v[48:51], v[80:83]
    ds_read_b128 v[32:35], v14 offset:0
    v_mfma_f32_16x16x32_bf16 v[84:87], a[244:247], v[48:51], v[84:87]
    ds_read_b128 v[36:39], v14 offset:1024
    v_mfma_f32_16x16x32_bf16 v[88:91], a[240:243], v[52:55], v[88:91]
    v_mfma_f32_16x16x32_bf16 v[92:95], a[244:247], v[52:55], v[92:95]
    v_mfma_f32_16x16x32_bf16 v[80:83], a[248:251], v[56:59], v[80:83]
    ds_read_b128 v[40:43], v14 offset:2048
    v_mfma_f32_16x16x32_bf16 v[84:87], a[252:255], v[56:59], v[84:87]
    ds_read_b128 v[44:47], v14 offset:3072
    v_mfma_f32_16x16x32_bf16 v[88:91], a[248:251], v[60:63], v[88:91]
    v_mfma_f32_16x16x32_bf16 v[92:95], a[252:255], v[60:63], v[92:95]
    s_add_u32 s53, s53, 262144
    s_add_u32 s58, s58, 1
    v_swap_b32 v13, v14
    s_xor_b32 s54, s54, 65536
    s_xor_b32 s55, s55, 65536
    s_mov_b32 s76, s57
    v_swap_b32 v15, v16
    s_add_u32 s57, s57, 131072
    ds_write_b128 v7, v[80:83] offset:0
    ds_write_b128 v7, v[84:87] offset:64
    ds_write_b128 v7, v[88:91] offset:2304
    ds_write_b128 v7, v[92:95] offset:2368
    s_cmp_lt_u32 s58, s51
    s_cbranch_scc1 L_e_loop_145
    s_branch L_e_fin_147
L_e_one_146:
    s_waitcnt vmcnt(8)
    s_barrier
    ds_read_b128 v[32:35], v13 offset:0
    ds_read_b128 v[36:39], v13 offset:1024
    ds_read_b128 v[40:43], v13 offset:2048
    ds_read_b128 v[44:47], v13 offset:3072
    s_waitcnt lgkmcnt(2)
    v_mfma_f32_16x16x32_bf16 v[80:83], a[0:3], v[32:35], 0
    ds_read_b128 v[48:51], v13 offset:4096
    v_mfma_f32_16x16x32_bf16 v[84:87], a[4:7], v[32:35], 0
    ds_read_b128 v[52:55], v13 offset:5120
    v_mfma_f32_16x16x32_bf16 v[88:91], a[0:3], v[36:39], 0
    ds_read_b128 v[56:59], v13 offset:6144
    v_mfma_f32_16x16x32_bf16 v[92:95], a[4:7], v[36:39], 0
    ds_read_b128 v[60:63], v13 offset:7168
    s_waitcnt lgkmcnt(4)
    v_mfma_f32_16x16x32_bf16 v[80:83], a[8:11], v[40:43], v[80:83]
    ds_read_b128 v[32:35], v13 offset:8192
    v_mfma_f32_16x16x32_bf16 v[84:87], a[12:15], v[40:43], v[84:87]
    ds_read_b128 v[36:39], v13 offset:9216
    v_mfma_f32_16x16x32_bf16 v[88:91], a[8:11], v[44:47], v[88:91]
    v_mfma_f32_16x16x32_bf16 v[92:95], a[12:15], v[44:47], v[92:95]
    s_waitcnt lgkmcnt(4)
    v_mfma_f32_16x16x32_bf16 v[80:83], a[16:19], v[48:51], v[80:83]
    ds_read_b128 v[40:43], v13 offset:10240
    v_mfma_f32_16x16x32_bf16 v[84:87], a[20:23], v[48:51], v[84:87]
    ds_read_b128 v[44:47], v13 offset:11264
    v_mfma_f32_16x16x32_bf16 v[88:91], a[16:19], v[52:55], v[88:91]
    v_mfma_f32_16x16x32_bf16 v[92:95], a[20:23], v[52:55], v[92:95]
    s_waitcnt lgkmcnt(4)
    v_mfma_f32_16x16x32_bf16 v[80:83], a[24:27], v[56:59], v[80:83]
    ds_read_b128 v[48:51], v13 offset:12288
    v_mfma_f32_16x16x32_bf16 v[84:87], a[28:31], v[56:59], v[84:87]
    ds_read_b128 v[52:55], v13 offset:13312
    v_mfma_f32_16x16x32_bf16 v[88:91], a[24:27], v[60:63], v[88:91]
    v_mfma_f32_16x16x32_bf16 v[92:95], a[28:31], v[60:63], v[92:95]
    s_waitcnt lgkmcnt(4)
    v_mfma_f32_16x16x32_bf16 v[80:83], a[32:35], v[32:35], v[80:83]
    ds_read_b128 v[56:59], v13 offset:14336
    v_mfma_f32_16x16x32_bf16 v[84:87], a[36:39], v[32:35], v[84:87]
    ds_read_b128 v[60:63], v13 offset:15360
    v_mfma_f32_16x16x32_bf16 v[88:91], a[32:35], v[36:39], v[88:91]
    v_mfma_f32_16x16x32_bf16 v[92:95], a[36:39], v[36:39], v[92:95]
    s_waitcnt lgkmcnt(4)
    v_mfma_f32_16x16x32_bf16 v[80:83], a[40:43], v[40:43], v[80:83]
    ds_read_b128 v[32:35], v13 offset:16384
    v_mfma_f32_16x16x32_bf16 v[84:87], a[44:47], v[40:43], v[84:87]
    ds_read_b128 v[36:39], v13 offset:17408
    v_mfma_f32_16x16x32_bf16 v[88:91], a[40:43], v[44:47], v[88:91]
    v_mfma_f32_16x16x32_bf16 v[92:95], a[44:47], v[44:47], v[92:95]
    s_waitcnt lgkmcnt(4)
    v_mfma_f32_16x16x32_bf16 v[80:83], a[48:51], v[48:51], v[80:83]
    ds_read_b128 v[40:43], v13 offset:18432
    v_mfma_f32_16x16x32_bf16 v[84:87], a[52:55], v[48:51], v[84:87]
    ds_read_b128 v[44:47], v13 offset:19456
    v_mfma_f32_16x16x32_bf16 v[88:91], a[48:51], v[52:55], v[88:91]
    v_mfma_f32_16x16x32_bf16 v[92:95], a[52:55], v[52:55], v[92:95]
    s_waitcnt lgkmcnt(4)
    v_mfma_f32_16x16x32_bf16 v[80:83], a[56:59], v[56:59], v[80:83]
    ds_read_b128 v[48:51], v13 offset:20480
    v_mfma_f32_16x16x32_bf16 v[84:87], a[60:63], v[56:59], v[84:87]
    ds_read_b128 v[52:55], v13 offset:21504
    v_mfma_f32_16x16x32_bf16 v[88:91], a[56:59], v[60:63], v[88:91]
    v_mfma_f32_16x16x32_bf16 v[92:95], a[60:63], v[60:63], v[92:95]
    s_waitcnt lgkmcnt(4)
    v_mfma_f32_16x16x32_bf16 v[80:83], a[64:67], v[32:35], v[80:83]
    ds_read_b128 v[56:59], v13 offset:22528
    v_mfma_f32_16x16x32_bf16 v[84:87], a[68:71], v[32:35], v[84:87]
    ds_read_b128 v[60:63], v13 offset:23552
    v_mfma_f32_16x16x32_bf16 v[88:91], a[64:67], v[36:39], v[88:91]
    v_mfma_f32_16x16x32_bf16 v[92:95], a[68:71], v[36:39], v[92:95]
    s_waitcnt lgkmcnt(4)
    v_mfma_f32_16x16x32_bf16 v[80:83], a[72:75], v[40:43], v[80:83]
    ds_read_b128 v[32:35], v13 offset:24576
    v_mfma_f32_16x16x32_bf16 v[84:87], a[76:79], v[40:43], v[84:87]
    ds_read_b128 v[36:39], v13 offset:25600
    v_mfma_f32_16x16x32_bf16 v[88:91], a[72:75], v[44:47], v[88:91]
    v_mfma_f32_16x16x32_bf16 v[92:95], a[76:79], v[44:47], v[92:95]
    s_waitcnt lgkmcnt(4)
    v_mfma_f32_16x16x32_bf16 v[80:83], a[80:83], v[48:51], v[80:83]
    ds_read_b128 v[40:43], v13 offset:26624
    v_mfma_f32_16x16x32_bf16 v[84:87], a[84:87], v[48:51], v[84:87]
    ds_read_b128 v[44:47], v13 offset:27648
    v_mfma_f32_16x16x32_bf16 v[88:91], a[80:83], v[52:55], v[88:91]
    v_mfma_f32_16x16x32_bf16 v[92:95], a[84:87], v[52:55], v[92:95]
    s_waitcnt lgkmcnt(4)
    v_mfma_f32_16x16x32_bf16 v[80:83], a[88:91], v[56:59], v[80:83]
    ds_read_b128 v[48:51], v13 offset:28672
    v_mfma_f32_16x16x32_bf16 v[84:87], a[92:95], v[56:59], v[84:87]
    ds_read_b128 v[52:55], v13 offset:29696
    v_mfma_f32_16x16x32_bf16 v[88:91], a[88:91], v[60:63], v[88:91]
    v_mfma_f32_16x16x32_bf16 v[92:95], a[92:95], v[60:63], v[92:95]
    s_waitcnt lgkmcnt(4)
    v_mfma_f32_16x16x32_bf16 v[80:83], a[96:99], v[32:35], v[80:83]
    ds_read_b128 v[56:59], v13 offset:30720
    v_mfma_f32_16x16x32_bf16 v[84:87], a[100:103], v[32:35], v[84:87]
    ds_read_b128 v[60:63], v13 offset:31744
    v_mfma_f32_16x16x32_bf16 v[88:91], a[96:99], v[36:39], v[88:91]
    v_mfma_f32_16x16x32_bf16 v[92:95], a[100:103], v[36:39], v[92:95]
    s_waitcnt lgkmcnt(4)
    v_mfma_f32_16x16x32_bf16 v[80:83], a[104:107], v[40:43], v[80:83]
    v_mfma_f32_16x16x32_bf16 v[84:87], a[108:111], v[40:43], v[84:87]
    v_mfma_f32_16x16x32_bf16 v[88:91], a[104:107], v[44:47], v[88:91]
    v_mfma_f32_16x16x32_bf16 v[92:95], a[108:111], v[44:47], v[92:95]
    s_waitcnt vmcnt(0) lgkmcnt(0)
    s_barrier
    v_mfma_f32_16x16x32_bf16 v[80:83], a[112:115], v[48:51], v[80:83]
    ds_read_b128 v[32:35], v13 offset:32768
    v_mfma_f32_16x16x32_bf16 v[84:87], a[116:119], v[48:51], v[84:87]
    ds_read_b128 v[36:39], v13 offset:33792
    v_mfma_f32_16x16x32_bf16 v[88:91], a[112:115], v[52:55], v[88:91]
    v_mfma_f32_16x16x32_bf16 v[92:95], a[116:119], v[52:55], v[92:95]
    v_mfma_f32_16x16x32_bf16 v[80:83], a[120:123], v[56:59], v[80:83]
    ds_read_b128 v[40:43], v13 offset:34816
    v_mfma_f32_16x16x32_bf16 v[84:87], a[124:127], v[56:59], v[84:87]
    ds_read_b128 v[44:47], v13 offset:35840
    v_mfma_f32_16x16x32_bf16 v[88:91], a[120:123], v[60:63], v[88:91]
    v_mfma_f32_16x16x32_bf16 v[92:95], a[124:127], v[60:63], v[92:95]
    s_waitcnt lgkmcnt(2)
    v_mfma_f32_16x16x32_bf16 v[80:83], a[128:131], v[32:35], v[80:83]
    ds_read_b128 v[48:51], v13 offset:36864
    v_mfma_f32_16x16x32_bf16 v[84:87], a[132:135], v[32:35], v[84:87]
    ds_read_b128 v[52:55], v13 offset:37888
    v_mfma_f32_16x16x32_bf16 v[88:91], a[128:131], v[36:39], v[88:91]
    ds_read_b128 v[56:59], v13 offset:38912
    v_mfma_f32_16x16x32_bf16 v[92:95], a[132:135], v[36:39], v[92:95]
    ds_read_b128 v[60:63], v13 offset:39936
    s_waitcnt lgkmcnt(4)
    v_mfma_f32_16x16x32_bf16 v[80:83], a[136:139], v[40:43], v[80:83]
    ds_read_b128 v[32:35], v13 offset:40960
    v_mfma_f32_16x16x32_bf16 v[84:87], a[140:143], v[40:43], v[84:87]
    ds_read_b128 v[36:39], v13 offset:41984
    v_mfma_f32_16x16x32_bf16 v[88:91], a[136:139], v[44:47], v[88:91]
    v_mfma_f32_16x16x32_bf16 v[92:95], a[140:143], v[44:47], v[92:95]
    s_waitcnt lgkmcnt(4)
    v_mfma_f32_16x16x32_bf16 v[80:83], a[144:147], v[48:51], v[80:83]
    ds_read_b128 v[40:43], v13 offset:43008
    v_mfma_f32_16x16x32_bf16 v[84:87], a[148:151], v[48:51], v[84:87]
    ds_read_b128 v[44:47], v13 offset:44032
    v_mfma_f32_16x16x32_bf16 v[88:91], a[144:147], v[52:55], v[88:91]
    v_mfma_f32_16x16x32_bf16 v[92:95], a[148:151], v[52:55], v[92:95]
    s_waitcnt lgkmcnt(4)
    v_mfma_f32_16x16x32_bf16 v[80:83], a[152:155], v[56:59], v[80:83]
    ds_read_b128 v[48:51], v13 offset:45056
    v_mfma_f32_16x16x32_bf16 v[84:87], a[156:159], v[56:59], v[84:87]
    ds_read_b128 v[52:55], v13 offset:46080
    v_mfma_f32_16x16x32_bf16 v[88:91], a[152:155], v[60:63], v[88:91]
    v_mfma_f32_16x16x32_bf16 v[92:95], a[156:159], v[60:63], v[92:95]
    s_waitcnt lgkmcnt(4)
    v_mfma_f32_16x16x32_bf16 v[80:83], a[160:163], v[32:35], v[80:83]
    ds_read_b128 v[56:59], v13 offset:47104
    v_mfma_f32_16x16x32_bf16 v[84:87], a[164:167], v[32:35], v[84:87]
    ds_read_b128 v[60:63], v13 offset:48128
    v_mfma_f32_16x16x32_bf16 v[88:91], a[160:163], v[36:39], v[88:91]
    v_mfma_f32_16x16x32_bf16 v[92:95], a[164:167], v[36:39], v[92:95]
    s_waitcnt lgkmcnt(4)
    v_mfma_f32_16x16x32_bf16 v[80:83], a[168:171], v[40:43], v[80:83]
    ds_read_b128 v[32:35], v13 offset:49152
    v_mfma_f32_16x16x32_bf16 v[84:87], a[172:175], v[40:43], v[84:87]
    ds_read_b128 v[36:39], v13 offset:50176
    v_mfma_f32_16x16x32_bf16 v[88:91], a[168:171], v[44:47], v[88:91]
    v_mfma_f32_16x16x32_bf16 v[92:95], a[172:175], v[44:47], v[92:95]
    s_waitcnt lgkmcnt(4)
    v_mfma_f32_16x16x32_bf16 v[80:83], a[176:179], v[48:51], v[80:83]
    ds_read_b128 v[40:43], v13 offset:51200
    v_mfma_f32_16x16x32_bf16 v[84:87], a[180:183], v[48:51], v[84:87]
    ds_read_b128 v[44:47], v13 offset:52224
    v_mfma_f32_16x16x32_bf16 v[88:91], a[176:179], v[52:55], v[88:91]
    v_mfma_f32_16x16x32_bf16 v[92:95], a[180:183], v[52:55], v[92:95]
    s_waitcnt lgkmcnt(4)
    v_mfma_f32_16x16x32_bf16 v[80:83], a[184:187], v[56:59], v[80:83]
    ds_read_b128 v[48:51], v13 offset:53248
    v_mfma_f32_16x16x32_bf16 v[84:87], a[188:191], v[56:59], v[84:87]
    ds_read_b128 v[52:55], v13 offset:54272
    v_mfma_f32_16x16x32_bf16 v[88:91], a[184:187], v[60:63], v[88:91]
    v_mfma_f32_16x16x32_bf16 v[92:95], a[188:191], v[60:63], v[92:95]
    s_waitcnt lgkmcnt(4)
    v_mfma_f32_16x16x32_bf16 v[80:83], a[192:195], v[32:35], v[80:83]
    ds_read_b128 v[56:59], v13 offset:55296
    v_mfma_f32_16x16x32_bf16 v[84:87], a[196:199], v[32:35], v[84:87]
    ds_read_b128 v[60:63], v13 offset:56320
    v_mfma_f32_16x16x32_bf16 v[88:91], a[192:195], v[36:39], v[88:91]
    v_mfma_f32_16x16x32_bf16 v[92:95], a[196:199], v[36:39], v[92:95]
    s_waitcnt lgkmcnt(4)
    v_mfma_f32_16x16x32_bf16 v[80:83], a[200:203], v[40:43], v[80:83]
    ds_read_b128 v[32:35], v13 offset:57344
    v_mfma_f32_16x16x32_bf16 v[84:87], a[204:207], v[40:43], v[84:87]
    ds_read_b128 v[36:39], v13 offset:58368
    v_mfma_f32_16x16x32_bf16 v[88:91], a[200:203], v[44:47], v[88:91]
    v_mfma_f32_16x16x32_bf16 v[92:95], a[204:207], v[44:47], v[92:95]
    s_waitcnt lgkmcnt(4)
    v_mfma_f32_16x16x32_bf16 v[80:83], a[208:211], v[48:51], v[80:83]
    ds_read_b128 v[40:43], v13 offset:59392
    v_mfma_f32_16x16x32_bf16 v[84:87], a[212:215], v[48:51], v[84:87]
    ds_read_b128 v[44:47], v13 offset:60416
    v_mfma_f32_16x16x32_bf16 v[88:91], a[208:211], v[52:55], v[88:91]
    v_mfma_f32_16x16x32_bf16 v[92:95], a[212:215], v[52:55], v[92:95]
    s_waitcnt lgkmcnt(4)
    v_mfma_f32_16x16x32_bf16 v[80:83], a[216:219], v[56:59], v[80:83]
    ds_read_b128 v[48:51], v13 offset:61440
    v_mfma_f32_16x16x32_bf16 v[84:87], a[220:223], v[56:59], v[84:87]
    ds_read_b128 v[52:55], v13 offset:62464
    v_mfma_f32_16x16x32_bf16 v[88:91], a[216:219], v[60:63], v[88:91]
    v_mfma_f32_16x16x32_bf16 v[92:95], a[220:223], v[60:63], v[92:95]
    s_waitcnt lgkmcnt(4)
    v_mfma_f32_16x16x32_bf16 v[80:83], a[224:227], v[32:35], v[80:83]
    ds_read_b128 v[56:59], v13 offset:63488
    v_mfma_f32_16x16x32_bf16 v[84:87], a[228:231], v[32:35], v[84:87]
    ds_read_b128 v[60:63], v13 offset:64512
    v_mfma_f32_16x16x32_bf16 v[88:91], a[224:227], v[36:39], v[88:91]
    v_mfma_f32_16x16x32_bf16 v[92:95], a[228:231], v[36:39], v[92:95]
    s_waitcnt lgkmcnt(4)
    v_mfma_f32_16x16x32_bf16 v[80:83], a[232:235], v[40:43], v[80:83]
    v_mfma_f32_16x16x32_bf16 v[84:87], a[236:239], v[40:43], v[84:87]
    v_mfma_f32_16x16x32_bf16 v[88:91], a[232:235], v[44:47], v[88:91]
    v_mfma_f32_16x16x32_bf16 v[92:95], a[236:239], v[44:47], v[92:95]
    s_waitcnt lgkmcnt(0)
    v_mfma_f32_16x16x32_bf16 v[80:83], a[240:243], v[48:51], v[80:83]
    v_mfma_f32_16x16x32_bf16 v[84:87], a[244:247], v[48:51], v[84:87]
    v_mfma_f32_16x16x32_bf16 v[88:91], a[240:243], v[52:55], v[88:91]
    v_mfma_f32_16x16x32_bf16 v[92:95], a[244:247], v[52:55], v[92:95]
    v_mfma_f32_16x16x32_bf16 v[80:83], a[248:251], v[56:59], v[80:83]
    v_mfma_f32_16x16x32_bf16 v[84:87], a[252:255], v[56:59], v[84:87]
    v_mfma_f32_16x16x32_bf16 v[88:91], a[248:251], v[60:63], v[88:91]
    v_mfma_f32_16x16x32_bf16 v[92:95], a[252:255], v[60:63], v[92:95]
    s_mov_b32 s76, s57
    s_nop 6
    ds_write_b128 v7, v[80:83] offset:0
    ds_write_b128 v7, v[84:87] offset:64
    ds_write_b128 v7, v[88:91] offset:2304
    ds_write_b128 v7, v[92:95] offset:2368
L_e_fin_147:
    s_waitcnt lgkmcnt(0)
    ds_read_b128 v[216:219], v8 offset:0
    ds_read_b128 v[220:223], v8 offset:1152
    ds_read_b128 v[224:227], v8 offset:2304
    ds_read_b128 v[228:231], v8 offset:3456
    s_waitcnt lgkmcnt(0)
    buffer_store_dwordx4 v[216:219], v11, s[12:15], s76 offen sc1
    s_add_u32 s76, s76, 32768
    buffer_store_dwordx4 v[220:223], v11, s[12:15], s76 offen sc1
    s_add_u32 s76, s76, 32768
    buffer_store_dwordx4 v[224:227], v11, s[12:15], s76 offen sc1
    s_add_u32 s76, s76, 32768
    buffer_store_dwordx4 v[228:231], v11, s[12:15], s76 offen sc1
    s_mov_b32 s92, s62
    s_cmp_eq_u32 s51, 1
    s_cbranch_scc1 L_a_loop_128_b
    s_waitcnt vmcnt(4)
L_a_loop_128_b:
    s_barrier
    s_branch L_a_loop_128
L_a_fin_133:
    s_waitcnt vmcnt(0)
    s_barrier
    s_cmp_lg_u32 s44, 0
    s_cbranch_scc1 L_pub_148
    v_mov_b32 v30, s92
    v_mov_b32 v31, 0
    s_mov_b64 exec, 1
    buffer_store_dword v30, v31, s[12:15], s67 offen sc1
    s_mov_b64 exec, -1
L_pub_148:
    s_branch L_w_done_98
L_role_b_126:
    s_load_dwordx2 s[6:7], s[0:1], 64
    s_load_dwordx2 s[8:9], s[0:1], 72
    s_waitcnt lgkmcnt(0)
    s_mov_b32 s24, s6
    s_and_b32 s25, s7, 0xffff
    s_mov_b32 s26, 0x700000
    s_mov_b32 s27, 0x00020000
    s_mov_b32 s32, s8
    s_and_b32 s33, s9, 0xffff
    s_mov_b32 s34, 0x1c00
    s_mov_b32 s35, 0x00020000
    s_min_u32 s45, s41, 27
    s_lshl_b32 s46, s45, 8
    s_waitcnt vmcnt(0)
    s_barrier
    v_lshrrev_b32 v20, 4, v1
    s_lshl_b32 s45, s44, 2
    v_add_u32 v21, s45, v20
    s_mov_b32 s45, 7168
    v_mul_lo_u32 v21, v21, s45
    v_lshlrev_b32 v22, 2, v20
    v_and_b32 v23, 15, v1
    v_xor_b32 v22, v22, v23
    v_lshlrev_b32 v22, 4, v22
    v_add_u32 v21, v21, v22
    v_bfe_u32 v22, v1, 2, 2
    v_lshlrev_b32 v23, 3, v20
    v_add_u32 v23, v23, v22
    v_lshlrev_b32 v23, 8, v23
    v_xor_b32 v22, s44, v22
    v_lshlrev_b32 v22, 6, v22
    v_add_u32 v23, v23, v22
    v_and_b32 v22, 3, v1
    v_lshlrev_b32 v22, 4, v22
    v_add_u32 v23, v23, v22
    v_add_u32 v24, 65536, v23
    v_add_u32 v25, 131072, v23
    s_lshl_b32 s47, s44, 10
    s_add_u32 s45, s46, 0x0
    s_add_u32 m0, s47, 0
    s_nop 0
    buffer_load_dwordx4 v21, s[24:27], s45 offen  lds
    s_add_u32 s45, s46, 0x1c000
    s_add_u32 m0, s47, 4096
    s_nop 0
    buffer_load_dwordx4 v21, s[24:27], s45 offen  lds
    s_add_u32 s45, s46, 0x38000
    s_add_u32 m0, s47, 8192
    s_nop 0
    buffer_load_dwordx4 v21, s[24:27], s45 offen  lds
    s_add_u32 s45, s46, 0x54000
    s_add_u32 m0, s47, 12288
    s_nop 0
    buffer_load_dwordx4 v21, s[24:27], s45 offen  lds
    s_add_u32 s45, s46, 0x70000
    s_add_u32 m0, s47, 16384
    s_nop 0
    buffer_load_dwordx4 v21, s[24:27], s45 offen  lds
    s_add_u32 s45, s46, 0x8c000
    s_add_u32 m0, s47, 20480
    s_nop 0
    buffer_load_dwordx4 v21, s[24:27], s45 offen  lds
    s_add_u32 s45, s46, 0xa8000
    s_add_u32 m0, s47, 24576
    s_nop 0
    buffer_load_dwordx4 v21, s[24:27], s45 offen  lds
    s_add_u32 s45, s46, 0xc4000
    s_add_u32 m0, s47, 28672
    s_nop 0
    buffer_load_dwordx4 v21, s[24:27], s45 offen  lds
    s_add_u32 s45, s46, 0xe0000
    s_add_u32 m0, s47, 32768
    s_nop 0
    buffer_load_dwordx4 v21, s[24:27], s45 offen  lds
    s_add_u32 s45, s46, 0xfc000
    s_add_u32 m0, s47, 36864
    s_nop 0
    buffer_load_dwordx4 v21, s[24:27], s45 offen  lds
    s_add_u32 s45, s46, 0x118000
    s_add_u32 m0, s47, 40960
    s_nop 0
    buffer_load_dwordx4 v21, s[24:27], s45 offen  lds
    s_add_u32 s45, s46, 0x134000
    s_add_u32 m0, s47, 45056
    s_nop 0
    buffer_load_dwordx4 v21, s[24:27], s45 offen  lds
    s_add_u32 s45, s46, 0x150000
    s_add_u32 m0, s47, 49152
    s_nop 0
    buffer_load_dwordx4 v21, s[24:27], s45 offen  lds
    s_add_u32 s45, s46, 0x16c000
    s_add_u32 m0, s47, 53248
    s_nop 0
    buffer_load_dwordx4 v21, s[24:27], s45 offen  lds
    s_add_u32 s45, s46, 0x188000
    s_add_u32 m0, s47, 57344
    s_nop 0
    buffer_load_dwordx4 v21, s[24:27], s45 offen  lds
    s_add_u32 s45, s46, 0x1a4000
    s_add_u32 m0, s47, 61440
    s_nop 0
    buffer_load_dwordx4 v21, s[24:27], s45 offen  lds
    s_add_u32 s45, s46, 0x1c0000
    s_add_u32 m0, s47, 65536
    s_nop 0
    buffer_load_dwordx4 v21, s[24:27], s45 offen  lds
    s_add_u32 s45, s46, 0x1dc000
    s_add_u32 m0, s47, 69632
    s_nop 0
    buffer_load_dwordx4 v21, s[24:27], s45 offen  lds
    s_add_u32 s45, s46, 0x1f8000
    s_add_u32 m0, s47, 73728
    s_nop 0
    buffer_load_dwordx4 v21, s[24:27], s45 offen  lds
    s_add_u32 s45, s46, 0x214000
    s_add_u32 m0, s47, 77824
    s_nop 0
    buffer_load_dwordx4 v21, s[24:27], s45 offen  lds
    s_add_u32 s45, s46, 0x230000
    s_add_u32 m0, s47, 81920
    s_nop 0
    buffer_load_dwordx4 v21, s[24:27], s45 offen  lds
    s_add_u32 s45, s46, 0x24c000
    s_add_u32 m0, s47, 86016
    s_nop 0
    buffer_load_dwordx4 v21, s[24:27], s45 offen  lds
    s_add_u32 s45, s46, 0x268000
    s_add_u32 m0, s47, 90112
    s_nop 0
    buffer_load_dwordx4 v21, s[24:27], s45 offen  lds
    s_add_u32 s45, s46, 0x284000
    s_add_u32 m0, s47, 94208
    s_nop 0
    buffer_load_dwordx4 v21, s[24:27], s45 offen  lds
    s_add_u32 s45, s46, 0x2a0000
    s_add_u32 m0, s47, 98304
    s_nop 0
    buffer_load_dwordx4 v21, s[24:27], s45 offen  lds
    s_add_u32 s45, s46, 0x2bc000
    s_add_u32 m0, s47, 102400
    s_nop 0
    buffer_load_dwordx4 v21, s[24:27], s45 offen  lds
    s_add_u32 s45, s46, 0x2d8000
    s_add_u32 m0, s47, 106496
    s_nop 0
    buffer_load_dwordx4 v21, s[24:27], s45 offen  lds
    s_add_u32 s45, s46, 0x2f4000
    s_add_u32 m0, s47, 110592
    s_nop 0
    buffer_load_dwordx4 v21, s[24:27], s45 offen  lds
    s_add_u32 s45, s46, 0x310000
    s_add_u32 m0, s47, 114688
    s_nop 0
    buffer_load_dwordx4 v21, s[24:27], s45 offen  lds
    s_add_u32 s45, s46, 0x32c000
    s_add_u32 m0, s47, 118784
    s_nop 0
    buffer_load_dwordx4 v21, s[24:27], s45 offen  lds
    s_add_u32 s45, s46, 0x348000
    s_add_u32 m0, s47, 122880
    s_nop 0
    buffer_load_dwordx4 v21, s[24:27], s45 offen  lds
    s_add_u32 s45, s46, 0x364000
    s_add_u32 m0, s47, 126976
    s_nop 0
    buffer_load_dwordx4 v21, s[24:27], s45 offen  lds
    s_waitcnt vmcnt(28)
    s_barrier
    s_add_u32 s45, s46, 0x380000
    s_add_u32 m0, s47, 131072
    s_nop 0
    buffer_load_dwordx4 v21, s[24:27], s45 offen  lds
    s_add_u32 s45, s46, 0x39c000
    s_add_u32 m0, s47, 135168
    s_nop 0
    buffer_load_dwordx4 v21, s[24:27], s45 offen  lds
    s_add_u32 s45, s46, 0x3b8000
    s_add_u32 m0, s47, 139264
    s_nop 0
    buffer_load_dwordx4 v21, s[24:27], s45 offen  lds
    s_add_u32 s45, s46, 0x3d4000
    s_add_u32 m0, s47, 143360
    s_nop 0
    buffer_load_dwordx4 v21, s[24:27], s45 offen  lds
    ds_read_b64_tr_b16 a[0:1], v23 offset:0
    ds_read_b64_tr_b16 a[2:3], v23 offset:1024
    ds_read_b64_tr_b16 a[4:5], v23 offset:8
    ds_read_b64_tr_b16 a[6:7], v23 offset:1032
    ds_read_b64_tr_b16 a[8:9], v23 offset:8192
    ds_read_b64_tr_b16 a[10:11], v23 offset:9216
    ds_read_b64_tr_b16 a[12:13], v23 offset:8200
    ds_read_b64_tr_b16 a[14:15], v23 offset:9224
    s_waitcnt lgkmcnt(0)
    s_waitcnt vmcnt(28)
    s_barrier
    s_add_u32 s45, s46, 0x3f0000
    s_add_u32 m0, s47, 0
    s_nop 0
    buffer_load_dwordx4 v21, s[24:27], s45 offen  lds
    s_add_u32 s45, s46, 0x40c000
    s_add_u32 m0, s47, 4096
    s_nop 0
    buffer_load_dwordx4 v21, s[24:27], s45 offen  lds
    s_add_u32 s45, s46, 0x428000
    s_add_u32 m0, s47, 8192
    s_nop 0
    buffer_load_dwordx4 v21, s[24:27], s45 offen  lds
    s_add_u32 s45, s46, 0x444000
    s_add_u32 m0, s47, 12288
    s_nop 0
    buffer_load_dwordx4 v21, s[24:27], s45 offen  lds
    ds_read_b64_tr_b16 a[16:17], v23 offset:16384
    ds_read_b64_tr_b16 a[18:19], v23 offset:17408
    ds_read_b64_tr_b16 a[20:21], v23 offset:16392
    ds_read_b64_tr_b16 a[22:23], v23 offset:17416
    ds_read_b64_tr_b16 a[24:25], v23 offset:24576
    ds_read_b64_tr_b16 a[26:27], v23 offset:25600
    ds_read_b64_tr_b16 a[28:29], v23 offset:24584
    ds_read_b64_tr_b16 a[30:31], v23 offset:25608
    s_waitcnt lgkmcnt(0)
    s_waitcnt vmcnt(28)
    s_barrier
    s_add_u32 s45, s46, 0x460000
    s_add_u32 m0, s47, 16384
    s_nop 0
    buffer_load_dwordx4 v21, s[24:27], s45 offen  lds
    s_add_u32 s45, s46, 0x47c000
    s_add_u32 m0, s47, 20480
    s_nop 0
    buffer_load_dwordx4 v21, s[24:27], s45 offen  lds
    s_add_u32 s45, s46, 0x498000
    s_add_u32 m0, s47, 24576
    s_nop 0
    buffer_load_dwordx4 v21, s[24:27], s45 offen  lds
    s_add_u32 s45, s46, 0x4b4000
    s_add_u32 m0, s47, 28672
    s_nop 0
    buffer_load_dwordx4 v21, s[24:27], s45 offen  lds
    ds_read_b64_tr_b16 a[32:33], v23 offset:32768
    ds_read_b64_tr_b16 a[34:35], v23 offset:33792
    ds_read_b64_tr_b16 a[36:37], v23 offset:32776
    ds_read_b64_tr_b16 a[38:39], v23 offset:33800
    ds_read_b64_tr_b16 a[40:41], v23 offset:40960
    ds_read_b64_tr_b16 a[42:43], v23 offset:41984
    ds_read_b64_tr_b16 a[44:45], v23 offset:40968
    ds_read_b64_tr_b16 a[46:47], v23 offset:41992
    s_waitcnt lgkmcnt(0)
    s_waitcnt vmcnt(28)
    s_barrier
    s_add_u32 s45, s46, 0x4d0000
    s_add_u32 m0, s47, 32768
    s_nop 0
    buffer_load_dwordx4 v21, s[24:27], s45 offen  lds
    s_add_u32 s45, s46, 0x4ec000
    s_add_u32 m0, s47, 36864
    s_nop 0
    buffer_load_dwordx4 v21, s[24:27], s45 offen  lds
    s_add_u32 s45, s46, 0x508000
    s_add_u32 m0, s47, 40960
    s_nop 0
    buffer_load_dwordx4 v21, s[24:27], s45 offen  lds
    s_add_u32 s45, s46, 0x524000
    s_add_u32 m0, s47, 45056
    s_nop 0
    buffer_load_dwordx4 v21, s[24:27], s45 offen  lds
    ds_read_b64_tr_b16 a[48:49], v23 offset:49152
    ds_read_b64_tr_b16 a[50:51], v23 offset:50176
    ds_read_b64_tr_b16 a[52:53], v23 offset:49160
    ds_read_b64_tr_b16 a[54:55], v23 offset:50184
    ds_read_b64_tr_b16 a[56:57], v23 offset:57344
    ds_read_b64_tr_b16 a[58:59], v23 offset:58368
    ds_read_b64_tr_b16 a[60:61], v23 offset:57352
    ds_read_b64_tr_b16 a[62:63], v23 offset:58376
    s_waitcnt lgkmcnt(0)
    s_waitcnt vmcnt(28)
    s_barrier
    s_add_u32 s45, s46, 0x540000
    s_add_u32 m0, s47, 49152
    s_nop 0
    buffer_load_dwordx4 v21, s[24:27], s45 offen  lds
    s_add_u32 s45, s46, 0x55c000
    s_add_u32 m0, s47, 53248
    s_nop 0
    buffer_load_dwordx4 v21, s[24:27], s45 offen  lds
    s_add_u32 s45, s46, 0x578000
    s_add_u32 m0, s47, 57344
    s_nop 0
    buffer_load_dwordx4 v21, s[24:27], s45 offen  lds
    s_add_u32 s45, s46, 0x594000
    s_add_u32 m0, s47, 61440
    s_nop 0
    buffer_load_dwordx4 v21, s[24:27], s45 offen  lds
    ds_read_b64_tr_b16 a[64:65], v24 offset:0
    ds_read_b64_tr_b16 a[66:67], v24 offset:1024
    ds_read_b64_tr_b16 a[68:69], v24 offset:8
    ds_read_b64_tr_b16 a[70:71], v24 offset:1032
    ds_read_b64_tr_b16 a[72:73], v24 offset:8192
    ds_read_b64_tr_b16 a[74:75], v24 offset:9216
    ds_read_b64_tr_b16 a[76:77], v24 offset:8200
    ds_read_b64_tr_b16 a[78:79], v24 offset:9224
    s_waitcnt lgkmcnt(0)
    s_waitcnt vmcnt(28)
    s_barrier
    s_add_u32 s45, s46, 0x5b0000
    s_add_u32 m0, s47, 65536
    s_nop 0
    buffer_load_dwordx4 v21, s[24:27], s45 offen  lds
    s_add_u32 s45, s46, 0x5cc000
    s_add_u32 m0, s47, 69632
    s_nop 0
    buffer_load_dwordx4 v21, s[24:27], s45 offen  lds
    s_add_u32 s45, s46, 0x5e8000
    s_add_u32 m0, s47, 73728
    s_nop 0
    buffer_load_dwordx4 v21, s[24:27], s45 offen  lds
    s_add_u32 s45, s46, 0x604000
    s_add_u32 m0, s47, 77824
    s_nop 0
    buffer_load_dwordx4 v21, s[24:27], s45 offen  lds
    ds_read_b64_tr_b16 a[80:81], v24 offset:16384
    ds_read_b64_tr_b16 a[82:83], v24 offset:17408
    ds_read_b64_tr_b16 a[84:85], v24 offset:16392
    ds_read_b64_tr_b16 a[86:87], v24 offset:17416
    ds_read_b64_tr_b16 a[88:89], v24 offset:24576
    ds_read_b64_tr_b16 a[90:91], v24 offset:25600
    ds_read_b64_tr_b16 a[92:93], v24 offset:24584
    ds_read_b64_tr_b16 a[94:95], v24 offset:25608
    s_waitcnt lgkmcnt(0)
    s_waitcnt vmcnt(28)
    s_barrier
    s_add_u32 s45, s46, 0x620000
    s_add_u32 m0, s47, 81920
    s_nop 0
    buffer_load_dwordx4 v21, s[24:27], s45 offen  lds
    s_add_u32 s45, s46, 0x63c000
    s_add_u32 m0, s47, 86016
    s_nop 0
    buffer_load_dwordx4 v21, s[24:27], s45 offen  lds
    s_add_u32 s45, s46, 0x658000
    s_add_u32 m0, s47, 90112
    s_nop 0
    buffer_load_dwordx4 v21, s[24:27], s45 offen  lds
    s_add_u32 s45, s46, 0x674000
    s_add_u32 m0, s47, 94208
    s_nop 0
    buffer_load_dwordx4 v21, s[24:27], s45 offen  lds
    ds_read_b64_tr_b16 a[96:97], v24 offset:32768
    ds_read_b64_tr_b16 a[98:99], v24 offset:33792
    ds_read_b64_tr_b16 a[100:101], v24 offset:32776
    ds_read_b64_tr_b16 a[102:103], v24 offset:33800
    ds_read_b64_tr_b16 a[104:105], v24 offset:40960
    ds_read_b64_tr_b16 a[106:107], v24 offset:41984
    ds_read_b64_tr_b16 a[108:109], v24 offset:40968
    ds_read_b64_tr_b16 a[110:111], v24 offset:41992
    s_waitcnt lgkmcnt(0)
    s_waitcnt vmcnt(28)
    s_barrier
    s_add_u32 s45, s46, 0x690000
    s_add_u32 m0, s47, 98304
    s_nop 0
    buffer_load_dwordx4 v21, s[24:27], s45 offen  lds
    s_add_u32 s45, s46, 0x6ac000
    s_add_u32 m0, s47, 102400
    s_nop 0
    buffer_load_dwordx4 v21, s[24:27], s45 offen  lds
    s_add_u32 s45, s46, 0x6c8000
    s_add_u32 m0, s47, 106496
    s_nop 0
    buffer_load_dwordx4 v21, s[24:27], s45 offen  lds
    s_add_u32 s45, s46, 0x6e4000
    s_add_u32 m0, s47, 110592
    s_nop 0
    buffer_load_dwordx4 v21, s[24:27], s45 offen  lds
    ds_read_b64_tr_b16 a[112:113], v24 offset:49152
    ds_read_b64_tr_b16 a[114:115], v24 offset:50176
    ds_read_b64_tr_b16 a[116:117], v24 offset:49160
    ds_read_b64_tr_b16 a[118:119], v24 offset:50184
    ds_read_b64_tr_b16 a[120:121], v24 offset:57344
    ds_read_b64_tr_b16 a[122:123], v24 offset:58368
    ds_read_b64_tr_b16 a[124:125], v24 offset:57352
    ds_read_b64_tr_b16 a[126:127], v24 offset:58376
    s_waitcnt lgkmcnt(0)
    s_waitcnt vmcnt(28)
    s_barrier
    ds_read_b64_tr_b16 a[128:129], v25 offset:0
    ds_read_b64_tr_b16 a[130:131], v25 offset:1024
    ds_read_b64_tr_b16 a[132:133], v25 offset:8
    ds_read_b64_tr_b16 a[134:135], v25 offset:1032
    ds_read_b64_tr_b16 a[136:137], v25 offset:8192
    ds_read_b64_tr_b16 a[138:139], v25 offset:9216
    ds_read_b64_tr_b16 a[140:141], v25 offset:8200
    ds_read_b64_tr_b16 a[142:143], v25 offset:9224
    s_waitcnt lgkmcnt(0)
    s_waitcnt vmcnt(24)
    s_barrier
    ds_read_b64_tr_b16 a[144:145], v23 offset:0
    ds_read_b64_tr_b16 a[146:147], v23 offset:1024
    ds_read_b64_tr_b16 a[148:149], v23 offset:8
    ds_read_b64_tr_b16 a[150:151], v23 offset:1032
    ds_read_b64_tr_b16 a[152:153], v23 offset:8192
    ds_read_b64_tr_b16 a[154:155], v23 offset:9216
    ds_read_b64_tr_b16 a[156:157], v23 offset:8200
    ds_read_b64_tr_b16 a[158:159], v23 offset:9224
    s_waitcnt lgkmcnt(0)
    s_waitcnt vmcnt(20)
    s_barrier
    ds_read_b64_tr_b16 a[160:161], v23 offset:16384
    ds_read_b64_tr_b16 a[162:163], v23 offset:17408
    ds_read_b64_tr_b16 a[164:165], v23 offset:16392
    ds_read_b64_tr_b16 a[166:167], v23 offset:17416
    ds_read_b64_tr_b16 a[168:169], v23 offset:24576
    ds_read_b64_tr_b16 a[170:171], v23 offset:25600
    ds_read_b64_tr_b16 a[172:173], v23 offset:24584
    ds_read_b64_tr_b16 a[174:175], v23 offset:25608
    s_waitcnt lgkmcnt(0)
    s_waitcnt vmcnt(16)
    s_barrier
    ds_read_b64_tr_b16 a[176:177], v23 offset:32768
    ds_read_b64_tr_b16 a[178:179], v23 offset:33792
    ds_read_b64_tr_b16 a[180:181], v23 offset:32776
    ds_read_b64_tr_b16 a[182:183], v23 offset:33800
    ds_read_b64_tr_b16 a[184:185], v23 offset:40960
    ds_read_b64_tr_b16 a[186:187], v23 offset:41984
    ds_read_b64_tr_b16 a[188:189], v23 offset:40968
    ds_read_b64_tr_b16 a[190:191], v23 offset:41992
    s_waitcnt lgkmcnt(0)
    s_waitcnt vmcnt(12)
    s_barrier
    ds_read_b64_tr_b16 a[192:193], v23 offset:49152
    ds_read_b64_tr_b16 a[194:195], v23 offset:50176
    ds_read_b64_tr_b16 a[196:197], v23 offset:49160
    ds_read_b64_tr_b16 a[198:199], v23 offset:50184
    ds_read_b64_tr_b16 a[200:201], v23 offset:57344
    ds_read_b64_tr_b16 a[202:203], v23 offset:58368
    ds_read_b64_tr_b16 a[204:205], v23 offset:57352
    ds_read_b64_tr_b16 a[206:207], v23 offset:58376
    s_waitcnt lgkmcnt(0)
    s_waitcnt vmcnt(8)
    s_barrier
    ds_read_b64_tr_b16 a[208:209], v24 offset:0
    ds_read_b64_tr_b16 a[210:211], v24 offset:1024
    ds_read_b64_tr_b16 a[212:213], v24 offset:8
    ds_read_b64_tr_b16 a[214:215], v24 offset:1032
    ds_read_b64_tr_b16 a[216:217], v24 offset:8192
    ds_read_b64_tr_b16 a[218:219], v24 offset:9216
    ds_read_b64_tr_b16 a[220:221], v24 offset:8200
    ds_read_b64_tr_b16 a[222:223], v24 offset:9224
    s_waitcnt lgkmcnt(0)
    s_waitcnt vmcnt(4)
    s_barrier
    ds_read_b64_tr_b16 a[224:225], v24 offset:16384
    ds_read_b64_tr_b16 a[226:227], v24 offset:17408
    ds_read_b64_tr_b16 a[228:229], v24 offset:16392
    ds_read_b64_tr_b16 a[230:231], v24 offset:17416
    ds_read_b64_tr_b16 a[232:233], v24 offset:24576
    ds_read_b64_tr_b16 a[234:235], v24 offset:25600
    ds_read_b64_tr_b16 a[236:237], v24 offset:24584
    ds_read_b64_tr_b16 a[238:239], v24 offset:25608
    s_waitcnt lgkmcnt(0)
    s_waitcnt vmcnt(0)
    s_barrier
    ds_read_b64_tr_b16 a[240:241], v24 offset:32768
    ds_read_b64_tr_b16 a[242:243], v24 offset:33792
    ds_read_b64_tr_b16 a[244:245], v24 offset:32776
    ds_read_b64_tr_b16 a[246:247], v24 offset:33800
    ds_read_b64_tr_b16 a[248:249], v24 offset:40960
    ds_read_b64_tr_b16 a[250:251], v24 offset:41984
    ds_read_b64_tr_b16 a[252:253], v24 offset:40968
    ds_read_b64_tr_b16 a[254:255], v24 offset:41992
    s_waitcnt lgkmcnt(0)
    s_barrier
    s_min_u32 s45, s41, 27
    s_lshl_b32 s45, s45, 8
    s_lshl_b32 s46, s44, 6
    s_add_u32 s45, s45, s46
    v_lshrrev_b32 v29, 4, v1
    v_lshlrev_b32 v29, 4, v29
    buffer_load_dwordx4 v[80:83], v29, s[32:35], s45 offen
    s_waitcnt vmcnt(0)
    v_lshlrev_b32 v96, 16, v80
    v_and_b32 v97, 0xffff0000, v80
    v_lshlrev_b32 v98, 16, v81
    v_and_b32 v99, 0xffff0000, v81
    v_lshlrev_b32 v100, 16, v82
    v_and_b32 v101, 0xffff0000, v82
    v_lshlrev_b32 v102, 16, v83
    v_and_b32 v103, 0xffff0000, v83
    v_mov_b32 v104, 0xbdd2d3e8
    v_mov_b32 v105, v104
    v_mov_b32 v106, 0xc0135761
    v_mov_b32 v107, v106
    s_cmp_lg_u32 s44, 0
    s_cbranch_scc1 L_pd_149
    v_mov_b32 v29, 127232
    s_mov_b32 s46, 96
    s_mov_b64 exec, 1
    s_mov_b32 s70, 0
L_wp_150:
    buffer_load_dword v31, v29, s[12:15], 0 offen sc1
    s_add_u32 s70, s70, 1
    s_cmp_ge_u32 s70, 0x200000
    s_cbranch_scc1 L_w_done_98
L_wp_150_c:
    s_waitcnt vmcnt(0)
    v_cmp_gt_u32 vcc, s46, v31
    s_nop 1
    s_cbranch_vccz L_wp_150_ok
    s_sleep 3
    s_branch L_wp_150
L_wp_150_ok:
    s_mov_b64 exec, -1
L_pd_149:
    s_barrier
    v_lshlrev_b32 v29, 5, v1
    s_mov_b32 s45, 8192
    buffer_load_dwordx4 v[112:115], v29, s[12:15], s45 offen offset:0 sc1
    buffer_load_dwordx4 v[116:119], v29, s[12:15], s45 offen offset:16 sc1
    buffer_load_dwordx4 v[120:123], v29, s[12:15], s45 offen offset:2048 sc1
    buffer_load_dwordx4 v[124:127], v29, s[12:15], s45 offen offset:2064 sc1
    s_mov_b32 s45, 32768
    buffer_load_dwordx4 v[32:35], v29, s[12:15], s45 offen offset:0 sc1
    buffer_load_dwordx4 v[36:39], v29, s[12:15], s45 offen offset:16 sc1
    buffer_load_dwordx4 v[40:43], v29, s[12:15], s45 offen offset:2048 sc1
    buffer_load_dwordx4 v[44:47], v29, s[12:15], s45 offen offset:2064 sc1
    s_mov_b32 s45, 12288
    buffer_load_dwordx4 v[128:131], v29, s[12:15], s45 offen offset:0 sc1
    buffer_load_dwordx4 v[132:135], v29, s[12:15], s45 offen offset:16 sc1
    buffer_load_dwordx4 v[136:139], v29, s[12:15], s45 offen offset:2048 sc1
    buffer_load_dwordx4 v[140:143], v29, s[12:15], s45 offen offset:2064 sc1
    s_mov_b32 s45, 36864
    buffer_load_dwordx4 v[48:51], v29, s[12:15], s45 offen offset:0 sc1
    buffer_load_dwordx4 v[52:55], v29, s[12:15], s45 offen offset:16 sc1
    buffer_load_dwordx4 v[56:59], v29, s[12:15], s45 offen offset:2048 sc1
    buffer_load_dwordx4 v[60:63], v29, s[12:15], s45 offen offset:2064 sc1
    s_mov_b32 s45, 16384
    buffer_load_dwordx4 v[144:147], v29, s[12:15], s45 offen offset:0 sc1
    buffer_load_dwordx4 v[148:151], v29, s[12:15], s45 offen offset:16 sc1
    buffer_load_dwordx4 v[152:155], v29, s[12:15], s45 offen offset:2048 sc1
    buffer_load_dwordx4 v[156:159], v29, s[12:15], s45 offen offset:2064 sc1
    s_mov_b32 s45, 40960
    buffer_load_dwordx4 v[64:67], v29, s[12:15], s45 offen offset:0 sc1
    buffer_load_dwordx4 v[68:71], v29, s[12:15], s45 offen offset:16 sc1
    buffer_load_dwordx4 v[72:75], v29, s[12:15], s45 offen offset:2048 sc1
    buffer_load_dwordx4 v[76:79], v29, s[12:15], s45 offen offset:2064 sc1
    s_waitcnt vmcnt(0)
    v_add_f32 v112, v112, v32
    v_cvt_pk_bf16_f32 v112, v112, v112
    v_lshlrev_b32 v112, 16, v112
    v_add_f32 v113, v113, v33
    v_cvt_pk_bf16_f32 v113, v113, v113
    v_lshlrev_b32 v113, 16, v113
    v_add_f32 v114, v114, v34
    v_cvt_pk_bf16_f32 v114, v114, v114
    v_lshlrev_b32 v114, 16, v114
    v_add_f32 v115, v115, v35
    v_cvt_pk_bf16_f32 v115, v115, v115
    v_lshlrev_b32 v115, 16, v115
    v_add_f32 v116, v116, v36
    v_cvt_pk_bf16_f32 v116, v116, v116
    v_lshlrev_b32 v116, 16, v116
    v_add_f32 v117, v117, v37
    v_cvt_pk_bf16_f32 v117, v117, v117
    v_lshlrev_b32 v117, 16, v117
    v_add_f32 v118, v118, v38
    v_cvt_pk_bf16_f32 v118, v118, v118
    v_lshlrev_b32 v118, 16, v118
    v_add_f32 v119, v119, v39
    v_cvt_pk_bf16_f32 v119, v119, v119
    v_lshlrev_b32 v119, 16, v119
    v_add_f32 v120, v120, v40
    v_cvt_pk_bf16_f32 v120, v120, v120
    v_lshlrev_b32 v120, 16, v120
    v_add_f32 v121, v121, v41
    v_cvt_pk_bf16_f32 v121, v121, v121
    v_lshlrev_b32 v121, 16, v121
    v_add_f32 v122, v122, v42
    v_cvt_pk_bf16_f32 v122, v122, v122
    v_lshlrev_b32 v122, 16, v122
    v_add_f32 v123, v123, v43
    v_cvt_pk_bf16_f32 v123, v123, v123
    v_lshlrev_b32 v123, 16, v123
    v_add_f32 v124, v124, v44
    v_cvt_pk_bf16_f32 v124, v124, v124
    v_lshlrev_b32 v124, 16, v124
    v_add_f32 v125, v125, v45
    v_cvt_pk_bf16_f32 v125, v125, v125
    v_lshlrev_b32 v125, 16, v125
    v_add_f32 v126, v126, v46
    v_cvt_pk_bf16_f32 v126, v126, v126
    v_lshlrev_b32 v126, 16, v126
    v_add_f32 v127, v127, v47
    v_cvt_pk_bf16_f32 v127, v127, v127
    v_lshlrev_b32 v127, 16, v127
    v_add_f32 v128, v128, v48
    v_cvt_pk_bf16_f32 v128, v128, v128
    v_lshlrev_b32 v128, 16, v128
    v_add_f32 v129, v129, v49
    v_cvt_pk_bf16_f32 v129, v129, v129
    v_lshlrev_b32 v129, 16, v129
    v_add_f32 v130, v130, v50
    v_cvt_pk_bf16_f32 v130, v130, v130
    v_lshlrev_b32 v130, 16, v130
    v_add_f32 v131, v131, v51
    v_cvt_pk_bf16_f32 v131, v131, v131
    v_lshlrev_b32 v131, 16, v131
    v_add_f32 v132, v132, v52
    v_cvt_pk_bf16_f32 v132, v132, v132
    v_lshlrev_b32 v132, 16, v132
    v_add_f32 v133, v133, v53
    v_cvt_pk_bf16_f32 v133, v133, v133
    v_lshlrev_b32 v133, 16, v133
    v_add_f32 v134, v134, v54
    v_cvt_pk_bf16_f32 v134, v134, v134
    v_lshlrev_b32 v134, 16, v134
    v_add_f32 v135, v135, v55
    v_cvt_pk_bf16_f32 v135, v135, v135
    v_lshlrev_b32 v135, 16, v135
    v_add_f32 v136, v136, v56
    v_cvt_pk_bf16_f32 v136, v136, v136
    v_lshlrev_b32 v136, 16, v136
    v_add_f32 v137, v137, v57
    v_cvt_pk_bf16_f32 v137, v137, v137
    v_lshlrev_b32 v137, 16, v137
    v_add_f32 v138, v138, v58
    v_cvt_pk_bf16_f32 v138, v138, v138
    v_lshlrev_b32 v138, 16, v138
    v_add_f32 v139, v139, v59
    v_cvt_pk_bf16_f32 v139, v139, v139
    v_lshlrev_b32 v139, 16, v139
    v_add_f32 v140, v140, v60
    v_cvt_pk_bf16_f32 v140, v140, v140
    v_lshlrev_b32 v140, 16, v140
    v_add_f32 v141, v141, v61
    v_cvt_pk_bf16_f32 v141, v141, v141
    v_lshlrev_b32 v141, 16, v141
    v_add_f32 v142, v142, v62
    v_cvt_pk_bf16_f32 v142, v142, v142
    v_lshlrev_b32 v142, 16, v142
    v_add_f32 v143, v143, v63
    v_cvt_pk_bf16_f32 v143, v143, v143
    v_lshlrev_b32 v143, 16, v143
    v_add_f32 v144, v144, v64
    v_cvt_pk_bf16_f32 v144, v144, v144
    v_lshlrev_b32 v144, 16, v144
    v_add_f32 v144, 1.0, v144
    v_cvt_pk_bf16_f32 v144, v144, v144
    v_lshlrev_b32 v144, 16, v144
    v_add_f32 v145, v145, v65
    v_cvt_pk_bf16_f32 v145, v145, v145
    v_lshlrev_b32 v145, 16, v145
    v_add_f32 v145, 1.0, v145
    v_cvt_pk_bf16_f32 v145, v145, v145
    v_lshlrev_b32 v145, 16, v145
    v_add_f32 v146, v146, v66
    v_cvt_pk_bf16_f32 v146, v146, v146
    v_lshlrev_b32 v146, 16, v146
    v_add_f32 v146, 1.0, v146
    v_cvt_pk_bf16_f32 v146, v146, v146
    v_lshlrev_b32 v146, 16, v146
    v_add_f32 v147, v147, v67
    v_cvt_pk_bf16_f32 v147, v147, v147
    v_lshlrev_b32 v147, 16, v147
    v_add_f32 v147, 1.0, v147
    v_cvt_pk_bf16_f32 v147, v147, v147
    v_lshlrev_b32 v147, 16, v147
    v_add_f32 v148, v148, v68
    v_cvt_pk_bf16_f32 v148, v148, v148
    v_lshlrev_b32 v148, 16, v148
    v_add_f32 v148, 1.0, v148
    v_cvt_pk_bf16_f32 v148, v148, v148
    v_lshlrev_b32 v148, 16, v148
    v_add_f32 v149, v149, v69
    v_cvt_pk_bf16_f32 v149, v149, v149
    v_lshlrev_b32 v149, 16, v149
    v_add_f32 v149, 1.0, v149
    v_cvt_pk_bf16_f32 v149, v149, v149
    v_lshlrev_b32 v149, 16, v149
    v_add_f32 v150, v150, v70
    v_cvt_pk_bf16_f32 v150, v150, v150
    v_lshlrev_b32 v150, 16, v150
    v_add_f32 v150, 1.0, v150
    v_cvt_pk_bf16_f32 v150, v150, v150
    v_lshlrev_b32 v150, 16, v150
    v_add_f32 v151, v151, v71
    v_cvt_pk_bf16_f32 v151, v151, v151
    v_lshlrev_b32 v151, 16, v151
    v_add_f32 v151, 1.0, v151
    v_cvt_pk_bf16_f32 v151, v151, v151
    v_lshlrev_b32 v151, 16, v151
    v_add_f32 v152, v152, v72
    v_cvt_pk_bf16_f32 v152, v152, v152
    v_lshlrev_b32 v152, 16, v152
    v_add_f32 v152, 1.0, v152
    v_cvt_pk_bf16_f32 v152, v152, v152
    v_lshlrev_b32 v152, 16, v152
    v_add_f32 v153, v153, v73
    v_cvt_pk_bf16_f32 v153, v153, v153
    v_lshlrev_b32 v153, 16, v153
    v_add_f32 v153, 1.0, v153
    v_cvt_pk_bf16_f32 v153, v153, v153
    v_lshlrev_b32 v153, 16, v153
    v_add_f32 v154, v154, v74
    v_cvt_pk_bf16_f32 v154, v154, v154
    v_lshlrev_b32 v154, 16, v154
    v_add_f32 v154, 1.0, v154
    v_cvt_pk_bf16_f32 v154, v154, v154
    v_lshlrev_b32 v154, 16, v154
    v_add_f32 v155, v155, v75
    v_cvt_pk_bf16_f32 v155, v155, v155
    v_lshlrev_b32 v155, 16, v155
    v_add_f32 v155, 1.0, v155
    v_cvt_pk_bf16_f32 v155, v155, v155
    v_lshlrev_b32 v155, 16, v155
    v_add_f32 v156, v156, v76
    v_cvt_pk_bf16_f32 v156, v156, v156
    v_lshlrev_b32 v156, 16, v156
    v_add_f32 v156, 1.0, v156
    v_cvt_pk_bf16_f32 v156, v156, v156
    v_lshlrev_b32 v156, 16, v156
    v_add_f32 v157, v157, v77
    v_cvt_pk_bf16_f32 v157, v157, v157
    v_lshlrev_b32 v157, 16, v157
    v_add_f32 v157, 1.0, v157
    v_cvt_pk_bf16_f32 v157, v157, v157
    v_lshlrev_b32 v157, 16, v157
    v_add_f32 v158, v158, v78
    v_cvt_pk_bf16_f32 v158, v158, v158
    v_lshlrev_b32 v158, 16, v158
    v_add_f32 v158, 1.0, v158
    v_cvt_pk_bf16_f32 v158, v158, v158
    v_lshlrev_b32 v158, 16, v158
    v_add_f32 v159, v159, v79
    v_cvt_pk_bf16_f32 v159, v159, v159
    v_lshlrev_b32 v159, 16, v159
    v_add_f32 v159, 1.0, v159
    v_cvt_pk_bf16_f32 v159, v159, v159
    v_lshlrev_b32 v159, 16, v159
    s_lshl_b32 s46, s44, 10
    s_add_u32 s45, s46, 8192
    buffer_load_dwordx4 v[18:21], v10, s[12:15], s45 offen sc1
    s_add_u32 s45, s46, 32768
    buffer_load_dwordx4 v[32:35], v10, s[12:15], s45 offen sc1
    s_add_u32 s45, s46, 12288
    buffer_load_dwordx4 v[22:25], v10, s[12:15], s45 offen sc1
    s_add_u32 s45, s46, 36864
    buffer_load_dwordx4 v[36:39], v10, s[12:15], s45 offen sc1
    s_add_u32 s45, s46, 16384
    buffer_load_dwordx4 v[108:111], v10, s[12:15], s45 offen sc1
    s_add_u32 s45, s46, 40960
    buffer_load_dwordx4 v[40:43], v10, s[12:15], s45 offen sc1
    s_waitcnt vmcnt(0)
    v_add_f32 v18, v18, v32
    v_cvt_pk_bf16_f32 v18, v18, v18
    v_lshlrev_b32 v18, 16, v18
    v_add_f32 v19, v19, v33
    v_cvt_pk_bf16_f32 v19, v19, v19
    v_lshlrev_b32 v19, 16, v19
    v_add_f32 v20, v20, v34
    v_cvt_pk_bf16_f32 v20, v20, v20
    v_lshlrev_b32 v20, 16, v20
    v_add_f32 v21, v21, v35
    v_cvt_pk_bf16_f32 v21, v21, v21
    v_lshlrev_b32 v21, 16, v21
    v_add_f32 v22, v22, v36
    v_cvt_pk_bf16_f32 v22, v22, v22
    v_lshlrev_b32 v22, 16, v22
    v_add_f32 v23, v23, v37
    v_cvt_pk_bf16_f32 v23, v23, v23
    v_lshlrev_b32 v23, 16, v23
    v_add_f32 v24, v24, v38
    v_cvt_pk_bf16_f32 v24, v24, v24
    v_lshlrev_b32 v24, 16, v24
    v_add_f32 v25, v25, v39
    v_cvt_pk_bf16_f32 v25, v25, v25
    v_lshlrev_b32 v25, 16, v25
    v_add_f32 v108, v108, v40
    v_cvt_pk_bf16_f32 v108, v108, v108
    v_lshlrev_b32 v108, 16, v108
    v_add_f32 v108, 1.0, v108
    v_cvt_pk_bf16_f32 v108, v108, v108
    v_lshlrev_b32 v108, 16, v108
    v_add_f32 v109, v109, v41
    v_cvt_pk_bf16_f32 v109, v109, v109
    v_lshlrev_b32 v109, 16, v109
    v_add_f32 v109, 1.0, v109
    v_cvt_pk_bf16_f32 v109, v109, v109
    v_lshlrev_b32 v109, 16, v109
    v_add_f32 v110, v110, v42
    v_cvt_pk_bf16_f32 v110, v110, v110
    v_lshlrev_b32 v110, 16, v110
    v_add_f32 v110, 1.0, v110
    v_cvt_pk_bf16_f32 v110, v110, v110
    v_lshlrev_b32 v110, 16, v110
    v_add_f32 v111, v111, v43
    v_cvt_pk_bf16_f32 v111, v111, v111
    v_lshlrev_b32 v111, 16, v111
    v_add_f32 v111, 1.0, v111
    v_cvt_pk_bf16_f32 v111, v111, v111
    v_lshlrev_b32 v111, 16, v111
    s_mov_b32 s52, 0xc00000
    s_lshl_b32 s56, s41, 13
    s_add_u32 s56, s56, 0x6000000
    s_lshl_b32 s45, s40, 7
    s_add_u32 s45, s45, 127488
    v_mov_b32 v29, s45
    s_mov_b32 s46, 536870912
    s_mov_b64 exec, 1
    s_mov_b32 s70, 0
L_wp_154:
    buffer_load_dword v31, v29, s[12:15], 0 offen sc1
    s_add_u32 s70, s70, 1
    s_cmp_ge_u32 s70, 0x200000
    s_cbranch_scc1 L_w_done_98
L_wp_154_c:
    s_waitcnt vmcnt(0)
    v_cmp_gt_u32 vcc, s46, v31
    s_nop 1
    s_cbranch_vccz L_wp_154_ok
    s_sleep 2
    s_branch L_wp_154
L_wp_154_ok:
    s_mov_b64 exec, -1
    v_readfirstlane_b32 s45, v31
    s_nop 3
    s_and_b32 s46, s45, 511
    s_mul_i32 s46, s46, s46
    s_bfe_u32 s45, s45, 0xf0009
    s_lshl_b32 s45, s45, 5
    s_mov_b32 s80, s12
    s_mov_b32 s81, s13
    s_mov_b32 s83, 0x00020000
    s_mov_b32 s84, s12
    s_mov_b32 s85, s13
    s_mov_b32 s87, 0x00020000
    s_cmp_eq_u32 s45, s46
    s_cselect_b32 s82, s14, 0
    s_cselect_b32 s86, 0, s14
    s_mov_b32 s92, 0
L_b_loop_151:
    s_cmp_eq_u64 s[36:37], 0
    s_cbranch_scc1 L_a_fin_133
    s_ff1_i32_b64 s50, s[36:37]
    s_bitset0_b64 s[36:37], s50
    s_lshr_b64 s[74:75], s[72:73], s50
    s_ff1_i32_b64 s51, s[74:75]
    s_add_u32 s51, s51, 1
    s_add_u32 s62, s50, s51
    s_cmp_lg_u32 s51, 1
    s_cbranch_scc1 L_b_skip2_153
    s_lshl_b32 s63, s50, 5
    s_add_u32 s63, s63, s41
    s_lshl_b32 s47, s63, 11
    s_lshl_b32 s45, s44, 9
    s_add_u32 s47, s47, s45
    v_lshlrev_b32 v17, 3, v1
    buffer_load_dwordx2 v[208:209], v17, s[28:31], s47 offen
    s_add_u32 s45, s64, 4096
    s_cmp_lg_u32 s44, 1
    s_cbranch_scc1 L_pi_155
    s_mov_b32 exec_hi, 0
    buffer_load_dword v31, v5, s[12:15], s45 offen sc1
    s_mov_b64 exec, -1
L_pi_155:
    s_waitcnt vmcnt(0)
    s_barrier
    s_cmp_lg_u32 s44, 0
    s_cbranch_scc1 L_pub_156
    v_mov_b32 v30, s92
    v_mov_b32 v31, 0
    s_mov_b64 exec, 1
    buffer_store_dword v30, v31, s[12:15], s67 offen sc1
    s_mov_b64 exec, -1
L_pub_156:
    s_cmp_lg_u32 s44, 1
    s_cbranch_scc1 L_pw_157
    s_mov_b32 exec_hi, 0
    s_mov_b32 s70, 0
    s_branch L_wp_158_c
L_wp_158:
    buffer_load_dword v31, v5, s[12:15], s45 offen sc1
    s_add_u32 s70, s70, 1
    s_cmp_ge_u32 s70, 0x200000
    s_cbranch_scc1 L_w_done_98
L_wp_158_c:
    s_waitcnt vmcnt(0)
    v_cmp_gt_u32 vcc, s62, v31
    s_nop 1
    s_cbranch_vccz L_wp_158_ok
    s_sleep 1
    s_branch L_wp_158
L_wp_158_ok:
    s_mov_b64 exec, -1
L_pw_157:
    s_barrier
    s_lshl_b32 s45, s63, 12
    s_lshl_b32 s46, s44, 10
    s_add_u32 s45, s45, s46
    s_add_u32 s45, s45, 0x8000000
    buffer_load_dwordx4 v[64:67], v10, s[12:15], s45 offen sc1
    s_add_u32 s45, s45, 0x800000
    buffer_load_dwordx4 v[68:71], v10, s[12:15], s45 offen sc1
    s_add_u32 s45, s45, 0x800000
    buffer_load_dwordx4 v[72:75], v10, s[12:15], s45 offen sc1
    s_add_u32 s45, s45, 0x800000
    buffer_load_dwordx4 v[76:79], v10, s[12:15], s45 offen sc1
    s_waitcnt vmcnt(4)
    v_lshlrev_b32 v160, 16, v208
    v_and_b32 v161, 0xffff0000, v208
    v_lshlrev_b32 v162, 16, v209
    v_and_b32 v163, 0xffff0000, v209
    s_waitcnt vmcnt(0)
    v_pk_add_f32 v[64:65], v[64:65], v[68:69]
    v_pk_add_f32 v[72:73], v[72:73], v[76:77]
    v_pk_add_f32 v[66:67], v[66:67], v[70:71]
    v_pk_add_f32 v[74:75], v[74:75], v[78:79]
    v_pk_add_f32 v[64:65], v[64:65], v[72:73]
    v_pk_add_f32 v[66:67], v[66:67], v[74:75]
    v_cvt_pk_bf16_f32 v64, v64, v64
    v_lshlrev_b32 v64, 16, v64
    v_cvt_pk_bf16_f32 v65, v65, v65
    v_lshlrev_b32 v65, 16, v65
    v_cvt_pk_bf16_f32 v66, v66, v66
    v_lshlrev_b32 v66, 16, v66
    v_cvt_pk_bf16_f32 v67, v67, v67
    v_lshlrev_b32 v67, 16, v67
    v_mul_f32 v64, v64, v18
    v_cvt_pk_bf16_f32 v64, v64, v64
    v_lshlrev_b32 v64, 16, v64
    v_add_f32 v64, v64, v160
    v_mul_f32 v65, v65, v19
    v_cvt_pk_bf16_f32 v65, v65, v65
    v_lshlrev_b32 v65, 16, v65
    v_add_f32 v65, v65, v161
    v_mul_f32 v66, v66, v20
    v_cvt_pk_bf16_f32 v66, v66, v66
    v_lshlrev_b32 v66, 16, v66
    v_add_f32 v66, v66, v162
    v_mul_f32 v67, v67, v21
    v_cvt_pk_bf16_f32 v67, v67, v67
    v_lshlrev_b32 v67, 16, v67
    v_add_f32 v67, v67, v163
    v_cvt_pk_bf16_f32 v208, v64, v65
    v_cvt_pk_bf16_f32 v209, v66, v67
    s_add_u32 s47, s47, 0x800000
    buffer_store_dwordx2 v[208:209], v17, s[12:15], s47 offen sc1
    v_lshlrev_b32 v64, 16, v208
    v_and_b32 v65, 0xffff0000, v208
    v_lshlrev_b32 v66, 16, v209
    v_and_b32 v67, 0xffff0000, v209
    v_add_f32 v26, v64, v65
    v_add_f32 v27, v66, v67
    v_add_f32 v26, v26, v27
    s_nop 1
    v_add_f32_dpp v26, v26, v26 row_shr:1 row_mask:0xf bank_mask:0xf bound_ctrl:0
    s_nop 1
    v_add_f32_dpp v26, v26, v26 row_shr:2 row_mask:0xf bank_mask:0xf bound_ctrl:0
    s_nop 1
    v_add_f32_dpp v26, v26, v26 row_shr:4 row_mask:0xf bank_mask:0xf bound_ctrl:0
    s_nop 1
    v_add_f32_dpp v26, v26, v26 row_shr:8 row_mask:0xf bank_mask:0xf bound_ctrl:0
    s_nop 1
    v_add_f32_dpp v26, v26, v26 row_bcast:15 row_mask:0xa bank_mask:0xf
    s_nop 1
    v_add_f32_dpp v26, v26, v26 row_bcast:31 row_mask:0xc bank_mask:0xf
    s_nop 1
    v_readlane_b32 s66, v26, 63
    s_nop 1
    v_mov_b32 v28, s66
    v_mul_f32 v28, 0x3b800000, v28
    v_mov_b32 v26, 0
    v_sub_f32 v27, v64, v28
    v_fmac_f32 v26, v27, v27
    v_sub_f32 v27, v65, v28
    v_fmac_f32 v26, v27, v27
    v_sub_f32 v27, v66, v28
    v_fmac_f32 v26, v27, v27
    v_sub_f32 v27, v67, v28
    v_fmac_f32 v26, v27, v27
    s_nop 1
    v_add_f32_dpp v26, v26, v26 row_shr:1 row_mask:0xf bank_mask:0xf bound_ctrl:0
    s_nop 1
    v_add_f32_dpp v26, v26, v26 row_shr:2 row_mask:0xf bank_mask:0xf bound_ctrl:0
    s_nop 1
    v_add_f32_dpp v26, v26, v26 row_shr:4 row_mask:0xf bank_mask:0xf bound_ctrl:0
    s_nop 1
    v_add_f32_dpp v26, v26, v26 row_shr:8 row_mask:0xf bank_mask:0xf bound_ctrl:0
    s_nop 1
    v_add_f32_dpp v26, v26, v26 row_bcast:15 row_mask:0xa bank_mask:0xf
    s_nop 1
    v_add_f32_dpp v26, v26, v26 row_bcast:31 row_mask:0xc bank_mask:0xf
    s_nop 1
    v_readlane_b32 s66, v26, 63
    s_lshl_b32 s45, s44, 3
    s_add_u32 s45, s45, 131072
    v_mov_b32 v29, s66
    v_mov_b32 v27, s45
    ds_write_b64 v27, v[28:29]
    v_mov_b32 v27, 131072
    s_waitcnt lgkmcnt(0)
    s_barrier
    ds_read_b128 v[68:71], v27
    ds_read_b128 v[72:75], v27 offset:16
    s_waitcnt lgkmcnt(0)
    v_add_f32 v27, v68, v70
    v_add_f32 v26, v72, v74
    v_add_f32 v27, v27, v26
    v_mul_f32 v27, 0x3e800000, v27
    v_add_f32 v26, v69, v71
    v_add_f32 v28, v73, v75
    v_add_f32 v26, v26, v28
    v_mov_b32 v28, 0
    v_sub_f32 v68, v68, v27
    v_fmac_f32 v28, v68, v68
    v_sub_f32 v70, v70, v27
    v_fmac_f32 v28, v70, v70
    v_sub_f32 v72, v72, v27
    v_fmac_f32 v28, v72, v72
    v_sub_f32 v74, v74, v27
    v_fmac_f32 v28, v74, v74
    v_mul_f32 v28, 0x43800000, v28
    v_add_f32 v26, v26, v28
    v_mul_f32 v26, 0x3a800000, v26
    v_cvt_pk_bf16_f32 v26, v26, v26
    v_lshlrev_b32 v26, 16, v26
    v_cvt_pk_bf16_f32 v27, v27, v27
    v_lshlrev_b32 v27, 16, v27
    v_add_f32 v26, 0x3727c5ac, v26
    v_cvt_pk_bf16_f32 v26, v26, v26
    v_lshlrev_b32 v26, 16, v26
    v_sqrt_f32 v26, v26
    s_nop 0
    v_cvt_pk_bf16_f32 v26, v26, v26
    v_lshlrev_b32 v26, 16, v26
    v_rcp_f32 v26, v26
    s_nop 0
    v_sub_f32 v64, v64, v27
    v_cvt_pk_bf16_f32 v64, v64, v64
    v_lshlrev_b32 v64, 16, v64
    v_mul_f32 v64, v64, v26
    v_cvt_pk_bf16_f32 v64, v64, v64
    v_lshlrev_b32 v64, 16, v64
    v_mul_f32 v64, v64, v108
    v_cvt_pk_bf16_f32 v64, v64, v64
    v_lshlrev_b32 v64, 16, v64
    v_add_f32 v64, v64, v22
    v_sub_f32 v65, v65, v27
    v_cvt_pk_bf16_f32 v65, v65, v65
    v_lshlrev_b32 v65, 16, v65
    v_mul_f32 v65, v65, v26
    v_cvt_pk_bf16_f32 v65, v65, v65
    v_lshlrev_b32 v65, 16, v65
    v_mul_f32 v65, v65, v109
    v_cvt_pk_bf16_f32 v65, v65, v65
    v_lshlrev_b32 v65, 16, v65
    v_add_f32 v65, v65, v23
    v_sub_f32 v66, v66, v27
    v_cvt_pk_bf16_f32 v66, v66, v66
    v_lshlrev_b32 v66, 16, v66
    v_mul_f32 v66, v66, v26
    v_cvt_pk_bf16_f32 v66, v66, v66
    v_lshlrev_b32 v66, 16, v66
    v_mul_f32 v66, v66, v110
    v_cvt_pk_bf16_f32 v66, v66, v66
    v_lshlrev_b32 v66, 16, v66
    v_add_f32 v66, v66, v24
    v_sub_f32 v67, v67, v27
    v_cvt_pk_bf16_f32 v67, v67, v67
    v_lshlrev_b32 v67, 16, v67
    v_mul_f32 v67, v67, v26
    v_cvt_pk_bf16_f32 v67, v67, v67
    v_lshlrev_b32 v67, 16, v67
    v_mul_f32 v67, v67, v111
    v_cvt_pk_bf16_f32 v67, v67, v67
    v_lshlrev_b32 v67, 16, v67
    v_add_f32 v67, v67, v25
    v_cvt_pk_bf16_f32 v64, v64, v65
    v_cvt_pk_bf16_f32 v65, v66, v67
    v_lshrrev_b32 v26, 5, v1
    v_lshlrev_b32 v26, 13, v26
    v_and_b32 v27, 255, v17
    v_add_u32 v26, v26, v27
    s_lshl_b32 s45, s50, 16
    s_lshl_b32 s46, s41, 8
    s_add_u32 s45, s45, s46
    s_lshl_b32 s46, s44, 14
    s_add_u32 s45, s45, s46
    s_add_u32 s45, s45, 0xc00000
    buffer_store_dwordx2 v[64:65], v26, s[12:15], s45 offen sc1
    s_branch L_b_skip_152
L_b_skip2_153:
    s_add_u32 s63, s50, s44
    s_lshl_b32 s63, s63, 5
    s_add_u32 s63, s63, s41
    s_lshl_b32 s47, s63, 11
    buffer_load_dwordx4 v[208:211], v10, s[28:31], s47 offen
    buffer_load_dwordx4 v[212:215], v10, s[28:31], s47 offen offset:1024
    s_add_u32 s45, s64, 4096
    s_cmp_lg_u32 s44, 1
    s_cbranch_scc1 L_pi_159
    s_mov_b32 exec_hi, 0
    buffer_load_dword v31, v5, s[12:15], s45 offen sc1
    s_mov_b64 exec, -1
L_pi_159:
    s_waitcnt vmcnt(0)
    s_barrier
    s_cmp_lg_u32 s44, 0
    s_cbranch_scc1 L_pub_160
    v_mov_b32 v30, s92
    v_mov_b32 v31, 0
    s_mov_b64 exec, 1
    buffer_store_dword v30, v31, s[12:15], s67 offen sc1
    s_mov_b64 exec, -1
L_pub_160:
    s_cmp_lg_u32 s44, 1
    s_cbranch_scc1 L_pw_161
    s_mov_b32 exec_hi, 0
    s_mov_b32 s70, 0
    s_branch L_wp_162_c
L_wp_162:
    buffer_load_dword v31, v5, s[12:15], s45 offen sc1
    s_add_u32 s70, s70, 1
    s_cmp_ge_u32 s70, 0x200000
    s_cbranch_scc1 L_w_done_98
L_wp_162_c:
    s_waitcnt vmcnt(0)
    v_cmp_gt_u32 vcc, s62, v31
    s_nop 1
    s_cbranch_vccz L_wp_162_ok
    s_sleep 2
    s_branch L_wp_162
L_wp_162_ok:
    s_mov_b64 exec, -1
L_pw_161:
    s_barrier
    s_cmp_ge_u32 s44, s51
    s_cbranch_scc1 L_b_skip_152
    s_lshl_b32 s45, s63, 12
    s_add_u32 s45, s45, 0x8000000
    v_lshlrev_b32 v29, 5, v1
    buffer_load_dwordx4 v[64:67], v29, s[12:15], s45 offen offset:0 sc1
    buffer_load_dwordx4 v[68:71], v29, s[12:15], s45 offen offset:16 sc1
    buffer_load_dwordx4 v[72:75], v29, s[12:15], s45 offen offset:2048 sc1
    buffer_load_dwordx4 v[76:79], v29, s[12:15], s45 offen offset:2064 sc1
    s_add_u32 s45, s45, 0x800000
    buffer_load_dwordx4 v[160:163], v29, s[12:15], s45 offen offset:0 sc1
    buffer_load_dwordx4 v[164:167], v29, s[12:15], s45 offen offset:16 sc1
    buffer_load_dwordx4 v[168:171], v29, s[12:15], s45 offen offset:2048 sc1
    buffer_load_dwordx4 v[172:175], v29, s[12:15], s45 offen offset:2064 sc1
    s_add_u32 s45, s45, 0x800000
    buffer_load_dwordx4 v[176:179], v29, s[12:15], s45 offen offset:0 sc1
    buffer_load_dwordx4 v[180:183], v29, s[12:15], s45 offen offset:16 sc1
    buffer_load_dwordx4 v[184:187], v29, s[12:15], s45 offen offset:2048 sc1
    buffer_load_dwordx4 v[188:191], v29, s[12:15], s45 offen offset:2064 sc1
    s_add_u32 s45, s45, 0x800000
    buffer_load_dwordx4 v[192:195], v29, s[12:15], s45 offen offset:0 sc1
    buffer_load_dwordx4 v[196:199], v29, s[12:15], s45 offen offset:16 sc1
    buffer_load_dwordx4 v[200:203], v29, s[12:15], s45 offen offset:2048 sc1
    buffer_load_dwordx4 v[204:207], v29, s[12:15], s45 offen offset:2064 sc1
    s_waitcnt vmcnt(0)
    v_pk_add_f32 v[64:65], v[64:65], v[160:161]
    v_pk_add_f32 v[176:177], v[176:177], v[192:193]
    v_pk_add_f32 v[66:67], v[66:67], v[162:163]
    v_pk_add_f32 v[178:179], v[178:179], v[194:195]
    v_pk_add_f32 v[68:69], v[68:69], v[164:165]
    v_pk_add_f32 v[180:181], v[180:181], v[196:197]
    v_pk_add_f32 v[70:71], v[70:71], v[166:167]
    v_pk_add_f32 v[182:183], v[182:183], v[198:199]
    v_pk_add_f32 v[72:73], v[72:73], v[168:169]
    v_pk_add_f32 v[184:185], v[184:185], v[200:201]
    v_pk_add_f32 v[74:75], v[74:75], v[170:171]
    v_pk_add_f32 v[186:187], v[186:187], v[202:203]
    v_pk_add_f32 v[76:77], v[76:77], v[172:173]
    v_pk_add_f32 v[188:189], v[188:189], v[204:205]
    v_pk_add_f32 v[78:79], v[78:79], v[174:175]
    v_pk_add_f32 v[190:191], v[190:191], v[206:207]
    v_pk_add_f32 v[64:65], v[64:65], v[176:177]
    v_pk_add_f32 v[66:67], v[66:67], v[178:179]
    v_pk_add_f32 v[68:69], v[68:69], v[180:181]
    v_pk_add_f32 v[70:71], v[70:71], v[182:183]
    v_pk_add_f32 v[72:73], v[72:73], v[184:185]
    v_pk_add_f32 v[74:75], v[74:75], v[186:187]
    v_pk_add_f32 v[76:77], v[76:77], v[188:189]
    v_pk_add_f32 v[78:79], v[78:79], v[190:191]
    v_cvt_pk_bf16_f32 v64, v64, v64
    v_lshlrev_b32 v64, 16, v64
    v_cvt_pk_bf16_f32 v65, v65, v65
    v_lshlrev_b32 v65, 16, v65
    v_cvt_pk_bf16_f32 v66, v66, v66
    v_lshlrev_b32 v66, 16, v66
    v_cvt_pk_bf16_f32 v67, v67, v67
    v_lshlrev_b32 v67, 16, v67
    v_cvt_pk_bf16_f32 v68, v68, v68
    v_lshlrev_b32 v68, 16, v68
    v_cvt_pk_bf16_f32 v69, v69, v69
    v_lshlrev_b32 v69, 16, v69
    v_cvt_pk_bf16_f32 v70, v70, v70
    v_lshlrev_b32 v70, 16, v70
    v_cvt_pk_bf16_f32 v71, v71, v71
    v_lshlrev_b32 v71, 16, v71
    v_cvt_pk_bf16_f32 v72, v72, v72
    v_lshlrev_b32 v72, 16, v72
    v_cvt_pk_bf16_f32 v73, v73, v73
    v_lshlrev_b32 v73, 16, v73
    v_cvt_pk_bf16_f32 v74, v74, v74
    v_lshlrev_b32 v74, 16, v74
    v_cvt_pk_bf16_f32 v75, v75, v75
    v_lshlrev_b32 v75, 16, v75
    v_cvt_pk_bf16_f32 v76, v76, v76
    v_lshlrev_b32 v76, 16, v76
    v_cvt_pk_bf16_f32 v77, v77, v77
    v_lshlrev_b32 v77, 16, v77
    v_cvt_pk_bf16_f32 v78, v78, v78
    v_lshlrev_b32 v78, 16, v78
    v_cvt_pk_bf16_f32 v79, v79, v79
    v_lshlrev_b32 v79, 16, v79
    v_lshlrev_b32 v160, 16, v208
    v_and_b32 v161, 0xffff0000, v208
    v_lshlrev_b32 v162, 16, v209
    v_and_b32 v163, 0xffff0000, v209
    v_lshlrev_b32 v164, 16, v210
    v_and_b32 v165, 0xffff0000, v210
    v_lshlrev_b32 v166, 16, v211
    v_and_b32 v167, 0xffff0000, v211
    v_lshlrev_b32 v168, 16, v212
    v_and_b32 v169, 0xffff0000, v212
    v_lshlrev_b32 v170, 16, v213
    v_and_b32 v171, 0xffff0000, v213
    v_lshlrev_b32 v172, 16, v214
    v_and_b32 v173, 0xffff0000, v214
    v_lshlrev_b32 v174, 16, v215
    v_and_b32 v175, 0xffff0000, v215
    v_mul_f32 v64, v64, v112
    v_cvt_pk_bf16_f32 v64, v64, v64
    v_lshlrev_b32 v64, 16, v64
    v_add_f32 v64, v64, v160
    v_mul_f32 v65, v65, v113
    v_cvt_pk_bf16_f32 v65, v65, v65
    v_lshlrev_b32 v65, 16, v65
    v_add_f32 v65, v65, v161
    v_mul_f32 v66, v66, v114
    v_cvt_pk_bf16_f32 v66, v66, v66
    v_lshlrev_b32 v66, 16, v66
    v_add_f32 v66, v66, v162
    v_mul_f32 v67, v67, v115
    v_cvt_pk_bf16_f32 v67, v67, v67
    v_lshlrev_b32 v67, 16, v67
    v_add_f32 v67, v67, v163
    v_mul_f32 v68, v68, v116
    v_cvt_pk_bf16_f32 v68, v68, v68
    v_lshlrev_b32 v68, 16, v68
    v_add_f32 v68, v68, v164
    v_mul_f32 v69, v69, v117
    v_cvt_pk_bf16_f32 v69, v69, v69
    v_lshlrev_b32 v69, 16, v69
    v_add_f32 v69, v69, v165
    v_mul_f32 v70, v70, v118
    v_cvt_pk_bf16_f32 v70, v70, v70
    v_lshlrev_b32 v70, 16, v70
    v_add_f32 v70, v70, v166
    v_mul_f32 v71, v71, v119
    v_cvt_pk_bf16_f32 v71, v71, v71
    v_lshlrev_b32 v71, 16, v71
    v_add_f32 v71, v71, v167
    v_mul_f32 v72, v72, v120
    v_cvt_pk_bf16_f32 v72, v72, v72
    v_lshlrev_b32 v72, 16, v72
    v_add_f32 v72, v72, v168
    v_mul_f32 v73, v73, v121
    v_cvt_pk_bf16_f32 v73, v73, v73
    v_lshlrev_b32 v73, 16, v73
    v_add_f32 v73, v73, v169
    v_mul_f32 v74, v74, v122
    v_cvt_pk_bf16_f32 v74, v74, v74
    v_lshlrev_b32 v74, 16, v74
    v_add_f32 v74, v74, v170
    v_mul_f32 v75, v75, v123
    v_cvt_pk_bf16_f32 v75, v75, v75
    v_lshlrev_b32 v75, 16, v75
    v_add_f32 v75, v75, v171
    v_mul_f32 v76, v76, v124
    v_cvt_pk_bf16_f32 v76, v76, v76
    v_lshlrev_b32 v76, 16, v76
    v_add_f32 v76, v76, v172
    v_mul_f32 v77, v77, v125
    v_cvt_pk_bf16_f32 v77, v77, v77
    v_lshlrev_b32 v77, 16, v77
    v_add_f32 v77, v77, v173
    v_mul_f32 v78, v78, v126
    v_cvt_pk_bf16_f32 v78, v78, v78
    v_lshlrev_b32 v78, 16, v78
    v_add_f32 v78, v78, v174
    v_mul_f32 v79, v79, v127
    v_cvt_pk_bf16_f32 v79, v79, v79
    v_lshlrev_b32 v79, 16, v79
    v_add_f32 v79, v79, v175
    v_cvt_pk_bf16_f32 v208, v64, v65
    v_cvt_pk_bf16_f32 v209, v66, v67
    v_cvt_pk_bf16_f32 v210, v68, v69
    v_cvt_pk_bf16_f32 v211, v70, v71
    v_cvt_pk_bf16_f32 v212, v72, v73
    v_cvt_pk_bf16_f32 v213, v74, v75
    v_cvt_pk_bf16_f32 v214, v76, v77
    v_cvt_pk_bf16_f32 v215, v78, v79
    s_add_u32 s47, s47, 0x800000
    buffer_store_dwordx4 v[208:211], v10, s[12:15], s47 offen sc1
    buffer_store_dwordx4 v[212:215], v10, s[12:15], s47 offen offset:1024 sc1
    v_lshlrev_b32 v64, 16, v208
    v_and_b32 v65, 0xffff0000, v208
    v_lshlrev_b32 v66, 16, v209
    v_and_b32 v67, 0xffff0000, v209
    v_lshlrev_b32 v68, 16, v210
    v_and_b32 v69, 0xffff0000, v210
    v_lshlrev_b32 v70, 16, v211
    v_and_b32 v71, 0xffff0000, v211
    v_lshlrev_b32 v72, 16, v212
    v_and_b32 v73, 0xffff0000, v212
    v_lshlrev_b32 v74, 16, v213
    v_and_b32 v75, 0xffff0000, v213
    v_lshlrev_b32 v76, 16, v214
    v_and_b32 v77, 0xffff0000, v214
    v_lshlrev_b32 v78, 16, v215
    v_and_b32 v79, 0xffff0000, v215
    v_add_f32 v26, v64, v65
    v_add_f32 v26, v26, v66
    v_add_f32 v26, v26, v67
    v_add_f32 v26, v26, v68
    v_add_f32 v26, v26, v69
    v_add_f32 v26, v26, v70
    v_add_f32 v26, v26, v71
    v_add_f32 v26, v26, v72
    v_add_f32 v26, v26, v73
    v_add_f32 v26, v26, v74
    v_add_f32 v26, v26, v75
    v_add_f32 v26, v26, v76
    v_add_f32 v26, v26, v77
    v_add_f32 v26, v26, v78
    v_add_f32 v26, v26, v79
    s_nop 1
    v_add_f32_dpp v26, v26, v26 row_shr:1 row_mask:0xf bank_mask:0xf bound_ctrl:0
    s_nop 1
    v_add_f32_dpp v26, v26, v26 row_shr:2 row_mask:0xf bank_mask:0xf bound_ctrl:0
    s_nop 1
    v_add_f32_dpp v26, v26, v26 row_shr:4 row_mask:0xf bank_mask:0xf bound_ctrl:0
    s_nop 1
    v_add_f32_dpp v26, v26, v26 row_shr:8 row_mask:0xf bank_mask:0xf bound_ctrl:0
    s_nop 1
    v_add_f32_dpp v26, v26, v26 row_bcast:15 row_mask:0xa bank_mask:0xf
    s_nop 1
    v_add_f32_dpp v26, v26, v26 row_bcast:31 row_mask:0xc bank_mask:0xf
    s_nop 1
    v_readlane_b32 s66, v26, 63
    s_nop 1
    v_mov_b32 v27, s66
    v_mul_f32 v27, 0x3a800000, v27
    v_mov_b32 v26, 0
    v_sub_f32 v28, v64, v27
    v_fmac_f32 v26, v28, v28
    v_sub_f32 v28, v65, v27
    v_fmac_f32 v26, v28, v28
    v_sub_f32 v28, v66, v27
    v_fmac_f32 v26, v28, v28
    v_sub_f32 v28, v67, v27
    v_fmac_f32 v26, v28, v28
    v_sub_f32 v28, v68, v27
    v_fmac_f32 v26, v28, v28
    v_sub_f32 v28, v69, v27
    v_fmac_f32 v26, v28, v28
    v_sub_f32 v28, v70, v27
    v_fmac_f32 v26, v28, v28
    v_sub_f32 v28, v71, v27
    v_fmac_f32 v26, v28, v28
    v_sub_f32 v28, v72, v27
    v_fmac_f32 v26, v28, v28
    v_sub_f32 v28, v73, v27
    v_fmac_f32 v26, v28, v28
    v_sub_f32 v28, v74, v27
    v_fmac_f32 v26, v28, v28
    v_sub_f32 v28, v75, v27
    v_fmac_f32 v26, v28, v28
    v_sub_f32 v28, v76, v27
    v_fmac_f32 v26, v28, v28
    v_sub_f32 v28, v77, v27
    v_fmac_f32 v26, v28, v28
    v_sub_f32 v28, v78, v27
    v_fmac_f32 v26, v28, v28
    v_sub_f32 v28, v79, v27
    v_fmac_f32 v26, v28, v28
    s_nop 1
    v_add_f32_dpp v26, v26, v26 row_shr:1 row_mask:0xf bank_mask:0xf bound_ctrl:0
    s_nop 1
    v_add_f32_dpp v26, v26, v26 row_shr:2 row_mask:0xf bank_mask:0xf bound_ctrl:0
    s_nop 1
    v_add_f32_dpp v26, v26, v26 row_shr:4 row_mask:0xf bank_mask:0xf bound_ctrl:0
    s_nop 1
    v_add_f32_dpp v26, v26, v26 row_shr:8 row_mask:0xf bank_mask:0xf bound_ctrl:0
    s_nop 1
    v_add_f32_dpp v26, v26, v26 row_bcast:15 row_mask:0xa bank_mask:0xf
    s_nop 1
    v_add_f32_dpp v26, v26, v26 row_bcast:31 row_mask:0xc bank_mask:0xf
    s_nop 1
    v_readlane_b32 s66, v26, 63
    s_nop 1
    v_mov_b32 v26, s66
    v_mul_f32 v26, 0x3a800000, v26
    v_cvt_pk_bf16_f32 v26, v26, v26
    v_lshlrev_b32 v26, 16, v26
    v_cvt_pk_bf16_f32 v27, v27, v27
    v_lshlrev_b32 v27, 16, v27
    v_add_f32 v26, 0x3727c5ac, v26
    v_cvt_pk_bf16_f32 v26, v26, v26
    v_lshlrev_b32 v26, 16, v26
    v_sqrt_f32 v26, v26
    s_nop 0
    v_cvt_pk_bf16_f32 v26, v26, v26
    v_lshlrev_b32 v26, 16, v26
    v_rcp_f32 v26, v26
    s_nop 0
    v_sub_f32 v64, v64, v27
    v_cvt_pk_bf16_f32 v64, v64, v64
    v_lshlrev_b32 v64, 16, v64
    v_mul_f32 v64, v64, v26
    v_cvt_pk_bf16_f32 v64, v64, v64
    v_lshlrev_b32 v64, 16, v64
    v_sub_f32 v65, v65, v27
    v_cvt_pk_bf16_f32 v65, v65, v65
    v_lshlrev_b32 v65, 16, v65
    v_mul_f32 v65, v65, v26
    v_cvt_pk_bf16_f32 v65, v65, v65
    v_lshlrev_b32 v65, 16, v65
    v_sub_f32 v66, v66, v27
    v_cvt_pk_bf16_f32 v66, v66, v66
    v_lshlrev_b32 v66, 16, v66
    v_mul_f32 v66, v66, v26
    v_cvt_pk_bf16_f32 v66, v66, v66
    v_lshlrev_b32 v66, 16, v66
    v_sub_f32 v67, v67, v27
    v_cvt_pk_bf16_f32 v67, v67, v67
    v_lshlrev_b32 v67, 16, v67
    v_mul_f32 v67, v67, v26
    v_cvt_pk_bf16_f32 v67, v67, v67
    v_lshlrev_b32 v67, 16, v67
    v_sub_f32 v68, v68, v27
    v_cvt_pk_bf16_f32 v68, v68, v68
    v_lshlrev_b32 v68, 16, v68
    v_mul_f32 v68, v68, v26
    v_cvt_pk_bf16_f32 v68, v68, v68
    v_lshlrev_b32 v68, 16, v68
    v_sub_f32 v69, v69, v27
    v_cvt_pk_bf16_f32 v69, v69, v69
    v_lshlrev_b32 v69, 16, v69
    v_mul_f32 v69, v69, v26
    v_cvt_pk_bf16_f32 v69, v69, v69
    v_lshlrev_b32 v69, 16, v69
    v_sub_f32 v70, v70, v27
    v_cvt_pk_bf16_f32 v70, v70, v70
    v_lshlrev_b32 v70, 16, v70
    v_mul_f32 v70, v70, v26
    v_cvt_pk_bf16_f32 v70, v70, v70
    v_lshlrev_b32 v70, 16, v70
    v_sub_f32 v71, v71, v27
    v_cvt_pk_bf16_f32 v71, v71, v71
    v_lshlrev_b32 v71, 16, v71
    v_mul_f32 v71, v71, v26
    v_cvt_pk_bf16_f32 v71, v71, v71
    v_lshlrev_b32 v71, 16, v71
    v_sub_f32 v72, v72, v27
    v_cvt_pk_bf16_f32 v72, v72, v72
    v_lshlrev_b32 v72, 16, v72
    v_mul_f32 v72, v72, v26
    v_cvt_pk_bf16_f32 v72, v72, v72
    v_lshlrev_b32 v72, 16, v72
    v_sub_f32 v73, v73, v27
    v_cvt_pk_bf16_f32 v73, v73, v73
    v_lshlrev_b32 v73, 16, v73
    v_mul_f32 v73, v73, v26
    v_cvt_pk_bf16_f32 v73, v73, v73
    v_lshlrev_b32 v73, 16, v73
    v_sub_f32 v74, v74, v27
    v_cvt_pk_bf16_f32 v74, v74, v74
    v_lshlrev_b32 v74, 16, v74
    v_mul_f32 v74, v74, v26
    v_cvt_pk_bf16_f32 v74, v74, v74
    v_lshlrev_b32 v74, 16, v74
    v_sub_f32 v75, v75, v27
    v_cvt_pk_bf16_f32 v75, v75, v75
    v_lshlrev_b32 v75, 16, v75
    v_mul_f32 v75, v75, v26
    v_cvt_pk_bf16_f32 v75, v75, v75
    v_lshlrev_b32 v75, 16, v75
    v_sub_f32 v76, v76, v27
    v_cvt_pk_bf16_f32 v76, v76, v76
    v_lshlrev_b32 v76, 16, v76
    v_mul_f32 v76, v76, v26
    v_cvt_pk_bf16_f32 v76, v76, v76
    v_lshlrev_b32 v76, 16, v76
    v_sub_f32 v77, v77, v27
    v_cvt_pk_bf16_f32 v77, v77, v77
    v_lshlrev_b32 v77, 16, v77
    v_mul_f32 v77, v77, v26
    v_cvt_pk_bf16_f32 v77, v77, v77
    v_lshlrev_b32 v77, 16, v77
    v_sub_f32 v78, v78, v27
    v_cvt_pk_bf16_f32 v78, v78, v78
    v_lshlrev_b32 v78, 16, v78
    v_mul_f32 v78, v78, v26
    v_cvt_pk_bf16_f32 v78, v78, v78
    v_lshlrev_b32 v78, 16, v78
    v_sub_f32 v79, v79, v27
    v_cvt_pk_bf16_f32 v79, v79, v79
    v_lshlrev_b32 v79, 16, v79
    v_mul_f32 v79, v79, v26
    v_cvt_pk_bf16_f32 v79, v79, v79
    v_lshlrev_b32 v79, 16, v79
    v_mul_f32 v64, v64, v144
    v_cvt_pk_bf16_f32 v64, v64, v64
    v_lshlrev_b32 v64, 16, v64
    v_add_f32 v64, v64, v128
    v_mul_f32 v65, v65, v145
    v_cvt_pk_bf16_f32 v65, v65, v65
    v_lshlrev_b32 v65, 16, v65
    v_add_f32 v65, v65, v129
    v_mul_f32 v66, v66, v146
    v_cvt_pk_bf16_f32 v66, v66, v66
    v_lshlrev_b32 v66, 16, v66
    v_add_f32 v66, v66, v130
    v_mul_f32 v67, v67, v147
    v_cvt_pk_bf16_f32 v67, v67, v67
    v_lshlrev_b32 v67, 16, v67
    v_add_f32 v67, v67, v131
    v_mul_f32 v68, v68, v148
    v_cvt_pk_bf16_f32 v68, v68, v68
    v_lshlrev_b32 v68, 16, v68
    v_add_f32 v68, v68, v132
    v_mul_f32 v69, v69, v149
    v_cvt_pk_bf16_f32 v69, v69, v69
    v_lshlrev_b32 v69, 16, v69
    v_add_f32 v69, v69, v133
    v_mul_f32 v70, v70, v150
    v_cvt_pk_bf16_f32 v70, v70, v70
    v_lshlrev_b32 v70, 16, v70
    v_add_f32 v70, v70, v134
    v_mul_f32 v71, v71, v151
    v_cvt_pk_bf16_f32 v71, v71, v71
    v_lshlrev_b32 v71, 16, v71
    v_add_f32 v71, v71, v135
    v_mul_f32 v72, v72, v152
    v_cvt_pk_bf16_f32 v72, v72, v72
    v_lshlrev_b32 v72, 16, v72
    v_add_f32 v72, v72, v136
    v_mul_f32 v73, v73, v153
    v_cvt_pk_bf16_f32 v73, v73, v73
    v_lshlrev_b32 v73, 16, v73
    v_add_f32 v73, v73, v137
    v_mul_f32 v74, v74, v154
    v_cvt_pk_bf16_f32 v74, v74, v74
    v_lshlrev_b32 v74, 16, v74
    v_add_f32 v74, v74, v138
    v_mul_f32 v75, v75, v155
    v_cvt_pk_bf16_f32 v75, v75, v75
    v_lshlrev_b32 v75, 16, v75
    v_add_f32 v75, v75, v139
    v_mul_f32 v76, v76, v156
    v_cvt_pk_bf16_f32 v76, v76, v76
    v_lshlrev_b32 v76, 16, v76
    v_add_f32 v76, v76, v140
    v_mul_f32 v77, v77, v157
    v_cvt_pk_bf16_f32 v77, v77, v77
    v_lshlrev_b32 v77, 16, v77
    v_add_f32 v77, v77, v141
    v_mul_f32 v78, v78, v158
    v_cvt_pk_bf16_f32 v78, v78, v78
    v_lshlrev_b32 v78, 16, v78
    v_add_f32 v78, v78, v142
    v_mul_f32 v79, v79, v159
    v_cvt_pk_bf16_f32 v79, v79, v79
    v_lshlrev_b32 v79, 16, v79
    v_add_f32 v79, v79, v143
    v_cvt_pk_bf16_f32 v80, v64, v65
    v_cvt_pk_bf16_f32 v81, v66, v67
    v_cvt_pk_bf16_f32 v82, v68, v69
    v_cvt_pk_bf16_f32 v83, v70, v71
    v_cvt_pk_bf16_f32 v84, v72, v73
    v_cvt_pk_bf16_f32 v85, v74, v75
    v_cvt_pk_bf16_f32 v86, v76, v77
    v_cvt_pk_bf16_f32 v87, v78, v79
    s_lshr_b32 s45, s63, 5
    s_lshl_b32 s45, s45, 16
    s_and_b32 s46, s63, 31
    s_lshl_b32 s46, s46, 8
    s_add_u32 s45, s45, s46
    s_add_u32 s45, s45, 0xc00000
    s_add_u32 s46, s45, 32768
    buffer_store_dwordx4 v[80:83], v2, s[12:15], s45 offen sc1
    buffer_store_dwordx4 v[84:87], v2, s[12:15], s46 offen sc1
L_b_skip_152:
    s_waitcnt vmcnt(0)
    s_barrier
    s_cmp_lg_u32 s44, 0
    s_cbranch_scc1 L_pub_163
    v_mov_b32 v30, s62
    v_mov_b32 v31, 0
    s_mov_b64 exec, 1
    buffer_store_dword v30, v31, s[80:83], s65 offen
    buffer_store_dword v30, v31, s[84:87], s65 offen sc1
    s_mov_b64 exec, -1
L_pub_163:
    s_cmp_ge_u32 s41, 28
    s_cbranch_scc1 L_b_loop_151
    s_add_u32 s45, s64, 8192
    s_cmp_lg_u32 s44, 1
    s_cbranch_scc1 L_pw_164
    s_mov_b32 exec_hi, 0
    s_mov_b32 s70, 0
L_wp_165:
    buffer_load_dword v31, v5, s[12:15], s45 offen sc1
    s_add_u32 s70, s70, 1
    s_cmp_ge_u32 s70, 0x200000
    s_cbranch_scc1 L_w_done_98
L_wp_165_c:
    s_waitcnt vmcnt(0)
    v_cmp_gt_u32 vcc, s62, v31
    s_nop 1
    s_cbranch_vccz L_wp_165_ok
    s_sleep 1
    s_branch L_wp_165
L_wp_165_ok:
    s_mov_b64 exec, -1
L_pw_164:
    s_barrier
    s_mul_i32 s53, s50, 65536
    s_add_u32 s53, s53, s52
    s_lshl_b32 s54, s44, 13
    s_add_u32 s53, s53, s54
    s_mul_i32 s57, s50, 229376
    s_add_u32 s57, s57, s56
    s_lshl_b32 s45, s44, 11
    s_add_u32 s57, s57, s45
    s_add_u32 s55, s54, 65536
    s_mov_b32 s58, 0
    v_mov_b32 v13, v3
    v_add_u32 v14, 65536, v13
    v_xor_b32 v15, 64, v13
    v_xor_b32 v16, 64, v14
    s_mov_b32 s76, 0x20000000
    s_add_u32 s48, s53, 0
    s_add_u32 s49, s48, 4096
    s_add_u32 m0, s54, 0
    s_nop 0
    buffer_load_dwordx4 v6, s[12:15], s48 offen offset:0 sc1 lds
    s_add_u32 m0, s54, 1024
    s_nop 0
    buffer_load_dwordx4 v9, s[12:15], s48 offen offset:0 sc1 lds
    s_add_u32 m0, s54, 2048
    s_nop 0
    buffer_load_dwordx4 v6, s[12:15], s49 offen offset:0 sc1 lds
    s_add_u32 m0, s54, 3072
    s_nop 0
    buffer_load_dwordx4 v9, s[12:15], s49 offen offset:0 sc1 lds
    s_add_u32 m0, s54, 3968
    s_nop 0
    buffer_load_dwordx4 v6, s[12:15], s48 offen offset:128 sc1 lds
    s_add_u32 m0, s54, 4992
    s_nop 0
    buffer_load_dwordx4 v9, s[12:15], s48 offen offset:128 sc1 lds
    s_add_u32 m0, s54, 6016
    s_nop 0
    buffer_load_dwordx4 v6, s[12:15], s49 offen offset:128 sc1 lds
    s_add_u32 m0, s54, 7040
    s_nop 0
    buffer_load_dwordx4 v9, s[12:15], s49 offen offset:128 sc1 lds
    s_add_u32 s48, s53, 32768
    s_add_u32 s49, s48, 4096
    s_add_u32 s46, s54, 32768
    s_add_u32 m0, s46, 0
    s_nop 0
    buffer_load_dwordx4 v6, s[12:15], s48 offen offset:0 sc1 lds
    s_add_u32 m0, s46, 1024
    s_nop 0
    buffer_load_dwordx4 v9, s[12:15], s48 offen offset:0 sc1 lds
    s_add_u32 m0, s46, 2048
    s_nop 0
    buffer_load_dwordx4 v6, s[12:15], s49 offen offset:0 sc1 lds
    s_add_u32 m0, s46, 3072
    s_nop 0
    buffer_load_dwordx4 v9, s[12:15], s49 offen offset:0 sc1 lds
    s_add_u32 m0, s46, 3968
    s_nop 0
    buffer_load_dwordx4 v6, s[12:15], s48 offen offset:128 sc1 lds
    s_add_u32 m0, s46, 4992
    s_nop 0
    buffer_load_dwordx4 v9, s[12:15], s48 offen offset:128 sc1 lds
    s_add_u32 m0, s46, 6016
    s_nop 0
    buffer_load_dwordx4 v6, s[12:15], s49 offen offset:128 sc1 lds
    s_add_u32 m0, s46, 7040
    s_nop 0
    buffer_load_dwordx4 v9, s[12:15], s49 offen offset:128 sc1 lds
    s_cmp_eq_u32 s51, 1
    s_cbranch_scc1 L_e_one_167
    s_add_u32 s48, s53, 65536
    s_add_u32 s49, s48, 4096
    s_add_u32 m0, s55, 0
    s_nop 0
    buffer_load_dwordx4 v6, s[12:15], s48 offen offset:0 sc1 lds
    s_add_u32 m0, s55, 1024
    s_nop 0
    buffer_load_dwordx4 v9, s[12:15], s48 offen offset:0 sc1 lds
    s_add_u32 m0, s55, 2048
    s_nop 0
    buffer_load_dwordx4 v6, s[12:15], s49 offen offset:0 sc1 lds
    s_add_u32 m0, s55, 3072
    s_nop 0
    buffer_load_dwordx4 v9, s[12:15], s49 offen offset:0 sc1 lds
    s_add_u32 m0, s55, 3968
    s_nop 0
    buffer_load_dwordx4 v6, s[12:15], s48 offen offset:128 sc1 lds
    s_add_u32 m0, s55, 4992
    s_nop 0
    buffer_load_dwordx4 v9, s[12:15], s48 offen offset:128 sc1 lds
    s_add_u32 m0, s55, 6016
    s_nop 0
    buffer_load_dwordx4 v6, s[12:15], s49 offen offset:128 sc1 lds
    s_add_u32 m0, s55, 7040
    s_nop 0
    buffer_load_dwordx4 v9, s[12:15], s49 offen offset:128 sc1 lds
    s_waitcnt vmcnt(16)
    s_barrier
    ds_read_b128 v[32:35], v13 offset:0
    ds_read_b128 v[36:39], v13 offset:2048
    ds_read_b128 v[40:43], v15 offset:0
    ds_read_b128 v[44:47], v15 offset:2048
    s_add_u32 s48, s53, 98304
    s_add_u32 s46, s58, 1
    s_cmp_lt_u32 s46, s51
    s_cselect_b32 s48, s48, 0x20000000
    s_add_u32 s49, s48, 4096
    s_add_u32 s59, s55, 32768
L_e_loop_166:
    s_waitcnt lgkmcnt(2)
    v_mfma_f32_16x16x32_bf16 v[80:83], a[0:3], v[32:35], 0
    ds_read_b128 v[48:51], v13 offset:4096
    v_mul_f32 v240, v224, v224
    v_mfma_f32_16x16x32_bf16 v[84:87], a[4:7], v[32:35], 0
    ds_read_b128 v[52:55], v13 offset:6144
    v_mul_f32 v241, v225, v225
    v_mfma_f32_16x16x32_bf16 v[88:91], a[0:3], v[36:39], 0
    ds_read_b128 v[56:59], v15 offset:4096
    s_add_u32 m0, s59, 0
    v_mul_f32 v242, v226, v226
    v_mfma_f32_16x16x32_bf16 v[92:95], a[4:7], v[36:39], 0
    ds_read_b128 v[60:63], v15 offset:6144
    buffer_load_dwordx4 v6, s[12:15], s48 offen offset:0 sc1 lds
    s_waitcnt lgkmcnt(4)
    v_mfma_f32_16x16x32_bf16 v[80:83], a[8:11], v[40:43], v[80:83]
    ds_read_b128 v[32:35], v13 offset:8192
    v_mul_f32 v243, v227, v227
    v_mfma_f32_16x16x32_bf16 v[84:87], a[12:15], v[40:43], v[84:87]
    ds_read_b128 v[36:39], v13 offset:10240
    v_mul_f32 v244, v228, v228
    v_mfma_f32_16x16x32_bf16 v[88:91], a[8:11], v[44:47], v[88:91]
    s_add_u32 m0, s59, 1024
    v_mul_f32 v245, v229, v229
    v_mul_f32 v246, v230, v230
    v_mfma_f32_16x16x32_bf16 v[92:95], a[12:15], v[44:47], v[92:95]
    buffer_load_dwordx4 v9, s[12:15], s48 offen offset:0 sc1 lds
    s_waitcnt lgkmcnt(4)
    v_mfma_f32_16x16x32_bf16 v[80:83], a[16:19], v[48:51], v[80:83]
    ds_read_b128 v[40:43], v15 offset:8192
    v_mul_f32 v247, v231, v231
    v_mfma_f32_16x16x32_bf16 v[84:87], a[20:23], v[48:51], v[84:87]
    ds_read_b128 v[44:47], v15 offset:10240
    v_mul_f32 v248, v232, v232
    v_mfma_f32_16x16x32_bf16 v[88:91], a[16:19], v[52:55], v[88:91]
    s_add_u32 m0, s59, 2048
    v_mul_f32 v249, v233, v233
    v_mul_f32 v250, v234, v234
    v_mfma_f32_16x16x32_bf16 v[92:95], a[20:23], v[52:55], v[92:95]
    buffer_load_dwordx4 v6, s[12:15], s49 offen offset:0 sc1 lds
    s_waitcnt lgkmcnt(4)
    v_mfma_f32_16x16x32_bf16 v[80:83], a[24:27], v[56:59], v[80:83]
    ds_read_b128 v[48:51], v13 offset:12288
    v_mul_f32 v251, v235, v235
    v_mfma_f32_16x16x32_bf16 v[84:87], a[28:31], v[56:59], v[84:87]
    ds_read_b128 v[52:55], v13 offset:14336
    v_mul_f32 v252, v236, v236
    v_mfma_f32_16x16x32_bf16 v[88:91], a[24:27], v[60:63], v[88:91]
    s_add_u32 m0, s59, 3072
    v_mul_f32 v253, v237, v237
    v_mul_f32 v254, v238, v238
    v_mfma_f32_16x16x32_bf16 v[92:95], a[28:31], v[60:63], v[92:95]
    buffer_load_dwordx4 v9, s[12:15], s49 offen offset:0 sc1 lds
    s_waitcnt lgkmcnt(4)
    v_mfma_f32_16x16x32_bf16 v[80:83], a[32:35], v[32:35], v[80:83]
    ds_read_b128 v[56:59], v15 offset:12288
    v_mul_f32 v255, v239, v239
    v_mfma_f32_16x16x32_bf16 v[84:87], a[36:39], v[32:35], v[84:87]
    ds_read_b128 v[60:63], v15 offset:14336
    v_fma_f32 v240, v240, v104, v106
    v_mfma_f32_16x16x32_bf16 v[88:91], a[32:35], v[36:39], v[88:91]
    s_add_u32 m0, s59, 3968
    v_fma_f32 v241, v241, v105, v107
    v_fma_f32 v242, v242, v104, v106
    v_mfma_f32_16x16x32_bf16 v[92:95], a[36:39], v[36:39], v[92:95]
    buffer_load_dwordx4 v6, s[12:15], s48 offen offset:128 sc1 lds
    s_waitcnt lgkmcnt(4)
    v_mfma_f32_16x16x32_bf16 v[80:83], a[40:43], v[40:43], v[80:83]
    ds_read_b128 v[32:35], v13 offset:16384
    v_fma_f32 v243, v243, v105, v107
    v_mfma_f32_16x16x32_bf16 v[84:87], a[44:47], v[40:43], v[84:87]
    ds_read_b128 v[36:39], v13 offset:18432
    v_fma_f32 v244, v244, v104, v106
    v_mfma_f32_16x16x32_bf16 v[88:91], a[40:43], v[44:47], v[88:91]
    s_add_u32 m0, s59, 4992
    v_fma_f32 v245, v245, v105, v107
    v_fma_f32 v246, v246, v104, v106
    v_mfma_f32_16x16x32_bf16 v[92:95], a[44:47], v[44:47], v[92:95]
    buffer_load_dwordx4 v9, s[12:15], s48 offen offset:128 sc1 lds
    s_waitcnt lgkmcnt(4)
    v_mfma_f32_16x16x32_bf16 v[80:83], a[48:51], v[48:51], v[80:83]
    ds_read_b128 v[40:43], v15 offset:16384
    v_fma_f32 v247, v247, v105, v107
    v_mfma_f32_16x16x32_bf16 v[84:87], a[52:55], v[48:51], v[84:87]
    ds_read_b128 v[44:47], v15 offset:18432
    v_fma_f32 v248, v248, v104, v106
    v_mfma_f32_16x16x32_bf16 v[88:91], a[48:51], v[52:55], v[88:91]
    s_add_u32 m0, s59, 6016
    v_fma_f32 v249, v249, v105, v107
    v_fma_f32 v250, v250, v104, v106
    v_mfma_f32_16x16x32_bf16 v[92:95], a[52:55], v[52:55], v[92:95]
    buffer_load_dwordx4 v6, s[12:15], s49 offen offset:128 sc1 lds
    s_waitcnt lgkmcnt(4)
    v_mfma_f32_16x16x32_bf16 v[80:83], a[56:59], v[56:59], v[80:83]
    ds_read_b128 v[48:51], v13 offset:20480
    v_fma_f32 v251, v251, v105, v107
    v_mfma_f32_16x16x32_bf16 v[84:87], a[60:63], v[56:59], v[84:87]
    ds_read_b128 v[52:55], v13 offset:22528
    v_fma_f32 v252, v252, v104, v106
    v_mfma_f32_16x16x32_bf16 v[88:91], a[56:59], v[60:63], v[88:91]
    s_add_u32 m0, s59, 7040
    v_fma_f32 v253, v253, v105, v107
    v_fma_f32 v254, v254, v104, v106
    v_mfma_f32_16x16x32_bf16 v[92:95], a[60:63], v[60:63], v[92:95]
    buffer_load_dwordx4 v9, s[12:15], s49 offen offset:128 sc1 lds
    s_waitcnt lgkmcnt(4)
    v_mfma_f32_16x16x32_bf16 v[80:83], a[64:67], v[32:35], v[80:83]
    ds_read_b128 v[56:59], v15 offset:20480
    v_fma_f32 v255, v255, v105, v107
    v_mfma_f32_16x16x32_bf16 v[84:87], a[68:71], v[32:35], v[84:87]
    ds_read_b128 v[60:63], v15 offset:22528
    v_mul_f32 v240, v240, v224
    v_mfma_f32_16x16x32_bf16 v[88:91], a[64:67], v[36:39], v[88:91]
    s_add_u32 s48, s53, 131072
    v_mul_f32 v241, v241, v225
    v_mul_f32 v242, v242, v226
    v_mul_f32 v243, v243, v227
    v_mfma_f32_16x16x32_bf16 v[92:95], a[68:71], v[36:39], v[92:95]
    s_add_u32 s46, s58, 2
    v_mul_f32 v244, v244, v228
    s_waitcnt lgkmcnt(4)
    v_mfma_f32_16x16x32_bf16 v[80:83], a[72:75], v[40:43], v[80:83]
    ds_read_b128 v[32:35], v13 offset:24576
    v_mul_f32 v245, v245, v229
    v_mfma_f32_16x16x32_bf16 v[84:87], a[76:79], v[40:43], v[84:87]
    ds_read_b128 v[36:39], v13 offset:26624
    v_mul_f32 v246, v246, v230
    v_mfma_f32_16x16x32_bf16 v[88:91], a[72:75], v[44:47], v[88:91]
    s_cmp_lt_u32 s46, s51
    s_cselect_b32 s48, s48, 0x20000000
    v_mul_f32 v247, v247, v231
    v_mul_f32 v248, v248, v232
    v_mfma_f32_16x16x32_bf16 v[92:95], a[76:79], v[44:47], v[92:95]
    s_add_u32 s49, s48, 4096
    v_mul_f32 v249, v249, v233
    s_waitcnt lgkmcnt(4)
    v_mfma_f32_16x16x32_bf16 v[80:83], a[80:83], v[48:51], v[80:83]
    ds_read_b128 v[40:43], v15 offset:24576
    v_mul_f32 v250, v250, v234
    v_mfma_f32_16x16x32_bf16 v[84:87], a[84:87], v[48:51], v[84:87]
    ds_read_b128 v[44:47], v15 offset:26624
    v_mul_f32 v251, v251, v235
    v_mfma_f32_16x16x32_bf16 v[88:91], a[80:83], v[52:55], v[88:91]
    s_mov_b32 s59, s54
    v_mul_f32 v252, v252, v236
    v_mul_f32 v253, v253, v237
    v_mfma_f32_16x16x32_bf16 v[92:95], a[84:87], v[52:55], v[92:95]
    v_mul_f32 v254, v254, v238
    s_waitcnt lgkmcnt(4)
    v_mfma_f32_16x16x32_bf16 v[80:83], a[88:91], v[56:59], v[80:83]
    ds_read_b128 v[48:51], v13 offset:28672
    v_mul_f32 v255, v255, v239
    v_mfma_f32_16x16x32_bf16 v[84:87], a[92:95], v[56:59], v[84:87]
    ds_read_b128 v[52:55], v13 offset:30720
    v_exp_f32 v240, v240
    v_mfma_f32_16x16x32_bf16 v[88:91], a[88:91], v[60:63], v[88:91]
    v_exp_f32 v241, v241
    v_mfma_f32_16x16x32_bf16 v[92:95], a[92:95], v[60:63], v[92:95]
    v_exp_f32 v242, v242
    s_waitcnt lgkmcnt(4)
    v_mfma_f32_16x16x32_bf16 v[80:83], a[96:99], v[32:35], v[80:83]
    ds_read_b128 v[56:59], v15 offset:28672
    v_exp_f32 v243, v243
    v_mfma_f32_16x16x32_bf16 v[84:87], a[100:103], v[32:35], v[84:87]
    ds_read_b128 v[60:63], v15 offset:30720
    v_exp_f32 v244, v244
    v_mfma_f32_16x16x32_bf16 v[88:91], a[96:99], v[36:39], v[88:91]
    v_exp_f32 v245, v245
    v_mfma_f32_16x16x32_bf16 v[92:95], a[100:103], v[36:39], v[92:95]
    v_exp_f32 v246, v246
    s_waitcnt lgkmcnt(4)
    v_mfma_f32_16x16x32_bf16 v[80:83], a[104:107], v[40:43], v[80:83]
    v_exp_f32 v247, v247
    v_mfma_f32_16x16x32_bf16 v[84:87], a[108:111], v[40:43], v[84:87]
    v_exp_f32 v248, v248
    v_mfma_f32_16x16x32_bf16 v[88:91], a[104:107], v[44:47], v[88:91]
    v_exp_f32 v249, v249
    v_mfma_f32_16x16x32_bf16 v[92:95], a[108:111], v[44:47], v[92:95]
    v_exp_f32 v250, v250
    s_waitcnt vmcnt(16) lgkmcnt(0)
    s_barrier
    v_mfma_f32_16x16x32_bf16 v[80:83], a[112:115], v[48:51], v[80:83]
    ds_read_b128 v[32:35], v13 offset:32768
    v_exp_f32 v251, v251
    v_mfma_f32_16x16x32_bf16 v[84:87], a[116:119], v[48:51], v[84:87]
    ds_read_b128 v[36:39], v13 offset:34816
    v_exp_f32 v252, v252
    v_mfma_f32_16x16x32_bf16 v[88:91], a[112:115], v[52:55], v[88:91]
    v_exp_f32 v253, v253
    v_mfma_f32_16x16x32_bf16 v[92:95], a[116:119], v[52:55], v[92:95]
    v_exp_f32 v254, v254
    v_mfma_f32_16x16x32_bf16 v[80:83], a[120:123], v[56:59], v[80:83]
    ds_read_b128 v[40:43], v15 offset:32768
    v_exp_f32 v255, v255
    v_mfma_f32_16x16x32_bf16 v[84:87], a[124:127], v[56:59], v[84:87]
    ds_read_b128 v[44:47], v15 offset:34816
    v_add_f32 v240, 1.0, v240
    v_mfma_f32_16x16x32_bf16 v[88:91], a[120:123], v[60:63], v[88:91]
    v_add_f32 v241, 1.0, v241
    v_add_f32 v242, 1.0, v242
    v_mfma_f32_16x16x32_bf16 v[92:95], a[124:127], v[60:63], v[92:95]
    v_add_f32 v243, 1.0, v243
    s_waitcnt lgkmcnt(2)
    v_mfma_f32_16x16x32_bf16 v[80:83], a[128:131], v[32:35], v[80:83]
    ds_read_b128 v[48:51], v13 offset:36864
    v_add_f32 v244, 1.0, v244
    v_mfma_f32_16x16x32_bf16 v[84:87], a[132:135], v[32:35], v[84:87]
    ds_read_b128 v[52:55], v13 offset:38912
    v_add_f32 v245, 1.0, v245
    v_mfma_f32_16x16x32_bf16 v[88:91], a[128:131], v[36:39], v[88:91]
    ds_read_b128 v[56:59], v15 offset:36864
    s_add_u32 m0, s59, 0
    v_add_f32 v246, 1.0, v246
    v_mfma_f32_16x16x32_bf16 v[92:95], a[132:135], v[36:39], v[92:95]
    ds_read_b128 v[60:63], v15 offset:38912
    buffer_load_dwordx4 v6, s[12:15], s48 offen offset:0 sc1 lds
    s_waitcnt lgkmcnt(4)
    v_mfma_f32_16x16x32_bf16 v[80:83], a[136:139], v[40:43], v[80:83]
    ds_read_b128 v[32:35], v13 offset:40960
    v_add_f32 v247, 1.0, v247
    v_mfma_f32_16x16x32_bf16 v[84:87], a[140:143], v[40:43], v[84:87]
    ds_read_b128 v[36:39], v13 offset:43008
    v_add_f32 v248, 1.0, v248
    v_mfma_f32_16x16x32_bf16 v[88:91], a[136:139], v[44:47], v[88:91]
    s_add_u32 m0, s59, 1024
    v_add_f32 v249, 1.0, v249
    v_add_f32 v250, 1.0, v250
    v_mfma_f32_16x16x32_bf16 v[92:95], a[140:143], v[44:47], v[92:95]
    buffer_load_dwordx4 v9, s[12:15], s48 offen offset:0 sc1 lds
    s_waitcnt lgkmcnt(4)
    v_mfma_f32_16x16x32_bf16 v[80:83], a[144:147], v[48:51], v[80:83]
    ds_read_b128 v[40:43], v15 offset:40960
    v_add_f32 v251, 1.0, v251
    v_mfma_f32_16x16x32_bf16 v[84:87], a[148:151], v[48:51], v[84:87]
    ds_read_b128 v[44:47], v15 offset:43008
    v_add_f32 v252, 1.0, v252
    v_mfma_f32_16x16x32_bf16 v[88:91], a[144:147], v[52:55], v[88:91]
    s_add_u32 m0, s59, 2048
    v_add_f32 v253, 1.0, v253
    v_add_f32 v254, 1.0, v254
    v_mfma_f32_16x16x32_bf16 v[92:95], a[148:151], v[52:55], v[92:95]
    buffer_load_dwordx4 v6, s[12:15], s49 offen offset:0 sc1 lds
    s_waitcnt lgkmcnt(4)
    v_mfma_f32_16x16x32_bf16 v[80:83], a[152:155], v[56:59], v[80:83]
    ds_read_b128 v[48:51], v13 offset:45056
    v_add_f32 v255, 1.0, v255
    v_mfma_f32_16x16x32_bf16 v[84:87], a[156:159], v[56:59], v[84:87]
    ds_read_b128 v[52:55], v13 offset:47104
    v_rcp_f32 v240, v240
    v_mfma_f32_16x16x32_bf16 v[88:91], a[152:155], v[60:63], v[88:91]
    s_add_u32 m0, s59, 3072
    v_rcp_f32 v241, v241
    v_mfma_f32_16x16x32_bf16 v[92:95], a[156:159], v[60:63], v[92:95]
    buffer_load_dwordx4 v9, s[12:15], s49 offen offset:0 sc1 lds
    s_waitcnt lgkmcnt(4)
    v_mfma_f32_16x16x32_bf16 v[80:83], a[160:163], v[32:35], v[80:83]
    ds_read_b128 v[56:59], v15 offset:45056
    v_rcp_f32 v242, v242
    v_mfma_f32_16x16x32_bf16 v[84:87], a[164:167], v[32:35], v[84:87]
    ds_read_b128 v[60:63], v15 offset:47104
    v_rcp_f32 v243, v243
    v_mfma_f32_16x16x32_bf16 v[88:91], a[160:163], v[36:39], v[88:91]
    s_add_u32 m0, s59, 3968
    v_rcp_f32 v244, v244
    v_mfma_f32_16x16x32_bf16 v[92:95], a[164:167], v[36:39], v[92:95]
    buffer_load_dwordx4 v6, s[12:15], s48 offen offset:128 sc1 lds
    s_waitcnt lgkmcnt(4)
    v_mfma_f32_16x16x32_bf16 v[80:83], a[168:171], v[40:43], v[80:83]
    ds_read_b128 v[32:35], v13 offset:49152
    v_rcp_f32 v245, v245
    v_mfma_f32_16x16x32_bf16 v[84:87], a[172:175], v[40:43], v[84:87]
    ds_read_b128 v[36:39], v13 offset:51200
    v_rcp_f32 v246, v246
    v_mfma_f32_16x16x32_bf16 v[88:91], a[168:171], v[44:47], v[88:91]
    s_add_u32 m0, s59, 4992
    v_rcp_f32 v247, v247
    v_mfma_f32_16x16x32_bf16 v[92:95], a[172:175], v[44:47], v[92:95]
    buffer_load_dwordx4 v9, s[12:15], s48 offen offset:128 sc1 lds
    s_waitcnt lgkmcnt(4)
    v_mfma_f32_16x16x32_bf16 v[80:83], a[176:179], v[48:51], v[80:83]
    ds_read_b128 v[40:43], v15 offset:49152
    v_rcp_f32 v248, v248
    v_mfma_f32_16x16x32_bf16 v[84:87], a[180:183], v[48:51], v[84:87]
    ds_read_b128 v[44:47], v15 offset:51200
    v_rcp_f32 v249, v249
    v_mfma_f32_16x16x32_bf16 v[88:91], a[176:179], v[52:55], v[88:91]
    s_add_u32 m0, s59, 6016
    v_rcp_f32 v250, v250
    v_mfma_f32_16x16x32_bf16 v[92:95], a[180:183], v[52:55], v[92:95]
    buffer_load_dwordx4 v6, s[12:15], s49 offen offset:128 sc1 lds
    s_waitcnt lgkmcnt(4)
    v_mfma_f32_16x16x32_bf16 v[80:83], a[184:187], v[56:59], v[80:83]
    ds_read_b128 v[48:51], v13 offset:53248
    v_rcp_f32 v251, v251
    v_mfma_f32_16x16x32_bf16 v[84:87], a[188:191], v[56:59], v[84:87]
    ds_read_b128 v[52:55], v13 offset:55296
    v_mfma_f32_16x16x32_bf16 v[88:91], a[184:187], v[60:63], v[88:91]
    s_add_u32 m0, s59, 7040
    v_rcp_f32 v252, v252
    v_mfma_f32_16x16x32_bf16 v[92:95], a[188:191], v[60:63], v[92:95]
    buffer_load_dwordx4 v9, s[12:15], s49 offen offset:128 sc1 lds
    s_waitcnt lgkmcnt(4)
    v_mfma_f32_16x16x32_bf16 v[80:83], a[192:195], v[32:35], v[80:83]
    ds_read_b128 v[56:59], v15 offset:53248
    v_rcp_f32 v253, v253
    v_mfma_f32_16x16x32_bf16 v[84:87], a[196:199], v[32:35], v[84:87]
    ds_read_b128 v[60:63], v15 offset:55296
    v_mfma_f32_16x16x32_bf16 v[88:91], a[192:195], v[36:39], v[88:91]
    s_add_u32 s48, s53, 163840
    v_rcp_f32 v254, v254
    v_mfma_f32_16x16x32_bf16 v[92:95], a[196:199], v[36:39], v[92:95]
    s_add_u32 s46, s58, 2
    s_waitcnt lgkmcnt(4)
    v_mfma_f32_16x16x32_bf16 v[80:83], a[200:203], v[40:43], v[80:83]
    ds_read_b128 v[32:35], v13 offset:57344
    v_rcp_f32 v255, v255
    v_mfma_f32_16x16x32_bf16 v[84:87], a[204:207], v[40:43], v[84:87]
    ds_read_b128 v[36:39], v13 offset:59392
    v_mul_f32 v224, v224, v240
    v_mfma_f32_16x16x32_bf16 v[88:91], a[200:203], v[44:47], v[88:91]
    s_cmp_lt_u32 s46, s51
    s_cselect_b32 s48, s48, 0x20000000
    v_mul_f32 v225, v225, v241
    v_mul_f32 v226, v226, v242
    v_mfma_f32_16x16x32_bf16 v[92:95], a[204:207], v[44:47], v[92:95]
    s_add_u32 s49, s48, 4096
    v_mul_f32 v227, v227, v243
    s_waitcnt lgkmcnt(4)
    v_mfma_f32_16x16x32_bf16 v[80:83], a[208:211], v[48:51], v[80:83]
    ds_read_b128 v[40:43], v15 offset:57344
    v_mul_f32 v228, v228, v244
    v_mfma_f32_16x16x32_bf16 v[84:87], a[212:215], v[48:51], v[84:87]
    ds_read_b128 v[44:47], v15 offset:59392
    v_mul_f32 v229, v229, v245
    v_mfma_f32_16x16x32_bf16 v[88:91], a[208:211], v[52:55], v[88:91]
    s_add_u32 s59, s54, 32768
    v_mul_f32 v230, v230, v246
    v_mul_f32 v231, v231, v247
    v_mfma_f32_16x16x32_bf16 v[92:95], a[212:215], v[52:55], v[92:95]
    v_mul_f32 v232, v232, v248
    s_waitcnt lgkmcnt(4)
    v_mfma_f32_16x16x32_bf16 v[80:83], a[216:219], v[56:59], v[80:83]
    ds_read_b128 v[48:51], v13 offset:61440
    v_mul_f32 v233, v233, v249
    v_mfma_f32_16x16x32_bf16 v[84:87], a[220:223], v[56:59], v[84:87]
    ds_read_b128 v[52:55], v13 offset:63488
    v_mul_f32 v234, v234, v250
    v_mfma_f32_16x16x32_bf16 v[88:91], a[216:219], v[60:63], v[88:91]
    v_mul_f32 v235, v235, v251
    v_mul_f32 v236, v236, v252
    v_mfma_f32_16x16x32_bf16 v[92:95], a[220:223], v[60:63], v[92:95]
    v_mul_f32 v237, v237, v253
    s_waitcnt lgkmcnt(4)
    v_mfma_f32_16x16x32_bf16 v[80:83], a[224:227], v[32:35], v[80:83]
    ds_read_b128 v[56:59], v15 offset:61440
    v_mul_f32 v238, v238, v254
    v_mfma_f32_16x16x32_bf16 v[84:87], a[228:231], v[32:35], v[84:87]
    ds_read_b128 v[60:63], v15 offset:63488
    v_mul_f32 v239, v239, v255
    v_mfma_f32_16x16x32_bf16 v[88:91], a[224:227], v[36:39], v[88:91]
    v_cvt_pk_bf16_f32 v240, v224, v225
    v_cvt_pk_bf16_f32 v241, v226, v227
    v_mfma_f32_16x16x32_bf16 v[92:95], a[228:231], v[36:39], v[92:95]
    v_cvt_pk_bf16_f32 v242, v228, v229
    s_waitcnt lgkmcnt(4)
    v_mfma_f32_16x16x32_bf16 v[80:83], a[232:235], v[40:43], v[80:83]
    v_cvt_pk_bf16_f32 v243, v230, v231
    v_cvt_pk_bf16_f32 v244, v232, v233
    v_mfma_f32_16x16x32_bf16 v[84:87], a[236:239], v[40:43], v[84:87]
    v_cvt_pk_bf16_f32 v245, v234, v235
    v_cvt_pk_bf16_f32 v246, v236, v237
    v_mfma_f32_16x16x32_bf16 v[88:91], a[232:235], v[44:47], v[88:91]
    v_cvt_pk_bf16_f32 v247, v238, v239
    buffer_store_dwordx4 v[240:243], v10, s[12:15], s76 offen sc1
    v_mfma_f32_16x16x32_bf16 v[92:95], a[236:239], v[44:47], v[92:95]
    buffer_store_dwordx4 v[244:247], v10, s[12:15], s76 offen offset:1024 sc1
    s_waitcnt vmcnt(16) lgkmcnt(0)
    s_barrier
    v_mfma_f32_16x16x32_bf16 v[80:83], a[240:243], v[48:51], v[80:83]
    ds_read_b128 v[32:35], v14 offset:0
    v_mfma_f32_16x16x32_bf16 v[84:87], a[244:247], v[48:51], v[84:87]
    ds_read_b128 v[36:39], v14 offset:2048
    v_mfma_f32_16x16x32_bf16 v[88:91], a[240:243], v[52:55], v[88:91]
    v_mfma_f32_16x16x32_bf16 v[92:95], a[244:247], v[52:55], v[92:95]
    v_mfma_f32_16x16x32_bf16 v[80:83], a[248:251], v[56:59], v[80:83]
    ds_read_b128 v[40:43], v16 offset:0
    v_mfma_f32_16x16x32_bf16 v[84:87], a[252:255], v[56:59], v[84:87]
    ds_read_b128 v[44:47], v16 offset:2048
    v_mfma_f32_16x16x32_bf16 v[88:91], a[248:251], v[60:63], v[88:91]
    v_mfma_f32_16x16x32_bf16 v[92:95], a[252:255], v[60:63], v[92:95]
    s_add_u32 s53, s53, 65536
    s_add_u32 s58, s58, 1
    v_swap_b32 v13, v14
    s_xor_b32 s54, s54, 65536
    s_xor_b32 s55, s55, 65536
    s_mov_b32 s76, s57
    v_swap_b32 v15, v16
    s_add_u32 s57, s57, 229376
    v_pk_add_f32 v[224:225], v[80:81], v[96:97]
    v_pk_add_f32 v[226:227], v[82:83], v[98:99]
    v_pk_add_f32 v[228:229], v[84:85], v[100:101]
    v_pk_add_f32 v[230:231], v[86:87], v[102:103]
    v_pk_add_f32 v[232:233], v[88:89], v[96:97]
    v_pk_add_f32 v[234:235], v[90:91], v[98:99]
    v_pk_add_f32 v[236:237], v[92:93], v[100:101]
    v_pk_add_f32 v[238:239], v[94:95], v[102:103]
    s_cmp_lt_u32 s58, s51
    s_cbranch_scc1 L_e_loop_166
    s_branch L_e_fin_168
L_e_one_167:
    s_waitcnt vmcnt(8)
    s_barrier
    ds_read_b128 v[32:35], v13 offset:0
    ds_read_b128 v[36:39], v13 offset:2048
    ds_read_b128 v[40:43], v15 offset:0
    ds_read_b128 v[44:47], v15 offset:2048
    s_waitcnt lgkmcnt(2)
    v_mfma_f32_16x16x32_bf16 v[80:83], a[0:3], v[32:35], 0
    ds_read_b128 v[48:51], v13 offset:4096
    v_mfma_f32_16x16x32_bf16 v[84:87], a[4:7], v[32:35], 0
    ds_read_b128 v[52:55], v13 offset:6144
    v_mfma_f32_16x16x32_bf16 v[88:91], a[0:3], v[36:39], 0
    ds_read_b128 v[56:59], v15 offset:4096
    v_mfma_f32_16x16x32_bf16 v[92:95], a[4:7], v[36:39], 0
    ds_read_b128 v[60:63], v15 offset:6144
    s_waitcnt lgkmcnt(4)
    v_mfma_f32_16x16x32_bf16 v[80:83], a[8:11], v[40:43], v[80:83]
    ds_read_b128 v[32:35], v13 offset:8192
    v_mfma_f32_16x16x32_bf16 v[84:87], a[12:15], v[40:43], v[84:87]
    ds_read_b128 v[36:39], v13 offset:10240
    v_mfma_f32_16x16x32_bf16 v[88:91], a[8:11], v[44:47], v[88:91]
    v_mfma_f32_16x16x32_bf16 v[92:95], a[12:15], v[44:47], v[92:95]
    s_waitcnt lgkmcnt(4)
    v_mfma_f32_16x16x32_bf16 v[80:83], a[16:19], v[48:51], v[80:83]
    ds_read_b128 v[40:43], v15 offset:8192
    v_mfma_f32_16x16x32_bf16 v[84:87], a[20:23], v[48:51], v[84:87]
    ds_read_b128 v[44:47], v15 offset:10240
    v_mfma_f32_16x16x32_bf16 v[88:91], a[16:19], v[52:55], v[88:91]
    v_mfma_f32_16x16x32_bf16 v[92:95], a[20:23], v[52:55], v[92:95]
    s_waitcnt lgkmcnt(4)
    v_mfma_f32_16x16x32_bf16 v[80:83], a[24:27], v[56:59], v[80:83]
    ds_read_b128 v[48:51], v13 offset:12288
    v_mfma_f32_16x16x32_bf16 v[84:87], a[28:31], v[56:59], v[84:87]
    ds_read_b128 v[52:55], v13 offset:14336
    v_mfma_f32_16x16x32_bf16 v[88:91], a[24:27], v[60:63], v[88:91]
    v_mfma_f32_16x16x32_bf16 v[92:95], a[28:31], v[60:63], v[92:95]
    s_waitcnt lgkmcnt(4)
    v_mfma_f32_16x16x32_bf16 v[80:83], a[32:35], v[32:35], v[80:83]
    ds_read_b128 v[56:59], v15 offset:12288
    v_mfma_f32_16x16x32_bf16 v[84:87], a[36:39], v[32:35], v[84:87]
    ds_read_b128 v[60:63], v15 offset:14336
    v_mfma_f32_16x16x32_bf16 v[88:91], a[32:35], v[36:39], v[88:91]
    v_mfma_f32_16x16x32_bf16 v[92:95], a[36:39], v[36:39], v[92:95]
    s_waitcnt lgkmcnt(4)
    v_mfma_f32_16x16x32_bf16 v[80:83], a[40:43], v[40:43], v[80:83]
    ds_read_b128 v[32:35], v13 offset:16384
    v_mfma_f32_16x16x32_bf16 v[84:87], a[44:47], v[40:43], v[84:87]
    ds_read_b128 v[36:39], v13 offset:18432
    v_mfma_f32_16x16x32_bf16 v[88:91], a[40:43], v[44:47], v[88:91]
    v_mfma_f32_16x16x32_bf16 v[92:95], a[44:47], v[44:47], v[92:95]
    s_waitcnt lgkmcnt(4)
    v_mfma_f32_16x16x32_bf16 v[80:83], a[48:51], v[48:51], v[80:83]
    ds_read_b128 v[40:43], v15 offset:16384
    v_mfma_f32_16x16x32_bf16 v[84:87], a[52:55], v[48:51], v[84:87]
    ds_read_b128 v[44:47], v15 offset:18432
    v_mfma_f32_16x16x32_bf16 v[88:91], a[48:51], v[52:55], v[88:91]
    v_mfma_f32_16x16x32_bf16 v[92:95], a[52:55], v[52:55], v[92:95]
    s_waitcnt lgkmcnt(4)
    v_mfma_f32_16x16x32_bf16 v[80:83], a[56:59], v[56:59], v[80:83]
    ds_read_b128 v[48:51], v13 offset:20480
    v_mfma_f32_16x16x32_bf16 v[84:87], a[60:63], v[56:59], v[84:87]
    ds_read_b128 v[52:55], v13 offset:22528
    v_mfma_f32_16x16x32_bf16 v[88:91], a[56:59], v[60:63], v[88:91]
    v_mfma_f32_16x16x32_bf16 v[92:95], a[60:63], v[60:63], v[92:95]
    s_waitcnt lgkmcnt(4)
    v_mfma_f32_16x16x32_bf16 v[80:83], a[64:67], v[32:35], v[80:83]
    ds_read_b128 v[56:59], v15 offset:20480
    v_mfma_f32_16x16x32_bf16 v[84:87], a[68:71], v[32:35], v[84:87]
    ds_read_b128 v[60:63], v15 offset:22528
    v_mfma_f32_16x16x32_bf16 v[88:91], a[64:67], v[36:39], v[88:91]
    v_mfma_f32_16x16x32_bf16 v[92:95], a[68:71], v[36:39], v[92:95]
    s_waitcnt lgkmcnt(4)
    v_mfma_f32_16x16x32_bf16 v[80:83], a[72:75], v[40:43], v[80:83]
    ds_read_b128 v[32:35], v13 offset:24576
    v_mfma_f32_16x16x32_bf16 v[84:87], a[76:79], v[40:43], v[84:87]
    ds_read_b128 v[36:39], v13 offset:26624
    v_mfma_f32_16x16x32_bf16 v[88:91], a[72:75], v[44:47], v[88:91]
    v_mfma_f32_16x16x32_bf16 v[92:95], a[76:79], v[44:47], v[92:95]
    s_waitcnt lgkmcnt(4)
    v_mfma_f32_16x16x32_bf16 v[80:83], a[80:83], v[48:51], v[80:83]
    ds_read_b128 v[40:43], v15 offset:24576
    v_mfma_f32_16x16x32_bf16 v[84:87], a[84:87], v[48:51], v[84:87]
    ds_read_b128 v[44:47], v15 offset:26624
    v_mfma_f32_16x16x32_bf16 v[88:91], a[80:83], v[52:55], v[88:91]
    v_mfma_f32_16x16x32_bf16 v[92:95], a[84:87], v[52:55], v[92:95]
    s_waitcnt lgkmcnt(4)
    v_mfma_f32_16x16x32_bf16 v[80:83], a[88:91], v[56:59], v[80:83]
    ds_read_b128 v[48:51], v13 offset:28672
    v_mfma_f32_16x16x32_bf16 v[84:87], a[92:95], v[56:59], v[84:87]
    ds_read_b128 v[52:55], v13 offset:30720
    v_mfma_f32_16x16x32_bf16 v[88:91], a[88:91], v[60:63], v[88:91]
    v_mfma_f32_16x16x32_bf16 v[92:95], a[92:95], v[60:63], v[92:95]
    s_waitcnt lgkmcnt(4)
    v_mfma_f32_16x16x32_bf16 v[80:83], a[96:99], v[32:35], v[80:83]
    ds_read_b128 v[56:59], v15 offset:28672
    v_mfma_f32_16x16x32_bf16 v[84:87], a[100:103], v[32:35], v[84:87]
    ds_read_b128 v[60:63], v15 offset:30720
    v_mfma_f32_16x16x32_bf16 v[88:91], a[96:99], v[36:39], v[88:91]
    v_mfma_f32_16x16x32_bf16 v[92:95], a[100:103], v[36:39], v[92:95]
    s_waitcnt lgkmcnt(4)
    v_mfma_f32_16x16x32_bf16 v[80:83], a[104:107], v[40:43], v[80:83]
    v_mfma_f32_16x16x32_bf16 v[84:87], a[108:111], v[40:43], v[84:87]
    v_mfma_f32_16x16x32_bf16 v[88:91], a[104:107], v[44:47], v[88:91]
    v_mfma_f32_16x16x32_bf16 v[92:95], a[108:111], v[44:47], v[92:95]
    s_waitcnt vmcnt(0) lgkmcnt(0)
    s_barrier
    v_mfma_f32_16x16x32_bf16 v[80:83], a[112:115], v[48:51], v[80:83]
    ds_read_b128 v[32:35], v13 offset:32768
    v_mfma_f32_16x16x32_bf16 v[84:87], a[116:119], v[48:51], v[84:87]
    ds_read_b128 v[36:39], v13 offset:34816
    v_mfma_f32_16x16x32_bf16 v[88:91], a[112:115], v[52:55], v[88:91]
    v_mfma_f32_16x16x32_bf16 v[92:95], a[116:119], v[52:55], v[92:95]
    v_mfma_f32_16x16x32_bf16 v[80:83], a[120:123], v[56:59], v[80:83]
    ds_read_b128 v[40:43], v15 offset:32768
    v_mfma_f32_16x16x32_bf16 v[84:87], a[124:127], v[56:59], v[84:87]
    ds_read_b128 v[44:47], v15 offset:34816
    v_mfma_f32_16x16x32_bf16 v[88:91], a[120:123], v[60:63], v[88:91]
    v_mfma_f32_16x16x32_bf16 v[92:95], a[124:127], v[60:63], v[92:95]
    s_waitcnt lgkmcnt(2)
    v_mfma_f32_16x16x32_bf16 v[80:83], a[128:131], v[32:35], v[80:83]
    ds_read_b128 v[48:51], v13 offset:36864
    v_mfma_f32_16x16x32_bf16 v[84:87], a[132:135], v[32:35], v[84:87]
    ds_read_b128 v[52:55], v13 offset:38912
    v_mfma_f32_16x16x32_bf16 v[88:91], a[128:131], v[36:39], v[88:91]
    ds_read_b128 v[56:59], v15 offset:36864
    v_mfma_f32_16x16x32_bf16 v[92:95], a[132:135], v[36:39], v[92:95]
    ds_read_b128 v[60:63], v15 offset:38912
    s_waitcnt lgkmcnt(4)
    v_mfma_f32_16x16x32_bf16 v[80:83], a[136:139], v[40:43], v[80:83]
    ds_read_b128 v[32:35], v13 offset:40960
    v_mfma_f32_16x16x32_bf16 v[84:87], a[140:143], v[40:43], v[84:87]
    ds_read_b128 v[36:39], v13 offset:43008
    v_mfma_f32_16x16x32_bf16 v[88:91], a[136:139], v[44:47], v[88:91]
    v_mfma_f32_16x16x32_bf16 v[92:95], a[140:143], v[44:47], v[92:95]
    s_waitcnt lgkmcnt(4)
    v_mfma_f32_16x16x32_bf16 v[80:83], a[144:147], v[48:51], v[80:83]
    ds_read_b128 v[40:43], v15 offset:40960
    v_mfma_f32_16x16x32_bf16 v[84:87], a[148:151], v[48:51], v[84:87]
    ds_read_b128 v[44:47], v15 offset:43008
    v_mfma_f32_16x16x32_bf16 v[88:91], a[144:147], v[52:55], v[88:91]
    v_mfma_f32_16x16x32_bf16 v[92:95], a[148:151], v[52:55], v[92:95]
    s_waitcnt lgkmcnt(4)
    v_mfma_f32_16x16x32_bf16 v[80:83], a[152:155], v[56:59], v[80:83]
    ds_read_b128 v[48:51], v13 offset:45056
    v_mfma_f32_16x16x32_bf16 v[84:87], a[156:159], v[56:59], v[84:87]
    ds_read_b128 v[52:55], v13 offset:47104
    v_mfma_f32_16x16x32_bf16 v[88:91], a[152:155], v[60:63], v[88:91]
    v_mfma_f32_16x16x32_bf16 v[92:95], a[156:159], v[60:63], v[92:95]
    s_waitcnt lgkmcnt(4)
    v_mfma_f32_16x16x32_bf16 v[80:83], a[160:163], v[32:35], v[80:83]
    ds_read_b128 v[56:59], v15 offset:45056
    v_mfma_f32_16x16x32_bf16 v[84:87], a[164:167], v[32:35], v[84:87]
    ds_read_b128 v[60:63], v15 offset:47104
    v_mfma_f32_16x16x32_bf16 v[88:91], a[160:163], v[36:39], v[88:91]
    v_mfma_f32_16x16x32_bf16 v[92:95], a[164:167], v[36:39], v[92:95]
    s_waitcnt lgkmcnt(4)
    v_mfma_f32_16x16x32_bf16 v[80:83], a[168:171], v[40:43], v[80:83]
    ds_read_b128 v[32:35], v13 offset:49152
    v_mfma_f32_16x16x32_bf16 v[84:87], a[172:175], v[40:43], v[84:87]
    ds_read_b128 v[36:39], v13 offset:51200
    v_mfma_f32_16x16x32_bf16 v[88:91], a[168:171], v[44:47], v[88:91]
    v_mfma_f32_16x16x32_bf16 v[92:95], a[172:175], v[44:47], v[92:95]
    s_waitcnt lgkmcnt(4)
    v_mfma_f32_16x16x32_bf16 v[80:83], a[176:179], v[48:51], v[80:83]
    ds_read_b128 v[40:43], v15 offset:49152
    v_mfma_f32_16x16x32_bf16 v[84:87], a[180:183], v[48:51], v[84:87]
    ds_read_b128 v[44:47], v15 offset:51200
    v_mfma_f32_16x16x32_bf16 v[88:91], a[176:179], v[52:55], v[88:91]
    v_mfma_f32_16x16x32_bf16 v[92:95], a[180:183], v[52:55], v[92:95]
    s_waitcnt lgkmcnt(4)
    v_mfma_f32_16x16x32_bf16 v[80:83], a[184:187], v[56:59], v[80:83]
    ds_read_b128 v[48:51], v13 offset:53248
    v_mfma_f32_16x16x32_bf16 v[84:87], a[188:191], v[56:59], v[84:87]
    ds_read_b128 v[52:55], v13 offset:55296
    v_mfma_f32_16x16x32_bf16 v[88:91], a[184:187], v[60:63], v[88:91]
    v_mfma_f32_16x16x32_bf16 v[92:95], a[188:191], v[60:63], v[92:95]
    s_waitcnt lgkmcnt(4)
    v_mfma_f32_16x16x32_bf16 v[80:83], a[192:195], v[32:35], v[80:83]
    ds_read_b128 v[56:59], v15 offset:53248
    v_mfma_f32_16x16x32_bf16 v[84:87], a[196:199], v[32:35], v[84:87]
    ds_read_b128 v[60:63], v15 offset:55296
    v_mfma_f32_16x16x32_bf16 v[88:91], a[192:195], v[36:39], v[88:91]
    v_mfma_f32_16x16x32_bf16 v[92:95], a[196:199], v[36:39], v[92:95]
    s_waitcnt lgkmcnt(4)
    v_mfma_f32_16x16x32_bf16 v[80:83], a[200:203], v[40:43], v[80:83]
    ds_read_b128 v[32:35], v13 offset:57344
    v_mfma_f32_16x16x32_bf16 v[84:87], a[204:207], v[40:43], v[84:87]
    ds_read_b128 v[36:39], v13 offset:59392
    v_mfma_f32_16x16x32_bf16 v[88:91], a[200:203], v[44:47], v[88:91]
    v_mfma_f32_16x16x32_bf16 v[92:95], a[204:207], v[44:47], v[92:95]
    s_waitcnt lgkmcnt(4)
    v_mfma_f32_16x16x32_bf16 v[80:83], a[208:211], v[48:51], v[80:83]
    ds_read_b128 v[40:43], v15 offset:57344
    v_mfma_f32_16x16x32_bf16 v[84:87], a[212:215], v[48:51], v[84:87]
    ds_read_b128 v[44:47], v15 offset:59392
    v_mfma_f32_16x16x32_bf16 v[88:91], a[208:211], v[52:55], v[88:91]
    v_mfma_f32_16x16x32_bf16 v[92:95], a[212:215], v[52:55], v[92:95]
    s_waitcnt lgkmcnt(4)
    v_mfma_f32_16x16x32_bf16 v[80:83], a[216:219], v[56:59], v[80:83]
    ds_read_b128 v[48:51], v13 offset:61440
    v_mfma_f32_16x16x32_bf16 v[84:87], a[220:223], v[56:59], v[84:87]
    ds_read_b128 v[52:55], v13 offset:63488
    v_mfma_f32_16x16x32_bf16 v[88:91], a[216:219], v[60:63], v[88:91]
    v_mfma_f32_16x16x32_bf16 v[92:95], a[220:223], v[60:63], v[92:95]
    s_waitcnt lgkmcnt(4)
    v_mfma_f32_16x16x32_bf16 v[80:83], a[224:227], v[32:35], v[80:83]
    ds_read_b128 v[56:59], v15 offset:61440
    v_mfma_f32_16x16x32_bf16 v[84:87], a[228:231], v[32:35], v[84:87]
    ds_read_b128 v[60:63], v15 offset:63488
    v_mfma_f32_16x16x32_bf16 v[88:91], a[224:227], v[36:39], v[88:91]
    v_mfma_f32_16x16x32_bf16 v[92:95], a[228:231], v[36:39], v[92:95]
    s_waitcnt lgkmcnt(4)
    v_mfma_f32_16x16x32_bf16 v[80:83], a[232:235], v[40:43], v[80:83]
    v_mfma_f32_16x16x32_bf16 v[84:87], a[236:239], v[40:43], v[84:87]
    v_mfma_f32_16x16x32_bf16 v[88:91], a[232:235], v[44:47], v[88:91]
    v_mfma_f32_16x16x32_bf16 v[92:95], a[236:239], v[44:47], v[92:95]
    s_waitcnt lgkmcnt(0)
    v_mfma_f32_16x16x32_bf16 v[80:83], a[240:243], v[48:51], v[80:83]
    v_mfma_f32_16x16x32_bf16 v[84:87], a[244:247], v[48:51], v[84:87]
    v_mfma_f32_16x16x32_bf16 v[88:91], a[240:243], v[52:55], v[88:91]
    v_mfma_f32_16x16x32_bf16 v[92:95], a[244:247], v[52:55], v[92:95]
    v_mfma_f32_16x16x32_bf16 v[80:83], a[248:251], v[56:59], v[80:83]
    v_mfma_f32_16x16x32_bf16 v[84:87], a[252:255], v[56:59], v[84:87]
    v_mfma_f32_16x16x32_bf16 v[88:91], a[248:251], v[60:63], v[88:91]
    v_mfma_f32_16x16x32_bf16 v[92:95], a[252:255], v[60:63], v[92:95]
    s_mov_b32 s76, s57
    s_nop 6
    v_pk_add_f32 v[224:225], v[80:81], v[96:97]
    v_pk_add_f32 v[226:227], v[82:83], v[98:99]
    v_pk_add_f32 v[228:229], v[84:85], v[100:101]
    v_pk_add_f32 v[230:231], v[86:87], v[102:103]
    v_pk_add_f32 v[232:233], v[88:89], v[96:97]
    v_pk_add_f32 v[234:235], v[90:91], v[98:99]
    v_pk_add_f32 v[236:237], v[92:93], v[100:101]
    v_pk_add_f32 v[238:239], v[94:95], v[102:103]
L_e_fin_168:
    v_pk_mul_f32 v[240:241], v[224:225], v[224:225]
    v_pk_mul_f32 v[242:243], v[226:227], v[226:227]
    v_pk_mul_f32 v[244:245], v[228:229], v[228:229]
    v_pk_mul_f32 v[246:247], v[230:231], v[230:231]
    v_pk_mul_f32 v[248:249], v[232:233], v[232:233]
    v_pk_mul_f32 v[250:251], v[234:235], v[234:235]
    v_pk_mul_f32 v[252:253], v[236:237], v[236:237]
    v_pk_mul_f32 v[254:255], v[238:239], v[238:239]
    v_pk_fma_f32 v[240:241], v[240:241], v[104:105], v[106:107]
    v_pk_fma_f32 v[242:243], v[242:243], v[104:105], v[106:107]
    v_pk_fma_f32 v[244:245], v[244:245], v[104:105], v[106:107]
    v_pk_fma_f32 v[246:247], v[246:247], v[104:105], v[106:107]
    v_pk_fma_f32 v[248:249], v[248:249], v[104:105], v[106:107]
    v_pk_fma_f32 v[250:251], v[250:251], v[104:105], v[106:107]
    v_pk_fma_f32 v[252:253], v[252:253], v[104:105], v[106:107]
    v_pk_fma_f32 v[254:255], v[254:255], v[104:105], v[106:107]
    v_pk_mul_f32 v[240:241], v[240:241], v[224:225]
    v_pk_mul_f32 v[242:243], v[242:243], v[226:227]
    v_pk_mul_f32 v[244:245], v[244:245], v[228:229]
    v_pk_mul_f32 v[246:247], v[246:247], v[230:231]
    v_pk_mul_f32 v[248:249], v[248:249], v[232:233]
    v_pk_mul_f32 v[250:251], v[250:251], v[234:235]
    v_pk_mul_f32 v[252:253], v[252:253], v[236:237]
    v_pk_mul_f32 v[254:255], v[254:255], v[238:239]
    v_exp_f32 v240, v240
    v_exp_f32 v241, v241
    v_exp_f32 v242, v242
    v_exp_f32 v243, v243
    v_exp_f32 v244, v244
    v_exp_f32 v245, v245
    v_exp_f32 v246, v246
    v_exp_f32 v247, v247
    v_exp_f32 v248, v248
    v_exp_f32 v249, v249
    v_exp_f32 v250, v250
    v_exp_f32 v251, v251
    v_exp_f32 v252, v252
    v_exp_f32 v253, v253
    v_exp_f32 v254, v254
    v_exp_f32 v255, v255
    v_add_f32 v240, 1.0, v240
    v_add_f32 v241, 1.0, v241
    v_add_f32 v242, 1.0, v242
    v_add_f32 v243, 1.0, v243
    v_add_f32 v244, 1.0, v244
    v_add_f32 v245, 1.0, v245
    v_add_f32 v246, 1.0, v246
    v_add_f32 v247, 1.0, v247
    v_add_f32 v248, 1.0, v248
    v_add_f32 v249, 1.0, v249
    v_add_f32 v250, 1.0, v250
    v_add_f32 v251, 1.0, v251
    v_add_f32 v252, 1.0, v252
    v_add_f32 v253, 1.0, v253
    v_add_f32 v254, 1.0, v254
    v_add_f32 v255, 1.0, v255
    v_rcp_f32 v240, v240
    v_rcp_f32 v241, v241
    v_rcp_f32 v242, v242
    v_rcp_f32 v243, v243
    v_rcp_f32 v244, v244
    v_rcp_f32 v245, v245
    v_rcp_f32 v246, v246
    v_rcp_f32 v247, v247
    v_rcp_f32 v248, v248
    v_rcp_f32 v249, v249
    v_rcp_f32 v250, v250
    v_rcp_f32 v251, v251
    v_rcp_f32 v252, v252
    v_rcp_f32 v253, v253
    v_rcp_f32 v254, v254
    v_rcp_f32 v255, v255
    v_pk_mul_f32 v[224:225], v[224:225], v[240:241]
    v_pk_mul_f32 v[226:227], v[226:227], v[242:243]
    v_pk_mul_f32 v[228:229], v[228:229], v[244:245]
    v_pk_mul_f32 v[230:231], v[230:231], v[246:247]
    v_pk_mul_f32 v[232:233], v[232:233], v[248:249]
    v_pk_mul_f32 v[234:235], v[234:235], v[250:251]
    v_pk_mul_f32 v[236:237], v[236:237], v[252:253]
    v_pk_mul_f32 v[238:239], v[238:239], v[254:255]
    v_cvt_pk_bf16_f32 v240, v224, v225
    v_cvt_pk_bf16_f32 v241, v226, v227
    v_cvt_pk_bf16_f32 v242, v228, v229
    v_cvt_pk_bf16_f32 v243, v230, v231
    v_cvt_pk_bf16_f32 v244, v232, v233
    v_cvt_pk_bf16_f32 v245, v234, v235
    v_cvt_pk_bf16_f32 v246, v236, v237
    v_cvt_pk_bf16_f32 v247, v238, v239
    buffer_store_dwordx4 v[240:243], v10, s[12:15], s76 offen sc1
    buffer_store_dwordx4 v[244:247], v10, s[12:15], s76 offen offset:1024 sc1
    s_waitcnt lgkmcnt(0)
    s_mov_b32 s92, s62
    s_branch L_b_loop_151
L_role_c_127:
    s_load_dwordx2 s[6:7], s[0:1], 80
    s_load_dwordx2 s[8:9], s[0:1], 88
    s_load_dwordx2 s[10:11], s[0:1], 112
    s_waitcnt lgkmcnt(0)
    s_mov_b32 s24, s6
    s_and_b32 s25, s7, 0xffff
    s_mov_b32 s26, 0x700000
    s_mov_b32 s27, 0x00020000
    s_mov_b32 s28, s8
    s_and_b32 s29, s9, 0xffff
    s_mov_b32 s30, 0x800
    s_mov_b32 s31, 0x00020000
    s_mov_b32 s32, s10
    s_and_b32 s33, s11, 0xffff
    s_mov_b32 s34, 0x400000
    s_mov_b32 s35, 0x00020000
    s_mul_i32 s46, s38, 1835008
    s_lshl_b32 s45, s68, 8
    s_add_u32 s46, s46, s45
    s_waitcnt vmcnt(0)
    s_barrier
    v_lshrrev_b32 v20, 4, v1
    s_lshl_b32 s45, s44, 2
    v_add_u32 v21, s45, v20
    s_mov_b32 s45, 2048
    v_mul_lo_u32 v21, v21, s45
    v_lshlrev_b32 v22, 2, v20
    v_and_b32 v23, 15, v1
    v_xor_b32 v22, v22, v23
    v_lshlrev_b32 v22, 4, v22
    v_add_u32 v21, v21, v22
    v_bfe_u32 v22, v1, 2, 2
    v_lshlrev_b32 v23, 3, v20
    v_add_u32 v23, v23, v22
    v_lshlrev_b32 v23, 8, v23
    v_xor_b32 v22, s44, v22
    v_lshlrev_b32 v22, 6, v22
    v_add_u32 v23, v23, v22
    v_and_b32 v22, 3, v1
    v_lshlrev_b32 v22, 3, v22
    v_add_u32 v23, v23, v22
    v_add_u32 v24, 65536, v23
    v_add_u32 v25, 131072, v23
    s_lshl_b32 s47, s44, 10
    s_add_u32 s45, s46, 0x0
    s_add_u32 m0, s47, 0
    s_nop 0
    buffer_load_dwordx4 v21, s[24:27], s45 offen  lds
    s_add_u32 s45, s46, 0x8000
    s_add_u32 m0, s47, 4096
    s_nop 0
    buffer_load_dwordx4 v21, s[24:27], s45 offen  lds
    s_add_u32 s45, s46, 0x10000
    s_add_u32 m0, s47, 8192
    s_nop 0
    buffer_load_dwordx4 v21, s[24:27], s45 offen  lds
    s_add_u32 s45, s46, 0x18000
    s_add_u32 m0, s47, 12288
    s_nop 0
    buffer_load_dwordx4 v21, s[24:27], s45 offen  lds
    s_add_u32 s45, s46, 0x20000
    s_add_u32 m0, s47, 16384
    s_nop 0
    buffer_load_dwordx4 v21, s[24:27], s45 offen  lds
    s_add_u32 s45, s46, 0x28000
    s_add_u32 m0, s47, 20480
    s_nop 0
    buffer_load_dwordx4 v21, s[24:27], s45 offen  lds
    s_add_u32 s45, s46, 0x30000
    s_add_u32 m0, s47, 24576
    s_nop 0
    buffer_load_dwordx4 v21, s[24:27], s45 offen  lds
    s_add_u32 s45, s46, 0x38000
    s_add_u32 m0, s47, 28672
    s_nop 0
    buffer_load_dwordx4 v21, s[24:27], s45 offen  lds
    s_add_u32 s45, s46, 0x40000
    s_add_u32 m0, s47, 32768
    s_nop 0
    buffer_load_dwordx4 v21, s[24:27], s45 offen  lds
    s_add_u32 s45, s46, 0x48000
    s_add_u32 m0, s47, 36864
    s_nop 0
    buffer_load_dwordx4 v21, s[24:27], s45 offen  lds
    s_add_u32 s45, s46, 0x50000
    s_add_u32 m0, s47, 40960
    s_nop 0
    buffer_load_dwordx4 v21, s[24:27], s45 offen  lds
    s_add_u32 s45, s46, 0x58000
    s_add_u32 m0, s47, 45056
    s_nop 0
    buffer_load_dwordx4 v21, s[24:27], s45 offen  lds
    s_add_u32 s45, s46, 0x60000
    s_add_u32 m0, s47, 49152
    s_nop 0
    buffer_load_dwordx4 v21, s[24:27], s45 offen  lds
    s_add_u32 s45, s46, 0x68000
    s_add_u32 m0, s47, 53248
    s_nop 0
    buffer_load_dwordx4 v21, s[24:27], s45 offen  lds
    s_add_u32 s45, s46, 0x70000
    s_add_u32 m0, s47, 57344
    s_nop 0
    buffer_load_dwordx4 v21, s[24:27], s45 offen  lds
    s_add_u32 s45, s46, 0x78000
    s_add_u32 m0, s47, 61440
    s_nop 0
    buffer_load_dwordx4 v21, s[24:27], s45 offen  lds
    s_add_u32 s45, s46, 0x80000
    s_add_u32 m0, s47, 65536
    s_nop 0
    buffer_load_dwordx4 v21, s[24:27], s45 offen  lds
    s_add_u32 s45, s46, 0x88000
    s_add_u32 m0, s47, 69632
    s_nop 0
    buffer_load_dwordx4 v21, s[24:27], s45 offen  lds
    s_add_u32 s45, s46, 0x90000
    s_add_u32 m0, s47, 73728
    s_nop 0
    buffer_load_dwordx4 v21, s[24:27], s45 offen  lds
    s_add_u32 s45, s46, 0x98000
    s_add_u32 m0, s47, 77824
    s_nop 0
    buffer_load_dwordx4 v21, s[24:27], s45 offen  lds
    s_add_u32 s45, s46, 0xa0000
    s_add_u32 m0, s47, 81920
    s_nop 0
    buffer_load_dwordx4 v21, s[24:27], s45 offen  lds
    s_add_u32 s45, s46, 0xa8000
    s_add_u32 m0, s47, 86016
    s_nop 0
    buffer_load_dwordx4 v21, s[24:27], s45 offen  lds
    s_add_u32 s45, s46, 0xb0000
    s_add_u32 m0, s47, 90112
    s_nop 0
    buffer_load_dwordx4 v21, s[24:27], s45 offen  lds
    s_add_u32 s45, s46, 0xb8000
    s_add_u32 m0, s47, 94208
    s_nop 0
    buffer_load_dwordx4 v21, s[24:27], s45 offen  lds
    s_add_u32 s45, s46, 0xc0000
    s_add_u32 m0, s47, 98304
    s_nop 0
    buffer_load_dwordx4 v21, s[24:27], s45 offen  lds
    s_add_u32 s45, s46, 0xc8000
    s_add_u32 m0, s47, 102400
    s_nop 0
    buffer_load_dwordx4 v21, s[24:27], s45 offen  lds
    s_add_u32 s45, s46, 0xd0000
    s_add_u32 m0, s47, 106496
    s_nop 0
    buffer_load_dwordx4 v21, s[24:27], s45 offen  lds
    s_add_u32 s45, s46, 0xd8000
    s_add_u32 m0, s47, 110592
    s_nop 0
    buffer_load_dwordx4 v21, s[24:27], s45 offen  lds
    s_add_u32 s45, s46, 0xe0000
    s_add_u32 m0, s47, 114688
    s_nop 0
    buffer_load_dwordx4 v21, s[24:27], s45 offen  lds
    s_add_u32 s45, s46, 0xe8000
    s_add_u32 m0, s47, 118784
    s_nop 0
    buffer_load_dwordx4 v21, s[24:27], s45 offen  lds
    s_add_u32 s45, s46, 0xf0000
    s_add_u32 m0, s47, 122880
    s_nop 0
    buffer_load_dwordx4 v21, s[24:27], s45 offen  lds
    s_add_u32 s45, s46, 0xf8000
    s_add_u32 m0, s47, 126976
    s_nop 0
    buffer_load_dwordx4 v21, s[24:27], s45 offen  lds
    s_waitcnt vmcnt(28)
    s_barrier
    s_add_u32 s45, s46, 0x100000
    s_add_u32 m0, s47, 131072
    s_nop 0
    buffer_load_dwordx4 v21, s[24:27], s45 offen  lds
    s_add_u32 s45, s46, 0x108000
    s_add_u32 m0, s47, 135168
    s_nop 0
    buffer_load_dwordx4 v21, s[24:27], s45 offen  lds
    s_add_u32 s45, s46, 0x110000
    s_add_u32 m0, s47, 139264
    s_nop 0
    buffer_load_dwordx4 v21, s[24:27], s45 offen  lds
    s_add_u32 s45, s46, 0x118000
    s_add_u32 m0, s47, 143360
    s_nop 0
    buffer_load_dwordx4 v21, s[24:27], s45 offen  lds
    ds_read_b64_tr_b16 a[0:1], v23 offset:0
    ds_read_b64_tr_b16 a[2:3], v23 offset:1024
    ds_read_b64_tr_b16 a[4:5], v23 offset:32
    ds_read_b64_tr_b16 a[6:7], v23 offset:1056
    ds_read_b64_tr_b16 a[8:9], v23 offset:8192
    ds_read_b64_tr_b16 a[10:11], v23 offset:9216
    ds_read_b64_tr_b16 a[12:13], v23 offset:8224
    ds_read_b64_tr_b16 a[14:15], v23 offset:9248
    s_waitcnt lgkmcnt(0)
    s_waitcnt vmcnt(28)
    s_barrier
    s_add_u32 s45, s46, 0x120000
    s_add_u32 m0, s47, 0
    s_nop 0
    buffer_load_dwordx4 v21, s[24:27], s45 offen  lds
    s_add_u32 s45, s46, 0x128000
    s_add_u32 m0, s47, 4096
    s_nop 0
    buffer_load_dwordx4 v21, s[24:27], s45 offen  lds
    s_add_u32 s45, s46, 0x130000
    s_add_u32 m0, s47, 8192
    s_nop 0
    buffer_load_dwordx4 v21, s[24:27], s45 offen  lds
    s_add_u32 s45, s46, 0x138000
    s_add_u32 m0, s47, 12288
    s_nop 0
    buffer_load_dwordx4 v21, s[24:27], s45 offen  lds
    ds_read_b64_tr_b16 a[16:17], v23 offset:16384
    ds_read_b64_tr_b16 a[18:19], v23 offset:17408
    ds_read_b64_tr_b16 a[20:21], v23 offset:16416
    ds_read_b64_tr_b16 a[22:23], v23 offset:17440
    ds_read_b64_tr_b16 a[24:25], v23 offset:24576
    ds_read_b64_tr_b16 a[26:27], v23 offset:25600
    ds_read_b64_tr_b16 a[28:29], v23 offset:24608
    ds_read_b64_tr_b16 a[30:31], v23 offset:25632
    s_waitcnt lgkmcnt(0)
    s_waitcnt vmcnt(28)
    s_barrier
    s_add_u32 s45, s46, 0x140000
    s_add_u32 m0, s47, 16384
    s_nop 0
    buffer_load_dwordx4 v21, s[24:27], s45 offen  lds
    s_add_u32 s45, s46, 0x148000
    s_add_u32 m0, s47, 20480
    s_nop 0
    buffer_load_dwordx4 v21, s[24:27], s45 offen  lds
    s_add_u32 s45, s46, 0x150000
    s_add_u32 m0, s47, 24576
    s_nop 0
    buffer_load_dwordx4 v21, s[24:27], s45 offen  lds
    s_add_u32 s45, s46, 0x158000
    s_add_u32 m0, s47, 28672
    s_nop 0
    buffer_load_dwordx4 v21, s[24:27], s45 offen  lds
    ds_read_b64_tr_b16 a[32:33], v23 offset:32768
    ds_read_b64_tr_b16 a[34:35], v23 offset:33792
    ds_read_b64_tr_b16 a[36:37], v23 offset:32800
    ds_read_b64_tr_b16 a[38:39], v23 offset:33824
    ds_read_b64_tr_b16 a[40:41], v23 offset:40960
    ds_read_b64_tr_b16 a[42:43], v23 offset:41984
    ds_read_b64_tr_b16 a[44:45], v23 offset:40992
    ds_read_b64_tr_b16 a[46:47], v23 offset:42016
    s_waitcnt lgkmcnt(0)
    s_waitcnt vmcnt(28)
    s_barrier
    s_add_u32 s45, s46, 0x160000
    s_add_u32 m0, s47, 32768
    s_nop 0
    buffer_load_dwordx4 v21, s[24:27], s45 offen  lds
    s_add_u32 s45, s46, 0x168000
    s_add_u32 m0, s47, 36864
    s_nop 0
    buffer_load_dwordx4 v21, s[24:27], s45 offen  lds
    s_add_u32 s45, s46, 0x170000
    s_add_u32 m0, s47, 40960
    s_nop 0
    buffer_load_dwordx4 v21, s[24:27], s45 offen  lds
    s_add_u32 s45, s46, 0x178000
    s_add_u32 m0, s47, 45056
    s_nop 0
    buffer_load_dwordx4 v21, s[24:27], s45 offen  lds
    ds_read_b64_tr_b16 a[48:49], v23 offset:49152
    ds_read_b64_tr_b16 a[50:51], v23 offset:50176
    ds_read_b64_tr_b16 a[52:53], v23 offset:49184
    ds_read_b64_tr_b16 a[54:55], v23 offset:50208
    ds_read_b64_tr_b16 a[56:57], v23 offset:57344
    ds_read_b64_tr_b16 a[58:59], v23 offset:58368
    ds_read_b64_tr_b16 a[60:61], v23 offset:57376
    ds_read_b64_tr_b16 a[62:63], v23 offset:58400
    s_waitcnt lgkmcnt(0)
    s_waitcnt vmcnt(28)
    s_barrier
    s_add_u32 s45, s46, 0x180000
    s_add_u32 m0, s47, 49152
    s_nop 0
    buffer_load_dwordx4 v21, s[24:27], s45 offen  lds
    s_add_u32 s45, s46, 0x188000
    s_add_u32 m0, s47, 53248
    s_nop 0
    buffer_load_dwordx4 v21, s[24:27], s45 offen  lds
    s_add_u32 s45, s46, 0x190000
    s_add_u32 m0, s47, 57344
    s_nop 0
    buffer_load_dwordx4 v21, s[24:27], s45 offen  lds
    s_add_u32 s45, s46, 0x198000
    s_add_u32 m0, s47, 61440
    s_nop 0
    buffer_load_dwordx4 v21, s[24:27], s45 offen  lds
    ds_read_b64_tr_b16 a[64:65], v24 offset:0
    ds_read_b64_tr_b16 a[66:67], v24 offset:1024
    ds_read_b64_tr_b16 a[68:69], v24 offset:32
    ds_read_b64_tr_b16 a[70:71], v24 offset:1056
    ds_read_b64_tr_b16 a[72:73], v24 offset:8192
    ds_read_b64_tr_b16 a[74:75], v24 offset:9216
    ds_read_b64_tr_b16 a[76:77], v24 offset:8224
    ds_read_b64_tr_b16 a[78:79], v24 offset:9248
    s_waitcnt lgkmcnt(0)
    s_waitcnt vmcnt(28)
    s_barrier
    s_add_u32 s45, s46, 0x1a0000
    s_add_u32 m0, s47, 65536
    s_nop 0
    buffer_load_dwordx4 v21, s[24:27], s45 offen  lds
    s_add_u32 s45, s46, 0x1a8000
    s_add_u32 m0, s47, 69632
    s_nop 0
    buffer_load_dwordx4 v21, s[24:27], s45 offen  lds
    s_add_u32 s45, s46, 0x1b0000
    s_add_u32 m0, s47, 73728
    s_nop 0
    buffer_load_dwordx4 v21, s[24:27], s45 offen  lds
    s_add_u32 s45, s46, 0x1b8000
    s_add_u32 m0, s47, 77824
    s_nop 0
    buffer_load_dwordx4 v21, s[24:27], s45 offen  lds
    ds_read_b64_tr_b16 a[80:81], v24 offset:16384
    ds_read_b64_tr_b16 a[82:83], v24 offset:17408
    ds_read_b64_tr_b16 a[84:85], v24 offset:16416
    ds_read_b64_tr_b16 a[86:87], v24 offset:17440
    ds_read_b64_tr_b16 a[88:89], v24 offset:24576
    ds_read_b64_tr_b16 a[90:91], v24 offset:25600
    ds_read_b64_tr_b16 a[92:93], v24 offset:24608
    ds_read_b64_tr_b16 a[94:95], v24 offset:25632
    s_waitcnt lgkmcnt(0)
    s_waitcnt vmcnt(28)
    s_barrier
    ds_read_b64_tr_b16 a[96:97], v24 offset:32768
    ds_read_b64_tr_b16 a[98:99], v24 offset:33792
    ds_read_b64_tr_b16 a[100:101], v24 offset:32800
    ds_read_b64_tr_b16 a[102:103], v24 offset:33824
    ds_read_b64_tr_b16 a[104:105], v24 offset:40960
    ds_read_b64_tr_b16 a[106:107], v24 offset:41984
    ds_read_b64_tr_b16 a[108:109], v24 offset:40992
    ds_read_b64_tr_b16 a[110:111], v24 offset:42016
    s_waitcnt lgkmcnt(0)
    s_waitcnt vmcnt(24)
    s_barrier
    ds_read_b64_tr_b16 a[112:113], v24 offset:49152
    ds_read_b64_tr_b16 a[114:115], v24 offset:50176
    ds_read_b64_tr_b16 a[116:117], v24 offset:49184
    ds_read_b64_tr_b16 a[118:119], v24 offset:50208
    ds_read_b64_tr_b16 a[120:121], v24 offset:57344
    ds_read_b64_tr_b16 a[122:123], v24 offset:58368
    ds_read_b64_tr_b16 a[124:125], v24 offset:57376
    ds_read_b64_tr_b16 a[126:127], v24 offset:58400
    s_waitcnt lgkmcnt(0)
    s_waitcnt vmcnt(20)
    s_barrier
    ds_read_b64_tr_b16 a[128:129], v25 offset:0
    ds_read_b64_tr_b16 a[130:131], v25 offset:1024
    ds_read_b64_tr_b16 a[132:133], v25 offset:32
    ds_read_b64_tr_b16 a[134:135], v25 offset:1056
    ds_read_b64_tr_b16 a[136:137], v25 offset:8192
    ds_read_b64_tr_b16 a[138:139], v25 offset:9216
    ds_read_b64_tr_b16 a[140:141], v25 offset:8224
    ds_read_b64_tr_b16 a[142:143], v25 offset:9248
    s_waitcnt lgkmcnt(0)
    s_waitcnt vmcnt(16)
    s_barrier
    ds_read_b64_tr_b16 a[144:145], v23 offset:0
    ds_read_b64_tr_b16 a[146:147], v23 offset:1024
    ds_read_b64_tr_b16 a[148:149], v23 offset:32
    ds_read_b64_tr_b16 a[150:151], v23 offset:1056
    ds_read_b64_tr_b16 a[152:153], v23 offset:8192
    ds_read_b64_tr_b16 a[154:155], v23 offset:9216
    ds_read_b64_tr_b16 a[156:157], v23 offset:8224
    ds_read_b64_tr_b16 a[158:159], v23 offset:9248
    s_waitcnt lgkmcnt(0)
    s_waitcnt vmcnt(12)
    s_barrier
    ds_read_b64_tr_b16 a[160:161], v23 offset:16384
    ds_read_b64_tr_b16 a[162:163], v23 offset:17408
    ds_read_b64_tr_b16 a[164:165], v23 offset:16416
    ds_read_b64_tr_b16 a[166:167], v23 offset:17440
    ds_read_b64_tr_b16 a[168:169], v23 offset:24576
    ds_read_b64_tr_b16 a[170:171], v23 offset:25600
    ds_read_b64_tr_b16 a[172:173], v23 offset:24608
    ds_read_b64_tr_b16 a[174:175], v23 offset:25632
    s_waitcnt lgkmcnt(0)
    s_waitcnt vmcnt(8)
    s_barrier
    ds_read_b64_tr_b16 a[176:177], v23 offset:32768
    ds_read_b64_tr_b16 a[178:179], v23 offset:33792
    ds_read_b64_tr_b16 a[180:181], v23 offset:32800
    ds_read_b64_tr_b16 a[182:183], v23 offset:33824
    ds_read_b64_tr_b16 a[184:185], v23 offset:40960
    ds_read_b64_tr_b16 a[186:187], v23 offset:41984
    ds_read_b64_tr_b16 a[188:189], v23 offset:40992
    ds_read_b64_tr_b16 a[190:191], v23 offset:42016
    s_waitcnt lgkmcnt(0)
    s_waitcnt vmcnt(4)
    s_barrier
    ds_read_b64_tr_b16 a[192:193], v23 offset:49152
    ds_read_b64_tr_b16 a[194:195], v23 offset:50176
    ds_read_b64_tr_b16 a[196:197], v23 offset:49184
    ds_read_b64_tr_b16 a[198:199], v23 offset:50208
    ds_read_b64_tr_b16 a[200:201], v23 offset:57344
    ds_read_b64_tr_b16 a[202:203], v23 offset:58368
    ds_read_b64_tr_b16 a[204:205], v23 offset:57376
    ds_read_b64_tr_b16 a[206:207], v23 offset:58400
    s_waitcnt lgkmcnt(0)
    s_waitcnt vmcnt(0)
    s_barrier
    ds_read_b64_tr_b16 a[208:209], v24 offset:0
    ds_read_b64_tr_b16 a[210:211], v24 offset:1024
    ds_read_b64_tr_b16 a[212:213], v24 offset:32
    ds_read_b64_tr_b16 a[214:215], v24 offset:1056
    ds_read_b64_tr_b16 a[216:217], v24 offset:8192
    ds_read_b64_tr_b16 a[218:219], v24 offset:9216
    ds_read_b64_tr_b16 a[220:221], v24 offset:8224
    ds_read_b64_tr_b16 a[222:223], v24 offset:9248
    s_waitcnt lgkmcnt(0)
    s_barrier
    buffer_load_dwordx4 v[80:83], v10, s[28:31], 0 offen
    buffer_load_dwordx4 v[84:87], v10, s[28:31], 0 offen offset:1024
    s_waitcnt vmcnt(0)
    v_lshlrev_b32 v96, 16, v80
    v_and_b32 v97, 0xffff0000, v80
    v_lshlrev_b32 v98, 16, v81
    v_and_b32 v99, 0xffff0000, v81
    v_lshlrev_b32 v100, 16, v82
    v_and_b32 v101, 0xffff0000, v82
    v_lshlrev_b32 v102, 16, v83
    v_and_b32 v103, 0xffff0000, v83
    v_lshlrev_b32 v104, 16, v84
    v_and_b32 v105, 0xffff0000, v84
    v_lshlrev_b32 v106, 16, v85
    v_and_b32 v107, 0xffff0000, v85
    v_lshlrev_b32 v108, 16, v86
    v_and_b32 v109, 0xffff0000, v86
    v_lshlrev_b32 v110, 16, v87
    v_and_b32 v111, 0xffff0000, v87
    s_cmp_lg_u32 s44, 0
    s_cbranch_scc1 L_pd_169
    v_mov_b32 v29, 127232
    s_mov_b32 s46, 96
    s_mov_b64 exec, 1
    s_mov_b32 s70, 0
L_wp_170:
    buffer_load_dword v31, v29, s[12:15], 0 offen sc1
    s_add_u32 s70, s70, 1
    s_cmp_ge_u32 s70, 0x200000
    s_cbranch_scc1 L_w_done_98
L_wp_170_c:
    s_waitcnt vmcnt(0)
    v_cmp_gt_u32 vcc, s46, v31
    s_nop 1
    s_cbranch_vccz L_wp_170_ok
    s_sleep 3
    s_branch L_wp_170
L_wp_170_ok:
    s_mov_b64 exec, -1
L_pd_169:
    s_barrier
    v_lshlrev_b32 v29, 5, v1
    s_mov_b32 s45, 20480
    buffer_load_dwordx4 v[112:115], v29, s[12:15], s45 offen offset:0 sc1
    buffer_load_dwordx4 v[116:119], v29, s[12:15], s45 offen offset:16 sc1
    buffer_load_dwordx4 v[120:123], v29, s[12:15], s45 offen offset:2048 sc1
    buffer_load_dwordx4 v[124:127], v29, s[12:15], s45 offen offset:2064 sc1
    s_mov_b32 s45, 45056
    buffer_load_dwordx4 v[32:35], v29, s[12:15], s45 offen offset:0 sc1
    buffer_load_dwordx4 v[36:39], v29, s[12:15], s45 offen offset:16 sc1
    buffer_load_dwordx4 v[40:43], v29, s[12:15], s45 offen offset:2048 sc1
    buffer_load_dwordx4 v[44:47], v29, s[12:15], s45 offen offset:2064 sc1
    s_waitcnt vmcnt(0)
    v_add_f32 v112, v112, v32
    v_cvt_pk_bf16_f32 v112, v112, v112
    v_lshlrev_b32 v112, 16, v112
    v_add_f32 v113, v113, v33
    v_cvt_pk_bf16_f32 v113, v113, v113
    v_lshlrev_b32 v113, 16, v113
    v_add_f32 v114, v114, v34
    v_cvt_pk_bf16_f32 v114, v114, v114
    v_lshlrev_b32 v114, 16, v114
    v_add_f32 v115, v115, v35
    v_cvt_pk_bf16_f32 v115, v115, v115
    v_lshlrev_b32 v115, 16, v115
    v_add_f32 v116, v116, v36
    v_cvt_pk_bf16_f32 v116, v116, v116
    v_lshlrev_b32 v116, 16, v116
    v_add_f32 v117, v117, v37
    v_cvt_pk_bf16_f32 v117, v117, v117
    v_lshlrev_b32 v117, 16, v117
    v_add_f32 v118, v118, v38
    v_cvt_pk_bf16_f32 v118, v118, v118
    v_lshlrev_b32 v118, 16, v118
    v_add_f32 v119, v119, v39
    v_cvt_pk_bf16_f32 v119, v119, v119
    v_lshlrev_b32 v119, 16, v119
    v_add_f32 v120, v120, v40
    v_cvt_pk_bf16_f32 v120, v120, v120
    v_lshlrev_b32 v120, 16, v120
    v_add_f32 v121, v121, v41
    v_cvt_pk_bf16_f32 v121, v121, v121
    v_lshlrev_b32 v121, 16, v121
    v_add_f32 v122, v122, v42
    v_cvt_pk_bf16_f32 v122, v122, v122
    v_lshlrev_b32 v122, 16, v122
    v_add_f32 v123, v123, v43
    v_cvt_pk_bf16_f32 v123, v123, v123
    v_lshlrev_b32 v123, 16, v123
    v_add_f32 v124, v124, v44
    v_cvt_pk_bf16_f32 v124, v124, v124
    v_lshlrev_b32 v124, 16, v124
    v_add_f32 v125, v125, v45
    v_cvt_pk_bf16_f32 v125, v125, v125
    v_lshlrev_b32 v125, 16, v125
    v_add_f32 v126, v126, v46
    v_cvt_pk_bf16_f32 v126, v126, v126
    v_lshlrev_b32 v126, 16, v126
    v_add_f32 v127, v127, v47
    v_cvt_pk_bf16_f32 v127, v127, v127
    v_lshlrev_b32 v127, 16, v127
    s_lshl_b32 s46, s44, 10
    s_add_u32 s45, s46, 20480
    buffer_load_dwordx4 v[22:25], v10, s[12:15], s45 offen sc1
    s_add_u32 s45, s46, 45056
    buffer_load_dwordx4 v[32:35], v10, s[12:15], s45 offen sc1
    s_waitcnt vmcnt(0)
    v_add_f32 v22, v22, v32
    v_cvt_pk_bf16_f32 v22, v22, v22
    v_lshlrev_b32 v22, 16, v22
    v_add_f32 v23, v23, v33
    v_cvt_pk_bf16_f32 v23, v23, v23
    v_lshlrev_b32 v23, 16, v23
    v_add_f32 v24, v24, v34
    v_cvt_pk_bf16_f32 v24, v24, v24
    v_lshlrev_b32 v24, 16, v24
    v_add_f32 v25, v25, v35
    v_cvt_pk_bf16_f32 v25, v25, v25
    v_lshlrev_b32 v25, 16, v25
    v_lshlrev_b32 v17, 3, v1
    s_lshl_b32 s45, s44, 9
    buffer_load_dwordx2 v[80:81], v17, s[28:31], s45 offen
    s_waitcnt vmcnt(0)
    v_lshlrev_b32 v18, 16, v80
    v_and_b32 v19, 0xffff0000, v80
    v_lshlrev_b32 v20, 16, v81
    v_and_b32 v21, 0xffff0000, v81
    s_mul_i32 s52, s38, 57344
    s_add_u32 s52, s52, 0x6000000
    s_lshl_b32 s56, s38, 23
    s_lshl_b32 s45, s68, 9
    s_add_u32 s56, s56, s45
    s_add_u32 s56, s56, 0xc000000
    s_lshl_b32 s45, s40, 7
    s_add_u32 s45, s45, 127488
    v_mov_b32 v29, s45
    s_mov_b32 s46, 536870912
    s_mov_b64 exec, 1
    s_mov_b32 s70, 0
L_wp_173:
    buffer_load_dword v31, v29, s[12:15], 0 offen sc1
    s_add_u32 s70, s70, 1
    s_cmp_ge_u32 s70, 0x200000
    s_cbranch_scc1 L_w_done_98
L_wp_173_c:
    s_waitcnt vmcnt(0)
    v_cmp_gt_u32 vcc, s46, v31
    s_nop 1
    s_cbranch_vccz L_wp_173_ok
    s_sleep 2
    s_branch L_wp_173
L_wp_173_ok:
    s_mov_b64 exec, -1
    v_readfirstlane_b32 s45, v31
    s_nop 3
    s_and_b32 s46, s45, 511
    s_mul_i32 s46, s46, s46
    s_bfe_u32 s45, s45, 0xf0009
    s_lshl_b32 s45, s45, 5
    s_mov_b32 s80, s12
    s_mov_b32 s81, s13
    s_mov_b32 s83, 0x00020000
    s_mov_b32 s84, s12
    s_mov_b32 s85, s13
    s_mov_b32 s87, 0x00020000
    s_cmp_eq_u32 s45, s46
    s_cselect_b32 s82, s14, 0
    s_cselect_b32 s86, 0, s14
L_c_loop_171:
    s_cmp_eq_u64 s[36:37], 0
    s_cbranch_scc1 L_w_done_98
    s_ff1_i32_b64 s50, s[36:37]
    s_bitset0_b64 s[36:37], s50
    s_lshr_b64 s[74:75], s[72:73], s50
    s_ff1_i32_b64 s51, s[74:75]
    s_add_u32 s51, s51, 1
    s_add_u32 s62, s50, s51
    s_mul_i32 s45, s38, 896
    s_add_u32 s45, s45, s64
    s_add_u32 s45, s45, 12288
    s_cmp_lg_u32 s44, 1
    s_cbranch_scc1 L_pw_174
    s_mov_b64 exec, 127
    s_mov_b32 s70, 0
L_wp_175:
    buffer_load_dword v31, v5, s[12:15], s45 offen sc1
    s_add_u32 s70, s70, 1
    s_cmp_ge_u32 s70, 0x200000
    s_cbranch_scc1 L_w_done_98
L_wp_175_c:
    s_waitcnt vmcnt(0)
    v_cmp_gt_u32 vcc, s62, v31
    s_nop 1
    s_cbranch_vccz L_wp_175_ok
    s_sleep 2
    s_branch L_wp_175
L_wp_175_ok:
    s_mov_b64 exec, -1
L_pw_174:
    s_barrier
    s_mul_i32 s53, s50, 229376
    s_add_u32 s53, s53, s52
    s_lshl_b32 s54, s44, 13
    s_add_u32 s53, s53, s54
    s_mul_i32 s57, s50, 131072
    s_add_u32 s57, s57, s56
    s_lshl_b32 s45, s44, 7
    s_add_u32 s57, s57, s45
    s_add_u32 s55, s54, 65536
    s_mov_b32 s58, 0
    v_mov_b32 v13, v10
    v_add_u32 v14, 65536, v13
    v_xor_b32 v15, 64, v13
    v_xor_b32 v16, 64, v14
    s_mov_b32 s76, 0x20000000
    s_add_u32 s48, s53, 0
    s_add_u32 s49, s48, 4096
    s_add_u32 m0, s54, 0
    s_nop 0
    buffer_load_dwordx4 v10, s[12:15], s48 offen offset:0 sc1 lds
    buffer_load_dwordx4 v10, s[12:15], s48 offen offset:1024 sc1 lds
    buffer_load_dwordx4 v10, s[12:15], s48 offen offset:2048 sc1 lds
    buffer_load_dwordx4 v10, s[12:15], s48 offen offset:3072 sc1 lds
    s_add_u32 m0, s54, 4096
    s_nop 0
    buffer_load_dwordx4 v10, s[12:15], s49 offen offset:0 sc1 lds
    buffer_load_dwordx4 v10, s[12:15], s49 offen offset:1024 sc1 lds
    buffer_load_dwordx4 v10, s[12:15], s49 offen offset:2048 sc1 lds
    buffer_load_dwordx4 v10, s[12:15], s49 offen offset:3072 sc1 lds
    s_add_u32 s48, s53, 32768
    s_cmp_lt_u32 s44, 3
    s_cselect_b32 s48, s48, 0x20000000
    s_add_u32 s49, s48, 4096
    s_add_u32 s46, s54, 32768
    s_add_u32 m0, s46, 0
    s_nop 0
    buffer_load_dwordx4 v10, s[12:15], s48 offen offset:0 sc1 lds
    buffer_load_dwordx4 v10, s[12:15], s48 offen offset:1024 sc1 lds
    buffer_load_dwordx4 v10, s[12:15], s48 offen offset:2048 sc1 lds
    buffer_load_dwordx4 v10, s[12:15], s48 offen offset:3072 sc1 lds
    s_add_u32 m0, s46, 4096
    s_nop 0
    buffer_load_dwordx4 v10, s[12:15], s49 offen offset:0 sc1 lds
    buffer_load_dwordx4 v10, s[12:15], s49 offen offset:1024 sc1 lds
    buffer_load_dwordx4 v10, s[12:15], s49 offen offset:2048 sc1 lds
    buffer_load_dwordx4 v10, s[12:15], s49 offen offset:3072 sc1 lds
    s_cmp_eq_u32 s51, 1
    s_cbranch_scc1 L_e_one_177
    s_add_u32 s48, s53, 229376
    s_add_u32 s49, s48, 4096
    s_add_u32 m0, s55, 0
    s_nop 0
    buffer_load_dwordx4 v10, s[12:15], s48 offen offset:0 sc1 lds
    buffer_load_dwordx4 v10, s[12:15], s48 offen offset:1024 sc1 lds
    buffer_load_dwordx4 v10, s[12:15], s48 offen offset:2048 sc1 lds
    buffer_load_dwordx4 v10, s[12:15], s48 offen offset:3072 sc1 lds
    s_add_u32 m0, s55, 4096
    s_nop 0
    buffer_load_dwordx4 v10, s[12:15], s49 offen offset:0 sc1 lds
    buffer_load_dwordx4 v10, s[12:15], s49 offen offset:1024 sc1 lds
    buffer_load_dwordx4 v10, s[12:15], s49 offen offset:2048 sc1 lds
    buffer_load_dwordx4 v10, s[12:15], s49 offen offset:3072 sc1 lds
    s_waitcnt vmcnt(16)
    s_barrier
    ds_read_b128 v[32:35], v13 offset:0
    ds_read_b128 v[36:39], v13 offset:1024
    ds_read_b128 v[40:43], v13 offset:2048
    ds_read_b128 v[44:47], v13 offset:3072
    s_add_u32 s48, s53, 262144
    s_add_u32 s46, s58, 1
    s_cmp_lt_u32 s46, s51
    s_cselect_b32 s48, s48, 0x20000000
    s_cmp_lt_u32 s44, 3
    s_cselect_b32 s48, s48, 0x20000000
    s_add_u32 s49, s48, 4096
    s_add_u32 s59, s55, 32768
L_e_loop_176:
    s_waitcnt lgkmcnt(2)
    v_mfma_f32_16x16x32_bf16 v[80:83], a[0:3], v[32:35], 0
    ds_read_b128 v[48:51], v13 offset:4096
    v_mfma_f32_16x16x32_bf16 v[84:87], a[4:7], v[32:35], 0
    ds_read_b128 v[52:55], v13 offset:5120
    v_mfma_f32_16x16x32_bf16 v[88:91], a[0:3], v[36:39], 0
    ds_read_b128 v[56:59], v13 offset:6144
    s_add_u32 m0, s59, 0
    v_mfma_f32_16x16x32_bf16 v[92:95], a[4:7], v[36:39], 0
    ds_read_b128 v[60:63], v13 offset:7168
    buffer_load_dwordx4 v10, s[12:15], s48 offen offset:0 sc1 lds
    s_waitcnt lgkmcnt(4)
    v_mfma_f32_16x16x32_bf16 v[80:83], a[8:11], v[40:43], v[80:83]
    ds_read_b128 v[32:35], v13 offset:8192
    v_mfma_f32_16x16x32_bf16 v[84:87], a[12:15], v[40:43], v[84:87]
    ds_read_b128 v[36:39], v13 offset:9216
    v_mfma_f32_16x16x32_bf16 v[88:91], a[8:11], v[44:47], v[88:91]
    v_mfma_f32_16x16x32_bf16 v[92:95], a[12:15], v[44:47], v[92:95]
    buffer_load_dwordx4 v10, s[12:15], s48 offen offset:1024 sc1 lds
    s_waitcnt lgkmcnt(4)
    v_mfma_f32_16x16x32_bf16 v[80:83], a[16:19], v[48:51], v[80:83]
    ds_read_b128 v[40:43], v13 offset:10240
    v_mfma_f32_16x16x32_bf16 v[84:87], a[20:23], v[48:51], v[84:87]
    ds_read_b128 v[44:47], v13 offset:11264
    v_mfma_f32_16x16x32_bf16 v[88:91], a[16:19], v[52:55], v[88:91]
    v_mfma_f32_16x16x32_bf16 v[92:95], a[20:23], v[52:55], v[92:95]
    buffer_load_dwordx4 v10, s[12:15], s48 offen offset:2048 sc1 lds
    s_waitcnt lgkmcnt(4)
    v_mfma_f32_16x16x32_bf16 v[80:83], a[24:27], v[56:59], v[80:83]
    ds_read_b128 v[48:51], v13 offset:12288
    v_mfma_f32_16x16x32_bf16 v[84:87], a[28:31], v[56:59], v[84:87]
    ds_read_b128 v[52:55], v13 offset:13312
    v_mfma_f32_16x16x32_bf16 v[88:91], a[24:27], v[60:63], v[88:91]
    v_mfma_f32_16x16x32_bf16 v[92:95], a[28:31], v[60:63], v[92:95]
    buffer_load_dwordx4 v10, s[12:15], s48 offen offset:3072 sc1 lds
    s_waitcnt lgkmcnt(4)
    v_mfma_f32_16x16x32_bf16 v[80:83], a[32:35], v[32:35], v[80:83]
    ds_read_b128 v[56:59], v13 offset:14336
    v_mfma_f32_16x16x32_bf16 v[84:87], a[36:39], v[32:35], v[84:87]
    ds_read_b128 v[60:63], v13 offset:15360
    v_mfma_f32_16x16x32_bf16 v[88:91], a[32:35], v[36:39], v[88:91]
    s_add_u32 m0, s59, 4096
    v_mfma_f32_16x16x32_bf16 v[92:95], a[36:39], v[36:39], v[92:95]
    buffer_load_dwordx4 v10, s[12:15], s49 offen offset:0 sc1 lds
    s_waitcnt lgkmcnt(4)
    v_mfma_f32_16x16x32_bf16 v[80:83], a[40:43], v[40:43], v[80:83]
    ds_read_b128 v[32:35], v13 offset:16384
    v_mfma_f32_16x16x32_bf16 v[84:87], a[44:47], v[40:43], v[84:87]
    ds_read_b128 v[36:39], v13 offset:17408
    v_mfma_f32_16x16x32_bf16 v[88:91], a[40:43], v[44:47], v[88:91]
    v_mfma_f32_16x16x32_bf16 v[92:95], a[44:47], v[44:47], v[92:95]
    buffer_load_dwordx4 v10, s[12:15], s49 offen offset:1024 sc1 lds
    s_waitcnt lgkmcnt(4)
    v_mfma_f32_16x16x32_bf16 v[80:83], a[48:51], v[48:51], v[80:83]
    ds_read_b128 v[40:43], v13 offset:18432
    v_mfma_f32_16x16x32_bf16 v[84:87], a[52:55], v[48:51], v[84:87]
    ds_read_b128 v[44:47], v13 offset:19456
    v_mfma_f32_16x16x32_bf16 v[88:91], a[48:51], v[52:55], v[88:91]
    v_mfma_f32_16x16x32_bf16 v[92:95], a[52:55], v[52:55], v[92:95]
    buffer_load_dwordx4 v10, s[12:15], s49 offen offset:2048 sc1 lds
    s_waitcnt lgkmcnt(4)
    v_mfma_f32_16x16x32_bf16 v[80:83], a[56:59], v[56:59], v[80:83]
    ds_read_b128 v[48:51], v13 offset:20480
    v_mfma_f32_16x16x32_bf16 v[84:87], a[60:63], v[56:59], v[84:87]
    ds_read_b128 v[52:55], v13 offset:21504
    v_mfma_f32_16x16x32_bf16 v[88:91], a[56:59], v[60:63], v[88:91]
    v_mfma_f32_16x16x32_bf16 v[92:95], a[60:63], v[60:63], v[92:95]
    buffer_load_dwordx4 v10, s[12:15], s49 offen offset:3072 sc1 lds
    s_waitcnt lgkmcnt(4)
    v_mfma_f32_16x16x32_bf16 v[80:83], a[64:67], v[32:35], v[80:83]
    ds_read_b128 v[56:59], v13 offset:22528
    v_mfma_f32_16x16x32_bf16 v[84:87], a[68:71], v[32:35], v[84:87]
    ds_read_b128 v[60:63], v13 offset:23552
    v_mfma_f32_16x16x32_bf16 v[88:91], a[64:67], v[36:39], v[88:91]
    s_add_u32 s48, s53, 458752
    v_mfma_f32_16x16x32_bf16 v[92:95], a[68:71], v[36:39], v[92:95]
    s_add_u32 s46, s58, 2
    s_waitcnt lgkmcnt(4)
    v_mfma_f32_16x16x32_bf16 v[80:83], a[72:75], v[40:43], v[80:83]
    ds_read_b128 v[32:35], v13 offset:24576
    v_mfma_f32_16x16x32_bf16 v[84:87], a[76:79], v[40:43], v[84:87]
    ds_read_b128 v[36:39], v13 offset:25600
    v_mfma_f32_16x16x32_bf16 v[88:91], a[72:75], v[44:47], v[88:91]
    s_cmp_lt_u32 s46, s51
    s_cselect_b32 s48, s48, 0x20000000
    v_mfma_f32_16x16x32_bf16 v[92:95], a[76:79], v[44:47], v[92:95]
    s_add_u32 s49, s48, 4096
    s_waitcnt lgkmcnt(4)
    v_mfma_f32_16x16x32_bf16 v[80:83], a[80:83], v[48:51], v[80:83]
    ds_read_b128 v[40:43], v13 offset:26624
    v_mfma_f32_16x16x32_bf16 v[84:87], a[84:87], v[48:51], v[84:87]
    ds_read_b128 v[44:47], v13 offset:27648
    v_mfma_f32_16x16x32_bf16 v[88:91], a[80:83], v[52:55], v[88:91]
    s_mov_b32 s59, s54
    v_mfma_f32_16x16x32_bf16 v[92:95], a[84:87], v[52:55], v[92:95]
    s_waitcnt lgkmcnt(4)
    v_mfma_f32_16x16x32_bf16 v[80:83], a[88:91], v[56:59], v[80:83]
    ds_read_b128 v[48:51], v13 offset:28672
    v_mfma_f32_16x16x32_bf16 v[84:87], a[92:95], v[56:59], v[84:87]
    ds_read_b128 v[52:55], v13 offset:29696
    v_mfma_f32_16x16x32_bf16 v[88:91], a[88:91], v[60:63], v[88:91]
    v_mfma_f32_16x16x32_bf16 v[92:95], a[92:95], v[60:63], v[92:95]
    s_waitcnt lgkmcnt(4)
    v_mfma_f32_16x16x32_bf16 v[80:83], a[96:99], v[32:35], v[80:83]
    ds_read_b128 v[56:59], v13 offset:30720
    v_mfma_f32_16x16x32_bf16 v[84:87], a[100:103], v[32:35], v[84:87]
    ds_read_b128 v[60:63], v13 offset:31744
    v_mfma_f32_16x16x32_bf16 v[88:91], a[96:99], v[36:39], v[88:91]
    v_mfma_f32_16x16x32_bf16 v[92:95], a[100:103], v[36:39], v[92:95]
    s_waitcnt lgkmcnt(4)
    v_mfma_f32_16x16x32_bf16 v[80:83], a[104:107], v[40:43], v[80:83]
    ds_read_b128 v[216:219], v8 offset:0
    v_mfma_f32_16x16x32_bf16 v[84:87], a[108:111], v[40:43], v[84:87]
    ds_read_b128 v[220:223], v8 offset:1152
    v_mfma_f32_16x16x32_bf16 v[88:91], a[104:107], v[44:47], v[88:91]
    ds_read_b128 v[224:227], v8 offset:2304
    v_mfma_f32_16x16x32_bf16 v[92:95], a[108:111], v[44:47], v[92:95]
    ds_read_b128 v[228:231], v8 offset:3456
    s_waitcnt vmcnt(16) lgkmcnt(0)
    s_barrier
    v_mfma_f32_16x16x32_bf16 v[80:83], a[112:115], v[48:51], v[80:83]
    ds_read_b128 v[32:35], v13 offset:32768
    buffer_store_dwordx4 v[216:219], v11, s[12:15], s76 offen sc1
    v_mfma_f32_16x16x32_bf16 v[84:87], a[116:119], v[48:51], v[84:87]
    ds_read_b128 v[36:39], v13 offset:33792
    s_add_u32 s76, s76, 32768
    v_mfma_f32_16x16x32_bf16 v[88:91], a[112:115], v[52:55], v[88:91]
    buffer_store_dwordx4 v[220:223], v11, s[12:15], s76 offen sc1
    s_add_u32 s76, s76, 32768
    v_mfma_f32_16x16x32_bf16 v[92:95], a[116:119], v[52:55], v[92:95]
    buffer_store_dwordx4 v[224:227], v11, s[12:15], s76 offen sc1
    v_mfma_f32_16x16x32_bf16 v[80:83], a[120:123], v[56:59], v[80:83]
    ds_read_b128 v[40:43], v13 offset:34816
    s_add_u32 s76, s76, 32768
    v_mfma_f32_16x16x32_bf16 v[84:87], a[124:127], v[56:59], v[84:87]
    ds_read_b128 v[44:47], v13 offset:35840
    buffer_store_dwordx4 v[228:231], v11, s[12:15], s76 offen sc1
    v_mfma_f32_16x16x32_bf16 v[88:91], a[120:123], v[60:63], v[88:91]
    v_mfma_f32_16x16x32_bf16 v[92:95], a[124:127], v[60:63], v[92:95]
    s_waitcnt lgkmcnt(2)
    v_mfma_f32_16x16x32_bf16 v[80:83], a[128:131], v[32:35], v[80:83]
    ds_read_b128 v[48:51], v13 offset:36864
    v_mfma_f32_16x16x32_bf16 v[84:87], a[132:135], v[32:35], v[84:87]
    ds_read_b128 v[52:55], v13 offset:37888
    v_mfma_f32_16x16x32_bf16 v[88:91], a[128:131], v[36:39], v[88:91]
    ds_read_b128 v[56:59], v13 offset:38912
    s_add_u32 m0, s59, 0
    v_mfma_f32_16x16x32_bf16 v[92:95], a[132:135], v[36:39], v[92:95]
    ds_read_b128 v[60:63], v13 offset:39936
    buffer_load_dwordx4 v10, s[12:15], s48 offen offset:0 sc1 lds
    s_waitcnt lgkmcnt(4)
    v_mfma_f32_16x16x32_bf16 v[80:83], a[136:139], v[40:43], v[80:83]
    ds_read_b128 v[32:35], v13 offset:40960
    v_mfma_f32_16x16x32_bf16 v[84:87], a[140:143], v[40:43], v[84:87]
    ds_read_b128 v[36:39], v13 offset:41984
    v_mfma_f32_16x16x32_bf16 v[88:91], a[136:139], v[44:47], v[88:91]
    v_mfma_f32_16x16x32_bf16 v[92:95], a[140:143], v[44:47], v[92:95]
    buffer_load_dwordx4 v10, s[12:15], s48 offen offset:1024 sc1 lds
    s_waitcnt lgkmcnt(4)
    v_mfma_f32_16x16x32_bf16 v[80:83], a[144:147], v[48:51], v[80:83]
    ds_read_b128 v[40:43], v13 offset:43008
    v_mfma_f32_16x16x32_bf16 v[84:87], a[148:151], v[48:51], v[84:87]
    ds_read_b128 v[44:47], v13 offset:44032
    v_mfma_f32_16x16x32_bf16 v[88:91], a[144:147], v[52:55], v[88:91]
    v_mfma_f32_16x16x32_bf16 v[92:95], a[148:151], v[52:55], v[92:95]
    buffer_load_dwordx4 v10, s[12:15], s48 offen offset:2048 sc1 lds
    s_waitcnt lgkmcnt(4)
    v_mfma_f32_16x16x32_bf16 v[80:83], a[152:155], v[56:59], v[80:83]
    ds_read_b128 v[48:51], v13 offset:45056
    v_mfma_f32_16x16x32_bf16 v[84:87], a[156:159], v[56:59], v[84:87]
    ds_read_b128 v[52:55], v13 offset:46080
    v_mfma_f32_16x16x32_bf16 v[88:91], a[152:155], v[60:63], v[88:91]
    v_mfma_f32_16x16x32_bf16 v[92:95], a[156:159], v[60:63], v[92:95]
    buffer_load_dwordx4 v10, s[12:15], s48 offen offset:3072 sc1 lds
    s_waitcnt lgkmcnt(4)
    v_mfma_f32_16x16x32_bf16 v[80:83], a[160:163], v[32:35], v[80:83]
    ds_read_b128 v[56:59], v13 offset:47104
    v_mfma_f32_16x16x32_bf16 v[84:87], a[164:167], v[32:35], v[84:87]
    ds_read_b128 v[60:63], v13 offset:48128
    v_mfma_f32_16x16x32_bf16 v[88:91], a[160:163], v[36:39], v[88:91]
    s_add_u32 m0, s59, 4096
    v_mfma_f32_16x16x32_bf16 v[92:95], a[164:167], v[36:39], v[92:95]
    buffer_load_dwordx4 v10, s[12:15], s49 offen offset:0 sc1 lds
    s_waitcnt lgkmcnt(4)
    v_mfma_f32_16x16x32_bf16 v[80:83], a[168:171], v[40:43], v[80:83]
    ds_read_b128 v[32:35], v13 offset:49152
    v_mfma_f32_16x16x32_bf16 v[84:87], a[172:175], v[40:43], v[84:87]
    ds_read_b128 v[36:39], v13 offset:50176
    v_mfma_f32_16x16x32_bf16 v[88:91], a[168:171], v[44:47], v[88:91]
    v_mfma_f32_16x16x32_bf16 v[92:95], a[172:175], v[44:47], v[92:95]
    buffer_load_dwordx4 v10, s[12:15], s49 offen offset:1024 sc1 lds
    s_waitcnt lgkmcnt(4)
    v_mfma_f32_16x16x32_bf16 v[80:83], a[176:179], v[48:51], v[80:83]
    ds_read_b128 v[40:43], v13 offset:51200
    v_mfma_f32_16x16x32_bf16 v[84:87], a[180:183], v[48:51], v[84:87]
    ds_read_b128 v[44:47], v13 offset:52224
    v_mfma_f32_16x16x32_bf16 v[88:91], a[176:179], v[52:55], v[88:91]
    v_mfma_f32_16x16x32_bf16 v[92:95], a[180:183], v[52:55], v[92:95]
    buffer_load_dwordx4 v10, s[12:15], s49 offen offset:2048 sc1 lds
    s_waitcnt lgkmcnt(4)
    v_mfma_f32_16x16x32_bf16 v[80:83], a[184:187], v[56:59], v[80:83]
    ds_read_b128 v[48:51], v13 offset:53248
    v_mfma_f32_16x16x32_bf16 v[84:87], a[188:191], v[56:59], v[84:87]
    ds_read_b128 v[52:55], v13 offset:54272
    v_mfma_f32_16x16x32_bf16 v[88:91], a[184:187], v[60:63], v[88:91]
    v_mfma_f32_16x16x32_bf16 v[92:95], a[188:191], v[60:63], v[92:95]
    buffer_load_dwordx4 v10, s[12:15], s49 offen offset:3072 sc1 lds
    s_waitcnt lgkmcnt(4)
    v_mfma_f32_16x16x32_bf16 v[80:83], a[192:195], v[32:35], v[80:83]
    ds_read_b128 v[56:59], v13 offset:55296
    v_mfma_f32_16x16x32_bf16 v[84:87], a[196:199], v[32:35], v[84:87]
    ds_read_b128 v[60:63], v13 offset:56320
    v_mfma_f32_16x16x32_bf16 v[88:91], a[192:195], v[36:39], v[88:91]
    s_add_u32 s48, s53, 491520
    v_mfma_f32_16x16x32_bf16 v[92:95], a[196:199], v[36:39], v[92:95]
    s_add_u32 s46, s58, 2
    s_waitcnt lgkmcnt(4)
    v_mfma_f32_16x16x32_bf16 v[80:83], a[200:203], v[40:43], v[80:83]
    v_mfma_f32_16x16x32_bf16 v[84:87], a[204:207], v[40:43], v[84:87]
    v_mfma_f32_16x16x32_bf16 v[88:91], a[200:203], v[44:47], v[88:91]
    s_cmp_lt_u32 s46, s51
    s_cselect_b32 s48, s48, 0x20000000
    v_mfma_f32_16x16x32_bf16 v[92:95], a[204:207], v[44:47], v[92:95]
    s_cmp_lt_u32 s44, 3
    s_cselect_b32 s48, s48, 0x20000000
    s_waitcnt vmcnt(16) lgkmcnt(0)
    s_barrier
    v_mfma_f32_16x16x32_bf16 v[80:83], a[208:211], v[48:51], v[80:83]
    ds_read_b128 v[32:35], v14 offset:0
    v_mfma_f32_16x16x32_bf16 v[84:87], a[212:215], v[48:51], v[84:87]
    ds_read_b128 v[36:39], v14 offset:1024
    v_mfma_f32_16x16x32_bf16 v[88:91], a[208:211], v[52:55], v[88:91]
    s_add_u32 s49, s48, 4096
    v_mfma_f32_16x16x32_bf16 v[92:95], a[212:215], v[52:55], v[92:95]
    s_add_u32 s59, s54, 32768
    v_mfma_f32_16x16x32_bf16 v[80:83], a[216:219], v[56:59], v[80:83]
    ds_read_b128 v[40:43], v14 offset:2048
    v_mfma_f32_16x16x32_bf16 v[84:87], a[220:223], v[56:59], v[84:87]
    ds_read_b128 v[44:47], v14 offset:3072
    v_mfma_f32_16x16x32_bf16 v[88:91], a[216:219], v[60:63], v[88:91]
    v_mfma_f32_16x16x32_bf16 v[92:95], a[220:223], v[60:63], v[92:95]
    s_add_u32 s53, s53, 229376
    s_add_u32 s58, s58, 1
    v_swap_b32 v13, v14
    s_xor_b32 s54, s54, 65536
    s_xor_b32 s55, s55, 65536
    s_mov_b32 s76, s57
    v_swap_b32 v15, v16
    s_add_u32 s57, s57, 131072
    ds_write_b128 v7, v[80:83] offset:0
    ds_write_b128 v7, v[84:87] offset:64
    ds_write_b128 v7, v[88:91] offset:2304
    ds_write_b128 v7, v[92:95] offset:2368
    s_cmp_lt_u32 s58, s51
    s_cbranch_scc1 L_e_loop_176
    s_branch L_e_fin_178
L_e_one_177:
    s_waitcnt vmcnt(8)
    s_barrier
    ds_read_b128 v[32:35], v13 offset:0
    ds_read_b128 v[36:39], v13 offset:1024
    ds_read_b128 v[40:43], v13 offset:2048
    ds_read_b128 v[44:47], v13 offset:3072
    s_waitcnt lgkmcnt(2)
    v_mfma_f32_16x16x32_bf16 v[80:83], a[0:3], v[32:35], 0
    ds_read_b128 v[48:51], v13 offset:4096
    v_mfma_f32_16x16x32_bf16 v[84:87], a[4:7], v[32:35], 0
    ds_read_b128 v[52:55], v13 offset:5120
    v_mfma_f32_16x16x32_bf16 v[88:91], a[0:3], v[36:39], 0
    ds_read_b128 v[56:59], v13 offset:6144
    v_mfma_f32_16x16x32_bf16 v[92:95], a[4:7], v[36:39], 0
    ds_read_b128 v[60:63], v13 offset:7168
    s_waitcnt lgkmcnt(4)
    v_mfma_f32_16x16x32_bf16 v[80:83], a[8:11], v[40:43], v[80:83]
    ds_read_b128 v[32:35], v13 offset:8192
    v_mfma_f32_16x16x32_bf16 v[84:87], a[12:15], v[40:43], v[84:87]
    ds_read_b128 v[36:39], v13 offset:9216
    v_mfma_f32_16x16x32_bf16 v[88:91], a[8:11], v[44:47], v[88:91]
    v_mfma_f32_16x16x32_bf16 v[92:95], a[12:15], v[44:47], v[92:95]
    s_waitcnt lgkmcnt(4)
    v_mfma_f32_16x16x32_bf16 v[80:83], a[16:19], v[48:51], v[80:83]
    ds_read_b128 v[40:43], v13 offset:10240
    v_mfma_f32_16x16x32_bf16 v[84:87], a[20:23], v[48:51], v[84:87]
    ds_read_b128 v[44:47], v13 offset:11264
    v_mfma_f32_16x16x32_bf16 v[88:91], a[16:19], v[52:55], v[88:91]
    v_mfma_f32_16x16x32_bf16 v[92:95], a[20:23], v[52:55], v[92:95]
    s_waitcnt lgkmcnt(4)
    v_mfma_f32_16x16x32_bf16 v[80:83], a[24:27], v[56:59], v[80:83]
    ds_read_b128 v[48:51], v13 offset:12288
    v_mfma_f32_16x16x32_bf16 v[84:87], a[28:31], v[56:59], v[84:87]
    ds_read_b128 v[52:55], v13 offset:13312
    v_mfma_f32_16x16x32_bf16 v[88:91], a[24:27], v[60:63], v[88:91]
    v_mfma_f32_16x16x32_bf16 v[92:95], a[28:31], v[60:63], v[92:95]
    s_waitcnt lgkmcnt(4)
    v_mfma_f32_16x16x32_bf16 v[80:83], a[32:35], v[32:35], v[80:83]
    ds_read_b128 v[56:59], v13 offset:14336
    v_mfma_f32_16x16x32_bf16 v[84:87], a[36:39], v[32:35], v[84:87]
    ds_read_b128 v[60:63], v13 offset:15360
    v_mfma_f32_16x16x32_bf16 v[88:91], a[32:35], v[36:39], v[88:91]
    v_mfma_f32_16x16x32_bf16 v[92:95], a[36:39], v[36:39], v[92:95]
    s_waitcnt lgkmcnt(4)
    v_mfma_f32_16x16x32_bf16 v[80:83], a[40:43], v[40:43], v[80:83]
    ds_read_b128 v[32:35], v13 offset:16384
    v_mfma_f32_16x16x32_bf16 v[84:87], a[44:47], v[40:43], v[84:87]
    ds_read_b128 v[36:39], v13 offset:17408
    v_mfma_f32_16x16x32_bf16 v[88:91], a[40:43], v[44:47], v[88:91]
    v_mfma_f32_16x16x32_bf16 v[92:95], a[44:47], v[44:47], v[92:95]
    s_waitcnt lgkmcnt(4)
    v_mfma_f32_16x16x32_bf16 v[80:83], a[48:51], v[48:51], v[80:83]
    ds_read_b128 v[40:43], v13 offset:18432
    v_mfma_f32_16x16x32_bf16 v[84:87], a[52:55], v[48:51], v[84:87]
    ds_read_b128 v[44:47], v13 offset:19456
    v_mfma_f32_16x16x32_bf16 v[88:91], a[48:51], v[52:55], v[88:91]
    v_mfma_f32_16x16x32_bf16 v[92:95], a[52:55], v[52:55], v[92:95]
    s_waitcnt lgkmcnt(4)
    v_mfma_f32_16x16x32_bf16 v[80:83], a[56:59], v[56:59], v[80:83]
    ds_read_b128 v[48:51], v13 offset:20480
    v_mfma_f32_16x16x32_bf16 v[84:87], a[60:63], v[56:59], v[84:87]
    ds_read_b128 v[52:55], v13 offset:21504
    v_mfma_f32_16x16x32_bf16 v[88:91], a[56:59], v[60:63], v[88:91]
    v_mfma_f32_16x16x32_bf16 v[92:95], a[60:63], v[60:63], v[92:95]
    s_waitcnt lgkmcnt(4)
    v_mfma_f32_16x16x32_bf16 v[80:83], a[64:67], v[32:35], v[80:83]
    ds_read_b128 v[56:59], v13 offset:22528
    v_mfma_f32_16x16x32_bf16 v[84:87], a[68:71], v[32:35], v[84:87]
    ds_read_b128 v[60:63], v13 offset:23552
    v_mfma_f32_16x16x32_bf16 v[88:91], a[64:67], v[36:39], v[88:91]
    v_mfma_f32_16x16x32_bf16 v[92:95], a[68:71], v[36:39], v[92:95]
    s_waitcnt lgkmcnt(4)
    v_mfma_f32_16x16x32_bf16 v[80:83], a[72:75], v[40:43], v[80:83]
    ds_read_b128 v[32:35], v13 offset:24576
    v_mfma_f32_16x16x32_bf16 v[84:87], a[76:79], v[40:43], v[84:87]
    ds_read_b128 v[36:39], v13 offset:25600
    v_mfma_f32_16x16x32_bf16 v[88:91], a[72:75], v[44:47], v[88:91]
    v_mfma_f32_16x16x32_bf16 v[92:95], a[76:79], v[44:47], v[92:95]
    s_waitcnt lgkmcnt(4)
    v_mfma_f32_16x16x32_bf16 v[80:83], a[80:83], v[48:51], v[80:83]
    ds_read_b128 v[40:43], v13 offset:26624
    v_mfma_f32_16x16x32_bf16 v[84:87], a[84:87], v[48:51], v[84:87]
    ds_read_b128 v[44:47], v13 offset:27648
    v_mfma_f32_16x16x32_bf16 v[88:91], a[80:83], v[52:55], v[88:91]
    v_mfma_f32_16x16x32_bf16 v[92:95], a[84:87], v[52:55], v[92:95]
    s_waitcnt lgkmcnt(4)
    v_mfma_f32_16x16x32_bf16 v[80:83], a[88:91], v[56:59], v[80:83]
    ds_read_b128 v[48:51], v13 offset:28672
    v_mfma_f32_16x16x32_bf16 v[84:87], a[92:95], v[56:59], v[84:87]
    ds_read_b128 v[52:55], v13 offset:29696
    v_mfma_f32_16x16x32_bf16 v[88:91], a[88:91], v[60:63], v[88:91]
    v_mfma_f32_16x16x32_bf16 v[92:95], a[92:95], v[60:63], v[92:95]
    s_waitcnt lgkmcnt(4)
    v_mfma_f32_16x16x32_bf16 v[80:83], a[96:99], v[32:35], v[80:83]
    ds_read_b128 v[56:59], v13 offset:30720
    v_mfma_f32_16x16x32_bf16 v[84:87], a[100:103], v[32:35], v[84:87]
    ds_read_b128 v[60:63], v13 offset:31744
    v_mfma_f32_16x16x32_bf16 v[88:91], a[96:99], v[36:39], v[88:91]
    v_mfma_f32_16x16x32_bf16 v[92:95], a[100:103], v[36:39], v[92:95]
    s_waitcnt lgkmcnt(4)
    v_mfma_f32_16x16x32_bf16 v[80:83], a[104:107], v[40:43], v[80:83]
    v_mfma_f32_16x16x32_bf16 v[84:87], a[108:111], v[40:43], v[84:87]
    v_mfma_f32_16x16x32_bf16 v[88:91], a[104:107], v[44:47], v[88:91]
    v_mfma_f32_16x16x32_bf16 v[92:95], a[108:111], v[44:47], v[92:95]
    s_waitcnt vmcnt(0) lgkmcnt(0)
    s_barrier
    v_mfma_f32_16x16x32_bf16 v[80:83], a[112:115], v[48:51], v[80:83]
    ds_read_b128 v[32:35], v13 offset:32768
    v_mfma_f32_16x16x32_bf16 v[84:87], a[116:119], v[48:51], v[84:87]
    ds_read_b128 v[36:39], v13 offset:33792
    v_mfma_f32_16x16x32_bf16 v[88:91], a[112:115], v[52:55], v[88:91]
    v_mfma_f32_16x16x32_bf16 v[92:95], a[116:119], v[52:55], v[92:95]
    v_mfma_f32_16x16x32_bf16 v[80:83], a[120:123], v[56:59], v[80:83]
    ds_read_b128 v[40:43], v13 offset:34816
    v_mfma_f32_16x16x32_bf16 v[84:87], a[124:127], v[56:59], v[84:87]
    ds_read_b128 v[44:47], v13 offset:35840
    v_mfma_f32_16x16x32_bf16 v[88:91], a[120:123], v[60:63], v[88:91]
    v_mfma_f32_16x16x32_bf16 v[92:95], a[124:127], v[60:63], v[92:95]
    s_waitcnt lgkmcnt(2)
    v_mfma_f32_16x16x32_bf16 v[80:83], a[128:131], v[32:35], v[80:83]
    ds_read_b128 v[48:51], v13 offset:36864
    v_mfma_f32_16x16x32_bf16 v[84:87], a[132:135], v[32:35], v[84:87]
    ds_read_b128 v[52:55], v13 offset:37888
    v_mfma_f32_16x16x32_bf16 v[88:91], a[128:131], v[36:39], v[88:91]
    ds_read_b128 v[56:59], v13 offset:38912
    v_mfma_f32_16x16x32_bf16 v[92:95], a[132:135], v[36:39], v[92:95]
    ds_read_b128 v[60:63], v13 offset:39936
    s_waitcnt lgkmcnt(4)
    v_mfma_f32_16x16x32_bf16 v[80:83], a[136:139], v[40:43], v[80:83]
    ds_read_b128 v[32:35], v13 offset:40960
    v_mfma_f32_16x16x32_bf16 v[84:87], a[140:143], v[40:43], v[84:87]
    ds_read_b128 v[36:39], v13 offset:41984
    v_mfma_f32_16x16x32_bf16 v[88:91], a[136:139], v[44:47], v[88:91]
    v_mfma_f32_16x16x32_bf16 v[92:95], a[140:143], v[44:47], v[92:95]
    s_waitcnt lgkmcnt(4)
    v_mfma_f32_16x16x32_bf16 v[80:83], a[144:147], v[48:51], v[80:83]
    ds_read_b128 v[40:43], v13 offset:43008
    v_mfma_f32_16x16x32_bf16 v[84:87], a[148:151], v[48:51], v[84:87]
    ds_read_b128 v[44:47], v13 offset:44032
    v_mfma_f32_16x16x32_bf16 v[88:91], a[144:147], v[52:55], v[88:91]
    v_mfma_f32_16x16x32_bf16 v[92:95], a[148:151], v[52:55], v[92:95]
    s_waitcnt lgkmcnt(4)
    v_mfma_f32_16x16x32_bf16 v[80:83], a[152:155], v[56:59], v[80:83]
    ds_read_b128 v[48:51], v13 offset:45056
    v_mfma_f32_16x16x32_bf16 v[84:87], a[156:159], v[56:59], v[84:87]
    ds_read_b128 v[52:55], v13 offset:46080
    v_mfma_f32_16x16x32_bf16 v[88:91], a[152:155], v[60:63], v[88:91]
    v_mfma_f32_16x16x32_bf16 v[92:95], a[156:159], v[60:63], v[92:95]
    s_waitcnt lgkmcnt(4)
    v_mfma_f32_16x16x32_bf16 v[80:83], a[160:163], v[32:35], v[80:83]
    ds_read_b128 v[56:59], v13 offset:47104
    v_mfma_f32_16x16x32_bf16 v[84:87], a[164:167], v[32:35], v[84:87]
    ds_read_b128 v[60:63], v13 offset:48128
    v_mfma_f32_16x16x32_bf16 v[88:91], a[160:163], v[36:39], v[88:91]
    v_mfma_f32_16x16x32_bf16 v[92:95], a[164:167], v[36:39], v[92:95]
    s_waitcnt lgkmcnt(4)
    v_mfma_f32_16x16x32_bf16 v[80:83], a[168:171], v[40:43], v[80:83]
    ds_read_b128 v[32:35], v13 offset:49152
    v_mfma_f32_16x16x32_bf16 v[84:87], a[172:175], v[40:43], v[84:87]
    ds_read_b128 v[36:39], v13 offset:50176
    v_mfma_f32_16x16x32_bf16 v[88:91], a[168:171], v[44:47], v[88:91]
    v_mfma_f32_16x16x32_bf16 v[92:95], a[172:175], v[44:47], v[92:95]
    s_waitcnt lgkmcnt(4)
    v_mfma_f32_16x16x32_bf16 v[80:83], a[176:179], v[48:51], v[80:83]
    ds_read_b128 v[40:43], v13 offset:51200
    v_mfma_f32_16x16x32_bf16 v[84:87], a[180:183], v[48:51], v[84:87]
    ds_read_b128 v[44:47], v13 offset:52224
    v_mfma_f32_16x16x32_bf16 v[88:91], a[176:179], v[52:55], v[88:91]
    v_mfma_f32_16x16x32_bf16 v[92:95], a[180:183], v[52:55], v[92:95]
    s_waitcnt lgkmcnt(4)
    v_mfma_f32_16x16x32_bf16 v[80:83], a[184:187], v[56:59], v[80:83]
    ds_read_b128 v[48:51], v13 offset:53248
    v_mfma_f32_16x16x32_bf16 v[84:87], a[188:191], v[56:59], v[84:87]
    ds_read_b128 v[52:55], v13 offset:54272
    v_mfma_f32_16x16x32_bf16 v[88:91], a[184:187], v[60:63], v[88:91]
    v_mfma_f32_16x16x32_bf16 v[92:95], a[188:191], v[60:63], v[92:95]
    s_waitcnt lgkmcnt(4)
    v_mfma_f32_16x16x32_bf16 v[80:83], a[192:195], v[32:35], v[80:83]
    ds_read_b128 v[56:59], v13 offset:55296
    v_mfma_f32_16x16x32_bf16 v[84:87], a[196:199], v[32:35], v[84:87]
    ds_read_b128 v[60:63], v13 offset:56320
    v_mfma_f32_16x16x32_bf16 v[88:91], a[192:195], v[36:39], v[88:91]
    v_mfma_f32_16x16x32_bf16 v[92:95], a[196:199], v[36:39], v[92:95]
    s_waitcnt lgkmcnt(4)
    v_mfma_f32_16x16x32_bf16 v[80:83], a[200:203], v[40:43], v[80:83]
    v_mfma_f32_16x16x32_bf16 v[84:87], a[204:207], v[40:43], v[84:87]
    v_mfma_f32_16x16x32_bf16 v[88:91], a[200:203], v[44:47], v[88:91]
    v_mfma_f32_16x16x32_bf16 v[92:95], a[204:207], v[44:47], v[92:95]
    s_waitcnt lgkmcnt(0)
    v_mfma_f32_16x16x32_bf16 v[80:83], a[208:211], v[48:51], v[80:83]
    v_mfma_f32_16x16x32_bf16 v[84:87], a[212:215], v[48:51], v[84:87]
    v_mfma_f32_16x16x32_bf16 v[88:91], a[208:211], v[52:55], v[88:91]
    v_mfma_f32_16x16x32_bf16 v[92:95], a[212:215], v[52:55], v[92:95]
    v_mfma_f32_16x16x32_bf16 v[80:83], a[216:219], v[56:59], v[80:83]
    v_mfma_f32_16x16x32_bf16 v[84:87], a[220:223], v[56:59], v[84:87]
    v_mfma_f32_16x16x32_bf16 v[88:91], a[216:219], v[60:63], v[88:91]
    v_mfma_f32_16x16x32_bf16 v[92:95], a[220:223], v[60:63], v[92:95]
    s_mov_b32 s76, s57
    s_nop 6
    ds_write_b128 v7, v[80:83] offset:0
    ds_write_b128 v7, v[84:87] offset:64
    ds_write_b128 v7, v[88:91] offset:2304
    ds_write_b128 v7, v[92:95] offset:2368
L_e_fin_178:
    s_waitcnt lgkmcnt(0)
    ds_read_b128 v[216:219], v8 offset:0
    ds_read_b128 v[220:223], v8 offset:1152
    ds_read_b128 v[224:227], v8 offset:2304
    ds_read_b128 v[228:231], v8 offset:3456
    s_waitcnt lgkmcnt(0)
    buffer_store_dwordx4 v[216:219], v11, s[12:15], s76 offen sc1
    s_add_u32 s76, s76, 32768
    buffer_store_dwordx4 v[220:223], v11, s[12:15], s76 offen sc1
    s_add_u32 s76, s76, 32768
    buffer_store_dwordx4 v[224:227], v11, s[12:15], s76 offen sc1
    s_add_u32 s76, s76, 32768
    buffer_store_dwordx4 v[228:231], v11, s[12:15], s76 offen sc1
    s_waitcnt vmcnt(0)
    s_barrier
    s_cmp_lg_u32 s44, 0
    s_cbranch_scc1 L_pub_179
    v_mov_b32 v30, s62
    v_mov_b32 v31, 0
    s_mov_b64 exec, 1
    buffer_store_dword v30, v31, s[80:83], s65 offen
    buffer_store_dword v30, v31, s[84:87], s65 offen sc1
    s_mov_b64 exec, -1
L_pub_179:
    s_cmp_lg_u32 s51, 1
    s_cbranch_scc1 L_c_skip_172
    s_lshl_b32 s63, s50, 5
    s_add_u32 s63, s63, s41
    s_lshl_b32 s47, s63, 11
    s_lshl_b32 s45, s44, 9
    s_add_u32 s47, s47, s45
    s_add_u32 s46, s47, 0x800000
    v_lshlrev_b32 v17, 3, v1
    buffer_load_dwordx2 v[208:209], v17, s[12:15], s46 offen sc1
    s_add_u32 s45, s64, 16384
    s_cmp_lg_u32 s44, 1
    s_cbranch_scc1 L_pw_180
    s_mov_b32 exec_hi, 0
    s_mov_b32 s70, 0
L_wp_181:
    buffer_load_dword v31, v5, s[12:15], s45 offen sc1
    s_add_u32 s70, s70, 1
    s_cmp_ge_u32 s70, 0x200000
    s_cbranch_scc1 L_w_done_98
L_wp_181_c:
    s_waitcnt vmcnt(0)
    v_cmp_gt_u32 vcc, s62, v31
    s_nop 1
    s_cbranch_vccz L_wp_181_ok
    s_sleep 1
    s_branch L_wp_181
L_wp_181_ok:
    s_mov_b64 exec, -1
L_pw_180:
    s_barrier
    s_lshl_b32 s45, s63, 12
    s_lshl_b32 s46, s44, 10
    s_add_u32 s45, s45, s46
    s_add_u32 s45, s45, 0xc000000
    buffer_load_dwordx4 v[64:67], v10, s[12:15], s45 offen sc1
    s_add_u32 s45, s45, 0x800000
    buffer_load_dwordx4 v[68:71], v10, s[12:15], s45 offen sc1
    s_add_u32 s45, s45, 0x800000
    buffer_load_dwordx4 v[72:75], v10, s[12:15], s45 offen sc1
    s_add_u32 s45, s45, 0x800000
    buffer_load_dwordx4 v[76:79], v10, s[12:15], s45 offen sc1
    s_waitcnt vmcnt(4)
    v_lshlrev_b32 v160, 16, v208
    v_and_b32 v161, 0xffff0000, v208
    v_lshlrev_b32 v162, 16, v209
    v_and_b32 v163, 0xffff0000, v209
    s_waitcnt vmcnt(0)
    v_pk_add_f32 v[64:65], v[64:65], v[68:69]
    v_pk_add_f32 v[72:73], v[72:73], v[76:77]
    v_pk_add_f32 v[66:67], v[66:67], v[70:71]
    v_pk_add_f32 v[74:75], v[74:75], v[78:79]
    v_pk_add_f32 v[64:65], v[64:65], v[72:73]
    v_pk_add_f32 v[66:67], v[66:67], v[74:75]
    v_cvt_pk_bf16_f32 v64, v64, v64
    v_lshlrev_b32 v64, 16, v64
    v_cvt_pk_bf16_f32 v65, v65, v65
    v_lshlrev_b32 v65, 16, v65
    v_cvt_pk_bf16_f32 v66, v66, v66
    v_lshlrev_b32 v66, 16, v66
    v_cvt_pk_bf16_f32 v67, v67, v67
    v_lshlrev_b32 v67, 16, v67
    v_add_f32 v64, v64, v18
    v_cvt_pk_bf16_f32 v64, v64, v64
    v_lshlrev_b32 v64, 16, v64
    v_mul_f32 v64, v64, v22
    v_cvt_pk_bf16_f32 v64, v64, v64
    v_lshlrev_b32 v64, 16, v64
    v_add_f32 v64, v64, v160
    v_add_f32 v65, v65, v19
    v_cvt_pk_bf16_f32 v65, v65, v65
    v_lshlrev_b32 v65, 16, v65
    v_mul_f32 v65, v65, v23
    v_cvt_pk_bf16_f32 v65, v65, v65
    v_lshlrev_b32 v65, 16, v65
    v_add_f32 v65, v65, v161
    v_add_f32 v66, v66, v20
    v_cvt_pk_bf16_f32 v66, v66, v66
    v_lshlrev_b32 v66, 16, v66
    v_mul_f32 v66, v66, v24
    v_cvt_pk_bf16_f32 v66, v66, v66
    v_lshlrev_b32 v66, 16, v66
    v_add_f32 v66, v66, v162
    v_add_f32 v67, v67, v21
    v_cvt_pk_bf16_f32 v67, v67, v67
    v_lshlrev_b32 v67, 16, v67
    v_mul_f32 v67, v67, v25
    v_cvt_pk_bf16_f32 v67, v67, v67
    v_lshlrev_b32 v67, 16, v67
    v_add_f32 v67, v67, v163
    v_cvt_pk_bf16_f32 v208, v64, v65
    v_cvt_pk_bf16_f32 v209, v66, v67
    buffer_store_dwordx2 v[208:209], v17, s[32:35], s47 offen
    s_branch L_c_loop_171
L_c_skip_172:
    s_add_u32 s63, s50, s44
    s_lshl_b32 s63, s63, 5
    s_add_u32 s63, s63, s41
    s_lshl_b32 s47, s63, 11
    s_add_u32 s46, s47, 0x800000
    s_cmp_lt_u32 s44, s51
    s_cselect_b32 s46, s46, 0x20000000
    buffer_load_dwordx4 v[208:211], v10, s[12:15], s46 offen sc1
    buffer_load_dwordx4 v[212:215], v10, s[12:15], s46 offen offset:1024 sc1
    s_add_u32 s45, s64, 16384
    s_cmp_lg_u32 s44, 1
    s_cbranch_scc1 L_pw_182
    s_mov_b32 exec_hi, 0
    s_mov_b32 s70, 0
L_wp_183:
    buffer_load_dword v31, v5, s[12:15], s45 offen sc1
    s_add_u32 s70, s70, 1
    s_cmp_ge_u32 s70, 0x200000
    s_cbranch_scc1 L_w_done_98
L_wp_183_c:
    s_waitcnt vmcnt(0)
    v_cmp_gt_u32 vcc, s62, v31
    s_nop 1
    s_cbranch_vccz L_wp_183_ok
    s_sleep 1
    s_branch L_wp_183
L_wp_183_ok:
    s_mov_b64 exec, -1
L_pw_182:
    s_barrier
    s_cmp_ge_u32 s44, s51
    s_cbranch_scc1 L_c_loop_171
    s_lshl_b32 s45, s63, 12
    s_add_u32 s45, s45, 0xc000000
    v_lshlrev_b32 v29, 5, v1
    buffer_load_dwordx4 v[64:67], v29, s[12:15], s45 offen offset:0 sc1
    buffer_load_dwordx4 v[68:71], v29, s[12:15], s45 offen offset:16 sc1
    buffer_load_dwordx4 v[72:75], v29, s[12:15], s45 offen offset:2048 sc1
    buffer_load_dwordx4 v[76:79], v29, s[12:15], s45 offen offset:2064 sc1
    s_add_u32 s45, s45, 0x800000
    buffer_load_dwordx4 v[160:163], v29, s[12:15], s45 offen offset:0 sc1
    buffer_load_dwordx4 v[164:167], v29, s[12:15], s45 offen offset:16 sc1
    buffer_load_dwordx4 v[168:171], v29, s[12:15], s45 offen offset:2048 sc1
    buffer_load_dwordx4 v[172:175], v29, s[12:15], s45 offen offset:2064 sc1
    s_add_u32 s45, s45, 0x800000
    buffer_load_dwordx4 v[176:179], v29, s[12:15], s45 offen offset:0 sc1
    buffer_load_dwordx4 v[180:183], v29, s[12:15], s45 offen offset:16 sc1
    buffer_load_dwordx4 v[184:187], v29, s[12:15], s45 offen offset:2048 sc1
    buffer_load_dwordx4 v[188:191], v29, s[12:15], s45 offen offset:2064 sc1
    s_add_u32 s45, s45, 0x800000
    buffer_load_dwordx4 v[192:195], v29, s[12:15], s45 offen offset:0 sc1
    buffer_load_dwordx4 v[196:199], v29, s[12:15], s45 offen offset:16 sc1
    buffer_load_dwordx4 v[200:203], v29, s[12:15], s45 offen offset:2048 sc1
    buffer_load_dwordx4 v[204:207], v29, s[12:15], s45 offen offset:2064 sc1
    s_waitcnt vmcnt(0)
    v_pk_add_f32 v[64:65], v[64:65], v[160:161]
    v_pk_add_f32 v[176:177], v[176:177], v[192:193]
    v_pk_add_f32 v[66:67], v[66:67], v[162:163]
    v_pk_add_f32 v[178:179], v[178:179], v[194:195]
    v_pk_add_f32 v[68:69], v[68:69], v[164:165]
    v_pk_add_f32 v[180:181], v[180:181], v[196:197]
    v_pk_add_f32 v[70:71], v[70:71], v[166:167]
    v_pk_add_f32 v[182:183], v[182:183], v[198:199]
    v_pk_add_f32 v[72:73], v[72:73], v[168:169]
    v_pk_add_f32 v[184:185], v[184:185], v[200:201]
    v_pk_add_f32 v[74:75], v[74:75], v[170:171]
    v_pk_add_f32 v[186:187], v[186:187], v[202:203]
    v_pk_add_f32 v[76:77], v[76:77], v[172:173]
    v_pk_add_f32 v[188:189], v[188:189], v[204:205]
    v_pk_add_f32 v[78:79], v[78:79], v[174:175]
    v_pk_add_f32 v[190:191], v[190:191], v[206:207]
    v_pk_add_f32 v[64:65], v[64:65], v[176:177]
    v_pk_add_f32 v[66:67], v[66:67], v[178:179]
    v_pk_add_f32 v[68:69], v[68:69], v[180:181]
    v_pk_add_f32 v[70:71], v[70:71], v[182:183]
    v_pk_add_f32 v[72:73], v[72:73], v[184:185]
    v_pk_add_f32 v[74:75], v[74:75], v[186:187]
    v_pk_add_f32 v[76:77], v[76:77], v[188:189]
    v_pk_add_f32 v[78:79], v[78:79], v[190:191]
    v_cvt_pk_bf16_f32 v64, v64, v64
    v_lshlrev_b32 v64, 16, v64
    v_cvt_pk_bf16_f32 v65, v65, v65
    v_lshlrev_b32 v65, 16, v65
    v_cvt_pk_bf16_f32 v66, v66, v66
    v_lshlrev_b32 v66, 16, v66
    v_cvt_pk_bf16_f32 v67, v67, v67
    v_lshlrev_b32 v67, 16, v67
    v_cvt_pk_bf16_f32 v68, v68, v68
    v_lshlrev_b32 v68, 16, v68
    v_cvt_pk_bf16_f32 v69, v69, v69
    v_lshlrev_b32 v69, 16, v69
    v_cvt_pk_bf16_f32 v70, v70, v70
    v_lshlrev_b32 v70, 16, v70
    v_cvt_pk_bf16_f32 v71, v71, v71
    v_lshlrev_b32 v71, 16, v71
    v_cvt_pk_bf16_f32 v72, v72, v72
    v_lshlrev_b32 v72, 16, v72
    v_cvt_pk_bf16_f32 v73, v73, v73
    v_lshlrev_b32 v73, 16, v73
    v_cvt_pk_bf16_f32 v74, v74, v74
    v_lshlrev_b32 v74, 16, v74
    v_cvt_pk_bf16_f32 v75, v75, v75
    v_lshlrev_b32 v75, 16, v75
    v_cvt_pk_bf16_f32 v76, v76, v76
    v_lshlrev_b32 v76, 16, v76
    v_cvt_pk_bf16_f32 v77, v77, v77
    v_lshlrev_b32 v77, 16, v77
    v_cvt_pk_bf16_f32 v78, v78, v78
    v_lshlrev_b32 v78, 16, v78
    v_cvt_pk_bf16_f32 v79, v79, v79
    v_lshlrev_b32 v79, 16, v79
    v_lshlrev_b32 v160, 16, v208
    v_and_b32 v161, 0xffff0000, v208
    v_lshlrev_b32 v162, 16, v209
    v_and_b32 v163, 0xffff0000, v209
    v_lshlrev_b32 v164, 16, v210
    v_and_b32 v165, 0xffff0000, v210
    v_lshlrev_b32 v166, 16, v211
    v_and_b32 v167, 0xffff0000, v211
    v_lshlrev_b32 v168, 16, v212
    v_and_b32 v169, 0xffff0000, v212
    v_lshlrev_b32 v170, 16, v213
    v_and_b32 v171, 0xffff0000, v213
    v_lshlrev_b32 v172, 16, v214
    v_and_b32 v173, 0xffff0000, v214
    v_lshlrev_b32 v174, 16, v215
    v_and_b32 v175, 0xffff0000, v215
    v_add_f32 v64, v64, v96
    v_cvt_pk_bf16_f32 v64, v64, v64
    v_lshlrev_b32 v64, 16, v64
    v_mul_f32 v64, v64, v112
    v_cvt_pk_bf16_f32 v64, v64, v64
    v_lshlrev_b32 v64, 16, v64
    v_add_f32 v64, v64, v160
    v_add_f32 v65, v65, v97
    v_cvt_pk_bf16_f32 v65, v65, v65
    v_lshlrev_b32 v65, 16, v65
    v_mul_f32 v65, v65, v113
    v_cvt_pk_bf16_f32 v65, v65, v65
    v_lshlrev_b32 v65, 16, v65
    v_add_f32 v65, v65, v161
    v_add_f32 v66, v66, v98
    v_cvt_pk_bf16_f32 v66, v66, v66
    v_lshlrev_b32 v66, 16, v66
    v_mul_f32 v66, v66, v114
    v_cvt_pk_bf16_f32 v66, v66, v66
    v_lshlrev_b32 v66, 16, v66
    v_add_f32 v66, v66, v162
    v_add_f32 v67, v67, v99
    v_cvt_pk_bf16_f32 v67, v67, v67
    v_lshlrev_b32 v67, 16, v67
    v_mul_f32 v67, v67, v115
    v_cvt_pk_bf16_f32 v67, v67, v67
    v_lshlrev_b32 v67, 16, v67
    v_add_f32 v67, v67, v163
    v_add_f32 v68, v68, v100
    v_cvt_pk_bf16_f32 v68, v68, v68
    v_lshlrev_b32 v68, 16, v68
    v_mul_f32 v68, v68, v116
    v_cvt_pk_bf16_f32 v68, v68, v68
    v_lshlrev_b32 v68, 16, v68
    v_add_f32 v68, v68, v164
    v_add_f32 v69, v69, v101
    v_cvt_pk_bf16_f32 v69, v69, v69
    v_lshlrev_b32 v69, 16, v69
    v_mul_f32 v69, v69, v117
    v_cvt_pk_bf16_f32 v69, v69, v69
    v_lshlrev_b32 v69, 16, v69
    v_add_f32 v69, v69, v165
    v_add_f32 v70, v70, v102
    v_cvt_pk_bf16_f32 v70, v70, v70
    v_lshlrev_b32 v70, 16, v70
    v_mul_f32 v70, v70, v118
    v_cvt_pk_bf16_f32 v70, v70, v70
    v_lshlrev_b32 v70, 16, v70
    v_add_f32 v70, v70, v166
    v_add_f32 v71, v71, v103
    v_cvt_pk_bf16_f32 v71, v71, v71
    v_lshlrev_b32 v71, 16, v71
    v_mul_f32 v71, v71, v119
    v_cvt_pk_bf16_f32 v71, v71, v71
    v_lshlrev_b32 v71, 16, v71
    v_add_f32 v71, v71, v167
    v_add_f32 v72, v72, v104
    v_cvt_pk_bf16_f32 v72, v72, v72
    v_lshlrev_b32 v72, 16, v72
    v_mul_f32 v72, v72, v120
    v_cvt_pk_bf16_f32 v72, v72, v72
    v_lshlrev_b32 v72, 16, v72
    v_add_f32 v72, v72, v168
    v_add_f32 v73, v73, v105
    v_cvt_pk_bf16_f32 v73, v73, v73
    v_lshlrev_b32 v73, 16, v73
    v_mul_f32 v73, v73, v121
    v_cvt_pk_bf16_f32 v73, v73, v73
    v_lshlrev_b32 v73, 16, v73
    v_add_f32 v73, v73, v169
    v_add_f32 v74, v74, v106
    v_cvt_pk_bf16_f32 v74, v74, v74
    v_lshlrev_b32 v74, 16, v74
    v_mul_f32 v74, v74, v122
    v_cvt_pk_bf16_f32 v74, v74, v74
    v_lshlrev_b32 v74, 16, v74
    v_add_f32 v74, v74, v170
    v_add_f32 v75, v75, v107
    v_cvt_pk_bf16_f32 v75, v75, v75
    v_lshlrev_b32 v75, 16, v75
    v_mul_f32 v75, v75, v123
    v_cvt_pk_bf16_f32 v75, v75, v75
    v_lshlrev_b32 v75, 16, v75
    v_add_f32 v75, v75, v171
    v_add_f32 v76, v76, v108
    v_cvt_pk_bf16_f32 v76, v76, v76
    v_lshlrev_b32 v76, 16, v76
    v_mul_f32 v76, v76, v124
    v_cvt_pk_bf16_f32 v76, v76, v76
    v_lshlrev_b32 v76, 16, v76
    v_add_f32 v76, v76, v172
    v_add_f32 v77, v77, v109
    v_cvt_pk_bf16_f32 v77, v77, v77
    v_lshlrev_b32 v77, 16, v77
    v_mul_f32 v77, v77, v125
    v_cvt_pk_bf16_f32 v77, v77, v77
    v_lshlrev_b32 v77, 16, v77
    v_add_f32 v77, v77, v173
    v_add_f32 v78, v78, v110
    v_cvt_pk_bf16_f32 v78, v78, v78
    v_lshlrev_b32 v78, 16, v78
    v_mul_f32 v78, v78, v126
    v_cvt_pk_bf16_f32 v78, v78, v78
    v_lshlrev_b32 v78, 16, v78
    v_add_f32 v78, v78, v174
    v_add_f32 v79, v79, v111
    v_cvt_pk_bf16_f32 v79, v79, v79
    v_lshlrev_b32 v79, 16, v79
    v_mul_f32 v79, v79, v127
    v_cvt_pk_bf16_f32 v79, v79, v79
    v_lshlrev_b32 v79, 16, v79
    v_add_f32 v79, v79, v175
    v_cvt_pk_bf16_f32 v208, v64, v65
    v_cvt_pk_bf16_f32 v209, v66, v67
    v_cvt_pk_bf16_f32 v210, v68, v69
    v_cvt_pk_bf16_f32 v211, v70, v71
    v_cvt_pk_bf16_f32 v212, v72, v73
    v_cvt_pk_bf16_f32 v213, v74, v75
    v_cvt_pk_bf16_f32 v214, v76, v77
    v_cvt_pk_bf16_f32 v215, v78, v79
    buffer_store_dwordx4 v[208:211], v10, s[32:35], s47 offen
    buffer_store_dwordx4 v[212:215], v10, s[32:35], s47 offen offset:1024
    s_branch L_c_loop_171
L_w_done_98:
    s_endpgm
.section .rodata,"a"
.p2align 6
.amdhsa_kernel adaLN_cond__memory_aug_recurrent_mem_tr__dense_activation_gelu__prompt_kernel
  .amdhsa_next_free_vgpr 512
  .amdhsa_next_free_sgpr 102
  .amdhsa_accum_offset 256
  .amdhsa_group_segment_fixed_size 0
  .amdhsa_kernarg_size 136
  .amdhsa_user_sgpr_count 2
  .amdhsa_user_sgpr_kernarg_segment_ptr 1
  .amdhsa_system_sgpr_workgroup_id_x 1
.end_amdhsa_kernel
```

```asm
; @launch kernel=adaLN_cond__memory_aug_recurrent_mem_tr__dense_activation_gelu__prompt_kernel grid=(256,1,1) block=(256,1,1) lds=163840
.amdgcn_target "amdgcn-amd-amdhsa--gfx950"
.text
.globl adaLN_cond__memory_aug_recurrent_mem_tr__dense_activation_gelu__prompt_kernel
.p2align 8
.type adaLN_cond__memory_aug_recurrent_mem_tr__dense_activation_gelu__prompt_kernel,@function
adaLN_cond__memory_aug_recurrent_mem_tr__dense_activation_gelu__prompt_kernel:
    s_cmp_lt_u32 s2, 256
    s_cbranch_scc1 L_c_done_1_go
    s_endpgm
L_c_done_1_go:
    s_and_b32 s40, s2, 7
    s_load_dwordx4 s[4:7], s[0:1], 16
    s_load_dwordx4 s[8:11], s[0:1], 32
    s_load_dwordx2 s[20:21], s[0:1], 128
    s_load_dwordx2 s[22:23], s[0:1], 120
    s_load_dwordx2 s[50:51], s[0:1], 8
    s_lshr_b32 s41, s2, 3
    s_and_b32 s42, s41, 15
    v_and_b32 v1, 63, v0
    v_lshrrev_b32 v2, 6, v0
    s_nop 0
    v_readfirstlane_b32 s44, v2
    s_waitcnt lgkmcnt(0)
    s_mov_b32 s24, s4
    s_and_b32 s25, s5, 0xffff
    s_mov_b32 s26, 0x800000
    s_mov_b32 s27, 0x00020000
    s_mov_b32 s28, s6
    s_and_b32 s29, s7, 0xffff
    s_mov_b32 s30, 0x800000
    s_mov_b32 s31, 0x00020000
    s_mov_b32 s32, s8
    s_and_b32 s33, s9, 0xffff
    s_mov_b32 s34, 0x800000
    s_mov_b32 s35, 0x00020000
    s_mov_b32 s36, s10
    s_and_b32 s37, s11, 0xffff
    s_mov_b32 s38, 0x800000
    s_mov_b32 s39, 0x00020000
    s_mov_b32 s12, s20
    s_and_b32 s13, s21, 0xffff
    s_mov_b32 s14, 0x10000000
    s_mov_b32 s15, 0x00020000
    s_mov_b32 s16, s22
    s_and_b32 s17, s23, 0xffff
    s_mov_b32 s18, 0x100
    s_mov_b32 s19, 0x00020000
    s_mov_b32 s52, s50
    s_and_b32 s53, s51, 0xffff
    s_mov_b32 s54, 0x4000
    s_mov_b32 s55, 0x00020000
    v_mov_b32 v41, 0
    s_cmp_lg_u32 s2, 1
    s_cbranch_scc1 L_worker_3_a
    s_getreg_b32 s45, hwreg(HW_REG_XCC_ID)
    s_and_b32 s45, s45, 1
    s_add_u32 s45, s45, 1
    v_mov_b32 v40, s45
    buffer_store_dword v40, v41, s[16:19], 0 offen offset:24 sc1
L_worker_3_a:
    s_cmp_eq_u32 s40, 1
    s_cbranch_scc1 L_worker_3_g0
    s_cmp_lt_u32 s40, 3
    s_cbranch_scc1 L_worker_3_q
    s_sub_u32 s40, s40, 2
    s_branch L_worker_3
L_worker_3_q:
    s_mov_b32 s70, 0
L_worker_3_p:
    buffer_load_dword v40, v41, s[16:19], 0 offen offset:24 sc1
    s_add_u32 s70, s70, 1
    s_cmp_ge_u32 s70, 0x200000
    s_cbranch_scc1 L_c_done_1
    s_waitcnt vmcnt(0)
    v_readfirstlane_b32 s45, v40
    s_nop 3
    s_cmp_eq_u32 s45, 0
    s_cbranch_scc1 L_worker_3_p
    s_and_b32 s45, s45, 2
    s_cmp_lg_u32 s45, s40
    s_mov_b32 s40, 1
    s_cbranch_scc1 L_worker_3_no
    s_mov_b32 s40, 0
    s_branch L_worker_3
L_worker_3_g0:
    s_mov_b32 s40, 0
L_worker_3_no:
    s_lshl_b32 s43, s40, 4
    s_add_u32 s43, s43, s42
    s_lshl_b32 s3, s43, 7
    s_lshr_b32 s45, s41, 4
    s_lshl_b32 s45, s45, 4
    s_add_u32 s3, s3, s45
    s_lshl_b32 s45, s44, 2
    s_add_u32 s3, s3, s45
    s_add_u32 s3, s3, 0x11000
    v_and_b32 v21, 8, v1
    v_cmp_eq_u32 s[56:57], 0, v21
    v_mov_b32 v2, 0xeeee
    v_mov_b32 v3, 0x4444
    v_cndmask_b32 v2, v2, v3, s[56:57]
    v_lshlrev_b32 v68, 4, v1
    s_lshl_b32 s45, s44, 12
    v_add_u32 v3, s45, v68
    v_add_u32 v4, 4096, v3
    v_and_b32 v4, 16383, v4
    v_add_u32 v21, 8192, v3
    v_and_b32 v21, 16383, v21
    v_add_u32 v23, 12288, v3
    v_and_b32 v23, 16383, v23
    s_mul_i32 s45, s44, 24576
    s_add_u32 s45, s45, 65536
    v_add_u32 v5, s45, v68
    v_lshrrev_b32 v63, 4, v1
    s_lshl_b32 s45, s44, 2
    v_add_u32 v64, s45, v63
    s_lshr_b32 s45, s44, 1
    s_lshl_b32 s45, s45, 2
    v_add_u32 v65, s45, v63
    v_bfe_u32 v66, v1, 1, 3
    v_xor_b32 v66, v66, v65
    v_lshlrev_b32 v66, 5, v66
    v_and_b32 v67, 1, v1
    v_lshlrev_b32 v67, 4, v67
    v_add_u32 v66, v66, v67
    v_lshlrev_b32 v64, 13, v64
    v_add_u32 v82, v64, v66
    s_lshl_b32 s47, s43, 8
    s_lshl_b32 s48, s44, 10
    v_bfe_u32 v64, v1, 2, 2
    v_bfe_u32 v65, v1, 4, 1
    v_lshlrev_b32 v65, 2, v65
    v_add_u32 v65, v65, v64
    v_lshlrev_b32 v66, 3, v63
    v_add_u32 v66, v66, v64
    v_lshlrev_b32 v66, 8, v66
    v_and_b32 v67, 3, v1
    v_lshlrev_b32 v67, 3, v67
    v_add_u32 v66, v66, v67
    s_lshl_b32 s45, s44, 1
    v_xor_b32 v65, s45, v65
    v_lshlrev_b32 v65, 5, v65
    v_add_u32 v80, v66, v65
    v_xor_b32 v81, 32, v80
    v_lshrrev_b32 v64, 5, v1
    v_mul_u32_u24 v64, 20480, v64
    v_add_u32 v64, 65536, v64
    v_add_u32 v84, v64, v80
    v_add_u32 v85, v64, v81
    v_add_u32 v86, 49152, v84
    v_add_u32 v87, 49152, v85
    v_mov_b32 v40, -1
    v_mov_b32 v41, -1
    v_mov_b32 v42, -1
    v_mov_b32 v43, -1
    v_mov_b32 v44, 0
    s_mov_b32 s68, 0
    s_cmp_ge_u32 s41, 16
    s_cbranch_scc1 L_c_vo_2
    s_lshl_b32 s45, s42, 11
    s_lshr_b32 s46, s44, 1
    s_lshl_b32 s46, s46, 10
    s_add_u32 s45, s45, s46
    s_and_b32 s46, s44, 1
    s_lshl_b32 s46, s46, 7
    s_add_u32 s45, s45, s46
    v_add_u32 v17, s45, v68
    v_mov_b32 v63, 0x20000000
    v_cndmask_b32 v17, v63, v17, s[56:57]
    s_lshl_b32 s62, s40, 17
    s_add_u32 s62, s62, 0x7040000
    s_add_u32 s63, s62, 0
    buffer_store_dwordx4 v[40:43], v17, s[12:15], s63 offen sc1
    s_add_u32 s63, s62, 32768
    buffer_store_dwordx4 v[40:43], v17, s[12:15], s63 offen sc1
    s_add_u32 s63, s62, 65536
    buffer_store_dwordx4 v[40:43], v17, s[12:15], s63 offen sc1
    s_add_u32 s63, s62, 98304
    buffer_store_dwordx4 v[40:43], v17, s[12:15], s63 offen sc1
    s_mov_b64 exec, -1
    s_lshl_b32 s45, s40, 12
    s_lshl_b32 s46, s42, 4
    s_add_u32 s45, s45, s46
    s_add_u32 s45, s45, 0x7080000
    s_lshl_b32 s46, s44, 2
    s_add_u32 s45, s45, s46
    v_lshlrev_b32 v20, 8, v1
    v_add_u32 v20, s45, v20
    v_cmp_gt_u32 vcc, 16, v1
    s_nop 1
    v_cndmask_b32 v20, v63, v20, vcc
    buffer_store_dword v44, v20, s[12:15], 0 offen sc1
    s_lshl_b32 s45, s43, 7
    s_add_u32 s45, s45, 0x10010
    v_lshlrev_b32 v64, 2, v1
    s_mov_b64 exec, 0xff
    buffer_store_dword v44, v64, s[12:15], s45 offen sc1
    s_mov_b64 exec, 1
    v_mov_b32 v65, 63
    buffer_store_dword v44, v64, s[12:15], s3 offen sc1
    buffer_store_dword v65, v64, s[12:15], s3 offen offset:16 sc1
    s_mov_b64 exec, 0xffff
    v_lshlrev_b32 v64, 7, v1
    s_cmp_eq_u32 s2, 1
    s_mov_b32 s45, 0x1f000
    s_cselect_b32 s45, s45, 0x20000000
    buffer_store_dword v44, v64, s[12:15], s45 offen sc1
    s_mov_b64 exec, -1
    s_add_u32 s79, s41, 0
    s_and_b32 s79, s79, 3
    s_lshl_b32 s79, s79, 19
    s_add_u32 s79, s79, s47
    s_add_u32 s46, s79, 0x0
    s_add_u32 m0, s48, 69632
    s_nop 0
    buffer_load_dwordx4 v82, s[24:27], s46 offen  lds
    s_add_u32 s46, s79, 0x20000
    s_add_u32 m0, s48, 94208
    s_nop 0
    buffer_load_dwordx4 v82, s[24:27], s46 offen  lds
    s_add_u32 s46, s79, 0x40000
    s_add_u32 m0, s48, 118784
    s_nop 0
    buffer_load_dwordx4 v82, s[24:27], s46 offen  lds
    s_add_u32 s46, s79, 0x60000
    s_add_u32 m0, s48, 143360
    s_nop 0
    buffer_load_dwordx4 v82, s[24:27], s46 offen  lds
    s_add_u32 s79, s41, 1
    s_and_b32 s79, s79, 3
    s_lshl_b32 s79, s79, 19
    s_add_u32 s79, s79, s47
    s_add_u32 s46, s79, 0x0
    s_add_u32 m0, s48, 73728
    s_nop 0
    buffer_load_dwordx4 v82, s[24:27], s46 offen  lds
    s_add_u32 s46, s79, 0x20000
    s_add_u32 m0, s48, 98304
    s_nop 0
    buffer_load_dwordx4 v82, s[24:27], s46 offen  lds
    s_add_u32 s46, s79, 0x40000
    s_add_u32 m0, s48, 122880
    s_nop 0
    buffer_load_dwordx4 v82, s[24:27], s46 offen  lds
    s_add_u32 s46, s79, 0x60000
    s_add_u32 m0, s48, 147456
    s_nop 0
    buffer_load_dwordx4 v82, s[24:27], s46 offen  lds
    s_add_u32 s79, s41, 2
    s_and_b32 s79, s79, 3
    s_lshl_b32 s79, s79, 19
    s_add_u32 s79, s79, s47
    s_add_u32 s46, s79, 0x0
    s_add_u32 m0, s48, 81920
    s_nop 0
    buffer_load_dwordx4 v82, s[24:27], s46 offen  lds
    s_add_u32 s46, s79, 0x20000
    s_add_u32 m0, s48, 106496
    s_nop 0
    buffer_load_dwordx4 v82, s[24:27], s46 offen  lds
    s_add_u32 s46, s79, 0x40000
    s_add_u32 m0, s48, 131072
    s_nop 0
    buffer_load_dwordx4 v82, s[24:27], s46 offen  lds
    s_add_u32 s46, s79, 0x60000
    s_add_u32 m0, s48, 155648
    s_nop 0
    buffer_load_dwordx4 v82, s[24:27], s46 offen  lds
    s_add_u32 s79, s41, 3
    s_and_b32 s79, s79, 3
    s_lshl_b32 s79, s79, 19
    s_add_u32 s79, s79, s47
    s_add_u32 s46, s79, 0x0
    s_add_u32 m0, s48, 86016
    s_nop 0
    buffer_load_dwordx4 v82, s[24:27], s46 offen  lds
    s_add_u32 s46, s79, 0x20000
    s_add_u32 m0, s48, 110592
    s_nop 0
    buffer_load_dwordx4 v82, s[24:27], s46 offen  lds
    s_add_u32 s46, s79, 0x40000
    s_add_u32 m0, s48, 135168
    s_nop 0
    buffer_load_dwordx4 v82, s[24:27], s46 offen  lds
    s_add_u32 s46, s79, 0x60000
    s_add_u32 m0, s48, 159744
    s_nop 0
    buffer_load_dwordx4 v82, s[24:27], s46 offen  lds
    s_add_u32 s79, s41, 4
    s_and_b32 s79, s79, 3
    s_lshl_b32 s79, s79, 19
    s_add_u32 s79, s79, s47
    s_add_u32 s46, s79, 0x200000
    s_add_u32 m0, s48, 0
    s_nop 0
    buffer_load_dwordx4 v82, s[24:27], s46 offen  lds
    s_add_u32 s46, s79, 0x220000
    s_add_u32 m0, s48, 4096
    s_nop 0
    buffer_load_dwordx4 v82, s[24:27], s46 offen  lds
    s_add_u32 s46, s79, 0x240000
    s_add_u32 m0, s48, 8192
    s_nop 0
    buffer_load_dwordx4 v82, s[24:27], s46 offen  lds
    s_add_u32 s46, s79, 0x260000
    s_add_u32 m0, s48, 12288
    s_nop 0
    buffer_load_dwordx4 v82, s[24:27], s46 offen  lds
    s_add_u32 s79, s41, 5
    s_and_b32 s79, s79, 3
    s_lshl_b32 s79, s79, 19
    s_add_u32 s79, s79, s47
    s_add_u32 s46, s79, 0x200000
    s_add_u32 m0, s48, 16384
    s_nop 0
    buffer_load_dwordx4 v82, s[24:27], s46 offen  lds
    s_add_u32 s46, s79, 0x220000
    s_add_u32 m0, s48, 20480
    s_nop 0
    buffer_load_dwordx4 v82, s[24:27], s46 offen  lds
    s_add_u32 s46, s79, 0x240000
    s_add_u32 m0, s48, 24576
    s_nop 0
    buffer_load_dwordx4 v82, s[24:27], s46 offen  lds
    s_add_u32 s46, s79, 0x260000
    s_add_u32 m0, s48, 28672
    s_nop 0
    buffer_load_dwordx4 v82, s[24:27], s46 offen  lds
    s_add_u32 s79, s41, 6
    s_and_b32 s79, s79, 3
    s_lshl_b32 s79, s79, 19
    s_add_u32 s79, s79, s47
    s_add_u32 s46, s79, 0x200000
    s_add_u32 m0, s48, 32768
    s_nop 0
    buffer_load_dwordx4 v82, s[24:27], s46 offen  lds
    s_add_u32 s46, s79, 0x220000
    s_add_u32 m0, s48, 36864
    s_nop 0
    buffer_load_dwordx4 v82, s[24:27], s46 offen  lds
    s_add_u32 s46, s79, 0x240000
    s_add_u32 m0, s48, 40960
    s_nop 0
    buffer_load_dwordx4 v82, s[24:27], s46 offen  lds
    s_add_u32 s46, s79, 0x260000
    s_add_u32 m0, s48, 45056
    s_nop 0
    buffer_load_dwordx4 v82, s[24:27], s46 offen  lds
    s_add_u32 s79, s41, 7
    s_and_b32 s79, s79, 3
    s_lshl_b32 s79, s79, 19
    s_add_u32 s79, s79, s47
    s_add_u32 s46, s79, 0x200000
    s_add_u32 m0, s48, 49152
    s_nop 0
    buffer_load_dwordx4 v82, s[24:27], s46 offen  lds
    s_add_u32 s46, s79, 0x220000
    s_add_u32 m0, s48, 53248
    s_nop 0
    buffer_load_dwordx4 v82, s[24:27], s46 offen  lds
    s_add_u32 s46, s79, 0x240000
    s_add_u32 m0, s48, 57344
    s_nop 0
    buffer_load_dwordx4 v82, s[24:27], s46 offen  lds
    s_add_u32 s46, s79, 0x260000
    s_add_u32 m0, s48, 61440
    s_nop 0
    buffer_load_dwordx4 v82, s[24:27], s46 offen  lds
    s_waitcnt vmcnt(28)
    s_barrier
    s_cmp_lg_u32 s44, 0
    s_cbranch_scc1 L_lw_4_0
    ds_read_b64_tr_b16 a[0:1], v84 offset:4096
    ds_read_b64_tr_b16 a[2:3], v84 offset:5120
    ds_read_b64_tr_b16 a[4:5], v86 offset:4096
    ds_read_b64_tr_b16 a[6:7], v86 offset:5120
    ds_read_b64_tr_b16 a[8:9], v85 offset:4096
    ds_read_b64_tr_b16 a[10:11], v85 offset:5120
    ds_read_b64_tr_b16 a[12:13], v87 offset:4096
    ds_read_b64_tr_b16 a[14:15], v87 offset:5120
    s_branch L_lw_4
L_lw_4_0:
    s_cmp_lg_u32 s44, 1
    s_cbranch_scc1 L_lw_4_1
    ds_read_b64_tr_b16 v[128:129], v84 offset:4096
    ds_read_b64_tr_b16 v[130:131], v84 offset:5120
    ds_read_b64_tr_b16 v[132:133], v86 offset:4096
    ds_read_b64_tr_b16 v[134:135], v86 offset:5120
    ds_read_b64_tr_b16 v[136:137], v85 offset:4096
    ds_read_b64_tr_b16 v[138:139], v85 offset:5120
    ds_read_b64_tr_b16 v[140:141], v87 offset:4096
    ds_read_b64_tr_b16 v[142:143], v87 offset:5120
    s_branch L_lw_4
L_lw_4_1:
    s_cmp_lg_u32 s44, 2
    s_cbranch_scc1 L_lw_4_2
    ds_read_b64_tr_b16 a[192:193], v84 offset:4096
    ds_read_b64_tr_b16 a[194:195], v84 offset:5120
    ds_read_b64_tr_b16 a[196:197], v86 offset:4096
    ds_read_b64_tr_b16 a[198:199], v86 offset:5120
    ds_read_b64_tr_b16 v[56:57], v85 offset:4096
    ds_read_b64_tr_b16 v[58:59], v85 offset:5120
    ds_read_b64_tr_b16 v[60:61], v87 offset:4096
    ds_read_b64_tr_b16 v[62:63], v87 offset:5120
    s_waitcnt lgkmcnt(0)
    ds_write_b128 v5, v[56:59] offset:0
    ds_write_b128 v5, v[60:63] offset:1024
    s_branch L_lw_4
L_lw_4_2:
    ds_read_b64_tr_b16 a[96:97], v84 offset:4096
    ds_read_b64_tr_b16 a[98:99], v84 offset:5120
    ds_read_b64_tr_b16 a[100:101], v86 offset:4096
    ds_read_b64_tr_b16 a[102:103], v86 offset:5120
    ds_read_b64_tr_b16 v[56:57], v85 offset:4096
    ds_read_b64_tr_b16 v[58:59], v85 offset:5120
    ds_read_b64_tr_b16 v[60:61], v87 offset:4096
    ds_read_b64_tr_b16 v[62:63], v87 offset:5120
    s_waitcnt lgkmcnt(0)
    ds_write_b128 v5, v[56:59] offset:2048
    ds_write_b128 v5, v[60:63] offset:3072
L_lw_4:
    s_waitcnt lgkmcnt(0)
    s_waitcnt vmcnt(24)
    s_barrier
    s_cmp_lg_u32 s44, 0
    s_cbranch_scc1 L_hs_5
    s_getreg_b32 s45, hwreg(HW_REG_XCC_ID)
    s_and_b32 s45, s45, 15
    s_mul_i32 s46, s45, s45
    s_lshl_b32 s46, s46, 9
    s_add_u32 s45, s45, s46
    s_cmp_eq_u32 s40, 0
    s_cselect_b32 s46, s45, 0
    s_cselect_b32 s45, 0, s45
    s_lshl_b32 s68, s68, 24
    s_add_u32 s46, s46, s68
    s_add_u32 s45, s45, 16777216
    v_mov_b32 v40, s46
    v_mov_b32 v41, s45
    v_mov_b32 v42, 0
    s_mov_b64 exec, 1
    buffer_atomic_add_x2 v[40:41], v42, s[16:19], 0 offen sc1
    v_mov_b32 v43, 1
    buffer_atomic_add v43, v42, s[16:19], 0 offen offset:8 sc1
    s_mov_b64 exec, -1
L_hs_5:
    s_cmp_lg_u32 s44, 0
    s_cbranch_scc1 L_lw_6_0
    ds_read_b64_tr_b16 a[32:33], v84 offset:8192
    ds_read_b64_tr_b16 a[34:35], v84 offset:9216
    ds_read_b64_tr_b16 a[36:37], v86 offset:8192
    ds_read_b64_tr_b16 a[38:39], v86 offset:9216
    ds_read_b64_tr_b16 a[40:41], v85 offset:8192
    ds_read_b64_tr_b16 a[42:43], v85 offset:9216
    ds_read_b64_tr_b16 a[44:45], v87 offset:8192
    ds_read_b64_tr_b16 a[46:47], v87 offset:9216
    s_branch L_lw_6
L_lw_6_0:
    s_cmp_lg_u32 s44, 1
    s_cbranch_scc1 L_lw_6_1
    ds_read_b64_tr_b16 v[160:161], v84 offset:8192
    ds_read_b64_tr_b16 v[162:163], v84 offset:9216
    ds_read_b64_tr_b16 v[164:165], v86 offset:8192
    ds_read_b64_tr_b16 v[166:167], v86 offset:9216
    ds_read_b64_tr_b16 v[168:169], v85 offset:8192
    ds_read_b64_tr_b16 v[170:171], v85 offset:9216
    ds_read_b64_tr_b16 v[172:173], v87 offset:8192
    ds_read_b64_tr_b16 v[174:175], v87 offset:9216
    s_branch L_lw_6
L_lw_6_1:
    s_cmp_lg_u32 s44, 2
    s_cbranch_scc1 L_lw_6_2
    ds_read_b64_tr_b16 a[216:217], v84 offset:8192
    ds_read_b64_tr_b16 a[218:219], v84 offset:9216
    ds_read_b64_tr_b16 a[220:221], v86 offset:8192
    ds_read_b64_tr_b16 a[222:223], v86 offset:9216
    ds_read_b64_tr_b16 v[56:57], v85 offset:8192
    ds_read_b64_tr_b16 v[58:59], v85 offset:9216
    ds_read_b64_tr_b16 v[60:61], v87 offset:8192
    ds_read_b64_tr_b16 v[62:63], v87 offset:9216
    s_waitcnt lgkmcnt(0)
    ds_write_b128 v5, v[56:59] offset:4096
    ds_write_b128 v5, v[60:63] offset:5120
    s_branch L_lw_6
L_lw_6_2:
    ds_read_b64_tr_b16 a[120:121], v84 offset:8192
    ds_read_b64_tr_b16 a[122:123], v84 offset:9216
    ds_read_b64_tr_b16 a[124:125], v86 offset:8192
    ds_read_b64_tr_b16 a[126:127], v86 offset:9216
    ds_read_b64_tr_b16 v[56:57], v85 offset:8192
    ds_read_b64_tr_b16 v[58:59], v85 offset:9216
    ds_read_b64_tr_b16 v[60:61], v87 offset:8192
    ds_read_b64_tr_b16 v[62:63], v87 offset:9216
    s_waitcnt lgkmcnt(0)
    ds_write_b128 v5, v[56:59] offset:6144
    ds_write_b128 v5, v[60:63] offset:7168
L_lw_6:
    s_waitcnt lgkmcnt(0)
    s_waitcnt vmcnt(20)
    s_barrier
    s_cmp_lg_u32 s44, 0
    s_cbranch_scc1 L_lw_7_0
    ds_read_b64_tr_b16 a[64:65], v84 offset:16384
    ds_read_b64_tr_b16 a[66:67], v84 offset:17408
    ds_read_b64_tr_b16 a[68:69], v86 offset:16384
    ds_read_b64_tr_b16 a[70:71], v86 offset:17408
    ds_read_b64_tr_b16 v[56:57], v85 offset:16384
    ds_read_b64_tr_b16 v[58:59], v85 offset:17408
    ds_read_b64_tr_b16 v[60:61], v87 offset:16384
    ds_read_b64_tr_b16 v[62:63], v87 offset:17408
    s_waitcnt lgkmcnt(0)
    ds_write_b128 v5, v[56:59] offset:8192
    ds_write_b128 v5, v[60:63] offset:9216
    s_branch L_lw_7
L_lw_7_0:
    s_cmp_lg_u32 s44, 1
    s_cbranch_scc1 L_lw_7_1
    ds_read_b64_tr_b16 v[192:193], v84 offset:16384
    ds_read_b64_tr_b16 v[194:195], v84 offset:17408
    ds_read_b64_tr_b16 v[196:197], v86 offset:16384
    ds_read_b64_tr_b16 v[198:199], v86 offset:17408
    ds_read_b64_tr_b16 v[200:201], v85 offset:16384
    ds_read_b64_tr_b16 v[202:203], v85 offset:17408
    ds_read_b64_tr_b16 v[204:205], v87 offset:16384
    ds_read_b64_tr_b16 v[206:207], v87 offset:17408
    s_branch L_lw_7
L_lw_7_1:
    s_cmp_lg_u32 s44, 2
    s_cbranch_scc1 L_lw_7_2
    ds_read_b64_tr_b16 a[240:241], v84 offset:16384
    ds_read_b64_tr_b16 a[242:243], v84 offset:17408
    ds_read_b64_tr_b16 a[244:245], v86 offset:16384
    ds_read_b64_tr_b16 a[246:247], v86 offset:17408
    ds_read_b64_tr_b16 v[56:57], v85 offset:16384
    ds_read_b64_tr_b16 v[58:59], v85 offset:17408
    ds_read_b64_tr_b16 v[60:61], v87 offset:16384
    ds_read_b64_tr_b16 v[62:63], v87 offset:17408
    s_waitcnt lgkmcnt(0)
    ds_write_b128 v5, v[56:59] offset:10240
    ds_write_b128 v5, v[60:63] offset:11264
    s_branch L_lw_7
L_lw_7_2:
    ds_read_b64_tr_b16 a[144:145], v84 offset:16384
    ds_read_b64_tr_b16 a[146:147], v84 offset:17408
    ds_read_b64_tr_b16 a[148:149], v86 offset:16384
    ds_read_b64_tr_b16 a[150:151], v86 offset:17408
    ds_read_b64_tr_b16 v[56:57], v85 offset:16384
    ds_read_b64_tr_b16 v[58:59], v85 offset:17408
    ds_read_b64_tr_b16 v[60:61], v87 offset:16384
    ds_read_b64_tr_b16 v[62:63], v87 offset:17408
    s_waitcnt lgkmcnt(0)
    ds_write_b128 v5, v[56:59] offset:12288
    ds_write_b128 v5, v[60:63] offset:13312
L_lw_7:
    s_waitcnt lgkmcnt(0)
    s_waitcnt vmcnt(16)
    s_barrier
    s_cmp_lg_u32 s44, 0
    s_cbranch_scc1 L_lw_8_0
    ds_read_b64_tr_b16 a[80:81], v84 offset:20480
    ds_read_b64_tr_b16 a[82:83], v84 offset:21504
    ds_read_b64_tr_b16 a[84:85], v86 offset:20480
    ds_read_b64_tr_b16 a[86:87], v86 offset:21504
    ds_read_b64_tr_b16 v[56:57], v85 offset:20480
    ds_read_b64_tr_b16 v[58:59], v85 offset:21504
    ds_read_b64_tr_b16 v[60:61], v87 offset:20480
    ds_read_b64_tr_b16 v[62:63], v87 offset:21504
    s_waitcnt lgkmcnt(0)
    ds_write_b128 v5, v[56:59] offset:14336
    ds_write_b128 v5, v[60:63] offset:15360
    s_branch L_lw_8
L_lw_8_0:
    s_cmp_lg_u32 s44, 1
    s_cbranch_scc1 L_lw_8_1
    ds_read_b64_tr_b16 v[224:225], v84 offset:20480
    ds_read_b64_tr_b16 v[226:227], v84 offset:21504
    ds_read_b64_tr_b16 v[228:229], v86 offset:20480
    ds_read_b64_tr_b16 v[230:231], v86 offset:21504
    ds_read_b64_tr_b16 v[232:233], v85 offset:20480
    ds_read_b64_tr_b16 v[234:235], v85 offset:21504
    ds_read_b64_tr_b16 v[236:237], v87 offset:20480
    ds_read_b64_tr_b16 v[238:239], v87 offset:21504
    s_branch L_lw_8
L_lw_8_1:
    s_cmp_lg_u32 s44, 2
    s_cbranch_scc1 L_lw_8_2
    ds_read_b64_tr_b16 v[104:105], v84 offset:20480
    ds_read_b64_tr_b16 v[106:107], v84 offset:21504
    ds_read_b64_tr_b16 v[108:109], v86 offset:20480
    ds_read_b64_tr_b16 v[110:111], v86 offset:21504
    ds_read_b64_tr_b16 v[56:57], v85 offset:20480
    ds_read_b64_tr_b16 v[58:59], v85 offset:21504
    ds_read_b64_tr_b16 v[60:61], v87 offset:20480
    ds_read_b64_tr_b16 v[62:63], v87 offset:21504
    s_waitcnt lgkmcnt(0)
    ds_write_b128 v5, v[56:59] offset:16384
    ds_write_b128 v5, v[60:63] offset:17408
    s_branch L_lw_8
L_lw_8_2:
    ds_read_b64_tr_b16 a[168:169], v84 offset:20480
    ds_read_b64_tr_b16 a[170:171], v84 offset:21504
    ds_read_b64_tr_b16 a[172:173], v86 offset:20480
    ds_read_b64_tr_b16 a[174:175], v86 offset:21504
    ds_read_b64_tr_b16 v[56:57], v85 offset:20480
    ds_read_b64_tr_b16 v[58:59], v85 offset:21504
    ds_read_b64_tr_b16 v[60:61], v87 offset:20480
    ds_read_b64_tr_b16 v[62:63], v87 offset:21504
    s_waitcnt lgkmcnt(0)
    ds_write_b128 v5, v[56:59] offset:18432
    ds_write_b128 v5, v[60:63] offset:19456
L_lw_8:
    s_waitcnt lgkmcnt(0)
    s_waitcnt vmcnt(12)
    s_barrier
    s_add_u32 s79, s41, 8
    s_and_b32 s79, s79, 3
    s_lshl_b32 s79, s79, 19
    s_add_u32 s79, s79, s47
    s_add_u32 s46, s79, 0x400000
    s_add_u32 m0, s48, 86016
    s_nop 0
    buffer_load_dwordx4 v82, s[24:27], s46 offen  lds
    s_add_u32 s46, s79, 0x420000
    s_add_u32 m0, s48, 110592
    s_nop 0
    buffer_load_dwordx4 v82, s[24:27], s46 offen  lds
    s_add_u32 s46, s79, 0x440000
    s_add_u32 m0, s48, 135168
    s_nop 0
    buffer_load_dwordx4 v82, s[24:27], s46 offen  lds
    s_add_u32 s46, s79, 0x460000
    s_add_u32 m0, s48, 159744
    s_nop 0
    buffer_load_dwordx4 v82, s[24:27], s46 offen  lds
    s_cmp_lg_u32 s44, 0
    s_cbranch_scc1 L_lw_9_0
    ds_read_b64_tr_b16 a[96:97], v80 offset:0
    ds_read_b64_tr_b16 a[98:99], v80 offset:1024
    ds_read_b64_tr_b16 a[100:101], v80 offset:8192
    ds_read_b64_tr_b16 a[102:103], v80 offset:9216
    ds_read_b64_tr_b16 v[56:57], v81 offset:0
    ds_read_b64_tr_b16 v[58:59], v81 offset:1024
    ds_read_b64_tr_b16 v[60:61], v81 offset:8192
    ds_read_b64_tr_b16 v[62:63], v81 offset:9216
    s_waitcnt lgkmcnt(0)
    ds_write_b128 v5, v[56:59] offset:2048
    ds_write_b128 v5, v[60:63] offset:3072
    s_branch L_lw_9
L_lw_9_0:
    s_cmp_lg_u32 s44, 1
    s_cbranch_scc1 L_lw_9_1
    ds_read_b64_tr_b16 a[0:1], v80 offset:0
    ds_read_b64_tr_b16 a[2:3], v80 offset:1024
    ds_read_b64_tr_b16 a[4:5], v80 offset:8192
    ds_read_b64_tr_b16 a[6:7], v80 offset:9216
    ds_read_b64_tr_b16 a[8:9], v81 offset:0
    ds_read_b64_tr_b16 a[10:11], v81 offset:1024
    ds_read_b64_tr_b16 a[12:13], v81 offset:8192
    ds_read_b64_tr_b16 a[14:15], v81 offset:9216
    s_branch L_lw_9
L_lw_9_1:
    s_cmp_lg_u32 s44, 2
    s_cbranch_scc1 L_lw_9_2
    ds_read_b64_tr_b16 v[128:129], v80 offset:0
    ds_read_b64_tr_b16 v[130:131], v80 offset:1024
    ds_read_b64_tr_b16 v[132:133], v80 offset:8192
    ds_read_b64_tr_b16 v[134:135], v80 offset:9216
    ds_read_b64_tr_b16 v[136:137], v81 offset:0
    ds_read_b64_tr_b16 v[138:139], v81 offset:1024
    ds_read_b64_tr_b16 v[140:141], v81 offset:8192
    ds_read_b64_tr_b16 v[142:143], v81 offset:9216
    s_branch L_lw_9
L_lw_9_2:
    ds_read_b64_tr_b16 a[192:193], v80 offset:0
    ds_read_b64_tr_b16 a[194:195], v80 offset:1024
    ds_read_b64_tr_b16 a[196:197], v80 offset:8192
    ds_read_b64_tr_b16 a[198:199], v80 offset:9216
    ds_read_b64_tr_b16 v[56:57], v81 offset:0
    ds_read_b64_tr_b16 v[58:59], v81 offset:1024
    ds_read_b64_tr_b16 v[60:61], v81 offset:8192
    ds_read_b64_tr_b16 v[62:63], v81 offset:9216
    s_waitcnt lgkmcnt(0)
    ds_write_b128 v5, v[56:59] offset:0
    ds_write_b128 v5, v[60:63] offset:1024
L_lw_9:
    s_waitcnt lgkmcnt(0)
    s_waitcnt vmcnt(12)
    s_barrier
    s_add_u32 s79, s41, 9
    s_and_b32 s79, s79, 3
    s_lshl_b32 s79, s79, 19
    s_add_u32 s79, s79, s47
    s_add_u32 s46, s79, 0x400000
    s_add_u32 m0, s48, 0
    s_nop 0
    buffer_load_dwordx4 v82, s[24:27], s46 offen  lds
    s_add_u32 s46, s79, 0x420000
    s_add_u32 m0, s48, 4096
    s_nop 0
    buffer_load_dwordx4 v82, s[24:27], s46 offen  lds
    s_add_u32 s46, s79, 0x440000
    s_add_u32 m0, s48, 8192
    s_nop 0
    buffer_load_dwordx4 v82, s[24:27], s46 offen  lds
    s_add_u32 s46, s79, 0x460000
    s_add_u32 m0, s48, 12288
    s_nop 0
    buffer_load_dwordx4 v82, s[24:27], s46 offen  lds
    s_cmp_lg_u32 s44, 0
    s_cbranch_scc1 L_lw_10_0
    ds_read_b64_tr_b16 a[120:121], v80 offset:16384
    ds_read_b64_tr_b16 a[122:123], v80 offset:17408
    ds_read_b64_tr_b16 a[124:125], v80 offset:24576
    ds_read_b64_tr_b16 a[126:127], v80 offset:25600
    ds_read_b64_tr_b16 v[56:57], v81 offset:16384
    ds_read_b64_tr_b16 v[58:59], v81 offset:17408
    ds_read_b64_tr_b16 v[60:61], v81 offset:24576
    ds_read_b64_tr_b16 v[62:63], v81 offset:25600
    s_waitcnt lgkmcnt(0)
    ds_write_b128 v5, v[56:59] offset:6144
    ds_write_b128 v5, v[60:63] offset:7168
    s_branch L_lw_10
L_lw_10_0:
    s_cmp_lg_u32 s44, 1
    s_cbranch_scc1 L_lw_10_1
    ds_read_b64_tr_b16 a[32:33], v80 offset:16384
    ds_read_b64_tr_b16 a[34:35], v80 offset:17408
    ds_read_b64_tr_b16 a[36:37], v80 offset:24576
    ds_read_b64_tr_b16 a[38:39], v80 offset:25600
    ds_read_b64_tr_b16 a[40:41], v81 offset:16384
    ds_read_b64_tr_b16 a[42:43], v81 offset:17408
    ds_read_b64_tr_b16 a[44:45], v81 offset:24576
    ds_read_b64_tr_b16 a[46:47], v81 offset:25600
    s_branch L_lw_10
L_lw_10_1:
    s_cmp_lg_u32 s44, 2
    s_cbranch_scc1 L_lw_10_2
    ds_read_b64_tr_b16 v[160:161], v80 offset:16384
    ds_read_b64_tr_b16 v[162:163], v80 offset:17408
    ds_read_b64_tr_b16 v[164:165], v80 offset:24576
    ds_read_b64_tr_b16 v[166:167], v80 offset:25600
    ds_read_b64_tr_b16 v[168:169], v81 offset:16384
    ds_read_b64_tr_b16 v[170:171], v81 offset:17408
    ds_read_b64_tr_b16 v[172:173], v81 offset:24576
    ds_read_b64_tr_b16 v[174:175], v81 offset:25600
    s_branch L_lw_10
L_lw_10_2:
    ds_read_b64_tr_b16 a[216:217], v80 offset:16384
    ds_read_b64_tr_b16 a[218:219], v80 offset:17408
    ds_read_b64_tr_b16 a[220:221], v80 offset:24576
    ds_read_b64_tr_b16 a[222:223], v80 offset:25600
    ds_read_b64_tr_b16 v[56:57], v81 offset:16384
    ds_read_b64_tr_b16 v[58:59], v81 offset:17408
    ds_read_b64_tr_b16 v[60:61], v81 offset:24576
    ds_read_b64_tr_b16 v[62:63], v81 offset:25600
    s_waitcnt lgkmcnt(0)
    ds_write_b128 v5, v[56:59] offset:4096
    ds_write_b128 v5, v[60:63] offset:5120
L_lw_10:
    s_waitcnt lgkmcnt(0)
    s_waitcnt vmcnt(12)
    s_barrier
    s_add_u32 s79, s41, 10
    s_and_b32 s79, s79, 3
    s_lshl_b32 s79, s79, 19
    s_add_u32 s79, s79, s47
    s_add_u32 s46, s79, 0x400000
    s_add_u32 m0, s48, 16384
    s_nop 0
    buffer_load_dwordx4 v82, s[24:27], s46 offen  lds
    s_add_u32 s46, s79, 0x420000
    s_add_u32 m0, s48, 20480
    s_nop 0
    buffer_load_dwordx4 v82, s[24:27], s46 offen  lds
    s_add_u32 s46, s79, 0x440000
    s_add_u32 m0, s48, 24576
    s_nop 0
    buffer_load_dwordx4 v82, s[24:27], s46 offen  lds
    s_add_u32 s46, s79, 0x460000
    s_add_u32 m0, s48, 28672
    s_nop 0
    buffer_load_dwordx4 v82, s[24:27], s46 offen  lds
    s_cmp_lg_u32 s44, 0
    s_cbranch_scc1 L_lw_11_0
    ds_read_b64_tr_b16 a[144:145], v80 offset:32768
    ds_read_b64_tr_b16 a[146:147], v80 offset:33792
    ds_read_b64_tr_b16 a[148:149], v80 offset:40960
    ds_read_b64_tr_b16 a[150:151], v80 offset:41984
    ds_read_b64_tr_b16 v[56:57], v81 offset:32768
    ds_read_b64_tr_b16 v[58:59], v81 offset:33792
    ds_read_b64_tr_b16 v[60:61], v81 offset:40960
    ds_read_b64_tr_b16 v[62:63], v81 offset:41984
    s_waitcnt lgkmcnt(0)
    ds_write_b128 v5, v[56:59] offset:12288
    ds_write_b128 v5, v[60:63] offset:13312
    s_branch L_lw_11
L_lw_11_0:
    s_cmp_lg_u32 s44, 1
    s_cbranch_scc1 L_lw_11_1
    ds_read_b64_tr_b16 a[64:65], v80 offset:32768
    ds_read_b64_tr_b16 a[66:67], v80 offset:33792
    ds_read_b64_tr_b16 a[68:69], v80 offset:40960
    ds_read_b64_tr_b16 a[70:71], v80 offset:41984
    ds_read_b64_tr_b16 v[56:57], v81 offset:32768
    ds_read_b64_tr_b16 v[58:59], v81 offset:33792
    ds_read_b64_tr_b16 v[60:61], v81 offset:40960
    ds_read_b64_tr_b16 v[62:63], v81 offset:41984
    s_waitcnt lgkmcnt(0)
    ds_write_b128 v5, v[56:59] offset:8192
    ds_write_b128 v5, v[60:63] offset:9216
    s_branch L_lw_11
L_lw_11_1:
    s_cmp_lg_u32 s44, 2
    s_cbranch_scc1 L_lw_11_2
    ds_read_b64_tr_b16 v[192:193], v80 offset:32768
    ds_read_b64_tr_b16 v[194:195], v80 offset:33792
    ds_read_b64_tr_b16 v[196:197], v80 offset:40960
    ds_read_b64_tr_b16 v[198:199], v80 offset:41984
    ds_read_b64_tr_b16 v[200:201], v81 offset:32768
    ds_read_b64_tr_b16 v[202:203], v81 offset:33792
    ds_read_b64_tr_b16 v[204:205], v81 offset:40960
    ds_read_b64_tr_b16 v[206:207], v81 offset:41984
    s_branch L_lw_11
L_lw_11_2:
    ds_read_b64_tr_b16 a[240:241], v80 offset:32768
    ds_read_b64_tr_b16 a[242:243], v80 offset:33792
    ds_read_b64_tr_b16 a[244:245], v80 offset:40960
    ds_read_b64_tr_b16 a[246:247], v80 offset:41984
    ds_read_b64_tr_b16 v[56:57], v81 offset:32768
    ds_read_b64_tr_b16 v[58:59], v81 offset:33792
    ds_read_b64_tr_b16 v[60:61], v81 offset:40960
    ds_read_b64_tr_b16 v[62:63], v81 offset:41984
    s_waitcnt lgkmcnt(0)
    ds_write_b128 v5, v[56:59] offset:10240
    ds_write_b128 v5, v[60:63] offset:11264
L_lw_11:
    s_waitcnt lgkmcnt(0)
    s_waitcnt vmcnt(12)
    s_barrier
    s_add_u32 s79, s41, 11
    s_and_b32 s79, s79, 3
    s_lshl_b32 s79, s79, 19
    s_add_u32 s79, s79, s47
    s_add_u32 s46, s79, 0x400000
    s_add_u32 m0, s48, 32768
    s_nop 0
    buffer_load_dwordx4 v82, s[24:27], s46 offen  lds
    s_add_u32 s46, s79, 0x420000
    s_add_u32 m0, s48, 36864
    s_nop 0
    buffer_load_dwordx4 v82, s[24:27], s46 offen  lds
    s_add_u32 s46, s79, 0x440000
    s_add_u32 m0, s48, 40960
    s_nop 0
    buffer_load_dwordx4 v82, s[24:27], s46 offen  lds
    s_add_u32 s46, s79, 0x460000
    s_add_u32 m0, s48, 45056
    s_nop 0
    buffer_load_dwordx4 v82, s[24:27], s46 offen  lds
    s_cmp_lg_u32 s44, 0
    s_cbranch_scc1 L_lw_12_0
    ds_read_b64_tr_b16 a[168:169], v80 offset:49152
    ds_read_b64_tr_b16 a[170:171], v80 offset:50176
    ds_read_b64_tr_b16 a[172:173], v80 offset:57344
    ds_read_b64_tr_b16 a[174:175], v80 offset:58368
    ds_read_b64_tr_b16 v[56:57], v81 offset:49152
    ds_read_b64_tr_b16 v[58:59], v81 offset:50176
    ds_read_b64_tr_b16 v[60:61], v81 offset:57344
    ds_read_b64_tr_b16 v[62:63], v81 offset:58368
    s_waitcnt lgkmcnt(0)
    ds_write_b128 v5, v[56:59] offset:18432
    ds_write_b128 v5, v[60:63] offset:19456
    s_branch L_lw_12
L_lw_12_0:
    s_cmp_lg_u32 s44, 1
    s_cbranch_scc1 L_lw_12_1
    ds_read_b64_tr_b16 a[80:81], v80 offset:49152
    ds_read_b64_tr_b16 a[82:83], v80 offset:50176
    ds_read_b64_tr_b16 a[84:85], v80 offset:57344
    ds_read_b64_tr_b16 a[86:87], v80 offset:58368
    ds_read_b64_tr_b16 v[56:57], v81 offset:49152
    ds_read_b64_tr_b16 v[58:59], v81 offset:50176
    ds_read_b64_tr_b16 v[60:61], v81 offset:57344
    ds_read_b64_tr_b16 v[62:63], v81 offset:58368
    s_waitcnt lgkmcnt(0)
    ds_write_b128 v5, v[56:59] offset:14336
    ds_write_b128 v5, v[60:63] offset:15360
    s_branch L_lw_12
L_lw_12_1:
    s_cmp_lg_u32 s44, 2
    s_cbranch_scc1 L_lw_12_2
    ds_read_b64_tr_b16 v[224:225], v80 offset:49152
    ds_read_b64_tr_b16 v[226:227], v80 offset:50176
    ds_read_b64_tr_b16 v[228:229], v80 offset:57344
    ds_read_b64_tr_b16 v[230:231], v80 offset:58368
    ds_read_b64_tr_b16 v[232:233], v81 offset:49152
    ds_read_b64_tr_b16 v[234:235], v81 offset:50176
    ds_read_b64_tr_b16 v[236:237], v81 offset:57344
    ds_read_b64_tr_b16 v[238:239], v81 offset:58368
    s_branch L_lw_12
L_lw_12_2:
    ds_read_b64_tr_b16 v[104:105], v80 offset:49152
    ds_read_b64_tr_b16 v[106:107], v80 offset:50176
    ds_read_b64_tr_b16 v[108:109], v80 offset:57344
    ds_read_b64_tr_b16 v[110:111], v80 offset:58368
    ds_read_b64_tr_b16 v[56:57], v81 offset:49152
    ds_read_b64_tr_b16 v[58:59], v81 offset:50176
    ds_read_b64_tr_b16 v[60:61], v81 offset:57344
    ds_read_b64_tr_b16 v[62:63], v81 offset:58368
    s_waitcnt lgkmcnt(0)
    ds_write_b128 v5, v[56:59] offset:16384
    ds_write_b128 v5, v[60:63] offset:17408
L_lw_12:
    s_waitcnt lgkmcnt(0)
    s_waitcnt vmcnt(12)
    s_barrier
    s_add_u32 s79, s41, 12
    s_and_b32 s79, s79, 3
    s_lshl_b32 s79, s79, 19
    s_add_u32 s79, s79, s47
    s_add_u32 s46, s79, 0x600000
    s_add_u32 m0, s48, 49152
    s_nop 0
    buffer_load_dwordx4 v82, s[24:27], s46 offen  lds
    s_add_u32 s46, s79, 0x620000
    s_add_u32 m0, s48, 53248
    s_nop 0
    buffer_load_dwordx4 v82, s[24:27], s46 offen  lds
    s_add_u32 s46, s79, 0x640000
    s_add_u32 m0, s48, 57344
    s_nop 0
    buffer_load_dwordx4 v82, s[24:27], s46 offen  lds
    s_add_u32 s46, s79, 0x660000
    s_add_u32 m0, s48, 61440
    s_nop 0
    buffer_load_dwordx4 v82, s[24:27], s46 offen  lds
    s_cmp_lg_u32 s44, 0
    s_cbranch_scc1 L_lw_13_0
    ds_read_b64_tr_b16 a[192:193], v84 offset:20480
    ds_read_b64_tr_b16 a[194:195], v84 offset:21504
    ds_read_b64_tr_b16 a[196:197], v86 offset:20480
    ds_read_b64_tr_b16 a[198:199], v86 offset:21504
    ds_read_b64_tr_b16 v[56:57], v85 offset:20480
    ds_read_b64_tr_b16 v[58:59], v85 offset:21504
    ds_read_b64_tr_b16 v[60:61], v87 offset:20480
    ds_read_b64_tr_b16 v[62:63], v87 offset:21504
    s_waitcnt lgkmcnt(0)
    ds_write_b128 v5, v[56:59] offset:0
    ds_write_b128 v5, v[60:63] offset:1024
    s_branch L_lw_13
L_lw_13_0:
    s_cmp_lg_u32 s44, 1
    s_cbranch_scc1 L_lw_13_1
    ds_read_b64_tr_b16 a[96:97], v84 offset:20480
    ds_read_b64_tr_b16 a[98:99], v84 offset:21504
    ds_read_b64_tr_b16 a[100:101], v86 offset:20480
    ds_read_b64_tr_b16 a[102:103], v86 offset:21504
    ds_read_b64_tr_b16 v[56:57], v85 offset:20480
    ds_read_b64_tr_b16 v[58:59], v85 offset:21504
    ds_read_b64_tr_b16 v[60:61], v87 offset:20480
    ds_read_b64_tr_b16 v[62:63], v87 offset:21504
    s_waitcnt lgkmcnt(0)
    ds_write_b128 v5, v[56:59] offset:2048
    ds_write_b128 v5, v[60:63] offset:3072
    s_branch L_lw_13
L_lw_13_1:
    s_cmp_lg_u32 s44, 2
    s_cbranch_scc1 L_lw_13_2
    ds_read_b64_tr_b16 a[0:1], v84 offset:20480
    ds_read_b64_tr_b16 a[2:3], v84 offset:21504
    ds_read_b64_tr_b16 a[4:5], v86 offset:20480
    ds_read_b64_tr_b16 a[6:7], v86 offset:21504
    ds_read_b64_tr_b16 a[8:9], v85 offset:20480
    ds_read_b64_tr_b16 a[10:11], v85 offset:21504
    ds_read_b64_tr_b16 a[12:13], v87 offset:20480
    ds_read_b64_tr_b16 a[14:15], v87 offset:21504
    s_branch L_lw_13
L_lw_13_2:
    ds_read_b64_tr_b16 v[128:129], v84 offset:20480
    ds_read_b64_tr_b16 v[130:131], v84 offset:21504
    ds_read_b64_tr_b16 v[132:133], v86 offset:20480
    ds_read_b64_tr_b16 v[134:135], v86 offset:21504
    ds_read_b64_tr_b16 v[136:137], v85 offset:20480
    ds_read_b64_tr_b16 v[138:139], v85 offset:21504
    ds_read_b64_tr_b16 v[140:141], v87 offset:20480
    ds_read_b64_tr_b16 v[142:143], v87 offset:21504
L_lw_13:
    s_waitcnt lgkmcnt(0)
    s_waitcnt vmcnt(12)
    s_barrier
    s_add_u32 s79, s41, 13
    s_and_b32 s79, s79, 3
    s_lshl_b32 s79, s79, 19
    s_add_u32 s79, s79, s47
    s_add_u32 s46, s79, 0x600000
    s_add_u32 m0, s48, 86016
    s_nop 0
    buffer_load_dwordx4 v82, s[24:27], s46 offen  lds
    s_add_u32 s46, s79, 0x620000
    s_add_u32 m0, s48, 110592
    s_nop 0
    buffer_load_dwordx4 v82, s[24:27], s46 offen  lds
    s_add_u32 s46, s79, 0x640000
    s_add_u32 m0, s48, 135168
    s_nop 0
    buffer_load_dwordx4 v82, s[24:27], s46 offen  lds
    s_add_u32 s46, s79, 0x660000
    s_add_u32 m0, s48, 159744
    s_nop 0
    buffer_load_dwordx4 v82, s[24:27], s46 offen  lds
    s_cmp_lg_u32 s44, 0
    s_cbranch_scc1 L_lw_14_0
    ds_read_b64_tr_b16 a[216:217], v80 offset:0
    ds_read_b64_tr_b16 a[218:219], v80 offset:1024
    ds_read_b64_tr_b16 a[220:221], v80 offset:8192
    ds_read_b64_tr_b16 a[222:223], v80 offset:9216
    ds_read_b64_tr_b16 v[56:57], v81 offset:0
    ds_read_b64_tr_b16 v[58:59], v81 offset:1024
    ds_read_b64_tr_b16 v[60:61], v81 offset:8192
    ds_read_b64_tr_b16 v[62:63], v81 offset:9216
    s_waitcnt lgkmcnt(0)
    ds_write_b128 v5, v[56:59] offset:4096
    ds_write_b128 v5, v[60:63] offset:5120
    s_branch L_lw_14
L_lw_14_0:
    s_cmp_lg_u32 s44, 1
    s_cbranch_scc1 L_lw_14_1
    ds_read_b64_tr_b16 a[120:121], v80 offset:0
    ds_read_b64_tr_b16 a[122:123], v80 offset:1024
    ds_read_b64_tr_b16 a[124:125], v80 offset:8192
    ds_read_b64_tr_b16 a[126:127], v80 offset:9216
    ds_read_b64_tr_b16 v[56:57], v81 offset:0
    ds_read_b64_tr_b16 v[58:59], v81 offset:1024
    ds_read_b64_tr_b16 v[60:61], v81 offset:8192
    ds_read_b64_tr_b16 v[62:63], v81 offset:9216
    s_waitcnt lgkmcnt(0)
    ds_write_b128 v5, v[56:59] offset:6144
    ds_write_b128 v5, v[60:63] offset:7168
    s_branch L_lw_14
L_lw_14_1:
    s_cmp_lg_u32 s44, 2
    s_cbranch_scc1 L_lw_14_2
    ds_read_b64_tr_b16 a[32:33], v80 offset:0
    ds_read_b64_tr_b16 a[34:35], v80 offset:1024
    ds_read_b64_tr_b16 a[36:37], v80 offset:8192
    ds_read_b64_tr_b16 a[38:39], v80 offset:9216
    ds_read_b64_tr_b16 a[40:41], v81 offset:0
    ds_read_b64_tr_b16 a[42:43], v81 offset:1024
    ds_read_b64_tr_b16 a[44:45], v81 offset:8192
    ds_read_b64_tr_b16 a[46:47], v81 offset:9216
    s_branch L_lw_14
L_lw_14_2:
    ds_read_b64_tr_b16 v[160:161], v80 offset:0
    ds_read_b64_tr_b16 v[162:163], v80 offset:1024
    ds_read_b64_tr_b16 v[164:165], v80 offset:8192
    ds_read_b64_tr_b16 v[166:167], v80 offset:9216
    ds_read_b64_tr_b16 v[168:169], v81 offset:0
    ds_read_b64_tr_b16 v[170:171], v81 offset:1024
    ds_read_b64_tr_b16 v[172:173], v81 offset:8192
    ds_read_b64_tr_b16 v[174:175], v81 offset:9216
L_lw_14:
    s_waitcnt lgkmcnt(0)
    s_waitcnt vmcnt(12)
    s_barrier
    s_add_u32 s79, s41, 14
    s_and_b32 s79, s79, 3
    s_lshl_b32 s79, s79, 19
    s_add_u32 s79, s79, s47
    s_add_u32 s46, s79, 0x600000
    s_add_u32 m0, s48, 0
    s_nop 0
    buffer_load_dwordx4 v82, s[24:27], s46 offen  lds
    s_add_u32 s46, s79, 0x620000
    s_add_u32 m0, s48, 4096
    s_nop 0
    buffer_load_dwordx4 v82, s[24:27], s46 offen  lds
    s_add_u32 s46, s79, 0x640000
    s_add_u32 m0, s48, 8192
    s_nop 0
    buffer_load_dwordx4 v82, s[24:27], s46 offen  lds
    s_add_u32 s46, s79, 0x660000
    s_add_u32 m0, s48, 12288
    s_nop 0
    buffer_load_dwordx4 v82, s[24:27], s46 offen  lds
    s_cmp_lg_u32 s44, 0
    s_cbranch_scc1 L_lw_15_0
    ds_read_b64_tr_b16 a[240:241], v80 offset:16384
    ds_read_b64_tr_b16 a[242:243], v80 offset:17408
    ds_read_b64_tr_b16 a[244:245], v80 offset:24576
    ds_read_b64_tr_b16 a[246:247], v80 offset:25600
    ds_read_b64_tr_b16 v[56:57], v81 offset:16384
    ds_read_b64_tr_b16 v[58:59], v81 offset:17408
    ds_read_b64_tr_b16 v[60:61], v81 offset:24576
    ds_read_b64_tr_b16 v[62:63], v81 offset:25600
    s_waitcnt lgkmcnt(0)
    ds_write_b128 v5, v[56:59] offset:10240
    ds_write_b128 v5, v[60:63] offset:11264
    s_branch L_lw_15
L_lw_15_0:
    s_cmp_lg_u32 s44, 1
    s_cbranch_scc1 L_lw_15_1
    ds_read_b64_tr_b16 a[144:145], v80 offset:16384
    ds_read_b64_tr_b16 a[146:147], v80 offset:17408
    ds_read_b64_tr_b16 a[148:149], v80 offset:24576
    ds_read_b64_tr_b16 a[150:151], v80 offset:25600
    ds_read_b64_tr_b16 v[56:57], v81 offset:16384
    ds_read_b64_tr_b16 v[58:59], v81 offset:17408
    ds_read_b64_tr_b16 v[60:61], v81 offset:24576
    ds_read_b64_tr_b16 v[62:63], v81 offset:25600
    s_waitcnt lgkmcnt(0)
    ds_write_b128 v5, v[56:59] offset:12288
    ds_write_b128 v5, v[60:63] offset:13312
    s_branch L_lw_15
L_lw_15_1:
    s_cmp_lg_u32 s44, 2
    s_cbranch_scc1 L_lw_15_2
    ds_read_b64_tr_b16 a[64:65], v80 offset:16384
    ds_read_b64_tr_b16 a[66:67], v80 offset:17408
    ds_read_b64_tr_b16 a[68:69], v80 offset:24576
    ds_read_b64_tr_b16 a[70:71], v80 offset:25600
    ds_read_b64_tr_b16 v[56:57], v81 offset:16384
    ds_read_b64_tr_b16 v[58:59], v81 offset:17408
    ds_read_b64_tr_b16 v[60:61], v81 offset:24576
    ds_read_b64_tr_b16 v[62:63], v81 offset:25600
    s_waitcnt lgkmcnt(0)
    ds_write_b128 v5, v[56:59] offset:8192
    ds_write_b128 v5, v[60:63] offset:9216
    s_branch L_lw_15
L_lw_15_2:
    ds_read_b64_tr_b16 v[192:193], v80 offset:16384
    ds_read_b64_tr_b16 v[194:195], v80 offset:17408
    ds_read_b64_tr_b16 v[196:197], v80 offset:24576
    ds_read_b64_tr_b16 v[198:199], v80 offset:25600
    ds_read_b64_tr_b16 v[200:201], v81 offset:16384
    ds_read_b64_tr_b16 v[202:203], v81 offset:17408
    ds_read_b64_tr_b16 v[204:205], v81 offset:24576
    ds_read_b64_tr_b16 v[206:207], v81 offset:25600
L_lw_15:
    s_waitcnt lgkmcnt(0)
    s_waitcnt vmcnt(12)
    s_barrier
    s_add_u32 s79, s41, 15
    s_and_b32 s79, s79, 3
    s_lshl_b32 s79, s79, 19
    s_add_u32 s79, s79, s47
    s_add_u32 s46, s79, 0x600000
    s_add_u32 m0, s48, 16384
    s_nop 0
    buffer_load_dwordx4 v82, s[24:27], s46 offen  lds
    s_add_u32 s46, s79, 0x620000
    s_add_u32 m0, s48, 20480
    s_nop 0
    buffer_load_dwordx4 v82, s[24:27], s46 offen  lds
    s_add_u32 s46, s79, 0x640000
    s_add_u32 m0, s48, 24576
    s_nop 0
    buffer_load_dwordx4 v82, s[24:27], s46 offen  lds
    s_add_u32 s46, s79, 0x660000
    s_add_u32 m0, s48, 28672
    s_nop 0
    buffer_load_dwordx4 v82, s[24:27], s46 offen  lds
    s_cmp_lg_u32 s44, 0
    s_cbranch_scc1 L_lw_16_0
    ds_read_b64_tr_b16 v[104:105], v80 offset:32768
    ds_read_b64_tr_b16 v[106:107], v80 offset:33792
    ds_read_b64_tr_b16 v[108:109], v80 offset:40960
    ds_read_b64_tr_b16 v[110:111], v80 offset:41984
    ds_read_b64_tr_b16 v[56:57], v81 offset:32768
    ds_read_b64_tr_b16 v[58:59], v81 offset:33792
    ds_read_b64_tr_b16 v[60:61], v81 offset:40960
    ds_read_b64_tr_b16 v[62:63], v81 offset:41984
    s_waitcnt lgkmcnt(0)
    ds_write_b128 v5, v[56:59] offset:16384
    ds_write_b128 v5, v[60:63] offset:17408
    s_branch L_lw_16
L_lw_16_0:
    s_cmp_lg_u32 s44, 1
    s_cbranch_scc1 L_lw_16_1
    ds_read_b64_tr_b16 a[168:169], v80 offset:32768
    ds_read_b64_tr_b16 a[170:171], v80 offset:33792
    ds_read_b64_tr_b16 a[172:173], v80 offset:40960
    ds_read_b64_tr_b16 a[174:175], v80 offset:41984
    ds_read_b64_tr_b16 v[56:57], v81 offset:32768
    ds_read_b64_tr_b16 v[58:59], v81 offset:33792
    ds_read_b64_tr_b16 v[60:61], v81 offset:40960
    ds_read_b64_tr_b16 v[62:63], v81 offset:41984
    s_waitcnt lgkmcnt(0)
    ds_write_b128 v5, v[56:59] offset:18432
    ds_write_b128 v5, v[60:63] offset:19456
    s_branch L_lw_16
L_lw_16_1:
    s_cmp_lg_u32 s44, 2
    s_cbranch_scc1 L_lw_16_2
    ds_read_b64_tr_b16 a[80:81], v80 offset:32768
    ds_read_b64_tr_b16 a[82:83], v80 offset:33792
    ds_read_b64_tr_b16 a[84:85], v80 offset:40960
    ds_read_b64_tr_b16 a[86:87], v80 offset:41984
    ds_read_b64_tr_b16 v[56:57], v81 offset:32768
    ds_read_b64_tr_b16 v[58:59], v81 offset:33792
    ds_read_b64_tr_b16 v[60:61], v81 offset:40960
    ds_read_b64_tr_b16 v[62:63], v81 offset:41984
    s_waitcnt lgkmcnt(0)
    ds_write_b128 v5, v[56:59] offset:14336
    ds_write_b128 v5, v[60:63] offset:15360
    s_branch L_lw_16
L_lw_16_2:
    ds_read_b64_tr_b16 v[224:225], v80 offset:32768
    ds_read_b64_tr_b16 v[226:227], v80 offset:33792
    ds_read_b64_tr_b16 v[228:229], v80 offset:40960
    ds_read_b64_tr_b16 v[230:231], v80 offset:41984
    ds_read_b64_tr_b16 v[232:233], v81 offset:32768
    ds_read_b64_tr_b16 v[234:235], v81 offset:33792
    ds_read_b64_tr_b16 v[236:237], v81 offset:40960
    ds_read_b64_tr_b16 v[238:239], v81 offset:41984
L_lw_16:
    s_waitcnt lgkmcnt(0)
    s_waitcnt vmcnt(12)
    s_barrier
    s_add_u32 s79, s41, 0
    s_and_b32 s79, s79, 3
    s_lshl_b32 s79, s79, 19
    s_add_u32 s79, s79, s47
    s_add_u32 s46, s79, 0x0
    s_add_u32 m0, s48, 32768
    s_nop 0
    buffer_load_dwordx4 v82, s[28:31], s46 offen  lds
    s_add_u32 s46, s79, 0x20000
    s_add_u32 m0, s48, 36864
    s_nop 0
    buffer_load_dwordx4 v82, s[28:31], s46 offen  lds
    s_add_u32 s46, s79, 0x40000
    s_add_u32 m0, s48, 40960
    s_nop 0
    buffer_load_dwordx4 v82, s[28:31], s46 offen  lds
    s_add_u32 s46, s79, 0x60000
    s_add_u32 m0, s48, 45056
    s_nop 0
    buffer_load_dwordx4 v82, s[28:31], s46 offen  lds
    s_cmp_lg_u32 s44, 0
    s_cbranch_scc1 L_lw_17_0
    ds_read_b64_tr_b16 v[128:129], v80 offset:49152
    ds_read_b64_tr_b16 v[130:131], v80 offset:50176
    ds_read_b64_tr_b16 v[132:133], v80 offset:57344
    ds_read_b64_tr_b16 v[134:135], v80 offset:58368
    ds_read_b64_tr_b16 v[136:137], v81 offset:49152
    ds_read_b64_tr_b16 v[138:139], v81 offset:50176
    ds_read_b64_tr_b16 v[140:141], v81 offset:57344
    ds_read_b64_tr_b16 v[142:143], v81 offset:58368
    s_branch L_lw_17
L_lw_17_0:
    s_cmp_lg_u32 s44, 1
    s_cbranch_scc1 L_lw_17_1
    ds_read_b64_tr_b16 a[192:193], v80 offset:49152
    ds_read_b64_tr_b16 a[194:195], v80 offset:50176
    ds_read_b64_tr_b16 a[196:197], v80 offset:57344
    ds_read_b64_tr_b16 a[198:199], v80 offset:58368
    ds_read_b64_tr_b16 v[56:57], v81 offset:49152
    ds_read_b64_tr_b16 v[58:59], v81 offset:50176
    ds_read_b64_tr_b16 v[60:61], v81 offset:57344
    ds_read_b64_tr_b16 v[62:63], v81 offset:58368
    s_waitcnt lgkmcnt(0)
    ds_write_b128 v5, v[56:59] offset:0
    ds_write_b128 v5, v[60:63] offset:1024
    s_branch L_lw_17
L_lw_17_1:
    s_cmp_lg_u32 s44, 2
    s_cbranch_scc1 L_lw_17_2
    ds_read_b64_tr_b16 a[96:97], v80 offset:49152
    ds_read_b64_tr_b16 a[98:99], v80 offset:50176
    ds_read_b64_tr_b16 a[100:101], v80 offset:57344
    ds_read_b64_tr_b16 a[102:103], v80 offset:58368
    ds_read_b64_tr_b16 v[56:57], v81 offset:49152
    ds_read_b64_tr_b16 v[58:59], v81 offset:50176
    ds_read_b64_tr_b16 v[60:61], v81 offset:57344
    ds_read_b64_tr_b16 v[62:63], v81 offset:58368
    s_waitcnt lgkmcnt(0)
    ds_write_b128 v5, v[56:59] offset:2048
    ds_write_b128 v5, v[60:63] offset:3072
    s_branch L_lw_17
L_lw_17_2:
    ds_read_b64_tr_b16 a[0:1], v80 offset:49152
    ds_read_b64_tr_b16 a[2:3], v80 offset:50176
    ds_read_b64_tr_b16 a[4:5], v80 offset:57344
    ds_read_b64_tr_b16 a[6:7], v80 offset:58368
    ds_read_b64_tr_b16 a[8:9], v81 offset:49152
    ds_read_b64_tr_b16 a[10:11], v81 offset:50176
    ds_read_b64_tr_b16 a[12:13], v81 offset:57344
    ds_read_b64_tr_b16 a[14:15], v81 offset:58368
L_lw_17:
    s_waitcnt lgkmcnt(0)
    s_waitcnt vmcnt(12)
    s_barrier
    s_add_u32 s79, s41, 1
    s_and_b32 s79, s79, 3
    s_lshl_b32 s79, s79, 19
    s_add_u32 s79, s79, s47
    s_add_u32 s46, s79, 0x0
    s_add_u32 m0, s48, 49152
    s_nop 0
    buffer_load_dwordx4 v82, s[28:31], s46 offen  lds
    s_add_u32 s46, s79, 0x20000
    s_add_u32 m0, s48, 53248
    s_nop 0
    buffer_load_dwordx4 v82, s[28:31], s46 offen  lds
    s_add_u32 s46, s79, 0x40000
    s_add_u32 m0, s48, 57344
    s_nop 0
    buffer_load_dwordx4 v82, s[28:31], s46 offen  lds
    s_add_u32 s46, s79, 0x60000
    s_add_u32 m0, s48, 61440
    s_nop 0
    buffer_load_dwordx4 v82, s[28:31], s46 offen  lds
    s_cmp_lg_u32 s44, 0
    s_cbranch_scc1 L_lw_18_0
    ds_read_b64_tr_b16 v[160:161], v84 offset:20480
    ds_read_b64_tr_b16 v[162:163], v84 offset:21504
    ds_read_b64_tr_b16 v[164:165], v86 offset:20480
    ds_read_b64_tr_b16 v[166:167], v86 offset:21504
    ds_read_b64_tr_b16 v[168:169], v85 offset:20480
    ds_read_b64_tr_b16 v[170:171], v85 offset:21504
    ds_read_b64_tr_b16 v[172:173], v87 offset:20480
    ds_read_b64_tr_b16 v[174:175], v87 offset:21504
    s_branch L_lw_18
L_lw_18_0:
    s_cmp_lg_u32 s44, 1
    s_cbranch_scc1 L_lw_18_1
    ds_read_b64_tr_b16 a[216:217], v84 offset:20480
    ds_read_b64_tr_b16 a[218:219], v84 offset:21504
    ds_read_b64_tr_b16 a[220:221], v86 offset:20480
    ds_read_b64_tr_b16 a[222:223], v86 offset:21504
    ds_read_b64_tr_b16 v[56:57], v85 offset:20480
    ds_read_b64_tr_b16 v[58:59], v85 offset:21504
    ds_read_b64_tr_b16 v[60:61], v87 offset:20480
    ds_read_b64_tr_b16 v[62:63], v87 offset:21504
    s_waitcnt lgkmcnt(0)
    ds_write_b128 v5, v[56:59] offset:4096
    ds_write_b128 v5, v[60:63] offset:5120
    s_branch L_lw_18
L_lw_18_1:
    s_cmp_lg_u32 s44, 2
    s_cbranch_scc1 L_lw_18_2
    ds_read_b64_tr_b16 a[120:121], v84 offset:20480
    ds_read_b64_tr_b16 a[122:123], v84 offset:21504
    ds_read_b64_tr_b16 a[124:125], v86 offset:20480
    ds_read_b64_tr_b16 a[126:127], v86 offset:21504
    ds_read_b64_tr_b16 v[56:57], v85 offset:20480
    ds_read_b64_tr_b16 v[58:59], v85 offset:21504
    ds_read_b64_tr_b16 v[60:61], v87 offset:20480
    ds_read_b64_tr_b16 v[62:63], v87 offset:21504
    s_waitcnt lgkmcnt(0)
    ds_write_b128 v5, v[56:59] offset:6144
    ds_write_b128 v5, v[60:63] offset:7168
    s_branch L_lw_18
L_lw_18_2:
    ds_read_b64_tr_b16 a[32:33], v84 offset:20480
    ds_read_b64_tr_b16 a[34:35], v84 offset:21504
    ds_read_b64_tr_b16 a[36:37], v86 offset:20480
    ds_read_b64_tr_b16 a[38:39], v86 offset:21504
    ds_read_b64_tr_b16 a[40:41], v85 offset:20480
    ds_read_b64_tr_b16 a[42:43], v85 offset:21504
    ds_read_b64_tr_b16 a[44:45], v87 offset:20480
    ds_read_b64_tr_b16 a[46:47], v87 offset:21504
L_lw_18:
    s_waitcnt lgkmcnt(0)
    s_waitcnt vmcnt(12)
    s_barrier
    s_cmp_lg_u32 s44, 0
    s_cbranch_scc1 L_lw_19_0
    ds_read_b64_tr_b16 v[192:193], v80 offset:0
    ds_read_b64_tr_b16 v[194:195], v80 offset:1024
    ds_read_b64_tr_b16 v[196:197], v80 offset:8192
    ds_read_b64_tr_b16 v[198:199], v80 offset:9216
    ds_read_b64_tr_b16 v[200:201], v81 offset:0
    ds_read_b64_tr_b16 v[202:203], v81 offset:1024
    ds_read_b64_tr_b16 v[204:205], v81 offset:8192
    ds_read_b64_tr_b16 v[206:207], v81 offset:9216
    s_branch L_lw_19
L_lw_19_0:
    s_cmp_lg_u32 s44, 1
    s_cbranch_scc1 L_lw_19_1
    ds_read_b64_tr_b16 a[240:241], v80 offset:0
    ds_read_b64_tr_b16 a[242:243], v80 offset:1024
    ds_read_b64_tr_b16 a[244:245], v80 offset:8192
    ds_read_b64_tr_b16 a[246:247], v80 offset:9216
    ds_read_b64_tr_b16 v[56:57], v81 offset:0
    ds_read_b64_tr_b16 v[58:59], v81 offset:1024
    ds_read_b64_tr_b16 v[60:61], v81 offset:8192
    ds_read_b64_tr_b16 v[62:63], v81 offset:9216
    s_waitcnt lgkmcnt(0)
    ds_write_b128 v5, v[56:59] offset:10240
    ds_write_b128 v5, v[60:63] offset:11264
    s_branch L_lw_19
L_lw_19_1:
    s_cmp_lg_u32 s44, 2
    s_cbranch_scc1 L_lw_19_2
    ds_read_b64_tr_b16 a[144:145], v80 offset:0
    ds_read_b64_tr_b16 a[146:147], v80 offset:1024
    ds_read_b64_tr_b16 a[148:149], v80 offset:8192
    ds_read_b64_tr_b16 a[150:151], v80 offset:9216
    ds_read_b64_tr_b16 v[56:57], v81 offset:0
    ds_read_b64_tr_b16 v[58:59], v81 offset:1024
    ds_read_b64_tr_b16 v[60:61], v81 offset:8192
    ds_read_b64_tr_b16 v[62:63], v81 offset:9216
    s_waitcnt lgkmcnt(0)
    ds_write_b128 v5, v[56:59] offset:12288
    ds_write_b128 v5, v[60:63] offset:13312
    s_branch L_lw_19
L_lw_19_2:
    ds_read_b64_tr_b16 a[64:65], v80 offset:0
    ds_read_b64_tr_b16 a[66:67], v80 offset:1024
    ds_read_b64_tr_b16 a[68:69], v80 offset:8192
    ds_read_b64_tr_b16 a[70:71], v80 offset:9216
    ds_read_b64_tr_b16 v[56:57], v81 offset:0
    ds_read_b64_tr_b16 v[58:59], v81 offset:1024
    ds_read_b64_tr_b16 v[60:61], v81 offset:8192
    ds_read_b64_tr_b16 v[62:63], v81 offset:9216
    s_waitcnt lgkmcnt(0)
    ds_write_b128 v5, v[56:59] offset:8192
    ds_write_b128 v5, v[60:63] offset:9216
L_lw_19:
    s_waitcnt lgkmcnt(0)
    s_waitcnt vmcnt(8)
    s_barrier
    s_add_u32 s79, s41, 2
    s_and_b32 s79, s79, 3
    s_lshl_b32 s79, s79, 19
    s_add_u32 s79, s79, s47
    s_add_u32 s46, s79, 0x0
    s_add_u32 m0, s48, 0
    s_nop 0
    buffer_load_dwordx4 v82, s[28:31], s46 offen  lds
    s_add_u32 s46, s79, 0x20000
    s_add_u32 m0, s48, 4096
    s_nop 0
    buffer_load_dwordx4 v82, s[28:31], s46 offen  lds
    s_add_u32 s46, s79, 0x40000
    s_add_u32 m0, s48, 8192
    s_nop 0
    buffer_load_dwordx4 v82, s[28:31], s46 offen  lds
    s_add_u32 s46, s79, 0x60000
    s_add_u32 m0, s48, 12288
    s_nop 0
    buffer_load_dwordx4 v82, s[28:31], s46 offen  lds
    s_cmp_lg_u32 s44, 0
    s_cbranch_scc1 L_lw_20_0
    ds_read_b64_tr_b16 v[224:225], v80 offset:16384
    ds_read_b64_tr_b16 v[226:227], v80 offset:17408
    ds_read_b64_tr_b16 v[228:229], v80 offset:24576
    ds_read_b64_tr_b16 v[230:231], v80 offset:25600
    ds_read_b64_tr_b16 v[232:233], v81 offset:16384
    ds_read_b64_tr_b16 v[234:235], v81 offset:17408
    ds_read_b64_tr_b16 v[236:237], v81 offset:24576
    ds_read_b64_tr_b16 v[238:239], v81 offset:25600
    s_branch L_lw_20
L_lw_20_0:
    s_cmp_lg_u32 s44, 1
    s_cbranch_scc1 L_lw_20_1
    ds_read_b64_tr_b16 v[104:105], v80 offset:16384
    ds_read_b64_tr_b16 v[106:107], v80 offset:17408
    ds_read_b64_tr_b16 v[108:109], v80 offset:24576
    ds_read_b64_tr_b16 v[110:111], v80 offset:25600
    ds_read_b64_tr_b16 v[56:57], v81 offset:16384
    ds_read_b64_tr_b16 v[58:59], v81 offset:17408
    ds_read_b64_tr_b16 v[60:61], v81 offset:24576
    ds_read_b64_tr_b16 v[62:63], v81 offset:25600
    s_waitcnt lgkmcnt(0)
    ds_write_b128 v5, v[56:59] offset:16384
    ds_write_b128 v5, v[60:63] offset:17408
    s_branch L_lw_20
L_lw_20_1:
    s_cmp_lg_u32 s44, 2
    s_cbranch_scc1 L_lw_20_2
    ds_read_b64_tr_b16 a[168:169], v80 offset:16384
    ds_read_b64_tr_b16 a[170:171], v80 offset:17408
    ds_read_b64_tr_b16 a[172:173], v80 offset:24576
    ds_read_b64_tr_b16 a[174:175], v80 offset:25600
    ds_read_b64_tr_b16 v[56:57], v81 offset:16384
    ds_read_b64_tr_b16 v[58:59], v81 offset:17408
    ds_read_b64_tr_b16 v[60:61], v81 offset:24576
    ds_read_b64_tr_b16 v[62:63], v81 offset:25600
    s_waitcnt lgkmcnt(0)
    ds_write_b128 v5, v[56:59] offset:18432
    ds_write_b128 v5, v[60:63] offset:19456
    s_branch L_lw_20
L_lw_20_2:
    ds_read_b64_tr_b16 a[80:81], v80 offset:16384
    ds_read_b64_tr_b16 a[82:83], v80 offset:17408
    ds_read_b64_tr_b16 a[84:85], v80 offset:24576
    ds_read_b64_tr_b16 a[86:87], v80 offset:25600
    ds_read_b64_tr_b16 v[56:57], v81 offset:16384
    ds_read_b64_tr_b16 v[58:59], v81 offset:17408
    ds_read_b64_tr_b16 v[60:61], v81 offset:24576
    ds_read_b64_tr_b16 v[62:63], v81 offset:25600
    s_waitcnt lgkmcnt(0)
    ds_write_b128 v5, v[56:59] offset:14336
    ds_write_b128 v5, v[60:63] offset:15360
L_lw_20:
    s_waitcnt lgkmcnt(0)
    s_waitcnt vmcnt(8)
    s_barrier
    s_add_u32 s79, s41, 3
    s_and_b32 s79, s79, 3
    s_lshl_b32 s79, s79, 19
    s_add_u32 s79, s79, s47
    s_add_u32 s46, s79, 0x0
    s_add_u32 m0, s48, 16384
    s_nop 0
    buffer_load_dwordx4 v82, s[28:31], s46 offen  lds
    s_add_u32 s46, s79, 0x20000
    s_add_u32 m0, s48, 20480
    s_nop 0
    buffer_load_dwordx4 v82, s[28:31], s46 offen  lds
    s_add_u32 s46, s79, 0x40000
    s_add_u32 m0, s48, 24576
    s_nop 0
    buffer_load_dwordx4 v82, s[28:31], s46 offen  lds
    s_add_u32 s46, s79, 0x60000
    s_add_u32 m0, s48, 28672
    s_nop 0
    buffer_load_dwordx4 v82, s[28:31], s46 offen  lds
    s_cmp_lg_u32 s44, 0
    s_cbranch_scc1 L_lw_21_0
    ds_read_b64_tr_b16 a[16:17], v80 offset:32768
    ds_read_b64_tr_b16 a[18:19], v80 offset:33792
    ds_read_b64_tr_b16 a[20:21], v80 offset:40960
    ds_read_b64_tr_b16 a[22:23], v80 offset:41984
    ds_read_b64_tr_b16 a[24:25], v81 offset:32768
    ds_read_b64_tr_b16 a[26:27], v81 offset:33792
    ds_read_b64_tr_b16 a[28:29], v81 offset:40960
    ds_read_b64_tr_b16 a[30:31], v81 offset:41984
    s_branch L_lw_21
L_lw_21_0:
    s_cmp_lg_u32 s44, 1
    s_cbranch_scc1 L_lw_21_1
    ds_read_b64_tr_b16 v[144:145], v80 offset:32768
    ds_read_b64_tr_b16 v[146:147], v80 offset:33792
    ds_read_b64_tr_b16 v[148:149], v80 offset:40960
    ds_read_b64_tr_b16 v[150:151], v80 offset:41984
    ds_read_b64_tr_b16 v[152:153], v81 offset:32768
    ds_read_b64_tr_b16 v[154:155], v81 offset:33792
    ds_read_b64_tr_b16 v[156:157], v81 offset:40960
    ds_read_b64_tr_b16 v[158:159], v81 offset:41984
    s_branch L_lw_21
L_lw_21_1:
    s_cmp_lg_u32 s44, 2
    s_cbranch_scc1 L_lw_21_2
    ds_read_b64_tr_b16 a[200:201], v80 offset:32768
    ds_read_b64_tr_b16 a[202:203], v80 offset:33792
    ds_read_b64_tr_b16 a[204:205], v80 offset:40960
    ds_read_b64_tr_b16 a[206:207], v80 offset:41984
    ds_read_b64_tr_b16 a[208:209], v81 offset:32768
    ds_read_b64_tr_b16 a[210:211], v81 offset:33792
    ds_read_b64_tr_b16 a[212:213], v81 offset:40960
    ds_read_b64_tr_b16 a[214:215], v81 offset:41984
    s_branch L_lw_21
L_lw_21_2:
    ds_read_b64_tr_b16 a[104:105], v80 offset:32768
    ds_read_b64_tr_b16 a[106:107], v80 offset:33792
    ds_read_b64_tr_b16 a[108:109], v80 offset:40960
    ds_read_b64_tr_b16 a[110:111], v80 offset:41984
    ds_read_b64_tr_b16 a[112:113], v81 offset:32768
    ds_read_b64_tr_b16 a[114:115], v81 offset:33792
    ds_read_b64_tr_b16 a[116:117], v81 offset:40960
    ds_read_b64_tr_b16 a[118:119], v81 offset:41984
L_lw_21:
    s_waitcnt lgkmcnt(0)
    s_waitcnt vmcnt(8)
    s_barrier
    s_add_u32 s79, s41, 4
    s_and_b32 s79, s79, 3
    s_lshl_b32 s79, s79, 19
    s_add_u32 s79, s79, s47
    s_add_u32 s46, s79, 0x200000
    s_add_u32 m0, s48, 32768
    s_nop 0
    buffer_load_dwordx4 v82, s[28:31], s46 offen  lds
    s_add_u32 s46, s79, 0x220000
    s_add_u32 m0, s48, 36864
    s_nop 0
    buffer_load_dwordx4 v82, s[28:31], s46 offen  lds
    s_add_u32 s46, s79, 0x240000
    s_add_u32 m0, s48, 40960
    s_nop 0
    buffer_load_dwordx4 v82, s[28:31], s46 offen  lds
    s_add_u32 s46, s79, 0x260000
    s_add_u32 m0, s48, 45056
    s_nop 0
    buffer_load_dwordx4 v82, s[28:31], s46 offen  lds
    s_cmp_lg_u32 s44, 0
    s_cbranch_scc1 L_lw_22_0
    ds_read_b64_tr_b16 a[48:49], v80 offset:49152
    ds_read_b64_tr_b16 a[50:51], v80 offset:50176
    ds_read_b64_tr_b16 a[52:53], v80 offset:57344
    ds_read_b64_tr_b16 a[54:55], v80 offset:58368
    ds_read_b64_tr_b16 a[56:57], v81 offset:49152
    ds_read_b64_tr_b16 a[58:59], v81 offset:50176
    ds_read_b64_tr_b16 a[60:61], v81 offset:57344
    ds_read_b64_tr_b16 a[62:63], v81 offset:58368
    s_branch L_lw_22
L_lw_22_0:
    s_cmp_lg_u32 s44, 1
    s_cbranch_scc1 L_lw_22_1
    ds_read_b64_tr_b16 v[176:177], v80 offset:49152
    ds_read_b64_tr_b16 v[178:179], v80 offset:50176
    ds_read_b64_tr_b16 v[180:181], v80 offset:57344
    ds_read_b64_tr_b16 v[182:183], v80 offset:58368
    ds_read_b64_tr_b16 v[184:185], v81 offset:49152
    ds_read_b64_tr_b16 v[186:187], v81 offset:50176
    ds_read_b64_tr_b16 v[188:189], v81 offset:57344
    ds_read_b64_tr_b16 v[190:191], v81 offset:58368
    s_branch L_lw_22
L_lw_22_1:
    s_cmp_lg_u32 s44, 2
    s_cbranch_scc1 L_lw_22_2
    ds_read_b64_tr_b16 a[224:225], v80 offset:49152
    ds_read_b64_tr_b16 a[226:227], v80 offset:50176
    ds_read_b64_tr_b16 a[228:229], v80 offset:57344
    ds_read_b64_tr_b16 a[230:231], v80 offset:58368
    ds_read_b64_tr_b16 a[232:233], v81 offset:49152
    ds_read_b64_tr_b16 a[234:235], v81 offset:50176
    ds_read_b64_tr_b16 a[236:237], v81 offset:57344
    ds_read_b64_tr_b16 a[238:239], v81 offset:58368
    s_branch L_lw_22
L_lw_22_2:
    ds_read_b64_tr_b16 a[128:129], v80 offset:49152
    ds_read_b64_tr_b16 a[130:131], v80 offset:50176
    ds_read_b64_tr_b16 a[132:133], v80 offset:57344
    ds_read_b64_tr_b16 a[134:135], v80 offset:58368
    ds_read_b64_tr_b16 a[136:137], v81 offset:49152
    ds_read_b64_tr_b16 a[138:139], v81 offset:50176
    ds_read_b64_tr_b16 a[140:141], v81 offset:57344
    ds_read_b64_tr_b16 a[142:143], v81 offset:58368
L_lw_22:
    s_waitcnt lgkmcnt(0)
    s_waitcnt vmcnt(8)
    s_barrier
    s_add_u32 s79, s41, 5
    s_and_b32 s79, s79, 3
    s_lshl_b32 s79, s79, 19
    s_add_u32 s79, s79, s47
    s_add_u32 s46, s79, 0x200000
    s_add_u32 m0, s48, 49152
    s_nop 0
    buffer_load_dwordx4 v82, s[28:31], s46 offen  lds
    s_add_u32 s46, s79, 0x220000
    s_add_u32 m0, s48, 53248
    s_nop 0
    buffer_load_dwordx4 v82, s[28:31], s46 offen  lds
    s_add_u32 s46, s79, 0x240000
    s_add_u32 m0, s48, 57344
    s_nop 0
    buffer_load_dwordx4 v82, s[28:31], s46 offen  lds
    s_add_u32 s46, s79, 0x260000
    s_add_u32 m0, s48, 61440
    s_nop 0
    buffer_load_dwordx4 v82, s[28:31], s46 offen  lds
    s_cmp_lg_u32 s44, 0
    s_cbranch_scc1 L_lw_23_0
    ds_read_b64_tr_b16 a[72:73], v80 offset:0
    ds_read_b64_tr_b16 a[74:75], v80 offset:1024
    ds_read_b64_tr_b16 a[76:77], v80 offset:8192
    ds_read_b64_tr_b16 a[78:79], v80 offset:9216
    ds_read_b64_tr_b16 v[56:57], v81 offset:0
    ds_read_b64_tr_b16 v[58:59], v81 offset:1024
    ds_read_b64_tr_b16 v[60:61], v81 offset:8192
    ds_read_b64_tr_b16 v[62:63], v81 offset:9216
    s_waitcnt lgkmcnt(0)
    ds_write_b128 v5, v[56:59] offset:20480
    ds_write_b128 v5, v[60:63] offset:21504
    s_branch L_lw_23
L_lw_23_0:
    s_cmp_lg_u32 s44, 1
    s_cbranch_scc1 L_lw_23_1
    ds_read_b64_tr_b16 v[208:209], v80 offset:0
    ds_read_b64_tr_b16 v[210:211], v80 offset:1024
    ds_read_b64_tr_b16 v[212:213], v80 offset:8192
    ds_read_b64_tr_b16 v[214:215], v80 offset:9216
    ds_read_b64_tr_b16 v[216:217], v81 offset:0
    ds_read_b64_tr_b16 v[218:219], v81 offset:1024
    ds_read_b64_tr_b16 v[220:221], v81 offset:8192
    ds_read_b64_tr_b16 v[222:223], v81 offset:9216
    s_branch L_lw_23
L_lw_23_1:
    s_cmp_lg_u32 s44, 2
    s_cbranch_scc1 L_lw_23_2
    ds_read_b64_tr_b16 a[248:249], v80 offset:0
    ds_read_b64_tr_b16 a[250:251], v80 offset:1024
    ds_read_b64_tr_b16 a[252:253], v80 offset:8192
    ds_read_b64_tr_b16 a[254:255], v80 offset:9216
    ds_read_b64_tr_b16 v[96:97], v81 offset:0
    ds_read_b64_tr_b16 v[98:99], v81 offset:1024
    ds_read_b64_tr_b16 v[100:101], v81 offset:8192
    ds_read_b64_tr_b16 v[102:103], v81 offset:9216
    s_branch L_lw_23
L_lw_23_2:
    ds_read_b64_tr_b16 a[152:153], v80 offset:0
    ds_read_b64_tr_b16 a[154:155], v80 offset:1024
    ds_read_b64_tr_b16 a[156:157], v80 offset:8192
    ds_read_b64_tr_b16 a[158:159], v80 offset:9216
    ds_read_b64_tr_b16 a[160:161], v81 offset:0
    ds_read_b64_tr_b16 a[162:163], v81 offset:1024
    ds_read_b64_tr_b16 a[164:165], v81 offset:8192
    ds_read_b64_tr_b16 a[166:167], v81 offset:9216
L_lw_23:
    s_waitcnt lgkmcnt(0)
    s_waitcnt vmcnt(8)
    s_barrier
    s_add_u32 s79, s41, 6
    s_and_b32 s79, s79, 3
    s_lshl_b32 s79, s79, 19
    s_add_u32 s79, s79, s47
    s_add_u32 s46, s79, 0x200000
    s_add_u32 m0, s48, 0
    s_nop 0
    buffer_load_dwordx4 v82, s[28:31], s46 offen  lds
    s_add_u32 s46, s79, 0x220000
    s_add_u32 m0, s48, 4096
    s_nop 0
    buffer_load_dwordx4 v82, s[28:31], s46 offen  lds
    s_add_u32 s46, s79, 0x240000
    s_add_u32 m0, s48, 8192
    s_nop 0
    buffer_load_dwordx4 v82, s[28:31], s46 offen  lds
    s_add_u32 s46, s79, 0x260000
    s_add_u32 m0, s48, 12288
    s_nop 0
    buffer_load_dwordx4 v82, s[28:31], s46 offen  lds
    s_cmp_lg_u32 s44, 0
    s_cbranch_scc1 L_lw_24_0
    ds_read_b64_tr_b16 a[88:89], v80 offset:16384
    ds_read_b64_tr_b16 a[90:91], v80 offset:17408
    ds_read_b64_tr_b16 a[92:93], v80 offset:24576
    ds_read_b64_tr_b16 a[94:95], v80 offset:25600
    ds_read_b64_tr_b16 v[56:57], v81 offset:16384
    ds_read_b64_tr_b16 v[58:59], v81 offset:17408
    ds_read_b64_tr_b16 v[60:61], v81 offset:24576
    ds_read_b64_tr_b16 v[62:63], v81 offset:25600
    s_waitcnt lgkmcnt(0)
    ds_write_b128 v5, v[56:59] offset:22528
    ds_write_b128 v5, v[60:63] offset:23552
    s_branch L_lw_24
L_lw_24_0:
    s_cmp_lg_u32 s44, 1
    s_cbranch_scc1 L_lw_24_1
    ds_read_b64_tr_b16 v[240:241], v80 offset:16384
    ds_read_b64_tr_b16 v[242:243], v80 offset:17408
    ds_read_b64_tr_b16 v[244:245], v80 offset:24576
    ds_read_b64_tr_b16 v[246:247], v80 offset:25600
    ds_read_b64_tr_b16 v[248:249], v81 offset:16384
    ds_read_b64_tr_b16 v[250:251], v81 offset:17408
    ds_read_b64_tr_b16 v[252:253], v81 offset:24576
    ds_read_b64_tr_b16 v[254:255], v81 offset:25600
    s_branch L_lw_24
L_lw_24_1:
    s_cmp_lg_u32 s44, 2
    s_cbranch_scc1 L_lw_24_2
    ds_read_b64_tr_b16 v[112:113], v80 offset:16384
    ds_read_b64_tr_b16 v[114:115], v80 offset:17408
    ds_read_b64_tr_b16 v[116:117], v80 offset:24576
    ds_read_b64_tr_b16 v[118:119], v80 offset:25600
    ds_read_b64_tr_b16 v[120:121], v81 offset:16384
    ds_read_b64_tr_b16 v[122:123], v81 offset:17408
    ds_read_b64_tr_b16 v[124:125], v81 offset:24576
    ds_read_b64_tr_b16 v[126:127], v81 offset:25600
    s_branch L_lw_24
L_lw_24_2:
    ds_read_b64_tr_b16 a[176:177], v80 offset:16384
    ds_read_b64_tr_b16 a[178:179], v80 offset:17408
    ds_read_b64_tr_b16 a[180:181], v80 offset:24576
    ds_read_b64_tr_b16 a[182:183], v80 offset:25600
    ds_read_b64_tr_b16 a[184:185], v81 offset:16384
    ds_read_b64_tr_b16 a[186:187], v81 offset:17408
    ds_read_b64_tr_b16 a[188:189], v81 offset:24576
    ds_read_b64_tr_b16 a[190:191], v81 offset:25600
L_lw_24:
    s_waitcnt lgkmcnt(0)
    s_waitcnt vmcnt(8)
    s_barrier
    s_add_u32 s79, s41, 7
    s_and_b32 s79, s79, 3
    s_lshl_b32 s79, s79, 19
    s_add_u32 s79, s79, s47
    s_add_u32 s46, s79, 0x200000
    s_add_u32 m0, s48, 16384
    s_nop 0
    buffer_load_dwordx4 v82, s[28:31], s46 offen  lds
    s_add_u32 s46, s79, 0x220000
    s_add_u32 m0, s48, 20480
    s_nop 0
    buffer_load_dwordx4 v82, s[28:31], s46 offen  lds
    s_add_u32 s46, s79, 0x240000
    s_add_u32 m0, s48, 24576
    s_nop 0
    buffer_load_dwordx4 v82, s[28:31], s46 offen  lds
    s_add_u32 s46, s79, 0x260000
    s_add_u32 m0, s48, 28672
    s_nop 0
    buffer_load_dwordx4 v82, s[28:31], s46 offen  lds
    s_cmp_lg_u32 s44, 0
    s_cbranch_scc1 L_lw_25_0
    ds_read_b64_tr_b16 a[104:105], v80 offset:32768
    ds_read_b64_tr_b16 a[106:107], v80 offset:33792
    ds_read_b64_tr_b16 a[108:109], v80 offset:40960
    ds_read_b64_tr_b16 a[110:111], v80 offset:41984
    ds_read_b64_tr_b16 a[112:113], v81 offset:32768
    ds_read_b64_tr_b16 a[114:115], v81 offset:33792
    ds_read_b64_tr_b16 a[116:117], v81 offset:40960
    ds_read_b64_tr_b16 a[118:119], v81 offset:41984
    s_branch L_lw_25
L_lw_25_0:
    s_cmp_lg_u32 s44, 1
    s_cbranch_scc1 L_lw_25_1
    ds_read_b64_tr_b16 a[16:17], v80 offset:32768
    ds_read_b64_tr_b16 a[18:19], v80 offset:33792
    ds_read_b64_tr_b16 a[20:21], v80 offset:40960
    ds_read_b64_tr_b16 a[22:23], v80 offset:41984
    ds_read_b64_tr_b16 a[24:25], v81 offset:32768
    ds_read_b64_tr_b16 a[26:27], v81 offset:33792
    ds_read_b64_tr_b16 a[28:29], v81 offset:40960
    ds_read_b64_tr_b16 a[30:31], v81 offset:41984
    s_branch L_lw_25
L_lw_25_1:
    s_cmp_lg_u32 s44, 2
    s_cbranch_scc1 L_lw_25_2
    ds_read_b64_tr_b16 v[144:145], v80 offset:32768
    ds_read_b64_tr_b16 v[146:147], v80 offset:33792
    ds_read_b64_tr_b16 v[148:149], v80 offset:40960
    ds_read_b64_tr_b16 v[150:151], v80 offset:41984
    ds_read_b64_tr_b16 v[152:153], v81 offset:32768
    ds_read_b64_tr_b16 v[154:155], v81 offset:33792
    ds_read_b64_tr_b16 v[156:157], v81 offset:40960
    ds_read_b64_tr_b16 v[158:159], v81 offset:41984
    s_branch L_lw_25
L_lw_25_2:
    ds_read_b64_tr_b16 a[200:201], v80 offset:32768
    ds_read_b64_tr_b16 a[202:203], v80 offset:33792
    ds_read_b64_tr_b16 a[204:205], v80 offset:40960
    ds_read_b64_tr_b16 a[206:207], v80 offset:41984
    ds_read_b64_tr_b16 a[208:209], v81 offset:32768
    ds_read_b64_tr_b16 a[210:211], v81 offset:33792
    ds_read_b64_tr_b16 a[212:213], v81 offset:40960
    ds_read_b64_tr_b16 a[214:215], v81 offset:41984
L_lw_25:
    s_waitcnt lgkmcnt(0)
    s_waitcnt vmcnt(8)
    s_barrier
    s_add_u32 s79, s41, 8
    s_and_b32 s79, s79, 3
    s_lshl_b32 s79, s79, 19
    s_add_u32 s79, s79, s47
    s_add_u32 s46, s79, 0x400000
    s_add_u32 m0, s48, 32768
    s_nop 0
    buffer_load_dwordx4 v82, s[28:31], s46 offen  lds
    s_add_u32 s46, s79, 0x420000
    s_add_u32 m0, s48, 36864
    s_nop 0
    buffer_load_dwordx4 v82, s[28:31], s46 offen  lds
    s_add_u32 s46, s79, 0x440000
    s_add_u32 m0, s48, 40960
    s_nop 0
    buffer_load_dwordx4 v82, s[28:31], s46 offen  lds
    s_add_u32 s46, s79, 0x460000
    s_add_u32 m0, s48, 45056
    s_nop 0
    buffer_load_dwordx4 v82, s[28:31], s46 offen  lds
    s_cmp_lg_u32 s44, 0
    s_cbranch_scc1 L_lw_26_0
    ds_read_b64_tr_b16 a[128:129], v80 offset:49152
    ds_read_b64_tr_b16 a[130:131], v80 offset:50176
    ds_read_b64_tr_b16 a[132:133], v80 offset:57344
    ds_read_b64_tr_b16 a[134:135], v80 offset:58368
    ds_read_b64_tr_b16 a[136:137], v81 offset:49152
    ds_read_b64_tr_b16 a[138:139], v81 offset:50176
    ds_read_b64_tr_b16 a[140:141], v81 offset:57344
    ds_read_b64_tr_b16 a[142:143], v81 offset:58368
    s_branch L_lw_26
L_lw_26_0:
    s_cmp_lg_u32 s44, 1
    s_cbranch_scc1 L_lw_26_1
    ds_read_b64_tr_b16 a[48:49], v80 offset:49152
    ds_read_b64_tr_b16 a[50:51], v80 offset:50176
    ds_read_b64_tr_b16 a[52:53], v80 offset:57344
    ds_read_b64_tr_b16 a[54:55], v80 offset:58368
    ds_read_b64_tr_b16 a[56:57], v81 offset:49152
    ds_read_b64_tr_b16 a[58:59], v81 offset:50176
    ds_read_b64_tr_b16 a[60:61], v81 offset:57344
    ds_read_b64_tr_b16 a[62:63], v81 offset:58368
    s_branch L_lw_26
L_lw_26_1:
    s_cmp_lg_u32 s44, 2
    s_cbranch_scc1 L_lw_26_2
    ds_read_b64_tr_b16 v[176:177], v80 offset:49152
    ds_read_b64_tr_b16 v[178:179], v80 offset:50176
    ds_read_b64_tr_b16 v[180:181], v80 offset:57344
    ds_read_b64_tr_b16 v[182:183], v80 offset:58368
    ds_read_b64_tr_b16 v[184:185], v81 offset:49152
    ds_read_b64_tr_b16 v[186:187], v81 offset:50176
    ds_read_b64_tr_b16 v[188:189], v81 offset:57344
    ds_read_b64_tr_b16 v[190:191], v81 offset:58368
    s_branch L_lw_26
L_lw_26_2:
    ds_read_b64_tr_b16 a[224:225], v80 offset:49152
    ds_read_b64_tr_b16 a[226:227], v80 offset:50176
    ds_read_b64_tr_b16 a[228:229], v80 offset:57344
    ds_read_b64_tr_b16 a[230:231], v80 offset:58368
    ds_read_b64_tr_b16 a[232:233], v81 offset:49152
    ds_read_b64_tr_b16 a[234:235], v81 offset:50176
    ds_read_b64_tr_b16 a[236:237], v81 offset:57344
    ds_read_b64_tr_b16 a[238:239], v81 offset:58368
L_lw_26:
    s_waitcnt lgkmcnt(0)
    s_waitcnt vmcnt(8)
    s_barrier
    s_add_u32 s79, s41, 9
    s_and_b32 s79, s79, 3
    s_lshl_b32 s79, s79, 19
    s_add_u32 s79, s79, s47
    s_add_u32 s46, s79, 0x400000
    s_add_u32 m0, s48, 49152
    s_nop 0
    buffer_load_dwordx4 v82, s[28:31], s46 offen  lds
    s_add_u32 s46, s79, 0x420000
    s_add_u32 m0, s48, 53248
    s_nop 0
    buffer_load_dwordx4 v82, s[28:31], s46 offen  lds
    s_add_u32 s46, s79, 0x440000
    s_add_u32 m0, s48, 57344
    s_nop 0
    buffer_load_dwordx4 v82, s[28:31], s46 offen  lds
    s_add_u32 s46, s79, 0x460000
    s_add_u32 m0, s48, 61440
    s_nop 0
    buffer_load_dwordx4 v82, s[28:31], s46 offen  lds
    s_cmp_lg_u32 s44, 0
    s_cbranch_scc1 L_lw_27_0
    ds_read_b64_tr_b16 a[152:153], v80 offset:0
    ds_read_b64_tr_b16 a[154:155], v80 offset:1024
    ds_read_b64_tr_b16 a[156:157], v80 offset:8192
    ds_read_b64_tr_b16 a[158:159], v80 offset:9216
    ds_read_b64_tr_b16 a[160:161], v81 offset:0
    ds_read_b64_tr_b16 a[162:163], v81 offset:1024
    ds_read_b64_tr_b16 a[164:165], v81 offset:8192
    ds_read_b64_tr_b16 a[166:167], v81 offset:9216
    s_branch L_lw_27
L_lw_27_0:
    s_cmp_lg_u32 s44, 1
    s_cbranch_scc1 L_lw_27_1
    ds_read_b64_tr_b16 a[72:73], v80 offset:0
    ds_read_b64_tr_b16 a[74:75], v80 offset:1024
    ds_read_b64_tr_b16 a[76:77], v80 offset:8192
    ds_read_b64_tr_b16 a[78:79], v80 offset:9216
    ds_read_b64_tr_b16 v[56:57], v81 offset:0
    ds_read_b64_tr_b16 v[58:59], v81 offset:1024
    ds_read_b64_tr_b16 v[60:61], v81 offset:8192
    ds_read_b64_tr_b16 v[62:63], v81 offset:9216
    s_waitcnt lgkmcnt(0)
    ds_write_b128 v5, v[56:59] offset:20480
    ds_write_b128 v5, v[60:63] offset:21504
    s_branch L_lw_27
L_lw_27_1:
    s_cmp_lg_u32 s44, 2
    s_cbranch_scc1 L_lw_27_2
    ds_read_b64_tr_b16 v[208:209], v80 offset:0
    ds_read_b64_tr_b16 v[210:211], v80 offset:1024
    ds_read_b64_tr_b16 v[212:213], v80 offset:8192
    ds_read_b64_tr_b16 v[214:215], v80 offset:9216
    ds_read_b64_tr_b16 v[216:217], v81 offset:0
    ds_read_b64_tr_b16 v[218:219], v81 offset:1024
    ds_read_b64_tr_b16 v[220:221], v81 offset:8192
    ds_read_b64_tr_b16 v[222:223], v81 offset:9216
    s_branch L_lw_27
L_lw_27_2:
    ds_read_b64_tr_b16 a[248:249], v80 offset:0
    ds_read_b64_tr_b16 a[250:251], v80 offset:1024
    ds_read_b64_tr_b16 a[252:253], v80 offset:8192
    ds_read_b64_tr_b16 a[254:255], v80 offset:9216
    ds_read_b64_tr_b16 v[96:97], v81 offset:0
    ds_read_b64_tr_b16 v[98:99], v81 offset:1024
    ds_read_b64_tr_b16 v[100:101], v81 offset:8192
    ds_read_b64_tr_b16 v[102:103], v81 offset:9216
L_lw_27:
    s_waitcnt lgkmcnt(0)
    s_waitcnt vmcnt(8)
    s_barrier
    s_add_u32 s79, s41, 10
    s_and_b32 s79, s79, 3
    s_lshl_b32 s79, s79, 19
    s_add_u32 s79, s79, s47
    s_add_u32 s46, s79, 0x400000
    s_add_u32 m0, s48, 0
    s_nop 0
    buffer_load_dwordx4 v82, s[28:31], s46 offen  lds
    s_add_u32 s46, s79, 0x420000
    s_add_u32 m0, s48, 4096
    s_nop 0
    buffer_load_dwordx4 v82, s[28:31], s46 offen  lds
    s_add_u32 s46, s79, 0x440000
    s_add_u32 m0, s48, 8192
    s_nop 0
    buffer_load_dwordx4 v82, s[28:31], s46 offen  lds
    s_add_u32 s46, s79, 0x460000
    s_add_u32 m0, s48, 12288
    s_nop 0
    buffer_load_dwordx4 v82, s[28:31], s46 offen  lds
    s_cmp_lg_u32 s44, 0
    s_cbranch_scc1 L_lw_28_0
    ds_read_b64_tr_b16 a[176:177], v80 offset:16384
    ds_read_b64_tr_b16 a[178:179], v80 offset:17408
    ds_read_b64_tr_b16 a[180:181], v80 offset:24576
    ds_read_b64_tr_b16 a[182:183], v80 offset:25600
    ds_read_b64_tr_b16 a[184:185], v81 offset:16384
    ds_read_b64_tr_b16 a[186:187], v81 offset:17408
    ds_read_b64_tr_b16 a[188:189], v81 offset:24576
    ds_read_b64_tr_b16 a[190:191], v81 offset:25600
    s_branch L_lw_28
L_lw_28_0:
    s_cmp_lg_u32 s44, 1
    s_cbranch_scc1 L_lw_28_1
    ds_read_b64_tr_b16 a[88:89], v80 offset:16384
    ds_read_b64_tr_b16 a[90:91], v80 offset:17408
    ds_read_b64_tr_b16 a[92:93], v80 offset:24576
    ds_read_b64_tr_b16 a[94:95], v80 offset:25600
    ds_read_b64_tr_b16 v[56:57], v81 offset:16384
    ds_read_b64_tr_b16 v[58:59], v81 offset:17408
    ds_read_b64_tr_b16 v[60:61], v81 offset:24576
    ds_read_b64_tr_b16 v[62:63], v81 offset:25600
    s_waitcnt lgkmcnt(0)
    ds_write_b128 v5, v[56:59] offset:22528
    ds_write_b128 v5, v[60:63] offset:23552
    s_branch L_lw_28
L_lw_28_1:
    s_cmp_lg_u32 s44, 2
    s_cbranch_scc1 L_lw_28_2
    ds_read_b64_tr_b16 v[240:241], v80 offset:16384
    ds_read_b64_tr_b16 v[242:243], v80 offset:17408
    ds_read_b64_tr_b16 v[244:245], v80 offset:24576
    ds_read_b64_tr_b16 v[246:247], v80 offset:25600
    ds_read_b64_tr_b16 v[248:249], v81 offset:16384
    ds_read_b64_tr_b16 v[250:251], v81 offset:17408
    ds_read_b64_tr_b16 v[252:253], v81 offset:24576
    ds_read_b64_tr_b16 v[254:255], v81 offset:25600
    s_branch L_lw_28
L_lw_28_2:
    ds_read_b64_tr_b16 v[112:113], v80 offset:16384
    ds_read_b64_tr_b16 v[114:115], v80 offset:17408
    ds_read_b64_tr_b16 v[116:117], v80 offset:24576
    ds_read_b64_tr_b16 v[118:119], v80 offset:25600
    ds_read_b64_tr_b16 v[120:121], v81 offset:16384
    ds_read_b64_tr_b16 v[122:123], v81 offset:17408
    ds_read_b64_tr_b16 v[124:125], v81 offset:24576
    ds_read_b64_tr_b16 v[126:127], v81 offset:25600
L_lw_28:
    s_waitcnt lgkmcnt(0)
    s_waitcnt vmcnt(8)
    s_barrier
    s_add_u32 s79, s41, 11
    s_and_b32 s79, s79, 3
    s_lshl_b32 s79, s79, 19
    s_add_u32 s79, s79, s47
    s_add_u32 s46, s79, 0x400000
    s_add_u32 m0, s48, 16384
    s_nop 0
    buffer_load_dwordx4 v82, s[28:31], s46 offen  lds
    s_add_u32 s46, s79, 0x420000
    s_add_u32 m0, s48, 20480
    s_nop 0
    buffer_load_dwordx4 v82, s[28:31], s46 offen  lds
    s_add_u32 s46, s79, 0x440000
    s_add_u32 m0, s48, 24576
    s_nop 0
    buffer_load_dwordx4 v82, s[28:31], s46 offen  lds
    s_add_u32 s46, s79, 0x460000
    s_add_u32 m0, s48, 28672
    s_nop 0
    buffer_load_dwordx4 v82, s[28:31], s46 offen  lds
    s_cmp_lg_u32 s44, 0
    s_cbranch_scc1 L_lw_29_0
    ds_read_b64_tr_b16 a[200:201], v80 offset:32768
    ds_read_b64_tr_b16 a[202:203], v80 offset:33792
    ds_read_b64_tr_b16 a[204:205], v80 offset:40960
    ds_read_b64_tr_b16 a[206:207], v80 offset:41984
    ds_read_b64_tr_b16 a[208:209], v81 offset:32768
    ds_read_b64_tr_b16 a[210:211], v81 offset:33792
    ds_read_b64_tr_b16 a[212:213], v81 offset:40960
    ds_read_b64_tr_b16 a[214:215], v81 offset:41984
    s_branch L_lw_29
L_lw_29_0:
    s_cmp_lg_u32 s44, 1
    s_cbranch_scc1 L_lw_29_1
    ds_read_b64_tr_b16 a[104:105], v80 offset:32768
    ds_read_b64_tr_b16 a[106:107], v80 offset:33792
    ds_read_b64_tr_b16 a[108:109], v80 offset:40960
    ds_read_b64_tr_b16 a[110:111], v80 offset:41984
    ds_read_b64_tr_b16 a[112:113], v81 offset:32768
    ds_read_b64_tr_b16 a[114:115], v81 offset:33792
    ds_read_b64_tr_b16 a[116:117], v81 offset:40960
    ds_read_b64_tr_b16 a[118:119], v81 offset:41984
    s_branch L_lw_29
L_lw_29_1:
    s_cmp_lg_u32 s44, 2
    s_cbranch_scc1 L_lw_29_2
    ds_read_b64_tr_b16 a[16:17], v80 offset:32768
    ds_read_b64_tr_b16 a[18:19], v80 offset:33792
    ds_read_b64_tr_b16 a[20:21], v80 offset:40960
    ds_read_b64_tr_b16 a[22:23], v80 offset:41984
    ds_read_b64_tr_b16 a[24:25], v81 offset:32768
    ds_read_b64_tr_b16 a[26:27], v81 offset:33792
    ds_read_b64_tr_b16 a[28:29], v81 offset:40960
    ds_read_b64_tr_b16 a[30:31], v81 offset:41984
    s_branch L_lw_29
L_lw_29_2:
    ds_read_b64_tr_b16 v[144:145], v80 offset:32768
    ds_read_b64_tr_b16 v[146:147], v80 offset:33792
    ds_read_b64_tr_b16 v[148:149], v80 offset:40960
    ds_read_b64_tr_b16 v[150:151], v80 offset:41984
    ds_read_b64_tr_b16 v[152:153], v81 offset:32768
    ds_read_b64_tr_b16 v[154:155], v81 offset:33792
    ds_read_b64_tr_b16 v[156:157], v81 offset:40960
    ds_read_b64_tr_b16 v[158:159], v81 offset:41984
L_lw_29:
    s_waitcnt lgkmcnt(0)
    s_waitcnt vmcnt(8)
    s_barrier
    s_add_u32 s79, s41, 12
    s_and_b32 s79, s79, 3
    s_lshl_b32 s79, s79, 19
    s_add_u32 s79, s79, s47
    s_add_u32 s46, s79, 0x600000
    s_add_u32 m0, s48, 32768
    s_nop 0
    buffer_load_dwordx4 v82, s[28:31], s46 offen  lds
    s_add_u32 s46, s79, 0x620000
    s_add_u32 m0, s48, 36864
    s_nop 0
    buffer_load_dwordx4 v82, s[28:31], s46 offen  lds
    s_add_u32 s46, s79, 0x640000
    s_add_u32 m0, s48, 40960
    s_nop 0
    buffer_load_dwordx4 v82, s[28:31], s46 offen  lds
    s_add_u32 s46, s79, 0x660000
    s_add_u32 m0, s48, 45056
    s_nop 0
    buffer_load_dwordx4 v82, s[28:31], s46 offen  lds
    s_cmp_lg_u32 s44, 0
    s_cbranch_scc1 L_lw_30_0
    ds_read_b64_tr_b16 a[224:225], v80 offset:49152
    ds_read_b64_tr_b16 a[226:227], v80 offset:50176
    ds_read_b64_tr_b16 a[228:229], v80 offset:57344
    ds_read_b64_tr_b16 a[230:231], v80 offset:58368
    ds_read_b64_tr_b16 a[232:233], v81 offset:49152
    ds_read_b64_tr_b16 a[234:235], v81 offset:50176
    ds_read_b64_tr_b16 a[236:237], v81 offset:57344
    ds_read_b64_tr_b16 a[238:239], v81 offset:58368
    s_branch L_lw_30
L_lw_30_0:
    s_cmp_lg_u32 s44, 1
    s_cbranch_scc1 L_lw_30_1
    ds_read_b64_tr_b16 a[128:129], v80 offset:49152
    ds_read_b64_tr_b16 a[130:131], v80 offset:50176
    ds_read_b64_tr_b16 a[132:133], v80 offset:57344
    ds_read_b64_tr_b16 a[134:135], v80 offset:58368
    ds_read_b64_tr_b16 a[136:137], v81 offset:49152
    ds_read_b64_tr_b16 a[138:139], v81 offset:50176
    ds_read_b64_tr_b16 a[140:141], v81 offset:57344
    ds_read_b64_tr_b16 a[142:143], v81 offset:58368
    s_branch L_lw_30
L_lw_30_1:
    s_cmp_lg_u32 s44, 2
    s_cbranch_scc1 L_lw_30_2
    ds_read_b64_tr_b16 a[48:49], v80 offset:49152
    ds_read_b64_tr_b16 a[50:51], v80 offset:50176
    ds_read_b64_tr_b16 a[52:53], v80 offset:57344
    ds_read_b64_tr_b16 a[54:55], v80 offset:58368
    ds_read_b64_tr_b16 a[56:57], v81 offset:49152
    ds_read_b64_tr_b16 a[58:59], v81 offset:50176
    ds_read_b64_tr_b16 a[60:61], v81 offset:57344
    ds_read_b64_tr_b16 a[62:63], v81 offset:58368
    s_branch L_lw_30
L_lw_30_2:
    ds_read_b64_tr_b16 v[176:177], v80 offset:49152
    ds_read_b64_tr_b16 v[178:179], v80 offset:50176
    ds_read_b64_tr_b16 v[180:181], v80 offset:57344
    ds_read_b64_tr_b16 v[182:183], v80 offset:58368
    ds_read_b64_tr_b16 v[184:185], v81 offset:49152
    ds_read_b64_tr_b16 v[186:187], v81 offset:50176
    ds_read_b64_tr_b16 v[188:189], v81 offset:57344
    ds_read_b64_tr_b16 v[190:191], v81 offset:58368
L_lw_30:
    s_waitcnt lgkmcnt(0)
    s_waitcnt vmcnt(8)
    s_barrier
    s_add_u32 s79, s41, 13
    s_and_b32 s79, s79, 3
    s_lshl_b32 s79, s79, 19
    s_add_u32 s79, s79, s47
    s_add_u32 s46, s79, 0x600000
    s_add_u32 m0, s48, 49152
    s_nop 0
    buffer_load_dwordx4 v82, s[28:31], s46 offen  lds
    s_add_u32 s46, s79, 0x620000
    s_add_u32 m0, s48, 53248
    s_nop 0
    buffer_load_dwordx4 v82, s[28:31], s46 offen  lds
    s_add_u32 s46, s79, 0x640000
    s_add_u32 m0, s48, 57344
    s_nop 0
    buffer_load_dwordx4 v82, s[28:31], s46 offen  lds
    s_add_u32 s46, s79, 0x660000
    s_add_u32 m0, s48, 61440
    s_nop 0
    buffer_load_dwordx4 v82, s[28:31], s46 offen  lds
    s_cmp_lg_u32 s44, 0
    s_cbranch_scc1 L_lw_31_0
    ds_read_b64_tr_b16 a[248:249], v80 offset:0
    ds_read_b64_tr_b16 a[250:251], v80 offset:1024
    ds_read_b64_tr_b16 a[252:253], v80 offset:8192
    ds_read_b64_tr_b16 a[254:255], v80 offset:9216
    ds_read_b64_tr_b16 v[96:97], v81 offset:0
    ds_read_b64_tr_b16 v[98:99], v81 offset:1024
    ds_read_b64_tr_b16 v[100:101], v81 offset:8192
    ds_read_b64_tr_b16 v[102:103], v81 offset:9216
    s_branch L_lw_31
L_lw_31_0:
    s_cmp_lg_u32 s44, 1
    s_cbranch_scc1 L_lw_31_1
    ds_read_b64_tr_b16 a[152:153], v80 offset:0
    ds_read_b64_tr_b16 a[154:155], v80 offset:1024
    ds_read_b64_tr_b16 a[156:157], v80 offset:8192
    ds_read_b64_tr_b16 a[158:159], v80 offset:9216
    ds_read_b64_tr_b16 a[160:161], v81 offset:0
    ds_read_b64_tr_b16 a[162:163], v81 offset:1024
    ds_read_b64_tr_b16 a[164:165], v81 offset:8192
    ds_read_b64_tr_b16 a[166:167], v81 offset:9216
    s_branch L_lw_31
L_lw_31_1:
    s_cmp_lg_u32 s44, 2
    s_cbranch_scc1 L_lw_31_2
    ds_read_b64_tr_b16 a[72:73], v80 offset:0
    ds_read_b64_tr_b16 a[74:75], v80 offset:1024
    ds_read_b64_tr_b16 a[76:77], v80 offset:8192
    ds_read_b64_tr_b16 a[78:79], v80 offset:9216
    ds_read_b64_tr_b16 v[56:57], v81 offset:0
    ds_read_b64_tr_b16 v[58:59], v81 offset:1024
    ds_read_b64_tr_b16 v[60:61], v81 offset:8192
    ds_read_b64_tr_b16 v[62:63], v81 offset:9216
    s_waitcnt lgkmcnt(0)
    ds_write_b128 v5, v[56:59] offset:20480
    ds_write_b128 v5, v[60:63] offset:21504
    s_branch L_lw_31
L_lw_31_2:
    ds_read_b64_tr_b16 v[208:209], v80 offset:0
    ds_read_b64_tr_b16 v[210:211], v80 offset:1024
    ds_read_b64_tr_b16 v[212:213], v80 offset:8192
    ds_read_b64_tr_b16 v[214:215], v80 offset:9216
    ds_read_b64_tr_b16 v[216:217], v81 offset:0
    ds_read_b64_tr_b16 v[218:219], v81 offset:1024
    ds_read_b64_tr_b16 v[220:221], v81 offset:8192
    ds_read_b64_tr_b16 v[222:223], v81 offset:9216
L_lw_31:
    s_waitcnt lgkmcnt(0)
    s_waitcnt vmcnt(8)
    s_barrier
    s_add_u32 s79, s41, 14
    s_and_b32 s79, s79, 3
    s_lshl_b32 s79, s79, 19
    s_add_u32 s79, s79, s47
    s_add_u32 s46, s79, 0x600000
    s_add_u32 m0, s48, 0
    s_nop 0
    buffer_load_dwordx4 v82, s[28:31], s46 offen  lds
    s_add_u32 s46, s79, 0x620000
    s_add_u32 m0, s48, 4096
    s_nop 0
    buffer_load_dwordx4 v82, s[28:31], s46 offen  lds
    s_add_u32 s46, s79, 0x640000
    s_add_u32 m0, s48, 8192
    s_nop 0
    buffer_load_dwordx4 v82, s[28:31], s46 offen  lds
    s_add_u32 s46, s79, 0x660000
    s_add_u32 m0, s48, 12288
    s_nop 0
    buffer_load_dwordx4 v82, s[28:31], s46 offen  lds
    s_cmp_lg_u32 s44, 0
    s_cbranch_scc1 L_lw_32_0
    ds_read_b64_tr_b16 v[112:113], v80 offset:16384
    ds_read_b64_tr_b16 v[114:115], v80 offset:17408
    ds_read_b64_tr_b16 v[116:117], v80 offset:24576
    ds_read_b64_tr_b16 v[118:119], v80 offset:25600
    ds_read_b64_tr_b16 v[120:121], v81 offset:16384
    ds_read_b64_tr_b16 v[122:123], v81 offset:17408
    ds_read_b64_tr_b16 v[124:125], v81 offset:24576
    ds_read_b64_tr_b16 v[126:127], v81 offset:25600
    s_branch L_lw_32
L_lw_32_0:
    s_cmp_lg_u32 s44, 1
    s_cbranch_scc1 L_lw_32_1
    ds_read_b64_tr_b16 a[176:177], v80 offset:16384
    ds_read_b64_tr_b16 a[178:179], v80 offset:17408
    ds_read_b64_tr_b16 a[180:181], v80 offset:24576
    ds_read_b64_tr_b16 a[182:183], v80 offset:25600
    ds_read_b64_tr_b16 a[184:185], v81 offset:16384
    ds_read_b64_tr_b16 a[186:187], v81 offset:17408
    ds_read_b64_tr_b16 a[188:189], v81 offset:24576
    ds_read_b64_tr_b16 a[190:191], v81 offset:25600
    s_branch L_lw_32
L_lw_32_1:
    s_cmp_lg_u32 s44, 2
    s_cbranch_scc1 L_lw_32_2
    ds_read_b64_tr_b16 a[88:89], v80 offset:16384
    ds_read_b64_tr_b16 a[90:91], v80 offset:17408
    ds_read_b64_tr_b16 a[92:93], v80 offset:24576
    ds_read_b64_tr_b16 a[94:95], v80 offset:25600
    ds_read_b64_tr_b16 v[56:57], v81 offset:16384
    ds_read_b64_tr_b16 v[58:59], v81 offset:17408
    ds_read_b64_tr_b16 v[60:61], v81 offset:24576
    ds_read_b64_tr_b16 v[62:63], v81 offset:25600
    s_waitcnt lgkmcnt(0)
    ds_write_b128 v5, v[56:59] offset:22528
    ds_write_b128 v5, v[60:63] offset:23552
    s_branch L_lw_32
L_lw_32_2:
    ds_read_b64_tr_b16 v[240:241], v80 offset:16384
    ds_read_b64_tr_b16 v[242:243], v80 offset:17408
    ds_read_b64_tr_b16 v[244:245], v80 offset:24576
    ds_read_b64_tr_b16 v[246:247], v80 offset:25600
    ds_read_b64_tr_b16 v[248:249], v81 offset:16384
    ds_read_b64_tr_b16 v[250:251], v81 offset:17408
    ds_read_b64_tr_b16 v[252:253], v81 offset:24576
    ds_read_b64_tr_b16 v[254:255], v81 offset:25600
L_lw_32:
    s_waitcnt lgkmcnt(0)
    s_waitcnt vmcnt(8)
    s_barrier
    s_add_u32 s79, s41, 15
    s_and_b32 s79, s79, 3
    s_lshl_b32 s79, s79, 19
    s_add_u32 s79, s79, s47
    s_add_u32 s46, s79, 0x600000
    s_add_u32 m0, s48, 16384
    s_nop 0
    buffer_load_dwordx4 v82, s[28:31], s46 offen  lds
    s_add_u32 s46, s79, 0x620000
    s_add_u32 m0, s48, 20480
    s_nop 0
    buffer_load_dwordx4 v82, s[28:31], s46 offen  lds
    s_add_u32 s46, s79, 0x640000
    s_add_u32 m0, s48, 24576
    s_nop 0
    buffer_load_dwordx4 v82, s[28:31], s46 offen  lds
    s_add_u32 s46, s79, 0x660000
    s_add_u32 m0, s48, 28672
    s_nop 0
    buffer_load_dwordx4 v82, s[28:31], s46 offen  lds
    v_mov_b32 v46, 0
    buffer_load_dwordx2 v[44:45], v46, s[16:19], 0 offen sc1
    s_cmp_lg_u32 s44, 0
    s_cbranch_scc1 L_lw_33_0
    ds_read_b64_tr_b16 v[144:145], v80 offset:32768
    ds_read_b64_tr_b16 v[146:147], v80 offset:33792
    ds_read_b64_tr_b16 v[148:149], v80 offset:40960
    ds_read_b64_tr_b16 v[150:151], v80 offset:41984
    ds_read_b64_tr_b16 v[152:153], v81 offset:32768
    ds_read_b64_tr_b16 v[154:155], v81 offset:33792
    ds_read_b64_tr_b16 v[156:157], v81 offset:40960
    ds_read_b64_tr_b16 v[158:159], v81 offset:41984
    s_branch L_lw_33
L_lw_33_0:
    s_cmp_lg_u32 s44, 1
    s_cbranch_scc1 L_lw_33_1
    ds_read_b64_tr_b16 a[200:201], v80 offset:32768
    ds_read_b64_tr_b16 a[202:203], v80 offset:33792
    ds_read_b64_tr_b16 a[204:205], v80 offset:40960
    ds_read_b64_tr_b16 a[206:207], v80 offset:41984
    ds_read_b64_tr_b16 a[208:209], v81 offset:32768
    ds_read_b64_tr_b16 a[210:211], v81 offset:33792
    ds_read_b64_tr_b16 a[212:213], v81 offset:40960
    ds_read_b64_tr_b16 a[214:215], v81 offset:41984
    s_branch L_lw_33
L_lw_33_1:
    s_cmp_lg_u32 s44, 2
    s_cbranch_scc1 L_lw_33_2
    ds_read_b64_tr_b16 a[104:105], v80 offset:32768
    ds_read_b64_tr_b16 a[106:107], v80 offset:33792
    ds_read_b64_tr_b16 a[108:109], v80 offset:40960
    ds_read_b64_tr_b16 a[110:111], v80 offset:41984
    ds_read_b64_tr_b16 a[112:113], v81 offset:32768
    ds_read_b64_tr_b16 a[114:115], v81 offset:33792
    ds_read_b64_tr_b16 a[116:117], v81 offset:40960
    ds_read_b64_tr_b16 a[118:119], v81 offset:41984
    s_branch L_lw_33
L_lw_33_2:
    ds_read_b64_tr_b16 a[16:17], v80 offset:32768
    ds_read_b64_tr_b16 a[18:19], v80 offset:33792
    ds_read_b64_tr_b16 a[20:21], v80 offset:40960
    ds_read_b64_tr_b16 a[22:23], v80 offset:41984
    ds_read_b64_tr_b16 a[24:25], v81 offset:32768
    ds_read_b64_tr_b16 a[26:27], v81 offset:33792
    ds_read_b64_tr_b16 a[28:29], v81 offset:40960
    ds_read_b64_tr_b16 a[30:31], v81 offset:41984
L_lw_33:
    s_waitcnt lgkmcnt(0)
    s_waitcnt vmcnt(8)
    s_barrier
    s_cmp_lg_u32 s44, 0
    s_cbranch_scc1 L_lw_34_0
    ds_read_b64_tr_b16 v[176:177], v80 offset:49152
    ds_read_b64_tr_b16 v[178:179], v80 offset:50176
    ds_read_b64_tr_b16 v[180:181], v80 offset:57344
    ds_read_b64_tr_b16 v[182:183], v80 offset:58368
    ds_read_b64_tr_b16 v[184:185], v81 offset:49152
    ds_read_b64_tr_b16 v[186:187], v81 offset:50176
    ds_read_b64_tr_b16 v[188:189], v81 offset:57344
    ds_read_b64_tr_b16 v[190:191], v81 offset:58368
    s_branch L_lw_34
L_lw_34_0:
    s_cmp_lg_u32 s44, 1
    s_cbranch_scc1 L_lw_34_1
    ds_read_b64_tr_b16 a[224:225], v80 offset:49152
    ds_read_b64_tr_b16 a[226:227], v80 offset:50176
    ds_read_b64_tr_b16 a[228:229], v80 offset:57344
    ds_read_b64_tr_b16 a[230:231], v80 offset:58368
    ds_read_b64_tr_b16 a[232:233], v81 offset:49152
    ds_read_b64_tr_b16 a[234:235], v81 offset:50176
    ds_read_b64_tr_b16 a[236:237], v81 offset:57344
    ds_read_b64_tr_b16 a[238:239], v81 offset:58368
    s_branch L_lw_34
L_lw_34_1:
    s_cmp_lg_u32 s44, 2
    s_cbranch_scc1 L_lw_34_2
    ds_read_b64_tr_b16 a[128:129], v80 offset:49152
    ds_read_b64_tr_b16 a[130:131], v80 offset:50176
    ds_read_b64_tr_b16 a[132:133], v80 offset:57344
    ds_read_b64_tr_b16 a[134:135], v80 offset:58368
    ds_read_b64_tr_b16 a[136:137], v81 offset:49152
    ds_read_b64_tr_b16 a[138:139], v81 offset:50176
    ds_read_b64_tr_b16 a[140:141], v81 offset:57344
    ds_read_b64_tr_b16 a[142:143], v81 offset:58368
    s_branch L_lw_34
L_lw_34_2:
    ds_read_b64_tr_b16 a[48:49], v80 offset:49152
    ds_read_b64_tr_b16 a[50:51], v80 offset:50176
    ds_read_b64_tr_b16 a[52:53], v80 offset:57344
    ds_read_b64_tr_b16 a[54:55], v80 offset:58368
    ds_read_b64_tr_b16 a[56:57], v81 offset:49152
    ds_read_b64_tr_b16 a[58:59], v81 offset:50176
    ds_read_b64_tr_b16 a[60:61], v81 offset:57344
    ds_read_b64_tr_b16 a[62:63], v81 offset:58368
L_lw_34:
    s_waitcnt lgkmcnt(0)
    s_waitcnt vmcnt(4)
    s_barrier
    s_cmp_lg_u32 s44, 0
    s_cbranch_scc1 L_lw_35_0
    ds_read_b64_tr_b16 v[208:209], v80 offset:0
    ds_read_b64_tr_b16 v[210:211], v80 offset:1024
    ds_read_b64_tr_b16 v[212:213], v80 offset:8192
    ds_read_b64_tr_b16 v[214:215], v80 offset:9216
    ds_read_b64_tr_b16 v[216:217], v81 offset:0
    ds_read_b64_tr_b16 v[218:219], v81 offset:1024
    ds_read_b64_tr_b16 v[220:221], v81 offset:8192
    ds_read_b64_tr_b16 v[222:223], v81 offset:9216
    s_branch L_lw_35
L_lw_35_0:
    s_cmp_lg_u32 s44, 1
    s_cbranch_scc1 L_lw_35_1
    ds_read_b64_tr_b16 a[248:249], v80 offset:0
    ds_read_b64_tr_b16 a[250:251], v80 offset:1024
    ds_read_b64_tr_b16 a[252:253], v80 offset:8192
    ds_read_b64_tr_b16 a[254:255], v80 offset:9216
    ds_read_b64_tr_b16 v[96:97], v81 offset:0
    ds_read_b64_tr_b16 v[98:99], v81 offset:1024
    ds_read_b64_tr_b16 v[100:101], v81 offset:8192
    ds_read_b64_tr_b16 v[102:103], v81 offset:9216
    s_branch L_lw_35
L_lw_35_1:
    s_cmp_lg_u32 s44, 2
    s_cbranch_scc1 L_lw_35_2
    ds_read_b64_tr_b16 a[152:153], v80 offset:0
    ds_read_b64_tr_b16 a[154:155], v80 offset:1024
    ds_read_b64_tr_b16 a[156:157], v80 offset:8192
    ds_read_b64_tr_b16 a[158:159], v80 offset:9216
    ds_read_b64_tr_b16 a[160:161], v81 offset:0
    ds_read_b64_tr_b16 a[162:163], v81 offset:1024
    ds_read_b64_tr_b16 a[164:165], v81 offset:8192
    ds_read_b64_tr_b16 a[166:167], v81 offset:9216
    s_branch L_lw_35
L_lw_35_2:
    ds_read_b64_tr_b16 a[72:73], v80 offset:0
    ds_read_b64_tr_b16 a[74:75], v80 offset:1024
    ds_read_b64_tr_b16 a[76:77], v80 offset:8192
    ds_read_b64_tr_b16 a[78:79], v80 offset:9216
    ds_read_b64_tr_b16 v[56:57], v81 offset:0
    ds_read_b64_tr_b16 v[58:59], v81 offset:1024
    ds_read_b64_tr_b16 v[60:61], v81 offset:8192
    ds_read_b64_tr_b16 v[62:63], v81 offset:9216
    s_waitcnt lgkmcnt(0)
    ds_write_b128 v5, v[56:59] offset:20480
    ds_write_b128 v5, v[60:63] offset:21504
L_lw_35:
    s_waitcnt lgkmcnt(0)
    s_waitcnt vmcnt(0)
    s_barrier
    s_add_u32 s63, s62, 0
    buffer_load_dword v47, v17, s[12:15], s63 offen sc1
    s_add_u32 s63, s62, 32768
    buffer_load_dword v47, v17, s[12:15], s63 offen sc1
    s_add_u32 s63, s62, 65536
    buffer_load_dword v47, v17, s[12:15], s63 offen sc1
    s_add_u32 s63, s62, 98304
    buffer_load_dword v47, v17, s[12:15], s63 offen sc1
    buffer_load_dword v47, v20, s[12:15], 0 offen sc1
    s_cmp_lg_u32 s44, 0
    s_cbranch_scc1 L_lw_36_0
    ds_read_b64_tr_b16 v[240:241], v80 offset:16384
    ds_read_b64_tr_b16 v[242:243], v80 offset:17408
    ds_read_b64_tr_b16 v[244:245], v80 offset:24576
    ds_read_b64_tr_b16 v[246:247], v80 offset:25600
    ds_read_b64_tr_b16 v[248:249], v81 offset:16384
    ds_read_b64_tr_b16 v[250:251], v81 offset:17408
    ds_read_b64_tr_b16 v[252:253], v81 offset:24576
    ds_read_b64_tr_b16 v[254:255], v81 offset:25600
    s_branch L_lw_36
L_lw_36_0:
    s_cmp_lg_u32 s44, 1
    s_cbranch_scc1 L_lw_36_1
    ds_read_b64_tr_b16 v[112:113], v80 offset:16384
    ds_read_b64_tr_b16 v[114:115], v80 offset:17408
    ds_read_b64_tr_b16 v[116:117], v80 offset:24576
    ds_read_b64_tr_b16 v[118:119], v80 offset:25600
    ds_read_b64_tr_b16 v[120:121], v81 offset:16384
    ds_read_b64_tr_b16 v[122:123], v81 offset:17408
    ds_read_b64_tr_b16 v[124:125], v81 offset:24576
    ds_read_b64_tr_b16 v[126:127], v81 offset:25600
    s_branch L_lw_36
L_lw_36_1:
    s_cmp_lg_u32 s44, 2
    s_cbranch_scc1 L_lw_36_2
    ds_read_b64_tr_b16 a[176:177], v80 offset:16384
    ds_read_b64_tr_b16 a[178:179], v80 offset:17408
    ds_read_b64_tr_b16 a[180:181], v80 offset:24576
    ds_read_b64_tr_b16 a[182:183], v80 offset:25600
    ds_read_b64_tr_b16 a[184:185], v81 offset:16384
    ds_read_b64_tr_b16 a[186:187], v81 offset:17408
    ds_read_b64_tr_b16 a[188:189], v81 offset:24576
    ds_read_b64_tr_b16 a[190:191], v81 offset:25600
    s_branch L_lw_36
L_lw_36_2:
    ds_read_b64_tr_b16 a[88:89], v80 offset:16384
    ds_read_b64_tr_b16 a[90:91], v80 offset:17408
    ds_read_b64_tr_b16 a[92:93], v80 offset:24576
    ds_read_b64_tr_b16 a[94:95], v80 offset:25600
    ds_read_b64_tr_b16 v[56:57], v81 offset:16384
    ds_read_b64_tr_b16 v[58:59], v81 offset:17408
    ds_read_b64_tr_b16 v[60:61], v81 offset:24576
    ds_read_b64_tr_b16 v[62:63], v81 offset:25600
    s_waitcnt lgkmcnt(0)
    ds_write_b128 v5, v[56:59] offset:22528
    ds_write_b128 v5, v[60:63] offset:23552
L_lw_36:
    s_waitcnt lgkmcnt(0)
    s_barrier
    v_and_b32 v63, 15, v1
    v_lshrrev_b32 v64, 4, v1
    v_lshrrev_b32 v65, 5, v1
    v_lshlrev_b32 v65, 4, v65
    v_add_u32 v65, v65, v63
    v_lshlrev_b32 v65, 4, v65
    v_and_b32 v66, 1, v64
    v_lshlrev_b32 v66, 3, v66
    s_lshl_b32 s45, s44, 9
    s_add_u32 s45, s45, 53248
    v_add3_u32 v6, v65, v66, s45
    v_bfe_u32 v65, v1, 2, 2
    v_lshlrev_b32 v66, 3, v64
    v_add_u32 v65, v65, v66
    v_lshlrev_b32 v65, 4, v65
    v_and_b32 v66, 1, v1
    v_lshlrev_b32 v66, 3, v66
    v_add_u32 v65, v65, v66
    v_add_u32 v7, 53248, v65
    v_bfe_u32 v65, v1, 2, 1
    v_mul_u32_u24 v65, 520, v65
    v_bfe_u32 v66, v1, 3, 1
    v_lshlrev_b32 v14, 7, v66
    v_and_b32 v67, 3, v1
    v_lshlrev_b32 v67, 5, v67
    v_add3_u32 v65, v65, v14, v67
    v_lshlrev_b32 v66, 1, v66
    v_xor_b32 v66, v66, v64
    v_lshlrev_b32 v66, 3, v66
    s_mul_i32 s45, s44, 1040
    s_add_u32 s45, s45, 55296
    v_add3_u32 v18, v65, v66, s45
    v_lshlrev_b32 v14, 3, v1
    v_and_b32 v65, 16, v1
    v_xor_b32 v14, v14, v65
    v_lshlrev_b32 v16, 3, v1
    v_lshlrev_b32 v8, 4, v1
    v_lshrrev_b32 v65, 2, v1
    v_lshlrev_b32 v65, 4, v65
    v_and_b32 v66, 1, v1
    v_lshlrev_b32 v66, 3, v66
    s_lshl_b32 s45, s44, 11
    v_add3_u32 v65, v65, v66, s45
    v_and_b32 v66, 2, v1
    v_lshlrev_b32 v66, 7, v66
    v_add_u32 v9, v65, v66
    s_lshl_b32 s45, s43, 11
    s_lshl_b32 s46, s44, 9
    s_add_u32 s45, s45, s46
    s_add_u32 s51, s45, 0x7020000
    s_lshl_b32 s63, s43, 19
    s_add_u32 s63, s63, 0x3000000
    s_mov_b32 s50, 0
    s_lshl_b32 s64, s44, 11
    s_sub_u32 s63, s63, s64
    s_add_u32 s64, s64, 16384
    s_add_u32 s65, s64, 8192
    s_lshl_b32 s66, s43, 12
    s_add_u32 s66, s66, 0x1000000
    s_mov_b32 s69, 16384
    s_mov_b32 s52, 0x3e0293ee
    s_mov_b32 s53, 0x41800000
    s_lshl_b32 s45, s40, 5
    s_add_u32 s45, s45, s41
    s_lshl_b32 s45, s45, 8
    s_lshl_b32 s46, s44, 6
    s_add_u32 s45, s45, s46
    s_add_u32 s45, s45, 0x7084000
    v_and_b32 v19, 15, v1
    v_lshlrev_b32 v19, 2, v19
    v_add_u32 v19, s45, v19
    s_mov_b32 s70, 0
    v_mov_b32 v41, 0
    s_branch L_hw_37_c
L_hw_37:
    buffer_load_dwordx2 v[44:45], v41, s[16:19], 0 offen sc1
    s_add_u32 s70, s70, 1
    s_cmp_ge_u32 s70, 0x100000
    s_cbranch_scc1 L_c_done_1
L_hw_37_c:
    s_waitcnt vmcnt(0)
    v_readfirstlane_b32 s45, v44
    v_readfirstlane_b32 s46, v45
    s_nop 3
    s_lshr_b32 s47, s46, 24
    s_cmp_lg_u32 s47, 64
    s_cbranch_scc1 L_hw_37
    s_lshr_b32 s68, s45, 24
    s_and_b32 s47, s45, 511
    s_mul_i32 s47, s47, s47
    s_bfe_u32 s45, s45, 0xf0009
    s_lshl_b32 s45, s45, 5
    s_sub_u32 s45, s45, s47
    s_and_b32 s47, s46, 511
    s_mul_i32 s47, s47, s47
    s_bfe_u32 s46, s46, 0xf0009
    s_lshl_b32 s46, s46, 5
    s_sub_u32 s46, s46, s47
    s_or_b32 s45, s45, s46
    s_cmp_eq_u32 s45, 0
    s_cselect_b32 s67, 1, 0
    s_mov_b32 s24, s12
    s_mov_b32 s25, s13
    s_mov_b32 s28, s12
    s_mov_b32 s29, s13
    s_cmp_eq_u32 s67, 1
    s_cselect_b32 s26, s14, 0
    s_cselect_b32 s30, 0, s14
    s_cmp_ge_u32 s68, 16
    s_cselect_b32 s68, 8192, 0
    s_mov_b32 s6, 0x11111111
    s_mov_b32 s7, 0xffaaa491
    s_mov_b32 s60, 0
    s_lshl_b32 s58, s40, 16
    s_add_u32 s58, s58, 0x7000000
    s_mov_b32 s61, s58
    s_lshl_b32 s59, s40, 17
    s_add_u32 s59, s59, 0x7040000
    s_mov_b32 s62, s59
    s_add_u32 s32, s41, 0
    s_and_b32 s32, s32, 3
    s_lshl_b32 s32, s32, 10
    s_add_u32 s33, s41, 1
    s_and_b32 s33, s33, 3
    s_lshl_b32 s33, s33, 10
    s_add_u32 s34, s41, 2
    s_and_b32 s34, s34, 3
    s_lshl_b32 s34, s34, 10
    s_add_u32 s35, s41, 3
    s_and_b32 s35, s35, 3
    s_lshl_b32 s35, s35, 10
    s_mov_b32 s47, 0
    s_cmp_lt_u32 s47, s50
    s_cbranch_scc1 L_kv_rdy_38
    s_lshl_b32 s45, s43, 7
    s_add_u32 s45, s45, 0x10014
    v_mov_b32 v0, 0
    s_mov_b32 s70, 0
L_kv_rdy_38_p:
    buffer_load_dwordx2 v[10:11], v0, s[12:15], s45 offen sc1
    s_add_u32 s70, s70, 1
    s_cmp_ge_u32 s70, 0x200000
    s_cbranch_scc1 L_c_done_1
    s_waitcnt vmcnt(0)
    v_min_u32 v10, v10, v11
    s_nop 0
    v_readfirstlane_b32 s50, v10
    s_nop 3
    s_cmp_lt_u32 s47, s50
    s_cbranch_scc1 L_kv_rdy_38
    s_sleep 2
    s_branch L_kv_rdy_38_p
L_kv_rdy_38:
    s_mov_b32 m0, s64
    s_add_u32 s46, s63, 0x1000000
    buffer_load_dwordx4 v3, s[12:15], s63 offen sc1 lds
    buffer_load_dwordx4 v3, s[12:15], s63 offen offset:1024 sc1 lds
    s_mov_b32 m0, s65
    s_add_u32 s63, s63, 8192
    buffer_load_dwordx4 v3, s[12:15], s46 offen sc1 lds
    buffer_load_dwordx4 v3, s[12:15], s46 offen offset:1024 sc1 lds
    s_add_u32 s64, s64, 16384
    s_add_u32 s65, s65, 16384
    s_cmp_lg_u32 s44, 0
    s_cbranch_scc1 L_ld_39
    v_mov_b32 v40, 1
    v_mov_b32 v41, 127360
    s_mov_b64 exec, 1
    buffer_atomic_add v40, v41, s[12:15], 0 offen sc1
    s_mov_b64 exec, -1
L_ld_39:
L_q_loop_40:
    ds_read_b128 v[56:59], v5 offset:8192
    ds_read_b128 v[60:63], v5 offset:9216
    ds_read_b128 v[64:67], v5 offset:20480
    ds_read_b128 v[68:71], v5 offset:21504
    ds_read_b128 v[72:75], v5 offset:14336
    ds_read_b128 v[76:79], v5 offset:15360
    ds_read_b128 v[80:83], v5 offset:22528
    ds_read_b128 v[84:87], v5 offset:23552
    ds_read_b128 v[88:91], v5 offset:2048
    ds_read_b128 v[92:95], v5 offset:3072
    s_add_u32 s46, s60, 1
    v_mov_b32 v15, s46
    v_mov_b32 v0, -1
    v_mov_b32 v24, 0
    v_mov_b32 v25, 0
    v_mov_b32 v26, 0
    v_mov_b32 v27, 0
    v_mov_b32 v28, 0
    v_mov_b32 v29, 0
    v_mov_b32 v30, 0
    v_mov_b32 v31, 0
    v_mov_b32 v32, 0
    v_mov_b32 v33, 0
    v_mov_b32 v34, 0
    v_mov_b32 v35, 0
    v_mov_b32 v36, 0
    v_mov_b32 v37, 0
    v_mov_b32 v38, 0
    v_mov_b32 v39, 0
    s_add_u32 s8, s61, s32
    s_add_u32 s9, s61, s33
    s_add_u32 s10, s61, s34
    s_add_u32 s11, s61, s35
    s_waitcnt lgkmcnt(0)
    s_cmp_eq_u32 s60, 0
    s_cbranch_scc1 L_q_first_41
    s_sleep 16
    s_waitcnt vmcnt(0)
    s_mov_b64 exec, 65535
    buffer_load_dword v40, v19, s[12:15], 0 offen sc1
    s_nop 15
    buffer_load_dword v41, v19, s[12:15], 0 offen sc1
    s_nop 15
    buffer_load_dword v42, v19, s[12:15], 0 offen sc1
    s_nop 15
    buffer_load_dword v43, v19, s[12:15], 0 offen sc1
    s_mov_b32 s70, 0
L_pp_42:
    s_waitcnt vmcnt(3)
    v_cmp_gt_u32 vcc, s60, v40
    s_nop 1
    s_cbranch_vccz L_ppd_43
    buffer_load_dword v40, v19, s[12:15], 0 offen sc1
    s_waitcnt vmcnt(3)
    v_cmp_gt_u32 vcc, s60, v41
    s_nop 1
    s_cbranch_vccz L_ppd_43
    buffer_load_dword v41, v19, s[12:15], 0 offen sc1
    s_waitcnt vmcnt(3)
    v_cmp_gt_u32 vcc, s60, v42
    s_nop 1
    s_cbranch_vccz L_ppd_43
    buffer_load_dword v42, v19, s[12:15], 0 offen sc1
    s_waitcnt vmcnt(3)
    v_cmp_gt_u32 vcc, s60, v43
    s_nop 1
    s_cbranch_vccz L_ppd_43
    buffer_load_dword v43, v19, s[12:15], 0 offen sc1
    s_add_u32 s70, s70, 1
    s_cmp_lt_u32 s70, 0x100000
    s_cbranch_scc1 L_pp_42
    s_branch L_c_done_1
.p2align 5
    s_nop 0
    s_nop 0
    s_nop 0
    s_nop 0
    s_nop 0
    s_nop 0
L_ppd_43:
    s_mov_b64 exec, -1
L_q_first_41:
    buffer_load_dwordx4 v[40:43], v3, s[12:15], s8 offen sc1
    s_nop 4
    buffer_load_dwordx4 v[44:47], v3, s[12:15], s9 offen sc1
    s_nop 4
    buffer_load_dwordx4 v[48:51], v3, s[12:15], s10 offen sc1
    s_nop 4
    buffer_load_dwordx4 v[52:55], v3, s[12:15], s11 offen sc1
    s_mov_b32 s70, 0
L_mg_44_p:
    s_waitcnt vmcnt(3)
    ds_write_b128 v3, v[40:43] offset:0
    v_smfmac_f32_16x16x64_bf16 v[24:27], v[40:43], a[0:7], v2
    v_max3_u32 v22, v40, v41, v42
    v_smfmac_f32_16x16x64_bf16 v[28:31], v[40:43], a[8:15], v2
    v_max_u32 v22, v22, v43
    v_smfmac_f32_16x16x64_bf16 v[32:35], v[40:43], a[16:23], v2
    v_smfmac_f32_16x16x64_bf16 v[36:39], v[40:43], a[24:31], v2
    s_waitcnt vmcnt(2)
    ds_write_b128 v3, v[44:47] offset:1024
    v_smfmac_f32_16x16x64_bf16 v[24:27], v[44:47], a[32:39], v2
    v_max3_u32 v22, v22, v44, v45
    v_smfmac_f32_16x16x64_bf16 v[28:31], v[44:47], a[40:47], v2
    v_max3_u32 v22, v22, v46, v47
    v_smfmac_f32_16x16x64_bf16 v[32:35], v[44:47], a[48:55], v2
    v_smfmac_f32_16x16x64_bf16 v[36:39], v[44:47], a[56:63], v2
    s_waitcnt vmcnt(1)
    ds_write_b128 v3, v[48:51] offset:2048
    v_smfmac_f32_16x16x64_bf16 v[24:27], v[48:51], a[64:71], v2
    v_max3_u32 v22, v22, v48, v49
    v_smfmac_f32_16x16x64_bf16 v[28:31], v[48:51], v[56:63], v2
    v_max3_u32 v22, v22, v50, v51
    s_waitcnt vmcnt(0)
    ds_write_b128 v3, v[52:55] offset:3072
    v_smfmac_f32_16x16x64_bf16 v[32:35], v[48:51], a[72:79], v2
    v_max3_u32 v22, v22, v52, v53
    v_smfmac_f32_16x16x64_bf16 v[36:39], v[48:51], v[64:71], v2
    v_max3_u32 v22, v22, v54, v55
    v_cmp_eq_u32 vcc, -1, v22
    s_nop 0
    s_waitcnt lgkmcnt(0)
    s_cbranch_vccnz L_mg_44_r
    s_barrier
    ds_read_b128 v[40:43], v4 offset:0
    ds_read_b128 v[44:47], v4 offset:1024
    ds_read_b128 v[48:51], v4 offset:2048
    ds_read_b128 v[56:59], v5 offset:6144
    v_smfmac_f32_16x16x64_bf16 v[24:27], v[52:55], a[80:87], v2
    ds_read_b128 v[60:63], v5 offset:7168
    v_smfmac_f32_16x16x64_bf16 v[28:31], v[52:55], v[72:79], v2
    ds_read_b128 v[64:67], v5 offset:12288
    v_smfmac_f32_16x16x64_bf16 v[32:35], v[52:55], a[88:95], v2
    ds_read_b128 v[68:71], v5 offset:13312
    v_smfmac_f32_16x16x64_bf16 v[36:39], v[52:55], v[80:87], v2
    ds_read_b128 v[52:55], v4 offset:3072
    s_waitcnt lgkmcnt(4)
    v_smfmac_f32_16x16x64_bf16 v[24:27], v[40:43], a[96:103], v2
    ds_read_b128 v[72:75], v5 offset:18432
    v_smfmac_f32_16x16x64_bf16 v[28:31], v[40:43], v[88:95], v2
    ds_read_b128 v[76:79], v5 offset:19456
    v_smfmac_f32_16x16x64_bf16 v[32:35], v[40:43], a[104:111], v2
    ds_read_b128 v[80:83], v5 offset:0
    v_smfmac_f32_16x16x64_bf16 v[36:39], v[40:43], a[112:119], v2
    ds_read_b128 v[40:43], v21 offset:0
    v_smfmac_f32_16x16x64_bf16 v[24:27], v[44:47], a[120:127], v2
    ds_read_b128 v[84:87], v5 offset:1024
    s_waitcnt lgkmcnt(4)
    v_smfmac_f32_16x16x64_bf16 v[28:31], v[44:47], v[56:63], v2
    ds_read_b128 v[88:91], v5 offset:4096
    v_smfmac_f32_16x16x64_bf16 v[32:35], v[44:47], a[128:135], v2
    ds_read_b128 v[92:95], v5 offset:5120
    v_smfmac_f32_16x16x64_bf16 v[36:39], v[44:47], a[136:143], v2
    ds_read_b128 v[44:47], v21 offset:1024
    v_smfmac_f32_16x16x64_bf16 v[24:27], v[48:51], a[144:151], v2
    ds_read_b128 v[56:59], v5 offset:10240
    v_smfmac_f32_16x16x64_bf16 v[28:31], v[48:51], v[64:71], v2
    ds_read_b128 v[48:51], v21 offset:2048
    v_smfmac_f32_16x16x64_bf16 v[24:27], v[52:55], a[168:175], v2
    ds_read_b128 v[60:63], v5 offset:11264
    s_waitcnt lgkmcnt(4)
    v_smfmac_f32_16x16x64_bf16 v[28:31], v[52:55], v[72:79], v2
    ds_read_b128 v[52:55], v21 offset:3072
    v_smfmac_f32_16x16x64_bf16 v[24:27], v[40:43], a[192:199], v2
    ds_read_b128 v[64:67], v5 offset:16384
    v_smfmac_f32_16x16x64_bf16 v[28:31], v[40:43], v[80:87], v2
    ds_read_b128 v[40:43], v23 offset:0
    s_waitcnt lgkmcnt(4)
    v_smfmac_f32_16x16x64_bf16 v[24:27], v[44:47], a[216:223], v2
    ds_read_b128 v[68:71], v5 offset:17408
    v_smfmac_f32_16x16x64_bf16 v[28:31], v[44:47], v[88:95], v2
    ds_read_b128 v[44:47], v23 offset:1024
    v_smfmac_f32_16x16x64_bf16 v[24:27], v[48:51], a[240:247], v2
    s_waitcnt lgkmcnt(3)
    v_smfmac_f32_16x16x64_bf16 v[28:31], v[48:51], v[56:63], v2
    ds_read_b128 v[48:51], v23 offset:2048
    v_smfmac_f32_16x16x64_bf16 v[24:27], v[52:55], v[104:111], v2
    s_waitcnt lgkmcnt(2)
    v_smfmac_f32_16x16x64_bf16 v[28:31], v[52:55], v[64:71], v2
    ds_read_b128 v[52:55], v23 offset:3072
    v_smfmac_f32_16x16x64_bf16 v[24:27], v[40:43], v[128:135], v2
    v_smfmac_f32_16x16x64_bf16 v[28:31], v[40:43], v[136:143], v2
    s_waitcnt lgkmcnt(1)
    v_smfmac_f32_16x16x64_bf16 v[24:27], v[44:47], v[160:167], v2
    v_smfmac_f32_16x16x64_bf16 v[28:31], v[44:47], v[168:175], v2
    ds_read_b128 v[72:75], v8 offset:20480
    v_smfmac_f32_16x16x64_bf16 v[24:27], v[48:51], v[192:199], v2
    ds_read_b128 v[76:79], v8 offset:21504
    v_smfmac_f32_16x16x64_bf16 v[28:31], v[48:51], v[200:207], v2
    ds_read_b128 v[56:59], v8 offset:16384
    s_waitcnt lgkmcnt(3)
    v_smfmac_f32_16x16x64_bf16 v[24:27], v[52:55], v[224:231], v2
    ds_read_b128 v[60:63], v8 offset:17408
    v_smfmac_f32_16x16x64_bf16 v[28:31], v[52:55], v[232:239], v2
    ds_read_b128 v[64:67], v8 offset:18432
    v_smfmac_f32_16x16x64_bf16 v[32:35], v[52:55], v[240:247], v2
    ds_read_b128 v[68:71], v8 offset:19456
    v_smfmac_f32_16x16x64_bf16 v[36:39], v[52:55], v[248:255], v2
    ds_read_b128 v[52:55], v21 offset:3072
    v_smfmac_f32_16x16x64_bf16 v[32:35], v[48:51], v[208:215], v2
    s_nop 1
    v_permlane32_swap_b32 v24, v28
    v_permlane32_swap_b32 v25, v29
    v_smfmac_f32_16x16x64_bf16 v[36:39], v[48:51], v[216:223], v2
    ds_read_b128 v[48:51], v21 offset:2048
    v_permlane32_swap_b32 v26, v30
    v_smfmac_f32_16x16x64_bf16 v[32:35], v[44:47], v[176:183], v2
    v_permlane32_swap_b32 v27, v31
    v_add_f32 v24, v24, v28
    v_smfmac_f32_16x16x64_bf16 v[36:39], v[44:47], v[184:191], v2
    ds_read_b128 v[44:47], v21 offset:1024
    v_add_f32 v25, v25, v29
    v_smfmac_f32_16x16x64_bf16 v[32:35], v[40:43], v[144:151], v2
    v_add_f32 v26, v26, v30
    v_add_f32 v27, v27, v31
    v_smfmac_f32_16x16x64_bf16 v[36:39], v[40:43], v[152:159], v2
    ds_read_b128 v[40:43], v21 offset:0
    v_cvt_pk_bf16_f32 v24, v24, v25
    s_waitcnt lgkmcnt(2)
    v_smfmac_f32_16x16x64_bf16 v[32:35], v[52:55], v[112:119], v2
    v_cvt_pk_bf16_f32 v25, v26, v27
    v_smfmac_f32_16x16x64_bf16 v[36:39], v[52:55], v[120:127], v2
    ds_read_b128 v[52:55], v4 offset:3072
    v_smfmac_f32_16x16x64_bf16 v[32:35], v[48:51], a[248:255], v2
    ds_write_b64 v6, v[24:25]
    v_smfmac_f32_16x16x64_bf16 v[36:39], v[48:51], v[96:103], v2
    ds_read_b128 v[48:51], v4 offset:2048
    s_waitcnt lgkmcnt(3)
    v_smfmac_f32_16x16x64_bf16 v[32:35], v[44:47], a[224:231], v2
    v_smfmac_f32_16x16x64_bf16 v[36:39], v[44:47], a[232:239], v2
    v_smfmac_f32_16x16x64_bf16 v[32:35], v[40:43], a[200:207], v2
    s_waitcnt lgkmcnt(1)
    s_barrier
    ds_read_b64_tr_b16 v[80:81], v7 offset:0
    v_smfmac_f32_16x16x64_bf16 v[36:39], v[40:43], a[208:215], v2
    ds_read_b64_tr_b16 v[82:83], v7 offset:64
    ds_read_b64_tr_b16 v[84:85], v7 offset:512
    v_smfmac_f32_16x16x64_bf16 v[32:35], v[52:55], a[176:183], v2
    ds_read_b64_tr_b16 v[86:87], v7 offset:576
    v_smfmac_f32_16x16x64_bf16 v[36:39], v[52:55], a[184:191], v2
    ds_read_b64_tr_b16 v[88:89], v7 offset:1024
    s_waitcnt lgkmcnt(5)
    v_smfmac_f32_16x16x64_bf16 v[32:35], v[48:51], a[152:159], v2
    ds_read_b64_tr_b16 v[90:91], v7 offset:1088
    v_smfmac_f32_16x16x64_bf16 v[36:39], v[48:51], a[160:167], v2
    ds_read_b64_tr_b16 v[92:93], v7 offset:1536
    ds_read_b64_tr_b16 v[94:95], v7 offset:1600
    s_waitcnt lgkmcnt(5)
    v_mfma_f32_16x16x32_bf16 v[24:27], v[56:59], v[80:83], 0
    ds_read_b128 v[56:59], v8 offset:22528
    v_mfma_f32_16x16x32_bf16 v[28:31], v[60:63], v[80:83], 0
    ds_read_b128 v[60:63], v8 offset:23552
    s_waitcnt lgkmcnt(5)
    v_mfma_f32_16x16x32_bf16 v[24:27], v[64:67], v[84:87], v[24:27]
    v_cvt_pk_bf16_f32 v32, v32, v33
    v_cvt_pk_bf16_f32 v33, v34, v35
    v_cvt_pk_bf16_f32 v34, v36, v37
    v_cvt_pk_bf16_f32 v35, v38, v39
    ds_write2_b64 v18, v[32:33], v[34:35] offset1:32
    v_mfma_f32_16x16x32_bf16 v[28:31], v[68:71], v[84:87], v[28:31]
    s_waitcnt lgkmcnt(3)
    v_mfma_f32_16x16x32_bf16 v[24:27], v[72:75], v[88:91], v[24:27]
    s_cmp_eq_u32 s60, 63
    v_mfma_f32_16x16x32_bf16 v[28:31], v[76:79], v[88:91], v[28:31]
    s_waitcnt lgkmcnt(0)
    s_barrier
    v_mfma_f32_16x16x32_bf16 v[24:27], v[56:59], v[92:95], v[24:27]
    ds_read_b64_tr_b16 v[40:41], v14 offset:55296
    ds_read_b64_tr_b16 v[42:43], v14 offset:55816
    v_mfma_f32_16x16x32_bf16 v[28:31], v[60:63], v[92:95], v[28:31]
    buffer_load_dwordx2 v[0:1], v16, s[12:15], s51 offen sc1
    ds_read_b64_tr_b16 v[44:45], v14 offset:56336
    ds_read_b64_tr_b16 v[46:47], v14 offset:56856
    ds_read_b64_tr_b16 v[48:49], v14 offset:57376
    ds_read_b64_tr_b16 v[50:51], v14 offset:57896
    v_mov_b32 v32, 0x3f803f80
    ds_read_b64_tr_b16 v[52:53], v14 offset:58416
    ds_read_b64_tr_b16 v[54:55], v14 offset:58936
    s_cbranch_scc1 L_q_last_45
    v_cndmask_b32 v24, v28, v24, s[56:57]
    v_cndmask_b32 v25, v29, v25, s[56:57]
    v_cndmask_b32 v26, v30, v26, s[56:57]
    v_cndmask_b32 v27, v31, v27, s[56:57]
    v_max3_f32 v11, v24, v25, v26
    v_max_f32 v11, v11, v27
    s_waitcnt lgkmcnt(0)
    v_mfma_f32_16x16x32_bf16 v[36:39], v[40:43], v[80:83], 0
    ds_read_b64_tr_b16 v[64:65], v9 offset:24576
    v_max_f32_dpp v12, v11, v11 row_ror:8 row_mask:0xf bank_mask:0xf
    v_max_f32_dpp v13, v11, v11 row_ror:8 row_mask:0xf bank_mask:0xf
    v_mfma_f32_16x16x32_bf16 v[36:39], v[44:47], v[84:87], v[36:39]
    ds_read_b64_tr_b16 v[66:67], v9 offset:25600
    v_permlane32_swap_b32 v12, v13
    v_max_f32 v22, v12, v13
    v_max_f32 v13, v12, v13
    v_mfma_f32_16x16x32_bf16 v[36:39], v[48:51], v[88:91], v[36:39]
    ds_read_b64_tr_b16 v[68:69], v9 offset:25088
    v_permlane16_swap_b32 v22, v13
    v_mfma_f32_16x16x32_bf16 v[36:39], v[52:55], v[92:95], v[36:39]
    ds_read_b64_tr_b16 v[70:71], v9 offset:26112
    v_max_f32 v11, v22, v13
    v_mul_f32 v10, s52, v11
    v_fma_f32 v24, v24, s52, -v10
    v_fma_f32 v25, v25, s52, -v10
    v_fma_f32 v26, v26, s52, -v10
    v_fma_f32 v27, v27, s52, -v10
    v_exp_f32 v24, v24
    v_exp_f32 v25, v25
    v_exp_f32 v26, v26
    v_exp_f32 v27, v27
    v_permlane32_swap_b32 v36, v38
    v_cvt_pk_bf16_f32 v60, v24, v25
    v_cvt_pk_bf16_f32 v61, v26, v27
    v_permlane32_swap_b32 v37, v39
    v_mov_b32_dpp v62, v60 row_ror:8 row_mask:0xf bank_mask:0xf
    v_mov_b32_dpp v63, v61 row_ror:8 row_mask:0xf bank_mask:0xf
    v_add_f32 v36, v36, v38
    v_add_f32 v37, v37, v39
    s_waitcnt lgkmcnt(0)
    v_mfma_f32_16x16x32_bf16 v[72:75], v[64:67], v[60:63], 0
    buffer_store_dword v15, v20, s[24:27], 0 offen
    v_fma_f32 v12, v36, s52, -v10
    v_fma_f32 v13, v37, s52, -v10
    v_mov_b32 v33, 0x3f803f80
    v_mfma_f32_16x16x32_bf16 v[76:79], v[68:71], v[60:63], 0
    v_mov_b32 v34, 0x3f803f80
    v_mov_b32 v35, 0x3f803f80
    v_max_f32 v11, v12, v13
    v_exp_f32 v36, v12
    v_mfma_f32_16x16x32_bf16 v[24:27], v[32:35], v[60:63], 0
    s_waitcnt vmcnt(1)
    v_max_u32 v22, v0, v1
    v_cmp_lt_f32 s[8:9], s53, v11
    v_cmp_eq_u32 vcc, -1, v22
    v_exp_f32 v37, v13
    v_mov_b32 v57, 0
    v_cvt_pk_bf16_f32 v56, v36, v37
    s_or_b64 s[10:11], vcc, s[8:9]
    s_cbranch_scc1 L_q_vm_46_s
L_q_vm_46_j:
    v_mfma_f32_16x16x16_bf16 v[24:27], v[32:33], v[56:57], v[24:27]
    s_nop 0
    v_mov_b32 v58, 0
    v_mov_b32 v59, v56
    v_mfma_f32_16x16x16_bf16 v[72:75], v[0:1], v[56:57], v[72:75]
    s_nop 2
    v_mfma_f32_16x16x16_bf16 v[76:79], v[0:1], v[58:59], v[76:79]
    v_rcp_f32 v12, v24
    s_nop 2
    v_pk_mul_f32 v[72:73], v[72:73], v[12:13] op_sel_hi:[1,0]
    v_pk_mul_f32 v[74:75], v[74:75], v[12:13] op_sel_hi:[1,0]
    v_cvt_pk_bf16_f32 v72, v72, v73
    v_cvt_pk_bf16_f32 v73, v74, v75
    v_pk_mul_f32 v[76:77], v[76:77], v[12:13] op_sel_hi:[1,0]
    v_pk_mul_f32 v[78:79], v[78:79], v[12:13] op_sel_hi:[1,0]
    v_cvt_pk_bf16_f32 v74, v76, v77
    v_cvt_pk_bf16_f32 v75, v78, v79
    buffer_store_dwordx4 v[72:75], v17, s[24:27], s62 offen
    buffer_store_dwordx4 v[72:75], v17, s[28:31], s62 offen sc1
    buffer_store_dword v15, v20, s[28:31], 0 offen sc1
    v_mov_b32 v60, -1
    v_mov_b32 v61, -1
    v_mov_b32 v62, -1
    v_mov_b32 v63, -1
    s_add_u32 s45, s60, 3
    s_and_b32 s45, s45, 3
    s_lshl_b32 s45, s45, 15
    s_add_u32 s45, s45, s59
    buffer_store_dwordx4 v[60:63], v17, s[24:27], s45 offen
    buffer_store_dwordx4 v[60:63], v17, s[28:31], s45 offen sc1
    s_barrier
    s_and_b32 s45, s51, 0xffff
    s_lshl_b32 s46, s60, 16
    s_add_u32 s45, s45, s46
    s_add_u32 s45, s45, 0x1800000
    buffer_store_dwordx2 v[0:1], v16, s[12:15], s45 offen sc1
L_q_last_45:
    s_waitcnt lgkmcnt(0)
    v_lshlrev_b32 v22, 1, v16
    s_cmp_lg_u32 s44, 0
    s_cbranch_scc1 L_q_km_47_0
    buffer_store_dwordx4 v[40:43], v22, s[12:15], s66 offen offset:0 sc1
L_q_km_47_0:
    s_cmp_lg_u32 s44, 1
    s_cbranch_scc1 L_q_km_47_1
    buffer_store_dwordx4 v[44:47], v22, s[12:15], s66 offen offset:1024 sc1
L_q_km_47_1:
    s_cmp_lg_u32 s44, 2
    s_cbranch_scc1 L_q_km_47_2
    buffer_store_dwordx4 v[48:51], v22, s[12:15], s66 offen offset:2048 sc1
L_q_km_47_2:
    s_cmp_lg_u32 s44, 3
    s_cbranch_scc1 L_q_km_47_3
    buffer_store_dwordx4 v[52:55], v22, s[12:15], s66 offen offset:3072 sc1
L_q_km_47_3:
    s_cmp_eq_u32 s60, 63
    s_cbranch_scc1 L_q_fin_48
    s_cmp_eq_u32 s60, 62
    s_cbranch_scc1 L_q_fin_48_n
    s_add_u32 s47, s60, 1
    s_cmp_lt_u32 s47, s50
    s_cbranch_scc1 L_kv_rdy_49
    s_lshl_b32 s45, s43, 7
    s_add_u32 s45, s45, 0x10014
    v_mov_b32 v0, 0
    s_mov_b32 s70, 0
L_kv_rdy_49_p:
    buffer_load_dwordx2 v[10:11], v0, s[12:15], s45 offen sc1
    s_add_u32 s70, s70, 1
    s_cmp_ge_u32 s70, 0x200000
    s_cbranch_scc1 L_c_done_1
    s_waitcnt vmcnt(0)
    v_min_u32 v10, v10, v11
    s_nop 0
    v_readfirstlane_b32 s50, v10
    s_nop 3
    s_cmp_lt_u32 s47, s50
    s_cbranch_scc1 L_kv_rdy_49
    s_sleep 2
    s_branch L_kv_rdy_49_p
L_kv_rdy_49:
    s_mov_b32 m0, s64
    s_add_u32 s46, s63, 0x1000000
    buffer_load_dwordx4 v3, s[12:15], s63 offen sc1 lds
    buffer_load_dwordx4 v3, s[12:15], s63 offen offset:1024 sc1 lds
    s_mov_b32 m0, s65
    s_add_u32 s63, s63, 8192
    buffer_load_dwordx4 v3, s[12:15], s46 offen sc1 lds
    buffer_load_dwordx4 v3, s[12:15], s46 offen offset:1024 sc1 lds
    s_branch L_q_fin_48_k
L_q_fin_48_n:
    s_waitcnt vmcnt(0)
L_q_fin_48_k:
    s_add_u32 s47, s60, 1
    s_bitcmp1_b64 s[6:7], s47
    s_cselect_b32 s47, s47, s60
    s_cbranch_scc0 L_q_fin_48_m
    s_waitcnt vmcnt(4)
L_q_fin_48_m:
    v_mov_b32 v22, s47
    v_mov_b32 v0, 0
    s_mov_b64 exec, 1
    buffer_store_dword v22, v0, s[12:15], s3 offen sc1
    s_mov_b64 exec, -1
    s_mov_b64 exec, -1
    v_add_u32 v8, s69, v8
    v_add_u32 v9, s69, v9
    s_sub_u32 s64, s64, s69
    s_sub_u32 s65, s65, s69
    s_sub_u32 s69, 0, s69
    s_add_u32 s66, s66, 131072
    s_xor_b32 s51, s51, 65536
    s_add_u32 s60, s60, 1
    s_and_b32 s45, s60, 3
    s_lshl_b32 s46, s45, 14
    s_add_u32 s61, s58, s46
    s_lshl_b32 s46, s45, 15
    s_add_u32 s62, s59, s46
    s_branch L_q_loop_40
L_q_fin_48:
    s_waitcnt vmcnt(0)
    v_mov_b32 v22, 64
    v_mov_b32 v0, 0
    s_mov_b64 exec, 1
    buffer_store_dword v22, v0, s[12:15], s3 offen sc1
    s_mov_b64 exec, -1
    s_endpgm
L_mg_44_r:
    buffer_load_dwordx4 v[40:43], v3, s[12:15], s8 offen sc1
    buffer_load_dwordx4 v[44:47], v3, s[12:15], s9 offen sc1
    buffer_load_dwordx4 v[48:51], v3, s[12:15], s10 offen sc1
    buffer_load_dwordx4 v[52:55], v3, s[12:15], s11 offen sc1
    s_add_u32 s70, s70, 1
    s_cmp_ge_u32 s70, 0x100000
    s_cbranch_scc1 L_c_done_1
    s_nop 1
    v_mov_b32 v24, 0
    v_mov_b32 v25, 0
    v_mov_b32 v26, 0
    v_mov_b32 v27, 0
    v_mov_b32 v28, 0
    v_mov_b32 v29, 0
    v_mov_b32 v30, 0
    v_mov_b32 v31, 0
    v_mov_b32 v32, 0
    v_mov_b32 v33, 0
    v_mov_b32 v34, 0
    v_mov_b32 v35, 0
    v_mov_b32 v36, 0
    v_mov_b32 v37, 0
    v_mov_b32 v38, 0
    v_mov_b32 v39, 0
    s_branch L_mg_44_p
L_q_vm_46_s:
    s_cbranch_vccz L_q_vm_46_t
    buffer_load_dwordx2 v[0:1], v16, s[12:15], s51 offen sc1
    s_add_u32 s70, s70, 1
    s_nop 0
    s_cmp_ge_u32 s70, 0x100000
    s_cbranch_scc1 L_c_done_1
    s_waitcnt vmcnt(0)
    v_max_u32 v22, v0, v1
    v_cmp_eq_u32 vcc, -1, v22
    s_nop 1
    s_branch L_q_vm_46_s
L_q_vm_46_t:
    s_cmp_eq_u64 s[8:9], 0
    s_cbranch_scc1 L_q_vm_46_j
    v_max_f32 v11, 0, v11
    v_mov_b32 v22, v11
    s_nop 1
    v_permlane32_swap_b32 v11, v22
    v_max_f32 v11, v11, v22
    v_mov_b32 v22, v11
    s_nop 1
    v_permlane16_swap_b32 v11, v22
    v_max_f32 v11, v11, v22
    v_sub_f32 v12, v12, v11
    v_sub_f32 v13, v13, v11
    v_sub_f32 v11, 0, v11
    v_exp_f32 v36, v12
    v_exp_f32 v37, v13
    v_exp_f32 v11, v11
    s_nop 7
    v_mul_f32 v72, v72, v11
    v_mul_f32 v73, v73, v11
    v_mul_f32 v74, v74, v11
    v_mul_f32 v75, v75, v11
    v_mul_f32 v76, v76, v11
    v_mul_f32 v77, v77, v11
    v_mul_f32 v78, v78, v11
    v_mul_f32 v79, v79, v11
    v_mul_f32 v24, v24, v11
    v_cvt_pk_bf16_f32 v56, v36, v37
    v_cvt_pk_bf16_f32 v59, v36, v37
    s_nop 1
    s_branch L_q_vm_46_j
L_c_vo_2:
    s_lshl_b32 s45, s43, 11
    s_lshl_b32 s46, s44, 9
    s_add_u32 s45, s45, s46
    v_lshlrev_b32 v10, 3, v1
    v_add_u32 v10, s45, v10
    v_lshlrev_b32 v11, 3, v0
    v_bfe_u32 v69, v1, 4, 1
    v_lshlrev_b32 v69, 2, v69
    v_lshrrev_b32 v63, 5, v1
    v_lshlrev_b32 v63, 1, v63
    v_and_b32 v64, 1, v1
    v_add3_u32 v69, v69, v63, v64
    v_bfe_u32 v63, v1, 1, 1
    v_lshlrev_b32 v63, 3, v63
    v_add_u32 v63, v63, v69
    v_lshlrev_b32 v63, 4, v63
    v_bfe_u32 v64, v1, 2, 2
    v_lshlrev_b32 v64, 2, v64
    s_lshl_b32 s45, s42, 10
    s_lshl_b32 s46, s44, 8
    s_add_u32 s45, s45, s46
    v_add3_u32 v12, v63, v64, s45
    v_and_b32 v64, 1, v1
    v_cmp_eq_u32 vcc, 0, v64
    v_mov_b32 v9, 0x07060302
    v_mov_b32 v63, 0x01000504
    v_cndmask_b32 v9, v9, v63, vcc
    s_lshl_b32 s63, s40, 19
    s_lshl_b32 s45, s42, 15
    s_add_u32 s63, s63, s45
    s_add_u32 s63, s63, 0x7100000
    s_xor_b32 s64, s63, 524288
    s_lshl_b32 s45, s40, 13
    s_lshl_b32 s46, s44, 2
    s_add_u32 s45, s45, s46
    s_lshl_b32 s46, s42, 4
    s_add_u32 s45, s45, s46
    s_add_u32 s45, s45, 0x7084000
    v_lshlrev_b32 v20, 8, v1
    v_add_u32 v20, s45, v20
    v_mov_b32 v63, 0x20000000
    v_cmp_gt_u32 vcc, 16, v1
    s_nop 1
    v_cndmask_b32 v20, v63, v20, vcc
    buffer_store_dword v44, v20, s[12:15], 0 offen sc1
    s_mov_b32 s45, 0x7020000
    buffer_store_dwordx2 v[40:41], v10, s[12:15], s45 offen sc1
    s_mov_b32 s45, 0x7030000
    buffer_store_dwordx2 v[40:41], v10, s[12:15], s45 offen sc1
    s_add_u32 s45, s63, 0
    buffer_store_dwordx2 v[40:41], v11, s[12:15], s45 offen sc1
    s_add_u32 s45, s63, 4096
    buffer_store_dwordx2 v[40:41], v11, s[12:15], s45 offen sc1
    s_add_u32 s45, s63, 8192
    buffer_store_dwordx2 v[40:41], v11, s[12:15], s45 offen sc1
    s_add_u32 s45, s63, 12288
    buffer_store_dwordx2 v[40:41], v11, s[12:15], s45 offen sc1
    s_add_u32 s45, s63, 16384
    buffer_store_dwordx2 v[40:41], v11, s[12:15], s45 offen sc1
    s_add_u32 s45, s63, 20480
    buffer_store_dwordx2 v[40:41], v11, s[12:15], s45 offen sc1
    s_add_u32 s45, s63, 24576
    buffer_store_dwordx2 v[40:41], v11, s[12:15], s45 offen sc1
    s_add_u32 s45, s63, 28672
    buffer_store_dwordx2 v[40:41], v11, s[12:15], s45 offen sc1
    s_lshl_b32 s61, s40, 16
    s_add_u32 s61, s61, 0x7000000
    s_add_u32 s45, s61, 16384
    buffer_store_dword v40, v12, s[12:15], s45 offen sc1
    s_add_u32 s45, s61, 32768
    buffer_store_dword v40, v12, s[12:15], s45 offen sc1
    s_add_u32 s45, s61, 49152
    buffer_store_dword v40, v12, s[12:15], s45 offen sc1
    v_lshlrev_b32 v63, 11, v69
    v_and_b32 v64, 14, v1
    v_lshlrev_b32 v64, 1, v64
    v_add_u32 v63, v63, v64
    s_lshl_b32 s45, s42, 7
    s_lshl_b32 s46, s44, 5
    s_add_u32 s45, s45, s46
    buffer_load_dword v45, v63, s[52:55], s45 offen
    s_mov_b32 s76, -1
    s_mov_b32 s77, -1
    v_lshrrev_b32 v63, 3, v1
    v_lshlrev_b32 v63, 11, v63
    v_bfe_u32 v64, v1, 1, 2
    v_and_b32 v65, 1, v1
    v_lshlrev_b32 v65, 4, v65
    v_add_u32 v63, v63, v65
    v_xor_b32 v66, 0, v64
    v_lshlrev_b32 v66, 5, v66
    v_add_u32 v70, v63, v66
    v_xor_b32 v66, 1, v64
    v_lshlrev_b32 v66, 5, v66
    v_add_u32 v71, v63, v66
    v_xor_b32 v66, 2, v64
    v_lshlrev_b32 v66, 5, v66
    v_add_u32 v72, v63, v66
    v_xor_b32 v66, 3, v64
    v_lshlrev_b32 v66, 5, v66
    v_add_u32 v73, v63, v66
    v_bfe_u32 v63, v1, 3, 1
    v_lshlrev_b32 v63, 1, v63
    v_bfe_u32 v64, v1, 4, 1
    v_add_u32 v63, v63, v64
    v_lshlrev_b32 v64, 3, v63
    v_lshrrev_b32 v65, 5, v1
    v_lshlrev_b32 v65, 2, v65
    v_add_u32 v64, v64, v65
    v_bfe_u32 v65, v1, 2, 1
    v_add_u32 v64, v64, v65
    v_lshlrev_b32 v64, 7, v64
    v_and_b32 v65, 3, v1
    v_lshlrev_b32 v65, 3, v65
    v_add_u32 v64, v64, v65
    s_lshl_b32 s45, s44, 12
    v_add_u32 v64, s45, v64
    s_add_u32 s45, s44, 1
    s_and_b32 s45, s45, 3
    v_xor_b32 v65, s45, v63
    v_lshlrev_b32 v65, 5, v65
    v_add_u32 v74, v64, v65
    s_mul_i32 s45, s44, 20480
    s_add_u32 s45, s45, 65536
    v_add_u32 v88, s45, v74
    s_add_u32 s45, s44, 2
    s_and_b32 s45, s45, 3
    v_xor_b32 v65, s45, v63
    v_lshlrev_b32 v65, 5, v65
    v_add_u32 v75, v64, v65
    s_mul_i32 s45, s44, 20480
    s_add_u32 s45, s45, 65536
    v_add_u32 v89, s45, v75
    s_add_u32 s45, s44, 3
    s_and_b32 s45, s45, 3
    v_xor_b32 v65, s45, v63
    v_lshlrev_b32 v65, 5, v65
    v_add_u32 v76, v64, v65
    s_mul_i32 s45, s44, 20480
    s_add_u32 s45, s45, 65536
    v_add_u32 v90, s45, v76
    s_add_u32 s45, s44, 4
    s_and_b32 s45, s45, 3
    v_xor_b32 v65, s45, v63
    v_lshlrev_b32 v65, 5, v65
    v_add_u32 v77, v64, v65
    s_mul_i32 s45, s44, 20480
    s_add_u32 s45, s45, 65536
    v_add_u32 v91, s45, v77
    s_mul_i32 s65, s44, 24576
    s_lshl_b32 s49, s40, 22
    s_lshl_b32 s45, s44, 20
    s_add_u32 s49, s49, s45
    s_lshl_b32 s45, s42, 7
    s_add_u32 s49, s49, s45
    s_lshl_b32 s50, s44, 12
    s_mul_i32 s69, s42, 1
    s_add_u32 s51, s69, 0
    s_and_b32 s51, s51, 7
    s_lshl_b32 s51, s51, 17
    s_add_u32 s51, s51, s49
    s_add_u32 s46, s51, 0x0
    s_add_u32 m0, s65, 65536
    s_nop 0
    buffer_load_dwordx4 v70, s[36:39], s46 offen  lds
    s_add_u32 s46, s51, 0x8000
    s_add_u32 m0, s65, 66560
    s_nop 0
    buffer_load_dwordx4 v71, s[36:39], s46 offen  lds
    s_add_u32 s46, s51, 0x10000
    s_add_u32 m0, s65, 67584
    s_nop 0
    buffer_load_dwordx4 v72, s[36:39], s46 offen  lds
    s_add_u32 s46, s51, 0x18000
    s_add_u32 m0, s65, 68608
    s_nop 0
    buffer_load_dwordx4 v73, s[36:39], s46 offen  lds
    s_add_u32 s51, s69, 0
    s_and_b32 s51, s51, 7
    s_lshl_b32 s51, s51, 17
    s_add_u32 s51, s51, s49
    s_add_u32 s46, s51, 0x4000
    s_add_u32 m0, s65, 69632
    s_nop 0
    buffer_load_dwordx4 v70, s[36:39], s46 offen  lds
    s_add_u32 s46, s51, 0xc000
    s_add_u32 m0, s65, 70656
    s_nop 0
    buffer_load_dwordx4 v71, s[36:39], s46 offen  lds
    s_add_u32 s46, s51, 0x14000
    s_add_u32 m0, s65, 71680
    s_nop 0
    buffer_load_dwordx4 v72, s[36:39], s46 offen  lds
    s_add_u32 s46, s51, 0x1c000
    s_add_u32 m0, s65, 72704
    s_nop 0
    buffer_load_dwordx4 v73, s[36:39], s46 offen  lds
    s_add_u32 s51, s69, 1
    s_and_b32 s51, s51, 7
    s_lshl_b32 s51, s51, 17
    s_add_u32 s51, s51, s49
    s_add_u32 s46, s51, 0x0
    s_add_u32 m0, s65, 73728
    s_nop 0
    buffer_load_dwordx4 v70, s[36:39], s46 offen  lds
    s_add_u32 s46, s51, 0x8000
    s_add_u32 m0, s65, 74752
    s_nop 0
    buffer_load_dwordx4 v71, s[36:39], s46 offen  lds
    s_add_u32 s46, s51, 0x10000
    s_add_u32 m0, s65, 75776
    s_nop 0
    buffer_load_dwordx4 v72, s[36:39], s46 offen  lds
    s_add_u32 s46, s51, 0x18000
    s_add_u32 m0, s65, 76800
    s_nop 0
    buffer_load_dwordx4 v73, s[36:39], s46 offen  lds
    s_add_u32 s51, s69, 1
    s_and_b32 s51, s51, 7
    s_lshl_b32 s51, s51, 17
    s_add_u32 s51, s51, s49
    s_add_u32 s46, s51, 0x4000
    s_add_u32 m0, s65, 77824
    s_nop 0
    buffer_load_dwordx4 v70, s[36:39], s46 offen  lds
    s_add_u32 s46, s51, 0xc000
    s_add_u32 m0, s65, 78848
    s_nop 0
    buffer_load_dwordx4 v71, s[36:39], s46 offen  lds
    s_add_u32 s46, s51, 0x14000
    s_add_u32 m0, s65, 79872
    s_nop 0
    buffer_load_dwordx4 v72, s[36:39], s46 offen  lds
    s_add_u32 s46, s51, 0x1c000
    s_add_u32 m0, s65, 80896
    s_nop 0
    buffer_load_dwordx4 v73, s[36:39], s46 offen  lds
    s_add_u32 s51, s69, 2
    s_and_b32 s51, s51, 7
    s_lshl_b32 s51, s51, 17
    s_add_u32 s51, s51, s49
    s_add_u32 s46, s51, 0x0
    s_add_u32 m0, s65, 81920
    s_nop 0
    buffer_load_dwordx4 v70, s[36:39], s46 offen  lds
    s_add_u32 s46, s51, 0x8000
    s_add_u32 m0, s65, 82944
    s_nop 0
    buffer_load_dwordx4 v71, s[36:39], s46 offen  lds
    s_add_u32 s46, s51, 0x10000
    s_add_u32 m0, s65, 83968
    s_nop 0
    buffer_load_dwordx4 v72, s[36:39], s46 offen  lds
    s_add_u32 s46, s51, 0x18000
    s_add_u32 m0, s65, 84992
    s_nop 0
    buffer_load_dwordx4 v73, s[36:39], s46 offen  lds
    s_add_u32 s51, s69, 2
    s_and_b32 s51, s51, 7
    s_lshl_b32 s51, s51, 17
    s_add_u32 s51, s51, s49
    s_add_u32 s46, s51, 0x4000
    s_add_u32 m0, s65, 86016
    s_nop 0
    buffer_load_dwordx4 v70, s[36:39], s46 offen  lds
    s_add_u32 s46, s51, 0xc000
    s_add_u32 m0, s65, 87040
    s_nop 0
    buffer_load_dwordx4 v71, s[36:39], s46 offen  lds
    s_add_u32 s46, s51, 0x14000
    s_add_u32 m0, s65, 88064
    s_nop 0
    buffer_load_dwordx4 v72, s[36:39], s46 offen  lds
    s_add_u32 s46, s51, 0x1c000
    s_add_u32 m0, s65, 89088
    s_nop 0
    buffer_load_dwordx4 v73, s[36:39], s46 offen  lds
    s_add_u32 s51, s69, 3
    s_and_b32 s51, s51, 7
    s_lshl_b32 s51, s51, 17
    s_add_u32 s51, s51, s49
    s_add_u32 s46, s51, 0x0
    s_add_u32 m0, s50, 0
    s_nop 0
    buffer_load_dwordx4 v70, s[36:39], s46 offen  lds
    s_add_u32 s46, s51, 0x8000
    s_add_u32 m0, s50, 1024
    s_nop 0
    buffer_load_dwordx4 v71, s[36:39], s46 offen  lds
    s_add_u32 s46, s51, 0x10000
    s_add_u32 m0, s50, 2048
    s_nop 0
    buffer_load_dwordx4 v72, s[36:39], s46 offen  lds
    s_add_u32 s46, s51, 0x18000
    s_add_u32 m0, s50, 3072
    s_nop 0
    buffer_load_dwordx4 v73, s[36:39], s46 offen  lds
    s_add_u32 s51, s69, 3
    s_and_b32 s51, s51, 7
    s_lshl_b32 s51, s51, 17
    s_add_u32 s51, s51, s49
    s_add_u32 s46, s51, 0x4000
    s_add_u32 m0, s50, 16384
    s_nop 0
    buffer_load_dwordx4 v70, s[36:39], s46 offen  lds
    s_add_u32 s46, s51, 0xc000
    s_add_u32 m0, s50, 17408
    s_nop 0
    buffer_load_dwordx4 v71, s[36:39], s46 offen  lds
    s_add_u32 s46, s51, 0x14000
    s_add_u32 m0, s50, 18432
    s_nop 0
    buffer_load_dwordx4 v72, s[36:39], s46 offen  lds
    s_add_u32 s46, s51, 0x1c000
    s_add_u32 m0, s50, 19456
    s_nop 0
    buffer_load_dwordx4 v73, s[36:39], s46 offen  lds
    s_add_u32 s51, s69, 4
    s_and_b32 s51, s51, 7
    s_lshl_b32 s51, s51, 17
    s_add_u32 s51, s51, s49
    s_add_u32 s46, s51, 0x0
    s_add_u32 m0, s50, 32768
    s_nop 0
    buffer_load_dwordx4 v70, s[36:39], s46 offen  lds
    s_add_u32 s46, s51, 0x8000
    s_add_u32 m0, s50, 33792
    s_nop 0
    buffer_load_dwordx4 v71, s[36:39], s46 offen  lds
    s_add_u32 s46, s51, 0x10000
    s_add_u32 m0, s50, 34816
    s_nop 0
    buffer_load_dwordx4 v72, s[36:39], s46 offen  lds
    s_add_u32 s46, s51, 0x18000
    s_add_u32 m0, s50, 35840
    s_nop 0
    buffer_load_dwordx4 v73, s[36:39], s46 offen  lds
    s_add_u32 s51, s69, 4
    s_and_b32 s51, s51, 7
    s_lshl_b32 s51, s51, 17
    s_add_u32 s51, s51, s49
    s_add_u32 s46, s51, 0x4000
    s_add_u32 m0, s50, 49152
    s_nop 0
    buffer_load_dwordx4 v70, s[36:39], s46 offen  lds
    s_add_u32 s46, s51, 0xc000
    s_add_u32 m0, s50, 50176
    s_nop 0
    buffer_load_dwordx4 v71, s[36:39], s46 offen  lds
    s_add_u32 s46, s51, 0x14000
    s_add_u32 m0, s50, 51200
    s_nop 0
    buffer_load_dwordx4 v72, s[36:39], s46 offen  lds
    s_add_u32 s46, s51, 0x1c000
    s_add_u32 m0, s50, 52224
    s_nop 0
    buffer_load_dwordx4 v73, s[36:39], s46 offen  lds
    s_waitcnt vmcnt(40)
    v_min_u32 v45, -2, v45
    buffer_store_dword v45, v12, s[12:15], s61 offen sc1
    s_waitcnt vmcnt(36)
    s_barrier
    ds_read_b64_tr_b16 a[160:161], v88 offset:0
    ds_read_b64_tr_b16 a[162:163], v88 offset:256
    ds_read_b64_tr_b16 a[168:169], v89 offset:0
    ds_read_b64_tr_b16 a[170:171], v89 offset:256
    ds_read_b64_tr_b16 a[176:177], v90 offset:0
    ds_read_b64_tr_b16 a[178:179], v90 offset:256
    ds_read_b64_tr_b16 a[184:185], v91 offset:0
    ds_read_b64_tr_b16 a[186:187], v91 offset:256
L_lw_50:
    s_waitcnt lgkmcnt(0)
    s_cmp_lg_u32 s44, 0
    s_cbranch_scc1 L_v_probe_51
    s_add_u32 s45, s63, 0
    s_memtime s[72:73]
    s_waitcnt lgkmcnt(0)
    s_load_dword s78, s[20:21], s45
    s_waitcnt lgkmcnt(0)
    s_memtime s[74:75]
    s_waitcnt lgkmcnt(0)
    s_sub_u32 s45, s74, s72
    s_min_u32 s76, s76, s45
    s_cmp_lt_u32 s77, s76
    s_cselect_b32 s68, 1, 0
L_v_probe_51:
    s_waitcnt vmcnt(32)
    s_barrier
    s_add_u32 s51, s69, 5
    s_and_b32 s51, s51, 7
    s_lshl_b32 s51, s51, 17
    s_add_u32 s51, s51, s49
    s_add_u32 s46, s51, 0x0
    s_add_u32 m0, s65, 65536
    s_nop 0
    buffer_load_dwordx4 v70, s[36:39], s46 offen  lds
    s_add_u32 s46, s51, 0x8000
    s_add_u32 m0, s65, 66560
    s_nop 0
    buffer_load_dwordx4 v71, s[36:39], s46 offen  lds
    s_add_u32 s46, s51, 0x10000
    s_add_u32 m0, s65, 67584
    s_nop 0
    buffer_load_dwordx4 v72, s[36:39], s46 offen  lds
    s_add_u32 s46, s51, 0x18000
    s_add_u32 m0, s65, 68608
    s_nop 0
    buffer_load_dwordx4 v73, s[36:39], s46 offen  lds
    ds_read_b64_tr_b16 a[164:165], v88 offset:4096
    ds_read_b64_tr_b16 a[166:167], v88 offset:4352
    ds_read_b64_tr_b16 a[172:173], v89 offset:4096
    ds_read_b64_tr_b16 a[174:175], v89 offset:4352
    ds_read_b64_tr_b16 a[180:181], v90 offset:4096
    ds_read_b64_tr_b16 a[182:183], v90 offset:4352
    ds_read_b64_tr_b16 a[188:189], v91 offset:4096
    ds_read_b64_tr_b16 a[190:191], v91 offset:4352
L_lw_52:
    s_waitcnt lgkmcnt(0)
    s_cmp_lg_u32 s44, 0
    s_cbranch_scc1 L_v_probe_53
    s_add_u32 s45, s63, 8192
    s_memtime s[72:73]
    s_waitcnt lgkmcnt(0)
    s_load_dword s78, s[20:21], s45
    s_waitcnt lgkmcnt(0)
    s_memtime s[74:75]
    s_waitcnt lgkmcnt(0)
    s_sub_u32 s45, s74, s72
    s_min_u32 s77, s77, s45
    s_cmp_lt_u32 s77, s76
    s_cselect_b32 s68, 1, 0
L_v_probe_53:
    s_waitcnt vmcnt(32)
    s_barrier
    s_add_u32 s51, s69, 5
    s_and_b32 s51, s51, 7
    s_lshl_b32 s51, s51, 17
    s_add_u32 s51, s51, s49
    s_add_u32 s46, s51, 0x4000
    s_add_u32 m0, s65, 69632
    s_nop 0
    buffer_load_dwordx4 v70, s[36:39], s46 offen  lds
    s_add_u32 s46, s51, 0xc000
    s_add_u32 m0, s65, 70656
    s_nop 0
    buffer_load_dwordx4 v71, s[36:39], s46 offen  lds
    s_add_u32 s46, s51, 0x14000
    s_add_u32 m0, s65, 71680
    s_nop 0
    buffer_load_dwordx4 v72, s[36:39], s46 offen  lds
    s_add_u32 s46, s51, 0x1c000
    s_add_u32 m0, s65, 72704
    s_nop 0
    buffer_load_dwordx4 v73, s[36:39], s46 offen  lds
    ds_read_b64_tr_b16 a[192:193], v88 offset:8192
    ds_read_b64_tr_b16 a[194:195], v88 offset:8448
    ds_read_b64_tr_b16 a[200:201], v89 offset:8192
    ds_read_b64_tr_b16 a[202:203], v89 offset:8448
    ds_read_b64_tr_b16 a[208:209], v90 offset:8192
    ds_read_b64_tr_b16 a[210:211], v90 offset:8448
    ds_read_b64_tr_b16 a[216:217], v91 offset:8192
    ds_read_b64_tr_b16 a[218:219], v91 offset:8448
L_lw_54:
    s_waitcnt lgkmcnt(0)
    s_cmp_lg_u32 s44, 0
    s_cbranch_scc1 L_v_probe_55
    s_add_u32 s45, s63, 128
    s_memtime s[72:73]
    s_waitcnt lgkmcnt(0)
    s_load_dword s78, s[20:21], s45
    s_waitcnt lgkmcnt(0)
    s_memtime s[74:75]
    s_waitcnt lgkmcnt(0)
    s_sub_u32 s45, s74, s72
    s_min_u32 s76, s76, s45
    s_cmp_lt_u32 s77, s76
    s_cselect_b32 s68, 1, 0
L_v_probe_55:
    s_waitcnt vmcnt(32)
    s_barrier
    s_add_u32 s51, s69, 6
    s_and_b32 s51, s51, 7
    s_lshl_b32 s51, s51, 17
    s_add_u32 s51, s51, s49
    s_add_u32 s46, s51, 0x0
    s_add_u32 m0, s65, 73728
    s_nop 0
    buffer_load_dwordx4 v70, s[36:39], s46 offen  lds
    s_add_u32 s46, s51, 0x8000
    s_add_u32 m0, s65, 74752
    s_nop 0
    buffer_load_dwordx4 v71, s[36:39], s46 offen  lds
    s_add_u32 s46, s51, 0x10000
    s_add_u32 m0, s65, 75776
    s_nop 0
    buffer_load_dwordx4 v72, s[36:39], s46 offen  lds
    s_add_u32 s46, s51, 0x18000
    s_add_u32 m0, s65, 76800
    s_nop 0
    buffer_load_dwordx4 v73, s[36:39], s46 offen  lds
    ds_read_b64_tr_b16 a[196:197], v88 offset:12288
    ds_read_b64_tr_b16 a[198:199], v88 offset:12544
    ds_read_b64_tr_b16 a[204:205], v89 offset:12288
    ds_read_b64_tr_b16 a[206:207], v89 offset:12544
    ds_read_b64_tr_b16 a[212:213], v90 offset:12288
    ds_read_b64_tr_b16 a[214:215], v90 offset:12544
    ds_read_b64_tr_b16 a[220:221], v91 offset:12288
    ds_read_b64_tr_b16 a[222:223], v91 offset:12544
L_lw_56:
    s_waitcnt lgkmcnt(0)
    s_cmp_lg_u32 s44, 0
    s_cbranch_scc1 L_v_probe_57
    s_add_u32 s45, s63, 8320
    s_memtime s[72:73]
    s_waitcnt lgkmcnt(0)
    s_load_dword s78, s[20:21], s45
    s_waitcnt lgkmcnt(0)
    s_memtime s[74:75]
    s_waitcnt lgkmcnt(0)
    s_sub_u32 s45, s74, s72
    s_min_u32 s77, s77, s45
    s_cmp_lt_u32 s77, s76
    s_cselect_b32 s68, 1, 0
L_v_probe_57:
    s_waitcnt vmcnt(32)
    s_barrier
    s_add_u32 s51, s69, 6
    s_and_b32 s51, s51, 7
    s_lshl_b32 s51, s51, 17
    s_add_u32 s51, s51, s49
    s_add_u32 s46, s51, 0x4000
    s_add_u32 m0, s65, 77824
    s_nop 0
    buffer_load_dwordx4 v70, s[36:39], s46 offen  lds
    s_add_u32 s46, s51, 0xc000
    s_add_u32 m0, s65, 78848
    s_nop 0
    buffer_load_dwordx4 v71, s[36:39], s46 offen  lds
    s_add_u32 s46, s51, 0x14000
    s_add_u32 m0, s65, 79872
    s_nop 0
    buffer_load_dwordx4 v72, s[36:39], s46 offen  lds
    s_add_u32 s46, s51, 0x1c000
    s_add_u32 m0, s65, 80896
    s_nop 0
    buffer_load_dwordx4 v73, s[36:39], s46 offen  lds
    ds_read_b64_tr_b16 a[224:225], v88 offset:16384
    ds_read_b64_tr_b16 a[226:227], v88 offset:16640
    ds_read_b64_tr_b16 a[232:233], v89 offset:16384
    ds_read_b64_tr_b16 a[234:235], v89 offset:16640
    ds_read_b64_tr_b16 a[240:241], v90 offset:16384
    ds_read_b64_tr_b16 a[242:243], v90 offset:16640
    ds_read_b64_tr_b16 a[248:249], v91 offset:16384
    ds_read_b64_tr_b16 a[250:251], v91 offset:16640
L_lw_58:
    s_waitcnt lgkmcnt(0)
    s_cmp_lg_u32 s44, 0
    s_cbranch_scc1 L_v_probe_59
    s_add_u32 s45, s63, 256
    s_memtime s[72:73]
    s_waitcnt lgkmcnt(0)
    s_load_dword s78, s[20:21], s45
    s_waitcnt lgkmcnt(0)
    s_memtime s[74:75]
    s_waitcnt lgkmcnt(0)
    s_sub_u32 s45, s74, s72
    s_min_u32 s76, s76, s45
    s_cmp_lt_u32 s77, s76
    s_cselect_b32 s68, 1, 0
L_v_probe_59:
    s_waitcnt vmcnt(32)
    s_barrier
    s_add_u32 s51, s69, 7
    s_and_b32 s51, s51, 7
    s_lshl_b32 s51, s51, 17
    s_add_u32 s51, s51, s49
    s_add_u32 s46, s51, 0x0
    s_add_u32 m0, s65, 81920
    s_nop 0
    buffer_load_dwordx4 v70, s[36:39], s46 offen  lds
    s_add_u32 s46, s51, 0x8000
    s_add_u32 m0, s65, 82944
    s_nop 0
    buffer_load_dwordx4 v71, s[36:39], s46 offen  lds
    s_add_u32 s46, s51, 0x10000
    s_add_u32 m0, s65, 83968
    s_nop 0
    buffer_load_dwordx4 v72, s[36:39], s46 offen  lds
    s_add_u32 s46, s51, 0x18000
    s_add_u32 m0, s65, 84992
    s_nop 0
    buffer_load_dwordx4 v73, s[36:39], s46 offen  lds
    ds_read_b64_tr_b16 a[228:229], v88 offset:20480
    ds_read_b64_tr_b16 a[230:231], v88 offset:20736
    ds_read_b64_tr_b16 a[236:237], v89 offset:20480
    ds_read_b64_tr_b16 a[238:239], v89 offset:20736
    ds_read_b64_tr_b16 a[244:245], v90 offset:20480
    ds_read_b64_tr_b16 a[246:247], v90 offset:20736
    ds_read_b64_tr_b16 a[252:253], v91 offset:20480
    ds_read_b64_tr_b16 a[254:255], v91 offset:20736
L_lw_60:
    s_waitcnt lgkmcnt(0)
    s_cmp_lg_u32 s44, 0
    s_cbranch_scc1 L_v_probe_61
    s_add_u32 s45, s63, 8448
    s_memtime s[72:73]
    s_waitcnt lgkmcnt(0)
    s_load_dword s78, s[20:21], s45
    s_waitcnt lgkmcnt(0)
    s_memtime s[74:75]
    s_waitcnt lgkmcnt(0)
    s_sub_u32 s45, s74, s72
    s_min_u32 s77, s77, s45
    s_cmp_lt_u32 s77, s76
    s_cselect_b32 s68, 1, 0
L_v_probe_61:
    s_waitcnt vmcnt(32)
    s_barrier
    s_add_u32 s51, s69, 7
    s_and_b32 s51, s51, 7
    s_lshl_b32 s51, s51, 17
    s_add_u32 s51, s51, s49
    s_add_u32 s46, s51, 0x4000
    s_add_u32 m0, s65, 86016
    s_nop 0
    buffer_load_dwordx4 v70, s[36:39], s46 offen  lds
    s_add_u32 s46, s51, 0xc000
    s_add_u32 m0, s65, 87040
    s_nop 0
    buffer_load_dwordx4 v71, s[36:39], s46 offen  lds
    s_add_u32 s46, s51, 0x14000
    s_add_u32 m0, s65, 88064
    s_nop 0
    buffer_load_dwordx4 v72, s[36:39], s46 offen  lds
    s_add_u32 s46, s51, 0x1c000
    s_add_u32 m0, s65, 89088
    s_nop 0
    buffer_load_dwordx4 v73, s[36:39], s46 offen  lds
    ds_read_b64_tr_b16 v[96:97], v74 offset:0
    ds_read_b64_tr_b16 v[98:99], v74 offset:256
    ds_read_b64_tr_b16 v[104:105], v75 offset:0
    ds_read_b64_tr_b16 v[106:107], v75 offset:256
    ds_read_b64_tr_b16 v[112:113], v76 offset:0
    ds_read_b64_tr_b16 v[114:115], v76 offset:256
    ds_read_b64_tr_b16 v[120:121], v77 offset:0
    ds_read_b64_tr_b16 v[122:123], v77 offset:256
L_lw_62:
    s_waitcnt lgkmcnt(0)
    s_waitcnt vmcnt(32)
    s_barrier
    s_add_u32 s79, s41, 0
    s_and_b32 s79, s79, 3
    s_lshl_b32 s79, s79, 19
    s_add_u32 s79, s79, s47
    s_add_u32 s46, s79, 0x0
    s_add_u32 m0, s48, 0
    s_nop 0
    buffer_load_dwordx4 v82, s[32:35], s46 offen  lds
    s_add_u32 s46, s79, 0x20000
    s_add_u32 m0, s48, 4096
    s_nop 0
    buffer_load_dwordx4 v82, s[32:35], s46 offen  lds
    s_add_u32 s46, s79, 0x40000
    s_add_u32 m0, s48, 8192
    s_nop 0
    buffer_load_dwordx4 v82, s[32:35], s46 offen  lds
    s_add_u32 s46, s79, 0x60000
    s_add_u32 m0, s48, 12288
    s_nop 0
    buffer_load_dwordx4 v82, s[32:35], s46 offen  lds
    ds_read_b64_tr_b16 v[100:101], v74 offset:16384
    ds_read_b64_tr_b16 v[102:103], v74 offset:16640
    ds_read_b64_tr_b16 v[108:109], v75 offset:16384
    ds_read_b64_tr_b16 v[110:111], v75 offset:16640
    ds_read_b64_tr_b16 v[116:117], v76 offset:16384
    ds_read_b64_tr_b16 v[118:119], v76 offset:16640
    ds_read_b64_tr_b16 v[124:125], v77 offset:16384
    ds_read_b64_tr_b16 v[126:127], v77 offset:16640
L_lw_63:
    s_waitcnt lgkmcnt(0)
    s_waitcnt vmcnt(32)
    s_barrier
    s_add_u32 s79, s41, 1
    s_and_b32 s79, s79, 3
    s_lshl_b32 s79, s79, 19
    s_add_u32 s79, s79, s47
    s_add_u32 s46, s79, 0x0
    s_add_u32 m0, s48, 16384
    s_nop 0
    buffer_load_dwordx4 v82, s[32:35], s46 offen  lds
    s_add_u32 s46, s79, 0x20000
    s_add_u32 m0, s48, 20480
    s_nop 0
    buffer_load_dwordx4 v82, s[32:35], s46 offen  lds
    s_add_u32 s46, s79, 0x40000
    s_add_u32 m0, s48, 24576
    s_nop 0
    buffer_load_dwordx4 v82, s[32:35], s46 offen  lds
    s_add_u32 s46, s79, 0x60000
    s_add_u32 m0, s48, 28672
    s_nop 0
    buffer_load_dwordx4 v82, s[32:35], s46 offen  lds
    ds_read_b64_tr_b16 v[128:129], v74 offset:32768
    ds_read_b64_tr_b16 v[130:131], v74 offset:33024
    ds_read_b64_tr_b16 v[136:137], v75 offset:32768
    ds_read_b64_tr_b16 v[138:139], v75 offset:33024
    ds_read_b64_tr_b16 v[144:145], v76 offset:32768
    ds_read_b64_tr_b16 v[146:147], v76 offset:33024
    ds_read_b64_tr_b16 v[152:153], v77 offset:32768
    ds_read_b64_tr_b16 v[154:155], v77 offset:33024
L_lw_64:
    s_waitcnt lgkmcnt(0)
    s_waitcnt vmcnt(32)
    s_barrier
    s_add_u32 s79, s41, 2
    s_and_b32 s79, s79, 3
    s_lshl_b32 s79, s79, 19
    s_add_u32 s79, s79, s47
    s_add_u32 s46, s79, 0x0
    s_add_u32 m0, s48, 32768
    s_nop 0
    buffer_load_dwordx4 v82, s[32:35], s46 offen  lds
    s_add_u32 s46, s79, 0x20000
    s_add_u32 m0, s48, 36864
    s_nop 0
    buffer_load_dwordx4 v82, s[32:35], s46 offen  lds
    s_add_u32 s46, s79, 0x40000
    s_add_u32 m0, s48, 40960
    s_nop 0
    buffer_load_dwordx4 v82, s[32:35], s46 offen  lds
    s_add_u32 s46, s79, 0x60000
    s_add_u32 m0, s48, 45056
    s_nop 0
    buffer_load_dwordx4 v82, s[32:35], s46 offen  lds
    ds_read_b64_tr_b16 v[132:133], v74 offset:49152
    ds_read_b64_tr_b16 v[134:135], v74 offset:49408
    ds_read_b64_tr_b16 v[140:141], v75 offset:49152
    ds_read_b64_tr_b16 v[142:143], v75 offset:49408
    ds_read_b64_tr_b16 v[148:149], v76 offset:49152
    ds_read_b64_tr_b16 v[150:151], v76 offset:49408
    ds_read_b64_tr_b16 v[156:157], v77 offset:49152
    ds_read_b64_tr_b16 v[158:159], v77 offset:49408
L_lw_65:
    s_waitcnt lgkmcnt(0)
    s_waitcnt vmcnt(32)
    s_barrier
    s_add_u32 s79, s41, 3
    s_and_b32 s79, s79, 3
    s_lshl_b32 s79, s79, 19
    s_add_u32 s79, s79, s47
    s_add_u32 s46, s79, 0x0
    s_add_u32 m0, s48, 49152
    s_nop 0
    buffer_load_dwordx4 v82, s[32:35], s46 offen  lds
    s_add_u32 s46, s79, 0x20000
    s_add_u32 m0, s48, 53248
    s_nop 0
    buffer_load_dwordx4 v82, s[32:35], s46 offen  lds
    s_add_u32 s46, s79, 0x40000
    s_add_u32 m0, s48, 57344
    s_nop 0
    buffer_load_dwordx4 v82, s[32:35], s46 offen  lds
    s_add_u32 s46, s79, 0x60000
    s_add_u32 m0, s48, 61440
    s_nop 0
    buffer_load_dwordx4 v82, s[32:35], s46 offen  lds
    ds_read_b64_tr_b16 v[160:161], v88 offset:0
    ds_read_b64_tr_b16 v[162:163], v88 offset:256
    ds_read_b64_tr_b16 v[168:169], v89 offset:0
    ds_read_b64_tr_b16 v[170:171], v89 offset:256
    ds_read_b64_tr_b16 v[176:177], v90 offset:0
    ds_read_b64_tr_b16 v[178:179], v90 offset:256
    ds_read_b64_tr_b16 v[184:185], v91 offset:0
    ds_read_b64_tr_b16 v[186:187], v91 offset:256
L_lw_66:
    s_waitcnt lgkmcnt(0)
    s_waitcnt vmcnt(32)
    s_barrier
    s_cmp_lg_u32 s44, 0
    s_cbranch_scc1 L_hs_67
    s_getreg_b32 s45, hwreg(HW_REG_XCC_ID)
    s_and_b32 s45, s45, 15
    s_mul_i32 s46, s45, s45
    s_lshl_b32 s46, s46, 9
    s_add_u32 s45, s45, s46
    s_cmp_eq_u32 s40, 0
    s_cselect_b32 s46, s45, 0
    s_cselect_b32 s45, 0, s45
    s_lshl_b32 s68, s68, 24
    s_add_u32 s46, s46, s68
    s_add_u32 s45, s45, 16777216
    v_mov_b32 v40, s46
    v_mov_b32 v41, s45
    v_mov_b32 v42, 0
    s_mov_b64 exec, 1
    buffer_atomic_add_x2 v[40:41], v42, s[16:19], 0 offen sc1
    s_mov_b64 exec, -1
L_hs_67:
    ds_read_b64_tr_b16 v[164:165], v88 offset:4096
    ds_read_b64_tr_b16 v[166:167], v88 offset:4352
    ds_read_b64_tr_b16 v[172:173], v89 offset:4096
    ds_read_b64_tr_b16 v[174:175], v89 offset:4352
    ds_read_b64_tr_b16 v[180:181], v90 offset:4096
    ds_read_b64_tr_b16 v[182:183], v90 offset:4352
    ds_read_b64_tr_b16 v[188:189], v91 offset:4096
    ds_read_b64_tr_b16 v[190:191], v91 offset:4352
L_lw_68:
    s_waitcnt lgkmcnt(0)
    s_waitcnt vmcnt(28)
    s_barrier
    ds_read_b64_tr_b16 v[192:193], v88 offset:8192
    ds_read_b64_tr_b16 v[194:195], v88 offset:8448
    ds_read_b64_tr_b16 v[200:201], v89 offset:8192
    ds_read_b64_tr_b16 v[202:203], v89 offset:8448
    ds_read_b64_tr_b16 v[208:209], v90 offset:8192
    ds_read_b64_tr_b16 v[210:211], v90 offset:8448
    ds_read_b64_tr_b16 v[216:217], v91 offset:8192
    ds_read_b64_tr_b16 v[218:219], v91 offset:8448
L_lw_69:
    s_waitcnt lgkmcnt(0)
    s_waitcnt vmcnt(24)
    s_barrier
    ds_read_b64_tr_b16 v[196:197], v88 offset:12288
    ds_read_b64_tr_b16 v[198:199], v88 offset:12544
    ds_read_b64_tr_b16 v[204:205], v89 offset:12288
    ds_read_b64_tr_b16 v[206:207], v89 offset:12544
    ds_read_b64_tr_b16 v[212:213], v90 offset:12288
    ds_read_b64_tr_b16 v[214:215], v90 offset:12544
    ds_read_b64_tr_b16 v[220:221], v91 offset:12288
    ds_read_b64_tr_b16 v[222:223], v91 offset:12544
L_lw_70:
    s_waitcnt lgkmcnt(0)
    s_waitcnt vmcnt(20)
    s_barrier
    ds_read_b64_tr_b16 v[224:225], v88 offset:16384
    ds_read_b64_tr_b16 v[226:227], v88 offset:16640
    ds_read_b64_tr_b16 v[232:233], v89 offset:16384
    ds_read_b64_tr_b16 v[234:235], v89 offset:16640
    ds_read_b64_tr_b16 v[240:241], v90 offset:16384
    ds_read_b64_tr_b16 v[242:243], v90 offset:16640
    ds_read_b64_tr_b16 v[248:249], v91 offset:16384
    ds_read_b64_tr_b16 v[250:251], v91 offset:16640
L_lw_71:
    s_waitcnt lgkmcnt(0)
    s_waitcnt vmcnt(16)
    s_barrier
    ds_read_b64_tr_b16 v[228:229], v88 offset:20480
    ds_read_b64_tr_b16 v[230:231], v88 offset:20736
    ds_read_b64_tr_b16 v[236:237], v89 offset:20480
    ds_read_b64_tr_b16 v[238:239], v89 offset:20736
    ds_read_b64_tr_b16 v[244:245], v90 offset:20480
    ds_read_b64_tr_b16 v[246:247], v90 offset:20736
    ds_read_b64_tr_b16 v[252:253], v91 offset:20480
    ds_read_b64_tr_b16 v[254:255], v91 offset:20736
L_lw_72:
    s_waitcnt lgkmcnt(0)
    s_waitcnt vmcnt(12)
    s_barrier
    s_cmp_lg_u32 s44, 0
    s_cbranch_scc1 L_lw_73_0
    ds_read_b64_tr_b16 a[0:1], v80 offset:0
    ds_read_b64_tr_b16 a[2:3], v80 offset:1024
    ds_read_b64_tr_b16 a[4:5], v80 offset:8192
    ds_read_b64_tr_b16 a[6:7], v80 offset:9216
    ds_read_b64_tr_b16 a[8:9], v81 offset:0
    ds_read_b64_tr_b16 a[10:11], v81 offset:1024
    ds_read_b64_tr_b16 a[12:13], v81 offset:8192
    ds_read_b64_tr_b16 a[14:15], v81 offset:9216
    s_branch L_lw_73
L_lw_73_0:
    s_cmp_lg_u32 s44, 1
    s_cbranch_scc1 L_lw_73_1
    ds_read_b64_tr_b16 a[120:121], v80 offset:0
    ds_read_b64_tr_b16 a[122:123], v80 offset:1024
    ds_read_b64_tr_b16 a[124:125], v80 offset:8192
    ds_read_b64_tr_b16 a[126:127], v80 offset:9216
    ds_read_b64_tr_b16 v[56:57], v81 offset:0
    ds_read_b64_tr_b16 v[58:59], v81 offset:1024
    ds_read_b64_tr_b16 v[60:61], v81 offset:8192
    ds_read_b64_tr_b16 v[62:63], v81 offset:9216
    s_waitcnt lgkmcnt(0)
    ds_write_b128 v5, v[56:59] offset:0
    ds_write_b128 v5, v[60:63] offset:1024
    s_branch L_lw_73
L_lw_73_1:
    s_cmp_lg_u32 s44, 2
    s_cbranch_scc1 L_lw_73_2
    ds_read_b64_tr_b16 a[80:81], v80 offset:0
    ds_read_b64_tr_b16 a[82:83], v80 offset:1024
    ds_read_b64_tr_b16 a[84:85], v80 offset:8192
    ds_read_b64_tr_b16 a[86:87], v80 offset:9216
    ds_read_b64_tr_b16 v[56:57], v81 offset:0
    ds_read_b64_tr_b16 v[58:59], v81 offset:1024
    ds_read_b64_tr_b16 v[60:61], v81 offset:8192
    ds_read_b64_tr_b16 v[62:63], v81 offset:9216
    s_waitcnt lgkmcnt(0)
    ds_write_b128 v5, v[56:59] offset:2048
    ds_write_b128 v5, v[60:63] offset:3072
    s_branch L_lw_73
L_lw_73_2:
    ds_read_b64_tr_b16 a[48:49], v80 offset:0
    ds_read_b64_tr_b16 a[50:51], v80 offset:1024
    ds_read_b64_tr_b16 a[52:53], v80 offset:8192
    ds_read_b64_tr_b16 a[54:55], v80 offset:9216
    ds_read_b64_tr_b16 v[56:57], v81 offset:0
    ds_read_b64_tr_b16 v[58:59], v81 offset:1024
    ds_read_b64_tr_b16 v[60:61], v81 offset:8192
    ds_read_b64_tr_b16 v[62:63], v81 offset:9216
    s_waitcnt lgkmcnt(0)
    ds_write_b128 v5, v[56:59] offset:4096
    ds_write_b128 v5, v[60:63] offset:5120
L_lw_73:
    s_waitcnt lgkmcnt(0)
    s_waitcnt vmcnt(8)
    s_barrier
    s_add_u32 s79, s41, 4
    s_and_b32 s79, s79, 3
    s_lshl_b32 s79, s79, 19
    s_add_u32 s79, s79, s47
    s_add_u32 s46, s79, 0x200000
    s_add_u32 m0, s48, 0
    s_nop 0
    buffer_load_dwordx4 v82, s[32:35], s46 offen  lds
    s_add_u32 s46, s79, 0x220000
    s_add_u32 m0, s48, 4096
    s_nop 0
    buffer_load_dwordx4 v82, s[32:35], s46 offen  lds
    s_add_u32 s46, s79, 0x240000
    s_add_u32 m0, s48, 8192
    s_nop 0
    buffer_load_dwordx4 v82, s[32:35], s46 offen  lds
    s_add_u32 s46, s79, 0x260000
    s_add_u32 m0, s48, 12288
    s_nop 0
    buffer_load_dwordx4 v82, s[32:35], s46 offen  lds
    s_cmp_lg_u32 s44, 0
    s_cbranch_scc1 L_lw_74_0
    ds_read_b64_tr_b16 a[16:17], v80 offset:16384
    ds_read_b64_tr_b16 a[18:19], v80 offset:17408
    ds_read_b64_tr_b16 a[20:21], v80 offset:24576
    ds_read_b64_tr_b16 a[22:23], v80 offset:25600
    ds_read_b64_tr_b16 a[24:25], v81 offset:16384
    ds_read_b64_tr_b16 a[26:27], v81 offset:17408
    ds_read_b64_tr_b16 a[28:29], v81 offset:24576
    ds_read_b64_tr_b16 a[30:31], v81 offset:25600
    s_branch L_lw_74
L_lw_74_0:
    s_cmp_lg_u32 s44, 1
    s_cbranch_scc1 L_lw_74_1
    ds_read_b64_tr_b16 a[128:129], v80 offset:16384
    ds_read_b64_tr_b16 a[130:131], v80 offset:17408
    ds_read_b64_tr_b16 a[132:133], v80 offset:24576
    ds_read_b64_tr_b16 a[134:135], v80 offset:25600
    ds_read_b64_tr_b16 a[136:137], v81 offset:16384
    ds_read_b64_tr_b16 a[138:139], v81 offset:17408
    ds_read_b64_tr_b16 a[140:141], v81 offset:24576
    ds_read_b64_tr_b16 a[142:143], v81 offset:25600
    s_branch L_lw_74
L_lw_74_1:
    s_cmp_lg_u32 s44, 2
    s_cbranch_scc1 L_lw_74_2
    ds_read_b64_tr_b16 a[88:89], v80 offset:16384
    ds_read_b64_tr_b16 a[90:91], v80 offset:17408
    ds_read_b64_tr_b16 a[92:93], v80 offset:24576
    ds_read_b64_tr_b16 a[94:95], v80 offset:25600
    ds_read_b64_tr_b16 a[96:97], v81 offset:16384
    ds_read_b64_tr_b16 a[98:99], v81 offset:17408
    ds_read_b64_tr_b16 a[100:101], v81 offset:24576
    ds_read_b64_tr_b16 a[102:103], v81 offset:25600
    s_branch L_lw_74
L_lw_74_2:
    ds_read_b64_tr_b16 a[56:57], v80 offset:16384
    ds_read_b64_tr_b16 a[58:59], v80 offset:17408
    ds_read_b64_tr_b16 a[60:61], v80 offset:24576
    ds_read_b64_tr_b16 a[62:63], v80 offset:25600
    ds_read_b64_tr_b16 v[56:57], v81 offset:16384
    ds_read_b64_tr_b16 v[58:59], v81 offset:17408
    ds_read_b64_tr_b16 v[60:61], v81 offset:24576
    ds_read_b64_tr_b16 v[62:63], v81 offset:25600
    s_waitcnt lgkmcnt(0)
    ds_write_b128 v5, v[56:59] offset:6144
    ds_write_b128 v5, v[60:63] offset:7168
L_lw_74:
    s_waitcnt lgkmcnt(0)
    s_waitcnt vmcnt(8)
    s_barrier
    s_add_u32 s79, s41, 5
    s_and_b32 s79, s79, 3
    s_lshl_b32 s79, s79, 19
    s_add_u32 s79, s79, s47
    s_add_u32 s46, s79, 0x200000
    s_add_u32 m0, s48, 16384
    s_nop 0
    buffer_load_dwordx4 v82, s[32:35], s46 offen  lds
    s_add_u32 s46, s79, 0x220000
    s_add_u32 m0, s48, 20480
    s_nop 0
    buffer_load_dwordx4 v82, s[32:35], s46 offen  lds
    s_add_u32 s46, s79, 0x240000
    s_add_u32 m0, s48, 24576
    s_nop 0
    buffer_load_dwordx4 v82, s[32:35], s46 offen  lds
    s_add_u32 s46, s79, 0x260000
    s_add_u32 m0, s48, 28672
    s_nop 0
    buffer_load_dwordx4 v82, s[32:35], s46 offen  lds
    s_cmp_lg_u32 s44, 0
    s_cbranch_scc1 L_lw_75_0
    ds_read_b64_tr_b16 a[32:33], v80 offset:32768
    ds_read_b64_tr_b16 a[34:35], v80 offset:33792
    ds_read_b64_tr_b16 a[36:37], v80 offset:40960
    ds_read_b64_tr_b16 a[38:39], v80 offset:41984
    ds_read_b64_tr_b16 v[56:57], v81 offset:32768
    ds_read_b64_tr_b16 v[58:59], v81 offset:33792
    ds_read_b64_tr_b16 v[60:61], v81 offset:40960
    ds_read_b64_tr_b16 v[62:63], v81 offset:41984
    s_waitcnt lgkmcnt(0)
    ds_write_b128 v5, v[56:59] offset:8192
    ds_write_b128 v5, v[60:63] offset:9216
    s_branch L_lw_75
L_lw_75_0:
    s_cmp_lg_u32 s44, 1
    s_cbranch_scc1 L_lw_75_1
    ds_read_b64_tr_b16 a[144:145], v80 offset:32768
    ds_read_b64_tr_b16 a[146:147], v80 offset:33792
    ds_read_b64_tr_b16 a[148:149], v80 offset:40960
    ds_read_b64_tr_b16 a[150:151], v80 offset:41984
    ds_read_b64_tr_b16 v[56:57], v81 offset:32768
    ds_read_b64_tr_b16 v[58:59], v81 offset:33792
    ds_read_b64_tr_b16 v[60:61], v81 offset:40960
    ds_read_b64_tr_b16 v[62:63], v81 offset:41984
    s_waitcnt lgkmcnt(0)
    ds_write_b128 v5, v[56:59] offset:10240
    ds_write_b128 v5, v[60:63] offset:11264
    s_branch L_lw_75
L_lw_75_1:
    s_cmp_lg_u32 s44, 2
    s_cbranch_scc1 L_lw_75_2
    ds_read_b64_tr_b16 a[104:105], v80 offset:32768
    ds_read_b64_tr_b16 a[106:107], v80 offset:33792
    ds_read_b64_tr_b16 a[108:109], v80 offset:40960
    ds_read_b64_tr_b16 a[110:111], v80 offset:41984
    ds_read_b64_tr_b16 v[56:57], v81 offset:32768
    ds_read_b64_tr_b16 v[58:59], v81 offset:33792
    ds_read_b64_tr_b16 v[60:61], v81 offset:40960
    ds_read_b64_tr_b16 v[62:63], v81 offset:41984
    s_waitcnt lgkmcnt(0)
    ds_write_b128 v5, v[56:59] offset:12288
    ds_write_b128 v5, v[60:63] offset:13312
    s_branch L_lw_75
L_lw_75_2:
    ds_read_b64_tr_b16 a[64:65], v80 offset:32768
    ds_read_b64_tr_b16 a[66:67], v80 offset:33792
    ds_read_b64_tr_b16 a[68:69], v80 offset:40960
    ds_read_b64_tr_b16 a[70:71], v80 offset:41984
    ds_read_b64_tr_b16 v[56:57], v81 offset:32768
    ds_read_b64_tr_b16 v[58:59], v81 offset:33792
    ds_read_b64_tr_b16 v[60:61], v81 offset:40960
    ds_read_b64_tr_b16 v[62:63], v81 offset:41984
    s_waitcnt lgkmcnt(0)
    ds_write_b128 v5, v[56:59] offset:14336
    ds_write_b128 v5, v[60:63] offset:15360
L_lw_75:
    s_waitcnt lgkmcnt(0)
    s_waitcnt vmcnt(8)
    s_barrier
    s_add_u32 s79, s41, 6
    s_and_b32 s79, s79, 3
    s_lshl_b32 s79, s79, 19
    s_add_u32 s79, s79, s47
    s_add_u32 s46, s79, 0x200000
    s_add_u32 m0, s48, 32768
    s_nop 0
    buffer_load_dwordx4 v82, s[32:35], s46 offen  lds
    s_add_u32 s46, s79, 0x220000
    s_add_u32 m0, s48, 36864
    s_nop 0
    buffer_load_dwordx4 v82, s[32:35], s46 offen  lds
    s_add_u32 s46, s79, 0x240000
    s_add_u32 m0, s48, 40960
    s_nop 0
    buffer_load_dwordx4 v82, s[32:35], s46 offen  lds
    s_add_u32 s46, s79, 0x260000
    s_add_u32 m0, s48, 45056
    s_nop 0
    buffer_load_dwordx4 v82, s[32:35], s46 offen  lds
    s_cmp_lg_u32 s44, 0
    s_cbranch_scc1 L_lw_76_0
    ds_read_b64_tr_b16 a[40:41], v80 offset:49152
    ds_read_b64_tr_b16 a[42:43], v80 offset:50176
    ds_read_b64_tr_b16 a[44:45], v80 offset:57344
    ds_read_b64_tr_b16 a[46:47], v80 offset:58368
    ds_read_b64_tr_b16 v[56:57], v81 offset:49152
    ds_read_b64_tr_b16 v[58:59], v81 offset:50176
    ds_read_b64_tr_b16 v[60:61], v81 offset:57344
    ds_read_b64_tr_b16 v[62:63], v81 offset:58368
    s_waitcnt lgkmcnt(0)
    ds_write_b128 v5, v[56:59] offset:16384
    ds_write_b128 v5, v[60:63] offset:17408
    s_branch L_lw_76
L_lw_76_0:
    s_cmp_lg_u32 s44, 1
    s_cbranch_scc1 L_lw_76_1
    ds_read_b64_tr_b16 a[152:153], v80 offset:49152
    ds_read_b64_tr_b16 a[154:155], v80 offset:50176
    ds_read_b64_tr_b16 a[156:157], v80 offset:57344
    ds_read_b64_tr_b16 a[158:159], v80 offset:58368
    ds_read_b64_tr_b16 v[56:57], v81 offset:49152
    ds_read_b64_tr_b16 v[58:59], v81 offset:50176
    ds_read_b64_tr_b16 v[60:61], v81 offset:57344
    ds_read_b64_tr_b16 v[62:63], v81 offset:58368
    s_waitcnt lgkmcnt(0)
    ds_write_b128 v5, v[56:59] offset:18432
    ds_write_b128 v5, v[60:63] offset:19456
    s_branch L_lw_76
L_lw_76_1:
    s_cmp_lg_u32 s44, 2
    s_cbranch_scc1 L_lw_76_2
    ds_read_b64_tr_b16 a[112:113], v80 offset:49152
    ds_read_b64_tr_b16 a[114:115], v80 offset:50176
    ds_read_b64_tr_b16 a[116:117], v80 offset:57344
    ds_read_b64_tr_b16 a[118:119], v80 offset:58368
    ds_read_b64_tr_b16 v[56:57], v81 offset:49152
    ds_read_b64_tr_b16 v[58:59], v81 offset:50176
    ds_read_b64_tr_b16 v[60:61], v81 offset:57344
    ds_read_b64_tr_b16 v[62:63], v81 offset:58368
    s_waitcnt lgkmcnt(0)
    ds_write_b128 v5, v[56:59] offset:20480
    ds_write_b128 v5, v[60:63] offset:21504
    s_branch L_lw_76
L_lw_76_2:
    ds_read_b64_tr_b16 a[72:73], v80 offset:49152
    ds_read_b64_tr_b16 a[74:75], v80 offset:50176
    ds_read_b64_tr_b16 a[76:77], v80 offset:57344
    ds_read_b64_tr_b16 a[78:79], v80 offset:58368
    ds_read_b64_tr_b16 v[56:57], v81 offset:49152
    ds_read_b64_tr_b16 v[58:59], v81 offset:50176
    ds_read_b64_tr_b16 v[60:61], v81 offset:57344
    ds_read_b64_tr_b16 v[62:63], v81 offset:58368
    s_waitcnt lgkmcnt(0)
    ds_write_b128 v5, v[56:59] offset:22528
    ds_write_b128 v5, v[60:63] offset:23552
L_lw_76:
    s_waitcnt lgkmcnt(0)
    s_waitcnt vmcnt(8)
    s_barrier
    s_add_u32 s79, s41, 7
    s_and_b32 s79, s79, 3
    s_lshl_b32 s79, s79, 19
    s_add_u32 s79, s79, s47
    s_add_u32 s46, s79, 0x200000
    s_add_u32 m0, s48, 49152
    s_nop 0
    buffer_load_dwordx4 v82, s[32:35], s46 offen  lds
    s_add_u32 s46, s79, 0x220000
    s_add_u32 m0, s48, 53248
    s_nop 0
    buffer_load_dwordx4 v82, s[32:35], s46 offen  lds
    s_add_u32 s46, s79, 0x240000
    s_add_u32 m0, s48, 57344
    s_nop 0
    buffer_load_dwordx4 v82, s[32:35], s46 offen  lds
    s_add_u32 s46, s79, 0x260000
    s_add_u32 m0, s48, 61440
    s_nop 0
    buffer_load_dwordx4 v82, s[32:35], s46 offen  lds
    s_cmp_lg_u32 s44, 0
    s_cbranch_scc1 L_lw_77_0
    ds_read_b64_tr_b16 a[48:49], v80 offset:0
    ds_read_b64_tr_b16 a[50:51], v80 offset:1024
    ds_read_b64_tr_b16 a[52:53], v80 offset:8192
    ds_read_b64_tr_b16 a[54:55], v80 offset:9216
    ds_read_b64_tr_b16 v[56:57], v81 offset:0
    ds_read_b64_tr_b16 v[58:59], v81 offset:1024
    ds_read_b64_tr_b16 v[60:61], v81 offset:8192
    ds_read_b64_tr_b16 v[62:63], v81 offset:9216
    s_waitcnt lgkmcnt(0)
    ds_write_b128 v5, v[56:59] offset:4096
    ds_write_b128 v5, v[60:63] offset:5120
    s_branch L_lw_77
L_lw_77_0:
    s_cmp_lg_u32 s44, 1
    s_cbranch_scc1 L_lw_77_1
    ds_read_b64_tr_b16 a[0:1], v80 offset:0
    ds_read_b64_tr_b16 a[2:3], v80 offset:1024
    ds_read_b64_tr_b16 a[4:5], v80 offset:8192
    ds_read_b64_tr_b16 a[6:7], v80 offset:9216
    ds_read_b64_tr_b16 a[8:9], v81 offset:0
    ds_read_b64_tr_b16 a[10:11], v81 offset:1024
    ds_read_b64_tr_b16 a[12:13], v81 offset:8192
    ds_read_b64_tr_b16 a[14:15], v81 offset:9216
    s_branch L_lw_77
L_lw_77_1:
    s_cmp_lg_u32 s44, 2
    s_cbranch_scc1 L_lw_77_2
    ds_read_b64_tr_b16 a[120:121], v80 offset:0
    ds_read_b64_tr_b16 a[122:123], v80 offset:1024
    ds_read_b64_tr_b16 a[124:125], v80 offset:8192
    ds_read_b64_tr_b16 a[126:127], v80 offset:9216
    ds_read_b64_tr_b16 v[56:57], v81 offset:0
    ds_read_b64_tr_b16 v[58:59], v81 offset:1024
    ds_read_b64_tr_b16 v[60:61], v81 offset:8192
    ds_read_b64_tr_b16 v[62:63], v81 offset:9216
    s_waitcnt lgkmcnt(0)
    ds_write_b128 v5, v[56:59] offset:0
    ds_write_b128 v5, v[60:63] offset:1024
    s_branch L_lw_77
L_lw_77_2:
    ds_read_b64_tr_b16 a[80:81], v80 offset:0
    ds_read_b64_tr_b16 a[82:83], v80 offset:1024
    ds_read_b64_tr_b16 a[84:85], v80 offset:8192
    ds_read_b64_tr_b16 a[86:87], v80 offset:9216
    ds_read_b64_tr_b16 v[56:57], v81 offset:0
    ds_read_b64_tr_b16 v[58:59], v81 offset:1024
    ds_read_b64_tr_b16 v[60:61], v81 offset:8192
    ds_read_b64_tr_b16 v[62:63], v81 offset:9216
    s_waitcnt lgkmcnt(0)
    ds_write_b128 v5, v[56:59] offset:2048
    ds_write_b128 v5, v[60:63] offset:3072
L_lw_77:
    s_waitcnt lgkmcnt(0)
    s_waitcnt vmcnt(8)
    s_barrier
    s_add_u32 s79, s41, 8
    s_and_b32 s79, s79, 3
    s_lshl_b32 s79, s79, 19
    s_add_u32 s79, s79, s47
    s_add_u32 s46, s79, 0x400000
    s_add_u32 m0, s48, 0
    s_nop 0
    buffer_load_dwordx4 v82, s[32:35], s46 offen  lds
    s_add_u32 s46, s79, 0x420000
    s_add_u32 m0, s48, 4096
    s_nop 0
    buffer_load_dwordx4 v82, s[32:35], s46 offen  lds
    s_add_u32 s46, s79, 0x440000
    s_add_u32 m0, s48, 8192
    s_nop 0
    buffer_load_dwordx4 v82, s[32:35], s46 offen  lds
    s_add_u32 s46, s79, 0x460000
    s_add_u32 m0, s48, 12288
    s_nop 0
    buffer_load_dwordx4 v82, s[32:35], s46 offen  lds
    s_cmp_lg_u32 s44, 0
    s_cbranch_scc1 L_lw_78_0
    ds_read_b64_tr_b16 a[56:57], v80 offset:16384
    ds_read_b64_tr_b16 a[58:59], v80 offset:17408
    ds_read_b64_tr_b16 a[60:61], v80 offset:24576
    ds_read_b64_tr_b16 a[62:63], v80 offset:25600
    ds_read_b64_tr_b16 v[56:57], v81 offset:16384
    ds_read_b64_tr_b16 v[58:59], v81 offset:17408
    ds_read_b64_tr_b16 v[60:61], v81 offset:24576
    ds_read_b64_tr_b16 v[62:63], v81 offset:25600
    s_waitcnt lgkmcnt(0)
    ds_write_b128 v5, v[56:59] offset:6144
    ds_write_b128 v5, v[60:63] offset:7168
    s_branch L_lw_78
L_lw_78_0:
    s_cmp_lg_u32 s44, 1
    s_cbranch_scc1 L_lw_78_1
    ds_read_b64_tr_b16 a[16:17], v80 offset:16384
    ds_read_b64_tr_b16 a[18:19], v80 offset:17408
    ds_read_b64_tr_b16 a[20:21], v80 offset:24576
    ds_read_b64_tr_b16 a[22:23], v80 offset:25600
    ds_read_b64_tr_b16 a[24:25], v81 offset:16384
    ds_read_b64_tr_b16 a[26:27], v81 offset:17408
    ds_read_b64_tr_b16 a[28:29], v81 offset:24576
    ds_read_b64_tr_b16 a[30:31], v81 offset:25600
    s_branch L_lw_78
L_lw_78_1:
    s_cmp_lg_u32 s44, 2
    s_cbranch_scc1 L_lw_78_2
    ds_read_b64_tr_b16 a[128:129], v80 offset:16384
    ds_read_b64_tr_b16 a[130:131], v80 offset:17408
    ds_read_b64_tr_b16 a[132:133], v80 offset:24576
    ds_read_b64_tr_b16 a[134:135], v80 offset:25600
    ds_read_b64_tr_b16 a[136:137], v81 offset:16384
    ds_read_b64_tr_b16 a[138:139], v81 offset:17408
    ds_read_b64_tr_b16 a[140:141], v81 offset:24576
    ds_read_b64_tr_b16 a[142:143], v81 offset:25600
    s_branch L_lw_78
L_lw_78_2:
    ds_read_b64_tr_b16 a[88:89], v80 offset:16384
    ds_read_b64_tr_b16 a[90:91], v80 offset:17408
    ds_read_b64_tr_b16 a[92:93], v80 offset:24576
    ds_read_b64_tr_b16 a[94:95], v80 offset:25600
    ds_read_b64_tr_b16 a[96:97], v81 offset:16384
    ds_read_b64_tr_b16 a[98:99], v81 offset:17408
    ds_read_b64_tr_b16 a[100:101], v81 offset:24576
    ds_read_b64_tr_b16 a[102:103], v81 offset:25600
L_lw_78:
    s_waitcnt lgkmcnt(0)
    s_waitcnt vmcnt(8)
    s_barrier
    s_add_u32 s79, s41, 9
    s_and_b32 s79, s79, 3
    s_lshl_b32 s79, s79, 19
    s_add_u32 s79, s79, s47
    s_add_u32 s46, s79, 0x400000
    s_add_u32 m0, s48, 16384
    s_nop 0
    buffer_load_dwordx4 v82, s[32:35], s46 offen  lds
    s_add_u32 s46, s79, 0x420000
    s_add_u32 m0, s48, 20480
    s_nop 0
    buffer_load_dwordx4 v82, s[32:35], s46 offen  lds
    s_add_u32 s46, s79, 0x440000
    s_add_u32 m0, s48, 24576
    s_nop 0
    buffer_load_dwordx4 v82, s[32:35], s46 offen  lds
    s_add_u32 s46, s79, 0x460000
    s_add_u32 m0, s48, 28672
    s_nop 0
    buffer_load_dwordx4 v82, s[32:35], s46 offen  lds
    s_cmp_lg_u32 s44, 0
    s_cbranch_scc1 L_lw_79_0
    ds_read_b64_tr_b16 a[64:65], v80 offset:32768
    ds_read_b64_tr_b16 a[66:67], v80 offset:33792
    ds_read_b64_tr_b16 a[68:69], v80 offset:40960
    ds_read_b64_tr_b16 a[70:71], v80 offset:41984
    ds_read_b64_tr_b16 v[56:57], v81 offset:32768
    ds_read_b64_tr_b16 v[58:59], v81 offset:33792
    ds_read_b64_tr_b16 v[60:61], v81 offset:40960
    ds_read_b64_tr_b16 v[62:63], v81 offset:41984
    s_waitcnt lgkmcnt(0)
    ds_write_b128 v5, v[56:59] offset:14336
    ds_write_b128 v5, v[60:63] offset:15360
    s_branch L_lw_79
L_lw_79_0:
    s_cmp_lg_u32 s44, 1
    s_cbranch_scc1 L_lw_79_1
    ds_read_b64_tr_b16 a[32:33], v80 offset:32768
    ds_read_b64_tr_b16 a[34:35], v80 offset:33792
    ds_read_b64_tr_b16 a[36:37], v80 offset:40960
    ds_read_b64_tr_b16 a[38:39], v80 offset:41984
    ds_read_b64_tr_b16 v[56:57], v81 offset:32768
    ds_read_b64_tr_b16 v[58:59], v81 offset:33792
    ds_read_b64_tr_b16 v[60:61], v81 offset:40960
    ds_read_b64_tr_b16 v[62:63], v81 offset:41984
    s_waitcnt lgkmcnt(0)
    ds_write_b128 v5, v[56:59] offset:8192
    ds_write_b128 v5, v[60:63] offset:9216
    s_branch L_lw_79
L_lw_79_1:
    s_cmp_lg_u32 s44, 2
    s_cbranch_scc1 L_lw_79_2
    ds_read_b64_tr_b16 a[144:145], v80 offset:32768
    ds_read_b64_tr_b16 a[146:147], v80 offset:33792
    ds_read_b64_tr_b16 a[148:149], v80 offset:40960
    ds_read_b64_tr_b16 a[150:151], v80 offset:41984
    ds_read_b64_tr_b16 v[56:57], v81 offset:32768
    ds_read_b64_tr_b16 v[58:59], v81 offset:33792
    ds_read_b64_tr_b16 v[60:61], v81 offset:40960
    ds_read_b64_tr_b16 v[62:63], v81 offset:41984
    s_waitcnt lgkmcnt(0)
    ds_write_b128 v5, v[56:59] offset:10240
    ds_write_b128 v5, v[60:63] offset:11264
    s_branch L_lw_79
L_lw_79_2:
    ds_read_b64_tr_b16 a[104:105], v80 offset:32768
    ds_read_b64_tr_b16 a[106:107], v80 offset:33792
    ds_read_b64_tr_b16 a[108:109], v80 offset:40960
    ds_read_b64_tr_b16 a[110:111], v80 offset:41984
    ds_read_b64_tr_b16 v[56:57], v81 offset:32768
    ds_read_b64_tr_b16 v[58:59], v81 offset:33792
    ds_read_b64_tr_b16 v[60:61], v81 offset:40960
    ds_read_b64_tr_b16 v[62:63], v81 offset:41984
    s_waitcnt lgkmcnt(0)
    ds_write_b128 v5, v[56:59] offset:12288
    ds_write_b128 v5, v[60:63] offset:13312
L_lw_79:
    s_waitcnt lgkmcnt(0)
    s_waitcnt vmcnt(8)
    s_barrier
    s_add_u32 s79, s41, 10
    s_and_b32 s79, s79, 3
    s_lshl_b32 s79, s79, 19
    s_add_u32 s79, s79, s47
    s_add_u32 s46, s79, 0x400000
    s_add_u32 m0, s48, 32768
    s_nop 0
    buffer_load_dwordx4 v82, s[32:35], s46 offen  lds
    s_add_u32 s46, s79, 0x420000
    s_add_u32 m0, s48, 36864
    s_nop 0
    buffer_load_dwordx4 v82, s[32:35], s46 offen  lds
    s_add_u32 s46, s79, 0x440000
    s_add_u32 m0, s48, 40960
    s_nop 0
    buffer_load_dwordx4 v82, s[32:35], s46 offen  lds
    s_add_u32 s46, s79, 0x460000
    s_add_u32 m0, s48, 45056
    s_nop 0
    buffer_load_dwordx4 v82, s[32:35], s46 offen  lds
    s_cmp_lg_u32 s44, 0
    s_cbranch_scc1 L_lw_80_0
    ds_read_b64_tr_b16 a[72:73], v80 offset:49152
    ds_read_b64_tr_b16 a[74:75], v80 offset:50176
    ds_read_b64_tr_b16 a[76:77], v80 offset:57344
    ds_read_b64_tr_b16 a[78:79], v80 offset:58368
    ds_read_b64_tr_b16 v[56:57], v81 offset:49152
    ds_read_b64_tr_b16 v[58:59], v81 offset:50176
    ds_read_b64_tr_b16 v[60:61], v81 offset:57344
    ds_read_b64_tr_b16 v[62:63], v81 offset:58368
    s_waitcnt lgkmcnt(0)
    ds_write_b128 v5, v[56:59] offset:22528
    ds_write_b128 v5, v[60:63] offset:23552
    s_branch L_lw_80
L_lw_80_0:
    s_cmp_lg_u32 s44, 1
    s_cbranch_scc1 L_lw_80_1
    ds_read_b64_tr_b16 a[40:41], v80 offset:49152
    ds_read_b64_tr_b16 a[42:43], v80 offset:50176
    ds_read_b64_tr_b16 a[44:45], v80 offset:57344
    ds_read_b64_tr_b16 a[46:47], v80 offset:58368
    ds_read_b64_tr_b16 v[56:57], v81 offset:49152
    ds_read_b64_tr_b16 v[58:59], v81 offset:50176
    ds_read_b64_tr_b16 v[60:61], v81 offset:57344
    ds_read_b64_tr_b16 v[62:63], v81 offset:58368
    s_waitcnt lgkmcnt(0)
    ds_write_b128 v5, v[56:59] offset:16384
    ds_write_b128 v5, v[60:63] offset:17408
    s_branch L_lw_80
L_lw_80_1:
    s_cmp_lg_u32 s44, 2
    s_cbranch_scc1 L_lw_80_2
    ds_read_b64_tr_b16 a[152:153], v80 offset:49152
    ds_read_b64_tr_b16 a[154:155], v80 offset:50176
    ds_read_b64_tr_b16 a[156:157], v80 offset:57344
    ds_read_b64_tr_b16 a[158:159], v80 offset:58368
    ds_read_b64_tr_b16 v[56:57], v81 offset:49152
    ds_read_b64_tr_b16 v[58:59], v81 offset:50176
    ds_read_b64_tr_b16 v[60:61], v81 offset:57344
    ds_read_b64_tr_b16 v[62:63], v81 offset:58368
    s_waitcnt lgkmcnt(0)
    ds_write_b128 v5, v[56:59] offset:18432
    ds_write_b128 v5, v[60:63] offset:19456
    s_branch L_lw_80
L_lw_80_2:
    ds_read_b64_tr_b16 a[112:113], v80 offset:49152
    ds_read_b64_tr_b16 a[114:115], v80 offset:50176
    ds_read_b64_tr_b16 a[116:117], v80 offset:57344
    ds_read_b64_tr_b16 a[118:119], v80 offset:58368
    ds_read_b64_tr_b16 v[56:57], v81 offset:49152
    ds_read_b64_tr_b16 v[58:59], v81 offset:50176
    ds_read_b64_tr_b16 v[60:61], v81 offset:57344
    ds_read_b64_tr_b16 v[62:63], v81 offset:58368
    s_waitcnt lgkmcnt(0)
    ds_write_b128 v5, v[56:59] offset:20480
    ds_write_b128 v5, v[60:63] offset:21504
L_lw_80:
    s_waitcnt lgkmcnt(0)
    s_waitcnt vmcnt(8)
    s_barrier
    s_add_u32 s79, s41, 11
    s_and_b32 s79, s79, 3
    s_lshl_b32 s79, s79, 19
    s_add_u32 s79, s79, s47
    s_add_u32 s46, s79, 0x400000
    s_add_u32 m0, s48, 49152
    s_nop 0
    buffer_load_dwordx4 v82, s[32:35], s46 offen  lds
    s_add_u32 s46, s79, 0x420000
    s_add_u32 m0, s48, 53248
    s_nop 0
    buffer_load_dwordx4 v82, s[32:35], s46 offen  lds
    s_add_u32 s46, s79, 0x440000
    s_add_u32 m0, s48, 57344
    s_nop 0
    buffer_load_dwordx4 v82, s[32:35], s46 offen  lds
    s_add_u32 s46, s79, 0x460000
    s_add_u32 m0, s48, 61440
    s_nop 0
    buffer_load_dwordx4 v82, s[32:35], s46 offen  lds
    s_cmp_lg_u32 s44, 0
    s_cbranch_scc1 L_lw_81_0
    ds_read_b64_tr_b16 a[80:81], v80 offset:0
    ds_read_b64_tr_b16 a[82:83], v80 offset:1024
    ds_read_b64_tr_b16 a[84:85], v80 offset:8192
    ds_read_b64_tr_b16 a[86:87], v80 offset:9216
    ds_read_b64_tr_b16 v[56:57], v81 offset:0
    ds_read_b64_tr_b16 v[58:59], v81 offset:1024
    ds_read_b64_tr_b16 v[60:61], v81 offset:8192
    ds_read_b64_tr_b16 v[62:63], v81 offset:9216
    s_waitcnt lgkmcnt(0)
    ds_write_b128 v5, v[56:59] offset:2048
    ds_write_b128 v5, v[60:63] offset:3072
    s_branch L_lw_81
L_lw_81_0:
    s_cmp_lg_u32 s44, 1
    s_cbranch_scc1 L_lw_81_1
    ds_read_b64_tr_b16 a[48:49], v80 offset:0
    ds_read_b64_tr_b16 a[50:51], v80 offset:1024
    ds_read_b64_tr_b16 a[52:53], v80 offset:8192
    ds_read_b64_tr_b16 a[54:55], v80 offset:9216
    ds_read_b64_tr_b16 v[56:57], v81 offset:0
    ds_read_b64_tr_b16 v[58:59], v81 offset:1024
    ds_read_b64_tr_b16 v[60:61], v81 offset:8192
    ds_read_b64_tr_b16 v[62:63], v81 offset:9216
    s_waitcnt lgkmcnt(0)
    ds_write_b128 v5, v[56:59] offset:4096
    ds_write_b128 v5, v[60:63] offset:5120
    s_branch L_lw_81
L_lw_81_1:
    s_cmp_lg_u32 s44, 2
    s_cbranch_scc1 L_lw_81_2
    ds_read_b64_tr_b16 a[0:1], v80 offset:0
    ds_read_b64_tr_b16 a[2:3], v80 offset:1024
    ds_read_b64_tr_b16 a[4:5], v80 offset:8192
    ds_read_b64_tr_b16 a[6:7], v80 offset:9216
    ds_read_b64_tr_b16 a[8:9], v81 offset:0
    ds_read_b64_tr_b16 a[10:11], v81 offset:1024
    ds_read_b64_tr_b16 a[12:13], v81 offset:8192
    ds_read_b64_tr_b16 a[14:15], v81 offset:9216
    s_branch L_lw_81
L_lw_81_2:
    ds_read_b64_tr_b16 a[120:121], v80 offset:0
    ds_read_b64_tr_b16 a[122:123], v80 offset:1024
    ds_read_b64_tr_b16 a[124:125], v80 offset:8192
    ds_read_b64_tr_b16 a[126:127], v80 offset:9216
    ds_read_b64_tr_b16 v[56:57], v81 offset:0
    ds_read_b64_tr_b16 v[58:59], v81 offset:1024
    ds_read_b64_tr_b16 v[60:61], v81 offset:8192
    ds_read_b64_tr_b16 v[62:63], v81 offset:9216
    s_waitcnt lgkmcnt(0)
    ds_write_b128 v5, v[56:59] offset:0
    ds_write_b128 v5, v[60:63] offset:1024
L_lw_81:
    s_waitcnt lgkmcnt(0)
    s_waitcnt vmcnt(8)
    s_barrier
    s_add_u32 s79, s41, 12
    s_and_b32 s79, s79, 3
    s_lshl_b32 s79, s79, 19
    s_add_u32 s79, s79, s47
    s_add_u32 s46, s79, 0x600000
    s_add_u32 m0, s48, 0
    s_nop 0
    buffer_load_dwordx4 v82, s[32:35], s46 offen  lds
    s_add_u32 s46, s79, 0x620000
    s_add_u32 m0, s48, 4096
    s_nop 0
    buffer_load_dwordx4 v82, s[32:35], s46 offen  lds
    s_add_u32 s46, s79, 0x640000
    s_add_u32 m0, s48, 8192
    s_nop 0
    buffer_load_dwordx4 v82, s[32:35], s46 offen  lds
    s_add_u32 s46, s79, 0x660000
    s_add_u32 m0, s48, 12288
    s_nop 0
    buffer_load_dwordx4 v82, s[32:35], s46 offen  lds
    s_cmp_lg_u32 s44, 0
    s_cbranch_scc1 L_lw_82_0
    ds_read_b64_tr_b16 a[88:89], v80 offset:16384
    ds_read_b64_tr_b16 a[90:91], v80 offset:17408
    ds_read_b64_tr_b16 a[92:93], v80 offset:24576
    ds_read_b64_tr_b16 a[94:95], v80 offset:25600
    ds_read_b64_tr_b16 a[96:97], v81 offset:16384
    ds_read_b64_tr_b16 a[98:99], v81 offset:17408
    ds_read_b64_tr_b16 a[100:101], v81 offset:24576
    ds_read_b64_tr_b16 a[102:103], v81 offset:25600
    s_branch L_lw_82
L_lw_82_0:
    s_cmp_lg_u32 s44, 1
    s_cbranch_scc1 L_lw_82_1
    ds_read_b64_tr_b16 a[56:57], v80 offset:16384
    ds_read_b64_tr_b16 a[58:59], v80 offset:17408
    ds_read_b64_tr_b16 a[60:61], v80 offset:24576
    ds_read_b64_tr_b16 a[62:63], v80 offset:25600
    ds_read_b64_tr_b16 v[56:57], v81 offset:16384
    ds_read_b64_tr_b16 v[58:59], v81 offset:17408
    ds_read_b64_tr_b16 v[60:61], v81 offset:24576
    ds_read_b64_tr_b16 v[62:63], v81 offset:25600
    s_waitcnt lgkmcnt(0)
    ds_write_b128 v5, v[56:59] offset:6144
    ds_write_b128 v5, v[60:63] offset:7168
    s_branch L_lw_82
L_lw_82_1:
    s_cmp_lg_u32 s44, 2
    s_cbranch_scc1 L_lw_82_2
    ds_read_b64_tr_b16 a[16:17], v80 offset:16384
    ds_read_b64_tr_b16 a[18:19], v80 offset:17408
    ds_read_b64_tr_b16 a[20:21], v80 offset:24576
    ds_read_b64_tr_b16 a[22:23], v80 offset:25600
    ds_read_b64_tr_b16 a[24:25], v81 offset:16384
    ds_read_b64_tr_b16 a[26:27], v81 offset:17408
    ds_read_b64_tr_b16 a[28:29], v81 offset:24576
    ds_read_b64_tr_b16 a[30:31], v81 offset:25600
    s_branch L_lw_82
L_lw_82_2:
    ds_read_b64_tr_b16 a[128:129], v80 offset:16384
    ds_read_b64_tr_b16 a[130:131], v80 offset:17408
    ds_read_b64_tr_b16 a[132:133], v80 offset:24576
    ds_read_b64_tr_b16 a[134:135], v80 offset:25600
    ds_read_b64_tr_b16 a[136:137], v81 offset:16384
    ds_read_b64_tr_b16 a[138:139], v81 offset:17408
    ds_read_b64_tr_b16 a[140:141], v81 offset:24576
    ds_read_b64_tr_b16 a[142:143], v81 offset:25600
L_lw_82:
    s_waitcnt lgkmcnt(0)
    s_waitcnt vmcnt(8)
    s_barrier
    s_add_u32 s79, s41, 13
    s_and_b32 s79, s79, 3
    s_lshl_b32 s79, s79, 19
    s_add_u32 s79, s79, s47
    s_add_u32 s46, s79, 0x600000
    s_add_u32 m0, s48, 16384
    s_nop 0
    buffer_load_dwordx4 v82, s[32:35], s46 offen  lds
    s_add_u32 s46, s79, 0x620000
    s_add_u32 m0, s48, 20480
    s_nop 0
    buffer_load_dwordx4 v82, s[32:35], s46 offen  lds
    s_add_u32 s46, s79, 0x640000
    s_add_u32 m0, s48, 24576
    s_nop 0
    buffer_load_dwordx4 v82, s[32:35], s46 offen  lds
    s_add_u32 s46, s79, 0x660000
    s_add_u32 m0, s48, 28672
    s_nop 0
    buffer_load_dwordx4 v82, s[32:35], s46 offen  lds
    s_cmp_lg_u32 s44, 0
    s_cbranch_scc1 L_lw_83_0
    ds_read_b64_tr_b16 a[104:105], v80 offset:32768
    ds_read_b64_tr_b16 a[106:107], v80 offset:33792
    ds_read_b64_tr_b16 a[108:109], v80 offset:40960
    ds_read_b64_tr_b16 a[110:111], v80 offset:41984
    ds_read_b64_tr_b16 v[56:57], v81 offset:32768
    ds_read_b64_tr_b16 v[58:59], v81 offset:33792
    ds_read_b64_tr_b16 v[60:61], v81 offset:40960
    ds_read_b64_tr_b16 v[62:63], v81 offset:41984
    s_waitcnt lgkmcnt(0)
    ds_write_b128 v5, v[56:59] offset:12288
    ds_write_b128 v5, v[60:63] offset:13312
    s_branch L_lw_83
L_lw_83_0:
    s_cmp_lg_u32 s44, 1
    s_cbranch_scc1 L_lw_83_1
    ds_read_b64_tr_b16 a[64:65], v80 offset:32768
    ds_read_b64_tr_b16 a[66:67], v80 offset:33792
    ds_read_b64_tr_b16 a[68:69], v80 offset:40960
    ds_read_b64_tr_b16 a[70:71], v80 offset:41984
    ds_read_b64_tr_b16 v[56:57], v81 offset:32768
    ds_read_b64_tr_b16 v[58:59], v81 offset:33792
    ds_read_b64_tr_b16 v[60:61], v81 offset:40960
    ds_read_b64_tr_b16 v[62:63], v81 offset:41984
    s_waitcnt lgkmcnt(0)
    ds_write_b128 v5, v[56:59] offset:14336
    ds_write_b128 v5, v[60:63] offset:15360
    s_branch L_lw_83
L_lw_83_1:
    s_cmp_lg_u32 s44, 2
    s_cbranch_scc1 L_lw_83_2
    ds_read_b64_tr_b16 a[32:33], v80 offset:32768
    ds_read_b64_tr_b16 a[34:35], v80 offset:33792
    ds_read_b64_tr_b16 a[36:37], v80 offset:40960
    ds_read_b64_tr_b16 a[38:39], v80 offset:41984
    ds_read_b64_tr_b16 v[56:57], v81 offset:32768
    ds_read_b64_tr_b16 v[58:59], v81 offset:33792
    ds_read_b64_tr_b16 v[60:61], v81 offset:40960
    ds_read_b64_tr_b16 v[62:63], v81 offset:41984
    s_waitcnt lgkmcnt(0)
    ds_write_b128 v5, v[56:59] offset:8192
    ds_write_b128 v5, v[60:63] offset:9216
    s_branch L_lw_83
L_lw_83_2:
    ds_read_b64_tr_b16 a[144:145], v80 offset:32768
    ds_read_b64_tr_b16 a[146:147], v80 offset:33792
    ds_read_b64_tr_b16 a[148:149], v80 offset:40960
    ds_read_b64_tr_b16 a[150:151], v80 offset:41984
    ds_read_b64_tr_b16 v[56:57], v81 offset:32768
    ds_read_b64_tr_b16 v[58:59], v81 offset:33792
    ds_read_b64_tr_b16 v[60:61], v81 offset:40960
    ds_read_b64_tr_b16 v[62:63], v81 offset:41984
    s_waitcnt lgkmcnt(0)
    ds_write_b128 v5, v[56:59] offset:10240
    ds_write_b128 v5, v[60:63] offset:11264
L_lw_83:
    s_waitcnt lgkmcnt(0)
    s_waitcnt vmcnt(8)
    s_barrier
    s_add_u32 s79, s41, 14
    s_and_b32 s79, s79, 3
    s_lshl_b32 s79, s79, 19
    s_add_u32 s79, s79, s47
    s_add_u32 s46, s79, 0x600000
    s_add_u32 m0, s48, 32768
    s_nop 0
    buffer_load_dwordx4 v82, s[32:35], s46 offen  lds
    s_add_u32 s46, s79, 0x620000
    s_add_u32 m0, s48, 36864
    s_nop 0
    buffer_load_dwordx4 v82, s[32:35], s46 offen  lds
    s_add_u32 s46, s79, 0x640000
    s_add_u32 m0, s48, 40960
    s_nop 0
    buffer_load_dwordx4 v82, s[32:35], s46 offen  lds
    s_add_u32 s46, s79, 0x660000
    s_add_u32 m0, s48, 45056
    s_nop 0
    buffer_load_dwordx4 v82, s[32:35], s46 offen  lds
    s_cmp_lg_u32 s44, 0
    s_cbranch_scc1 L_lw_84_0
    ds_read_b64_tr_b16 a[112:113], v80 offset:49152
    ds_read_b64_tr_b16 a[114:115], v80 offset:50176
    ds_read_b64_tr_b16 a[116:117], v80 offset:57344
    ds_read_b64_tr_b16 a[118:119], v80 offset:58368
    ds_read_b64_tr_b16 v[56:57], v81 offset:49152
    ds_read_b64_tr_b16 v[58:59], v81 offset:50176
    ds_read_b64_tr_b16 v[60:61], v81 offset:57344
    ds_read_b64_tr_b16 v[62:63], v81 offset:58368
    s_waitcnt lgkmcnt(0)
    ds_write_b128 v5, v[56:59] offset:20480
    ds_write_b128 v5, v[60:63] offset:21504
    s_branch L_lw_84
L_lw_84_0:
    s_cmp_lg_u32 s44, 1
    s_cbranch_scc1 L_lw_84_1
    ds_read_b64_tr_b16 a[72:73], v80 offset:49152
    ds_read_b64_tr_b16 a[74:75], v80 offset:50176
    ds_read_b64_tr_b16 a[76:77], v80 offset:57344
    ds_read_b64_tr_b16 a[78:79], v80 offset:58368
    ds_read_b64_tr_b16 v[56:57], v81 offset:49152
    ds_read_b64_tr_b16 v[58:59], v81 offset:50176
    ds_read_b64_tr_b16 v[60:61], v81 offset:57344
    ds_read_b64_tr_b16 v[62:63], v81 offset:58368
    s_waitcnt lgkmcnt(0)
    ds_write_b128 v5, v[56:59] offset:22528
    ds_write_b128 v5, v[60:63] offset:23552
    s_branch L_lw_84
L_lw_84_1:
    s_cmp_lg_u32 s44, 2
    s_cbranch_scc1 L_lw_84_2
    ds_read_b64_tr_b16 a[40:41], v80 offset:49152
    ds_read_b64_tr_b16 a[42:43], v80 offset:50176
    ds_read_b64_tr_b16 a[44:45], v80 offset:57344
    ds_read_b64_tr_b16 a[46:47], v80 offset:58368
    ds_read_b64_tr_b16 v[56:57], v81 offset:49152
    ds_read_b64_tr_b16 v[58:59], v81 offset:50176
    ds_read_b64_tr_b16 v[60:61], v81 offset:57344
    ds_read_b64_tr_b16 v[62:63], v81 offset:58368
    s_waitcnt lgkmcnt(0)
    ds_write_b128 v5, v[56:59] offset:16384
    ds_write_b128 v5, v[60:63] offset:17408
    s_branch L_lw_84
L_lw_84_2:
    ds_read_b64_tr_b16 a[152:153], v80 offset:49152
    ds_read_b64_tr_b16 a[154:155], v80 offset:50176
    ds_read_b64_tr_b16 a[156:157], v80 offset:57344
    ds_read_b64_tr_b16 a[158:159], v80 offset:58368
    ds_read_b64_tr_b16 v[56:57], v81 offset:49152
    ds_read_b64_tr_b16 v[58:59], v81 offset:50176
    ds_read_b64_tr_b16 v[60:61], v81 offset:57344
    ds_read_b64_tr_b16 v[62:63], v81 offset:58368
    s_waitcnt lgkmcnt(0)
    ds_write_b128 v5, v[56:59] offset:18432
    ds_write_b128 v5, v[60:63] offset:19456
L_lw_84:
    s_waitcnt lgkmcnt(0)
    s_waitcnt vmcnt(8)
    s_barrier
    s_add_u32 s79, s41, 15
    s_and_b32 s79, s79, 3
    s_lshl_b32 s79, s79, 19
    s_add_u32 s79, s79, s47
    s_add_u32 s46, s79, 0x600000
    s_add_u32 m0, s48, 49152
    s_nop 0
    buffer_load_dwordx4 v82, s[32:35], s46 offen  lds
    s_add_u32 s46, s79, 0x620000
    s_add_u32 m0, s48, 53248
    s_nop 0
    buffer_load_dwordx4 v82, s[32:35], s46 offen  lds
    s_add_u32 s46, s79, 0x640000
    s_add_u32 m0, s48, 57344
    s_nop 0
    buffer_load_dwordx4 v82, s[32:35], s46 offen  lds
    s_add_u32 s46, s79, 0x660000
    s_add_u32 m0, s48, 61440
    s_nop 0
    buffer_load_dwordx4 v82, s[32:35], s46 offen  lds
    v_mov_b32 v46, 0
    buffer_load_dwordx2 v[44:45], v46, s[16:19], 0 offen sc1
    s_cmp_lg_u32 s44, 0
    s_cbranch_scc1 L_lw_85_0
    ds_read_b64_tr_b16 a[120:121], v80 offset:0
    ds_read_b64_tr_b16 a[122:123], v80 offset:1024
    ds_read_b64_tr_b16 a[124:125], v80 offset:8192
    ds_read_b64_tr_b16 a[126:127], v80 offset:9216
    ds_read_b64_tr_b16 v[56:57], v81 offset:0
    ds_read_b64_tr_b16 v[58:59], v81 offset:1024
    ds_read_b64_tr_b16 v[60:61], v81 offset:8192
    ds_read_b64_tr_b16 v[62:63], v81 offset:9216
    s_waitcnt lgkmcnt(0)
    ds_write_b128 v5, v[56:59] offset:0
    ds_write_b128 v5, v[60:63] offset:1024
    s_branch L_lw_85
L_lw_85_0:
    s_cmp_lg_u32 s44, 1
    s_cbranch_scc1 L_lw_85_1
    ds_read_b64_tr_b16 a[80:81], v80 offset:0
    ds_read_b64_tr_b16 a[82:83], v80 offset:1024
    ds_read_b64_tr_b16 a[84:85], v80 offset:8192
    ds_read_b64_tr_b16 a[86:87], v80 offset:9216
    ds_read_b64_tr_b16 v[56:57], v81 offset:0
    ds_read_b64_tr_b16 v[58:59], v81 offset:1024
    ds_read_b64_tr_b16 v[60:61], v81 offset:8192
    ds_read_b64_tr_b16 v[62:63], v81 offset:9216
    s_waitcnt lgkmcnt(0)
    ds_write_b128 v5, v[56:59] offset:2048
    ds_write_b128 v5, v[60:63] offset:3072
    s_branch L_lw_85
L_lw_85_1:
    s_cmp_lg_u32 s44, 2
    s_cbranch_scc1 L_lw_85_2
    ds_read_b64_tr_b16 a[48:49], v80 offset:0
    ds_read_b64_tr_b16 a[50:51], v80 offset:1024
    ds_read_b64_tr_b16 a[52:53], v80 offset:8192
    ds_read_b64_tr_b16 a[54:55], v80 offset:9216
    ds_read_b64_tr_b16 v[56:57], v81 offset:0
    ds_read_b64_tr_b16 v[58:59], v81 offset:1024
    ds_read_b64_tr_b16 v[60:61], v81 offset:8192
    ds_read_b64_tr_b16 v[62:63], v81 offset:9216
    s_waitcnt lgkmcnt(0)
    ds_write_b128 v5, v[56:59] offset:4096
    ds_write_b128 v5, v[60:63] offset:5120
    s_branch L_lw_85
L_lw_85_2:
    ds_read_b64_tr_b16 a[0:1], v80 offset:0
    ds_read_b64_tr_b16 a[2:3], v80 offset:1024
    ds_read_b64_tr_b16 a[4:5], v80 offset:8192
    ds_read_b64_tr_b16 a[6:7], v80 offset:9216
    ds_read_b64_tr_b16 a[8:9], v81 offset:0
    ds_read_b64_tr_b16 a[10:11], v81 offset:1024
    ds_read_b64_tr_b16 a[12:13], v81 offset:8192
    ds_read_b64_tr_b16 a[14:15], v81 offset:9216
L_lw_85:
    s_waitcnt lgkmcnt(0)
    s_waitcnt vmcnt(8)
    s_barrier
    s_cmp_lg_u32 s44, 0
    s_cbranch_scc1 L_lw_86_0
    ds_read_b64_tr_b16 a[128:129], v80 offset:16384
    ds_read_b64_tr_b16 a[130:131], v80 offset:17408
    ds_read_b64_tr_b16 a[132:133], v80 offset:24576
    ds_read_b64_tr_b16 a[134:135], v80 offset:25600
    ds_read_b64_tr_b16 a[136:137], v81 offset:16384
    ds_read_b64_tr_b16 a[138:139], v81 offset:17408
    ds_read_b64_tr_b16 a[140:141], v81 offset:24576
    ds_read_b64_tr_b16 a[142:143], v81 offset:25600
    s_branch L_lw_86
L_lw_86_0:
    s_cmp_lg_u32 s44, 1
    s_cbranch_scc1 L_lw_86_1
    ds_read_b64_tr_b16 a[88:89], v80 offset:16384
    ds_read_b64_tr_b16 a[90:91], v80 offset:17408
    ds_read_b64_tr_b16 a[92:93], v80 offset:24576
    ds_read_b64_tr_b16 a[94:95], v80 offset:25600
    ds_read_b64_tr_b16 a[96:97], v81 offset:16384
    ds_read_b64_tr_b16 a[98:99], v81 offset:17408
    ds_read_b64_tr_b16 a[100:101], v81 offset:24576
    ds_read_b64_tr_b16 a[102:103], v81 offset:25600
    s_branch L_lw_86
L_lw_86_1:
    s_cmp_lg_u32 s44, 2
    s_cbranch_scc1 L_lw_86_2
    ds_read_b64_tr_b16 a[56:57], v80 offset:16384
    ds_read_b64_tr_b16 a[58:59], v80 offset:17408
    ds_read_b64_tr_b16 a[60:61], v80 offset:24576
    ds_read_b64_tr_b16 a[62:63], v80 offset:25600
    ds_read_b64_tr_b16 v[56:57], v81 offset:16384
    ds_read_b64_tr_b16 v[58:59], v81 offset:17408
    ds_read_b64_tr_b16 v[60:61], v81 offset:24576
    ds_read_b64_tr_b16 v[62:63], v81 offset:25600
    s_waitcnt lgkmcnt(0)
    ds_write_b128 v5, v[56:59] offset:6144
    ds_write_b128 v5, v[60:63] offset:7168
    s_branch L_lw_86
L_lw_86_2:
    ds_read_b64_tr_b16 a[16:17], v80 offset:16384
    ds_read_b64_tr_b16 a[18:19], v80 offset:17408
    ds_read_b64_tr_b16 a[20:21], v80 offset:24576
    ds_read_b64_tr_b16 a[22:23], v80 offset:25600
    ds_read_b64_tr_b16 a[24:25], v81 offset:16384
    ds_read_b64_tr_b16 a[26:27], v81 offset:17408
    ds_read_b64_tr_b16 a[28:29], v81 offset:24576
    ds_read_b64_tr_b16 a[30:31], v81 offset:25600
L_lw_86:
    s_waitcnt lgkmcnt(0)
    s_waitcnt vmcnt(4)
    s_barrier
    s_cmp_lg_u32 s44, 0
    s_cbranch_scc1 L_lw_87_0
    ds_read_b64_tr_b16 a[144:145], v80 offset:32768
    ds_read_b64_tr_b16 a[146:147], v80 offset:33792
    ds_read_b64_tr_b16 a[148:149], v80 offset:40960
    ds_read_b64_tr_b16 a[150:151], v80 offset:41984
    ds_read_b64_tr_b16 v[56:57], v81 offset:32768
    ds_read_b64_tr_b16 v[58:59], v81 offset:33792
    ds_read_b64_tr_b16 v[60:61], v81 offset:40960
    ds_read_b64_tr_b16 v[62:63], v81 offset:41984
    s_waitcnt lgkmcnt(0)
    ds_write_b128 v5, v[56:59] offset:10240
    ds_write_b128 v5, v[60:63] offset:11264
    s_branch L_lw_87
L_lw_87_0:
    s_cmp_lg_u32 s44, 1
    s_cbranch_scc1 L_lw_87_1
    ds_read_b64_tr_b16 a[104:105], v80 offset:32768
    ds_read_b64_tr_b16 a[106:107], v80 offset:33792
    ds_read_b64_tr_b16 a[108:109], v80 offset:40960
    ds_read_b64_tr_b16 a[110:111], v80 offset:41984
    ds_read_b64_tr_b16 v[56:57], v81 offset:32768
    ds_read_b64_tr_b16 v[58:59], v81 offset:33792
    ds_read_b64_tr_b16 v[60:61], v81 offset:40960
    ds_read_b64_tr_b16 v[62:63], v81 offset:41984
    s_waitcnt lgkmcnt(0)
    ds_write_b128 v5, v[56:59] offset:12288
    ds_write_b128 v5, v[60:63] offset:13312
    s_branch L_lw_87
L_lw_87_1:
    s_cmp_lg_u32 s44, 2
    s_cbranch_scc1 L_lw_87_2
    ds_read_b64_tr_b16 a[64:65], v80 offset:32768
    ds_read_b64_tr_b16 a[66:67], v80 offset:33792
    ds_read_b64_tr_b16 a[68:69], v80 offset:40960
    ds_read_b64_tr_b16 a[70:71], v80 offset:41984
    ds_read_b64_tr_b16 v[56:57], v81 offset:32768
    ds_read_b64_tr_b16 v[58:59], v81 offset:33792
    ds_read_b64_tr_b16 v[60:61], v81 offset:40960
    ds_read_b64_tr_b16 v[62:63], v81 offset:41984
    s_waitcnt lgkmcnt(0)
    ds_write_b128 v5, v[56:59] offset:14336
    ds_write_b128 v5, v[60:63] offset:15360
    s_branch L_lw_87
L_lw_87_2:
    ds_read_b64_tr_b16 a[32:33], v80 offset:32768
    ds_read_b64_tr_b16 a[34:35], v80 offset:33792
    ds_read_b64_tr_b16 a[36:37], v80 offset:40960
    ds_read_b64_tr_b16 a[38:39], v80 offset:41984
    ds_read_b64_tr_b16 v[56:57], v81 offset:32768
    ds_read_b64_tr_b16 v[58:59], v81 offset:33792
    ds_read_b64_tr_b16 v[60:61], v81 offset:40960
    ds_read_b64_tr_b16 v[62:63], v81 offset:41984
    s_waitcnt lgkmcnt(0)
    ds_write_b128 v5, v[56:59] offset:8192
    ds_write_b128 v5, v[60:63] offset:9216
L_lw_87:
    s_waitcnt lgkmcnt(0)
    s_waitcnt vmcnt(0)
    s_barrier
    s_add_u32 s45, s61, 0
    buffer_load_dword v47, v12, s[12:15], s45 offen sc1
    s_add_u32 s45, s61, 16384
    buffer_load_dword v47, v12, s[12:15], s45 offen sc1
    s_add_u32 s45, s61, 32768
    buffer_load_dword v47, v12, s[12:15], s45 offen sc1
    s_add_u32 s45, s61, 49152
    buffer_load_dword v47, v12, s[12:15], s45 offen sc1
    s_mov_b32 s45, 0x7020000
    buffer_load_dword v47, v10, s[12:15], s45 offen sc1
    s_mov_b32 s45, 0x7030000
    buffer_load_dword v47, v10, s[12:15], s45 offen sc1
    buffer_load_dword v47, v20, s[12:15], 0 offen sc1
    s_cmp_lg_u32 s44, 0
    s_cbranch_scc1 L_lw_88_0
    ds_read_b64_tr_b16 a[152:153], v80 offset:49152
    ds_read_b64_tr_b16 a[154:155], v80 offset:50176
    ds_read_b64_tr_b16 a[156:157], v80 offset:57344
    ds_read_b64_tr_b16 a[158:159], v80 offset:58368
    ds_read_b64_tr_b16 v[56:57], v81 offset:49152
    ds_read_b64_tr_b16 v[58:59], v81 offset:50176
    ds_read_b64_tr_b16 v[60:61], v81 offset:57344
    ds_read_b64_tr_b16 v[62:63], v81 offset:58368
    s_waitcnt lgkmcnt(0)
    ds_write_b128 v5, v[56:59] offset:18432
    ds_write_b128 v5, v[60:63] offset:19456
    s_branch L_lw_88
L_lw_88_0:
    s_cmp_lg_u32 s44, 1
    s_cbranch_scc1 L_lw_88_1
    ds_read_b64_tr_b16 a[112:113], v80 offset:49152
    ds_read_b64_tr_b16 a[114:115], v80 offset:50176
    ds_read_b64_tr_b16 a[116:117], v80 offset:57344
    ds_read_b64_tr_b16 a[118:119], v80 offset:58368
    ds_read_b64_tr_b16 v[56:57], v81 offset:49152
    ds_read_b64_tr_b16 v[58:59], v81 offset:50176
    ds_read_b64_tr_b16 v[60:61], v81 offset:57344
    ds_read_b64_tr_b16 v[62:63], v81 offset:58368
    s_waitcnt lgkmcnt(0)
    ds_write_b128 v5, v[56:59] offset:20480
    ds_write_b128 v5, v[60:63] offset:21504
    s_branch L_lw_88
L_lw_88_1:
    s_cmp_lg_u32 s44, 2
    s_cbranch_scc1 L_lw_88_2
    ds_read_b64_tr_b16 a[72:73], v80 offset:49152
    ds_read_b64_tr_b16 a[74:75], v80 offset:50176
    ds_read_b64_tr_b16 a[76:77], v80 offset:57344
    ds_read_b64_tr_b16 a[78:79], v80 offset:58368
    ds_read_b64_tr_b16 v[56:57], v81 offset:49152
    ds_read_b64_tr_b16 v[58:59], v81 offset:50176
    ds_read_b64_tr_b16 v[60:61], v81 offset:57344
    ds_read_b64_tr_b16 v[62:63], v81 offset:58368
    s_waitcnt lgkmcnt(0)
    ds_write_b128 v5, v[56:59] offset:22528
    ds_write_b128 v5, v[60:63] offset:23552
    s_branch L_lw_88
L_lw_88_2:
    ds_read_b64_tr_b16 a[40:41], v80 offset:49152
    ds_read_b64_tr_b16 a[42:43], v80 offset:50176
    ds_read_b64_tr_b16 a[44:45], v80 offset:57344
    ds_read_b64_tr_b16 a[46:47], v80 offset:58368
    ds_read_b64_tr_b16 v[56:57], v81 offset:49152
    ds_read_b64_tr_b16 v[58:59], v81 offset:50176
    ds_read_b64_tr_b16 v[60:61], v81 offset:57344
    ds_read_b64_tr_b16 v[62:63], v81 offset:58368
    s_waitcnt lgkmcnt(0)
    ds_write_b128 v5, v[56:59] offset:16384
    ds_write_b128 v5, v[60:63] offset:17408
L_lw_88:
    s_waitcnt lgkmcnt(0)
    s_barrier
    v_lshlrev_b32 v68, 3, v1
    s_mul_i32 s45, s44, 3072
    s_add_u32 s45, s45, 53248
    v_add_u32 v6, s45, v68
    s_sub_u32 s45, s44, 1
    s_and_b32 s45, s45, 3
    s_mul_i32 s45, s45, 3072
    s_add_u32 s45, s45, 53248
    v_add_u32 v7, s45, v68
    s_sub_u32 s45, s44, 2
    s_and_b32 s45, s45, 3
    s_mul_i32 s45, s45, 3072
    s_add_u32 s45, s45, 54272
    v_add_u32 v8, s45, v68
    s_sub_u32 s45, s44, 3
    s_and_b32 s45, s45, 3
    s_mul_i32 s45, s45, 3072
    s_add_u32 s45, s45, 55296
    v_add_u32 v18, s45, v68
    v_lshlrev_b32 v68, 4, v1
    s_add_u32 s45, s69, 0
    s_and_b32 s45, s45, 7
    s_lshl_b32 s45, s45, 10
    s_lshl_b32 s46, s44, 13
    s_add_u32 s45, s45, s46
    v_add_u32 v80, s45, v68
    s_add_u32 s45, s69, 1
    s_and_b32 s45, s45, 7
    s_lshl_b32 s45, s45, 10
    s_lshl_b32 s46, s44, 13
    s_add_u32 s45, s45, s46
    v_add_u32 v81, s45, v68
    s_add_u32 s45, s69, 2
    s_and_b32 s45, s45, 7
    s_lshl_b32 s45, s45, 10
    s_lshl_b32 s46, s44, 13
    s_add_u32 s45, s45, s46
    v_add_u32 v82, s45, v68
    s_add_u32 s45, s69, 3
    s_and_b32 s45, s45, 7
    s_lshl_b32 s45, s45, 10
    s_lshl_b32 s46, s44, 13
    s_add_u32 s45, s45, s46
    v_add_u32 v83, s45, v68
    s_add_u32 s45, s69, 4
    s_and_b32 s45, s45, 7
    s_lshl_b32 s45, s45, 10
    s_lshl_b32 s46, s44, 13
    s_add_u32 s45, s45, s46
    v_add_u32 v84, s45, v68
    s_add_u32 s45, s69, 5
    s_and_b32 s45, s45, 7
    s_lshl_b32 s45, s45, 10
    s_lshl_b32 s46, s44, 13
    s_add_u32 s45, s45, s46
    v_add_u32 v85, s45, v68
    s_add_u32 s45, s69, 6
    s_and_b32 s45, s45, 7
    s_lshl_b32 s45, s45, 10
    s_lshl_b32 s46, s44, 13
    s_add_u32 s45, s45, s46
    v_add_u32 v86, s45, v68
    s_add_u32 s45, s69, 7
    s_and_b32 s45, s45, 7
    s_lshl_b32 s45, s45, 10
    s_lshl_b32 s46, s44, 13
    s_add_u32 s45, s45, s46
    v_add_u32 v87, s45, v68
    s_lshl_b32 s45, s40, 4
    s_add_u32 s45, s45, s42
    s_lshl_b32 s45, s45, 8
    s_lshl_b32 s46, s44, 6
    s_add_u32 s45, s45, s46
    s_add_u32 s45, s45, 0x7080000
    v_and_b32 v13, 15, v1
    v_lshlrev_b32 v13, 2, v13
    v_add_u32 v13, s45, v13
    s_mov_b32 s66, 0x1800000
    v_mov_b32 v14, -1
    v_mov_b32 v15, -1
    s_mov_b32 s70, 0
    v_mov_b32 v41, 0
    s_branch L_hw_89_c
L_hw_89:
    buffer_load_dwordx2 v[44:45], v41, s[16:19], 0 offen sc1
    s_add_u32 s70, s70, 1
    s_cmp_ge_u32 s70, 0x100000
    s_cbranch_scc1 L_c_done_1
L_hw_89_c:
    s_waitcnt vmcnt(0)
    v_readfirstlane_b32 s45, v44
    v_readfirstlane_b32 s46, v45
    s_nop 3
    s_lshr_b32 s47, s46, 24
    s_cmp_lg_u32 s47, 64
    s_cbranch_scc1 L_hw_89
    s_lshr_b32 s68, s45, 24
    s_and_b32 s47, s45, 511
    s_mul_i32 s47, s47, s47
    s_bfe_u32 s45, s45, 0xf0009
    s_lshl_b32 s45, s45, 5
    s_sub_u32 s45, s45, s47
    s_and_b32 s47, s46, 511
    s_mul_i32 s47, s47, s47
    s_bfe_u32 s46, s46, 0xf0009
    s_lshl_b32 s46, s46, 5
    s_sub_u32 s46, s46, s47
    s_or_b32 s45, s45, s46
    s_cmp_eq_u32 s45, 0
    s_cselect_b32 s67, 1, 0
    s_mov_b32 s24, s12
    s_mov_b32 s25, s13
    s_mov_b32 s28, s12
    s_mov_b32 s29, s13
    s_cmp_eq_u32 s67, 1
    s_cselect_b32 s26, s14, 0
    s_cselect_b32 s30, 0, s14
    s_cmp_ge_u32 s68, 16
    s_cselect_b32 s68, 8192, 0
    s_mov_b32 s6, 0x11111111
    s_mov_b32 s7, 0xffaaa491
    s_mov_b32 s60, 0
    s_lshl_b32 s58, s40, 16
    s_add_u32 s58, s58, 0x7000000
    s_mov_b32 s61, s58
    s_lshl_b32 s59, s40, 17
    s_add_u32 s59, s59, 0x7040000
    s_mov_b32 s62, s59
    s_add_u32 s32, s41, 0
    s_and_b32 s32, s32, 3
    s_lshl_b32 s32, s32, 10
    s_add_u32 s33, s41, 1
    s_and_b32 s33, s33, 3
    s_lshl_b32 s33, s33, 10
    s_add_u32 s34, s41, 2
    s_and_b32 s34, s34, 3
    s_lshl_b32 s34, s34, 10
    s_add_u32 s35, s41, 3
    s_and_b32 s35, s35, 3
    s_lshl_b32 s35, s35, 10
    s_cmp_lg_u32 s44, 0
    s_cbranch_scc1 L_ld_90
    v_mov_b32 v40, 1
    v_mov_b32 v41, 127360
    s_mov_b64 exec, 1
    buffer_atomic_add v40, v41, s[12:15], 0 offen sc1
    s_mov_b64 exec, -1
L_ld_90:
    s_add_u32 s63, s63, s68
    s_add_u32 s64, s64, s68
    s_lshl_b32 s36, s40, 12
    s_add_u32 s36, s36, 0x5000
    ds_read_b128 v[56:59], v5 offset:8192
    ds_read_b128 v[60:63], v5 offset:9216
    ds_read_b128 v[64:67], v5 offset:16384
    ds_read_b128 v[68:71], v5 offset:17408
    ds_read_b128 v[72:75], v5 offset:4096
    ds_read_b128 v[76:79], v5 offset:5120
    ds_read_b128 v[88:91], v5 offset:6144
    ds_read_b128 v[92:95], v5 offset:7168
    ds_read_b128 v[32:35], v5 offset:14336
    ds_read_b128 v[36:39], v5 offset:15360
L_v_loop_91:
    s_add_u32 s8, s61, s32
    s_add_u32 s9, s61, s33
    s_add_u32 s10, s61, s34
    s_add_u32 s11, s61, s35
    v_mov_b32 v24, 0
    v_mov_b32 v25, 0
    v_mov_b32 v26, 0
    v_mov_b32 v27, 0
    v_mov_b32 v28, 0
    v_mov_b32 v29, 0
    v_mov_b32 v30, 0
    v_mov_b32 v31, 0
    s_and_b32 s37, s60, 1
    s_lshl_b32 s37, s37, 16
    s_add_u32 s37, s37, 0x7020000
    s_xor_b32 s38, s37, 65536
    s_add_u32 s39, s60, 3
    s_and_b32 s39, s39, 3
    s_lshl_b32 s39, s39, 14
    s_add_u32 s39, s39, s58
    s_nop 15
    s_waitcnt lgkmcnt(0)
    buffer_load_dwordx4 v[40:43], v3, s[12:15], s8 offen sc1
    s_nop 4
    buffer_load_dwordx4 v[44:47], v3, s[12:15], s9 offen sc1
    s_nop 4
    buffer_load_dwordx4 v[48:51], v3, s[12:15], s10 offen sc1
    s_nop 4
    buffer_load_dwordx4 v[52:55], v3, s[12:15], s11 offen sc1
    s_mov_b32 s70, 0
    s_waitcnt vmcnt(3)
    v_max3_u32 v22, v40, v41, v42
    ds_write_b128 v3, v[40:43] offset:0
    v_max_u32 v22, v22, v43
    v_cmp_eq_u32 vcc, -1, v22
    s_nop 0
    s_nop 0
    s_cbranch_vccnz L_mg_92_r0
L_mg_92_c0:
    v_smfmac_f32_16x16x64_bf16 v[24:27], v[40:43], a[0:7], v2
    s_waitcnt vmcnt(2)
    v_max3_u32 v22, v44, v45, v46
    ds_write_b128 v3, v[44:47] offset:1024
    v_max_u32 v22, v22, v47
    v_cmp_eq_u32 vcc, -1, v22
    v_smfmac_f32_16x16x64_bf16 v[28:31], v[40:43], a[8:15], v2
    s_nop 0
    s_cbranch_vccnz L_mg_92_r1
L_mg_92_c1:
    v_smfmac_f32_16x16x64_bf16 v[24:27], v[44:47], a[16:23], v2
    s_waitcnt vmcnt(1)
    v_max3_u32 v22, v48, v49, v50
    ds_write_b128 v3, v[48:51] offset:2048
    v_max_u32 v22, v22, v51
    v_cmp_eq_u32 vcc, -1, v22
    v_smfmac_f32_16x16x64_bf16 v[28:31], v[44:47], a[24:31], v2
    s_nop 0
    s_cbranch_vccnz L_mg_92_r2
L_mg_92_c2:
    s_waitcnt vmcnt(0)
    v_max3_u32 v22, v52, v53, v54
    ds_write_b128 v3, v[52:55] offset:3072
    v_max_u32 v22, v22, v55
    v_cmp_eq_u32 vcc, -1, v22
    s_waitcnt lgkmcnt(0)
    s_nop 0
    s_cbranch_vccnz L_mg_92_r3
L_mg_92_c3:
    s_barrier
    ds_read_b128 v[40:43], v4 offset:0
    ds_read_b128 v[44:47], v4 offset:1024
    v_smfmac_f32_16x16x64_bf16 v[24:27], v[48:51], a[32:39], v2
    v_smfmac_f32_16x16x64_bf16 v[28:31], v[48:51], v[56:63], v2
    ds_read_b128 v[48:51], v4 offset:2048
    v_smfmac_f32_16x16x64_bf16 v[24:27], v[52:55], a[40:47], v2
    ds_read_b128 v[56:59], v5 offset:22528
    v_smfmac_f32_16x16x64_bf16 v[28:31], v[52:55], v[64:71], v2
    ds_read_b128 v[52:55], v4 offset:3072
    s_waitcnt lgkmcnt(3)
    v_smfmac_f32_16x16x64_bf16 v[24:27], v[40:43], a[48:55], v2
    ds_read_b128 v[60:63], v5 offset:23552
    v_smfmac_f32_16x16x64_bf16 v[28:31], v[40:43], v[72:79], v2
    ds_read_b128 v[40:43], v21 offset:0
    v_smfmac_f32_16x16x64_bf16 v[24:27], v[44:47], a[56:63], v2
    ds_read_b128 v[64:67], v5 offset:2048
    v_smfmac_f32_16x16x64_bf16 v[28:31], v[44:47], v[88:95], v2
    ds_read_b128 v[44:47], v21 offset:1024
    ds_read_b128 v[68:71], v5 offset:3072
    s_waitcnt lgkmcnt(5)
    v_smfmac_f32_16x16x64_bf16 v[24:27], v[48:51], a[64:71], v2
    ds_read_b128 v[72:75], v5 offset:12288
    v_smfmac_f32_16x16x64_bf16 v[28:31], v[48:51], v[32:39], v2
    ds_read_b128 v[48:51], v21 offset:2048
    ds_read_b128 v[76:79], v5 offset:13312
    v_smfmac_f32_16x16x64_bf16 v[24:27], v[52:55], a[72:79], v2
    ds_read_b128 v[88:91], v5 offset:20480
    s_waitcnt lgkmcnt(6)
    v_smfmac_f32_16x16x64_bf16 v[28:31], v[52:55], v[56:63], v2
    ds_read_b128 v[52:55], v21 offset:3072
    ds_read_b128 v[92:95], v5 offset:21504
    v_smfmac_f32_16x16x64_bf16 v[24:27], v[40:43], a[80:87], v2
    ds_read_b128 v[32:35], v5 offset:0
    s_waitcnt lgkmcnt(6)
    v_smfmac_f32_16x16x64_bf16 v[28:31], v[40:43], v[64:71], v2
    ds_read_b128 v[40:43], v23 offset:0
    ds_read_b128 v[36:39], v5 offset:1024
    v_smfmac_f32_16x16x64_bf16 v[24:27], v[44:47], a[88:95], v2
    ds_read_b128 v[56:59], v5 offset:10240
    v_smfmac_f32_16x16x64_bf16 v[28:31], v[44:47], a[96:103], v2
    ds_read_b128 v[44:47], v23 offset:1024
    s_waitcnt lgkmcnt(5)
    v_smfmac_f32_16x16x64_bf16 v[24:27], v[48:51], a[104:111], v2
    ds_read_b128 v[60:63], v5 offset:11264
    v_smfmac_f32_16x16x64_bf16 v[28:31], v[48:51], v[72:79], v2
    ds_read_b128 v[48:51], v23 offset:2048
    v_smfmac_f32_16x16x64_bf16 v[24:27], v[52:55], a[112:119], v2
    ds_read_b128 v[64:67], v5 offset:18432
    v_smfmac_f32_16x16x64_bf16 v[28:31], v[52:55], v[88:95], v2
    ds_read_b128 v[52:55], v23 offset:3072
    s_waitcnt lgkmcnt(4)
    v_smfmac_f32_16x16x64_bf16 v[24:27], v[40:43], a[120:127], v2
    ds_read_b128 v[68:71], v5 offset:19456
    v_smfmac_f32_16x16x64_bf16 v[28:31], v[40:43], v[32:39], v2
    v_smfmac_f32_16x16x64_bf16 v[24:27], v[44:47], a[128:135], v2
    v_smfmac_f32_16x16x64_bf16 v[28:31], v[44:47], a[136:143], v2
    s_waitcnt lgkmcnt(1)
    v_smfmac_f32_16x16x64_bf16 v[24:27], v[48:51], a[144:151], v2
    v_smfmac_f32_16x16x64_bf16 v[28:31], v[48:51], v[56:63], v2
    v_smfmac_f32_16x16x64_bf16 v[24:27], v[52:55], a[152:159], v2
    s_waitcnt lgkmcnt(0)
    v_smfmac_f32_16x16x64_bf16 v[28:31], v[52:55], v[64:71], v2
    s_nop 5
    v_permlane32_swap_b32 v24, v26
    v_permlane32_swap_b32 v25, v27
    v_permlane32_swap_b32 v28, v30
    v_permlane32_swap_b32 v29, v31
    v_pk_add_f32 v[24:25], v[24:25], v[26:27]
    v_pk_add_f32 v[28:29], v[28:29], v[30:31]
    v_cvt_pk_bf16_f32 v16, v24, v25
    v_cvt_pk_bf16_f32 v17, v28, v29
    buffer_store_dwordx2 v[16:17], v10, s[24:27], s37 offen
    buffer_store_dwordx2 v[14:15], v10, s[24:27], s38 offen
    buffer_store_dword v14, v12, s[24:27], s39 offen
    buffer_store_dwordx2 v[16:17], v10, s[28:31], s37 offen sc1
    buffer_store_dwordx2 v[14:15], v10, s[28:31], s38 offen sc1
    buffer_store_dword v14, v12, s[28:31], s39 offen sc1
    s_barrier
    s_cmp_eq_u32 s60, 63
    s_cbranch_scc1 L_v_fin_93
    s_and_b32 s65, s60, 1
    s_lshl_b32 s65, s65, 12
    s_and_b32 s45, s60, 2
    s_lshl_b32 s45, s45, 13
    s_add_u32 s65, s65, s45
    s_xor_b32 s45, s65, 16384
    s_add_u32 s45, s45, s63
    buffer_store_dwordx2 v[14:15], v11, s[12:15], s45 offen sc1
    s_add_u32 s48, s63, s65
    s_add_u32 s49, s64, s65
    v_mov_b32 v24, 0
    v_mov_b32 v25, 0
    v_mov_b32 v26, 0
    v_mov_b32 v27, 0
    v_mov_b32 v28, 0
    v_mov_b32 v29, 0
    v_mov_b32 v30, 0
    v_mov_b32 v31, 0
    v_mov_b32 v32, 0
    v_mov_b32 v33, 0
    v_mov_b32 v34, 0
    v_mov_b32 v35, 0
    v_mov_b32 v36, 0
    v_mov_b32 v37, 0
    v_mov_b32 v38, 0
    v_mov_b32 v39, 0
    s_sleep 4
    s_waitcnt vmcnt(0)
    s_mov_b64 exec, 65535
    buffer_load_dword v40, v13, s[12:15], 0 offen sc1
    s_nop 15
    buffer_load_dword v41, v13, s[12:15], 0 offen sc1
    s_nop 15
    buffer_load_dword v42, v13, s[12:15], 0 offen sc1
    s_nop 15
    buffer_load_dword v43, v13, s[12:15], 0 offen sc1
    s_mov_b32 s70, 0
L_pp_94:
    s_waitcnt vmcnt(3)
    v_cmp_ge_u32 vcc, s60, v40
    s_nop 1
    s_cbranch_vccz L_ppd_95
    buffer_load_dword v40, v13, s[12:15], 0 offen sc1
    s_waitcnt vmcnt(3)
    v_cmp_ge_u32 vcc, s60, v41
    s_nop 1
    s_cbranch_vccz L_ppd_95
    buffer_load_dword v41, v13, s[12:15], 0 offen sc1
    s_waitcnt vmcnt(3)
    v_cmp_ge_u32 vcc, s60, v42
    s_nop 1
    s_cbranch_vccz L_ppd_95
    buffer_load_dword v42, v13, s[12:15], 0 offen sc1
    s_waitcnt vmcnt(3)
    v_cmp_ge_u32 vcc, s60, v43
    s_nop 1
    s_cbranch_vccz L_ppd_95
    buffer_load_dword v43, v13, s[12:15], 0 offen sc1
    s_add_u32 s70, s70, 1
    s_cmp_lt_u32 s70, 0x100000
    s_cbranch_scc1 L_pp_94
    s_branch L_c_done_1
.p2align 5
    s_nop 0
    s_nop 0
    s_nop 0
    s_nop 0
    s_nop 0
    s_nop 0
    s_nop 0
L_ppd_95:
    s_mov_b64 exec, -1
    s_nop 3
    s_mov_b32 s70, 0
    buffer_load_dwordx4 v[40:43], v80, s[12:15], s62 offen sc1
    s_nop 7
    buffer_load_dwordx4 v[44:47], v81, s[12:15], s62 offen sc1
    s_nop 7
    buffer_load_dwordx4 v[48:51], v82, s[12:15], s62 offen sc1
    s_nop 7
    buffer_load_dwordx4 v[52:55], v83, s[12:15], s62 offen sc1
    s_nop 7
    buffer_load_dwordx4 v[56:59], v84, s[12:15], s62 offen sc1
    s_nop 7
    buffer_load_dwordx4 v[60:63], v85, s[12:15], s62 offen sc1
    s_waitcnt vmcnt(5)
    v_cmp_eq_u32 vcc, -1, v43
    s_nop 1
    s_cbranch_vccnz L_v_og_96_r0
L_v_og_96_c0:
    v_smfmac_f32_16x16x64_bf16 v[24:27], v[40:43], a[160:167], v2
    buffer_load_dwordx4 v[64:67], v86, s[12:15], s62 offen sc1
    v_smfmac_f32_16x16x64_bf16 v[28:31], v[40:43], a[168:175], v2
    s_waitcnt vmcnt(5)
    v_cmp_eq_u32 vcc, -1, v47
    v_smfmac_f32_16x16x64_bf16 v[32:35], v[40:43], a[176:183], v2
    v_smfmac_f32_16x16x64_bf16 v[36:39], v[40:43], a[184:191], v2
    s_cbranch_vccnz L_v_og_96_r1
L_v_og_96_c1:
    v_smfmac_f32_16x16x64_bf16 v[24:27], v[44:47], a[192:199], v2
    buffer_load_dwordx4 v[68:71], v87, s[12:15], s62 offen sc1
    v_smfmac_f32_16x16x64_bf16 v[28:31], v[44:47], a[200:207], v2
    s_waitcnt vmcnt(5)
    v_cmp_eq_u32 vcc, -1, v51
    v_smfmac_f32_16x16x64_bf16 v[32:35], v[44:47], a[208:215], v2
    v_smfmac_f32_16x16x64_bf16 v[36:39], v[44:47], a[216:223], v2
    s_cbranch_vccnz L_v_og_96_r2
L_v_og_96_c2:
    v_smfmac_f32_16x16x64_bf16 v[24:27], v[48:51], a[224:231], v2
    s_waitcnt vmcnt(4)
    v_cmp_eq_u32 vcc, -1, v55
    v_smfmac_f32_16x16x64_bf16 v[28:31], v[48:51], a[232:239], v2
    v_smfmac_f32_16x16x64_bf16 v[32:35], v[48:51], a[240:247], v2
    s_cbranch_vccnz L_v_og_96_r3
L_v_og_96_c3:
    v_smfmac_f32_16x16x64_bf16 v[24:27], v[52:55], v[96:103], v2
    s_add_u32 s46, s60, 1
    s_and_b32 s45, s46, 3
    v_smfmac_f32_16x16x64_bf16 v[28:31], v[52:55], v[104:111], v2
    s_waitcnt vmcnt(3)
    v_cmp_eq_u32 vcc, -1, v59
    v_smfmac_f32_16x16x64_bf16 v[32:35], v[52:55], v[112:119], v2
    v_smfmac_f32_16x16x64_bf16 v[36:39], v[52:55], v[120:127], v2
    s_cbranch_vccnz L_v_og_96_r4
L_v_og_96_c4:
    v_smfmac_f32_16x16x64_bf16 v[24:27], v[56:59], v[128:135], v2
    s_waitcnt vmcnt(2)
    v_cmp_eq_u32 vcc, -1, v63
    v_smfmac_f32_16x16x64_bf16 v[28:31], v[56:59], v[136:143], v2
    v_smfmac_f32_16x16x64_bf16 v[32:35], v[56:59], v[144:151], v2
    s_cbranch_vccnz L_v_og_96_r5
L_v_og_96_c5:
    v_smfmac_f32_16x16x64_bf16 v[24:27], v[60:63], v[160:167], v2
    s_mov_b32 s60, s46
    s_lshl_b32 s46, s45, 14
    v_smfmac_f32_16x16x64_bf16 v[28:31], v[60:63], v[168:175], v2
    s_waitcnt vmcnt(1)
    v_cmp_eq_u32 vcc, -1, v67
    v_smfmac_f32_16x16x64_bf16 v[32:35], v[60:63], v[176:183], v2
    v_smfmac_f32_16x16x64_bf16 v[36:39], v[60:63], v[184:191], v2
    s_cbranch_vccnz L_v_og_96_r6
L_v_og_96_c6:
    v_smfmac_f32_16x16x64_bf16 v[24:27], v[64:67], v[192:199], v2
    s_add_u32 s61, s58, s46
    v_smfmac_f32_16x16x64_bf16 v[28:31], v[64:67], v[200:207], v2
    v_smfmac_f32_16x16x64_bf16 v[32:35], v[64:67], v[208:215], v2
    s_waitcnt vmcnt(0)
    v_cmp_eq_u32 vcc, -1, v71
    v_smfmac_f32_16x16x64_bf16 v[36:39], v[64:67], v[216:223], v2
    s_nop 0
    s_cbranch_vccnz L_v_og_96_r7
L_v_og_96_c7:
    v_smfmac_f32_16x16x64_bf16 v[24:27], v[68:71], v[224:231], v2
    s_lshl_b32 s46, s45, 15
    s_add_u32 s62, s59, s46
    v_smfmac_f32_16x16x64_bf16 v[28:31], v[68:71], v[232:239], v2
    s_nop 0
    s_nop 0
    v_smfmac_f32_16x16x64_bf16 v[32:35], v[68:71], v[240:247], v2
    s_nop 0
    s_nop 0
    v_permlane32_swap_b32 v24, v26
    v_permlane32_swap_b32 v25, v27
    v_pk_add_f32 v[24:25], v[24:25], v[26:27]
    v_smfmac_f32_16x16x64_bf16 v[36:39], v[48:51], a[248:255], v2
    ds_write_b64 v6, v[24:25] offset:0
    v_permlane32_swap_b32 v28, v30
    v_permlane32_swap_b32 v29, v31
    v_pk_add_f32 v[28:29], v[28:29], v[30:31]
    v_smfmac_f32_16x16x64_bf16 v[36:39], v[56:59], v[152:159], v2
    ds_write_b64 v6, v[28:29] offset:1024
    v_permlane32_swap_b32 v32, v34
    v_permlane32_swap_b32 v33, v35
    v_pk_add_f32 v[32:33], v[32:33], v[34:35]
    v_smfmac_f32_16x16x64_bf16 v[36:39], v[68:71], v[248:255], v2
    ds_write_b64 v6, v[32:33] offset:2048
    v_mov_b32 v19, s60
    s_nop 5
    v_permlane32_swap_b32 v36, v38
    v_permlane32_swap_b32 v37, v39
    v_pk_add_f32 v[36:37], v[36:37], v[38:39]
    s_waitcnt lgkmcnt(0)
    s_barrier
    ds_read_b64 v[40:41], v7
    ds_read_b64 v[42:43], v8
    ds_read_b64 v[44:45], v18
    s_waitcnt lgkmcnt(2)
    v_pk_add_f32 v[36:37], v[36:37], v[40:41]
    s_waitcnt lgkmcnt(0)
    v_pk_add_f32 v[42:43], v[42:43], v[44:45]
    v_pk_add_f32 v[24:25], v[36:37], v[42:43]
    buffer_store_dwordx2 v[24:25], v11, s[12:15], s48 offen sc1
    ds_read_b128 v[56:59], v5 offset:8192
    ds_read_b128 v[60:63], v5 offset:9216
    ds_read_b128 v[64:67], v5 offset:16384
    ds_read_b128 v[68:71], v5 offset:17408
    ds_read_b128 v[72:75], v5 offset:4096
    ds_read_b128 v[76:79], v5 offset:5120
    ds_read_b128 v[88:91], v5 offset:6144
    ds_read_b128 v[92:95], v5 offset:7168
    ds_read_b128 v[32:35], v5 offset:14336
    ds_read_b128 v[36:39], v5 offset:15360
    s_sleep 4
    buffer_load_dwordx2 v[40:41], v11, s[12:15], s49 offen sc1
    s_mov_b32 s70, 0
L_v_xp_97:
    s_waitcnt vmcnt(0)
    v_max_u32 v22, v40, v41
    v_cmp_eq_u32 vcc, -1, v22
    v_pk_add_f32 v[28:29], v[24:25], v[40:41]
    v_cvt_pk_bf16_f32 v28, v28, v29
    s_cbranch_vccnz L_v_xp_97_r
L_v_xp_97_ok:
    buffer_store_dword v19, v20, s[24:27], 0 offen
    v_mov_b32_dpp v29, v28 quad_perm:[1,0,3,2] row_mask:0xf bank_mask:0xf
    v_perm_b32 v28, v28, v29, v9
    buffer_store_dword v28, v12, s[24:27], s61 offen
    buffer_store_dword v28, v12, s[28:31], s61 offen sc1
    buffer_store_dword v19, v20, s[28:31], 0 offen sc1
    s_add_u32 s66, s66, 65536
    s_branch L_v_loop_91
L_v_fin_93:
    buffer_store_dwordx2 v[16:17], v10, s[12:15], s66 offen sc1
    s_waitcnt vmcnt(0)
    v_mov_b32 v22, 64
    v_mov_b32 v0, 0
    s_mov_b64 exec, 1
    buffer_store_dword v22, v0, s[12:15], s3 offen sc1
    s_mov_b64 exec, -1
L_c_done_1:
    s_endpgm
L_v_og_96_r0:
    buffer_load_dwordx4 v[40:43], v80, s[12:15], s62 offen sc1
    buffer_load_dwordx4 v[44:47], v81, s[12:15], s62 offen sc1
    buffer_load_dwordx4 v[48:51], v82, s[12:15], s62 offen sc1
    buffer_load_dwordx4 v[52:55], v83, s[12:15], s62 offen sc1
    buffer_load_dwordx4 v[56:59], v84, s[12:15], s62 offen sc1
    buffer_load_dwordx4 v[60:63], v85, s[12:15], s62 offen sc1
    s_add_u32 s70, s70, 1
    s_cmp_ge_u32 s70, 0x100000
    s_cbranch_scc1 L_c_done_1
    s_waitcnt vmcnt(5)
    v_cmp_eq_u32 vcc, -1, v43
    s_nop 1
    s_cbranch_vccnz L_v_og_96_r0
    s_branch L_v_og_96_c0
L_v_og_96_r1:
    buffer_load_dwordx4 v[44:47], v81, s[12:15], s62 offen sc1
    buffer_load_dwordx4 v[48:51], v82, s[12:15], s62 offen sc1
    buffer_load_dwordx4 v[52:55], v83, s[12:15], s62 offen sc1
    buffer_load_dwordx4 v[56:59], v84, s[12:15], s62 offen sc1
    buffer_load_dwordx4 v[60:63], v85, s[12:15], s62 offen sc1
    buffer_load_dwordx4 v[64:67], v86, s[12:15], s62 offen sc1
    s_add_u32 s70, s70, 1
    s_cmp_ge_u32 s70, 0x100000
    s_cbranch_scc1 L_c_done_1
    s_waitcnt vmcnt(5)
    v_cmp_eq_u32 vcc, -1, v47
    s_nop 1
    s_cbranch_vccnz L_v_og_96_r1
    s_branch L_v_og_96_c1
L_v_og_96_r2:
    buffer_load_dwordx4 v[48:51], v82, s[12:15], s62 offen sc1
    buffer_load_dwordx4 v[52:55], v83, s[12:15], s62 offen sc1
    buffer_load_dwordx4 v[56:59], v84, s[12:15], s62 offen sc1
    buffer_load_dwordx4 v[60:63], v85, s[12:15], s62 offen sc1
    buffer_load_dwordx4 v[64:67], v86, s[12:15], s62 offen sc1
    buffer_load_dwordx4 v[68:71], v87, s[12:15], s62 offen sc1
    s_add_u32 s70, s70, 1
    s_cmp_ge_u32 s70, 0x100000
    s_cbranch_scc1 L_c_done_1
    s_waitcnt vmcnt(5)
    v_cmp_eq_u32 vcc, -1, v51
    s_nop 1
    s_cbranch_vccnz L_v_og_96_r2
    s_branch L_v_og_96_c2
L_v_og_96_r3:
    buffer_load_dwordx4 v[52:55], v83, s[12:15], s62 offen sc1
    buffer_load_dwordx4 v[56:59], v84, s[12:15], s62 offen sc1
    buffer_load_dwordx4 v[60:63], v85, s[12:15], s62 offen sc1
    buffer_load_dwordx4 v[64:67], v86, s[12:15], s62 offen sc1
    buffer_load_dwordx4 v[68:71], v87, s[12:15], s62 offen sc1
    s_add_u32 s70, s70, 1
    s_cmp_ge_u32 s70, 0x100000
    s_cbranch_scc1 L_c_done_1
    s_waitcnt vmcnt(4)
    v_cmp_eq_u32 vcc, -1, v55
    s_nop 1
    s_cbranch_vccnz L_v_og_96_r3
    s_branch L_v_og_96_c3
L_v_og_96_r4:
    buffer_load_dwordx4 v[56:59], v84, s[12:15], s62 offen sc1
    buffer_load_dwordx4 v[60:63], v85, s[12:15], s62 offen sc1
    buffer_load_dwordx4 v[64:67], v86, s[12:15], s62 offen sc1
    buffer_load_dwordx4 v[68:71], v87, s[12:15], s62 offen sc1
    s_add_u32 s70, s70, 1
    s_cmp_ge_u32 s70, 0x100000
    s_cbranch_scc1 L_c_done_1
    s_waitcnt vmcnt(3)
    v_cmp_eq_u32 vcc, -1, v59
    s_nop 1
    s_cbranch_vccnz L_v_og_96_r4
    s_branch L_v_og_96_c4
L_v_og_96_r5:
    buffer_load_dwordx4 v[60:63], v85, s[12:15], s62 offen sc1
    buffer_load_dwordx4 v[64:67], v86, s[12:15], s62 offen sc1
    buffer_load_dwordx4 v[68:71], v87, s[12:15], s62 offen sc1
    s_add_u32 s70, s70, 1
    s_cmp_ge_u32 s70, 0x100000
    s_cbranch_scc1 L_c_done_1
    s_waitcnt vmcnt(2)
    v_cmp_eq_u32 vcc, -1, v63
    s_nop 1
    s_cbranch_vccnz L_v_og_96_r5
    s_branch L_v_og_96_c5
L_v_og_96_r6:
    buffer_load_dwordx4 v[64:67], v86, s[12:15], s62 offen sc1
    buffer_load_dwordx4 v[68:71], v87, s[12:15], s62 offen sc1
    s_add_u32 s70, s70, 1
    s_cmp_ge_u32 s70, 0x100000
    s_cbranch_scc1 L_c_done_1
    s_waitcnt vmcnt(1)
    v_cmp_eq_u32 vcc, -1, v67
    s_nop 1
    s_cbranch_vccnz L_v_og_96_r6
    s_branch L_v_og_96_c6
L_v_og_96_r7:
    buffer_load_dwordx4 v[68:71], v87, s[12:15], s62 offen sc1
    s_add_u32 s70, s70, 1
    s_cmp_ge_u32 s70, 0x100000
    s_cbranch_scc1 L_c_done_1
    s_waitcnt vmcnt(0)
    v_cmp_eq_u32 vcc, -1, v71
    s_nop 1
    s_cbranch_vccnz L_v_og_96_r7
    s_branch L_v_og_96_c7
L_mg_92_r0:
    buffer_load_dwordx4 v[40:43], v3, s[12:15], s8 offen sc1
    buffer_load_dwordx4 v[44:47], v3, s[12:15], s9 offen sc1
    buffer_load_dwordx4 v[48:51], v3, s[12:15], s10 offen sc1
    buffer_load_dwordx4 v[52:55], v3, s[12:15], s11 offen sc1
    s_add_u32 s70, s70, 1
    s_cmp_ge_u32 s70, 0x100000
    s_cbranch_scc1 L_c_done_1
    s_waitcnt vmcnt(3)
    ds_write_b128 v3, v[40:43] offset:0
    v_max3_u32 v22, v40, v41, v42
    v_max_u32 v22, v22, v43
    v_cmp_eq_u32 vcc, -1, v22
    s_waitcnt lgkmcnt(0)
    s_nop 0
    s_cbranch_vccnz L_mg_92_r0
    s_branch L_mg_92_c0
L_mg_92_r1:
    buffer_load_dwordx4 v[44:47], v3, s[12:15], s9 offen sc1
    buffer_load_dwordx4 v[48:51], v3, s[12:15], s10 offen sc1
    buffer_load_dwordx4 v[52:55], v3, s[12:15], s11 offen sc1
    s_add_u32 s70, s70, 1
    s_cmp_ge_u32 s70, 0x100000
    s_cbranch_scc1 L_c_done_1
    s_waitcnt vmcnt(2)
    ds_write_b128 v3, v[44:47] offset:1024
    v_max3_u32 v22, v44, v45, v46
    v_max_u32 v22, v22, v47
    v_cmp_eq_u32 vcc, -1, v22
    s_waitcnt lgkmcnt(0)
    s_nop 0
    s_cbranch_vccnz L_mg_92_r1
    s_branch L_mg_92_c1
L_mg_92_r2:
    buffer_load_dwordx4 v[48:51], v3, s[12:15], s10 offen sc1
    buffer_load_dwordx4 v[52:55], v3, s[12:15], s11 offen sc1
    s_add_u32 s70, s70, 1
    s_cmp_ge_u32 s70, 0x100000
    s_cbranch_scc1 L_c_done_1
    s_waitcnt vmcnt(1)
    ds_write_b128 v3, v[48:51] offset:2048
    v_max3_u32 v22, v48, v49, v50
    v_max_u32 v22, v22, v51
    v_cmp_eq_u32 vcc, -1, v22
    s_waitcnt lgkmcnt(0)
    s_nop 0
    s_cbranch_vccnz L_mg_92_r2
    s_branch L_mg_92_c2
L_mg_92_r3:
    buffer_load_dwordx4 v[52:55], v3, s[12:15], s11 offen sc1
    s_add_u32 s70, s70, 1
    s_cmp_ge_u32 s70, 0x100000
    s_cbranch_scc1 L_c_done_1
    s_waitcnt vmcnt(0)
    ds_write_b128 v3, v[52:55] offset:3072
    v_max3_u32 v22, v52, v53, v54
    v_max_u32 v22, v22, v55
    v_cmp_eq_u32 vcc, -1, v22
    s_waitcnt lgkmcnt(0)
    s_nop 0
    s_cbranch_vccnz L_mg_92_r3
    s_branch L_mg_92_c3
L_v_xp_97_r:
    buffer_load_dwordx2 v[40:41], v11, s[12:15], s49 offen sc1
    s_add_u32 s70, s70, 1
    s_cmp_lt_u32 s70, 0x100000
    s_cbranch_scc1 L_v_xp_97
    s_endpgm
L_worker_3:
    s_lshr_b32 s41, s2, 3
    s_and_b32 s42, s40, 1
    s_lshr_b32 s43, s40, 1
    s_lshl_b32 s39, s43, 5
    s_add_u32 s39, s39, s41
    s_load_dwordx2 s[4:5], s[0:1], 0
    s_waitcnt lgkmcnt(0)
    s_mov_b32 s28, s4
    s_and_b32 s29, s5, 0xffff
    s_mov_b32 s30, 0x400000
    s_mov_b32 s31, 0x00020000
    v_lshrrev_b32 v2, 4, v1
    v_and_b32 v4, 15, v1
    v_lshrrev_b32 v3, 1, v4
    v_xor_b32 v3, v3, v2
    v_lshlrev_b32 v3, 4, v3
    v_lshlrev_b32 v6, 7, v4
    v_add_u32 v3, v3, v6
    v_mul_u32_u24 v7, 144, v4
    v_lshlrev_b32 v6, 4, v2
    s_mul_i32 s45, s44, 4608
    s_add_u32 s45, s45, 131072
    v_add3_u32 v7, v7, v6, s45
    v_lshrrev_b32 v9, 3, v1
    v_mul_u32_u24 v8, 144, v9
    v_and_b32 v6, 7, v1
    v_lshlrev_b32 v6, 4, v6
    v_add3_u32 v8, v8, v6, s45
    v_lshlrev_b32 v11, 12, v9
    v_add_u32 v11, v11, v6
    v_lshlrev_b32 v2, 13, v2
    v_lshlrev_b32 v6, 4, v4
    v_add_u32 v2, v2, v6
    v_lshrrev_b32 v6, 3, v1
    v_lshrrev_b32 v9, 4, v1
    v_and_b32 v4, 7, v1
    v_xor_b32 v9, v9, v4
    v_lshlrev_b32 v9, 4, v9
    v_lshlrev_b32 v6, 8, v6
    v_add_u32 v6, v6, v9
    v_xor_b32 v9, 64, v6
    v_add_u32 v9, 2048, v9
    v_lshlrev_b32 v10, 4, v1
    v_lshlrev_b32 v12, 2, v1
    v_lshlrev_b32 v5, 7, v1
    s_lshl_b32 s61, s41, 7
    s_lshl_b32 s45, s43, 2
    s_add_u32 s61, s61, s45
    s_add_u32 s61, s61, 0x10010
    s_mul_i32 s64, s42, 24576
    s_add_u32 s64, s64, 0x12000
    s_lshl_b32 s45, s41, 7
    s_add_u32 s65, s64, s45
    s_lshl_b32 s45, s43, 13
    s_add_u32 s65, s65, s45
    s_add_u32 s67, s65, 4096
    s_cmp_lg_u32 s42, 0
    s_cbranch_scc1 L_w_kv_99
    v_mov_b32 v30, 0
    v_mov_b32 v31, 0
    v_mov_b32 v29, 24576
    s_mov_b64 exec, 1
    buffer_store_dword v30, v31, s[12:15], s65 offen sc1
    buffer_store_dword v30, v31, s[12:15], s67 offen sc1
    buffer_store_dword v30, v29, s[12:15], s65 offen sc1
    buffer_store_dword v30, v29, s[12:15], s67 offen sc1
    s_mov_b64 exec, -1
    s_lshl_b32 s63, s39, 2
    s_add_u32 s63, s63, s44
    s_load_dwordx2 s[4:5], s[0:1], 96
    s_load_dwordx2 s[6:7], s[0:1], 104
    v_and_b32 v14, 7, v0
    v_lshrrev_b32 v15, 3, v0
    s_waitcnt lgkmcnt(0)
    s_mov_b32 s32, s4
    s_and_b32 s33, s5, 0xffff
    s_mov_b32 s34, 0x800
    s_mov_b32 s35, 0x00020000
    s_mov_b32 s24, s6
    s_and_b32 s25, s7, 0xffff
    s_mov_b32 s26, 0xc00000
    s_mov_b32 s27, 0x00020000
    s_and_b32 s47, s39, 1
    s_lshl_b32 s45, s47, 10
    v_lshlrev_b32 v16, 5, v15
    buffer_load_dwordx4 v[104:107], v16, s[32:35], s45 offen
    buffer_load_dwordx4 v[108:111], v16, s[32:35], s45 offen offset:16
    s_mov_b32 s45, 196608
    v_mul_lo_u32 v17, v15, s45
    v_lshlrev_b32 v18, 4, v14
    v_add_u32 v17, v17, v18
    s_lshr_b32 s46, s39, 1
    s_lshl_b32 s46, s46, 7
    s_mul_i32 s45, s47, 6291456
    s_add_u32 s46, s46, s45
    buffer_load_dwordx4 v[32:35], v17, s[24:27], s46 offen
    v_add_u32 v17, 12288, v17
    buffer_load_dwordx4 v[36:39], v17, s[24:27], s46 offen
    v_add_u32 v17, 12288, v17
    buffer_load_dwordx4 v[40:43], v17, s[24:27], s46 offen
    v_add_u32 v17, 12288, v17
    buffer_load_dwordx4 v[44:47], v17, s[24:27], s46 offen
    v_add_u32 v17, 12288, v17
    buffer_load_dwordx4 v[48:51], v17, s[24:27], s46 offen
    v_add_u32 v17, 12288, v17
    buffer_load_dwordx4 v[52:55], v17, s[24:27], s46 offen
    v_add_u32 v17, 12288, v17
    buffer_load_dwordx4 v[56:59], v17, s[24:27], s46 offen
    v_add_u32 v17, 12288, v17
    buffer_load_dwordx4 v[60:63], v17, s[24:27], s46 offen
    v_add_u32 v17, 12288, v17
    buffer_load_dwordx4 v[64:67], v17, s[24:27], s46 offen
    v_add_u32 v17, 12288, v17
    buffer_load_dwordx4 v[68:71], v17, s[24:27], s46 offen
    v_add_u32 v17, 12288, v17
    buffer_load_dwordx4 v[72:75], v17, s[24:27], s46 offen
    v_add_u32 v17, 12288, v17
    buffer_load_dwordx4 v[76:79], v17, s[24:27], s46 offen
    v_add_u32 v17, 12288, v17
    buffer_load_dwordx4 v[80:83], v17, s[24:27], s46 offen
    v_add_u32 v17, 12288, v17
    buffer_load_dwordx4 v[84:87], v17, s[24:27], s46 offen
    v_add_u32 v17, 12288, v17
    buffer_load_dwordx4 v[88:91], v17, s[24:27], s46 offen
    v_add_u32 v17, 12288, v17
    buffer_load_dwordx4 v[92:95], v17, s[24:27], s46 offen
    s_add_u32 s45, s63, 0
    s_lshl_b32 s45, s45, 11
    buffer_load_dwordx4 v[128:131], v10, s[28:31], s45 offen
    buffer_load_dwordx4 v[132:135], v10, s[28:31], s45 offen offset:1024
    s_add_u32 s45, s63, 384
    s_lshl_b32 s45, s45, 11
    buffer_load_dwordx4 v[136:139], v10, s[28:31], s45 offen
    buffer_load_dwordx4 v[140:143], v10, s[28:31], s45 offen offset:1024
    s_add_u32 s45, s63, 768
    s_lshl_b32 s45, s45, 11
    buffer_load_dwordx4 v[144:147], v10, s[28:31], s45 offen
    buffer_load_dwordx4 v[148:151], v10, s[28:31], s45 offen offset:1024
    s_add_u32 s45, s63, 1152
    s_lshl_b32 s45, s45, 11
    buffer_load_dwordx4 v[152:155], v10, s[28:31], s45 offen
    buffer_load_dwordx4 v[156:159], v10, s[28:31], s45 offen offset:1024
    s_add_u32 s45, s63, 1536
    s_lshl_b32 s45, s45, 11
    buffer_load_dwordx4 v[160:163], v10, s[28:31], s45 offen
    buffer_load_dwordx4 v[164:167], v10, s[28:31], s45 offen offset:1024
    s_add_u32 s45, s63, 1920
    s_lshl_b32 s45, s45, 11
    buffer_load_dwordx4 v[168:171], v10, s[28:31], s45 offen
    buffer_load_dwordx4 v[172:175], v10, s[28:31], s45 offen offset:1024
    s_waitcnt vmcnt(28)
    v_lshlrev_b32 v112, 16, v104
    v_and_b32 v113, 0xffff0000, v104
    v_lshlrev_b32 v114, 16, v105
    v_and_b32 v115, 0xffff0000, v105
    v_lshlrev_b32 v116, 16, v106
    v_and_b32 v117, 0xffff0000, v106
    v_lshlrev_b32 v118, 16, v107
    v_and_b32 v119, 0xffff0000, v107
    v_lshlrev_b32 v120, 16, v108
    v_and_b32 v121, 0xffff0000, v108
    v_lshlrev_b32 v122, 16, v109
    v_and_b32 v123, 0xffff0000, v109
    v_lshlrev_b32 v124, 16, v110
    v_and_b32 v125, 0xffff0000, v110
    v_lshlrev_b32 v126, 16, v111
    v_and_b32 v127, 0xffff0000, v111
    v_mul_f32 v18, 0xbfb8aa3b, v112
    v_exp_f32 v18, v18
    s_nop 0
    v_add_f32 v18, 1.0, v18
    v_rcp_f32 v18, v18
    s_nop 0
    v_mul_f32 v112, v112, v18
    v_cvt_pk_bf16_f32 v112, v112, v112
    v_lshlrev_b32 v112, 16, v112
    v_mul_f32 v18, 0xbfb8aa3b, v113
    v_exp_f32 v18, v18
    s_nop 0
    v_add_f32 v18, 1.0, v18
    v_rcp_f32 v18, v18
    s_nop 0
    v_mul_f32 v113, v113, v18
    v_cvt_pk_bf16_f32 v113, v113, v113
    v_lshlrev_b32 v113, 16, v113
    v_mul_f32 v18, 0xbfb8aa3b, v114
    v_exp_f32 v18, v18
    s_nop 0
    v_add_f32 v18, 1.0, v18
    v_rcp_f32 v18, v18
    s_nop 0
    v_mul_f32 v114, v114, v18
    v_cvt_pk_bf16_f32 v114, v114, v114
    v_lshlrev_b32 v114, 16, v114
    v_mul_f32 v18, 0xbfb8aa3b, v115
    v_exp_f32 v18, v18
    s_nop 0
    v_add_f32 v18, 1.0, v18
    v_rcp_f32 v18, v18
    s_nop 0
    v_mul_f32 v115, v115, v18
    v_cvt_pk_bf16_f32 v115, v115, v115
    v_lshlrev_b32 v115, 16, v115
    v_mul_f32 v18, 0xbfb8aa3b, v116
    v_exp_f32 v18, v18
    s_nop 0
    v_add_f32 v18, 1.0, v18
    v_rcp_f32 v18, v18
    s_nop 0
    v_mul_f32 v116, v116, v18
    v_cvt_pk_bf16_f32 v116, v116, v116
    v_lshlrev_b32 v116, 16, v116
    v_mul_f32 v18, 0xbfb8aa3b, v117
    v_exp_f32 v18, v18
    s_nop 0
    v_add_f32 v18, 1.0, v18
    v_rcp_f32 v18, v18
    s_nop 0
    v_mul_f32 v117, v117, v18
    v_cvt_pk_bf16_f32 v117, v117, v117
    v_lshlrev_b32 v117, 16, v117
    v_mul_f32 v18, 0xbfb8aa3b, v118
    v_exp_f32 v18, v18
    s_nop 0
    v_add_f32 v18, 1.0, v18
    v_rcp_f32 v18, v18
    s_nop 0
    v_mul_f32 v118, v118, v18
    v_cvt_pk_bf16_f32 v118, v118, v118
    v_lshlrev_b32 v118, 16, v118
    v_mul_f32 v18, 0xbfb8aa3b, v119
    v_exp_f32 v18, v18
    s_nop 0
    v_add_f32 v18, 1.0, v18
    v_rcp_f32 v18, v18
    s_nop 0
    v_mul_f32 v119, v119, v18
    v_cvt_pk_bf16_f32 v119, v119, v119
    v_lshlrev_b32 v119, 16, v119
    v_mul_f32 v18, 0xbfb8aa3b, v120
    v_exp_f32 v18, v18
    s_nop 0
    v_add_f32 v18, 1.0, v18
    v_rcp_f32 v18, v18
    s_nop 0
    v_mul_f32 v120, v120, v18
    v_cvt_pk_bf16_f32 v120, v120, v120
    v_lshlrev_b32 v120, 16, v120
    v_mul_f32 v18, 0xbfb8aa3b, v121
    v_exp_f32 v18, v18
    s_nop 0
    v_add_f32 v18, 1.0, v18
    v_rcp_f32 v18, v18
    s_nop 0
    v_mul_f32 v121, v121, v18
    v_cvt_pk_bf16_f32 v121, v121, v121
    v_lshlrev_b32 v121, 16, v121
    v_mul_f32 v18, 0xbfb8aa3b, v122
    v_exp_f32 v18, v18
    s_nop 0
    v_add_f32 v18, 1.0, v18
    v_rcp_f32 v18, v18
    s_nop 0
    v_mul_f32 v122, v122, v18
    v_cvt_pk_bf16_f32 v122, v122, v122
    v_lshlrev_b32 v122, 16, v122
    v_mul_f32 v18, 0xbfb8aa3b, v123
    v_exp_f32 v18, v18
    s_nop 0
    v_add_f32 v18, 1.0, v18
    v_rcp_f32 v18, v18
    s_nop 0
    v_mul_f32 v123, v123, v18
    v_cvt_pk_bf16_f32 v123, v123, v123
    v_lshlrev_b32 v123, 16, v123
    v_mul_f32 v18, 0xbfb8aa3b, v124
    v_exp_f32 v18, v18
    s_nop 0
    v_add_f32 v18, 1.0, v18
    v_rcp_f32 v18, v18
    s_nop 0
    v_mul_f32 v124, v124, v18
    v_cvt_pk_bf16_f32 v124, v124, v124
    v_lshlrev_b32 v124, 16, v124
    v_mul_f32 v18, 0xbfb8aa3b, v125
    v_exp_f32 v18, v18
    s_nop 0
    v_add_f32 v18, 1.0, v18
    v_rcp_f32 v18, v18
    s_nop 0
    v_mul_f32 v125, v125, v18
    v_cvt_pk_bf16_f32 v125, v125, v125
    v_lshlrev_b32 v125, 16, v125
    v_mul_f32 v18, 0xbfb8aa3b, v126
    v_exp_f32 v18, v18
    s_nop 0
    v_add_f32 v18, 1.0, v18
    v_rcp_f32 v18, v18
    s_nop 0
    v_mul_f32 v126, v126, v18
    v_cvt_pk_bf16_f32 v126, v126, v126
    v_lshlrev_b32 v126, 16, v126
    v_mul_f32 v18, 0xbfb8aa3b, v127
    v_exp_f32 v18, v18
    s_nop 0
    v_add_f32 v18, 1.0, v18
    v_rcp_f32 v18, v18
    s_nop 0
    v_mul_f32 v127, v127, v18
    v_cvt_pk_bf16_f32 v127, v127, v127
    v_lshlrev_b32 v127, 16, v127
    v_mov_b32 v96, 0
    v_mov_b32 v97, 0
    v_mov_b32 v98, 0
    v_mov_b32 v99, 0
    v_mov_b32 v100, 0
    v_mov_b32 v101, 0
    v_mov_b32 v102, 0
    v_mov_b32 v103, 0
    s_waitcnt vmcnt(27)
    v_lshlrev_b32 v18, 16, v32
    v_and_b32 v19, 0xffff0000, v32
    v_fmac_f32 v96, v18, v112
    v_fmac_f32 v97, v19, v112
    v_lshlrev_b32 v18, 16, v33
    v_and_b32 v19, 0xffff0000, v33
    v_fmac_f32 v98, v18, v112
    v_fmac_f32 v99, v19, v112
    v_lshlrev_b32 v18, 16, v34
    v_and_b32 v19, 0xffff0000, v34
    v_fmac_f32 v100, v18, v112
    v_fmac_f32 v101, v19, v112
    v_lshlrev_b32 v18, 16, v35
    v_and_b32 v19, 0xffff0000, v35
    v_fmac_f32 v102, v18, v112
    v_fmac_f32 v103, v19, v112
    s_waitcnt vmcnt(26)
    v_lshlrev_b32 v18, 16, v36
    v_and_b32 v19, 0xffff0000, v36
    v_fmac_f32 v96, v18, v113
    v_fmac_f32 v97, v19, v113
    v_lshlrev_b32 v18, 16, v37
    v_and_b32 v19, 0xffff0000, v37
    v_fmac_f32 v98, v18, v113
    v_fmac_f32 v99, v19, v113
    v_lshlrev_b32 v18, 16, v38
    v_and_b32 v19, 0xffff0000, v38
    v_fmac_f32 v100, v18, v113
    v_fmac_f32 v101, v19, v113
    v_lshlrev_b32 v18, 16, v39
    v_and_b32 v19, 0xffff0000, v39
    v_fmac_f32 v102, v18, v113
    v_fmac_f32 v103, v19, v113
    s_waitcnt vmcnt(25)
    v_lshlrev_b32 v18, 16, v40
    v_and_b32 v19, 0xffff0000, v40
    v_fmac_f32 v96, v18, v114
    v_fmac_f32 v97, v19, v114
    v_lshlrev_b32 v18, 16, v41
    v_and_b32 v19, 0xffff0000, v41
    v_fmac_f32 v98, v18, v114
    v_fmac_f32 v99, v19, v114
    v_lshlrev_b32 v18, 16, v42
    v_and_b32 v19, 0xffff0000, v42
    v_fmac_f32 v100, v18, v114
    v_fmac_f32 v101, v19, v114
    v_lshlrev_b32 v18, 16, v43
    v_and_b32 v19, 0xffff0000, v43
    v_fmac_f32 v102, v18, v114
    v_fmac_f32 v103, v19, v114
    s_waitcnt vmcnt(24)
    v_lshlrev_b32 v18, 16, v44
    v_and_b32 v19, 0xffff0000, v44
    v_fmac_f32 v96, v18, v115
    v_fmac_f32 v97, v19, v115
    v_lshlrev_b32 v18, 16, v45
    v_and_b32 v19, 0xffff0000, v45
    v_fmac_f32 v98, v18, v115
    v_fmac_f32 v99, v19, v115
    v_lshlrev_b32 v18, 16, v46
    v_and_b32 v19, 0xffff0000, v46
    v_fmac_f32 v100, v18, v115
    v_fmac_f32 v101, v19, v115
    v_lshlrev_b32 v18, 16, v47
    v_and_b32 v19, 0xffff0000, v47
    v_fmac_f32 v102, v18, v115
    v_fmac_f32 v103, v19, v115
    s_waitcnt vmcnt(23)
    v_lshlrev_b32 v18, 16, v48
    v_and_b32 v19, 0xffff0000, v48
    v_fmac_f32 v96, v18, v116
    v_fmac_f32 v97, v19, v116
    v_lshlrev_b32 v18, 16, v49
    v_and_b32 v19, 0xffff0000, v49
    v_fmac_f32 v98, v18, v116
    v_fmac_f32 v99, v19, v116
    v_lshlrev_b32 v18, 16, v50
    v_and_b32 v19, 0xffff0000, v50
    v_fmac_f32 v100, v18, v116
    v_fmac_f32 v101, v19, v116
    v_lshlrev_b32 v18, 16, v51
    v_and_b32 v19, 0xffff0000, v51
    v_fmac_f32 v102, v18, v116
    v_fmac_f32 v103, v19, v116
    s_waitcnt vmcnt(22)
    v_lshlrev_b32 v18, 16, v52
    v_and_b32 v19, 0xffff0000, v52
    v_fmac_f32 v96, v18, v117
    v_fmac_f32 v97, v19, v117
    v_lshlrev_b32 v18, 16, v53
    v_and_b32 v19, 0xffff0000, v53
    v_fmac_f32 v98, v18, v117
    v_fmac_f32 v99, v19, v117
    v_lshlrev_b32 v18, 16, v54
    v_and_b32 v19, 0xffff0000, v54
    v_fmac_f32 v100, v18, v117
    v_fmac_f32 v101, v19, v117
    v_lshlrev_b32 v18, 16, v55
    v_and_b32 v19, 0xffff0000, v55
    v_fmac_f32 v102, v18, v117
    v_fmac_f32 v103, v19, v117
    s_waitcnt vmcnt(21)
    v_lshlrev_b32 v18, 16, v56
    v_and_b32 v19, 0xffff0000, v56
    v_fmac_f32 v96, v18, v118
    v_fmac_f32 v97, v19, v118
    v_lshlrev_b32 v18, 16, v57
    v_and_b32 v19, 0xffff0000, v57
    v_fmac_f32 v98, v18, v118
    v_fmac_f32 v99, v19, v118
    v_lshlrev_b32 v18, 16, v58
    v_and_b32 v19, 0xffff0000, v58
    v_fmac_f32 v100, v18, v118
    v_fmac_f32 v101, v19, v118
    v_lshlrev_b32 v18, 16, v59
    v_and_b32 v19, 0xffff0000, v59
    v_fmac_f32 v102, v18, v118
    v_fmac_f32 v103, v19, v118
    s_waitcnt vmcnt(20)
    v_lshlrev_b32 v18, 16, v60
    v_and_b32 v19, 0xffff0000, v60
    v_fmac_f32 v96, v18, v119
    v_fmac_f32 v97, v19, v119
    v_lshlrev_b32 v18, 16, v61
    v_and_b32 v19, 0xffff0000, v61
    v_fmac_f32 v98, v18, v119
    v_fmac_f32 v99, v19, v119
    v_lshlrev_b32 v18, 16, v62
    v_and_b32 v19, 0xffff0000, v62
    v_fmac_f32 v100, v18, v119
    v_fmac_f32 v101, v19, v119
    v_lshlrev_b32 v18, 16, v63
    v_and_b32 v19, 0xffff0000, v63
    v_fmac_f32 v102, v18, v119
    v_fmac_f32 v103, v19, v119
    s_waitcnt vmcnt(19)
    v_lshlrev_b32 v18, 16, v64
    v_and_b32 v19, 0xffff0000, v64
    v_fmac_f32 v96, v18, v120
    v_fmac_f32 v97, v19, v120
    v_lshlrev_b32 v18, 16, v65
    v_and_b32 v19, 0xffff0000, v65
    v_fmac_f32 v98, v18, v120
    v_fmac_f32 v99, v19, v120
    v_lshlrev_b32 v18, 16, v66
    v_and_b32 v19, 0xffff0000, v66
    v_fmac_f32 v100, v18, v120
    v_fmac_f32 v101, v19, v120
    v_lshlrev_b32 v18, 16, v67
    v_and_b32 v19, 0xffff0000, v67
    v_fmac_f32 v102, v18, v120
    v_fmac_f32 v103, v19, v120
    s_waitcnt vmcnt(18)
    v_lshlrev_b32 v18, 16, v68
    v_and_b32 v19, 0xffff0000, v68
    v_fmac_f32 v96, v18, v121
    v_fmac_f32 v97, v19, v121
    v_lshlrev_b32 v18, 16, v69
    v_and_b32 v19, 0xffff0000, v69
    v_fmac_f32 v98, v18, v121
    v_fmac_f32 v99, v19, v121
    v_lshlrev_b32 v18, 16, v70
    v_and_b32 v19, 0xffff0000, v70
    v_fmac_f32 v100, v18, v121
    v_fmac_f32 v101, v19, v121
    v_lshlrev_b32 v18, 16, v71
    v_and_b32 v19, 0xffff0000, v71
    v_fmac_f32 v102, v18, v121
    v_fmac_f32 v103, v19, v121
    s_waitcnt vmcnt(17)
    v_lshlrev_b32 v18, 16, v72
    v_and_b32 v19, 0xffff0000, v72
    v_fmac_f32 v96, v18, v122
    v_fmac_f32 v97, v19, v122
    v_lshlrev_b32 v18, 16, v73
    v_and_b32 v19, 0xffff0000, v73
    v_fmac_f32 v98, v18, v122
    v_fmac_f32 v99, v19, v122
    v_lshlrev_b32 v18, 16, v74
    v_and_b32 v19, 0xffff0000, v74
    v_fmac_f32 v100, v18, v122
    v_fmac_f32 v101, v19, v122
    v_lshlrev_b32 v18, 16, v75
    v_and_b32 v19, 0xffff0000, v75
    v_fmac_f32 v102, v18, v122
    v_fmac_f32 v103, v19, v122
    s_waitcnt vmcnt(16)
    v_lshlrev_b32 v18, 16, v76
    v_and_b32 v19, 0xffff0000, v76
    v_fmac_f32 v96, v18, v123
    v_fmac_f32 v97, v19, v123
    v_lshlrev_b32 v18, 16, v77
    v_and_b32 v19, 0xffff0000, v77
    v_fmac_f32 v98, v18, v123
    v_fmac_f32 v99, v19, v123
    v_lshlrev_b32 v18, 16, v78
    v_and_b32 v19, 0xffff0000, v78
    v_fmac_f32 v100, v18, v123
    v_fmac_f32 v101, v19, v123
    v_lshlrev_b32 v18, 16, v79
    v_and_b32 v19, 0xffff0000, v79
    v_fmac_f32 v102, v18, v123
    v_fmac_f32 v103, v19, v123
    s_waitcnt vmcnt(15)
    v_lshlrev_b32 v18, 16, v80
    v_and_b32 v19, 0xffff0000, v80
    v_fmac_f32 v96, v18, v124
    v_fmac_f32 v97, v19, v124
    v_lshlrev_b32 v18, 16, v81
    v_and_b32 v19, 0xffff0000, v81
    v_fmac_f32 v98, v18, v124
    v_fmac_f32 v99, v19, v124
    v_lshlrev_b32 v18, 16, v82
    v_and_b32 v19, 0xffff0000, v82
    v_fmac_f32 v100, v18, v124
    v_fmac_f32 v101, v19, v124
    v_lshlrev_b32 v18, 16, v83
    v_and_b32 v19, 0xffff0000, v83
    v_fmac_f32 v102, v18, v124
    v_fmac_f32 v103, v19, v124
    s_waitcnt vmcnt(14)
    v_lshlrev_b32 v18, 16, v84
    v_and_b32 v19, 0xffff0000, v84
    v_fmac_f32 v96, v18, v125
    v_fmac_f32 v97, v19, v125
    v_lshlrev_b32 v18, 16, v85
    v_and_b32 v19, 0xffff0000, v85
    v_fmac_f32 v98, v18, v125
    v_fmac_f32 v99, v19, v125
    v_lshlrev_b32 v18, 16, v86
    v_and_b32 v19, 0xffff0000, v86
    v_fmac_f32 v100, v18, v125
    v_fmac_f32 v101, v19, v125
    v_lshlrev_b32 v18, 16, v87
    v_and_b32 v19, 0xffff0000, v87
    v_fmac_f32 v102, v18, v125
    v_fmac_f32 v103, v19, v125
    s_waitcnt vmcnt(13)
    v_lshlrev_b32 v18, 16, v88
    v_and_b32 v19, 0xffff0000, v88
    v_fmac_f32 v96, v18, v126
    v_fmac_f32 v97, v19, v126
    v_lshlrev_b32 v18, 16, v89
    v_and_b32 v19, 0xffff0000, v89
    v_fmac_f32 v98, v18, v126
    v_fmac_f32 v99, v19, v126
    v_lshlrev_b32 v18, 16, v90
    v_and_b32 v19, 0xffff0000, v90
    v_fmac_f32 v100, v18, v126
    v_fmac_f32 v101, v19, v126
    v_lshlrev_b32 v18, 16, v91
    v_and_b32 v19, 0xffff0000, v91
    v_fmac_f32 v102, v18, v126
    v_fmac_f32 v103, v19, v126
    s_waitcnt vmcnt(12)
    v_lshlrev_b32 v18, 16, v92
    v_and_b32 v19, 0xffff0000, v92
    v_fmac_f32 v96, v18, v127
    v_fmac_f32 v97, v19, v127
    v_lshlrev_b32 v18, 16, v93
    v_and_b32 v19, 0xffff0000, v93
    v_fmac_f32 v98, v18, v127
    v_fmac_f32 v99, v19, v127
    v_lshlrev_b32 v18, 16, v94
    v_and_b32 v19, 0xffff0000, v94
    v_fmac_f32 v100, v18, v127
    v_fmac_f32 v101, v19, v127
    v_lshlrev_b32 v18, 16, v95
    v_and_b32 v19, 0xffff0000, v95
    v_fmac_f32 v102, v18, v127
    v_fmac_f32 v103, v19, v127
    v_lshlrev_b32 v16, 5, v0
    ds_write_b128 v16, v[96:99]
    ds_write_b128 v16, v[100:103] offset:16
    s_waitcnt lgkmcnt(0)
    s_barrier
    s_cmp_lg_u32 s44, 0
    s_cbranch_scc1 L_mod_fin_101
    v_mov_b32 v18, 0
    ds_read_b32 v32, v12 offset:0
    ds_read_b32 v33, v12 offset:256
    ds_read_b32 v34, v12 offset:512
    ds_read_b32 v35, v12 offset:768
    ds_read_b32 v36, v12 offset:1024
    ds_read_b32 v37, v12 offset:1280
    ds_read_b32 v38, v12 offset:1536
    ds_read_b32 v39, v12 offset:1792
    ds_read_b32 v40, v12 offset:2048
    ds_read_b32 v41, v12 offset:2304
    ds_read_b32 v42, v12 offset:2560
    ds_read_b32 v43, v12 offset:2816
    ds_read_b32 v44, v12 offset:3072
    ds_read_b32 v45, v12 offset:3328
    ds_read_b32 v46, v12 offset:3584
    ds_read_b32 v47, v12 offset:3840
    s_waitcnt lgkmcnt(0)
    v_add_f32 v18, v18, v32
    v_add_f32 v18, v18, v33
    v_add_f32 v18, v18, v34
    v_add_f32 v18, v18, v35
    v_add_f32 v18, v18, v36
    v_add_f32 v18, v18, v37
    v_add_f32 v18, v18, v38
    v_add_f32 v18, v18, v39
    v_add_f32 v18, v18, v40
    v_add_f32 v18, v18, v41
    v_add_f32 v18, v18, v42
    v_add_f32 v18, v18, v43
    v_add_f32 v18, v18, v44
    v_add_f32 v18, v18, v45
    v_add_f32 v18, v18, v46
    v_add_f32 v18, v18, v47
    ds_read_b32 v32, v12 offset:4096
    ds_read_b32 v33, v12 offset:4352
    ds_read_b32 v34, v12 offset:4608
    ds_read_b32 v35, v12 offset:4864
    ds_read_b32 v36, v12 offset:5120
    ds_read_b32 v37, v12 offset:5376
    ds_read_b32 v38, v12 offset:5632
    ds_read_b32 v39, v12 offset:5888
    ds_read_b32 v40, v12 offset:6144
    ds_read_b32 v41, v12 offset:6400
    ds_read_b32 v42, v12 offset:6656
    ds_read_b32 v43, v12 offset:6912
    ds_read_b32 v44, v12 offset:7168
    ds_read_b32 v45, v12 offset:7424
    ds_read_b32 v46, v12 offset:7680
    ds_read_b32 v47, v12 offset:7936
    s_waitcnt lgkmcnt(0)
    v_add_f32 v18, v18, v32
    v_add_f32 v18, v18, v33
    v_add_f32 v18, v18, v34
    v_add_f32 v18, v18, v35
    v_add_f32 v18, v18, v36
    v_add_f32 v18, v18, v37
    v_add_f32 v18, v18, v38
    v_add_f32 v18, v18, v39
    v_add_f32 v18, v18, v40
    v_add_f32 v18, v18, v41
    v_add_f32 v18, v18, v42
    v_add_f32 v18, v18, v43
    v_add_f32 v18, v18, v44
    v_add_f32 v18, v18, v45
    v_add_f32 v18, v18, v46
    v_add_f32 v18, v18, v47
    s_lshr_b32 s45, s39, 1
    s_lshl_b32 s45, s45, 8
    s_mul_i32 s46, s47, 24576
    s_add_u32 s45, s45, s46
    buffer_store_dword v18, v12, s[12:15], s45 offen sc1
L_mod_fin_101:
    s_waitcnt vmcnt(0)
    s_barrier
    s_cmp_lg_u32 s44, 0
    s_cbranch_scc1 L_cnt_102
    v_mov_b32 v30, 1
    v_mov_b32 v31, 128
    s_mov_b64 exec, 1
    buffer_atomic_add v30, v31, s[16:19], 0 offen sc1
    s_mov_b64 exec, -1
L_cnt_102:
    v_lshlrev_b32 v192, 16, v128
    v_and_b32 v193, 0xffff0000, v128
    v_lshlrev_b32 v194, 16, v129
    v_and_b32 v195, 0xffff0000, v129
    v_lshlrev_b32 v196, 16, v130
    v_and_b32 v197, 0xffff0000, v130
    v_lshlrev_b32 v198, 16, v131
    v_and_b32 v199, 0xffff0000, v131
    v_lshlrev_b32 v200, 16, v132
    v_and_b32 v201, 0xffff0000, v132
    v_lshlrev_b32 v202, 16, v133
    v_and_b32 v203, 0xffff0000, v133
    v_lshlrev_b32 v204, 16, v134
    v_and_b32 v205, 0xffff0000, v134
    v_lshlrev_b32 v206, 16, v135
    v_and_b32 v207, 0xffff0000, v135
    v_add_f32 v26, v192, v193
    v_add_f32 v26, v26, v194
    v_add_f32 v26, v26, v195
    v_add_f32 v26, v26, v196
    v_add_f32 v26, v26, v197
    v_add_f32 v26, v26, v198
    v_add_f32 v26, v26, v199
    v_add_f32 v26, v26, v200
    v_add_f32 v26, v26, v201
    v_add_f32 v26, v26, v202
    v_add_f32 v26, v26, v203
    v_add_f32 v26, v26, v204
    v_add_f32 v26, v26, v205
    v_add_f32 v26, v26, v206
    v_add_f32 v26, v26, v207
    s_nop 1
    v_add_f32_dpp v26, v26, v26 row_shr:1 row_mask:0xf bank_mask:0xf bound_ctrl:0
    s_nop 1
    v_add_f32_dpp v26, v26, v26 row_shr:2 row_mask:0xf bank_mask:0xf bound_ctrl:0
    s_nop 1
    v_add_f32_dpp v26, v26, v26 row_shr:4 row_mask:0xf bank_mask:0xf bound_ctrl:0
    s_nop 1
    v_add_f32_dpp v26, v26, v26 row_shr:8 row_mask:0xf bank_mask:0xf bound_ctrl:0
    s_nop 1
    v_add_f32_dpp v26, v26, v26 row_bcast:15 row_mask:0xa bank_mask:0xf
    s_nop 1
    v_add_f32_dpp v26, v26, v26 row_bcast:31 row_mask:0xc bank_mask:0xf
    s_nop 1
    v_readlane_b32 s66, v26, 63
    s_nop 1
    v_mov_b32 v27, s66
    v_mul_f32 v27, 0x3a800000, v27
    v_mov_b32 v26, 0
    v_sub_f32 v28, v192, v27
    v_fmac_f32 v26, v28, v28
    v_sub_f32 v28, v193, v27
    v_fmac_f32 v26, v28, v28
    v_sub_f32 v28, v194, v27
    v_fmac_f32 v26, v28, v28
    v_sub_f32 v28, v195, v27
    v_fmac_f32 v26, v28, v28
    v_sub_f32 v28, v196, v27
    v_fmac_f32 v26, v28, v28
    v_sub_f32 v28, v197, v27
    v_fmac_f32 v26, v28, v28
    v_sub_f32 v28, v198, v27
    v_fmac_f32 v26, v28, v28
    v_sub_f32 v28, v199, v27
    v_fmac_f32 v26, v28, v28
    v_sub_f32 v28, v200, v27
    v_fmac_f32 v26, v28, v28
    v_sub_f32 v28, v201, v27
    v_fmac_f32 v26, v28, v28
    v_sub_f32 v28, v202, v27
    v_fmac_f32 v26, v28, v28
    v_sub_f32 v28, v203, v27
    v_fmac_f32 v26, v28, v28
    v_sub_f32 v28, v204, v27
    v_fmac_f32 v26, v28, v28
    v_sub_f32 v28, v205, v27
    v_fmac_f32 v26, v28, v28
    v_sub_f32 v28, v206, v27
    v_fmac_f32 v26, v28, v28
    v_sub_f32 v28, v207, v27
    v_fmac_f32 v26, v28, v28
    s_nop 1
    v_add_f32_dpp v26, v26, v26 row_shr:1 row_mask:0xf bank_mask:0xf bound_ctrl:0
    s_nop 1
    v_add_f32_dpp v26, v26, v26 row_shr:2 row_mask:0xf bank_mask:0xf bound_ctrl:0
    s_nop 1
    v_add_f32_dpp v26, v26, v26 row_shr:4 row_mask:0xf bank_mask:0xf bound_ctrl:0
    s_nop 1
    v_add_f32_dpp v26, v26, v26 row_shr:8 row_mask:0xf bank_mask:0xf bound_ctrl:0
    s_nop 1
    v_add_f32_dpp v26, v26, v26 row_bcast:15 row_mask:0xa bank_mask:0xf
    s_nop 1
    v_add_f32_dpp v26, v26, v26 row_bcast:31 row_mask:0xc bank_mask:0xf
    s_nop 1
    v_readlane_b32 s66, v26, 63
    s_nop 1
    v_mov_b32 v26, s66
    v_mul_f32 v26, 0x3a800000, v26
    v_cvt_pk_bf16_f32 v26, v26, v26
    v_lshlrev_b32 v26, 16, v26
    v_cvt_pk_bf16_f32 v27, v27, v27
    v_lshlrev_b32 v27, 16, v27
    v_add_f32 v26, 0x3727c5ac, v26
    v_cvt_pk_bf16_f32 v26, v26, v26
    v_lshlrev_b32 v26, 16, v26
    v_sqrt_f32 v26, v26
    s_nop 0
    v_cvt_pk_bf16_f32 v26, v26, v26
    v_lshlrev_b32 v26, 16, v26
    v_rcp_f32 v26, v26
    s_nop 0
    v_sub_f32 v192, v192, v27
    v_cvt_pk_bf16_f32 v192, v192, v192
    v_lshlrev_b32 v192, 16, v192
    v_mul_f32 v192, v192, v26
    v_cvt_pk_bf16_f32 v192, v192, v192
    v_lshlrev_b32 v192, 16, v192
    v_sub_f32 v193, v193, v27
    v_cvt_pk_bf16_f32 v193, v193, v193
    v_lshlrev_b32 v193, 16, v193
    v_mul_f32 v193, v193, v26
    v_cvt_pk_bf16_f32 v193, v193, v193
    v_lshlrev_b32 v193, 16, v193
    v_sub_f32 v194, v194, v27
    v_cvt_pk_bf16_f32 v194, v194, v194
    v_lshlrev_b32 v194, 16, v194
    v_mul_f32 v194, v194, v26
    v_cvt_pk_bf16_f32 v194, v194, v194
    v_lshlrev_b32 v194, 16, v194
    v_sub_f32 v195, v195, v27
    v_cvt_pk_bf16_f32 v195, v195, v195
    v_lshlrev_b32 v195, 16, v195
    v_mul_f32 v195, v195, v26
    v_cvt_pk_bf16_f32 v195, v195, v195
    v_lshlrev_b32 v195, 16, v195
    v_sub_f32 v196, v196, v27
    v_cvt_pk_bf16_f32 v196, v196, v196
    v_lshlrev_b32 v196, 16, v196
    v_mul_f32 v196, v196, v26
    v_cvt_pk_bf16_f32 v196, v196, v196
    v_lshlrev_b32 v196, 16, v196
    v_sub_f32 v197, v197, v27
    v_cvt_pk_bf16_f32 v197, v197, v197
    v_lshlrev_b32 v197, 16, v197
    v_mul_f32 v197, v197, v26
    v_cvt_pk_bf16_f32 v197, v197, v197
    v_lshlrev_b32 v197, 16, v197
    v_sub_f32 v198, v198, v27
    v_cvt_pk_bf16_f32 v198, v198, v198
    v_lshlrev_b32 v198, 16, v198
    v_mul_f32 v198, v198, v26
    v_cvt_pk_bf16_f32 v198, v198, v198
    v_lshlrev_b32 v198, 16, v198
    v_sub_f32 v199, v199, v27
    v_cvt_pk_bf16_f32 v199, v199, v199
    v_lshlrev_b32 v199, 16, v199
    v_mul_f32 v199, v199, v26
    v_cvt_pk_bf16_f32 v199, v199, v199
    v_lshlrev_b32 v199, 16, v199
    v_sub_f32 v200, v200, v27
    v_cvt_pk_bf16_f32 v200, v200, v200
    v_lshlrev_b32 v200, 16, v200
    v_mul_f32 v200, v200, v26
    v_cvt_pk_bf16_f32 v200, v200, v200
    v_lshlrev_b32 v200, 16, v200
    v_sub_f32 v201, v201, v27
    v_cvt_pk_bf16_f32 v201, v201, v201
    v_lshlrev_b32 v201, 16, v201
    v_mul_f32 v201, v201, v26
    v_cvt_pk_bf16_f32 v201, v201, v201
    v_lshlrev_b32 v201, 16, v201
    v_sub_f32 v202, v202, v27
    v_cvt_pk_bf16_f32 v202, v202, v202
    v_lshlrev_b32 v202, 16, v202
    v_mul_f32 v202, v202, v26
    v_cvt_pk_bf16_f32 v202, v202, v202
    v_lshlrev_b32 v202, 16, v202
    v_sub_f32 v203, v203, v27
    v_cvt_pk_bf16_f32 v203, v203, v203
    v_lshlrev_b32 v203, 16, v203
    v_mul_f32 v203, v203, v26
    v_cvt_pk_bf16_f32 v203, v203, v203
    v_lshlrev_b32 v203, 16, v203
    v_sub_f32 v204, v204, v27
    v_cvt_pk_bf16_f32 v204, v204, v204
    v_lshlrev_b32 v204, 16, v204
    v_mul_f32 v204, v204, v26
    v_cvt_pk_bf16_f32 v204, v204, v204
    v_lshlrev_b32 v204, 16, v204
    v_sub_f32 v205, v205, v27
    v_cvt_pk_bf16_f32 v205, v205, v205
    v_lshlrev_b32 v205, 16, v205
    v_mul_f32 v205, v205, v26
    v_cvt_pk_bf16_f32 v205, v205, v205
    v_lshlrev_b32 v205, 16, v205
    v_sub_f32 v206, v206, v27
    v_cvt_pk_bf16_f32 v206, v206, v206
    v_lshlrev_b32 v206, 16, v206
    v_mul_f32 v206, v206, v26
    v_cvt_pk_bf16_f32 v206, v206, v206
    v_lshlrev_b32 v206, 16, v206
    v_sub_f32 v207, v207, v27
    v_cvt_pk_bf16_f32 v207, v207, v207
    v_lshlrev_b32 v207, 16, v207
    v_mul_f32 v207, v207, v26
    v_cvt_pk_bf16_f32 v207, v207, v207
    v_lshlrev_b32 v207, 16, v207
    v_lshlrev_b32 v208, 16, v136
    v_and_b32 v209, 0xffff0000, v136
    v_lshlrev_b32 v210, 16, v137
    v_and_b32 v211, 0xffff0000, v137
    v_lshlrev_b32 v212, 16, v138
    v_and_b32 v213, 0xffff0000, v138
    v_lshlrev_b32 v214, 16, v139
    v_and_b32 v215, 0xffff0000, v139
    v_lshlrev_b32 v216, 16, v140
    v_and_b32 v217, 0xffff0000, v140
    v_lshlrev_b32 v218, 16, v141
    v_and_b32 v219, 0xffff0000, v141
    v_lshlrev_b32 v220, 16, v142
    v_and_b32 v221, 0xffff0000, v142
    v_lshlrev_b32 v222, 16, v143
    v_and_b32 v223, 0xffff0000, v143
    v_add_f32 v26, v208, v209
    v_add_f32 v26, v26, v210
    v_add_f32 v26, v26, v211
    v_add_f32 v26, v26, v212
    v_add_f32 v26, v26, v213
    v_add_f32 v26, v26, v214
    v_add_f32 v26, v26, v215
    v_add_f32 v26, v26, v216
    v_add_f32 v26, v26, v217
    v_add_f32 v26, v26, v218
    v_add_f32 v26, v26, v219
    v_add_f32 v26, v26, v220
    v_add_f32 v26, v26, v221
    v_add_f32 v26, v26, v222
    v_add_f32 v26, v26, v223
    s_nop 1
    v_add_f32_dpp v26, v26, v26 row_shr:1 row_mask:0xf bank_mask:0xf bound_ctrl:0
    s_nop 1
    v_add_f32_dpp v26, v26, v26 row_shr:2 row_mask:0xf bank_mask:0xf bound_ctrl:0
    s_nop 1
    v_add_f32_dpp v26, v26, v26 row_shr:4 row_mask:0xf bank_mask:0xf bound_ctrl:0
    s_nop 1
    v_add_f32_dpp v26, v26, v26 row_shr:8 row_mask:0xf bank_mask:0xf bound_ctrl:0
    s_nop 1
    v_add_f32_dpp v26, v26, v26 row_bcast:15 row_mask:0xa bank_mask:0xf
    s_nop 1
    v_add_f32_dpp v26, v26, v26 row_bcast:31 row_mask:0xc bank_mask:0xf
    s_nop 1
    v_readlane_b32 s66, v26, 63
    s_nop 1
    v_mov_b32 v27, s66
    v_mul_f32 v27, 0x3a800000, v27
    v_mov_b32 v26, 0
    v_sub_f32 v28, v208, v27
    v_fmac_f32 v26, v28, v28
    v_sub_f32 v28, v209, v27
    v_fmac_f32 v26, v28, v28
    v_sub_f32 v28, v210, v27
    v_fmac_f32 v26, v28, v28
    v_sub_f32 v28, v211, v27
    v_fmac_f32 v26, v28, v28
    v_sub_f32 v28, v212, v27
    v_fmac_f32 v26, v28, v28
    v_sub_f32 v28, v213, v27
    v_fmac_f32 v26, v28, v28
    v_sub_f32 v28, v214, v27
    v_fmac_f32 v26, v28, v28
    v_sub_f32 v28, v215, v27
    v_fmac_f32 v26, v28, v28
    v_sub_f32 v28, v216, v27
    v_fmac_f32 v26, v28, v28
    v_sub_f32 v28, v217, v27
    v_fmac_f32 v26, v28, v28
    v_sub_f32 v28, v218, v27
    v_fmac_f32 v26, v28, v28
    v_sub_f32 v28, v219, v27
    v_fmac_f32 v26, v28, v28
    v_sub_f32 v28, v220, v27
    v_fmac_f32 v26, v28, v28
    v_sub_f32 v28, v221, v27
    v_fmac_f32 v26, v28, v28
    v_sub_f32 v28, v222, v27
    v_fmac_f32 v26, v28, v28
    v_sub_f32 v28, v223, v27
    v_fmac_f32 v26, v28, v28
    s_nop 1
    v_add_f32_dpp v26, v26, v26 row_shr:1 row_mask:0xf bank_mask:0xf bound_ctrl:0
    s_nop 1
    v_add_f32_dpp v26, v26, v26 row_shr:2 row_mask:0xf bank_mask:0xf bound_ctrl:0
    s_nop 1
    v_add_f32_dpp v26, v26, v26 row_shr:4 row_mask:0xf bank_mask:0xf bound_ctrl:0
    s_nop 1
    v_add_f32_dpp v26, v26, v26 row_shr:8 row_mask:0xf bank_mask:0xf bound_ctrl:0
    s_nop 1
    v_add_f32_dpp v26, v26, v26 row_bcast:15 row_mask:0xa bank_mask:0xf
    s_nop 1
    v_add_f32_dpp v26, v26, v26 row_bcast:31 row_mask:0xc bank_mask:0xf
    s_nop 1
    v_readlane_b32 s66, v26, 63
    s_nop 1
    v_mov_b32 v26, s66
    v_mul_f32 v26, 0x3a800000, v26
    v_cvt_pk_bf16_f32 v26, v26, v26
    v_lshlrev_b32 v26, 16, v26
    v_cvt_pk_bf16_f32 v27, v27, v27
    v_lshlrev_b32 v27, 16, v27
    v_add_f32 v26, 0x3727c5ac, v26
    v_cvt_pk_bf16_f32 v26, v26, v26
    v_lshlrev_b32 v26, 16, v26
    v_sqrt_f32 v26, v26
    s_nop 0
    v_cvt_pk_bf16_f32 v26, v26, v26
    v_lshlrev_b32 v26, 16, v26
    v_rcp_f32 v26, v26
    s_nop 0
    v_sub_f32 v208, v208, v27
    v_cvt_pk_bf16_f32 v208, v208, v208
    v_lshlrev_b32 v208, 16, v208
    v_mul_f32 v208, v208, v26
    v_cvt_pk_bf16_f32 v208, v208, v208
    v_lshlrev_b32 v208, 16, v208
    v_sub_f32 v209, v209, v27
    v_cvt_pk_bf16_f32 v209, v209, v209
    v_lshlrev_b32 v209, 16, v209
    v_mul_f32 v209, v209, v26
    v_cvt_pk_bf16_f32 v209, v209, v209
    v_lshlrev_b32 v209, 16, v209
    v_sub_f32 v210, v210, v27
    v_cvt_pk_bf16_f32 v210, v210, v210
    v_lshlrev_b32 v210, 16, v210
    v_mul_f32 v210, v210, v26
    v_cvt_pk_bf16_f32 v210, v210, v210
    v_lshlrev_b32 v210, 16, v210
    v_sub_f32 v211, v211, v27
    v_cvt_pk_bf16_f32 v211, v211, v211
    v_lshlrev_b32 v211, 16, v211
    v_mul_f32 v211, v211, v26
    v_cvt_pk_bf16_f32 v211, v211, v211
    v_lshlrev_b32 v211, 16, v211
    v_sub_f32 v212, v212, v27
    v_cvt_pk_bf16_f32 v212, v212, v212
    v_lshlrev_b32 v212, 16, v212
    v_mul_f32 v212, v212, v26
    v_cvt_pk_bf16_f32 v212, v212, v212
    v_lshlrev_b32 v212, 16, v212
    v_sub_f32 v213, v213, v27
    v_cvt_pk_bf16_f32 v213, v213, v213
    v_lshlrev_b32 v213, 16, v213
    v_mul_f32 v213, v213, v26
    v_cvt_pk_bf16_f32 v213, v213, v213
    v_lshlrev_b32 v213, 16, v213
    v_sub_f32 v214, v214, v27
    v_cvt_pk_bf16_f32 v214, v214, v214
    v_lshlrev_b32 v214, 16, v214
    v_mul_f32 v214, v214, v26
    v_cvt_pk_bf16_f32 v214, v214, v214
    v_lshlrev_b32 v214, 16, v214
    v_sub_f32 v215, v215, v27
    v_cvt_pk_bf16_f32 v215, v215, v215
    v_lshlrev_b32 v215, 16, v215
    v_mul_f32 v215, v215, v26
    v_cvt_pk_bf16_f32 v215, v215, v215
    v_lshlrev_b32 v215, 16, v215
    v_sub_f32 v216, v216, v27
    v_cvt_pk_bf16_f32 v216, v216, v216
    v_lshlrev_b32 v216, 16, v216
    v_mul_f32 v216, v216, v26
    v_cvt_pk_bf16_f32 v216, v216, v216
    v_lshlrev_b32 v216, 16, v216
    v_sub_f32 v217, v217, v27
    v_cvt_pk_bf16_f32 v217, v217, v217
    v_lshlrev_b32 v217, 16, v217
    v_mul_f32 v217, v217, v26
    v_cvt_pk_bf16_f32 v217, v217, v217
    v_lshlrev_b32 v217, 16, v217
    v_sub_f32 v218, v218, v27
    v_cvt_pk_bf16_f32 v218, v218, v218
    v_lshlrev_b32 v218, 16, v218
    v_mul_f32 v218, v218, v26
    v_cvt_pk_bf16_f32 v218, v218, v218
    v_lshlrev_b32 v218, 16, v218
    v_sub_f32 v219, v219, v27
    v_cvt_pk_bf16_f32 v219, v219, v219
    v_lshlrev_b32 v219, 16, v219
    v_mul_f32 v219, v219, v26
    v_cvt_pk_bf16_f32 v219, v219, v219
    v_lshlrev_b32 v219, 16, v219
    v_sub_f32 v220, v220, v27
    v_cvt_pk_bf16_f32 v220, v220, v220
    v_lshlrev_b32 v220, 16, v220
    v_mul_f32 v220, v220, v26
    v_cvt_pk_bf16_f32 v220, v220, v220
    v_lshlrev_b32 v220, 16, v220
    v_sub_f32 v221, v221, v27
    v_cvt_pk_bf16_f32 v221, v221, v221
    v_lshlrev_b32 v221, 16, v221
    v_mul_f32 v221, v221, v26
    v_cvt_pk_bf16_f32 v221, v221, v221
    v_lshlrev_b32 v221, 16, v221
    v_sub_f32 v222, v222, v27
    v_cvt_pk_bf16_f32 v222, v222, v222
    v_lshlrev_b32 v222, 16, v222
    v_mul_f32 v222, v222, v26
    v_cvt_pk_bf16_f32 v222, v222, v222
    v_lshlrev_b32 v222, 16, v222
    v_sub_f32 v223, v223, v27
    v_cvt_pk_bf16_f32 v223, v223, v223
    v_lshlrev_b32 v223, 16, v223
    v_mul_f32 v223, v223, v26
    v_cvt_pk_bf16_f32 v223, v223, v223
    v_lshlrev_b32 v223, 16, v223
    s_cmp_lg_u32 s44, 0
    s_cbranch_scc1 L_pd_103
    v_mov_b32 v29, 8
    s_mov_b32 s46, 32
    s_mov_b64 exec, 1
    s_mov_b32 s70, 0
L_wp_104:
    buffer_load_dword v31, v29, s[16:19], 0 offen sc1
    s_add_u32 s70, s70, 1
    s_cmp_ge_u32 s70, 0x200000
    s_cbranch_scc1 L_w_done_98
L_wp_104_c:
    s_waitcnt vmcnt(0)
    v_cmp_gt_u32 vcc, s46, v31
    s_nop 1
    s_cbranch_vccz L_wp_104_ok
    s_sleep 3
    s_branch L_wp_104
L_wp_104_ok:
    s_mov_b64 exec, -1
L_pd_103:
    s_barrier
    s_cmp_lg_u32 s44, 0
    s_cbranch_scc1 L_pd_105
    v_mov_b32 v29, 128
    s_mov_b32 s46, 96
    s_mov_b64 exec, 1
    s_mov_b32 s70, 0
L_wp_106:
    buffer_load_dword v31, v29, s[16:19], 0 offen sc1
    s_add_u32 s70, s70, 1
    s_cmp_ge_u32 s70, 0x200000
    s_cbranch_scc1 L_w_done_98
L_wp_106_c:
    s_waitcnt vmcnt(0)
    v_cmp_gt_u32 vcc, s46, v31
    s_nop 1
    s_cbranch_vccz L_wp_106_ok
    s_sleep 1
    s_branch L_wp_106
L_wp_106_ok:
    s_mov_b64 exec, -1
L_pd_105:
    s_barrier
    v_lshlrev_b32 v29, 5, v1
    s_mov_b32 s45, 0
    buffer_load_dwordx4 v[96:99], v29, s[12:15], s45 offen offset:0 sc1
    buffer_load_dwordx4 v[100:103], v29, s[12:15], s45 offen offset:16 sc1
    buffer_load_dwordx4 v[104:107], v29, s[12:15], s45 offen offset:2048 sc1
    buffer_load_dwordx4 v[108:111], v29, s[12:15], s45 offen offset:2064 sc1
    s_mov_b32 s45, 24576
    buffer_load_dwordx4 v[32:35], v29, s[12:15], s45 offen offset:0 sc1
    buffer_load_dwordx4 v[36:39], v29, s[12:15], s45 offen offset:16 sc1
    buffer_load_dwordx4 v[40:43], v29, s[12:15], s45 offen offset:2048 sc1
    buffer_load_dwordx4 v[44:47], v29, s[12:15], s45 offen offset:2064 sc1
    s_mov_b32 s45, 4096
    buffer_load_dwordx4 v[112:115], v29, s[12:15], s45 offen offset:0 sc1
    buffer_load_dwordx4 v[116:119], v29, s[12:15], s45 offen offset:16 sc1
    buffer_load_dwordx4 v[120:123], v29, s[12:15], s45 offen offset:2048 sc1
    buffer_load_dwordx4 v[124:127], v29, s[12:15], s45 offen offset:2064 sc1
    s_mov_b32 s45, 28672
    buffer_load_dwordx4 v[48:51], v29, s[12:15], s45 offen offset:0 sc1
    buffer_load_dwordx4 v[52:55], v29, s[12:15], s45 offen offset:16 sc1
    buffer_load_dwordx4 v[56:59], v29, s[12:15], s45 offen offset:2048 sc1
    buffer_load_dwordx4 v[60:63], v29, s[12:15], s45 offen offset:2064 sc1
    s_waitcnt vmcnt(0)
    v_add_f32 v96, v96, v32
    v_cvt_pk_bf16_f32 v96, v96, v96
    v_lshlrev_b32 v96, 16, v96
    v_add_f32 v97, v97, v33
    v_cvt_pk_bf16_f32 v97, v97, v97
    v_lshlrev_b32 v97, 16, v97
    v_add_f32 v98, v98, v34
    v_cvt_pk_bf16_f32 v98, v98, v98
    v_lshlrev_b32 v98, 16, v98
    v_add_f32 v99, v99, v35
    v_cvt_pk_bf16_f32 v99, v99, v99
    v_lshlrev_b32 v99, 16, v99
    v_add_f32 v100, v100, v36
    v_cvt_pk_bf16_f32 v100, v100, v100
    v_lshlrev_b32 v100, 16, v100
    v_add_f32 v101, v101, v37
    v_cvt_pk_bf16_f32 v101, v101, v101
    v_lshlrev_b32 v101, 16, v101
    v_add_f32 v102, v102, v38
    v_cvt_pk_bf16_f32 v102, v102, v102
    v_lshlrev_b32 v102, 16, v102
    v_add_f32 v103, v103, v39
    v_cvt_pk_bf16_f32 v103, v103, v103
    v_lshlrev_b32 v103, 16, v103
    v_add_f32 v104, v104, v40
    v_cvt_pk_bf16_f32 v104, v104, v104
    v_lshlrev_b32 v104, 16, v104
    v_add_f32 v105, v105, v41
    v_cvt_pk_bf16_f32 v105, v105, v105
    v_lshlrev_b32 v105, 16, v105
    v_add_f32 v106, v106, v42
    v_cvt_pk_bf16_f32 v106, v106, v106
    v_lshlrev_b32 v106, 16, v106
    v_add_f32 v107, v107, v43
    v_cvt_pk_bf16_f32 v107, v107, v107
    v_lshlrev_b32 v107, 16, v107
    v_add_f32 v108, v108, v44
    v_cvt_pk_bf16_f32 v108, v108, v108
    v_lshlrev_b32 v108, 16, v108
    v_add_f32 v109, v109, v45
    v_cvt_pk_bf16_f32 v109, v109, v109
    v_lshlrev_b32 v109, 16, v109
    v_add_f32 v110, v110, v46
    v_cvt_pk_bf16_f32 v110, v110, v110
    v_lshlrev_b32 v110, 16, v110
    v_add_f32 v111, v111, v47
    v_cvt_pk_bf16_f32 v111, v111, v111
    v_lshlrev_b32 v111, 16, v111
    v_add_f32 v112, v112, v48
    v_cvt_pk_bf16_f32 v112, v112, v112
    v_lshlrev_b32 v112, 16, v112
    v_add_f32 v112, 1.0, v112
    v_cvt_pk_bf16_f32 v112, v112, v112
    v_lshlrev_b32 v112, 16, v112
    v_add_f32 v113, v113, v49
    v_cvt_pk_bf16_f32 v113, v113, v113
    v_lshlrev_b32 v113, 16, v113
    v_add_f32 v113, 1.0, v113
    v_cvt_pk_bf16_f32 v113, v113, v113
    v_lshlrev_b32 v113, 16, v113
    v_add_f32 v114, v114, v50
    v_cvt_pk_bf16_f32 v114, v114, v114
    v_lshlrev_b32 v114, 16, v114
    v_add_f32 v114, 1.0, v114
    v_cvt_pk_bf16_f32 v114, v114, v114
    v_lshlrev_b32 v114, 16, v114
    v_add_f32 v115, v115, v51
    v_cvt_pk_bf16_f32 v115, v115, v115
    v_lshlrev_b32 v115, 16, v115
    v_add_f32 v115, 1.0, v115
    v_cvt_pk_bf16_f32 v115, v115, v115
    v_lshlrev_b32 v115, 16, v115
    v_add_f32 v116, v116, v52
    v_cvt_pk_bf16_f32 v116, v116, v116
    v_lshlrev_b32 v116, 16, v116
    v_add_f32 v116, 1.0, v116
    v_cvt_pk_bf16_f32 v116, v116, v116
    v_lshlrev_b32 v116, 16, v116
    v_add_f32 v117, v117, v53
    v_cvt_pk_bf16_f32 v117, v117, v117
    v_lshlrev_b32 v117, 16, v117
    v_add_f32 v117, 1.0, v117
    v_cvt_pk_bf16_f32 v117, v117, v117
    v_lshlrev_b32 v117, 16, v117
    v_add_f32 v118, v118, v54
    v_cvt_pk_bf16_f32 v118, v118, v118
    v_lshlrev_b32 v118, 16, v118
    v_add_f32 v118, 1.0, v118
    v_cvt_pk_bf16_f32 v118, v118, v118
    v_lshlrev_b32 v118, 16, v118
    v_add_f32 v119, v119, v55
    v_cvt_pk_bf16_f32 v119, v119, v119
    v_lshlrev_b32 v119, 16, v119
    v_add_f32 v119, 1.0, v119
    v_cvt_pk_bf16_f32 v119, v119, v119
    v_lshlrev_b32 v119, 16, v119
    v_add_f32 v120, v120, v56
    v_cvt_pk_bf16_f32 v120, v120, v120
    v_lshlrev_b32 v120, 16, v120
    v_add_f32 v120, 1.0, v120
    v_cvt_pk_bf16_f32 v120, v120, v120
    v_lshlrev_b32 v120, 16, v120
    v_add_f32 v121, v121, v57
    v_cvt_pk_bf16_f32 v121, v121, v121
    v_lshlrev_b32 v121, 16, v121
    v_add_f32 v121, 1.0, v121
    v_cvt_pk_bf16_f32 v121, v121, v121
    v_lshlrev_b32 v121, 16, v121
    v_add_f32 v122, v122, v58
    v_cvt_pk_bf16_f32 v122, v122, v122
    v_lshlrev_b32 v122, 16, v122
    v_add_f32 v122, 1.0, v122
    v_cvt_pk_bf16_f32 v122, v122, v122
    v_lshlrev_b32 v122, 16, v122
    v_add_f32 v123, v123, v59
    v_cvt_pk_bf16_f32 v123, v123, v123
    v_lshlrev_b32 v123, 16, v123
    v_add_f32 v123, 1.0, v123
    v_cvt_pk_bf16_f32 v123, v123, v123
    v_lshlrev_b32 v123, 16, v123
    v_add_f32 v124, v124, v60
    v_cvt_pk_bf16_f32 v124, v124, v124
    v_lshlrev_b32 v124, 16, v124
    v_add_f32 v124, 1.0, v124
    v_cvt_pk_bf16_f32 v124, v124, v124
    v_lshlrev_b32 v124, 16, v124
    v_add_f32 v125, v125, v61
    v_cvt_pk_bf16_f32 v125, v125, v125
    v_lshlrev_b32 v125, 16, v125
    v_add_f32 v125, 1.0, v125
    v_cvt_pk_bf16_f32 v125, v125, v125
    v_lshlrev_b32 v125, 16, v125
    v_add_f32 v126, v126, v62
    v_cvt_pk_bf16_f32 v126, v126, v126
    v_lshlrev_b32 v126, 16, v126
    v_add_f32 v126, 1.0, v126
    v_cvt_pk_bf16_f32 v126, v126, v126
    v_lshlrev_b32 v126, 16, v126
    v_add_f32 v127, v127, v63
    v_cvt_pk_bf16_f32 v127, v127, v127
    v_lshlrev_b32 v127, 16, v127
    v_add_f32 v127, 1.0, v127
    v_cvt_pk_bf16_f32 v127, v127, v127
    v_lshlrev_b32 v127, 16, v127
    v_mul_f32 v192, v192, v112
    v_cvt_pk_bf16_f32 v192, v192, v192
    v_lshlrev_b32 v192, 16, v192
    v_add_f32 v192, v192, v96
    v_mul_f32 v193, v193, v113
    v_cvt_pk_bf16_f32 v193, v193, v193
    v_lshlrev_b32 v193, 16, v193
    v_add_f32 v193, v193, v97
    v_mul_f32 v194, v194, v114
    v_cvt_pk_bf16_f32 v194, v194, v194
    v_lshlrev_b32 v194, 16, v194
    v_add_f32 v194, v194, v98
    v_mul_f32 v195, v195, v115
    v_cvt_pk_bf16_f32 v195, v195, v195
    v_lshlrev_b32 v195, 16, v195
    v_add_f32 v195, v195, v99
    v_mul_f32 v196, v196, v116
    v_cvt_pk_bf16_f32 v196, v196, v196
    v_lshlrev_b32 v196, 16, v196
    v_add_f32 v196, v196, v100
    v_mul_f32 v197, v197, v117
    v_cvt_pk_bf16_f32 v197, v197, v197
    v_lshlrev_b32 v197, 16, v197
    v_add_f32 v197, v197, v101
    v_mul_f32 v198, v198, v118
    v_cvt_pk_bf16_f32 v198, v198, v198
    v_lshlrev_b32 v198, 16, v198
    v_add_f32 v198, v198, v102
    v_mul_f32 v199, v199, v119
    v_cvt_pk_bf16_f32 v199, v199, v199
    v_lshlrev_b32 v199, 16, v199
    v_add_f32 v199, v199, v103
    v_mul_f32 v200, v200, v120
    v_cvt_pk_bf16_f32 v200, v200, v200
    v_lshlrev_b32 v200, 16, v200
    v_add_f32 v200, v200, v104
    v_mul_f32 v201, v201, v121
    v_cvt_pk_bf16_f32 v201, v201, v201
    v_lshlrev_b32 v201, 16, v201
    v_add_f32 v201, v201, v105
    v_mul_f32 v202, v202, v122
    v_cvt_pk_bf16_f32 v202, v202, v202
    v_lshlrev_b32 v202, 16, v202
    v_add_f32 v202, v202, v106
    v_mul_f32 v203, v203, v123
    v_cvt_pk_bf16_f32 v203, v203, v203
    v_lshlrev_b32 v203, 16, v203
    v_add_f32 v203, v203, v107
    v_mul_f32 v204, v204, v124
    v_cvt_pk_bf16_f32 v204, v204, v204
    v_lshlrev_b32 v204, 16, v204
    v_add_f32 v204, v204, v108
    v_mul_f32 v205, v205, v125
    v_cvt_pk_bf16_f32 v205, v205, v205
    v_lshlrev_b32 v205, 16, v205
    v_add_f32 v205, v205, v109
    v_mul_f32 v206, v206, v126
    v_cvt_pk_bf16_f32 v206, v206, v206
    v_lshlrev_b32 v206, 16, v206
    v_add_f32 v206, v206, v110
    v_mul_f32 v207, v207, v127
    v_cvt_pk_bf16_f32 v207, v207, v207
    v_lshlrev_b32 v207, 16, v207
    v_add_f32 v207, v207, v111
    v_cvt_pk_bf16_f32 v80, v192, v193
    v_cvt_pk_bf16_f32 v81, v194, v195
    v_cvt_pk_bf16_f32 v82, v196, v197
    v_cvt_pk_bf16_f32 v83, v198, v199
    v_cvt_pk_bf16_f32 v84, v200, v201
    v_cvt_pk_bf16_f32 v85, v202, v203
    v_cvt_pk_bf16_f32 v86, v204, v205
    v_cvt_pk_bf16_f32 v87, v206, v207
    s_lshr_b32 s45, s63, 5
    s_lshl_b32 s45, s45, 16
    s_and_b32 s46, s63, 31
    s_lshl_b32 s46, s46, 8
    s_add_u32 s45, s45, s46
    s_add_u32 s45, s45, 0x400000
    s_add_u32 s46, s45, 32768
    buffer_store_dwordx4 v[80:83], v2, s[12:15], s45 offen sc1
    buffer_store_dwordx4 v[84:87], v2, s[12:15], s46 offen sc1
    s_add_u32 s63, s63, 384
    v_mul_f32 v208, v208, v112
    v_cvt_pk_bf16_f32 v208, v208, v208
    v_lshlrev_b32 v208, 16, v208
    v_add_f32 v208, v208, v96
    v_mul_f32 v209, v209, v113
    v_cvt_pk_bf16_f32 v209, v209, v209
    v_lshlrev_b32 v209, 16, v209
    v_add_f32 v209, v209, v97
    v_mul_f32 v210, v210, v114
    v_cvt_pk_bf16_f32 v210, v210, v210
    v_lshlrev_b32 v210, 16, v210
    v_add_f32 v210, v210, v98
    v_mul_f32 v211, v211, v115
    v_cvt_pk_bf16_f32 v211, v211, v211
    v_lshlrev_b32 v211, 16, v211
    v_add_f32 v211, v211, v99
    v_mul_f32 v212, v212, v116
    v_cvt_pk_bf16_f32 v212, v212, v212
    v_lshlrev_b32 v212, 16, v212
    v_add_f32 v212, v212, v100
    v_mul_f32 v213, v213, v117
    v_cvt_pk_bf16_f32 v213, v213, v213
    v_lshlrev_b32 v213, 16, v213
    v_add_f32 v213, v213, v101
    v_mul_f32 v214, v214, v118
    v_cvt_pk_bf16_f32 v214, v214, v214
    v_lshlrev_b32 v214, 16, v214
    v_add_f32 v214, v214, v102
    v_mul_f32 v215, v215, v119
    v_cvt_pk_bf16_f32 v215, v215, v215
    v_lshlrev_b32 v215, 16, v215
    v_add_f32 v215, v215, v103
    v_mul_f32 v216, v216, v120
    v_cvt_pk_bf16_f32 v216, v216, v216
    v_lshlrev_b32 v216, 16, v216
    v_add_f32 v216, v216, v104
    v_mul_f32 v217, v217, v121
    v_cvt_pk_bf16_f32 v217, v217, v217
    v_lshlrev_b32 v217, 16, v217
    v_add_f32 v217, v217, v105
    v_mul_f32 v218, v218, v122
    v_cvt_pk_bf16_f32 v218, v218, v218
    v_lshlrev_b32 v218, 16, v218
    v_add_f32 v218, v218, v106
    v_mul_f32 v219, v219, v123
    v_cvt_pk_bf16_f32 v219, v219, v219
    v_lshlrev_b32 v219, 16, v219
    v_add_f32 v219, v219, v107
    v_mul_f32 v220, v220, v124
    v_cvt_pk_bf16_f32 v220, v220, v220
    v_lshlrev_b32 v220, 16, v220
    v_add_f32 v220, v220, v108
    v_mul_f32 v221, v221, v125
    v_cvt_pk_bf16_f32 v221, v221, v221
    v_lshlrev_b32 v221, 16, v221
    v_add_f32 v221, v221, v109
    v_mul_f32 v222, v222, v126
    v_cvt_pk_bf16_f32 v222, v222, v222
    v_lshlrev_b32 v222, 16, v222
    v_add_f32 v222, v222, v110
    v_mul_f32 v223, v223, v127
    v_cvt_pk_bf16_f32 v223, v223, v223
    v_lshlrev_b32 v223, 16, v223
    v_add_f32 v223, v223, v111
    v_cvt_pk_bf16_f32 v88, v208, v209
    v_cvt_pk_bf16_f32 v89, v210, v211
    v_cvt_pk_bf16_f32 v90, v212, v213
    v_cvt_pk_bf16_f32 v91, v214, v215
    v_cvt_pk_bf16_f32 v92, v216, v217
    v_cvt_pk_bf16_f32 v93, v218, v219
    v_cvt_pk_bf16_f32 v94, v220, v221
    v_cvt_pk_bf16_f32 v95, v222, v223
    s_lshr_b32 s45, s63, 5
    s_lshl_b32 s45, s45, 16
    s_and_b32 s46, s63, 31
    s_lshl_b32 s46, s46, 8
    s_add_u32 s45, s45, s46
    s_add_u32 s45, s45, 0x400000
    s_add_u32 s46, s45, 32768
    buffer_store_dwordx4 v[88:91], v2, s[12:15], s45 offen sc1
    buffer_store_dwordx4 v[92:95], v2, s[12:15], s46 offen sc1
    s_waitcnt vmcnt(2)
    s_barrier
    s_cmp_lg_u32 s44, 0
    s_cbranch_scc1 L_cnt_108
    v_mov_b32 v30, 1
    v_mov_b32 v31, 126976
    s_mov_b64 exec, 1
    buffer_atomic_add v30, v31, s[12:15], 0 offen sc1
    s_mov_b64 exec, -1
L_cnt_108:
    s_add_u32 s63, s63, 384
    v_lshlrev_b32 v64, 16, v144
    v_and_b32 v65, 0xffff0000, v144
    v_lshlrev_b32 v66, 16, v145
    v_and_b32 v67, 0xffff0000, v145
    v_lshlrev_b32 v68, 16, v146
    v_and_b32 v69, 0xffff0000, v146
    v_lshlrev_b32 v70, 16, v147
    v_and_b32 v71, 0xffff0000, v147
    v_lshlrev_b32 v72, 16, v148
    v_and_b32 v73, 0xffff0000, v148
    v_lshlrev_b32 v74, 16, v149
    v_and_b32 v75, 0xffff0000, v149
    v_lshlrev_b32 v76, 16, v150
    v_and_b32 v77, 0xffff0000, v150
    v_lshlrev_b32 v78, 16, v151
    v_and_b32 v79, 0xffff0000, v151
    v_add_f32 v26, v64, v65
    v_add_f32 v26, v26, v66
    v_add_f32 v26, v26, v67
    v_add_f32 v26, v26, v68
    v_add_f32 v26, v26, v69
    v_add_f32 v26, v26, v70
    v_add_f32 v26, v26, v71
    v_add_f32 v26, v26, v72
    v_add_f32 v26, v26, v73
    v_add_f32 v26, v26, v74
    v_add_f32 v26, v26, v75
    v_add_f32 v26, v26, v76
    v_add_f32 v26, v26, v77
    v_add_f32 v26, v26, v78
    v_add_f32 v26, v26, v79
    s_nop 1
    v_add_f32_dpp v26, v26, v26 row_shr:1 row_mask:0xf bank_mask:0xf bound_ctrl:0
    s_nop 1
    v_add_f32_dpp v26, v26, v26 row_shr:2 row_mask:0xf bank_mask:0xf bound_ctrl:0
    s_nop 1
    v_add_f32_dpp v26, v26, v26 row_shr:4 row_mask:0xf bank_mask:0xf bound_ctrl:0
    s_nop 1
    v_add_f32_dpp v26, v26, v26 row_shr:8 row_mask:0xf bank_mask:0xf bound_ctrl:0
    s_nop 1
    v_add_f32_dpp v26, v26, v26 row_bcast:15 row_mask:0xa bank_mask:0xf
    s_nop 1
    v_add_f32_dpp v26, v26, v26 row_bcast:31 row_mask:0xc bank_mask:0xf
    s_nop 1
    v_readlane_b32 s66, v26, 63
    s_nop 1
    v_mov_b32 v27, s66
    v_mul_f32 v27, 0x3a800000, v27
    v_mov_b32 v26, 0
    v_sub_f32 v28, v64, v27
    v_fmac_f32 v26, v28, v28
    v_sub_f32 v28, v65, v27
    v_fmac_f32 v26, v28, v28
    v_sub_f32 v28, v66, v27
    v_fmac_f32 v26, v28, v28
    v_sub_f32 v28, v67, v27
    v_fmac_f32 v26, v28, v28
    v_sub_f32 v28, v68, v27
    v_fmac_f32 v26, v28, v28
    v_sub_f32 v28, v69, v27
    v_fmac_f32 v26, v28, v28
    v_sub_f32 v28, v70, v27
    v_fmac_f32 v26, v28, v28
    v_sub_f32 v28, v71, v27
    v_fmac_f32 v26, v28, v28
    v_sub_f32 v28, v72, v27
    v_fmac_f32 v26, v28, v28
    v_sub_f32 v28, v73, v27
    v_fmac_f32 v26, v28, v28
    v_sub_f32 v28, v74, v27
    v_fmac_f32 v26, v28, v28
    v_sub_f32 v28, v75, v27
    v_fmac_f32 v26, v28, v28
    v_sub_f32 v28, v76, v27
    v_fmac_f32 v26, v28, v28
    v_sub_f32 v28, v77, v27
    v_fmac_f32 v26, v28, v28
    v_sub_f32 v28, v78, v27
    v_fmac_f32 v26, v28, v28
    v_sub_f32 v28, v79, v27
    v_fmac_f32 v26, v28, v28
    s_nop 1
    v_add_f32_dpp v26, v26, v26 row_shr:1 row_mask:0xf bank_mask:0xf bound_ctrl:0
    s_nop 1
    v_add_f32_dpp v26, v26, v26 row_shr:2 row_mask:0xf bank_mask:0xf bound_ctrl:0
    s_nop 1
    v_add_f32_dpp v26, v26, v26 row_shr:4 row_mask:0xf bank_mask:0xf bound_ctrl:0
    s_nop 1
    v_add_f32_dpp v26, v26, v26 row_shr:8 row_mask:0xf bank_mask:0xf bound_ctrl:0
    s_nop 1
    v_add_f32_dpp v26, v26, v26 row_bcast:15 row_mask:0xa bank_mask:0xf
    s_nop 1
    v_add_f32_dpp v26, v26, v26 row_bcast:31 row_mask:0xc bank_mask:0xf
    s_nop 1
    v_readlane_b32 s66, v26, 63
    s_nop 1
    v_mov_b32 v26, s66
    v_mul_f32 v26, 0x3a800000, v26
    v_cvt_pk_bf16_f32 v26, v26, v26
    v_lshlrev_b32 v26, 16, v26
    v_cvt_pk_bf16_f32 v27, v27, v27
    v_lshlrev_b32 v27, 16, v27
    v_add_f32 v26, 0x3727c5ac, v26
    v_cvt_pk_bf16_f32 v26, v26, v26
    v_lshlrev_b32 v26, 16, v26
    v_sqrt_f32 v26, v26
    s_nop 0
    v_cvt_pk_bf16_f32 v26, v26, v26
    v_lshlrev_b32 v26, 16, v26
    v_rcp_f32 v26, v26
    s_nop 0
    v_sub_f32 v64, v64, v27
    v_cvt_pk_bf16_f32 v64, v64, v64
    v_lshlrev_b32 v64, 16, v64
    v_mul_f32 v64, v64, v26
    v_cvt_pk_bf16_f32 v64, v64, v64
    v_lshlrev_b32 v64, 16, v64
    v_sub_f32 v65, v65, v27
    v_cvt_pk_bf16_f32 v65, v65, v65
    v_lshlrev_b32 v65, 16, v65
    v_mul_f32 v65, v65, v26
    v_cvt_pk_bf16_f32 v65, v65, v65
    v_lshlrev_b32 v65, 16, v65
    v_sub_f32 v66, v66, v27
    v_cvt_pk_bf16_f32 v66, v66, v66
    v_lshlrev_b32 v66, 16, v66
    v_mul_f32 v66, v66, v26
    v_cvt_pk_bf16_f32 v66, v66, v66
    v_lshlrev_b32 v66, 16, v66
    v_sub_f32 v67, v67, v27
    v_cvt_pk_bf16_f32 v67, v67, v67
    v_lshlrev_b32 v67, 16, v67
    v_mul_f32 v67, v67, v26
    v_cvt_pk_bf16_f32 v67, v67, v67
    v_lshlrev_b32 v67, 16, v67
    v_sub_f32 v68, v68, v27
    v_cvt_pk_bf16_f32 v68, v68, v68
    v_lshlrev_b32 v68, 16, v68
    v_mul_f32 v68, v68, v26
    v_cvt_pk_bf16_f32 v68, v68, v68
    v_lshlrev_b32 v68, 16, v68
    v_sub_f32 v69, v69, v27
    v_cvt_pk_bf16_f32 v69, v69, v69
    v_lshlrev_b32 v69, 16, v69
    v_mul_f32 v69, v69, v26
    v_cvt_pk_bf16_f32 v69, v69, v69
    v_lshlrev_b32 v69, 16, v69
    v_sub_f32 v70, v70, v27
    v_cvt_pk_bf16_f32 v70, v70, v70
    v_lshlrev_b32 v70, 16, v70
    v_mul_f32 v70, v70, v26
    v_cvt_pk_bf16_f32 v70, v70, v70
    v_lshlrev_b32 v70, 16, v70
    v_sub_f32 v71, v71, v27
    v_cvt_pk_bf16_f32 v71, v71, v71
    v_lshlrev_b32 v71, 16, v71
    v_mul_f32 v71, v71, v26
    v_cvt_pk_bf16_f32 v71, v71, v71
    v_lshlrev_b32 v71, 16, v71
    v_sub_f32 v72, v72, v27
    v_cvt_pk_bf16_f32 v72, v72, v72
    v_lshlrev_b32 v72, 16, v72
    v_mul_f32 v72, v72, v26
    v_cvt_pk_bf16_f32 v72, v72, v72
    v_lshlrev_b32 v72, 16, v72
    v_sub_f32 v73, v73, v27
    v_cvt_pk_bf16_f32 v73, v73, v73
    v_lshlrev_b32 v73, 16, v73
    v_mul_f32 v73, v73, v26
    v_cvt_pk_bf16_f32 v73, v73, v73
    v_lshlrev_b32 v73, 16, v73
    v_sub_f32 v74, v74, v27
    v_cvt_pk_bf16_f32 v74, v74, v74
    v_lshlrev_b32 v74, 16, v74
    v_mul_f32 v74, v74, v26
    v_cvt_pk_bf16_f32 v74, v74, v74
    v_lshlrev_b32 v74, 16, v74
    v_sub_f32 v75, v75, v27
    v_cvt_pk_bf16_f32 v75, v75, v75
    v_lshlrev_b32 v75, 16, v75
    v_mul_f32 v75, v75, v26
    v_cvt_pk_bf16_f32 v75, v75, v75
    v_lshlrev_b32 v75, 16, v75
    v_sub_f32 v76, v76, v27
    v_cvt_pk_bf16_f32 v76, v76, v76
    v_lshlrev_b32 v76, 16, v76
    v_mul_f32 v76, v76, v26
    v_cvt_pk_bf16_f32 v76, v76, v76
    v_lshlrev_b32 v76, 16, v76
    v_sub_f32 v77, v77, v27
    v_cvt_pk_bf16_f32 v77, v77, v77
    v_lshlrev_b32 v77, 16, v77
    v_mul_f32 v77, v77, v26
    v_cvt_pk_bf16_f32 v77, v77, v77
    v_lshlrev_b32 v77, 16, v77
    v_sub_f32 v78, v78, v27
    v_cvt_pk_bf16_f32 v78, v78, v78
    v_lshlrev_b32 v78, 16, v78
    v_mul_f32 v78, v78, v26
    v_cvt_pk_bf16_f32 v78, v78, v78
    v_lshlrev_b32 v78, 16, v78
    v_sub_f32 v79, v79, v27
    v_cvt_pk_bf16_f32 v79, v79, v79
    v_lshlrev_b32 v79, 16, v79
    v_mul_f32 v79, v79, v26
    v_cvt_pk_bf16_f32 v79, v79, v79
    v_lshlrev_b32 v79, 16, v79
    v_mul_f32 v64, v64, v112
    v_cvt_pk_bf16_f32 v64, v64, v64
    v_lshlrev_b32 v64, 16, v64
    v_add_f32 v64, v64, v96
    v_mul_f32 v65, v65, v113
    v_cvt_pk_bf16_f32 v65, v65, v65
    v_lshlrev_b32 v65, 16, v65
    v_add_f32 v65, v65, v97
    v_mul_f32 v66, v66, v114
    v_cvt_pk_bf16_f32 v66, v66, v66
    v_lshlrev_b32 v66, 16, v66
    v_add_f32 v66, v66, v98
    v_mul_f32 v67, v67, v115
    v_cvt_pk_bf16_f32 v67, v67, v67
    v_lshlrev_b32 v67, 16, v67
    v_add_f32 v67, v67, v99
    v_mul_f32 v68, v68, v116
    v_cvt_pk_bf16_f32 v68, v68, v68
    v_lshlrev_b32 v68, 16, v68
    v_add_f32 v68, v68, v100
    v_mul_f32 v69, v69, v117
    v_cvt_pk_bf16_f32 v69, v69, v69
    v_lshlrev_b32 v69, 16, v69
    v_add_f32 v69, v69, v101
    v_mul_f32 v70, v70, v118
    v_cvt_pk_bf16_f32 v70, v70, v70
    v_lshlrev_b32 v70, 16, v70
    v_add_f32 v70, v70, v102
    v_mul_f32 v71, v71, v119
    v_cvt_pk_bf16_f32 v71, v71, v71
    v_lshlrev_b32 v71, 16, v71
    v_add_f32 v71, v71, v103
    v_mul_f32 v72, v72, v120
    v_cvt_pk_bf16_f32 v72, v72, v72
    v_lshlrev_b32 v72, 16, v72
    v_add_f32 v72, v72, v104
    v_mul_f32 v73, v73, v121
    v_cvt_pk_bf16_f32 v73, v73, v73
    v_lshlrev_b32 v73, 16, v73
    v_add_f32 v73, v73, v105
    v_mul_f32 v74, v74, v122
    v_cvt_pk_bf16_f32 v74, v74, v74
    v_lshlrev_b32 v74, 16, v74
    v_add_f32 v74, v74, v106
    v_mul_f32 v75, v75, v123
    v_cvt_pk_bf16_f32 v75, v75, v75
    v_lshlrev_b32 v75, 16, v75
    v_add_f32 v75, v75, v107
    v_mul_f32 v76, v76, v124
    v_cvt_pk_bf16_f32 v76, v76, v76
    v_lshlrev_b32 v76, 16, v76
    v_add_f32 v76, v76, v108
    v_mul_f32 v77, v77, v125
    v_cvt_pk_bf16_f32 v77, v77, v77
    v_lshlrev_b32 v77, 16, v77
    v_add_f32 v77, v77, v109
    v_mul_f32 v78, v78, v126
    v_cvt_pk_bf16_f32 v78, v78, v78
    v_lshlrev_b32 v78, 16, v78
    v_add_f32 v78, v78, v110
    v_mul_f32 v79, v79, v127
    v_cvt_pk_bf16_f32 v79, v79, v79
    v_lshlrev_b32 v79, 16, v79
    v_add_f32 v79, v79, v111
    v_cvt_pk_bf16_f32 v80, v64, v65
    v_cvt_pk_bf16_f32 v81, v66, v67
    v_cvt_pk_bf16_f32 v82, v68, v69
    v_cvt_pk_bf16_f32 v83, v70, v71
    v_cvt_pk_bf16_f32 v84, v72, v73
    v_cvt_pk_bf16_f32 v85, v74, v75
    v_cvt_pk_bf16_f32 v86, v76, v77
    v_cvt_pk_bf16_f32 v87, v78, v79
    s_lshr_b32 s45, s63, 5
    s_lshl_b32 s45, s45, 16
    s_and_b32 s46, s63, 31
    s_lshl_b32 s46, s46, 8
    s_add_u32 s45, s45, s46
    s_add_u32 s45, s45, 0x400000
    s_add_u32 s46, s45, 32768
    buffer_store_dwordx4 v[80:83], v2, s[12:15], s45 offen sc1
    buffer_store_dwordx4 v[84:87], v2, s[12:15], s46 offen sc1
    s_add_u32 s63, s63, 384
    v_lshlrev_b32 v64, 16, v152
    v_and_b32 v65, 0xffff0000, v152
    v_lshlrev_b32 v66, 16, v153
    v_and_b32 v67, 0xffff0000, v153
    v_lshlrev_b32 v68, 16, v154
    v_and_b32 v69, 0xffff0000, v154
    v_lshlrev_b32 v70, 16, v155
    v_and_b32 v71, 0xffff0000, v155
    v_lshlrev_b32 v72, 16, v156
    v_and_b32 v73, 0xffff0000, v156
    v_lshlrev_b32 v74, 16, v157
    v_and_b32 v75, 0xffff0000, v157
    v_lshlrev_b32 v76, 16, v158
    v_and_b32 v77, 0xffff0000, v158
    v_lshlrev_b32 v78, 16, v159
    v_and_b32 v79, 0xffff0000, v159
    v_add_f32 v26, v64, v65
    v_add_f32 v26, v26, v66
    v_add_f32 v26, v26, v67
    v_add_f32 v26, v26, v68
    v_add_f32 v26, v26, v69
    v_add_f32 v26, v26, v70
    v_add_f32 v26, v26, v71
    v_add_f32 v26, v26, v72
    v_add_f32 v26, v26, v73
    v_add_f32 v26, v26, v74
    v_add_f32 v26, v26, v75
    v_add_f32 v26, v26, v76
    v_add_f32 v26, v26, v77
    v_add_f32 v26, v26, v78
    v_add_f32 v26, v26, v79
    s_nop 1
    v_add_f32_dpp v26, v26, v26 row_shr:1 row_mask:0xf bank_mask:0xf bound_ctrl:0
    s_nop 1
    v_add_f32_dpp v26, v26, v26 row_shr:2 row_mask:0xf bank_mask:0xf bound_ctrl:0
    s_nop 1
    v_add_f32_dpp v26, v26, v26 row_shr:4 row_mask:0xf bank_mask:0xf bound_ctrl:0
    s_nop 1
    v_add_f32_dpp v26, v26, v26 row_shr:8 row_mask:0xf bank_mask:0xf bound_ctrl:0
    s_nop 1
    v_add_f32_dpp v26, v26, v26 row_bcast:15 row_mask:0xa bank_mask:0xf
    s_nop 1
    v_add_f32_dpp v26, v26, v26 row_bcast:31 row_mask:0xc bank_mask:0xf
    s_nop 1
    v_readlane_b32 s66, v26, 63
    s_nop 1
    v_mov_b32 v27, s66
    v_mul_f32 v27, 0x3a800000, v27
    v_mov_b32 v26, 0
    v_sub_f32 v28, v64, v27
    v_fmac_f32 v26, v28, v28
    v_sub_f32 v28, v65, v27
    v_fmac_f32 v26, v28, v28
    v_sub_f32 v28, v66, v27
    v_fmac_f32 v26, v28, v28
    v_sub_f32 v28, v67, v27
    v_fmac_f32 v26, v28, v28
    v_sub_f32 v28, v68, v27
    v_fmac_f32 v26, v28, v28
    v_sub_f32 v28, v69, v27
    v_fmac_f32 v26, v28, v28
    v_sub_f32 v28, v70, v27
    v_fmac_f32 v26, v28, v28
    v_sub_f32 v28, v71, v27
    v_fmac_f32 v26, v28, v28
    v_sub_f32 v28, v72, v27
    v_fmac_f32 v26, v28, v28
    v_sub_f32 v28, v73, v27
    v_fmac_f32 v26, v28, v28
    v_sub_f32 v28, v74, v27
    v_fmac_f32 v26, v28, v28
    v_sub_f32 v28, v75, v27
    v_fmac_f32 v26, v28, v28
    v_sub_f32 v28, v76, v27
    v_fmac_f32 v26, v28, v28
    v_sub_f32 v28, v77, v27
    v_fmac_f32 v26, v28, v28
    v_sub_f32 v28, v78, v27
    v_fmac_f32 v26, v28, v28
    v_sub_f32 v28, v79, v27
    v_fmac_f32 v26, v28, v28
    s_nop 1
    v_add_f32_dpp v26, v26, v26 row_shr:1 row_mask:0xf bank_mask:0xf bound_ctrl:0
    s_nop 1
    v_add_f32_dpp v26, v26, v26 row_shr:2 row_mask:0xf bank_mask:0xf bound_ctrl:0
    s_nop 1
    v_add_f32_dpp v26, v26, v26 row_shr:4 row_mask:0xf bank_mask:0xf bound_ctrl:0
    s_nop 1
    v_add_f32_dpp v26, v26, v26 row_shr:8 row_mask:0xf bank_mask:0xf bound_ctrl:0
    s_nop 1
    v_add_f32_dpp v26, v26, v26 row_bcast:15 row_mask:0xa bank_mask:0xf
    s_nop 1
    v_add_f32_dpp v26, v26, v26 row_bcast:31 row_mask:0xc bank_mask:0xf
    s_nop 1
    v_readlane_b32 s66, v26, 63
    s_nop 1
    v_mov_b32 v26, s66
    v_mul_f32 v26, 0x3a800000, v26
    v_cvt_pk_bf16_f32 v26, v26, v26
    v_lshlrev_b32 v26, 16, v26
    v_cvt_pk_bf16_f32 v27, v27, v27
    v_lshlrev_b32 v27, 16, v27
    v_add_f32 v26, 0x3727c5ac, v26
    v_cvt_pk_bf16_f32 v26, v26, v26
    v_lshlrev_b32 v26, 16, v26
    v_sqrt_f32 v26, v26
    s_nop 0
    v_cvt_pk_bf16_f32 v26, v26, v26
    v_lshlrev_b32 v26, 16, v26
    v_rcp_f32 v26, v26
    s_nop 0
    v_sub_f32 v64, v64, v27
    v_cvt_pk_bf16_f32 v64, v64, v64
    v_lshlrev_b32 v64, 16, v64
    v_mul_f32 v64, v64, v26
    v_cvt_pk_bf16_f32 v64, v64, v64
    v_lshlrev_b32 v64, 16, v64
    v_sub_f32 v65, v65, v27
    v_cvt_pk_bf16_f32 v65, v65, v65
    v_lshlrev_b32 v65, 16, v65
    v_mul_f32 v65, v65, v26
    v_cvt_pk_bf16_f32 v65, v65, v65
    v_lshlrev_b32 v65, 16, v65
    v_sub_f32 v66, v66, v27
    v_cvt_pk_bf16_f32 v66, v66, v66
    v_lshlrev_b32 v66, 16, v66
    v_mul_f32 v66, v66, v26
    v_cvt_pk_bf16_f32 v66, v66, v66
    v_lshlrev_b32 v66, 16, v66
    v_sub_f32 v67, v67, v27
    v_cvt_pk_bf16_f32 v67, v67, v67
    v_lshlrev_b32 v67, 16, v67
    v_mul_f32 v67, v67, v26
    v_cvt_pk_bf16_f32 v67, v67, v67
    v_lshlrev_b32 v67, 16, v67
    v_sub_f32 v68, v68, v27
    v_cvt_pk_bf16_f32 v68, v68, v68
    v_lshlrev_b32 v68, 16, v68
    v_mul_f32 v68, v68, v26
    v_cvt_pk_bf16_f32 v68, v68, v68
    v_lshlrev_b32 v68, 16, v68
    v_sub_f32 v69, v69, v27
    v_cvt_pk_bf16_f32 v69, v69, v69
    v_lshlrev_b32 v69, 16, v69
    v_mul_f32 v69, v69, v26
    v_cvt_pk_bf16_f32 v69, v69, v69
    v_lshlrev_b32 v69, 16, v69
    v_sub_f32 v70, v70, v27
    v_cvt_pk_bf16_f32 v70, v70, v70
    v_lshlrev_b32 v70, 16, v70
    v_mul_f32 v70, v70, v26
    v_cvt_pk_bf16_f32 v70, v70, v70
    v_lshlrev_b32 v70, 16, v70
    v_sub_f32 v71, v71, v27
    v_cvt_pk_bf16_f32 v71, v71, v71
    v_lshlrev_b32 v71, 16, v71
    v_mul_f32 v71, v71, v26
    v_cvt_pk_bf16_f32 v71, v71, v71
    v_lshlrev_b32 v71, 16, v71
    v_sub_f32 v72, v72, v27
    v_cvt_pk_bf16_f32 v72, v72, v72
    v_lshlrev_b32 v72, 16, v72
    v_mul_f32 v72, v72, v26
    v_cvt_pk_bf16_f32 v72, v72, v72
    v_lshlrev_b32 v72, 16, v72
    v_sub_f32 v73, v73, v27
    v_cvt_pk_bf16_f32 v73, v73, v73
    v_lshlrev_b32 v73, 16, v73
    v_mul_f32 v73, v73, v26
    v_cvt_pk_bf16_f32 v73, v73, v73
    v_lshlrev_b32 v73, 16, v73
    v_sub_f32 v74, v74, v27
    v_cvt_pk_bf16_f32 v74, v74, v74
    v_lshlrev_b32 v74, 16, v74
    v_mul_f32 v74, v74, v26
    v_cvt_pk_bf16_f32 v74, v74, v74
    v_lshlrev_b32 v74, 16, v74
    v_sub_f32 v75, v75, v27
    v_cvt_pk_bf16_f32 v75, v75, v75
    v_lshlrev_b32 v75, 16, v75
    v_mul_f32 v75, v75, v26
    v_cvt_pk_bf16_f32 v75, v75, v75
    v_lshlrev_b32 v75, 16, v75
    v_sub_f32 v76, v76, v27
    v_cvt_pk_bf16_f32 v76, v76, v76
    v_lshlrev_b32 v76, 16, v76
    v_mul_f32 v76, v76, v26
    v_cvt_pk_bf16_f32 v76, v76, v76
    v_lshlrev_b32 v76, 16, v76
    v_sub_f32 v77, v77, v27
    v_cvt_pk_bf16_f32 v77, v77, v77
    v_lshlrev_b32 v77, 16, v77
    v_mul_f32 v77, v77, v26
    v_cvt_pk_bf16_f32 v77, v77, v77
    v_lshlrev_b32 v77, 16, v77
    v_sub_f32 v78, v78, v27
    v_cvt_pk_bf16_f32 v78, v78, v78
    v_lshlrev_b32 v78, 16, v78
    v_mul_f32 v78, v78, v26
    v_cvt_pk_bf16_f32 v78, v78, v78
    v_lshlrev_b32 v78, 16, v78
    v_sub_f32 v79, v79, v27
    v_cvt_pk_bf16_f32 v79, v79, v79
    v_lshlrev_b32 v79, 16, v79
    v_mul_f32 v79, v79, v26
    v_cvt_pk_bf16_f32 v79, v79, v79
    v_lshlrev_b32 v79, 16, v79
    v_mul_f32 v64, v64, v112
    v_cvt_pk_bf16_f32 v64, v64, v64
    v_lshlrev_b32 v64, 16, v64
    v_add_f32 v64, v64, v96
    v_mul_f32 v65, v65, v113
    v_cvt_pk_bf16_f32 v65, v65, v65
    v_lshlrev_b32 v65, 16, v65
    v_add_f32 v65, v65, v97
    v_mul_f32 v66, v66, v114
    v_cvt_pk_bf16_f32 v66, v66, v66
    v_lshlrev_b32 v66, 16, v66
    v_add_f32 v66, v66, v98
    v_mul_f32 v67, v67, v115
    v_cvt_pk_bf16_f32 v67, v67, v67
    v_lshlrev_b32 v67, 16, v67
    v_add_f32 v67, v67, v99
    v_mul_f32 v68, v68, v116
    v_cvt_pk_bf16_f32 v68, v68, v68
    v_lshlrev_b32 v68, 16, v68
    v_add_f32 v68, v68, v100
    v_mul_f32 v69, v69, v117
    v_cvt_pk_bf16_f32 v69, v69, v69
    v_lshlrev_b32 v69, 16, v69
    v_add_f32 v69, v69, v101
    v_mul_f32 v70, v70, v118
    v_cvt_pk_bf16_f32 v70, v70, v70
    v_lshlrev_b32 v70, 16, v70
    v_add_f32 v70, v70, v102
    v_mul_f32 v71, v71, v119
    v_cvt_pk_bf16_f32 v71, v71, v71
    v_lshlrev_b32 v71, 16, v71
    v_add_f32 v71, v71, v103
    v_mul_f32 v72, v72, v120
    v_cvt_pk_bf16_f32 v72, v72, v72
    v_lshlrev_b32 v72, 16, v72
    v_add_f32 v72, v72, v104
    v_mul_f32 v73, v73, v121
    v_cvt_pk_bf16_f32 v73, v73, v73
    v_lshlrev_b32 v73, 16, v73
    v_add_f32 v73, v73, v105
    v_mul_f32 v74, v74, v122
    v_cvt_pk_bf16_f32 v74, v74, v74
    v_lshlrev_b32 v74, 16, v74
    v_add_f32 v74, v74, v106
    v_mul_f32 v75, v75, v123
    v_cvt_pk_bf16_f32 v75, v75, v75
    v_lshlrev_b32 v75, 16, v75
    v_add_f32 v75, v75, v107
    v_mul_f32 v76, v76, v124
    v_cvt_pk_bf16_f32 v76, v76, v76
    v_lshlrev_b32 v76, 16, v76
    v_add_f32 v76, v76, v108
    v_mul_f32 v77, v77, v125
    v_cvt_pk_bf16_f32 v77, v77, v77
    v_lshlrev_b32 v77, 16, v77
    v_add_f32 v77, v77, v109
    v_mul_f32 v78, v78, v126
    v_cvt_pk_bf16_f32 v78, v78, v78
    v_lshlrev_b32 v78, 16, v78
    v_add_f32 v78, v78, v110
    v_mul_f32 v79, v79, v127
    v_cvt_pk_bf16_f32 v79, v79, v79
    v_lshlrev_b32 v79, 16, v79
    v_add_f32 v79, v79, v111
    v_cvt_pk_bf16_f32 v80, v64, v65
    v_cvt_pk_bf16_f32 v81, v66, v67
    v_cvt_pk_bf16_f32 v82, v68, v69
    v_cvt_pk_bf16_f32 v83, v70, v71
    v_cvt_pk_bf16_f32 v84, v72, v73
    v_cvt_pk_bf16_f32 v85, v74, v75
    v_cvt_pk_bf16_f32 v86, v76, v77
    v_cvt_pk_bf16_f32 v87, v78, v79
    s_lshr_b32 s45, s63, 5
    s_lshl_b32 s45, s45, 16
    s_and_b32 s46, s63, 31
    s_lshl_b32 s46, s46, 8
    s_add_u32 s45, s45, s46
    s_add_u32 s45, s45, 0x400000
    s_add_u32 s46, s45, 32768
    buffer_store_dwordx4 v[80:83], v2, s[12:15], s45 offen sc1
    buffer_store_dwordx4 v[84:87], v2, s[12:15], s46 offen sc1
    s_add_u32 s63, s63, 384
    v_lshlrev_b32 v64, 16, v160
    v_and_b32 v65, 0xffff0000, v160
    v_lshlrev_b32 v66, 16, v161
    v_and_b32 v67, 0xffff0000, v161
    v_lshlrev_b32 v68, 16, v162
    v_and_b32 v69, 0xffff0000, v162
    v_lshlrev_b32 v70, 16, v163
    v_and_b32 v71, 0xffff0000, v163
    v_lshlrev_b32 v72, 16, v164
    v_and_b32 v73, 0xffff0000, v164
    v_lshlrev_b32 v74, 16, v165
    v_and_b32 v75, 0xffff0000, v165
    v_lshlrev_b32 v76, 16, v166
    v_and_b32 v77, 0xffff0000, v166
    v_lshlrev_b32 v78, 16, v167
    v_and_b32 v79, 0xffff0000, v167
    v_add_f32 v26, v64, v65
    v_add_f32 v26, v26, v66
    v_add_f32 v26, v26, v67
    v_add_f32 v26, v26, v68
    v_add_f32 v26, v26, v69
    v_add_f32 v26, v26, v70
    v_add_f32 v26, v26, v71
    v_add_f32 v26, v26, v72
    v_add_f32 v26, v26, v73
    v_add_f32 v26, v26, v74
    v_add_f32 v26, v26, v75
    v_add_f32 v26, v26, v76
    v_add_f32 v26, v26, v77
    v_add_f32 v26, v26, v78
    v_add_f32 v26, v26, v79
    s_nop 1
    v_add_f32_dpp v26, v26, v26 row_shr:1 row_mask:0xf bank_mask:0xf bound_ctrl:0
    s_nop 1
    v_add_f32_dpp v26, v26, v26 row_shr:2 row_mask:0xf bank_mask:0xf bound_ctrl:0
    s_nop 1
    v_add_f32_dpp v26, v26, v26 row_shr:4 row_mask:0xf bank_mask:0xf bound_ctrl:0
    s_nop 1
    v_add_f32_dpp v26, v26, v26 row_shr:8 row_mask:0xf bank_mask:0xf bound_ctrl:0
    s_nop 1
    v_add_f32_dpp v26, v26, v26 row_bcast:15 row_mask:0xa bank_mask:0xf
    s_nop 1
    v_add_f32_dpp v26, v26, v26 row_bcast:31 row_mask:0xc bank_mask:0xf
    s_nop 1
    v_readlane_b32 s66, v26, 63
    s_nop 1
    v_mov_b32 v27, s66
    v_mul_f32 v27, 0x3a800000, v27
    v_mov_b32 v26, 0
    v_sub_f32 v28, v64, v27
    v_fmac_f32 v26, v28, v28
    v_sub_f32 v28, v65, v27
    v_fmac_f32 v26, v28, v28
    v_sub_f32 v28, v66, v27
    v_fmac_f32 v26, v28, v28
    v_sub_f32 v28, v67, v27
    v_fmac_f32 v26, v28, v28
    v_sub_f32 v28, v68, v27
    v_fmac_f32 v26, v28, v28
    v_sub_f32 v28, v69, v27
    v_fmac_f32 v26, v28, v28
    v_sub_f32 v28, v70, v27
    v_fmac_f32 v26, v28, v28
    v_sub_f32 v28, v71, v27
    v_fmac_f32 v26, v28, v28
    v_sub_f32 v28, v72, v27
    v_fmac_f32 v26, v28, v28
    v_sub_f32 v28, v73, v27
    v_fmac_f32 v26, v28, v28
    v_sub_f32 v28, v74, v27
    v_fmac_f32 v26, v28, v28
    v_sub_f32 v28, v75, v27
    v_fmac_f32 v26, v28, v28
    v_sub_f32 v28, v76, v27
    v_fmac_f32 v26, v28, v28
    v_sub_f32 v28, v77, v27
    v_fmac_f32 v26, v28, v28
    v_sub_f32 v28, v78, v27
    v_fmac_f32 v26, v28, v28
    v_sub_f32 v28, v79, v27
    v_fmac_f32 v26, v28, v28
    s_nop 1
    v_add_f32_dpp v26, v26, v26 row_shr:1 row_mask:0xf bank_mask:0xf bound_ctrl:0
    s_nop 1
    v_add_f32_dpp v26, v26, v26 row_shr:2 row_mask:0xf bank_mask:0xf bound_ctrl:0
    s_nop 1
    v_add_f32_dpp v26, v26, v26 row_shr:4 row_mask:0xf bank_mask:0xf bound_ctrl:0
    s_nop 1
    v_add_f32_dpp v26, v26, v26 row_shr:8 row_mask:0xf bank_mask:0xf bound_ctrl:0
    s_nop 1
    v_add_f32_dpp v26, v26, v26 row_bcast:15 row_mask:0xa bank_mask:0xf
    s_nop 1
    v_add_f32_dpp v26, v26, v26 row_bcast:31 row_mask:0xc bank_mask:0xf
    s_nop 1
    v_readlane_b32 s66, v26, 63
    s_nop 1
    v_mov_b32 v26, s66
    v_mul_f32 v26, 0x3a800000, v26
    v_cvt_pk_bf16_f32 v26, v26, v26
    v_lshlrev_b32 v26, 16, v26
    v_cvt_pk_bf16_f32 v27, v27, v27
    v_lshlrev_b32 v27, 16, v27
    v_add_f32 v26, 0x3727c5ac, v26
    v_cvt_pk_bf16_f32 v26, v26, v26
    v_lshlrev_b32 v26, 16, v26
    v_sqrt_f32 v26, v26
    s_nop 0
    v_cvt_pk_bf16_f32 v26, v26, v26
    v_lshlrev_b32 v26, 16, v26
    v_rcp_f32 v26, v26
    s_nop 0
    v_sub_f32 v64, v64, v27
    v_cvt_pk_bf16_f32 v64, v64, v64
    v_lshlrev_b32 v64, 16, v64
    v_mul_f32 v64, v64, v26
    v_cvt_pk_bf16_f32 v64, v64, v64
    v_lshlrev_b32 v64, 16, v64
    v_sub_f32 v65, v65, v27
    v_cvt_pk_bf16_f32 v65, v65, v65
    v_lshlrev_b32 v65, 16, v65
    v_mul_f32 v65, v65, v26
    v_cvt_pk_bf16_f32 v65, v65, v65
    v_lshlrev_b32 v65, 16, v65
    v_sub_f32 v66, v66, v27
    v_cvt_pk_bf16_f32 v66, v66, v66
    v_lshlrev_b32 v66, 16, v66
    v_mul_f32 v66, v66, v26
    v_cvt_pk_bf16_f32 v66, v66, v66
    v_lshlrev_b32 v66, 16, v66
    v_sub_f32 v67, v67, v27
    v_cvt_pk_bf16_f32 v67, v67, v67
    v_lshlrev_b32 v67, 16, v67
    v_mul_f32 v67, v67, v26
    v_cvt_pk_bf16_f32 v67, v67, v67
    v_lshlrev_b32 v67, 16, v67
    v_sub_f32 v68, v68, v27
    v_cvt_pk_bf16_f32 v68, v68, v68
    v_lshlrev_b32 v68, 16, v68
    v_mul_f32 v68, v68, v26
    v_cvt_pk_bf16_f32 v68, v68, v68
    v_lshlrev_b32 v68, 16, v68
    v_sub_f32 v69, v69, v27
    v_cvt_pk_bf16_f32 v69, v69, v69
    v_lshlrev_b32 v69, 16, v69
    v_mul_f32 v69, v69, v26
    v_cvt_pk_bf16_f32 v69, v69, v69
    v_lshlrev_b32 v69, 16, v69
    v_sub_f32 v70, v70, v27
    v_cvt_pk_bf16_f32 v70, v70, v70
    v_lshlrev_b32 v70, 16, v70
    v_mul_f32 v70, v70, v26
    v_cvt_pk_bf16_f32 v70, v70, v70
    v_lshlrev_b32 v70, 16, v70
    v_sub_f32 v71, v71, v27
    v_cvt_pk_bf16_f32 v71, v71, v71
    v_lshlrev_b32 v71, 16, v71
    v_mul_f32 v71, v71, v26
    v_cvt_pk_bf16_f32 v71, v71, v71
    v_lshlrev_b32 v71, 16, v71
    v_sub_f32 v72, v72, v27
    v_cvt_pk_bf16_f32 v72, v72, v72
    v_lshlrev_b32 v72, 16, v72
    v_mul_f32 v72, v72, v26
    v_cvt_pk_bf16_f32 v72, v72, v72
    v_lshlrev_b32 v72, 16, v72
    v_sub_f32 v73, v73, v27
    v_cvt_pk_bf16_f32 v73, v73, v73
    v_lshlrev_b32 v73, 16, v73
    v_mul_f32 v73, v73, v26
    v_cvt_pk_bf16_f32 v73, v73, v73
    v_lshlrev_b32 v73, 16, v73
    v_sub_f32 v74, v74, v27
    v_cvt_pk_bf16_f32 v74, v74, v74
    v_lshlrev_b32 v74, 16, v74
    v_mul_f32 v74, v74, v26
    v_cvt_pk_bf16_f32 v74, v74, v74
    v_lshlrev_b32 v74, 16, v74
    v_sub_f32 v75, v75, v27
    v_cvt_pk_bf16_f32 v75, v75, v75
    v_lshlrev_b32 v75, 16, v75
    v_mul_f32 v75, v75, v26
    v_cvt_pk_bf16_f32 v75, v75, v75
    v_lshlrev_b32 v75, 16, v75
    v_sub_f32 v76, v76, v27
    v_cvt_pk_bf16_f32 v76, v76, v76
    v_lshlrev_b32 v76, 16, v76
    v_mul_f32 v76, v76, v26
    v_cvt_pk_bf16_f32 v76, v76, v76
    v_lshlrev_b32 v76, 16, v76
    v_sub_f32 v77, v77, v27
    v_cvt_pk_bf16_f32 v77, v77, v77
    v_lshlrev_b32 v77, 16, v77
    v_mul_f32 v77, v77, v26
    v_cvt_pk_bf16_f32 v77, v77, v77
    v_lshlrev_b32 v77, 16, v77
    v_sub_f32 v78, v78, v27
    v_cvt_pk_bf16_f32 v78, v78, v78
    v_lshlrev_b32 v78, 16, v78
    v_mul_f32 v78, v78, v26
    v_cvt_pk_bf16_f32 v78, v78, v78
    v_lshlrev_b32 v78, 16, v78
    v_sub_f32 v79, v79, v27
    v_cvt_pk_bf16_f32 v79, v79, v79
    v_lshlrev_b32 v79, 16, v79
    v_mul_f32 v79, v79, v26
    v_cvt_pk_bf16_f32 v79, v79, v79
    v_lshlrev_b32 v79, 16, v79
    v_mul_f32 v64, v64, v112
    v_cvt_pk_bf16_f32 v64, v64, v64
    v_lshlrev_b32 v64, 16, v64
    v_add_f32 v64, v64, v96
    v_mul_f32 v65, v65, v113
    v_cvt_pk_bf16_f32 v65, v65, v65
    v_lshlrev_b32 v65, 16, v65
    v_add_f32 v65, v65, v97
    v_mul_f32 v66, v66, v114
    v_cvt_pk_bf16_f32 v66, v66, v66
    v_lshlrev_b32 v66, 16, v66
    v_add_f32 v66, v66, v98
    v_mul_f32 v67, v67, v115
    v_cvt_pk_bf16_f32 v67, v67, v67
    v_lshlrev_b32 v67, 16, v67
    v_add_f32 v67, v67, v99
    v_mul_f32 v68, v68, v116
    v_cvt_pk_bf16_f32 v68, v68, v68
    v_lshlrev_b32 v68, 16, v68
    v_add_f32 v68, v68, v100
    v_mul_f32 v69, v69, v117
    v_cvt_pk_bf16_f32 v69, v69, v69
    v_lshlrev_b32 v69, 16, v69
    v_add_f32 v69, v69, v101
    v_mul_f32 v70, v70, v118
    v_cvt_pk_bf16_f32 v70, v70, v70
    v_lshlrev_b32 v70, 16, v70
    v_add_f32 v70, v70, v102
    v_mul_f32 v71, v71, v119
    v_cvt_pk_bf16_f32 v71, v71, v71
    v_lshlrev_b32 v71, 16, v71
    v_add_f32 v71, v71, v103
    v_mul_f32 v72, v72, v120
    v_cvt_pk_bf16_f32 v72, v72, v72
    v_lshlrev_b32 v72, 16, v72
    v_add_f32 v72, v72, v104
    v_mul_f32 v73, v73, v121
    v_cvt_pk_bf16_f32 v73, v73, v73
    v_lshlrev_b32 v73, 16, v73
    v_add_f32 v73, v73, v105
    v_mul_f32 v74, v74, v122
    v_cvt_pk_bf16_f32 v74, v74, v74
    v_lshlrev_b32 v74, 16, v74
    v_add_f32 v74, v74, v106
    v_mul_f32 v75, v75, v123
    v_cvt_pk_bf16_f32 v75, v75, v75
    v_lshlrev_b32 v75, 16, v75
    v_add_f32 v75, v75, v107
    v_mul_f32 v76, v76, v124
    v_cvt_pk_bf16_f32 v76, v76, v76
    v_lshlrev_b32 v76, 16, v76
    v_add_f32 v76, v76, v108
    v_mul_f32 v77, v77, v125
    v_cvt_pk_bf16_f32 v77, v77, v77
    v_lshlrev_b32 v77, 16, v77
    v_add_f32 v77, v77, v109
    v_mul_f32 v78, v78, v126
    v_cvt_pk_bf16_f32 v78, v78, v78
    v_lshlrev_b32 v78, 16, v78
    v_add_f32 v78, v78, v110
    v_mul_f32 v79, v79, v127
    v_cvt_pk_bf16_f32 v79, v79, v79
    v_lshlrev_b32 v79, 16, v79
    v_add_f32 v79, v79, v111
    v_cvt_pk_bf16_f32 v80, v64, v65
    v_cvt_pk_bf16_f32 v81, v66, v67
    v_cvt_pk_bf16_f32 v82, v68, v69
    v_cvt_pk_bf16_f32 v83, v70, v71
    v_cvt_pk_bf16_f32 v84, v72, v73
    v_cvt_pk_bf16_f32 v85, v74, v75
    v_cvt_pk_bf16_f32 v86, v76, v77
    v_cvt_pk_bf16_f32 v87, v78, v79
    s_lshr_b32 s45, s63, 5
    s_lshl_b32 s45, s45, 16
    s_and_b32 s46, s63, 31
    s_lshl_b32 s46, s46, 8
    s_add_u32 s45, s45, s46
    s_add_u32 s45, s45, 0x400000
    s_add_u32 s46, s45, 32768
    buffer_store_dwordx4 v[80:83], v2, s[12:15], s45 offen sc1
    buffer_store_dwordx4 v[84:87], v2, s[12:15], s46 offen sc1
    s_add_u32 s63, s63, 384
    s_cmp_ge_u32 s63, 2048
    s_cbranch_scc1 L_ln_done_107
    v_lshlrev_b32 v64, 16, v168
    v_and_b32 v65, 0xffff0000, v168
    v_lshlrev_b32 v66, 16, v169
    v_and_b32 v67, 0xffff0000, v169
    v_lshlrev_b32 v68, 16, v170
    v_and_b32 v69, 0xffff0000, v170
    v_lshlrev_b32 v70, 16, v171
    v_and_b32 v71, 0xffff0000, v171
    v_lshlrev_b32 v72, 16, v172
    v_and_b32 v73, 0xffff0000, v172
    v_lshlrev_b32 v74, 16, v173
    v_and_b32 v75, 0xffff0000, v173
    v_lshlrev_b32 v76, 16, v174
    v_and_b32 v77, 0xffff0000, v174
    v_lshlrev_b32 v78, 16, v175
    v_and_b32 v79, 0xffff0000, v175
    v_add_f32 v26, v64, v65
    v_add_f32 v26, v26, v66
    v_add_f32 v26, v26, v67
    v_add_f32 v26, v26, v68
    v_add_f32 v26, v26, v69
    v_add_f32 v26, v26, v70
    v_add_f32 v26, v26, v71
    v_add_f32 v26, v26, v72
    v_add_f32 v26, v26, v73
    v_add_f32 v26, v26, v74
    v_add_f32 v26, v26, v75
    v_add_f32 v26, v26, v76
    v_add_f32 v26, v26, v77
    v_add_f32 v26, v26, v78
    v_add_f32 v26, v26, v79
    s_nop 1
    v_add_f32_dpp v26, v26, v26 row_shr:1 row_mask:0xf bank_mask:0xf bound_ctrl:0
    s_nop 1
    v_add_f32_dpp v26, v26, v26 row_shr:2 row_mask:0xf bank_mask:0xf bound_ctrl:0
    s_nop 1
    v_add_f32_dpp v26, v26, v26 row_shr:4 row_mask:0xf bank_mask:0xf bound_ctrl:0
    s_nop 1
    v_add_f32_dpp v26, v26, v26 row_shr:8 row_mask:0xf bank_mask:0xf bound_ctrl:0
    s_nop 1
    v_add_f32_dpp v26, v26, v26 row_bcast:15 row_mask:0xa bank_mask:0xf
    s_nop 1
    v_add_f32_dpp v26, v26, v26 row_bcast:31 row_mask:0xc bank_mask:0xf
    s_nop 1
    v_readlane_b32 s66, v26, 63
    s_nop 1
    v_mov_b32 v27, s66
    v_mul_f32 v27, 0x3a800000, v27
    v_mov_b32 v26, 0
    v_sub_f32 v28, v64, v27
    v_fmac_f32 v26, v28, v28
    v_sub_f32 v28, v65, v27
    v_fmac_f32 v26, v28, v28
    v_sub_f32 v28, v66, v27
    v_fmac_f32 v26, v28, v28
    v_sub_f32 v28, v67, v27
    v_fmac_f32 v26, v28, v28
    v_sub_f32 v28, v68, v27
    v_fmac_f32 v26, v28, v28
    v_sub_f32 v28, v69, v27
    v_fmac_f32 v26, v28, v28
    v_sub_f32 v28, v70, v27
    v_fmac_f32 v26, v28, v28
    v_sub_f32 v28, v71, v27
    v_fmac_f32 v26, v28, v28
    v_sub_f32 v28, v72, v27
    v_fmac_f32 v26, v28, v28
    v_sub_f32 v28, v73, v27
    v_fmac_f32 v26, v28, v28
    v_sub_f32 v28, v74, v27
    v_fmac_f32 v26, v28, v28
    v_sub_f32 v28, v75, v27
    v_fmac_f32 v26, v28, v28
    v_sub_f32 v28, v76, v27
    v_fmac_f32 v26, v28, v28
    v_sub_f32 v28, v77, v27
    v_fmac_f32 v26, v28, v28
    v_sub_f32 v28, v78, v27
    v_fmac_f32 v26, v28, v28
    v_sub_f32 v28, v79, v27
    v_fmac_f32 v26, v28, v28
    s_nop 1
    v_add_f32_dpp v26, v26, v26 row_shr:1 row_mask:0xf bank_mask:0xf bound_ctrl:0
    s_nop 1
    v_add_f32_dpp v26, v26, v26 row_shr:2 row_mask:0xf bank_mask:0xf bound_ctrl:0
    s_nop 1
    v_add_f32_dpp v26, v26, v26 row_shr:4 row_mask:0xf bank_mask:0xf bound_ctrl:0
    s_nop 1
    v_add_f32_dpp v26, v26, v26 row_shr:8 row_mask:0xf bank_mask:0xf bound_ctrl:0
    s_nop 1
    v_add_f32_dpp v26, v26, v26 row_bcast:15 row_mask:0xa bank_mask:0xf
    s_nop 1
    v_add_f32_dpp v26, v26, v26 row_bcast:31 row_mask:0xc bank_mask:0xf
    s_nop 1
    v_readlane_b32 s66, v26, 63
    s_nop 1
    v_mov_b32 v26, s66
    v_mul_f32 v26, 0x3a800000, v26
    v_cvt_pk_bf16_f32 v26, v26, v26
    v_lshlrev_b32 v26, 16, v26
    v_cvt_pk_bf16_f32 v27, v27, v27
    v_lshlrev_b32 v27, 16, v27
    v_add_f32 v26, 0x3727c5ac, v26
    v_cvt_pk_bf16_f32 v26, v26, v26
    v_lshlrev_b32 v26, 16, v26
    v_sqrt_f32 v26, v26
    s_nop 0
    v_cvt_pk_bf16_f32 v26, v26, v26
    v_lshlrev_b32 v26, 16, v26
    v_rcp_f32 v26, v26
    s_nop 0
    v_sub_f32 v64, v64, v27
    v_cvt_pk_bf16_f32 v64, v64, v64
    v_lshlrev_b32 v64, 16, v64
    v_mul_f32 v64, v64, v26
    v_cvt_pk_bf16_f32 v64, v64, v64
    v_lshlrev_b32 v64, 16, v64
    v_sub_f32 v65, v65, v27
    v_cvt_pk_bf16_f32 v65, v65, v65
    v_lshlrev_b32 v65, 16, v65
    v_mul_f32 v65, v65, v26
    v_cvt_pk_bf16_f32 v65, v65, v65
    v_lshlrev_b32 v65, 16, v65
    v_sub_f32 v66, v66, v27
    v_cvt_pk_bf16_f32 v66, v66, v66
    v_lshlrev_b32 v66, 16, v66
    v_mul_f32 v66, v66, v26
    v_cvt_pk_bf16_f32 v66, v66, v66
    v_lshlrev_b32 v66, 16, v66
    v_sub_f32 v67, v67, v27
    v_cvt_pk_bf16_f32 v67, v67, v67
    v_lshlrev_b32 v67, 16, v67
    v_mul_f32 v67, v67, v26
    v_cvt_pk_bf16_f32 v67, v67, v67
    v_lshlrev_b32 v67, 16, v67
    v_sub_f32 v68, v68, v27
    v_cvt_pk_bf16_f32 v68, v68, v68
    v_lshlrev_b32 v68, 16, v68
    v_mul_f32 v68, v68, v26
    v_cvt_pk_bf16_f32 v68, v68, v68
    v_lshlrev_b32 v68, 16, v68
    v_sub_f32 v69, v69, v27
    v_cvt_pk_bf16_f32 v69, v69, v69
    v_lshlrev_b32 v69, 16, v69
    v_mul_f32 v69, v69, v26
    v_cvt_pk_bf16_f32 v69, v69, v69
    v_lshlrev_b32 v69, 16, v69
    v_sub_f32 v70, v70, v27
    v_cvt_pk_bf16_f32 v70, v70, v70
    v_lshlrev_b32 v70, 16, v70
    v_mul_f32 v70, v70, v26
    v_cvt_pk_bf16_f32 v70, v70, v70
    v_lshlrev_b32 v70, 16, v70
    v_sub_f32 v71, v71, v27
    v_cvt_pk_bf16_f32 v71, v71, v71
    v_lshlrev_b32 v71, 16, v71
    v_mul_f32 v71, v71, v26
    v_cvt_pk_bf16_f32 v71, v71, v71
    v_lshlrev_b32 v71, 16, v71
    v_sub_f32 v72, v72, v27
    v_cvt_pk_bf16_f32 v72, v72, v72
    v_lshlrev_b32 v72, 16, v72
    v_mul_f32 v72, v72, v26
    v_cvt_pk_bf16_f32 v72, v72, v72
    v_lshlrev_b32 v72, 16, v72
    v_sub_f32 v73, v73, v27
    v_cvt_pk_bf16_f32 v73, v73, v73
    v_lshlrev_b32 v73, 16, v73
    v_mul_f32 v73, v73, v26
    v_cvt_pk_bf16_f32 v73, v73, v73
    v_lshlrev_b32 v73, 16, v73
    v_sub_f32 v74, v74, v27
    v_cvt_pk_bf16_f32 v74, v74, v74
    v_lshlrev_b32 v74, 16, v74
    v_mul_f32 v74, v74, v26
    v_cvt_pk_bf16_f32 v74, v74, v74
    v_lshlrev_b32 v74, 16, v74
    v_sub_f32 v75, v75, v27
    v_cvt_pk_bf16_f32 v75, v75, v75
    v_lshlrev_b32 v75, 16, v75
    v_mul_f32 v75, v75, v26
    v_cvt_pk_bf16_f32 v75, v75, v75
    v_lshlrev_b32 v75, 16, v75
    v_sub_f32 v76, v76, v27
    v_cvt_pk_bf16_f32 v76, v76, v76
    v_lshlrev_b32 v76, 16, v76
    v_mul_f32 v76, v76, v26
    v_cvt_pk_bf16_f32 v76, v76, v76
    v_lshlrev_b32 v76, 16, v76
    v_sub_f32 v77, v77, v27
    v_cvt_pk_bf16_f32 v77, v77, v77
    v_lshlrev_b32 v77, 16, v77
    v_mul_f32 v77, v77, v26
    v_cvt_pk_bf16_f32 v77, v77, v77
    v_lshlrev_b32 v77, 16, v77
    v_sub_f32 v78, v78, v27
    v_cvt_pk_bf16_f32 v78, v78, v78
    v_lshlrev_b32 v78, 16, v78
    v_mul_f32 v78, v78, v26
    v_cvt_pk_bf16_f32 v78, v78, v78
    v_lshlrev_b32 v78, 16, v78
    v_sub_f32 v79, v79, v27
    v_cvt_pk_bf16_f32 v79, v79, v79
    v_lshlrev_b32 v79, 16, v79
    v_mul_f32 v79, v79, v26
    v_cvt_pk_bf16_f32 v79, v79, v79
    v_lshlrev_b32 v79, 16, v79
    v_mul_f32 v64, v64, v112
    v_cvt_pk_bf16_f32 v64, v64, v64
    v_lshlrev_b32 v64, 16, v64
    v_add_f32 v64, v64, v96
    v_mul_f32 v65, v65, v113
    v_cvt_pk_bf16_f32 v65, v65, v65
    v_lshlrev_b32 v65, 16, v65
    v_add_f32 v65, v65, v97
    v_mul_f32 v66, v66, v114
    v_cvt_pk_bf16_f32 v66, v66, v66
    v_lshlrev_b32 v66, 16, v66
    v_add_f32 v66, v66, v98
    v_mul_f32 v67, v67, v115
    v_cvt_pk_bf16_f32 v67, v67, v67
    v_lshlrev_b32 v67, 16, v67
    v_add_f32 v67, v67, v99
    v_mul_f32 v68, v68, v116
    v_cvt_pk_bf16_f32 v68, v68, v68
    v_lshlrev_b32 v68, 16, v68
    v_add_f32 v68, v68, v100
    v_mul_f32 v69, v69, v117
    v_cvt_pk_bf16_f32 v69, v69, v69
    v_lshlrev_b32 v69, 16, v69
    v_add_f32 v69, v69, v101
    v_mul_f32 v70, v70, v118
    v_cvt_pk_bf16_f32 v70, v70, v70
    v_lshlrev_b32 v70, 16, v70
    v_add_f32 v70, v70, v102
    v_mul_f32 v71, v71, v119
    v_cvt_pk_bf16_f32 v71, v71, v71
    v_lshlrev_b32 v71, 16, v71
    v_add_f32 v71, v71, v103
    v_mul_f32 v72, v72, v120
    v_cvt_pk_bf16_f32 v72, v72, v72
    v_lshlrev_b32 v72, 16, v72
    v_add_f32 v72, v72, v104
    v_mul_f32 v73, v73, v121
    v_cvt_pk_bf16_f32 v73, v73, v73
    v_lshlrev_b32 v73, 16, v73
    v_add_f32 v73, v73, v105
    v_mul_f32 v74, v74, v122
    v_cvt_pk_bf16_f32 v74, v74, v74
    v_lshlrev_b32 v74, 16, v74
    v_add_f32 v74, v74, v106
    v_mul_f32 v75, v75, v123
    v_cvt_pk_bf16_f32 v75, v75, v75
    v_lshlrev_b32 v75, 16, v75
    v_add_f32 v75, v75, v107
    v_mul_f32 v76, v76, v124
    v_cvt_pk_bf16_f32 v76, v76, v76
    v_lshlrev_b32 v76, 16, v76
    v_add_f32 v76, v76, v108
    v_mul_f32 v77, v77, v125
    v_cvt_pk_bf16_f32 v77, v77, v77
    v_lshlrev_b32 v77, 16, v77
    v_add_f32 v77, v77, v109
    v_mul_f32 v78, v78, v126
    v_cvt_pk_bf16_f32 v78, v78, v78
    v_lshlrev_b32 v78, 16, v78
    v_add_f32 v78, v78, v110
    v_mul_f32 v79, v79, v127
    v_cvt_pk_bf16_f32 v79, v79, v79
    v_lshlrev_b32 v79, 16, v79
    v_add_f32 v79, v79, v111
    v_cvt_pk_bf16_f32 v80, v64, v65
    v_cvt_pk_bf16_f32 v81, v66, v67
    v_cvt_pk_bf16_f32 v82, v68, v69
    v_cvt_pk_bf16_f32 v83, v70, v71
    v_cvt_pk_bf16_f32 v84, v72, v73
    v_cvt_pk_bf16_f32 v85, v74, v75
    v_cvt_pk_bf16_f32 v86, v76, v77
    v_cvt_pk_bf16_f32 v87, v78, v79
    s_lshr_b32 s45, s63, 5
    s_lshl_b32 s45, s45, 16
    s_and_b32 s46, s63, 31
    s_lshl_b32 s46, s46, 8
    s_add_u32 s45, s45, s46
    s_add_u32 s45, s45, 0x400000
    s_add_u32 s46, s45, 32768
    buffer_store_dwordx4 v[80:83], v2, s[12:15], s45 offen sc1
    buffer_store_dwordx4 v[84:87], v2, s[12:15], s46 offen sc1
    s_add_u32 s63, s63, 384
L_ln_done_107:
    s_waitcnt vmcnt(0)
    s_barrier
    s_cmp_lg_u32 s44, 0
    s_cbranch_scc1 L_cnt_109
    v_mov_b32 v30, 1
    v_mov_b32 v31, 127104
    s_mov_b64 exec, 1
    buffer_atomic_add v30, v31, s[12:15], 0 offen sc1
    s_mov_b64 exec, -1
L_cnt_109:
    s_add_u32 s39, s39, 96
    s_load_dwordx2 s[4:5], s[0:1], 96
    s_load_dwordx2 s[6:7], s[0:1], 104
    v_and_b32 v14, 7, v0
    v_lshrrev_b32 v15, 3, v0
    s_waitcnt lgkmcnt(0)
    s_mov_b32 s32, s4
    s_and_b32 s33, s5, 0xffff
    s_mov_b32 s34, 0x800
    s_mov_b32 s35, 0x00020000
    s_mov_b32 s24, s6
    s_and_b32 s25, s7, 0xffff
    s_mov_b32 s26, 0xc00000
    s_mov_b32 s27, 0x00020000
    s_and_b32 s47, s39, 1
    s_lshl_b32 s45, s47, 10
    v_lshlrev_b32 v16, 5, v15
    buffer_load_dwordx4 v[104:107], v16, s[32:35], s45 offen
    buffer_load_dwordx4 v[108:111], v16, s[32:35], s45 offen offset:16
    s_mov_b32 s45, 196608
    v_mul_lo_u32 v17, v15, s45
    v_lshlrev_b32 v18, 4, v14
    v_add_u32 v17, v17, v18
    s_lshr_b32 s46, s39, 1
    s_lshl_b32 s46, s46, 7
    s_mul_i32 s45, s47, 6291456
    s_add_u32 s46, s46, s45
    buffer_load_dwordx4 v[32:35], v17, s[24:27], s46 offen
    v_add_u32 v17, 12288, v17
    buffer_load_dwordx4 v[36:39], v17, s[24:27], s46 offen
    v_add_u32 v17, 12288, v17
    buffer_load_dwordx4 v[40:43], v17, s[24:27], s46 offen
    v_add_u32 v17, 12288, v17
    buffer_load_dwordx4 v[44:47], v17, s[24:27], s46 offen
    v_add_u32 v17, 12288, v17
    buffer_load_dwordx4 v[48:51], v17, s[24:27], s46 offen
    v_add_u32 v17, 12288, v17
    buffer_load_dwordx4 v[52:55], v17, s[24:27], s46 offen
    v_add_u32 v17, 12288, v17
    buffer_load_dwordx4 v[56:59], v17, s[24:27], s46 offen
    v_add_u32 v17, 12288, v17
    buffer_load_dwordx4 v[60:63], v17, s[24:27], s46 offen
    v_add_u32 v17, 12288, v17
    buffer_load_dwordx4 v[64:67], v17, s[24:27], s46 offen
    v_add_u32 v17, 12288, v17
    buffer_load_dwordx4 v[68:71], v17, s[24:27], s46 offen
    v_add_u32 v17, 12288, v17
    buffer_load_dwordx4 v[72:75], v17, s[24:27], s46 offen
    v_add_u32 v17, 12288, v17
    buffer_load_dwordx4 v[76:79], v17, s[24:27], s46 offen
    v_add_u32 v17, 12288, v17
    buffer_load_dwordx4 v[80:83], v17, s[24:27], s46 offen
    v_add_u32 v17, 12288, v17
    buffer_load_dwordx4 v[84:87], v17, s[24:27], s46 offen
    v_add_u32 v17, 12288, v17
    buffer_load_dwordx4 v[88:91], v17, s[24:27], s46 offen
    v_add_u32 v17, 12288, v17
    buffer_load_dwordx4 v[92:95], v17, s[24:27], s46 offen
    s_waitcnt vmcnt(16)
    v_lshlrev_b32 v112, 16, v104
    v_and_b32 v113, 0xffff0000, v104
    v_lshlrev_b32 v114, 16, v105
    v_and_b32 v115, 0xffff0000, v105
    v_lshlrev_b32 v116, 16, v106
    v_and_b32 v117, 0xffff0000, v106
    v_lshlrev_b32 v118, 16, v107
    v_and_b32 v119, 0xffff0000, v107
    v_lshlrev_b32 v120, 16, v108
    v_and_b32 v121, 0xffff0000, v108
    v_lshlrev_b32 v122, 16, v109
    v_and_b32 v123, 0xffff0000, v109
    v_lshlrev_b32 v124, 16, v110
    v_and_b32 v125, 0xffff0000, v110
    v_lshlrev_b32 v126, 16, v111
    v_and_b32 v127, 0xffff0000, v111
    v_mul_f32 v18, 0xbfb8aa3b, v112
    v_exp_f32 v18, v18
    s_nop 0
    v_add_f32 v18, 1.0, v18
    v_rcp_f32 v18, v18
    s_nop 0
    v_mul_f32 v112, v112, v18
    v_cvt_pk_bf16_f32 v112, v112, v112
    v_lshlrev_b32 v112, 16, v112
    v_mul_f32 v18, 0xbfb8aa3b, v113
    v_exp_f32 v18, v18
    s_nop 0
    v_add_f32 v18, 1.0, v18
    v_rcp_f32 v18, v18
    s_nop 0
    v_mul_f32 v113, v113, v18
    v_cvt_pk_bf16_f32 v113, v113, v113
    v_lshlrev_b32 v113, 16, v113
    v_mul_f32 v18, 0xbfb8aa3b, v114
    v_exp_f32 v18, v18
    s_nop 0
    v_add_f32 v18, 1.0, v18
    v_rcp_f32 v18, v18
    s_nop 0
    v_mul_f32 v114, v114, v18
    v_cvt_pk_bf16_f32 v114, v114, v114
    v_lshlrev_b32 v114, 16, v114
    v_mul_f32 v18, 0xbfb8aa3b, v115
    v_exp_f32 v18, v18
    s_nop 0
    v_add_f32 v18, 1.0, v18
    v_rcp_f32 v18, v18
    s_nop 0
    v_mul_f32 v115, v115, v18
    v_cvt_pk_bf16_f32 v115, v115, v115
    v_lshlrev_b32 v115, 16, v115
    v_mul_f32 v18, 0xbfb8aa3b, v116
    v_exp_f32 v18, v18
    s_nop 0
    v_add_f32 v18, 1.0, v18
    v_rcp_f32 v18, v18
    s_nop 0
    v_mul_f32 v116, v116, v18
    v_cvt_pk_bf16_f32 v116, v116, v116
    v_lshlrev_b32 v116, 16, v116
    v_mul_f32 v18, 0xbfb8aa3b, v117
    v_exp_f32 v18, v18
    s_nop 0
    v_add_f32 v18, 1.0, v18
    v_rcp_f32 v18, v18
    s_nop 0
    v_mul_f32 v117, v117, v18
    v_cvt_pk_bf16_f32 v117, v117, v117
    v_lshlrev_b32 v117, 16, v117
    v_mul_f32 v18, 0xbfb8aa3b, v118
    v_exp_f32 v18, v18
    s_nop 0
    v_add_f32 v18, 1.0, v18
    v_rcp_f32 v18, v18
    s_nop 0
    v_mul_f32 v118, v118, v18
    v_cvt_pk_bf16_f32 v118, v118, v118
    v_lshlrev_b32 v118, 16, v118
    v_mul_f32 v18, 0xbfb8aa3b, v119
    v_exp_f32 v18, v18
    s_nop 0
    v_add_f32 v18, 1.0, v18
    v_rcp_f32 v18, v18
    s_nop 0
    v_mul_f32 v119, v119, v18
    v_cvt_pk_bf16_f32 v119, v119, v119
    v_lshlrev_b32 v119, 16, v119
    v_mul_f32 v18, 0xbfb8aa3b, v120
    v_exp_f32 v18, v18
    s_nop 0
    v_add_f32 v18, 1.0, v18
    v_rcp_f32 v18, v18
    s_nop 0
    v_mul_f32 v120, v120, v18
    v_cvt_pk_bf16_f32 v120, v120, v120
    v_lshlrev_b32 v120, 16, v120
    v_mul_f32 v18, 0xbfb8aa3b, v121
    v_exp_f32 v18, v18
    s_nop 0
    v_add_f32 v18, 1.0, v18
    v_rcp_f32 v18, v18
    s_nop 0
    v_mul_f32 v121, v121, v18
    v_cvt_pk_bf16_f32 v121, v121, v121
    v_lshlrev_b32 v121, 16, v121
    v_mul_f32 v18, 0xbfb8aa3b, v122
    v_exp_f32 v18, v18
    s_nop 0
    v_add_f32 v18, 1.0, v18
    v_rcp_f32 v18, v18
    s_nop 0
    v_mul_f32 v122, v122, v18
    v_cvt_pk_bf16_f32 v122, v122, v122
    v_lshlrev_b32 v122, 16, v122
    v_mul_f32 v18, 0xbfb8aa3b, v123
    v_exp_f32 v18, v18
    s_nop 0
    v_add_f32 v18, 1.0, v18
    v_rcp_f32 v18, v18
    s_nop 0
    v_mul_f32 v123, v123, v18
    v_cvt_pk_bf16_f32 v123, v123, v123
    v_lshlrev_b32 v123, 16, v123
    v_mul_f32 v18, 0xbfb8aa3b, v124
    v_exp_f32 v18, v18
    s_nop 0
    v_add_f32 v18, 1.0, v18
    v_rcp_f32 v18, v18
    s_nop 0
    v_mul_f32 v124, v124, v18
    v_cvt_pk_bf16_f32 v124, v124, v124
    v_lshlrev_b32 v124, 16, v124
    v_mul_f32 v18, 0xbfb8aa3b, v125
    v_exp_f32 v18, v18
    s_nop 0
    v_add_f32 v18, 1.0, v18
    v_rcp_f32 v18, v18
    s_nop 0
    v_mul_f32 v125, v125, v18
    v_cvt_pk_bf16_f32 v125, v125, v125
    v_lshlrev_b32 v125, 16, v125
    v_mul_f32 v18, 0xbfb8aa3b, v126
    v_exp_f32 v18, v18
    s_nop 0
    v_add_f32 v18, 1.0, v18
    v_rcp_f32 v18, v18
    s_nop 0
    v_mul_f32 v126, v126, v18
    v_cvt_pk_bf16_f32 v126, v126, v126
    v_lshlrev_b32 v126, 16, v126
    v_mul_f32 v18, 0xbfb8aa3b, v127
    v_exp_f32 v18, v18
    s_nop 0
    v_add_f32 v18, 1.0, v18
    v_rcp_f32 v18, v18
    s_nop 0
    v_mul_f32 v127, v127, v18
    v_cvt_pk_bf16_f32 v127, v127, v127
    v_lshlrev_b32 v127, 16, v127
    v_mov_b32 v96, 0
    v_mov_b32 v97, 0
    v_mov_b32 v98, 0
    v_mov_b32 v99, 0
    v_mov_b32 v100, 0
    v_mov_b32 v101, 0
    v_mov_b32 v102, 0
    v_mov_b32 v103, 0
    s_waitcnt vmcnt(15)
    v_lshlrev_b32 v18, 16, v32
    v_and_b32 v19, 0xffff0000, v32
    v_fmac_f32 v96, v18, v112
    v_fmac_f32 v97, v19, v112
    v_lshlrev_b32 v18, 16, v33
    v_and_b32 v19, 0xffff0000, v33
    v_fmac_f32 v98, v18, v112
    v_fmac_f32 v99, v19, v112
    v_lshlrev_b32 v18, 16, v34
    v_and_b32 v19, 0xffff0000, v34
    v_fmac_f32 v100, v18, v112
    v_fmac_f32 v101, v19, v112
    v_lshlrev_b32 v18, 16, v35
    v_and_b32 v19, 0xffff0000, v35
    v_fmac_f32 v102, v18, v112
    v_fmac_f32 v103, v19, v112
    s_waitcnt vmcnt(14)
    v_lshlrev_b32 v18, 16, v36
    v_and_b32 v19, 0xffff0000, v36
    v_fmac_f32 v96, v18, v113
    v_fmac_f32 v97, v19, v113
    v_lshlrev_b32 v18, 16, v37
    v_and_b32 v19, 0xffff0000, v37
    v_fmac_f32 v98, v18, v113
    v_fmac_f32 v99, v19, v113
    v_lshlrev_b32 v18, 16, v38
    v_and_b32 v19, 0xffff0000, v38
    v_fmac_f32 v100, v18, v113
    v_fmac_f32 v101, v19, v113
    v_lshlrev_b32 v18, 16, v39
    v_and_b32 v19, 0xffff0000, v39
    v_fmac_f32 v102, v18, v113
    v_fmac_f32 v103, v19, v113
    s_waitcnt vmcnt(13)
    v_lshlrev_b32 v18, 16, v40
    v_and_b32 v19, 0xffff0000, v40
    v_fmac_f32 v96, v18, v114
    v_fmac_f32 v97, v19, v114
    v_lshlrev_b32 v18, 16, v41
    v_and_b32 v19, 0xffff0000, v41
    v_fmac_f32 v98, v18, v114
    v_fmac_f32 v99, v19, v114
    v_lshlrev_b32 v18, 16, v42
    v_and_b32 v19, 0xffff0000, v42
    v_fmac_f32 v100, v18, v114
    v_fmac_f32 v101, v19, v114
    v_lshlrev_b32 v18, 16, v43
    v_and_b32 v19, 0xffff0000, v43
    v_fmac_f32 v102, v18, v114
    v_fmac_f32 v103, v19, v114
    s_waitcnt vmcnt(12)
    v_lshlrev_b32 v18, 16, v44
    v_and_b32 v19, 0xffff0000, v44
    v_fmac_f32 v96, v18, v115
    v_fmac_f32 v97, v19, v115
    v_lshlrev_b32 v18, 16, v45
    v_and_b32 v19, 0xffff0000, v45
    v_fmac_f32 v98, v18, v115
    v_fmac_f32 v99, v19, v115
    v_lshlrev_b32 v18, 16, v46
    v_and_b32 v19, 0xffff0000, v46
    v_fmac_f32 v100, v18, v115
    v_fmac_f32 v101, v19, v115
    v_lshlrev_b32 v18, 16, v47
    v_and_b32 v19, 0xffff0000, v47
    v_fmac_f32 v102, v18, v115
    v_fmac_f32 v103, v19, v115
    s_waitcnt vmcnt(11)
    v_lshlrev_b32 v18, 16, v48
    v_and_b32 v19, 0xffff0000, v48
    v_fmac_f32 v96, v18, v116
    v_fmac_f32 v97, v19, v116
    v_lshlrev_b32 v18, 16, v49
    v_and_b32 v19, 0xffff0000, v49
    v_fmac_f32 v98, v18, v116
    v_fmac_f32 v99, v19, v116
    v_lshlrev_b32 v18, 16, v50
    v_and_b32 v19, 0xffff0000, v50
    v_fmac_f32 v100, v18, v116
    v_fmac_f32 v101, v19, v116
    v_lshlrev_b32 v18, 16, v51
    v_and_b32 v19, 0xffff0000, v51
    v_fmac_f32 v102, v18, v116
    v_fmac_f32 v103, v19, v116
    s_waitcnt vmcnt(10)
    v_lshlrev_b32 v18, 16, v52
    v_and_b32 v19, 0xffff0000, v52
    v_fmac_f32 v96, v18, v117
    v_fmac_f32 v97, v19, v117
    v_lshlrev_b32 v18, 16, v53
    v_and_b32 v19, 0xffff0000, v53
    v_fmac_f32 v98, v18, v117
    v_fmac_f32 v99, v19, v117
    v_lshlrev_b32 v18, 16, v54
    v_and_b32 v19, 0xffff0000, v54
    v_fmac_f32 v100, v18, v117
    v_fmac_f32 v101, v19, v117
    v_lshlrev_b32 v18, 16, v55
    v_and_b32 v19, 0xffff0000, v55
    v_fmac_f32 v102, v18, v117
    v_fmac_f32 v103, v19, v117
    s_waitcnt vmcnt(9)
    v_lshlrev_b32 v18, 16, v56
    v_and_b32 v19, 0xffff0000, v56
    v_fmac_f32 v96, v18, v118
    v_fmac_f32 v97, v19, v118
    v_lshlrev_b32 v18, 16, v57
    v_and_b32 v19, 0xffff0000, v57
    v_fmac_f32 v98, v18, v118
    v_fmac_f32 v99, v19, v118
    v_lshlrev_b32 v18, 16, v58
    v_and_b32 v19, 0xffff0000, v58
    v_fmac_f32 v100, v18, v118
    v_fmac_f32 v101, v19, v118
    v_lshlrev_b32 v18, 16, v59
    v_and_b32 v19, 0xffff0000, v59
    v_fmac_f32 v102, v18, v118
    v_fmac_f32 v103, v19, v118
    s_waitcnt vmcnt(8)
    v_lshlrev_b32 v18, 16, v60
    v_and_b32 v19, 0xffff0000, v60
    v_fmac_f32 v96, v18, v119
    v_fmac_f32 v97, v19, v119
    v_lshlrev_b32 v18, 16, v61
    v_and_b32 v19, 0xffff0000, v61
    v_fmac_f32 v98, v18, v119
    v_fmac_f32 v99, v19, v119
    v_lshlrev_b32 v18, 16, v62
    v_and_b32 v19, 0xffff0000, v62
    v_fmac_f32 v100, v18, v119
    v_fmac_f32 v101, v19, v119
    v_lshlrev_b32 v18, 16, v63
    v_and_b32 v19, 0xffff0000, v63
    v_fmac_f32 v102, v18, v119
    v_fmac_f32 v103, v19, v119
    s_waitcnt vmcnt(7)
    v_lshlrev_b32 v18, 16, v64
    v_and_b32 v19, 0xffff0000, v64
    v_fmac_f32 v96, v18, v120
    v_fmac_f32 v97, v19, v120
    v_lshlrev_b32 v18, 16, v65
    v_and_b32 v19, 0xffff0000, v65
    v_fmac_f32 v98, v18, v120
    v_fmac_f32 v99, v19, v120
    v_lshlrev_b32 v18, 16, v66
    v_and_b32 v19, 0xffff0000, v66
    v_fmac_f32 v100, v18, v120
    v_fmac_f32 v101, v19, v120
    v_lshlrev_b32 v18, 16, v67
    v_and_b32 v19, 0xffff0000, v67
    v_fmac_f32 v102, v18, v120
    v_fmac_f32 v103, v19, v120
    s_waitcnt vmcnt(6)
    v_lshlrev_b32 v18, 16, v68
    v_and_b32 v19, 0xffff0000, v68
    v_fmac_f32 v96, v18, v121
    v_fmac_f32 v97, v19, v121
    v_lshlrev_b32 v18, 16, v69
    v_and_b32 v19, 0xffff0000, v69
    v_fmac_f32 v98, v18, v121
    v_fmac_f32 v99, v19, v121
    v_lshlrev_b32 v18, 16, v70
    v_and_b32 v19, 0xffff0000, v70
    v_fmac_f32 v100, v18, v121
    v_fmac_f32 v101, v19, v121
    v_lshlrev_b32 v18, 16, v71
    v_and_b32 v19, 0xffff0000, v71
    v_fmac_f32 v102, v18, v121
    v_fmac_f32 v103, v19, v121
    s_waitcnt vmcnt(5)
    v_lshlrev_b32 v18, 16, v72
    v_and_b32 v19, 0xffff0000, v72
    v_fmac_f32 v96, v18, v122
    v_fmac_f32 v97, v19, v122
    v_lshlrev_b32 v18, 16, v73
    v_and_b32 v19, 0xffff0000, v73
    v_fmac_f32 v98, v18, v122
    v_fmac_f32 v99, v19, v122
    v_lshlrev_b32 v18, 16, v74
    v_and_b32 v19, 0xffff0000, v74
    v_fmac_f32 v100, v18, v122
    v_fmac_f32 v101, v19, v122
    v_lshlrev_b32 v18, 16, v75
    v_and_b32 v19, 0xffff0000, v75
    v_fmac_f32 v102, v18, v122
    v_fmac_f32 v103, v19, v122
    s_waitcnt vmcnt(4)
    v_lshlrev_b32 v18, 16, v76
    v_and_b32 v19, 0xffff0000, v76
    v_fmac_f32 v96, v18, v123
    v_fmac_f32 v97, v19, v123
    v_lshlrev_b32 v18, 16, v77
    v_and_b32 v19, 0xffff0000, v77
    v_fmac_f32 v98, v18, v123
    v_fmac_f32 v99, v19, v123
    v_lshlrev_b32 v18, 16, v78
    v_and_b32 v19, 0xffff0000, v78
    v_fmac_f32 v100, v18, v123
    v_fmac_f32 v101, v19, v123
    v_lshlrev_b32 v18, 16, v79
    v_and_b32 v19, 0xffff0000, v79
    v_fmac_f32 v102, v18, v123
    v_fmac_f32 v103, v19, v123
    s_waitcnt vmcnt(3)
    v_lshlrev_b32 v18, 16, v80
    v_and_b32 v19, 0xffff0000, v80
    v_fmac_f32 v96, v18, v124
    v_fmac_f32 v97, v19, v124
    v_lshlrev_b32 v18, 16, v81
    v_and_b32 v19, 0xffff0000, v81
    v_fmac_f32 v98, v18, v124
    v_fmac_f32 v99, v19, v124
    v_lshlrev_b32 v18, 16, v82
    v_and_b32 v19, 0xffff0000, v82
    v_fmac_f32 v100, v18, v124
    v_fmac_f32 v101, v19, v124
    v_lshlrev_b32 v18, 16, v83
    v_and_b32 v19, 0xffff0000, v83
    v_fmac_f32 v102, v18, v124
    v_fmac_f32 v103, v19, v124
    s_waitcnt vmcnt(2)
    v_lshlrev_b32 v18, 16, v84
    v_and_b32 v19, 0xffff0000, v84
    v_fmac_f32 v96, v18, v125
    v_fmac_f32 v97, v19, v125
    v_lshlrev_b32 v18, 16, v85
    v_and_b32 v19, 0xffff0000, v85
    v_fmac_f32 v98, v18, v125
    v_fmac_f32 v99, v19, v125
    v_lshlrev_b32 v18, 16, v86
    v_and_b32 v19, 0xffff0000, v86
    v_fmac_f32 v100, v18, v125
    v_fmac_f32 v101, v19, v125
    v_lshlrev_b32 v18, 16, v87
    v_and_b32 v19, 0xffff0000, v87
    v_fmac_f32 v102, v18, v125
    v_fmac_f32 v103, v19, v125
    s_waitcnt vmcnt(1)
    v_lshlrev_b32 v18, 16, v88
    v_and_b32 v19, 0xffff0000, v88
    v_fmac_f32 v96, v18, v126
    v_fmac_f32 v97, v19, v126
    v_lshlrev_b32 v18, 16, v89
    v_and_b32 v19, 0xffff0000, v89
    v_fmac_f32 v98, v18, v126
    v_fmac_f32 v99, v19, v126
    v_lshlrev_b32 v18, 16, v90
    v_and_b32 v19, 0xffff0000, v90
    v_fmac_f32 v100, v18, v126
    v_fmac_f32 v101, v19, v126
    v_lshlrev_b32 v18, 16, v91
    v_and_b32 v19, 0xffff0000, v91
    v_fmac_f32 v102, v18, v126
    v_fmac_f32 v103, v19, v126
    s_waitcnt vmcnt(0)
    v_lshlrev_b32 v18, 16, v92
    v_and_b32 v19, 0xffff0000, v92
    v_fmac_f32 v96, v18, v127
    v_fmac_f32 v97, v19, v127
    v_lshlrev_b32 v18, 16, v93
    v_and_b32 v19, 0xffff0000, v93
    v_fmac_f32 v98, v18, v127
    v_fmac_f32 v99, v19, v127
    v_lshlrev_b32 v18, 16, v94
    v_and_b32 v19, 0xffff0000, v94
    v_fmac_f32 v100, v18, v127
    v_fmac_f32 v101, v19, v127
    v_lshlrev_b32 v18, 16, v95
    v_and_b32 v19, 0xffff0000, v95
    v_fmac_f32 v102, v18, v127
    v_fmac_f32 v103, v19, v127
    v_lshlrev_b32 v16, 5, v0
    ds_write_b128 v16, v[96:99]
    ds_write_b128 v16, v[100:103] offset:16
    s_waitcnt lgkmcnt(0)
    s_barrier
    s_cmp_lg_u32 s44, 0
    s_cbranch_scc1 L_mod_fin_110
    v_mov_b32 v18, 0
    ds_read_b32 v32, v12 offset:0
    ds_read_b32 v33, v12 offset:256
    ds_read_b32 v34, v12 offset:512
    ds_read_b32 v35, v12 offset:768
    ds_read_b32 v36, v12 offset:1024
    ds_read_b32 v37, v12 offset:1280
    ds_read_b32 v38, v12 offset:1536
    ds_read_b32 v39, v12 offset:1792
    ds_read_b32 v40, v12 offset:2048
    ds_read_b32 v41, v12 offset:2304
    ds_read_b32 v42, v12 offset:2560
    ds_read_b32 v43, v12 offset:2816
    ds_read_b32 v44, v12 offset:3072
    ds_read_b32 v45, v12 offset:3328
    ds_read_b32 v46, v12 offset:3584
    ds_read_b32 v47, v12 offset:3840
    s_waitcnt lgkmcnt(0)
    v_add_f32 v18, v18, v32
    v_add_f32 v18, v18, v33
    v_add_f32 v18, v18, v34
    v_add_f32 v18, v18, v35
    v_add_f32 v18, v18, v36
    v_add_f32 v18, v18, v37
    v_add_f32 v18, v18, v38
    v_add_f32 v18, v18, v39
    v_add_f32 v18, v18, v40
    v_add_f32 v18, v18, v41
    v_add_f32 v18, v18, v42
    v_add_f32 v18, v18, v43
    v_add_f32 v18, v18, v44
    v_add_f32 v18, v18, v45
    v_add_f32 v18, v18, v46
    v_add_f32 v18, v18, v47
    ds_read_b32 v32, v12 offset:4096
    ds_read_b32 v33, v12 offset:4352
    ds_read_b32 v34, v12 offset:4608
    ds_read_b32 v35, v12 offset:4864
    ds_read_b32 v36, v12 offset:5120
    ds_read_b32 v37, v12 offset:5376
    ds_read_b32 v38, v12 offset:5632
    ds_read_b32 v39, v12 offset:5888
    ds_read_b32 v40, v12 offset:6144
    ds_read_b32 v41, v12 offset:6400
    ds_read_b32 v42, v12 offset:6656
    ds_read_b32 v43, v12 offset:6912
    ds_read_b32 v44, v12 offset:7168
    ds_read_b32 v45, v12 offset:7424
    ds_read_b32 v46, v12 offset:7680
    ds_read_b32 v47, v12 offset:7936
    s_waitcnt lgkmcnt(0)
    v_add_f32 v18, v18, v32
    v_add_f32 v18, v18, v33
    v_add_f32 v18, v18, v34
    v_add_f32 v18, v18, v35
    v_add_f32 v18, v18, v36
    v_add_f32 v18, v18, v37
    v_add_f32 v18, v18, v38
    v_add_f32 v18, v18, v39
    v_add_f32 v18, v18, v40
    v_add_f32 v18, v18, v41
    v_add_f32 v18, v18, v42
    v_add_f32 v18, v18, v43
    v_add_f32 v18, v18, v44
    v_add_f32 v18, v18, v45
    v_add_f32 v18, v18, v46
    v_add_f32 v18, v18, v47
    s_lshr_b32 s45, s39, 1
    s_lshl_b32 s45, s45, 8
    s_mul_i32 s46, s47, 24576
    s_add_u32 s45, s45, s46
    buffer_store_dword v18, v12, s[12:15], s45 offen sc1
L_mod_fin_110:
    s_waitcnt vmcnt(0)
    s_barrier
    s_cmp_lg_u32 s44, 0
    s_cbranch_scc1 L_cnt_111
    v_mov_b32 v30, 1
    v_mov_b32 v31, 127232
    s_mov_b64 exec, 1
    buffer_atomic_add v30, v31, s[12:15], 0 offen sc1
    s_mov_b64 exec, -1
L_cnt_111:
    s_sub_u32 s90, 2, s43
    s_cmp_eq_u32 s43, 2
    s_cselect_b32 s51, 22, 10
    s_cmp_eq_u32 s43, 0
    s_cselect_b32 s51, 0, s51
    s_cmp_eq_u32 s51, 0
    s_cbranch_scc1 L_w_roles_100
    s_sub_u32 s60, 64, s51
    s_mov_b32 s91, 64
    s_mov_b32 s71, 127104
    s_lshl_b32 s61, s41, 7
    s_lshl_b32 s45, s90, 2
    s_add_u32 s61, s61, s45
    s_add_u32 s61, s61, 0x10020
    s_branch L_w_kv_99_h
L_w_kv_99:
    s_mov_b32 s90, s43
    s_mov_b32 s60, 0
    s_mov_b32 s51, 1
    s_mov_b32 s71, 126976
    s_cmp_eq_u32 s43, 0
    s_cselect_b32 s91, 42, 54
    s_cmp_eq_u32 s43, 2
    s_cselect_b32 s91, 64, s91
L_w_kv_99_h:
    s_lshl_b32 s45, s90, 3
    s_add_u32 s45, s45, 16
    s_load_dwordx2 s[6:7], s[0:1], s45
    s_waitcnt lgkmcnt(0)
    s_mov_b32 s24, s6
    s_and_b32 s25, s7, 0xffff
    s_mov_b32 s26, 0x800000
    s_mov_b32 s27, 0x00020000
    s_lshl_b32 s46, s41, 8
    s_barrier
    v_lshrrev_b32 v20, 4, v1
    s_lshl_b32 s45, s44, 2
    v_add_u32 v21, s45, v20
    s_mov_b32 s45, 8192
    v_mul_lo_u32 v21, v21, s45
    v_lshlrev_b32 v22, 2, v20
    v_and_b32 v23, 15, v1
    v_xor_b32 v22, v22, v23
    v_lshlrev_b32 v22, 4, v22
    v_add_u32 v21, v21, v22
    v_bfe_u32 v22, v1, 2, 2
    v_lshlrev_b32 v23, 3, v20
    v_add_u32 v23, v23, v22
    v_lshlrev_b32 v23, 8, v23
    v_xor_b32 v22, s44, v22
    v_lshlrev_b32 v22, 6, v22
    v_add_u32 v23, v23, v22
    v_and_b32 v22, 3, v1
    v_lshlrev_b32 v22, 4, v22
    v_add_u32 v23, v23, v22
    v_add_u32 v24, 65536, v23
    v_add_u32 v25, 131072, v23
    s_lshl_b32 s47, s44, 10
    s_add_u32 s45, s46, 0x0
    s_add_u32 m0, s47, 0
    s_nop 0
    buffer_load_dwordx4 v21, s[24:27], s45 offen  lds
    s_add_u32 s45, s46, 0x20000
    s_add_u32 m0, s47, 4096
    s_nop 0
    buffer_load_dwordx4 v21, s[24:27], s45 offen  lds
    s_add_u32 s45, s46, 0x40000
    s_add_u32 m0, s47, 8192
    s_nop 0
    buffer_load_dwordx4 v21, s[24:27], s45 offen  lds
    s_add_u32 s45, s46, 0x60000
    s_add_u32 m0, s47, 12288
    s_nop 0
    buffer_load_dwordx4 v21, s[24:27], s45 offen  lds
    s_add_u32 s45, s46, 0x80000
    s_add_u32 m0, s47, 16384
    s_nop 0
    buffer_load_dwordx4 v21, s[24:27], s45 offen  lds
    s_add_u32 s45, s46, 0xa0000
    s_add_u32 m0, s47, 20480
    s_nop 0
    buffer_load_dwordx4 v21, s[24:27], s45 offen  lds
    s_add_u32 s45, s46, 0xc0000
    s_add_u32 m0, s47, 24576
    s_nop 0
    buffer_load_dwordx4 v21, s[24:27], s45 offen  lds
    s_add_u32 s45, s46, 0xe0000
    s_add_u32 m0, s47, 28672
    s_nop 0
    buffer_load_dwordx4 v21, s[24:27], s45 offen  lds
    s_add_u32 s45, s46, 0x100000
    s_add_u32 m0, s47, 32768
    s_nop 0
    buffer_load_dwordx4 v21, s[24:27], s45 offen  lds
    s_add_u32 s45, s46, 0x120000
    s_add_u32 m0, s47, 36864
    s_nop 0
    buffer_load_dwordx4 v21, s[24:27], s45 offen  lds
    s_add_u32 s45, s46, 0x140000
    s_add_u32 m0, s47, 40960
    s_nop 0
    buffer_load_dwordx4 v21, s[24:27], s45 offen  lds
    s_add_u32 s45, s46, 0x160000
    s_add_u32 m0, s47, 45056
    s_nop 0
    buffer_load_dwordx4 v21, s[24:27], s45 offen  lds
    s_add_u32 s45, s46, 0x180000
    s_add_u32 m0, s47, 49152
    s_nop 0
    buffer_load_dwordx4 v21, s[24:27], s45 offen  lds
    s_add_u32 s45, s46, 0x1a0000
    s_add_u32 m0, s47, 53248
    s_nop 0
    buffer_load_dwordx4 v21, s[24:27], s45 offen  lds
    s_add_u32 s45, s46, 0x1c0000
    s_add_u32 m0, s47, 57344
    s_nop 0
    buffer_load_dwordx4 v21, s[24:27], s45 offen  lds
    s_add_u32 s45, s46, 0x1e0000
    s_add_u32 m0, s47, 61440
    s_nop 0
    buffer_load_dwordx4 v21, s[24:27], s45 offen  lds
    s_add_u32 s45, s46, 0x200000
    s_add_u32 m0, s47, 65536
    s_nop 0
    buffer_load_dwordx4 v21, s[24:27], s45 offen  lds
    s_add_u32 s45, s46, 0x220000
    s_add_u32 m0, s47, 69632
    s_nop 0
    buffer_load_dwordx4 v21, s[24:27], s45 offen  lds
    s_add_u32 s45, s46, 0x240000
    s_add_u32 m0, s47, 73728
    s_nop 0
    buffer_load_dwordx4 v21, s[24:27], s45 offen  lds
    s_add_u32 s45, s46, 0x260000
    s_add_u32 m0, s47, 77824
    s_nop 0
    buffer_load_dwordx4 v21, s[24:27], s45 offen  lds
    s_add_u32 s45, s46, 0x280000
    s_add_u32 m0, s47, 81920
    s_nop 0
    buffer_load_dwordx4 v21, s[24:27], s45 offen  lds
    s_add_u32 s45, s46, 0x2a0000
    s_add_u32 m0, s47, 86016
    s_nop 0
    buffer_load_dwordx4 v21, s[24:27], s45 offen  lds
    s_add_u32 s45, s46, 0x2c0000
    s_add_u32 m0, s47, 90112
    s_nop 0
    buffer_load_dwordx4 v21, s[24:27], s45 offen  lds
    s_add_u32 s45, s46, 0x2e0000
    s_add_u32 m0, s47, 94208
    s_nop 0
    buffer_load_dwordx4 v21, s[24:27], s45 offen  lds
    s_add_u32 s45, s46, 0x300000
    s_add_u32 m0, s47, 98304
    s_nop 0
    buffer_load_dwordx4 v21, s[24:27], s45 offen  lds
    s_add_u32 s45, s46, 0x320000
    s_add_u32 m0, s47, 102400
    s_nop 0
    buffer_load_dwordx4 v21, s[24:27], s45 offen  lds
    s_add_u32 s45, s46, 0x340000
    s_add_u32 m0, s47, 106496
    s_nop 0
    buffer_load_dwordx4 v21, s[24:27], s45 offen  lds
    s_add_u32 s45, s46, 0x360000
    s_add_u32 m0, s47, 110592
    s_nop 0
    buffer_load_dwordx4 v21, s[24:27], s45 offen  lds
    s_add_u32 s45, s46, 0x380000
    s_add_u32 m0, s47, 114688
    s_nop 0
    buffer_load_dwordx4 v21, s[24:27], s45 offen  lds
    s_add_u32 s45, s46, 0x3a0000
    s_add_u32 m0, s47, 118784
    s_nop 0
    buffer_load_dwordx4 v21, s[24:27], s45 offen  lds
    s_add_u32 s45, s46, 0x3c0000
    s_add_u32 m0, s47, 122880
    s_nop 0
    buffer_load_dwordx4 v21, s[24:27], s45 offen  lds
    s_add_u32 s45, s46, 0x3e0000
    s_add_u32 m0, s47, 126976
    s_nop 0
    buffer_load_dwordx4 v21, s[24:27], s45 offen  lds
    s_waitcnt vmcnt(28)
    s_barrier
    s_add_u32 s45, s46, 0x400000
    s_add_u32 m0, s47, 131072
    s_nop 0
    buffer_load_dwordx4 v21, s[24:27], s45 offen  lds
    s_add_u32 s45, s46, 0x420000
    s_add_u32 m0, s47, 135168
    s_nop 0
    buffer_load_dwordx4 v21, s[24:27], s45 offen  lds
    s_add_u32 s45, s46, 0x440000
    s_add_u32 m0, s47, 139264
    s_nop 0
    buffer_load_dwordx4 v21, s[24:27], s45 offen  lds
    s_add_u32 s45, s46, 0x460000
    s_add_u32 m0, s47, 143360
    s_nop 0
    buffer_load_dwordx4 v21, s[24:27], s45 offen  lds
    ds_read_b64_tr_b16 a[0:1], v23 offset:0
    ds_read_b64_tr_b16 a[2:3], v23 offset:1024
    ds_read_b64_tr_b16 a[4:5], v23 offset:8
    ds_read_b64_tr_b16 a[6:7], v23 offset:1032
    ds_read_b64_tr_b16 a[8:9], v23 offset:8192
    ds_read_b64_tr_b16 a[10:11], v23 offset:9216
    ds_read_b64_tr_b16 a[12:13], v23 offset:8200
    ds_read_b64_tr_b16 a[14:15], v23 offset:9224
    s_waitcnt lgkmcnt(0)
    s_waitcnt vmcnt(28)
    s_barrier
    s_add_u32 s45, s46, 0x480000
    s_add_u32 m0, s47, 0
    s_nop 0
    buffer_load_dwordx4 v21, s[24:27], s45 offen  lds
    s_add_u32 s45, s46, 0x4a0000
    s_add_u32 m0, s47, 4096
    s_nop 0
    buffer_load_dwordx4 v21, s[24:27], s45 offen  lds
    s_add_u32 s45, s46, 0x4c0000
    s_add_u32 m0, s47, 8192
    s_nop 0
    buffer_load_dwordx4 v21, s[24:27], s45 offen  lds
    s_add_u32 s45, s46, 0x4e0000
    s_add_u32 m0, s47, 12288
    s_nop 0
    buffer_load_dwordx4 v21, s[24:27], s45 offen  lds
    ds_read_b64_tr_b16 a[16:17], v23 offset:16384
    ds_read_b64_tr_b16 a[18:19], v23 offset:17408
    ds_read_b64_tr_b16 a[20:21], v23 offset:16392
    ds_read_b64_tr_b16 a[22:23], v23 offset:17416
    ds_read_b64_tr_b16 a[24:25], v23 offset:24576
    ds_read_b64_tr_b16 a[26:27], v23 offset:25600
    ds_read_b64_tr_b16 a[28:29], v23 offset:24584
    ds_read_b64_tr_b16 a[30:31], v23 offset:25608
    s_waitcnt lgkmcnt(0)
    s_waitcnt vmcnt(28)
    s_barrier
    s_add_u32 s45, s46, 0x500000
    s_add_u32 m0, s47, 16384
    s_nop 0
    buffer_load_dwordx4 v21, s[24:27], s45 offen  lds
    s_add_u32 s45, s46, 0x520000
    s_add_u32 m0, s47, 20480
    s_nop 0
    buffer_load_dwordx4 v21, s[24:27], s45 offen  lds
    s_add_u32 s45, s46, 0x540000
    s_add_u32 m0, s47, 24576
    s_nop 0
    buffer_load_dwordx4 v21, s[24:27], s45 offen  lds
    s_add_u32 s45, s46, 0x560000
    s_add_u32 m0, s47, 28672
    s_nop 0
    buffer_load_dwordx4 v21, s[24:27], s45 offen  lds
    ds_read_b64_tr_b16 a[32:33], v23 offset:32768
    ds_read_b64_tr_b16 a[34:35], v23 offset:33792
    ds_read_b64_tr_b16 a[36:37], v23 offset:32776
    ds_read_b64_tr_b16 a[38:39], v23 offset:33800
    ds_read_b64_tr_b16 a[40:41], v23 offset:40960
    ds_read_b64_tr_b16 a[42:43], v23 offset:41984
    ds_read_b64_tr_b16 a[44:45], v23 offset:40968
    ds_read_b64_tr_b16 a[46:47], v23 offset:41992
    s_waitcnt lgkmcnt(0)
    s_waitcnt vmcnt(28)
    s_barrier
    s_add_u32 s45, s46, 0x580000
    s_add_u32 m0, s47, 32768
    s_nop 0
    buffer_load_dwordx4 v21, s[24:27], s45 offen  lds
    s_add_u32 s45, s46, 0x5a0000
    s_add_u32 m0, s47, 36864
    s_nop 0
    buffer_load_dwordx4 v21, s[24:27], s45 offen  lds
    s_add_u32 s45, s46, 0x5c0000
    s_add_u32 m0, s47, 40960
    s_nop 0
    buffer_load_dwordx4 v21, s[24:27], s45 offen  lds
    s_add_u32 s45, s46, 0x5e0000
    s_add_u32 m0, s47, 45056
    s_nop 0
    buffer_load_dwordx4 v21, s[24:27], s45 offen  lds
    ds_read_b64_tr_b16 a[48:49], v23 offset:49152
    ds_read_b64_tr_b16 a[50:51], v23 offset:50176
    ds_read_b64_tr_b16 a[52:53], v23 offset:49160
    ds_read_b64_tr_b16 a[54:55], v23 offset:50184
    ds_read_b64_tr_b16 a[56:57], v23 offset:57344
    ds_read_b64_tr_b16 a[58:59], v23 offset:58368
    ds_read_b64_tr_b16 a[60:61], v23 offset:57352
    ds_read_b64_tr_b16 a[62:63], v23 offset:58376
    s_waitcnt lgkmcnt(0)
    s_waitcnt vmcnt(28)
    s_barrier
    s_add_u32 s45, s46, 0x600000
    s_add_u32 m0, s47, 49152
    s_nop 0
    buffer_load_dwordx4 v21, s[24:27], s45 offen  lds
    s_add_u32 s45, s46, 0x620000
    s_add_u32 m0, s47, 53248
    s_nop 0
    buffer_load_dwordx4 v21, s[24:27], s45 offen  lds
    s_add_u32 s45, s46, 0x640000
    s_add_u32 m0, s47, 57344
    s_nop 0
    buffer_load_dwordx4 v21, s[24:27], s45 offen  lds
    s_add_u32 s45, s46, 0x660000
    s_add_u32 m0, s47, 61440
    s_nop 0
    buffer_load_dwordx4 v21, s[24:27], s45 offen  lds
    ds_read_b64_tr_b16 a[64:65], v24 offset:0
    ds_read_b64_tr_b16 a[66:67], v24 offset:1024
    ds_read_b64_tr_b16 a[68:69], v24 offset:8
    ds_read_b64_tr_b16 a[70:71], v24 offset:1032
    ds_read_b64_tr_b16 a[72:73], v24 offset:8192
    ds_read_b64_tr_b16 a[74:75], v24 offset:9216
    ds_read_b64_tr_b16 a[76:77], v24 offset:8200
    ds_read_b64_tr_b16 a[78:79], v24 offset:9224
    s_waitcnt lgkmcnt(0)
    s_waitcnt vmcnt(28)
    s_barrier
    s_add_u32 s45, s46, 0x680000
    s_add_u32 m0, s47, 65536
    s_nop 0
    buffer_load_dwordx4 v21, s[24:27], s45 offen  lds
    s_add_u32 s45, s46, 0x6a0000
    s_add_u32 m0, s47, 69632
    s_nop 0
    buffer_load_dwordx4 v21, s[24:27], s45 offen  lds
    s_add_u32 s45, s46, 0x6c0000
    s_add_u32 m0, s47, 73728
    s_nop 0
    buffer_load_dwordx4 v21, s[24:27], s45 offen  lds
    s_add_u32 s45, s46, 0x6e0000
    s_add_u32 m0, s47, 77824
    s_nop 0
    buffer_load_dwordx4 v21, s[24:27], s45 offen  lds
    ds_read_b64_tr_b16 a[80:81], v24 offset:16384
    ds_read_b64_tr_b16 a[82:83], v24 offset:17408
    ds_read_b64_tr_b16 a[84:85], v24 offset:16392
    ds_read_b64_tr_b16 a[86:87], v24 offset:17416
    ds_read_b64_tr_b16 a[88:89], v24 offset:24576
    ds_read_b64_tr_b16 a[90:91], v24 offset:25600
    ds_read_b64_tr_b16 a[92:93], v24 offset:24584
    ds_read_b64_tr_b16 a[94:95], v24 offset:25608
    s_waitcnt lgkmcnt(0)
    s_waitcnt vmcnt(28)
    s_barrier
    s_add_u32 s45, s46, 0x700000
    s_add_u32 m0, s47, 81920
    s_nop 0
    buffer_load_dwordx4 v21, s[24:27], s45 offen  lds
    s_add_u32 s45, s46, 0x720000
    s_add_u32 m0, s47, 86016
    s_nop 0
    buffer_load_dwordx4 v21, s[24:27], s45 offen  lds
    s_add_u32 s45, s46, 0x740000
    s_add_u32 m0, s47, 90112
    s_nop 0
    buffer_load_dwordx4 v21, s[24:27], s45 offen  lds
    s_add_u32 s45, s46, 0x760000
    s_add_u32 m0, s47, 94208
    s_nop 0
    buffer_load_dwordx4 v21, s[24:27], s45 offen  lds
    ds_read_b64_tr_b16 a[96:97], v24 offset:32768
    ds_read_b64_tr_b16 a[98:99], v24 offset:33792
    ds_read_b64_tr_b16 a[100:101], v24 offset:32776
    ds_read_b64_tr_b16 a[102:103], v24 offset:33800
    ds_read_b64_tr_b16 a[104:105], v24 offset:40960
    ds_read_b64_tr_b16 a[106:107], v24 offset:41984
    ds_read_b64_tr_b16 a[108:109], v24 offset:40968
    ds_read_b64_tr_b16 a[110:111], v24 offset:41992
    s_waitcnt lgkmcnt(0)
    s_waitcnt vmcnt(28)
    s_barrier
    s_add_u32 s45, s46, 0x780000
    s_add_u32 m0, s47, 98304
    s_nop 0
    buffer_load_dwordx4 v21, s[24:27], s45 offen  lds
    s_add_u32 s45, s46, 0x7a0000
    s_add_u32 m0, s47, 102400
    s_nop 0
    buffer_load_dwordx4 v21, s[24:27], s45 offen  lds
    s_add_u32 s45, s46, 0x7c0000
    s_add_u32 m0, s47, 106496
    s_nop 0
    buffer_load_dwordx4 v21, s[24:27], s45 offen  lds
    s_add_u32 s45, s46, 0x7e0000
    s_add_u32 m0, s47, 110592
    s_nop 0
    buffer_load_dwordx4 v21, s[24:27], s45 offen  lds
    ds_read_b64_tr_b16 a[112:113], v24 offset:49152
    ds_read_b64_tr_b16 a[114:115], v24 offset:50176
    ds_read_b64_tr_b16 a[116:117], v24 offset:49160
    ds_read_b64_tr_b16 a[118:119], v24 offset:50184
    ds_read_b64_tr_b16 a[120:121], v24 offset:57344
    ds_read_b64_tr_b16 a[122:123], v24 offset:58368
    ds_read_b64_tr_b16 a[124:125], v24 offset:57352
    ds_read_b64_tr_b16 a[126:127], v24 offset:58376
    s_waitcnt lgkmcnt(0)
    s_waitcnt vmcnt(28)
    s_barrier
    ds_read_b64_tr_b16 a[128:129], v25 offset:0
    ds_read_b64_tr_b16 a[130:131], v25 offset:1024
    ds_read_b64_tr_b16 a[132:133], v25 offset:8
    ds_read_b64_tr_b16 a[134:135], v25 offset:1032
    ds_read_b64_tr_b16 a[136:137], v25 offset:8192
    ds_read_b64_tr_b16 a[138:139], v25 offset:9216
    ds_read_b64_tr_b16 a[140:141], v25 offset:8200
    ds_read_b64_tr_b16 a[142:143], v25 offset:9224
    s_waitcnt lgkmcnt(0)
    s_waitcnt vmcnt(24)
    s_barrier
    ds_read_b64_tr_b16 a[144:145], v23 offset:0
    ds_read_b64_tr_b16 a[146:147], v23 offset:1024
    ds_read_b64_tr_b16 a[148:149], v23 offset:8
    ds_read_b64_tr_b16 a[150:151], v23 offset:1032
    ds_read_b64_tr_b16 a[152:153], v23 offset:8192
    ds_read_b64_tr_b16 a[154:155], v23 offset:9216
    ds_read_b64_tr_b16 a[156:157], v23 offset:8200
    ds_read_b64_tr_b16 a[158:159], v23 offset:9224
    s_waitcnt lgkmcnt(0)
    s_waitcnt vmcnt(20)
    s_barrier
    ds_read_b64_tr_b16 a[160:161], v23 offset:16384
    ds_read_b64_tr_b16 a[162:163], v23 offset:17408
    ds_read_b64_tr_b16 a[164:165], v23 offset:16392
    ds_read_b64_tr_b16 a[166:167], v23 offset:17416
    ds_read_b64_tr_b16 a[168:169], v23 offset:24576
    ds_read_b64_tr_b16 a[170:171], v23 offset:25600
    ds_read_b64_tr_b16 a[172:173], v23 offset:24584
    ds_read_b64_tr_b16 a[174:175], v23 offset:25608
    s_waitcnt lgkmcnt(0)
    s_waitcnt vmcnt(16)
    s_barrier
    ds_read_b64_tr_b16 a[176:177], v23 offset:32768
    ds_read_b64_tr_b16 a[178:179], v23 offset:33792
    ds_read_b64_tr_b16 a[180:181], v23 offset:32776
    ds_read_b64_tr_b16 a[182:183], v23 offset:33800
    ds_read_b64_tr_b16 a[184:185], v23 offset:40960
    ds_read_b64_tr_b16 a[186:187], v23 offset:41984
    ds_read_b64_tr_b16 a[188:189], v23 offset:40968
    ds_read_b64_tr_b16 a[190:191], v23 offset:41992
    s_waitcnt lgkmcnt(0)
    s_waitcnt vmcnt(12)
    s_barrier
    ds_read_b64_tr_b16 a[192:193], v23 offset:49152
    ds_read_b64_tr_b16 a[194:195], v23 offset:50176
    ds_read_b64_tr_b16 a[196:197], v23 offset:49160
    ds_read_b64_tr_b16 a[198:199], v23 offset:50184
    ds_read_b64_tr_b16 a[200:201], v23 offset:57344
    ds_read_b64_tr_b16 a[202:203], v23 offset:58368
    ds_read_b64_tr_b16 a[204:205], v23 offset:57352
    ds_read_b64_tr_b16 a[206:207], v23 offset:58376
    s_waitcnt lgkmcnt(0)
    s_waitcnt vmcnt(8)
    s_barrier
    ds_read_b64_tr_b16 a[208:209], v24 offset:0
    ds_read_b64_tr_b16 a[210:211], v24 offset:1024
    ds_read_b64_tr_b16 a[212:213], v24 offset:8
    ds_read_b64_tr_b16 a[214:215], v24 offset:1032
    ds_read_b64_tr_b16 a[216:217], v24 offset:8192
    ds_read_b64_tr_b16 a[218:219], v24 offset:9216
    ds_read_b64_tr_b16 a[220:221], v24 offset:8200
    ds_read_b64_tr_b16 a[222:223], v24 offset:9224
    s_waitcnt lgkmcnt(0)
    s_waitcnt vmcnt(4)
    s_barrier
    ds_read_b64_tr_b16 a[224:225], v24 offset:16384
    ds_read_b64_tr_b16 a[226:227], v24 offset:17408
    ds_read_b64_tr_b16 a[228:229], v24 offset:16392
    ds_read_b64_tr_b16 a[230:231], v24 offset:17416
    ds_read_b64_tr_b16 a[232:233], v24 offset:24576
    ds_read_b64_tr_b16 a[234:235], v24 offset:25600
    ds_read_b64_tr_b16 a[236:237], v24 offset:24584
    ds_read_b64_tr_b16 a[238:239], v24 offset:25608
    s_waitcnt lgkmcnt(0)
    s_waitcnt vmcnt(0)
    s_barrier
    ds_read_b64_tr_b16 a[240:241], v24 offset:32768
    ds_read_b64_tr_b16 a[242:243], v24 offset:33792
    ds_read_b64_tr_b16 a[244:245], v24 offset:32776
    ds_read_b64_tr_b16 a[246:247], v24 offset:33800
    ds_read_b64_tr_b16 a[248:249], v24 offset:40960
    ds_read_b64_tr_b16 a[250:251], v24 offset:41984
    ds_read_b64_tr_b16 a[252:253], v24 offset:40968
    ds_read_b64_tr_b16 a[254:255], v24 offset:41992
    s_waitcnt lgkmcnt(0)
    s_barrier
    s_cmp_lg_u32 s44, 0
    s_cbranch_scc1 L_pd_112
    v_mov_b32 v29, 8
    s_mov_b32 s46, 32
    s_mov_b64 exec, 1
    s_mov_b32 s70, 0
L_wp_113:
    buffer_load_dword v31, v29, s[16:19], 0 offen sc1
    s_add_u32 s70, s70, 1
    s_cmp_ge_u32 s70, 0x200000
    s_cbranch_scc1 L_w_done_98
L_wp_113_c:
    s_waitcnt vmcnt(0)
    v_cmp_gt_u32 vcc, s46, v31
    s_nop 1
    s_cbranch_vccz L_wp_113_ok
    s_sleep 3
    s_branch L_wp_113
L_wp_113_ok:
    s_mov_b64 exec, -1
L_pd_112:
    s_barrier
    s_mov_b32 s52, 0x400000
    s_lshl_b32 s56, s90, 5
    s_add_u32 s56, s56, s41
    s_lshl_b32 s56, s56, 19
    s_add_u32 s56, s56, 0x2000000
L_w_qkv_114:
    s_cmp_lg_u32 s44, 0
    s_cbranch_scc1 L_pd_115
    v_mov_b32 v29, s71
    s_mov_b32 s46, 96
    s_mov_b64 exec, 1
    s_mov_b32 s70, 0
L_wp_116:
    buffer_load_dword v31, v29, s[12:15], 0 offen sc1
    s_add_u32 s70, s70, 1
    s_cmp_ge_u32 s70, 0x200000
    s_cbranch_scc1 L_w_done_98
L_wp_116_c:
    s_waitcnt vmcnt(0)
    v_cmp_gt_u32 vcc, s46, v31
    s_nop 1
    s_cbranch_vccz L_wp_116_ok
    s_sleep 2
    s_branch L_wp_116
L_wp_116_ok:
    s_mov_b64 exec, -1
L_pd_115:
    s_barrier
L_w_qkv_114_n:
    s_mov_b32 s50, s60
    s_mul_i32 s53, s50, 65536
    s_add_u32 s53, s53, s52
    s_lshl_b32 s54, s44, 13
    s_add_u32 s53, s53, s54
    s_mul_i32 s57, s50, 8192
    s_add_u32 s57, s57, s56
    s_lshl_b32 s45, s44, 11
    s_add_u32 s57, s57, s45
    s_add_u32 s55, s54, 65536
    s_mov_b32 s58, 0
    v_mov_b32 v13, v3
    v_add_u32 v14, 65536, v13
    v_xor_b32 v15, 64, v13
    v_xor_b32 v16, 64, v14
    s_mov_b32 s76, 0x20000000
    s_add_u32 s48, s53, 0
    s_add_u32 s49, s48, 4096
    s_add_u32 m0, s54, 0
    s_nop 0
    buffer_load_dwordx4 v6, s[12:15], s48 offen offset:0 sc1 lds
    s_add_u32 m0, s54, 1024
    s_nop 0
    buffer_load_dwordx4 v9, s[12:15], s48 offen offset:0 sc1 lds
    s_add_u32 m0, s54, 2048
    s_nop 0
    buffer_load_dwordx4 v6, s[12:15], s49 offen offset:0 sc1 lds
    s_add_u32 m0, s54, 3072
    s_nop 0
    buffer_load_dwordx4 v9, s[12:15], s49 offen offset:0 sc1 lds
    s_add_u32 m0, s54, 3968
    s_nop 0
    buffer_load_dwordx4 v6, s[12:15], s48 offen offset:128 sc1 lds
    s_add_u32 m0, s54, 4992
    s_nop 0
    buffer_load_dwordx4 v9, s[12:15], s48 offen offset:128 sc1 lds
    s_add_u32 m0, s54, 6016
    s_nop 0
    buffer_load_dwordx4 v6, s[12:15], s49 offen offset:128 sc1 lds
    s_add_u32 m0, s54, 7040
    s_nop 0
    buffer_load_dwordx4 v9, s[12:15], s49 offen offset:128 sc1 lds
    s_add_u32 s48, s53, 32768
    s_add_u32 s49, s48, 4096
    s_add_u32 s46, s54, 32768
    s_add_u32 m0, s46, 0
    s_nop 0
    buffer_load_dwordx4 v6, s[12:15], s48 offen offset:0 sc1 lds
    s_add_u32 m0, s46, 1024
    s_nop 0
    buffer_load_dwordx4 v9, s[12:15], s48 offen offset:0 sc1 lds
    s_add_u32 m0, s46, 2048
    s_nop 0
    buffer_load_dwordx4 v6, s[12:15], s49 offen offset:0 sc1 lds
    s_add_u32 m0, s46, 3072
    s_nop 0
    buffer_load_dwordx4 v9, s[12:15], s49 offen offset:0 sc1 lds
    s_add_u32 m0, s46, 3968
    s_nop 0
    buffer_load_dwordx4 v6, s[12:15], s48 offen offset:128 sc1 lds
    s_add_u32 m0, s46, 4992
    s_nop 0
    buffer_load_dwordx4 v9, s[12:15], s48 offen offset:128 sc1 lds
    s_add_u32 m0, s46, 6016
    s_nop 0
    buffer_load_dwordx4 v6, s[12:15], s49 offen offset:128 sc1 lds
    s_add_u32 m0, s46, 7040
    s_nop 0
    buffer_load_dwordx4 v9, s[12:15], s49 offen offset:128 sc1 lds
    s_cmp_eq_u32 s51, 1
    s_cbranch_scc1 L_e_one_118
    s_add_u32 s48, s53, 65536
    s_add_u32 s49, s48, 4096
    s_add_u32 m0, s55, 0
    s_nop 0
    buffer_load_dwordx4 v6, s[12:15], s48 offen offset:0 sc1 lds
    s_add_u32 m0, s55, 1024
    s_nop 0
    buffer_load_dwordx4 v9, s[12:15], s48 offen offset:0 sc1 lds
    s_add_u32 m0, s55, 2048
    s_nop 0
    buffer_load_dwordx4 v6, s[12:15], s49 offen offset:0 sc1 lds
    s_add_u32 m0, s55, 3072
    s_nop 0
    buffer_load_dwordx4 v9, s[12:15], s49 offen offset:0 sc1 lds
    s_add_u32 m0, s55, 3968
    s_nop 0
    buffer_load_dwordx4 v6, s[12:15], s48 offen offset:128 sc1 lds
    s_add_u32 m0, s55, 4992
    s_nop 0
    buffer_load_dwordx4 v9, s[12:15], s48 offen offset:128 sc1 lds
    s_add_u32 m0, s55, 6016
    s_nop 0
    buffer_load_dwordx4 v6, s[12:15], s49 offen offset:128 sc1 lds
    s_add_u32 m0, s55, 7040
    s_nop 0
    buffer_load_dwordx4 v9, s[12:15], s49 offen offset:128 sc1 lds
    s_waitcnt vmcnt(16)
    s_barrier
    ds_read_b128 v[32:35], v13 offset:0
    ds_read_b128 v[36:39], v13 offset:2048
    ds_read_b128 v[40:43], v15 offset:0
    ds_read_b128 v[44:47], v15 offset:2048
    s_add_u32 s48, s53, 98304
    s_add_u32 s46, s58, 1
    s_cmp_lt_u32 s46, s51
    s_cselect_b32 s48, s48, 0x20000000
    s_add_u32 s49, s48, 4096
    s_add_u32 s59, s55, 32768
L_e_loop_117:
    s_waitcnt lgkmcnt(2)
    v_mfma_f32_16x16x32_bf16 v[80:83], a[0:3], v[32:35], 0
    ds_read_b128 v[48:51], v13 offset:4096
    v_mfma_f32_16x16x32_bf16 v[84:87], a[4:7], v[32:35], 0
    ds_read_b128 v[52:55], v13 offset:6144
    v_mfma_f32_16x16x32_bf16 v[88:91], a[0:3], v[36:39], 0
    ds_read_b128 v[56:59], v15 offset:4096
    s_add_u32 m0, s59, 0
    v_mfma_f32_16x16x32_bf16 v[92:95], a[4:7], v[36:39], 0
    ds_read_b128 v[60:63], v15 offset:6144
    buffer_load_dwordx4 v6, s[12:15], s48 offen offset:0 sc1 lds
    s_waitcnt lgkmcnt(4)
    v_mfma_f32_16x16x32_bf16 v[80:83], a[8:11], v[40:43], v[80:83]
    ds_read_b128 v[32:35], v13 offset:8192
    v_mfma_f32_16x16x32_bf16 v[84:87], a[12:15], v[40:43], v[84:87]
    ds_read_b128 v[36:39], v13 offset:10240
    v_mfma_f32_16x16x32_bf16 v[88:91], a[8:11], v[44:47], v[88:91]
    s_add_u32 m0, s59, 1024
    v_mfma_f32_16x16x32_bf16 v[92:95], a[12:15], v[44:47], v[92:95]
    buffer_load_dwordx4 v9, s[12:15], s48 offen offset:0 sc1 lds
    s_waitcnt lgkmcnt(4)
    v_mfma_f32_16x16x32_bf16 v[80:83], a[16:19], v[48:51], v[80:83]
    ds_read_b128 v[40:43], v15 offset:8192
    v_mfma_f32_16x16x32_bf16 v[84:87], a[20:23], v[48:51], v[84:87]
    ds_read_b128 v[44:47], v15 offset:10240
    v_mfma_f32_16x16x32_bf16 v[88:91], a[16:19], v[52:55], v[88:91]
    s_add_u32 m0, s59, 2048
    v_mfma_f32_16x16x32_bf16 v[92:95], a[20:23], v[52:55], v[92:95]
    buffer_load_dwordx4 v6, s[12:15], s49 offen offset:0 sc1 lds
    s_waitcnt lgkmcnt(4)
    v_mfma_f32_16x16x32_bf16 v[80:83], a[24:27], v[56:59], v[80:83]
    ds_read_b128 v[48:51], v13 offset:12288
    v_mfma_f32_16x16x32_bf16 v[84:87], a[28:31], v[56:59], v[84:87]
    ds_read_b128 v[52:55], v13 offset:14336
    v_mfma_f32_16x16x32_bf16 v[88:91], a[24:27], v[60:63], v[88:91]
    s_add_u32 m0, s59, 3072
    v_mfma_f32_16x16x32_bf16 v[92:95], a[28:31], v[60:63], v[92:95]
    buffer_load_dwordx4 v9, s[12:15], s49 offen offset:0 sc1 lds
    s_waitcnt lgkmcnt(4)
    v_mfma_f32_16x16x32_bf16 v[80:83], a[32:35], v[32:35], v[80:83]
    ds_read_b128 v[56:59], v15 offset:12288
    v_mfma_f32_16x16x32_bf16 v[84:87], a[36:39], v[32:35], v[84:87]
    ds_read_b128 v[60:63], v15 offset:14336
    v_mfma_f32_16x16x32_bf16 v[88:91], a[32:35], v[36:39], v[88:91]
    s_add_u32 m0, s59, 3968
    v_mfma_f32_16x16x32_bf16 v[92:95], a[36:39], v[36:39], v[92:95]
    buffer_load_dwordx4 v6, s[12:15], s48 offen offset:128 sc1 lds
    s_waitcnt lgkmcnt(4)
    v_mfma_f32_16x16x32_bf16 v[80:83], a[40:43], v[40:43], v[80:83]
    ds_read_b128 v[32:35], v13 offset:16384
    v_mfma_f32_16x16x32_bf16 v[84:87], a[44:47], v[40:43], v[84:87]
    ds_read_b128 v[36:39], v13 offset:18432
    v_mfma_f32_16x16x32_bf16 v[88:91], a[40:43], v[44:47], v[88:91]
    s_add_u32 m0, s59, 4992
    v_mfma_f32_16x16x32_bf16 v[92:95], a[44:47], v[44:47], v[92:95]
    buffer_load_dwordx4 v9, s[12:15], s48 offen offset:128 sc1 lds
    s_waitcnt lgkmcnt(4)
    v_mfma_f32_16x16x32_bf16 v[80:83], a[48:51], v[48:51], v[80:83]
    ds_read_b128 v[40:43], v15 offset:16384
    v_mfma_f32_16x16x32_bf16 v[84:87], a[52:55], v[48:51], v[84:87]
    ds_read_b128 v[44:47], v15 offset:18432
    v_mfma_f32_16x16x32_bf16 v[88:91], a[48:51], v[52:55], v[88:91]
    s_add_u32 m0, s59, 6016
    v_mfma_f32_16x16x32_bf16 v[92:95], a[52:55], v[52:55], v[92:95]
    buffer_load_dwordx4 v6, s[12:15], s49 offen offset:128 sc1 lds
    s_waitcnt lgkmcnt(4)
    v_mfma_f32_16x16x32_bf16 v[80:83], a[56:59], v[56:59], v[80:83]
    ds_read_b128 v[48:51], v13 offset:20480
    v_mfma_f32_16x16x32_bf16 v[84:87], a[60:63], v[56:59], v[84:87]
    ds_read_b128 v[52:55], v13 offset:22528
    v_mfma_f32_16x16x32_bf16 v[88:91], a[56:59], v[60:63], v[88:91]
    s_add_u32 m0, s59, 7040
    v_mfma_f32_16x16x32_bf16 v[92:95], a[60:63], v[60:63], v[92:95]
    buffer_load_dwordx4 v9, s[12:15], s49 offen offset:128 sc1 lds
    s_waitcnt lgkmcnt(4)
    v_mfma_f32_16x16x32_bf16 v[80:83], a[64:67], v[32:35], v[80:83]
    ds_read_b128 v[56:59], v15 offset:20480
    v_mfma_f32_16x16x32_bf16 v[84:87], a[68:71], v[32:35], v[84:87]
    ds_read_b128 v[60:63], v15 offset:22528
    v_mfma_f32_16x16x32_bf16 v[88:91], a[64:67], v[36:39], v[88:91]
    s_add_u32 s48, s53, 131072
    v_mfma_f32_16x16x32_bf16 v[92:95], a[68:71], v[36:39], v[92:95]
    s_add_u32 s46, s58, 2
    s_waitcnt lgkmcnt(4)
    v_mfma_f32_16x16x32_bf16 v[80:83], a[72:75], v[40:43], v[80:83]
    ds_read_b128 v[32:35], v13 offset:24576
    v_mfma_f32_16x16x32_bf16 v[84:87], a[76:79], v[40:43], v[84:87]
    ds_read_b128 v[36:39], v13 offset:26624
    v_mfma_f32_16x16x32_bf16 v[88:91], a[72:75], v[44:47], v[88:91]
    s_cmp_lt_u32 s46, s51
    s_cselect_b32 s48, s48, 0x20000000
    v_mfma_f32_16x16x32_bf16 v[92:95], a[76:79], v[44:47], v[92:95]
    s_add_u32 s49, s48, 4096
    s_waitcnt lgkmcnt(4)
    v_mfma_f32_16x16x32_bf16 v[80:83], a[80:83], v[48:51], v[80:83]
    ds_read_b128 v[40:43], v15 offset:24576
    v_mfma_f32_16x16x32_bf16 v[84:87], a[84:87], v[48:51], v[84:87]
    ds_read_b128 v[44:47], v15 offset:26624
    v_mfma_f32_16x16x32_bf16 v[88:91], a[80:83], v[52:55], v[88:91]
    s_mov_b32 s59, s54
    v_mfma_f32_16x16x32_bf16 v[92:95], a[84:87], v[52:55], v[92:95]
    s_waitcnt lgkmcnt(4)
    v_mfma_f32_16x16x32_bf16 v[80:83], a[88:91], v[56:59], v[80:83]
    ds_read_b128 v[48:51], v13 offset:28672
    v_mfma_f32_16x16x32_bf16 v[84:87], a[92:95], v[56:59], v[84:87]
    ds_read_b128 v[52:55], v13 offset:30720
    v_mfma_f32_16x16x32_bf16 v[88:91], a[88:91], v[60:63], v[88:91]
    v_mfma_f32_16x16x32_bf16 v[92:95], a[92:95], v[60:63], v[92:95]
    s_waitcnt lgkmcnt(4)
    v_mfma_f32_16x16x32_bf16 v[80:83], a[96:99], v[32:35], v[80:83]
    ds_read_b128 v[56:59], v15 offset:28672
    v_mfma_f32_16x16x32_bf16 v[84:87], a[100:103], v[32:35], v[84:87]
    ds_read_b128 v[60:63], v15 offset:30720
    v_mfma_f32_16x16x32_bf16 v[88:91], a[96:99], v[36:39], v[88:91]
    v_mfma_f32_16x16x32_bf16 v[92:95], a[100:103], v[36:39], v[92:95]
    s_waitcnt lgkmcnt(4)
    v_mfma_f32_16x16x32_bf16 v[80:83], a[104:107], v[40:43], v[80:83]
    v_mfma_f32_16x16x32_bf16 v[84:87], a[108:111], v[40:43], v[84:87]
    v_mfma_f32_16x16x32_bf16 v[88:91], a[104:107], v[44:47], v[88:91]
    v_mfma_f32_16x16x32_bf16 v[92:95], a[108:111], v[44:47], v[92:95]
    s_waitcnt vmcnt(16) lgkmcnt(0)
    s_barrier
    v_mfma_f32_16x16x32_bf16 v[80:83], a[112:115], v[48:51], v[80:83]
    ds_read_b128 v[32:35], v13 offset:32768
    v_mfma_f32_16x16x32_bf16 v[84:87], a[116:119], v[48:51], v[84:87]
    ds_read_b128 v[36:39], v13 offset:34816
    v_mfma_f32_16x16x32_bf16 v[88:91], a[112:115], v[52:55], v[88:91]
    v_mfma_f32_16x16x32_bf16 v[92:95], a[116:119], v[52:55], v[92:95]
    v_mfma_f32_16x16x32_bf16 v[80:83], a[120:123], v[56:59], v[80:83]
    ds_read_b128 v[40:43], v15 offset:32768
    v_mfma_f32_16x16x32_bf16 v[84:87], a[124:127], v[56:59], v[84:87]
    ds_read_b128 v[44:47], v15 offset:34816
    v_mfma_f32_16x16x32_bf16 v[88:91], a[120:123], v[60:63], v[88:91]
    v_mfma_f32_16x16x32_bf16 v[92:95], a[124:127], v[60:63], v[92:95]
    s_waitcnt lgkmcnt(2)
    v_mfma_f32_16x16x32_bf16 v[80:83], a[128:131], v[32:35], v[80:83]
    ds_read_b128 v[48:51], v13 offset:36864
    v_mfma_f32_16x16x32_bf16 v[84:87], a[132:135], v[32:35], v[84:87]
    ds_read_b128 v[52:55], v13 offset:38912
    v_mfma_f32_16x16x32_bf16 v[88:91], a[128:131], v[36:39], v[88:91]
    ds_read_b128 v[56:59], v15 offset:36864
    s_add_u32 m0, s59, 0
    v_mfma_f32_16x16x32_bf16 v[92:95], a[132:135], v[36:39], v[92:95]
    ds_read_b128 v[60:63], v15 offset:38912
    buffer_load_dwordx4 v6, s[12:15], s48 offen offset:0 sc1 lds
    s_waitcnt lgkmcnt(4)
    v_mfma_f32_16x16x32_bf16 v[80:83], a[136:139], v[40:43], v[80:83]
    ds_read_b128 v[32:35], v13 offset:40960
    v_mfma_f32_16x16x32_bf16 v[84:87], a[140:143], v[40:43], v[84:87]
    ds_read_b128 v[36:39], v13 offset:43008
    v_mfma_f32_16x16x32_bf16 v[88:91], a[136:139], v[44:47], v[88:91]
    s_add_u32 m0, s59, 1024
    v_mfma_f32_16x16x32_bf16 v[92:95], a[140:143], v[44:47], v[92:95]
    buffer_load_dwordx4 v9, s[12:15], s48 offen offset:0 sc1 lds
    s_waitcnt lgkmcnt(4)
    v_mfma_f32_16x16x32_bf16 v[80:83], a[144:147], v[48:51], v[80:83]
    ds_read_b128 v[40:43], v15 offset:40960
    v_mfma_f32_16x16x32_bf16 v[84:87], a[148:151], v[48:51], v[84:87]
    ds_read_b128 v[44:47], v15 offset:43008
    v_mfma_f32_16x16x32_bf16 v[88:91], a[144:147], v[52:55], v[88:91]
    s_add_u32 m0, s59, 2048
    v_mfma_f32_16x16x32_bf16 v[92:95], a[148:151], v[52:55], v[92:95]
    buffer_load_dwordx4 v6, s[12:15], s49 offen offset:0 sc1 lds
    s_waitcnt lgkmcnt(4)
    v_mfma_f32_16x16x32_bf16 v[80:83], a[152:155], v[56:59], v[80:83]
    ds_read_b128 v[48:51], v13 offset:45056
    v_mfma_f32_16x16x32_bf16 v[84:87], a[156:159], v[56:59], v[84:87]
    ds_read_b128 v[52:55], v13 offset:47104
    v_mfma_f32_16x16x32_bf16 v[88:91], a[152:155], v[60:63], v[88:91]
    s_add_u32 m0, s59, 3072
    v_mfma_f32_16x16x32_bf16 v[92:95], a[156:159], v[60:63], v[92:95]
    buffer_load_dwordx4 v9, s[12:15], s49 offen offset:0 sc1 lds
    s_waitcnt lgkmcnt(4)
    v_mfma_f32_16x16x32_bf16 v[80:83], a[160:163], v[32:35], v[80:83]
    ds_read_b128 v[56:59], v15 offset:45056
    v_mfma_f32_16x16x32_bf16 v[84:87], a[164:167], v[32:35], v[84:87]
    ds_read_b128 v[60:63], v15 offset:47104
    v_mfma_f32_16x16x32_bf16 v[88:91], a[160:163], v[36:39], v[88:91]
    s_add_u32 m0, s59, 3968
    v_mfma_f32_16x16x32_bf16 v[92:95], a[164:167], v[36:39], v[92:95]
    buffer_load_dwordx4 v6, s[12:15], s48 offen offset:128 sc1 lds
    s_waitcnt lgkmcnt(4)
    v_mfma_f32_16x16x32_bf16 v[80:83], a[168:171], v[40:43], v[80:83]
    ds_read_b128 v[32:35], v13 offset:49152
    v_mfma_f32_16x16x32_bf16 v[84:87], a[172:175], v[40:43], v[84:87]
    ds_read_b128 v[36:39], v13 offset:51200
    v_mfma_f32_16x16x32_bf16 v[88:91], a[168:171], v[44:47], v[88:91]
    s_add_u32 m0, s59, 4992
    v_mfma_f32_16x16x32_bf16 v[92:95], a[172:175], v[44:47], v[92:95]
    buffer_load_dwordx4 v9, s[12:15], s48 offen offset:128 sc1 lds
    s_waitcnt lgkmcnt(4)
    v_mfma_f32_16x16x32_bf16 v[80:83], a[176:179], v[48:51], v[80:83]
    ds_read_b128 v[40:43], v15 offset:49152
    v_mfma_f32_16x16x32_bf16 v[84:87], a[180:183], v[48:51], v[84:87]
    ds_read_b128 v[44:47], v15 offset:51200
    v_mfma_f32_16x16x32_bf16 v[88:91], a[176:179], v[52:55], v[88:91]
    s_add_u32 m0, s59, 6016
    v_mfma_f32_16x16x32_bf16 v[92:95], a[180:183], v[52:55], v[92:95]
    buffer_load_dwordx4 v6, s[12:15], s49 offen offset:128 sc1 lds
    s_waitcnt lgkmcnt(4)
    v_mfma_f32_16x16x32_bf16 v[80:83], a[184:187], v[56:59], v[80:83]
    ds_read_b128 v[48:51], v13 offset:53248
    v_mfma_f32_16x16x32_bf16 v[84:87], a[188:191], v[56:59], v[84:87]
    ds_read_b128 v[52:55], v13 offset:55296
    v_mfma_f32_16x16x32_bf16 v[88:91], a[184:187], v[60:63], v[88:91]
    s_add_u32 m0, s59, 7040
    v_mfma_f32_16x16x32_bf16 v[92:95], a[188:191], v[60:63], v[92:95]
    buffer_load_dwordx4 v9, s[12:15], s49 offen offset:128 sc1 lds
    s_waitcnt lgkmcnt(4)
    v_mfma_f32_16x16x32_bf16 v[80:83], a[192:195], v[32:35], v[80:83]
    ds_read_b128 v[56:59], v15 offset:53248
    v_mfma_f32_16x16x32_bf16 v[84:87], a[196:199], v[32:35], v[84:87]
    ds_read_b128 v[60:63], v15 offset:55296
    v_mfma_f32_16x16x32_bf16 v[88:91], a[192:195], v[36:39], v[88:91]
    s_add_u32 s48, s53, 163840
    v_mfma_f32_16x16x32_bf16 v[92:95], a[196:199], v[36:39], v[92:95]
    s_add_u32 s46, s58, 2
    s_waitcnt lgkmcnt(4)
    v_mfma_f32_16x16x32_bf16 v[80:83], a[200:203], v[40:43], v[80:83]
    ds_read_b128 v[32:35], v13 offset:57344
    v_mfma_f32_16x16x32_bf16 v[84:87], a[204:207], v[40:43], v[84:87]
    ds_read_b128 v[36:39], v13 offset:59392
    v_mfma_f32_16x16x32_bf16 v[88:91], a[200:203], v[44:47], v[88:91]
    s_cmp_lt_u32 s46, s51
    s_cselect_b32 s48, s48, 0x20000000
    v_mfma_f32_16x16x32_bf16 v[92:95], a[204:207], v[44:47], v[92:95]
    s_add_u32 s49, s48, 4096
    s_waitcnt lgkmcnt(4)
    v_mfma_f32_16x16x32_bf16 v[80:83], a[208:211], v[48:51], v[80:83]
    ds_read_b128 v[40:43], v15 offset:57344
    v_mfma_f32_16x16x32_bf16 v[84:87], a[212:215], v[48:51], v[84:87]
    ds_read_b128 v[44:47], v15 offset:59392
    v_mfma_f32_16x16x32_bf16 v[88:91], a[208:211], v[52:55], v[88:91]
    s_add_u32 s59, s54, 32768
    v_mfma_f32_16x16x32_bf16 v[92:95], a[212:215], v[52:55], v[92:95]
    s_waitcnt lgkmcnt(4)
    v_mfma_f32_16x16x32_bf16 v[80:83], a[216:219], v[56:59], v[80:83]
    ds_read_b128 v[48:51], v13 offset:61440
    v_mfma_f32_16x16x32_bf16 v[84:87], a[220:223], v[56:59], v[84:87]
    ds_read_b128 v[52:55], v13 offset:63488
    v_mfma_f32_16x16x32_bf16 v[88:91], a[216:219], v[60:63], v[88:91]
    v_mfma_f32_16x16x32_bf16 v[92:95], a[220:223], v[60:63], v[92:95]
    s_waitcnt lgkmcnt(4)
    v_mfma_f32_16x16x32_bf16 v[80:83], a[224:227], v[32:35], v[80:83]
    ds_read_b128 v[56:59], v15 offset:61440
    v_mfma_f32_16x16x32_bf16 v[84:87], a[228:231], v[32:35], v[84:87]
    ds_read_b128 v[60:63], v15 offset:63488
    v_mfma_f32_16x16x32_bf16 v[88:91], a[224:227], v[36:39], v[88:91]
    v_mfma_f32_16x16x32_bf16 v[92:95], a[228:231], v[36:39], v[92:95]
    s_waitcnt lgkmcnt(4)
    v_mfma_f32_16x16x32_bf16 v[80:83], a[232:235], v[40:43], v[80:83]
    v_mfma_f32_16x16x32_bf16 v[84:87], a[236:239], v[40:43], v[84:87]
    v_mfma_f32_16x16x32_bf16 v[88:91], a[232:235], v[44:47], v[88:91]
    v_mfma_f32_16x16x32_bf16 v[92:95], a[236:239], v[44:47], v[92:95]
    s_waitcnt vmcnt(16) lgkmcnt(0)
    s_barrier
    s_cmp_lg_u32 s44, 0
    s_cbranch_scc1 L_e_pr_120
    s_add_u32 s45, s58, s60
    v_mov_b32 v30, s45
    v_mov_b32 v31, 0
    s_mov_b64 exec, 1
    buffer_store_dword v30, v31, s[12:15], s61 offen sc1
    s_mov_b64 exec, -1
L_e_pr_120:
    v_mfma_f32_16x16x32_bf16 v[80:83], a[240:243], v[48:51], v[80:83]
    ds_read_b128 v[32:35], v14 offset:0
    v_mfma_f32_16x16x32_bf16 v[84:87], a[244:247], v[48:51], v[84:87]
    ds_read_b128 v[36:39], v14 offset:2048
    v_mfma_f32_16x16x32_bf16 v[88:91], a[240:243], v[52:55], v[88:91]
    v_mfma_f32_16x16x32_bf16 v[92:95], a[244:247], v[52:55], v[92:95]
    v_mfma_f32_16x16x32_bf16 v[80:83], a[248:251], v[56:59], v[80:83]
    ds_read_b128 v[40:43], v16 offset:0
    v_mfma_f32_16x16x32_bf16 v[84:87], a[252:255], v[56:59], v[84:87]
    ds_read_b128 v[44:47], v16 offset:2048
    v_mfma_f32_16x16x32_bf16 v[88:91], a[248:251], v[60:63], v[88:91]
    v_mfma_f32_16x16x32_bf16 v[92:95], a[252:255], v[60:63], v[92:95]
    s_add_u32 s53, s53, 65536
    s_add_u32 s58, s58, 1
    v_swap_b32 v13, v14
    s_xor_b32 s54, s54, 65536
    s_xor_b32 s55, s55, 65536
    s_mov_b32 s76, s57
    v_swap_b32 v15, v16
    s_add_u32 s57, s57, 8192
    v_cvt_pk_bf16_f32 v216, v80, v81
    v_cvt_pk_bf16_f32 v217, v82, v83
    v_cvt_pk_bf16_f32 v218, v84, v85
    v_cvt_pk_bf16_f32 v219, v86, v87
    v_cvt_pk_bf16_f32 v220, v88, v89
    v_cvt_pk_bf16_f32 v221, v90, v91
    v_cvt_pk_bf16_f32 v222, v92, v93
    v_cvt_pk_bf16_f32 v223, v94, v95
    buffer_store_dwordx4 v[216:219], v10, s[12:15], s76 offen sc1
    buffer_store_dwordx4 v[220:223], v10, s[12:15], s76 offen offset:1024 sc1
    s_cmp_lt_u32 s58, s51
    s_cbranch_scc1 L_e_loop_117
    s_branch L_e_fin_119
L_e_one_118:
    s_waitcnt vmcnt(8)
    s_barrier
    ds_read_b128 v[32:35], v13 offset:0
    ds_read_b128 v[36:39], v13 offset:2048
    ds_read_b128 v[40:43], v15 offset:0
    ds_read_b128 v[44:47], v15 offset:2048
    s_waitcnt lgkmcnt(2)
    v_mfma_f32_16x16x32_bf16 v[80:83], a[0:3], v[32:35], 0
    ds_read_b128 v[48:51], v13 offset:4096
    v_mfma_f32_16x16x32_bf16 v[84:87], a[4:7], v[32:35], 0
    ds_read_b128 v[52:55], v13 offset:6144
    v_mfma_f32_16x16x32_bf16 v[88:91], a[0:3], v[36:39], 0
    ds_read_b128 v[56:59], v15 offset:4096
    v_mfma_f32_16x16x32_bf16 v[92:95], a[4:7], v[36:39], 0
    ds_read_b128 v[60:63], v15 offset:6144
    s_waitcnt lgkmcnt(4)
    v_mfma_f32_16x16x32_bf16 v[80:83], a[8:11], v[40:43], v[80:83]
    ds_read_b128 v[32:35], v13 offset:8192
    v_mfma_f32_16x16x32_bf16 v[84:87], a[12:15], v[40:43], v[84:87]
    ds_read_b128 v[36:39], v13 offset:10240
    v_mfma_f32_16x16x32_bf16 v[88:91], a[8:11], v[44:47], v[88:91]
    v_mfma_f32_16x16x32_bf16 v[92:95], a[12:15], v[44:47], v[92:95]
    s_waitcnt lgkmcnt(4)
    v_mfma_f32_16x16x32_bf16 v[80:83], a[16:19], v[48:51], v[80:83]
    ds_read_b128 v[40:43], v15 offset:8192
    v_mfma_f32_16x16x32_bf16 v[84:87], a[20:23], v[48:51], v[84:87]
    ds_read_b128 v[44:47], v15 offset:10240
    v_mfma_f32_16x16x32_bf16 v[88:91], a[16:19], v[52:55], v[88:91]
    v_mfma_f32_16x16x32_bf16 v[92:95], a[20:23], v[52:55], v[92:95]
    s_waitcnt lgkmcnt(4)
    v_mfma_f32_16x16x32_bf16 v[80:83], a[24:27], v[56:59], v[80:83]
    ds_read_b128 v[48:51], v13 offset:12288
    v_mfma_f32_16x16x32_bf16 v[84:87], a[28:31], v[56:59], v[84:87]
    ds_read_b128 v[52:55], v13 offset:14336
    v_mfma_f32_16x16x32_bf16 v[88:91], a[24:27], v[60:63], v[88:91]
    v_mfma_f32_16x16x32_bf16 v[92:95], a[28:31], v[60:63], v[92:95]
    s_waitcnt lgkmcnt(4)
    v_mfma_f32_16x16x32_bf16 v[80:83], a[32:35], v[32:35], v[80:83]
    ds_read_b128 v[56:59], v15 offset:12288
    v_mfma_f32_16x16x32_bf16 v[84:87], a[36:39], v[32:35], v[84:87]
    ds_read_b128 v[60:63], v15 offset:14336
    v_mfma_f32_16x16x32_bf16 v[88:91], a[32:35], v[36:39], v[88:91]
    v_mfma_f32_16x16x32_bf16 v[92:95], a[36:39], v[36:39], v[92:95]
    s_waitcnt lgkmcnt(4)
    v_mfma_f32_16x16x32_bf16 v[80:83], a[40:43], v[40:43], v[80:83]
    ds_read_b128 v[32:35], v13 offset:16384
    v_mfma_f32_16x16x32_bf16 v[84:87], a[44:47], v[40:43], v[84:87]
    ds_read_b128 v[36:39], v13 offset:18432
    v_mfma_f32_16x16x32_bf16 v[88:91], a[40:43], v[44:47], v[88:91]
    v_mfma_f32_16x16x32_bf16 v[92:95], a[44:47], v[44:47], v[92:95]
    s_waitcnt lgkmcnt(4)
    v_mfma_f32_16x16x32_bf16 v[80:83], a[48:51], v[48:51], v[80:83]
    ds_read_b128 v[40:43], v15 offset:16384
    v_mfma_f32_16x16x32_bf16 v[84:87], a[52:55], v[48:51], v[84:87]
    ds_read_b128 v[44:47], v15 offset:18432
    v_mfma_f32_16x16x32_bf16 v[88:91], a[48:51], v[52:55], v[88:91]
    v_mfma_f32_16x16x32_bf16 v[92:95], a[52:55], v[52:55], v[92:95]
    s_waitcnt lgkmcnt(4)
    v_mfma_f32_16x16x32_bf16 v[80:83], a[56:59], v[56:59], v[80:83]
    ds_read_b128 v[48:51], v13 offset:20480
    v_mfma_f32_16x16x32_bf16 v[84:87], a[60:63], v[56:59], v[84:87]
    ds_read_b128 v[52:55], v13 offset:22528
    v_mfma_f32_16x16x32_bf16 v[88:91], a[56:59], v[60:63], v[88:91]
    v_mfma_f32_16x16x32_bf16 v[92:95], a[60:63], v[60:63], v[92:95]
    s_waitcnt lgkmcnt(4)
    v_mfma_f32_16x16x32_bf16 v[80:83], a[64:67], v[32:35], v[80:83]
    ds_read_b128 v[56:59], v15 offset:20480
    v_mfma_f32_16x16x32_bf16 v[84:87], a[68:71], v[32:35], v[84:87]
    ds_read_b128 v[60:63], v15 offset:22528
    v_mfma_f32_16x16x32_bf16 v[88:91], a[64:67], v[36:39], v[88:91]
    v_mfma_f32_16x16x32_bf16 v[92:95], a[68:71], v[36:39], v[92:95]
    s_waitcnt lgkmcnt(4)
    v_mfma_f32_16x16x32_bf16 v[80:83], a[72:75], v[40:43], v[80:83]
    ds_read_b128 v[32:35], v13 offset:24576
    v_mfma_f32_16x16x32_bf16 v[84:87], a[76:79], v[40:43], v[84:87]
    ds_read_b128 v[36:39], v13 offset:26624
    v_mfma_f32_16x16x32_bf16 v[88:91], a[72:75], v[44:47], v[88:91]
    v_mfma_f32_16x16x32_bf16 v[92:95], a[76:79], v[44:47], v[92:95]
    s_waitcnt lgkmcnt(4)
    v_mfma_f32_16x16x32_bf16 v[80:83], a[80:83], v[48:51], v[80:83]
    ds_read_b128 v[40:43], v15 offset:24576
    v_mfma_f32_16x16x32_bf16 v[84:87], a[84:87], v[48:51], v[84:87]
    ds_read_b128 v[44:47], v15 offset:26624
    v_mfma_f32_16x16x32_bf16 v[88:91], a[80:83], v[52:55], v[88:91]
    v_mfma_f32_16x16x32_bf16 v[92:95], a[84:87], v[52:55], v[92:95]
    s_waitcnt lgkmcnt(4)
    v_mfma_f32_16x16x32_bf16 v[80:83], a[88:91], v[56:59], v[80:83]
    ds_read_b128 v[48:51], v13 offset:28672
    v_mfma_f32_16x16x32_bf16 v[84:87], a[92:95], v[56:59], v[84:87]
    ds_read_b128 v[52:55], v13 offset:30720
    v_mfma_f32_16x16x32_bf16 v[88:91], a[88:91], v[60:63], v[88:91]
    v_mfma_f32_16x16x32_bf16 v[92:95], a[92:95], v[60:63], v[92:95]
    s_waitcnt lgkmcnt(4)
    v_mfma_f32_16x16x32_bf16 v[80:83], a[96:99], v[32:35], v[80:83]
    ds_read_b128 v[56:59], v15 offset:28672
    v_mfma_f32_16x16x32_bf16 v[84:87], a[100:103], v[32:35], v[84:87]
    ds_read_b128 v[60:63], v15 offset:30720
    v_mfma_f32_16x16x32_bf16 v[88:91], a[96:99], v[36:39], v[88:91]
    v_mfma_f32_16x16x32_bf16 v[92:95], a[100:103], v[36:39], v[92:95]
    s_waitcnt lgkmcnt(4)
    v_mfma_f32_16x16x32_bf16 v[80:83], a[104:107], v[40:43], v[80:83]
    v_mfma_f32_16x16x32_bf16 v[84:87], a[108:111], v[40:43], v[84:87]
    v_mfma_f32_16x16x32_bf16 v[88:91], a[104:107], v[44:47], v[88:91]
    v_mfma_f32_16x16x32_bf16 v[92:95], a[108:111], v[44:47], v[92:95]
    s_waitcnt vmcnt(0) lgkmcnt(0)
    s_barrier
    v_mfma_f32_16x16x32_bf16 v[80:83], a[112:115], v[48:51], v[80:83]
    ds_read_b128 v[32:35], v13 offset:32768
    v_mfma_f32_16x16x32_bf16 v[84:87], a[116:119], v[48:51], v[84:87]
    ds_read_b128 v[36:39], v13 offset:34816
    v_mfma_f32_16x16x32_bf16 v[88:91], a[112:115], v[52:55], v[88:91]
    v_mfma_f32_16x16x32_bf16 v[92:95], a[116:119], v[52:55], v[92:95]
    v_mfma_f32_16x16x32_bf16 v[80:83], a[120:123], v[56:59], v[80:83]
    ds_read_b128 v[40:43], v15 offset:32768
    v_mfma_f32_16x16x32_bf16 v[84:87], a[124:127], v[56:59], v[84:87]
    ds_read_b128 v[44:47], v15 offset:34816
    v_mfma_f32_16x16x32_bf16 v[88:91], a[120:123], v[60:63], v[88:91]
    v_mfma_f32_16x16x32_bf16 v[92:95], a[124:127], v[60:63], v[92:95]
    s_waitcnt lgkmcnt(2)
    v_mfma_f32_16x16x32_bf16 v[80:83], a[128:131], v[32:35], v[80:83]
    ds_read_b128 v[48:51], v13 offset:36864
    v_mfma_f32_16x16x32_bf16 v[84:87], a[132:135], v[32:35], v[84:87]
    ds_read_b128 v[52:55], v13 offset:38912
    v_mfma_f32_16x16x32_bf16 v[88:91], a[128:131], v[36:39], v[88:91]
    ds_read_b128 v[56:59], v15 offset:36864
    v_mfma_f32_16x16x32_bf16 v[92:95], a[132:135], v[36:39], v[92:95]
    ds_read_b128 v[60:63], v15 offset:38912
    s_waitcnt lgkmcnt(4)
    v_mfma_f32_16x16x32_bf16 v[80:83], a[136:139], v[40:43], v[80:83]
    ds_read_b128 v[32:35], v13 offset:40960
    v_mfma_f32_16x16x32_bf16 v[84:87], a[140:143], v[40:43], v[84:87]
    ds_read_b128 v[36:39], v13 offset:43008
    v_mfma_f32_16x16x32_bf16 v[88:91], a[136:139], v[44:47], v[88:91]
    v_mfma_f32_16x16x32_bf16 v[92:95], a[140:143], v[44:47], v[92:95]
    s_waitcnt lgkmcnt(4)
    v_mfma_f32_16x16x32_bf16 v[80:83], a[144:147], v[48:51], v[80:83]
    ds_read_b128 v[40:43], v15 offset:40960
    v_mfma_f32_16x16x32_bf16 v[84:87], a[148:151], v[48:51], v[84:87]
    ds_read_b128 v[44:47], v15 offset:43008
    v_mfma_f32_16x16x32_bf16 v[88:91], a[144:147], v[52:55], v[88:91]
    v_mfma_f32_16x16x32_bf16 v[92:95], a[148:151], v[52:55], v[92:95]
    s_waitcnt lgkmcnt(4)
    v_mfma_f32_16x16x32_bf16 v[80:83], a[152:155], v[56:59], v[80:83]
    ds_read_b128 v[48:51], v13 offset:45056
    v_mfma_f32_16x16x32_bf16 v[84:87], a[156:159], v[56:59], v[84:87]
    ds_read_b128 v[52:55], v13 offset:47104
    v_mfma_f32_16x16x32_bf16 v[88:91], a[152:155], v[60:63], v[88:91]
    v_mfma_f32_16x16x32_bf16 v[92:95], a[156:159], v[60:63], v[92:95]
    s_waitcnt lgkmcnt(4)
    v_mfma_f32_16x16x32_bf16 v[80:83], a[160:163], v[32:35], v[80:83]
    ds_read_b128 v[56:59], v15 offset:45056
    v_mfma_f32_16x16x32_bf16 v[84:87], a[164:167], v[32:35], v[84:87]
    ds_read_b128 v[60:63], v15 offset:47104
    v_mfma_f32_16x16x32_bf16 v[88:91], a[160:163], v[36:39], v[88:91]
    v_mfma_f32_16x16x32_bf16 v[92:95], a[164:167], v[36:39], v[92:95]
    s_waitcnt lgkmcnt(4)
    v_mfma_f32_16x16x32_bf16 v[80:83], a[168:171], v[40:43], v[80:83]
    ds_read_b128 v[32:35], v13 offset:49152
    v_mfma_f32_16x16x32_bf16 v[84:87], a[172:175], v[40:43], v[84:87]
    ds_read_b128 v[36:39], v13 offset:51200
    v_mfma_f32_16x16x32_bf16 v[88:91], a[168:171], v[44:47], v[88:91]
    v_mfma_f32_16x16x32_bf16 v[92:95], a[172:175], v[44:47], v[92:95]
    s_waitcnt lgkmcnt(4)
    v_mfma_f32_16x16x32_bf16 v[80:83], a[176:179], v[48:51], v[80:83]
    ds_read_b128 v[40:43], v15 offset:49152
    v_mfma_f32_16x16x32_bf16 v[84:87], a[180:183], v[48:51], v[84:87]
    ds_read_b128 v[44:47], v15 offset:51200
    v_mfma_f32_16x16x32_bf16 v[88:91], a[176:179], v[52:55], v[88:91]
    v_mfma_f32_16x16x32_bf16 v[92:95], a[180:183], v[52:55], v[92:95]
    s_waitcnt lgkmcnt(4)
    v_mfma_f32_16x16x32_bf16 v[80:83], a[184:187], v[56:59], v[80:83]
    ds_read_b128 v[48:51], v13 offset:53248
    v_mfma_f32_16x16x32_bf16 v[84:87], a[188:191], v[56:59], v[84:87]
    ds_read_b128 v[52:55], v13 offset:55296
    v_mfma_f32_16x16x32_bf16 v[88:91], a[184:187], v[60:63], v[88:91]
    v_mfma_f32_16x16x32_bf16 v[92:95], a[188:191], v[60:63], v[92:95]
    s_waitcnt lgkmcnt(4)
    v_mfma_f32_16x16x32_bf16 v[80:83], a[192:195], v[32:35], v[80:83]
    ds_read_b128 v[56:59], v15 offset:53248
    v_mfma_f32_16x16x32_bf16 v[84:87], a[196:199], v[32:35], v[84:87]
    ds_read_b128 v[60:63], v15 offset:55296
    v_mfma_f32_16x16x32_bf16 v[88:91], a[192:195], v[36:39], v[88:91]
    v_mfma_f32_16x16x32_bf16 v[92:95], a[196:199], v[36:39], v[92:95]
    s_waitcnt lgkmcnt(4)
    v_mfma_f32_16x16x32_bf16 v[80:83], a[200:203], v[40:43], v[80:83]
    ds_read_b128 v[32:35], v13 offset:57344
    v_mfma_f32_16x16x32_bf16 v[84:87], a[204:207], v[40:43], v[84:87]
    ds_read_b128 v[36:39], v13 offset:59392
    v_mfma_f32_16x16x32_bf16 v[88:91], a[200:203], v[44:47], v[88:91]
    v_mfma_f32_16x16x32_bf16 v[92:95], a[204:207], v[44:47], v[92:95]
    s_waitcnt lgkmcnt(4)
    v_mfma_f32_16x16x32_bf16 v[80:83], a[208:211], v[48:51], v[80:83]
    ds_read_b128 v[40:43], v15 offset:57344
    v_mfma_f32_16x16x32_bf16 v[84:87], a[212:215], v[48:51], v[84:87]
    ds_read_b128 v[44:47], v15 offset:59392
    v_mfma_f32_16x16x32_bf16 v[88:91], a[208:211], v[52:55], v[88:91]
    v_mfma_f32_16x16x32_bf16 v[92:95], a[212:215], v[52:55], v[92:95]
    s_waitcnt lgkmcnt(4)
    v_mfma_f32_16x16x32_bf16 v[80:83], a[216:219], v[56:59], v[80:83]
    ds_read_b128 v[48:51], v13 offset:61440
    v_mfma_f32_16x16x32_bf16 v[84:87], a[220:223], v[56:59], v[84:87]
    ds_read_b128 v[52:55], v13 offset:63488
    v_mfma_f32_16x16x32_bf16 v[88:91], a[216:219], v[60:63], v[88:91]
    v_mfma_f32_16x16x32_bf16 v[92:95], a[220:223], v[60:63], v[92:95]
    s_waitcnt lgkmcnt(4)
    v_mfma_f32_16x16x32_bf16 v[80:83], a[224:227], v[32:35], v[80:83]
    ds_read_b128 v[56:59], v15 offset:61440
    v_mfma_f32_16x16x32_bf16 v[84:87], a[228:231], v[32:35], v[84:87]
    ds_read_b128 v[60:63], v15 offset:63488
    v_mfma_f32_16x16x32_bf16 v[88:91], a[224:227], v[36:39], v[88:91]
    v_mfma_f32_16x16x32_bf16 v[92:95], a[228:231], v[36:39], v[92:95]
    s_waitcnt lgkmcnt(4)
    v_mfma_f32_16x16x32_bf16 v[80:83], a[232:235], v[40:43], v[80:83]
    v_mfma_f32_16x16x32_bf16 v[84:87], a[236:239], v[40:43], v[84:87]
    v_mfma_f32_16x16x32_bf16 v[88:91], a[232:235], v[44:47], v[88:91]
    v_mfma_f32_16x16x32_bf16 v[92:95], a[236:239], v[44:47], v[92:95]
    s_waitcnt lgkmcnt(0)
    v_mfma_f32_16x16x32_bf16 v[80:83], a[240:243], v[48:51], v[80:83]
    v_mfma_f32_16x16x32_bf16 v[84:87], a[244:247], v[48:51], v[84:87]
    v_mfma_f32_16x16x32_bf16 v[88:91], a[240:243], v[52:55], v[88:91]
    v_mfma_f32_16x16x32_bf16 v[92:95], a[244:247], v[52:55], v[92:95]
    v_mfma_f32_16x16x32_bf16 v[80:83], a[248:251], v[56:59], v[80:83]
    v_mfma_f32_16x16x32_bf16 v[84:87], a[252:255], v[56:59], v[84:87]
    v_mfma_f32_16x16x32_bf16 v[88:91], a[248:251], v[60:63], v[88:91]
    v_mfma_f32_16x16x32_bf16 v[92:95], a[252:255], v[60:63], v[92:95]
    s_mov_b32 s76, s57
    s_nop 6
    v_cvt_pk_bf16_f32 v216, v80, v81
    v_cvt_pk_bf16_f32 v217, v82, v83
    v_cvt_pk_bf16_f32 v218, v84, v85
    v_cvt_pk_bf16_f32 v219, v86, v87
    v_cvt_pk_bf16_f32 v220, v88, v89
    v_cvt_pk_bf16_f32 v221, v90, v91
    v_cvt_pk_bf16_f32 v222, v92, v93
    v_cvt_pk_bf16_f32 v223, v94, v95
    buffer_store_dwordx4 v[216:219], v10, s[12:15], s76 offen sc1
    buffer_store_dwordx4 v[220:223], v10, s[12:15], s76 offen offset:1024 sc1
L_e_fin_119:
    s_waitcnt lgkmcnt(0)
    s_add_u32 s60, s60, s51
    s_waitcnt vmcnt(0)
    s_barrier
    s_cmp_lg_u32 s44, 0
    s_cbranch_scc1 L_pub_121
    v_mov_b32 v30, s60
    v_mov_b32 v31, 0
    s_mov_b64 exec, 1
    buffer_store_dword v30, v31, s[12:15], s61 offen sc1
    s_mov_b64 exec, -1
L_pub_121:
    s_cmp_eq_u32 s60, 2
    s_cselect_b32 s51, 10, s51
    s_sub_u32 s45, s91, 12
    s_cmp_eq_u32 s60, 12
    s_cselect_b32 s51, s45, s51
    s_cselect_b32 s71, 127104, s71
    s_cbranch_scc1 L_w_qkv_114
    s_cmp_lt_u32 s60, s91
    s_cbranch_scc1 L_w_qkv_114_n
    s_cmp_eq_u32 s60, 64
    s_cbranch_scc1 L_w_qkv_114_e
    s_add_u32 s45, s61, 16
    s_mov_b32 s47, 64
    s_cmp_lg_u32 s44, 1
    s_cbranch_scc1 L_pw_122
    s_mov_b64 exec, 1
    s_mov_b32 s70, 0
L_wp_123:
    buffer_load_dword v31, v12, s[12:15], s45 offen sc1
    s_add_u32 s70, s70, 1
    s_cmp_ge_u32 s70, 0x200000
    s_cbranch_scc1 L_w_done_98
L_wp_123_c:
    s_waitcnt vmcnt(0)
    v_cmp_gt_u32 vcc, s47, v31
    s_nop 1
    s_cbranch_vccz L_wp_123_ok
    s_sleep 2
    s_branch L_wp_123
L_wp_123_ok:
    s_mov_b64 exec, -1
L_pw_122:
    s_barrier
    s_waitcnt vmcnt(0)
    s_barrier
    s_cmp_lg_u32 s44, 0
    s_cbranch_scc1 L_pub_124
    v_mov_b32 v30, 64
    v_mov_b32 v31, 0
    s_mov_b64 exec, 1
    buffer_store_dword v30, v31, s[12:15], s61 offen sc1
    s_mov_b64 exec, -1
L_pub_124:
L_w_qkv_114_e:
L_w_roles_100:
    s_cmp_lg_u32 s44, 0
    s_cbranch_scc1 L_gj_125
    s_getreg_b32 s45, hwreg(HW_REG_XCC_ID)
    s_and_b32 s45, s45, 15
    s_mul_i32 s46, s45, s45
    s_lshl_b32 s46, s46, 9
    s_add_u32 s45, s45, s46
    s_add_u32 s45, s45, 16777216
    v_mov_b32 v30, s45
    s_lshl_b32 s45, s40, 7
    v_mov_b32 v31, 127488
    s_mov_b64 exec, 1
    buffer_atomic_add v30, v31, s[12:15], s45 offen sc1
    s_mov_b64 exec, -1
L_gj_125:
    s_mov_b32 s36, 0x1011111
    s_mov_b32 s37, 0x55222081
    s_cmp_eq_u32 s42, 0
    s_cselect_b32 s36, s36, 0x10100000
    s_cselect_b32 s37, s37, 0xaa888410
    s_mov_b32 s72, 0x88888888
    s_mov_b32 s73, 0xffd55248
    s_lshr_b32 s38, s41, 3
    s_and_b32 s68, s41, 7
    s_cmp_eq_u32 s43, 1
    s_cbranch_scc1 L_role_b_126
    s_cmp_eq_u32 s43, 2
    s_cbranch_scc1 L_role_c_127
    s_load_dwordx2 s[6:7], s[0:1], 40
    s_waitcnt lgkmcnt(0)
    s_mov_b32 s24, s6
    s_and_b32 s25, s7, 0xffff
    s_mov_b32 s26, 0x800000
    s_mov_b32 s27, 0x00020000
    s_lshl_b32 s46, s38, 21
    s_lshl_b32 s45, s68, 8
    s_add_u32 s46, s46, s45
    s_waitcnt vmcnt(0)
    s_barrier
    v_lshrrev_b32 v20, 4, v1
    s_lshl_b32 s45, s44, 2
    v_add_u32 v21, s45, v20
    s_mov_b32 s45, 2048
    v_mul_lo_u32 v21, v21, s45
    v_lshlrev_b32 v22, 2, v20
    v_and_b32 v23, 15, v1
    v_xor_b32 v22, v22, v23
    v_lshlrev_b32 v22, 4, v22
    v_add_u32 v21, v21, v22
    v_bfe_u32 v22, v1, 2, 2
    v_lshlrev_b32 v23, 2, v20
    v_add_u32 v23, v23, v22
    v_lshlrev_b32 v23, 8, v23
    v_xor_b32 v22, s44, v22
    v_lshlrev_b32 v22, 6, v22
    v_add_u32 v23, v23, v22
    v_and_b32 v22, 3, v1
    v_lshlrev_b32 v22, 3, v22
    v_add_u32 v23, v23, v22
    v_add_u32 v24, 65536, v23
    v_add_u32 v25, 131072, v23
    s_lshl_b32 s47, s44, 10
    s_add_u32 s45, s46, 0x0
    s_add_u32 m0, s47, 0
    s_nop 0
    buffer_load_dwordx4 v21, s[24:27], s45 offen  lds
    s_add_u32 s45, s46, 0x8000
    s_add_u32 m0, s47, 4096
    s_nop 0
    buffer_load_dwordx4 v21, s[24:27], s45 offen  lds
    s_add_u32 s45, s46, 0x10000
    s_add_u32 m0, s47, 8192
    s_nop 0
    buffer_load_dwordx4 v21, s[24:27], s45 offen  lds
    s_add_u32 s45, s46, 0x18000
    s_add_u32 m0, s47, 12288
    s_nop 0
    buffer_load_dwordx4 v21, s[24:27], s45 offen  lds
    s_add_u32 s45, s46, 0x20000
    s_add_u32 m0, s47, 16384
    s_nop 0
    buffer_load_dwordx4 v21, s[24:27], s45 offen  lds
    s_add_u32 s45, s46, 0x28000
    s_add_u32 m0, s47, 20480
    s_nop 0
    buffer_load_dwordx4 v21, s[24:27], s45 offen  lds
    s_add_u32 s45, s46, 0x30000
    s_add_u32 m0, s47, 24576
    s_nop 0
    buffer_load_dwordx4 v21, s[24:27], s45 offen  lds
    s_add_u32 s45, s46, 0x38000
    s_add_u32 m0, s47, 28672
    s_nop 0
    buffer_load_dwordx4 v21, s[24:27], s45 offen  lds
    s_add_u32 s45, s46, 0x40000
    s_add_u32 m0, s47, 32768
    s_nop 0
    buffer_load_dwordx4 v21, s[24:27], s45 offen  lds
    s_add_u32 s45, s46, 0x48000
    s_add_u32 m0, s47, 36864
    s_nop 0
    buffer_load_dwordx4 v21, s[24:27], s45 offen  lds
    s_add_u32 s45, s46, 0x50000
    s_add_u32 m0, s47, 40960
    s_nop 0
    buffer_load_dwordx4 v21, s[24:27], s45 offen  lds
    s_add_u32 s45, s46, 0x58000
    s_add_u32 m0, s47, 45056
    s_nop 0
    buffer_load_dwordx4 v21, s[24:27], s45 offen  lds
    s_add_u32 s45, s46, 0x60000
    s_add_u32 m0, s47, 49152
    s_nop 0
    buffer_load_dwordx4 v21, s[24:27], s45 offen  lds
    s_add_u32 s45, s46, 0x68000
    s_add_u32 m0, s47, 53248
    s_nop 0
    buffer_load_dwordx4 v21, s[24:27], s45 offen  lds
    s_add_u32 s45, s46, 0x70000
    s_add_u32 m0, s47, 57344
    s_nop 0
    buffer_load_dwordx4 v21, s[24:27], s45 offen  lds
    s_add_u32 s45, s46, 0x78000
    s_add_u32 m0, s47, 61440
    s_nop 0
    buffer_load_dwordx4 v21, s[24:27], s45 offen  lds
    s_add_u32 s45, s46, 0x80000
    s_add_u32 m0, s47, 65536
    s_nop 0
    buffer_load_dwordx4 v21, s[24:27], s45 offen  lds
    s_add_u32 s45, s46, 0x88000
    s_add_u32 m0, s47, 69632
    s_nop 0
    buffer_load_dwordx4 v21, s[24:27], s45 offen  lds
    s_add_u32 s45, s46, 0x90000
    s_add_u32 m0, s47, 73728
    s_nop 0
    buffer_load_dwordx4 v21, s[24:27], s45 offen  lds
    s_add_u32 s45, s46, 0x98000
    s_add_u32 m0, s47, 77824
    s_nop 0
    buffer_load_dwordx4 v21, s[24:27], s45 offen  lds
    s_add_u32 s45, s46, 0xa0000
    s_add_u32 m0, s47, 81920
    s_nop 0
    buffer_load_dwordx4 v21, s[24:27], s45 offen  lds
    s_add_u32 s45, s46, 0xa8000
    s_add_u32 m0, s47, 86016
    s_nop 0
    buffer_load_dwordx4 v21, s[24:27], s45 offen  lds
    s_add_u32 s45, s46, 0xb0000
    s_add_u32 m0, s47, 90112
    s_nop 0
    buffer_load_dwordx4 v21, s[24:27], s45 offen  lds
    s_add_u32 s45, s46, 0xb8000
    s_add_u32 m0, s47, 94208
    s_nop 0
    buffer_load_dwordx4 v21, s[24:27], s45 offen  lds
    s_add_u32 s45, s46, 0xc0000
    s_add_u32 m0, s47, 98304
    s_nop 0
    buffer_load_dwordx4 v21, s[24:27], s45 offen  lds
    s_add_u32 s45, s46, 0xc8000
    s_add_u32 m0, s47, 102400
    s_nop 0
    buffer_load_dwordx4 v21, s[24:27], s45 offen  lds
    s_add_u32 s45, s46, 0xd0000
    s_add_u32 m0, s47, 106496
    s_nop 0
    buffer_load_dwordx4 v21, s[24:27], s45 offen  lds
    s_add_u32 s45, s46, 0xd8000
    s_add_u32 m0, s47, 110592
    s_nop 0
    buffer_load_dwordx4 v21, s[24:27], s45 offen  lds
    s_add_u32 s45, s46, 0xe0000
    s_add_u32 m0, s47, 114688
    s_nop 0
    buffer_load_dwordx4 v21, s[24:27], s45 offen  lds
    s_add_u32 s45, s46, 0xe8000
    s_add_u32 m0, s47, 118784
    s_nop 0
    buffer_load_dwordx4 v21, s[24:27], s45 offen  lds
    s_add_u32 s45, s46, 0xf0000
    s_add_u32 m0, s47, 122880
    s_nop 0
    buffer_load_dwordx4 v21, s[24:27], s45 offen  lds
    s_add_u32 s45, s46, 0xf8000
    s_add_u32 m0, s47, 126976
    s_nop 0
    buffer_load_dwordx4 v21, s[24:27], s45 offen  lds
    s_waitcnt vmcnt(28)
    s_barrier
    s_add_u32 s45, s46, 0x100000
    s_add_u32 m0, s47, 131072
    s_nop 0
    buffer_load_dwordx4 v21, s[24:27], s45 offen  lds
    s_add_u32 s45, s46, 0x108000
    s_add_u32 m0, s47, 135168
    s_nop 0
    buffer_load_dwordx4 v21, s[24:27], s45 offen  lds
    s_add_u32 s45, s46, 0x110000
    s_add_u32 m0, s47, 139264
    s_nop 0
    buffer_load_dwordx4 v21, s[24:27], s45 offen  lds
    s_add_u32 s45, s46, 0x118000
    s_add_u32 m0, s47, 143360
    s_nop 0
    buffer_load_dwordx4 v21, s[24:27], s45 offen  lds
    ds_read_b64_tr_b16 a[0:1], v23 offset:0
    ds_read_b64_tr_b16 a[2:3], v23 offset:4096
    ds_read_b64_tr_b16 a[4:5], v23 offset:32
    ds_read_b64_tr_b16 a[6:7], v23 offset:4128
    ds_read_b64_tr_b16 a[8:9], v23 offset:8192
    ds_read_b64_tr_b16 a[10:11], v23 offset:12288
    ds_read_b64_tr_b16 a[12:13], v23 offset:8224
    ds_read_b64_tr_b16 a[14:15], v23 offset:12320
    s_waitcnt lgkmcnt(0)
    s_waitcnt vmcnt(28)
    s_barrier
    s_add_u32 s45, s46, 0x120000
    s_add_u32 m0, s47, 0
    s_nop 0
    buffer_load_dwordx4 v21, s[24:27], s45 offen  lds
    s_add_u32 s45, s46, 0x128000
    s_add_u32 m0, s47, 4096
    s_nop 0
    buffer_load_dwordx4 v21, s[24:27], s45 offen  lds
    s_add_u32 s45, s46, 0x130000
    s_add_u32 m0, s47, 8192
    s_nop 0
    buffer_load_dwordx4 v21, s[24:27], s45 offen  lds
    s_add_u32 s45, s46, 0x138000
    s_add_u32 m0, s47, 12288
    s_nop 0
    buffer_load_dwordx4 v21, s[24:27], s45 offen  lds
    ds_read_b64_tr_b16 a[16:17], v23 offset:16384
    ds_read_b64_tr_b16 a[18:19], v23 offset:20480
    ds_read_b64_tr_b16 a[20:21], v23 offset:16416
    ds_read_b64_tr_b16 a[22:23], v23 offset:20512
    ds_read_b64_tr_b16 a[24:25], v23 offset:24576
    ds_read_b64_tr_b16 a[26:27], v23 offset:28672
    ds_read_b64_tr_b16 a[28:29], v23 offset:24608
    ds_read_b64_tr_b16 a[30:31], v23 offset:28704
    s_waitcnt lgkmcnt(0)
    s_waitcnt vmcnt(28)
    s_barrier
    s_add_u32 s45, s46, 0x140000
    s_add_u32 m0, s47, 16384
    s_nop 0
    buffer_load_dwordx4 v21, s[24:27], s45 offen  lds
    s_add_u32 s45, s46, 0x148000
    s_add_u32 m0, s47, 20480
    s_nop 0
    buffer_load_dwordx4 v21, s[24:27], s45 offen  lds
    s_add_u32 s45, s46, 0x150000
    s_add_u32 m0, s47, 24576
    s_nop 0
    buffer_load_dwordx4 v21, s[24:27], s45 offen  lds
    s_add_u32 s45, s46, 0x158000
    s_add_u32 m0, s47, 28672
    s_nop 0
    buffer_load_dwordx4 v21, s[24:27], s45 offen  lds
    ds_read_b64_tr_b16 a[32:33], v23 offset:32768
    ds_read_b64_tr_b16 a[34:35], v23 offset:36864
    ds_read_b64_tr_b16 a[36:37], v23 offset:32800
    ds_read_b64_tr_b16 a[38:39], v23 offset:36896
    ds_read_b64_tr_b16 a[40:41], v23 offset:40960
    ds_read_b64_tr_b16 a[42:43], v23 offset:45056
    ds_read_b64_tr_b16 a[44:45], v23 offset:40992
    ds_read_b64_tr_b16 a[46:47], v23 offset:45088
    s_waitcnt lgkmcnt(0)
    s_waitcnt vmcnt(28)
    s_barrier
    s_add_u32 s45, s46, 0x160000
    s_add_u32 m0, s47, 32768
    s_nop 0
    buffer_load_dwordx4 v21, s[24:27], s45 offen  lds
    s_add_u32 s45, s46, 0x168000
    s_add_u32 m0, s47, 36864
    s_nop 0
    buffer_load_dwordx4 v21, s[24:27], s45 offen  lds
    s_add_u32 s45, s46, 0x170000
    s_add_u32 m0, s47, 40960
    s_nop 0
    buffer_load_dwordx4 v21, s[24:27], s45 offen  lds
    s_add_u32 s45, s46, 0x178000
    s_add_u32 m0, s47, 45056
    s_nop 0
    buffer_load_dwordx4 v21, s[24:27], s45 offen  lds
    ds_read_b64_tr_b16 a[48:49], v23 offset:49152
    ds_read_b64_tr_b16 a[50:51], v23 offset:53248
    ds_read_b64_tr_b16 a[52:53], v23 offset:49184
    ds_read_b64_tr_b16 a[54:55], v23 offset:53280
    ds_read_b64_tr_b16 a[56:57], v23 offset:57344
    ds_read_b64_tr_b16 a[58:59], v23 offset:61440
    ds_read_b64_tr_b16 a[60:61], v23 offset:57376
    ds_read_b64_tr_b16 a[62:63], v23 offset:61472
    s_waitcnt lgkmcnt(0)
    s_waitcnt vmcnt(28)
    s_barrier
    s_add_u32 s45, s46, 0x180000
    s_add_u32 m0, s47, 49152
    s_nop 0
    buffer_load_dwordx4 v21, s[24:27], s45 offen  lds
    s_add_u32 s45, s46, 0x188000
    s_add_u32 m0, s47, 53248
    s_nop 0
    buffer_load_dwordx4 v21, s[24:27], s45 offen  lds
    s_add_u32 s45, s46, 0x190000
    s_add_u32 m0, s47, 57344
    s_nop 0
    buffer_load_dwordx4 v21, s[24:27], s45 offen  lds
    s_add_u32 s45, s46, 0x198000
    s_add_u32 m0, s47, 61440
    s_nop 0
    buffer_load_dwordx4 v21, s[24:27], s45 offen  lds
    ds_read_b64_tr_b16 a[64:65], v24 offset:0
    ds_read_b64_tr_b16 a[66:67], v24 offset:4096
    ds_read_b64_tr_b16 a[68:69], v24 offset:32
    ds_read_b64_tr_b16 a[70:71], v24 offset:4128
    ds_read_b64_tr_b16 a[72:73], v24 offset:8192
    ds_read_b64_tr_b16 a[74:75], v24 offset:12288
    ds_read_b64_tr_b16 a[76:77], v24 offset:8224
    ds_read_b64_tr_b16 a[78:79], v24 offset:12320
    s_waitcnt lgkmcnt(0)
    s_waitcnt vmcnt(28)
    s_barrier
    s_add_u32 s45, s46, 0x1a0000
    s_add_u32 m0, s47, 65536
    s_nop 0
    buffer_load_dwordx4 v21, s[24:27], s45 offen  lds
    s_add_u32 s45, s46, 0x1a8000
    s_add_u32 m0, s47, 69632
    s_nop 0
    buffer_load_dwordx4 v21, s[24:27], s45 offen  lds
    s_add_u32 s45, s46, 0x1b0000
    s_add_u32 m0, s47, 73728
    s_nop 0
    buffer_load_dwordx4 v21, s[24:27], s45 offen  lds
    s_add_u32 s45, s46, 0x1b8000
    s_add_u32 m0, s47, 77824
    s_nop 0
    buffer_load_dwordx4 v21, s[24:27], s45 offen  lds
    ds_read_b64_tr_b16 a[80:81], v24 offset:16384
    ds_read_b64_tr_b16 a[82:83], v24 offset:20480
    ds_read_b64_tr_b16 a[84:85], v24 offset:16416
    ds_read_b64_tr_b16 a[86:87], v24 offset:20512
    ds_read_b64_tr_b16 a[88:89], v24 offset:24576
    ds_read_b64_tr_b16 a[90:91], v24 offset:28672
    ds_read_b64_tr_b16 a[92:93], v24 offset:24608
    ds_read_b64_tr_b16 a[94:95], v24 offset:28704
    s_waitcnt lgkmcnt(0)
    s_waitcnt vmcnt(28)
    s_barrier
    s_add_u32 s45, s46, 0x1c0000
    s_add_u32 m0, s47, 81920
    s_nop 0
    buffer_load_dwordx4 v21, s[24:27], s45 offen  lds
    s_add_u32 s45, s46, 0x1c8000
    s_add_u32 m0, s47, 86016
    s_nop 0
    buffer_load_dwordx4 v21, s[24:27], s45 offen  lds
    s_add_u32 s45, s46, 0x1d0000
    s_add_u32 m0, s47, 90112
    s_nop 0
    buffer_load_dwordx4 v21, s[24:27], s45 offen  lds
    s_add_u32 s45, s46, 0x1d8000
    s_add_u32 m0, s47, 94208
    s_nop 0
    buffer_load_dwordx4 v21, s[24:27], s45 offen  lds
    ds_read_b64_tr_b16 a[96:97], v24 offset:32768
    ds_read_b64_tr_b16 a[98:99], v24 offset:36864
    ds_read_b64_tr_b16 a[100:101], v24 offset:32800
    ds_read_b64_tr_b16 a[102:103], v24 offset:36896
    ds_read_b64_tr_b16 a[104:105], v24 offset:40960
    ds_read_b64_tr_b16 a[106:107], v24 offset:45056
    ds_read_b64_tr_b16 a[108:109], v24 offset:40992
    ds_read_b64_tr_b16 a[110:111], v24 offset:45088
    s_waitcnt lgkmcnt(0)
    s_waitcnt vmcnt(28)
    s_barrier
    s_add_u32 s45, s46, 0x1e0000
    s_add_u32 m0, s47, 98304
    s_nop 0
    buffer_load_dwordx4 v21, s[24:27], s45 offen  lds
    s_add_u32 s45, s46, 0x1e8000
    s_add_u32 m0, s47, 102400
    s_nop 0
    buffer_load_dwordx4 v21, s[24:27], s45 offen  lds
    s_add_u32 s45, s46, 0x1f0000
    s_add_u32 m0, s47, 106496
    s_nop 0
    buffer_load_dwordx4 v21, s[24:27], s45 offen  lds
    s_add_u32 s45, s46, 0x1f8000
    s_add_u32 m0, s47, 110592
    s_nop 0
    buffer_load_dwordx4 v21, s[24:27], s45 offen  lds
    ds_read_b64_tr_b16 a[112:113], v24 offset:49152
    ds_read_b64_tr_b16 a[114:115], v24 offset:53248
    ds_read_b64_tr_b16 a[116:117], v24 offset:49184
    ds_read_b64_tr_b16 a[118:119], v24 offset:53280
    ds_read_b64_tr_b16 a[120:121], v24 offset:57344
    ds_read_b64_tr_b16 a[122:123], v24 offset:61440
    ds_read_b64_tr_b16 a[124:125], v24 offset:57376
    ds_read_b64_tr_b16 a[126:127], v24 offset:61472
    s_waitcnt lgkmcnt(0)
    s_waitcnt vmcnt(28)
    s_barrier
    ds_read_b64_tr_b16 a[128:129], v25 offset:0
    ds_read_b64_tr_b16 a[130:131], v25 offset:4096
    ds_read_b64_tr_b16 a[132:133], v25 offset:32
    ds_read_b64_tr_b16 a[134:135], v25 offset:4128
    ds_read_b64_tr_b16 a[136:137], v25 offset:8192
    ds_read_b64_tr_b16 a[138:139], v25 offset:12288
    ds_read_b64_tr_b16 a[140:141], v25 offset:8224
    ds_read_b64_tr_b16 a[142:143], v25 offset:12320
    s_waitcnt lgkmcnt(0)
    s_waitcnt vmcnt(24)
    s_barrier
    ds_read_b64_tr_b16 a[144:145], v23 offset:0
    ds_read_b64_tr_b16 a[146:147], v23 offset:4096
    ds_read_b64_tr_b16 a[148:149], v23 offset:32
    ds_read_b64_tr_b16 a[150:151], v23 offset:4128
    ds_read_b64_tr_b16 a[152:153], v23 offset:8192
    ds_read_b64_tr_b16 a[154:155], v23 offset:12288
    ds_read_b64_tr_b16 a[156:157], v23 offset:8224
    ds_read_b64_tr_b16 a[158:159], v23 offset:12320
    s_waitcnt lgkmcnt(0)
    s_waitcnt vmcnt(20)
    s_barrier
    ds_read_b64_tr_b16 a[160:161], v23 offset:16384
    ds_read_b64_tr_b16 a[162:163], v23 offset:20480
    ds_read_b64_tr_b16 a[164:165], v23 offset:16416
    ds_read_b64_tr_b16 a[166:167], v23 offset:20512
    ds_read_b64_tr_b16 a[168:169], v23 offset:24576
    ds_read_b64_tr_b16 a[170:171], v23 offset:28672
    ds_read_b64_tr_b16 a[172:173], v23 offset:24608
    ds_read_b64_tr_b16 a[174:175], v23 offset:28704
    s_waitcnt lgkmcnt(0)
    s_waitcnt vmcnt(16)
    s_barrier
    ds_read_b64_tr_b16 a[176:177], v23 offset:32768
    ds_read_b64_tr_b16 a[178:179], v23 offset:36864
    ds_read_b64_tr_b16 a[180:181], v23 offset:32800
    ds_read_b64_tr_b16 a[182:183], v23 offset:36896
    ds_read_b64_tr_b16 a[184:185], v23 offset:40960
    ds_read_b64_tr_b16 a[186:187], v23 offset:45056
    ds_read_b64_tr_b16 a[188:189], v23 offset:40992
    ds_read_b64_tr_b16 a[190:191], v23 offset:45088
    s_waitcnt lgkmcnt(0)
    s_waitcnt vmcnt(12)
    s_barrier
    ds_read_b64_tr_b16 a[192:193], v23 offset:49152
    ds_read_b64_tr_b16 a[194:195], v23 offset:53248
    ds_read_b64_tr_b16 a[196:197], v23 offset:49184
    ds_read_b64_tr_b16 a[198:199], v23 offset:53280
    ds_read_b64_tr_b16 a[200:201], v23 offset:57344
    ds_read_b64_tr_b16 a[202:203], v23 offset:61440
    ds_read_b64_tr_b16 a[204:205], v23 offset:57376
    ds_read_b64_tr_b16 a[206:207], v23 offset:61472
    s_waitcnt lgkmcnt(0)
    s_waitcnt vmcnt(8)
    s_barrier
    ds_read_b64_tr_b16 a[208:209], v24 offset:0
    ds_read_b64_tr_b16 a[210:211], v24 offset:4096
    ds_read_b64_tr_b16 a[212:213], v24 offset:32
    ds_read_b64_tr_b16 a[214:215], v24 offset:4128
    ds_read_b64_tr_b16 a[216:217], v24 offset:8192
    ds_read_b64_tr_b16 a[218:219], v24 offset:12288
    ds_read_b64_tr_b16 a[220:221], v24 offset:8224
    ds_read_b64_tr_b16 a[222:223], v24 offset:12320
    s_waitcnt lgkmcnt(0)
    s_waitcnt vmcnt(4)
    s_barrier
    ds_read_b64_tr_b16 a[224:225], v24 offset:16384
    ds_read_b64_tr_b16 a[226:227], v24 offset:20480
    ds_read_b64_tr_b16 a[228:229], v24 offset:16416
    ds_read_b64_tr_b16 a[230:231], v24 offset:20512
    ds_read_b64_tr_b16 a[232:233], v24 offset:24576
    ds_read_b64_tr_b16 a[234:235], v24 offset:28672
    ds_read_b64_tr_b16 a[236:237], v24 offset:24608
    ds_read_b64_tr_b16 a[238:239], v24 offset:28704
    s_waitcnt lgkmcnt(0)
    s_waitcnt vmcnt(0)
    s_barrier
    ds_read_b64_tr_b16 a[240:241], v24 offset:32768
    ds_read_b64_tr_b16 a[242:243], v24 offset:36864
    ds_read_b64_tr_b16 a[244:245], v24 offset:32800
    ds_read_b64_tr_b16 a[246:247], v24 offset:36896
    ds_read_b64_tr_b16 a[248:249], v24 offset:40960
    ds_read_b64_tr_b16 a[250:251], v24 offset:45056
    ds_read_b64_tr_b16 a[252:253], v24 offset:40992
    ds_read_b64_tr_b16 a[254:255], v24 offset:45088
    s_waitcnt lgkmcnt(0)
    s_barrier
    s_lshl_b32 s52, s38, 16
    s_add_u32 s52, s52, 0x5000000
    s_lshl_b32 s56, s38, 23
    s_lshl_b32 s45, s68, 9
    s_add_u32 s56, s56, s45
    s_add_u32 s56, s56, 0x8000000
    s_lshl_b32 s45, s40, 7
    s_add_u32 s45, s45, 127488
    v_mov_b32 v29, s45
    s_mov_b32 s46, 536870912
    s_mov_b64 exec, 1
    s_mov_b32 s70, 0
L_wp_130:
    buffer_load_dword v31, v29, s[12:15], 0 offen sc1
    s_add_u32 s70, s70, 1
    s_cmp_ge_u32 s70, 0x200000
    s_cbranch_scc1 L_w_done_98
L_wp_130_c:
    s_waitcnt vmcnt(0)
    v_cmp_gt_u32 vcc, s46, v31
    s_nop 1
    s_cbranch_vccz L_wp_130_ok
    s_sleep 2
    s_branch L_wp_130
L_wp_130_ok:
    s_mov_b64 exec, -1
    v_readfirstlane_b32 s45, v31
    s_nop 3
    s_and_b32 s46, s45, 511
    s_mul_i32 s46, s46, s46
    s_bfe_u32 s45, s45, 0xf0009
    s_lshl_b32 s45, s45, 5
    s_mov_b32 s80, s12
    s_mov_b32 s81, s13
    s_mov_b32 s83, 0x00020000
    s_mov_b32 s84, s12
    s_mov_b32 s85, s13
    s_mov_b32 s87, 0x00020000
    s_cmp_eq_u32 s45, s46
    s_cselect_b32 s82, s14, 0
    s_cselect_b32 s86, 0, s14
    s_sub_u32 s79, 3, s44
    s_mov_b32 s78, 0
    s_mov_b32 s92, 0
    s_cmp_eq_u64 s[36:37], 0
    s_cbranch_scc1 L_xl_131
    s_ff1_i32_b64 s47, s[36:37]
    s_lshr_b64 s[74:75], s[72:73], s47
    s_ff1_i32_b64 s48, s[74:75]
    s_cmp_gt_u32 s79, s48
    s_cbranch_scc1 L_xl_131
    s_add_u32 s47, s47, s79
    s_cmp_lt_u32 s47, s78
    s_cbranch_scc1 L_xl_131_go
    s_lshl_b32 s45, s41, 7
    s_add_u32 s45, s45, 0x10010
    s_add_u32 s46, s47, 1
    s_mov_b64 exec, 7
    s_mov_b32 s70, 0
L_wp_132:
    buffer_load_dword v31, v12, s[12:15], s45 offen sc1
    s_add_u32 s70, s70, 1
    s_cmp_ge_u32 s70, 0x200000
    s_cbranch_scc1 L_w_done_98
L_wp_132_c:
    s_waitcnt vmcnt(0)
    v_cmp_gt_u32 vcc, s46, v31
    s_nop 1
    s_cbranch_vccz L_wp_132_ok
    s_sleep 2
    s_branch L_wp_132
L_wp_132_ok:
    s_mov_b64 exec, -1
    v_readlane_b32 s78, v31, 0
    v_readlane_b32 s45, v31, 1
    v_readlane_b32 s46, v31, 2
    s_nop 3
    s_min_u32 s78, s78, s45
    s_min_u32 s78, s78, s46
L_xl_131_go:
    s_lshl_b32 s45, s41, 19
    s_lshl_b32 s46, s47, 13
    s_add_u32 s45, s45, s46
    s_add_u32 s45, s45, 0x2000000
    s_add_u32 s46, s45, 4096
    s_add_u32 s48, s45, 16777216
    s_add_u32 s49, s48, 4096
    s_add_u32 s76, s48, 16777216
    s_add_u32 s77, s76, 4096
    buffer_load_dwordx4 v[96:99], v10, s[12:15], s76 offen offset:0 sc1
    buffer_load_dwordx4 v[128:131], v10, s[12:15], s45 offen offset:0 sc1
    buffer_load_dwordx4 v[160:163], v10, s[12:15], s48 offen offset:0 sc1
    buffer_load_dwordx4 v[100:103], v10, s[12:15], s76 offen offset:1024 sc1
    buffer_load_dwordx4 v[144:147], v10, s[12:15], s45 offen offset:1024 sc1
    buffer_load_dwordx4 v[176:179], v10, s[12:15], s48 offen offset:1024 sc1
    buffer_load_dwordx4 v[104:107], v10, s[12:15], s76 offen offset:2048 sc1
    buffer_load_dwordx4 v[132:135], v10, s[12:15], s45 offen offset:2048 sc1
    buffer_load_dwordx4 v[164:167], v10, s[12:15], s48 offen offset:2048 sc1
    buffer_load_dwordx4 v[108:111], v10, s[12:15], s76 offen offset:3072 sc1
    buffer_load_dwordx4 v[148:151], v10, s[12:15], s45 offen offset:3072 sc1
    buffer_load_dwordx4 v[180:183], v10, s[12:15], s48 offen offset:3072 sc1
    buffer_load_dwordx4 v[112:115], v10, s[12:15], s77 offen offset:0 sc1
    buffer_load_dwordx4 v[136:139], v10, s[12:15], s46 offen offset:0 sc1
    buffer_load_dwordx4 v[168:171], v10, s[12:15], s49 offen offset:0 sc1
    buffer_load_dwordx4 v[116:119], v10, s[12:15], s77 offen offset:1024 sc1
    buffer_load_dwordx4 v[152:155], v10, s[12:15], s46 offen offset:1024 sc1
    buffer_load_dwordx4 v[184:187], v10, s[12:15], s49 offen offset:1024 sc1
    buffer_load_dwordx4 v[120:123], v10, s[12:15], s77 offen offset:2048 sc1
    buffer_load_dwordx4 v[140:143], v10, s[12:15], s46 offen offset:2048 sc1
    buffer_load_dwordx4 v[172:175], v10, s[12:15], s49 offen offset:2048 sc1
    buffer_load_dwordx4 v[124:127], v10, s[12:15], s77 offen offset:3072 sc1
    buffer_load_dwordx4 v[156:159], v10, s[12:15], s46 offen offset:3072 sc1
    buffer_load_dwordx4 v[188:191], v10, s[12:15], s49 offen offset:3072 sc1
L_xl_131:
    s_waitcnt vmcnt(0)
L_a_loop_128:
    s_cmp_eq_u64 s[36:37], 0
    s_cbranch_scc1 L_a_fin_133
    s_ff1_i32_b64 s50, s[36:37]
    s_bitset0_b64 s[36:37], s50
    s_lshr_b64 s[74:75], s[72:73], s50
    s_ff1_i32_b64 s51, s[74:75]
    s_add_u32 s51, s51, 1
    s_add_u32 s62, s50, s51
    s_add_u32 s63, s50, s79
    s_cmp_ge_u32 s79, s51
    s_cbranch_scc1 L_xs1_134
    s_lshl_b32 s47, s44, 13
    v_add_u32 v18, s47, v10
    v_and_b32 v14, 15, v1
    v_lshrrev_b32 v16, 4, v1
    ds_write_b128 v18, v[96:99] offset:0
    ds_write_b128 v18, v[100:103] offset:1024
    ds_write_b128 v18, v[104:107] offset:2048
    ds_write_b128 v18, v[108:111] offset:3072
    ds_write_b128 v18, v[112:115] offset:4096
    ds_write_b128 v18, v[116:119] offset:5120
    ds_write_b128 v18, v[120:123] offset:6144
    ds_write_b128 v18, v[124:127] offset:7168
    v_mfma_f32_16x16x32_bf16 v[32:35], v[160:163], v[128:131], 0
    v_mfma_f32_16x16x32_bf16 v[36:39], v[160:163], v[144:147], 0
    v_mfma_f32_16x16x32_bf16 v[44:47], v[176:179], v[144:147], 0
    v_mfma_f32_16x16x32_bf16 v[32:35], v[164:167], v[132:135], v[32:35]
    v_mfma_f32_16x16x32_bf16 v[36:39], v[164:167], v[148:151], v[36:39]
    v_mfma_f32_16x16x32_bf16 v[44:47], v[180:183], v[148:151], v[44:47]
    v_mfma_f32_16x16x32_bf16 v[32:35], v[168:171], v[136:139], v[32:35]
    v_mfma_f32_16x16x32_bf16 v[36:39], v[168:171], v[152:155], v[36:39]
    v_mfma_f32_16x16x32_bf16 v[44:47], v[184:187], v[152:155], v[44:47]
    v_mfma_f32_16x16x32_bf16 v[32:35], v[172:175], v[140:143], v[32:35]
    v_mfma_f32_16x16x32_bf16 v[36:39], v[172:175], v[156:159], v[36:39]
    v_mfma_f32_16x16x32_bf16 v[44:47], v[188:191], v[156:159], v[44:47]
    v_lshlrev_b32 v19, 2, v16
    v_lshrrev_b32 v20, 2, v1
    v_lshlrev_b32 v20, 4, v20
    v_and_b32 v21, 1, v1
    v_lshlrev_b32 v21, 3, v21
    v_add3_u32 v20, v20, v21, s47
    v_and_b32 v21, 2, v1
    v_lshlrev_b32 v21, 7, v21
    v_add_u32 v20, v20, v21
    v_mov_b32 v22, 0xff800000
    s_waitcnt lgkmcnt(0)
    ds_read_b64_tr_b16 v[208:209], v20 offset:0
    ds_read_b64_tr_b16 v[210:211], v20 offset:1024
    ds_read_b64_tr_b16 v[212:213], v20 offset:512
    ds_read_b64_tr_b16 v[214:215], v20 offset:1536
    ds_read_b64_tr_b16 v[216:217], v20 offset:2048
    ds_read_b64_tr_b16 v[218:219], v20 offset:3072
    ds_read_b64_tr_b16 v[220:221], v20 offset:2560
    ds_read_b64_tr_b16 v[222:223], v20 offset:3584
    ds_read_b64_tr_b16 v[224:225], v20 offset:4096
    ds_read_b64_tr_b16 v[226:227], v20 offset:5120
    ds_read_b64_tr_b16 v[228:229], v20 offset:4608
    ds_read_b64_tr_b16 v[230:231], v20 offset:5632
    ds_read_b64_tr_b16 v[232:233], v20 offset:6144
    ds_read_b64_tr_b16 v[234:235], v20 offset:7168
    ds_read_b64_tr_b16 v[236:237], v20 offset:6656
    ds_read_b64_tr_b16 v[238:239], v20 offset:7680
    v_add_u32 v21, 0, v19
    v_cmp_gt_u32 vcc, v21, v14
    s_nop 1
    v_cndmask_b32 v32, v32, v22, vcc
    v_cndmask_b32 v44, v44, v22, vcc
    v_add_u32 v21, 1, v19
    v_cmp_gt_u32 vcc, v21, v14
    s_nop 1
    v_cndmask_b32 v33, v33, v22, vcc
    v_cndmask_b32 v45, v45, v22, vcc
    v_add_u32 v21, 2, v19
    v_cmp_gt_u32 vcc, v21, v14
    s_nop 1
    v_cndmask_b32 v34, v34, v22, vcc
    v_cndmask_b32 v46, v46, v22, vcc
    v_add_u32 v21, 3, v19
    v_cmp_gt_u32 vcc, v21, v14
    s_nop 1
    v_cndmask_b32 v35, v35, v22, vcc
    v_cndmask_b32 v47, v47, v22, vcc
L_xs1_134:
    s_lshl_b32 s45, s41, 7
    s_add_u32 s45, s45, 0x11000
    s_cmp_lg_u32 s44, 1
    s_cbranch_scc1 L_pi_136
    s_mov_b64 exec, 255
    buffer_load_dword v31, v12, s[12:15], s45 offen sc1
    s_mov_b64 exec, -1
L_pi_136:
    s_waitcnt vmcnt(0)
    s_barrier
    s_cmp_lg_u32 s44, 0
    s_cbranch_scc1 L_pub_137
    v_mov_b32 v30, s92
    v_mov_b32 v31, 0
    s_mov_b64 exec, 1
    buffer_store_dword v30, v31, s[12:15], s67 offen sc1
    s_mov_b64 exec, -1
L_pub_137:
    s_cmp_lg_u32 s44, 1
    s_cbranch_scc1 L_pw_138
    s_mov_b64 exec, 255
    s_mov_b32 s70, 0
    s_branch L_wp_139_c
L_wp_139:
    buffer_load_dword v31, v12, s[12:15], s45 offen sc1
    s_add_u32 s70, s70, 1
    s_cmp_ge_u32 s70, 0x200000
    s_cbranch_scc1 L_w_done_98
L_wp_139_c:
    s_waitcnt vmcnt(0)
    v_cmp_gt_u32 vcc, s62, v31
    s_nop 1
    s_cbranch_vccz L_wp_139_ok
    s_sleep 1
    s_branch L_wp_139
L_wp_139_ok:
    s_mov_b64 exec, -1
L_pw_138:
    s_barrier
    s_cmp_ge_u32 s79, s51
    s_cbranch_scc1 L_xs2_135
    s_lshl_b32 s45, s63, 17
    s_lshl_b32 s46, s41, 12
    s_add_u32 s45, s45, s46
    s_lshr_b32 s46, s45, 1
    s_add_u32 s45, s45, 0x1000000
    s_add_u32 s46, s46, 0x1800000
    v_lshlrev_b32 v21, 3, v1
    buffer_load_dwordx4 v[192:195], v10, s[12:15], s45 offen offset:0 sc1
    buffer_load_dwordx4 v[196:199], v10, s[12:15], s45 offen offset:1024 sc1
    buffer_load_dwordx4 v[200:203], v10, s[12:15], s45 offen offset:2048 sc1
    buffer_load_dwordx4 v[204:207], v10, s[12:15], s45 offen offset:3072 sc1
    buffer_load_dwordx2 v[240:241], v21, s[12:15], s46 offen offset:0 sc1
    buffer_load_dwordx2 v[242:243], v21, s[12:15], s46 offen offset:512 sc1
    buffer_load_dwordx2 v[244:245], v21, s[12:15], s46 offen offset:1024 sc1
    buffer_load_dwordx2 v[246:247], v21, s[12:15], s46 offen offset:1536 sc1
    s_waitcnt vmcnt(4)
    v_mfma_f32_16x16x32_bf16 v[48:51], v[192:195], v[128:131], 0
    v_mfma_f32_16x16x32_bf16 v[52:55], v[192:195], v[144:147], 0
    v_mfma_f32_16x16x32_bf16 v[48:51], v[196:199], v[132:135], v[48:51]
    v_mfma_f32_16x16x32_bf16 v[52:55], v[196:199], v[148:151], v[52:55]
    v_mfma_f32_16x16x32_bf16 v[48:51], v[200:203], v[136:139], v[48:51]
    v_mfma_f32_16x16x32_bf16 v[52:55], v[200:203], v[152:155], v[52:55]
    v_mfma_f32_16x16x32_bf16 v[48:51], v[204:207], v[140:143], v[48:51]
    v_mfma_f32_16x16x32_bf16 v[52:55], v[204:207], v[156:159], v[52:55]
    s_mov_b32 s45, 0x3e0293ee
    s_nop 6
    v_permlane32_swap_b32 v48, v50
    v_permlane32_swap_b32 v49, v51
    v_pk_add_f32 v[48:49], v[48:49], v[50:51]
    v_permlane32_swap_b32 v52, v54
    v_permlane32_swap_b32 v53, v55
    v_pk_add_f32 v[52:53], v[52:53], v[54:55]
    v_max_f32 v22, v32, v33
    v_max3_f32 v22, v22, v34, v35
    v_max3_f32 v22, v22, v48, v49
    v_max_f32 v23, v36, v37
    v_max3_f32 v23, v23, v38, v39
    v_max3_f32 v23, v23, v44, v45
    v_max3_f32 v23, v23, v46, v47
    v_max3_f32 v23, v23, v52, v53
    v_mov_b32 v24, v22
    v_mov_b32 v25, v23
    s_nop 0
    v_permlane32_swap_b32 v22, v24
    v_permlane32_swap_b32 v23, v25
    v_max_f32 v22, v22, v24
    v_max_f32 v23, v23, v25
    v_mov_b32 v24, v22
    v_mov_b32 v25, v23
    s_nop 0
    v_permlane16_swap_b32 v22, v24
    v_permlane16_swap_b32 v23, v25
    v_max_f32 v22, v22, v24
    v_max_f32 v23, v23, v25
    v_mul_f32 v22, s45, v22
    v_mul_f32 v23, s45, v23
    v_fma_f32 v32, v32, s45, -v22
    v_fma_f32 v33, v33, s45, -v22
    v_fma_f32 v34, v34, s45, -v22
    v_fma_f32 v35, v35, s45, -v22
    v_fma_f32 v48, v48, s45, -v22
    v_fma_f32 v49, v49, s45, -v22
    v_exp_f32 v32, v32
    v_exp_f32 v33, v33
    v_exp_f32 v34, v34
    v_exp_f32 v35, v35
    v_exp_f32 v48, v48
    v_exp_f32 v49, v49
    v_fma_f32 v36, v36, s45, -v23
    v_fma_f32 v37, v37, s45, -v23
    v_fma_f32 v38, v38, s45, -v23
    v_fma_f32 v39, v39, s45, -v23
    v_fma_f32 v44, v44, s45, -v23
    v_fma_f32 v45, v45, s45, -v23
    v_fma_f32 v46, v46, s45, -v23
    v_fma_f32 v47, v47, s45, -v23
    v_fma_f32 v52, v52, s45, -v23
    v_fma_f32 v53, v53, s45, -v23
    v_exp_f32 v36, v36
    v_exp_f32 v37, v37
    v_exp_f32 v38, v38
    v_exp_f32 v39, v39
    v_exp_f32 v44, v44
    v_exp_f32 v45, v45
    v_exp_f32 v46, v46
    v_exp_f32 v47, v47
    v_exp_f32 v52, v52
    v_exp_f32 v53, v53
    v_add_f32 v22, v32, v33
    v_add_f32 v22, v22, v34
    v_add_f32 v22, v22, v35
    v_add_f32 v22, v22, v48
    v_add_f32 v22, v22, v49
    v_add_f32 v23, v36, v37
    v_add_f32 v23, v23, v38
    v_add_f32 v23, v23, v39
    v_add_f32 v23, v23, v44
    v_add_f32 v23, v23, v45
    v_add_f32 v23, v23, v46
    v_add_f32 v23, v23, v47
    v_add_f32 v23, v23, v52
    v_add_f32 v23, v23, v53
    v_mov_b32 v24, v22
    v_mov_b32 v25, v23
    s_nop 0
    v_permlane32_swap_b32 v22, v24
    v_permlane32_swap_b32 v23, v25
    v_add_f32 v22, v22, v24
    v_add_f32 v23, v23, v25
    v_mov_b32 v24, v22
    v_mov_b32 v25, v23
    s_nop 0
    v_permlane16_swap_b32 v22, v24
    v_permlane16_swap_b32 v23, v25
    v_add_f32 v22, v22, v24
    v_add_f32 v23, v23, v25
    v_rcp_f32 v22, v22
    v_rcp_f32 v23, v23
    s_nop 0
    v_mul_f32 v32, v32, v22
    v_mul_f32 v33, v33, v22
    v_mul_f32 v34, v34, v22
    v_mul_f32 v35, v35, v22
    v_mul_f32 v48, v48, v22
    v_mul_f32 v49, v49, v22
    v_mul_f32 v36, v36, v23
    v_mul_f32 v37, v37, v23
    v_mul_f32 v38, v38, v23
    v_mul_f32 v39, v39, v23
    v_mul_f32 v44, v44, v23
    v_mul_f32 v45, v45, v23
    v_mul_f32 v46, v46, v23
    v_mul_f32 v47, v47, v23
    v_mul_f32 v52, v52, v23
    v_mul_f32 v53, v53, v23
    v_cvt_pk_bf16_f32 v128, v32, v33
    v_cvt_pk_bf16_f32 v129, v34, v35
    v_mov_b32 v130, 0
    v_mov_b32 v131, 0
    v_cvt_pk_bf16_f32 v132, v48, v49
    v_mov_b32 v133, 0
    v_mov_b32 v134, 0
    v_cvt_pk_bf16_f32 v135, v48, v49
    v_cvt_pk_bf16_f32 v136, v36, v37
    v_cvt_pk_bf16_f32 v137, v38, v39
    v_cvt_pk_bf16_f32 v138, v44, v45
    v_cvt_pk_bf16_f32 v139, v46, v47
    v_cvt_pk_bf16_f32 v140, v52, v53
    v_mov_b32 v141, 0
    v_mov_b32 v142, 0
    v_cvt_pk_bf16_f32 v143, v52, v53
    s_waitcnt vmcnt(0) lgkmcnt(0)
    s_nop 0
    v_mfma_f32_16x16x32_bf16 v[64:67], v[208:211], v[128:131], 0
    v_mfma_f32_16x16x32_bf16 v[68:71], v[212:215], v[128:131], 0
    v_mfma_f32_16x16x32_bf16 v[72:75], v[216:219], v[128:131], 0
    v_mfma_f32_16x16x32_bf16 v[76:79], v[220:223], v[128:131], 0
    v_mfma_f32_16x16x32_bf16 v[80:83], v[224:227], v[128:131], 0
    v_mfma_f32_16x16x32_bf16 v[84:87], v[228:231], v[128:131], 0
    v_mfma_f32_16x16x32_bf16 v[88:91], v[232:235], v[128:131], 0
    v_mfma_f32_16x16x32_bf16 v[92:95], v[236:239], v[128:131], 0
    v_mfma_f32_16x16x16_bf16 v[64:67], v[240:241], v[132:133], v[64:67]
    v_mfma_f32_16x16x16_bf16 v[68:71], v[240:241], v[134:135], v[68:71]
    v_mfma_f32_16x16x16_bf16 v[72:75], v[242:243], v[132:133], v[72:75]
    v_mfma_f32_16x16x16_bf16 v[76:79], v[242:243], v[134:135], v[76:79]
    v_mfma_f32_16x16x16_bf16 v[80:83], v[244:245], v[132:133], v[80:83]
    v_mfma_f32_16x16x16_bf16 v[84:87], v[244:245], v[134:135], v[84:87]
    v_mfma_f32_16x16x16_bf16 v[88:91], v[246:247], v[132:133], v[88:91]
    v_mfma_f32_16x16x16_bf16 v[92:95], v[246:247], v[134:135], v[92:95]
    v_mfma_f32_16x16x32_bf16 v[96:99], v[208:211], v[136:139], 0
    v_mfma_f32_16x16x32_bf16 v[100:103], v[212:215], v[136:139], 0
    v_mfma_f32_16x16x32_bf16 v[104:107], v[216:219], v[136:139], 0
    v_mfma_f32_16x16x32_bf16 v[108:111], v[220:223], v[136:139], 0
    v_mfma_f32_16x16x32_bf16 v[112:115], v[224:227], v[136:139], 0
    v_mfma_f32_16x16x32_bf16 v[116:119], v[228:231], v[136:139], 0
    v_mfma_f32_16x16x32_bf16 v[120:123], v[232:235], v[136:139], 0
    v_mfma_f32_16x16x32_bf16 v[124:127], v[236:239], v[136:139], 0
    v_mfma_f32_16x16x16_bf16 v[96:99], v[240:241], v[140:141], v[96:99]
    v_mfma_f32_16x16x16_bf16 v[100:103], v[240:241], v[142:143], v[100:103]
    v_mfma_f32_16x16x16_bf16 v[104:107], v[242:243], v[140:141], v[104:107]
    v_mfma_f32_16x16x16_bf16 v[108:111], v[242:243], v[142:143], v[108:111]
    v_mfma_f32_16x16x16_bf16 v[112:115], v[244:245], v[140:141], v[112:115]
    v_mfma_f32_16x16x16_bf16 v[116:119], v[244:245], v[142:143], v[116:119]
    v_mfma_f32_16x16x16_bf16 v[120:123], v[246:247], v[140:141], v[120:123]
    v_mfma_f32_16x16x16_bf16 v[124:127], v[246:247], v[142:143], v[124:127]
    s_lshl_b32 s45, s63, 18
    s_lshl_b32 s46, s41, 13
    s_add_u32 s45, s45, s46
    s_add_u32 s45, s45, 0x5000000
    s_add_u32 s46, s45, 4096
    v_cvt_pk_bf16_f32 v64, v64, v65
    v_cvt_pk_bf16_f32 v65, v66, v67
    v_cvt_pk_bf16_f32 v66, v68, v69
    v_cvt_pk_bf16_f32 v67, v70, v71
    buffer_store_dwordx4 v[64:67], v10, s[12:15], s45 offen offset:0 sc1
    v_cvt_pk_bf16_f32 v72, v72, v73
    v_cvt_pk_bf16_f32 v73, v74, v75
    v_cvt_pk_bf16_f32 v74, v76, v77
    v_cvt_pk_bf16_f32 v75, v78, v79
    buffer_store_dwordx4 v[72:75], v10, s[12:15], s45 offen offset:2048 sc1
    v_cvt_pk_bf16_f32 v80, v80, v81
    v_cvt_pk_bf16_f32 v81, v82, v83
    v_cvt_pk_bf16_f32 v82, v84, v85
    v_cvt_pk_bf16_f32 v83, v86, v87
    buffer_store_dwordx4 v[80:83], v10, s[12:15], s46 offen offset:0 sc1
    v_cvt_pk_bf16_f32 v88, v88, v89
    v_cvt_pk_bf16_f32 v89, v90, v91
    v_cvt_pk_bf16_f32 v90, v92, v93
    v_cvt_pk_bf16_f32 v91, v94, v95
    buffer_store_dwordx4 v[88:91], v10, s[12:15], s46 offen offset:2048 sc1
    v_cvt_pk_bf16_f32 v96, v96, v97
    v_cvt_pk_bf16_f32 v97, v98, v99
    v_cvt_pk_bf16_f32 v98, v100, v101
    v_cvt_pk_bf16_f32 v99, v102, v103
    buffer_store_dwordx4 v[96:99], v10, s[12:15], s45 offen offset:1024 sc1
    v_cvt_pk_bf16_f32 v104, v104, v105
    v_cvt_pk_bf16_f32 v105, v106, v107
    v_cvt_pk_bf16_f32 v106, v108, v109
    v_cvt_pk_bf16_f32 v107, v110, v111
    buffer_store_dwordx4 v[104:107], v10, s[12:15], s45 offen offset:3072 sc1
    v_cvt_pk_bf16_f32 v112, v112, v113
    v_cvt_pk_bf16_f32 v113, v114, v115
    v_cvt_pk_bf16_f32 v114, v116, v117
    v_cvt_pk_bf16_f32 v115, v118, v119
    buffer_store_dwordx4 v[112:115], v10, s[12:15], s46 offen offset:1024 sc1
    v_cvt_pk_bf16_f32 v120, v120, v121
    v_cvt_pk_bf16_f32 v121, v122, v123
    v_cvt_pk_bf16_f32 v122, v124, v125
    v_cvt_pk_bf16_f32 v123, v126, v127
    buffer_store_dwordx4 v[120:123], v10, s[12:15], s46 offen offset:3072 sc1
L_xs2_135:
    s_waitcnt vmcnt(0)
    s_barrier
    s_cmp_lg_u32 s44, 0
    s_cbranch_scc1 L_pub_140
    v_mov_b32 v30, s62
    v_mov_b32 v31, 0
    s_mov_b64 exec, 1
    buffer_store_dword v30, v31, s[80:83], s65 offen
    buffer_store_dword v30, v31, s[84:87], s65 offen sc1
    s_mov_b64 exec, -1
L_pub_140:
    s_cmp_eq_u64 s[36:37], 0
    s_cbranch_scc1 L_xl_141
    s_ff1_i32_b64 s47, s[36:37]
    s_lshr_b64 s[74:75], s[72:73], s47
    s_ff1_i32_b64 s48, s[74:75]
    s_cmp_gt_u32 s79, s48
    s_cbranch_scc1 L_xl_141
    s_add_u32 s47, s47, s79
    s_cmp_lt_u32 s47, s78
    s_cbranch_scc1 L_xl_141_go
    s_lshl_b32 s45, s41, 7
    s_add_u32 s45, s45, 0x10010
    s_add_u32 s46, s47, 1
    s_mov_b64 exec, 7
    s_mov_b32 s70, 0
L_wp_142:
    buffer_load_dword v31, v12, s[12:15], s45 offen sc1
    s_add_u32 s70, s70, 1
    s_cmp_ge_u32 s70, 0x200000
    s_cbranch_scc1 L_w_done_98
L_wp_142_c:
    s_waitcnt vmcnt(0)
    v_cmp_gt_u32 vcc, s46, v31
    s_nop 1
    s_cbranch_vccz L_wp_142_ok
    s_sleep 2
    s_branch L_wp_142
L_wp_142_ok:
    s_mov_b64 exec, -1
    v_readlane_b32 s78, v31, 0
    v_readlane_b32 s45, v31, 1
    v_readlane_b32 s46, v31, 2
    s_nop 3
    s_min_u32 s78, s78, s45
    s_min_u32 s78, s78, s46
L_xl_141_go:
    s_lshl_b32 s45, s41, 19
    s_lshl_b32 s46, s47, 13
    s_add_u32 s45, s45, s46
    s_add_u32 s45, s45, 0x2000000
    s_add_u32 s46, s45, 4096
    s_add_u32 s48, s45, 16777216
    s_add_u32 s49, s48, 4096
    s_add_u32 s76, s48, 16777216
    s_add_u32 s77, s76, 4096
    buffer_load_dwordx4 v[96:99], v10, s[12:15], s76 offen offset:0 sc1
    buffer_load_dwordx4 v[128:131], v10, s[12:15], s45 offen offset:0 sc1
    buffer_load_dwordx4 v[160:163], v10, s[12:15], s48 offen offset:0 sc1
    buffer_load_dwordx4 v[100:103], v10, s[12:15], s76 offen offset:1024 sc1
    buffer_load_dwordx4 v[144:147], v10, s[12:15], s45 offen offset:1024 sc1
    buffer_load_dwordx4 v[176:179], v10, s[12:15], s48 offen offset:1024 sc1
    buffer_load_dwordx4 v[104:107], v10, s[12:15], s76 offen offset:2048 sc1
    buffer_load_dwordx4 v[132:135], v10, s[12:15], s45 offen offset:2048 sc1
    buffer_load_dwordx4 v[164:167], v10, s[12:15], s48 offen offset:2048 sc1
    buffer_load_dwordx4 v[108:111], v10, s[12:15], s76 offen offset:3072 sc1
    buffer_load_dwordx4 v[148:151], v10, s[12:15], s45 offen offset:3072 sc1
    buffer_load_dwordx4 v[180:183], v10, s[12:15], s48 offen offset:3072 sc1
    buffer_load_dwordx4 v[112:115], v10, s[12:15], s77 offen offset:0 sc1
    buffer_load_dwordx4 v[136:139], v10, s[12:15], s46 offen offset:0 sc1
    buffer_load_dwordx4 v[168:171], v10, s[12:15], s49 offen offset:0 sc1
    buffer_load_dwordx4 v[116:119], v10, s[12:15], s77 offen offset:1024 sc1
    buffer_load_dwordx4 v[152:155], v10, s[12:15], s46 offen offset:1024 sc1
    buffer_load_dwordx4 v[184:187], v10, s[12:15], s49 offen offset:1024 sc1
    buffer_load_dwordx4 v[120:123], v10, s[12:15], s77 offen offset:2048 sc1
    buffer_load_dwordx4 v[140:143], v10, s[12:15], s46 offen offset:2048 sc1
    buffer_load_dwordx4 v[172:175], v10, s[12:15], s49 offen offset:2048 sc1
    buffer_load_dwordx4 v[124:127], v10, s[12:15], s77 offen offset:3072 sc1
    buffer_load_dwordx4 v[156:159], v10, s[12:15], s46 offen offset:3072 sc1
    buffer_load_dwordx4 v[188:191], v10, s[12:15], s49 offen offset:3072 sc1
L_xl_141:
    s_lshl_b32 s45, s38, 10
    s_add_u32 s45, s45, s64
    s_cmp_lg_u32 s44, 0
    s_cbranch_scc1 L_pw_143
    s_mov_b64 exec, 255
    s_mov_b32 s70, 0
L_wp_144:
    buffer_load_dword v31, v5, s[12:15], s45 offen sc1
    s_add_u32 s70, s70, 1
    s_cmp_ge_u32 s70, 0x200000
    s_cbranch_scc1 L_w_done_98
L_wp_144_c:
    s_waitcnt vmcnt(0)
    v_cmp_gt_u32 vcc, s62, v31
    s_nop 1
    s_cbranch_vccz L_wp_144_ok
    s_sleep 1
    s_branch L_wp_144
L_wp_144_ok:
    s_mov_b64 exec, -1
L_pw_143:
    s_barrier
    s_mul_i32 s53, s50, 262144
    s_add_u32 s53, s53, s52
    s_lshl_b32 s54, s44, 13
    s_add_u32 s53, s53, s54
    s_mul_i32 s57, s50, 131072
    s_add_u32 s57, s57, s56
    s_lshl_b32 s45, s44, 7
    s_add_u32 s57, s57, s45
    s_add_u32 s55, s54, 65536
    s_mov_b32 s58, 0
    v_mov_b32 v13, v10
    v_add_u32 v14, 65536, v13
    v_xor_b32 v15, 64, v13
    v_xor_b32 v16, 64, v14
    s_mov_b32 s76, 0x20000000
    s_add_u32 s48, s53, 0
    s_add_u32 s49, s48, 4096
    s_add_u32 m0, s54, 0
    s_nop 0
    buffer_load_dwordx4 v10, s[12:15], s48 offen offset:0 sc1 lds
    buffer_load_dwordx4 v10, s[12:15], s48 offen offset:1024 sc1 lds
    buffer_load_dwordx4 v10, s[12:15], s48 offen offset:2048 sc1 lds
    buffer_load_dwordx4 v10, s[12:15], s48 offen offset:3072 sc1 lds
    s_add_u32 m0, s54, 4096
    s_nop 0
    buffer_load_dwordx4 v10, s[12:15], s49 offen offset:0 sc1 lds
    buffer_load_dwordx4 v10, s[12:15], s49 offen offset:1024 sc1 lds
    buffer_load_dwordx4 v10, s[12:15], s49 offen offset:2048 sc1 lds
    buffer_load_dwordx4 v10, s[12:15], s49 offen offset:3072 sc1 lds
    s_add_u32 s48, s53, 32768
    s_add_u32 s49, s48, 4096
    s_add_u32 s46, s54, 32768
    s_add_u32 m0, s46, 0
    s_nop 0
    buffer_load_dwordx4 v10, s[12:15], s48 offen offset:0 sc1 lds
    buffer_load_dwordx4 v10, s[12:15], s48 offen offset:1024 sc1 lds
    buffer_load_dwordx4 v10, s[12:15], s48 offen offset:2048 sc1 lds
    buffer_load_dwordx4 v10, s[12:15], s48 offen offset:3072 sc1 lds
    s_add_u32 m0, s46, 4096
    s_nop 0
    buffer_load_dwordx4 v10, s[12:15], s49 offen offset:0 sc1 lds
    buffer_load_dwordx4 v10, s[12:15], s49 offen offset:1024 sc1 lds
    buffer_load_dwordx4 v10, s[12:15], s49 offen offset:2048 sc1 lds
    buffer_load_dwordx4 v10, s[12:15], s49 offen offset:3072 sc1 lds
    s_cmp_eq_u32 s51, 1
    s_cbranch_scc1 L_e_one_146
    s_add_u32 s48, s53, 262144
    s_add_u32 s49, s48, 4096
    s_add_u32 m0, s55, 0
    s_nop 0
    buffer_load_dwordx4 v10, s[12:15], s48 offen offset:0 sc1 lds
    buffer_load_dwordx4 v10, s[12:15], s48 offen offset:1024 sc1 lds
    buffer_load_dwordx4 v10, s[12:15], s48 offen offset:2048 sc1 lds
    buffer_load_dwordx4 v10, s[12:15], s48 offen offset:3072 sc1 lds
    s_add_u32 m0, s55, 4096
    s_nop 0
    buffer_load_dwordx4 v10, s[12:15], s49 offen offset:0 sc1 lds
    buffer_load_dwordx4 v10, s[12:15], s49 offen offset:1024 sc1 lds
    buffer_load_dwordx4 v10, s[12:15], s49 offen offset:2048 sc1 lds
    buffer_load_dwordx4 v10, s[12:15], s49 offen offset:3072 sc1 lds
    s_waitcnt vmcnt(16)
    s_barrier
    ds_read_b128 v[32:35], v13 offset:0
    ds_read_b128 v[36:39], v13 offset:1024
    ds_read_b128 v[40:43], v13 offset:2048
    ds_read_b128 v[44:47], v13 offset:3072
    s_add_u32 s48, s53, 294912
    s_add_u32 s46, s58, 1
    s_cmp_lt_u32 s46, s51
    s_cselect_b32 s48, s48, 0x20000000
    s_add_u32 s49, s48, 4096
    s_add_u32 s59, s55, 32768
L_e_loop_145:
    s_waitcnt lgkmcnt(2)
    v_mfma_f32_16x16x32_bf16 v[80:83], a[0:3], v[32:35], 0
    ds_read_b128 v[48:51], v13 offset:4096
    v_mfma_f32_16x16x32_bf16 v[84:87], a[4:7], v[32:35], 0
    ds_read_b128 v[52:55], v13 offset:5120
    v_mfma_f32_16x16x32_bf16 v[88:91], a[0:3], v[36:39], 0
    ds_read_b128 v[56:59], v13 offset:6144
    s_add_u32 m0, s59, 0
    v_mfma_f32_16x16x32_bf16 v[92:95], a[4:7], v[36:39], 0
    ds_read_b128 v[60:63], v13 offset:7168
    buffer_load_dwordx4 v10, s[12:15], s48 offen offset:0 sc1 lds
    s_waitcnt lgkmcnt(4)
    v_mfma_f32_16x16x32_bf16 v[80:83], a[8:11], v[40:43], v[80:83]
    ds_read_b128 v[32:35], v13 offset:8192
    v_mfma_f32_16x16x32_bf16 v[84:87], a[12:15], v[40:43], v[84:87]
    ds_read_b128 v[36:39], v13 offset:9216
    v_mfma_f32_16x16x32_bf16 v[88:91], a[8:11], v[44:47], v[88:91]
    v_mfma_f32_16x16x32_bf16 v[92:95], a[12:15], v[44:47], v[92:95]
    buffer_load_dwordx4 v10, s[12:15], s48 offen offset:1024 sc1 lds
    s_waitcnt lgkmcnt(4)
    v_mfma_f32_16x16x32_bf16 v[80:83], a[16:19], v[48:51], v[80:83]
    ds_read_b128 v[40:43], v13 offset:10240
    v_mfma_f32_16x16x32_bf16 v[84:87], a[20:23], v[48:51], v[84:87]
    ds_read_b128 v[44:47], v13 offset:11264
    v_mfma_f32_16x16x32_bf16 v[88:91], a[16:19], v[52:55], v[88:91]
    v_mfma_f32_16x16x32_bf16 v[92:95], a[20:23], v[52:55], v[92:95]
    buffer_load_dwordx4 v10, s[12:15], s48 offen offset:2048 sc1 lds
    s_waitcnt lgkmcnt(4)
    v_mfma_f32_16x16x32_bf16 v[80:83], a[24:27], v[56:59], v[80:83]
    ds_read_b128 v[48:51], v13 offset:12288
    v_mfma_f32_16x16x32_bf16 v[84:87], a[28:31], v[56:59], v[84:87]
    ds_read_b128 v[52:55], v13 offset:13312
    v_mfma_f32_16x16x32_bf16 v[88:91], a[24:27], v[60:63], v[88:91]
    v_mfma_f32_16x16x32_bf16 v[92:95], a[28:31], v[60:63], v[92:95]
    buffer_load_dwordx4 v10, s[12:15], s48 offen offset:3072 sc1 lds
    s_waitcnt lgkmcnt(4)
    v_mfma_f32_16x16x32_bf16 v[80:83], a[32:35], v[32:35], v[80:83]
    ds_read_b128 v[56:59], v13 offset:14336
    v_mfma_f32_16x16x32_bf16 v[84:87], a[36:39], v[32:35], v[84:87]
    ds_read_b128 v[60:63], v13 offset:15360
    v_mfma_f32_16x16x32_bf16 v[88:91], a[32:35], v[36:39], v[88:91]
    s_add_u32 m0, s59, 4096
    v_mfma_f32_16x16x32_bf16 v[92:95], a[36:39], v[36:39], v[92:95]
    buffer_load_dwordx4 v10, s[12:15], s49 offen offset:0 sc1 lds
    s_waitcnt lgkmcnt(4)
    v_mfma_f32_16x16x32_bf16 v[80:83], a[40:43], v[40:43], v[80:83]
    ds_read_b128 v[32:35], v13 offset:16384
    v_mfma_f32_16x16x32_bf16 v[84:87], a[44:47], v[40:43], v[84:87]
    ds_read_b128 v[36:39], v13 offset:17408
    v_mfma_f32_16x16x32_bf16 v[88:91], a[40:43], v[44:47], v[88:91]
    v_mfma_f32_16x16x32_bf16 v[92:95], a[44:47], v[44:47], v[92:95]
    buffer_load_dwordx4 v10, s[12:15], s49 offen offset:1024 sc1 lds
    s_waitcnt lgkmcnt(4)
    v_mfma_f32_16x16x32_bf16 v[80:83], a[48:51], v[48:51], v[80:83]
    ds_read_b128 v[40:43], v13 offset:18432
    v_mfma_f32_16x16x32_bf16 v[84:87], a[52:55], v[48:51], v[84:87]
    ds_read_b128 v[44:47], v13 offset:19456
    v_mfma_f32_16x16x32_bf16 v[88:91], a[48:51], v[52:55], v[88:91]
    v_mfma_f32_16x16x32_bf16 v[92:95], a[52:55], v[52:55], v[92:95]
    buffer_load_dwordx4 v10, s[12:15], s49 offen offset:2048 sc1 lds
    s_waitcnt lgkmcnt(4)
    v_mfma_f32_16x16x32_bf16 v[80:83], a[56:59], v[56:59], v[80:83]
    ds_read_b128 v[48:51], v13 offset:20480
    v_mfma_f32_16x16x32_bf16 v[84:87], a[60:63], v[56:59], v[84:87]
    ds_read_b128 v[52:55], v13 offset:21504
    v_mfma_f32_16x16x32_bf16 v[88:91], a[56:59], v[60:63], v[88:91]
    v_mfma_f32_16x16x32_bf16 v[92:95], a[60:63], v[60:63], v[92:95]
    buffer_load_dwordx4 v10, s[12:15], s49 offen offset:3072 sc1 lds
    s_waitcnt lgkmcnt(4)
    v_mfma_f32_16x16x32_bf16 v[80:83], a[64:67], v[32:35], v[80:83]
    ds_read_b128 v[56:59], v13 offset:22528
    v_mfma_f32_16x16x32_bf16 v[84:87], a[68:71], v[32:35], v[84:87]
    ds_read_b128 v[60:63], v13 offset:23552
    v_mfma_f32_16x16x32_bf16 v[88:91], a[64:67], v[36:39], v[88:91]
    s_add_u32 s48, s53, 524288
    v_mfma_f32_16x16x32_bf16 v[92:95], a[68:71], v[36:39], v[92:95]
    s_add_u32 s46, s58, 2
    s_waitcnt lgkmcnt(4)
    v_mfma_f32_16x16x32_bf16 v[80:83], a[72:75], v[40:43], v[80:83]
    ds_read_b128 v[32:35], v13 offset:24576
    v_mfma_f32_16x16x32_bf16 v[84:87], a[76:79], v[40:43], v[84:87]
    ds_read_b128 v[36:39], v13 offset:25600
    v_mfma_f32_16x16x32_bf16 v[88:91], a[72:75], v[44:47], v[88:91]
    s_cmp_lt_u32 s46, s51
    s_cselect_b32 s48, s48, 0x20000000
    v_mfma_f32_16x16x32_bf16 v[92:95], a[76:79], v[44:47], v[92:95]
    s_add_u32 s49, s48, 4096
    s_waitcnt lgkmcnt(4)
    v_mfma_f32_16x16x32_bf16 v[80:83], a[80:83], v[48:51], v[80:83]
    ds_read_b128 v[40:43], v13 offset:26624
    v_mfma_f32_16x16x32_bf16 v[84:87], a[84:87], v[48:51], v[84:87]
    ds_read_b128 v[44:47], v13 offset:27648
    v_mfma_f32_16x16x32_bf16 v[88:91], a[80:83], v[52:55], v[88:91]
    s_mov_b32 s59, s54
    v_mfma_f32_16x16x32_bf16 v[92:95], a[84:87], v[52:55], v[92:95]
    s_waitcnt lgkmcnt(4)
    v_mfma_f32_16x16x32_bf16 v[80:83], a[88:91], v[56:59], v[80:83]
    ds_read_b128 v[48:51], v13 offset:28672
    v_mfma_f32_16x16x32_bf16 v[84:87], a[92:95], v[56:59], v[84:87]
    ds_read_b128 v[52:55], v13 offset:29696
    v_mfma_f32_16x16x32_bf16 v[88:91], a[88:91], v[60:63], v[88:91]
    v_mfma_f32_16x16x32_bf16 v[92:95], a[92:95], v[60:63], v[92:95]
    s_waitcnt lgkmcnt(4)
    v_mfma_f32_16x16x32_bf16 v[80:83], a[96:99], v[32:35], v[80:83]
    ds_read_b128 v[56:59], v13 offset:30720
    v_mfma_f32_16x16x32_bf16 v[84:87], a[100:103], v[32:35], v[84:87]
    ds_read_b128 v[60:63], v13 offset:31744
    v_mfma_f32_16x16x32_bf16 v[88:91], a[96:99], v[36:39], v[88:91]
    v_mfma_f32_16x16x32_bf16 v[92:95], a[100:103], v[36:39], v[92:95]
    s_waitcnt lgkmcnt(4)
    v_mfma_f32_16x16x32_bf16 v[80:83], a[104:107], v[40:43], v[80:83]
    ds_read_b128 v[216:219], v8 offset:0
    v_mfma_f32_16x16x32_bf16 v[84:87], a[108:111], v[40:43], v[84:87]
    ds_read_b128 v[220:223], v8 offset:1152
    v_mfma_f32_16x16x32_bf16 v[88:91], a[104:107], v[44:47], v[88:91]
    ds_read_b128 v[224:227], v8 offset:2304
    v_mfma_f32_16x16x32_bf16 v[92:95], a[108:111], v[44:47], v[92:95]
    ds_read_b128 v[228:231], v8 offset:3456
    s_waitcnt vmcnt(16) lgkmcnt(0)
    s_barrier
    v_mfma_f32_16x16x32_bf16 v[80:83], a[112:115], v[48:51], v[80:83]
    ds_read_b128 v[32:35], v13 offset:32768
    buffer_store_dwordx4 v[216:219], v11, s[12:15], s76 offen sc1
    v_mfma_f32_16x16x32_bf16 v[84:87], a[116:119], v[48:51], v[84:87]
    ds_read_b128 v[36:39], v13 offset:33792
    s_add_u32 s76, s76, 32768
    v_mfma_f32_16x16x32_bf16 v[88:91], a[112:115], v[52:55], v[88:91]
    buffer_store_dwordx4 v[220:223], v11, s[12:15], s76 offen sc1
    s_add_u32 s76, s76, 32768
    v_mfma_f32_16x16x32_bf16 v[92:95], a[116:119], v[52:55], v[92:95]
    buffer_store_dwordx4 v[224:227], v11, s[12:15], s76 offen sc1
    v_mfma_f32_16x16x32_bf16 v[80:83], a[120:123], v[56:59], v[80:83]
    ds_read_b128 v[40:43], v13 offset:34816
    s_add_u32 s76, s76, 32768
    v_mfma_f32_16x16x32_bf16 v[84:87], a[124:127], v[56:59], v[84:87]
    ds_read_b128 v[44:47], v13 offset:35840
    buffer_store_dwordx4 v[228:231], v11, s[12:15], s76 offen sc1
    v_mfma_f32_16x16x32_bf16 v[88:91], a[120:123], v[60:63], v[88:91]
    v_mfma_f32_16x16x32_bf16 v[92:95], a[124:127], v[60:63], v[92:95]
    s_waitcnt lgkmcnt(2)
    v_mfma_f32_16x16x32_bf16 v[80:83], a[128:131], v[32:35], v[80:83]
    ds_read_b128 v[48:51], v13 offset:36864
    v_mfma_f32_16x16x32_bf16 v[84:87], a[132:135], v[32:35], v[84:87]
    ds_read_b128 v[52:55], v13 offset:37888
    v_mfma_f32_16x16x32_bf16 v[88:91], a[128:131], v[36:39], v[88:91]
    ds_read_b128 v[56:59], v13 offset:38912
    s_add_u32 m0, s59, 0
    v_mfma_f32_16x16x32_bf16 v[92:95], a[132:135], v[36:39], v[92:95]
    ds_read_b128 v[60:63], v13 offset:39936
    buffer_load_dwordx4 v10, s[12:15], s48 offen offset:0 sc1 lds
    s_waitcnt lgkmcnt(4)
    v_mfma_f32_16x16x32_bf16 v[80:83], a[136:139], v[40:43], v[80:83]
    ds_read_b128 v[32:35], v13 offset:40960
    v_mfma_f32_16x16x32_bf16 v[84:87], a[140:143], v[40:43], v[84:87]
    ds_read_b128 v[36:39], v13 offset:41984
    v_mfma_f32_16x16x32_bf16 v[88:91], a[136:139], v[44:47], v[88:91]
    v_mfma_f32_16x16x32_bf16 v[92:95], a[140:143], v[44:47], v[92:95]
    buffer_load_dwordx4 v10, s[12:15], s48 offen offset:1024 sc1 lds
    s_waitcnt lgkmcnt(4)
    v_mfma_f32_16x16x32_bf16 v[80:83], a[144:147], v[48:51], v[80:83]
    ds_read_b128 v[40:43], v13 offset:43008
    v_mfma_f32_16x16x32_bf16 v[84:87], a[148:151], v[48:51], v[84:87]
    ds_read_b128 v[44:47], v13 offset:44032
    v_mfma_f32_16x16x32_bf16 v[88:91], a[144:147], v[52:55], v[88:91]
    v_mfma_f32_16x16x32_bf16 v[92:95], a[148:151], v[52:55], v[92:95]
    buffer_load_dwordx4 v10, s[12:15], s48 offen offset:2048 sc1 lds
    s_waitcnt lgkmcnt(4)
    v_mfma_f32_16x16x32_bf16 v[80:83], a[152:155], v[56:59], v[80:83]
    ds_read_b128 v[48:51], v13 offset:45056
    v_mfma_f32_16x16x32_bf16 v[84:87], a[156:159], v[56:59], v[84:87]
    ds_read_b128 v[52:55], v13 offset:46080
    v_mfma_f32_16x16x32_bf16 v[88:91], a[152:155], v[60:63], v[88:91]
    v_mfma_f32_16x16x32_bf16 v[92:95], a[156:159], v[60:63], v[92:95]
    buffer_load_dwordx4 v10, s[12:15], s48 offen offset:3072 sc1 lds
    s_waitcnt lgkmcnt(4)
    v_mfma_f32_16x16x32_bf16 v[80:83], a[160:163], v[32:35], v[80:83]
    ds_read_b128 v[56:59], v13 offset:47104
    v_mfma_f32_16x16x32_bf16 v[84:87], a[164:167], v[32:35], v[84:87]
    ds_read_b128 v[60:63], v13 offset:48128
    v_mfma_f32_16x16x32_bf16 v[88:91], a[160:163], v[36:39], v[88:91]
    s_add_u32 m0, s59, 4096
    v_mfma_f32_16x16x32_bf16 v[92:95], a[164:167], v[36:39], v[92:95]
    buffer_load_dwordx4 v10, s[12:15], s49 offen offset:0 sc1 lds
    s_waitcnt lgkmcnt(4)
    v_mfma_f32_16x16x32_bf16 v[80:83], a[168:171], v[40:43], v[80:83]
    ds_read_b128 v[32:35], v13 offset:49152
    v_mfma_f32_16x16x32_bf16 v[84:87], a[172:175], v[40:43], v[84:87]
    ds_read_b128 v[36:39], v13 offset:50176
    v_mfma_f32_16x16x32_bf16 v[88:91], a[168:171], v[44:47], v[88:91]
    v_mfma_f32_16x16x32_bf16 v[92:95], a[172:175], v[44:47], v[92:95]
    buffer_load_dwordx4 v10, s[12:15], s49 offen offset:1024 sc1 lds
    s_waitcnt lgkmcnt(4)
    v_mfma_f32_16x16x32_bf16 v[80:83], a[176:179], v[48:51], v[80:83]
    ds_read_b128 v[40:43], v13 offset:51200
    v_mfma_f32_16x16x32_bf16 v[84:87], a[180:183], v[48:51], v[84:87]
    ds_read_b128 v[44:47], v13 offset:52224
    v_mfma_f32_16x16x32_bf16 v[88:91], a[176:179], v[52:55], v[88:91]
    v_mfma_f32_16x16x32_bf16 v[92:95], a[180:183], v[52:55], v[92:95]
    buffer_load_dwordx4 v10, s[12:15], s49 offen offset:2048 sc1 lds
    s_waitcnt lgkmcnt(4)
    v_mfma_f32_16x16x32_bf16 v[80:83], a[184:187], v[56:59], v[80:83]
    ds_read_b128 v[48:51], v13 offset:53248
    v_mfma_f32_16x16x32_bf16 v[84:87], a[188:191], v[56:59], v[84:87]
    ds_read_b128 v[52:55], v13 offset:54272
    v_mfma_f32_16x16x32_bf16 v[88:91], a[184:187], v[60:63], v[88:91]
    v_mfma_f32_16x16x32_bf16 v[92:95], a[188:191], v[60:63], v[92:95]
    buffer_load_dwordx4 v10, s[12:15], s49 offen offset:3072 sc1 lds
    s_waitcnt lgkmcnt(4)
    v_mfma_f32_16x16x32_bf16 v[80:83], a[192:195], v[32:35], v[80:83]
    ds_read_b128 v[56:59], v13 offset:55296
    v_mfma_f32_16x16x32_bf16 v[84:87], a[196:199], v[32:35], v[84:87]
    ds_read_b128 v[60:63], v13 offset:56320
    v_mfma_f32_16x16x32_bf16 v[88:91], a[192:195], v[36:39], v[88:91]
    s_add_u32 s48, s53, 557056
    v_mfma_f32_16x16x32_bf16 v[92:95], a[196:199], v[36:39], v[92:95]
    s_add_u32 s46, s58, 2
    s_waitcnt lgkmcnt(4)
    v_mfma_f32_16x16x32_bf16 v[80:83], a[200:203], v[40:43], v[80:83]
    ds_read_b128 v[32:35], v13 offset:57344
    v_mfma_f32_16x16x32_bf16 v[84:87], a[204:207], v[40:43], v[84:87]
    ds_read_b128 v[36:39], v13 offset:58368
    v_mfma_f32_16x16x32_bf16 v[88:91], a[200:203], v[44:47], v[88:91]
    s_cmp_lt_u32 s46, s51
    s_cselect_b32 s48, s48, 0x20000000
    v_mfma_f32_16x16x32_bf16 v[92:95], a[204:207], v[44:47], v[92:95]
    s_add_u32 s49, s48, 4096
    s_waitcnt lgkmcnt(4)
    v_mfma_f32_16x16x32_bf16 v[80:83], a[208:211], v[48:51], v[80:83]
    ds_read_b128 v[40:43], v13 offset:59392
    v_mfma_f32_16x16x32_bf16 v[84:87], a[212:215], v[48:51], v[84:87]
    ds_read_b128 v[44:47], v13 offset:60416
    v_mfma_f32_16x16x32_bf16 v[88:91], a[208:211], v[52:55], v[88:91]
    s_add_u32 s59, s54, 32768
    v_mfma_f32_16x16x32_bf16 v[92:95], a[212:215], v[52:55], v[92:95]
    s_waitcnt lgkmcnt(4)
    v_mfma_f32_16x16x32_bf16 v[80:83], a[216:219], v[56:59], v[80:83]
    ds_read_b128 v[48:51], v13 offset:61440
    v_mfma_f32_16x16x32_bf16 v[84:87], a[220:223], v[56:59], v[84:87]
    ds_read_b128 v[52:55], v13 offset:62464
    v_mfma_f32_16x16x32_bf16 v[88:91], a[216:219], v[60:63], v[88:91]
    v_mfma_f32_16x16x32_bf16 v[92:95], a[220:223], v[60:63], v[92:95]
    s_waitcnt lgkmcnt(4)
    v_mfma_f32_16x16x32_bf16 v[80:83], a[224:227], v[32:35], v[80:83]
    ds_read_b128 v[56:59], v13 offset:63488
    v_mfma_f32_16x16x32_bf16 v[84:87], a[228:231], v[32:35], v[84:87]
    ds_read_b128 v[60:63], v13 offset:64512
    v_mfma_f32_16x16x32_bf16 v[88:91], a[224:227], v[36:39], v[88:91]
    v_mfma_f32_16x16x32_bf16 v[92:95], a[228:231], v[36:39], v[92:95]
    s_waitcnt lgkmcnt(4)
    v_mfma_f32_16x16x32_bf16 v[80:83], a[232:235], v[40:43], v[80:83]
    v_mfma_f32_16x16x32_bf16 v[84:87], a[236:239], v[40:43], v[84:87]
    v_mfma_f32_16x16x32_bf16 v[88:91], a[232:235], v[44:47], v[88:91]
    v_mfma_f32_16x16x32_bf16 v[92:95], a[236:239], v[44:47], v[92:95]
    s_waitcnt vmcnt(16) lgkmcnt(0)
    s_barrier
    v_mfma_f32_16x16x32_bf16 v[80:83], a[240:243], v[48:51], v[80:83]
    ds_read_b128 v[32:35], v14 offset:0
    v_mfma_f32_16x16x32_bf16 v[84:87], a[244:247], v[48:51], v[84:87]
    ds_read_b128 v[36:39], v14 offset:1024
    v_mfma_f32_16x16x32_bf16 v[88:91], a[240:243], v[52:55], v[88:91]
    v_mfma_f32_16x16x32_bf16 v[92:95], a[244:247], v[52:55], v[92:95]
    v_mfma_f32_16x16x32_bf16 v[80:83], a[248:251], v[56:59], v[80:83]
    ds_read_b128 v[40:43], v14 offset:2048
    v_mfma_f32_16x16x32_bf16 v[84:87], a[252:255], v[56:59], v[84:87]
    ds_read_b128 v[44:47], v14 offset:3072
    v_mfma_f32_16x16x32_bf16 v[88:91], a[248:251], v[60:63], v[88:91]
    v_mfma_f32_16x16x32_bf16 v[92:95], a[252:255], v[60:63], v[92:95]
    s_add_u32 s53, s53, 262144
    s_add_u32 s58, s58, 1
    v_swap_b32 v13, v14
    s_xor_b32 s54, s54, 65536
    s_xor_b32 s55, s55, 65536
    s_mov_b32 s76, s57
    v_swap_b32 v15, v16
    s_add_u32 s57, s57, 131072
    ds_write_b128 v7, v[80:83] offset:0
    ds_write_b128 v7, v[84:87] offset:64
    ds_write_b128 v7, v[88:91] offset:2304
    ds_write_b128 v7, v[92:95] offset:2368
    s_cmp_lt_u32 s58, s51
    s_cbranch_scc1 L_e_loop_145
    s_branch L_e_fin_147
L_e_one_146:
    s_waitcnt vmcnt(8)
    s_barrier
    ds_read_b128 v[32:35], v13 offset:0
    ds_read_b128 v[36:39], v13 offset:1024
    ds_read_b128 v[40:43], v13 offset:2048
    ds_read_b128 v[44:47], v13 offset:3072
    s_waitcnt lgkmcnt(2)
    v_mfma_f32_16x16x32_bf16 v[80:83], a[0:3], v[32:35], 0
    ds_read_b128 v[48:51], v13 offset:4096
    v_mfma_f32_16x16x32_bf16 v[84:87], a[4:7], v[32:35], 0
    ds_read_b128 v[52:55], v13 offset:5120
    v_mfma_f32_16x16x32_bf16 v[88:91], a[0:3], v[36:39], 0
    ds_read_b128 v[56:59], v13 offset:6144
    v_mfma_f32_16x16x32_bf16 v[92:95], a[4:7], v[36:39], 0
    ds_read_b128 v[60:63], v13 offset:7168
    s_waitcnt lgkmcnt(4)
    v_mfma_f32_16x16x32_bf16 v[80:83], a[8:11], v[40:43], v[80:83]
    ds_read_b128 v[32:35], v13 offset:8192
    v_mfma_f32_16x16x32_bf16 v[84:87], a[12:15], v[40:43], v[84:87]
    ds_read_b128 v[36:39], v13 offset:9216
    v_mfma_f32_16x16x32_bf16 v[88:91], a[8:11], v[44:47], v[88:91]
    v_mfma_f32_16x16x32_bf16 v[92:95], a[12:15], v[44:47], v[92:95]
    s_waitcnt lgkmcnt(4)
    v_mfma_f32_16x16x32_bf16 v[80:83], a[16:19], v[48:51], v[80:83]
    ds_read_b128 v[40:43], v13 offset:10240
    v_mfma_f32_16x16x32_bf16 v[84:87], a[20:23], v[48:51], v[84:87]
    ds_read_b128 v[44:47], v13 offset:11264
    v_mfma_f32_16x16x32_bf16 v[88:91], a[16:19], v[52:55], v[88:91]
    v_mfma_f32_16x16x32_bf16 v[92:95], a[20:23], v[52:55], v[92:95]
    s_waitcnt lgkmcnt(4)
    v_mfma_f32_16x16x32_bf16 v[80:83], a[24:27], v[56:59], v[80:83]
    ds_read_b128 v[48:51], v13 offset:12288
    v_mfma_f32_16x16x32_bf16 v[84:87], a[28:31], v[56:59], v[84:87]
    ds_read_b128 v[52:55], v13 offset:13312
    v_mfma_f32_16x16x32_bf16 v[88:91], a[24:27], v[60:63], v[88:91]
    v_mfma_f32_16x16x32_bf16 v[92:95], a[28:31], v[60:63], v[92:95]
    s_waitcnt lgkmcnt(4)
    v_mfma_f32_16x16x32_bf16 v[80:83], a[32:35], v[32:35], v[80:83]
    ds_read_b128 v[56:59], v13 offset:14336
    v_mfma_f32_16x16x32_bf16 v[84:87], a[36:39], v[32:35], v[84:87]
    ds_read_b128 v[60:63], v13 offset:15360
    v_mfma_f32_16x16x32_bf16 v[88:91], a[32:35], v[36:39], v[88:91]
    v_mfma_f32_16x16x32_bf16 v[92:95], a[36:39], v[36:39], v[92:95]
    s_waitcnt lgkmcnt(4)
    v_mfma_f32_16x16x32_bf16 v[80:83], a[40:43], v[40:43], v[80:83]
    ds_read_b128 v[32:35], v13 offset:16384
    v_mfma_f32_16x16x32_bf16 v[84:87], a[44:47], v[40:43], v[84:87]
    ds_read_b128 v[36:39], v13 offset:17408
    v_mfma_f32_16x16x32_bf16 v[88:91], a[40:43], v[44:47], v[88:91]
    v_mfma_f32_16x16x32_bf16 v[92:95], a[44:47], v[44:47], v[92:95]
    s_waitcnt lgkmcnt(4)
    v_mfma_f32_16x16x32_bf16 v[80:83], a[48:51], v[48:51], v[80:83]
    ds_read_b128 v[40:43], v13 offset:18432
    v_mfma_f32_16x16x32_bf16 v[84:87], a[52:55], v[48:51], v[84:87]
    ds_read_b128 v[44:47], v13 offset:19456
    v_mfma_f32_16x16x32_bf16 v[88:91], a[48:51], v[52:55], v[88:91]
    v_mfma_f32_16x16x32_bf16 v[92:95], a[52:55], v[52:55], v[92:95]
    s_waitcnt lgkmcnt(4)
    v_mfma_f32_16x16x32_bf16 v[80:83], a[56:59], v[56:59], v[80:83]
    ds_read_b128 v[48:51], v13 offset:20480
    v_mfma_f32_16x16x32_bf16 v[84:87], a[60:63], v[56:59], v[84:87]
    ds_read_b128 v[52:55], v13 offset:21504
    v_mfma_f32_16x16x32_bf16 v[88:91], a[56:59], v[60:63], v[88:91]
    v_mfma_f32_16x16x32_bf16 v[92:95], a[60:63], v[60:63], v[92:95]
    s_waitcnt lgkmcnt(4)
    v_mfma_f32_16x16x32_bf16 v[80:83], a[64:67], v[32:35], v[80:83]
    ds_read_b128 v[56:59], v13 offset:22528
    v_mfma_f32_16x16x32_bf16 v[84:87], a[68:71], v[32:35], v[84:87]
    ds_read_b128 v[60:63], v13 offset:23552
    v_mfma_f32_16x16x32_bf16 v[88:91], a[64:67], v[36:39], v[88:91]
    v_mfma_f32_16x16x32_bf16 v[92:95], a[68:71], v[36:39], v[92:95]
    s_waitcnt lgkmcnt(4)
    v_mfma_f32_16x16x32_bf16 v[80:83], a[72:75], v[40:43], v[80:83]
    ds_read_b128 v[32:35], v13 offset:24576
    v_mfma_f32_16x16x32_bf16 v[84:87], a[76:79], v[40:43], v[84:87]
    ds_read_b128 v[36:39], v13 offset:25600
    v_mfma_f32_16x16x32_bf16 v[88:91], a[72:75], v[44:47], v[88:91]
    v_mfma_f32_16x16x32_bf16 v[92:95], a[76:79], v[44:47], v[92:95]
    s_waitcnt lgkmcnt(4)
    v_mfma_f32_16x16x32_bf16 v[80:83], a[80:83], v[48:51], v[80:83]
    ds_read_b128 v[40:43], v13 offset:26624
    v_mfma_f32_16x16x32_bf16 v[84:87], a[84:87], v[48:51], v[84:87]
    ds_read_b128 v[44:47], v13 offset:27648
    v_mfma_f32_16x16x32_bf16 v[88:91], a[80:83], v[52:55], v[88:91]
    v_mfma_f32_16x16x32_bf16 v[92:95], a[84:87], v[52:55], v[92:95]
    s_waitcnt lgkmcnt(4)
    v_mfma_f32_16x16x32_bf16 v[80:83], a[88:91], v[56:59], v[80:83]
    ds_read_b128 v[48:51], v13 offset:28672
    v_mfma_f32_16x16x32_bf16 v[84:87], a[92:95], v[56:59], v[84:87]
    ds_read_b128 v[52:55], v13 offset:29696
    v_mfma_f32_16x16x32_bf16 v[88:91], a[88:91], v[60:63], v[88:91]
    v_mfma_f32_16x16x32_bf16 v[92:95], a[92:95], v[60:63], v[92:95]
    s_waitcnt lgkmcnt(4)
    v_mfma_f32_16x16x32_bf16 v[80:83], a[96:99], v[32:35], v[80:83]
    ds_read_b128 v[56:59], v13 offset:30720
    v_mfma_f32_16x16x32_bf16 v[84:87], a[100:103], v[32:35], v[84:87]
    ds_read_b128 v[60:63], v13 offset:31744
    v_mfma_f32_16x16x32_bf16 v[88:91], a[96:99], v[36:39], v[88:91]
    v_mfma_f32_16x16x32_bf16 v[92:95], a[100:103], v[36:39], v[92:95]
    s_waitcnt lgkmcnt(4)
    v_mfma_f32_16x16x32_bf16 v[80:83], a[104:107], v[40:43], v[80:83]
    v_mfma_f32_16x16x32_bf16 v[84:87], a[108:111], v[40:43], v[84:87]
    v_mfma_f32_16x16x32_bf16 v[88:91], a[104:107], v[44:47], v[88:91]
    v_mfma_f32_16x16x32_bf16 v[92:95], a[108:111], v[44:47], v[92:95]
    s_waitcnt vmcnt(0) lgkmcnt(0)
    s_barrier
    v_mfma_f32_16x16x32_bf16 v[80:83], a[112:115], v[48:51], v[80:83]
    ds_read_b128 v[32:35], v13 offset:32768
    v_mfma_f32_16x16x32_bf16 v[84:87], a[116:119], v[48:51], v[84:87]
    ds_read_b128 v[36:39], v13 offset:33792
    v_mfma_f32_16x16x32_bf16 v[88:91], a[112:115], v[52:55], v[88:91]
    v_mfma_f32_16x16x32_bf16 v[92:95], a[116:119], v[52:55], v[92:95]
    v_mfma_f32_16x16x32_bf16 v[80:83], a[120:123], v[56:59], v[80:83]
    ds_read_b128 v[40:43], v13 offset:34816
    v_mfma_f32_16x16x32_bf16 v[84:87], a[124:127], v[56:59], v[84:87]
    ds_read_b128 v[44:47], v13 offset:35840
    v_mfma_f32_16x16x32_bf16 v[88:91], a[120:123], v[60:63], v[88:91]
    v_mfma_f32_16x16x32_bf16 v[92:95], a[124:127], v[60:63], v[92:95]
    s_waitcnt lgkmcnt(2)
    v_mfma_f32_16x16x32_bf16 v[80:83], a[128:131], v[32:35], v[80:83]
    ds_read_b128 v[48:51], v13 offset:36864
    v_mfma_f32_16x16x32_bf16 v[84:87], a[132:135], v[32:35], v[84:87]
    ds_read_b128 v[52:55], v13 offset:37888
    v_mfma_f32_16x16x32_bf16 v[88:91], a[128:131], v[36:39], v[88:91]
    ds_read_b128 v[56:59], v13 offset:38912
    v_mfma_f32_16x16x32_bf16 v[92:95], a[132:135], v[36:39], v[92:95]
    ds_read_b128 v[60:63], v13 offset:39936
    s_waitcnt lgkmcnt(4)
    v_mfma_f32_16x16x32_bf16 v[80:83], a[136:139], v[40:43], v[80:83]
    ds_read_b128 v[32:35], v13 offset:40960
    v_mfma_f32_16x16x32_bf16 v[84:87], a[140:143], v[40:43], v[84:87]
    ds_read_b128 v[36:39], v13 offset:41984
    v_mfma_f32_16x16x32_bf16 v[88:91], a[136:139], v[44:47], v[88:91]
    v_mfma_f32_16x16x32_bf16 v[92:95], a[140:143], v[44:47], v[92:95]
    s_waitcnt lgkmcnt(4)
    v_mfma_f32_16x16x32_bf16 v[80:83], a[144:147], v[48:51], v[80:83]
    ds_read_b128 v[40:43], v13 offset:43008
    v_mfma_f32_16x16x32_bf16 v[84:87], a[148:151], v[48:51], v[84:87]
    ds_read_b128 v[44:47], v13 offset:44032
    v_mfma_f32_16x16x32_bf16 v[88:91], a[144:147], v[52:55], v[88:91]
    v_mfma_f32_16x16x32_bf16 v[92:95], a[148:151], v[52:55], v[92:95]
    s_waitcnt lgkmcnt(4)
    v_mfma_f32_16x16x32_bf16 v[80:83], a[152:155], v[56:59], v[80:83]
    ds_read_b128 v[48:51], v13 offset:45056
    v_mfma_f32_16x16x32_bf16 v[84:87], a[156:159], v[56:59], v[84:87]
    ds_read_b128 v[52:55], v13 offset:46080
    v_mfma_f32_16x16x32_bf16 v[88:91], a[152:155], v[60:63], v[88:91]
    v_mfma_f32_16x16x32_bf16 v[92:95], a[156:159], v[60:63], v[92:95]
    s_waitcnt lgkmcnt(4)
    v_mfma_f32_16x16x32_bf16 v[80:83], a[160:163], v[32:35], v[80:83]
    ds_read_b128 v[56:59], v13 offset:47104
    v_mfma_f32_16x16x32_bf16 v[84:87], a[164:167], v[32:35], v[84:87]
    ds_read_b128 v[60:63], v13 offset:48128
    v_mfma_f32_16x16x32_bf16 v[88:91], a[160:163], v[36:39], v[88:91]
    v_mfma_f32_16x16x32_bf16 v[92:95], a[164:167], v[36:39], v[92:95]
    s_waitcnt lgkmcnt(4)
    v_mfma_f32_16x16x32_bf16 v[80:83], a[168:171], v[40:43], v[80:83]
    ds_read_b128 v[32:35], v13 offset:49152
    v_mfma_f32_16x16x32_bf16 v[84:87], a[172:175], v[40:43], v[84:87]
    ds_read_b128 v[36:39], v13 offset:50176
    v_mfma_f32_16x16x32_bf16 v[88:91], a[168:171], v[44:47], v[88:91]
    v_mfma_f32_16x16x32_bf16 v[92:95], a[172:175], v[44:47], v[92:95]
    s_waitcnt lgkmcnt(4)
    v_mfma_f32_16x16x32_bf16 v[80:83], a[176:179], v[48:51], v[80:83]
    ds_read_b128 v[40:43], v13 offset:51200
    v_mfma_f32_16x16x32_bf16 v[84:87], a[180:183], v[48:51], v[84:87]
    ds_read_b128 v[44:47], v13 offset:52224
    v_mfma_f32_16x16x32_bf16 v[88:91], a[176:179], v[52:55], v[88:91]
    v_mfma_f32_16x16x32_bf16 v[92:95], a[180:183], v[52:55], v[92:95]
    s_waitcnt lgkmcnt(4)
    v_mfma_f32_16x16x32_bf16 v[80:83], a[184:187], v[56:59], v[80:83]
    ds_read_b128 v[48:51], v13 offset:53248
    v_mfma_f32_16x16x32_bf16 v[84:87], a[188:191], v[56:59], v[84:87]
    ds_read_b128 v[52:55], v13 offset:54272
    v_mfma_f32_16x16x32_bf16 v[88:91], a[184:187], v[60:63], v[88:91]
    v_mfma_f32_16x16x32_bf16 v[92:95], a[188:191], v[60:63], v[92:95]
    s_waitcnt lgkmcnt(4)
    v_mfma_f32_16x16x32_bf16 v[80:83], a[192:195], v[32:35], v[80:83]
    ds_read_b128 v[56:59], v13 offset:55296
    v_mfma_f32_16x16x32_bf16 v[84:87], a[196:199], v[32:35], v[84:87]
    ds_read_b128 v[60:63], v13 offset:56320
    v_mfma_f32_16x16x32_bf16 v[88:91], a[192:195], v[36:39], v[88:91]
    v_mfma_f32_16x16x32_bf16 v[92:95], a[196:199], v[36:39], v[92:95]
    s_waitcnt lgkmcnt(4)
    v_mfma_f32_16x16x32_bf16 v[80:83], a[200:203], v[40:43], v[80:83]
    ds_read_b128 v[32:35], v13 offset:57344
    v_mfma_f32_16x16x32_bf16 v[84:87], a[204:207], v[40:43], v[84:87]
    ds_read_b128 v[36:39], v13 offset:58368
    v_mfma_f32_16x16x32_bf16 v[88:91], a[200:203], v[44:47], v[88:91]
    v_mfma_f32_16x16x32_bf16 v[92:95], a[204:207], v[44:47], v[92:95]
    s_waitcnt lgkmcnt(4)
    v_mfma_f32_16x16x32_bf16 v[80:83], a[208:211], v[48:51], v[80:83]
    ds_read_b128 v[40:43], v13 offset:59392
    v_mfma_f32_16x16x32_bf16 v[84:87], a[212:215], v[48:51], v[84:87]
    ds_read_b128 v[44:47], v13 offset:60416
    v_mfma_f32_16x16x32_bf16 v[88:91], a[208:211], v[52:55], v[88:91]
    v_mfma_f32_16x16x32_bf16 v[92:95], a[212:215], v[52:55], v[92:95]
    s_waitcnt lgkmcnt(4)
    v_mfma_f32_16x16x32_bf16 v[80:83], a[216:219], v[56:59], v[80:83]
    ds_read_b128 v[48:51], v13 offset:61440
    v_mfma_f32_16x16x32_bf16 v[84:87], a[220:223], v[56:59], v[84:87]
    ds_read_b128 v[52:55], v13 offset:62464
    v_mfma_f32_16x16x32_bf16 v[88:91], a[216:219], v[60:63], v[88:91]
    v_mfma_f32_16x16x32_bf16 v[92:95], a[220:223], v[60:63], v[92:95]
    s_waitcnt lgkmcnt(4)
    v_mfma_f32_16x16x32_bf16 v[80:83], a[224:227], v[32:35], v[80:83]
    ds_read_b128 v[56:59], v13 offset:63488
    v_mfma_f32_16x16x32_bf16 v[84:87], a[228:231], v[32:35], v[84:87]
    ds_read_b128 v[60:63], v13 offset:64512
    v_mfma_f32_16x16x32_bf16 v[88:91], a[224:227], v[36:39], v[88:91]
    v_mfma_f32_16x16x32_bf16 v[92:95], a[228:231], v[36:39], v[92:95]
    s_waitcnt lgkmcnt(4)
    v_mfma_f32_16x16x32_bf16 v[80:83], a[232:235], v[40:43], v[80:83]
    v_mfma_f32_16x16x32_bf16 v[84:87], a[236:239], v[40:43], v[84:87]
    v_mfma_f32_16x16x32_bf16 v[88:91], a[232:235], v[44:47], v[88:91]
    v_mfma_f32_16x16x32_bf16 v[92:95], a[236:239], v[44:47], v[92:95]
    s_waitcnt lgkmcnt(0)
    v_mfma_f32_16x16x32_bf16 v[80:83], a[240:243], v[48:51], v[80:83]
    v_mfma_f32_16x16x32_bf16 v[84:87], a[244:247], v[48:51], v[84:87]
    v_mfma_f32_16x16x32_bf16 v[88:91], a[240:243], v[52:55], v[88:91]
    v_mfma_f32_16x16x32_bf16 v[92:95], a[244:247], v[52:55], v[92:95]
    v_mfma_f32_16x16x32_bf16 v[80:83], a[248:251], v[56:59], v[80:83]
    v_mfma_f32_16x16x32_bf16 v[84:87], a[252:255], v[56:59], v[84:87]
    v_mfma_f32_16x16x32_bf16 v[88:91], a[248:251], v[60:63], v[88:91]
    v_mfma_f32_16x16x32_bf16 v[92:95], a[252:255], v[60:63], v[92:95]
    s_mov_b32 s76, s57
    s_nop 6
    ds_write_b128 v7, v[80:83] offset:0
    ds_write_b128 v7, v[84:87] offset:64
    ds_write_b128 v7, v[88:91] offset:2304
    ds_write_b128 v7, v[92:95] offset:2368
L_e_fin_147:
    s_waitcnt lgkmcnt(0)
    ds_read_b128 v[216:219], v8 offset:0
    ds_read_b128 v[220:223], v8 offset:1152
    ds_read_b128 v[224:227], v8 offset:2304
    ds_read_b128 v[228:231], v8 offset:3456
    s_waitcnt lgkmcnt(0)
    buffer_store_dwordx4 v[216:219], v11, s[12:15], s76 offen sc1
    s_add_u32 s76, s76, 32768
    buffer_store_dwordx4 v[220:223], v11, s[12:15], s76 offen sc1
    s_add_u32 s76, s76, 32768
    buffer_store_dwordx4 v[224:227], v11, s[12:15], s76 offen sc1
    s_add_u32 s76, s76, 32768
    buffer_store_dwordx4 v[228:231], v11, s[12:15], s76 offen sc1
    s_mov_b32 s92, s62
    s_cmp_eq_u32 s51, 1
    s_cbranch_scc1 L_a_loop_128_b
    s_waitcnt vmcnt(4)
L_a_loop_128_b:
    s_barrier
    s_branch L_a_loop_128
L_a_fin_133:
    s_waitcnt vmcnt(0)
    s_barrier
    s_cmp_lg_u32 s44, 0
    s_cbranch_scc1 L_pub_148
    v_mov_b32 v30, s92
    v_mov_b32 v31, 0
    s_mov_b64 exec, 1
    buffer_store_dword v30, v31, s[12:15], s67 offen sc1
    s_mov_b64 exec, -1
L_pub_148:
    s_branch L_w_done_98
L_role_b_126:
    s_load_dwordx2 s[6:7], s[0:1], 64
    s_load_dwordx2 s[8:9], s[0:1], 72
    s_waitcnt lgkmcnt(0)
    s_mov_b32 s24, s6
    s_and_b32 s25, s7, 0xffff
    s_mov_b32 s26, 0x700000
    s_mov_b32 s27, 0x00020000
    s_mov_b32 s32, s8
    s_and_b32 s33, s9, 0xffff
    s_mov_b32 s34, 0x1c00
    s_mov_b32 s35, 0x00020000
    s_min_u32 s45, s41, 27
    s_lshl_b32 s46, s45, 8
    s_waitcnt vmcnt(0)
    s_barrier
    v_lshrrev_b32 v20, 4, v1
    s_lshl_b32 s45, s44, 2
    v_add_u32 v21, s45, v20
    s_mov_b32 s45, 7168
    v_mul_lo_u32 v21, v21, s45
    v_lshlrev_b32 v22, 2, v20
    v_and_b32 v23, 15, v1
    v_xor_b32 v22, v22, v23
    v_lshlrev_b32 v22, 4, v22
    v_add_u32 v21, v21, v22
    v_bfe_u32 v22, v1, 2, 2
    v_lshlrev_b32 v23, 3, v20
    v_add_u32 v23, v23, v22
    v_lshlrev_b32 v23, 8, v23
    v_xor_b32 v22, s44, v22
    v_lshlrev_b32 v22, 6, v22
    v_add_u32 v23, v23, v22
    v_and_b32 v22, 3, v1
    v_lshlrev_b32 v22, 4, v22
    v_add_u32 v23, v23, v22
    v_add_u32 v24, 65536, v23
    v_add_u32 v25, 131072, v23
    s_lshl_b32 s47, s44, 10
    s_add_u32 s45, s46, 0x0
    s_add_u32 m0, s47, 0
    s_nop 0
    buffer_load_dwordx4 v21, s[24:27], s45 offen  lds
    s_add_u32 s45, s46, 0x1c000
    s_add_u32 m0, s47, 4096
    s_nop 0
    buffer_load_dwordx4 v21, s[24:27], s45 offen  lds
    s_add_u32 s45, s46, 0x38000
    s_add_u32 m0, s47, 8192
    s_nop 0
    buffer_load_dwordx4 v21, s[24:27], s45 offen  lds
    s_add_u32 s45, s46, 0x54000
    s_add_u32 m0, s47, 12288
    s_nop 0
    buffer_load_dwordx4 v21, s[24:27], s45 offen  lds
    s_add_u32 s45, s46, 0x70000
    s_add_u32 m0, s47, 16384
    s_nop 0
    buffer_load_dwordx4 v21, s[24:27], s45 offen  lds
    s_add_u32 s45, s46, 0x8c000
    s_add_u32 m0, s47, 20480
    s_nop 0
    buffer_load_dwordx4 v21, s[24:27], s45 offen  lds
    s_add_u32 s45, s46, 0xa8000
    s_add_u32 m0, s47, 24576
    s_nop 0
    buffer_load_dwordx4 v21, s[24:27], s45 offen  lds
    s_add_u32 s45, s46, 0xc4000
    s_add_u32 m0, s47, 28672
    s_nop 0
    buffer_load_dwordx4 v21, s[24:27], s45 offen  lds
    s_add_u32 s45, s46, 0xe0000
    s_add_u32 m0, s47, 32768
    s_nop 0
    buffer_load_dwordx4 v21, s[24:27], s45 offen  lds
    s_add_u32 s45, s46, 0xfc000
    s_add_u32 m0, s47, 36864
    s_nop 0
    buffer_load_dwordx4 v21, s[24:27], s45 offen  lds
    s_add_u32 s45, s46, 0x118000
    s_add_u32 m0, s47, 40960
    s_nop 0
    buffer_load_dwordx4 v21, s[24:27], s45 offen  lds
    s_add_u32 s45, s46, 0x134000
    s_add_u32 m0, s47, 45056
    s_nop 0
    buffer_load_dwordx4 v21, s[24:27], s45 offen  lds
    s_add_u32 s45, s46, 0x150000
    s_add_u32 m0, s47, 49152
    s_nop 0
    buffer_load_dwordx4 v21, s[24:27], s45 offen  lds
    s_add_u32 s45, s46, 0x16c000
    s_add_u32 m0, s47, 53248
    s_nop 0
    buffer_load_dwordx4 v21, s[24:27], s45 offen  lds
    s_add_u32 s45, s46, 0x188000
    s_add_u32 m0, s47, 57344
    s_nop 0
    buffer_load_dwordx4 v21, s[24:27], s45 offen  lds
    s_add_u32 s45, s46, 0x1a4000
    s_add_u32 m0, s47, 61440
    s_nop 0
    buffer_load_dwordx4 v21, s[24:27], s45 offen  lds
    s_add_u32 s45, s46, 0x1c0000
    s_add_u32 m0, s47, 65536
    s_nop 0
    buffer_load_dwordx4 v21, s[24:27], s45 offen  lds
    s_add_u32 s45, s46, 0x1dc000
    s_add_u32 m0, s47, 69632
    s_nop 0
    buffer_load_dwordx4 v21, s[24:27], s45 offen  lds
    s_add_u32 s45, s46, 0x1f8000
    s_add_u32 m0, s47, 73728
    s_nop 0
    buffer_load_dwordx4 v21, s[24:27], s45 offen  lds
    s_add_u32 s45, s46, 0x214000
    s_add_u32 m0, s47, 77824
    s_nop 0
    buffer_load_dwordx4 v21, s[24:27], s45 offen  lds
    s_add_u32 s45, s46, 0x230000
    s_add_u32 m0, s47, 81920
    s_nop 0
    buffer_load_dwordx4 v21, s[24:27], s45 offen  lds
    s_add_u32 s45, s46, 0x24c000
    s_add_u32 m0, s47, 86016
    s_nop 0
    buffer_load_dwordx4 v21, s[24:27], s45 offen  lds
    s_add_u32 s45, s46, 0x268000
    s_add_u32 m0, s47, 90112
    s_nop 0
    buffer_load_dwordx4 v21, s[24:27], s45 offen  lds
    s_add_u32 s45, s46, 0x284000
    s_add_u32 m0, s47, 94208
    s_nop 0
    buffer_load_dwordx4 v21, s[24:27], s45 offen  lds
    s_add_u32 s45, s46, 0x2a0000
    s_add_u32 m0, s47, 98304
    s_nop 0
    buffer_load_dwordx4 v21, s[24:27], s45 offen  lds
    s_add_u32 s45, s46, 0x2bc000
    s_add_u32 m0, s47, 102400
    s_nop 0
    buffer_load_dwordx4 v21, s[24:27], s45 offen  lds
    s_add_u32 s45, s46, 0x2d8000
    s_add_u32 m0, s47, 106496
    s_nop 0
    buffer_load_dwordx4 v21, s[24:27], s45 offen  lds
    s_add_u32 s45, s46, 0x2f4000
    s_add_u32 m0, s47, 110592
    s_nop 0
    buffer_load_dwordx4 v21, s[24:27], s45 offen  lds
    s_add_u32 s45, s46, 0x310000
    s_add_u32 m0, s47, 114688
    s_nop 0
    buffer_load_dwordx4 v21, s[24:27], s45 offen  lds
    s_add_u32 s45, s46, 0x32c000
    s_add_u32 m0, s47, 118784
    s_nop 0
    buffer_load_dwordx4 v21, s[24:27], s45 offen  lds
    s_add_u32 s45, s46, 0x348000
    s_add_u32 m0, s47, 122880
    s_nop 0
    buffer_load_dwordx4 v21, s[24:27], s45 offen  lds
    s_add_u32 s45, s46, 0x364000
    s_add_u32 m0, s47, 126976
    s_nop 0
    buffer_load_dwordx4 v21, s[24:27], s45 offen  lds
    s_waitcnt vmcnt(28)
    s_barrier
    s_add_u32 s45, s46, 0x380000
    s_add_u32 m0, s47, 131072
    s_nop 0
    buffer_load_dwordx4 v21, s[24:27], s45 offen  lds
    s_add_u32 s45, s46, 0x39c000
    s_add_u32 m0, s47, 135168
    s_nop 0
    buffer_load_dwordx4 v21, s[24:27], s45 offen  lds
    s_add_u32 s45, s46, 0x3b8000
    s_add_u32 m0, s47, 139264
    s_nop 0
    buffer_load_dwordx4 v21, s[24:27], s45 offen  lds
    s_add_u32 s45, s46, 0x3d4000
    s_add_u32 m0, s47, 143360
    s_nop 0
    buffer_load_dwordx4 v21, s[24:27], s45 offen  lds
    ds_read_b64_tr_b16 a[0:1], v23 offset:0
    ds_read_b64_tr_b16 a[2:3], v23 offset:1024
    ds_read_b64_tr_b16 a[4:5], v23 offset:8
    ds_read_b64_tr_b16 a[6:7], v23 offset:1032
    ds_read_b64_tr_b16 a[8:9], v23 offset:8192
    ds_read_b64_tr_b16 a[10:11], v23 offset:9216
    ds_read_b64_tr_b16 a[12:13], v23 offset:8200
    ds_read_b64_tr_b16 a[14:15], v23 offset:9224
    s_waitcnt lgkmcnt(0)
    s_waitcnt vmcnt(28)
    s_barrier
    s_add_u32 s45, s46, 0x3f0000
    s_add_u32 m0, s47, 0
    s_nop 0
    buffer_load_dwordx4 v21, s[24:27], s45 offen  lds
    s_add_u32 s45, s46, 0x40c000
    s_add_u32 m0, s47, 4096
    s_nop 0
    buffer_load_dwordx4 v21, s[24:27], s45 offen  lds
    s_add_u32 s45, s46, 0x428000
    s_add_u32 m0, s47, 8192
    s_nop 0
    buffer_load_dwordx4 v21, s[24:27], s45 offen  lds
    s_add_u32 s45, s46, 0x444000
    s_add_u32 m0, s47, 12288
    s_nop 0
    buffer_load_dwordx4 v21, s[24:27], s45 offen  lds
    ds_read_b64_tr_b16 a[16:17], v23 offset:16384
    ds_read_b64_tr_b16 a[18:19], v23 offset:17408
    ds_read_b64_tr_b16 a[20:21], v23 offset:16392
    ds_read_b64_tr_b16 a[22:23], v23 offset:17416
    ds_read_b64_tr_b16 a[24:25], v23 offset:24576
    ds_read_b64_tr_b16 a[26:27], v23 offset:25600
    ds_read_b64_tr_b16 a[28:29], v23 offset:24584
    ds_read_b64_tr_b16 a[30:31], v23 offset:25608
    s_waitcnt lgkmcnt(0)
    s_waitcnt vmcnt(28)
    s_barrier
    s_add_u32 s45, s46, 0x460000
    s_add_u32 m0, s47, 16384
    s_nop 0
    buffer_load_dwordx4 v21, s[24:27], s45 offen  lds
    s_add_u32 s45, s46, 0x47c000
    s_add_u32 m0, s47, 20480
    s_nop 0
    buffer_load_dwordx4 v21, s[24:27], s45 offen  lds
    s_add_u32 s45, s46, 0x498000
    s_add_u32 m0, s47, 24576
    s_nop 0
    buffer_load_dwordx4 v21, s[24:27], s45 offen  lds
    s_add_u32 s45, s46, 0x4b4000
    s_add_u32 m0, s47, 28672
    s_nop 0
    buffer_load_dwordx4 v21, s[24:27], s45 offen  lds
    ds_read_b64_tr_b16 a[32:33], v23 offset:32768
    ds_read_b64_tr_b16 a[34:35], v23 offset:33792
    ds_read_b64_tr_b16 a[36:37], v23 offset:32776
    ds_read_b64_tr_b16 a[38:39], v23 offset:33800
    ds_read_b64_tr_b16 a[40:41], v23 offset:40960
    ds_read_b64_tr_b16 a[42:43], v23 offset:41984
    ds_read_b64_tr_b16 a[44:45], v23 offset:40968
    ds_read_b64_tr_b16 a[46:47], v23 offset:41992
    s_waitcnt lgkmcnt(0)
    s_waitcnt vmcnt(28)
    s_barrier
    s_add_u32 s45, s46, 0x4d0000
    s_add_u32 m0, s47, 32768
    s_nop 0
    buffer_load_dwordx4 v21, s[24:27], s45 offen  lds
    s_add_u32 s45, s46, 0x4ec000
    s_add_u32 m0, s47, 36864
    s_nop 0
    buffer_load_dwordx4 v21, s[24:27], s45 offen  lds
    s_add_u32 s45, s46, 0x508000
    s_add_u32 m0, s47, 40960
    s_nop 0
    buffer_load_dwordx4 v21, s[24:27], s45 offen  lds
    s_add_u32 s45, s46, 0x524000
    s_add_u32 m0, s47, 45056
    s_nop 0
    buffer_load_dwordx4 v21, s[24:27], s45 offen  lds
    ds_read_b64_tr_b16 a[48:49], v23 offset:49152
    ds_read_b64_tr_b16 a[50:51], v23 offset:50176
    ds_read_b64_tr_b16 a[52:53], v23 offset:49160
    ds_read_b64_tr_b16 a[54:55], v23 offset:50184
    ds_read_b64_tr_b16 a[56:57], v23 offset:57344
    ds_read_b64_tr_b16 a[58:59], v23 offset:58368
    ds_read_b64_tr_b16 a[60:61], v23 offset:57352
    ds_read_b64_tr_b16 a[62:63], v23 offset:58376
    s_waitcnt lgkmcnt(0)
    s_waitcnt vmcnt(28)
    s_barrier
    s_add_u32 s45, s46, 0x540000
    s_add_u32 m0, s47, 49152
    s_nop 0
    buffer_load_dwordx4 v21, s[24:27], s45 offen  lds
    s_add_u32 s45, s46, 0x55c000
    s_add_u32 m0, s47, 53248
    s_nop 0
    buffer_load_dwordx4 v21, s[24:27], s45 offen  lds
    s_add_u32 s45, s46, 0x578000
    s_add_u32 m0, s47, 57344
    s_nop 0
    buffer_load_dwordx4 v21, s[24:27], s45 offen  lds
    s_add_u32 s45, s46, 0x594000
    s_add_u32 m0, s47, 61440
    s_nop 0
    buffer_load_dwordx4 v21, s[24:27], s45 offen  lds
    ds_read_b64_tr_b16 a[64:65], v24 offset:0
    ds_read_b64_tr_b16 a[66:67], v24 offset:1024
    ds_read_b64_tr_b16 a[68:69], v24 offset:8
    ds_read_b64_tr_b16 a[70:71], v24 offset:1032
    ds_read_b64_tr_b16 a[72:73], v24 offset:8192
    ds_read_b64_tr_b16 a[74:75], v24 offset:9216
    ds_read_b64_tr_b16 a[76:77], v24 offset:8200
    ds_read_b64_tr_b16 a[78:79], v24 offset:9224
    s_waitcnt lgkmcnt(0)
    s_waitcnt vmcnt(28)
    s_barrier
    s_add_u32 s45, s46, 0x5b0000
    s_add_u32 m0, s47, 65536
    s_nop 0
    buffer_load_dwordx4 v21, s[24:27], s45 offen  lds
    s_add_u32 s45, s46, 0x5cc000
    s_add_u32 m0, s47, 69632
    s_nop 0
    buffer_load_dwordx4 v21, s[24:27], s45 offen  lds
    s_add_u32 s45, s46, 0x5e8000
    s_add_u32 m0, s47, 73728
    s_nop 0
    buffer_load_dwordx4 v21, s[24:27], s45 offen  lds
    s_add_u32 s45, s46, 0x604000
    s_add_u32 m0, s47, 77824
    s_nop 0
    buffer_load_dwordx4 v21, s[24:27], s45 offen  lds
    ds_read_b64_tr_b16 a[80:81], v24 offset:16384
    ds_read_b64_tr_b16 a[82:83], v24 offset:17408
    ds_read_b64_tr_b16 a[84:85], v24 offset:16392
    ds_read_b64_tr_b16 a[86:87], v24 offset:17416
    ds_read_b64_tr_b16 a[88:89], v24 offset:24576
    ds_read_b64_tr_b16 a[90:91], v24 offset:25600
    ds_read_b64_tr_b16 a[92:93], v24 offset:24584
    ds_read_b64_tr_b16 a[94:95], v24 offset:25608
    s_waitcnt lgkmcnt(0)
    s_waitcnt vmcnt(28)
    s_barrier
    s_add_u32 s45, s46, 0x620000
    s_add_u32 m0, s47, 81920
    s_nop 0
    buffer_load_dwordx4 v21, s[24:27], s45 offen  lds
    s_add_u32 s45, s46, 0x63c000
    s_add_u32 m0, s47, 86016
    s_nop 0
    buffer_load_dwordx4 v21, s[24:27], s45 offen  lds
    s_add_u32 s45, s46, 0x658000
    s_add_u32 m0, s47, 90112
    s_nop 0
    buffer_load_dwordx4 v21, s[24:27], s45 offen  lds
    s_add_u32 s45, s46, 0x674000
    s_add_u32 m0, s47, 94208
    s_nop 0
    buffer_load_dwordx4 v21, s[24:27], s45 offen  lds
    ds_read_b64_tr_b16 a[96:97], v24 offset:32768
    ds_read_b64_tr_b16 a[98:99], v24 offset:33792
    ds_read_b64_tr_b16 a[100:101], v24 offset:32776
    ds_read_b64_tr_b16 a[102:103], v24 offset:33800
    ds_read_b64_tr_b16 a[104:105], v24 offset:40960
    ds_read_b64_tr_b16 a[106:107], v24 offset:41984
    ds_read_b64_tr_b16 a[108:109], v24 offset:40968
    ds_read_b64_tr_b16 a[110:111], v24 offset:41992
    s_waitcnt lgkmcnt(0)
    s_waitcnt vmcnt(28)
    s_barrier
    s_add_u32 s45, s46, 0x690000
    s_add_u32 m0, s47, 98304
    s_nop 0
    buffer_load_dwordx4 v21, s[24:27], s45 offen  lds
    s_add_u32 s45, s46, 0x6ac000
    s_add_u32 m0, s47, 102400
    s_nop 0
    buffer_load_dwordx4 v21, s[24:27], s45 offen  lds
    s_add_u32 s45, s46, 0x6c8000
    s_add_u32 m0, s47, 106496
    s_nop 0
    buffer_load_dwordx4 v21, s[24:27], s45 offen  lds
    s_add_u32 s45, s46, 0x6e4000
    s_add_u32 m0, s47, 110592
    s_nop 0
    buffer_load_dwordx4 v21, s[24:27], s45 offen  lds
    ds_read_b64_tr_b16 a[112:113], v24 offset:49152
    ds_read_b64_tr_b16 a[114:115], v24 offset:50176
    ds_read_b64_tr_b16 a[116:117], v24 offset:49160
    ds_read_b64_tr_b16 a[118:119], v24 offset:50184
    ds_read_b64_tr_b16 a[120:121], v24 offset:57344
    ds_read_b64_tr_b16 a[122:123], v24 offset:58368
    ds_read_b64_tr_b16 a[124:125], v24 offset:57352
    ds_read_b64_tr_b16 a[126:127], v24 offset:58376
    s_waitcnt lgkmcnt(0)
    s_waitcnt vmcnt(28)
    s_barrier
    ds_read_b64_tr_b16 a[128:129], v25 offset:0
    ds_read_b64_tr_b16 a[130:131], v25 offset:1024
    ds_read_b64_tr_b16 a[132:133], v25 offset:8
    ds_read_b64_tr_b16 a[134:135], v25 offset:1032
    ds_read_b64_tr_b16 a[136:137], v25 offset:8192
    ds_read_b64_tr_b16 a[138:139], v25 offset:9216
    ds_read_b64_tr_b16 a[140:141], v25 offset:8200
    ds_read_b64_tr_b16 a[142:143], v25 offset:9224
    s_waitcnt lgkmcnt(0)
    s_waitcnt vmcnt(24)
    s_barrier
    ds_read_b64_tr_b16 a[144:145], v23 offset:0
    ds_read_b64_tr_b16 a[146:147], v23 offset:1024
    ds_read_b64_tr_b16 a[148:149], v23 offset:8
    ds_read_b64_tr_b16 a[150:151], v23 offset:1032
    ds_read_b64_tr_b16 a[152:153], v23 offset:8192
    ds_read_b64_tr_b16 a[154:155], v23 offset:9216
    ds_read_b64_tr_b16 a[156:157], v23 offset:8200
    ds_read_b64_tr_b16 a[158:159], v23 offset:9224
    s_waitcnt lgkmcnt(0)
    s_waitcnt vmcnt(20)
    s_barrier
    ds_read_b64_tr_b16 a[160:161], v23 offset:16384
    ds_read_b64_tr_b16 a[162:163], v23 offset:17408
    ds_read_b64_tr_b16 a[164:165], v23 offset:16392
    ds_read_b64_tr_b16 a[166:167], v23 offset:17416
    ds_read_b64_tr_b16 a[168:169], v23 offset:24576
    ds_read_b64_tr_b16 a[170:171], v23 offset:25600
    ds_read_b64_tr_b16 a[172:173], v23 offset:24584
    ds_read_b64_tr_b16 a[174:175], v23 offset:25608
    s_waitcnt lgkmcnt(0)
    s_waitcnt vmcnt(16)
    s_barrier
    ds_read_b64_tr_b16 a[176:177], v23 offset:32768
    ds_read_b64_tr_b16 a[178:179], v23 offset:33792
    ds_read_b64_tr_b16 a[180:181], v23 offset:32776
    ds_read_b64_tr_b16 a[182:183], v23 offset:33800
    ds_read_b64_tr_b16 a[184:185], v23 offset:40960
    ds_read_b64_tr_b16 a[186:187], v23 offset:41984
    ds_read_b64_tr_b16 a[188:189], v23 offset:40968
    ds_read_b64_tr_b16 a[190:191], v23 offset:41992
    s_waitcnt lgkmcnt(0)
    s_waitcnt vmcnt(12)
    s_barrier
    ds_read_b64_tr_b16 a[192:193], v23 offset:49152
    ds_read_b64_tr_b16 a[194:195], v23 offset:50176
    ds_read_b64_tr_b16 a[196:197], v23 offset:49160
    ds_read_b64_tr_b16 a[198:199], v23 offset:50184
    ds_read_b64_tr_b16 a[200:201], v23 offset:57344
    ds_read_b64_tr_b16 a[202:203], v23 offset:58368
    ds_read_b64_tr_b16 a[204:205], v23 offset:57352
    ds_read_b64_tr_b16 a[206:207], v23 offset:58376
    s_waitcnt lgkmcnt(0)
    s_waitcnt vmcnt(8)
    s_barrier
    ds_read_b64_tr_b16 a[208:209], v24 offset:0
    ds_read_b64_tr_b16 a[210:211], v24 offset:1024
    ds_read_b64_tr_b16 a[212:213], v24 offset:8
    ds_read_b64_tr_b16 a[214:215], v24 offset:1032
    ds_read_b64_tr_b16 a[216:217], v24 offset:8192
    ds_read_b64_tr_b16 a[218:219], v24 offset:9216
    ds_read_b64_tr_b16 a[220:221], v24 offset:8200
    ds_read_b64_tr_b16 a[222:223], v24 offset:9224
    s_waitcnt lgkmcnt(0)
    s_waitcnt vmcnt(4)
    s_barrier
    ds_read_b64_tr_b16 a[224:225], v24 offset:16384
    ds_read_b64_tr_b16 a[226:227], v24 offset:17408
    ds_read_b64_tr_b16 a[228:229], v24 offset:16392
    ds_read_b64_tr_b16 a[230:231], v24 offset:17416
    ds_read_b64_tr_b16 a[232:233], v24 offset:24576
    ds_read_b64_tr_b16 a[234:235], v24 offset:25600
    ds_read_b64_tr_b16 a[236:237], v24 offset:24584
    ds_read_b64_tr_b16 a[238:239], v24 offset:25608
    s_waitcnt lgkmcnt(0)
    s_waitcnt vmcnt(0)
    s_barrier
    ds_read_b64_tr_b16 a[240:241], v24 offset:32768
    ds_read_b64_tr_b16 a[242:243], v24 offset:33792
    ds_read_b64_tr_b16 a[244:245], v24 offset:32776
    ds_read_b64_tr_b16 a[246:247], v24 offset:33800
    ds_read_b64_tr_b16 a[248:249], v24 offset:40960
    ds_read_b64_tr_b16 a[250:251], v24 offset:41984
    ds_read_b64_tr_b16 a[252:253], v24 offset:40968
    ds_read_b64_tr_b16 a[254:255], v24 offset:41992
    s_waitcnt lgkmcnt(0)
    s_barrier
    s_min_u32 s45, s41, 27
    s_lshl_b32 s45, s45, 8
    s_lshl_b32 s46, s44, 6
    s_add_u32 s45, s45, s46
    v_lshrrev_b32 v29, 4, v1
    v_lshlrev_b32 v29, 4, v29
    buffer_load_dwordx4 v[80:83], v29, s[32:35], s45 offen
    s_waitcnt vmcnt(0)
    v_lshlrev_b32 v96, 16, v80
    v_and_b32 v97, 0xffff0000, v80
    v_lshlrev_b32 v98, 16, v81
    v_and_b32 v99, 0xffff0000, v81
    v_lshlrev_b32 v100, 16, v82
    v_and_b32 v101, 0xffff0000, v82
    v_lshlrev_b32 v102, 16, v83
    v_and_b32 v103, 0xffff0000, v83
    v_mov_b32 v104, 0xbdd2d3e8
    v_mov_b32 v105, v104
    v_mov_b32 v106, 0xc0135761
    v_mov_b32 v107, v106
    s_cmp_lg_u32 s44, 0
    s_cbranch_scc1 L_pd_149
    v_mov_b32 v29, 127232
    s_mov_b32 s46, 96
    s_mov_b64 exec, 1
    s_mov_b32 s70, 0
L_wp_150:
    buffer_load_dword v31, v29, s[12:15], 0 offen sc1
    s_add_u32 s70, s70, 1
    s_cmp_ge_u32 s70, 0x200000
    s_cbranch_scc1 L_w_done_98
L_wp_150_c:
    s_waitcnt vmcnt(0)
    v_cmp_gt_u32 vcc, s46, v31
    s_nop 1
    s_cbranch_vccz L_wp_150_ok
    s_sleep 3
    s_branch L_wp_150
L_wp_150_ok:
    s_mov_b64 exec, -1
L_pd_149:
    s_barrier
    v_lshlrev_b32 v29, 5, v1
    s_mov_b32 s45, 8192
    buffer_load_dwordx4 v[112:115], v29, s[12:15], s45 offen offset:0 sc1
    buffer_load_dwordx4 v[116:119], v29, s[12:15], s45 offen offset:16 sc1
    buffer_load_dwordx4 v[120:123], v29, s[12:15], s45 offen offset:2048 sc1
    buffer_load_dwordx4 v[124:127], v29, s[12:15], s45 offen offset:2064 sc1
    s_mov_b32 s45, 32768
    buffer_load_dwordx4 v[32:35], v29, s[12:15], s45 offen offset:0 sc1
    buffer_load_dwordx4 v[36:39], v29, s[12:15], s45 offen offset:16 sc1
    buffer_load_dwordx4 v[40:43], v29, s[12:15], s45 offen offset:2048 sc1
    buffer_load_dwordx4 v[44:47], v29, s[12:15], s45 offen offset:2064 sc1
    s_mov_b32 s45, 12288
    buffer_load_dwordx4 v[128:131], v29, s[12:15], s45 offen offset:0 sc1
    buffer_load_dwordx4 v[132:135], v29, s[12:15], s45 offen offset:16 sc1
    buffer_load_dwordx4 v[136:139], v29, s[12:15], s45 offen offset:2048 sc1
    buffer_load_dwordx4 v[140:143], v29, s[12:15], s45 offen offset:2064 sc1
    s_mov_b32 s45, 36864
    buffer_load_dwordx4 v[48:51], v29, s[12:15], s45 offen offset:0 sc1
    buffer_load_dwordx4 v[52:55], v29, s[12:15], s45 offen offset:16 sc1
    buffer_load_dwordx4 v[56:59], v29, s[12:15], s45 offen offset:2048 sc1
    buffer_load_dwordx4 v[60:63], v29, s[12:15], s45 offen offset:2064 sc1
    s_mov_b32 s45, 16384
    buffer_load_dwordx4 v[144:147], v29, s[12:15], s45 offen offset:0 sc1
    buffer_load_dwordx4 v[148:151], v29, s[12:15], s45 offen offset:16 sc1
    buffer_load_dwordx4 v[152:155], v29, s[12:15], s45 offen offset:2048 sc1
    buffer_load_dwordx4 v[156:159], v29, s[12:15], s45 offen offset:2064 sc1
    s_mov_b32 s45, 40960
    buffer_load_dwordx4 v[64:67], v29, s[12:15], s45 offen offset:0 sc1
    buffer_load_dwordx4 v[68:71], v29, s[12:15], s45 offen offset:16 sc1
    buffer_load_dwordx4 v[72:75], v29, s[12:15], s45 offen offset:2048 sc1
    buffer_load_dwordx4 v[76:79], v29, s[12:15], s45 offen offset:2064 sc1
    s_waitcnt vmcnt(0)
    v_add_f32 v112, v112, v32
    v_cvt_pk_bf16_f32 v112, v112, v112
    v_lshlrev_b32 v112, 16, v112
    v_add_f32 v113, v113, v33
    v_cvt_pk_bf16_f32 v113, v113, v113
    v_lshlrev_b32 v113, 16, v113
    v_add_f32 v114, v114, v34
    v_cvt_pk_bf16_f32 v114, v114, v114
    v_lshlrev_b32 v114, 16, v114
    v_add_f32 v115, v115, v35
    v_cvt_pk_bf16_f32 v115, v115, v115
    v_lshlrev_b32 v115, 16, v115
    v_add_f32 v116, v116, v36
    v_cvt_pk_bf16_f32 v116, v116, v116
    v_lshlrev_b32 v116, 16, v116
    v_add_f32 v117, v117, v37
    v_cvt_pk_bf16_f32 v117, v117, v117
    v_lshlrev_b32 v117, 16, v117
    v_add_f32 v118, v118, v38
    v_cvt_pk_bf16_f32 v118, v118, v118
    v_lshlrev_b32 v118, 16, v118
    v_add_f32 v119, v119, v39
    v_cvt_pk_bf16_f32 v119, v119, v119
    v_lshlrev_b32 v119, 16, v119
    v_add_f32 v120, v120, v40
    v_cvt_pk_bf16_f32 v120, v120, v120
    v_lshlrev_b32 v120, 16, v120
    v_add_f32 v121, v121, v41
    v_cvt_pk_bf16_f32 v121, v121, v121
    v_lshlrev_b32 v121, 16, v121
    v_add_f32 v122, v122, v42
    v_cvt_pk_bf16_f32 v122, v122, v122
    v_lshlrev_b32 v122, 16, v122
    v_add_f32 v123, v123, v43
    v_cvt_pk_bf16_f32 v123, v123, v123
    v_lshlrev_b32 v123, 16, v123
    v_add_f32 v124, v124, v44
    v_cvt_pk_bf16_f32 v124, v124, v124
    v_lshlrev_b32 v124, 16, v124
    v_add_f32 v125, v125, v45
    v_cvt_pk_bf16_f32 v125, v125, v125
    v_lshlrev_b32 v125, 16, v125
    v_add_f32 v126, v126, v46
    v_cvt_pk_bf16_f32 v126, v126, v126
    v_lshlrev_b32 v126, 16, v126
    v_add_f32 v127, v127, v47
    v_cvt_pk_bf16_f32 v127, v127, v127
    v_lshlrev_b32 v127, 16, v127
    v_add_f32 v128, v128, v48
    v_cvt_pk_bf16_f32 v128, v128, v128
    v_lshlrev_b32 v128, 16, v128
    v_add_f32 v129, v129, v49
    v_cvt_pk_bf16_f32 v129, v129, v129
    v_lshlrev_b32 v129, 16, v129
    v_add_f32 v130, v130, v50
    v_cvt_pk_bf16_f32 v130, v130, v130
    v_lshlrev_b32 v130, 16, v130
    v_add_f32 v131, v131, v51
    v_cvt_pk_bf16_f32 v131, v131, v131
    v_lshlrev_b32 v131, 16, v131
    v_add_f32 v132, v132, v52
    v_cvt_pk_bf16_f32 v132, v132, v132
    v_lshlrev_b32 v132, 16, v132
    v_add_f32 v133, v133, v53
    v_cvt_pk_bf16_f32 v133, v133, v133
    v_lshlrev_b32 v133, 16, v133
    v_add_f32 v134, v134, v54
    v_cvt_pk_bf16_f32 v134, v134, v134
    v_lshlrev_b32 v134, 16, v134
    v_add_f32 v135, v135, v55
    v_cvt_pk_bf16_f32 v135, v135, v135
    v_lshlrev_b32 v135, 16, v135
    v_add_f32 v136, v136, v56
    v_cvt_pk_bf16_f32 v136, v136, v136
    v_lshlrev_b32 v136, 16, v136
    v_add_f32 v137, v137, v57
    v_cvt_pk_bf16_f32 v137, v137, v137
    v_lshlrev_b32 v137, 16, v137
    v_add_f32 v138, v138, v58
    v_cvt_pk_bf16_f32 v138, v138, v138
    v_lshlrev_b32 v138, 16, v138
    v_add_f32 v139, v139, v59
    v_cvt_pk_bf16_f32 v139, v139, v139
    v_lshlrev_b32 v139, 16, v139
    v_add_f32 v140, v140, v60
    v_cvt_pk_bf16_f32 v140, v140, v140
    v_lshlrev_b32 v140, 16, v140
    v_add_f32 v141, v141, v61
    v_cvt_pk_bf16_f32 v141, v141, v141
    v_lshlrev_b32 v141, 16, v141
    v_add_f32 v142, v142, v62
    v_cvt_pk_bf16_f32 v142, v142, v142
    v_lshlrev_b32 v142, 16, v142
    v_add_f32 v143, v143, v63
    v_cvt_pk_bf16_f32 v143, v143, v143
    v_lshlrev_b32 v143, 16, v143
    v_add_f32 v144, v144, v64
    v_cvt_pk_bf16_f32 v144, v144, v144
    v_lshlrev_b32 v144, 16, v144
    v_add_f32 v144, 1.0, v144
    v_cvt_pk_bf16_f32 v144, v144, v144
    v_lshlrev_b32 v144, 16, v144
    v_add_f32 v145, v145, v65
    v_cvt_pk_bf16_f32 v145, v145, v145
    v_lshlrev_b32 v145, 16, v145
    v_add_f32 v145, 1.0, v145
    v_cvt_pk_bf16_f32 v145, v145, v145
    v_lshlrev_b32 v145, 16, v145
    v_add_f32 v146, v146, v66
    v_cvt_pk_bf16_f32 v146, v146, v146
    v_lshlrev_b32 v146, 16, v146
    v_add_f32 v146, 1.0, v146
    v_cvt_pk_bf16_f32 v146, v146, v146
    v_lshlrev_b32 v146, 16, v146
    v_add_f32 v147, v147, v67
    v_cvt_pk_bf16_f32 v147, v147, v147
    v_lshlrev_b32 v147, 16, v147
    v_add_f32 v147, 1.0, v147
    v_cvt_pk_bf16_f32 v147, v147, v147
    v_lshlrev_b32 v147, 16, v147
    v_add_f32 v148, v148, v68
    v_cvt_pk_bf16_f32 v148, v148, v148
    v_lshlrev_b32 v148, 16, v148
    v_add_f32 v148, 1.0, v148
    v_cvt_pk_bf16_f32 v148, v148, v148
    v_lshlrev_b32 v148, 16, v148
    v_add_f32 v149, v149, v69
    v_cvt_pk_bf16_f32 v149, v149, v149
    v_lshlrev_b32 v149, 16, v149
    v_add_f32 v149, 1.0, v149
    v_cvt_pk_bf16_f32 v149, v149, v149
    v_lshlrev_b32 v149, 16, v149
    v_add_f32 v150, v150, v70
    v_cvt_pk_bf16_f32 v150, v150, v150
    v_lshlrev_b32 v150, 16, v150
    v_add_f32 v150, 1.0, v150
    v_cvt_pk_bf16_f32 v150, v150, v150
    v_lshlrev_b32 v150, 16, v150
    v_add_f32 v151, v151, v71
    v_cvt_pk_bf16_f32 v151, v151, v151
    v_lshlrev_b32 v151, 16, v151
    v_add_f32 v151, 1.0, v151
    v_cvt_pk_bf16_f32 v151, v151, v151
    v_lshlrev_b32 v151, 16, v151
    v_add_f32 v152, v152, v72
    v_cvt_pk_bf16_f32 v152, v152, v152
    v_lshlrev_b32 v152, 16, v152
    v_add_f32 v152, 1.0, v152
    v_cvt_pk_bf16_f32 v152, v152, v152
    v_lshlrev_b32 v152, 16, v152
    v_add_f32 v153, v153, v73
    v_cvt_pk_bf16_f32 v153, v153, v153
    v_lshlrev_b32 v153, 16, v153
    v_add_f32 v153, 1.0, v153
    v_cvt_pk_bf16_f32 v153, v153, v153
    v_lshlrev_b32 v153, 16, v153
    v_add_f32 v154, v154, v74
    v_cvt_pk_bf16_f32 v154, v154, v154
    v_lshlrev_b32 v154, 16, v154
    v_add_f32 v154, 1.0, v154
    v_cvt_pk_bf16_f32 v154, v154, v154
    v_lshlrev_b32 v154, 16, v154
    v_add_f32 v155, v155, v75
    v_cvt_pk_bf16_f32 v155, v155, v155
    v_lshlrev_b32 v155, 16, v155
    v_add_f32 v155, 1.0, v155
    v_cvt_pk_bf16_f32 v155, v155, v155
    v_lshlrev_b32 v155, 16, v155
    v_add_f32 v156, v156, v76
    v_cvt_pk_bf16_f32 v156, v156, v156
    v_lshlrev_b32 v156, 16, v156
    v_add_f32 v156, 1.0, v156
    v_cvt_pk_bf16_f32 v156, v156, v156
    v_lshlrev_b32 v156, 16, v156
    v_add_f32 v157, v157, v77
    v_cvt_pk_bf16_f32 v157, v157, v157
    v_lshlrev_b32 v157, 16, v157
    v_add_f32 v157, 1.0, v157
    v_cvt_pk_bf16_f32 v157, v157, v157
    v_lshlrev_b32 v157, 16, v157
    v_add_f32 v158, v158, v78
    v_cvt_pk_bf16_f32 v158, v158, v158
    v_lshlrev_b32 v158, 16, v158
    v_add_f32 v158, 1.0, v158
    v_cvt_pk_bf16_f32 v158, v158, v158
    v_lshlrev_b32 v158, 16, v158
    v_add_f32 v159, v159, v79
    v_cvt_pk_bf16_f32 v159, v159, v159
    v_lshlrev_b32 v159, 16, v159
    v_add_f32 v159, 1.0, v159
    v_cvt_pk_bf16_f32 v159, v159, v159
    v_lshlrev_b32 v159, 16, v159
    s_lshl_b32 s46, s44, 10
    s_add_u32 s45, s46, 8192
    buffer_load_dwordx4 v[18:21], v10, s[12:15], s45 offen sc1
    s_add_u32 s45, s46, 32768
    buffer_load_dwordx4 v[32:35], v10, s[12:15], s45 offen sc1
    s_add_u32 s45, s46, 12288
    buffer_load_dwordx4 v[22:25], v10, s[12:15], s45 offen sc1
    s_add_u32 s45, s46, 36864
    buffer_load_dwordx4 v[36:39], v10, s[12:15], s45 offen sc1
    s_add_u32 s45, s46, 16384
    buffer_load_dwordx4 v[108:111], v10, s[12:15], s45 offen sc1
    s_add_u32 s45, s46, 40960
    buffer_load_dwordx4 v[40:43], v10, s[12:15], s45 offen sc1
    s_waitcnt vmcnt(0)
    v_add_f32 v18, v18, v32
    v_cvt_pk_bf16_f32 v18, v18, v18
    v_lshlrev_b32 v18, 16, v18
    v_add_f32 v19, v19, v33
    v_cvt_pk_bf16_f32 v19, v19, v19
    v_lshlrev_b32 v19, 16, v19
    v_add_f32 v20, v20, v34
    v_cvt_pk_bf16_f32 v20, v20, v20
    v_lshlrev_b32 v20, 16, v20
    v_add_f32 v21, v21, v35
    v_cvt_pk_bf16_f32 v21, v21, v21
    v_lshlrev_b32 v21, 16, v21
    v_add_f32 v22, v22, v36
    v_cvt_pk_bf16_f32 v22, v22, v22
    v_lshlrev_b32 v22, 16, v22
    v_add_f32 v23, v23, v37
    v_cvt_pk_bf16_f32 v23, v23, v23
    v_lshlrev_b32 v23, 16, v23
    v_add_f32 v24, v24, v38
    v_cvt_pk_bf16_f32 v24, v24, v24
    v_lshlrev_b32 v24, 16, v24
    v_add_f32 v25, v25, v39
    v_cvt_pk_bf16_f32 v25, v25, v25
    v_lshlrev_b32 v25, 16, v25
    v_add_f32 v108, v108, v40
    v_cvt_pk_bf16_f32 v108, v108, v108
    v_lshlrev_b32 v108, 16, v108
    v_add_f32 v108, 1.0, v108
    v_cvt_pk_bf16_f32 v108, v108, v108
    v_lshlrev_b32 v108, 16, v108
    v_add_f32 v109, v109, v41
    v_cvt_pk_bf16_f32 v109, v109, v109
    v_lshlrev_b32 v109, 16, v109
    v_add_f32 v109, 1.0, v109
    v_cvt_pk_bf16_f32 v109, v109, v109
    v_lshlrev_b32 v109, 16, v109
    v_add_f32 v110, v110, v42
    v_cvt_pk_bf16_f32 v110, v110, v110
    v_lshlrev_b32 v110, 16, v110
    v_add_f32 v110, 1.0, v110
    v_cvt_pk_bf16_f32 v110, v110, v110
    v_lshlrev_b32 v110, 16, v110
    v_add_f32 v111, v111, v43
    v_cvt_pk_bf16_f32 v111, v111, v111
    v_lshlrev_b32 v111, 16, v111
    v_add_f32 v111, 1.0, v111
    v_cvt_pk_bf16_f32 v111, v111, v111
    v_lshlrev_b32 v111, 16, v111
    s_mov_b32 s52, 0xc00000
    s_lshl_b32 s56, s41, 13
    s_add_u32 s56, s56, 0x6000000
    s_lshl_b32 s45, s40, 7
    s_add_u32 s45, s45, 127488
    v_mov_b32 v29, s45
    s_mov_b32 s46, 536870912
    s_mov_b64 exec, 1
    s_mov_b32 s70, 0
L_wp_154:
    buffer_load_dword v31, v29, s[12:15], 0 offen sc1
    s_add_u32 s70, s70, 1
    s_cmp_ge_u32 s70, 0x200000
    s_cbranch_scc1 L_w_done_98
L_wp_154_c:
    s_waitcnt vmcnt(0)
    v_cmp_gt_u32 vcc, s46, v31
    s_nop 1
    s_cbranch_vccz L_wp_154_ok
    s_sleep 2
    s_branch L_wp_154
L_wp_154_ok:
    s_mov_b64 exec, -1
    v_readfirstlane_b32 s45, v31
    s_nop 3
    s_and_b32 s46, s45, 511
    s_mul_i32 s46, s46, s46
    s_bfe_u32 s45, s45, 0xf0009
    s_lshl_b32 s45, s45, 5
    s_mov_b32 s80, s12
    s_mov_b32 s81, s13
    s_mov_b32 s83, 0x00020000
    s_mov_b32 s84, s12
    s_mov_b32 s85, s13
    s_mov_b32 s87, 0x00020000
    s_cmp_eq_u32 s45, s46
    s_cselect_b32 s82, s14, 0
    s_cselect_b32 s86, 0, s14
    s_mov_b32 s92, 0
L_b_loop_151:
    s_cmp_eq_u64 s[36:37], 0
    s_cbranch_scc1 L_a_fin_133
    s_ff1_i32_b64 s50, s[36:37]
    s_bitset0_b64 s[36:37], s50
    s_lshr_b64 s[74:75], s[72:73], s50
    s_ff1_i32_b64 s51, s[74:75]
    s_add_u32 s51, s51, 1
    s_add_u32 s62, s50, s51
    s_cmp_lg_u32 s51, 1
    s_cbranch_scc1 L_b_skip2_153
    s_lshl_b32 s63, s50, 5
    s_add_u32 s63, s63, s41
    s_lshl_b32 s47, s63, 11
    s_lshl_b32 s45, s44, 9
    s_add_u32 s47, s47, s45
    v_lshlrev_b32 v17, 3, v1
    buffer_load_dwordx2 v[208:209], v17, s[28:31], s47 offen
    s_add_u32 s45, s64, 4096
    s_cmp_lg_u32 s44, 1
    s_cbranch_scc1 L_pi_155
    s_mov_b32 exec_hi, 0
    buffer_load_dword v31, v5, s[12:15], s45 offen sc1
    s_mov_b64 exec, -1
L_pi_155:
    s_waitcnt vmcnt(0)
    s_barrier
    s_cmp_lg_u32 s44, 0
    s_cbranch_scc1 L_pub_156
    v_mov_b32 v30, s92
    v_mov_b32 v31, 0
    s_mov_b64 exec, 1
    buffer_store_dword v30, v31, s[12:15], s67 offen sc1
    s_mov_b64 exec, -1
L_pub_156:
    s_cmp_lg_u32 s44, 1
    s_cbranch_scc1 L_pw_157
    s_mov_b32 exec_hi, 0
    s_mov_b32 s70, 0
    s_branch L_wp_158_c
L_wp_158:
    buffer_load_dword v31, v5, s[12:15], s45 offen sc1
    s_add_u32 s70, s70, 1
    s_cmp_ge_u32 s70, 0x200000
    s_cbranch_scc1 L_w_done_98
L_wp_158_c:
    s_waitcnt vmcnt(0)
    v_cmp_gt_u32 vcc, s62, v31
    s_nop 1
    s_cbranch_vccz L_wp_158_ok
    s_sleep 1
    s_branch L_wp_158
L_wp_158_ok:
    s_mov_b64 exec, -1
L_pw_157:
    s_barrier
    s_lshl_b32 s45, s63, 12
    s_lshl_b32 s46, s44, 10
    s_add_u32 s45, s45, s46
    s_add_u32 s45, s45, 0x8000000
    buffer_load_dwordx4 v[64:67], v10, s[12:15], s45 offen sc1
    s_add_u32 s45, s45, 0x800000
    buffer_load_dwordx4 v[68:71], v10, s[12:15], s45 offen sc1
    s_add_u32 s45, s45, 0x800000
    buffer_load_dwordx4 v[72:75], v10, s[12:15], s45 offen sc1
    s_add_u32 s45, s45, 0x800000
    buffer_load_dwordx4 v[76:79], v10, s[12:15], s45 offen sc1
    s_waitcnt vmcnt(4)
    v_lshlrev_b32 v160, 16, v208
    v_and_b32 v161, 0xffff0000, v208
    v_lshlrev_b32 v162, 16, v209
    v_and_b32 v163, 0xffff0000, v209
    s_waitcnt vmcnt(0)
    v_pk_add_f32 v[64:65], v[64:65], v[68:69]
    v_pk_add_f32 v[72:73], v[72:73], v[76:77]
    v_pk_add_f32 v[66:67], v[66:67], v[70:71]
    v_pk_add_f32 v[74:75], v[74:75], v[78:79]
    v_pk_add_f32 v[64:65], v[64:65], v[72:73]
    v_pk_add_f32 v[66:67], v[66:67], v[74:75]
    v_cvt_pk_bf16_f32 v64, v64, v64
    v_lshlrev_b32 v64, 16, v64
    v_cvt_pk_bf16_f32 v65, v65, v65
    v_lshlrev_b32 v65, 16, v65
    v_cvt_pk_bf16_f32 v66, v66, v66
    v_lshlrev_b32 v66, 16, v66
    v_cvt_pk_bf16_f32 v67, v67, v67
    v_lshlrev_b32 v67, 16, v67
    v_mul_f32 v64, v64, v18
    v_cvt_pk_bf16_f32 v64, v64, v64
    v_lshlrev_b32 v64, 16, v64
    v_add_f32 v64, v64, v160
    v_mul_f32 v65, v65, v19
    v_cvt_pk_bf16_f32 v65, v65, v65
    v_lshlrev_b32 v65, 16, v65
    v_add_f32 v65, v65, v161
    v_mul_f32 v66, v66, v20
    v_cvt_pk_bf16_f32 v66, v66, v66
    v_lshlrev_b32 v66, 16, v66
    v_add_f32 v66, v66, v162
    v_mul_f32 v67, v67, v21
    v_cvt_pk_bf16_f32 v67, v67, v67
    v_lshlrev_b32 v67, 16, v67
    v_add_f32 v67, v67, v163
    v_cvt_pk_bf16_f32 v208, v64, v65
    v_cvt_pk_bf16_f32 v209, v66, v67
    s_add_u32 s47, s47, 0x800000
    buffer_store_dwordx2 v[208:209], v17, s[12:15], s47 offen sc1
    v_lshlrev_b32 v64, 16, v208
    v_and_b32 v65, 0xffff0000, v208
    v_lshlrev_b32 v66, 16, v209
    v_and_b32 v67, 0xffff0000, v209
    v_add_f32 v26, v64, v65
    v_add_f32 v27, v66, v67
    v_add_f32 v26, v26, v27
    s_nop 1
    v_add_f32_dpp v26, v26, v26 row_shr:1 row_mask:0xf bank_mask:0xf bound_ctrl:0
    s_nop 1
    v_add_f32_dpp v26, v26, v26 row_shr:2 row_mask:0xf bank_mask:0xf bound_ctrl:0
    s_nop 1
    v_add_f32_dpp v26, v26, v26 row_shr:4 row_mask:0xf bank_mask:0xf bound_ctrl:0
    s_nop 1
    v_add_f32_dpp v26, v26, v26 row_shr:8 row_mask:0xf bank_mask:0xf bound_ctrl:0
    s_nop 1
    v_add_f32_dpp v26, v26, v26 row_bcast:15 row_mask:0xa bank_mask:0xf
    s_nop 1
    v_add_f32_dpp v26, v26, v26 row_bcast:31 row_mask:0xc bank_mask:0xf
    s_nop 1
    v_readlane_b32 s66, v26, 63
    s_nop 1
    v_mov_b32 v28, s66
    v_mul_f32 v28, 0x3b800000, v28
    v_mov_b32 v26, 0
    v_sub_f32 v27, v64, v28
    v_fmac_f32 v26, v27, v27
    v_sub_f32 v27, v65, v28
    v_fmac_f32 v26, v27, v27
    v_sub_f32 v27, v66, v28
    v_fmac_f32 v26, v27, v27
    v_sub_f32 v27, v67, v28
    v_fmac_f32 v26, v27, v27
    s_nop 1
    v_add_f32_dpp v26, v26, v26 row_shr:1 row_mask:0xf bank_mask:0xf bound_ctrl:0
    s_nop 1
    v_add_f32_dpp v26, v26, v26 row_shr:2 row_mask:0xf bank_mask:0xf bound_ctrl:0
    s_nop 1
    v_add_f32_dpp v26, v26, v26 row_shr:4 row_mask:0xf bank_mask:0xf bound_ctrl:0
    s_nop 1
    v_add_f32_dpp v26, v26, v26 row_shr:8 row_mask:0xf bank_mask:0xf bound_ctrl:0
    s_nop 1
    v_add_f32_dpp v26, v26, v26 row_bcast:15 row_mask:0xa bank_mask:0xf
    s_nop 1
    v_add_f32_dpp v26, v26, v26 row_bcast:31 row_mask:0xc bank_mask:0xf
    s_nop 1
    v_readlane_b32 s66, v26, 63
    s_lshl_b32 s45, s44, 3
    s_add_u32 s45, s45, 131072
    v_mov_b32 v29, s66
    v_mov_b32 v27, s45
    ds_write_b64 v27, v[28:29]
    v_mov_b32 v27, 131072
    s_waitcnt lgkmcnt(0)
    s_barrier
    ds_read_b128 v[68:71], v27
    ds_read_b128 v[72:75], v27 offset:16
    s_waitcnt lgkmcnt(0)
    v_add_f32 v27, v68, v70
    v_add_f32 v26, v72, v74
    v_add_f32 v27, v27, v26
    v_mul_f32 v27, 0x3e800000, v27
    v_add_f32 v26, v69, v71
    v_add_f32 v28, v73, v75
    v_add_f32 v26, v26, v28
    v_mov_b32 v28, 0
    v_sub_f32 v68, v68, v27
    v_fmac_f32 v28, v68, v68
    v_sub_f32 v70, v70, v27
    v_fmac_f32 v28, v70, v70
    v_sub_f32 v72, v72, v27
    v_fmac_f32 v28, v72, v72
    v_sub_f32 v74, v74, v27
    v_fmac_f32 v28, v74, v74
    v_mul_f32 v28, 0x43800000, v28
    v_add_f32 v26, v26, v28
    v_mul_f32 v26, 0x3a800000, v26
    v_cvt_pk_bf16_f32 v26, v26, v26
    v_lshlrev_b32 v26, 16, v26
    v_cvt_pk_bf16_f32 v27, v27, v27
    v_lshlrev_b32 v27, 16, v27
    v_add_f32 v26, 0x3727c5ac, v26
    v_cvt_pk_bf16_f32 v26, v26, v26
    v_lshlrev_b32 v26, 16, v26
    v_sqrt_f32 v26, v26
    s_nop 0
    v_cvt_pk_bf16_f32 v26, v26, v26
    v_lshlrev_b32 v26, 16, v26
    v_rcp_f32 v26, v26
    s_nop 0
    v_sub_f32 v64, v64, v27
    v_cvt_pk_bf16_f32 v64, v64, v64
    v_lshlrev_b32 v64, 16, v64
    v_mul_f32 v64, v64, v26
    v_cvt_pk_bf16_f32 v64, v64, v64
    v_lshlrev_b32 v64, 16, v64
    v_mul_f32 v64, v64, v108
    v_cvt_pk_bf16_f32 v64, v64, v64
    v_lshlrev_b32 v64, 16, v64
    v_add_f32 v64, v64, v22
    v_sub_f32 v65, v65, v27
    v_cvt_pk_bf16_f32 v65, v65, v65
    v_lshlrev_b32 v65, 16, v65
    v_mul_f32 v65, v65, v26
    v_cvt_pk_bf16_f32 v65, v65, v65
    v_lshlrev_b32 v65, 16, v65
    v_mul_f32 v65, v65, v109
    v_cvt_pk_bf16_f32 v65, v65, v65
    v_lshlrev_b32 v65, 16, v65
    v_add_f32 v65, v65, v23
    v_sub_f32 v66, v66, v27
    v_cvt_pk_bf16_f32 v66, v66, v66
    v_lshlrev_b32 v66, 16, v66
    v_mul_f32 v66, v66, v26
    v_cvt_pk_bf16_f32 v66, v66, v66
    v_lshlrev_b32 v66, 16, v66
    v_mul_f32 v66, v66, v110
    v_cvt_pk_bf16_f32 v66, v66, v66
    v_lshlrev_b32 v66, 16, v66
    v_add_f32 v66, v66, v24
    v_sub_f32 v67, v67, v27
    v_cvt_pk_bf16_f32 v67, v67, v67
    v_lshlrev_b32 v67, 16, v67
    v_mul_f32 v67, v67, v26
    v_cvt_pk_bf16_f32 v67, v67, v67
    v_lshlrev_b32 v67, 16, v67
    v_mul_f32 v67, v67, v111
    v_cvt_pk_bf16_f32 v67, v67, v67
    v_lshlrev_b32 v67, 16, v67
    v_add_f32 v67, v67, v25
    v_cvt_pk_bf16_f32 v64, v64, v65
    v_cvt_pk_bf16_f32 v65, v66, v67
    v_lshrrev_b32 v26, 5, v1
    v_lshlrev_b32 v26, 13, v26
    v_and_b32 v27, 255, v17
    v_add_u32 v26, v26, v27
    s_lshl_b32 s45, s50, 16
    s_lshl_b32 s46, s41, 8
    s_add_u32 s45, s45, s46
    s_lshl_b32 s46, s44, 14
    s_add_u32 s45, s45, s46
    s_add_u32 s45, s45, 0xc00000
    buffer_store_dwordx2 v[64:65], v26, s[12:15], s45 offen sc1
    s_branch L_b_skip_152
L_b_skip2_153:
    s_add_u32 s63, s50, s44
    s_lshl_b32 s63, s63, 5
    s_add_u32 s63, s63, s41
    s_lshl_b32 s47, s63, 11
    buffer_load_dwordx4 v[208:211], v10, s[28:31], s47 offen
    buffer_load_dwordx4 v[212:215], v10, s[28:31], s47 offen offset:1024
    s_add_u32 s45, s64, 4096
    s_cmp_lg_u32 s44, 1
    s_cbranch_scc1 L_pi_159
    s_mov_b32 exec_hi, 0
    buffer_load_dword v31, v5, s[12:15], s45 offen sc1
    s_mov_b64 exec, -1
L_pi_159:
    s_waitcnt vmcnt(0)
    s_barrier
    s_cmp_lg_u32 s44, 0
    s_cbranch_scc1 L_pub_160
    v_mov_b32 v30, s92
    v_mov_b32 v31, 0
    s_mov_b64 exec, 1
    buffer_store_dword v30, v31, s[12:15], s67 offen sc1
    s_mov_b64 exec, -1
L_pub_160:
    s_cmp_lg_u32 s44, 1
    s_cbranch_scc1 L_pw_161
    s_mov_b32 exec_hi, 0
    s_mov_b32 s70, 0
    s_branch L_wp_162_c
L_wp_162:
    buffer_load_dword v31, v5, s[12:15], s45 offen sc1
    s_add_u32 s70, s70, 1
    s_cmp_ge_u32 s70, 0x200000
    s_cbranch_scc1 L_w_done_98
L_wp_162_c:
    s_waitcnt vmcnt(0)
    v_cmp_gt_u32 vcc, s62, v31
    s_nop 1
    s_cbranch_vccz L_wp_162_ok
    s_sleep 2
    s_branch L_wp_162
L_wp_162_ok:
    s_mov_b64 exec, -1
L_pw_161:
    s_barrier
    s_cmp_ge_u32 s44, s51
    s_cbranch_scc1 L_b_skip_152
    s_lshl_b32 s45, s63, 12
    s_add_u32 s45, s45, 0x8000000
    v_lshlrev_b32 v29, 5, v1
    buffer_load_dwordx4 v[64:67], v29, s[12:15], s45 offen offset:0 sc1
    buffer_load_dwordx4 v[68:71], v29, s[12:15], s45 offen offset:16 sc1
    buffer_load_dwordx4 v[72:75], v29, s[12:15], s45 offen offset:2048 sc1
    buffer_load_dwordx4 v[76:79], v29, s[12:15], s45 offen offset:2064 sc1
    s_add_u32 s45, s45, 0x800000
    buffer_load_dwordx4 v[160:163], v29, s[12:15], s45 offen offset:0 sc1
    buffer_load_dwordx4 v[164:167], v29, s[12:15], s45 offen offset:16 sc1
    buffer_load_dwordx4 v[168:171], v29, s[12:15], s45 offen offset:2048 sc1
    buffer_load_dwordx4 v[172:175], v29, s[12:15], s45 offen offset:2064 sc1
    s_add_u32 s45, s45, 0x800000
    buffer_load_dwordx4 v[176:179], v29, s[12:15], s45 offen offset:0 sc1
    buffer_load_dwordx4 v[180:183], v29, s[12:15], s45 offen offset:16 sc1
    buffer_load_dwordx4 v[184:187], v29, s[12:15], s45 offen offset:2048 sc1
    buffer_load_dwordx4 v[188:191], v29, s[12:15], s45 offen offset:2064 sc1
    s_add_u32 s45, s45, 0x800000
    buffer_load_dwordx4 v[192:195], v29, s[12:15], s45 offen offset:0 sc1
    buffer_load_dwordx4 v[196:199], v29, s[12:15], s45 offen offset:16 sc1
    buffer_load_dwordx4 v[200:203], v29, s[12:15], s45 offen offset:2048 sc1
    buffer_load_dwordx4 v[204:207], v29, s[12:15], s45 offen offset:2064 sc1
    s_waitcnt vmcnt(0)
    v_pk_add_f32 v[64:65], v[64:65], v[160:161]
    v_pk_add_f32 v[176:177], v[176:177], v[192:193]
    v_pk_add_f32 v[66:67], v[66:67], v[162:163]
    v_pk_add_f32 v[178:179], v[178:179], v[194:195]
    v_pk_add_f32 v[68:69], v[68:69], v[164:165]
    v_pk_add_f32 v[180:181], v[180:181], v[196:197]
    v_pk_add_f32 v[70:71], v[70:71], v[166:167]
    v_pk_add_f32 v[182:183], v[182:183], v[198:199]
    v_pk_add_f32 v[72:73], v[72:73], v[168:169]
    v_pk_add_f32 v[184:185], v[184:185], v[200:201]
    v_pk_add_f32 v[74:75], v[74:75], v[170:171]
    v_pk_add_f32 v[186:187], v[186:187], v[202:203]
    v_pk_add_f32 v[76:77], v[76:77], v[172:173]
    v_pk_add_f32 v[188:189], v[188:189], v[204:205]
    v_pk_add_f32 v[78:79], v[78:79], v[174:175]
    v_pk_add_f32 v[190:191], v[190:191], v[206:207]
    v_pk_add_f32 v[64:65], v[64:65], v[176:177]
    v_pk_add_f32 v[66:67], v[66:67], v[178:179]
    v_pk_add_f32 v[68:69], v[68:69], v[180:181]
    v_pk_add_f32 v[70:71], v[70:71], v[182:183]
    v_pk_add_f32 v[72:73], v[72:73], v[184:185]
    v_pk_add_f32 v[74:75], v[74:75], v[186:187]
    v_pk_add_f32 v[76:77], v[76:77], v[188:189]
    v_pk_add_f32 v[78:79], v[78:79], v[190:191]
    v_cvt_pk_bf16_f32 v64, v64, v64
    v_lshlrev_b32 v64, 16, v64
    v_cvt_pk_bf16_f32 v65, v65, v65
    v_lshlrev_b32 v65, 16, v65
    v_cvt_pk_bf16_f32 v66, v66, v66
    v_lshlrev_b32 v66, 16, v66
    v_cvt_pk_bf16_f32 v67, v67, v67
    v_lshlrev_b32 v67, 16, v67
    v_cvt_pk_bf16_f32 v68, v68, v68
    v_lshlrev_b32 v68, 16, v68
    v_cvt_pk_bf16_f32 v69, v69, v69
    v_lshlrev_b32 v69, 16, v69
    v_cvt_pk_bf16_f32 v70, v70, v70
    v_lshlrev_b32 v70, 16, v70
    v_cvt_pk_bf16_f32 v71, v71, v71
    v_lshlrev_b32 v71, 16, v71
    v_cvt_pk_bf16_f32 v72, v72, v72
    v_lshlrev_b32 v72, 16, v72
    v_cvt_pk_bf16_f32 v73, v73, v73
    v_lshlrev_b32 v73, 16, v73
    v_cvt_pk_bf16_f32 v74, v74, v74
    v_lshlrev_b32 v74, 16, v74
    v_cvt_pk_bf16_f32 v75, v75, v75
    v_lshlrev_b32 v75, 16, v75
    v_cvt_pk_bf16_f32 v76, v76, v76
    v_lshlrev_b32 v76, 16, v76
    v_cvt_pk_bf16_f32 v77, v77, v77
    v_lshlrev_b32 v77, 16, v77
    v_cvt_pk_bf16_f32 v78, v78, v78
    v_lshlrev_b32 v78, 16, v78
    v_cvt_pk_bf16_f32 v79, v79, v79
    v_lshlrev_b32 v79, 16, v79
    v_lshlrev_b32 v160, 16, v208
    v_and_b32 v161, 0xffff0000, v208
    v_lshlrev_b32 v162, 16, v209
    v_and_b32 v163, 0xffff0000, v209
    v_lshlrev_b32 v164, 16, v210
    v_and_b32 v165, 0xffff0000, v210
    v_lshlrev_b32 v166, 16, v211
    v_and_b32 v167, 0xffff0000, v211
    v_lshlrev_b32 v168, 16, v212
    v_and_b32 v169, 0xffff0000, v212
    v_lshlrev_b32 v170, 16, v213
    v_and_b32 v171, 0xffff0000, v213
    v_lshlrev_b32 v172, 16, v214
    v_and_b32 v173, 0xffff0000, v214
    v_lshlrev_b32 v174, 16, v215
    v_and_b32 v175, 0xffff0000, v215
    v_mul_f32 v64, v64, v112
    v_cvt_pk_bf16_f32 v64, v64, v64
    v_lshlrev_b32 v64, 16, v64
    v_add_f32 v64, v64, v160
    v_mul_f32 v65, v65, v113
    v_cvt_pk_bf16_f32 v65, v65, v65
    v_lshlrev_b32 v65, 16, v65
    v_add_f32 v65, v65, v161
    v_mul_f32 v66, v66, v114
    v_cvt_pk_bf16_f32 v66, v66, v66
    v_lshlrev_b32 v66, 16, v66
    v_add_f32 v66, v66, v162
    v_mul_f32 v67, v67, v115
    v_cvt_pk_bf16_f32 v67, v67, v67
    v_lshlrev_b32 v67, 16, v67
    v_add_f32 v67, v67, v163
    v_mul_f32 v68, v68, v116
    v_cvt_pk_bf16_f32 v68, v68, v68
    v_lshlrev_b32 v68, 16, v68
    v_add_f32 v68, v68, v164
    v_mul_f32 v69, v69, v117
    v_cvt_pk_bf16_f32 v69, v69, v69
    v_lshlrev_b32 v69, 16, v69
    v_add_f32 v69, v69, v165
    v_mul_f32 v70, v70, v118
    v_cvt_pk_bf16_f32 v70, v70, v70
    v_lshlrev_b32 v70, 16, v70
    v_add_f32 v70, v70, v166
    v_mul_f32 v71, v71, v119
    v_cvt_pk_bf16_f32 v71, v71, v71
    v_lshlrev_b32 v71, 16, v71
    v_add_f32 v71, v71, v167
    v_mul_f32 v72, v72, v120
    v_cvt_pk_bf16_f32 v72, v72, v72
    v_lshlrev_b32 v72, 16, v72
    v_add_f32 v72, v72, v168
    v_mul_f32 v73, v73, v121
    v_cvt_pk_bf16_f32 v73, v73, v73
    v_lshlrev_b32 v73, 16, v73
    v_add_f32 v73, v73, v169
    v_mul_f32 v74, v74, v122
    v_cvt_pk_bf16_f32 v74, v74, v74
    v_lshlrev_b32 v74, 16, v74
    v_add_f32 v74, v74, v170
    v_mul_f32 v75, v75, v123
    v_cvt_pk_bf16_f32 v75, v75, v75
    v_lshlrev_b32 v75, 16, v75
    v_add_f32 v75, v75, v171
    v_mul_f32 v76, v76, v124
    v_cvt_pk_bf16_f32 v76, v76, v76
    v_lshlrev_b32 v76, 16, v76
    v_add_f32 v76, v76, v172
    v_mul_f32 v77, v77, v125
    v_cvt_pk_bf16_f32 v77, v77, v77
    v_lshlrev_b32 v77, 16, v77
    v_add_f32 v77, v77, v173
    v_mul_f32 v78, v78, v126
    v_cvt_pk_bf16_f32 v78, v78, v78
    v_lshlrev_b32 v78, 16, v78
    v_add_f32 v78, v78, v174
    v_mul_f32 v79, v79, v127
    v_cvt_pk_bf16_f32 v79, v79, v79
    v_lshlrev_b32 v79, 16, v79
    v_add_f32 v79, v79, v175
    v_cvt_pk_bf16_f32 v208, v64, v65
    v_cvt_pk_bf16_f32 v209, v66, v67
    v_cvt_pk_bf16_f32 v210, v68, v69
    v_cvt_pk_bf16_f32 v211, v70, v71
    v_cvt_pk_bf16_f32 v212, v72, v73
    v_cvt_pk_bf16_f32 v213, v74, v75
    v_cvt_pk_bf16_f32 v214, v76, v77
    v_cvt_pk_bf16_f32 v215, v78, v79
    s_add_u32 s47, s47, 0x800000
    buffer_store_dwordx4 v[208:211], v10, s[12:15], s47 offen sc1
    buffer_store_dwordx4 v[212:215], v10, s[12:15], s47 offen offset:1024 sc1
    v_lshlrev_b32 v64, 16, v208
    v_and_b32 v65, 0xffff0000, v208
    v_lshlrev_b32 v66, 16, v209
    v_and_b32 v67, 0xffff0000, v209
    v_lshlrev_b32 v68, 16, v210
    v_and_b32 v69, 0xffff0000, v210
    v_lshlrev_b32 v70, 16, v211
    v_and_b32 v71, 0xffff0000, v211
    v_lshlrev_b32 v72, 16, v212
    v_and_b32 v73, 0xffff0000, v212
    v_lshlrev_b32 v74, 16, v213
    v_and_b32 v75, 0xffff0000, v213
    v_lshlrev_b32 v76, 16, v214
    v_and_b32 v77, 0xffff0000, v214
    v_lshlrev_b32 v78, 16, v215
    v_and_b32 v79, 0xffff0000, v215
    v_add_f32 v26, v64, v65
    v_add_f32 v26, v26, v66
    v_add_f32 v26, v26, v67
    v_add_f32 v26, v26, v68
    v_add_f32 v26, v26, v69
    v_add_f32 v26, v26, v70
    v_add_f32 v26, v26, v71
    v_add_f32 v26, v26, v72
    v_add_f32 v26, v26, v73
    v_add_f32 v26, v26, v74
    v_add_f32 v26, v26, v75
    v_add_f32 v26, v26, v76
    v_add_f32 v26, v26, v77
    v_add_f32 v26, v26, v78
    v_add_f32 v26, v26, v79
    s_nop 1
    v_add_f32_dpp v26, v26, v26 row_shr:1 row_mask:0xf bank_mask:0xf bound_ctrl:0
    s_nop 1
    v_add_f32_dpp v26, v26, v26 row_shr:2 row_mask:0xf bank_mask:0xf bound_ctrl:0
    s_nop 1
    v_add_f32_dpp v26, v26, v26 row_shr:4 row_mask:0xf bank_mask:0xf bound_ctrl:0
    s_nop 1
    v_add_f32_dpp v26, v26, v26 row_shr:8 row_mask:0xf bank_mask:0xf bound_ctrl:0
    s_nop 1
    v_add_f32_dpp v26, v26, v26 row_bcast:15 row_mask:0xa bank_mask:0xf
    s_nop 1
    v_add_f32_dpp v26, v26, v26 row_bcast:31 row_mask:0xc bank_mask:0xf
    s_nop 1
    v_readlane_b32 s66, v26, 63
    s_nop 1
    v_mov_b32 v27, s66
    v_mul_f32 v27, 0x3a800000, v27
    v_mov_b32 v26, 0
    v_sub_f32 v28, v64, v27
    v_fmac_f32 v26, v28, v28
    v_sub_f32 v28, v65, v27
    v_fmac_f32 v26, v28, v28
    v_sub_f32 v28, v66, v27
    v_fmac_f32 v26, v28, v28
    v_sub_f32 v28, v67, v27
    v_fmac_f32 v26, v28, v28
    v_sub_f32 v28, v68, v27
    v_fmac_f32 v26, v28, v28
    v_sub_f32 v28, v69, v27
    v_fmac_f32 v26, v28, v28
    v_sub_f32 v28, v70, v27
    v_fmac_f32 v26, v28, v28
    v_sub_f32 v28, v71, v27
    v_fmac_f32 v26, v28, v28
    v_sub_f32 v28, v72, v27
    v_fmac_f32 v26, v28, v28
    v_sub_f32 v28, v73, v27
    v_fmac_f32 v26, v28, v28
    v_sub_f32 v28, v74, v27
    v_fmac_f32 v26, v28, v28
    v_sub_f32 v28, v75, v27
    v_fmac_f32 v26, v28, v28
    v_sub_f32 v28, v76, v27
    v_fmac_f32 v26, v28, v28
    v_sub_f32 v28, v77, v27
    v_fmac_f32 v26, v28, v28
    v_sub_f32 v28, v78, v27
    v_fmac_f32 v26, v28, v28
    v_sub_f32 v28, v79, v27
    v_fmac_f32 v26, v28, v28
    s_nop 1
    v_add_f32_dpp v26, v26, v26 row_shr:1 row_mask:0xf bank_mask:0xf bound_ctrl:0
    s_nop 1
    v_add_f32_dpp v26, v26, v26 row_shr:2 row_mask:0xf bank_mask:0xf bound_ctrl:0
    s_nop 1
    v_add_f32_dpp v26, v26, v26 row_shr:4 row_mask:0xf bank_mask:0xf bound_ctrl:0
    s_nop 1
    v_add_f32_dpp v26, v26, v26 row_shr:8 row_mask:0xf bank_mask:0xf bound_ctrl:0
    s_nop 1
    v_add_f32_dpp v26, v26, v26 row_bcast:15 row_mask:0xa bank_mask:0xf
    s_nop 1
    v_add_f32_dpp v26, v26, v26 row_bcast:31 row_mask:0xc bank_mask:0xf
    s_nop 1
    v_readlane_b32 s66, v26, 63
    s_nop 1
    v_mov_b32 v26, s66
    v_mul_f32 v26, 0x3a800000, v26
    v_cvt_pk_bf16_f32 v26, v26, v26
    v_lshlrev_b32 v26, 16, v26
    v_cvt_pk_bf16_f32 v27, v27, v27
    v_lshlrev_b32 v27, 16, v27
    v_add_f32 v26, 0x3727c5ac, v26
    v_cvt_pk_bf16_f32 v26, v26, v26
    v_lshlrev_b32 v26, 16, v26
    v_sqrt_f32 v26, v26
    s_nop 0
    v_cvt_pk_bf16_f32 v26, v26, v26
    v_lshlrev_b32 v26, 16, v26
    v_rcp_f32 v26, v26
    s_nop 0
    v_sub_f32 v64, v64, v27
    v_cvt_pk_bf16_f32 v64, v64, v64
    v_lshlrev_b32 v64, 16, v64
    v_mul_f32 v64, v64, v26
    v_cvt_pk_bf16_f32 v64, v64, v64
    v_lshlrev_b32 v64, 16, v64
    v_sub_f32 v65, v65, v27
    v_cvt_pk_bf16_f32 v65, v65, v65
    v_lshlrev_b32 v65, 16, v65
    v_mul_f32 v65, v65, v26
    v_cvt_pk_bf16_f32 v65, v65, v65
    v_lshlrev_b32 v65, 16, v65
    v_sub_f32 v66, v66, v27
    v_cvt_pk_bf16_f32 v66, v66, v66
    v_lshlrev_b32 v66, 16, v66
    v_mul_f32 v66, v66, v26
    v_cvt_pk_bf16_f32 v66, v66, v66
    v_lshlrev_b32 v66, 16, v66
    v_sub_f32 v67, v67, v27
    v_cvt_pk_bf16_f32 v67, v67, v67
    v_lshlrev_b32 v67, 16, v67
    v_mul_f32 v67, v67, v26
    v_cvt_pk_bf16_f32 v67, v67, v67
    v_lshlrev_b32 v67, 16, v67
    v_sub_f32 v68, v68, v27
    v_cvt_pk_bf16_f32 v68, v68, v68
    v_lshlrev_b32 v68, 16, v68
    v_mul_f32 v68, v68, v26
    v_cvt_pk_bf16_f32 v68, v68, v68
    v_lshlrev_b32 v68, 16, v68
    v_sub_f32 v69, v69, v27
    v_cvt_pk_bf16_f32 v69, v69, v69
    v_lshlrev_b32 v69, 16, v69
    v_mul_f32 v69, v69, v26
    v_cvt_pk_bf16_f32 v69, v69, v69
    v_lshlrev_b32 v69, 16, v69
    v_sub_f32 v70, v70, v27
    v_cvt_pk_bf16_f32 v70, v70, v70
    v_lshlrev_b32 v70, 16, v70
    v_mul_f32 v70, v70, v26
    v_cvt_pk_bf16_f32 v70, v70, v70
    v_lshlrev_b32 v70, 16, v70
    v_sub_f32 v71, v71, v27
    v_cvt_pk_bf16_f32 v71, v71, v71
    v_lshlrev_b32 v71, 16, v71
    v_mul_f32 v71, v71, v26
    v_cvt_pk_bf16_f32 v71, v71, v71
    v_lshlrev_b32 v71, 16, v71
    v_sub_f32 v72, v72, v27
    v_cvt_pk_bf16_f32 v72, v72, v72
    v_lshlrev_b32 v72, 16, v72
    v_mul_f32 v72, v72, v26
    v_cvt_pk_bf16_f32 v72, v72, v72
    v_lshlrev_b32 v72, 16, v72
    v_sub_f32 v73, v73, v27
    v_cvt_pk_bf16_f32 v73, v73, v73
    v_lshlrev_b32 v73, 16, v73
    v_mul_f32 v73, v73, v26
    v_cvt_pk_bf16_f32 v73, v73, v73
    v_lshlrev_b32 v73, 16, v73
    v_sub_f32 v74, v74, v27
    v_cvt_pk_bf16_f32 v74, v74, v74
    v_lshlrev_b32 v74, 16, v74
    v_mul_f32 v74, v74, v26
    v_cvt_pk_bf16_f32 v74, v74, v74
    v_lshlrev_b32 v74, 16, v74
    v_sub_f32 v75, v75, v27
    v_cvt_pk_bf16_f32 v75, v75, v75
    v_lshlrev_b32 v75, 16, v75
    v_mul_f32 v75, v75, v26
    v_cvt_pk_bf16_f32 v75, v75, v75
    v_lshlrev_b32 v75, 16, v75
    v_sub_f32 v76, v76, v27
    v_cvt_pk_bf16_f32 v76, v76, v76
    v_lshlrev_b32 v76, 16, v76
    v_mul_f32 v76, v76, v26
    v_cvt_pk_bf16_f32 v76, v76, v76
    v_lshlrev_b32 v76, 16, v76
    v_sub_f32 v77, v77, v27
    v_cvt_pk_bf16_f32 v77, v77, v77
    v_lshlrev_b32 v77, 16, v77
    v_mul_f32 v77, v77, v26
    v_cvt_pk_bf16_f32 v77, v77, v77
    v_lshlrev_b32 v77, 16, v77
    v_sub_f32 v78, v78, v27
    v_cvt_pk_bf16_f32 v78, v78, v78
    v_lshlrev_b32 v78, 16, v78
    v_mul_f32 v78, v78, v26
    v_cvt_pk_bf16_f32 v78, v78, v78
    v_lshlrev_b32 v78, 16, v78
    v_sub_f32 v79, v79, v27
    v_cvt_pk_bf16_f32 v79, v79, v79
    v_lshlrev_b32 v79, 16, v79
    v_mul_f32 v79, v79, v26
    v_cvt_pk_bf16_f32 v79, v79, v79
    v_lshlrev_b32 v79, 16, v79
    v_mul_f32 v64, v64, v144
    v_cvt_pk_bf16_f32 v64, v64, v64
    v_lshlrev_b32 v64, 16, v64
    v_add_f32 v64, v64, v128
    v_mul_f32 v65, v65, v145
    v_cvt_pk_bf16_f32 v65, v65, v65
    v_lshlrev_b32 v65, 16, v65
    v_add_f32 v65, v65, v129
    v_mul_f32 v66, v66, v146
    v_cvt_pk_bf16_f32 v66, v66, v66
    v_lshlrev_b32 v66, 16, v66
    v_add_f32 v66, v66, v130
    v_mul_f32 v67, v67, v147
    v_cvt_pk_bf16_f32 v67, v67, v67
    v_lshlrev_b32 v67, 16, v67
    v_add_f32 v67, v67, v131
    v_mul_f32 v68, v68, v148
    v_cvt_pk_bf16_f32 v68, v68, v68
    v_lshlrev_b32 v68, 16, v68
    v_add_f32 v68, v68, v132
    v_mul_f32 v69, v69, v149
    v_cvt_pk_bf16_f32 v69, v69, v69
    v_lshlrev_b32 v69, 16, v69
    v_add_f32 v69, v69, v133
    v_mul_f32 v70, v70, v150
    v_cvt_pk_bf16_f32 v70, v70, v70
    v_lshlrev_b32 v70, 16, v70
    v_add_f32 v70, v70, v134
    v_mul_f32 v71, v71, v151
    v_cvt_pk_bf16_f32 v71, v71, v71
    v_lshlrev_b32 v71, 16, v71
    v_add_f32 v71, v71, v135
    v_mul_f32 v72, v72, v152
    v_cvt_pk_bf16_f32 v72, v72, v72
    v_lshlrev_b32 v72, 16, v72
    v_add_f32 v72, v72, v136
    v_mul_f32 v73, v73, v153
    v_cvt_pk_bf16_f32 v73, v73, v73
    v_lshlrev_b32 v73, 16, v73
    v_add_f32 v73, v73, v137
    v_mul_f32 v74, v74, v154
    v_cvt_pk_bf16_f32 v74, v74, v74
    v_lshlrev_b32 v74, 16, v74
    v_add_f32 v74, v74, v138
    v_mul_f32 v75, v75, v155
    v_cvt_pk_bf16_f32 v75, v75, v75
    v_lshlrev_b32 v75, 16, v75
    v_add_f32 v75, v75, v139
    v_mul_f32 v76, v76, v156
    v_cvt_pk_bf16_f32 v76, v76, v76
    v_lshlrev_b32 v76, 16, v76
    v_add_f32 v76, v76, v140
    v_mul_f32 v77, v77, v157
    v_cvt_pk_bf16_f32 v77, v77, v77
    v_lshlrev_b32 v77, 16, v77
    v_add_f32 v77, v77, v141
    v_mul_f32 v78, v78, v158
    v_cvt_pk_bf16_f32 v78, v78, v78
    v_lshlrev_b32 v78, 16, v78
    v_add_f32 v78, v78, v142
    v_mul_f32 v79, v79, v159
    v_cvt_pk_bf16_f32 v79, v79, v79
    v_lshlrev_b32 v79, 16, v79
    v_add_f32 v79, v79, v143
    v_cvt_pk_bf16_f32 v80, v64, v65
    v_cvt_pk_bf16_f32 v81, v66, v67
    v_cvt_pk_bf16_f32 v82, v68, v69
    v_cvt_pk_bf16_f32 v83, v70, v71
    v_cvt_pk_bf16_f32 v84, v72, v73
    v_cvt_pk_bf16_f32 v85, v74, v75
    v_cvt_pk_bf16_f32 v86, v76, v77
    v_cvt_pk_bf16_f32 v87, v78, v79
    s_lshr_b32 s45, s63, 5
    s_lshl_b32 s45, s45, 16
    s_and_b32 s46, s63, 31
    s_lshl_b32 s46, s46, 8
    s_add_u32 s45, s45, s46
    s_add_u32 s45, s45, 0xc00000
    s_add_u32 s46, s45, 32768
    buffer_store_dwordx4 v[80:83], v2, s[12:15], s45 offen sc1
    buffer_store_dwordx4 v[84:87], v2, s[12:15], s46 offen sc1
L_b_skip_152:
    s_waitcnt vmcnt(0)
    s_barrier
    s_cmp_lg_u32 s44, 0
    s_cbranch_scc1 L_pub_163
    v_mov_b32 v30, s62
    v_mov_b32 v31, 0
    s_mov_b64 exec, 1
    buffer_store_dword v30, v31, s[80:83], s65 offen
    buffer_store_dword v30, v31, s[84:87], s65 offen sc1
    s_mov_b64 exec, -1
L_pub_163:
    s_cmp_ge_u32 s41, 28
    s_cbranch_scc1 L_b_loop_151
    s_add_u32 s45, s64, 8192
    s_cmp_lg_u32 s44, 1
    s_cbranch_scc1 L_pw_164
    s_mov_b32 exec_hi, 0
    s_mov_b32 s70, 0
L_wp_165:
    buffer_load_dword v31, v5, s[12:15], s45 offen sc1
    s_add_u32 s70, s70, 1
    s_cmp_ge_u32 s70, 0x200000
    s_cbranch_scc1 L_w_done_98
L_wp_165_c:
    s_waitcnt vmcnt(0)
    v_cmp_gt_u32 vcc, s62, v31
    s_nop 1
    s_cbranch_vccz L_wp_165_ok
    s_sleep 1
    s_branch L_wp_165
L_wp_165_ok:
    s_mov_b64 exec, -1
L_pw_164:
    s_barrier
    s_mul_i32 s53, s50, 65536
    s_add_u32 s53, s53, s52
    s_lshl_b32 s54, s44, 13
    s_add_u32 s53, s53, s54
    s_mul_i32 s57, s50, 229376
    s_add_u32 s57, s57, s56
    s_lshl_b32 s45, s44, 11
    s_add_u32 s57, s57, s45
    s_add_u32 s55, s54, 65536
    s_mov_b32 s58, 0
    v_mov_b32 v13, v3
    v_add_u32 v14, 65536, v13
    v_xor_b32 v15, 64, v13
    v_xor_b32 v16, 64, v14
    s_mov_b32 s76, 0x20000000
    s_add_u32 s48, s53, 0
    s_add_u32 s49, s48, 4096
    s_add_u32 m0, s54, 0
    s_nop 0
    buffer_load_dwordx4 v6, s[12:15], s48 offen offset:0 sc1 lds
    s_add_u32 m0, s54, 1024
    s_nop 0
    buffer_load_dwordx4 v9, s[12:15], s48 offen offset:0 sc1 lds
    s_add_u32 m0, s54, 2048
    s_nop 0
    buffer_load_dwordx4 v6, s[12:15], s49 offen offset:0 sc1 lds
    s_add_u32 m0, s54, 3072
    s_nop 0
    buffer_load_dwordx4 v9, s[12:15], s49 offen offset:0 sc1 lds
    s_add_u32 m0, s54, 3968
    s_nop 0
    buffer_load_dwordx4 v6, s[12:15], s48 offen offset:128 sc1 lds
    s_add_u32 m0, s54, 4992
    s_nop 0
    buffer_load_dwordx4 v9, s[12:15], s48 offen offset:128 sc1 lds
    s_add_u32 m0, s54, 6016
    s_nop 0
    buffer_load_dwordx4 v6, s[12:15], s49 offen offset:128 sc1 lds
    s_add_u32 m0, s54, 7040
    s_nop 0
    buffer_load_dwordx4 v9, s[12:15], s49 offen offset:128 sc1 lds
    s_add_u32 s48, s53, 32768
    s_add_u32 s49, s48, 4096
    s_add_u32 s46, s54, 32768
    s_add_u32 m0, s46, 0
    s_nop 0
    buffer_load_dwordx4 v6, s[12:15], s48 offen offset:0 sc1 lds
    s_add_u32 m0, s46, 1024
    s_nop 0
    buffer_load_dwordx4 v9, s[12:15], s48 offen offset:0 sc1 lds
    s_add_u32 m0, s46, 2048
    s_nop 0
    buffer_load_dwordx4 v6, s[12:15], s49 offen offset:0 sc1 lds
    s_add_u32 m0, s46, 3072
    s_nop 0
    buffer_load_dwordx4 v9, s[12:15], s49 offen offset:0 sc1 lds
    s_add_u32 m0, s46, 3968
    s_nop 0
    buffer_load_dwordx4 v6, s[12:15], s48 offen offset:128 sc1 lds
    s_add_u32 m0, s46, 4992
    s_nop 0
    buffer_load_dwordx4 v9, s[12:15], s48 offen offset:128 sc1 lds
    s_add_u32 m0, s46, 6016
    s_nop 0
    buffer_load_dwordx4 v6, s[12:15], s49 offen offset:128 sc1 lds
    s_add_u32 m0, s46, 7040
    s_nop 0
    buffer_load_dwordx4 v9, s[12:15], s49 offen offset:128 sc1 lds
    s_cmp_eq_u32 s51, 1
    s_cbranch_scc1 L_e_one_167
    s_add_u32 s48, s53, 65536
    s_add_u32 s49, s48, 4096
    s_add_u32 m0, s55, 0
    s_nop 0
    buffer_load_dwordx4 v6, s[12:15], s48 offen offset:0 sc1 lds
    s_add_u32 m0, s55, 1024
    s_nop 0
    buffer_load_dwordx4 v9, s[12:15], s48 offen offset:0 sc1 lds
    s_add_u32 m0, s55, 2048
    s_nop 0
    buffer_load_dwordx4 v6, s[12:15], s49 offen offset:0 sc1 lds
    s_add_u32 m0, s55, 3072
    s_nop 0
    buffer_load_dwordx4 v9, s[12:15], s49 offen offset:0 sc1 lds
    s_add_u32 m0, s55, 3968
    s_nop 0
    buffer_load_dwordx4 v6, s[12:15], s48 offen offset:128 sc1 lds
    s_add_u32 m0, s55, 4992
    s_nop 0
    buffer_load_dwordx4 v9, s[12:15], s48 offen offset:128 sc1 lds
    s_add_u32 m0, s55, 6016
    s_nop 0
    buffer_load_dwordx4 v6, s[12:15], s49 offen offset:128 sc1 lds
    s_add_u32 m0, s55, 7040
    s_nop 0
    buffer_load_dwordx4 v9, s[12:15], s49 offen offset:128 sc1 lds
    s_waitcnt vmcnt(16)
    s_barrier
    ds_read_b128 v[32:35], v13 offset:0
    ds_read_b128 v[36:39], v13 offset:2048
    ds_read_b128 v[40:43], v15 offset:0
    ds_read_b128 v[44:47], v15 offset:2048
    s_add_u32 s48, s53, 98304
    s_add_u32 s46, s58, 1
    s_cmp_lt_u32 s46, s51
    s_cselect_b32 s48, s48, 0x20000000
    s_add_u32 s49, s48, 4096
    s_add_u32 s59, s55, 32768
L_e_loop_166:
    s_waitcnt lgkmcnt(2)
    v_mfma_f32_16x16x32_bf16 v[80:83], a[0:3], v[32:35], 0
    ds_read_b128 v[48:51], v13 offset:4096
    v_mul_f32 v240, v224, v224
    v_mfma_f32_16x16x32_bf16 v[84:87], a[4:7], v[32:35], 0
    ds_read_b128 v[52:55], v13 offset:6144
    v_mul_f32 v241, v225, v225
    v_mfma_f32_16x16x32_bf16 v[88:91], a[0:3], v[36:39], 0
    ds_read_b128 v[56:59], v15 offset:4096
    s_add_u32 m0, s59, 0
    v_mul_f32 v242, v226, v226
    v_mfma_f32_16x16x32_bf16 v[92:95], a[4:7], v[36:39], 0
    ds_read_b128 v[60:63], v15 offset:6144
    buffer_load_dwordx4 v6, s[12:15], s48 offen offset:0 sc1 lds
    s_waitcnt lgkmcnt(4)
    v_mfma_f32_16x16x32_bf16 v[80:83], a[8:11], v[40:43], v[80:83]
    ds_read_b128 v[32:35], v13 offset:8192
    v_mul_f32 v243, v227, v227
    v_mfma_f32_16x16x32_bf16 v[84:87], a[12:15], v[40:43], v[84:87]
    ds_read_b128 v[36:39], v13 offset:10240
    v_mul_f32 v244, v228, v228
    v_mfma_f32_16x16x32_bf16 v[88:91], a[8:11], v[44:47], v[88:91]
    s_add_u32 m0, s59, 1024
    v_mul_f32 v245, v229, v229
    v_mul_f32 v246, v230, v230
    v_mfma_f32_16x16x32_bf16 v[92:95], a[12:15], v[44:47], v[92:95]
    buffer_load_dwordx4 v9, s[12:15], s48 offen offset:0 sc1 lds
    s_waitcnt lgkmcnt(4)
    v_mfma_f32_16x16x32_bf16 v[80:83], a[16:19], v[48:51], v[80:83]
    ds_read_b128 v[40:43], v15 offset:8192
    v_mul_f32 v247, v231, v231
    v_mfma_f32_16x16x32_bf16 v[84:87], a[20:23], v[48:51], v[84:87]
    ds_read_b128 v[44:47], v15 offset:10240
    v_mul_f32 v248, v232, v232
    v_mfma_f32_16x16x32_bf16 v[88:91], a[16:19], v[52:55], v[88:91]
    s_add_u32 m0, s59, 2048
    v_mul_f32 v249, v233, v233
    v_mul_f32 v250, v234, v234
    v_mfma_f32_16x16x32_bf16 v[92:95], a[20:23], v[52:55], v[92:95]
    buffer_load_dwordx4 v6, s[12:15], s49 offen offset:0 sc1 lds
    s_waitcnt lgkmcnt(4)
    v_mfma_f32_16x16x32_bf16 v[80:83], a[24:27], v[56:59], v[80:83]
    ds_read_b128 v[48:51], v13 offset:12288
    v_mul_f32 v251, v235, v235
    v_mfma_f32_16x16x32_bf16 v[84:87], a[28:31], v[56:59], v[84:87]
    ds_read_b128 v[52:55], v13 offset:14336
    v_mul_f32 v252, v236, v236
    v_mfma_f32_16x16x32_bf16 v[88:91], a[24:27], v[60:63], v[88:91]
    s_add_u32 m0, s59, 3072
    v_mul_f32 v253, v237, v237
    v_mul_f32 v254, v238, v238
    v_mfma_f32_16x16x32_bf16 v[92:95], a[28:31], v[60:63], v[92:95]
    buffer_load_dwordx4 v9, s[12:15], s49 offen offset:0 sc1 lds
    s_waitcnt lgkmcnt(4)
    v_mfma_f32_16x16x32_bf16 v[80:83], a[32:35], v[32:35], v[80:83]
    ds_read_b128 v[56:59], v15 offset:12288
    v_mul_f32 v255, v239, v239
    v_mfma_f32_16x16x32_bf16 v[84:87], a[36:39], v[32:35], v[84:87]
    ds_read_b128 v[60:63], v15 offset:14336
    v_fma_f32 v240, v240, v104, v106
    v_mfma_f32_16x16x32_bf16 v[88:91], a[32:35], v[36:39], v[88:91]
    s_add_u32 m0, s59, 3968
    v_fma_f32 v241, v241, v105, v107
    v_fma_f32 v242, v242, v104, v106
    v_mfma_f32_16x16x32_bf16 v[92:95], a[36:39], v[36:39], v[92:95]
    buffer_load_dwordx4 v6, s[12:15], s48 offen offset:128 sc1 lds
    s_waitcnt lgkmcnt(4)
    v_mfma_f32_16x16x32_bf16 v[80:83], a[40:43], v[40:43], v[80:83]
    ds_read_b128 v[32:35], v13 offset:16384
    v_fma_f32 v243, v243, v105, v107
    v_mfma_f32_16x16x32_bf16 v[84:87], a[44:47], v[40:43], v[84:87]
    ds_read_b128 v[36:39], v13 offset:18432
    v_fma_f32 v244, v244, v104, v106
    v_mfma_f32_16x16x32_bf16 v[88:91], a[40:43], v[44:47], v[88:91]
    s_add_u32 m0, s59, 4992
    v_fma_f32 v245, v245, v105, v107
    v_fma_f32 v246, v246, v104, v106
    v_mfma_f32_16x16x32_bf16 v[92:95], a[44:47], v[44:47], v[92:95]
    buffer_load_dwordx4 v9, s[12:15], s48 offen offset:128 sc1 lds
    s_waitcnt lgkmcnt(4)
    v_mfma_f32_16x16x32_bf16 v[80:83], a[48:51], v[48:51], v[80:83]
    ds_read_b128 v[40:43], v15 offset:16384
    v_fma_f32 v247, v247, v105, v107
    v_mfma_f32_16x16x32_bf16 v[84:87], a[52:55], v[48:51], v[84:87]
    ds_read_b128 v[44:47], v15 offset:18432
    v_fma_f32 v248, v248, v104, v106
    v_mfma_f32_16x16x32_bf16 v[88:91], a[48:51], v[52:55], v[88:91]
    s_add_u32 m0, s59, 6016
    v_fma_f32 v249, v249, v105, v107
    v_fma_f32 v250, v250, v104, v106
    v_mfma_f32_16x16x32_bf16 v[92:95], a[52:55], v[52:55], v[92:95]
    buffer_load_dwordx4 v6, s[12:15], s49 offen offset:128 sc1 lds
    s_waitcnt lgkmcnt(4)
    v_mfma_f32_16x16x32_bf16 v[80:83], a[56:59], v[56:59], v[80:83]
    ds_read_b128 v[48:51], v13 offset:20480
    v_fma_f32 v251, v251, v105, v107
    v_mfma_f32_16x16x32_bf16 v[84:87], a[60:63], v[56:59], v[84:87]
    ds_read_b128 v[52:55], v13 offset:22528
    v_fma_f32 v252, v252, v104, v106
    v_mfma_f32_16x16x32_bf16 v[88:91], a[56:59], v[60:63], v[88:91]
    s_add_u32 m0, s59, 7040
    v_fma_f32 v253, v253, v105, v107
    v_fma_f32 v254, v254, v104, v106
    v_mfma_f32_16x16x32_bf16 v[92:95], a[60:63], v[60:63], v[92:95]
    buffer_load_dwordx4 v9, s[12:15], s49 offen offset:128 sc1 lds
    s_waitcnt lgkmcnt(4)
    v_mfma_f32_16x16x32_bf16 v[80:83], a[64:67], v[32:35], v[80:83]
    ds_read_b128 v[56:59], v15 offset:20480
    v_fma_f32 v255, v255, v105, v107
    v_mfma_f32_16x16x32_bf16 v[84:87], a[68:71], v[32:35], v[84:87]
    ds_read_b128 v[60:63], v15 offset:22528
    v_mul_f32 v240, v240, v224
    v_mfma_f32_16x16x32_bf16 v[88:91], a[64:67], v[36:39], v[88:91]
    s_add_u32 s48, s53, 131072
    v_mul_f32 v241, v241, v225
    v_mul_f32 v242, v242, v226
    v_mul_f32 v243, v243, v227
    v_mfma_f32_16x16x32_bf16 v[92:95], a[68:71], v[36:39], v[92:95]
    s_add_u32 s46, s58, 2
    v_mul_f32 v244, v244, v228
    s_waitcnt lgkmcnt(4)
    v_mfma_f32_16x16x32_bf16 v[80:83], a[72:75], v[40:43], v[80:83]
    ds_read_b128 v[32:35], v13 offset:24576
    v_mul_f32 v245, v245, v229
    v_mfma_f32_16x16x32_bf16 v[84:87], a[76:79], v[40:43], v[84:87]
    ds_read_b128 v[36:39], v13 offset:26624
    v_mul_f32 v246, v246, v230
    v_mfma_f32_16x16x32_bf16 v[88:91], a[72:75], v[44:47], v[88:91]
    s_cmp_lt_u32 s46, s51
    s_cselect_b32 s48, s48, 0x20000000
    v_mul_f32 v247, v247, v231
    v_mul_f32 v248, v248, v232
    v_mfma_f32_16x16x32_bf16 v[92:95], a[76:79], v[44:47], v[92:95]
    s_add_u32 s49, s48, 4096
    v_mul_f32 v249, v249, v233
    s_waitcnt lgkmcnt(4)
    v_mfma_f32_16x16x32_bf16 v[80:83], a[80:83], v[48:51], v[80:83]
    ds_read_b128 v[40:43], v15 offset:24576
    v_mul_f32 v250, v250, v234
    v_mfma_f32_16x16x32_bf16 v[84:87], a[84:87], v[48:51], v[84:87]
    ds_read_b128 v[44:47], v15 offset:26624
    v_mul_f32 v251, v251, v235
    v_mfma_f32_16x16x32_bf16 v[88:91], a[80:83], v[52:55], v[88:91]
    s_mov_b32 s59, s54
    v_mul_f32 v252, v252, v236
    v_mul_f32 v253, v253, v237
    v_mfma_f32_16x16x32_bf16 v[92:95], a[84:87], v[52:55], v[92:95]
    v_mul_f32 v254, v254, v238
    s_waitcnt lgkmcnt(4)
    v_mfma_f32_16x16x32_bf16 v[80:83], a[88:91], v[56:59], v[80:83]
    ds_read_b128 v[48:51], v13 offset:28672
    v_mul_f32 v255, v255, v239
    v_mfma_f32_16x16x32_bf16 v[84:87], a[92:95], v[56:59], v[84:87]
    ds_read_b128 v[52:55], v13 offset:30720
    v_exp_f32 v240, v240
    v_mfma_f32_16x16x32_bf16 v[88:91], a[88:91], v[60:63], v[88:91]
    v_exp_f32 v241, v241
    v_mfma_f32_16x16x32_bf16 v[92:95], a[92:95], v[60:63], v[92:95]
    v_exp_f32 v242, v242
    s_waitcnt lgkmcnt(4)
    v_mfma_f32_16x16x32_bf16 v[80:83], a[96:99], v[32:35], v[80:83]
    ds_read_b128 v[56:59], v15 offset:28672
    v_exp_f32 v243, v243
    v_mfma_f32_16x16x32_bf16 v[84:87], a[100:103], v[32:35], v[84:87]
    ds_read_b128 v[60:63], v15 offset:30720
    v_exp_f32 v244, v244
    v_mfma_f32_16x16x32_bf16 v[88:91], a[96:99], v[36:39], v[88:91]
    v_exp_f32 v245, v245
    v_mfma_f32_16x16x32_bf16 v[92:95], a[100:103], v[36:39], v[92:95]
    v_exp_f32 v246, v246
    s_waitcnt lgkmcnt(4)
    v_mfma_f32_16x16x32_bf16 v[80:83], a[104:107], v[40:43], v[80:83]
    v_exp_f32 v247, v247
    v_mfma_f32_16x16x32_bf16 v[84:87], a[108:111], v[40:43], v[84:87]
    v_exp_f32 v248, v248
    v_mfma_f32_16x16x32_bf16 v[88:91], a[104:107], v[44:47], v[88:91]
    v_exp_f32 v249, v249
    v_mfma_f32_16x16x32_bf16 v[92:95], a[108:111], v[44:47], v[92:95]
    v_exp_f32 v250, v250
    s_waitcnt vmcnt(16) lgkmcnt(0)
    s_barrier
    v_mfma_f32_16x16x32_bf16 v[80:83], a[112:115], v[48:51], v[80:83]
    ds_read_b128 v[32:35], v13 offset:32768
    v_exp_f32 v251, v251
    v_mfma_f32_16x16x32_bf16 v[84:87], a[116:119], v[48:51], v[84:87]
    ds_read_b128 v[36:39], v13 offset:34816
    v_exp_f32 v252, v252
    v_mfma_f32_16x16x32_bf16 v[88:91], a[112:115], v[52:55], v[88:91]
    v_exp_f32 v253, v253
    v_mfma_f32_16x16x32_bf16 v[92:95], a[116:119], v[52:55], v[92:95]
    v_exp_f32 v254, v254
    v_mfma_f32_16x16x32_bf16 v[80:83], a[120:123], v[56:59], v[80:83]
    ds_read_b128 v[40:43], v15 offset:32768
    v_exp_f32 v255, v255
    v_mfma_f32_16x16x32_bf16 v[84:87], a[124:127], v[56:59], v[84:87]
    ds_read_b128 v[44:47], v15 offset:34816
    v_add_f32 v240, 1.0, v240
    v_mfma_f32_16x16x32_bf16 v[88:91], a[120:123], v[60:63], v[88:91]
    v_add_f32 v241, 1.0, v241
    v_add_f32 v242, 1.0, v242
    v_mfma_f32_16x16x32_bf16 v[92:95], a[124:127], v[60:63], v[92:95]
    v_add_f32 v243, 1.0, v243
    s_waitcnt lgkmcnt(2)
    v_mfma_f32_16x16x32_bf16 v[80:83], a[128:131], v[32:35], v[80:83]
    ds_read_b128 v[48:51], v13 offset:36864
    v_add_f32 v244, 1.0, v244
    v_mfma_f32_16x16x32_bf16 v[84:87], a[132:135], v[32:35], v[84:87]
    ds_read_b128 v[52:55], v13 offset:38912
    v_add_f32 v245, 1.0, v245
    v_mfma_f32_16x16x32_bf16 v[88:91], a[128:131], v[36:39], v[88:91]
    ds_read_b128 v[56:59], v15 offset:36864
    s_add_u32 m0, s59, 0
    v_add_f32 v246, 1.0, v246
    v_mfma_f32_16x16x32_bf16 v[92:95], a[132:135], v[36:39], v[92:95]
    ds_read_b128 v[60:63], v15 offset:38912
    buffer_load_dwordx4 v6, s[12:15], s48 offen offset:0 sc1 lds
    s_waitcnt lgkmcnt(4)
    v_mfma_f32_16x16x32_bf16 v[80:83], a[136:139], v[40:43], v[80:83]
    ds_read_b128 v[32:35], v13 offset:40960
    v_add_f32 v247, 1.0, v247
    v_mfma_f32_16x16x32_bf16 v[84:87], a[140:143], v[40:43], v[84:87]
    ds_read_b128 v[36:39], v13 offset:43008
    v_add_f32 v248, 1.0, v248
    v_mfma_f32_16x16x32_bf16 v[88:91], a[136:139], v[44:47], v[88:91]
    s_add_u32 m0, s59, 1024
    v_add_f32 v249, 1.0, v249
    v_add_f32 v250, 1.0, v250
    v_mfma_f32_16x16x32_bf16 v[92:95], a[140:143], v[44:47], v[92:95]
    buffer_load_dwordx4 v9, s[12:15], s48 offen offset:0 sc1 lds
    s_waitcnt lgkmcnt(4)
    v_mfma_f32_16x16x32_bf16 v[80:83], a[144:147], v[48:51], v[80:83]
    ds_read_b128 v[40:43], v15 offset:40960
    v_add_f32 v251, 1.0, v251
    v_mfma_f32_16x16x32_bf16 v[84:87], a[148:151], v[48:51], v[84:87]
    ds_read_b128 v[44:47], v15 offset:43008
    v_add_f32 v252, 1.0, v252
    v_mfma_f32_16x16x32_bf16 v[88:91], a[144:147], v[52:55], v[88:91]
    s_add_u32 m0, s59, 2048
    v_add_f32 v253, 1.0, v253
    v_add_f32 v254, 1.0, v254
    v_mfma_f32_16x16x32_bf16 v[92:95], a[148:151], v[52:55], v[92:95]
    buffer_load_dwordx4 v6, s[12:15], s49 offen offset:0 sc1 lds
    s_waitcnt lgkmcnt(4)
    v_mfma_f32_16x16x32_bf16 v[80:83], a[152:155], v[56:59], v[80:83]
    ds_read_b128 v[48:51], v13 offset:45056
    v_add_f32 v255, 1.0, v255
    v_mfma_f32_16x16x32_bf16 v[84:87], a[156:159], v[56:59], v[84:87]
    ds_read_b128 v[52:55], v13 offset:47104
    v_rcp_f32 v240, v240
    v_mfma_f32_16x16x32_bf16 v[88:91], a[152:155], v[60:63], v[88:91]
    s_add_u32 m0, s59, 3072
    v_rcp_f32 v241, v241
    v_mfma_f32_16x16x32_bf16 v[92:95], a[156:159], v[60:63], v[92:95]
    buffer_load_dwordx4 v9, s[12:15], s49 offen offset:0 sc1 lds
    s_waitcnt lgkmcnt(4)
    v_mfma_f32_16x16x32_bf16 v[80:83], a[160:163], v[32:35], v[80:83]
    ds_read_b128 v[56:59], v15 offset:45056
    v_rcp_f32 v242, v242
    v_mfma_f32_16x16x32_bf16 v[84:87], a[164:167], v[32:35], v[84:87]
    ds_read_b128 v[60:63], v15 offset:47104
    v_rcp_f32 v243, v243
    v_mfma_f32_16x16x32_bf16 v[88:91], a[160:163], v[36:39], v[88:91]
    s_add_u32 m0, s59, 3968
    v_rcp_f32 v244, v244
    v_mfma_f32_16x16x32_bf16 v[92:95], a[164:167], v[36:39], v[92:95]
    buffer_load_dwordx4 v6, s[12:15], s48 offen offset:128 sc1 lds
    s_waitcnt lgkmcnt(4)
    v_mfma_f32_16x16x32_bf16 v[80:83], a[168:171], v[40:43], v[80:83]
    ds_read_b128 v[32:35], v13 offset:49152
    v_rcp_f32 v245, v245
    v_mfma_f32_16x16x32_bf16 v[84:87], a[172:175], v[40:43], v[84:87]
    ds_read_b128 v[36:39], v13 offset:51200
    v_rcp_f32 v246, v246
    v_mfma_f32_16x16x32_bf16 v[88:91], a[168:171], v[44:47], v[88:91]
    s_add_u32 m0, s59, 4992
    v_rcp_f32 v247, v247
    v_mfma_f32_16x16x32_bf16 v[92:95], a[172:175], v[44:47], v[92:95]
    buffer_load_dwordx4 v9, s[12:15], s48 offen offset:128 sc1 lds
    s_waitcnt lgkmcnt(4)
    v_mfma_f32_16x16x32_bf16 v[80:83], a[176:179], v[48:51], v[80:83]
    ds_read_b128 v[40:43], v15 offset:49152
    v_rcp_f32 v248, v248
    v_mfma_f32_16x16x32_bf16 v[84:87], a[180:183], v[48:51], v[84:87]
    ds_read_b128 v[44:47], v15 offset:51200
    v_rcp_f32 v249, v249
    v_mfma_f32_16x16x32_bf16 v[88:91], a[176:179], v[52:55], v[88:91]
    s_add_u32 m0, s59, 6016
    v_rcp_f32 v250, v250
    v_mfma_f32_16x16x32_bf16 v[92:95], a[180:183], v[52:55], v[92:95]
    buffer_load_dwordx4 v6, s[12:15], s49 offen offset:128 sc1 lds
    s_waitcnt lgkmcnt(4)
    v_mfma_f32_16x16x32_bf16 v[80:83], a[184:187], v[56:59], v[80:83]
    ds_read_b128 v[48:51], v13 offset:53248
    v_rcp_f32 v251, v251
    v_mfma_f32_16x16x32_bf16 v[84:87], a[188:191], v[56:59], v[84:87]
    ds_read_b128 v[52:55], v13 offset:55296
    v_mfma_f32_16x16x32_bf16 v[88:91], a[184:187], v[60:63], v[88:91]
    s_add_u32 m0, s59, 7040
    v_rcp_f32 v252, v252
    v_mfma_f32_16x16x32_bf16 v[92:95], a[188:191], v[60:63], v[92:95]
    buffer_load_dwordx4 v9, s[12:15], s49 offen offset:128 sc1 lds
    s_waitcnt lgkmcnt(4)
    v_mfma_f32_16x16x32_bf16 v[80:83], a[192:195], v[32:35], v[80:83]
    ds_read_b128 v[56:59], v15 offset:53248
    v_rcp_f32 v253, v253
    v_mfma_f32_16x16x32_bf16 v[84:87], a[196:199], v[32:35], v[84:87]
    ds_read_b128 v[60:63], v15 offset:55296
    v_mfma_f32_16x16x32_bf16 v[88:91], a[192:195], v[36:39], v[88:91]
    s_add_u32 s48, s53, 163840
    v_rcp_f32 v254, v254
    v_mfma_f32_16x16x32_bf16 v[92:95], a[196:199], v[36:39], v[92:95]
    s_add_u32 s46, s58, 2
    s_waitcnt lgkmcnt(4)
    v_mfma_f32_16x16x32_bf16 v[80:83], a[200:203], v[40:43], v[80:83]
    ds_read_b128 v[32:35], v13 offset:57344
    v_rcp_f32 v255, v255
    v_mfma_f32_16x16x32_bf16 v[84:87], a[204:207], v[40:43], v[84:87]
    ds_read_b128 v[36:39], v13 offset:59392
    v_mul_f32 v224, v224, v240
    v_mfma_f32_16x16x32_bf16 v[88:91], a[200:203], v[44:47], v[88:91]
    s_cmp_lt_u32 s46, s51
    s_cselect_b32 s48, s48, 0x20000000
    v_mul_f32 v225, v225, v241
    v_mul_f32 v226, v226, v242
    v_mfma_f32_16x16x32_bf16 v[92:95], a[204:207], v[44:47], v[92:95]
    s_add_u32 s49, s48, 4096
    v_mul_f32 v227, v227, v243
    s_waitcnt lgkmcnt(4)
    v_mfma_f32_16x16x32_bf16 v[80:83], a[208:211], v[48:51], v[80:83]
    ds_read_b128 v[40:43], v15 offset:57344
    v_mul_f32 v228, v228, v244
    v_mfma_f32_16x16x32_bf16 v[84:87], a[212:215], v[48:51], v[84:87]
    ds_read_b128 v[44:47], v15 offset:59392
    v_mul_f32 v229, v229, v245
    v_mfma_f32_16x16x32_bf16 v[88:91], a[208:211], v[52:55], v[88:91]
    s_add_u32 s59, s54, 32768
    v_mul_f32 v230, v230, v246
    v_mul_f32 v231, v231, v247
    v_mfma_f32_16x16x32_bf16 v[92:95], a[212:215], v[52:55], v[92:95]
    v_mul_f32 v232, v232, v248
    s_waitcnt lgkmcnt(4)
    v_mfma_f32_16x16x32_bf16 v[80:83], a[216:219], v[56:59], v[80:83]
    ds_read_b128 v[48:51], v13 offset:61440
    v_mul_f32 v233, v233, v249
    v_mfma_f32_16x16x32_bf16 v[84:87], a[220:223], v[56:59], v[84:87]
    ds_read_b128 v[52:55], v13 offset:63488
    v_mul_f32 v234, v234, v250
    v_mfma_f32_16x16x32_bf16 v[88:91], a[216:219], v[60:63], v[88:91]
    v_mul_f32 v235, v235, v251
    v_mul_f32 v236, v236, v252
    v_mfma_f32_16x16x32_bf16 v[92:95], a[220:223], v[60:63], v[92:95]
    v_mul_f32 v237, v237, v253
    s_waitcnt lgkmcnt(4)
    v_mfma_f32_16x16x32_bf16 v[80:83], a[224:227], v[32:35], v[80:83]
    ds_read_b128 v[56:59], v15 offset:61440
    v_mul_f32 v238, v238, v254
    v_mfma_f32_16x16x32_bf16 v[84:87], a[228:231], v[32:35], v[84:87]
    ds_read_b128 v[60:63], v15 offset:63488
    v_mul_f32 v239, v239, v255
    v_mfma_f32_16x16x32_bf16 v[88:91], a[224:227], v[36:39], v[88:91]
    v_cvt_pk_bf16_f32 v240, v224, v225
    v_cvt_pk_bf16_f32 v241, v226, v227
    v_mfma_f32_16x16x32_bf16 v[92:95], a[228:231], v[36:39], v[92:95]
    v_cvt_pk_bf16_f32 v242, v228, v229
    s_waitcnt lgkmcnt(4)
    v_mfma_f32_16x16x32_bf16 v[80:83], a[232:235], v[40:43], v[80:83]
    v_cvt_pk_bf16_f32 v243, v230, v231
    v_cvt_pk_bf16_f32 v244, v232, v233
    v_mfma_f32_16x16x32_bf16 v[84:87], a[236:239], v[40:43], v[84:87]
    v_cvt_pk_bf16_f32 v245, v234, v235
    v_cvt_pk_bf16_f32 v246, v236, v237
    v_mfma_f32_16x16x32_bf16 v[88:91], a[232:235], v[44:47], v[88:91]
    v_cvt_pk_bf16_f32 v247, v238, v239
    buffer_store_dwordx4 v[240:243], v10, s[12:15], s76 offen sc1
    v_mfma_f32_16x16x32_bf16 v[92:95], a[236:239], v[44:47], v[92:95]
    buffer_store_dwordx4 v[244:247], v10, s[12:15], s76 offen offset:1024 sc1
    s_waitcnt vmcnt(16) lgkmcnt(0)
    s_barrier
    v_mfma_f32_16x16x32_bf16 v[80:83], a[240:243], v[48:51], v[80:83]
    ds_read_b128 v[32:35], v14 offset:0
    v_mfma_f32_16x16x32_bf16 v[84:87], a[244:247], v[48:51], v[84:87]
    ds_read_b128 v[36:39], v14 offset:2048
    v_mfma_f32_16x16x32_bf16 v[88:91], a[240:243], v[52:55], v[88:91]
    v_mfma_f32_16x16x32_bf16 v[92:95], a[244:247], v[52:55], v[92:95]
    v_mfma_f32_16x16x32_bf16 v[80:83], a[248:251], v[56:59], v[80:83]
    ds_read_b128 v[40:43], v16 offset:0
    v_mfma_f32_16x16x32_bf16 v[84:87], a[252:255], v[56:59], v[84:87]
    ds_read_b128 v[44:47], v16 offset:2048
    v_mfma_f32_16x16x32_bf16 v[88:91], a[248:251], v[60:63], v[88:91]
    v_mfma_f32_16x16x32_bf16 v[92:95], a[252:255], v[60:63], v[92:95]
    s_add_u32 s53, s53, 65536
    s_add_u32 s58, s58, 1
    v_swap_b32 v13, v14
    s_xor_b32 s54, s54, 65536
    s_xor_b32 s55, s55, 65536
    s_mov_b32 s76, s57
    v_swap_b32 v15, v16
    s_add_u32 s57, s57, 229376
    v_pk_add_f32 v[224:225], v[80:81], v[96:97]
    v_pk_add_f32 v[226:227], v[82:83], v[98:99]
    v_pk_add_f32 v[228:229], v[84:85], v[100:101]
    v_pk_add_f32 v[230:231], v[86:87], v[102:103]
    v_pk_add_f32 v[232:233], v[88:89], v[96:97]
    v_pk_add_f32 v[234:235], v[90:91], v[98:99]
    v_pk_add_f32 v[236:237], v[92:93], v[100:101]
    v_pk_add_f32 v[238:239], v[94:95], v[102:103]
    s_cmp_lt_u32 s58, s51
    s_cbranch_scc1 L_e_loop_166
    s_branch L_e_fin_168
L_e_one_167:
    s_waitcnt vmcnt(8)
    s_barrier
    ds_read_b128 v[32:35], v13 offset:0
    ds_read_b128 v[36:39], v13 offset:2048
    ds_read_b128 v[40:43], v15 offset:0
    ds_read_b128 v[44:47], v15 offset:2048
    s_waitcnt lgkmcnt(2)
    v_mfma_f32_16x16x32_bf16 v[80:83], a[0:3], v[32:35], 0
    ds_read_b128 v[48:51], v13 offset:4096
    v_mfma_f32_16x16x32_bf16 v[84:87], a[4:7], v[32:35], 0
    ds_read_b128 v[52:55], v13 offset:6144
    v_mfma_f32_16x16x32_bf16 v[88:91], a[0:3], v[36:39], 0
    ds_read_b128 v[56:59], v15 offset:4096
    v_mfma_f32_16x16x32_bf16 v[92:95], a[4:7], v[36:39], 0
    ds_read_b128 v[60:63], v15 offset:6144
    s_waitcnt lgkmcnt(4)
    v_mfma_f32_16x16x32_bf16 v[80:83], a[8:11], v[40:43], v[80:83]
    ds_read_b128 v[32:35], v13 offset:8192
    v_mfma_f32_16x16x32_bf16 v[84:87], a[12:15], v[40:43], v[84:87]
    ds_read_b128 v[36:39], v13 offset:10240
    v_mfma_f32_16x16x32_bf16 v[88:91], a[8:11], v[44:47], v[88:91]
    v_mfma_f32_16x16x32_bf16 v[92:95], a[12:15], v[44:47], v[92:95]
    s_waitcnt lgkmcnt(4)
    v_mfma_f32_16x16x32_bf16 v[80:83], a[16:19], v[48:51], v[80:83]
    ds_read_b128 v[40:43], v15 offset:8192
    v_mfma_f32_16x16x32_bf16 v[84:87], a[20:23], v[48:51], v[84:87]
    ds_read_b128 v[44:47], v15 offset:10240
    v_mfma_f32_16x16x32_bf16 v[88:91], a[16:19], v[52:55], v[88:91]
    v_mfma_f32_16x16x32_bf16 v[92:95], a[20:23], v[52:55], v[92:95]
    s_waitcnt lgkmcnt(4)
    v_mfma_f32_16x16x32_bf16 v[80:83], a[24:27], v[56:59], v[80:83]
    ds_read_b128 v[48:51], v13 offset:12288
    v_mfma_f32_16x16x32_bf16 v[84:87], a[28:31], v[56:59], v[84:87]
    ds_read_b128 v[52:55], v13 offset:14336
    v_mfma_f32_16x16x32_bf16 v[88:91], a[24:27], v[60:63], v[88:91]
    v_mfma_f32_16x16x32_bf16 v[92:95], a[28:31], v[60:63], v[92:95]
    s_waitcnt lgkmcnt(4)
    v_mfma_f32_16x16x32_bf16 v[80:83], a[32:35], v[32:35], v[80:83]
    ds_read_b128 v[56:59], v15 offset:12288
    v_mfma_f32_16x16x32_bf16 v[84:87], a[36:39], v[32:35], v[84:87]
    ds_read_b128 v[60:63], v15 offset:14336
    v_mfma_f32_16x16x32_bf16 v[88:91], a[32:35], v[36:39], v[88:91]
    v_mfma_f32_16x16x32_bf16 v[92:95], a[36:39], v[36:39], v[92:95]
    s_waitcnt lgkmcnt(4)
    v_mfma_f32_16x16x32_bf16 v[80:83], a[40:43], v[40:43], v[80:83]
    ds_read_b128 v[32:35], v13 offset:16384
    v_mfma_f32_16x16x32_bf16 v[84:87], a[44:47], v[40:43], v[84:87]
    ds_read_b128 v[36:39], v13 offset:18432
    v_mfma_f32_16x16x32_bf16 v[88:91], a[40:43], v[44:47], v[88:91]
    v_mfma_f32_16x16x32_bf16 v[92:95], a[44:47], v[44:47], v[92:95]
    s_waitcnt lgkmcnt(4)
    v_mfma_f32_16x16x32_bf16 v[80:83], a[48:51], v[48:51], v[80:83]
    ds_read_b128 v[40:43], v15 offset:16384
    v_mfma_f32_16x16x32_bf16 v[84:87], a[52:55], v[48:51], v[84:87]
    ds_read_b128 v[44:47], v15 offset:18432
    v_mfma_f32_16x16x32_bf16 v[88:91], a[48:51], v[52:55], v[88:91]
    v_mfma_f32_16x16x32_bf16 v[92:95], a[52:55], v[52:55], v[92:95]
    s_waitcnt lgkmcnt(4)
    v_mfma_f32_16x16x32_bf16 v[80:83], a[56:59], v[56:59], v[80:83]
    ds_read_b128 v[48:51], v13 offset:20480
    v_mfma_f32_16x16x32_bf16 v[84:87], a[60:63], v[56:59], v[84:87]
    ds_read_b128 v[52:55], v13 offset:22528
    v_mfma_f32_16x16x32_bf16 v[88:91], a[56:59], v[60:63], v[88:91]
    v_mfma_f32_16x16x32_bf16 v[92:95], a[60:63], v[60:63], v[92:95]
    s_waitcnt lgkmcnt(4)
    v_mfma_f32_16x16x32_bf16 v[80:83], a[64:67], v[32:35], v[80:83]
    ds_read_b128 v[56:59], v15 offset:20480
    v_mfma_f32_16x16x32_bf16 v[84:87], a[68:71], v[32:35], v[84:87]
    ds_read_b128 v[60:63], v15 offset:22528
    v_mfma_f32_16x16x32_bf16 v[88:91], a[64:67], v[36:39], v[88:91]
    v_mfma_f32_16x16x32_bf16 v[92:95], a[68:71], v[36:39], v[92:95]
    s_waitcnt lgkmcnt(4)
    v_mfma_f32_16x16x32_bf16 v[80:83], a[72:75], v[40:43], v[80:83]
    ds_read_b128 v[32:35], v13 offset:24576
    v_mfma_f32_16x16x32_bf16 v[84:87], a[76:79], v[40:43], v[84:87]
    ds_read_b128 v[36:39], v13 offset:26624
    v_mfma_f32_16x16x32_bf16 v[88:91], a[72:75], v[44:47], v[88:91]
    v_mfma_f32_16x16x32_bf16 v[92:95], a[76:79], v[44:47], v[92:95]
    s_waitcnt lgkmcnt(4)
    v_mfma_f32_16x16x32_bf16 v[80:83], a[80:83], v[48:51], v[80:83]
    ds_read_b128 v[40:43], v15 offset:24576
    v_mfma_f32_16x16x32_bf16 v[84:87], a[84:87], v[48:51], v[84:87]
    ds_read_b128 v[44:47], v15 offset:26624
    v_mfma_f32_16x16x32_bf16 v[88:91], a[80:83], v[52:55], v[88:91]
    v_mfma_f32_16x16x32_bf16 v[92:95], a[84:87], v[52:55], v[92:95]
    s_waitcnt lgkmcnt(4)
    v_mfma_f32_16x16x32_bf16 v[80:83], a[88:91], v[56:59], v[80:83]
    ds_read_b128 v[48:51], v13 offset:28672
    v_mfma_f32_16x16x32_bf16 v[84:87], a[92:95], v[56:59], v[84:87]
    ds_read_b128 v[52:55], v13 offset:30720
    v_mfma_f32_16x16x32_bf16 v[88:91], a[88:91], v[60:63], v[88:91]
    v_mfma_f32_16x16x32_bf16 v[92:95], a[92:95], v[60:63], v[92:95]
    s_waitcnt lgkmcnt(4)
    v_mfma_f32_16x16x32_bf16 v[80:83], a[96:99], v[32:35], v[80:83]
    ds_read_b128 v[56:59], v15 offset:28672
    v_mfma_f32_16x16x32_bf16 v[84:87], a[100:103], v[32:35], v[84:87]
    ds_read_b128 v[60:63], v15 offset:30720
    v_mfma_f32_16x16x32_bf16 v[88:91], a[96:99], v[36:39], v[88:91]
    v_mfma_f32_16x16x32_bf16 v[92:95], a[100:103], v[36:39], v[92:95]
    s_waitcnt lgkmcnt(4)
    v_mfma_f32_16x16x32_bf16 v[80:83], a[104:107], v[40:43], v[80:83]
    v_mfma_f32_16x16x32_bf16 v[84:87], a[108:111], v[40:43], v[84:87]
    v_mfma_f32_16x16x32_bf16 v[88:91], a[104:107], v[44:47], v[88:91]
    v_mfma_f32_16x16x32_bf16 v[92:95], a[108:111], v[44:47], v[92:95]
    s_waitcnt vmcnt(0) lgkmcnt(0)
    s_barrier
    v_mfma_f32_16x16x32_bf16 v[80:83], a[112:115], v[48:51], v[80:83]
    ds_read_b128 v[32:35], v13 offset:32768
    v_mfma_f32_16x16x32_bf16 v[84:87], a[116:119], v[48:51], v[84:87]
    ds_read_b128 v[36:39], v13 offset:34816
    v_mfma_f32_16x16x32_bf16 v[88:91], a[112:115], v[52:55], v[88:91]
    v_mfma_f32_16x16x32_bf16 v[92:95], a[116:119], v[52:55], v[92:95]
    v_mfma_f32_16x16x32_bf16 v[80:83], a[120:123], v[56:59], v[80:83]
    ds_read_b128 v[40:43], v15 offset:32768
    v_mfma_f32_16x16x32_bf16 v[84:87], a[124:127], v[56:59], v[84:87]
    ds_read_b128 v[44:47], v15 offset:34816
    v_mfma_f32_16x16x32_bf16 v[88:91], a[120:123], v[60:63], v[88:91]
    v_mfma_f32_16x16x32_bf16 v[92:95], a[124:127], v[60:63], v[92:95]
    s_waitcnt lgkmcnt(2)
    v_mfma_f32_16x16x32_bf16 v[80:83], a[128:131], v[32:35], v[80:83]
    ds_read_b128 v[48:51], v13 offset:36864
    v_mfma_f32_16x16x32_bf16 v[84:87], a[132:135], v[32:35], v[84:87]
    ds_read_b128 v[52:55], v13 offset:38912
    v_mfma_f32_16x16x32_bf16 v[88:91], a[128:131], v[36:39], v[88:91]
    ds_read_b128 v[56:59], v15 offset:36864
    v_mfma_f32_16x16x32_bf16 v[92:95], a[132:135], v[36:39], v[92:95]
    ds_read_b128 v[60:63], v15 offset:38912
    s_waitcnt lgkmcnt(4)
    v_mfma_f32_16x16x32_bf16 v[80:83], a[136:139], v[40:43], v[80:83]
    ds_read_b128 v[32:35], v13 offset:40960
    v_mfma_f32_16x16x32_bf16 v[84:87], a[140:143], v[40:43], v[84:87]
    ds_read_b128 v[36:39], v13 offset:43008
    v_mfma_f32_16x16x32_bf16 v[88:91], a[136:139], v[44:47], v[88:91]
    v_mfma_f32_16x16x32_bf16 v[92:95], a[140:143], v[44:47], v[92:95]
    s_waitcnt lgkmcnt(4)
    v_mfma_f32_16x16x32_bf16 v[80:83], a[144:147], v[48:51], v[80:83]
    ds_read_b128 v[40:43], v15 offset:40960
    v_mfma_f32_16x16x32_bf16 v[84:87], a[148:151], v[48:51], v[84:87]
    ds_read_b128 v[44:47], v15 offset:43008
    v_mfma_f32_16x16x32_bf16 v[88:91], a[144:147], v[52:55], v[88:91]
    v_mfma_f32_16x16x32_bf16 v[92:95], a[148:151], v[52:55], v[92:95]
    s_waitcnt lgkmcnt(4)
    v_mfma_f32_16x16x32_bf16 v[80:83], a[152:155], v[56:59], v[80:83]
    ds_read_b128 v[48:51], v13 offset:45056
    v_mfma_f32_16x16x32_bf16 v[84:87], a[156:159], v[56:59], v[84:87]
    ds_read_b128 v[52:55], v13 offset:47104
    v_mfma_f32_16x16x32_bf16 v[88:91], a[152:155], v[60:63], v[88:91]
    v_mfma_f32_16x16x32_bf16 v[92:95], a[156:159], v[60:63], v[92:95]
    s_waitcnt lgkmcnt(4)
    v_mfma_f32_16x16x32_bf16 v[80:83], a[160:163], v[32:35], v[80:83]
    ds_read_b128 v[56:59], v15 offset:45056
    v_mfma_f32_16x16x32_bf16 v[84:87], a[164:167], v[32:35], v[84:87]
    ds_read_b128 v[60:63], v15 offset:47104
    v_mfma_f32_16x16x32_bf16 v[88:91], a[160:163], v[36:39], v[88:91]
    v_mfma_f32_16x16x32_bf16 v[92:95], a[164:167], v[36:39], v[92:95]
    s_waitcnt lgkmcnt(4)
    v_mfma_f32_16x16x32_bf16 v[80:83], a[168:171], v[40:43], v[80:83]
    ds_read_b128 v[32:35], v13 offset:49152
    v_mfma_f32_16x16x32_bf16 v[84:87], a[172:175], v[40:43], v[84:87]
    ds_read_b128 v[36:39], v13 offset:51200
    v_mfma_f32_16x16x32_bf16 v[88:91], a[168:171], v[44:47], v[88:91]
    v_mfma_f32_16x16x32_bf16 v[92:95], a[172:175], v[44:47], v[92:95]
    s_waitcnt lgkmcnt(4)
    v_mfma_f32_16x16x32_bf16 v[80:83], a[176:179], v[48:51], v[80:83]
    ds_read_b128 v[40:43], v15 offset:49152
    v_mfma_f32_16x16x32_bf16 v[84:87], a[180:183], v[48:51], v[84:87]
    ds_read_b128 v[44:47], v15 offset:51200
    v_mfma_f32_16x16x32_bf16 v[88:91], a[176:179], v[52:55], v[88:91]
    v_mfma_f32_16x16x32_bf16 v[92:95], a[180:183], v[52:55], v[92:95]
    s_waitcnt lgkmcnt(4)
    v_mfma_f32_16x16x32_bf16 v[80:83], a[184:187], v[56:59], v[80:83]
    ds_read_b128 v[48:51], v13 offset:53248
    v_mfma_f32_16x16x32_bf16 v[84:87], a[188:191], v[56:59], v[84:87]
    ds_read_b128 v[52:55], v13 offset:55296
    v_mfma_f32_16x16x32_bf16 v[88:91], a[184:187], v[60:63], v[88:91]
    v_mfma_f32_16x16x32_bf16 v[92:95], a[188:191], v[60:63], v[92:95]
    s_waitcnt lgkmcnt(4)
    v_mfma_f32_16x16x32_bf16 v[80:83], a[192:195], v[32:35], v[80:83]
    ds_read_b128 v[56:59], v15 offset:53248
    v_mfma_f32_16x16x32_bf16 v[84:87], a[196:199], v[32:35], v[84:87]
    ds_read_b128 v[60:63], v15 offset:55296
    v_mfma_f32_16x16x32_bf16 v[88:91], a[192:195], v[36:39], v[88:91]
    v_mfma_f32_16x16x32_bf16 v[92:95], a[196:199], v[36:39], v[92:95]
    s_waitcnt lgkmcnt(4)
    v_mfma_f32_16x16x32_bf16 v[80:83], a[200:203], v[40:43], v[80:83]
    ds_read_b128 v[32:35], v13 offset:57344
    v_mfma_f32_16x16x32_bf16 v[84:87], a[204:207], v[40:43], v[84:87]
    ds_read_b128 v[36:39], v13 offset:59392
    v_mfma_f32_16x16x32_bf16 v[88:91], a[200:203], v[44:47], v[88:91]
    v_mfma_f32_16x16x32_bf16 v[92:95], a[204:207], v[44:47], v[92:95]
    s_waitcnt lgkmcnt(4)
    v_mfma_f32_16x16x32_bf16 v[80:83], a[208:211], v[48:51], v[80:83]
    ds_read_b128 v[40:43], v15 offset:57344
    v_mfma_f32_16x16x32_bf16 v[84:87], a[212:215], v[48:51], v[84:87]
    ds_read_b128 v[44:47], v15 offset:59392
    v_mfma_f32_16x16x32_bf16 v[88:91], a[208:211], v[52:55], v[88:91]
    v_mfma_f32_16x16x32_bf16 v[92:95], a[212:215], v[52:55], v[92:95]
    s_waitcnt lgkmcnt(4)
    v_mfma_f32_16x16x32_bf16 v[80:83], a[216:219], v[56:59], v[80:83]
    ds_read_b128 v[48:51], v13 offset:61440
    v_mfma_f32_16x16x32_bf16 v[84:87], a[220:223], v[56:59], v[84:87]
    ds_read_b128 v[52:55], v13 offset:63488
    v_mfma_f32_16x16x32_bf16 v[88:91], a[216:219], v[60:63], v[88:91]
    v_mfma_f32_16x16x32_bf16 v[92:95], a[220:223], v[60:63], v[92:95]
    s_waitcnt lgkmcnt(4)
    v_mfma_f32_16x16x32_bf16 v[80:83], a[224:227], v[32:35], v[80:83]
    ds_read_b128 v[56:59], v15 offset:61440
    v_mfma_f32_16x16x32_bf16 v[84:87], a[228:231], v[32:35], v[84:87]
    ds_read_b128 v[60:63], v15 offset:63488
    v_mfma_f32_16x16x32_bf16 v[88:91], a[224:227], v[36:39], v[88:91]
    v_mfma_f32_16x16x32_bf16 v[92:95], a[228:231], v[36:39], v[92:95]
    s_waitcnt lgkmcnt(4)
    v_mfma_f32_16x16x32_bf16 v[80:83], a[232:235], v[40:43], v[80:83]
    v_mfma_f32_16x16x32_bf16 v[84:87], a[236:239], v[40:43], v[84:87]
    v_mfma_f32_16x16x32_bf16 v[88:91], a[232:235], v[44:47], v[88:91]
    v_mfma_f32_16x16x32_bf16 v[92:95], a[236:239], v[44:47], v[92:95]
    s_waitcnt lgkmcnt(0)
    v_mfma_f32_16x16x32_bf16 v[80:83], a[240:243], v[48:51], v[80:83]
    v_mfma_f32_16x16x32_bf16 v[84:87], a[244:247], v[48:51], v[84:87]
    v_mfma_f32_16x16x32_bf16 v[88:91], a[240:243], v[52:55], v[88:91]
    v_mfma_f32_16x16x32_bf16 v[92:95], a[244:247], v[52:55], v[92:95]
    v_mfma_f32_16x16x32_bf16 v[80:83], a[248:251], v[56:59], v[80:83]
    v_mfma_f32_16x16x32_bf16 v[84:87], a[252:255], v[56:59], v[84:87]
    v_mfma_f32_16x16x32_bf16 v[88:91], a[248:251], v[60:63], v[88:91]
    v_mfma_f32_16x16x32_bf16 v[92:95], a[252:255], v[60:63], v[92:95]
    s_mov_b32 s76, s57
    s_nop 6
    v_pk_add_f32 v[224:225], v[80:81], v[96:97]
    v_pk_add_f32 v[226:227], v[82:83], v[98:99]
    v_pk_add_f32 v[228:229], v[84:85], v[100:101]
    v_pk_add_f32 v[230:231], v[86:87], v[102:103]
    v_pk_add_f32 v[232:233], v[88:89], v[96:97]
    v_pk_add_f32 v[234:235], v[90:91], v[98:99]
    v_pk_add_f32 v[236:237], v[92:93], v[100:101]
    v_pk_add_f32 v[238:239], v[94:95], v[102:103]
L_e_fin_168:
    v_pk_mul_f32 v[240:241], v[224:225], v[224:225]
    v_pk_mul_f32 v[242:243], v[226:227], v[226:227]
    v_pk_mul_f32 v[244:245], v[228:229], v[228:229]
    v_pk_mul_f32 v[246:247], v[230:231], v[230:231]
    v_pk_mul_f32 v[248:249], v[232:233], v[232:233]
    v_pk_mul_f32 v[250:251], v[234:235], v[234:235]
    v_pk_mul_f32 v[252:253], v[236:237], v[236:237]
    v_pk_mul_f32 v[254:255], v[238:239], v[238:239]
    v_pk_fma_f32 v[240:241], v[240:241], v[104:105], v[106:107]
    v_pk_fma_f32 v[242:243], v[242:243], v[104:105], v[106:107]
    v_pk_fma_f32 v[244:245], v[244:245], v[104:105], v[106:107]
    v_pk_fma_f32 v[246:247], v[246:247], v[104:105], v[106:107]
    v_pk_fma_f32 v[248:249], v[248:249], v[104:105], v[106:107]
    v_pk_fma_f32 v[250:251], v[250:251], v[104:105], v[106:107]
    v_pk_fma_f32 v[252:253], v[252:253], v[104:105], v[106:107]
    v_pk_fma_f32 v[254:255], v[254:255], v[104:105], v[106:107]
    v_pk_mul_f32 v[240:241], v[240:241], v[224:225]
    v_pk_mul_f32 v[242:243], v[242:243], v[226:227]
    v_pk_mul_f32 v[244:245], v[244:245], v[228:229]
    v_pk_mul_f32 v[246:247], v[246:247], v[230:231]
    v_pk_mul_f32 v[248:249], v[248:249], v[232:233]
    v_pk_mul_f32 v[250:251], v[250:251], v[234:235]
    v_pk_mul_f32 v[252:253], v[252:253], v[236:237]
    v_pk_mul_f32 v[254:255], v[254:255], v[238:239]
    v_exp_f32 v240, v240
    v_exp_f32 v241, v241
    v_exp_f32 v242, v242
    v_exp_f32 v243, v243
    v_exp_f32 v244, v244
    v_exp_f32 v245, v245
    v_exp_f32 v246, v246
    v_exp_f32 v247, v247
    v_exp_f32 v248, v248
    v_exp_f32 v249, v249
    v_exp_f32 v250, v250
    v_exp_f32 v251, v251
    v_exp_f32 v252, v252
    v_exp_f32 v253, v253
    v_exp_f32 v254, v254
    v_exp_f32 v255, v255
    v_add_f32 v240, 1.0, v240
    v_add_f32 v241, 1.0, v241
    v_add_f32 v242, 1.0, v242
    v_add_f32 v243, 1.0, v243
    v_add_f32 v244, 1.0, v244
    v_add_f32 v245, 1.0, v245
    v_add_f32 v246, 1.0, v246
    v_add_f32 v247, 1.0, v247
    v_add_f32 v248, 1.0, v248
    v_add_f32 v249, 1.0, v249
    v_add_f32 v250, 1.0, v250
    v_add_f32 v251, 1.0, v251
    v_add_f32 v252, 1.0, v252
    v_add_f32 v253, 1.0, v253
    v_add_f32 v254, 1.0, v254
    v_add_f32 v255, 1.0, v255
    v_rcp_f32 v240, v240
    v_rcp_f32 v241, v241
    v_rcp_f32 v242, v242
    v_rcp_f32 v243, v243
    v_rcp_f32 v244, v244
    v_rcp_f32 v245, v245
    v_rcp_f32 v246, v246
    v_rcp_f32 v247, v247
    v_rcp_f32 v248, v248
    v_rcp_f32 v249, v249
    v_rcp_f32 v250, v250
    v_rcp_f32 v251, v251
    v_rcp_f32 v252, v252
    v_rcp_f32 v253, v253
    v_rcp_f32 v254, v254
    v_rcp_f32 v255, v255
    v_pk_mul_f32 v[224:225], v[224:225], v[240:241]
    v_pk_mul_f32 v[226:227], v[226:227], v[242:243]
    v_pk_mul_f32 v[228:229], v[228:229], v[244:245]
    v_pk_mul_f32 v[230:231], v[230:231], v[246:247]
    v_pk_mul_f32 v[232:233], v[232:233], v[248:249]
    v_pk_mul_f32 v[234:235], v[234:235], v[250:251]
    v_pk_mul_f32 v[236:237], v[236:237], v[252:253]
    v_pk_mul_f32 v[238:239], v[238:239], v[254:255]
    v_cvt_pk_bf16_f32 v240, v224, v225
    v_cvt_pk_bf16_f32 v241, v226, v227
    v_cvt_pk_bf16_f32 v242, v228, v229
    v_cvt_pk_bf16_f32 v243, v230, v231
    v_cvt_pk_bf16_f32 v244, v232, v233
    v_cvt_pk_bf16_f32 v245, v234, v235
    v_cvt_pk_bf16_f32 v246, v236, v237
    v_cvt_pk_bf16_f32 v247, v238, v239
    buffer_store_dwordx4 v[240:243], v10, s[12:15], s76 offen sc1
    buffer_store_dwordx4 v[244:247], v10, s[12:15], s76 offen offset:1024 sc1
    s_waitcnt lgkmcnt(0)
    s_mov_b32 s92, s62
    s_branch L_b_loop_151
L_role_c_127:
    s_load_dwordx2 s[6:7], s[0:1], 80
    s_load_dwordx2 s[8:9], s[0:1], 88
    s_load_dwordx2 s[10:11], s[0:1], 112
    s_waitcnt lgkmcnt(0)
    s_mov_b32 s24, s6
    s_and_b32 s25, s7, 0xffff
    s_mov_b32 s26, 0x700000
    s_mov_b32 s27, 0x00020000
    s_mov_b32 s28, s8
    s_and_b32 s29, s9, 0xffff
    s_mov_b32 s30, 0x800
    s_mov_b32 s31, 0x00020000
    s_mov_b32 s32, s10
    s_and_b32 s33, s11, 0xffff
    s_mov_b32 s34, 0x400000
    s_mov_b32 s35, 0x00020000
    s_mul_i32 s46, s38, 1835008
    s_lshl_b32 s45, s68, 8
    s_add_u32 s46, s46, s45
    s_waitcnt vmcnt(0)
    s_barrier
    v_lshrrev_b32 v20, 4, v1
    s_lshl_b32 s45, s44, 2
    v_add_u32 v21, s45, v20
    s_mov_b32 s45, 2048
    v_mul_lo_u32 v21, v21, s45
    v_lshlrev_b32 v22, 2, v20
    v_and_b32 v23, 15, v1
    v_xor_b32 v22, v22, v23
    v_lshlrev_b32 v22, 4, v22
    v_add_u32 v21, v21, v22
    v_bfe_u32 v22, v1, 2, 2
    v_lshlrev_b32 v23, 3, v20
    v_add_u32 v23, v23, v22
    v_lshlrev_b32 v23, 8, v23
    v_xor_b32 v22, s44, v22
    v_lshlrev_b32 v22, 6, v22
    v_add_u32 v23, v23, v22
    v_and_b32 v22, 3, v1
    v_lshlrev_b32 v22, 3, v22
    v_add_u32 v23, v23, v22
    v_add_u32 v24, 65536, v23
    v_add_u32 v25, 131072, v23
    s_lshl_b32 s47, s44, 10
    s_add_u32 s45, s46, 0x0
    s_add_u32 m0, s47, 0
    s_nop 0
    buffer_load_dwordx4 v21, s[24:27], s45 offen  lds
    s_add_u32 s45, s46, 0x8000
    s_add_u32 m0, s47, 4096
    s_nop 0
    buffer_load_dwordx4 v21, s[24:27], s45 offen  lds
    s_add_u32 s45, s46, 0x10000
    s_add_u32 m0, s47, 8192
    s_nop 0
    buffer_load_dwordx4 v21, s[24:27], s45 offen  lds
    s_add_u32 s45, s46, 0x18000
    s_add_u32 m0, s47, 12288
    s_nop 0
    buffer_load_dwordx4 v21, s[24:27], s45 offen  lds
    s_add_u32 s45, s46, 0x20000
    s_add_u32 m0, s47, 16384
    s_nop 0
    buffer_load_dwordx4 v21, s[24:27], s45 offen  lds
    s_add_u32 s45, s46, 0x28000
    s_add_u32 m0, s47, 20480
    s_nop 0
    buffer_load_dwordx4 v21, s[24:27], s45 offen  lds
    s_add_u32 s45, s46, 0x30000
    s_add_u32 m0, s47, 24576
    s_nop 0
    buffer_load_dwordx4 v21, s[24:27], s45 offen  lds
    s_add_u32 s45, s46, 0x38000
    s_add_u32 m0, s47, 28672
    s_nop 0
    buffer_load_dwordx4 v21, s[24:27], s45 offen  lds
    s_add_u32 s45, s46, 0x40000
    s_add_u32 m0, s47, 32768
    s_nop 0
    buffer_load_dwordx4 v21, s[24:27], s45 offen  lds
    s_add_u32 s45, s46, 0x48000
    s_add_u32 m0, s47, 36864
    s_nop 0
    buffer_load_dwordx4 v21, s[24:27], s45 offen  lds
    s_add_u32 s45, s46, 0x50000
    s_add_u32 m0, s47, 40960
    s_nop 0
    buffer_load_dwordx4 v21, s[24:27], s45 offen  lds
    s_add_u32 s45, s46, 0x58000
    s_add_u32 m0, s47, 45056
    s_nop 0
    buffer_load_dwordx4 v21, s[24:27], s45 offen  lds
    s_add_u32 s45, s46, 0x60000
    s_add_u32 m0, s47, 49152
    s_nop 0
    buffer_load_dwordx4 v21, s[24:27], s45 offen  lds
    s_add_u32 s45, s46, 0x68000
    s_add_u32 m0, s47, 53248
    s_nop 0
    buffer_load_dwordx4 v21, s[24:27], s45 offen  lds
    s_add_u32 s45, s46, 0x70000
    s_add_u32 m0, s47, 57344
    s_nop 0
    buffer_load_dwordx4 v21, s[24:27], s45 offen  lds
    s_add_u32 s45, s46, 0x78000
    s_add_u32 m0, s47, 61440
    s_nop 0
    buffer_load_dwordx4 v21, s[24:27], s45 offen  lds
    s_add_u32 s45, s46, 0x80000
    s_add_u32 m0, s47, 65536
    s_nop 0
    buffer_load_dwordx4 v21, s[24:27], s45 offen  lds
    s_add_u32 s45, s46, 0x88000
    s_add_u32 m0, s47, 69632
    s_nop 0
    buffer_load_dwordx4 v21, s[24:27], s45 offen  lds
    s_add_u32 s45, s46, 0x90000
    s_add_u32 m0, s47, 73728
    s_nop 0
    buffer_load_dwordx4 v21, s[24:27], s45 offen  lds
    s_add_u32 s45, s46, 0x98000
    s_add_u32 m0, s47, 77824
    s_nop 0
    buffer_load_dwordx4 v21, s[24:27], s45 offen  lds
    s_add_u32 s45, s46, 0xa0000
    s_add_u32 m0, s47, 81920
    s_nop 0
    buffer_load_dwordx4 v21, s[24:27], s45 offen  lds
    s_add_u32 s45, s46, 0xa8000
    s_add_u32 m0, s47, 86016
    s_nop 0
    buffer_load_dwordx4 v21, s[24:27], s45 offen  lds
    s_add_u32 s45, s46, 0xb0000
    s_add_u32 m0, s47, 90112
    s_nop 0
    buffer_load_dwordx4 v21, s[24:27], s45 offen  lds
    s_add_u32 s45, s46, 0xb8000
    s_add_u32 m0, s47, 94208
    s_nop 0
    buffer_load_dwordx4 v21, s[24:27], s45 offen  lds
    s_add_u32 s45, s46, 0xc0000
    s_add_u32 m0, s47, 98304
    s_nop 0
    buffer_load_dwordx4 v21, s[24:27], s45 offen  lds
    s_add_u32 s45, s46, 0xc8000
    s_add_u32 m0, s47, 102400
    s_nop 0
    buffer_load_dwordx4 v21, s[24:27], s45 offen  lds
    s_add_u32 s45, s46, 0xd0000
    s_add_u32 m0, s47, 106496
    s_nop 0
    buffer_load_dwordx4 v21, s[24:27], s45 offen  lds
    s_add_u32 s45, s46, 0xd8000
    s_add_u32 m0, s47, 110592
    s_nop 0
    buffer_load_dwordx4 v21, s[24:27], s45 offen  lds
    s_add_u32 s45, s46, 0xe0000
    s_add_u32 m0, s47, 114688
    s_nop 0
    buffer_load_dwordx4 v21, s[24:27], s45 offen  lds
    s_add_u32 s45, s46, 0xe8000
    s_add_u32 m0, s47, 118784
    s_nop 0
    buffer_load_dwordx4 v21, s[24:27], s45 offen  lds
    s_add_u32 s45, s46, 0xf0000
    s_add_u32 m0, s47, 122880
    s_nop 0
    buffer_load_dwordx4 v21, s[24:27], s45 offen  lds
    s_add_u32 s45, s46, 0xf8000
    s_add_u32 m0, s47, 126976
    s_nop 0
    buffer_load_dwordx4 v21, s[24:27], s45 offen  lds
    s_waitcnt vmcnt(28)
    s_barrier
    s_add_u32 s45, s46, 0x100000
    s_add_u32 m0, s47, 131072
    s_nop 0
    buffer_load_dwordx4 v21, s[24:27], s45 offen  lds
    s_add_u32 s45, s46, 0x108000
    s_add_u32 m0, s47, 135168
    s_nop 0
    buffer_load_dwordx4 v21, s[24:27], s45 offen  lds
    s_add_u32 s45, s46, 0x110000
    s_add_u32 m0, s47, 139264
    s_nop 0
    buffer_load_dwordx4 v21, s[24:27], s45 offen  lds
    s_add_u32 s45, s46, 0x118000
    s_add_u32 m0, s47, 143360
    s_nop 0
    buffer_load_dwordx4 v21, s[24:27], s45 offen  lds
    ds_read_b64_tr_b16 a[0:1], v23 offset:0
    ds_read_b64_tr_b16 a[2:3], v23 offset:1024
    ds_read_b64_tr_b16 a[4:5], v23 offset:32
    ds_read_b64_tr_b16 a[6:7], v23 offset:1056
    ds_read_b64_tr_b16 a[8:9], v23 offset:8192
    ds_read_b64_tr_b16 a[10:11], v23 offset:9216
    ds_read_b64_tr_b16 a[12:13], v23 offset:8224
    ds_read_b64_tr_b16 a[14:15], v23 offset:9248
    s_waitcnt lgkmcnt(0)
    s_waitcnt vmcnt(28)
    s_barrier
    s_add_u32 s45, s46, 0x120000
    s_add_u32 m0, s47, 0
    s_nop 0
    buffer_load_dwordx4 v21, s[24:27], s45 offen  lds
    s_add_u32 s45, s46, 0x128000
    s_add_u32 m0, s47, 4096
    s_nop 0
    buffer_load_dwordx4 v21, s[24:27], s45 offen  lds
    s_add_u32 s45, s46, 0x130000
    s_add_u32 m0, s47, 8192
    s_nop 0
    buffer_load_dwordx4 v21, s[24:27], s45 offen  lds
    s_add_u32 s45, s46, 0x138000
    s_add_u32 m0, s47, 12288
    s_nop 0
    buffer_load_dwordx4 v21, s[24:27], s45 offen  lds
    ds_read_b64_tr_b16 a[16:17], v23 offset:16384
    ds_read_b64_tr_b16 a[18:19], v23 offset:17408
    ds_read_b64_tr_b16 a[20:21], v23 offset:16416
    ds_read_b64_tr_b16 a[22:23], v23 offset:17440
    ds_read_b64_tr_b16 a[24:25], v23 offset:24576
    ds_read_b64_tr_b16 a[26:27], v23 offset:25600
    ds_read_b64_tr_b16 a[28:29], v23 offset:24608
    ds_read_b64_tr_b16 a[30:31], v23 offset:25632
    s_waitcnt lgkmcnt(0)
    s_waitcnt vmcnt(28)
    s_barrier
    s_add_u32 s45, s46, 0x140000
    s_add_u32 m0, s47, 16384
    s_nop 0
    buffer_load_dwordx4 v21, s[24:27], s45 offen  lds
    s_add_u32 s45, s46, 0x148000
    s_add_u32 m0, s47, 20480
    s_nop 0
    buffer_load_dwordx4 v21, s[24:27], s45 offen  lds
    s_add_u32 s45, s46, 0x150000
    s_add_u32 m0, s47, 24576
    s_nop 0
    buffer_load_dwordx4 v21, s[24:27], s45 offen  lds
    s_add_u32 s45, s46, 0x158000
    s_add_u32 m0, s47, 28672
    s_nop 0
    buffer_load_dwordx4 v21, s[24:27], s45 offen  lds
    ds_read_b64_tr_b16 a[32:33], v23 offset:32768
    ds_read_b64_tr_b16 a[34:35], v23 offset:33792
    ds_read_b64_tr_b16 a[36:37], v23 offset:32800
    ds_read_b64_tr_b16 a[38:39], v23 offset:33824
    ds_read_b64_tr_b16 a[40:41], v23 offset:40960
    ds_read_b64_tr_b16 a[42:43], v23 offset:41984
    ds_read_b64_tr_b16 a[44:45], v23 offset:40992
    ds_read_b64_tr_b16 a[46:47], v23 offset:42016
    s_waitcnt lgkmcnt(0)
    s_waitcnt vmcnt(28)
    s_barrier
    s_add_u32 s45, s46, 0x160000
    s_add_u32 m0, s47, 32768
    s_nop 0
    buffer_load_dwordx4 v21, s[24:27], s45 offen  lds
    s_add_u32 s45, s46, 0x168000
    s_add_u32 m0, s47, 36864
    s_nop 0
    buffer_load_dwordx4 v21, s[24:27], s45 offen  lds
    s_add_u32 s45, s46, 0x170000
    s_add_u32 m0, s47, 40960
    s_nop 0
    buffer_load_dwordx4 v21, s[24:27], s45 offen  lds
    s_add_u32 s45, s46, 0x178000
    s_add_u32 m0, s47, 45056
    s_nop 0
    buffer_load_dwordx4 v21, s[24:27], s45 offen  lds
    ds_read_b64_tr_b16 a[48:49], v23 offset:49152
    ds_read_b64_tr_b16 a[50:51], v23 offset:50176
    ds_read_b64_tr_b16 a[52:53], v23 offset:49184
    ds_read_b64_tr_b16 a[54:55], v23 offset:50208
    ds_read_b64_tr_b16 a[56:57], v23 offset:57344
    ds_read_b64_tr_b16 a[58:59], v23 offset:58368
    ds_read_b64_tr_b16 a[60:61], v23 offset:57376
    ds_read_b64_tr_b16 a[62:63], v23 offset:58400
    s_waitcnt lgkmcnt(0)
    s_waitcnt vmcnt(28)
    s_barrier
    s_add_u32 s45, s46, 0x180000
    s_add_u32 m0, s47, 49152
    s_nop 0
    buffer_load_dwordx4 v21, s[24:27], s45 offen  lds
    s_add_u32 s45, s46, 0x188000
    s_add_u32 m0, s47, 53248
    s_nop 0
    buffer_load_dwordx4 v21, s[24:27], s45 offen  lds
    s_add_u32 s45, s46, 0x190000
    s_add_u32 m0, s47, 57344
    s_nop 0
    buffer_load_dwordx4 v21, s[24:27], s45 offen  lds
    s_add_u32 s45, s46, 0x198000
    s_add_u32 m0, s47, 61440
    s_nop 0
    buffer_load_dwordx4 v21, s[24:27], s45 offen  lds
    ds_read_b64_tr_b16 a[64:65], v24 offset:0
    ds_read_b64_tr_b16 a[66:67], v24 offset:1024
    ds_read_b64_tr_b16 a[68:69], v24 offset:32
    ds_read_b64_tr_b16 a[70:71], v24 offset:1056
    ds_read_b64_tr_b16 a[72:73], v24 offset:8192
    ds_read_b64_tr_b16 a[74:75], v24 offset:9216
    ds_read_b64_tr_b16 a[76:77], v24 offset:8224
    ds_read_b64_tr_b16 a[78:79], v24 offset:9248
    s_waitcnt lgkmcnt(0)
    s_waitcnt vmcnt(28)
    s_barrier
    s_add_u32 s45, s46, 0x1a0000
    s_add_u32 m0, s47, 65536
    s_nop 0
    buffer_load_dwordx4 v21, s[24:27], s45 offen  lds
    s_add_u32 s45, s46, 0x1a8000
    s_add_u32 m0, s47, 69632
    s_nop 0
    buffer_load_dwordx4 v21, s[24:27], s45 offen  lds
    s_add_u32 s45, s46, 0x1b0000
    s_add_u32 m0, s47, 73728
    s_nop 0
    buffer_load_dwordx4 v21, s[24:27], s45 offen  lds
    s_add_u32 s45, s46, 0x1b8000
    s_add_u32 m0, s47, 77824
    s_nop 0
    buffer_load_dwordx4 v21, s[24:27], s45 offen  lds
    ds_read_b64_tr_b16 a[80:81], v24 offset:16384
    ds_read_b64_tr_b16 a[82:83], v24 offset:17408
    ds_read_b64_tr_b16 a[84:85], v24 offset:16416
    ds_read_b64_tr_b16 a[86:87], v24 offset:17440
    ds_read_b64_tr_b16 a[88:89], v24 offset:24576
    ds_read_b64_tr_b16 a[90:91], v24 offset:25600
    ds_read_b64_tr_b16 a[92:93], v24 offset:24608
    ds_read_b64_tr_b16 a[94:95], v24 offset:25632
    s_waitcnt lgkmcnt(0)
    s_waitcnt vmcnt(28)
    s_barrier
    ds_read_b64_tr_b16 a[96:97], v24 offset:32768
    ds_read_b64_tr_b16 a[98:99], v24 offset:33792
    ds_read_b64_tr_b16 a[100:101], v24 offset:32800
    ds_read_b64_tr_b16 a[102:103], v24 offset:33824
    ds_read_b64_tr_b16 a[104:105], v24 offset:40960
    ds_read_b64_tr_b16 a[106:107], v24 offset:41984
    ds_read_b64_tr_b16 a[108:109], v24 offset:40992
    ds_read_b64_tr_b16 a[110:111], v24 offset:42016
    s_waitcnt lgkmcnt(0)
    s_waitcnt vmcnt(24)
    s_barrier
    ds_read_b64_tr_b16 a[112:113], v24 offset:49152
    ds_read_b64_tr_b16 a[114:115], v24 offset:50176
    ds_read_b64_tr_b16 a[116:117], v24 offset:49184
    ds_read_b64_tr_b16 a[118:119], v24 offset:50208
    ds_read_b64_tr_b16 a[120:121], v24 offset:57344
    ds_read_b64_tr_b16 a[122:123], v24 offset:58368
    ds_read_b64_tr_b16 a[124:125], v24 offset:57376
    ds_read_b64_tr_b16 a[126:127], v24 offset:58400
    s_waitcnt lgkmcnt(0)
    s_waitcnt vmcnt(20)
    s_barrier
    ds_read_b64_tr_b16 a[128:129], v25 offset:0
    ds_read_b64_tr_b16 a[130:131], v25 offset:1024
    ds_read_b64_tr_b16 a[132:133], v25 offset:32
    ds_read_b64_tr_b16 a[134:135], v25 offset:1056
    ds_read_b64_tr_b16 a[136:137], v25 offset:8192
    ds_read_b64_tr_b16 a[138:139], v25 offset:9216
    ds_read_b64_tr_b16 a[140:141], v25 offset:8224
    ds_read_b64_tr_b16 a[142:143], v25 offset:9248
    s_waitcnt lgkmcnt(0)
    s_waitcnt vmcnt(16)
    s_barrier
    ds_read_b64_tr_b16 a[144:145], v23 offset:0
    ds_read_b64_tr_b16 a[146:147], v23 offset:1024
    ds_read_b64_tr_b16 a[148:149], v23 offset:32
    ds_read_b64_tr_b16 a[150:151], v23 offset:1056
    ds_read_b64_tr_b16 a[152:153], v23 offset:8192
    ds_read_b64_tr_b16 a[154:155], v23 offset:9216
    ds_read_b64_tr_b16 a[156:157], v23 offset:8224
    ds_read_b64_tr_b16 a[158:159], v23 offset:9248
    s_waitcnt lgkmcnt(0)
    s_waitcnt vmcnt(12)
    s_barrier
    ds_read_b64_tr_b16 a[160:161], v23 offset:16384
    ds_read_b64_tr_b16 a[162:163], v23 offset:17408
    ds_read_b64_tr_b16 a[164:165], v23 offset:16416
    ds_read_b64_tr_b16 a[166:167], v23 offset:17440
    ds_read_b64_tr_b16 a[168:169], v23 offset:24576
    ds_read_b64_tr_b16 a[170:171], v23 offset:25600
    ds_read_b64_tr_b16 a[172:173], v23 offset:24608
    ds_read_b64_tr_b16 a[174:175], v23 offset:25632
    s_waitcnt lgkmcnt(0)
    s_waitcnt vmcnt(8)
    s_barrier
    ds_read_b64_tr_b16 a[176:177], v23 offset:32768
    ds_read_b64_tr_b16 a[178:179], v23 offset:33792
    ds_read_b64_tr_b16 a[180:181], v23 offset:32800
    ds_read_b64_tr_b16 a[182:183], v23 offset:33824
    ds_read_b64_tr_b16 a[184:185], v23 offset:40960
    ds_read_b64_tr_b16 a[186:187], v23 offset:41984
    ds_read_b64_tr_b16 a[188:189], v23 offset:40992
    ds_read_b64_tr_b16 a[190:191], v23 offset:42016
    s_waitcnt lgkmcnt(0)
    s_waitcnt vmcnt(4)
    s_barrier
    ds_read_b64_tr_b16 a[192:193], v23 offset:49152
    ds_read_b64_tr_b16 a[194:195], v23 offset:50176
    ds_read_b64_tr_b16 a[196:197], v23 offset:49184
    ds_read_b64_tr_b16 a[198:199], v23 offset:50208
    ds_read_b64_tr_b16 a[200:201], v23 offset:57344
    ds_read_b64_tr_b16 a[202:203], v23 offset:58368
    ds_read_b64_tr_b16 a[204:205], v23 offset:57376
    ds_read_b64_tr_b16 a[206:207], v23 offset:58400
    s_waitcnt lgkmcnt(0)
    s_waitcnt vmcnt(0)
    s_barrier
    ds_read_b64_tr_b16 a[208:209], v24 offset:0
    ds_read_b64_tr_b16 a[210:211], v24 offset:1024
    ds_read_b64_tr_b16 a[212:213], v24 offset:32
    ds_read_b64_tr_b16 a[214:215], v24 offset:1056
    ds_read_b64_tr_b16 a[216:217], v24 offset:8192
    ds_read_b64_tr_b16 a[218:219], v24 offset:9216
    ds_read_b64_tr_b16 a[220:221], v24 offset:8224
    ds_read_b64_tr_b16 a[222:223], v24 offset:9248
    s_waitcnt lgkmcnt(0)
    s_barrier
    buffer_load_dwordx4 v[80:83], v10, s[28:31], 0 offen
    buffer_load_dwordx4 v[84:87], v10, s[28:31], 0 offen offset:1024
    s_waitcnt vmcnt(0)
    v_lshlrev_b32 v96, 16, v80
    v_and_b32 v97, 0xffff0000, v80
    v_lshlrev_b32 v98, 16, v81
    v_and_b32 v99, 0xffff0000, v81
    v_lshlrev_b32 v100, 16, v82
    v_and_b32 v101, 0xffff0000, v82
    v_lshlrev_b32 v102, 16, v83
    v_and_b32 v103, 0xffff0000, v83
    v_lshlrev_b32 v104, 16, v84
    v_and_b32 v105, 0xffff0000, v84
    v_lshlrev_b32 v106, 16, v85
    v_and_b32 v107, 0xffff0000, v85
    v_lshlrev_b32 v108, 16, v86
    v_and_b32 v109, 0xffff0000, v86
    v_lshlrev_b32 v110, 16, v87
    v_and_b32 v111, 0xffff0000, v87
    s_cmp_lg_u32 s44, 0
    s_cbranch_scc1 L_pd_169
    v_mov_b32 v29, 127232
    s_mov_b32 s46, 96
    s_mov_b64 exec, 1
    s_mov_b32 s70, 0
L_wp_170:
    buffer_load_dword v31, v29, s[12:15], 0 offen sc1
    s_add_u32 s70, s70, 1
    s_cmp_ge_u32 s70, 0x200000
    s_cbranch_scc1 L_w_done_98
L_wp_170_c:
    s_waitcnt vmcnt(0)
    v_cmp_gt_u32 vcc, s46, v31
    s_nop 1
    s_cbranch_vccz L_wp_170_ok
    s_sleep 3
    s_branch L_wp_170
L_wp_170_ok:
    s_mov_b64 exec, -1
L_pd_169:
    s_barrier
    v_lshlrev_b32 v29, 5, v1
    s_mov_b32 s45, 20480
    buffer_load_dwordx4 v[112:115], v29, s[12:15], s45 offen offset:0 sc1
    buffer_load_dwordx4 v[116:119], v29, s[12:15], s45 offen offset:16 sc1
    buffer_load_dwordx4 v[120:123], v29, s[12:15], s45 offen offset:2048 sc1
    buffer_load_dwordx4 v[124:127], v29, s[12:15], s45 offen offset:2064 sc1
    s_mov_b32 s45, 45056
    buffer_load_dwordx4 v[32:35], v29, s[12:15], s45 offen offset:0 sc1
    buffer_load_dwordx4 v[36:39], v29, s[12:15], s45 offen offset:16 sc1
    buffer_load_dwordx4 v[40:43], v29, s[12:15], s45 offen offset:2048 sc1
    buffer_load_dwordx4 v[44:47], v29, s[12:15], s45 offen offset:2064 sc1
    s_waitcnt vmcnt(0)
    v_add_f32 v112, v112, v32
    v_cvt_pk_bf16_f32 v112, v112, v112
    v_lshlrev_b32 v112, 16, v112
    v_add_f32 v113, v113, v33
    v_cvt_pk_bf16_f32 v113, v113, v113
    v_lshlrev_b32 v113, 16, v113
    v_add_f32 v114, v114, v34
    v_cvt_pk_bf16_f32 v114, v114, v114
    v_lshlrev_b32 v114, 16, v114
    v_add_f32 v115, v115, v35
    v_cvt_pk_bf16_f32 v115, v115, v115
    v_lshlrev_b32 v115, 16, v115
    v_add_f32 v116, v116, v36
    v_cvt_pk_bf16_f32 v116, v116, v116
    v_lshlrev_b32 v116, 16, v116
    v_add_f32 v117, v117, v37
    v_cvt_pk_bf16_f32 v117, v117, v117
    v_lshlrev_b32 v117, 16, v117
    v_add_f32 v118, v118, v38
    v_cvt_pk_bf16_f32 v118, v118, v118
    v_lshlrev_b32 v118, 16, v118
    v_add_f32 v119, v119, v39
    v_cvt_pk_bf16_f32 v119, v119, v119
    v_lshlrev_b32 v119, 16, v119
    v_add_f32 v120, v120, v40
    v_cvt_pk_bf16_f32 v120, v120, v120
    v_lshlrev_b32 v120, 16, v120
    v_add_f32 v121, v121, v41
    v_cvt_pk_bf16_f32 v121, v121, v121
    v_lshlrev_b32 v121, 16, v121
    v_add_f32 v122, v122, v42
    v_cvt_pk_bf16_f32 v122, v122, v122
    v_lshlrev_b32 v122, 16, v122
    v_add_f32 v123, v123, v43
    v_cvt_pk_bf16_f32 v123, v123, v123
    v_lshlrev_b32 v123, 16, v123
    v_add_f32 v124, v124, v44
    v_cvt_pk_bf16_f32 v124, v124, v124
    v_lshlrev_b32 v124, 16, v124
    v_add_f32 v125, v125, v45
    v_cvt_pk_bf16_f32 v125, v125, v125
    v_lshlrev_b32 v125, 16, v125
    v_add_f32 v126, v126, v46
    v_cvt_pk_bf16_f32 v126, v126, v126
    v_lshlrev_b32 v126, 16, v126
    v_add_f32 v127, v127, v47
    v_cvt_pk_bf16_f32 v127, v127, v127
    v_lshlrev_b32 v127, 16, v127
    s_lshl_b32 s46, s44, 10
    s_add_u32 s45, s46, 20480
    buffer_load_dwordx4 v[22:25], v10, s[12:15], s45 offen sc1
    s_add_u32 s45, s46, 45056
    buffer_load_dwordx4 v[32:35], v10, s[12:15], s45 offen sc1
    s_waitcnt vmcnt(0)
    v_add_f32 v22, v22, v32
    v_cvt_pk_bf16_f32 v22, v22, v22
    v_lshlrev_b32 v22, 16, v22
    v_add_f32 v23, v23, v33
    v_cvt_pk_bf16_f32 v23, v23, v23
    v_lshlrev_b32 v23, 16, v23
    v_add_f32 v24, v24, v34
    v_cvt_pk_bf16_f32 v24, v24, v24
    v_lshlrev_b32 v24, 16, v24
    v_add_f32 v25, v25, v35
    v_cvt_pk_bf16_f32 v25, v25, v25
    v_lshlrev_b32 v25, 16, v25
    v_lshlrev_b32 v17, 3, v1
    s_lshl_b32 s45, s44, 9
    buffer_load_dwordx2 v[80:81], v17, s[28:31], s45 offen
    s_waitcnt vmcnt(0)
    v_lshlrev_b32 v18, 16, v80
    v_and_b32 v19, 0xffff0000, v80
    v_lshlrev_b32 v20, 16, v81
    v_and_b32 v21, 0xffff0000, v81
    s_mul_i32 s52, s38, 57344
    s_add_u32 s52, s52, 0x6000000
    s_lshl_b32 s56, s38, 23
    s_lshl_b32 s45, s68, 9
    s_add_u32 s56, s56, s45
    s_add_u32 s56, s56, 0xc000000
    s_lshl_b32 s45, s40, 7
    s_add_u32 s45, s45, 127488
    v_mov_b32 v29, s45
    s_mov_b32 s46, 536870912
    s_mov_b64 exec, 1
    s_mov_b32 s70, 0
L_wp_173:
    buffer_load_dword v31, v29, s[12:15], 0 offen sc1
    s_add_u32 s70, s70, 1
    s_cmp_ge_u32 s70, 0x200000
    s_cbranch_scc1 L_w_done_98
L_wp_173_c:
    s_waitcnt vmcnt(0)
    v_cmp_gt_u32 vcc, s46, v31
    s_nop 1
    s_cbranch_vccz L_wp_173_ok
    s_sleep 2
    s_branch L_wp_173
L_wp_173_ok:
    s_mov_b64 exec, -1
    v_readfirstlane_b32 s45, v31
    s_nop 3
    s_and_b32 s46, s45, 511
    s_mul_i32 s46, s46, s46
    s_bfe_u32 s45, s45, 0xf0009
    s_lshl_b32 s45, s45, 5
    s_mov_b32 s80, s12
    s_mov_b32 s81, s13
    s_mov_b32 s83, 0x00020000
    s_mov_b32 s84, s12
    s_mov_b32 s85, s13
    s_mov_b32 s87, 0x00020000
    s_cmp_eq_u32 s45, s46
    s_cselect_b32 s82, s14, 0
    s_cselect_b32 s86, 0, s14
L_c_loop_171:
    s_cmp_eq_u64 s[36:37], 0
    s_cbranch_scc1 L_w_done_98
    s_ff1_i32_b64 s50, s[36:37]
    s_bitset0_b64 s[36:37], s50
    s_lshr_b64 s[74:75], s[72:73], s50
    s_ff1_i32_b64 s51, s[74:75]
    s_add_u32 s51, s51, 1
    s_add_u32 s62, s50, s51
    s_mul_i32 s45, s38, 896
    s_add_u32 s45, s45, s64
    s_add_u32 s45, s45, 12288
    s_cmp_lg_u32 s44, 1
    s_cbranch_scc1 L_pw_174
    s_mov_b64 exec, 127
    s_mov_b32 s70, 0
L_wp_175:
    buffer_load_dword v31, v5, s[12:15], s45 offen sc1
    s_add_u32 s70, s70, 1
    s_cmp_ge_u32 s70, 0x200000
    s_cbranch_scc1 L_w_done_98
L_wp_175_c:
    s_waitcnt vmcnt(0)
    v_cmp_gt_u32 vcc, s62, v31
    s_nop 1
    s_cbranch_vccz L_wp_175_ok
    s_sleep 2
    s_branch L_wp_175
L_wp_175_ok:
    s_mov_b64 exec, -1
L_pw_174:
    s_barrier
    s_mul_i32 s53, s50, 229376
    s_add_u32 s53, s53, s52
    s_lshl_b32 s54, s44, 13
    s_add_u32 s53, s53, s54
    s_mul_i32 s57, s50, 131072
    s_add_u32 s57, s57, s56
    s_lshl_b32 s45, s44, 7
    s_add_u32 s57, s57, s45
    s_add_u32 s55, s54, 65536
    s_mov_b32 s58, 0
    v_mov_b32 v13, v10
    v_add_u32 v14, 65536, v13
    v_xor_b32 v15, 64, v13
    v_xor_b32 v16, 64, v14
    s_mov_b32 s76, 0x20000000
    s_add_u32 s48, s53, 0
    s_add_u32 s49, s48, 4096
    s_add_u32 m0, s54, 0
    s_nop 0
    buffer_load_dwordx4 v10, s[12:15], s48 offen offset:0 sc1 lds
    buffer_load_dwordx4 v10, s[12:15], s48 offen offset:1024 sc1 lds
    buffer_load_dwordx4 v10, s[12:15], s48 offen offset:2048 sc1 lds
    buffer_load_dwordx4 v10, s[12:15], s48 offen offset:3072 sc1 lds
    s_add_u32 m0, s54, 4096
    s_nop 0
    buffer_load_dwordx4 v10, s[12:15], s49 offen offset:0 sc1 lds
    buffer_load_dwordx4 v10, s[12:15], s49 offen offset:1024 sc1 lds
    buffer_load_dwordx4 v10, s[12:15], s49 offen offset:2048 sc1 lds
    buffer_load_dwordx4 v10, s[12:15], s49 offen offset:3072 sc1 lds
    s_add_u32 s48, s53, 32768
    s_cmp_lt_u32 s44, 3
    s_cselect_b32 s48, s48, 0x20000000
    s_add_u32 s49, s48, 4096
    s_add_u32 s46, s54, 32768
    s_add_u32 m0, s46, 0
    s_nop 0
    buffer_load_dwordx4 v10, s[12:15], s48 offen offset:0 sc1 lds
    buffer_load_dwordx4 v10, s[12:15], s48 offen offset:1024 sc1 lds
    buffer_load_dwordx4 v10, s[12:15], s48 offen offset:2048 sc1 lds
    buffer_load_dwordx4 v10, s[12:15], s48 offen offset:3072 sc1 lds
    s_add_u32 m0, s46, 4096
    s_nop 0
    buffer_load_dwordx4 v10, s[12:15], s49 offen offset:0 sc1 lds
    buffer_load_dwordx4 v10, s[12:15], s49 offen offset:1024 sc1 lds
    buffer_load_dwordx4 v10, s[12:15], s49 offen offset:2048 sc1 lds
    buffer_load_dwordx4 v10, s[12:15], s49 offen offset:3072 sc1 lds
    s_cmp_eq_u32 s51, 1
    s_cbranch_scc1 L_e_one_177
    s_add_u32 s48, s53, 229376
    s_add_u32 s49, s48, 4096
    s_add_u32 m0, s55, 0
    s_nop 0
    buffer_load_dwordx4 v10, s[12:15], s48 offen offset:0 sc1 lds
    buffer_load_dwordx4 v10, s[12:15], s48 offen offset:1024 sc1 lds
    buffer_load_dwordx4 v10, s[12:15], s48 offen offset:2048 sc1 lds
    buffer_load_dwordx4 v10, s[12:15], s48 offen offset:3072 sc1 lds
    s_add_u32 m0, s55, 4096
    s_nop 0
    buffer_load_dwordx4 v10, s[12:15], s49 offen offset:0 sc1 lds
    buffer_load_dwordx4 v10, s[12:15], s49 offen offset:1024 sc1 lds
    buffer_load_dwordx4 v10, s[12:15], s49 offen offset:2048 sc1 lds
    buffer_load_dwordx4 v10, s[12:15], s49 offen offset:3072 sc1 lds
    s_waitcnt vmcnt(16)
    s_barrier
    ds_read_b128 v[32:35], v13 offset:0
    ds_read_b128 v[36:39], v13 offset:1024
    ds_read_b128 v[40:43], v13 offset:2048
    ds_read_b128 v[44:47], v13 offset:3072
    s_add_u32 s48, s53, 262144
    s_add_u32 s46, s58, 1
    s_cmp_lt_u32 s46, s51
    s_cselect_b32 s48, s48, 0x20000000
    s_cmp_lt_u32 s44, 3
    s_cselect_b32 s48, s48, 0x20000000
    s_add_u32 s49, s48, 4096
    s_add_u32 s59, s55, 32768
L_e_loop_176:
    s_waitcnt lgkmcnt(2)
    v_mfma_f32_16x16x32_bf16 v[80:83], a[0:3], v[32:35], 0
    ds_read_b128 v[48:51], v13 offset:4096
    v_mfma_f32_16x16x32_bf16 v[84:87], a[4:7], v[32:35], 0
    ds_read_b128 v[52:55], v13 offset:5120
    v_mfma_f32_16x16x32_bf16 v[88:91], a[0:3], v[36:39], 0
    ds_read_b128 v[56:59], v13 offset:6144
    s_add_u32 m0, s59, 0
    v_mfma_f32_16x16x32_bf16 v[92:95], a[4:7], v[36:39], 0
    ds_read_b128 v[60:63], v13 offset:7168
    buffer_load_dwordx4 v10, s[12:15], s48 offen offset:0 sc1 lds
    s_waitcnt lgkmcnt(4)
    v_mfma_f32_16x16x32_bf16 v[80:83], a[8:11], v[40:43], v[80:83]
    ds_read_b128 v[32:35], v13 offset:8192
    v_mfma_f32_16x16x32_bf16 v[84:87], a[12:15], v[40:43], v[84:87]
    ds_read_b128 v[36:39], v13 offset:9216
    v_mfma_f32_16x16x32_bf16 v[88:91], a[8:11], v[44:47], v[88:91]
    v_mfma_f32_16x16x32_bf16 v[92:95], a[12:15], v[44:47], v[92:95]
    buffer_load_dwordx4 v10, s[12:15], s48 offen offset:1024 sc1 lds
    s_waitcnt lgkmcnt(4)
    v_mfma_f32_16x16x32_bf16 v[80:83], a[16:19], v[48:51], v[80:83]
    ds_read_b128 v[40:43], v13 offset:10240
    v_mfma_f32_16x16x32_bf16 v[84:87], a[20:23], v[48:51], v[84:87]
    ds_read_b128 v[44:47], v13 offset:11264
    v_mfma_f32_16x16x32_bf16 v[88:91], a[16:19], v[52:55], v[88:91]
    v_mfma_f32_16x16x32_bf16 v[92:95], a[20:23], v[52:55], v[92:95]
    buffer_load_dwordx4 v10, s[12:15], s48 offen offset:2048 sc1 lds
    s_waitcnt lgkmcnt(4)
    v_mfma_f32_16x16x32_bf16 v[80:83], a[24:27], v[56:59], v[80:83]
    ds_read_b128 v[48:51], v13 offset:12288
    v_mfma_f32_16x16x32_bf16 v[84:87], a[28:31], v[56:59], v[84:87]
    ds_read_b128 v[52:55], v13 offset:13312
    v_mfma_f32_16x16x32_bf16 v[88:91], a[24:27], v[60:63], v[88:91]
    v_mfma_f32_16x16x32_bf16 v[92:95], a[28:31], v[60:63], v[92:95]
    buffer_load_dwordx4 v10, s[12:15], s48 offen offset:3072 sc1 lds
    s_waitcnt lgkmcnt(4)
    v_mfma_f32_16x16x32_bf16 v[80:83], a[32:35], v[32:35], v[80:83]
    ds_read_b128 v[56:59], v13 offset:14336
    v_mfma_f32_16x16x32_bf16 v[84:87], a[36:39], v[32:35], v[84:87]
    ds_read_b128 v[60:63], v13 offset:15360
    v_mfma_f32_16x16x32_bf16 v[88:91], a[32:35], v[36:39], v[88:91]
    s_add_u32 m0, s59, 4096
    v_mfma_f32_16x16x32_bf16 v[92:95], a[36:39], v[36:39], v[92:95]
    buffer_load_dwordx4 v10, s[12:15], s49 offen offset:0 sc1 lds
    s_waitcnt lgkmcnt(4)
    v_mfma_f32_16x16x32_bf16 v[80:83], a[40:43], v[40:43], v[80:83]
    ds_read_b128 v[32:35], v13 offset:16384
    v_mfma_f32_16x16x32_bf16 v[84:87], a[44:47], v[40:43], v[84:87]
    ds_read_b128 v[36:39], v13 offset:17408
    v_mfma_f32_16x16x32_bf16 v[88:91], a[40:43], v[44:47], v[88:91]
    v_mfma_f32_16x16x32_bf16 v[92:95], a[44:47], v[44:47], v[92:95]
    buffer_load_dwordx4 v10, s[12:15], s49 offen offset:1024 sc1 lds
    s_waitcnt lgkmcnt(4)
    v_mfma_f32_16x16x32_bf16 v[80:83], a[48:51], v[48:51], v[80:83]
    ds_read_b128 v[40:43], v13 offset:18432
    v_mfma_f32_16x16x32_bf16 v[84:87], a[52:55], v[48:51], v[84:87]
    ds_read_b128 v[44:47], v13 offset:19456
    v_mfma_f32_16x16x32_bf16 v[88:91], a[48:51], v[52:55], v[88:91]
    v_mfma_f32_16x16x32_bf16 v[92:95], a[52:55], v[52:55], v[92:95]
    buffer_load_dwordx4 v10, s[12:15], s49 offen offset:2048 sc1 lds
    s_waitcnt lgkmcnt(4)
    v_mfma_f32_16x16x32_bf16 v[80:83], a[56:59], v[56:59], v[80:83]
    ds_read_b128 v[48:51], v13 offset:20480
    v_mfma_f32_16x16x32_bf16 v[84:87], a[60:63], v[56:59], v[84:87]
    ds_read_b128 v[52:55], v13 offset:21504
    v_mfma_f32_16x16x32_bf16 v[88:91], a[56:59], v[60:63], v[88:91]
    v_mfma_f32_16x16x32_bf16 v[92:95], a[60:63], v[60:63], v[92:95]
    buffer_load_dwordx4 v10, s[12:15], s49 offen offset:3072 sc1 lds
    s_waitcnt lgkmcnt(4)
    v_mfma_f32_16x16x32_bf16 v[80:83], a[64:67], v[32:35], v[80:83]
    ds_read_b128 v[56:59], v13 offset:22528
    v_mfma_f32_16x16x32_bf16 v[84:87], a[68:71], v[32:35], v[84:87]
    ds_read_b128 v[60:63], v13 offset:23552
    v_mfma_f32_16x16x32_bf16 v[88:91], a[64:67], v[36:39], v[88:91]
    s_add_u32 s48, s53, 458752
    v_mfma_f32_16x16x32_bf16 v[92:95], a[68:71], v[36:39], v[92:95]
    s_add_u32 s46, s58, 2
    s_waitcnt lgkmcnt(4)
    v_mfma_f32_16x16x32_bf16 v[80:83], a[72:75], v[40:43], v[80:83]
    ds_read_b128 v[32:35], v13 offset:24576
    v_mfma_f32_16x16x32_bf16 v[84:87], a[76:79], v[40:43], v[84:87]
    ds_read_b128 v[36:39], v13 offset:25600
    v_mfma_f32_16x16x32_bf16 v[88:91], a[72:75], v[44:47], v[88:91]
    s_cmp_lt_u32 s46, s51
    s_cselect_b32 s48, s48, 0x20000000
    v_mfma_f32_16x16x32_bf16 v[92:95], a[76:79], v[44:47], v[92:95]
    s_add_u32 s49, s48, 4096
    s_waitcnt lgkmcnt(4)
    v_mfma_f32_16x16x32_bf16 v[80:83], a[80:83], v[48:51], v[80:83]
    ds_read_b128 v[40:43], v13 offset:26624
    v_mfma_f32_16x16x32_bf16 v[84:87], a[84:87], v[48:51], v[84:87]
    ds_read_b128 v[44:47], v13 offset:27648
    v_mfma_f32_16x16x32_bf16 v[88:91], a[80:83], v[52:55], v[88:91]
    s_mov_b32 s59, s54
    v_mfma_f32_16x16x32_bf16 v[92:95], a[84:87], v[52:55], v[92:95]
    s_waitcnt lgkmcnt(4)
    v_mfma_f32_16x16x32_bf16 v[80:83], a[88:91], v[56:59], v[80:83]
    ds_read_b128 v[48:51], v13 offset:28672
    v_mfma_f32_16x16x32_bf16 v[84:87], a[92:95], v[56:59], v[84:87]
    ds_read_b128 v[52:55], v13 offset:29696
    v_mfma_f32_16x16x32_bf16 v[88:91], a[88:91], v[60:63], v[88:91]
    v_mfma_f32_16x16x32_bf16 v[92:95], a[92:95], v[60:63], v[92:95]
    s_waitcnt lgkmcnt(4)
    v_mfma_f32_16x16x32_bf16 v[80:83], a[96:99], v[32:35], v[80:83]
    ds_read_b128 v[56:59], v13 offset:30720
    v_mfma_f32_16x16x32_bf16 v[84:87], a[100:103], v[32:35], v[84:87]
    ds_read_b128 v[60:63], v13 offset:31744
    v_mfma_f32_16x16x32_bf16 v[88:91], a[96:99], v[36:39], v[88:91]
    v_mfma_f32_16x16x32_bf16 v[92:95], a[100:103], v[36:39], v[92:95]
    s_waitcnt lgkmcnt(4)
    v_mfma_f32_16x16x32_bf16 v[80:83], a[104:107], v[40:43], v[80:83]
    ds_read_b128 v[216:219], v8 offset:0
    v_mfma_f32_16x16x32_bf16 v[84:87], a[108:111], v[40:43], v[84:87]
    ds_read_b128 v[220:223], v8 offset:1152
    v_mfma_f32_16x16x32_bf16 v[88:91], a[104:107], v[44:47], v[88:91]
    ds_read_b128 v[224:227], v8 offset:2304
    v_mfma_f32_16x16x32_bf16 v[92:95], a[108:111], v[44:47], v[92:95]
    ds_read_b128 v[228:231], v8 offset:3456
    s_waitcnt vmcnt(16) lgkmcnt(0)
    s_barrier
    v_mfma_f32_16x16x32_bf16 v[80:83], a[112:115], v[48:51], v[80:83]
    ds_read_b128 v[32:35], v13 offset:32768
    buffer_store_dwordx4 v[216:219], v11, s[12:15], s76 offen sc1
    v_mfma_f32_16x16x32_bf16 v[84:87], a[116:119], v[48:51], v[84:87]
    ds_read_b128 v[36:39], v13 offset:33792
    s_add_u32 s76, s76, 32768
    v_mfma_f32_16x16x32_bf16 v[88:91], a[112:115], v[52:55], v[88:91]
    buffer_store_dwordx4 v[220:223], v11, s[12:15], s76 offen sc1
    s_add_u32 s76, s76, 32768
    v_mfma_f32_16x16x32_bf16 v[92:95], a[116:119], v[52:55], v[92:95]
    buffer_store_dwordx4 v[224:227], v11, s[12:15], s76 offen sc1
    v_mfma_f32_16x16x32_bf16 v[80:83], a[120:123], v[56:59], v[80:83]
    ds_read_b128 v[40:43], v13 offset:34816
    s_add_u32 s76, s76, 32768
    v_mfma_f32_16x16x32_bf16 v[84:87], a[124:127], v[56:59], v[84:87]
    ds_read_b128 v[44:47], v13 offset:35840
    buffer_store_dwordx4 v[228:231], v11, s[12:15], s76 offen sc1
    v_mfma_f32_16x16x32_bf16 v[88:91], a[120:123], v[60:63], v[88:91]
    v_mfma_f32_16x16x32_bf16 v[92:95], a[124:127], v[60:63], v[92:95]
    s_waitcnt lgkmcnt(2)
    v_mfma_f32_16x16x32_bf16 v[80:83], a[128:131], v[32:35], v[80:83]
    ds_read_b128 v[48:51], v13 offset:36864
    v_mfma_f32_16x16x32_bf16 v[84:87], a[132:135], v[32:35], v[84:87]
    ds_read_b128 v[52:55], v13 offset:37888
    v_mfma_f32_16x16x32_bf16 v[88:91], a[128:131], v[36:39], v[88:91]
    ds_read_b128 v[56:59], v13 offset:38912
    s_add_u32 m0, s59, 0
    v_mfma_f32_16x16x32_bf16 v[92:95], a[132:135], v[36:39], v[92:95]
    ds_read_b128 v[60:63], v13 offset:39936
    buffer_load_dwordx4 v10, s[12:15], s48 offen offset:0 sc1 lds
    s_waitcnt lgkmcnt(4)
    v_mfma_f32_16x16x32_bf16 v[80:83], a[136:139], v[40:43], v[80:83]
    ds_read_b128 v[32:35], v13 offset:40960
    v_mfma_f32_16x16x32_bf16 v[84:87], a[140:143], v[40:43], v[84:87]
    ds_read_b128 v[36:39], v13 offset:41984
    v_mfma_f32_16x16x32_bf16 v[88:91], a[136:139], v[44:47], v[88:91]
    v_mfma_f32_16x16x32_bf16 v[92:95], a[140:143], v[44:47], v[92:95]
    buffer_load_dwordx4 v10, s[12:15], s48 offen offset:1024 sc1 lds
    s_waitcnt lgkmcnt(4)
    v_mfma_f32_16x16x32_bf16 v[80:83], a[144:147], v[48:51], v[80:83]
    ds_read_b128 v[40:43], v13 offset:43008
    v_mfma_f32_16x16x32_bf16 v[84:87], a[148:151], v[48:51], v[84:87]
    ds_read_b128 v[44:47], v13 offset:44032
    v_mfma_f32_16x16x32_bf16 v[88:91], a[144:147], v[52:55], v[88:91]
    v_mfma_f32_16x16x32_bf16 v[92:95], a[148:151], v[52:55], v[92:95]
    buffer_load_dwordx4 v10, s[12:15], s48 offen offset:2048 sc1 lds
    s_waitcnt lgkmcnt(4)
    v_mfma_f32_16x16x32_bf16 v[80:83], a[152:155], v[56:59], v[80:83]
    ds_read_b128 v[48:51], v13 offset:45056
    v_mfma_f32_16x16x32_bf16 v[84:87], a[156:159], v[56:59], v[84:87]
    ds_read_b128 v[52:55], v13 offset:46080
    v_mfma_f32_16x16x32_bf16 v[88:91], a[152:155], v[60:63], v[88:91]
    v_mfma_f32_16x16x32_bf16 v[92:95], a[156:159], v[60:63], v[92:95]
    buffer_load_dwordx4 v10, s[12:15], s48 offen offset:3072 sc1 lds
    s_waitcnt lgkmcnt(4)
    v_mfma_f32_16x16x32_bf16 v[80:83], a[160:163], v[32:35], v[80:83]
    ds_read_b128 v[56:59], v13 offset:47104
    v_mfma_f32_16x16x32_bf16 v[84:87], a[164:167], v[32:35], v[84:87]
    ds_read_b128 v[60:63], v13 offset:48128
    v_mfma_f32_16x16x32_bf16 v[88:91], a[160:163], v[36:39], v[88:91]
    s_add_u32 m0, s59, 4096
    v_mfma_f32_16x16x32_bf16 v[92:95], a[164:167], v[36:39], v[92:95]
    buffer_load_dwordx4 v10, s[12:15], s49 offen offset:0 sc1 lds
    s_waitcnt lgkmcnt(4)
    v_mfma_f32_16x16x32_bf16 v[80:83], a[168:171], v[40:43], v[80:83]
    ds_read_b128 v[32:35], v13 offset:49152
    v_mfma_f32_16x16x32_bf16 v[84:87], a[172:175], v[40:43], v[84:87]
    ds_read_b128 v[36:39], v13 offset:50176
    v_mfma_f32_16x16x32_bf16 v[88:91], a[168:171], v[44:47], v[88:91]
    v_mfma_f32_16x16x32_bf16 v[92:95], a[172:175], v[44:47], v[92:95]
    buffer_load_dwordx4 v10, s[12:15], s49 offen offset:1024 sc1 lds
    s_waitcnt lgkmcnt(4)
    v_mfma_f32_16x16x32_bf16 v[80:83], a[176:179], v[48:51], v[80:83]
    ds_read_b128 v[40:43], v13 offset:51200
    v_mfma_f32_16x16x32_bf16 v[84:87], a[180:183], v[48:51], v[84:87]
    ds_read_b128 v[44:47], v13 offset:52224
    v_mfma_f32_16x16x32_bf16 v[88:91], a[176:179], v[52:55], v[88:91]
    v_mfma_f32_16x16x32_bf16 v[92:95], a[180:183], v[52:55], v[92:95]
    buffer_load_dwordx4 v10, s[12:15], s49 offen offset:2048 sc1 lds
    s_waitcnt lgkmcnt(4)
    v_mfma_f32_16x16x32_bf16 v[80:83], a[184:187], v[56:59], v[80:83]
    ds_read_b128 v[48:51], v13 offset:53248
    v_mfma_f32_16x16x32_bf16 v[84:87], a[188:191], v[56:59], v[84:87]
    ds_read_b128 v[52:55], v13 offset:54272
    v_mfma_f32_16x16x32_bf16 v[88:91], a[184:187], v[60:63], v[88:91]
    v_mfma_f32_16x16x32_bf16 v[92:95], a[188:191], v[60:63], v[92:95]
    buffer_load_dwordx4 v10, s[12:15], s49 offen offset:3072 sc1 lds
    s_waitcnt lgkmcnt(4)
    v_mfma_f32_16x16x32_bf16 v[80:83], a[192:195], v[32:35], v[80:83]
    ds_read_b128 v[56:59], v13 offset:55296
    v_mfma_f32_16x16x32_bf16 v[84:87], a[196:199], v[32:35], v[84:87]
    ds_read_b128 v[60:63], v13 offset:56320
    v_mfma_f32_16x16x32_bf16 v[88:91], a[192:195], v[36:39], v[88:91]
    s_add_u32 s48, s53, 491520
    v_mfma_f32_16x16x32_bf16 v[92:95], a[196:199], v[36:39], v[92:95]
    s_add_u32 s46, s58, 2
    s_waitcnt lgkmcnt(4)
    v_mfma_f32_16x16x32_bf16 v[80:83], a[200:203], v[40:43], v[80:83]
    v_mfma_f32_16x16x32_bf16 v[84:87], a[204:207], v[40:43], v[84:87]
    v_mfma_f32_16x16x32_bf16 v[88:91], a[200:203], v[44:47], v[88:91]
    s_cmp_lt_u32 s46, s51
    s_cselect_b32 s48, s48, 0x20000000
    v_mfma_f32_16x16x32_bf16 v[92:95], a[204:207], v[44:47], v[92:95]
    s_cmp_lt_u32 s44, 3
    s_cselect_b32 s48, s48, 0x20000000
    s_waitcnt vmcnt(16) lgkmcnt(0)
    s_barrier
    v_mfma_f32_16x16x32_bf16 v[80:83], a[208:211], v[48:51], v[80:83]
    ds_read_b128 v[32:35], v14 offset:0
    v_mfma_f32_16x16x32_bf16 v[84:87], a[212:215], v[48:51], v[84:87]
    ds_read_b128 v[36:39], v14 offset:1024
    v_mfma_f32_16x16x32_bf16 v[88:91], a[208:211], v[52:55], v[88:91]
    s_add_u32 s49, s48, 4096
    v_mfma_f32_16x16x32_bf16 v[92:95], a[212:215], v[52:55], v[92:95]
    s_add_u32 s59, s54, 32768
    v_mfma_f32_16x16x32_bf16 v[80:83], a[216:219], v[56:59], v[80:83]
    ds_read_b128 v[40:43], v14 offset:2048
    v_mfma_f32_16x16x32_bf16 v[84:87], a[220:223], v[56:59], v[84:87]
    ds_read_b128 v[44:47], v14 offset:3072
    v_mfma_f32_16x16x32_bf16 v[88:91], a[216:219], v[60:63], v[88:91]
    v_mfma_f32_16x16x32_bf16 v[92:95], a[220:223], v[60:63], v[92:95]
    s_add_u32 s53, s53, 229376
    s_add_u32 s58, s58, 1
    v_swap_b32 v13, v14
    s_xor_b32 s54, s54, 65536
    s_xor_b32 s55, s55, 65536
    s_mov_b32 s76, s57
    v_swap_b32 v15, v16
    s_add_u32 s57, s57, 131072
    ds_write_b128 v7, v[80:83] offset:0
    ds_write_b128 v7, v[84:87] offset:64
    ds_write_b128 v7, v[88:91] offset:2304
    ds_write_b128 v7, v[92:95] offset:2368
    s_cmp_lt_u32 s58, s51
    s_cbranch_scc1 L_e_loop_176
    s_branch L_e_fin_178
L_e_one_177:
    s_waitcnt vmcnt(8)
    s_barrier
    ds_read_b128 v[32:35], v13 offset:0
    ds_read_b128 v[36:39], v13 offset:1024
    ds_read_b128 v[40:43], v13 offset:2048
    ds_read_b128 v[44:47], v13 offset:3072
    s_waitcnt lgkmcnt(2)
    v_mfma_f32_16x16x32_bf16 v[80:83], a[0:3], v[32:35], 0
    ds_read_b128 v[48:51], v13 offset:4096
    v_mfma_f32_16x16x32_bf16 v[84:87], a[4:7], v[32:35], 0
    ds_read_b128 v[52:55], v13 offset:5120
    v_mfma_f32_16x16x32_bf16 v[88:91], a[0:3], v[36:39], 0
    ds_read_b128 v[56:59], v13 offset:6144
    v_mfma_f32_16x16x32_bf16 v[92:95], a[4:7], v[36:39], 0
    ds_read_b128 v[60:63], v13 offset:7168
    s_waitcnt lgkmcnt(4)
    v_mfma_f32_16x16x32_bf16 v[80:83], a[8:11], v[40:43], v[80:83]
    ds_read_b128 v[32:35], v13 offset:8192
    v_mfma_f32_16x16x32_bf16 v[84:87], a[12:15], v[40:43], v[84:87]
    ds_read_b128 v[36:39], v13 offset:9216
    v_mfma_f32_16x16x32_bf16 v[88:91], a[8:11], v[44:47], v[88:91]
    v_mfma_f32_16x16x32_bf16 v[92:95], a[12:15], v[44:47], v[92:95]
    s_waitcnt lgkmcnt(4)
    v_mfma_f32_16x16x32_bf16 v[80:83], a[16:19], v[48:51], v[80:83]
    ds_read_b128 v[40:43], v13 offset:10240
    v_mfma_f32_16x16x32_bf16 v[84:87], a[20:23], v[48:51], v[84:87]
    ds_read_b128 v[44:47], v13 offset:11264
    v_mfma_f32_16x16x32_bf16 v[88:91], a[16:19], v[52:55], v[88:91]
    v_mfma_f32_16x16x32_bf16 v[92:95], a[20:23], v[52:55], v[92:95]
    s_waitcnt lgkmcnt(4)
    v_mfma_f32_16x16x32_bf16 v[80:83], a[24:27], v[56:59], v[80:83]
    ds_read_b128 v[48:51], v13 offset:12288
    v_mfma_f32_16x16x32_bf16 v[84:87], a[28:31], v[56:59], v[84:87]
    ds_read_b128 v[52:55], v13 offset:13312
    v_mfma_f32_16x16x32_bf16 v[88:91], a[24:27], v[60:63], v[88:91]
    v_mfma_f32_16x16x32_bf16 v[92:95], a[28:31], v[60:63], v[92:95]
    s_waitcnt lgkmcnt(4)
    v_mfma_f32_16x16x32_bf16 v[80:83], a[32:35], v[32:35], v[80:83]
    ds_read_b128 v[56:59], v13 offset:14336
    v_mfma_f32_16x16x32_bf16 v[84:87], a[36:39], v[32:35], v[84:87]
    ds_read_b128 v[60:63], v13 offset:15360
    v_mfma_f32_16x16x32_bf16 v[88:91], a[32:35], v[36:39], v[88:91]
    v_mfma_f32_16x16x32_bf16 v[92:95], a[36:39], v[36:39], v[92:95]
    s_waitcnt lgkmcnt(4)
    v_mfma_f32_16x16x32_bf16 v[80:83], a[40:43], v[40:43], v[80:83]
    ds_read_b128 v[32:35], v13 offset:16384
    v_mfma_f32_16x16x32_bf16 v[84:87], a[44:47], v[40:43], v[84:87]
    ds_read_b128 v[36:39], v13 offset:17408
    v_mfma_f32_16x16x32_bf16 v[88:91], a[40:43], v[44:47], v[88:91]
    v_mfma_f32_16x16x32_bf16 v[92:95], a[44:47], v[44:47], v[92:95]
    s_waitcnt lgkmcnt(4)
    v_mfma_f32_16x16x32_bf16 v[80:83], a[48:51], v[48:51], v[80:83]
    ds_read_b128 v[40:43], v13 offset:18432
    v_mfma_f32_16x16x32_bf16 v[84:87], a[52:55], v[48:51], v[84:87]
    ds_read_b128 v[44:47], v13 offset:19456
    v_mfma_f32_16x16x32_bf16 v[88:91], a[48:51], v[52:55], v[88:91]
    v_mfma_f32_16x16x32_bf16 v[92:95], a[52:55], v[52:55], v[92:95]
    s_waitcnt lgkmcnt(4)
    v_mfma_f32_16x16x32_bf16 v[80:83], a[56:59], v[56:59], v[80:83]
    ds_read_b128 v[48:51], v13 offset:20480
    v_mfma_f32_16x16x32_bf16 v[84:87], a[60:63], v[56:59], v[84:87]
    ds_read_b128 v[52:55], v13 offset:21504
    v_mfma_f32_16x16x32_bf16 v[88:91], a[56:59], v[60:63], v[88:91]
    v_mfma_f32_16x16x32_bf16 v[92:95], a[60:63], v[60:63], v[92:95]
    s_waitcnt lgkmcnt(4)
    v_mfma_f32_16x16x32_bf16 v[80:83], a[64:67], v[32:35], v[80:83]
    ds_read_b128 v[56:59], v13 offset:22528
    v_mfma_f32_16x16x32_bf16 v[84:87], a[68:71], v[32:35], v[84:87]
    ds_read_b128 v[60:63], v13 offset:23552
    v_mfma_f32_16x16x32_bf16 v[88:91], a[64:67], v[36:39], v[88:91]
    v_mfma_f32_16x16x32_bf16 v[92:95], a[68:71], v[36:39], v[92:95]
    s_waitcnt lgkmcnt(4)
    v_mfma_f32_16x16x32_bf16 v[80:83], a[72:75], v[40:43], v[80:83]
    ds_read_b128 v[32:35], v13 offset:24576
    v_mfma_f32_16x16x32_bf16 v[84:87], a[76:79], v[40:43], v[84:87]
    ds_read_b128 v[36:39], v13 offset:25600
    v_mfma_f32_16x16x32_bf16 v[88:91], a[72:75], v[44:47], v[88:91]
    v_mfma_f32_16x16x32_bf16 v[92:95], a[76:79], v[44:47], v[92:95]
    s_waitcnt lgkmcnt(4)
    v_mfma_f32_16x16x32_bf16 v[80:83], a[80:83], v[48:51], v[80:83]
    ds_read_b128 v[40:43], v13 offset:26624
    v_mfma_f32_16x16x32_bf16 v[84:87], a[84:87], v[48:51], v[84:87]
    ds_read_b128 v[44:47], v13 offset:27648
    v_mfma_f32_16x16x32_bf16 v[88:91], a[80:83], v[52:55], v[88:91]
    v_mfma_f32_16x16x32_bf16 v[92:95], a[84:87], v[52:55], v[92:95]
    s_waitcnt lgkmcnt(4)
    v_mfma_f32_16x16x32_bf16 v[80:83], a[88:91], v[56:59], v[80:83]
    ds_read_b128 v[48:51], v13 offset:28672
    v_mfma_f32_16x16x32_bf16 v[84:87], a[92:95], v[56:59], v[84:87]
    ds_read_b128 v[52:55], v13 offset:29696
    v_mfma_f32_16x16x32_bf16 v[88:91], a[88:91], v[60:63], v[88:91]
    v_mfma_f32_16x16x32_bf16 v[92:95], a[92:95], v[60:63], v[92:95]
    s_waitcnt lgkmcnt(4)
    v_mfma_f32_16x16x32_bf16 v[80:83], a[96:99], v[32:35], v[80:83]
    ds_read_b128 v[56:59], v13 offset:30720
    v_mfma_f32_16x16x32_bf16 v[84:87], a[100:103], v[32:35], v[84:87]
    ds_read_b128 v[60:63], v13 offset:31744
    v_mfma_f32_16x16x32_bf16 v[88:91], a[96:99], v[36:39], v[88:91]
    v_mfma_f32_16x16x32_bf16 v[92:95], a[100:103], v[36:39], v[92:95]
    s_waitcnt lgkmcnt(4)
    v_mfma_f32_16x16x32_bf16 v[80:83], a[104:107], v[40:43], v[80:83]
    v_mfma_f32_16x16x32_bf16 v[84:87], a[108:111], v[40:43], v[84:87]
    v_mfma_f32_16x16x32_bf16 v[88:91], a[104:107], v[44:47], v[88:91]
    v_mfma_f32_16x16x32_bf16 v[92:95], a[108:111], v[44:47], v[92:95]
    s_waitcnt vmcnt(0) lgkmcnt(0)
    s_barrier
    v_mfma_f32_16x16x32_bf16 v[80:83], a[112:115], v[48:51], v[80:83]
    ds_read_b128 v[32:35], v13 offset:32768
    v_mfma_f32_16x16x32_bf16 v[84:87], a[116:119], v[48:51], v[84:87]
    ds_read_b128 v[36:39], v13 offset:33792
    v_mfma_f32_16x16x32_bf16 v[88:91], a[112:115], v[52:55], v[88:91]
    v_mfma_f32_16x16x32_bf16 v[92:95], a[116:119], v[52:55], v[92:95]
    v_mfma_f32_16x16x32_bf16 v[80:83], a[120:123], v[56:59], v[80:83]
    ds_read_b128 v[40:43], v13 offset:34816
    v_mfma_f32_16x16x32_bf16 v[84:87], a[124:127], v[56:59], v[84:87]
    ds_read_b128 v[44:47], v13 offset:35840
    v_mfma_f32_16x16x32_bf16 v[88:91], a[120:123], v[60:63], v[88:91]
    v_mfma_f32_16x16x32_bf16 v[92:95], a[124:127], v[60:63], v[92:95]
    s_waitcnt lgkmcnt(2)
    v_mfma_f32_16x16x32_bf16 v[80:83], a[128:131], v[32:35], v[80:83]
    ds_read_b128 v[48:51], v13 offset:36864
    v_mfma_f32_16x16x32_bf16 v[84:87], a[132:135], v[32:35], v[84:87]
    ds_read_b128 v[52:55], v13 offset:37888
    v_mfma_f32_16x16x32_bf16 v[88:91], a[128:131], v[36:39], v[88:91]
    ds_read_b128 v[56:59], v13 offset:38912
    v_mfma_f32_16x16x32_bf16 v[92:95], a[132:135], v[36:39], v[92:95]
    ds_read_b128 v[60:63], v13 offset:39936
    s_waitcnt lgkmcnt(4)
    v_mfma_f32_16x16x32_bf16 v[80:83], a[136:139], v[40:43], v[80:83]
    ds_read_b128 v[32:35], v13 offset:40960
    v_mfma_f32_16x16x32_bf16 v[84:87], a[140:143], v[40:43], v[84:87]
    ds_read_b128 v[36:39], v13 offset:41984
    v_mfma_f32_16x16x32_bf16 v[88:91], a[136:139], v[44:47], v[88:91]
    v_mfma_f32_16x16x32_bf16 v[92:95], a[140:143], v[44:47], v[92:95]
    s_waitcnt lgkmcnt(4)
    v_mfma_f32_16x16x32_bf16 v[80:83], a[144:147], v[48:51], v[80:83]
    ds_read_b128 v[40:43], v13 offset:43008
    v_mfma_f32_16x16x32_bf16 v[84:87], a[148:151], v[48:51], v[84:87]
    ds_read_b128 v[44:47], v13 offset:44032
    v_mfma_f32_16x16x32_bf16 v[88:91], a[144:147], v[52:55], v[88:91]
    v_mfma_f32_16x16x32_bf16 v[92:95], a[148:151], v[52:55], v[92:95]
    s_waitcnt lgkmcnt(4)
    v_mfma_f32_16x16x32_bf16 v[80:83], a[152:155], v[56:59], v[80:83]
    ds_read_b128 v[48:51], v13 offset:45056
    v_mfma_f32_16x16x32_bf16 v[84:87], a[156:159], v[56:59], v[84:87]
    ds_read_b128 v[52:55], v13 offset:46080
    v_mfma_f32_16x16x32_bf16 v[88:91], a[152:155], v[60:63], v[88:91]
    v_mfma_f32_16x16x32_bf16 v[92:95], a[156:159], v[60:63], v[92:95]
    s_waitcnt lgkmcnt(4)
    v_mfma_f32_16x16x32_bf16 v[80:83], a[160:163], v[32:35], v[80:83]
    ds_read_b128 v[56:59], v13 offset:47104
    v_mfma_f32_16x16x32_bf16 v[84:87], a[164:167], v[32:35], v[84:87]
    ds_read_b128 v[60:63], v13 offset:48128
    v_mfma_f32_16x16x32_bf16 v[88:91], a[160:163], v[36:39], v[88:91]
    v_mfma_f32_16x16x32_bf16 v[92:95], a[164:167], v[36:39], v[92:95]
    s_waitcnt lgkmcnt(4)
    v_mfma_f32_16x16x32_bf16 v[80:83], a[168:171], v[40:43], v[80:83]
    ds_read_b128 v[32:35], v13 offset:49152
    v_mfma_f32_16x16x32_bf16 v[84:87], a[172:175], v[40:43], v[84:87]
    ds_read_b128 v[36:39], v13 offset:50176
    v_mfma_f32_16x16x32_bf16 v[88:91], a[168:171], v[44:47], v[88:91]
    v_mfma_f32_16x16x32_bf16 v[92:95], a[172:175], v[44:47], v[92:95]
    s_waitcnt lgkmcnt(4)
    v_mfma_f32_16x16x32_bf16 v[80:83], a[176:179], v[48:51], v[80:83]
    ds_read_b128 v[40:43], v13 offset:51200
    v_mfma_f32_16x16x32_bf16 v[84:87], a[180:183], v[48:51], v[84:87]
    ds_read_b128 v[44:47], v13 offset:52224
    v_mfma_f32_16x16x32_bf16 v[88:91], a[176:179], v[52:55], v[88:91]
    v_mfma_f32_16x16x32_bf16 v[92:95], a[180:183], v[52:55], v[92:95]
    s_waitcnt lgkmcnt(4)
    v_mfma_f32_16x16x32_bf16 v[80:83], a[184:187], v[56:59], v[80:83]
    ds_read_b128 v[48:51], v13 offset:53248
    v_mfma_f32_16x16x32_bf16 v[84:87], a[188:191], v[56:59], v[84:87]
    ds_read_b128 v[52:55], v13 offset:54272
    v_mfma_f32_16x16x32_bf16 v[88:91], a[184:187], v[60:63], v[88:91]
    v_mfma_f32_16x16x32_bf16 v[92:95], a[188:191], v[60:63], v[92:95]
    s_waitcnt lgkmcnt(4)
    v_mfma_f32_16x16x32_bf16 v[80:83], a[192:195], v[32:35], v[80:83]
    ds_read_b128 v[56:59], v13 offset:55296
    v_mfma_f32_16x16x32_bf16 v[84:87], a[196:199], v[32:35], v[84:87]
    ds_read_b128 v[60:63], v13 offset:56320
    v_mfma_f32_16x16x32_bf16 v[88:91], a[192:195], v[36:39], v[88:91]
    v_mfma_f32_16x16x32_bf16 v[92:95], a[196:199], v[36:39], v[92:95]
    s_waitcnt lgkmcnt(4)
    v_mfma_f32_16x16x32_bf16 v[80:83], a[200:203], v[40:43], v[80:83]
    v_mfma_f32_16x16x32_bf16 v[84:87], a[204:207], v[40:43], v[84:87]
    v_mfma_f32_16x16x32_bf16 v[88:91], a[200:203], v[44:47], v[88:91]
    v_mfma_f32_16x16x32_bf16 v[92:95], a[204:207], v[44:47], v[92:95]
    s_waitcnt lgkmcnt(0)
    v_mfma_f32_16x16x32_bf16 v[80:83], a[208:211], v[48:51], v[80:83]
    v_mfma_f32_16x16x32_bf16 v[84:87], a[212:215], v[48:51], v[84:87]
    v_mfma_f32_16x16x32_bf16 v[88:91], a[208:211], v[52:55], v[88:91]
    v_mfma_f32_16x16x32_bf16 v[92:95], a[212:215], v[52:55], v[92:95]
    v_mfma_f32_16x16x32_bf16 v[80:83], a[216:219], v[56:59], v[80:83]
    v_mfma_f32_16x16x32_bf16 v[84:87], a[220:223], v[56:59], v[84:87]
    v_mfma_f32_16x16x32_bf16 v[88:91], a[216:219], v[60:63], v[88:91]
    v_mfma_f32_16x16x32_bf16 v[92:95], a[220:223], v[60:63], v[92:95]
    s_mov_b32 s76, s57
    s_nop 6
    ds_write_b128 v7, v[80:83] offset:0
    ds_write_b128 v7, v[84:87] offset:64
    ds_write_b128 v7, v[88:91] offset:2304
    ds_write_b128 v7, v[92:95] offset:2368
L_e_fin_178:
    s_waitcnt lgkmcnt(0)
    ds_read_b128 v[216:219], v8 offset:0
    ds_read_b128 v[220:223], v8 offset:1152
    ds_read_b128 v[224:227], v8 offset:2304
    ds_read_b128 v[228:231], v8 offset:3456
    s_waitcnt lgkmcnt(0)
    buffer_store_dwordx4 v[216:219], v11, s[12:15], s76 offen sc1
    s_add_u32 s76, s76, 32768
    buffer_store_dwordx4 v[220:223], v11, s[12:15], s76 offen sc1
    s_add_u32 s76, s76, 32768
    buffer_store_dwordx4 v[224:227], v11, s[12:15], s76 offen sc1
    s_add_u32 s76, s76, 32768
    buffer_store_dwordx4 v[228:231], v11, s[12:15], s76 offen sc1
    s_waitcnt vmcnt(0)
    s_barrier
    s_cmp_lg_u32 s44, 0
    s_cbranch_scc1 L_pub_179
    v_mov_b32 v30, s62
    v_mov_b32 v31, 0
    s_mov_b64 exec, 1
    buffer_store_dword v30, v31, s[80:83], s65 offen
    buffer_store_dword v30, v31, s[84:87], s65 offen sc1
    s_mov_b64 exec, -1
L_pub_179:
    s_cmp_lg_u32 s51, 1
    s_cbranch_scc1 L_c_skip_172
    s_lshl_b32 s63, s50, 5
    s_add_u32 s63, s63, s41
    s_lshl_b32 s47, s63, 11
    s_lshl_b32 s45, s44, 9
    s_add_u32 s47, s47, s45
    s_add_u32 s46, s47, 0x800000
    v_lshlrev_b32 v17, 3, v1
    buffer_load_dwordx2 v[208:209], v17, s[12:15], s46 offen sc1
    s_add_u32 s45, s64, 16384
    s_cmp_lg_u32 s44, 1
    s_cbranch_scc1 L_pw_180
    s_mov_b32 exec_hi, 0
    s_mov_b32 s70, 0
L_wp_181:
    buffer_load_dword v31, v5, s[12:15], s45 offen sc1
    s_add_u32 s70, s70, 1
    s_cmp_ge_u32 s70, 0x200000
    s_cbranch_scc1 L_w_done_98
L_wp_181_c:
    s_waitcnt vmcnt(0)
    v_cmp_gt_u32 vcc, s62, v31
    s_nop 1
    s_cbranch_vccz L_wp_181_ok
    s_sleep 1
    s_branch L_wp_181
L_wp_181_ok:
    s_mov_b64 exec, -1
L_pw_180:
    s_barrier
    s_lshl_b32 s45, s63, 12
    s_lshl_b32 s46, s44, 10
    s_add_u32 s45, s45, s46
    s_add_u32 s45, s45, 0xc000000
    buffer_load_dwordx4 v[64:67], v10, s[12:15], s45 offen sc1
    s_add_u32 s45, s45, 0x800000
    buffer_load_dwordx4 v[68:71], v10, s[12:15], s45 offen sc1
    s_add_u32 s45, s45, 0x800000
    buffer_load_dwordx4 v[72:75], v10, s[12:15], s45 offen sc1
    s_add_u32 s45, s45, 0x800000
    buffer_load_dwordx4 v[76:79], v10, s[12:15], s45 offen sc1
    s_waitcnt vmcnt(4)
    v_lshlrev_b32 v160, 16, v208
    v_and_b32 v161, 0xffff0000, v208
    v_lshlrev_b32 v162, 16, v209
    v_and_b32 v163, 0xffff0000, v209
    s_waitcnt vmcnt(0)
    v_pk_add_f32 v[64:65], v[64:65], v[68:69]
    v_pk_add_f32 v[72:73], v[72:73], v[76:77]
    v_pk_add_f32 v[66:67], v[66:67], v[70:71]
    v_pk_add_f32 v[74:75], v[74:75], v[78:79]
    v_pk_add_f32 v[64:65], v[64:65], v[72:73]
    v_pk_add_f32 v[66:67], v[66:67], v[74:75]
    v_cvt_pk_bf16_f32 v64, v64, v64
    v_lshlrev_b32 v64, 16, v64
    v_cvt_pk_bf16_f32 v65, v65, v65
    v_lshlrev_b32 v65, 16, v65
    v_cvt_pk_bf16_f32 v66, v66, v66
    v_lshlrev_b32 v66, 16, v66
    v_cvt_pk_bf16_f32 v67, v67, v67
    v_lshlrev_b32 v67, 16, v67
    v_add_f32 v64, v64, v18
    v_cvt_pk_bf16_f32 v64, v64, v64
    v_lshlrev_b32 v64, 16, v64
    v_mul_f32 v64, v64, v22
    v_cvt_pk_bf16_f32 v64, v64, v64
    v_lshlrev_b32 v64, 16, v64
    v_add_f32 v64, v64, v160
    v_add_f32 v65, v65, v19
    v_cvt_pk_bf16_f32 v65, v65, v65
    v_lshlrev_b32 v65, 16, v65
    v_mul_f32 v65, v65, v23
    v_cvt_pk_bf16_f32 v65, v65, v65
    v_lshlrev_b32 v65, 16, v65
    v_add_f32 v65, v65, v161
    v_add_f32 v66, v66, v20
    v_cvt_pk_bf16_f32 v66, v66, v66
    v_lshlrev_b32 v66, 16, v66
    v_mul_f32 v66, v66, v24
    v_cvt_pk_bf16_f32 v66, v66, v66
    v_lshlrev_b32 v66, 16, v66
    v_add_f32 v66, v66, v162
    v_add_f32 v67, v67, v21
    v_cvt_pk_bf16_f32 v67, v67, v67
    v_lshlrev_b32 v67, 16, v67
    v_mul_f32 v67, v67, v25
    v_cvt_pk_bf16_f32 v67, v67, v67
    v_lshlrev_b32 v67, 16, v67
    v_add_f32 v67, v67, v163
    v_cvt_pk_bf16_f32 v208, v64, v65
    v_cvt_pk_bf16_f32 v209, v66, v67
    buffer_store_dwordx2 v[208:209], v17, s[32:35], s47 offen
    s_branch L_c_loop_171
L_c_skip_172:
    s_add_u32 s63, s50, s44
    s_lshl_b32 s63, s63, 5
    s_add_u32 s63, s63, s41
    s_lshl_b32 s47, s63, 11
    s_add_u32 s46, s47, 0x800000
    s_cmp_lt_u32 s44, s51
    s_cselect_b32 s46, s46, 0x20000000
    buffer_load_dwordx4 v[208:211], v10, s[12:15], s46 offen sc1
    buffer_load_dwordx4 v[212:215], v10, s[12:15], s46 offen offset:1024 sc1
    s_add_u32 s45, s64, 16384
    s_cmp_lg_u32 s44, 1
    s_cbranch_scc1 L_pw_182
    s_mov_b32 exec_hi, 0
    s_mov_b32 s70, 0
L_wp_183:
    buffer_load_dword v31, v5, s[12:15], s45 offen sc1
    s_add_u32 s70, s70, 1
    s_cmp_ge_u32 s70, 0x200000
    s_cbranch_scc1 L_w_done_98
L_wp_183_c:
    s_waitcnt vmcnt(0)
    v_cmp_gt_u32 vcc, s62, v31
    s_nop 1
    s_cbranch_vccz L_wp_183_ok
    s_sleep 1
    s_branch L_wp_183
L_wp_183_ok:
    s_mov_b64 exec, -1
L_pw_182:
    s_barrier
    s_cmp_ge_u32 s44, s51
    s_cbranch_scc1 L_c_loop_171
    s_lshl_b32 s45, s63, 12
    s_add_u32 s45, s45, 0xc000000
    v_lshlrev_b32 v29, 5, v1
    buffer_load_dwordx4 v[64:67], v29, s[12:15], s45 offen offset:0 sc1
    buffer_load_dwordx4 v[68:71], v29, s[12:15], s45 offen offset:16 sc1
    buffer_load_dwordx4 v[72:75], v29, s[12:15], s45 offen offset:2048 sc1
    buffer_load_dwordx4 v[76:79], v29, s[12:15], s45 offen offset:2064 sc1
    s_add_u32 s45, s45, 0x800000
    buffer_load_dwordx4 v[160:163], v29, s[12:15], s45 offen offset:0 sc1
    buffer_load_dwordx4 v[164:167], v29, s[12:15], s45 offen offset:16 sc1
    buffer_load_dwordx4 v[168:171], v29, s[12:15], s45 offen offset:2048 sc1
    buffer_load_dwordx4 v[172:175], v29, s[12:15], s45 offen offset:2064 sc1
    s_add_u32 s45, s45, 0x800000
    buffer_load_dwordx4 v[176:179], v29, s[12:15], s45 offen offset:0 sc1
    buffer_load_dwordx4 v[180:183], v29, s[12:15], s45 offen offset:16 sc1
    buffer_load_dwordx4 v[184:187], v29, s[12:15], s45 offen offset:2048 sc1
    buffer_load_dwordx4 v[188:191], v29, s[12:15], s45 offen offset:2064 sc1
    s_add_u32 s45, s45, 0x800000
    buffer_load_dwordx4 v[192:195], v29, s[12:15], s45 offen offset:0 sc1
    buffer_load_dwordx4 v[196:199], v29, s[12:15], s45 offen offset:16 sc1
    buffer_load_dwordx4 v[200:203], v29, s[12:15], s45 offen offset:2048 sc1
    buffer_load_dwordx4 v[204:207], v29, s[12:15], s45 offen offset:2064 sc1
    s_waitcnt vmcnt(0)
    v_pk_add_f32 v[64:65], v[64:65], v[160:161]
    v_pk_add_f32 v[176:177], v[176:177], v[192:193]
    v_pk_add_f32 v[66:67], v[66:67], v[162:163]
    v_pk_add_f32 v[178:179], v[178:179], v[194:195]
    v_pk_add_f32 v[68:69], v[68:69], v[164:165]
    v_pk_add_f32 v[180:181], v[180:181], v[196:197]
    v_pk_add_f32 v[70:71], v[70:71], v[166:167]
    v_pk_add_f32 v[182:183], v[182:183], v[198:199]
    v_pk_add_f32 v[72:73], v[72:73], v[168:169]
    v_pk_add_f32 v[184:185], v[184:185], v[200:201]
    v_pk_add_f32 v[74:75], v[74:75], v[170:171]
    v_pk_add_f32 v[186:187], v[186:187], v[202:203]
    v_pk_add_f32 v[76:77], v[76:77], v[172:173]
    v_pk_add_f32 v[188:189], v[188:189], v[204:205]
    v_pk_add_f32 v[78:79], v[78:79], v[174:175]
    v_pk_add_f32 v[190:191], v[190:191], v[206:207]
    v_pk_add_f32 v[64:65], v[64:65], v[176:177]
    v_pk_add_f32 v[66:67], v[66:67], v[178:179]
    v_pk_add_f32 v[68:69], v[68:69], v[180:181]
    v_pk_add_f32 v[70:71], v[70:71], v[182:183]
    v_pk_add_f32 v[72:73], v[72:73], v[184:185]
    v_pk_add_f32 v[74:75], v[74:75], v[186:187]
    v_pk_add_f32 v[76:77], v[76:77], v[188:189]
    v_pk_add_f32 v[78:79], v[78:79], v[190:191]
    v_cvt_pk_bf16_f32 v64, v64, v64
    v_lshlrev_b32 v64, 16, v64
    v_cvt_pk_bf16_f32 v65, v65, v65
    v_lshlrev_b32 v65, 16, v65
    v_cvt_pk_bf16_f32 v66, v66, v66
    v_lshlrev_b32 v66, 16, v66
    v_cvt_pk_bf16_f32 v67, v67, v67
    v_lshlrev_b32 v67, 16, v67
    v_cvt_pk_bf16_f32 v68, v68, v68
    v_lshlrev_b32 v68, 16, v68
    v_cvt_pk_bf16_f32 v69, v69, v69
    v_lshlrev_b32 v69, 16, v69
    v_cvt_pk_bf16_f32 v70, v70, v70
    v_lshlrev_b32 v70, 16, v70
    v_cvt_pk_bf16_f32 v71, v71, v71
    v_lshlrev_b32 v71, 16, v71
    v_cvt_pk_bf16_f32 v72, v72, v72
    v_lshlrev_b32 v72, 16, v72
    v_cvt_pk_bf16_f32 v73, v73, v73
    v_lshlrev_b32 v73, 16, v73
    v_cvt_pk_bf16_f32 v74, v74, v74
    v_lshlrev_b32 v74, 16, v74
    v_cvt_pk_bf16_f32 v75, v75, v75
    v_lshlrev_b32 v75, 16, v75
    v_cvt_pk_bf16_f32 v76, v76, v76
    v_lshlrev_b32 v76, 16, v76
    v_cvt_pk_bf16_f32 v77, v77, v77
    v_lshlrev_b32 v77, 16, v77
    v_cvt_pk_bf16_f32 v78, v78, v78
    v_lshlrev_b32 v78, 16, v78
    v_cvt_pk_bf16_f32 v79, v79, v79
    v_lshlrev_b32 v79, 16, v79
    v_lshlrev_b32 v160, 16, v208
    v_and_b32 v161, 0xffff0000, v208
    v_lshlrev_b32 v162, 16, v209
    v_and_b32 v163, 0xffff0000, v209
    v_lshlrev_b32 v164, 16, v210
    v_and_b32 v165, 0xffff0000, v210
    v_lshlrev_b32 v166, 16, v211
    v_and_b32 v167, 0xffff0000, v211
    v_lshlrev_b32 v168, 16, v212
    v_and_b32 v169, 0xffff0000, v212
    v_lshlrev_b32 v170, 16, v213
    v_and_b32 v171, 0xffff0000, v213
    v_lshlrev_b32 v172, 16, v214
    v_and_b32 v173, 0xffff0000, v214
    v_lshlrev_b32 v174, 16, v215
    v_and_b32 v175, 0xffff0000, v215
    v_add_f32 v64, v64, v96
    v_cvt_pk_bf16_f32 v64, v64, v64
    v_lshlrev_b32 v64, 16, v64
    v_mul_f32 v64, v64, v112
    v_cvt_pk_bf16_f32 v64, v64, v64
    v_lshlrev_b32 v64, 16, v64
    v_add_f32 v64, v64, v160
    v_add_f32 v65, v65, v97
    v_cvt_pk_bf16_f32 v65, v65, v65
    v_lshlrev_b32 v65, 16, v65
    v_mul_f32 v65, v65, v113
    v_cvt_pk_bf16_f32 v65, v65, v65
    v_lshlrev_b32 v65, 16, v65
    v_add_f32 v65, v65, v161
    v_add_f32 v66, v66, v98
    v_cvt_pk_bf16_f32 v66, v66, v66
    v_lshlrev_b32 v66, 16, v66
    v_mul_f32 v66, v66, v114
    v_cvt_pk_bf16_f32 v66, v66, v66
    v_lshlrev_b32 v66, 16, v66
    v_add_f32 v66, v66, v162
    v_add_f32 v67, v67, v99
    v_cvt_pk_bf16_f32 v67, v67, v67
    v_lshlrev_b32 v67, 16, v67
    v_mul_f32 v67, v67, v115
    v_cvt_pk_bf16_f32 v67, v67, v67
    v_lshlrev_b32 v67, 16, v67
    v_add_f32 v67, v67, v163
    v_add_f32 v68, v68, v100
    v_cvt_pk_bf16_f32 v68, v68, v68
    v_lshlrev_b32 v68, 16, v68
    v_mul_f32 v68, v68, v116
    v_cvt_pk_bf16_f32 v68, v68, v68
    v_lshlrev_b32 v68, 16, v68
    v_add_f32 v68, v68, v164
    v_add_f32 v69, v69, v101
    v_cvt_pk_bf16_f32 v69, v69, v69
    v_lshlrev_b32 v69, 16, v69
    v_mul_f32 v69, v69, v117
    v_cvt_pk_bf16_f32 v69, v69, v69
    v_lshlrev_b32 v69, 16, v69
    v_add_f32 v69, v69, v165
    v_add_f32 v70, v70, v102
    v_cvt_pk_bf16_f32 v70, v70, v70
    v_lshlrev_b32 v70, 16, v70
    v_mul_f32 v70, v70, v118
    v_cvt_pk_bf16_f32 v70, v70, v70
    v_lshlrev_b32 v70, 16, v70
    v_add_f32 v70, v70, v166
    v_add_f32 v71, v71, v103
    v_cvt_pk_bf16_f32 v71, v71, v71
    v_lshlrev_b32 v71, 16, v71
    v_mul_f32 v71, v71, v119
    v_cvt_pk_bf16_f32 v71, v71, v71
    v_lshlrev_b32 v71, 16, v71
    v_add_f32 v71, v71, v167
    v_add_f32 v72, v72, v104
    v_cvt_pk_bf16_f32 v72, v72, v72
    v_lshlrev_b32 v72, 16, v72
    v_mul_f32 v72, v72, v120
    v_cvt_pk_bf16_f32 v72, v72, v72
    v_lshlrev_b32 v72, 16, v72
    v_add_f32 v72, v72, v168
    v_add_f32 v73, v73, v105
    v_cvt_pk_bf16_f32 v73, v73, v73
    v_lshlrev_b32 v73, 16, v73
    v_mul_f32 v73, v73, v121
    v_cvt_pk_bf16_f32 v73, v73, v73
    v_lshlrev_b32 v73, 16, v73
    v_add_f32 v73, v73, v169
    v_add_f32 v74, v74, v106
    v_cvt_pk_bf16_f32 v74, v74, v74
    v_lshlrev_b32 v74, 16, v74
    v_mul_f32 v74, v74, v122
    v_cvt_pk_bf16_f32 v74, v74, v74
    v_lshlrev_b32 v74, 16, v74
    v_add_f32 v74, v74, v170
    v_add_f32 v75, v75, v107
    v_cvt_pk_bf16_f32 v75, v75, v75
    v_lshlrev_b32 v75, 16, v75
    v_mul_f32 v75, v75, v123
    v_cvt_pk_bf16_f32 v75, v75, v75
    v_lshlrev_b32 v75, 16, v75
    v_add_f32 v75, v75, v171
    v_add_f32 v76, v76, v108
    v_cvt_pk_bf16_f32 v76, v76, v76
    v_lshlrev_b32 v76, 16, v76
    v_mul_f32 v76, v76, v124
    v_cvt_pk_bf16_f32 v76, v76, v76
    v_lshlrev_b32 v76, 16, v76
    v_add_f32 v76, v76, v172
    v_add_f32 v77, v77, v109
    v_cvt_pk_bf16_f32 v77, v77, v77
    v_lshlrev_b32 v77, 16, v77
    v_mul_f32 v77, v77, v125
    v_cvt_pk_bf16_f32 v77, v77, v77
    v_lshlrev_b32 v77, 16, v77
    v_add_f32 v77, v77, v173
    v_add_f32 v78, v78, v110
    v_cvt_pk_bf16_f32 v78, v78, v78
    v_lshlrev_b32 v78, 16, v78
    v_mul_f32 v78, v78, v126
    v_cvt_pk_bf16_f32 v78, v78, v78
    v_lshlrev_b32 v78, 16, v78
    v_add_f32 v78, v78, v174
    v_add_f32 v79, v79, v111
    v_cvt_pk_bf16_f32 v79, v79, v79
    v_lshlrev_b32 v79, 16, v79
    v_mul_f32 v79, v79, v127
    v_cvt_pk_bf16_f32 v79, v79, v79
    v_lshlrev_b32 v79, 16, v79
    v_add_f32 v79, v79, v175
    v_cvt_pk_bf16_f32 v208, v64, v65
    v_cvt_pk_bf16_f32 v209, v66, v67
    v_cvt_pk_bf16_f32 v210, v68, v69
    v_cvt_pk_bf16_f32 v211, v70, v71
    v_cvt_pk_bf16_f32 v212, v72, v73
    v_cvt_pk_bf16_f32 v213, v74, v75
    v_cvt_pk_bf16_f32 v214, v76, v77
    v_cvt_pk_bf16_f32 v215, v78, v79
    buffer_store_dwordx4 v[208:211], v10, s[32:35], s47 offen
    buffer_store_dwordx4 v[212:215], v10, s[32:35], s47 offen offset:1024
    s_branch L_c_loop_171
L_w_done_98:
    s_endpgm
.section .rodata,"a"
.p2align 6
.amdhsa_kernel adaLN_cond__memory_aug_recurrent_mem_tr__dense_activation_gelu__prompt_kernel
  .amdhsa_next_free_vgpr 512
  .amdhsa_next_free_sgpr 102
  .amdhsa_accum_offset 256
  .amdhsa_group_segment_fixed_size 0
  .amdhsa_kernarg_size 136
  .amdhsa_user_sgpr_count 2
  .amdhsa_user_sgpr_kernarg_segment_ptr 1
  .amdhsa_system_sgpr_workgroup_id_x 1
.end_amdhsa_kernel
```

```asm
; @launch kernel=adaLN_cond__memory_aug_recurrent_mem_tr__dense_activation_gelu__prompt_kernel grid=(256,1,1) block=(256,1,1) lds=163840
.amdgcn_target "amdgcn-amd-amdhsa--gfx950"
.text
.globl adaLN_cond__memory_aug_recurrent_mem_tr__dense_activation_gelu__prompt_kernel
.p2align 8
.type adaLN_cond__memory_aug_recurrent_mem_tr__dense_activation_gelu__prompt_kernel,@function
adaLN_cond__memory_aug_recurrent_mem_tr__dense_activation_gelu__prompt_kernel:
    s_cmp_lt_u32 s2, 256
    s_cbranch_scc1 L_c_done_1_go
    s_endpgm
L_c_done_1_go:
    s_and_b32 s40, s2, 7
    s_load_dwordx4 s[4:7], s[0:1], 16
    s_load_dwordx4 s[8:11], s[0:1], 32
    s_load_dwordx2 s[20:21], s[0:1], 128
    s_load_dwordx2 s[22:23], s[0:1], 120
    s_load_dwordx2 s[50:51], s[0:1], 8
    s_lshr_b32 s41, s2, 3
    s_and_b32 s42, s41, 15
    v_and_b32 v1, 63, v0
    v_lshrrev_b32 v2, 6, v0
    s_nop 0
    v_readfirstlane_b32 s44, v2
    s_waitcnt lgkmcnt(0)
    s_mov_b32 s24, s4
    s_and_b32 s25, s5, 0xffff
    s_mov_b32 s26, 0x800000
    s_mov_b32 s27, 0x00020000
    s_mov_b32 s28, s6
    s_and_b32 s29, s7, 0xffff
    s_mov_b32 s30, 0x800000
    s_mov_b32 s31, 0x00020000
    s_mov_b32 s32, s8
    s_and_b32 s33, s9, 0xffff
    s_mov_b32 s34, 0x800000
    s_mov_b32 s35, 0x00020000
    s_mov_b32 s36, s10
    s_and_b32 s37, s11, 0xffff
    s_mov_b32 s38, 0x800000
    s_mov_b32 s39, 0x00020000
    s_mov_b32 s12, s20
    s_and_b32 s13, s21, 0xffff
    s_mov_b32 s14, 0x10000000
    s_mov_b32 s15, 0x00020000
    s_mov_b32 s16, s22
    s_and_b32 s17, s23, 0xffff
    s_mov_b32 s18, 0x100
    s_mov_b32 s19, 0x00020000
    s_mov_b32 s52, s50
    s_and_b32 s53, s51, 0xffff
    s_mov_b32 s54, 0x4000
    s_mov_b32 s55, 0x00020000
    v_mov_b32 v41, 0
    s_cmp_lg_u32 s2, 1
    s_cbranch_scc1 L_worker_3_a
    s_getreg_b32 s45, hwreg(HW_REG_XCC_ID)
    s_and_b32 s45, s45, 1
    s_add_u32 s45, s45, 1
    v_mov_b32 v40, s45
    buffer_store_dword v40, v41, s[16:19], 0 offen offset:24 sc1
L_worker_3_a:
    s_cmp_lt_u32 s40, 3
    s_cbranch_scc1 L_worker_3_b
    s_sub_u32 s40, s40, 2
    s_branch L_worker_3
L_worker_3_b:
    s_cmp_eq_u32 s40, 1
    s_cbranch_scc1 L_worker_3_g0
    s_mov_b32 s70, 0
L_worker_3_p:
    buffer_load_dword v40, v41, s[16:19], 0 offen offset:24 sc1
    s_add_u32 s70, s70, 1
    s_cmp_ge_u32 s70, 0x200000
    s_cbranch_scc1 L_c_done_1
    s_waitcnt vmcnt(0)
    v_readfirstlane_b32 s45, v40
    s_nop 3
    s_cmp_eq_u32 s45, 0
    s_cbranch_scc1 L_worker_3_p
    s_and_b32 s45, s45, 2
    s_cmp_lg_u32 s45, s40
    s_mov_b32 s40, 1
    s_cbranch_scc1 L_worker_3_no
    s_mov_b32 s40, 0
    s_branch L_worker_3
L_worker_3_g0:
    s_mov_b32 s40, 0
L_worker_3_no:
    s_lshl_b32 s43, s40, 4
    s_add_u32 s43, s43, s42
    s_lshl_b32 s3, s43, 7
    s_lshr_b32 s45, s41, 4
    s_lshl_b32 s45, s45, 4
    s_add_u32 s3, s3, s45
    s_lshl_b32 s45, s44, 2
    s_add_u32 s3, s3, s45
    s_add_u32 s3, s3, 0x11000
    v_and_b32 v21, 8, v1
    v_cmp_eq_u32 s[56:57], 0, v21
    v_mov_b32 v2, 0xeeee
    v_mov_b32 v3, 0x4444
    v_cndmask_b32 v2, v2, v3, s[56:57]
    v_lshlrev_b32 v68, 4, v1
    s_lshl_b32 s45, s44, 12
    v_add_u32 v3, s45, v68
    v_add_u32 v4, 4096, v3
    v_and_b32 v4, 16383, v4
    v_add_u32 v21, 8192, v3
    v_and_b32 v21, 16383, v21
    v_add_u32 v23, 12288, v3
    v_and_b32 v23, 16383, v23
    s_mul_i32 s45, s44, 24576
    s_add_u32 s45, s45, 65536
    v_add_u32 v5, s45, v68
    v_lshrrev_b32 v63, 4, v1
    s_lshl_b32 s45, s44, 2
    v_add_u32 v64, s45, v63
    s_lshr_b32 s45, s44, 1
    s_lshl_b32 s45, s45, 2
    v_add_u32 v65, s45, v63
    v_bfe_u32 v66, v1, 1, 3
    v_xor_b32 v66, v66, v65
    v_lshlrev_b32 v66, 5, v66
    v_and_b32 v67, 1, v1
    v_lshlrev_b32 v67, 4, v67
    v_add_u32 v66, v66, v67
    v_lshlrev_b32 v64, 13, v64
    v_add_u32 v82, v64, v66
    s_lshl_b32 s47, s43, 8
    s_lshl_b32 s48, s44, 10
    v_bfe_u32 v64, v1, 2, 2
    v_bfe_u32 v65, v1, 4, 1
    v_lshlrev_b32 v65, 2, v65
    v_add_u32 v65, v65, v64
    v_lshlrev_b32 v66, 3, v63
    v_add_u32 v66, v66, v64
    v_lshlrev_b32 v66, 8, v66
    v_and_b32 v67, 3, v1
    v_lshlrev_b32 v67, 3, v67
    v_add_u32 v66, v66, v67
    s_lshl_b32 s45, s44, 1
    v_xor_b32 v65, s45, v65
    v_lshlrev_b32 v65, 5, v65
    v_add_u32 v80, v66, v65
    v_xor_b32 v81, 32, v80
    v_lshrrev_b32 v64, 5, v1
    v_mul_u32_u24 v64, 20480, v64
    v_add_u32 v64, 65536, v64
    v_add_u32 v84, v64, v80
    v_add_u32 v85, v64, v81
    v_add_u32 v86, 49152, v84
    v_add_u32 v87, 49152, v85
    v_mov_b32 v40, -1
    v_mov_b32 v41, -1
    v_mov_b32 v42, -1
    v_mov_b32 v43, -1
    v_mov_b32 v44, 0
    s_mov_b32 s68, 0
    s_cmp_ge_u32 s41, 16
    s_cbranch_scc1 L_c_vo_2
    s_lshl_b32 s45, s42, 11
    s_lshr_b32 s46, s44, 1
    s_lshl_b32 s46, s46, 10
    s_add_u32 s45, s45, s46
    s_and_b32 s46, s44, 1
    s_lshl_b32 s46, s46, 7
    s_add_u32 s45, s45, s46
    v_add_u32 v17, s45, v68
    v_mov_b32 v63, 0x20000000
    v_cndmask_b32 v17, v63, v17, s[56:57]
    s_lshl_b32 s62, s40, 17
    s_add_u32 s62, s62, 0x7040000
    s_add_u32 s63, s62, 0
    buffer_store_dwordx4 v[40:43], v17, s[12:15], s63 offen sc1
    s_add_u32 s63, s62, 32768
    buffer_store_dwordx4 v[40:43], v17, s[12:15], s63 offen sc1
    s_add_u32 s63, s62, 65536
    buffer_store_dwordx4 v[40:43], v17, s[12:15], s63 offen sc1
    s_add_u32 s63, s62, 98304
    buffer_store_dwordx4 v[40:43], v17, s[12:15], s63 offen sc1
    s_mov_b64 exec, -1
    s_lshl_b32 s45, s40, 12
    s_lshl_b32 s46, s42, 4
    s_add_u32 s45, s45, s46
    s_add_u32 s45, s45, 0x7080000
    s_lshl_b32 s46, s44, 2
    s_add_u32 s45, s45, s46
    v_lshlrev_b32 v20, 8, v1
    v_add_u32 v20, s45, v20
    v_cmp_gt_u32 vcc, 16, v1
    s_nop 1
    v_cndmask_b32 v20, v63, v20, vcc
    buffer_store_dword v44, v20, s[12:15], 0 offen sc1
    s_lshl_b32 s45, s43, 7
    s_add_u32 s45, s45, 0x10010
    v_lshlrev_b32 v64, 2, v1
    s_mov_b64 exec, 0xff
    buffer_store_dword v44, v64, s[12:15], s45 offen sc1
    s_mov_b64 exec, 1
    v_mov_b32 v65, 63
    buffer_store_dword v44, v64, s[12:15], s3 offen sc1
    buffer_store_dword v65, v64, s[12:15], s3 offen offset:16 sc1
    s_mov_b64 exec, 0xffff
    v_lshlrev_b32 v64, 7, v1
    s_cmp_eq_u32 s2, 1
    s_mov_b32 s45, 0x1f000
    s_cselect_b32 s45, s45, 0x20000000
    buffer_store_dword v44, v64, s[12:15], s45 offen sc1
    s_mov_b64 exec, -1
    s_add_u32 s79, s41, 0
    s_and_b32 s79, s79, 3
    s_lshl_b32 s79, s79, 19
    s_add_u32 s79, s79, s47
    s_add_u32 s46, s79, 0x0
    s_add_u32 m0, s48, 65536
    s_nop 0
    buffer_load_dwordx4 v82, s[24:27], s46 offen  lds
    s_add_u32 s46, s79, 0x20000
    s_add_u32 m0, s48, 90112
    s_nop 0
    buffer_load_dwordx4 v82, s[24:27], s46 offen  lds
    s_add_u32 s46, s79, 0x40000
    s_add_u32 m0, s48, 114688
    s_nop 0
    buffer_load_dwordx4 v82, s[24:27], s46 offen  lds
    s_add_u32 s46, s79, 0x60000
    s_add_u32 m0, s48, 139264
    s_nop 0
    buffer_load_dwordx4 v82, s[24:27], s46 offen  lds
    s_add_u32 s79, s41, 1
    s_and_b32 s79, s79, 3
    s_lshl_b32 s79, s79, 19
    s_add_u32 s79, s79, s47
    s_add_u32 s46, s79, 0x0
    s_add_u32 m0, s48, 69632
    s_nop 0
    buffer_load_dwordx4 v82, s[24:27], s46 offen  lds
    s_add_u32 s46, s79, 0x20000
    s_add_u32 m0, s48, 94208
    s_nop 0
    buffer_load_dwordx4 v82, s[24:27], s46 offen  lds
    s_add_u32 s46, s79, 0x40000
    s_add_u32 m0, s48, 118784
    s_nop 0
    buffer_load_dwordx4 v82, s[24:27], s46 offen  lds
    s_add_u32 s46, s79, 0x60000
    s_add_u32 m0, s48, 143360
    s_nop 0
    buffer_load_dwordx4 v82, s[24:27], s46 offen  lds
    s_add_u32 s79, s41, 2
    s_and_b32 s79, s79, 3
    s_lshl_b32 s79, s79, 19
    s_add_u32 s79, s79, s47
    s_add_u32 s46, s79, 0x0
    s_add_u32 m0, s48, 73728
    s_nop 0
    buffer_load_dwordx4 v82, s[24:27], s46 offen  lds
    s_add_u32 s46, s79, 0x20000
    s_add_u32 m0, s48, 98304
    s_nop 0
    buffer_load_dwordx4 v82, s[24:27], s46 offen  lds
    s_add_u32 s46, s79, 0x40000
    s_add_u32 m0, s48, 122880
    s_nop 0
    buffer_load_dwordx4 v82, s[24:27], s46 offen  lds
    s_add_u32 s46, s79, 0x60000
    s_add_u32 m0, s48, 147456
    s_nop 0
    buffer_load_dwordx4 v82, s[24:27], s46 offen  lds
    s_add_u32 s79, s41, 3
    s_and_b32 s79, s79, 3
    s_lshl_b32 s79, s79, 19
    s_add_u32 s79, s79, s47
    s_add_u32 s46, s79, 0x0
    s_add_u32 m0, s48, 0
    s_nop 0
    buffer_load_dwordx4 v82, s[24:27], s46 offen  lds
    s_add_u32 s46, s79, 0x20000
    s_add_u32 m0, s48, 4096
    s_nop 0
    buffer_load_dwordx4 v82, s[24:27], s46 offen  lds
    s_add_u32 s46, s79, 0x40000
    s_add_u32 m0, s48, 8192
    s_nop 0
    buffer_load_dwordx4 v82, s[24:27], s46 offen  lds
    s_add_u32 s46, s79, 0x60000
    s_add_u32 m0, s48, 12288
    s_nop 0
    buffer_load_dwordx4 v82, s[24:27], s46 offen  lds
    s_add_u32 s79, s41, 4
    s_and_b32 s79, s79, 3
    s_lshl_b32 s79, s79, 19
    s_add_u32 s79, s79, s47
    s_add_u32 s46, s79, 0x200000
    s_add_u32 m0, s48, 16384
    s_nop 0
    buffer_load_dwordx4 v82, s[24:27], s46 offen  lds
    s_add_u32 s46, s79, 0x220000
    s_add_u32 m0, s48, 20480
    s_nop 0
    buffer_load_dwordx4 v82, s[24:27], s46 offen  lds
    s_add_u32 s46, s79, 0x240000
    s_add_u32 m0, s48, 24576
    s_nop 0
    buffer_load_dwordx4 v82, s[24:27], s46 offen  lds
    s_add_u32 s46, s79, 0x260000
    s_add_u32 m0, s48, 28672
    s_nop 0
    buffer_load_dwordx4 v82, s[24:27], s46 offen  lds
    s_add_u32 s79, s41, 5
    s_and_b32 s79, s79, 3
    s_lshl_b32 s79, s79, 19
    s_add_u32 s79, s79, s47
    s_add_u32 s46, s79, 0x200000
    s_add_u32 m0, s48, 32768
    s_nop 0
    buffer_load_dwordx4 v82, s[24:27], s46 offen  lds
    s_add_u32 s46, s79, 0x220000
    s_add_u32 m0, s48, 36864
    s_nop 0
    buffer_load_dwordx4 v82, s[24:27], s46 offen  lds
    s_add_u32 s46, s79, 0x240000
    s_add_u32 m0, s48, 40960
    s_nop 0
    buffer_load_dwordx4 v82, s[24:27], s46 offen  lds
    s_add_u32 s46, s79, 0x260000
    s_add_u32 m0, s48, 45056
    s_nop 0
    buffer_load_dwordx4 v82, s[24:27], s46 offen  lds
    s_add_u32 s79, s41, 6
    s_and_b32 s79, s79, 3
    s_lshl_b32 s79, s79, 19
    s_add_u32 s79, s79, s47
    s_add_u32 s46, s79, 0x200000
    s_add_u32 m0, s48, 49152
    s_nop 0
    buffer_load_dwordx4 v82, s[24:27], s46 offen  lds
    s_add_u32 s46, s79, 0x220000
    s_add_u32 m0, s48, 53248
    s_nop 0
    buffer_load_dwordx4 v82, s[24:27], s46 offen  lds
    s_add_u32 s46, s79, 0x240000
    s_add_u32 m0, s48, 57344
    s_nop 0
    buffer_load_dwordx4 v82, s[24:27], s46 offen  lds
    s_add_u32 s46, s79, 0x260000
    s_add_u32 m0, s48, 61440
    s_nop 0
    buffer_load_dwordx4 v82, s[24:27], s46 offen  lds
    s_add_u32 s79, s41, 7
    s_and_b32 s79, s79, 3
    s_lshl_b32 s79, s79, 19
    s_add_u32 s79, s79, s47
    s_add_u32 s46, s79, 0x200000
    s_add_u32 m0, s48, 77824
    s_nop 0
    buffer_load_dwordx4 v82, s[24:27], s46 offen  lds
    s_add_u32 s46, s79, 0x220000
    s_add_u32 m0, s48, 102400
    s_nop 0
    buffer_load_dwordx4 v82, s[24:27], s46 offen  lds
    s_add_u32 s46, s79, 0x240000
    s_add_u32 m0, s48, 126976
    s_nop 0
    buffer_load_dwordx4 v82, s[24:27], s46 offen  lds
    s_add_u32 s46, s79, 0x260000
    s_add_u32 m0, s48, 151552
    s_nop 0
    buffer_load_dwordx4 v82, s[24:27], s46 offen  lds
    s_add_u32 s79, s41, 8
    s_and_b32 s79, s79, 3
    s_lshl_b32 s79, s79, 19
    s_add_u32 s79, s79, s47
    s_add_u32 s46, s79, 0x400000
    s_add_u32 m0, s48, 81920
    s_nop 0
    buffer_load_dwordx4 v82, s[24:27], s46 offen  lds
    s_add_u32 s46, s79, 0x420000
    s_add_u32 m0, s48, 106496
    s_nop 0
    buffer_load_dwordx4 v82, s[24:27], s46 offen  lds
    s_add_u32 s46, s79, 0x440000
    s_add_u32 m0, s48, 131072
    s_nop 0
    buffer_load_dwordx4 v82, s[24:27], s46 offen  lds
    s_add_u32 s46, s79, 0x460000
    s_add_u32 m0, s48, 155648
    s_nop 0
    buffer_load_dwordx4 v82, s[24:27], s46 offen  lds
    s_add_u32 s79, s41, 9
    s_and_b32 s79, s79, 3
    s_lshl_b32 s79, s79, 19
    s_add_u32 s79, s79, s47
    s_add_u32 s46, s79, 0x400000
    s_add_u32 m0, s48, 86016
    s_nop 0
    buffer_load_dwordx4 v82, s[24:27], s46 offen  lds
    s_add_u32 s46, s79, 0x420000
    s_add_u32 m0, s48, 110592
    s_nop 0
    buffer_load_dwordx4 v82, s[24:27], s46 offen  lds
    s_add_u32 s46, s79, 0x440000
    s_add_u32 m0, s48, 135168
    s_nop 0
    buffer_load_dwordx4 v82, s[24:27], s46 offen  lds
    s_add_u32 s46, s79, 0x460000
    s_add_u32 m0, s48, 159744
    s_nop 0
    buffer_load_dwordx4 v82, s[24:27], s46 offen  lds
    s_waitcnt vmcnt(36)
    s_barrier
    s_cmp_lg_u32 s44, 0
    s_cbranch_scc1 L_lw_4_0
    ds_read_b64_tr_b16 a[0:1], v84 offset:0
    ds_read_b64_tr_b16 a[2:3], v84 offset:1024
    ds_read_b64_tr_b16 a[4:5], v86 offset:0
    ds_read_b64_tr_b16 a[6:7], v86 offset:1024
    ds_read_b64_tr_b16 a[8:9], v85 offset:0
    ds_read_b64_tr_b16 a[10:11], v85 offset:1024
    ds_read_b64_tr_b16 a[12:13], v87 offset:0
    ds_read_b64_tr_b16 a[14:15], v87 offset:1024
    s_branch L_lw_4
L_lw_4_0:
    s_cmp_lg_u32 s44, 1
    s_cbranch_scc1 L_lw_4_1
    ds_read_b64_tr_b16 v[128:129], v84 offset:0
    ds_read_b64_tr_b16 v[130:131], v84 offset:1024
    ds_read_b64_tr_b16 v[132:133], v86 offset:0
    ds_read_b64_tr_b16 v[134:135], v86 offset:1024
    ds_read_b64_tr_b16 v[136:137], v85 offset:0
    ds_read_b64_tr_b16 v[138:139], v85 offset:1024
    ds_read_b64_tr_b16 v[140:141], v87 offset:0
    ds_read_b64_tr_b16 v[142:143], v87 offset:1024
    s_branch L_lw_4
L_lw_4_1:
    s_cmp_lg_u32 s44, 2
    s_cbranch_scc1 L_lw_4_2
    ds_read_b64_tr_b16 a[192:193], v84 offset:0
    ds_read_b64_tr_b16 a[194:195], v84 offset:1024
    ds_read_b64_tr_b16 a[196:197], v86 offset:0
    ds_read_b64_tr_b16 a[198:199], v86 offset:1024
    ds_read_b64_tr_b16 v[24:25], v85 offset:0
    ds_read_b64_tr_b16 v[26:27], v85 offset:1024
    ds_read_b64_tr_b16 v[28:29], v87 offset:0
    ds_read_b64_tr_b16 v[30:31], v87 offset:1024
    s_branch L_lw_4
L_lw_4_2:
    ds_read_b64_tr_b16 a[96:97], v84 offset:0
    ds_read_b64_tr_b16 a[98:99], v84 offset:1024
    ds_read_b64_tr_b16 a[100:101], v86 offset:0
    ds_read_b64_tr_b16 a[102:103], v86 offset:1024
    ds_read_b64_tr_b16 v[32:33], v85 offset:0
    ds_read_b64_tr_b16 v[34:35], v85 offset:1024
    ds_read_b64_tr_b16 v[36:37], v87 offset:0
    ds_read_b64_tr_b16 v[38:39], v87 offset:1024
L_lw_4:
    s_waitcnt lgkmcnt(0)
    s_waitcnt vmcnt(32)
    s_barrier
    s_cmp_lg_u32 s44, 0
    s_cbranch_scc1 L_hs_5
    s_getreg_b32 s45, hwreg(HW_REG_XCC_ID)
    s_and_b32 s45, s45, 15
    s_mul_i32 s46, s45, s45
    s_lshl_b32 s46, s46, 9
    s_add_u32 s45, s45, s46
    s_cmp_eq_u32 s40, 0
    s_cselect_b32 s46, s45, 0
    s_cselect_b32 s45, 0, s45
    s_lshl_b32 s68, s68, 24
    s_add_u32 s46, s46, s68
    s_add_u32 s45, s45, 16777216
    v_mov_b32 v40, s46
    v_mov_b32 v41, s45
    v_mov_b32 v42, 0
    s_mov_b64 exec, 1
    buffer_atomic_add_x2 v[40:41], v42, s[16:19], 0 offen sc1
    v_mov_b32 v43, 1
    buffer_atomic_add v43, v42, s[16:19], 0 offen offset:8 sc1
    s_mov_b64 exec, -1
L_hs_5:
    s_cmp_lg_u32 s44, 0
    s_cbranch_scc1 L_lw_6_0
    ds_read_b64_tr_b16 a[32:33], v84 offset:4096
    ds_read_b64_tr_b16 a[34:35], v84 offset:5120
    ds_read_b64_tr_b16 a[36:37], v86 offset:4096
    ds_read_b64_tr_b16 a[38:39], v86 offset:5120
    ds_read_b64_tr_b16 a[40:41], v85 offset:4096
    ds_read_b64_tr_b16 a[42:43], v85 offset:5120
    ds_read_b64_tr_b16 a[44:45], v87 offset:4096
    ds_read_b64_tr_b16 a[46:47], v87 offset:5120
    s_branch L_lw_6
L_lw_6_0:
    s_cmp_lg_u32 s44, 1
    s_cbranch_scc1 L_lw_6_1
    ds_read_b64_tr_b16 v[160:161], v84 offset:4096
    ds_read_b64_tr_b16 v[162:163], v84 offset:5120
    ds_read_b64_tr_b16 v[164:165], v86 offset:4096
    ds_read_b64_tr_b16 v[166:167], v86 offset:5120
    ds_read_b64_tr_b16 v[168:169], v85 offset:4096
    ds_read_b64_tr_b16 v[170:171], v85 offset:5120
    ds_read_b64_tr_b16 v[172:173], v87 offset:4096
    ds_read_b64_tr_b16 v[174:175], v87 offset:5120
    s_branch L_lw_6
L_lw_6_1:
    s_cmp_lg_u32 s44, 2
    s_cbranch_scc1 L_lw_6_2
    ds_read_b64_tr_b16 a[216:217], v84 offset:4096
    ds_read_b64_tr_b16 a[218:219], v84 offset:5120
    ds_read_b64_tr_b16 a[220:221], v86 offset:4096
    ds_read_b64_tr_b16 a[222:223], v86 offset:5120
    ds_read_b64_tr_b16 v[48:49], v85 offset:4096
    ds_read_b64_tr_b16 v[50:51], v85 offset:5120
    ds_read_b64_tr_b16 v[52:53], v87 offset:4096
    ds_read_b64_tr_b16 v[54:55], v87 offset:5120
    s_branch L_lw_6
L_lw_6_2:
    ds_read_b64_tr_b16 a[120:121], v84 offset:4096
    ds_read_b64_tr_b16 a[122:123], v84 offset:5120
    ds_read_b64_tr_b16 a[124:125], v86 offset:4096
    ds_read_b64_tr_b16 a[126:127], v86 offset:5120
    ds_read_b64_tr_b16 v[64:65], v85 offset:4096
    ds_read_b64_tr_b16 v[66:67], v85 offset:5120
    ds_read_b64_tr_b16 v[68:69], v87 offset:4096
    ds_read_b64_tr_b16 v[70:71], v87 offset:5120
L_lw_6:
    s_waitcnt lgkmcnt(0)
    s_waitcnt vmcnt(28)
    s_barrier
    s_cmp_lg_u32 s44, 0
    s_cbranch_scc1 L_lw_7_0
    ds_read_b64_tr_b16 a[64:65], v84 offset:8192
    ds_read_b64_tr_b16 a[66:67], v84 offset:9216
    ds_read_b64_tr_b16 a[68:69], v86 offset:8192
    ds_read_b64_tr_b16 a[70:71], v86 offset:9216
    ds_read_b64_tr_b16 v[72:73], v85 offset:8192
    ds_read_b64_tr_b16 v[74:75], v85 offset:9216
    ds_read_b64_tr_b16 v[76:77], v87 offset:8192
    ds_read_b64_tr_b16 v[78:79], v87 offset:9216
    s_branch L_lw_7
L_lw_7_0:
    s_cmp_lg_u32 s44, 1
    s_cbranch_scc1 L_lw_7_1
    ds_read_b64_tr_b16 v[192:193], v84 offset:8192
    ds_read_b64_tr_b16 v[194:195], v84 offset:9216
    ds_read_b64_tr_b16 v[196:197], v86 offset:8192
    ds_read_b64_tr_b16 v[198:199], v86 offset:9216
    ds_read_b64_tr_b16 v[200:201], v85 offset:8192
    ds_read_b64_tr_b16 v[202:203], v85 offset:9216
    ds_read_b64_tr_b16 v[204:205], v87 offset:8192
    ds_read_b64_tr_b16 v[206:207], v87 offset:9216
    s_branch L_lw_7
L_lw_7_1:
    s_cmp_lg_u32 s44, 2
    s_cbranch_scc1 L_lw_7_2
    ds_read_b64_tr_b16 a[240:241], v84 offset:8192
    ds_read_b64_tr_b16 a[242:243], v84 offset:9216
    ds_read_b64_tr_b16 a[244:245], v86 offset:8192
    ds_read_b64_tr_b16 a[246:247], v86 offset:9216
    ds_read_b64_tr_b16 v[88:89], v85 offset:8192
    ds_read_b64_tr_b16 v[90:91], v85 offset:9216
    ds_read_b64_tr_b16 v[92:93], v87 offset:8192
    ds_read_b64_tr_b16 v[94:95], v87 offset:9216
    s_branch L_lw_7
L_lw_7_2:
    ds_read_b64_tr_b16 a[144:145], v84 offset:8192
    ds_read_b64_tr_b16 a[146:147], v84 offset:9216
    ds_read_b64_tr_b16 a[148:149], v86 offset:8192
    ds_read_b64_tr_b16 a[150:151], v86 offset:9216
    ds_read_b64_tr_b16 v[56:57], v85 offset:8192
    ds_read_b64_tr_b16 v[58:59], v85 offset:9216
    ds_read_b64_tr_b16 v[60:61], v87 offset:8192
    ds_read_b64_tr_b16 v[62:63], v87 offset:9216
    s_waitcnt lgkmcnt(0)
    ds_write_b128 v5, v[56:59] offset:0
    ds_write_b128 v5, v[60:63] offset:1024
L_lw_7:
    s_waitcnt lgkmcnt(0)
    s_waitcnt vmcnt(24)
    s_barrier
    s_add_u32 s79, s41, 10
    s_and_b32 s79, s79, 3
    s_lshl_b32 s79, s79, 19
    s_add_u32 s79, s79, s47
    s_add_u32 s46, s79, 0x400000
    s_add_u32 m0, s48, 73728
    s_nop 0
    buffer_load_dwordx4 v82, s[24:27], s46 offen  lds
    s_add_u32 s46, s79, 0x420000
    s_add_u32 m0, s48, 98304
    s_nop 0
    buffer_load_dwordx4 v82, s[24:27], s46 offen  lds
    s_add_u32 s46, s79, 0x440000
    s_add_u32 m0, s48, 122880
    s_nop 0
    buffer_load_dwordx4 v82, s[24:27], s46 offen  lds
    s_add_u32 s46, s79, 0x460000
    s_add_u32 m0, s48, 147456
    s_nop 0
    buffer_load_dwordx4 v82, s[24:27], s46 offen  lds
    s_cmp_lg_u32 s44, 0
    s_cbranch_scc1 L_lw_8_0
    ds_read_b64_tr_b16 a[80:81], v80 offset:0
    ds_read_b64_tr_b16 a[82:83], v80 offset:1024
    ds_read_b64_tr_b16 a[84:85], v80 offset:8192
    ds_read_b64_tr_b16 a[86:87], v80 offset:9216
    ds_read_b64_tr_b16 v[56:57], v81 offset:0
    ds_read_b64_tr_b16 v[58:59], v81 offset:1024
    ds_read_b64_tr_b16 v[60:61], v81 offset:8192
    ds_read_b64_tr_b16 v[62:63], v81 offset:9216
    s_waitcnt lgkmcnt(0)
    ds_write_b128 v5, v[56:59] offset:2048
    ds_write_b128 v5, v[60:63] offset:3072
    s_branch L_lw_8
L_lw_8_0:
    s_cmp_lg_u32 s44, 1
    s_cbranch_scc1 L_lw_8_1
    ds_read_b64_tr_b16 v[224:225], v80 offset:0
    ds_read_b64_tr_b16 v[226:227], v80 offset:1024
    ds_read_b64_tr_b16 v[228:229], v80 offset:8192
    ds_read_b64_tr_b16 v[230:231], v80 offset:9216
    ds_read_b64_tr_b16 v[232:233], v81 offset:0
    ds_read_b64_tr_b16 v[234:235], v81 offset:1024
    ds_read_b64_tr_b16 v[236:237], v81 offset:8192
    ds_read_b64_tr_b16 v[238:239], v81 offset:9216
    s_branch L_lw_8
L_lw_8_1:
    s_cmp_lg_u32 s44, 2
    s_cbranch_scc1 L_lw_8_2
    ds_read_b64_tr_b16 v[104:105], v80 offset:0
    ds_read_b64_tr_b16 v[106:107], v80 offset:1024
    ds_read_b64_tr_b16 v[108:109], v80 offset:8192
    ds_read_b64_tr_b16 v[110:111], v80 offset:9216
    ds_read_b64_tr_b16 v[56:57], v81 offset:0
    ds_read_b64_tr_b16 v[58:59], v81 offset:1024
    ds_read_b64_tr_b16 v[60:61], v81 offset:8192
    ds_read_b64_tr_b16 v[62:63], v81 offset:9216
    s_waitcnt lgkmcnt(0)
    ds_write_b128 v5, v[56:59] offset:4096
    ds_write_b128 v5, v[60:63] offset:5120
    s_branch L_lw_8
L_lw_8_2:
    ds_read_b64_tr_b16 a[168:169], v80 offset:0
    ds_read_b64_tr_b16 a[170:171], v80 offset:1024
    ds_read_b64_tr_b16 a[172:173], v80 offset:8192
    ds_read_b64_tr_b16 a[174:175], v80 offset:9216
    ds_read_b64_tr_b16 v[56:57], v81 offset:0
    ds_read_b64_tr_b16 v[58:59], v81 offset:1024
    ds_read_b64_tr_b16 v[60:61], v81 offset:8192
    ds_read_b64_tr_b16 v[62:63], v81 offset:9216
    s_waitcnt lgkmcnt(0)
    ds_write_b128 v5, v[56:59] offset:6144
    ds_write_b128 v5, v[60:63] offset:7168
L_lw_8:
    s_waitcnt lgkmcnt(0)
    s_waitcnt vmcnt(24)
    s_barrier
    s_add_u32 s79, s41, 11
    s_and_b32 s79, s79, 3
    s_lshl_b32 s79, s79, 19
    s_add_u32 s79, s79, s47
    s_add_u32 s46, s79, 0x400000
    s_add_u32 m0, s48, 0
    s_nop 0
    buffer_load_dwordx4 v82, s[24:27], s46 offen  lds
    s_add_u32 s46, s79, 0x420000
    s_add_u32 m0, s48, 4096
    s_nop 0
    buffer_load_dwordx4 v82, s[24:27], s46 offen  lds
    s_add_u32 s46, s79, 0x440000
    s_add_u32 m0, s48, 8192
    s_nop 0
    buffer_load_dwordx4 v82, s[24:27], s46 offen  lds
    s_add_u32 s46, s79, 0x460000
    s_add_u32 m0, s48, 12288
    s_nop 0
    buffer_load_dwordx4 v82, s[24:27], s46 offen  lds
    s_cmp_lg_u32 s44, 0
    s_cbranch_scc1 L_lw_9_0
    ds_read_b64_tr_b16 a[96:97], v80 offset:16384
    ds_read_b64_tr_b16 a[98:99], v80 offset:17408
    ds_read_b64_tr_b16 a[100:101], v80 offset:24576
    ds_read_b64_tr_b16 a[102:103], v80 offset:25600
    ds_read_b64_tr_b16 v[32:33], v81 offset:16384
    ds_read_b64_tr_b16 v[34:35], v81 offset:17408
    ds_read_b64_tr_b16 v[36:37], v81 offset:24576
    ds_read_b64_tr_b16 v[38:39], v81 offset:25600
    s_branch L_lw_9
L_lw_9_0:
    s_cmp_lg_u32 s44, 1
    s_cbranch_scc1 L_lw_9_1
    ds_read_b64_tr_b16 a[0:1], v80 offset:16384
    ds_read_b64_tr_b16 a[2:3], v80 offset:17408
    ds_read_b64_tr_b16 a[4:5], v80 offset:24576
    ds_read_b64_tr_b16 a[6:7], v80 offset:25600
    ds_read_b64_tr_b16 a[8:9], v81 offset:16384
    ds_read_b64_tr_b16 a[10:11], v81 offset:17408
    ds_read_b64_tr_b16 a[12:13], v81 offset:24576
    ds_read_b64_tr_b16 a[14:15], v81 offset:25600
    s_branch L_lw_9
L_lw_9_1:
    s_cmp_lg_u32 s44, 2
    s_cbranch_scc1 L_lw_9_2
    ds_read_b64_tr_b16 v[128:129], v80 offset:16384
    ds_read_b64_tr_b16 v[130:131], v80 offset:17408
    ds_read_b64_tr_b16 v[132:133], v80 offset:24576
    ds_read_b64_tr_b16 v[134:135], v80 offset:25600
    ds_read_b64_tr_b16 v[136:137], v81 offset:16384
    ds_read_b64_tr_b16 v[138:139], v81 offset:17408
    ds_read_b64_tr_b16 v[140:141], v81 offset:24576
    ds_read_b64_tr_b16 v[142:143], v81 offset:25600
    s_branch L_lw_9
L_lw_9_2:
    ds_read_b64_tr_b16 a[192:193], v80 offset:16384
    ds_read_b64_tr_b16 a[194:195], v80 offset:17408
    ds_read_b64_tr_b16 a[196:197], v80 offset:24576
    ds_read_b64_tr_b16 a[198:199], v80 offset:25600
    ds_read_b64_tr_b16 v[24:25], v81 offset:16384
    ds_read_b64_tr_b16 v[26:27], v81 offset:17408
    ds_read_b64_tr_b16 v[28:29], v81 offset:24576
    ds_read_b64_tr_b16 v[30:31], v81 offset:25600
L_lw_9:
    s_waitcnt lgkmcnt(0)
    s_waitcnt vmcnt(24)
    s_barrier
    s_add_u32 s79, s41, 12
    s_and_b32 s79, s79, 3
    s_lshl_b32 s79, s79, 19
    s_add_u32 s79, s79, s47
    s_add_u32 s46, s79, 0x600000
    s_add_u32 m0, s48, 16384
    s_nop 0
    buffer_load_dwordx4 v82, s[24:27], s46 offen  lds
    s_add_u32 s46, s79, 0x620000
    s_add_u32 m0, s48, 20480
    s_nop 0
    buffer_load_dwordx4 v82, s[24:27], s46 offen  lds
    s_add_u32 s46, s79, 0x640000
    s_add_u32 m0, s48, 24576
    s_nop 0
    buffer_load_dwordx4 v82, s[24:27], s46 offen  lds
    s_add_u32 s46, s79, 0x660000
    s_add_u32 m0, s48, 28672
    s_nop 0
    buffer_load_dwordx4 v82, s[24:27], s46 offen  lds
    s_cmp_lg_u32 s44, 0
    s_cbranch_scc1 L_lw_10_0
    ds_read_b64_tr_b16 a[120:121], v80 offset:32768
    ds_read_b64_tr_b16 a[122:123], v80 offset:33792
    ds_read_b64_tr_b16 a[124:125], v80 offset:40960
    ds_read_b64_tr_b16 a[126:127], v80 offset:41984
    ds_read_b64_tr_b16 v[64:65], v81 offset:32768
    ds_read_b64_tr_b16 v[66:67], v81 offset:33792
    ds_read_b64_tr_b16 v[68:69], v81 offset:40960
    ds_read_b64_tr_b16 v[70:71], v81 offset:41984
    s_branch L_lw_10
L_lw_10_0:
    s_cmp_lg_u32 s44, 1
    s_cbranch_scc1 L_lw_10_1
    ds_read_b64_tr_b16 a[32:33], v80 offset:32768
    ds_read_b64_tr_b16 a[34:35], v80 offset:33792
    ds_read_b64_tr_b16 a[36:37], v80 offset:40960
    ds_read_b64_tr_b16 a[38:39], v80 offset:41984
    ds_read_b64_tr_b16 a[40:41], v81 offset:32768
    ds_read_b64_tr_b16 a[42:43], v81 offset:33792
    ds_read_b64_tr_b16 a[44:45], v81 offset:40960
    ds_read_b64_tr_b16 a[46:47], v81 offset:41984
    s_branch L_lw_10
L_lw_10_1:
    s_cmp_lg_u32 s44, 2
    s_cbranch_scc1 L_lw_10_2
    ds_read_b64_tr_b16 v[160:161], v80 offset:32768
    ds_read_b64_tr_b16 v[162:163], v80 offset:33792
    ds_read_b64_tr_b16 v[164:165], v80 offset:40960
    ds_read_b64_tr_b16 v[166:167], v80 offset:41984
    ds_read_b64_tr_b16 v[168:169], v81 offset:32768
    ds_read_b64_tr_b16 v[170:171], v81 offset:33792
    ds_read_b64_tr_b16 v[172:173], v81 offset:40960
    ds_read_b64_tr_b16 v[174:175], v81 offset:41984
    s_branch L_lw_10
L_lw_10_2:
    ds_read_b64_tr_b16 a[216:217], v80 offset:32768
    ds_read_b64_tr_b16 a[218:219], v80 offset:33792
    ds_read_b64_tr_b16 a[220:221], v80 offset:40960
    ds_read_b64_tr_b16 a[222:223], v80 offset:41984
    ds_read_b64_tr_b16 v[48:49], v81 offset:32768
    ds_read_b64_tr_b16 v[50:51], v81 offset:33792
    ds_read_b64_tr_b16 v[52:53], v81 offset:40960
    ds_read_b64_tr_b16 v[54:55], v81 offset:41984
L_lw_10:
    s_waitcnt lgkmcnt(0)
    s_waitcnt vmcnt(24)
    s_barrier
    s_add_u32 s79, s41, 13
    s_and_b32 s79, s79, 3
    s_lshl_b32 s79, s79, 19
    s_add_u32 s79, s79, s47
    s_add_u32 s46, s79, 0x600000
    s_add_u32 m0, s48, 32768
    s_nop 0
    buffer_load_dwordx4 v82, s[24:27], s46 offen  lds
    s_add_u32 s46, s79, 0x620000
    s_add_u32 m0, s48, 36864
    s_nop 0
    buffer_load_dwordx4 v82, s[24:27], s46 offen  lds
    s_add_u32 s46, s79, 0x640000
    s_add_u32 m0, s48, 40960
    s_nop 0
    buffer_load_dwordx4 v82, s[24:27], s46 offen  lds
    s_add_u32 s46, s79, 0x660000
    s_add_u32 m0, s48, 45056
    s_nop 0
    buffer_load_dwordx4 v82, s[24:27], s46 offen  lds
    s_cmp_lg_u32 s44, 0
    s_cbranch_scc1 L_lw_11_0
    ds_read_b64_tr_b16 a[144:145], v80 offset:49152
    ds_read_b64_tr_b16 a[146:147], v80 offset:50176
    ds_read_b64_tr_b16 a[148:149], v80 offset:57344
    ds_read_b64_tr_b16 a[150:151], v80 offset:58368
    ds_read_b64_tr_b16 v[56:57], v81 offset:49152
    ds_read_b64_tr_b16 v[58:59], v81 offset:50176
    ds_read_b64_tr_b16 v[60:61], v81 offset:57344
    ds_read_b64_tr_b16 v[62:63], v81 offset:58368
    s_waitcnt lgkmcnt(0)
    ds_write_b128 v5, v[56:59] offset:0
    ds_write_b128 v5, v[60:63] offset:1024
    s_branch L_lw_11
L_lw_11_0:
    s_cmp_lg_u32 s44, 1
    s_cbranch_scc1 L_lw_11_1
    ds_read_b64_tr_b16 a[64:65], v80 offset:49152
    ds_read_b64_tr_b16 a[66:67], v80 offset:50176
    ds_read_b64_tr_b16 a[68:69], v80 offset:57344
    ds_read_b64_tr_b16 a[70:71], v80 offset:58368
    ds_read_b64_tr_b16 v[72:73], v81 offset:49152
    ds_read_b64_tr_b16 v[74:75], v81 offset:50176
    ds_read_b64_tr_b16 v[76:77], v81 offset:57344
    ds_read_b64_tr_b16 v[78:79], v81 offset:58368
    s_branch L_lw_11
L_lw_11_1:
    s_cmp_lg_u32 s44, 2
    s_cbranch_scc1 L_lw_11_2
    ds_read_b64_tr_b16 v[192:193], v80 offset:49152
    ds_read_b64_tr_b16 v[194:195], v80 offset:50176
    ds_read_b64_tr_b16 v[196:197], v80 offset:57344
    ds_read_b64_tr_b16 v[198:199], v80 offset:58368
    ds_read_b64_tr_b16 v[200:201], v81 offset:49152
    ds_read_b64_tr_b16 v[202:203], v81 offset:50176
    ds_read_b64_tr_b16 v[204:205], v81 offset:57344
    ds_read_b64_tr_b16 v[206:207], v81 offset:58368
    s_branch L_lw_11
L_lw_11_2:
    ds_read_b64_tr_b16 a[240:241], v80 offset:49152
    ds_read_b64_tr_b16 a[242:243], v80 offset:50176
    ds_read_b64_tr_b16 a[244:245], v80 offset:57344
    ds_read_b64_tr_b16 a[246:247], v80 offset:58368
    ds_read_b64_tr_b16 v[88:89], v81 offset:49152
    ds_read_b64_tr_b16 v[90:91], v81 offset:50176
    ds_read_b64_tr_b16 v[92:93], v81 offset:57344
    ds_read_b64_tr_b16 v[94:95], v81 offset:58368
L_lw_11:
    s_waitcnt lgkmcnt(0)
    s_waitcnt vmcnt(24)
    s_barrier
    s_add_u32 s79, s41, 14
    s_and_b32 s79, s79, 3
    s_lshl_b32 s79, s79, 19
    s_add_u32 s79, s79, s47
    s_add_u32 s46, s79, 0x600000
    s_add_u32 m0, s48, 49152
    s_nop 0
    buffer_load_dwordx4 v82, s[24:27], s46 offen  lds
    s_add_u32 s46, s79, 0x620000
    s_add_u32 m0, s48, 53248
    s_nop 0
    buffer_load_dwordx4 v82, s[24:27], s46 offen  lds
    s_add_u32 s46, s79, 0x640000
    s_add_u32 m0, s48, 57344
    s_nop 0
    buffer_load_dwordx4 v82, s[24:27], s46 offen  lds
    s_add_u32 s46, s79, 0x660000
    s_add_u32 m0, s48, 61440
    s_nop 0
    buffer_load_dwordx4 v82, s[24:27], s46 offen  lds
    s_cmp_lg_u32 s44, 0
    s_cbranch_scc1 L_lw_12_0
    ds_read_b64_tr_b16 a[168:169], v84 offset:12288
    ds_read_b64_tr_b16 a[170:171], v84 offset:13312
    ds_read_b64_tr_b16 a[172:173], v86 offset:12288
    ds_read_b64_tr_b16 a[174:175], v86 offset:13312
    ds_read_b64_tr_b16 v[56:57], v85 offset:12288
    ds_read_b64_tr_b16 v[58:59], v85 offset:13312
    ds_read_b64_tr_b16 v[60:61], v87 offset:12288
    ds_read_b64_tr_b16 v[62:63], v87 offset:13312
    s_waitcnt lgkmcnt(0)
    ds_write_b128 v5, v[56:59] offset:6144
    ds_write_b128 v5, v[60:63] offset:7168
    s_branch L_lw_12
L_lw_12_0:
    s_cmp_lg_u32 s44, 1
    s_cbranch_scc1 L_lw_12_1
    ds_read_b64_tr_b16 a[80:81], v84 offset:12288
    ds_read_b64_tr_b16 a[82:83], v84 offset:13312
    ds_read_b64_tr_b16 a[84:85], v86 offset:12288
    ds_read_b64_tr_b16 a[86:87], v86 offset:13312
    ds_read_b64_tr_b16 v[56:57], v85 offset:12288
    ds_read_b64_tr_b16 v[58:59], v85 offset:13312
    ds_read_b64_tr_b16 v[60:61], v87 offset:12288
    ds_read_b64_tr_b16 v[62:63], v87 offset:13312
    s_waitcnt lgkmcnt(0)
    ds_write_b128 v5, v[56:59] offset:2048
    ds_write_b128 v5, v[60:63] offset:3072
    s_branch L_lw_12
L_lw_12_1:
    s_cmp_lg_u32 s44, 2
    s_cbranch_scc1 L_lw_12_2
    ds_read_b64_tr_b16 v[224:225], v84 offset:12288
    ds_read_b64_tr_b16 v[226:227], v84 offset:13312
    ds_read_b64_tr_b16 v[228:229], v86 offset:12288
    ds_read_b64_tr_b16 v[230:231], v86 offset:13312
    ds_read_b64_tr_b16 v[232:233], v85 offset:12288
    ds_read_b64_tr_b16 v[234:235], v85 offset:13312
    ds_read_b64_tr_b16 v[236:237], v87 offset:12288
    ds_read_b64_tr_b16 v[238:239], v87 offset:13312
    s_branch L_lw_12
L_lw_12_2:
    ds_read_b64_tr_b16 v[104:105], v84 offset:12288
    ds_read_b64_tr_b16 v[106:107], v84 offset:13312
    ds_read_b64_tr_b16 v[108:109], v86 offset:12288
    ds_read_b64_tr_b16 v[110:111], v86 offset:13312
    ds_read_b64_tr_b16 v[56:57], v85 offset:12288
    ds_read_b64_tr_b16 v[58:59], v85 offset:13312
    ds_read_b64_tr_b16 v[60:61], v87 offset:12288
    ds_read_b64_tr_b16 v[62:63], v87 offset:13312
    s_waitcnt lgkmcnt(0)
    ds_write_b128 v5, v[56:59] offset:4096
    ds_write_b128 v5, v[60:63] offset:5120
L_lw_12:
    s_waitcnt lgkmcnt(0)
    s_waitcnt vmcnt(24)
    s_barrier
    s_add_u32 s79, s41, 15
    s_and_b32 s79, s79, 3
    s_lshl_b32 s79, s79, 19
    s_add_u32 s79, s79, s47
    s_add_u32 s46, s79, 0x600000
    s_add_u32 m0, s48, 77824
    s_nop 0
    buffer_load_dwordx4 v82, s[24:27], s46 offen  lds
    s_add_u32 s46, s79, 0x620000
    s_add_u32 m0, s48, 102400
    s_nop 0
    buffer_load_dwordx4 v82, s[24:27], s46 offen  lds
    s_add_u32 s46, s79, 0x640000
    s_add_u32 m0, s48, 126976
    s_nop 0
    buffer_load_dwordx4 v82, s[24:27], s46 offen  lds
    s_add_u32 s46, s79, 0x660000
    s_add_u32 m0, s48, 151552
    s_nop 0
    buffer_load_dwordx4 v82, s[24:27], s46 offen  lds
    s_cmp_lg_u32 s44, 0
    s_cbranch_scc1 L_lw_13_0
    ds_read_b64_tr_b16 a[192:193], v84 offset:16384
    ds_read_b64_tr_b16 a[194:195], v84 offset:17408
    ds_read_b64_tr_b16 a[196:197], v86 offset:16384
    ds_read_b64_tr_b16 a[198:199], v86 offset:17408
    ds_read_b64_tr_b16 v[24:25], v85 offset:16384
    ds_read_b64_tr_b16 v[26:27], v85 offset:17408
    ds_read_b64_tr_b16 v[28:29], v87 offset:16384
    ds_read_b64_tr_b16 v[30:31], v87 offset:17408
    s_branch L_lw_13
L_lw_13_0:
    s_cmp_lg_u32 s44, 1
    s_cbranch_scc1 L_lw_13_1
    ds_read_b64_tr_b16 a[96:97], v84 offset:16384
    ds_read_b64_tr_b16 a[98:99], v84 offset:17408
    ds_read_b64_tr_b16 a[100:101], v86 offset:16384
    ds_read_b64_tr_b16 a[102:103], v86 offset:17408
    ds_read_b64_tr_b16 v[32:33], v85 offset:16384
    ds_read_b64_tr_b16 v[34:35], v85 offset:17408
    ds_read_b64_tr_b16 v[36:37], v87 offset:16384
    ds_read_b64_tr_b16 v[38:39], v87 offset:17408
    s_branch L_lw_13
L_lw_13_1:
    s_cmp_lg_u32 s44, 2
    s_cbranch_scc1 L_lw_13_2
    ds_read_b64_tr_b16 a[0:1], v84 offset:16384
    ds_read_b64_tr_b16 a[2:3], v84 offset:17408
    ds_read_b64_tr_b16 a[4:5], v86 offset:16384
    ds_read_b64_tr_b16 a[6:7], v86 offset:17408
    ds_read_b64_tr_b16 a[8:9], v85 offset:16384
    ds_read_b64_tr_b16 a[10:11], v85 offset:17408
    ds_read_b64_tr_b16 a[12:13], v87 offset:16384
    ds_read_b64_tr_b16 a[14:15], v87 offset:17408
    s_branch L_lw_13
L_lw_13_2:
    ds_read_b64_tr_b16 v[128:129], v84 offset:16384
    ds_read_b64_tr_b16 v[130:131], v84 offset:17408
    ds_read_b64_tr_b16 v[132:133], v86 offset:16384
    ds_read_b64_tr_b16 v[134:135], v86 offset:17408
    ds_read_b64_tr_b16 v[136:137], v85 offset:16384
    ds_read_b64_tr_b16 v[138:139], v85 offset:17408
    ds_read_b64_tr_b16 v[140:141], v87 offset:16384
    ds_read_b64_tr_b16 v[142:143], v87 offset:17408
L_lw_13:
    s_waitcnt lgkmcnt(0)
    s_waitcnt vmcnt(24)
    s_barrier
    s_add_u32 s79, s41, 0
    s_and_b32 s79, s79, 3
    s_lshl_b32 s79, s79, 19
    s_add_u32 s79, s79, s47
    s_add_u32 s46, s79, 0x0
    s_add_u32 m0, s48, 81920
    s_nop 0
    buffer_load_dwordx4 v82, s[28:31], s46 offen  lds
    s_add_u32 s46, s79, 0x20000
    s_add_u32 m0, s48, 106496
    s_nop 0
    buffer_load_dwordx4 v82, s[28:31], s46 offen  lds
    s_add_u32 s46, s79, 0x40000
    s_add_u32 m0, s48, 131072
    s_nop 0
    buffer_load_dwordx4 v82, s[28:31], s46 offen  lds
    s_add_u32 s46, s79, 0x60000
    s_add_u32 m0, s48, 155648
    s_nop 0
    buffer_load_dwordx4 v82, s[28:31], s46 offen  lds
    s_cmp_lg_u32 s44, 0
    s_cbranch_scc1 L_lw_14_0
    ds_read_b64_tr_b16 a[216:217], v84 offset:20480
    ds_read_b64_tr_b16 a[218:219], v84 offset:21504
    ds_read_b64_tr_b16 a[220:221], v86 offset:20480
    ds_read_b64_tr_b16 a[222:223], v86 offset:21504
    ds_read_b64_tr_b16 v[48:49], v85 offset:20480
    ds_read_b64_tr_b16 v[50:51], v85 offset:21504
    ds_read_b64_tr_b16 v[52:53], v87 offset:20480
    ds_read_b64_tr_b16 v[54:55], v87 offset:21504
    s_branch L_lw_14
L_lw_14_0:
    s_cmp_lg_u32 s44, 1
    s_cbranch_scc1 L_lw_14_1
    ds_read_b64_tr_b16 a[120:121], v84 offset:20480
    ds_read_b64_tr_b16 a[122:123], v84 offset:21504
    ds_read_b64_tr_b16 a[124:125], v86 offset:20480
    ds_read_b64_tr_b16 a[126:127], v86 offset:21504
    ds_read_b64_tr_b16 v[64:65], v85 offset:20480
    ds_read_b64_tr_b16 v[66:67], v85 offset:21504
    ds_read_b64_tr_b16 v[68:69], v87 offset:20480
    ds_read_b64_tr_b16 v[70:71], v87 offset:21504
    s_branch L_lw_14
L_lw_14_1:
    s_cmp_lg_u32 s44, 2
    s_cbranch_scc1 L_lw_14_2
    ds_read_b64_tr_b16 a[32:33], v84 offset:20480
    ds_read_b64_tr_b16 a[34:35], v84 offset:21504
    ds_read_b64_tr_b16 a[36:37], v86 offset:20480
    ds_read_b64_tr_b16 a[38:39], v86 offset:21504
    ds_read_b64_tr_b16 a[40:41], v85 offset:20480
    ds_read_b64_tr_b16 a[42:43], v85 offset:21504
    ds_read_b64_tr_b16 a[44:45], v87 offset:20480
    ds_read_b64_tr_b16 a[46:47], v87 offset:21504
    s_branch L_lw_14
L_lw_14_2:
    ds_read_b64_tr_b16 v[160:161], v84 offset:20480
    ds_read_b64_tr_b16 v[162:163], v84 offset:21504
    ds_read_b64_tr_b16 v[164:165], v86 offset:20480
    ds_read_b64_tr_b16 v[166:167], v86 offset:21504
    ds_read_b64_tr_b16 v[168:169], v85 offset:20480
    ds_read_b64_tr_b16 v[170:171], v85 offset:21504
    ds_read_b64_tr_b16 v[172:173], v87 offset:20480
    ds_read_b64_tr_b16 v[174:175], v87 offset:21504
L_lw_14:
    s_waitcnt lgkmcnt(0)
    s_waitcnt vmcnt(24)
    s_barrier
    s_add_u32 s79, s41, 1
    s_and_b32 s79, s79, 3
    s_lshl_b32 s79, s79, 19
    s_add_u32 s79, s79, s47
    s_add_u32 s46, s79, 0x0
    s_add_u32 m0, s48, 86016
    s_nop 0
    buffer_load_dwordx4 v82, s[28:31], s46 offen  lds
    s_add_u32 s46, s79, 0x20000
    s_add_u32 m0, s48, 110592
    s_nop 0
    buffer_load_dwordx4 v82, s[28:31], s46 offen  lds
    s_add_u32 s46, s79, 0x40000
    s_add_u32 m0, s48, 135168
    s_nop 0
    buffer_load_dwordx4 v82, s[28:31], s46 offen  lds
    s_add_u32 s46, s79, 0x60000
    s_add_u32 m0, s48, 159744
    s_nop 0
    buffer_load_dwordx4 v82, s[28:31], s46 offen  lds
    s_cmp_lg_u32 s44, 0
    s_cbranch_scc1 L_lw_15_0
    ds_read_b64_tr_b16 a[240:241], v84 offset:8192
    ds_read_b64_tr_b16 a[242:243], v84 offset:9216
    ds_read_b64_tr_b16 a[244:245], v86 offset:8192
    ds_read_b64_tr_b16 a[246:247], v86 offset:9216
    ds_read_b64_tr_b16 v[88:89], v85 offset:8192
    ds_read_b64_tr_b16 v[90:91], v85 offset:9216
    ds_read_b64_tr_b16 v[92:93], v87 offset:8192
    ds_read_b64_tr_b16 v[94:95], v87 offset:9216
    s_branch L_lw_15
L_lw_15_0:
    s_cmp_lg_u32 s44, 1
    s_cbranch_scc1 L_lw_15_1
    ds_read_b64_tr_b16 a[144:145], v84 offset:8192
    ds_read_b64_tr_b16 a[146:147], v84 offset:9216
    ds_read_b64_tr_b16 a[148:149], v86 offset:8192
    ds_read_b64_tr_b16 a[150:151], v86 offset:9216
    ds_read_b64_tr_b16 v[56:57], v85 offset:8192
    ds_read_b64_tr_b16 v[58:59], v85 offset:9216
    ds_read_b64_tr_b16 v[60:61], v87 offset:8192
    ds_read_b64_tr_b16 v[62:63], v87 offset:9216
    s_waitcnt lgkmcnt(0)
    ds_write_b128 v5, v[56:59] offset:0
    ds_write_b128 v5, v[60:63] offset:1024
    s_branch L_lw_15
L_lw_15_1:
    s_cmp_lg_u32 s44, 2
    s_cbranch_scc1 L_lw_15_2
    ds_read_b64_tr_b16 a[64:65], v84 offset:8192
    ds_read_b64_tr_b16 a[66:67], v84 offset:9216
    ds_read_b64_tr_b16 a[68:69], v86 offset:8192
    ds_read_b64_tr_b16 a[70:71], v86 offset:9216
    ds_read_b64_tr_b16 v[72:73], v85 offset:8192
    ds_read_b64_tr_b16 v[74:75], v85 offset:9216
    ds_read_b64_tr_b16 v[76:77], v87 offset:8192
    ds_read_b64_tr_b16 v[78:79], v87 offset:9216
    s_branch L_lw_15
L_lw_15_2:
    ds_read_b64_tr_b16 v[192:193], v84 offset:8192
    ds_read_b64_tr_b16 v[194:195], v84 offset:9216
    ds_read_b64_tr_b16 v[196:197], v86 offset:8192
    ds_read_b64_tr_b16 v[198:199], v86 offset:9216
    ds_read_b64_tr_b16 v[200:201], v85 offset:8192
    ds_read_b64_tr_b16 v[202:203], v85 offset:9216
    ds_read_b64_tr_b16 v[204:205], v87 offset:8192
    ds_read_b64_tr_b16 v[206:207], v87 offset:9216
L_lw_15:
    s_waitcnt lgkmcnt(0)
    s_waitcnt vmcnt(24)
    s_barrier
    s_cmp_lg_u32 s44, 0
    s_cbranch_scc1 L_lw_16_0
    ds_read_b64_tr_b16 v[104:105], v80 offset:0
    ds_read_b64_tr_b16 v[106:107], v80 offset:1024
    ds_read_b64_tr_b16 v[108:109], v80 offset:8192
    ds_read_b64_tr_b16 v[110:111], v80 offset:9216
    ds_read_b64_tr_b16 v[56:57], v81 offset:0
    ds_read_b64_tr_b16 v[58:59], v81 offset:1024
    ds_read_b64_tr_b16 v[60:61], v81 offset:8192
    ds_read_b64_tr_b16 v[62:63], v81 offset:9216
    s_waitcnt lgkmcnt(0)
    ds_write_b128 v5, v[56:59] offset:4096
    ds_write_b128 v5, v[60:63] offset:5120
    s_branch L_lw_16
L_lw_16_0:
    s_cmp_lg_u32 s44, 1
    s_cbranch_scc1 L_lw_16_1
    ds_read_b64_tr_b16 a[168:169], v80 offset:0
    ds_read_b64_tr_b16 a[170:171], v80 offset:1024
    ds_read_b64_tr_b16 a[172:173], v80 offset:8192
    ds_read_b64_tr_b16 a[174:175], v80 offset:9216
    ds_read_b64_tr_b16 v[56:57], v81 offset:0
    ds_read_b64_tr_b16 v[58:59], v81 offset:1024
    ds_read_b64_tr_b16 v[60:61], v81 offset:8192
    ds_read_b64_tr_b16 v[62:63], v81 offset:9216
    s_waitcnt lgkmcnt(0)
    ds_write_b128 v5, v[56:59] offset:6144
    ds_write_b128 v5, v[60:63] offset:7168
    s_branch L_lw_16
L_lw_16_1:
    s_cmp_lg_u32 s44, 2
    s_cbranch_scc1 L_lw_16_2
    ds_read_b64_tr_b16 a[80:81], v80 offset:0
    ds_read_b64_tr_b16 a[82:83], v80 offset:1024
    ds_read_b64_tr_b16 a[84:85], v80 offset:8192
    ds_read_b64_tr_b16 a[86:87], v80 offset:9216
    ds_read_b64_tr_b16 v[56:57], v81 offset:0
    ds_read_b64_tr_b16 v[58:59], v81 offset:1024
    ds_read_b64_tr_b16 v[60:61], v81 offset:8192
    ds_read_b64_tr_b16 v[62:63], v81 offset:9216
    s_waitcnt lgkmcnt(0)
    ds_write_b128 v5, v[56:59] offset:2048
    ds_write_b128 v5, v[60:63] offset:3072
    s_branch L_lw_16
L_lw_16_2:
    ds_read_b64_tr_b16 v[224:225], v80 offset:0
    ds_read_b64_tr_b16 v[226:227], v80 offset:1024
    ds_read_b64_tr_b16 v[228:229], v80 offset:8192
    ds_read_b64_tr_b16 v[230:231], v80 offset:9216
    ds_read_b64_tr_b16 v[232:233], v81 offset:0
    ds_read_b64_tr_b16 v[234:235], v81 offset:1024
    ds_read_b64_tr_b16 v[236:237], v81 offset:8192
    ds_read_b64_tr_b16 v[238:239], v81 offset:9216
L_lw_16:
    s_waitcnt lgkmcnt(0)
    s_waitcnt vmcnt(20)
    s_barrier
    s_add_u32 s79, s41, 2
    s_and_b32 s79, s79, 3
    s_lshl_b32 s79, s79, 19
    s_add_u32 s79, s79, s47
    s_add_u32 s46, s79, 0x0
    s_add_u32 m0, s48, 0
    s_nop 0
    buffer_load_dwordx4 v82, s[28:31], s46 offen  lds
    s_add_u32 s46, s79, 0x20000
    s_add_u32 m0, s48, 4096
    s_nop 0
    buffer_load_dwordx4 v82, s[28:31], s46 offen  lds
    s_add_u32 s46, s79, 0x40000
    s_add_u32 m0, s48, 8192
    s_nop 0
    buffer_load_dwordx4 v82, s[28:31], s46 offen  lds
    s_add_u32 s46, s79, 0x60000
    s_add_u32 m0, s48, 12288
    s_nop 0
    buffer_load_dwordx4 v82, s[28:31], s46 offen  lds
    s_cmp_lg_u32 s44, 0
    s_cbranch_scc1 L_lw_17_0
    ds_read_b64_tr_b16 v[128:129], v80 offset:16384
    ds_read_b64_tr_b16 v[130:131], v80 offset:17408
    ds_read_b64_tr_b16 v[132:133], v80 offset:24576
    ds_read_b64_tr_b16 v[134:135], v80 offset:25600
    ds_read_b64_tr_b16 v[136:137], v81 offset:16384
    ds_read_b64_tr_b16 v[138:139], v81 offset:17408
    ds_read_b64_tr_b16 v[140:141], v81 offset:24576
    ds_read_b64_tr_b16 v[142:143], v81 offset:25600
    s_branch L_lw_17
L_lw_17_0:
    s_cmp_lg_u32 s44, 1
    s_cbranch_scc1 L_lw_17_1
    ds_read_b64_tr_b16 a[192:193], v80 offset:16384
    ds_read_b64_tr_b16 a[194:195], v80 offset:17408
    ds_read_b64_tr_b16 a[196:197], v80 offset:24576
    ds_read_b64_tr_b16 a[198:199], v80 offset:25600
    ds_read_b64_tr_b16 v[24:25], v81 offset:16384
    ds_read_b64_tr_b16 v[26:27], v81 offset:17408
    ds_read_b64_tr_b16 v[28:29], v81 offset:24576
    ds_read_b64_tr_b16 v[30:31], v81 offset:25600
    s_branch L_lw_17
L_lw_17_1:
    s_cmp_lg_u32 s44, 2
    s_cbranch_scc1 L_lw_17_2
    ds_read_b64_tr_b16 a[96:97], v80 offset:16384
    ds_read_b64_tr_b16 a[98:99], v80 offset:17408
    ds_read_b64_tr_b16 a[100:101], v80 offset:24576
    ds_read_b64_tr_b16 a[102:103], v80 offset:25600
    ds_read_b64_tr_b16 v[32:33], v81 offset:16384
    ds_read_b64_tr_b16 v[34:35], v81 offset:17408
    ds_read_b64_tr_b16 v[36:37], v81 offset:24576
    ds_read_b64_tr_b16 v[38:39], v81 offset:25600
    s_branch L_lw_17
L_lw_17_2:
    ds_read_b64_tr_b16 a[0:1], v80 offset:16384
    ds_read_b64_tr_b16 a[2:3], v80 offset:17408
    ds_read_b64_tr_b16 a[4:5], v80 offset:24576
    ds_read_b64_tr_b16 a[6:7], v80 offset:25600
    ds_read_b64_tr_b16 a[8:9], v81 offset:16384
    ds_read_b64_tr_b16 a[10:11], v81 offset:17408
    ds_read_b64_tr_b16 a[12:13], v81 offset:24576
    ds_read_b64_tr_b16 a[14:15], v81 offset:25600
L_lw_17:
    s_waitcnt lgkmcnt(0)
    s_waitcnt vmcnt(20)
    s_barrier
    s_add_u32 s79, s41, 3
    s_and_b32 s79, s79, 3
    s_lshl_b32 s79, s79, 19
    s_add_u32 s79, s79, s47
    s_add_u32 s46, s79, 0x0
    s_add_u32 m0, s48, 16384
    s_nop 0
    buffer_load_dwordx4 v82, s[28:31], s46 offen  lds
    s_add_u32 s46, s79, 0x20000
    s_add_u32 m0, s48, 20480
    s_nop 0
    buffer_load_dwordx4 v82, s[28:31], s46 offen  lds
    s_add_u32 s46, s79, 0x40000
    s_add_u32 m0, s48, 24576
    s_nop 0
    buffer_load_dwordx4 v82, s[28:31], s46 offen  lds
    s_add_u32 s46, s79, 0x60000
    s_add_u32 m0, s48, 28672
    s_nop 0
    buffer_load_dwordx4 v82, s[28:31], s46 offen  lds
    s_cmp_lg_u32 s44, 0
    s_cbranch_scc1 L_lw_18_0
    ds_read_b64_tr_b16 v[160:161], v80 offset:32768
    ds_read_b64_tr_b16 v[162:163], v80 offset:33792
    ds_read_b64_tr_b16 v[164:165], v80 offset:40960
    ds_read_b64_tr_b16 v[166:167], v80 offset:41984
    ds_read_b64_tr_b16 v[168:169], v81 offset:32768
    ds_read_b64_tr_b16 v[170:171], v81 offset:33792
    ds_read_b64_tr_b16 v[172:173], v81 offset:40960
    ds_read_b64_tr_b16 v[174:175], v81 offset:41984
    s_branch L_lw_18
L_lw_18_0:
    s_cmp_lg_u32 s44, 1
    s_cbranch_scc1 L_lw_18_1
    ds_read_b64_tr_b16 a[216:217], v80 offset:32768
    ds_read_b64_tr_b16 a[218:219], v80 offset:33792
    ds_read_b64_tr_b16 a[220:221], v80 offset:40960
    ds_read_b64_tr_b16 a[222:223], v80 offset:41984
    ds_read_b64_tr_b16 v[48:49], v81 offset:32768
    ds_read_b64_tr_b16 v[50:51], v81 offset:33792
    ds_read_b64_tr_b16 v[52:53], v81 offset:40960
    ds_read_b64_tr_b16 v[54:55], v81 offset:41984
    s_branch L_lw_18
L_lw_18_1:
    s_cmp_lg_u32 s44, 2
    s_cbranch_scc1 L_lw_18_2
    ds_read_b64_tr_b16 a[120:121], v80 offset:32768
    ds_read_b64_tr_b16 a[122:123], v80 offset:33792
    ds_read_b64_tr_b16 a[124:125], v80 offset:40960
    ds_read_b64_tr_b16 a[126:127], v80 offset:41984
    ds_read_b64_tr_b16 v[64:65], v81 offset:32768
    ds_read_b64_tr_b16 v[66:67], v81 offset:33792
    ds_read_b64_tr_b16 v[68:69], v81 offset:40960
    ds_read_b64_tr_b16 v[70:71], v81 offset:41984
    s_branch L_lw_18
L_lw_18_2:
    ds_read_b64_tr_b16 a[32:33], v80 offset:32768
    ds_read_b64_tr_b16 a[34:35], v80 offset:33792
    ds_read_b64_tr_b16 a[36:37], v80 offset:40960
    ds_read_b64_tr_b16 a[38:39], v80 offset:41984
    ds_read_b64_tr_b16 a[40:41], v81 offset:32768
    ds_read_b64_tr_b16 a[42:43], v81 offset:33792
    ds_read_b64_tr_b16 a[44:45], v81 offset:40960
    ds_read_b64_tr_b16 a[46:47], v81 offset:41984
L_lw_18:
    s_waitcnt lgkmcnt(0)
    s_waitcnt vmcnt(20)
    s_barrier
    s_add_u32 s79, s41, 4
    s_and_b32 s79, s79, 3
    s_lshl_b32 s79, s79, 19
    s_add_u32 s79, s79, s47
    s_add_u32 s46, s79, 0x200000
    s_add_u32 m0, s48, 32768
    s_nop 0
    buffer_load_dwordx4 v82, s[28:31], s46 offen  lds
    s_add_u32 s46, s79, 0x220000
    s_add_u32 m0, s48, 36864
    s_nop 0
    buffer_load_dwordx4 v82, s[28:31], s46 offen  lds
    s_add_u32 s46, s79, 0x240000
    s_add_u32 m0, s48, 40960
    s_nop 0
    buffer_load_dwordx4 v82, s[28:31], s46 offen  lds
    s_add_u32 s46, s79, 0x260000
    s_add_u32 m0, s48, 45056
    s_nop 0
    buffer_load_dwordx4 v82, s[28:31], s46 offen  lds
    s_cmp_lg_u32 s44, 0
    s_cbranch_scc1 L_lw_19_0
    ds_read_b64_tr_b16 v[192:193], v80 offset:49152
    ds_read_b64_tr_b16 v[194:195], v80 offset:50176
    ds_read_b64_tr_b16 v[196:197], v80 offset:57344
    ds_read_b64_tr_b16 v[198:199], v80 offset:58368
    ds_read_b64_tr_b16 v[200:201], v81 offset:49152
    ds_read_b64_tr_b16 v[202:203], v81 offset:50176
    ds_read_b64_tr_b16 v[204:205], v81 offset:57344
    ds_read_b64_tr_b16 v[206:207], v81 offset:58368
    s_branch L_lw_19
L_lw_19_0:
    s_cmp_lg_u32 s44, 1
    s_cbranch_scc1 L_lw_19_1
    ds_read_b64_tr_b16 a[240:241], v80 offset:49152
    ds_read_b64_tr_b16 a[242:243], v80 offset:50176
    ds_read_b64_tr_b16 a[244:245], v80 offset:57344
    ds_read_b64_tr_b16 a[246:247], v80 offset:58368
    ds_read_b64_tr_b16 v[88:89], v81 offset:49152
    ds_read_b64_tr_b16 v[90:91], v81 offset:50176
    ds_read_b64_tr_b16 v[92:93], v81 offset:57344
    ds_read_b64_tr_b16 v[94:95], v81 offset:58368
    s_branch L_lw_19
L_lw_19_1:
    s_cmp_lg_u32 s44, 2
    s_cbranch_scc1 L_lw_19_2
    ds_read_b64_tr_b16 a[144:145], v80 offset:49152
    ds_read_b64_tr_b16 a[146:147], v80 offset:50176
    ds_read_b64_tr_b16 a[148:149], v80 offset:57344
    ds_read_b64_tr_b16 a[150:151], v80 offset:58368
    ds_read_b64_tr_b16 v[56:57], v81 offset:49152
    ds_read_b64_tr_b16 v[58:59], v81 offset:50176
    ds_read_b64_tr_b16 v[60:61], v81 offset:57344
    ds_read_b64_tr_b16 v[62:63], v81 offset:58368
    s_waitcnt lgkmcnt(0)
    ds_write_b128 v5, v[56:59] offset:0
    ds_write_b128 v5, v[60:63] offset:1024
    s_branch L_lw_19
L_lw_19_2:
    ds_read_b64_tr_b16 a[64:65], v80 offset:49152
    ds_read_b64_tr_b16 a[66:67], v80 offset:50176
    ds_read_b64_tr_b16 a[68:69], v80 offset:57344
    ds_read_b64_tr_b16 a[70:71], v80 offset:58368
    ds_read_b64_tr_b16 v[72:73], v81 offset:49152
    ds_read_b64_tr_b16 v[74:75], v81 offset:50176
    ds_read_b64_tr_b16 v[76:77], v81 offset:57344
    ds_read_b64_tr_b16 v[78:79], v81 offset:58368
L_lw_19:
    s_waitcnt lgkmcnt(0)
    s_waitcnt vmcnt(20)
    s_barrier
    s_add_u32 s79, s41, 5
    s_and_b32 s79, s79, 3
    s_lshl_b32 s79, s79, 19
    s_add_u32 s79, s79, s47
    s_add_u32 s46, s79, 0x200000
    s_add_u32 m0, s48, 49152
    s_nop 0
    buffer_load_dwordx4 v82, s[28:31], s46 offen  lds
    s_add_u32 s46, s79, 0x220000
    s_add_u32 m0, s48, 53248
    s_nop 0
    buffer_load_dwordx4 v82, s[28:31], s46 offen  lds
    s_add_u32 s46, s79, 0x240000
    s_add_u32 m0, s48, 57344
    s_nop 0
    buffer_load_dwordx4 v82, s[28:31], s46 offen  lds
    s_add_u32 s46, s79, 0x260000
    s_add_u32 m0, s48, 61440
    s_nop 0
    buffer_load_dwordx4 v82, s[28:31], s46 offen  lds
    s_cmp_lg_u32 s44, 0
    s_cbranch_scc1 L_lw_20_0
    ds_read_b64_tr_b16 v[224:225], v84 offset:12288
    ds_read_b64_tr_b16 v[226:227], v84 offset:13312
    ds_read_b64_tr_b16 v[228:229], v86 offset:12288
    ds_read_b64_tr_b16 v[230:231], v86 offset:13312
    ds_read_b64_tr_b16 v[232:233], v85 offset:12288
    ds_read_b64_tr_b16 v[234:235], v85 offset:13312
    ds_read_b64_tr_b16 v[236:237], v87 offset:12288
    ds_read_b64_tr_b16 v[238:239], v87 offset:13312
    s_branch L_lw_20
L_lw_20_0:
    s_cmp_lg_u32 s44, 1
    s_cbranch_scc1 L_lw_20_1
    ds_read_b64_tr_b16 v[104:105], v84 offset:12288
    ds_read_b64_tr_b16 v[106:107], v84 offset:13312
    ds_read_b64_tr_b16 v[108:109], v86 offset:12288
    ds_read_b64_tr_b16 v[110:111], v86 offset:13312
    ds_read_b64_tr_b16 v[56:57], v85 offset:12288
    ds_read_b64_tr_b16 v[58:59], v85 offset:13312
    ds_read_b64_tr_b16 v[60:61], v87 offset:12288
    ds_read_b64_tr_b16 v[62:63], v87 offset:13312
    s_waitcnt lgkmcnt(0)
    ds_write_b128 v5, v[56:59] offset:4096
    ds_write_b128 v5, v[60:63] offset:5120
    s_branch L_lw_20
L_lw_20_1:
    s_cmp_lg_u32 s44, 2
    s_cbranch_scc1 L_lw_20_2
    ds_read_b64_tr_b16 a[168:169], v84 offset:12288
    ds_read_b64_tr_b16 a[170:171], v84 offset:13312
    ds_read_b64_tr_b16 a[172:173], v86 offset:12288
    ds_read_b64_tr_b16 a[174:175], v86 offset:13312
    ds_read_b64_tr_b16 v[56:57], v85 offset:12288
    ds_read_b64_tr_b16 v[58:59], v85 offset:13312
    ds_read_b64_tr_b16 v[60:61], v87 offset:12288
    ds_read_b64_tr_b16 v[62:63], v87 offset:13312
    s_waitcnt lgkmcnt(0)
    ds_write_b128 v5, v[56:59] offset:6144
    ds_write_b128 v5, v[60:63] offset:7168
    s_branch L_lw_20
L_lw_20_2:
    ds_read_b64_tr_b16 a[80:81], v84 offset:12288
    ds_read_b64_tr_b16 a[82:83], v84 offset:13312
    ds_read_b64_tr_b16 a[84:85], v86 offset:12288
    ds_read_b64_tr_b16 a[86:87], v86 offset:13312
    ds_read_b64_tr_b16 v[56:57], v85 offset:12288
    ds_read_b64_tr_b16 v[58:59], v85 offset:13312
    ds_read_b64_tr_b16 v[60:61], v87 offset:12288
    ds_read_b64_tr_b16 v[62:63], v87 offset:13312
    s_waitcnt lgkmcnt(0)
    ds_write_b128 v5, v[56:59] offset:2048
    ds_write_b128 v5, v[60:63] offset:3072
L_lw_20:
    s_waitcnt lgkmcnt(0)
    s_waitcnt vmcnt(20)
    s_barrier
    s_add_u32 s79, s41, 6
    s_and_b32 s79, s79, 3
    s_lshl_b32 s79, s79, 19
    s_add_u32 s79, s79, s47
    s_add_u32 s46, s79, 0x200000
    s_add_u32 m0, s48, 77824
    s_nop 0
    buffer_load_dwordx4 v82, s[28:31], s46 offen  lds
    s_add_u32 s46, s79, 0x220000
    s_add_u32 m0, s48, 102400
    s_nop 0
    buffer_load_dwordx4 v82, s[28:31], s46 offen  lds
    s_add_u32 s46, s79, 0x240000
    s_add_u32 m0, s48, 126976
    s_nop 0
    buffer_load_dwordx4 v82, s[28:31], s46 offen  lds
    s_add_u32 s46, s79, 0x260000
    s_add_u32 m0, s48, 151552
    s_nop 0
    buffer_load_dwordx4 v82, s[28:31], s46 offen  lds
    s_cmp_lg_u32 s44, 0
    s_cbranch_scc1 L_lw_21_0
    ds_read_b64_tr_b16 a[16:17], v84 offset:16384
    ds_read_b64_tr_b16 a[18:19], v84 offset:17408
    ds_read_b64_tr_b16 a[20:21], v86 offset:16384
    ds_read_b64_tr_b16 a[22:23], v86 offset:17408
    ds_read_b64_tr_b16 a[24:25], v85 offset:16384
    ds_read_b64_tr_b16 a[26:27], v85 offset:17408
    ds_read_b64_tr_b16 a[28:29], v87 offset:16384
    ds_read_b64_tr_b16 a[30:31], v87 offset:17408
    s_branch L_lw_21
L_lw_21_0:
    s_cmp_lg_u32 s44, 1
    s_cbranch_scc1 L_lw_21_1
    ds_read_b64_tr_b16 v[144:145], v84 offset:16384
    ds_read_b64_tr_b16 v[146:147], v84 offset:17408
    ds_read_b64_tr_b16 v[148:149], v86 offset:16384
    ds_read_b64_tr_b16 v[150:151], v86 offset:17408
    ds_read_b64_tr_b16 v[152:153], v85 offset:16384
    ds_read_b64_tr_b16 v[154:155], v85 offset:17408
    ds_read_b64_tr_b16 v[156:157], v87 offset:16384
    ds_read_b64_tr_b16 v[158:159], v87 offset:17408
    s_branch L_lw_21
L_lw_21_1:
    s_cmp_lg_u32 s44, 2
    s_cbranch_scc1 L_lw_21_2
    ds_read_b64_tr_b16 a[200:201], v84 offset:16384
    ds_read_b64_tr_b16 a[202:203], v84 offset:17408
    ds_read_b64_tr_b16 a[204:205], v86 offset:16384
    ds_read_b64_tr_b16 a[206:207], v86 offset:17408
    ds_read_b64_tr_b16 a[208:209], v85 offset:16384
    ds_read_b64_tr_b16 a[210:211], v85 offset:17408
    ds_read_b64_tr_b16 a[212:213], v87 offset:16384
    ds_read_b64_tr_b16 a[214:215], v87 offset:17408
    s_branch L_lw_21
L_lw_21_2:
    ds_read_b64_tr_b16 a[104:105], v84 offset:16384
    ds_read_b64_tr_b16 a[106:107], v84 offset:17408
    ds_read_b64_tr_b16 a[108:109], v86 offset:16384
    ds_read_b64_tr_b16 a[110:111], v86 offset:17408
    ds_read_b64_tr_b16 a[112:113], v85 offset:16384
    ds_read_b64_tr_b16 a[114:115], v85 offset:17408
    ds_read_b64_tr_b16 a[116:117], v87 offset:16384
    ds_read_b64_tr_b16 a[118:119], v87 offset:17408
L_lw_21:
    s_waitcnt lgkmcnt(0)
    s_waitcnt vmcnt(20)
    s_barrier
    s_add_u32 s79, s41, 7
    s_and_b32 s79, s79, 3
    s_lshl_b32 s79, s79, 19
    s_add_u32 s79, s79, s47
    s_add_u32 s46, s79, 0x200000
    s_add_u32 m0, s48, 81920
    s_nop 0
    buffer_load_dwordx4 v82, s[28:31], s46 offen  lds
    s_add_u32 s46, s79, 0x220000
    s_add_u32 m0, s48, 106496
    s_nop 0
    buffer_load_dwordx4 v82, s[28:31], s46 offen  lds
    s_add_u32 s46, s79, 0x240000
    s_add_u32 m0, s48, 131072
    s_nop 0
    buffer_load_dwordx4 v82, s[28:31], s46 offen  lds
    s_add_u32 s46, s79, 0x260000
    s_add_u32 m0, s48, 155648
    s_nop 0
    buffer_load_dwordx4 v82, s[28:31], s46 offen  lds
    s_cmp_lg_u32 s44, 0
    s_cbranch_scc1 L_lw_22_0
    ds_read_b64_tr_b16 a[48:49], v84 offset:20480
    ds_read_b64_tr_b16 a[50:51], v84 offset:21504
    ds_read_b64_tr_b16 a[52:53], v86 offset:20480
    ds_read_b64_tr_b16 a[54:55], v86 offset:21504
    ds_read_b64_tr_b16 a[56:57], v85 offset:20480
    ds_read_b64_tr_b16 a[58:59], v85 offset:21504
    ds_read_b64_tr_b16 a[60:61], v87 offset:20480
    ds_read_b64_tr_b16 a[62:63], v87 offset:21504
    s_branch L_lw_22
L_lw_22_0:
    s_cmp_lg_u32 s44, 1
    s_cbranch_scc1 L_lw_22_1
    ds_read_b64_tr_b16 v[176:177], v84 offset:20480
    ds_read_b64_tr_b16 v[178:179], v84 offset:21504
    ds_read_b64_tr_b16 v[180:181], v86 offset:20480
    ds_read_b64_tr_b16 v[182:183], v86 offset:21504
    ds_read_b64_tr_b16 v[184:185], v85 offset:20480
    ds_read_b64_tr_b16 v[186:187], v85 offset:21504
    ds_read_b64_tr_b16 v[188:189], v87 offset:20480
    ds_read_b64_tr_b16 v[190:191], v87 offset:21504
    s_branch L_lw_22
L_lw_22_1:
    s_cmp_lg_u32 s44, 2
    s_cbranch_scc1 L_lw_22_2
    ds_read_b64_tr_b16 a[224:225], v84 offset:20480
    ds_read_b64_tr_b16 a[226:227], v84 offset:21504
    ds_read_b64_tr_b16 a[228:229], v86 offset:20480
    ds_read_b64_tr_b16 a[230:231], v86 offset:21504
    ds_read_b64_tr_b16 a[232:233], v85 offset:20480
    ds_read_b64_tr_b16 a[234:235], v85 offset:21504
    ds_read_b64_tr_b16 a[236:237], v87 offset:20480
    ds_read_b64_tr_b16 a[238:239], v87 offset:21504
    s_branch L_lw_22
L_lw_22_2:
    ds_read_b64_tr_b16 a[128:129], v84 offset:20480
    ds_read_b64_tr_b16 a[130:131], v84 offset:21504
    ds_read_b64_tr_b16 a[132:133], v86 offset:20480
    ds_read_b64_tr_b16 a[134:135], v86 offset:21504
    ds_read_b64_tr_b16 a[136:137], v85 offset:20480
    ds_read_b64_tr_b16 a[138:139], v85 offset:21504
    ds_read_b64_tr_b16 a[140:141], v87 offset:20480
    ds_read_b64_tr_b16 a[142:143], v87 offset:21504
L_lw_22:
    s_waitcnt lgkmcnt(0)
    s_waitcnt vmcnt(20)
    s_barrier
    s_add_u32 s79, s41, 8
    s_and_b32 s79, s79, 3
    s_lshl_b32 s79, s79, 19
    s_add_u32 s79, s79, s47
    s_add_u32 s46, s79, 0x400000
    s_add_u32 m0, s48, 86016
    s_nop 0
    buffer_load_dwordx4 v82, s[28:31], s46 offen  lds
    s_add_u32 s46, s79, 0x420000
    s_add_u32 m0, s48, 110592
    s_nop 0
    buffer_load_dwordx4 v82, s[28:31], s46 offen  lds
    s_add_u32 s46, s79, 0x440000
    s_add_u32 m0, s48, 135168
    s_nop 0
    buffer_load_dwordx4 v82, s[28:31], s46 offen  lds
    s_add_u32 s46, s79, 0x460000
    s_add_u32 m0, s48, 159744
    s_nop 0
    buffer_load_dwordx4 v82, s[28:31], s46 offen  lds
    s_cmp_lg_u32 s44, 0
    s_cbranch_scc1 L_lw_23_0
    ds_read_b64_tr_b16 a[72:73], v80 offset:0
    ds_read_b64_tr_b16 a[74:75], v80 offset:1024
    ds_read_b64_tr_b16 a[76:77], v80 offset:8192
    ds_read_b64_tr_b16 a[78:79], v80 offset:9216
    ds_read_b64_tr_b16 v[56:57], v81 offset:0
    ds_read_b64_tr_b16 v[58:59], v81 offset:1024
    ds_read_b64_tr_b16 v[60:61], v81 offset:8192
    ds_read_b64_tr_b16 v[62:63], v81 offset:9216
    s_waitcnt lgkmcnt(0)
    ds_write_b128 v5, v[56:59] offset:8192
    ds_write_b128 v5, v[60:63] offset:9216
    s_branch L_lw_23
L_lw_23_0:
    s_cmp_lg_u32 s44, 1
    s_cbranch_scc1 L_lw_23_1
    ds_read_b64_tr_b16 v[208:209], v80 offset:0
    ds_read_b64_tr_b16 v[210:211], v80 offset:1024
    ds_read_b64_tr_b16 v[212:213], v80 offset:8192
    ds_read_b64_tr_b16 v[214:215], v80 offset:9216
    ds_read_b64_tr_b16 v[216:217], v81 offset:0
    ds_read_b64_tr_b16 v[218:219], v81 offset:1024
    ds_read_b64_tr_b16 v[220:221], v81 offset:8192
    ds_read_b64_tr_b16 v[222:223], v81 offset:9216
    s_branch L_lw_23
L_lw_23_1:
    s_cmp_lg_u32 s44, 2
    s_cbranch_scc1 L_lw_23_2
    ds_read_b64_tr_b16 a[248:249], v80 offset:0
    ds_read_b64_tr_b16 a[250:251], v80 offset:1024
    ds_read_b64_tr_b16 a[252:253], v80 offset:8192
    ds_read_b64_tr_b16 a[254:255], v80 offset:9216
    ds_read_b64_tr_b16 v[96:97], v81 offset:0
    ds_read_b64_tr_b16 v[98:99], v81 offset:1024
    ds_read_b64_tr_b16 v[100:101], v81 offset:8192
    ds_read_b64_tr_b16 v[102:103], v81 offset:9216
    s_branch L_lw_23
L_lw_23_2:
    ds_read_b64_tr_b16 a[152:153], v80 offset:0
    ds_read_b64_tr_b16 a[154:155], v80 offset:1024
    ds_read_b64_tr_b16 a[156:157], v80 offset:8192
    ds_read_b64_tr_b16 a[158:159], v80 offset:9216
    ds_read_b64_tr_b16 a[160:161], v81 offset:0
    ds_read_b64_tr_b16 a[162:163], v81 offset:1024
    ds_read_b64_tr_b16 a[164:165], v81 offset:8192
    ds_read_b64_tr_b16 a[166:167], v81 offset:9216
L_lw_23:
    s_waitcnt lgkmcnt(0)
    s_waitcnt vmcnt(20)
    s_barrier
    s_add_u32 s79, s41, 9
    s_and_b32 s79, s79, 3
    s_lshl_b32 s79, s79, 19
    s_add_u32 s79, s79, s47
    s_add_u32 s46, s79, 0x400000
    s_add_u32 m0, s48, 0
    s_nop 0
    buffer_load_dwordx4 v82, s[28:31], s46 offen  lds
    s_add_u32 s46, s79, 0x420000
    s_add_u32 m0, s48, 4096
    s_nop 0
    buffer_load_dwordx4 v82, s[28:31], s46 offen  lds
    s_add_u32 s46, s79, 0x440000
    s_add_u32 m0, s48, 8192
    s_nop 0
    buffer_load_dwordx4 v82, s[28:31], s46 offen  lds
    s_add_u32 s46, s79, 0x460000
    s_add_u32 m0, s48, 12288
    s_nop 0
    buffer_load_dwordx4 v82, s[28:31], s46 offen  lds
    s_cmp_lg_u32 s44, 0
    s_cbranch_scc1 L_lw_24_0
    ds_read_b64_tr_b16 a[88:89], v80 offset:16384
    ds_read_b64_tr_b16 a[90:91], v80 offset:17408
    ds_read_b64_tr_b16 a[92:93], v80 offset:24576
    ds_read_b64_tr_b16 a[94:95], v80 offset:25600
    ds_read_b64_tr_b16 v[56:57], v81 offset:16384
    ds_read_b64_tr_b16 v[58:59], v81 offset:17408
    ds_read_b64_tr_b16 v[60:61], v81 offset:24576
    ds_read_b64_tr_b16 v[62:63], v81 offset:25600
    s_waitcnt lgkmcnt(0)
    ds_write_b128 v5, v[56:59] offset:10240
    ds_write_b128 v5, v[60:63] offset:11264
    s_branch L_lw_24
L_lw_24_0:
    s_cmp_lg_u32 s44, 1
    s_cbranch_scc1 L_lw_24_1
    ds_read_b64_tr_b16 v[240:241], v80 offset:16384
    ds_read_b64_tr_b16 v[242:243], v80 offset:17408
    ds_read_b64_tr_b16 v[244:245], v80 offset:24576
    ds_read_b64_tr_b16 v[246:247], v80 offset:25600
    ds_read_b64_tr_b16 v[248:249], v81 offset:16384
    ds_read_b64_tr_b16 v[250:251], v81 offset:17408
    ds_read_b64_tr_b16 v[252:253], v81 offset:24576
    ds_read_b64_tr_b16 v[254:255], v81 offset:25600
    s_branch L_lw_24
L_lw_24_1:
    s_cmp_lg_u32 s44, 2
    s_cbranch_scc1 L_lw_24_2
    ds_read_b64_tr_b16 v[112:113], v80 offset:16384
    ds_read_b64_tr_b16 v[114:115], v80 offset:17408
    ds_read_b64_tr_b16 v[116:117], v80 offset:24576
    ds_read_b64_tr_b16 v[118:119], v80 offset:25600
    ds_read_b64_tr_b16 v[120:121], v81 offset:16384
    ds_read_b64_tr_b16 v[122:123], v81 offset:17408
    ds_read_b64_tr_b16 v[124:125], v81 offset:24576
    ds_read_b64_tr_b16 v[126:127], v81 offset:25600
    s_branch L_lw_24
L_lw_24_2:
    ds_read_b64_tr_b16 a[176:177], v80 offset:16384
    ds_read_b64_tr_b16 a[178:179], v80 offset:17408
    ds_read_b64_tr_b16 a[180:181], v80 offset:24576
    ds_read_b64_tr_b16 a[182:183], v80 offset:25600
    ds_read_b64_tr_b16 a[184:185], v81 offset:16384
    ds_read_b64_tr_b16 a[186:187], v81 offset:17408
    ds_read_b64_tr_b16 a[188:189], v81 offset:24576
    ds_read_b64_tr_b16 a[190:191], v81 offset:25600
L_lw_24:
    s_waitcnt lgkmcnt(0)
    s_waitcnt vmcnt(20)
    s_barrier
    s_add_u32 s79, s41, 10
    s_and_b32 s79, s79, 3
    s_lshl_b32 s79, s79, 19
    s_add_u32 s79, s79, s47
    s_add_u32 s46, s79, 0x400000
    s_add_u32 m0, s48, 16384
    s_nop 0
    buffer_load_dwordx4 v82, s[28:31], s46 offen  lds
    s_add_u32 s46, s79, 0x420000
    s_add_u32 m0, s48, 20480
    s_nop 0
    buffer_load_dwordx4 v82, s[28:31], s46 offen  lds
    s_add_u32 s46, s79, 0x440000
    s_add_u32 m0, s48, 24576
    s_nop 0
    buffer_load_dwordx4 v82, s[28:31], s46 offen  lds
    s_add_u32 s46, s79, 0x460000
    s_add_u32 m0, s48, 28672
    s_nop 0
    buffer_load_dwordx4 v82, s[28:31], s46 offen  lds
    s_cmp_lg_u32 s44, 0
    s_cbranch_scc1 L_lw_25_0
    ds_read_b64_tr_b16 a[104:105], v80 offset:32768
    ds_read_b64_tr_b16 a[106:107], v80 offset:33792
    ds_read_b64_tr_b16 a[108:109], v80 offset:40960
    ds_read_b64_tr_b16 a[110:111], v80 offset:41984
    ds_read_b64_tr_b16 a[112:113], v81 offset:32768
    ds_read_b64_tr_b16 a[114:115], v81 offset:33792
    ds_read_b64_tr_b16 a[116:117], v81 offset:40960
    ds_read_b64_tr_b16 a[118:119], v81 offset:41984
    s_branch L_lw_25
L_lw_25_0:
    s_cmp_lg_u32 s44, 1
    s_cbranch_scc1 L_lw_25_1
    ds_read_b64_tr_b16 a[16:17], v80 offset:32768
    ds_read_b64_tr_b16 a[18:19], v80 offset:33792
    ds_read_b64_tr_b16 a[20:21], v80 offset:40960
    ds_read_b64_tr_b16 a[22:23], v80 offset:41984
    ds_read_b64_tr_b16 a[24:25], v81 offset:32768
    ds_read_b64_tr_b16 a[26:27], v81 offset:33792
    ds_read_b64_tr_b16 a[28:29], v81 offset:40960
    ds_read_b64_tr_b16 a[30:31], v81 offset:41984
    s_branch L_lw_25
L_lw_25_1:
    s_cmp_lg_u32 s44, 2
    s_cbranch_scc1 L_lw_25_2
    ds_read_b64_tr_b16 v[144:145], v80 offset:32768
    ds_read_b64_tr_b16 v[146:147], v80 offset:33792
    ds_read_b64_tr_b16 v[148:149], v80 offset:40960
    ds_read_b64_tr_b16 v[150:151], v80 offset:41984
    ds_read_b64_tr_b16 v[152:153], v81 offset:32768
    ds_read_b64_tr_b16 v[154:155], v81 offset:33792
    ds_read_b64_tr_b16 v[156:157], v81 offset:40960
    ds_read_b64_tr_b16 v[158:159], v81 offset:41984
    s_branch L_lw_25
L_lw_25_2:
    ds_read_b64_tr_b16 a[200:201], v80 offset:32768
    ds_read_b64_tr_b16 a[202:203], v80 offset:33792
    ds_read_b64_tr_b16 a[204:205], v80 offset:40960
    ds_read_b64_tr_b16 a[206:207], v80 offset:41984
    ds_read_b64_tr_b16 a[208:209], v81 offset:32768
    ds_read_b64_tr_b16 a[210:211], v81 offset:33792
    ds_read_b64_tr_b16 a[212:213], v81 offset:40960
    ds_read_b64_tr_b16 a[214:215], v81 offset:41984
L_lw_25:
    s_waitcnt lgkmcnt(0)
    s_waitcnt vmcnt(20)
    s_barrier
    s_add_u32 s79, s41, 11
    s_and_b32 s79, s79, 3
    s_lshl_b32 s79, s79, 19
    s_add_u32 s79, s79, s47
    s_add_u32 s46, s79, 0x400000
    s_add_u32 m0, s48, 32768
    s_nop 0
    buffer_load_dwordx4 v82, s[28:31], s46 offen  lds
    s_add_u32 s46, s79, 0x420000
    s_add_u32 m0, s48, 36864
    s_nop 0
    buffer_load_dwordx4 v82, s[28:31], s46 offen  lds
    s_add_u32 s46, s79, 0x440000
    s_add_u32 m0, s48, 40960
    s_nop 0
    buffer_load_dwordx4 v82, s[28:31], s46 offen  lds
    s_add_u32 s46, s79, 0x460000
    s_add_u32 m0, s48, 45056
    s_nop 0
    buffer_load_dwordx4 v82, s[28:31], s46 offen  lds
    s_cmp_lg_u32 s44, 0
    s_cbranch_scc1 L_lw_26_0
    ds_read_b64_tr_b16 a[128:129], v80 offset:49152
    ds_read_b64_tr_b16 a[130:131], v80 offset:50176
    ds_read_b64_tr_b16 a[132:133], v80 offset:57344
    ds_read_b64_tr_b16 a[134:135], v80 offset:58368
    ds_read_b64_tr_b16 a[136:137], v81 offset:49152
    ds_read_b64_tr_b16 a[138:139], v81 offset:50176
    ds_read_b64_tr_b16 a[140:141], v81 offset:57344
    ds_read_b64_tr_b16 a[142:143], v81 offset:58368
    s_branch L_lw_26
L_lw_26_0:
    s_cmp_lg_u32 s44, 1
    s_cbranch_scc1 L_lw_26_1
    ds_read_b64_tr_b16 a[48:49], v80 offset:49152
    ds_read_b64_tr_b16 a[50:51], v80 offset:50176
    ds_read_b64_tr_b16 a[52:53], v80 offset:57344
    ds_read_b64_tr_b16 a[54:55], v80 offset:58368
    ds_read_b64_tr_b16 a[56:57], v81 offset:49152
    ds_read_b64_tr_b16 a[58:59], v81 offset:50176
    ds_read_b64_tr_b16 a[60:61], v81 offset:57344
    ds_read_b64_tr_b16 a[62:63], v81 offset:58368
    s_branch L_lw_26
L_lw_26_1:
    s_cmp_lg_u32 s44, 2
    s_cbranch_scc1 L_lw_26_2
    ds_read_b64_tr_b16 v[176:177], v80 offset:49152
    ds_read_b64_tr_b16 v[178:179], v80 offset:50176
    ds_read_b64_tr_b16 v[180:181], v80 offset:57344
    ds_read_b64_tr_b16 v[182:183], v80 offset:58368
    ds_read_b64_tr_b16 v[184:185], v81 offset:49152
    ds_read_b64_tr_b16 v[186:187], v81 offset:50176
    ds_read_b64_tr_b16 v[188:189], v81 offset:57344
    ds_read_b64_tr_b16 v[190:191], v81 offset:58368
    s_branch L_lw_26
L_lw_26_2:
    ds_read_b64_tr_b16 a[224:225], v80 offset:49152
    ds_read_b64_tr_b16 a[226:227], v80 offset:50176
    ds_read_b64_tr_b16 a[228:229], v80 offset:57344
    ds_read_b64_tr_b16 a[230:231], v80 offset:58368
    ds_read_b64_tr_b16 a[232:233], v81 offset:49152
    ds_read_b64_tr_b16 a[234:235], v81 offset:50176
    ds_read_b64_tr_b16 a[236:237], v81 offset:57344
    ds_read_b64_tr_b16 a[238:239], v81 offset:58368
L_lw_26:
    s_waitcnt lgkmcnt(0)
    s_waitcnt vmcnt(20)
    s_barrier
    s_add_u32 s79, s41, 12
    s_and_b32 s79, s79, 3
    s_lshl_b32 s79, s79, 19
    s_add_u32 s79, s79, s47
    s_add_u32 s46, s79, 0x600000
    s_add_u32 m0, s48, 49152
    s_nop 0
    buffer_load_dwordx4 v82, s[28:31], s46 offen  lds
    s_add_u32 s46, s79, 0x620000
    s_add_u32 m0, s48, 53248
    s_nop 0
    buffer_load_dwordx4 v82, s[28:31], s46 offen  lds
    s_add_u32 s46, s79, 0x640000
    s_add_u32 m0, s48, 57344
    s_nop 0
    buffer_load_dwordx4 v82, s[28:31], s46 offen  lds
    s_add_u32 s46, s79, 0x660000
    s_add_u32 m0, s48, 61440
    s_nop 0
    buffer_load_dwordx4 v82, s[28:31], s46 offen  lds
    s_cmp_lg_u32 s44, 0
    s_cbranch_scc1 L_lw_27_0
    ds_read_b64_tr_b16 a[152:153], v84 offset:12288
    ds_read_b64_tr_b16 a[154:155], v84 offset:13312
    ds_read_b64_tr_b16 a[156:157], v86 offset:12288
    ds_read_b64_tr_b16 a[158:159], v86 offset:13312
    ds_read_b64_tr_b16 a[160:161], v85 offset:12288
    ds_read_b64_tr_b16 a[162:163], v85 offset:13312
    ds_read_b64_tr_b16 a[164:165], v87 offset:12288
    ds_read_b64_tr_b16 a[166:167], v87 offset:13312
    s_branch L_lw_27
L_lw_27_0:
    s_cmp_lg_u32 s44, 1
    s_cbranch_scc1 L_lw_27_1
    ds_read_b64_tr_b16 a[72:73], v84 offset:12288
    ds_read_b64_tr_b16 a[74:75], v84 offset:13312
    ds_read_b64_tr_b16 a[76:77], v86 offset:12288
    ds_read_b64_tr_b16 a[78:79], v86 offset:13312
    ds_read_b64_tr_b16 v[56:57], v85 offset:12288
    ds_read_b64_tr_b16 v[58:59], v85 offset:13312
    ds_read_b64_tr_b16 v[60:61], v87 offset:12288
    ds_read_b64_tr_b16 v[62:63], v87 offset:13312
    s_waitcnt lgkmcnt(0)
    ds_write_b128 v5, v[56:59] offset:8192
    ds_write_b128 v5, v[60:63] offset:9216
    s_branch L_lw_27
L_lw_27_1:
    s_cmp_lg_u32 s44, 2
    s_cbranch_scc1 L_lw_27_2
    ds_read_b64_tr_b16 v[208:209], v84 offset:12288
    ds_read_b64_tr_b16 v[210:211], v84 offset:13312
    ds_read_b64_tr_b16 v[212:213], v86 offset:12288
    ds_read_b64_tr_b16 v[214:215], v86 offset:13312
    ds_read_b64_tr_b16 v[216:217], v85 offset:12288
    ds_read_b64_tr_b16 v[218:219], v85 offset:13312
    ds_read_b64_tr_b16 v[220:221], v87 offset:12288
    ds_read_b64_tr_b16 v[222:223], v87 offset:13312
    s_branch L_lw_27
L_lw_27_2:
    ds_read_b64_tr_b16 a[248:249], v84 offset:12288
    ds_read_b64_tr_b16 a[250:251], v84 offset:13312
    ds_read_b64_tr_b16 a[252:253], v86 offset:12288
    ds_read_b64_tr_b16 a[254:255], v86 offset:13312
    ds_read_b64_tr_b16 v[96:97], v85 offset:12288
    ds_read_b64_tr_b16 v[98:99], v85 offset:13312
    ds_read_b64_tr_b16 v[100:101], v87 offset:12288
    ds_read_b64_tr_b16 v[102:103], v87 offset:13312
L_lw_27:
    s_waitcnt lgkmcnt(0)
    s_waitcnt vmcnt(20)
    s_barrier
    s_add_u32 s79, s41, 13
    s_and_b32 s79, s79, 3
    s_lshl_b32 s79, s79, 19
    s_add_u32 s79, s79, s47
    s_add_u32 s46, s79, 0x600000
    s_add_u32 m0, s48, 77824
    s_nop 0
    buffer_load_dwordx4 v82, s[28:31], s46 offen  lds
    s_add_u32 s46, s79, 0x620000
    s_add_u32 m0, s48, 102400
    s_nop 0
    buffer_load_dwordx4 v82, s[28:31], s46 offen  lds
    s_add_u32 s46, s79, 0x640000
    s_add_u32 m0, s48, 126976
    s_nop 0
    buffer_load_dwordx4 v82, s[28:31], s46 offen  lds
    s_add_u32 s46, s79, 0x660000
    s_add_u32 m0, s48, 151552
    s_nop 0
    buffer_load_dwordx4 v82, s[28:31], s46 offen  lds
    s_cmp_lg_u32 s44, 0
    s_cbranch_scc1 L_lw_28_0
    ds_read_b64_tr_b16 a[176:177], v84 offset:16384
    ds_read_b64_tr_b16 a[178:179], v84 offset:17408
    ds_read_b64_tr_b16 a[180:181], v86 offset:16384
    ds_read_b64_tr_b16 a[182:183], v86 offset:17408
    ds_read_b64_tr_b16 a[184:185], v85 offset:16384
    ds_read_b64_tr_b16 a[186:187], v85 offset:17408
    ds_read_b64_tr_b16 a[188:189], v87 offset:16384
    ds_read_b64_tr_b16 a[190:191], v87 offset:17408
    s_branch L_lw_28
L_lw_28_0:
    s_cmp_lg_u32 s44, 1
    s_cbranch_scc1 L_lw_28_1
    ds_read_b64_tr_b16 a[88:89], v84 offset:16384
    ds_read_b64_tr_b16 a[90:91], v84 offset:17408
    ds_read_b64_tr_b16 a[92:93], v86 offset:16384
    ds_read_b64_tr_b16 a[94:95], v86 offset:17408
    ds_read_b64_tr_b16 v[56:57], v85 offset:16384
    ds_read_b64_tr_b16 v[58:59], v85 offset:17408
    ds_read_b64_tr_b16 v[60:61], v87 offset:16384
    ds_read_b64_tr_b16 v[62:63], v87 offset:17408
    s_waitcnt lgkmcnt(0)
    ds_write_b128 v5, v[56:59] offset:10240
    ds_write_b128 v5, v[60:63] offset:11264
    s_branch L_lw_28
L_lw_28_1:
    s_cmp_lg_u32 s44, 2
    s_cbranch_scc1 L_lw_28_2
    ds_read_b64_tr_b16 v[240:241], v84 offset:16384
    ds_read_b64_tr_b16 v[242:243], v84 offset:17408
    ds_read_b64_tr_b16 v[244:245], v86 offset:16384
    ds_read_b64_tr_b16 v[246:247], v86 offset:17408
    ds_read_b64_tr_b16 v[248:249], v85 offset:16384
    ds_read_b64_tr_b16 v[250:251], v85 offset:17408
    ds_read_b64_tr_b16 v[252:253], v87 offset:16384
    ds_read_b64_tr_b16 v[254:255], v87 offset:17408
    s_branch L_lw_28
L_lw_28_2:
    ds_read_b64_tr_b16 v[112:113], v84 offset:16384
    ds_read_b64_tr_b16 v[114:115], v84 offset:17408
    ds_read_b64_tr_b16 v[116:117], v86 offset:16384
    ds_read_b64_tr_b16 v[118:119], v86 offset:17408
    ds_read_b64_tr_b16 v[120:121], v85 offset:16384
    ds_read_b64_tr_b16 v[122:123], v85 offset:17408
    ds_read_b64_tr_b16 v[124:125], v87 offset:16384
    ds_read_b64_tr_b16 v[126:127], v87 offset:17408
L_lw_28:
    s_waitcnt lgkmcnt(0)
    s_waitcnt vmcnt(20)
    s_barrier
    s_add_u32 s79, s41, 14
    s_and_b32 s79, s79, 3
    s_lshl_b32 s79, s79, 19
    s_add_u32 s79, s79, s47
    s_add_u32 s46, s79, 0x600000
    s_add_u32 m0, s48, 81920
    s_nop 0
    buffer_load_dwordx4 v82, s[28:31], s46 offen  lds
    s_add_u32 s46, s79, 0x620000
    s_add_u32 m0, s48, 106496
    s_nop 0
    buffer_load_dwordx4 v82, s[28:31], s46 offen  lds
    s_add_u32 s46, s79, 0x640000
    s_add_u32 m0, s48, 131072
    s_nop 0
    buffer_load_dwordx4 v82, s[28:31], s46 offen  lds
    s_add_u32 s46, s79, 0x660000
    s_add_u32 m0, s48, 155648
    s_nop 0
    buffer_load_dwordx4 v82, s[28:31], s46 offen  lds
    s_cmp_lg_u32 s44, 0
    s_cbranch_scc1 L_lw_29_0
    ds_read_b64_tr_b16 a[200:201], v84 offset:20480
    ds_read_b64_tr_b16 a[202:203], v84 offset:21504
    ds_read_b64_tr_b16 a[204:205], v86 offset:20480
    ds_read_b64_tr_b16 a[206:207], v86 offset:21504
    ds_read_b64_tr_b16 a[208:209], v85 offset:20480
    ds_read_b64_tr_b16 a[210:211], v85 offset:21504
    ds_read_b64_tr_b16 a[212:213], v87 offset:20480
    ds_read_b64_tr_b16 a[214:215], v87 offset:21504
    s_branch L_lw_29
L_lw_29_0:
    s_cmp_lg_u32 s44, 1
    s_cbranch_scc1 L_lw_29_1
    ds_read_b64_tr_b16 a[104:105], v84 offset:20480
    ds_read_b64_tr_b16 a[106:107], v84 offset:21504
    ds_read_b64_tr_b16 a[108:109], v86 offset:20480
    ds_read_b64_tr_b16 a[110:111], v86 offset:21504
    ds_read_b64_tr_b16 a[112:113], v85 offset:20480
    ds_read_b64_tr_b16 a[114:115], v85 offset:21504
    ds_read_b64_tr_b16 a[116:117], v87 offset:20480
    ds_read_b64_tr_b16 a[118:119], v87 offset:21504
    s_branch L_lw_29
L_lw_29_1:
    s_cmp_lg_u32 s44, 2
    s_cbranch_scc1 L_lw_29_2
    ds_read_b64_tr_b16 a[16:17], v84 offset:20480
    ds_read_b64_tr_b16 a[18:19], v84 offset:21504
    ds_read_b64_tr_b16 a[20:21], v86 offset:20480
    ds_read_b64_tr_b16 a[22:23], v86 offset:21504
    ds_read_b64_tr_b16 a[24:25], v85 offset:20480
    ds_read_b64_tr_b16 a[26:27], v85 offset:21504
    ds_read_b64_tr_b16 a[28:29], v87 offset:20480
    ds_read_b64_tr_b16 a[30:31], v87 offset:21504
    s_branch L_lw_29
L_lw_29_2:
    ds_read_b64_tr_b16 v[144:145], v84 offset:20480
    ds_read_b64_tr_b16 v[146:147], v84 offset:21504
    ds_read_b64_tr_b16 v[148:149], v86 offset:20480
    ds_read_b64_tr_b16 v[150:151], v86 offset:21504
    ds_read_b64_tr_b16 v[152:153], v85 offset:20480
    ds_read_b64_tr_b16 v[154:155], v85 offset:21504
    ds_read_b64_tr_b16 v[156:157], v87 offset:20480
    ds_read_b64_tr_b16 v[158:159], v87 offset:21504
L_lw_29:
    s_waitcnt lgkmcnt(0)
    s_waitcnt vmcnt(20)
    s_barrier
    s_add_u32 s79, s41, 15
    s_and_b32 s79, s79, 3
    s_lshl_b32 s79, s79, 19
    s_add_u32 s79, s79, s47
    s_add_u32 s46, s79, 0x600000
    s_add_u32 m0, s48, 86016
    s_nop 0
    buffer_load_dwordx4 v82, s[28:31], s46 offen  lds
    s_add_u32 s46, s79, 0x620000
    s_add_u32 m0, s48, 110592
    s_nop 0
    buffer_load_dwordx4 v82, s[28:31], s46 offen  lds
    s_add_u32 s46, s79, 0x640000
    s_add_u32 m0, s48, 135168
    s_nop 0
    buffer_load_dwordx4 v82, s[28:31], s46 offen  lds
    s_add_u32 s46, s79, 0x660000
    s_add_u32 m0, s48, 159744
    s_nop 0
    buffer_load_dwordx4 v82, s[28:31], s46 offen  lds
    s_cmp_lg_u32 s44, 0
    s_cbranch_scc1 L_lw_30_0
    ds_read_b64_tr_b16 a[224:225], v80 offset:0
    ds_read_b64_tr_b16 a[226:227], v80 offset:1024
    ds_read_b64_tr_b16 a[228:229], v80 offset:8192
    ds_read_b64_tr_b16 a[230:231], v80 offset:9216
    ds_read_b64_tr_b16 a[232:233], v81 offset:0
    ds_read_b64_tr_b16 a[234:235], v81 offset:1024
    ds_read_b64_tr_b16 a[236:237], v81 offset:8192
    ds_read_b64_tr_b16 a[238:239], v81 offset:9216
    s_branch L_lw_30
L_lw_30_0:
    s_cmp_lg_u32 s44, 1
    s_cbranch_scc1 L_lw_30_1
    ds_read_b64_tr_b16 a[128:129], v80 offset:0
    ds_read_b64_tr_b16 a[130:131], v80 offset:1024
    ds_read_b64_tr_b16 a[132:133], v80 offset:8192
    ds_read_b64_tr_b16 a[134:135], v80 offset:9216
    ds_read_b64_tr_b16 a[136:137], v81 offset:0
    ds_read_b64_tr_b16 a[138:139], v81 offset:1024
    ds_read_b64_tr_b16 a[140:141], v81 offset:8192
    ds_read_b64_tr_b16 a[142:143], v81 offset:9216
    s_branch L_lw_30
L_lw_30_1:
    s_cmp_lg_u32 s44, 2
    s_cbranch_scc1 L_lw_30_2
    ds_read_b64_tr_b16 a[48:49], v80 offset:0
    ds_read_b64_tr_b16 a[50:51], v80 offset:1024
    ds_read_b64_tr_b16 a[52:53], v80 offset:8192
    ds_read_b64_tr_b16 a[54:55], v80 offset:9216
    ds_read_b64_tr_b16 a[56:57], v81 offset:0
    ds_read_b64_tr_b16 a[58:59], v81 offset:1024
    ds_read_b64_tr_b16 a[60:61], v81 offset:8192
    ds_read_b64_tr_b16 a[62:63], v81 offset:9216
    s_branch L_lw_30
L_lw_30_2:
    ds_read_b64_tr_b16 v[176:177], v80 offset:0
    ds_read_b64_tr_b16 v[178:179], v80 offset:1024
    ds_read_b64_tr_b16 v[180:181], v80 offset:8192
    ds_read_b64_tr_b16 v[182:183], v80 offset:9216
    ds_read_b64_tr_b16 v[184:185], v81 offset:0
    ds_read_b64_tr_b16 v[186:187], v81 offset:1024
    ds_read_b64_tr_b16 v[188:189], v81 offset:8192
    ds_read_b64_tr_b16 v[190:191], v81 offset:9216
L_lw_30:
    s_waitcnt lgkmcnt(0)
    s_waitcnt vmcnt(20)
    s_barrier
    s_cmp_lg_u32 s44, 0
    s_cbranch_scc1 L_lw_31_0
    ds_read_b64_tr_b16 a[248:249], v80 offset:16384
    ds_read_b64_tr_b16 a[250:251], v80 offset:17408
    ds_read_b64_tr_b16 a[252:253], v80 offset:24576
    ds_read_b64_tr_b16 a[254:255], v80 offset:25600
    ds_read_b64_tr_b16 v[96:97], v81 offset:16384
    ds_read_b64_tr_b16 v[98:99], v81 offset:17408
    ds_read_b64_tr_b16 v[100:101], v81 offset:24576
    ds_read_b64_tr_b16 v[102:103], v81 offset:25600
    s_branch L_lw_31
L_lw_31_0:
    s_cmp_lg_u32 s44, 1
    s_cbranch_scc1 L_lw_31_1
    ds_read_b64_tr_b16 a[152:153], v80 offset:16384
    ds_read_b64_tr_b16 a[154:155], v80 offset:17408
    ds_read_b64_tr_b16 a[156:157], v80 offset:24576
    ds_read_b64_tr_b16 a[158:159], v80 offset:25600
    ds_read_b64_tr_b16 a[160:161], v81 offset:16384
    ds_read_b64_tr_b16 a[162:163], v81 offset:17408
    ds_read_b64_tr_b16 a[164:165], v81 offset:24576
    ds_read_b64_tr_b16 a[166:167], v81 offset:25600
    s_branch L_lw_31
L_lw_31_1:
    s_cmp_lg_u32 s44, 2
    s_cbranch_scc1 L_lw_31_2
    ds_read_b64_tr_b16 a[72:73], v80 offset:16384
    ds_read_b64_tr_b16 a[74:75], v80 offset:17408
    ds_read_b64_tr_b16 a[76:77], v80 offset:24576
    ds_read_b64_tr_b16 a[78:79], v80 offset:25600
    ds_read_b64_tr_b16 v[56:57], v81 offset:16384
    ds_read_b64_tr_b16 v[58:59], v81 offset:17408
    ds_read_b64_tr_b16 v[60:61], v81 offset:24576
    ds_read_b64_tr_b16 v[62:63], v81 offset:25600
    s_waitcnt lgkmcnt(0)
    ds_write_b128 v5, v[56:59] offset:8192
    ds_write_b128 v5, v[60:63] offset:9216
    s_branch L_lw_31
L_lw_31_2:
    ds_read_b64_tr_b16 v[208:209], v80 offset:16384
    ds_read_b64_tr_b16 v[210:211], v80 offset:17408
    ds_read_b64_tr_b16 v[212:213], v80 offset:24576
    ds_read_b64_tr_b16 v[214:215], v80 offset:25600
    ds_read_b64_tr_b16 v[216:217], v81 offset:16384
    ds_read_b64_tr_b16 v[218:219], v81 offset:17408
    ds_read_b64_tr_b16 v[220:221], v81 offset:24576
    ds_read_b64_tr_b16 v[222:223], v81 offset:25600
L_lw_31:
    s_waitcnt lgkmcnt(0)
    s_waitcnt vmcnt(16)
    s_barrier
    s_cmp_lg_u32 s44, 0
    s_cbranch_scc1 L_lw_32_0
    ds_read_b64_tr_b16 v[112:113], v80 offset:32768
    ds_read_b64_tr_b16 v[114:115], v80 offset:33792
    ds_read_b64_tr_b16 v[116:117], v80 offset:40960
    ds_read_b64_tr_b16 v[118:119], v80 offset:41984
    ds_read_b64_tr_b16 v[120:121], v81 offset:32768
    ds_read_b64_tr_b16 v[122:123], v81 offset:33792
    ds_read_b64_tr_b16 v[124:125], v81 offset:40960
    ds_read_b64_tr_b16 v[126:127], v81 offset:41984
    s_branch L_lw_32
L_lw_32_0:
    s_cmp_lg_u32 s44, 1
    s_cbranch_scc1 L_lw_32_1
    ds_read_b64_tr_b16 a[176:177], v80 offset:32768
    ds_read_b64_tr_b16 a[178:179], v80 offset:33792
    ds_read_b64_tr_b16 a[180:181], v80 offset:40960
    ds_read_b64_tr_b16 a[182:183], v80 offset:41984
    ds_read_b64_tr_b16 a[184:185], v81 offset:32768
    ds_read_b64_tr_b16 a[186:187], v81 offset:33792
    ds_read_b64_tr_b16 a[188:189], v81 offset:40960
    ds_read_b64_tr_b16 a[190:191], v81 offset:41984
    s_branch L_lw_32
L_lw_32_1:
    s_cmp_lg_u32 s44, 2
    s_cbranch_scc1 L_lw_32_2
    ds_read_b64_tr_b16 a[88:89], v80 offset:32768
    ds_read_b64_tr_b16 a[90:91], v80 offset:33792
    ds_read_b64_tr_b16 a[92:93], v80 offset:40960
    ds_read_b64_tr_b16 a[94:95], v80 offset:41984
    ds_read_b64_tr_b16 v[56:57], v81 offset:32768
    ds_read_b64_tr_b16 v[58:59], v81 offset:33792
    ds_read_b64_tr_b16 v[60:61], v81 offset:40960
    ds_read_b64_tr_b16 v[62:63], v81 offset:41984
    s_waitcnt lgkmcnt(0)
    ds_write_b128 v5, v[56:59] offset:10240
    ds_write_b128 v5, v[60:63] offset:11264
    s_branch L_lw_32
L_lw_32_2:
    ds_read_b64_tr_b16 v[240:241], v80 offset:32768
    ds_read_b64_tr_b16 v[242:243], v80 offset:33792
    ds_read_b64_tr_b16 v[244:245], v80 offset:40960
    ds_read_b64_tr_b16 v[246:247], v80 offset:41984
    ds_read_b64_tr_b16 v[248:249], v81 offset:32768
    ds_read_b64_tr_b16 v[250:251], v81 offset:33792
    ds_read_b64_tr_b16 v[252:253], v81 offset:40960
    ds_read_b64_tr_b16 v[254:255], v81 offset:41984
L_lw_32:
    s_waitcnt lgkmcnt(0)
    s_waitcnt vmcnt(12)
    s_barrier
    s_cmp_lg_u32 s44, 0
    s_cbranch_scc1 L_lw_33_0
    ds_read_b64_tr_b16 v[144:145], v80 offset:49152
    ds_read_b64_tr_b16 v[146:147], v80 offset:50176
    ds_read_b64_tr_b16 v[148:149], v80 offset:57344
    ds_read_b64_tr_b16 v[150:151], v80 offset:58368
    ds_read_b64_tr_b16 v[152:153], v81 offset:49152
    ds_read_b64_tr_b16 v[154:155], v81 offset:50176
    ds_read_b64_tr_b16 v[156:157], v81 offset:57344
    ds_read_b64_tr_b16 v[158:159], v81 offset:58368
    s_branch L_lw_33
L_lw_33_0:
    s_cmp_lg_u32 s44, 1
    s_cbranch_scc1 L_lw_33_1
    ds_read_b64_tr_b16 a[200:201], v80 offset:49152
    ds_read_b64_tr_b16 a[202:203], v80 offset:50176
    ds_read_b64_tr_b16 a[204:205], v80 offset:57344
    ds_read_b64_tr_b16 a[206:207], v80 offset:58368
    ds_read_b64_tr_b16 a[208:209], v81 offset:49152
    ds_read_b64_tr_b16 a[210:211], v81 offset:50176
    ds_read_b64_tr_b16 a[212:213], v81 offset:57344
    ds_read_b64_tr_b16 a[214:215], v81 offset:58368
    s_branch L_lw_33
L_lw_33_1:
    s_cmp_lg_u32 s44, 2
    s_cbranch_scc1 L_lw_33_2
    ds_read_b64_tr_b16 a[104:105], v80 offset:49152
    ds_read_b64_tr_b16 a[106:107], v80 offset:50176
    ds_read_b64_tr_b16 a[108:109], v80 offset:57344
    ds_read_b64_tr_b16 a[110:111], v80 offset:58368
    ds_read_b64_tr_b16 a[112:113], v81 offset:49152
    ds_read_b64_tr_b16 a[114:115], v81 offset:50176
    ds_read_b64_tr_b16 a[116:117], v81 offset:57344
    ds_read_b64_tr_b16 a[118:119], v81 offset:58368
    s_branch L_lw_33
L_lw_33_2:
    ds_read_b64_tr_b16 a[16:17], v80 offset:49152
    ds_read_b64_tr_b16 a[18:19], v80 offset:50176
    ds_read_b64_tr_b16 a[20:21], v80 offset:57344
    ds_read_b64_tr_b16 a[22:23], v80 offset:58368
    ds_read_b64_tr_b16 a[24:25], v81 offset:49152
    ds_read_b64_tr_b16 a[26:27], v81 offset:50176
    ds_read_b64_tr_b16 a[28:29], v81 offset:57344
    ds_read_b64_tr_b16 a[30:31], v81 offset:58368
L_lw_33:
    s_waitcnt lgkmcnt(0)
    s_waitcnt vmcnt(8)
    s_barrier
    s_cmp_lg_u32 s44, 0
    s_cbranch_scc1 L_lw_34_0
    ds_read_b64_tr_b16 v[176:177], v84 offset:12288
    ds_read_b64_tr_b16 v[178:179], v84 offset:13312
    ds_read_b64_tr_b16 v[180:181], v86 offset:12288
    ds_read_b64_tr_b16 v[182:183], v86 offset:13312
    ds_read_b64_tr_b16 v[184:185], v85 offset:12288
    ds_read_b64_tr_b16 v[186:187], v85 offset:13312
    ds_read_b64_tr_b16 v[188:189], v87 offset:12288
    ds_read_b64_tr_b16 v[190:191], v87 offset:13312
    s_branch L_lw_34
L_lw_34_0:
    s_cmp_lg_u32 s44, 1
    s_cbranch_scc1 L_lw_34_1
    ds_read_b64_tr_b16 a[224:225], v84 offset:12288
    ds_read_b64_tr_b16 a[226:227], v84 offset:13312
    ds_read_b64_tr_b16 a[228:229], v86 offset:12288
    ds_read_b64_tr_b16 a[230:231], v86 offset:13312
    ds_read_b64_tr_b16 a[232:233], v85 offset:12288
    ds_read_b64_tr_b16 a[234:235], v85 offset:13312
    ds_read_b64_tr_b16 a[236:237], v87 offset:12288
    ds_read_b64_tr_b16 a[238:239], v87 offset:13312
    s_branch L_lw_34
L_lw_34_1:
    s_cmp_lg_u32 s44, 2
    s_cbranch_scc1 L_lw_34_2
    ds_read_b64_tr_b16 a[128:129], v84 offset:12288
    ds_read_b64_tr_b16 a[130:131], v84 offset:13312
    ds_read_b64_tr_b16 a[132:133], v86 offset:12288
    ds_read_b64_tr_b16 a[134:135], v86 offset:13312
    ds_read_b64_tr_b16 a[136:137], v85 offset:12288
    ds_read_b64_tr_b16 a[138:139], v85 offset:13312
    ds_read_b64_tr_b16 a[140:141], v87 offset:12288
    ds_read_b64_tr_b16 a[142:143], v87 offset:13312
    s_branch L_lw_34
L_lw_34_2:
    ds_read_b64_tr_b16 a[48:49], v84 offset:12288
    ds_read_b64_tr_b16 a[50:51], v84 offset:13312
    ds_read_b64_tr_b16 a[52:53], v86 offset:12288
    ds_read_b64_tr_b16 a[54:55], v86 offset:13312
    ds_read_b64_tr_b16 a[56:57], v85 offset:12288
    ds_read_b64_tr_b16 a[58:59], v85 offset:13312
    ds_read_b64_tr_b16 a[60:61], v87 offset:12288
    ds_read_b64_tr_b16 a[62:63], v87 offset:13312
L_lw_34:
    s_waitcnt lgkmcnt(0)
    s_waitcnt vmcnt(4)
    s_barrier
    v_mov_b32 v46, 0
    buffer_load_dwordx2 v[44:45], v46, s[16:19], 0 offen sc1
    s_lshl_b32 s45, s43, 7
    s_add_u32 s45, s45, 0x10014
    buffer_load_dwordx2 v[40:41], v46, s[12:15], s45 offen sc1
    s_cmp_lg_u32 s44, 0
    s_cbranch_scc1 L_lw_35_0
    ds_read_b64_tr_b16 v[208:209], v84 offset:16384
    ds_read_b64_tr_b16 v[210:211], v84 offset:17408
    ds_read_b64_tr_b16 v[212:213], v86 offset:16384
    ds_read_b64_tr_b16 v[214:215], v86 offset:17408
    ds_read_b64_tr_b16 v[216:217], v85 offset:16384
    ds_read_b64_tr_b16 v[218:219], v85 offset:17408
    ds_read_b64_tr_b16 v[220:221], v87 offset:16384
    ds_read_b64_tr_b16 v[222:223], v87 offset:17408
    s_branch L_lw_35
L_lw_35_0:
    s_cmp_lg_u32 s44, 1
    s_cbranch_scc1 L_lw_35_1
    ds_read_b64_tr_b16 a[248:249], v84 offset:16384
    ds_read_b64_tr_b16 a[250:251], v84 offset:17408
    ds_read_b64_tr_b16 a[252:253], v86 offset:16384
    ds_read_b64_tr_b16 a[254:255], v86 offset:17408
    ds_read_b64_tr_b16 v[96:97], v85 offset:16384
    ds_read_b64_tr_b16 v[98:99], v85 offset:17408
    ds_read_b64_tr_b16 v[100:101], v87 offset:16384
    ds_read_b64_tr_b16 v[102:103], v87 offset:17408
    s_branch L_lw_35
L_lw_35_1:
    s_cmp_lg_u32 s44, 2
    s_cbranch_scc1 L_lw_35_2
    ds_read_b64_tr_b16 a[152:153], v84 offset:16384
    ds_read_b64_tr_b16 a[154:155], v84 offset:17408
    ds_read_b64_tr_b16 a[156:157], v86 offset:16384
    ds_read_b64_tr_b16 a[158:159], v86 offset:17408
    ds_read_b64_tr_b16 a[160:161], v85 offset:16384
    ds_read_b64_tr_b16 a[162:163], v85 offset:17408
    ds_read_b64_tr_b16 a[164:165], v87 offset:16384
    ds_read_b64_tr_b16 a[166:167], v87 offset:17408
    s_branch L_lw_35
L_lw_35_2:
    ds_read_b64_tr_b16 a[72:73], v84 offset:16384
    ds_read_b64_tr_b16 a[74:75], v84 offset:17408
    ds_read_b64_tr_b16 a[76:77], v86 offset:16384
    ds_read_b64_tr_b16 a[78:79], v86 offset:17408
    ds_read_b64_tr_b16 v[56:57], v85 offset:16384
    ds_read_b64_tr_b16 v[58:59], v85 offset:17408
    ds_read_b64_tr_b16 v[60:61], v87 offset:16384
    ds_read_b64_tr_b16 v[62:63], v87 offset:17408
    s_waitcnt lgkmcnt(0)
    ds_write_b128 v5, v[56:59] offset:8192
    ds_write_b128 v5, v[60:63] offset:9216
L_lw_35:
    s_waitcnt lgkmcnt(0)
    s_waitcnt vmcnt(0)
    s_barrier
    s_cmp_lg_u32 s44, 0
    s_cbranch_scc1 L_lw_36_0
    ds_read_b64_tr_b16 v[240:241], v84 offset:20480
    ds_read_b64_tr_b16 v[242:243], v84 offset:21504
    ds_read_b64_tr_b16 v[244:245], v86 offset:20480
    ds_read_b64_tr_b16 v[246:247], v86 offset:21504
    ds_read_b64_tr_b16 v[248:249], v85 offset:20480
    ds_read_b64_tr_b16 v[250:251], v85 offset:21504
    ds_read_b64_tr_b16 v[252:253], v87 offset:20480
    ds_read_b64_tr_b16 v[254:255], v87 offset:21504
    s_branch L_lw_36
L_lw_36_0:
    s_cmp_lg_u32 s44, 1
    s_cbranch_scc1 L_lw_36_1
    ds_read_b64_tr_b16 v[112:113], v84 offset:20480
    ds_read_b64_tr_b16 v[114:115], v84 offset:21504
    ds_read_b64_tr_b16 v[116:117], v86 offset:20480
    ds_read_b64_tr_b16 v[118:119], v86 offset:21504
    ds_read_b64_tr_b16 v[120:121], v85 offset:20480
    ds_read_b64_tr_b16 v[122:123], v85 offset:21504
    ds_read_b64_tr_b16 v[124:125], v87 offset:20480
    ds_read_b64_tr_b16 v[126:127], v87 offset:21504
    s_branch L_lw_36
L_lw_36_1:
    s_cmp_lg_u32 s44, 2
    s_cbranch_scc1 L_lw_36_2
    ds_read_b64_tr_b16 a[176:177], v84 offset:20480
    ds_read_b64_tr_b16 a[178:179], v84 offset:21504
    ds_read_b64_tr_b16 a[180:181], v86 offset:20480
    ds_read_b64_tr_b16 a[182:183], v86 offset:21504
    ds_read_b64_tr_b16 a[184:185], v85 offset:20480
    ds_read_b64_tr_b16 a[186:187], v85 offset:21504
    ds_read_b64_tr_b16 a[188:189], v87 offset:20480
    ds_read_b64_tr_b16 a[190:191], v87 offset:21504
    s_branch L_lw_36
L_lw_36_2:
    ds_read_b64_tr_b16 a[88:89], v84 offset:20480
    ds_read_b64_tr_b16 a[90:91], v84 offset:21504
    ds_read_b64_tr_b16 a[92:93], v86 offset:20480
    ds_read_b64_tr_b16 a[94:95], v86 offset:21504
    ds_read_b64_tr_b16 v[56:57], v85 offset:20480
    ds_read_b64_tr_b16 v[58:59], v85 offset:21504
    ds_read_b64_tr_b16 v[60:61], v87 offset:20480
    ds_read_b64_tr_b16 v[62:63], v87 offset:21504
    s_waitcnt lgkmcnt(0)
    ds_write_b128 v5, v[56:59] offset:10240
    ds_write_b128 v5, v[60:63] offset:11264
L_lw_36:
    s_waitcnt lgkmcnt(0)
    s_barrier
    ds_write_b128 v5, v[24:27] offset:12288
    ds_write_b128 v5, v[28:31] offset:13312
    ds_write_b128 v5, v[32:35] offset:14336
    ds_write_b128 v5, v[36:39] offset:15360
    ds_write_b128 v5, v[48:51] offset:16384
    ds_write_b128 v5, v[52:55] offset:17408
    ds_write_b128 v5, v[64:67] offset:18432
    ds_write_b128 v5, v[68:71] offset:19456
    ds_write_b128 v5, v[72:75] offset:20480
    ds_write_b128 v5, v[76:79] offset:21504
    ds_write_b128 v5, v[88:91] offset:22528
    ds_write_b128 v5, v[92:95] offset:23552
    s_waitcnt lgkmcnt(0)
    v_and_b32 v63, 15, v1
    v_lshrrev_b32 v64, 4, v1
    v_lshrrev_b32 v65, 5, v1
    v_lshlrev_b32 v65, 4, v65
    v_add_u32 v65, v65, v63
    v_lshlrev_b32 v65, 4, v65
    v_and_b32 v66, 1, v64
    v_lshlrev_b32 v66, 3, v66
    s_lshl_b32 s45, s44, 9
    s_add_u32 s45, s45, 53248
    v_add3_u32 v6, v65, v66, s45
    v_bfe_u32 v65, v1, 2, 2
    v_lshlrev_b32 v66, 3, v64
    v_add_u32 v65, v65, v66
    v_lshlrev_b32 v65, 4, v65
    v_and_b32 v66, 1, v1
    v_lshlrev_b32 v66, 3, v66
    v_add_u32 v65, v65, v66
    v_add_u32 v7, 53248, v65
    v_bfe_u32 v65, v1, 2, 1
    v_mul_u32_u24 v65, 520, v65
    v_bfe_u32 v66, v1, 3, 1
    v_lshlrev_b32 v14, 7, v66
    v_and_b32 v67, 3, v1
    v_lshlrev_b32 v67, 5, v67
    v_add3_u32 v65, v65, v14, v67
    v_lshlrev_b32 v66, 1, v66
    v_xor_b32 v66, v66, v64
    v_lshlrev_b32 v66, 3, v66
    s_mul_i32 s45, s44, 1040
    s_add_u32 s45, s45, 55296
    v_add3_u32 v18, v65, v66, s45
    v_lshlrev_b32 v14, 3, v1
    v_and_b32 v65, 16, v1
    v_xor_b32 v14, v14, v65
    v_lshlrev_b32 v16, 3, v1
    v_lshlrev_b32 v8, 4, v1
    v_lshrrev_b32 v65, 2, v1
    v_lshlrev_b32 v65, 4, v65
    v_and_b32 v66, 1, v1
    v_lshlrev_b32 v66, 3, v66
    s_lshl_b32 s45, s44, 11
    v_add3_u32 v65, v65, v66, s45
    v_and_b32 v66, 2, v1
    v_lshlrev_b32 v66, 7, v66
    v_add_u32 v9, v65, v66
    s_lshl_b32 s45, s43, 11
    s_lshl_b32 s46, s44, 9
    s_add_u32 s45, s45, s46
    s_add_u32 s51, s45, 0x7020000
    s_lshl_b32 s63, s43, 19
    s_add_u32 s63, s63, 0x3000000
    s_mov_b32 s50, 0
    s_lshl_b32 s64, s44, 11
    s_sub_u32 s63, s63, s64
    s_add_u32 s64, s64, 16384
    s_add_u32 s65, s64, 8192
    s_lshl_b32 s66, s43, 12
    s_add_u32 s66, s66, 0x1000000
    s_mov_b32 s69, 16384
    s_mov_b32 s52, 0x3e0293ee
    s_mov_b32 s53, 0x41800000
    s_lshl_b32 s45, s40, 5
    s_add_u32 s45, s45, s41
    s_lshl_b32 s45, s45, 8
    s_lshl_b32 s46, s44, 6
    s_add_u32 s45, s45, s46
    s_add_u32 s45, s45, 0x7084000
    v_and_b32 v19, 15, v1
    v_lshlrev_b32 v19, 2, v19
    v_add_u32 v19, s45, v19
    v_min_u32 v40, v40, v41
    s_nop 0
    v_readfirstlane_b32 s50, v40
    s_mov_b32 s70, 0
    v_mov_b32 v41, 0
    s_branch L_hw_37_c
L_hw_37:
    buffer_load_dwordx2 v[44:45], v41, s[16:19], 0 offen sc1
    s_add_u32 s70, s70, 1
    s_cmp_ge_u32 s70, 0x100000
    s_cbranch_scc1 L_c_done_1
L_hw_37_c:
    s_waitcnt vmcnt(0)
    v_readfirstlane_b32 s45, v44
    v_readfirstlane_b32 s46, v45
    s_nop 3
    s_lshr_b32 s47, s46, 24
    s_cmp_lg_u32 s47, 64
    s_cbranch_scc1 L_hw_37
    s_lshr_b32 s68, s45, 24
    s_and_b32 s47, s45, 511
    s_mul_i32 s47, s47, s47
    s_bfe_u32 s45, s45, 0xf0009
    s_lshl_b32 s45, s45, 5
    s_sub_u32 s45, s45, s47
    s_and_b32 s47, s46, 511
    s_mul_i32 s47, s47, s47
    s_bfe_u32 s46, s46, 0xf0009
    s_lshl_b32 s46, s46, 5
    s_sub_u32 s46, s46, s47
    s_or_b32 s45, s45, s46
    s_cmp_eq_u32 s45, 0
    s_cselect_b32 s67, 1, 0
    s_mov_b32 s24, s12
    s_mov_b32 s25, s13
    s_mov_b32 s28, s12
    s_mov_b32 s29, s13
    s_cmp_eq_u32 s67, 1
    s_cselect_b32 s26, s14, 0
    s_cselect_b32 s30, 0, s14
    s_cmp_ge_u32 s68, 16
    s_cselect_b32 s68, 8192, 0
    s_mov_b32 s6, 0x11111111
    s_mov_b32 s7, 0xffaaa491
    s_mov_b32 s60, 0
    s_lshl_b32 s58, s40, 16
    s_add_u32 s58, s58, 0x7000000
    s_mov_b32 s61, s58
    s_lshl_b32 s59, s40, 17
    s_add_u32 s59, s59, 0x7040000
    s_mov_b32 s62, s59
    s_add_u32 s32, s41, 0
    s_and_b32 s32, s32, 3
    s_lshl_b32 s32, s32, 10
    s_add_u32 s33, s41, 1
    s_and_b32 s33, s33, 3
    s_lshl_b32 s33, s33, 10
    s_add_u32 s34, s41, 2
    s_and_b32 s34, s34, 3
    s_lshl_b32 s34, s34, 10
    s_add_u32 s35, s41, 3
    s_and_b32 s35, s35, 3
    s_lshl_b32 s35, s35, 10
    s_mov_b32 s47, 0
    s_cmp_lt_u32 s47, s50
    s_cbranch_scc1 L_kv_rdy_38
    s_lshl_b32 s45, s43, 7
    s_add_u32 s45, s45, 0x10014
    v_mov_b32 v0, 0
    s_mov_b32 s70, 0
L_kv_rdy_38_p:
    buffer_load_dwordx2 v[10:11], v0, s[12:15], s45 offen sc1
    s_add_u32 s70, s70, 1
    s_cmp_ge_u32 s70, 0x200000
    s_cbranch_scc1 L_c_done_1
    s_waitcnt vmcnt(0)
    v_min_u32 v10, v10, v11
    s_nop 0
    v_readfirstlane_b32 s50, v10
    s_nop 3
    s_cmp_lt_u32 s47, s50
    s_cbranch_scc1 L_kv_rdy_38
    s_sleep 2
    s_branch L_kv_rdy_38_p
L_kv_rdy_38:
    s_mov_b32 m0, s64
    s_add_u32 s46, s63, 0x1000000
    buffer_load_dwordx4 v3, s[12:15], s63 offen sc1 lds
    buffer_load_dwordx4 v3, s[12:15], s63 offen offset:1024 sc1 lds
    s_mov_b32 m0, s65
    s_add_u32 s63, s63, 8192
    buffer_load_dwordx4 v3, s[12:15], s46 offen sc1 lds
    buffer_load_dwordx4 v3, s[12:15], s46 offen offset:1024 sc1 lds
    s_add_u32 s45, s62, 0
    buffer_load_dword v47, v17, s[12:15], s45 offen sc1
    s_add_u32 s45, s62, 32768
    buffer_load_dword v47, v17, s[12:15], s45 offen sc1
    s_add_u32 s45, s62, 65536
    buffer_load_dword v47, v17, s[12:15], s45 offen sc1
    s_add_u32 s45, s62, 98304
    buffer_load_dword v47, v17, s[12:15], s45 offen sc1
    buffer_load_dword v47, v20, s[12:15], 0 offen sc1
    s_add_u32 s64, s64, 16384
    s_add_u32 s65, s65, 16384
L_q_loop_39:
    ds_read_b128 v[56:59], v5 offset:20480
    ds_read_b128 v[60:63], v5 offset:21504
    ds_read_b128 v[64:67], v5 offset:8192
    ds_read_b128 v[68:71], v5 offset:9216
    ds_read_b128 v[72:75], v5 offset:2048
    ds_read_b128 v[76:79], v5 offset:3072
    ds_read_b128 v[80:83], v5 offset:10240
    ds_read_b128 v[84:87], v5 offset:11264
    ds_read_b128 v[88:91], v5 offset:14336
    ds_read_b128 v[92:95], v5 offset:15360
    s_add_u32 s46, s60, 1
    v_mov_b32 v15, s46
    v_mov_b32 v0, -1
    v_mov_b32 v24, 0
    v_mov_b32 v25, 0
    v_mov_b32 v26, 0
    v_mov_b32 v27, 0
    v_mov_b32 v28, 0
    v_mov_b32 v29, 0
    v_mov_b32 v30, 0
    v_mov_b32 v31, 0
    v_mov_b32 v32, 0
    v_mov_b32 v33, 0
    v_mov_b32 v34, 0
    v_mov_b32 v35, 0
    v_mov_b32 v36, 0
    v_mov_b32 v37, 0
    v_mov_b32 v38, 0
    v_mov_b32 v39, 0
    s_add_u32 s8, s61, s32
    s_add_u32 s9, s61, s33
    s_add_u32 s10, s61, s34
    s_add_u32 s11, s61, s35
    s_waitcnt lgkmcnt(0)
    s_cmp_eq_u32 s60, 0
    s_cbranch_scc1 L_q_first_40
    s_sleep 4
    s_waitcnt vmcnt(0)
    s_mov_b64 exec, 65535
    buffer_load_dword v40, v19, s[12:15], 0 offen sc1
    s_nop 15
    buffer_load_dword v41, v19, s[12:15], 0 offen sc1
    s_nop 15
    buffer_load_dword v42, v19, s[12:15], 0 offen sc1
    s_nop 15
    buffer_load_dword v43, v19, s[12:15], 0 offen sc1
    s_mov_b32 s70, 0
L_pp_41:
    s_waitcnt vmcnt(3)
    v_cmp_gt_u32 vcc, s60, v40
    s_nop 1
    s_cbranch_vccz L_ppd_42
    buffer_load_dword v40, v19, s[12:15], 0 offen sc1
    s_waitcnt vmcnt(3)
    v_cmp_gt_u32 vcc, s60, v41
    s_nop 1
    s_cbranch_vccz L_ppd_42
    buffer_load_dword v41, v19, s[12:15], 0 offen sc1
    s_waitcnt vmcnt(3)
    v_cmp_gt_u32 vcc, s60, v42
    s_nop 1
    s_cbranch_vccz L_ppd_42
    buffer_load_dword v42, v19, s[12:15], 0 offen sc1
    s_waitcnt vmcnt(3)
    v_cmp_gt_u32 vcc, s60, v43
    s_nop 1
    s_cbranch_vccz L_ppd_42
    buffer_load_dword v43, v19, s[12:15], 0 offen sc1
    s_add_u32 s70, s70, 1
    s_cmp_lt_u32 s70, 0x100000
    s_cbranch_scc1 L_pp_41
    s_branch L_c_done_1
.p2align 5
    s_nop 0
    s_nop 0
    s_nop 0
    s_nop 0
    s_nop 0
    s_nop 0
L_ppd_42:
    s_mov_b64 exec, -1
L_q_first_40:
    buffer_load_dwordx4 v[40:43], v3, s[12:15], s8 offen sc1
    s_nop 4
    buffer_load_dwordx4 v[44:47], v3, s[12:15], s9 offen sc1
    s_nop 4
    buffer_load_dwordx4 v[48:51], v3, s[12:15], s10 offen sc1
    s_nop 4
    buffer_load_dwordx4 v[52:55], v3, s[12:15], s11 offen sc1
    s_mov_b32 s70, 0
L_mg_43_p:
    s_waitcnt vmcnt(3)
    ds_write_b128 v3, v[40:43] offset:0
    v_smfmac_f32_16x16x64_bf16 v[24:27], v[40:43], a[0:7], v2
    v_max3_u32 v22, v40, v41, v42
    v_smfmac_f32_16x16x64_bf16 v[28:31], v[40:43], a[8:15], v2
    v_max_u32 v22, v22, v43
    v_smfmac_f32_16x16x64_bf16 v[32:35], v[40:43], a[16:23], v2
    v_smfmac_f32_16x16x64_bf16 v[36:39], v[40:43], a[24:31], v2
    s_waitcnt vmcnt(2)
    ds_write_b128 v3, v[44:47] offset:1024
    v_smfmac_f32_16x16x64_bf16 v[24:27], v[44:47], a[32:39], v2
    v_max3_u32 v22, v22, v44, v45
    v_smfmac_f32_16x16x64_bf16 v[28:31], v[44:47], a[40:47], v2
    v_max3_u32 v22, v22, v46, v47
    v_smfmac_f32_16x16x64_bf16 v[32:35], v[44:47], a[48:55], v2
    v_smfmac_f32_16x16x64_bf16 v[36:39], v[44:47], a[56:63], v2
    s_waitcnt vmcnt(1)
    ds_write_b128 v3, v[48:51] offset:2048
    v_smfmac_f32_16x16x64_bf16 v[24:27], v[48:51], a[64:71], v2
    v_max3_u32 v22, v22, v48, v49
    v_smfmac_f32_16x16x64_bf16 v[28:31], v[48:51], v[56:63], v2
    v_max3_u32 v22, v22, v50, v51
    s_waitcnt vmcnt(0)
    ds_write_b128 v3, v[52:55] offset:3072
    v_smfmac_f32_16x16x64_bf16 v[32:35], v[48:51], a[72:79], v2
    v_max3_u32 v22, v22, v52, v53
    v_smfmac_f32_16x16x64_bf16 v[36:39], v[48:51], v[64:71], v2
    v_max3_u32 v22, v22, v54, v55
    v_cmp_eq_u32 vcc, -1, v22
    s_nop 0
    s_waitcnt lgkmcnt(0)
    s_cbranch_vccnz L_mg_43_r
    s_barrier
    ds_read_b128 v[40:43], v4 offset:0
    ds_read_b128 v[44:47], v4 offset:1024
    ds_read_b128 v[48:51], v4 offset:2048
    ds_read_b128 v[56:59], v5 offset:18432
    v_smfmac_f32_16x16x64_bf16 v[24:27], v[52:55], a[80:87], v2
    ds_read_b128 v[60:63], v5 offset:19456
    v_smfmac_f32_16x16x64_bf16 v[28:31], v[52:55], v[72:79], v2
    ds_read_b128 v[64:67], v5 offset:0
    v_smfmac_f32_16x16x64_bf16 v[32:35], v[52:55], a[88:95], v2
    ds_read_b128 v[68:71], v5 offset:1024
    v_smfmac_f32_16x16x64_bf16 v[36:39], v[52:55], v[80:87], v2
    ds_read_b128 v[52:55], v4 offset:3072
    s_waitcnt lgkmcnt(4)
    v_smfmac_f32_16x16x64_bf16 v[24:27], v[40:43], a[96:103], v2
    ds_read_b128 v[72:75], v5 offset:6144
    v_smfmac_f32_16x16x64_bf16 v[28:31], v[40:43], v[88:95], v2
    ds_read_b128 v[76:79], v5 offset:7168
    v_smfmac_f32_16x16x64_bf16 v[32:35], v[40:43], a[104:111], v2
    ds_read_b128 v[80:83], v5 offset:12288
    v_smfmac_f32_16x16x64_bf16 v[36:39], v[40:43], a[112:119], v2
    ds_read_b128 v[40:43], v21 offset:0
    v_smfmac_f32_16x16x64_bf16 v[24:27], v[44:47], a[120:127], v2
    ds_read_b128 v[84:87], v5 offset:13312
    s_waitcnt lgkmcnt(4)
    v_smfmac_f32_16x16x64_bf16 v[28:31], v[44:47], v[56:63], v2
    ds_read_b128 v[88:91], v5 offset:16384
    v_smfmac_f32_16x16x64_bf16 v[32:35], v[44:47], a[128:135], v2
    ds_read_b128 v[92:95], v5 offset:17408
    v_smfmac_f32_16x16x64_bf16 v[36:39], v[44:47], a[136:143], v2
    ds_read_b128 v[44:47], v21 offset:1024
    v_smfmac_f32_16x16x64_bf16 v[24:27], v[48:51], a[144:151], v2
    ds_read_b128 v[56:59], v5 offset:22528
    v_smfmac_f32_16x16x64_bf16 v[28:31], v[48:51], v[64:71], v2
    ds_read_b128 v[48:51], v21 offset:2048
    v_smfmac_f32_16x16x64_bf16 v[24:27], v[52:55], a[168:175], v2
    ds_read_b128 v[60:63], v5 offset:23552
    s_waitcnt lgkmcnt(4)
    v_smfmac_f32_16x16x64_bf16 v[28:31], v[52:55], v[72:79], v2
    ds_read_b128 v[52:55], v21 offset:3072
    v_smfmac_f32_16x16x64_bf16 v[24:27], v[40:43], a[192:199], v2
    ds_read_b128 v[64:67], v5 offset:4096
    v_smfmac_f32_16x16x64_bf16 v[28:31], v[40:43], v[80:87], v2
    ds_read_b128 v[40:43], v23 offset:0
    s_waitcnt lgkmcnt(4)
    v_smfmac_f32_16x16x64_bf16 v[24:27], v[44:47], a[216:223], v2
    ds_read_b128 v[68:71], v5 offset:5120
    v_smfmac_f32_16x16x64_bf16 v[28:31], v[44:47], v[88:95], v2
    ds_read_b128 v[44:47], v23 offset:1024
    v_smfmac_f32_16x16x64_bf16 v[24:27], v[48:51], a[240:247], v2
    s_waitcnt lgkmcnt(3)
    v_smfmac_f32_16x16x64_bf16 v[28:31], v[48:51], v[56:63], v2
    ds_read_b128 v[48:51], v23 offset:2048
    v_smfmac_f32_16x16x64_bf16 v[24:27], v[52:55], v[104:111], v2
    s_waitcnt lgkmcnt(2)
    v_smfmac_f32_16x16x64_bf16 v[28:31], v[52:55], v[64:71], v2
    ds_read_b128 v[52:55], v23 offset:3072
    v_smfmac_f32_16x16x64_bf16 v[24:27], v[40:43], v[128:135], v2
    v_smfmac_f32_16x16x64_bf16 v[28:31], v[40:43], v[136:143], v2
    s_waitcnt lgkmcnt(1)
    v_smfmac_f32_16x16x64_bf16 v[24:27], v[44:47], v[160:167], v2
    v_smfmac_f32_16x16x64_bf16 v[28:31], v[44:47], v[168:175], v2
    ds_read_b128 v[72:75], v8 offset:20480
    v_smfmac_f32_16x16x64_bf16 v[24:27], v[48:51], v[192:199], v2
    ds_read_b128 v[76:79], v8 offset:21504
    v_smfmac_f32_16x16x64_bf16 v[28:31], v[48:51], v[200:207], v2
    ds_read_b128 v[56:59], v8 offset:16384
    s_waitcnt lgkmcnt(3)
    v_smfmac_f32_16x16x64_bf16 v[24:27], v[52:55], v[224:231], v2
    ds_read_b128 v[60:63], v8 offset:17408
    v_smfmac_f32_16x16x64_bf16 v[28:31], v[52:55], v[232:239], v2
    ds_read_b128 v[64:67], v8 offset:18432
    v_smfmac_f32_16x16x64_bf16 v[32:35], v[52:55], v[240:247], v2
    ds_read_b128 v[68:71], v8 offset:19456
    v_smfmac_f32_16x16x64_bf16 v[36:39], v[52:55], v[248:255], v2
    ds_read_b128 v[52:55], v21 offset:3072
    v_smfmac_f32_16x16x64_bf16 v[32:35], v[48:51], v[208:215], v2
    s_nop 1
    v_permlane32_swap_b32 v24, v28
    v_permlane32_swap_b32 v25, v29
    v_smfmac_f32_16x16x64_bf16 v[36:39], v[48:51], v[216:223], v2
    ds_read_b128 v[48:51], v21 offset:2048
    v_permlane32_swap_b32 v26, v30
    v_smfmac_f32_16x16x64_bf16 v[32:35], v[44:47], v[176:183], v2
    v_permlane32_swap_b32 v27, v31
    v_add_f32 v24, v24, v28
    v_smfmac_f32_16x16x64_bf16 v[36:39], v[44:47], v[184:191], v2
    ds_read_b128 v[44:47], v21 offset:1024
    v_add_f32 v25, v25, v29
    v_smfmac_f32_16x16x64_bf16 v[32:35], v[40:43], v[144:151], v2
    v_add_f32 v26, v26, v30
    v_add_f32 v27, v27, v31
    v_smfmac_f32_16x16x64_bf16 v[36:39], v[40:43], v[152:159], v2
    ds_read_b128 v[40:43], v21 offset:0
    v_cvt_pk_bf16_f32 v24, v24, v25
    s_waitcnt lgkmcnt(2)
    v_smfmac_f32_16x16x64_bf16 v[32:35], v[52:55], v[112:119], v2
    v_cvt_pk_bf16_f32 v25, v26, v27
    v_smfmac_f32_16x16x64_bf16 v[36:39], v[52:55], v[120:127], v2
    ds_read_b128 v[52:55], v4 offset:3072
    v_smfmac_f32_16x16x64_bf16 v[32:35], v[48:51], a[248:255], v2
    ds_write_b64 v6, v[24:25]
    v_smfmac_f32_16x16x64_bf16 v[36:39], v[48:51], v[96:103], v2
    ds_read_b128 v[48:51], v4 offset:2048
    s_waitcnt lgkmcnt(3)
    v_smfmac_f32_16x16x64_bf16 v[32:35], v[44:47], a[224:231], v2
    v_smfmac_f32_16x16x64_bf16 v[36:39], v[44:47], a[232:239], v2
    v_smfmac_f32_16x16x64_bf16 v[32:35], v[40:43], a[200:207], v2
    s_waitcnt lgkmcnt(1)
    s_barrier
    ds_read_b64_tr_b16 v[80:81], v7 offset:0
    v_smfmac_f32_16x16x64_bf16 v[36:39], v[40:43], a[208:215], v2
    ds_read_b64_tr_b16 v[82:83], v7 offset:64
    ds_read_b64_tr_b16 v[84:85], v7 offset:512
    v_smfmac_f32_16x16x64_bf16 v[32:35], v[52:55], a[176:183], v2
    ds_read_b64_tr_b16 v[86:87], v7 offset:576
    v_smfmac_f32_16x16x64_bf16 v[36:39], v[52:55], a[184:191], v2
    ds_read_b64_tr_b16 v[88:89], v7 offset:1024
    s_waitcnt lgkmcnt(5)
    v_smfmac_f32_16x16x64_bf16 v[32:35], v[48:51], a[152:159], v2
    ds_read_b64_tr_b16 v[90:91], v7 offset:1088
    v_smfmac_f32_16x16x64_bf16 v[36:39], v[48:51], a[160:167], v2
    ds_read_b64_tr_b16 v[92:93], v7 offset:1536
    ds_read_b64_tr_b16 v[94:95], v7 offset:1600
    s_waitcnt lgkmcnt(5)
    v_mfma_f32_16x16x32_bf16 v[24:27], v[56:59], v[80:83], 0
    ds_read_b128 v[56:59], v8 offset:22528
    v_mfma_f32_16x16x32_bf16 v[28:31], v[60:63], v[80:83], 0
    ds_read_b128 v[60:63], v8 offset:23552
    s_waitcnt lgkmcnt(5)
    v_mfma_f32_16x16x32_bf16 v[24:27], v[64:67], v[84:87], v[24:27]
    v_cvt_pk_bf16_f32 v32, v32, v33
    v_cvt_pk_bf16_f32 v33, v34, v35
    v_cvt_pk_bf16_f32 v34, v36, v37
    v_cvt_pk_bf16_f32 v35, v38, v39
    ds_write2_b64 v18, v[32:33], v[34:35] offset1:32
    v_mfma_f32_16x16x32_bf16 v[28:31], v[68:71], v[84:87], v[28:31]
    s_waitcnt lgkmcnt(3)
    v_mfma_f32_16x16x32_bf16 v[24:27], v[72:75], v[88:91], v[24:27]
    s_cmp_eq_u32 s60, 63
    v_mfma_f32_16x16x32_bf16 v[28:31], v[76:79], v[88:91], v[28:31]
    s_waitcnt lgkmcnt(0)
    s_barrier
    v_mfma_f32_16x16x32_bf16 v[24:27], v[56:59], v[92:95], v[24:27]
    ds_read_b64_tr_b16 v[40:41], v14 offset:55296
    ds_read_b64_tr_b16 v[42:43], v14 offset:55816
    v_mfma_f32_16x16x32_bf16 v[28:31], v[60:63], v[92:95], v[28:31]
    buffer_load_dwordx2 v[0:1], v16, s[12:15], s51 offen sc1
    ds_read_b64_tr_b16 v[44:45], v14 offset:56336
    ds_read_b64_tr_b16 v[46:47], v14 offset:56856
    ds_read_b64_tr_b16 v[48:49], v14 offset:57376
    ds_read_b64_tr_b16 v[50:51], v14 offset:57896
    v_mov_b32 v32, 0x3f803f80
    ds_read_b64_tr_b16 v[52:53], v14 offset:58416
    ds_read_b64_tr_b16 v[54:55], v14 offset:58936
    s_cbranch_scc1 L_q_last_44
    v_cndmask_b32 v24, v28, v24, s[56:57]
    v_cndmask_b32 v25, v29, v25, s[56:57]
    v_cndmask_b32 v26, v30, v26, s[56:57]
    v_cndmask_b32 v27, v31, v27, s[56:57]
    v_max3_f32 v11, v24, v25, v26
    v_max_f32 v11, v11, v27
    s_waitcnt lgkmcnt(0)
    v_mfma_f32_16x16x32_bf16 v[36:39], v[40:43], v[80:83], 0
    ds_read_b64_tr_b16 v[64:65], v9 offset:24576
    v_max_f32_dpp v12, v11, v11 row_ror:8 row_mask:0xf bank_mask:0xf
    v_max_f32_dpp v13, v11, v11 row_ror:8 row_mask:0xf bank_mask:0xf
    v_mfma_f32_16x16x32_bf16 v[36:39], v[44:47], v[84:87], v[36:39]
    ds_read_b64_tr_b16 v[66:67], v9 offset:25600
    v_permlane32_swap_b32 v12, v13
    v_max_f32 v22, v12, v13
    v_max_f32 v13, v12, v13
    v_mfma_f32_16x16x32_bf16 v[36:39], v[48:51], v[88:91], v[36:39]
    ds_read_b64_tr_b16 v[68:69], v9 offset:25088
    v_permlane16_swap_b32 v22, v13
    v_mfma_f32_16x16x32_bf16 v[36:39], v[52:55], v[92:95], v[36:39]
    ds_read_b64_tr_b16 v[70:71], v9 offset:26112
    v_max_f32 v11, v22, v13
    v_mul_f32 v10, s52, v11
    v_fma_f32 v24, v24, s52, -v10
    v_fma_f32 v25, v25, s52, -v10
    v_fma_f32 v26, v26, s52, -v10
    v_fma_f32 v27, v27, s52, -v10
    v_exp_f32 v24, v24
    v_exp_f32 v25, v25
    v_exp_f32 v26, v26
    v_exp_f32 v27, v27
    v_permlane32_swap_b32 v36, v38
    v_cvt_pk_bf16_f32 v60, v24, v25
    v_cvt_pk_bf16_f32 v61, v26, v27
    v_permlane32_swap_b32 v37, v39
    v_mov_b32_dpp v62, v60 row_ror:8 row_mask:0xf bank_mask:0xf
    v_mov_b32_dpp v63, v61 row_ror:8 row_mask:0xf bank_mask:0xf
    v_add_f32 v36, v36, v38
    v_add_f32 v37, v37, v39
    s_waitcnt lgkmcnt(0)
    v_mfma_f32_16x16x32_bf16 v[72:75], v[64:67], v[60:63], 0
    buffer_store_dword v15, v20, s[24:27], 0 offen
    v_fma_f32 v12, v36, s52, -v10
    v_fma_f32 v13, v37, s52, -v10
    v_mov_b32 v33, 0x3f803f80
    v_mfma_f32_16x16x32_bf16 v[76:79], v[68:71], v[60:63], 0
    v_mov_b32 v34, 0x3f803f80
    v_mov_b32 v35, 0x3f803f80
    v_max_f32 v11, v12, v13
    v_exp_f32 v36, v12
    v_mfma_f32_16x16x32_bf16 v[24:27], v[32:35], v[60:63], 0
    s_waitcnt vmcnt(1)
    v_max_u32 v22, v0, v1
    v_cmp_lt_f32 s[8:9], s53, v11
    v_cmp_eq_u32 vcc, -1, v22
    v_exp_f32 v37, v13
    v_mov_b32 v57, 0
    v_cvt_pk_bf16_f32 v56, v36, v37
    s_or_b64 s[10:11], vcc, s[8:9]
    s_cbranch_scc1 L_q_vm_45_s
L_q_vm_45_j:
    v_mfma_f32_16x16x16_bf16 v[24:27], v[32:33], v[56:57], v[24:27]
    s_nop 0
    v_mov_b32 v58, 0
    v_mov_b32 v59, v56
    v_mfma_f32_16x16x16_bf16 v[72:75], v[0:1], v[56:57], v[72:75]
    s_nop 2
    v_mfma_f32_16x16x16_bf16 v[76:79], v[0:1], v[58:59], v[76:79]
    v_rcp_f32 v12, v24
    s_nop 2
    v_pk_mul_f32 v[72:73], v[72:73], v[12:13] op_sel_hi:[1,0]
    v_pk_mul_f32 v[74:75], v[74:75], v[12:13] op_sel_hi:[1,0]
    v_cvt_pk_bf16_f32 v72, v72, v73
    v_cvt_pk_bf16_f32 v73, v74, v75
    v_pk_mul_f32 v[76:77], v[76:77], v[12:13] op_sel_hi:[1,0]
    v_pk_mul_f32 v[78:79], v[78:79], v[12:13] op_sel_hi:[1,0]
    v_cvt_pk_bf16_f32 v74, v76, v77
    v_cvt_pk_bf16_f32 v75, v78, v79
    buffer_store_dwordx4 v[72:75], v17, s[24:27], s62 offen
    buffer_store_dwordx4 v[72:75], v17, s[28:31], s62 offen sc1
    buffer_store_dword v15, v20, s[28:31], 0 offen sc1
    v_mov_b32 v60, -1
    v_mov_b32 v61, -1
    v_mov_b32 v62, -1
    v_mov_b32 v63, -1
    s_add_u32 s45, s60, 3
    s_and_b32 s45, s45, 3
    s_lshl_b32 s45, s45, 15
    s_add_u32 s45, s45, s59
    buffer_store_dwordx4 v[60:63], v17, s[24:27], s45 offen
    buffer_store_dwordx4 v[60:63], v17, s[28:31], s45 offen sc1
    s_barrier
    s_and_b32 s45, s51, 0xffff
    s_lshl_b32 s46, s60, 16
    s_add_u32 s45, s45, s46
    s_add_u32 s45, s45, 0x1800000
    buffer_store_dwordx2 v[0:1], v16, s[12:15], s45 offen sc1
L_q_last_44:
    s_waitcnt lgkmcnt(0)
    v_lshlrev_b32 v22, 1, v16
    s_cmp_lg_u32 s44, 0
    s_cbranch_scc1 L_q_km_46_0
    buffer_store_dwordx4 v[40:43], v22, s[12:15], s66 offen offset:0 sc1
L_q_km_46_0:
    s_cmp_lg_u32 s44, 1
    s_cbranch_scc1 L_q_km_46_1
    buffer_store_dwordx4 v[44:47], v22, s[12:15], s66 offen offset:1024 sc1
L_q_km_46_1:
    s_cmp_lg_u32 s44, 2
    s_cbranch_scc1 L_q_km_46_2
    buffer_store_dwordx4 v[48:51], v22, s[12:15], s66 offen offset:2048 sc1
L_q_km_46_2:
    s_cmp_lg_u32 s44, 3
    s_cbranch_scc1 L_q_km_46_3
    buffer_store_dwordx4 v[52:55], v22, s[12:15], s66 offen offset:3072 sc1
L_q_km_46_3:
    s_cmp_eq_u32 s60, 63
    s_cbranch_scc1 L_q_fin_47
    s_cmp_eq_u32 s60, 62
    s_cbranch_scc1 L_q_fin_47_n
    s_add_u32 s47, s60, 1
    s_cmp_lt_u32 s47, s50
    s_cbranch_scc1 L_kv_rdy_48
    s_lshl_b32 s45, s43, 7
    s_add_u32 s45, s45, 0x10014
    v_mov_b32 v0, 0
    s_mov_b32 s70, 0
L_kv_rdy_48_p:
    buffer_load_dwordx2 v[10:11], v0, s[12:15], s45 offen sc1
    s_add_u32 s70, s70, 1
    s_cmp_ge_u32 s70, 0x200000
    s_cbranch_scc1 L_c_done_1
    s_waitcnt vmcnt(0)
    v_min_u32 v10, v10, v11
    s_nop 0
    v_readfirstlane_b32 s50, v10
    s_nop 3
    s_cmp_lt_u32 s47, s50
    s_cbranch_scc1 L_kv_rdy_48
    s_sleep 2
    s_branch L_kv_rdy_48_p
L_kv_rdy_48:
    s_mov_b32 m0, s64
    s_add_u32 s46, s63, 0x1000000
    buffer_load_dwordx4 v3, s[12:15], s63 offen sc1 lds
    buffer_load_dwordx4 v3, s[12:15], s63 offen offset:1024 sc1 lds
    s_mov_b32 m0, s65
    s_add_u32 s63, s63, 8192
    buffer_load_dwordx4 v3, s[12:15], s46 offen sc1 lds
    buffer_load_dwordx4 v3, s[12:15], s46 offen offset:1024 sc1 lds
    s_branch L_q_fin_47_k
L_q_fin_47_n:
    s_waitcnt vmcnt(0)
L_q_fin_47_k:
    s_add_u32 s47, s60, 1
    s_bitcmp1_b64 s[6:7], s47
    s_cbranch_scc0 L_q_fin_47_m
    s_waitcnt vmcnt(4)
    v_mov_b32 v22, s47
    v_mov_b32 v0, 0
    s_mov_b64 exec, 1
    buffer_store_dword v22, v0, s[12:15], s3 offen sc1
    s_mov_b64 exec, -1
L_q_fin_47_m:
    s_mov_b64 exec, -1
    v_add_u32 v8, s69, v8
    v_add_u32 v9, s69, v9
    s_sub_u32 s64, s64, s69
    s_sub_u32 s65, s65, s69
    s_sub_u32 s69, 0, s69
    s_add_u32 s66, s66, 131072
    s_xor_b32 s51, s51, 65536
    s_add_u32 s60, s60, 1
    s_and_b32 s45, s60, 3
    s_lshl_b32 s46, s45, 14
    s_add_u32 s61, s58, s46
    s_lshl_b32 s46, s45, 15
    s_add_u32 s62, s59, s46
    s_branch L_q_loop_39
L_q_fin_47:
    s_waitcnt vmcnt(0)
    v_mov_b32 v22, 64
    v_mov_b32 v0, 0
    s_mov_b64 exec, 1
    buffer_store_dword v22, v0, s[12:15], s3 offen sc1
    s_mov_b64 exec, -1
    s_endpgm
L_mg_43_r:
    buffer_load_dwordx4 v[40:43], v3, s[12:15], s8 offen sc1
    buffer_load_dwordx4 v[44:47], v3, s[12:15], s9 offen sc1
    buffer_load_dwordx4 v[48:51], v3, s[12:15], s10 offen sc1
    buffer_load_dwordx4 v[52:55], v3, s[12:15], s11 offen sc1
    s_add_u32 s70, s70, 1
    s_cmp_ge_u32 s70, 0x100000
    s_cbranch_scc1 L_c_done_1
    s_nop 1
    v_mov_b32 v24, 0
    v_mov_b32 v25, 0
    v_mov_b32 v26, 0
    v_mov_b32 v27, 0
    v_mov_b32 v28, 0
    v_mov_b32 v29, 0
    v_mov_b32 v30, 0
    v_mov_b32 v31, 0
    v_mov_b32 v32, 0
    v_mov_b32 v33, 0
    v_mov_b32 v34, 0
    v_mov_b32 v35, 0
    v_mov_b32 v36, 0
    v_mov_b32 v37, 0
    v_mov_b32 v38, 0
    v_mov_b32 v39, 0
    s_branch L_mg_43_p
L_q_vm_45_s:
    s_cbranch_vccz L_q_vm_45_t
    buffer_load_dwordx2 v[0:1], v16, s[12:15], s51 offen sc1
    s_add_u32 s70, s70, 1
    s_nop 0
    s_cmp_ge_u32 s70, 0x100000
    s_cbranch_scc1 L_c_done_1
    s_waitcnt vmcnt(0)
    v_max_u32 v22, v0, v1
    v_cmp_eq_u32 vcc, -1, v22
    s_nop 1
    s_branch L_q_vm_45_s
L_q_vm_45_t:
    s_cmp_eq_u64 s[8:9], 0
    s_cbranch_scc1 L_q_vm_45_j
    v_max_f32 v11, 0, v11
    v_mov_b32 v22, v11
    s_nop 1
    v_permlane32_swap_b32 v11, v22
    v_max_f32 v11, v11, v22
    v_mov_b32 v22, v11
    s_nop 1
    v_permlane16_swap_b32 v11, v22
    v_max_f32 v11, v11, v22
    v_sub_f32 v12, v12, v11
    v_sub_f32 v13, v13, v11
    v_sub_f32 v11, 0, v11
    v_exp_f32 v36, v12
    v_exp_f32 v37, v13
    v_exp_f32 v11, v11
    s_nop 7
    v_mul_f32 v72, v72, v11
    v_mul_f32 v73, v73, v11
    v_mul_f32 v74, v74, v11
    v_mul_f32 v75, v75, v11
    v_mul_f32 v76, v76, v11
    v_mul_f32 v77, v77, v11
    v_mul_f32 v78, v78, v11
    v_mul_f32 v79, v79, v11
    v_mul_f32 v24, v24, v11
    v_cvt_pk_bf16_f32 v56, v36, v37
    v_cvt_pk_bf16_f32 v59, v36, v37
    s_nop 1
    s_branch L_q_vm_45_j
L_c_vo_2:
    s_lshl_b32 s45, s43, 11
    s_lshl_b32 s46, s44, 9
    s_add_u32 s45, s45, s46
    v_lshlrev_b32 v10, 3, v1
    v_add_u32 v10, s45, v10
    v_lshlrev_b32 v11, 3, v0
    v_bfe_u32 v69, v1, 4, 1
    v_lshlrev_b32 v69, 2, v69
    v_lshrrev_b32 v63, 5, v1
    v_lshlrev_b32 v63, 1, v63
    v_and_b32 v64, 1, v1
    v_add3_u32 v69, v69, v63, v64
    v_bfe_u32 v63, v1, 1, 1
    v_lshlrev_b32 v63, 3, v63
    v_add_u32 v63, v63, v69
    v_lshlrev_b32 v63, 4, v63
    v_bfe_u32 v64, v1, 2, 2
    v_lshlrev_b32 v64, 2, v64
    s_lshl_b32 s45, s42, 10
    s_lshl_b32 s46, s44, 8
    s_add_u32 s45, s45, s46
    v_add3_u32 v12, v63, v64, s45
    v_and_b32 v64, 1, v1
    v_cmp_eq_u32 vcc, 0, v64
    v_mov_b32 v9, 0x07060302
    v_mov_b32 v63, 0x01000504
    v_cndmask_b32 v9, v9, v63, vcc
    s_lshl_b32 s63, s40, 19
    s_lshl_b32 s45, s42, 15
    s_add_u32 s63, s63, s45
    s_add_u32 s63, s63, 0x7100000
    s_xor_b32 s64, s63, 524288
    s_lshl_b32 s45, s40, 13
    s_lshl_b32 s46, s44, 2
    s_add_u32 s45, s45, s46
    s_lshl_b32 s46, s42, 4
    s_add_u32 s45, s45, s46
    s_add_u32 s45, s45, 0x7084000
    v_lshlrev_b32 v20, 8, v1
    v_add_u32 v20, s45, v20
    v_mov_b32 v63, 0x20000000
    v_cmp_gt_u32 vcc, 16, v1
    s_nop 1
    v_cndmask_b32 v20, v63, v20, vcc
    buffer_store_dword v44, v20, s[12:15], 0 offen sc1
    s_mov_b32 s45, 0x7020000
    buffer_store_dwordx2 v[40:41], v10, s[12:15], s45 offen sc1
    s_mov_b32 s45, 0x7030000
    buffer_store_dwordx2 v[40:41], v10, s[12:15], s45 offen sc1
    s_add_u32 s45, s63, 0
    buffer_store_dwordx2 v[40:41], v11, s[12:15], s45 offen sc1
    s_add_u32 s45, s63, 4096
    buffer_store_dwordx2 v[40:41], v11, s[12:15], s45 offen sc1
    s_add_u32 s45, s63, 8192
    buffer_store_dwordx2 v[40:41], v11, s[12:15], s45 offen sc1
    s_add_u32 s45, s63, 12288
    buffer_store_dwordx2 v[40:41], v11, s[12:15], s45 offen sc1
    s_add_u32 s45, s63, 16384
    buffer_store_dwordx2 v[40:41], v11, s[12:15], s45 offen sc1
    s_add_u32 s45, s63, 20480
    buffer_store_dwordx2 v[40:41], v11, s[12:15], s45 offen sc1
    s_add_u32 s45, s63, 24576
    buffer_store_dwordx2 v[40:41], v11, s[12:15], s45 offen sc1
    s_add_u32 s45, s63, 28672
    buffer_store_dwordx2 v[40:41], v11, s[12:15], s45 offen sc1
    s_lshl_b32 s61, s40, 16
    s_add_u32 s61, s61, 0x7000000
    s_add_u32 s45, s61, 16384
    buffer_store_dword v40, v12, s[12:15], s45 offen sc1
    s_add_u32 s45, s61, 32768
    buffer_store_dword v40, v12, s[12:15], s45 offen sc1
    s_add_u32 s45, s61, 49152
    buffer_store_dword v40, v12, s[12:15], s45 offen sc1
    v_lshlrev_b32 v63, 11, v69
    v_and_b32 v64, 14, v1
    v_lshlrev_b32 v64, 1, v64
    v_add_u32 v63, v63, v64
    s_lshl_b32 s45, s42, 7
    s_lshl_b32 s46, s44, 5
    s_add_u32 s45, s45, s46
    buffer_load_dword v45, v63, s[52:55], s45 offen
    s_mov_b32 s76, -1
    s_mov_b32 s77, -1
    v_lshrrev_b32 v63, 3, v1
    v_lshlrev_b32 v63, 11, v63
    v_bfe_u32 v64, v1, 1, 2
    v_and_b32 v65, 1, v1
    v_lshlrev_b32 v65, 4, v65
    v_add_u32 v63, v63, v65
    v_xor_b32 v66, 0, v64
    v_lshlrev_b32 v66, 5, v66
    v_add_u32 v70, v63, v66
    v_xor_b32 v66, 1, v64
    v_lshlrev_b32 v66, 5, v66
    v_add_u32 v71, v63, v66
    v_xor_b32 v66, 2, v64
    v_lshlrev_b32 v66, 5, v66
    v_add_u32 v72, v63, v66
    v_xor_b32 v66, 3, v64
    v_lshlrev_b32 v66, 5, v66
    v_add_u32 v73, v63, v66
    v_bfe_u32 v63, v1, 3, 1
    v_lshlrev_b32 v63, 1, v63
    v_bfe_u32 v64, v1, 4, 1
    v_add_u32 v63, v63, v64
    v_lshlrev_b32 v64, 3, v63
    v_lshrrev_b32 v65, 5, v1
    v_lshlrev_b32 v65, 2, v65
    v_add_u32 v64, v64, v65
    v_bfe_u32 v65, v1, 2, 1
    v_add_u32 v64, v64, v65
    v_lshlrev_b32 v64, 7, v64
    v_and_b32 v65, 3, v1
    v_lshlrev_b32 v65, 3, v65
    v_add_u32 v64, v64, v65
    s_lshl_b32 s45, s44, 12
    v_add_u32 v64, s45, v64
    s_add_u32 s45, s44, 1
    s_and_b32 s45, s45, 3
    v_xor_b32 v65, s45, v63
    v_lshlrev_b32 v65, 5, v65
    v_add_u32 v74, v64, v65
    s_mul_i32 s45, s44, 20480
    s_add_u32 s45, s45, 65536
    v_add_u32 v88, s45, v74
    s_add_u32 s45, s44, 2
    s_and_b32 s45, s45, 3
    v_xor_b32 v65, s45, v63
    v_lshlrev_b32 v65, 5, v65
    v_add_u32 v75, v64, v65
    s_mul_i32 s45, s44, 20480
    s_add_u32 s45, s45, 65536
    v_add_u32 v89, s45, v75
    s_add_u32 s45, s44, 3
    s_and_b32 s45, s45, 3
    v_xor_b32 v65, s45, v63
    v_lshlrev_b32 v65, 5, v65
    v_add_u32 v76, v64, v65
    s_mul_i32 s45, s44, 20480
    s_add_u32 s45, s45, 65536
    v_add_u32 v90, s45, v76
    s_add_u32 s45, s44, 4
    s_and_b32 s45, s45, 3
    v_xor_b32 v65, s45, v63
    v_lshlrev_b32 v65, 5, v65
    v_add_u32 v77, v64, v65
    s_mul_i32 s45, s44, 20480
    s_add_u32 s45, s45, 65536
    v_add_u32 v91, s45, v77
    s_mul_i32 s65, s44, 24576
    s_lshl_b32 s49, s40, 22
    s_lshl_b32 s45, s44, 20
    s_add_u32 s49, s49, s45
    s_lshl_b32 s45, s42, 7
    s_add_u32 s49, s49, s45
    s_lshl_b32 s50, s44, 12
    s_mul_i32 s69, s42, 1
    s_add_u32 s51, s69, 0
    s_and_b32 s51, s51, 7
    s_lshl_b32 s51, s51, 17
    s_add_u32 s51, s51, s49
    s_add_u32 s46, s51, 0x0
    s_add_u32 m0, s65, 65536
    s_nop 0
    buffer_load_dwordx4 v70, s[36:39], s46 offen  lds
    s_add_u32 s46, s51, 0x8000
    s_add_u32 m0, s65, 66560
    s_nop 0
    buffer_load_dwordx4 v71, s[36:39], s46 offen  lds
    s_add_u32 s46, s51, 0x10000
    s_add_u32 m0, s65, 67584
    s_nop 0
    buffer_load_dwordx4 v72, s[36:39], s46 offen  lds
    s_add_u32 s46, s51, 0x18000
    s_add_u32 m0, s65, 68608
    s_nop 0
    buffer_load_dwordx4 v73, s[36:39], s46 offen  lds
    s_add_u32 s51, s69, 0
    s_and_b32 s51, s51, 7
    s_lshl_b32 s51, s51, 17
    s_add_u32 s51, s51, s49
    s_add_u32 s46, s51, 0x4000
    s_add_u32 m0, s65, 69632
    s_nop 0
    buffer_load_dwordx4 v70, s[36:39], s46 offen  lds
    s_add_u32 s46, s51, 0xc000
    s_add_u32 m0, s65, 70656
    s_nop 0
    buffer_load_dwordx4 v71, s[36:39], s46 offen  lds
    s_add_u32 s46, s51, 0x14000
    s_add_u32 m0, s65, 71680
    s_nop 0
    buffer_load_dwordx4 v72, s[36:39], s46 offen  lds
    s_add_u32 s46, s51, 0x1c000
    s_add_u32 m0, s65, 72704
    s_nop 0
    buffer_load_dwordx4 v73, s[36:39], s46 offen  lds
    s_add_u32 s51, s69, 1
    s_and_b32 s51, s51, 7
    s_lshl_b32 s51, s51, 17
    s_add_u32 s51, s51, s49
    s_add_u32 s46, s51, 0x0
    s_add_u32 m0, s65, 73728
    s_nop 0
    buffer_load_dwordx4 v70, s[36:39], s46 offen  lds
    s_add_u32 s46, s51, 0x8000
    s_add_u32 m0, s65, 74752
    s_nop 0
    buffer_load_dwordx4 v71, s[36:39], s46 offen  lds
    s_add_u32 s46, s51, 0x10000
    s_add_u32 m0, s65, 75776
    s_nop 0
    buffer_load_dwordx4 v72, s[36:39], s46 offen  lds
    s_add_u32 s46, s51, 0x18000
    s_add_u32 m0, s65, 76800
    s_nop 0
    buffer_load_dwordx4 v73, s[36:39], s46 offen  lds
    s_add_u32 s51, s69, 1
    s_and_b32 s51, s51, 7
    s_lshl_b32 s51, s51, 17
    s_add_u32 s51, s51, s49
    s_add_u32 s46, s51, 0x4000
    s_add_u32 m0, s65, 77824
    s_nop 0
    buffer_load_dwordx4 v70, s[36:39], s46 offen  lds
    s_add_u32 s46, s51, 0xc000
    s_add_u32 m0, s65, 78848
    s_nop 0
    buffer_load_dwordx4 v71, s[36:39], s46 offen  lds
    s_add_u32 s46, s51, 0x14000
    s_add_u32 m0, s65, 79872
    s_nop 0
    buffer_load_dwordx4 v72, s[36:39], s46 offen  lds
    s_add_u32 s46, s51, 0x1c000
    s_add_u32 m0, s65, 80896
    s_nop 0
    buffer_load_dwordx4 v73, s[36:39], s46 offen  lds
    s_add_u32 s51, s69, 2
    s_and_b32 s51, s51, 7
    s_lshl_b32 s51, s51, 17
    s_add_u32 s51, s51, s49
    s_add_u32 s46, s51, 0x0
    s_add_u32 m0, s65, 81920
    s_nop 0
    buffer_load_dwordx4 v70, s[36:39], s46 offen  lds
    s_add_u32 s46, s51, 0x8000
    s_add_u32 m0, s65, 82944
    s_nop 0
    buffer_load_dwordx4 v71, s[36:39], s46 offen  lds
    s_add_u32 s46, s51, 0x10000
    s_add_u32 m0, s65, 83968
    s_nop 0
    buffer_load_dwordx4 v72, s[36:39], s46 offen  lds
    s_add_u32 s46, s51, 0x18000
    s_add_u32 m0, s65, 84992
    s_nop 0
    buffer_load_dwordx4 v73, s[36:39], s46 offen  lds
    s_add_u32 s51, s69, 2
    s_and_b32 s51, s51, 7
    s_lshl_b32 s51, s51, 17
    s_add_u32 s51, s51, s49
    s_add_u32 s46, s51, 0x4000
    s_add_u32 m0, s50, 0
    s_nop 0
    buffer_load_dwordx4 v70, s[36:39], s46 offen  lds
    s_add_u32 s46, s51, 0xc000
    s_add_u32 m0, s50, 1024
    s_nop 0
    buffer_load_dwordx4 v71, s[36:39], s46 offen  lds
    s_add_u32 s46, s51, 0x14000
    s_add_u32 m0, s50, 2048
    s_nop 0
    buffer_load_dwordx4 v72, s[36:39], s46 offen  lds
    s_add_u32 s46, s51, 0x1c000
    s_add_u32 m0, s50, 3072
    s_nop 0
    buffer_load_dwordx4 v73, s[36:39], s46 offen  lds
    s_add_u32 s51, s69, 3
    s_and_b32 s51, s51, 7
    s_lshl_b32 s51, s51, 17
    s_add_u32 s51, s51, s49
    s_add_u32 s46, s51, 0x0
    s_add_u32 m0, s50, 16384
    s_nop 0
    buffer_load_dwordx4 v70, s[36:39], s46 offen  lds
    s_add_u32 s46, s51, 0x8000
    s_add_u32 m0, s50, 17408
    s_nop 0
    buffer_load_dwordx4 v71, s[36:39], s46 offen  lds
    s_add_u32 s46, s51, 0x10000
    s_add_u32 m0, s50, 18432
    s_nop 0
    buffer_load_dwordx4 v72, s[36:39], s46 offen  lds
    s_add_u32 s46, s51, 0x18000
    s_add_u32 m0, s50, 19456
    s_nop 0
    buffer_load_dwordx4 v73, s[36:39], s46 offen  lds
    s_add_u32 s51, s69, 3
    s_and_b32 s51, s51, 7
    s_lshl_b32 s51, s51, 17
    s_add_u32 s51, s51, s49
    s_add_u32 s46, s51, 0x4000
    s_add_u32 m0, s50, 32768
    s_nop 0
    buffer_load_dwordx4 v70, s[36:39], s46 offen  lds
    s_add_u32 s46, s51, 0xc000
    s_add_u32 m0, s50, 33792
    s_nop 0
    buffer_load_dwordx4 v71, s[36:39], s46 offen  lds
    s_add_u32 s46, s51, 0x14000
    s_add_u32 m0, s50, 34816
    s_nop 0
    buffer_load_dwordx4 v72, s[36:39], s46 offen  lds
    s_add_u32 s46, s51, 0x1c000
    s_add_u32 m0, s50, 35840
    s_nop 0
    buffer_load_dwordx4 v73, s[36:39], s46 offen  lds
    s_add_u32 s51, s69, 4
    s_and_b32 s51, s51, 7
    s_lshl_b32 s51, s51, 17
    s_add_u32 s51, s51, s49
    s_add_u32 s46, s51, 0x0
    s_add_u32 m0, s50, 49152
    s_nop 0
    buffer_load_dwordx4 v70, s[36:39], s46 offen  lds
    s_add_u32 s46, s51, 0x8000
    s_add_u32 m0, s50, 50176
    s_nop 0
    buffer_load_dwordx4 v71, s[36:39], s46 offen  lds
    s_add_u32 s46, s51, 0x10000
    s_add_u32 m0, s50, 51200
    s_nop 0
    buffer_load_dwordx4 v72, s[36:39], s46 offen  lds
    s_add_u32 s46, s51, 0x18000
    s_add_u32 m0, s50, 52224
    s_nop 0
    buffer_load_dwordx4 v73, s[36:39], s46 offen  lds
    s_add_u32 s51, s69, 4
    s_and_b32 s51, s51, 7
    s_lshl_b32 s51, s51, 17
    s_add_u32 s51, s51, s49
    s_add_u32 s46, s51, 0x4000
    s_add_u32 m0, s65, 86016
    s_nop 0
    buffer_load_dwordx4 v70, s[36:39], s46 offen  lds
    s_add_u32 s46, s51, 0xc000
    s_add_u32 m0, s65, 87040
    s_nop 0
    buffer_load_dwordx4 v71, s[36:39], s46 offen  lds
    s_add_u32 s46, s51, 0x14000
    s_add_u32 m0, s65, 88064
    s_nop 0
    buffer_load_dwordx4 v72, s[36:39], s46 offen  lds
    s_add_u32 s46, s51, 0x1c000
    s_add_u32 m0, s65, 89088
    s_nop 0
    buffer_load_dwordx4 v73, s[36:39], s46 offen  lds
    s_waitcnt vmcnt(40)
    v_min_u32 v45, -2, v45
    buffer_store_dword v45, v12, s[12:15], s61 offen sc1
    s_waitcnt vmcnt(36)
    s_barrier
    ds_read_b64_tr_b16 a[160:161], v88 offset:0
    ds_read_b64_tr_b16 a[162:163], v88 offset:256
    ds_read_b64_tr_b16 a[168:169], v89 offset:0
    ds_read_b64_tr_b16 a[170:171], v89 offset:256
    ds_read_b64_tr_b16 a[176:177], v90 offset:0
    ds_read_b64_tr_b16 a[178:179], v90 offset:256
    ds_read_b64_tr_b16 a[184:185], v91 offset:0
    ds_read_b64_tr_b16 a[186:187], v91 offset:256
L_lw_49:
    s_waitcnt lgkmcnt(0)
    s_cmp_lg_u32 s44, 0
    s_cbranch_scc1 L_v_probe_50
    s_add_u32 s45, s63, 0
    s_memtime s[72:73]
    s_waitcnt lgkmcnt(0)
    s_load_dword s78, s[20:21], s45
    s_waitcnt lgkmcnt(0)
    s_memtime s[74:75]
    s_waitcnt lgkmcnt(0)
    s_sub_u32 s45, s74, s72
    s_min_u32 s76, s76, s45
    s_cmp_lt_u32 s77, s76
    s_cselect_b32 s68, 1, 0
L_v_probe_50:
    s_waitcnt vmcnt(32)
    s_barrier
    s_add_u32 s51, s69, 5
    s_and_b32 s51, s51, 7
    s_lshl_b32 s51, s51, 17
    s_add_u32 s51, s51, s49
    s_add_u32 s46, s51, 0x0
    s_add_u32 m0, s65, 65536
    s_nop 0
    buffer_load_dwordx4 v70, s[36:39], s46 offen  lds
    s_add_u32 s46, s51, 0x8000
    s_add_u32 m0, s65, 66560
    s_nop 0
    buffer_load_dwordx4 v71, s[36:39], s46 offen  lds
    s_add_u32 s46, s51, 0x10000
    s_add_u32 m0, s65, 67584
    s_nop 0
    buffer_load_dwordx4 v72, s[36:39], s46 offen  lds
    s_add_u32 s46, s51, 0x18000
    s_add_u32 m0, s65, 68608
    s_nop 0
    buffer_load_dwordx4 v73, s[36:39], s46 offen  lds
    ds_read_b64_tr_b16 a[164:165], v88 offset:4096
    ds_read_b64_tr_b16 a[166:167], v88 offset:4352
    ds_read_b64_tr_b16 a[172:173], v89 offset:4096
    ds_read_b64_tr_b16 a[174:175], v89 offset:4352
    ds_read_b64_tr_b16 a[180:181], v90 offset:4096
    ds_read_b64_tr_b16 a[182:183], v90 offset:4352
    ds_read_b64_tr_b16 a[188:189], v91 offset:4096
    ds_read_b64_tr_b16 a[190:191], v91 offset:4352
L_lw_51:
    s_waitcnt lgkmcnt(0)
    s_cmp_lg_u32 s44, 0
    s_cbranch_scc1 L_v_probe_52
    s_add_u32 s45, s63, 8192
    s_memtime s[72:73]
    s_waitcnt lgkmcnt(0)
    s_load_dword s78, s[20:21], s45
    s_waitcnt lgkmcnt(0)
    s_memtime s[74:75]
    s_waitcnt lgkmcnt(0)
    s_sub_u32 s45, s74, s72
    s_min_u32 s77, s77, s45
    s_cmp_lt_u32 s77, s76
    s_cselect_b32 s68, 1, 0
L_v_probe_52:
    s_waitcnt vmcnt(32)
    s_barrier
    s_add_u32 s51, s69, 5
    s_and_b32 s51, s51, 7
    s_lshl_b32 s51, s51, 17
    s_add_u32 s51, s51, s49
    s_add_u32 s46, s51, 0x4000
    s_add_u32 m0, s65, 69632
    s_nop 0
    buffer_load_dwordx4 v70, s[36:39], s46 offen  lds
    s_add_u32 s46, s51, 0xc000
    s_add_u32 m0, s65, 70656
    s_nop 0
    buffer_load_dwordx4 v71, s[36:39], s46 offen  lds
    s_add_u32 s46, s51, 0x14000
    s_add_u32 m0, s65, 71680
    s_nop 0
    buffer_load_dwordx4 v72, s[36:39], s46 offen  lds
    s_add_u32 s46, s51, 0x1c000
    s_add_u32 m0, s65, 72704
    s_nop 0
    buffer_load_dwordx4 v73, s[36:39], s46 offen  lds
    ds_read_b64_tr_b16 a[192:193], v88 offset:8192
    ds_read_b64_tr_b16 a[194:195], v88 offset:8448
    ds_read_b64_tr_b16 a[200:201], v89 offset:8192
    ds_read_b64_tr_b16 a[202:203], v89 offset:8448
    ds_read_b64_tr_b16 a[208:209], v90 offset:8192
    ds_read_b64_tr_b16 a[210:211], v90 offset:8448
    ds_read_b64_tr_b16 a[216:217], v91 offset:8192
    ds_read_b64_tr_b16 a[218:219], v91 offset:8448
L_lw_53:
    s_waitcnt lgkmcnt(0)
    s_cmp_lg_u32 s44, 0
    s_cbranch_scc1 L_v_probe_54
    s_add_u32 s45, s63, 128
    s_memtime s[72:73]
    s_waitcnt lgkmcnt(0)
    s_load_dword s78, s[20:21], s45
    s_waitcnt lgkmcnt(0)
    s_memtime s[74:75]
    s_waitcnt lgkmcnt(0)
    s_sub_u32 s45, s74, s72
    s_min_u32 s76, s76, s45
    s_cmp_lt_u32 s77, s76
    s_cselect_b32 s68, 1, 0
L_v_probe_54:
    s_waitcnt vmcnt(32)
    s_barrier
    s_add_u32 s51, s69, 6
    s_and_b32 s51, s51, 7
    s_lshl_b32 s51, s51, 17
    s_add_u32 s51, s51, s49
    s_add_u32 s46, s51, 0x0
    s_add_u32 m0, s65, 73728
    s_nop 0
    buffer_load_dwordx4 v70, s[36:39], s46 offen  lds
    s_add_u32 s46, s51, 0x8000
    s_add_u32 m0, s65, 74752
    s_nop 0
    buffer_load_dwordx4 v71, s[36:39], s46 offen  lds
    s_add_u32 s46, s51, 0x10000
    s_add_u32 m0, s65, 75776
    s_nop 0
    buffer_load_dwordx4 v72, s[36:39], s46 offen  lds
    s_add_u32 s46, s51, 0x18000
    s_add_u32 m0, s65, 76800
    s_nop 0
    buffer_load_dwordx4 v73, s[36:39], s46 offen  lds
    ds_read_b64_tr_b16 a[196:197], v88 offset:12288
    ds_read_b64_tr_b16 a[198:199], v88 offset:12544
    ds_read_b64_tr_b16 a[204:205], v89 offset:12288
    ds_read_b64_tr_b16 a[206:207], v89 offset:12544
    ds_read_b64_tr_b16 a[212:213], v90 offset:12288
    ds_read_b64_tr_b16 a[214:215], v90 offset:12544
    ds_read_b64_tr_b16 a[220:221], v91 offset:12288
    ds_read_b64_tr_b16 a[222:223], v91 offset:12544
L_lw_55:
    s_waitcnt lgkmcnt(0)
    s_cmp_lg_u32 s44, 0
    s_cbranch_scc1 L_v_probe_56
    s_add_u32 s45, s63, 8320
    s_memtime s[72:73]
    s_waitcnt lgkmcnt(0)
    s_load_dword s78, s[20:21], s45
    s_waitcnt lgkmcnt(0)
    s_memtime s[74:75]
    s_waitcnt lgkmcnt(0)
    s_sub_u32 s45, s74, s72
    s_min_u32 s77, s77, s45
    s_cmp_lt_u32 s77, s76
    s_cselect_b32 s68, 1, 0
L_v_probe_56:
    s_waitcnt vmcnt(32)
    s_barrier
    s_add_u32 s51, s69, 6
    s_and_b32 s51, s51, 7
    s_lshl_b32 s51, s51, 17
    s_add_u32 s51, s51, s49
    s_add_u32 s46, s51, 0x4000
    s_add_u32 m0, s65, 77824
    s_nop 0
    buffer_load_dwordx4 v70, s[36:39], s46 offen  lds
    s_add_u32 s46, s51, 0xc000
    s_add_u32 m0, s65, 78848
    s_nop 0
    buffer_load_dwordx4 v71, s[36:39], s46 offen  lds
    s_add_u32 s46, s51, 0x14000
    s_add_u32 m0, s65, 79872
    s_nop 0
    buffer_load_dwordx4 v72, s[36:39], s46 offen  lds
    s_add_u32 s46, s51, 0x1c000
    s_add_u32 m0, s65, 80896
    s_nop 0
    buffer_load_dwordx4 v73, s[36:39], s46 offen  lds
    ds_read_b64_tr_b16 a[224:225], v88 offset:16384
    ds_read_b64_tr_b16 a[226:227], v88 offset:16640
    ds_read_b64_tr_b16 a[232:233], v89 offset:16384
    ds_read_b64_tr_b16 a[234:235], v89 offset:16640
    ds_read_b64_tr_b16 a[240:241], v90 offset:16384
    ds_read_b64_tr_b16 a[242:243], v90 offset:16640
    ds_read_b64_tr_b16 a[248:249], v91 offset:16384
    ds_read_b64_tr_b16 a[250:251], v91 offset:16640
L_lw_57:
    s_waitcnt lgkmcnt(0)
    s_cmp_lg_u32 s44, 0
    s_cbranch_scc1 L_v_probe_58
    s_add_u32 s45, s63, 256
    s_memtime s[72:73]
    s_waitcnt lgkmcnt(0)
    s_load_dword s78, s[20:21], s45
    s_waitcnt lgkmcnt(0)
    s_memtime s[74:75]
    s_waitcnt lgkmcnt(0)
    s_sub_u32 s45, s74, s72
    s_min_u32 s76, s76, s45
    s_cmp_lt_u32 s77, s76
    s_cselect_b32 s68, 1, 0
L_v_probe_58:
    s_waitcnt vmcnt(32)
    s_barrier
    s_add_u32 s51, s69, 7
    s_and_b32 s51, s51, 7
    s_lshl_b32 s51, s51, 17
    s_add_u32 s51, s51, s49
    s_add_u32 s46, s51, 0x0
    s_add_u32 m0, s65, 81920
    s_nop 0
    buffer_load_dwordx4 v70, s[36:39], s46 offen  lds
    s_add_u32 s46, s51, 0x8000
    s_add_u32 m0, s65, 82944
    s_nop 0
    buffer_load_dwordx4 v71, s[36:39], s46 offen  lds
    s_add_u32 s46, s51, 0x10000
    s_add_u32 m0, s65, 83968
    s_nop 0
    buffer_load_dwordx4 v72, s[36:39], s46 offen  lds
    s_add_u32 s46, s51, 0x18000
    s_add_u32 m0, s65, 84992
    s_nop 0
    buffer_load_dwordx4 v73, s[36:39], s46 offen  lds
    ds_read_b64_tr_b16 a[228:229], v74 offset:0
    ds_read_b64_tr_b16 a[230:231], v74 offset:256
    ds_read_b64_tr_b16 a[236:237], v75 offset:0
    ds_read_b64_tr_b16 a[238:239], v75 offset:256
    ds_read_b64_tr_b16 a[244:245], v76 offset:0
    ds_read_b64_tr_b16 a[246:247], v76 offset:256
    ds_read_b64_tr_b16 a[252:253], v77 offset:0
    ds_read_b64_tr_b16 a[254:255], v77 offset:256
L_lw_59:
    s_waitcnt lgkmcnt(0)
    s_cmp_lg_u32 s44, 0
    s_cbranch_scc1 L_v_probe_60
    s_add_u32 s45, s63, 8448
    s_memtime s[72:73]
    s_waitcnt lgkmcnt(0)
    s_load_dword s78, s[20:21], s45
    s_waitcnt lgkmcnt(0)
    s_memtime s[74:75]
    s_waitcnt lgkmcnt(0)
    s_sub_u32 s45, s74, s72
    s_min_u32 s77, s77, s45
    s_cmp_lt_u32 s77, s76
    s_cselect_b32 s68, 1, 0
L_v_probe_60:
    s_waitcnt vmcnt(32)
    s_barrier
    s_add_u32 s51, s69, 7
    s_and_b32 s51, s51, 7
    s_lshl_b32 s51, s51, 17
    s_add_u32 s51, s51, s49
    s_add_u32 s46, s51, 0x4000
    s_add_u32 m0, s50, 0
    s_nop 0
    buffer_load_dwordx4 v70, s[36:39], s46 offen  lds
    s_add_u32 s46, s51, 0xc000
    s_add_u32 m0, s50, 1024
    s_nop 0
    buffer_load_dwordx4 v71, s[36:39], s46 offen  lds
    s_add_u32 s46, s51, 0x14000
    s_add_u32 m0, s50, 2048
    s_nop 0
    buffer_load_dwordx4 v72, s[36:39], s46 offen  lds
    s_add_u32 s46, s51, 0x1c000
    s_add_u32 m0, s50, 3072
    s_nop 0
    buffer_load_dwordx4 v73, s[36:39], s46 offen  lds
    ds_read_b64_tr_b16 v[96:97], v74 offset:16384
    ds_read_b64_tr_b16 v[98:99], v74 offset:16640
    ds_read_b64_tr_b16 v[104:105], v75 offset:16384
    ds_read_b64_tr_b16 v[106:107], v75 offset:16640
    ds_read_b64_tr_b16 v[112:113], v76 offset:16384
    ds_read_b64_tr_b16 v[114:115], v76 offset:16640
    ds_read_b64_tr_b16 v[120:121], v77 offset:16384
    ds_read_b64_tr_b16 v[122:123], v77 offset:16640
L_lw_61:
    s_waitcnt lgkmcnt(0)
    s_waitcnt vmcnt(32)
    s_barrier
    s_add_u32 s79, s41, 0
    s_and_b32 s79, s79, 3
    s_lshl_b32 s79, s79, 19
    s_add_u32 s79, s79, s47
    s_add_u32 s46, s79, 0x0
    s_add_u32 m0, s48, 16384
    s_nop 0
    buffer_load_dwordx4 v82, s[32:35], s46 offen  lds
    s_add_u32 s46, s79, 0x20000
    s_add_u32 m0, s48, 20480
    s_nop 0
    buffer_load_dwordx4 v82, s[32:35], s46 offen  lds
    s_add_u32 s46, s79, 0x40000
    s_add_u32 m0, s48, 24576
    s_nop 0
    buffer_load_dwordx4 v82, s[32:35], s46 offen  lds
    s_add_u32 s46, s79, 0x60000
    s_add_u32 m0, s48, 28672
    s_nop 0
    buffer_load_dwordx4 v82, s[32:35], s46 offen  lds
    ds_read_b64_tr_b16 v[100:101], v74 offset:32768
    ds_read_b64_tr_b16 v[102:103], v74 offset:33024
    ds_read_b64_tr_b16 v[108:109], v75 offset:32768
    ds_read_b64_tr_b16 v[110:111], v75 offset:33024
    ds_read_b64_tr_b16 v[116:117], v76 offset:32768
    ds_read_b64_tr_b16 v[118:119], v76 offset:33024
    ds_read_b64_tr_b16 v[124:125], v77 offset:32768
    ds_read_b64_tr_b16 v[126:127], v77 offset:33024
L_lw_62:
    s_waitcnt lgkmcnt(0)
    s_waitcnt vmcnt(32)
    s_barrier
    s_add_u32 s79, s41, 1
    s_and_b32 s79, s79, 3
    s_lshl_b32 s79, s79, 19
    s_add_u32 s79, s79, s47
    s_add_u32 s46, s79, 0x0
    s_add_u32 m0, s48, 32768
    s_nop 0
    buffer_load_dwordx4 v82, s[32:35], s46 offen  lds
    s_add_u32 s46, s79, 0x20000
    s_add_u32 m0, s48, 36864
    s_nop 0
    buffer_load_dwordx4 v82, s[32:35], s46 offen  lds
    s_add_u32 s46, s79, 0x40000
    s_add_u32 m0, s48, 40960
    s_nop 0
    buffer_load_dwordx4 v82, s[32:35], s46 offen  lds
    s_add_u32 s46, s79, 0x60000
    s_add_u32 m0, s48, 45056
    s_nop 0
    buffer_load_dwordx4 v82, s[32:35], s46 offen  lds
    ds_read_b64_tr_b16 v[128:129], v74 offset:49152
    ds_read_b64_tr_b16 v[130:131], v74 offset:49408
    ds_read_b64_tr_b16 v[136:137], v75 offset:49152
    ds_read_b64_tr_b16 v[138:139], v75 offset:49408
    ds_read_b64_tr_b16 v[144:145], v76 offset:49152
    ds_read_b64_tr_b16 v[146:147], v76 offset:49408
    ds_read_b64_tr_b16 v[152:153], v77 offset:49152
    ds_read_b64_tr_b16 v[154:155], v77 offset:49408
L_lw_63:
    s_waitcnt lgkmcnt(0)
    s_waitcnt vmcnt(32)
    s_barrier
    s_add_u32 s79, s41, 2
    s_and_b32 s79, s79, 3
    s_lshl_b32 s79, s79, 19
    s_add_u32 s79, s79, s47
    s_add_u32 s46, s79, 0x0
    s_add_u32 m0, s48, 49152
    s_nop 0
    buffer_load_dwordx4 v82, s[32:35], s46 offen  lds
    s_add_u32 s46, s79, 0x20000
    s_add_u32 m0, s48, 53248
    s_nop 0
    buffer_load_dwordx4 v82, s[32:35], s46 offen  lds
    s_add_u32 s46, s79, 0x40000
    s_add_u32 m0, s48, 57344
    s_nop 0
    buffer_load_dwordx4 v82, s[32:35], s46 offen  lds
    s_add_u32 s46, s79, 0x60000
    s_add_u32 m0, s48, 61440
    s_nop 0
    buffer_load_dwordx4 v82, s[32:35], s46 offen  lds
    ds_read_b64_tr_b16 v[132:133], v88 offset:20480
    ds_read_b64_tr_b16 v[134:135], v88 offset:20736
    ds_read_b64_tr_b16 v[140:141], v89 offset:20480
    ds_read_b64_tr_b16 v[142:143], v89 offset:20736
    ds_read_b64_tr_b16 v[148:149], v90 offset:20480
    ds_read_b64_tr_b16 v[150:151], v90 offset:20736
    ds_read_b64_tr_b16 v[156:157], v91 offset:20480
    ds_read_b64_tr_b16 v[158:159], v91 offset:20736
L_lw_64:
    s_waitcnt lgkmcnt(0)
    s_waitcnt vmcnt(32)
    s_barrier
    s_add_u32 s79, s41, 3
    s_and_b32 s79, s79, 3
    s_lshl_b32 s79, s79, 19
    s_add_u32 s79, s79, s47
    s_add_u32 s46, s79, 0x0
    s_add_u32 m0, s48, 86016
    s_nop 0
    buffer_load_dwordx4 v82, s[32:35], s46 offen  lds
    s_add_u32 s46, s79, 0x20000
    s_add_u32 m0, s48, 110592
    s_nop 0
    buffer_load_dwordx4 v82, s[32:35], s46 offen  lds
    s_add_u32 s46, s79, 0x40000
    s_add_u32 m0, s48, 135168
    s_nop 0
    buffer_load_dwordx4 v82, s[32:35], s46 offen  lds
    s_add_u32 s46, s79, 0x60000
    s_add_u32 m0, s48, 159744
    s_nop 0
    buffer_load_dwordx4 v82, s[32:35], s46 offen  lds
    ds_read_b64_tr_b16 v[160:161], v88 offset:0
    ds_read_b64_tr_b16 v[162:163], v88 offset:256
    ds_read_b64_tr_b16 v[168:169], v89 offset:0
    ds_read_b64_tr_b16 v[170:171], v89 offset:256
    ds_read_b64_tr_b16 v[176:177], v90 offset:0
    ds_read_b64_tr_b16 v[178:179], v90 offset:256
    ds_read_b64_tr_b16 v[184:185], v91 offset:0
    ds_read_b64_tr_b16 v[186:187], v91 offset:256
L_lw_65:
    s_waitcnt lgkmcnt(0)
    s_waitcnt vmcnt(32)
    s_barrier
    s_cmp_lg_u32 s44, 0
    s_cbranch_scc1 L_hs_66
    s_getreg_b32 s45, hwreg(HW_REG_XCC_ID)
    s_and_b32 s45, s45, 15
    s_mul_i32 s46, s45, s45
    s_lshl_b32 s46, s46, 9
    s_add_u32 s45, s45, s46
    s_cmp_eq_u32 s40, 0
    s_cselect_b32 s46, s45, 0
    s_cselect_b32 s45, 0, s45
    s_lshl_b32 s68, s68, 24
    s_add_u32 s46, s46, s68
    s_add_u32 s45, s45, 16777216
    v_mov_b32 v40, s46
    v_mov_b32 v41, s45
    v_mov_b32 v42, 0
    s_mov_b64 exec, 1
    buffer_atomic_add_x2 v[40:41], v42, s[16:19], 0 offen sc1
    s_mov_b64 exec, -1
L_hs_66:
    ds_read_b64_tr_b16 v[164:165], v88 offset:4096
    ds_read_b64_tr_b16 v[166:167], v88 offset:4352
    ds_read_b64_tr_b16 v[172:173], v89 offset:4096
    ds_read_b64_tr_b16 v[174:175], v89 offset:4352
    ds_read_b64_tr_b16 v[180:181], v90 offset:4096
    ds_read_b64_tr_b16 v[182:183], v90 offset:4352
    ds_read_b64_tr_b16 v[188:189], v91 offset:4096
    ds_read_b64_tr_b16 v[190:191], v91 offset:4352
L_lw_67:
    s_waitcnt lgkmcnt(0)
    s_waitcnt vmcnt(28)
    s_barrier
    ds_read_b64_tr_b16 v[192:193], v88 offset:8192
    ds_read_b64_tr_b16 v[194:195], v88 offset:8448
    ds_read_b64_tr_b16 v[200:201], v89 offset:8192
    ds_read_b64_tr_b16 v[202:203], v89 offset:8448
    ds_read_b64_tr_b16 v[208:209], v90 offset:8192
    ds_read_b64_tr_b16 v[210:211], v90 offset:8448
    ds_read_b64_tr_b16 v[216:217], v91 offset:8192
    ds_read_b64_tr_b16 v[218:219], v91 offset:8448
L_lw_68:
    s_waitcnt lgkmcnt(0)
    s_waitcnt vmcnt(24)
    s_barrier
    ds_read_b64_tr_b16 v[196:197], v88 offset:12288
    ds_read_b64_tr_b16 v[198:199], v88 offset:12544
    ds_read_b64_tr_b16 v[204:205], v89 offset:12288
    ds_read_b64_tr_b16 v[206:207], v89 offset:12544
    ds_read_b64_tr_b16 v[212:213], v90 offset:12288
    ds_read_b64_tr_b16 v[214:215], v90 offset:12544
    ds_read_b64_tr_b16 v[220:221], v91 offset:12288
    ds_read_b64_tr_b16 v[222:223], v91 offset:12544
L_lw_69:
    s_waitcnt lgkmcnt(0)
    s_waitcnt vmcnt(20)
    s_barrier
    ds_read_b64_tr_b16 v[224:225], v88 offset:16384
    ds_read_b64_tr_b16 v[226:227], v88 offset:16640
    ds_read_b64_tr_b16 v[232:233], v89 offset:16384
    ds_read_b64_tr_b16 v[234:235], v89 offset:16640
    ds_read_b64_tr_b16 v[240:241], v90 offset:16384
    ds_read_b64_tr_b16 v[242:243], v90 offset:16640
    ds_read_b64_tr_b16 v[248:249], v91 offset:16384
    ds_read_b64_tr_b16 v[250:251], v91 offset:16640
L_lw_70:
    s_waitcnt lgkmcnt(0)
    s_waitcnt vmcnt(16)
    s_barrier
    ds_read_b64_tr_b16 v[228:229], v74 offset:0
    ds_read_b64_tr_b16 v[230:231], v74 offset:256
    ds_read_b64_tr_b16 v[236:237], v75 offset:0
    ds_read_b64_tr_b16 v[238:239], v75 offset:256
    ds_read_b64_tr_b16 v[244:245], v76 offset:0
    ds_read_b64_tr_b16 v[246:247], v76 offset:256
    ds_read_b64_tr_b16 v[252:253], v77 offset:0
    ds_read_b64_tr_b16 v[254:255], v77 offset:256
L_lw_71:
    s_waitcnt lgkmcnt(0)
    s_waitcnt vmcnt(12)
    s_barrier
    s_add_u32 s79, s41, 4
    s_and_b32 s79, s79, 3
    s_lshl_b32 s79, s79, 19
    s_add_u32 s79, s79, s47
    s_add_u32 s46, s79, 0x200000
    s_add_u32 m0, s48, 0
    s_nop 0
    buffer_load_dwordx4 v82, s[32:35], s46 offen  lds
    s_add_u32 s46, s79, 0x220000
    s_add_u32 m0, s48, 4096
    s_nop 0
    buffer_load_dwordx4 v82, s[32:35], s46 offen  lds
    s_add_u32 s46, s79, 0x240000
    s_add_u32 m0, s48, 8192
    s_nop 0
    buffer_load_dwordx4 v82, s[32:35], s46 offen  lds
    s_add_u32 s46, s79, 0x260000
    s_add_u32 m0, s48, 12288
    s_nop 0
    buffer_load_dwordx4 v82, s[32:35], s46 offen  lds
    s_cmp_lg_u32 s44, 0
    s_cbranch_scc1 L_lw_72_0
    ds_read_b64_tr_b16 a[0:1], v80 offset:16384
    ds_read_b64_tr_b16 a[2:3], v80 offset:17408
    ds_read_b64_tr_b16 a[4:5], v80 offset:24576
    ds_read_b64_tr_b16 a[6:7], v80 offset:25600
    ds_read_b64_tr_b16 a[8:9], v81 offset:16384
    ds_read_b64_tr_b16 a[10:11], v81 offset:17408
    ds_read_b64_tr_b16 a[12:13], v81 offset:24576
    ds_read_b64_tr_b16 a[14:15], v81 offset:25600
    s_branch L_lw_72
L_lw_72_0:
    s_cmp_lg_u32 s44, 1
    s_cbranch_scc1 L_lw_72_1
    ds_read_b64_tr_b16 a[120:121], v80 offset:16384
    ds_read_b64_tr_b16 a[122:123], v80 offset:17408
    ds_read_b64_tr_b16 a[124:125], v80 offset:24576
    ds_read_b64_tr_b16 a[126:127], v80 offset:25600
    ds_read_b64_tr_b16 v[24:25], v81 offset:16384
    ds_read_b64_tr_b16 v[26:27], v81 offset:17408
    ds_read_b64_tr_b16 v[28:29], v81 offset:24576
    ds_read_b64_tr_b16 v[30:31], v81 offset:25600
    s_branch L_lw_72
L_lw_72_1:
    s_cmp_lg_u32 s44, 2
    s_cbranch_scc1 L_lw_72_2
    ds_read_b64_tr_b16 a[80:81], v80 offset:16384
    ds_read_b64_tr_b16 a[82:83], v80 offset:17408
    ds_read_b64_tr_b16 a[84:85], v80 offset:24576
    ds_read_b64_tr_b16 a[86:87], v80 offset:25600
    ds_read_b64_tr_b16 v[32:33], v81 offset:16384
    ds_read_b64_tr_b16 v[34:35], v81 offset:17408
    ds_read_b64_tr_b16 v[36:37], v81 offset:24576
    ds_read_b64_tr_b16 v[38:39], v81 offset:25600
    s_branch L_lw_72
L_lw_72_2:
    ds_read_b64_tr_b16 a[48:49], v80 offset:16384
    ds_read_b64_tr_b16 a[50:51], v80 offset:17408
    ds_read_b64_tr_b16 a[52:53], v80 offset:24576
    ds_read_b64_tr_b16 a[54:55], v80 offset:25600
    ds_read_b64_tr_b16 v[48:49], v81 offset:16384
    ds_read_b64_tr_b16 v[50:51], v81 offset:17408
    ds_read_b64_tr_b16 v[52:53], v81 offset:24576
    ds_read_b64_tr_b16 v[54:55], v81 offset:25600
L_lw_72:
    s_waitcnt lgkmcnt(0)
    s_waitcnt vmcnt(12)
    s_barrier
    s_add_u32 s79, s41, 5
    s_and_b32 s79, s79, 3
    s_lshl_b32 s79, s79, 19
    s_add_u32 s79, s79, s47
    s_add_u32 s46, s79, 0x200000
    s_add_u32 m0, s48, 16384
    s_nop 0
    buffer_load_dwordx4 v82, s[32:35], s46 offen  lds
    s_add_u32 s46, s79, 0x220000
    s_add_u32 m0, s48, 20480
    s_nop 0
    buffer_load_dwordx4 v82, s[32:35], s46 offen  lds
    s_add_u32 s46, s79, 0x240000
    s_add_u32 m0, s48, 24576
    s_nop 0
    buffer_load_dwordx4 v82, s[32:35], s46 offen  lds
    s_add_u32 s46, s79, 0x260000
    s_add_u32 m0, s48, 28672
    s_nop 0
    buffer_load_dwordx4 v82, s[32:35], s46 offen  lds
    s_cmp_lg_u32 s44, 0
    s_cbranch_scc1 L_lw_73_0
    ds_read_b64_tr_b16 a[16:17], v80 offset:32768
    ds_read_b64_tr_b16 a[18:19], v80 offset:33792
    ds_read_b64_tr_b16 a[20:21], v80 offset:40960
    ds_read_b64_tr_b16 a[22:23], v80 offset:41984
    ds_read_b64_tr_b16 a[24:25], v81 offset:32768
    ds_read_b64_tr_b16 a[26:27], v81 offset:33792
    ds_read_b64_tr_b16 a[28:29], v81 offset:40960
    ds_read_b64_tr_b16 a[30:31], v81 offset:41984
    s_branch L_lw_73
L_lw_73_0:
    s_cmp_lg_u32 s44, 1
    s_cbranch_scc1 L_lw_73_1
    ds_read_b64_tr_b16 a[128:129], v80 offset:32768
    ds_read_b64_tr_b16 a[130:131], v80 offset:33792
    ds_read_b64_tr_b16 a[132:133], v80 offset:40960
    ds_read_b64_tr_b16 a[134:135], v80 offset:41984
    ds_read_b64_tr_b16 a[136:137], v81 offset:32768
    ds_read_b64_tr_b16 a[138:139], v81 offset:33792
    ds_read_b64_tr_b16 a[140:141], v81 offset:40960
    ds_read_b64_tr_b16 a[142:143], v81 offset:41984
    s_branch L_lw_73
L_lw_73_1:
    s_cmp_lg_u32 s44, 2
    s_cbranch_scc1 L_lw_73_2
    ds_read_b64_tr_b16 a[88:89], v80 offset:32768
    ds_read_b64_tr_b16 a[90:91], v80 offset:33792
    ds_read_b64_tr_b16 a[92:93], v80 offset:40960
    ds_read_b64_tr_b16 a[94:95], v80 offset:41984
    ds_read_b64_tr_b16 a[96:97], v81 offset:32768
    ds_read_b64_tr_b16 a[98:99], v81 offset:33792
    ds_read_b64_tr_b16 a[100:101], v81 offset:40960
    ds_read_b64_tr_b16 a[102:103], v81 offset:41984
    s_branch L_lw_73
L_lw_73_2:
    ds_read_b64_tr_b16 a[56:57], v80 offset:32768
    ds_read_b64_tr_b16 a[58:59], v80 offset:33792
    ds_read_b64_tr_b16 a[60:61], v80 offset:40960
    ds_read_b64_tr_b16 a[62:63], v80 offset:41984
    ds_read_b64_tr_b16 v[56:57], v81 offset:32768
    ds_read_b64_tr_b16 v[58:59], v81 offset:33792
    ds_read_b64_tr_b16 v[60:61], v81 offset:40960
    ds_read_b64_tr_b16 v[62:63], v81 offset:41984
    s_waitcnt lgkmcnt(0)
    ds_write_b128 v5, v[56:59] offset:0
    ds_write_b128 v5, v[60:63] offset:1024
L_lw_73:
    s_waitcnt lgkmcnt(0)
    s_waitcnt vmcnt(12)
    s_barrier
    s_add_u32 s79, s41, 6
    s_and_b32 s79, s79, 3
    s_lshl_b32 s79, s79, 19
    s_add_u32 s79, s79, s47
    s_add_u32 s46, s79, 0x200000
    s_add_u32 m0, s48, 32768
    s_nop 0
    buffer_load_dwordx4 v82, s[32:35], s46 offen  lds
    s_add_u32 s46, s79, 0x220000
    s_add_u32 m0, s48, 36864
    s_nop 0
    buffer_load_dwordx4 v82, s[32:35], s46 offen  lds
    s_add_u32 s46, s79, 0x240000
    s_add_u32 m0, s48, 40960
    s_nop 0
    buffer_load_dwordx4 v82, s[32:35], s46 offen  lds
    s_add_u32 s46, s79, 0x260000
    s_add_u32 m0, s48, 45056
    s_nop 0
    buffer_load_dwordx4 v82, s[32:35], s46 offen  lds
    s_cmp_lg_u32 s44, 0
    s_cbranch_scc1 L_lw_74_0
    ds_read_b64_tr_b16 a[32:33], v80 offset:49152
    ds_read_b64_tr_b16 a[34:35], v80 offset:50176
    ds_read_b64_tr_b16 a[36:37], v80 offset:57344
    ds_read_b64_tr_b16 a[38:39], v80 offset:58368
    ds_read_b64_tr_b16 v[56:57], v81 offset:49152
    ds_read_b64_tr_b16 v[58:59], v81 offset:50176
    ds_read_b64_tr_b16 v[60:61], v81 offset:57344
    ds_read_b64_tr_b16 v[62:63], v81 offset:58368
    s_waitcnt lgkmcnt(0)
    ds_write_b128 v5, v[56:59] offset:2048
    ds_write_b128 v5, v[60:63] offset:3072
    s_branch L_lw_74
L_lw_74_0:
    s_cmp_lg_u32 s44, 1
    s_cbranch_scc1 L_lw_74_1
    ds_read_b64_tr_b16 a[144:145], v80 offset:49152
    ds_read_b64_tr_b16 a[146:147], v80 offset:50176
    ds_read_b64_tr_b16 a[148:149], v80 offset:57344
    ds_read_b64_tr_b16 a[150:151], v80 offset:58368
    ds_read_b64_tr_b16 v[56:57], v81 offset:49152
    ds_read_b64_tr_b16 v[58:59], v81 offset:50176
    ds_read_b64_tr_b16 v[60:61], v81 offset:57344
    ds_read_b64_tr_b16 v[62:63], v81 offset:58368
    s_waitcnt lgkmcnt(0)
    ds_write_b128 v5, v[56:59] offset:4096
    ds_write_b128 v5, v[60:63] offset:5120
    s_branch L_lw_74
L_lw_74_1:
    s_cmp_lg_u32 s44, 2
    s_cbranch_scc1 L_lw_74_2
    ds_read_b64_tr_b16 a[104:105], v80 offset:49152
    ds_read_b64_tr_b16 a[106:107], v80 offset:50176
    ds_read_b64_tr_b16 a[108:109], v80 offset:57344
    ds_read_b64_tr_b16 a[110:111], v80 offset:58368
    ds_read_b64_tr_b16 v[56:57], v81 offset:49152
    ds_read_b64_tr_b16 v[58:59], v81 offset:50176
    ds_read_b64_tr_b16 v[60:61], v81 offset:57344
    ds_read_b64_tr_b16 v[62:63], v81 offset:58368
    s_waitcnt lgkmcnt(0)
    ds_write_b128 v5, v[56:59] offset:6144
    ds_write_b128 v5, v[60:63] offset:7168
    s_branch L_lw_74
L_lw_74_2:
    ds_read_b64_tr_b16 a[64:65], v80 offset:49152
    ds_read_b64_tr_b16 a[66:67], v80 offset:50176
    ds_read_b64_tr_b16 a[68:69], v80 offset:57344
    ds_read_b64_tr_b16 a[70:71], v80 offset:58368
    ds_read_b64_tr_b16 v[56:57], v81 offset:49152
    ds_read_b64_tr_b16 v[58:59], v81 offset:50176
    ds_read_b64_tr_b16 v[60:61], v81 offset:57344
    ds_read_b64_tr_b16 v[62:63], v81 offset:58368
    s_waitcnt lgkmcnt(0)
    ds_write_b128 v5, v[56:59] offset:8192
    ds_write_b128 v5, v[60:63] offset:9216
L_lw_74:
    s_waitcnt lgkmcnt(0)
    s_waitcnt vmcnt(12)
    s_barrier
    s_add_u32 s79, s41, 7
    s_and_b32 s79, s79, 3
    s_lshl_b32 s79, s79, 19
    s_add_u32 s79, s79, s47
    s_add_u32 s46, s79, 0x200000
    s_add_u32 m0, s48, 49152
    s_nop 0
    buffer_load_dwordx4 v82, s[32:35], s46 offen  lds
    s_add_u32 s46, s79, 0x220000
    s_add_u32 m0, s48, 53248
    s_nop 0
    buffer_load_dwordx4 v82, s[32:35], s46 offen  lds
    s_add_u32 s46, s79, 0x240000
    s_add_u32 m0, s48, 57344
    s_nop 0
    buffer_load_dwordx4 v82, s[32:35], s46 offen  lds
    s_add_u32 s46, s79, 0x260000
    s_add_u32 m0, s48, 61440
    s_nop 0
    buffer_load_dwordx4 v82, s[32:35], s46 offen  lds
    s_cmp_lg_u32 s44, 0
    s_cbranch_scc1 L_lw_75_0
    ds_read_b64_tr_b16 a[40:41], v84 offset:20480
    ds_read_b64_tr_b16 a[42:43], v84 offset:21504
    ds_read_b64_tr_b16 a[44:45], v86 offset:20480
    ds_read_b64_tr_b16 a[46:47], v86 offset:21504
    ds_read_b64_tr_b16 v[56:57], v85 offset:20480
    ds_read_b64_tr_b16 v[58:59], v85 offset:21504
    ds_read_b64_tr_b16 v[60:61], v87 offset:20480
    ds_read_b64_tr_b16 v[62:63], v87 offset:21504
    s_waitcnt lgkmcnt(0)
    ds_write_b128 v5, v[56:59] offset:10240
    ds_write_b128 v5, v[60:63] offset:11264
    s_branch L_lw_75
L_lw_75_0:
    s_cmp_lg_u32 s44, 1
    s_cbranch_scc1 L_lw_75_1
    ds_read_b64_tr_b16 a[152:153], v84 offset:20480
    ds_read_b64_tr_b16 a[154:155], v84 offset:21504
    ds_read_b64_tr_b16 a[156:157], v86 offset:20480
    ds_read_b64_tr_b16 a[158:159], v86 offset:21504
    ds_read_b64_tr_b16 v[56:57], v85 offset:20480
    ds_read_b64_tr_b16 v[58:59], v85 offset:21504
    ds_read_b64_tr_b16 v[60:61], v87 offset:20480
    ds_read_b64_tr_b16 v[62:63], v87 offset:21504
    s_waitcnt lgkmcnt(0)
    ds_write_b128 v5, v[56:59] offset:12288
    ds_write_b128 v5, v[60:63] offset:13312
    s_branch L_lw_75
L_lw_75_1:
    s_cmp_lg_u32 s44, 2
    s_cbranch_scc1 L_lw_75_2
    ds_read_b64_tr_b16 a[112:113], v84 offset:20480
    ds_read_b64_tr_b16 a[114:115], v84 offset:21504
    ds_read_b64_tr_b16 a[116:117], v86 offset:20480
    ds_read_b64_tr_b16 a[118:119], v86 offset:21504
    ds_read_b64_tr_b16 v[56:57], v85 offset:20480
    ds_read_b64_tr_b16 v[58:59], v85 offset:21504
    ds_read_b64_tr_b16 v[60:61], v87 offset:20480
    ds_read_b64_tr_b16 v[62:63], v87 offset:21504
    s_waitcnt lgkmcnt(0)
    ds_write_b128 v5, v[56:59] offset:14336
    ds_write_b128 v5, v[60:63] offset:15360
    s_branch L_lw_75
L_lw_75_2:
    ds_read_b64_tr_b16 a[72:73], v84 offset:20480
    ds_read_b64_tr_b16 a[74:75], v84 offset:21504
    ds_read_b64_tr_b16 a[76:77], v86 offset:20480
    ds_read_b64_tr_b16 a[78:79], v86 offset:21504
    ds_read_b64_tr_b16 v[56:57], v85 offset:20480
    ds_read_b64_tr_b16 v[58:59], v85 offset:21504
    ds_read_b64_tr_b16 v[60:61], v87 offset:20480
    ds_read_b64_tr_b16 v[62:63], v87 offset:21504
    s_waitcnt lgkmcnt(0)
    ds_write_b128 v5, v[56:59] offset:16384
    ds_write_b128 v5, v[60:63] offset:17408
L_lw_75:
    s_waitcnt lgkmcnt(0)
    s_waitcnt vmcnt(12)
    s_barrier
    s_add_u32 s79, s41, 8
    s_and_b32 s79, s79, 3
    s_lshl_b32 s79, s79, 19
    s_add_u32 s79, s79, s47
    s_add_u32 s46, s79, 0x400000
    s_add_u32 m0, s48, 86016
    s_nop 0
    buffer_load_dwordx4 v82, s[32:35], s46 offen  lds
    s_add_u32 s46, s79, 0x420000
    s_add_u32 m0, s48, 110592
    s_nop 0
    buffer_load_dwordx4 v82, s[32:35], s46 offen  lds
    s_add_u32 s46, s79, 0x440000
    s_add_u32 m0, s48, 135168
    s_nop 0
    buffer_load_dwordx4 v82, s[32:35], s46 offen  lds
    s_add_u32 s46, s79, 0x460000
    s_add_u32 m0, s48, 159744
    s_nop 0
    buffer_load_dwordx4 v82, s[32:35], s46 offen  lds
    s_cmp_lg_u32 s44, 0
    s_cbranch_scc1 L_lw_76_0
    ds_read_b64_tr_b16 a[48:49], v80 offset:0
    ds_read_b64_tr_b16 a[50:51], v80 offset:1024
    ds_read_b64_tr_b16 a[52:53], v80 offset:8192
    ds_read_b64_tr_b16 a[54:55], v80 offset:9216
    ds_read_b64_tr_b16 v[48:49], v81 offset:0
    ds_read_b64_tr_b16 v[50:51], v81 offset:1024
    ds_read_b64_tr_b16 v[52:53], v81 offset:8192
    ds_read_b64_tr_b16 v[54:55], v81 offset:9216
    s_branch L_lw_76
L_lw_76_0:
    s_cmp_lg_u32 s44, 1
    s_cbranch_scc1 L_lw_76_1
    ds_read_b64_tr_b16 a[0:1], v80 offset:0
    ds_read_b64_tr_b16 a[2:3], v80 offset:1024
    ds_read_b64_tr_b16 a[4:5], v80 offset:8192
    ds_read_b64_tr_b16 a[6:7], v80 offset:9216
    ds_read_b64_tr_b16 a[8:9], v81 offset:0
    ds_read_b64_tr_b16 a[10:11], v81 offset:1024
    ds_read_b64_tr_b16 a[12:13], v81 offset:8192
    ds_read_b64_tr_b16 a[14:15], v81 offset:9216
    s_branch L_lw_76
L_lw_76_1:
    s_cmp_lg_u32 s44, 2
    s_cbranch_scc1 L_lw_76_2
    ds_read_b64_tr_b16 a[120:121], v80 offset:0
    ds_read_b64_tr_b16 a[122:123], v80 offset:1024
    ds_read_b64_tr_b16 a[124:125], v80 offset:8192
    ds_read_b64_tr_b16 a[126:127], v80 offset:9216
    ds_read_b64_tr_b16 v[24:25], v81 offset:0
    ds_read_b64_tr_b16 v[26:27], v81 offset:1024
    ds_read_b64_tr_b16 v[28:29], v81 offset:8192
    ds_read_b64_tr_b16 v[30:31], v81 offset:9216
    s_branch L_lw_76
L_lw_76_2:
    ds_read_b64_tr_b16 a[80:81], v80 offset:0
    ds_read_b64_tr_b16 a[82:83], v80 offset:1024
    ds_read_b64_tr_b16 a[84:85], v80 offset:8192
    ds_read_b64_tr_b16 a[86:87], v80 offset:9216
    ds_read_b64_tr_b16 v[32:33], v81 offset:0
    ds_read_b64_tr_b16 v[34:35], v81 offset:1024
    ds_read_b64_tr_b16 v[36:37], v81 offset:8192
    ds_read_b64_tr_b16 v[38:39], v81 offset:9216
L_lw_76:
    s_waitcnt lgkmcnt(0)
    s_waitcnt vmcnt(12)
    s_barrier
    s_add_u32 s79, s41, 9
    s_and_b32 s79, s79, 3
    s_lshl_b32 s79, s79, 19
    s_add_u32 s79, s79, s47
    s_add_u32 s46, s79, 0x400000
    s_add_u32 m0, s48, 0
    s_nop 0
    buffer_load_dwordx4 v82, s[32:35], s46 offen  lds
    s_add_u32 s46, s79, 0x420000
    s_add_u32 m0, s48, 4096
    s_nop 0
    buffer_load_dwordx4 v82, s[32:35], s46 offen  lds
    s_add_u32 s46, s79, 0x440000
    s_add_u32 m0, s48, 8192
    s_nop 0
    buffer_load_dwordx4 v82, s[32:35], s46 offen  lds
    s_add_u32 s46, s79, 0x460000
    s_add_u32 m0, s48, 12288
    s_nop 0
    buffer_load_dwordx4 v82, s[32:35], s46 offen  lds
    s_cmp_lg_u32 s44, 0
    s_cbranch_scc1 L_lw_77_0
    ds_read_b64_tr_b16 a[56:57], v80 offset:16384
    ds_read_b64_tr_b16 a[58:59], v80 offset:17408
    ds_read_b64_tr_b16 a[60:61], v80 offset:24576
    ds_read_b64_tr_b16 a[62:63], v80 offset:25600
    ds_read_b64_tr_b16 v[56:57], v81 offset:16384
    ds_read_b64_tr_b16 v[58:59], v81 offset:17408
    ds_read_b64_tr_b16 v[60:61], v81 offset:24576
    ds_read_b64_tr_b16 v[62:63], v81 offset:25600
    s_waitcnt lgkmcnt(0)
    ds_write_b128 v5, v[56:59] offset:0
    ds_write_b128 v5, v[60:63] offset:1024
    s_branch L_lw_77
L_lw_77_0:
    s_cmp_lg_u32 s44, 1
    s_cbranch_scc1 L_lw_77_1
    ds_read_b64_tr_b16 a[16:17], v80 offset:16384
    ds_read_b64_tr_b16 a[18:19], v80 offset:17408
    ds_read_b64_tr_b16 a[20:21], v80 offset:24576
    ds_read_b64_tr_b16 a[22:23], v80 offset:25600
    ds_read_b64_tr_b16 a[24:25], v81 offset:16384
    ds_read_b64_tr_b16 a[26:27], v81 offset:17408
    ds_read_b64_tr_b16 a[28:29], v81 offset:24576
    ds_read_b64_tr_b16 a[30:31], v81 offset:25600
    s_branch L_lw_77
L_lw_77_1:
    s_cmp_lg_u32 s44, 2
    s_cbranch_scc1 L_lw_77_2
    ds_read_b64_tr_b16 a[128:129], v80 offset:16384
    ds_read_b64_tr_b16 a[130:131], v80 offset:17408
    ds_read_b64_tr_b16 a[132:133], v80 offset:24576
    ds_read_b64_tr_b16 a[134:135], v80 offset:25600
    ds_read_b64_tr_b16 a[136:137], v81 offset:16384
    ds_read_b64_tr_b16 a[138:139], v81 offset:17408
    ds_read_b64_tr_b16 a[140:141], v81 offset:24576
    ds_read_b64_tr_b16 a[142:143], v81 offset:25600
    s_branch L_lw_77
L_lw_77_2:
    ds_read_b64_tr_b16 a[88:89], v80 offset:16384
    ds_read_b64_tr_b16 a[90:91], v80 offset:17408
    ds_read_b64_tr_b16 a[92:93], v80 offset:24576
    ds_read_b64_tr_b16 a[94:95], v80 offset:25600
    ds_read_b64_tr_b16 a[96:97], v81 offset:16384
    ds_read_b64_tr_b16 a[98:99], v81 offset:17408
    ds_read_b64_tr_b16 a[100:101], v81 offset:24576
    ds_read_b64_tr_b16 a[102:103], v81 offset:25600
L_lw_77:
    s_waitcnt lgkmcnt(0)
    s_waitcnt vmcnt(12)
    s_barrier
    s_add_u32 s79, s41, 10
    s_and_b32 s79, s79, 3
    s_lshl_b32 s79, s79, 19
    s_add_u32 s79, s79, s47
    s_add_u32 s46, s79, 0x400000
    s_add_u32 m0, s48, 16384
    s_nop 0
    buffer_load_dwordx4 v82, s[32:35], s46 offen  lds
    s_add_u32 s46, s79, 0x420000
    s_add_u32 m0, s48, 20480
    s_nop 0
    buffer_load_dwordx4 v82, s[32:35], s46 offen  lds
    s_add_u32 s46, s79, 0x440000
    s_add_u32 m0, s48, 24576
    s_nop 0
    buffer_load_dwordx4 v82, s[32:35], s46 offen  lds
    s_add_u32 s46, s79, 0x460000
    s_add_u32 m0, s48, 28672
    s_nop 0
    buffer_load_dwordx4 v82, s[32:35], s46 offen  lds
    s_cmp_lg_u32 s44, 0
    s_cbranch_scc1 L_lw_78_0
    ds_read_b64_tr_b16 a[64:65], v80 offset:32768
    ds_read_b64_tr_b16 a[66:67], v80 offset:33792
    ds_read_b64_tr_b16 a[68:69], v80 offset:40960
    ds_read_b64_tr_b16 a[70:71], v80 offset:41984
    ds_read_b64_tr_b16 v[56:57], v81 offset:32768
    ds_read_b64_tr_b16 v[58:59], v81 offset:33792
    ds_read_b64_tr_b16 v[60:61], v81 offset:40960
    ds_read_b64_tr_b16 v[62:63], v81 offset:41984
    s_waitcnt lgkmcnt(0)
    ds_write_b128 v5, v[56:59] offset:8192
    ds_write_b128 v5, v[60:63] offset:9216
    s_branch L_lw_78
L_lw_78_0:
    s_cmp_lg_u32 s44, 1
    s_cbranch_scc1 L_lw_78_1
    ds_read_b64_tr_b16 a[32:33], v80 offset:32768
    ds_read_b64_tr_b16 a[34:35], v80 offset:33792
    ds_read_b64_tr_b16 a[36:37], v80 offset:40960
    ds_read_b64_tr_b16 a[38:39], v80 offset:41984
    ds_read_b64_tr_b16 v[56:57], v81 offset:32768
    ds_read_b64_tr_b16 v[58:59], v81 offset:33792
    ds_read_b64_tr_b16 v[60:61], v81 offset:40960
    ds_read_b64_tr_b16 v[62:63], v81 offset:41984
    s_waitcnt lgkmcnt(0)
    ds_write_b128 v5, v[56:59] offset:2048
    ds_write_b128 v5, v[60:63] offset:3072
    s_branch L_lw_78
L_lw_78_1:
    s_cmp_lg_u32 s44, 2
    s_cbranch_scc1 L_lw_78_2
    ds_read_b64_tr_b16 a[144:145], v80 offset:32768
    ds_read_b64_tr_b16 a[146:147], v80 offset:33792
    ds_read_b64_tr_b16 a[148:149], v80 offset:40960
    ds_read_b64_tr_b16 a[150:151], v80 offset:41984
    ds_read_b64_tr_b16 v[56:57], v81 offset:32768
    ds_read_b64_tr_b16 v[58:59], v81 offset:33792
    ds_read_b64_tr_b16 v[60:61], v81 offset:40960
    ds_read_b64_tr_b16 v[62:63], v81 offset:41984
    s_waitcnt lgkmcnt(0)
    ds_write_b128 v5, v[56:59] offset:4096
    ds_write_b128 v5, v[60:63] offset:5120
    s_branch L_lw_78
L_lw_78_2:
    ds_read_b64_tr_b16 a[104:105], v80 offset:32768
    ds_read_b64_tr_b16 a[106:107], v80 offset:33792
    ds_read_b64_tr_b16 a[108:109], v80 offset:40960
    ds_read_b64_tr_b16 a[110:111], v80 offset:41984
    ds_read_b64_tr_b16 v[56:57], v81 offset:32768
    ds_read_b64_tr_b16 v[58:59], v81 offset:33792
    ds_read_b64_tr_b16 v[60:61], v81 offset:40960
    ds_read_b64_tr_b16 v[62:63], v81 offset:41984
    s_waitcnt lgkmcnt(0)
    ds_write_b128 v5, v[56:59] offset:6144
    ds_write_b128 v5, v[60:63] offset:7168
L_lw_78:
    s_waitcnt lgkmcnt(0)
    s_waitcnt vmcnt(12)
    s_barrier
    s_add_u32 s79, s41, 11
    s_and_b32 s79, s79, 3
    s_lshl_b32 s79, s79, 19
    s_add_u32 s79, s79, s47
    s_add_u32 s46, s79, 0x400000
    s_add_u32 m0, s48, 32768
    s_nop 0
    buffer_load_dwordx4 v82, s[32:35], s46 offen  lds
    s_add_u32 s46, s79, 0x420000
    s_add_u32 m0, s48, 36864
    s_nop 0
    buffer_load_dwordx4 v82, s[32:35], s46 offen  lds
    s_add_u32 s46, s79, 0x440000
    s_add_u32 m0, s48, 40960
    s_nop 0
    buffer_load_dwordx4 v82, s[32:35], s46 offen  lds
    s_add_u32 s46, s79, 0x460000
    s_add_u32 m0, s48, 45056
    s_nop 0
    buffer_load_dwordx4 v82, s[32:35], s46 offen  lds
    s_cmp_lg_u32 s44, 0
    s_cbranch_scc1 L_lw_79_0
    ds_read_b64_tr_b16 a[72:73], v80 offset:49152
    ds_read_b64_tr_b16 a[74:75], v80 offset:50176
    ds_read_b64_tr_b16 a[76:77], v80 offset:57344
    ds_read_b64_tr_b16 a[78:79], v80 offset:58368
    ds_read_b64_tr_b16 v[56:57], v81 offset:49152
    ds_read_b64_tr_b16 v[58:59], v81 offset:50176
    ds_read_b64_tr_b16 v[60:61], v81 offset:57344
    ds_read_b64_tr_b16 v[62:63], v81 offset:58368
    s_waitcnt lgkmcnt(0)
    ds_write_b128 v5, v[56:59] offset:16384
    ds_write_b128 v5, v[60:63] offset:17408
    s_branch L_lw_79
L_lw_79_0:
    s_cmp_lg_u32 s44, 1
    s_cbranch_scc1 L_lw_79_1
    ds_read_b64_tr_b16 a[40:41], v80 offset:49152
    ds_read_b64_tr_b16 a[42:43], v80 offset:50176
    ds_read_b64_tr_b16 a[44:45], v80 offset:57344
    ds_read_b64_tr_b16 a[46:47], v80 offset:58368
    ds_read_b64_tr_b16 v[56:57], v81 offset:49152
    ds_read_b64_tr_b16 v[58:59], v81 offset:50176
    ds_read_b64_tr_b16 v[60:61], v81 offset:57344
    ds_read_b64_tr_b16 v[62:63], v81 offset:58368
    s_waitcnt lgkmcnt(0)
    ds_write_b128 v5, v[56:59] offset:10240
    ds_write_b128 v5, v[60:63] offset:11264
    s_branch L_lw_79
L_lw_79_1:
    s_cmp_lg_u32 s44, 2
    s_cbranch_scc1 L_lw_79_2
    ds_read_b64_tr_b16 a[152:153], v80 offset:49152
    ds_read_b64_tr_b16 a[154:155], v80 offset:50176
    ds_read_b64_tr_b16 a[156:157], v80 offset:57344
    ds_read_b64_tr_b16 a[158:159], v80 offset:58368
    ds_read_b64_tr_b16 v[56:57], v81 offset:49152
    ds_read_b64_tr_b16 v[58:59], v81 offset:50176
    ds_read_b64_tr_b16 v[60:61], v81 offset:57344
    ds_read_b64_tr_b16 v[62:63], v81 offset:58368
    s_waitcnt lgkmcnt(0)
    ds_write_b128 v5, v[56:59] offset:12288
    ds_write_b128 v5, v[60:63] offset:13312
    s_branch L_lw_79
L_lw_79_2:
    ds_read_b64_tr_b16 a[112:113], v80 offset:49152
    ds_read_b64_tr_b16 a[114:115], v80 offset:50176
    ds_read_b64_tr_b16 a[116:117], v80 offset:57344
    ds_read_b64_tr_b16 a[118:119], v80 offset:58368
    ds_read_b64_tr_b16 v[56:57], v81 offset:49152
    ds_read_b64_tr_b16 v[58:59], v81 offset:50176
    ds_read_b64_tr_b16 v[60:61], v81 offset:57344
    ds_read_b64_tr_b16 v[62:63], v81 offset:58368
    s_waitcnt lgkmcnt(0)
    ds_write_b128 v5, v[56:59] offset:14336
    ds_write_b128 v5, v[60:63] offset:15360
L_lw_79:
    s_waitcnt lgkmcnt(0)
    s_waitcnt vmcnt(12)
    s_barrier
    s_add_u32 s79, s41, 12
    s_and_b32 s79, s79, 3
    s_lshl_b32 s79, s79, 19
    s_add_u32 s79, s79, s47
    s_add_u32 s46, s79, 0x600000
    s_add_u32 m0, s48, 49152
    s_nop 0
    buffer_load_dwordx4 v82, s[32:35], s46 offen  lds
    s_add_u32 s46, s79, 0x620000
    s_add_u32 m0, s48, 53248
    s_nop 0
    buffer_load_dwordx4 v82, s[32:35], s46 offen  lds
    s_add_u32 s46, s79, 0x640000
    s_add_u32 m0, s48, 57344
    s_nop 0
    buffer_load_dwordx4 v82, s[32:35], s46 offen  lds
    s_add_u32 s46, s79, 0x660000
    s_add_u32 m0, s48, 61440
    s_nop 0
    buffer_load_dwordx4 v82, s[32:35], s46 offen  lds
    s_cmp_lg_u32 s44, 0
    s_cbranch_scc1 L_lw_80_0
    ds_read_b64_tr_b16 a[80:81], v84 offset:20480
    ds_read_b64_tr_b16 a[82:83], v84 offset:21504
    ds_read_b64_tr_b16 a[84:85], v86 offset:20480
    ds_read_b64_tr_b16 a[86:87], v86 offset:21504
    ds_read_b64_tr_b16 v[32:33], v85 offset:20480
    ds_read_b64_tr_b16 v[34:35], v85 offset:21504
    ds_read_b64_tr_b16 v[36:37], v87 offset:20480
    ds_read_b64_tr_b16 v[38:39], v87 offset:21504
    s_branch L_lw_80
L_lw_80_0:
    s_cmp_lg_u32 s44, 1
    s_cbranch_scc1 L_lw_80_1
    ds_read_b64_tr_b16 a[48:49], v84 offset:20480
    ds_read_b64_tr_b16 a[50:51], v84 offset:21504
    ds_read_b64_tr_b16 a[52:53], v86 offset:20480
    ds_read_b64_tr_b16 a[54:55], v86 offset:21504
    ds_read_b64_tr_b16 v[48:49], v85 offset:20480
    ds_read_b64_tr_b16 v[50:51], v85 offset:21504
    ds_read_b64_tr_b16 v[52:53], v87 offset:20480
    ds_read_b64_tr_b16 v[54:55], v87 offset:21504
    s_branch L_lw_80
L_lw_80_1:
    s_cmp_lg_u32 s44, 2
    s_cbranch_scc1 L_lw_80_2
    ds_read_b64_tr_b16 a[0:1], v84 offset:20480
    ds_read_b64_tr_b16 a[2:3], v84 offset:21504
    ds_read_b64_tr_b16 a[4:5], v86 offset:20480
    ds_read_b64_tr_b16 a[6:7], v86 offset:21504
    ds_read_b64_tr_b16 a[8:9], v85 offset:20480
    ds_read_b64_tr_b16 a[10:11], v85 offset:21504
    ds_read_b64_tr_b16 a[12:13], v87 offset:20480
    ds_read_b64_tr_b16 a[14:15], v87 offset:21504
    s_branch L_lw_80
L_lw_80_2:
    ds_read_b64_tr_b16 a[120:121], v84 offset:20480
    ds_read_b64_tr_b16 a[122:123], v84 offset:21504
    ds_read_b64_tr_b16 a[124:125], v86 offset:20480
    ds_read_b64_tr_b16 a[126:127], v86 offset:21504
    ds_read_b64_tr_b16 v[24:25], v85 offset:20480
    ds_read_b64_tr_b16 v[26:27], v85 offset:21504
    ds_read_b64_tr_b16 v[28:29], v87 offset:20480
    ds_read_b64_tr_b16 v[30:31], v87 offset:21504
L_lw_80:
    s_waitcnt lgkmcnt(0)
    s_waitcnt vmcnt(12)
    s_barrier
    s_add_u32 s79, s41, 13
    s_and_b32 s79, s79, 3
    s_lshl_b32 s79, s79, 19
    s_add_u32 s79, s79, s47
    s_add_u32 s46, s79, 0x600000
    s_add_u32 m0, s48, 86016
    s_nop 0
    buffer_load_dwordx4 v82, s[32:35], s46 offen  lds
    s_add_u32 s46, s79, 0x620000
    s_add_u32 m0, s48, 110592
    s_nop 0
    buffer_load_dwordx4 v82, s[32:35], s46 offen  lds
    s_add_u32 s46, s79, 0x640000
    s_add_u32 m0, s48, 135168
    s_nop 0
    buffer_load_dwordx4 v82, s[32:35], s46 offen  lds
    s_add_u32 s46, s79, 0x660000
    s_add_u32 m0, s48, 159744
    s_nop 0
    buffer_load_dwordx4 v82, s[32:35], s46 offen  lds
    s_cmp_lg_u32 s44, 0
    s_cbranch_scc1 L_lw_81_0
    ds_read_b64_tr_b16 a[88:89], v80 offset:0
    ds_read_b64_tr_b16 a[90:91], v80 offset:1024
    ds_read_b64_tr_b16 a[92:93], v80 offset:8192
    ds_read_b64_tr_b16 a[94:95], v80 offset:9216
    ds_read_b64_tr_b16 a[96:97], v81 offset:0
    ds_read_b64_tr_b16 a[98:99], v81 offset:1024
    ds_read_b64_tr_b16 a[100:101], v81 offset:8192
    ds_read_b64_tr_b16 a[102:103], v81 offset:9216
    s_branch L_lw_81
L_lw_81_0:
    s_cmp_lg_u32 s44, 1
    s_cbranch_scc1 L_lw_81_1
    ds_read_b64_tr_b16 a[56:57], v80 offset:0
    ds_read_b64_tr_b16 a[58:59], v80 offset:1024
    ds_read_b64_tr_b16 a[60:61], v80 offset:8192
    ds_read_b64_tr_b16 a[62:63], v80 offset:9216
    ds_read_b64_tr_b16 v[56:57], v81 offset:0
    ds_read_b64_tr_b16 v[58:59], v81 offset:1024
    ds_read_b64_tr_b16 v[60:61], v81 offset:8192
    ds_read_b64_tr_b16 v[62:63], v81 offset:9216
    s_waitcnt lgkmcnt(0)
    ds_write_b128 v5, v[56:59] offset:0
    ds_write_b128 v5, v[60:63] offset:1024
    s_branch L_lw_81
L_lw_81_1:
    s_cmp_lg_u32 s44, 2
    s_cbranch_scc1 L_lw_81_2
    ds_read_b64_tr_b16 a[16:17], v80 offset:0
    ds_read_b64_tr_b16 a[18:19], v80 offset:1024
    ds_read_b64_tr_b16 a[20:21], v80 offset:8192
    ds_read_b64_tr_b16 a[22:23], v80 offset:9216
    ds_read_b64_tr_b16 a[24:25], v81 offset:0
    ds_read_b64_tr_b16 a[26:27], v81 offset:1024
    ds_read_b64_tr_b16 a[28:29], v81 offset:8192
    ds_read_b64_tr_b16 a[30:31], v81 offset:9216
    s_branch L_lw_81
L_lw_81_2:
    ds_read_b64_tr_b16 a[128:129], v80 offset:0
    ds_read_b64_tr_b16 a[130:131], v80 offset:1024
    ds_read_b64_tr_b16 a[132:133], v80 offset:8192
    ds_read_b64_tr_b16 a[134:135], v80 offset:9216
    ds_read_b64_tr_b16 a[136:137], v81 offset:0
    ds_read_b64_tr_b16 a[138:139], v81 offset:1024
    ds_read_b64_tr_b16 a[140:141], v81 offset:8192
    ds_read_b64_tr_b16 a[142:143], v81 offset:9216
L_lw_81:
    s_waitcnt lgkmcnt(0)
    s_waitcnt vmcnt(12)
    s_barrier
    s_add_u32 s79, s41, 14
    s_and_b32 s79, s79, 3
    s_lshl_b32 s79, s79, 19
    s_add_u32 s79, s79, s47
    s_add_u32 s46, s79, 0x600000
    s_add_u32 m0, s48, 0
    s_nop 0
    buffer_load_dwordx4 v82, s[32:35], s46 offen  lds
    s_add_u32 s46, s79, 0x620000
    s_add_u32 m0, s48, 4096
    s_nop 0
    buffer_load_dwordx4 v82, s[32:35], s46 offen  lds
    s_add_u32 s46, s79, 0x640000
    s_add_u32 m0, s48, 8192
    s_nop 0
    buffer_load_dwordx4 v82, s[32:35], s46 offen  lds
    s_add_u32 s46, s79, 0x660000
    s_add_u32 m0, s48, 12288
    s_nop 0
    buffer_load_dwordx4 v82, s[32:35], s46 offen  lds
    s_cmp_lg_u32 s44, 0
    s_cbranch_scc1 L_lw_82_0
    ds_read_b64_tr_b16 a[104:105], v80 offset:16384
    ds_read_b64_tr_b16 a[106:107], v80 offset:17408
    ds_read_b64_tr_b16 a[108:109], v80 offset:24576
    ds_read_b64_tr_b16 a[110:111], v80 offset:25600
    ds_read_b64_tr_b16 v[56:57], v81 offset:16384
    ds_read_b64_tr_b16 v[58:59], v81 offset:17408
    ds_read_b64_tr_b16 v[60:61], v81 offset:24576
    ds_read_b64_tr_b16 v[62:63], v81 offset:25600
    s_waitcnt lgkmcnt(0)
    ds_write_b128 v5, v[56:59] offset:6144
    ds_write_b128 v5, v[60:63] offset:7168
    s_branch L_lw_82
L_lw_82_0:
    s_cmp_lg_u32 s44, 1
    s_cbranch_scc1 L_lw_82_1
    ds_read_b64_tr_b16 a[64:65], v80 offset:16384
    ds_read_b64_tr_b16 a[66:67], v80 offset:17408
    ds_read_b64_tr_b16 a[68:69], v80 offset:24576
    ds_read_b64_tr_b16 a[70:71], v80 offset:25600
    ds_read_b64_tr_b16 v[56:57], v81 offset:16384
    ds_read_b64_tr_b16 v[58:59], v81 offset:17408
    ds_read_b64_tr_b16 v[60:61], v81 offset:24576
    ds_read_b64_tr_b16 v[62:63], v81 offset:25600
    s_waitcnt lgkmcnt(0)
    ds_write_b128 v5, v[56:59] offset:8192
    ds_write_b128 v5, v[60:63] offset:9216
    s_branch L_lw_82
L_lw_82_1:
    s_cmp_lg_u32 s44, 2
    s_cbranch_scc1 L_lw_82_2
    ds_read_b64_tr_b16 a[32:33], v80 offset:16384
    ds_read_b64_tr_b16 a[34:35], v80 offset:17408
    ds_read_b64_tr_b16 a[36:37], v80 offset:24576
    ds_read_b64_tr_b16 a[38:39], v80 offset:25600
    ds_read_b64_tr_b16 v[56:57], v81 offset:16384
    ds_read_b64_tr_b16 v[58:59], v81 offset:17408
    ds_read_b64_tr_b16 v[60:61], v81 offset:24576
    ds_read_b64_tr_b16 v[62:63], v81 offset:25600
    s_waitcnt lgkmcnt(0)
    ds_write_b128 v5, v[56:59] offset:2048
    ds_write_b128 v5, v[60:63] offset:3072
    s_branch L_lw_82
L_lw_82_2:
    ds_read_b64_tr_b16 a[144:145], v80 offset:16384
    ds_read_b64_tr_b16 a[146:147], v80 offset:17408
    ds_read_b64_tr_b16 a[148:149], v80 offset:24576
    ds_read_b64_tr_b16 a[150:151], v80 offset:25600
    ds_read_b64_tr_b16 v[56:57], v81 offset:16384
    ds_read_b64_tr_b16 v[58:59], v81 offset:17408
    ds_read_b64_tr_b16 v[60:61], v81 offset:24576
    ds_read_b64_tr_b16 v[62:63], v81 offset:25600
    s_waitcnt lgkmcnt(0)
    ds_write_b128 v5, v[56:59] offset:4096
    ds_write_b128 v5, v[60:63] offset:5120
L_lw_82:
    s_waitcnt lgkmcnt(0)
    s_waitcnt vmcnt(12)
    s_barrier
    s_add_u32 s79, s41, 15
    s_and_b32 s79, s79, 3
    s_lshl_b32 s79, s79, 19
    s_add_u32 s79, s79, s47
    s_add_u32 s46, s79, 0x600000
    s_add_u32 m0, s48, 16384
    s_nop 0
    buffer_load_dwordx4 v82, s[32:35], s46 offen  lds
    s_add_u32 s46, s79, 0x620000
    s_add_u32 m0, s48, 20480
    s_nop 0
    buffer_load_dwordx4 v82, s[32:35], s46 offen  lds
    s_add_u32 s46, s79, 0x640000
    s_add_u32 m0, s48, 24576
    s_nop 0
    buffer_load_dwordx4 v82, s[32:35], s46 offen  lds
    s_add_u32 s46, s79, 0x660000
    s_add_u32 m0, s48, 28672
    s_nop 0
    buffer_load_dwordx4 v82, s[32:35], s46 offen  lds
    s_cmp_lg_u32 s44, 0
    s_cbranch_scc1 L_lw_83_0
    ds_read_b64_tr_b16 a[112:113], v80 offset:32768
    ds_read_b64_tr_b16 a[114:115], v80 offset:33792
    ds_read_b64_tr_b16 a[116:117], v80 offset:40960
    ds_read_b64_tr_b16 a[118:119], v80 offset:41984
    ds_read_b64_tr_b16 v[56:57], v81 offset:32768
    ds_read_b64_tr_b16 v[58:59], v81 offset:33792
    ds_read_b64_tr_b16 v[60:61], v81 offset:40960
    ds_read_b64_tr_b16 v[62:63], v81 offset:41984
    s_waitcnt lgkmcnt(0)
    ds_write_b128 v5, v[56:59] offset:14336
    ds_write_b128 v5, v[60:63] offset:15360
    s_branch L_lw_83
L_lw_83_0:
    s_cmp_lg_u32 s44, 1
    s_cbranch_scc1 L_lw_83_1
    ds_read_b64_tr_b16 a[72:73], v80 offset:32768
    ds_read_b64_tr_b16 a[74:75], v80 offset:33792
    ds_read_b64_tr_b16 a[76:77], v80 offset:40960
    ds_read_b64_tr_b16 a[78:79], v80 offset:41984
    ds_read_b64_tr_b16 v[56:57], v81 offset:32768
    ds_read_b64_tr_b16 v[58:59], v81 offset:33792
    ds_read_b64_tr_b16 v[60:61], v81 offset:40960
    ds_read_b64_tr_b16 v[62:63], v81 offset:41984
    s_waitcnt lgkmcnt(0)
    ds_write_b128 v5, v[56:59] offset:16384
    ds_write_b128 v5, v[60:63] offset:17408
    s_branch L_lw_83
L_lw_83_1:
    s_cmp_lg_u32 s44, 2
    s_cbranch_scc1 L_lw_83_2
    ds_read_b64_tr_b16 a[40:41], v80 offset:32768
    ds_read_b64_tr_b16 a[42:43], v80 offset:33792
    ds_read_b64_tr_b16 a[44:45], v80 offset:40960
    ds_read_b64_tr_b16 a[46:47], v80 offset:41984
    ds_read_b64_tr_b16 v[56:57], v81 offset:32768
    ds_read_b64_tr_b16 v[58:59], v81 offset:33792
    ds_read_b64_tr_b16 v[60:61], v81 offset:40960
    ds_read_b64_tr_b16 v[62:63], v81 offset:41984
    s_waitcnt lgkmcnt(0)
    ds_write_b128 v5, v[56:59] offset:10240
    ds_write_b128 v5, v[60:63] offset:11264
    s_branch L_lw_83
L_lw_83_2:
    ds_read_b64_tr_b16 a[152:153], v80 offset:32768
    ds_read_b64_tr_b16 a[154:155], v80 offset:33792
    ds_read_b64_tr_b16 a[156:157], v80 offset:40960
    ds_read_b64_tr_b16 a[158:159], v80 offset:41984
    ds_read_b64_tr_b16 v[56:57], v81 offset:32768
    ds_read_b64_tr_b16 v[58:59], v81 offset:33792
    ds_read_b64_tr_b16 v[60:61], v81 offset:40960
    ds_read_b64_tr_b16 v[62:63], v81 offset:41984
    s_waitcnt lgkmcnt(0)
    ds_write_b128 v5, v[56:59] offset:12288
    ds_write_b128 v5, v[60:63] offset:13312
L_lw_83:
    s_waitcnt lgkmcnt(0)
    s_waitcnt vmcnt(12)
    s_barrier
    s_cmp_lg_u32 s44, 0
    s_cbranch_scc1 L_lw_84_0
    ds_read_b64_tr_b16 a[120:121], v80 offset:49152
    ds_read_b64_tr_b16 a[122:123], v80 offset:50176
    ds_read_b64_tr_b16 a[124:125], v80 offset:57344
    ds_read_b64_tr_b16 a[126:127], v80 offset:58368
    ds_read_b64_tr_b16 v[24:25], v81 offset:49152
    ds_read_b64_tr_b16 v[26:27], v81 offset:50176
    ds_read_b64_tr_b16 v[28:29], v81 offset:57344
    ds_read_b64_tr_b16 v[30:31], v81 offset:58368
    s_branch L_lw_84
L_lw_84_0:
    s_cmp_lg_u32 s44, 1
    s_cbranch_scc1 L_lw_84_1
    ds_read_b64_tr_b16 a[80:81], v80 offset:49152
    ds_read_b64_tr_b16 a[82:83], v80 offset:50176
    ds_read_b64_tr_b16 a[84:85], v80 offset:57344
    ds_read_b64_tr_b16 a[86:87], v80 offset:58368
    ds_read_b64_tr_b16 v[32:33], v81 offset:49152
    ds_read_b64_tr_b16 v[34:35], v81 offset:50176
    ds_read_b64_tr_b16 v[36:37], v81 offset:57344
    ds_read_b64_tr_b16 v[38:39], v81 offset:58368
    s_branch L_lw_84
L_lw_84_1:
    s_cmp_lg_u32 s44, 2
    s_cbranch_scc1 L_lw_84_2
    ds_read_b64_tr_b16 a[48:49], v80 offset:49152
    ds_read_b64_tr_b16 a[50:51], v80 offset:50176
    ds_read_b64_tr_b16 a[52:53], v80 offset:57344
    ds_read_b64_tr_b16 a[54:55], v80 offset:58368
    ds_read_b64_tr_b16 v[48:49], v81 offset:49152
    ds_read_b64_tr_b16 v[50:51], v81 offset:50176
    ds_read_b64_tr_b16 v[52:53], v81 offset:57344
    ds_read_b64_tr_b16 v[54:55], v81 offset:58368
    s_branch L_lw_84
L_lw_84_2:
    ds_read_b64_tr_b16 a[0:1], v80 offset:49152
    ds_read_b64_tr_b16 a[2:3], v80 offset:50176
    ds_read_b64_tr_b16 a[4:5], v80 offset:57344
    ds_read_b64_tr_b16 a[6:7], v80 offset:58368
    ds_read_b64_tr_b16 a[8:9], v81 offset:49152
    ds_read_b64_tr_b16 a[10:11], v81 offset:50176
    ds_read_b64_tr_b16 a[12:13], v81 offset:57344
    ds_read_b64_tr_b16 a[14:15], v81 offset:58368
L_lw_84:
    s_waitcnt lgkmcnt(0)
    s_waitcnt vmcnt(8)
    s_barrier
    s_cmp_lg_u32 s44, 0
    s_cbranch_scc1 L_lw_85_0
    ds_read_b64_tr_b16 a[128:129], v84 offset:20480
    ds_read_b64_tr_b16 a[130:131], v84 offset:21504
    ds_read_b64_tr_b16 a[132:133], v86 offset:20480
    ds_read_b64_tr_b16 a[134:135], v86 offset:21504
    ds_read_b64_tr_b16 a[136:137], v85 offset:20480
    ds_read_b64_tr_b16 a[138:139], v85 offset:21504
    ds_read_b64_tr_b16 a[140:141], v87 offset:20480
    ds_read_b64_tr_b16 a[142:143], v87 offset:21504
    s_branch L_lw_85
L_lw_85_0:
    s_cmp_lg_u32 s44, 1
    s_cbranch_scc1 L_lw_85_1
    ds_read_b64_tr_b16 a[88:89], v84 offset:20480
    ds_read_b64_tr_b16 a[90:91], v84 offset:21504
    ds_read_b64_tr_b16 a[92:93], v86 offset:20480
    ds_read_b64_tr_b16 a[94:95], v86 offset:21504
    ds_read_b64_tr_b16 a[96:97], v85 offset:20480
    ds_read_b64_tr_b16 a[98:99], v85 offset:21504
    ds_read_b64_tr_b16 a[100:101], v87 offset:20480
    ds_read_b64_tr_b16 a[102:103], v87 offset:21504
    s_branch L_lw_85
L_lw_85_1:
    s_cmp_lg_u32 s44, 2
    s_cbranch_scc1 L_lw_85_2
    ds_read_b64_tr_b16 a[56:57], v84 offset:20480
    ds_read_b64_tr_b16 a[58:59], v84 offset:21504
    ds_read_b64_tr_b16 a[60:61], v86 offset:20480
    ds_read_b64_tr_b16 a[62:63], v86 offset:21504
    ds_read_b64_tr_b16 v[56:57], v85 offset:20480
    ds_read_b64_tr_b16 v[58:59], v85 offset:21504
    ds_read_b64_tr_b16 v[60:61], v87 offset:20480
    ds_read_b64_tr_b16 v[62:63], v87 offset:21504
    s_waitcnt lgkmcnt(0)
    ds_write_b128 v5, v[56:59] offset:0
    ds_write_b128 v5, v[60:63] offset:1024
    s_branch L_lw_85
L_lw_85_2:
    ds_read_b64_tr_b16 a[16:17], v84 offset:20480
    ds_read_b64_tr_b16 a[18:19], v84 offset:21504
    ds_read_b64_tr_b16 a[20:21], v86 offset:20480
    ds_read_b64_tr_b16 a[22:23], v86 offset:21504
    ds_read_b64_tr_b16 a[24:25], v85 offset:20480
    ds_read_b64_tr_b16 a[26:27], v85 offset:21504
    ds_read_b64_tr_b16 a[28:29], v87 offset:20480
    ds_read_b64_tr_b16 a[30:31], v87 offset:21504
L_lw_85:
    s_waitcnt lgkmcnt(0)
    s_waitcnt vmcnt(4)
    s_barrier
    v_mov_b32 v46, 0
    buffer_load_dwordx2 v[44:45], v46, s[16:19], 0 offen sc1
    s_lshl_b32 s45, s43, 7
    s_add_u32 s45, s45, 0x10014
    buffer_load_dwordx2 v[40:41], v46, s[12:15], s45 offen sc1
    s_cmp_lg_u32 s44, 0
    s_cbranch_scc1 L_lw_86_0
    ds_read_b64_tr_b16 a[144:145], v80 offset:0
    ds_read_b64_tr_b16 a[146:147], v80 offset:1024
    ds_read_b64_tr_b16 a[148:149], v80 offset:8192
    ds_read_b64_tr_b16 a[150:151], v80 offset:9216
    ds_read_b64_tr_b16 v[56:57], v81 offset:0
    ds_read_b64_tr_b16 v[58:59], v81 offset:1024
    ds_read_b64_tr_b16 v[60:61], v81 offset:8192
    ds_read_b64_tr_b16 v[62:63], v81 offset:9216
    s_waitcnt lgkmcnt(0)
    ds_write_b128 v5, v[56:59] offset:4096
    ds_write_b128 v5, v[60:63] offset:5120
    s_branch L_lw_86
L_lw_86_0:
    s_cmp_lg_u32 s44, 1
    s_cbranch_scc1 L_lw_86_1
    ds_read_b64_tr_b16 a[104:105], v80 offset:0
    ds_read_b64_tr_b16 a[106:107], v80 offset:1024
    ds_read_b64_tr_b16 a[108:109], v80 offset:8192
    ds_read_b64_tr_b16 a[110:111], v80 offset:9216
    ds_read_b64_tr_b16 v[56:57], v81 offset:0
    ds_read_b64_tr_b16 v[58:59], v81 offset:1024
    ds_read_b64_tr_b16 v[60:61], v81 offset:8192
    ds_read_b64_tr_b16 v[62:63], v81 offset:9216
    s_waitcnt lgkmcnt(0)
    ds_write_b128 v5, v[56:59] offset:6144
    ds_write_b128 v5, v[60:63] offset:7168
    s_branch L_lw_86
L_lw_86_1:
    s_cmp_lg_u32 s44, 2
    s_cbranch_scc1 L_lw_86_2
    ds_read_b64_tr_b16 a[64:65], v80 offset:0
    ds_read_b64_tr_b16 a[66:67], v80 offset:1024
    ds_read_b64_tr_b16 a[68:69], v80 offset:8192
    ds_read_b64_tr_b16 a[70:71], v80 offset:9216
    ds_read_b64_tr_b16 v[56:57], v81 offset:0
    ds_read_b64_tr_b16 v[58:59], v81 offset:1024
    ds_read_b64_tr_b16 v[60:61], v81 offset:8192
    ds_read_b64_tr_b16 v[62:63], v81 offset:9216
    s_waitcnt lgkmcnt(0)
    ds_write_b128 v5, v[56:59] offset:8192
    ds_write_b128 v5, v[60:63] offset:9216
    s_branch L_lw_86
L_lw_86_2:
    ds_read_b64_tr_b16 a[32:33], v80 offset:0
    ds_read_b64_tr_b16 a[34:35], v80 offset:1024
    ds_read_b64_tr_b16 a[36:37], v80 offset:8192
    ds_read_b64_tr_b16 a[38:39], v80 offset:9216
    ds_read_b64_tr_b16 v[56:57], v81 offset:0
    ds_read_b64_tr_b16 v[58:59], v81 offset:1024
    ds_read_b64_tr_b16 v[60:61], v81 offset:8192
    ds_read_b64_tr_b16 v[62:63], v81 offset:9216
    s_waitcnt lgkmcnt(0)
    ds_write_b128 v5, v[56:59] offset:2048
    ds_write_b128 v5, v[60:63] offset:3072
L_lw_86:
    s_waitcnt lgkmcnt(0)
    s_waitcnt vmcnt(0)
    s_barrier
    s_cmp_lg_u32 s44, 0
    s_cbranch_scc1 L_lw_87_0
    ds_read_b64_tr_b16 a[152:153], v80 offset:16384
    ds_read_b64_tr_b16 a[154:155], v80 offset:17408
    ds_read_b64_tr_b16 a[156:157], v80 offset:24576
    ds_read_b64_tr_b16 a[158:159], v80 offset:25600
    ds_read_b64_tr_b16 v[56:57], v81 offset:16384
    ds_read_b64_tr_b16 v[58:59], v81 offset:17408
    ds_read_b64_tr_b16 v[60:61], v81 offset:24576
    ds_read_b64_tr_b16 v[62:63], v81 offset:25600
    s_waitcnt lgkmcnt(0)
    ds_write_b128 v5, v[56:59] offset:12288
    ds_write_b128 v5, v[60:63] offset:13312
    s_branch L_lw_87
L_lw_87_0:
    s_cmp_lg_u32 s44, 1
    s_cbranch_scc1 L_lw_87_1
    ds_read_b64_tr_b16 a[112:113], v80 offset:16384
    ds_read_b64_tr_b16 a[114:115], v80 offset:17408
    ds_read_b64_tr_b16 a[116:117], v80 offset:24576
    ds_read_b64_tr_b16 a[118:119], v80 offset:25600
    ds_read_b64_tr_b16 v[56:57], v81 offset:16384
    ds_read_b64_tr_b16 v[58:59], v81 offset:17408
    ds_read_b64_tr_b16 v[60:61], v81 offset:24576
    ds_read_b64_tr_b16 v[62:63], v81 offset:25600
    s_waitcnt lgkmcnt(0)
    ds_write_b128 v5, v[56:59] offset:14336
    ds_write_b128 v5, v[60:63] offset:15360
    s_branch L_lw_87
L_lw_87_1:
    s_cmp_lg_u32 s44, 2
    s_cbranch_scc1 L_lw_87_2
    ds_read_b64_tr_b16 a[72:73], v80 offset:16384
    ds_read_b64_tr_b16 a[74:75], v80 offset:17408
    ds_read_b64_tr_b16 a[76:77], v80 offset:24576
    ds_read_b64_tr_b16 a[78:79], v80 offset:25600
    ds_read_b64_tr_b16 v[56:57], v81 offset:16384
    ds_read_b64_tr_b16 v[58:59], v81 offset:17408
    ds_read_b64_tr_b16 v[60:61], v81 offset:24576
    ds_read_b64_tr_b16 v[62:63], v81 offset:25600
    s_waitcnt lgkmcnt(0)
    ds_write_b128 v5, v[56:59] offset:16384
    ds_write_b128 v5, v[60:63] offset:17408
    s_branch L_lw_87
L_lw_87_2:
    ds_read_b64_tr_b16 a[40:41], v80 offset:16384
    ds_read_b64_tr_b16 a[42:43], v80 offset:17408
    ds_read_b64_tr_b16 a[44:45], v80 offset:24576
    ds_read_b64_tr_b16 a[46:47], v80 offset:25600
    ds_read_b64_tr_b16 v[56:57], v81 offset:16384
    ds_read_b64_tr_b16 v[58:59], v81 offset:17408
    ds_read_b64_tr_b16 v[60:61], v81 offset:24576
    ds_read_b64_tr_b16 v[62:63], v81 offset:25600
    s_waitcnt lgkmcnt(0)
    ds_write_b128 v5, v[56:59] offset:10240
    ds_write_b128 v5, v[60:63] offset:11264
L_lw_87:
    s_waitcnt lgkmcnt(0)
    s_barrier
    ds_write_b128 v5, v[24:27] offset:18432
    ds_write_b128 v5, v[28:31] offset:19456
    ds_write_b128 v5, v[32:35] offset:20480
    ds_write_b128 v5, v[36:39] offset:21504
    ds_write_b128 v5, v[48:51] offset:22528
    ds_write_b128 v5, v[52:55] offset:23552
    s_waitcnt lgkmcnt(0)
    v_lshlrev_b32 v68, 3, v1
    s_mul_i32 s45, s44, 3072
    s_add_u32 s45, s45, 53248
    v_add_u32 v6, s45, v68
    s_sub_u32 s45, s44, 1
    s_and_b32 s45, s45, 3
    s_mul_i32 s45, s45, 3072
    s_add_u32 s45, s45, 53248
    v_add_u32 v7, s45, v68
    s_sub_u32 s45, s44, 2
    s_and_b32 s45, s45, 3
    s_mul_i32 s45, s45, 3072
    s_add_u32 s45, s45, 54272
    v_add_u32 v8, s45, v68
    s_sub_u32 s45, s44, 3
    s_and_b32 s45, s45, 3
    s_mul_i32 s45, s45, 3072
    s_add_u32 s45, s45, 55296
    v_add_u32 v18, s45, v68
    v_lshlrev_b32 v68, 4, v1
    s_add_u32 s45, s69, 0
    s_and_b32 s45, s45, 7
    s_lshl_b32 s45, s45, 10
    s_lshl_b32 s46, s44, 13
    s_add_u32 s45, s45, s46
    v_add_u32 v80, s45, v68
    s_add_u32 s45, s69, 1
    s_and_b32 s45, s45, 7
    s_lshl_b32 s45, s45, 10
    s_lshl_b32 s46, s44, 13
    s_add_u32 s45, s45, s46
    v_add_u32 v81, s45, v68
    s_add_u32 s45, s69, 2
    s_and_b32 s45, s45, 7
    s_lshl_b32 s45, s45, 10
    s_lshl_b32 s46, s44, 13
    s_add_u32 s45, s45, s46
    v_add_u32 v82, s45, v68
    s_add_u32 s45, s69, 3
    s_and_b32 s45, s45, 7
    s_lshl_b32 s45, s45, 10
    s_lshl_b32 s46, s44, 13
    s_add_u32 s45, s45, s46
    v_add_u32 v83, s45, v68
    s_add_u32 s45, s69, 4
    s_and_b32 s45, s45, 7
    s_lshl_b32 s45, s45, 10
    s_lshl_b32 s46, s44, 13
    s_add_u32 s45, s45, s46
    v_add_u32 v84, s45, v68
    s_add_u32 s45, s69, 5
    s_and_b32 s45, s45, 7
    s_lshl_b32 s45, s45, 10
    s_lshl_b32 s46, s44, 13
    s_add_u32 s45, s45, s46
    v_add_u32 v85, s45, v68
    s_add_u32 s45, s69, 6
    s_and_b32 s45, s45, 7
    s_lshl_b32 s45, s45, 10
    s_lshl_b32 s46, s44, 13
    s_add_u32 s45, s45, s46
    v_add_u32 v86, s45, v68
    s_add_u32 s45, s69, 7
    s_and_b32 s45, s45, 7
    s_lshl_b32 s45, s45, 10
    s_lshl_b32 s46, s44, 13
    s_add_u32 s45, s45, s46
    v_add_u32 v87, s45, v68
    s_lshl_b32 s45, s40, 4
    s_add_u32 s45, s45, s42
    s_lshl_b32 s45, s45, 8
    s_lshl_b32 s46, s44, 6
    s_add_u32 s45, s45, s46
    s_add_u32 s45, s45, 0x7080000
    v_and_b32 v13, 15, v1
    v_lshlrev_b32 v13, 2, v13
    v_add_u32 v13, s45, v13
    s_mov_b32 s66, 0x1800000
    v_mov_b32 v14, -1
    v_mov_b32 v15, -1
    s_mov_b32 s70, 0
    v_mov_b32 v41, 0
    s_branch L_hw_88_c
L_hw_88:
    buffer_load_dwordx2 v[44:45], v41, s[16:19], 0 offen sc1
    s_add_u32 s70, s70, 1
    s_cmp_ge_u32 s70, 0x100000
    s_cbranch_scc1 L_c_done_1
L_hw_88_c:
    s_waitcnt vmcnt(0)
    v_readfirstlane_b32 s45, v44
    v_readfirstlane_b32 s46, v45
    s_nop 3
    s_lshr_b32 s47, s46, 24
    s_cmp_lg_u32 s47, 64
    s_cbranch_scc1 L_hw_88
    s_lshr_b32 s68, s45, 24
    s_and_b32 s47, s45, 511
    s_mul_i32 s47, s47, s47
    s_bfe_u32 s45, s45, 0xf0009
    s_lshl_b32 s45, s45, 5
    s_sub_u32 s45, s45, s47
    s_and_b32 s47, s46, 511
    s_mul_i32 s47, s47, s47
    s_bfe_u32 s46, s46, 0xf0009
    s_lshl_b32 s46, s46, 5
    s_sub_u32 s46, s46, s47
    s_or_b32 s45, s45, s46
    s_cmp_eq_u32 s45, 0
    s_cselect_b32 s67, 1, 0
    s_mov_b32 s24, s12
    s_mov_b32 s25, s13
    s_mov_b32 s28, s12
    s_mov_b32 s29, s13
    s_cmp_eq_u32 s67, 1
    s_cselect_b32 s26, s14, 0
    s_cselect_b32 s30, 0, s14
    s_cmp_ge_u32 s68, 16
    s_cselect_b32 s68, 8192, 0
    s_mov_b32 s6, 0x11111111
    s_mov_b32 s7, 0xffaaa491
    s_mov_b32 s60, 0
    s_lshl_b32 s58, s40, 16
    s_add_u32 s58, s58, 0x7000000
    s_mov_b32 s61, s58
    s_lshl_b32 s59, s40, 17
    s_add_u32 s59, s59, 0x7040000
    s_mov_b32 s62, s59
    s_add_u32 s32, s41, 0
    s_and_b32 s32, s32, 3
    s_lshl_b32 s32, s32, 10
    s_add_u32 s33, s41, 1
    s_and_b32 s33, s33, 3
    s_lshl_b32 s33, s33, 10
    s_add_u32 s34, s41, 2
    s_and_b32 s34, s34, 3
    s_lshl_b32 s34, s34, 10
    s_add_u32 s35, s41, 3
    s_and_b32 s35, s35, 3
    s_lshl_b32 s35, s35, 10
    s_add_u32 s45, s61, 0
    buffer_load_dword v47, v12, s[12:15], s45 offen sc1
    s_add_u32 s45, s61, 16384
    buffer_load_dword v47, v12, s[12:15], s45 offen sc1
    s_add_u32 s45, s61, 32768
    buffer_load_dword v47, v12, s[12:15], s45 offen sc1
    s_add_u32 s45, s61, 49152
    buffer_load_dword v47, v12, s[12:15], s45 offen sc1
    s_mov_b32 s45, 0x7020000
    buffer_load_dword v47, v10, s[12:15], s45 offen sc1
    s_mov_b32 s45, 0x7030000
    buffer_load_dword v47, v10, s[12:15], s45 offen sc1
    buffer_load_dword v47, v20, s[12:15], 0 offen sc1
    s_add_u32 s63, s63, s68
    s_add_u32 s64, s64, s68
    s_lshl_b32 s36, s40, 12
    s_add_u32 s36, s36, 0x5000
    ds_read_b128 v[56:59], v5 offset:2048
    ds_read_b128 v[60:63], v5 offset:3072
    ds_read_b128 v[64:67], v5 offset:10240
    ds_read_b128 v[68:71], v5 offset:11264
    ds_read_b128 v[72:75], v5 offset:22528
    ds_read_b128 v[76:79], v5 offset:23552
    ds_read_b128 v[88:91], v5 offset:0
    ds_read_b128 v[92:95], v5 offset:1024
    ds_read_b128 v[32:35], v5 offset:8192
    ds_read_b128 v[36:39], v5 offset:9216
L_v_loop_89:
    s_add_u32 s8, s61, s32
    s_add_u32 s9, s61, s33
    s_add_u32 s10, s61, s34
    s_add_u32 s11, s61, s35
    v_mov_b32 v24, 0
    v_mov_b32 v25, 0
    v_mov_b32 v26, 0
    v_mov_b32 v27, 0
    v_mov_b32 v28, 0
    v_mov_b32 v29, 0
    v_mov_b32 v30, 0
    v_mov_b32 v31, 0
    s_and_b32 s37, s60, 1
    s_lshl_b32 s37, s37, 16
    s_add_u32 s37, s37, 0x7020000
    s_xor_b32 s38, s37, 65536
    s_add_u32 s39, s60, 3
    s_and_b32 s39, s39, 3
    s_lshl_b32 s39, s39, 14
    s_add_u32 s39, s39, s58
    s_nop 15
    s_waitcnt lgkmcnt(0)
    buffer_load_dwordx4 v[40:43], v3, s[12:15], s8 offen sc1
    s_nop 4
    buffer_load_dwordx4 v[44:47], v3, s[12:15], s9 offen sc1
    s_nop 4
    buffer_load_dwordx4 v[48:51], v3, s[12:15], s10 offen sc1
    s_nop 4
    buffer_load_dwordx4 v[52:55], v3, s[12:15], s11 offen sc1
    s_mov_b32 s70, 0
    s_waitcnt vmcnt(3)
    v_max3_u32 v22, v40, v41, v42
    ds_write_b128 v3, v[40:43] offset:0
    v_max_u32 v22, v22, v43
    v_cmp_eq_u32 vcc, -1, v22
    s_nop 0
    s_nop 0
    s_cbranch_vccnz L_mg_90_r0
L_mg_90_c0:
    v_smfmac_f32_16x16x64_bf16 v[24:27], v[40:43], a[0:7], v2
    s_waitcnt vmcnt(2)
    v_max3_u32 v22, v44, v45, v46
    ds_write_b128 v3, v[44:47] offset:1024
    v_max_u32 v22, v22, v47
    v_cmp_eq_u32 vcc, -1, v22
    v_smfmac_f32_16x16x64_bf16 v[28:31], v[40:43], a[8:15], v2
    s_nop 0
    s_cbranch_vccnz L_mg_90_r1
L_mg_90_c1:
    v_smfmac_f32_16x16x64_bf16 v[24:27], v[44:47], a[16:23], v2
    s_waitcnt vmcnt(1)
    v_max3_u32 v22, v48, v49, v50
    ds_write_b128 v3, v[48:51] offset:2048
    v_max_u32 v22, v22, v51
    v_cmp_eq_u32 vcc, -1, v22
    v_smfmac_f32_16x16x64_bf16 v[28:31], v[44:47], a[24:31], v2
    s_nop 0
    s_cbranch_vccnz L_mg_90_r2
L_mg_90_c2:
    s_waitcnt vmcnt(0)
    v_max3_u32 v22, v52, v53, v54
    ds_write_b128 v3, v[52:55] offset:3072
    v_max_u32 v22, v22, v55
    v_cmp_eq_u32 vcc, -1, v22
    s_waitcnt lgkmcnt(0)
    s_nop 0
    s_cbranch_vccnz L_mg_90_r3
L_mg_90_c3:
    s_barrier
    ds_read_b128 v[40:43], v4 offset:0
    ds_read_b128 v[44:47], v4 offset:1024
    v_smfmac_f32_16x16x64_bf16 v[24:27], v[48:51], a[32:39], v2
    v_smfmac_f32_16x16x64_bf16 v[28:31], v[48:51], v[56:63], v2
    ds_read_b128 v[48:51], v4 offset:2048
    v_smfmac_f32_16x16x64_bf16 v[24:27], v[52:55], a[40:47], v2
    ds_read_b128 v[56:59], v5 offset:16384
    v_smfmac_f32_16x16x64_bf16 v[28:31], v[52:55], v[64:71], v2
    ds_read_b128 v[52:55], v4 offset:3072
    s_waitcnt lgkmcnt(3)
    v_smfmac_f32_16x16x64_bf16 v[24:27], v[40:43], a[48:55], v2
    ds_read_b128 v[60:63], v5 offset:17408
    v_smfmac_f32_16x16x64_bf16 v[28:31], v[40:43], v[72:79], v2
    ds_read_b128 v[40:43], v21 offset:0
    v_smfmac_f32_16x16x64_bf16 v[24:27], v[44:47], a[56:63], v2
    ds_read_b128 v[64:67], v5 offset:20480
    v_smfmac_f32_16x16x64_bf16 v[28:31], v[44:47], v[88:95], v2
    ds_read_b128 v[44:47], v21 offset:1024
    ds_read_b128 v[68:71], v5 offset:21504
    s_waitcnt lgkmcnt(5)
    v_smfmac_f32_16x16x64_bf16 v[24:27], v[48:51], a[64:71], v2
    ds_read_b128 v[72:75], v5 offset:6144
    v_smfmac_f32_16x16x64_bf16 v[28:31], v[48:51], v[32:39], v2
    ds_read_b128 v[48:51], v21 offset:2048
    ds_read_b128 v[76:79], v5 offset:7168
    v_smfmac_f32_16x16x64_bf16 v[24:27], v[52:55], a[72:79], v2
    ds_read_b128 v[88:91], v5 offset:14336
    s_waitcnt lgkmcnt(6)
    v_smfmac_f32_16x16x64_bf16 v[28:31], v[52:55], v[56:63], v2
    ds_read_b128 v[52:55], v21 offset:3072
    ds_read_b128 v[92:95], v5 offset:15360
    v_smfmac_f32_16x16x64_bf16 v[24:27], v[40:43], a[80:87], v2
    ds_read_b128 v[32:35], v5 offset:18432
    s_waitcnt lgkmcnt(6)
    v_smfmac_f32_16x16x64_bf16 v[28:31], v[40:43], v[64:71], v2
    ds_read_b128 v[40:43], v23 offset:0
    ds_read_b128 v[36:39], v5 offset:19456
    v_smfmac_f32_16x16x64_bf16 v[24:27], v[44:47], a[88:95], v2
    ds_read_b128 v[56:59], v5 offset:4096
    v_smfmac_f32_16x16x64_bf16 v[28:31], v[44:47], a[96:103], v2
    ds_read_b128 v[44:47], v23 offset:1024
    s_waitcnt lgkmcnt(5)
    v_smfmac_f32_16x16x64_bf16 v[24:27], v[48:51], a[104:111], v2
    ds_read_b128 v[60:63], v5 offset:5120
    v_smfmac_f32_16x16x64_bf16 v[28:31], v[48:51], v[72:79], v2
    ds_read_b128 v[48:51], v23 offset:2048
    v_smfmac_f32_16x16x64_bf16 v[24:27], v[52:55], a[112:119], v2
    ds_read_b128 v[64:67], v5 offset:12288
    v_smfmac_f32_16x16x64_bf16 v[28:31], v[52:55], v[88:95], v2
    ds_read_b128 v[52:55], v23 offset:3072
    s_waitcnt lgkmcnt(4)
    v_smfmac_f32_16x16x64_bf16 v[24:27], v[40:43], a[120:127], v2
    ds_read_b128 v[68:71], v5 offset:13312
    v_smfmac_f32_16x16x64_bf16 v[28:31], v[40:43], v[32:39], v2
    v_smfmac_f32_16x16x64_bf16 v[24:27], v[44:47], a[128:135], v2
    v_smfmac_f32_16x16x64_bf16 v[28:31], v[44:47], a[136:143], v2
    s_waitcnt lgkmcnt(1)
    v_smfmac_f32_16x16x64_bf16 v[24:27], v[48:51], a[144:151], v2
    v_smfmac_f32_16x16x64_bf16 v[28:31], v[48:51], v[56:63], v2
    v_smfmac_f32_16x16x64_bf16 v[24:27], v[52:55], a[152:159], v2
    s_waitcnt lgkmcnt(0)
    v_smfmac_f32_16x16x64_bf16 v[28:31], v[52:55], v[64:71], v2
    s_nop 5
    v_permlane32_swap_b32 v24, v26
    v_permlane32_swap_b32 v25, v27
    v_permlane32_swap_b32 v28, v30
    v_permlane32_swap_b32 v29, v31
    v_pk_add_f32 v[24:25], v[24:25], v[26:27]
    v_pk_add_f32 v[28:29], v[28:29], v[30:31]
    v_cvt_pk_bf16_f32 v16, v24, v25
    v_cvt_pk_bf16_f32 v17, v28, v29
    buffer_store_dwordx2 v[16:17], v10, s[24:27], s37 offen
    buffer_store_dwordx2 v[14:15], v10, s[24:27], s38 offen
    buffer_store_dword v14, v12, s[24:27], s39 offen
    buffer_store_dwordx2 v[16:17], v10, s[28:31], s37 offen sc1
    buffer_store_dwordx2 v[14:15], v10, s[28:31], s38 offen sc1
    buffer_store_dword v14, v12, s[28:31], s39 offen sc1
    s_barrier
    s_cmp_eq_u32 s60, 63
    s_cbranch_scc1 L_v_fin_91
    s_and_b32 s65, s60, 1
    s_lshl_b32 s65, s65, 12
    s_and_b32 s45, s60, 2
    s_lshl_b32 s45, s45, 13
    s_add_u32 s65, s65, s45
    s_xor_b32 s45, s65, 16384
    s_add_u32 s45, s45, s63
    buffer_store_dwordx2 v[14:15], v11, s[12:15], s45 offen sc1
    s_add_u32 s48, s63, s65
    s_add_u32 s49, s64, s65
    v_mov_b32 v24, 0
    v_mov_b32 v25, 0
    v_mov_b32 v26, 0
    v_mov_b32 v27, 0
    v_mov_b32 v28, 0
    v_mov_b32 v29, 0
    v_mov_b32 v30, 0
    v_mov_b32 v31, 0
    v_mov_b32 v32, 0
    v_mov_b32 v33, 0
    v_mov_b32 v34, 0
    v_mov_b32 v35, 0
    v_mov_b32 v36, 0
    v_mov_b32 v37, 0
    v_mov_b32 v38, 0
    v_mov_b32 v39, 0
    s_sleep 4
    s_waitcnt vmcnt(0)
    s_mov_b64 exec, 65535
    buffer_load_dword v40, v13, s[12:15], 0 offen sc1
    s_nop 15
    buffer_load_dword v41, v13, s[12:15], 0 offen sc1
    s_nop 15
    buffer_load_dword v42, v13, s[12:15], 0 offen sc1
    s_nop 15
    buffer_load_dword v43, v13, s[12:15], 0 offen sc1
    s_mov_b32 s70, 0
L_pp_92:
    s_waitcnt vmcnt(3)
    v_cmp_ge_u32 vcc, s60, v40
    s_nop 1
    s_cbranch_vccz L_ppd_93
    buffer_load_dword v40, v13, s[12:15], 0 offen sc1
    s_waitcnt vmcnt(3)
    v_cmp_ge_u32 vcc, s60, v41
    s_nop 1
    s_cbranch_vccz L_ppd_93
    buffer_load_dword v41, v13, s[12:15], 0 offen sc1
    s_waitcnt vmcnt(3)
    v_cmp_ge_u32 vcc, s60, v42
    s_nop 1
    s_cbranch_vccz L_ppd_93
    buffer_load_dword v42, v13, s[12:15], 0 offen sc1
    s_waitcnt vmcnt(3)
    v_cmp_ge_u32 vcc, s60, v43
    s_nop 1
    s_cbranch_vccz L_ppd_93
    buffer_load_dword v43, v13, s[12:15], 0 offen sc1
    s_add_u32 s70, s70, 1
    s_cmp_lt_u32 s70, 0x100000
    s_cbranch_scc1 L_pp_92
    s_branch L_c_done_1
.p2align 5
    s_nop 0
    s_nop 0
    s_nop 0
    s_nop 0
    s_nop 0
    s_nop 0
    s_nop 0
L_ppd_93:
    s_mov_b64 exec, -1
    s_nop 3
    s_mov_b32 s70, 0
    buffer_load_dwordx4 v[40:43], v80, s[12:15], s62 offen sc1
    s_nop 7
    buffer_load_dwordx4 v[44:47], v81, s[12:15], s62 offen sc1
    s_nop 7
    buffer_load_dwordx4 v[48:51], v82, s[12:15], s62 offen sc1
    s_nop 7
    buffer_load_dwordx4 v[52:55], v83, s[12:15], s62 offen sc1
    s_nop 7
    buffer_load_dwordx4 v[56:59], v84, s[12:15], s62 offen sc1
    s_nop 7
    buffer_load_dwordx4 v[60:63], v85, s[12:15], s62 offen sc1
    s_waitcnt vmcnt(5)
    v_cmp_eq_u32 vcc, -1, v43
    s_nop 1
    s_cbranch_vccnz L_v_og_94_r0
L_v_og_94_c0:
    v_smfmac_f32_16x16x64_bf16 v[24:27], v[40:43], a[160:167], v2
    buffer_load_dwordx4 v[64:67], v86, s[12:15], s62 offen sc1
    v_smfmac_f32_16x16x64_bf16 v[28:31], v[40:43], a[168:175], v2
    s_waitcnt vmcnt(5)
    v_cmp_eq_u32 vcc, -1, v47
    v_smfmac_f32_16x16x64_bf16 v[32:35], v[40:43], a[176:183], v2
    v_smfmac_f32_16x16x64_bf16 v[36:39], v[40:43], a[184:191], v2
    s_cbranch_vccnz L_v_og_94_r1
L_v_og_94_c1:
    v_smfmac_f32_16x16x64_bf16 v[24:27], v[44:47], a[192:199], v2
    buffer_load_dwordx4 v[68:71], v87, s[12:15], s62 offen sc1
    v_smfmac_f32_16x16x64_bf16 v[28:31], v[44:47], a[200:207], v2
    s_waitcnt vmcnt(5)
    v_cmp_eq_u32 vcc, -1, v51
    v_smfmac_f32_16x16x64_bf16 v[32:35], v[44:47], a[208:215], v2
    v_smfmac_f32_16x16x64_bf16 v[36:39], v[44:47], a[216:223], v2
    s_cbranch_vccnz L_v_og_94_r2
L_v_og_94_c2:
    v_smfmac_f32_16x16x64_bf16 v[24:27], v[48:51], a[224:231], v2
    s_waitcnt vmcnt(4)
    v_cmp_eq_u32 vcc, -1, v55
    v_smfmac_f32_16x16x64_bf16 v[28:31], v[48:51], a[232:239], v2
    v_smfmac_f32_16x16x64_bf16 v[32:35], v[48:51], a[240:247], v2
    s_cbranch_vccnz L_v_og_94_r3
L_v_og_94_c3:
    v_smfmac_f32_16x16x64_bf16 v[24:27], v[52:55], v[96:103], v2
    s_add_u32 s46, s60, 1
    s_and_b32 s45, s46, 3
    v_smfmac_f32_16x16x64_bf16 v[28:31], v[52:55], v[104:111], v2
    s_waitcnt vmcnt(3)
    v_cmp_eq_u32 vcc, -1, v59
    v_smfmac_f32_16x16x64_bf16 v[32:35], v[52:55], v[112:119], v2
    v_smfmac_f32_16x16x64_bf16 v[36:39], v[52:55], v[120:127], v2
    s_cbranch_vccnz L_v_og_94_r4
L_v_og_94_c4:
    v_smfmac_f32_16x16x64_bf16 v[24:27], v[56:59], v[128:135], v2
    s_waitcnt vmcnt(2)
    v_cmp_eq_u32 vcc, -1, v63
    v_smfmac_f32_16x16x64_bf16 v[28:31], v[56:59], v[136:143], v2
    v_smfmac_f32_16x16x64_bf16 v[32:35], v[56:59], v[144:151], v2
    s_cbranch_vccnz L_v_og_94_r5
L_v_og_94_c5:
    v_smfmac_f32_16x16x64_bf16 v[24:27], v[60:63], v[160:167], v2
    s_mov_b32 s60, s46
    s_lshl_b32 s46, s45, 14
    v_smfmac_f32_16x16x64_bf16 v[28:31], v[60:63], v[168:175], v2
    s_waitcnt vmcnt(1)
    v_cmp_eq_u32 vcc, -1, v67
    v_smfmac_f32_16x16x64_bf16 v[32:35], v[60:63], v[176:183], v2
    v_smfmac_f32_16x16x64_bf16 v[36:39], v[60:63], v[184:191], v2
    s_cbranch_vccnz L_v_og_94_r6
L_v_og_94_c6:
    v_smfmac_f32_16x16x64_bf16 v[24:27], v[64:67], v[192:199], v2
    s_add_u32 s61, s58, s46
    v_smfmac_f32_16x16x64_bf16 v[28:31], v[64:67], v[200:207], v2
    v_smfmac_f32_16x16x64_bf16 v[32:35], v[64:67], v[208:215], v2
    s_waitcnt vmcnt(0)
    v_cmp_eq_u32 vcc, -1, v71
    v_smfmac_f32_16x16x64_bf16 v[36:39], v[64:67], v[216:223], v2
    s_nop 0
    s_cbranch_vccnz L_v_og_94_r7
L_v_og_94_c7:
    v_smfmac_f32_16x16x64_bf16 v[24:27], v[68:71], v[224:231], v2
    s_lshl_b32 s46, s45, 15
    s_add_u32 s62, s59, s46
    v_smfmac_f32_16x16x64_bf16 v[28:31], v[68:71], v[232:239], v2
    s_nop 0
    s_nop 0
    v_smfmac_f32_16x16x64_bf16 v[32:35], v[68:71], v[240:247], v2
    s_nop 0
    s_nop 0
    v_permlane32_swap_b32 v24, v26
    v_permlane32_swap_b32 v25, v27
    v_pk_add_f32 v[24:25], v[24:25], v[26:27]
    v_smfmac_f32_16x16x64_bf16 v[36:39], v[48:51], a[248:255], v2
    ds_write_b64 v6, v[24:25] offset:0
    v_permlane32_swap_b32 v28, v30
    v_permlane32_swap_b32 v29, v31
    v_pk_add_f32 v[28:29], v[28:29], v[30:31]
    v_smfmac_f32_16x16x64_bf16 v[36:39], v[56:59], v[152:159], v2
    ds_write_b64 v6, v[28:29] offset:1024
    v_permlane32_swap_b32 v32, v34
    v_permlane32_swap_b32 v33, v35
    v_pk_add_f32 v[32:33], v[32:33], v[34:35]
    v_smfmac_f32_16x16x64_bf16 v[36:39], v[68:71], v[248:255], v2
    ds_write_b64 v6, v[32:33] offset:2048
    v_mov_b32 v19, s60
    s_nop 5
    v_permlane32_swap_b32 v36, v38
    v_permlane32_swap_b32 v37, v39
    v_pk_add_f32 v[36:37], v[36:37], v[38:39]
    s_waitcnt lgkmcnt(0)
    s_barrier
    ds_read_b64 v[40:41], v7
    ds_read_b64 v[42:43], v8
    ds_read_b64 v[44:45], v18
    s_waitcnt lgkmcnt(2)
    v_pk_add_f32 v[36:37], v[36:37], v[40:41]
    s_waitcnt lgkmcnt(0)
    v_pk_add_f32 v[42:43], v[42:43], v[44:45]
    v_pk_add_f32 v[24:25], v[36:37], v[42:43]
    buffer_store_dwordx2 v[24:25], v11, s[12:15], s48 offen sc1
    ds_read_b128 v[56:59], v5 offset:2048
    ds_read_b128 v[60:63], v5 offset:3072
    ds_read_b128 v[64:67], v5 offset:10240
    ds_read_b128 v[68:71], v5 offset:11264
    ds_read_b128 v[72:75], v5 offset:22528
    ds_read_b128 v[76:79], v5 offset:23552
    ds_read_b128 v[88:91], v5 offset:0
    ds_read_b128 v[92:95], v5 offset:1024
    ds_read_b128 v[32:35], v5 offset:8192
    ds_read_b128 v[36:39], v5 offset:9216
    s_sleep 4
    buffer_load_dwordx2 v[40:41], v11, s[12:15], s49 offen sc1
    s_mov_b32 s70, 0
L_v_xp_95:
    s_waitcnt vmcnt(0)
    v_max_u32 v22, v40, v41
    v_cmp_eq_u32 vcc, -1, v22
    v_pk_add_f32 v[28:29], v[24:25], v[40:41]
    v_cvt_pk_bf16_f32 v28, v28, v29
    s_cbranch_vccnz L_v_xp_95_r
L_v_xp_95_ok:
    buffer_store_dword v19, v20, s[24:27], 0 offen
    v_mov_b32_dpp v29, v28 quad_perm:[1,0,3,2] row_mask:0xf bank_mask:0xf
    v_perm_b32 v28, v28, v29, v9
    buffer_store_dword v28, v12, s[24:27], s61 offen
    buffer_store_dword v28, v12, s[28:31], s61 offen sc1
    buffer_store_dword v19, v20, s[28:31], 0 offen sc1
    s_add_u32 s66, s66, 65536
    s_branch L_v_loop_89
L_v_fin_91:
    buffer_store_dwordx2 v[16:17], v10, s[12:15], s66 offen sc1
    s_waitcnt vmcnt(0)
    v_mov_b32 v22, 64
    v_mov_b32 v0, 0
    s_mov_b64 exec, 1
    buffer_store_dword v22, v0, s[12:15], s3 offen sc1
    s_mov_b64 exec, -1
L_c_done_1:
    s_endpgm
L_v_og_94_r0:
    buffer_load_dwordx4 v[40:43], v80, s[12:15], s62 offen sc1
    buffer_load_dwordx4 v[44:47], v81, s[12:15], s62 offen sc1
    buffer_load_dwordx4 v[48:51], v82, s[12:15], s62 offen sc1
    buffer_load_dwordx4 v[52:55], v83, s[12:15], s62 offen sc1
    buffer_load_dwordx4 v[56:59], v84, s[12:15], s62 offen sc1
    buffer_load_dwordx4 v[60:63], v85, s[12:15], s62 offen sc1
    s_add_u32 s70, s70, 1
    s_cmp_ge_u32 s70, 0x100000
    s_cbranch_scc1 L_c_done_1
    s_waitcnt vmcnt(5)
    v_cmp_eq_u32 vcc, -1, v43
    s_nop 1
    s_cbranch_vccnz L_v_og_94_r0
    s_branch L_v_og_94_c0
L_v_og_94_r1:
    buffer_load_dwordx4 v[44:47], v81, s[12:15], s62 offen sc1
    buffer_load_dwordx4 v[48:51], v82, s[12:15], s62 offen sc1
    buffer_load_dwordx4 v[52:55], v83, s[12:15], s62 offen sc1
    buffer_load_dwordx4 v[56:59], v84, s[12:15], s62 offen sc1
    buffer_load_dwordx4 v[60:63], v85, s[12:15], s62 offen sc1
    buffer_load_dwordx4 v[64:67], v86, s[12:15], s62 offen sc1
    s_add_u32 s70, s70, 1
    s_cmp_ge_u32 s70, 0x100000
    s_cbranch_scc1 L_c_done_1
    s_waitcnt vmcnt(5)
    v_cmp_eq_u32 vcc, -1, v47
    s_nop 1
    s_cbranch_vccnz L_v_og_94_r1
    s_branch L_v_og_94_c1
L_v_og_94_r2:
    buffer_load_dwordx4 v[48:51], v82, s[12:15], s62 offen sc1
    buffer_load_dwordx4 v[52:55], v83, s[12:15], s62 offen sc1
    buffer_load_dwordx4 v[56:59], v84, s[12:15], s62 offen sc1
    buffer_load_dwordx4 v[60:63], v85, s[12:15], s62 offen sc1
    buffer_load_dwordx4 v[64:67], v86, s[12:15], s62 offen sc1
    buffer_load_dwordx4 v[68:71], v87, s[12:15], s62 offen sc1
    s_add_u32 s70, s70, 1
    s_cmp_ge_u32 s70, 0x100000
    s_cbranch_scc1 L_c_done_1
    s_waitcnt vmcnt(5)
    v_cmp_eq_u32 vcc, -1, v51
    s_nop 1
    s_cbranch_vccnz L_v_og_94_r2
    s_branch L_v_og_94_c2
L_v_og_94_r3:
    buffer_load_dwordx4 v[52:55], v83, s[12:15], s62 offen sc1
    buffer_load_dwordx4 v[56:59], v84, s[12:15], s62 offen sc1
    buffer_load_dwordx4 v[60:63], v85, s[12:15], s62 offen sc1
    buffer_load_dwordx4 v[64:67], v86, s[12:15], s62 offen sc1
    buffer_load_dwordx4 v[68:71], v87, s[12:15], s62 offen sc1
    s_add_u32 s70, s70, 1
    s_cmp_ge_u32 s70, 0x100000
    s_cbranch_scc1 L_c_done_1
    s_waitcnt vmcnt(4)
    v_cmp_eq_u32 vcc, -1, v55
    s_nop 1
    s_cbranch_vccnz L_v_og_94_r3
    s_branch L_v_og_94_c3
L_v_og_94_r4:
    buffer_load_dwordx4 v[56:59], v84, s[12:15], s62 offen sc1
    buffer_load_dwordx4 v[60:63], v85, s[12:15], s62 offen sc1
    buffer_load_dwordx4 v[64:67], v86, s[12:15], s62 offen sc1
    buffer_load_dwordx4 v[68:71], v87, s[12:15], s62 offen sc1
    s_add_u32 s70, s70, 1
    s_cmp_ge_u32 s70, 0x100000
    s_cbranch_scc1 L_c_done_1
    s_waitcnt vmcnt(3)
    v_cmp_eq_u32 vcc, -1, v59
    s_nop 1
    s_cbranch_vccnz L_v_og_94_r4
    s_branch L_v_og_94_c4
L_v_og_94_r5:
    buffer_load_dwordx4 v[60:63], v85, s[12:15], s62 offen sc1
    buffer_load_dwordx4 v[64:67], v86, s[12:15], s62 offen sc1
    buffer_load_dwordx4 v[68:71], v87, s[12:15], s62 offen sc1
    s_add_u32 s70, s70, 1
    s_cmp_ge_u32 s70, 0x100000
    s_cbranch_scc1 L_c_done_1
    s_waitcnt vmcnt(2)
    v_cmp_eq_u32 vcc, -1, v63
    s_nop 1
    s_cbranch_vccnz L_v_og_94_r5
    s_branch L_v_og_94_c5
L_v_og_94_r6:
    buffer_load_dwordx4 v[64:67], v86, s[12:15], s62 offen sc1
    buffer_load_dwordx4 v[68:71], v87, s[12:15], s62 offen sc1
    s_add_u32 s70, s70, 1
    s_cmp_ge_u32 s70, 0x100000
    s_cbranch_scc1 L_c_done_1
    s_waitcnt vmcnt(1)
    v_cmp_eq_u32 vcc, -1, v67
    s_nop 1
    s_cbranch_vccnz L_v_og_94_r6
    s_branch L_v_og_94_c6
L_v_og_94_r7:
    buffer_load_dwordx4 v[68:71], v87, s[12:15], s62 offen sc1
    s_add_u32 s70, s70, 1
    s_cmp_ge_u32 s70, 0x100000
    s_cbranch_scc1 L_c_done_1
    s_waitcnt vmcnt(0)
    v_cmp_eq_u32 vcc, -1, v71
    s_nop 1
    s_cbranch_vccnz L_v_og_94_r7
    s_branch L_v_og_94_c7
L_mg_90_r0:
    buffer_load_dwordx4 v[40:43], v3, s[12:15], s8 offen sc1
    buffer_load_dwordx4 v[44:47], v3, s[12:15], s9 offen sc1
    buffer_load_dwordx4 v[48:51], v3, s[12:15], s10 offen sc1
    buffer_load_dwordx4 v[52:55], v3, s[12:15], s11 offen sc1
    s_add_u32 s70, s70, 1
    s_cmp_ge_u32 s70, 0x100000
    s_cbranch_scc1 L_c_done_1
    s_waitcnt vmcnt(3)
    ds_write_b128 v3, v[40:43] offset:0
    v_max3_u32 v22, v40, v41, v42
    v_max_u32 v22, v22, v43
    v_cmp_eq_u32 vcc, -1, v22
    s_waitcnt lgkmcnt(0)
    s_nop 0
    s_cbranch_vccnz L_mg_90_r0
    s_branch L_mg_90_c0
L_mg_90_r1:
    buffer_load_dwordx4 v[44:47], v3, s[12:15], s9 offen sc1
    buffer_load_dwordx4 v[48:51], v3, s[12:15], s10 offen sc1
    buffer_load_dwordx4 v[52:55], v3, s[12:15], s11 offen sc1
    s_add_u32 s70, s70, 1
    s_cmp_ge_u32 s70, 0x100000
    s_cbranch_scc1 L_c_done_1
    s_waitcnt vmcnt(2)
    ds_write_b128 v3, v[44:47] offset:1024
    v_max3_u32 v22, v44, v45, v46
    v_max_u32 v22, v22, v47
    v_cmp_eq_u32 vcc, -1, v22
    s_waitcnt lgkmcnt(0)
    s_nop 0
    s_cbranch_vccnz L_mg_90_r1
    s_branch L_mg_90_c1
L_mg_90_r2:
    buffer_load_dwordx4 v[48:51], v3, s[12:15], s10 offen sc1
    buffer_load_dwordx4 v[52:55], v3, s[12:15], s11 offen sc1
    s_add_u32 s70, s70, 1
    s_cmp_ge_u32 s70, 0x100000
    s_cbranch_scc1 L_c_done_1
    s_waitcnt vmcnt(1)
    ds_write_b128 v3, v[48:51] offset:2048
    v_max3_u32 v22, v48, v49, v50
    v_max_u32 v22, v22, v51
    v_cmp_eq_u32 vcc, -1, v22
    s_waitcnt lgkmcnt(0)
    s_nop 0
    s_cbranch_vccnz L_mg_90_r2
    s_branch L_mg_90_c2
L_mg_90_r3:
    buffer_load_dwordx4 v[52:55], v3, s[12:15], s11 offen sc1
    s_add_u32 s70, s70, 1
    s_cmp_ge_u32 s70, 0x100000
    s_cbranch_scc1 L_c_done_1
    s_waitcnt vmcnt(0)
    ds_write_b128 v3, v[52:55] offset:3072
    v_max3_u32 v22, v52, v53, v54
    v_max_u32 v22, v22, v55
    v_cmp_eq_u32 vcc, -1, v22
    s_waitcnt lgkmcnt(0)
    s_nop 0
    s_cbranch_vccnz L_mg_90_r3
    s_branch L_mg_90_c3
L_v_xp_95_r:
    buffer_load_dwordx2 v[40:41], v11, s[12:15], s49 offen sc1
    s_add_u32 s70, s70, 1
    s_cmp_lt_u32 s70, 0x100000
    s_cbranch_scc1 L_v_xp_95
    s_endpgm
L_worker_3:
    s_lshr_b32 s41, s2, 3
    s_xor_b32 s40, s40, 1
    s_and_b32 s42, s40, 1
    s_lshr_b32 s43, s40, 1
    s_lshl_b32 s39, s43, 5
    s_add_u32 s39, s39, s41
    s_load_dwordx2 s[4:5], s[0:1], 0
    s_waitcnt lgkmcnt(0)
    s_mov_b32 s28, s4
    s_and_b32 s29, s5, 0xffff
    s_mov_b32 s30, 0x400000
    s_mov_b32 s31, 0x00020000
    v_lshrrev_b32 v2, 4, v1
    v_and_b32 v4, 15, v1
    v_lshrrev_b32 v3, 1, v4
    v_xor_b32 v3, v3, v2
    v_lshlrev_b32 v3, 4, v3
    v_lshlrev_b32 v6, 7, v4
    v_add_u32 v3, v3, v6
    v_mul_u32_u24 v7, 144, v4
    v_lshlrev_b32 v6, 4, v2
    s_mul_i32 s45, s44, 4608
    s_add_u32 s45, s45, 131072
    v_add3_u32 v7, v7, v6, s45
    v_lshrrev_b32 v9, 3, v1
    v_mul_u32_u24 v8, 144, v9
    v_and_b32 v6, 7, v1
    v_lshlrev_b32 v6, 4, v6
    v_add3_u32 v8, v8, v6, s45
    v_lshlrev_b32 v11, 12, v9
    v_add_u32 v11, v11, v6
    v_lshlrev_b32 v2, 13, v2
    v_lshlrev_b32 v6, 4, v4
    v_add_u32 v2, v2, v6
    v_lshrrev_b32 v6, 3, v1
    v_lshrrev_b32 v9, 4, v1
    v_and_b32 v4, 7, v1
    v_xor_b32 v9, v9, v4
    v_lshlrev_b32 v9, 4, v9
    v_lshlrev_b32 v6, 8, v6
    v_add_u32 v6, v6, v9
    v_xor_b32 v9, 64, v6
    v_add_u32 v9, 2048, v9
    v_lshlrev_b32 v10, 4, v1
    v_lshlrev_b32 v12, 2, v1
    v_lshlrev_b32 v5, 7, v1
    s_lshl_b32 s61, s41, 7
    s_lshl_b32 s45, s43, 2
    s_add_u32 s61, s61, s45
    s_add_u32 s61, s61, 0x10010
    s_mul_i32 s64, s42, 24576
    s_add_u32 s64, s64, 0x12000
    s_lshl_b32 s45, s41, 7
    s_add_u32 s65, s64, s45
    s_lshl_b32 s45, s43, 13
    s_add_u32 s65, s65, s45
    s_add_u32 s67, s65, 4096
    s_cmp_lg_u32 s42, 0
    s_cbranch_scc1 L_w_kv_97
    v_mov_b32 v30, 0
    v_mov_b32 v31, 0
    v_mov_b32 v29, 24576
    s_mov_b64 exec, 1
    buffer_store_dword v30, v31, s[12:15], s65 offen sc1
    buffer_store_dword v30, v31, s[12:15], s67 offen sc1
    buffer_store_dword v30, v29, s[12:15], s65 offen sc1
    buffer_store_dword v30, v29, s[12:15], s67 offen sc1
    s_mov_b64 exec, -1
    s_lshl_b32 s63, s39, 2
    s_add_u32 s63, s63, s44
    s_load_dwordx2 s[4:5], s[0:1], 96
    s_load_dwordx2 s[6:7], s[0:1], 104
    v_and_b32 v14, 7, v0
    v_lshrrev_b32 v15, 3, v0
    s_waitcnt lgkmcnt(0)
    s_mov_b32 s32, s4
    s_and_b32 s33, s5, 0xffff
    s_mov_b32 s34, 0x800
    s_mov_b32 s35, 0x00020000
    s_mov_b32 s24, s6
    s_and_b32 s25, s7, 0xffff
    s_mov_b32 s26, 0xc00000
    s_mov_b32 s27, 0x00020000
    s_and_b32 s47, s39, 1
    s_lshl_b32 s45, s47, 10
    v_lshlrev_b32 v16, 5, v15
    buffer_load_dwordx4 v[104:107], v16, s[32:35], s45 offen
    buffer_load_dwordx4 v[108:111], v16, s[32:35], s45 offen offset:16
    s_mov_b32 s45, 196608
    v_mul_lo_u32 v17, v15, s45
    v_lshlrev_b32 v18, 4, v14
    v_add_u32 v17, v17, v18
    s_lshr_b32 s46, s39, 1
    s_lshl_b32 s46, s46, 7
    s_mul_i32 s45, s47, 6291456
    s_add_u32 s46, s46, s45
    buffer_load_dwordx4 v[32:35], v17, s[24:27], s46 offen
    v_add_u32 v17, 12288, v17
    buffer_load_dwordx4 v[36:39], v17, s[24:27], s46 offen
    v_add_u32 v17, 12288, v17
    buffer_load_dwordx4 v[40:43], v17, s[24:27], s46 offen
    v_add_u32 v17, 12288, v17
    buffer_load_dwordx4 v[44:47], v17, s[24:27], s46 offen
    v_add_u32 v17, 12288, v17
    buffer_load_dwordx4 v[48:51], v17, s[24:27], s46 offen
    v_add_u32 v17, 12288, v17
    buffer_load_dwordx4 v[52:55], v17, s[24:27], s46 offen
    v_add_u32 v17, 12288, v17
    buffer_load_dwordx4 v[56:59], v17, s[24:27], s46 offen
    v_add_u32 v17, 12288, v17
    buffer_load_dwordx4 v[60:63], v17, s[24:27], s46 offen
    v_add_u32 v17, 12288, v17
    buffer_load_dwordx4 v[64:67], v17, s[24:27], s46 offen
    v_add_u32 v17, 12288, v17
    buffer_load_dwordx4 v[68:71], v17, s[24:27], s46 offen
    v_add_u32 v17, 12288, v17
    buffer_load_dwordx4 v[72:75], v17, s[24:27], s46 offen
    v_add_u32 v17, 12288, v17
    buffer_load_dwordx4 v[76:79], v17, s[24:27], s46 offen
    v_add_u32 v17, 12288, v17
    buffer_load_dwordx4 v[80:83], v17, s[24:27], s46 offen
    v_add_u32 v17, 12288, v17
    buffer_load_dwordx4 v[84:87], v17, s[24:27], s46 offen
    v_add_u32 v17, 12288, v17
    buffer_load_dwordx4 v[88:91], v17, s[24:27], s46 offen
    v_add_u32 v17, 12288, v17
    buffer_load_dwordx4 v[92:95], v17, s[24:27], s46 offen
    s_add_u32 s45, s63, 0
    s_lshl_b32 s45, s45, 11
    buffer_load_dwordx4 v[128:131], v10, s[28:31], s45 offen
    buffer_load_dwordx4 v[132:135], v10, s[28:31], s45 offen offset:1024
    s_add_u32 s45, s63, 384
    s_lshl_b32 s45, s45, 11
    buffer_load_dwordx4 v[136:139], v10, s[28:31], s45 offen
    buffer_load_dwordx4 v[140:143], v10, s[28:31], s45 offen offset:1024
    s_add_u32 s45, s63, 768
    s_lshl_b32 s45, s45, 11
    buffer_load_dwordx4 v[144:147], v10, s[28:31], s45 offen
    buffer_load_dwordx4 v[148:151], v10, s[28:31], s45 offen offset:1024
    s_add_u32 s45, s63, 1152
    s_lshl_b32 s45, s45, 11
    buffer_load_dwordx4 v[152:155], v10, s[28:31], s45 offen
    buffer_load_dwordx4 v[156:159], v10, s[28:31], s45 offen offset:1024
    s_add_u32 s45, s63, 1536
    s_lshl_b32 s45, s45, 11
    buffer_load_dwordx4 v[160:163], v10, s[28:31], s45 offen
    buffer_load_dwordx4 v[164:167], v10, s[28:31], s45 offen offset:1024
    s_add_u32 s45, s63, 1920
    s_lshl_b32 s45, s45, 11
    buffer_load_dwordx4 v[168:171], v10, s[28:31], s45 offen
    buffer_load_dwordx4 v[172:175], v10, s[28:31], s45 offen offset:1024
    s_waitcnt vmcnt(28)
    v_lshlrev_b32 v112, 16, v104
    v_and_b32 v113, 0xffff0000, v104
    v_lshlrev_b32 v114, 16, v105
    v_and_b32 v115, 0xffff0000, v105
    v_lshlrev_b32 v116, 16, v106
    v_and_b32 v117, 0xffff0000, v106
    v_lshlrev_b32 v118, 16, v107
    v_and_b32 v119, 0xffff0000, v107
    v_lshlrev_b32 v120, 16, v108
    v_and_b32 v121, 0xffff0000, v108
    v_lshlrev_b32 v122, 16, v109
    v_and_b32 v123, 0xffff0000, v109
    v_lshlrev_b32 v124, 16, v110
    v_and_b32 v125, 0xffff0000, v110
    v_lshlrev_b32 v126, 16, v111
    v_and_b32 v127, 0xffff0000, v111
    v_mul_f32 v18, 0xbfb8aa3b, v112
    v_exp_f32 v18, v18
    s_nop 0
    v_add_f32 v18, 1.0, v18
    v_rcp_f32 v18, v18
    s_nop 0
    v_mul_f32 v112, v112, v18
    v_cvt_pk_bf16_f32 v112, v112, v112
    v_lshlrev_b32 v112, 16, v112
    v_mul_f32 v18, 0xbfb8aa3b, v113
    v_exp_f32 v18, v18
    s_nop 0
    v_add_f32 v18, 1.0, v18
    v_rcp_f32 v18, v18
    s_nop 0
    v_mul_f32 v113, v113, v18
    v_cvt_pk_bf16_f32 v113, v113, v113
    v_lshlrev_b32 v113, 16, v113
    v_mul_f32 v18, 0xbfb8aa3b, v114
    v_exp_f32 v18, v18
    s_nop 0
    v_add_f32 v18, 1.0, v18
    v_rcp_f32 v18, v18
    s_nop 0
    v_mul_f32 v114, v114, v18
    v_cvt_pk_bf16_f32 v114, v114, v114
    v_lshlrev_b32 v114, 16, v114
    v_mul_f32 v18, 0xbfb8aa3b, v115
    v_exp_f32 v18, v18
    s_nop 0
    v_add_f32 v18, 1.0, v18
    v_rcp_f32 v18, v18
    s_nop 0
    v_mul_f32 v115, v115, v18
    v_cvt_pk_bf16_f32 v115, v115, v115
    v_lshlrev_b32 v115, 16, v115
    v_mul_f32 v18, 0xbfb8aa3b, v116
    v_exp_f32 v18, v18
    s_nop 0
    v_add_f32 v18, 1.0, v18
    v_rcp_f32 v18, v18
    s_nop 0
    v_mul_f32 v116, v116, v18
    v_cvt_pk_bf16_f32 v116, v116, v116
    v_lshlrev_b32 v116, 16, v116
    v_mul_f32 v18, 0xbfb8aa3b, v117
    v_exp_f32 v18, v18
    s_nop 0
    v_add_f32 v18, 1.0, v18
    v_rcp_f32 v18, v18
    s_nop 0
    v_mul_f32 v117, v117, v18
    v_cvt_pk_bf16_f32 v117, v117, v117
    v_lshlrev_b32 v117, 16, v117
    v_mul_f32 v18, 0xbfb8aa3b, v118
    v_exp_f32 v18, v18
    s_nop 0
    v_add_f32 v18, 1.0, v18
    v_rcp_f32 v18, v18
    s_nop 0
    v_mul_f32 v118, v118, v18
    v_cvt_pk_bf16_f32 v118, v118, v118
    v_lshlrev_b32 v118, 16, v118
    v_mul_f32 v18, 0xbfb8aa3b, v119
    v_exp_f32 v18, v18
    s_nop 0
    v_add_f32 v18, 1.0, v18
    v_rcp_f32 v18, v18
    s_nop 0
    v_mul_f32 v119, v119, v18
    v_cvt_pk_bf16_f32 v119, v119, v119
    v_lshlrev_b32 v119, 16, v119
    v_mul_f32 v18, 0xbfb8aa3b, v120
    v_exp_f32 v18, v18
    s_nop 0
    v_add_f32 v18, 1.0, v18
    v_rcp_f32 v18, v18
    s_nop 0
    v_mul_f32 v120, v120, v18
    v_cvt_pk_bf16_f32 v120, v120, v120
    v_lshlrev_b32 v120, 16, v120
    v_mul_f32 v18, 0xbfb8aa3b, v121
    v_exp_f32 v18, v18
    s_nop 0
    v_add_f32 v18, 1.0, v18
    v_rcp_f32 v18, v18
    s_nop 0
    v_mul_f32 v121, v121, v18
    v_cvt_pk_bf16_f32 v121, v121, v121
    v_lshlrev_b32 v121, 16, v121
    v_mul_f32 v18, 0xbfb8aa3b, v122
    v_exp_f32 v18, v18
    s_nop 0
    v_add_f32 v18, 1.0, v18
    v_rcp_f32 v18, v18
    s_nop 0
    v_mul_f32 v122, v122, v18
    v_cvt_pk_bf16_f32 v122, v122, v122
    v_lshlrev_b32 v122, 16, v122
    v_mul_f32 v18, 0xbfb8aa3b, v123
    v_exp_f32 v18, v18
    s_nop 0
    v_add_f32 v18, 1.0, v18
    v_rcp_f32 v18, v18
    s_nop 0
    v_mul_f32 v123, v123, v18
    v_cvt_pk_bf16_f32 v123, v123, v123
    v_lshlrev_b32 v123, 16, v123
    v_mul_f32 v18, 0xbfb8aa3b, v124
    v_exp_f32 v18, v18
    s_nop 0
    v_add_f32 v18, 1.0, v18
    v_rcp_f32 v18, v18
    s_nop 0
    v_mul_f32 v124, v124, v18
    v_cvt_pk_bf16_f32 v124, v124, v124
    v_lshlrev_b32 v124, 16, v124
    v_mul_f32 v18, 0xbfb8aa3b, v125
    v_exp_f32 v18, v18
    s_nop 0
    v_add_f32 v18, 1.0, v18
    v_rcp_f32 v18, v18
    s_nop 0
    v_mul_f32 v125, v125, v18
    v_cvt_pk_bf16_f32 v125, v125, v125
    v_lshlrev_b32 v125, 16, v125
    v_mul_f32 v18, 0xbfb8aa3b, v126
    v_exp_f32 v18, v18
    s_nop 0
    v_add_f32 v18, 1.0, v18
    v_rcp_f32 v18, v18
    s_nop 0
    v_mul_f32 v126, v126, v18
    v_cvt_pk_bf16_f32 v126, v126, v126
    v_lshlrev_b32 v126, 16, v126
    v_mul_f32 v18, 0xbfb8aa3b, v127
    v_exp_f32 v18, v18
    s_nop 0
    v_add_f32 v18, 1.0, v18
    v_rcp_f32 v18, v18
    s_nop 0
    v_mul_f32 v127, v127, v18
    v_cvt_pk_bf16_f32 v127, v127, v127
    v_lshlrev_b32 v127, 16, v127
    v_mov_b32 v96, 0
    v_mov_b32 v97, 0
    v_mov_b32 v98, 0
    v_mov_b32 v99, 0
    v_mov_b32 v100, 0
    v_mov_b32 v101, 0
    v_mov_b32 v102, 0
    v_mov_b32 v103, 0
    s_waitcnt vmcnt(27)
    v_lshlrev_b32 v18, 16, v32
    v_and_b32 v19, 0xffff0000, v32
    v_fmac_f32 v96, v18, v112
    v_fmac_f32 v97, v19, v112
    v_lshlrev_b32 v18, 16, v33
    v_and_b32 v19, 0xffff0000, v33
    v_fmac_f32 v98, v18, v112
    v_fmac_f32 v99, v19, v112
    v_lshlrev_b32 v18, 16, v34
    v_and_b32 v19, 0xffff0000, v34
    v_fmac_f32 v100, v18, v112
    v_fmac_f32 v101, v19, v112
    v_lshlrev_b32 v18, 16, v35
    v_and_b32 v19, 0xffff0000, v35
    v_fmac_f32 v102, v18, v112
    v_fmac_f32 v103, v19, v112
    s_waitcnt vmcnt(26)
    v_lshlrev_b32 v18, 16, v36
    v_and_b32 v19, 0xffff0000, v36
    v_fmac_f32 v96, v18, v113
    v_fmac_f32 v97, v19, v113
    v_lshlrev_b32 v18, 16, v37
    v_and_b32 v19, 0xffff0000, v37
    v_fmac_f32 v98, v18, v113
    v_fmac_f32 v99, v19, v113
    v_lshlrev_b32 v18, 16, v38
    v_and_b32 v19, 0xffff0000, v38
    v_fmac_f32 v100, v18, v113
    v_fmac_f32 v101, v19, v113
    v_lshlrev_b32 v18, 16, v39
    v_and_b32 v19, 0xffff0000, v39
    v_fmac_f32 v102, v18, v113
    v_fmac_f32 v103, v19, v113
    s_waitcnt vmcnt(25)
    v_lshlrev_b32 v18, 16, v40
    v_and_b32 v19, 0xffff0000, v40
    v_fmac_f32 v96, v18, v114
    v_fmac_f32 v97, v19, v114
    v_lshlrev_b32 v18, 16, v41
    v_and_b32 v19, 0xffff0000, v41
    v_fmac_f32 v98, v18, v114
    v_fmac_f32 v99, v19, v114
    v_lshlrev_b32 v18, 16, v42
    v_and_b32 v19, 0xffff0000, v42
    v_fmac_f32 v100, v18, v114
    v_fmac_f32 v101, v19, v114
    v_lshlrev_b32 v18, 16, v43
    v_and_b32 v19, 0xffff0000, v43
    v_fmac_f32 v102, v18, v114
    v_fmac_f32 v103, v19, v114
    s_waitcnt vmcnt(24)
    v_lshlrev_b32 v18, 16, v44
    v_and_b32 v19, 0xffff0000, v44
    v_fmac_f32 v96, v18, v115
    v_fmac_f32 v97, v19, v115
    v_lshlrev_b32 v18, 16, v45
    v_and_b32 v19, 0xffff0000, v45
    v_fmac_f32 v98, v18, v115
    v_fmac_f32 v99, v19, v115
    v_lshlrev_b32 v18, 16, v46
    v_and_b32 v19, 0xffff0000, v46
    v_fmac_f32 v100, v18, v115
    v_fmac_f32 v101, v19, v115
    v_lshlrev_b32 v18, 16, v47
    v_and_b32 v19, 0xffff0000, v47
    v_fmac_f32 v102, v18, v115
    v_fmac_f32 v103, v19, v115
    s_waitcnt vmcnt(23)
    v_lshlrev_b32 v18, 16, v48
    v_and_b32 v19, 0xffff0000, v48
    v_fmac_f32 v96, v18, v116
    v_fmac_f32 v97, v19, v116
    v_lshlrev_b32 v18, 16, v49
    v_and_b32 v19, 0xffff0000, v49
    v_fmac_f32 v98, v18, v116
    v_fmac_f32 v99, v19, v116
    v_lshlrev_b32 v18, 16, v50
    v_and_b32 v19, 0xffff0000, v50
    v_fmac_f32 v100, v18, v116
    v_fmac_f32 v101, v19, v116
    v_lshlrev_b32 v18, 16, v51
    v_and_b32 v19, 0xffff0000, v51
    v_fmac_f32 v102, v18, v116
    v_fmac_f32 v103, v19, v116
    s_waitcnt vmcnt(22)
    v_lshlrev_b32 v18, 16, v52
    v_and_b32 v19, 0xffff0000, v52
    v_fmac_f32 v96, v18, v117
    v_fmac_f32 v97, v19, v117
    v_lshlrev_b32 v18, 16, v53
    v_and_b32 v19, 0xffff0000, v53
    v_fmac_f32 v98, v18, v117
    v_fmac_f32 v99, v19, v117
    v_lshlrev_b32 v18, 16, v54
    v_and_b32 v19, 0xffff0000, v54
    v_fmac_f32 v100, v18, v117
    v_fmac_f32 v101, v19, v117
    v_lshlrev_b32 v18, 16, v55
    v_and_b32 v19, 0xffff0000, v55
    v_fmac_f32 v102, v18, v117
    v_fmac_f32 v103, v19, v117
    s_waitcnt vmcnt(21)
    v_lshlrev_b32 v18, 16, v56
    v_and_b32 v19, 0xffff0000, v56
    v_fmac_f32 v96, v18, v118
    v_fmac_f32 v97, v19, v118
    v_lshlrev_b32 v18, 16, v57
    v_and_b32 v19, 0xffff0000, v57
    v_fmac_f32 v98, v18, v118
    v_fmac_f32 v99, v19, v118
    v_lshlrev_b32 v18, 16, v58
    v_and_b32 v19, 0xffff0000, v58
    v_fmac_f32 v100, v18, v118
    v_fmac_f32 v101, v19, v118
    v_lshlrev_b32 v18, 16, v59
    v_and_b32 v19, 0xffff0000, v59
    v_fmac_f32 v102, v18, v118
    v_fmac_f32 v103, v19, v118
    s_waitcnt vmcnt(20)
    v_lshlrev_b32 v18, 16, v60
    v_and_b32 v19, 0xffff0000, v60
    v_fmac_f32 v96, v18, v119
    v_fmac_f32 v97, v19, v119
    v_lshlrev_b32 v18, 16, v61
    v_and_b32 v19, 0xffff0000, v61
    v_fmac_f32 v98, v18, v119
    v_fmac_f32 v99, v19, v119
    v_lshlrev_b32 v18, 16, v62
    v_and_b32 v19, 0xffff0000, v62
    v_fmac_f32 v100, v18, v119
    v_fmac_f32 v101, v19, v119
    v_lshlrev_b32 v18, 16, v63
    v_and_b32 v19, 0xffff0000, v63
    v_fmac_f32 v102, v18, v119
    v_fmac_f32 v103, v19, v119
    s_waitcnt vmcnt(19)
    v_lshlrev_b32 v18, 16, v64
    v_and_b32 v19, 0xffff0000, v64
    v_fmac_f32 v96, v18, v120
    v_fmac_f32 v97, v19, v120
    v_lshlrev_b32 v18, 16, v65
    v_and_b32 v19, 0xffff0000, v65
    v_fmac_f32 v98, v18, v120
    v_fmac_f32 v99, v19, v120
    v_lshlrev_b32 v18, 16, v66
    v_and_b32 v19, 0xffff0000, v66
    v_fmac_f32 v100, v18, v120
    v_fmac_f32 v101, v19, v120
    v_lshlrev_b32 v18, 16, v67
    v_and_b32 v19, 0xffff0000, v67
    v_fmac_f32 v102, v18, v120
    v_fmac_f32 v103, v19, v120
    s_waitcnt vmcnt(18)
    v_lshlrev_b32 v18, 16, v68
    v_and_b32 v19, 0xffff0000, v68
    v_fmac_f32 v96, v18, v121
    v_fmac_f32 v97, v19, v121
    v_lshlrev_b32 v18, 16, v69
    v_and_b32 v19, 0xffff0000, v69
    v_fmac_f32 v98, v18, v121
    v_fmac_f32 v99, v19, v121
    v_lshlrev_b32 v18, 16, v70
    v_and_b32 v19, 0xffff0000, v70
    v_fmac_f32 v100, v18, v121
    v_fmac_f32 v101, v19, v121
    v_lshlrev_b32 v18, 16, v71
    v_and_b32 v19, 0xffff0000, v71
    v_fmac_f32 v102, v18, v121
    v_fmac_f32 v103, v19, v121
    s_waitcnt vmcnt(17)
    v_lshlrev_b32 v18, 16, v72
    v_and_b32 v19, 0xffff0000, v72
    v_fmac_f32 v96, v18, v122
    v_fmac_f32 v97, v19, v122
    v_lshlrev_b32 v18, 16, v73
    v_and_b32 v19, 0xffff0000, v73
    v_fmac_f32 v98, v18, v122
    v_fmac_f32 v99, v19, v122
    v_lshlrev_b32 v18, 16, v74
    v_and_b32 v19, 0xffff0000, v74
    v_fmac_f32 v100, v18, v122
    v_fmac_f32 v101, v19, v122
    v_lshlrev_b32 v18, 16, v75
    v_and_b32 v19, 0xffff0000, v75
    v_fmac_f32 v102, v18, v122
    v_fmac_f32 v103, v19, v122
    s_waitcnt vmcnt(16)
    v_lshlrev_b32 v18, 16, v76
    v_and_b32 v19, 0xffff0000, v76
    v_fmac_f32 v96, v18, v123
    v_fmac_f32 v97, v19, v123
    v_lshlrev_b32 v18, 16, v77
    v_and_b32 v19, 0xffff0000, v77
    v_fmac_f32 v98, v18, v123
    v_fmac_f32 v99, v19, v123
    v_lshlrev_b32 v18, 16, v78
    v_and_b32 v19, 0xffff0000, v78
    v_fmac_f32 v100, v18, v123
    v_fmac_f32 v101, v19, v123
    v_lshlrev_b32 v18, 16, v79
    v_and_b32 v19, 0xffff0000, v79
    v_fmac_f32 v102, v18, v123
    v_fmac_f32 v103, v19, v123
    s_waitcnt vmcnt(15)
    v_lshlrev_b32 v18, 16, v80
    v_and_b32 v19, 0xffff0000, v80
    v_fmac_f32 v96, v18, v124
    v_fmac_f32 v97, v19, v124
    v_lshlrev_b32 v18, 16, v81
    v_and_b32 v19, 0xffff0000, v81
    v_fmac_f32 v98, v18, v124
    v_fmac_f32 v99, v19, v124
    v_lshlrev_b32 v18, 16, v82
    v_and_b32 v19, 0xffff0000, v82
    v_fmac_f32 v100, v18, v124
    v_fmac_f32 v101, v19, v124
    v_lshlrev_b32 v18, 16, v83
    v_and_b32 v19, 0xffff0000, v83
    v_fmac_f32 v102, v18, v124
    v_fmac_f32 v103, v19, v124
    s_waitcnt vmcnt(14)
    v_lshlrev_b32 v18, 16, v84
    v_and_b32 v19, 0xffff0000, v84
    v_fmac_f32 v96, v18, v125
    v_fmac_f32 v97, v19, v125
    v_lshlrev_b32 v18, 16, v85
    v_and_b32 v19, 0xffff0000, v85
    v_fmac_f32 v98, v18, v125
    v_fmac_f32 v99, v19, v125
    v_lshlrev_b32 v18, 16, v86
    v_and_b32 v19, 0xffff0000, v86
    v_fmac_f32 v100, v18, v125
    v_fmac_f32 v101, v19, v125
    v_lshlrev_b32 v18, 16, v87
    v_and_b32 v19, 0xffff0000, v87
    v_fmac_f32 v102, v18, v125
    v_fmac_f32 v103, v19, v125
    s_waitcnt vmcnt(13)
    v_lshlrev_b32 v18, 16, v88
    v_and_b32 v19, 0xffff0000, v88
    v_fmac_f32 v96, v18, v126
    v_fmac_f32 v97, v19, v126
    v_lshlrev_b32 v18, 16, v89
    v_and_b32 v19, 0xffff0000, v89
    v_fmac_f32 v98, v18, v126
    v_fmac_f32 v99, v19, v126
    v_lshlrev_b32 v18, 16, v90
    v_and_b32 v19, 0xffff0000, v90
    v_fmac_f32 v100, v18, v126
    v_fmac_f32 v101, v19, v126
    v_lshlrev_b32 v18, 16, v91
    v_and_b32 v19, 0xffff0000, v91
    v_fmac_f32 v102, v18, v126
    v_fmac_f32 v103, v19, v126
    s_waitcnt vmcnt(12)
    v_lshlrev_b32 v18, 16, v92
    v_and_b32 v19, 0xffff0000, v92
    v_fmac_f32 v96, v18, v127
    v_fmac_f32 v97, v19, v127
    v_lshlrev_b32 v18, 16, v93
    v_and_b32 v19, 0xffff0000, v93
    v_fmac_f32 v98, v18, v127
    v_fmac_f32 v99, v19, v127
    v_lshlrev_b32 v18, 16, v94
    v_and_b32 v19, 0xffff0000, v94
    v_fmac_f32 v100, v18, v127
    v_fmac_f32 v101, v19, v127
    v_lshlrev_b32 v18, 16, v95
    v_and_b32 v19, 0xffff0000, v95
    v_fmac_f32 v102, v18, v127
    v_fmac_f32 v103, v19, v127
    v_lshlrev_b32 v16, 5, v0
    ds_write_b128 v16, v[96:99]
    ds_write_b128 v16, v[100:103] offset:16
    s_waitcnt lgkmcnt(0)
    s_barrier
    s_cmp_lg_u32 s44, 0
    s_cbranch_scc1 L_mod_fin_99
    v_mov_b32 v18, 0
    ds_read_b32 v32, v12 offset:0
    ds_read_b32 v33, v12 offset:256
    ds_read_b32 v34, v12 offset:512
    ds_read_b32 v35, v12 offset:768
    ds_read_b32 v36, v12 offset:1024
    ds_read_b32 v37, v12 offset:1280
    ds_read_b32 v38, v12 offset:1536
    ds_read_b32 v39, v12 offset:1792
    ds_read_b32 v40, v12 offset:2048
    ds_read_b32 v41, v12 offset:2304
    ds_read_b32 v42, v12 offset:2560
    ds_read_b32 v43, v12 offset:2816
    ds_read_b32 v44, v12 offset:3072
    ds_read_b32 v45, v12 offset:3328
    ds_read_b32 v46, v12 offset:3584
    ds_read_b32 v47, v12 offset:3840
    s_waitcnt lgkmcnt(0)
    v_add_f32 v18, v18, v32
    v_add_f32 v18, v18, v33
    v_add_f32 v18, v18, v34
    v_add_f32 v18, v18, v35
    v_add_f32 v18, v18, v36
    v_add_f32 v18, v18, v37
    v_add_f32 v18, v18, v38
    v_add_f32 v18, v18, v39
    v_add_f32 v18, v18, v40
    v_add_f32 v18, v18, v41
    v_add_f32 v18, v18, v42
    v_add_f32 v18, v18, v43
    v_add_f32 v18, v18, v44
    v_add_f32 v18, v18, v45
    v_add_f32 v18, v18, v46
    v_add_f32 v18, v18, v47
    ds_read_b32 v32, v12 offset:4096
    ds_read_b32 v33, v12 offset:4352
    ds_read_b32 v34, v12 offset:4608
    ds_read_b32 v35, v12 offset:4864
    ds_read_b32 v36, v12 offset:5120
    ds_read_b32 v37, v12 offset:5376
    ds_read_b32 v38, v12 offset:5632
    ds_read_b32 v39, v12 offset:5888
    ds_read_b32 v40, v12 offset:6144
    ds_read_b32 v41, v12 offset:6400
    ds_read_b32 v42, v12 offset:6656
    ds_read_b32 v43, v12 offset:6912
    ds_read_b32 v44, v12 offset:7168
    ds_read_b32 v45, v12 offset:7424
    ds_read_b32 v46, v12 offset:7680
    ds_read_b32 v47, v12 offset:7936
    s_waitcnt lgkmcnt(0)
    v_add_f32 v18, v18, v32
    v_add_f32 v18, v18, v33
    v_add_f32 v18, v18, v34
    v_add_f32 v18, v18, v35
    v_add_f32 v18, v18, v36
    v_add_f32 v18, v18, v37
    v_add_f32 v18, v18, v38
    v_add_f32 v18, v18, v39
    v_add_f32 v18, v18, v40
    v_add_f32 v18, v18, v41
    v_add_f32 v18, v18, v42
    v_add_f32 v18, v18, v43
    v_add_f32 v18, v18, v44
    v_add_f32 v18, v18, v45
    v_add_f32 v18, v18, v46
    v_add_f32 v18, v18, v47
    s_lshr_b32 s45, s39, 1
    s_lshl_b32 s45, s45, 8
    s_mul_i32 s46, s47, 24576
    s_add_u32 s45, s45, s46
    buffer_store_dword v18, v12, s[12:15], s45 offen sc1
L_mod_fin_99:
    s_waitcnt vmcnt(0)
    s_barrier
    s_cmp_lg_u32 s44, 0
    s_cbranch_scc1 L_cnt_100
    v_mov_b32 v30, 1
    v_mov_b32 v31, 128
    s_mov_b64 exec, 1
    buffer_atomic_add v30, v31, s[16:19], 0 offen sc1
    s_mov_b64 exec, -1
L_cnt_100:
    v_lshlrev_b32 v192, 16, v128
    v_and_b32 v193, 0xffff0000, v128
    v_lshlrev_b32 v194, 16, v129
    v_and_b32 v195, 0xffff0000, v129
    v_lshlrev_b32 v196, 16, v130
    v_and_b32 v197, 0xffff0000, v130
    v_lshlrev_b32 v198, 16, v131
    v_and_b32 v199, 0xffff0000, v131
    v_lshlrev_b32 v200, 16, v132
    v_and_b32 v201, 0xffff0000, v132
    v_lshlrev_b32 v202, 16, v133
    v_and_b32 v203, 0xffff0000, v133
    v_lshlrev_b32 v204, 16, v134
    v_and_b32 v205, 0xffff0000, v134
    v_lshlrev_b32 v206, 16, v135
    v_and_b32 v207, 0xffff0000, v135
    v_add_f32 v26, v192, v193
    v_add_f32 v26, v26, v194
    v_add_f32 v26, v26, v195
    v_add_f32 v26, v26, v196
    v_add_f32 v26, v26, v197
    v_add_f32 v26, v26, v198
    v_add_f32 v26, v26, v199
    v_add_f32 v26, v26, v200
    v_add_f32 v26, v26, v201
    v_add_f32 v26, v26, v202
    v_add_f32 v26, v26, v203
    v_add_f32 v26, v26, v204
    v_add_f32 v26, v26, v205
    v_add_f32 v26, v26, v206
    v_add_f32 v26, v26, v207
    s_nop 1
    v_add_f32_dpp v26, v26, v26 row_shr:1 row_mask:0xf bank_mask:0xf bound_ctrl:0
    s_nop 1
    v_add_f32_dpp v26, v26, v26 row_shr:2 row_mask:0xf bank_mask:0xf bound_ctrl:0
    s_nop 1
    v_add_f32_dpp v26, v26, v26 row_shr:4 row_mask:0xf bank_mask:0xf bound_ctrl:0
    s_nop 1
    v_add_f32_dpp v26, v26, v26 row_shr:8 row_mask:0xf bank_mask:0xf bound_ctrl:0
    s_nop 1
    v_add_f32_dpp v26, v26, v26 row_bcast:15 row_mask:0xa bank_mask:0xf
    s_nop 1
    v_add_f32_dpp v26, v26, v26 row_bcast:31 row_mask:0xc bank_mask:0xf
    s_nop 1
    v_readlane_b32 s66, v26, 63
    s_nop 1
    v_mov_b32 v27, s66
    v_mul_f32 v27, 0x3a800000, v27
    v_mov_b32 v26, 0
    v_sub_f32 v28, v192, v27
    v_fmac_f32 v26, v28, v28
    v_sub_f32 v28, v193, v27
    v_fmac_f32 v26, v28, v28
    v_sub_f32 v28, v194, v27
    v_fmac_f32 v26, v28, v28
    v_sub_f32 v28, v195, v27
    v_fmac_f32 v26, v28, v28
    v_sub_f32 v28, v196, v27
    v_fmac_f32 v26, v28, v28
    v_sub_f32 v28, v197, v27
    v_fmac_f32 v26, v28, v28
    v_sub_f32 v28, v198, v27
    v_fmac_f32 v26, v28, v28
    v_sub_f32 v28, v199, v27
    v_fmac_f32 v26, v28, v28
    v_sub_f32 v28, v200, v27
    v_fmac_f32 v26, v28, v28
    v_sub_f32 v28, v201, v27
    v_fmac_f32 v26, v28, v28
    v_sub_f32 v28, v202, v27
    v_fmac_f32 v26, v28, v28
    v_sub_f32 v28, v203, v27
    v_fmac_f32 v26, v28, v28
    v_sub_f32 v28, v204, v27
    v_fmac_f32 v26, v28, v28
    v_sub_f32 v28, v205, v27
    v_fmac_f32 v26, v28, v28
    v_sub_f32 v28, v206, v27
    v_fmac_f32 v26, v28, v28
    v_sub_f32 v28, v207, v27
    v_fmac_f32 v26, v28, v28
    s_nop 1
    v_add_f32_dpp v26, v26, v26 row_shr:1 row_mask:0xf bank_mask:0xf bound_ctrl:0
    s_nop 1
    v_add_f32_dpp v26, v26, v26 row_shr:2 row_mask:0xf bank_mask:0xf bound_ctrl:0
    s_nop 1
    v_add_f32_dpp v26, v26, v26 row_shr:4 row_mask:0xf bank_mask:0xf bound_ctrl:0
    s_nop 1
    v_add_f32_dpp v26, v26, v26 row_shr:8 row_mask:0xf bank_mask:0xf bound_ctrl:0
    s_nop 1
    v_add_f32_dpp v26, v26, v26 row_bcast:15 row_mask:0xa bank_mask:0xf
    s_nop 1
    v_add_f32_dpp v26, v26, v26 row_bcast:31 row_mask:0xc bank_mask:0xf
    s_nop 1
    v_readlane_b32 s66, v26, 63
    s_nop 1
    v_mov_b32 v26, s66
    v_mul_f32 v26, 0x3a800000, v26
    v_cvt_pk_bf16_f32 v26, v26, v26
    v_lshlrev_b32 v26, 16, v26
    v_cvt_pk_bf16_f32 v27, v27, v27
    v_lshlrev_b32 v27, 16, v27
    v_add_f32 v26, 0x3727c5ac, v26
    v_cvt_pk_bf16_f32 v26, v26, v26
    v_lshlrev_b32 v26, 16, v26
    v_sqrt_f32 v26, v26
    s_nop 0
    v_cvt_pk_bf16_f32 v26, v26, v26
    v_lshlrev_b32 v26, 16, v26
    v_rcp_f32 v26, v26
    s_nop 0
    v_sub_f32 v192, v192, v27
    v_cvt_pk_bf16_f32 v192, v192, v192
    v_lshlrev_b32 v192, 16, v192
    v_mul_f32 v192, v192, v26
    v_cvt_pk_bf16_f32 v192, v192, v192
    v_lshlrev_b32 v192, 16, v192
    v_sub_f32 v193, v193, v27
    v_cvt_pk_bf16_f32 v193, v193, v193
    v_lshlrev_b32 v193, 16, v193
    v_mul_f32 v193, v193, v26
    v_cvt_pk_bf16_f32 v193, v193, v193
    v_lshlrev_b32 v193, 16, v193
    v_sub_f32 v194, v194, v27
    v_cvt_pk_bf16_f32 v194, v194, v194
    v_lshlrev_b32 v194, 16, v194
    v_mul_f32 v194, v194, v26
    v_cvt_pk_bf16_f32 v194, v194, v194
    v_lshlrev_b32 v194, 16, v194
    v_sub_f32 v195, v195, v27
    v_cvt_pk_bf16_f32 v195, v195, v195
    v_lshlrev_b32 v195, 16, v195
    v_mul_f32 v195, v195, v26
    v_cvt_pk_bf16_f32 v195, v195, v195
    v_lshlrev_b32 v195, 16, v195
    v_sub_f32 v196, v196, v27
    v_cvt_pk_bf16_f32 v196, v196, v196
    v_lshlrev_b32 v196, 16, v196
    v_mul_f32 v196, v196, v26
    v_cvt_pk_bf16_f32 v196, v196, v196
    v_lshlrev_b32 v196, 16, v196
    v_sub_f32 v197, v197, v27
    v_cvt_pk_bf16_f32 v197, v197, v197
    v_lshlrev_b32 v197, 16, v197
    v_mul_f32 v197, v197, v26
    v_cvt_pk_bf16_f32 v197, v197, v197
    v_lshlrev_b32 v197, 16, v197
    v_sub_f32 v198, v198, v27
    v_cvt_pk_bf16_f32 v198, v198, v198
    v_lshlrev_b32 v198, 16, v198
    v_mul_f32 v198, v198, v26
    v_cvt_pk_bf16_f32 v198, v198, v198
    v_lshlrev_b32 v198, 16, v198
    v_sub_f32 v199, v199, v27
    v_cvt_pk_bf16_f32 v199, v199, v199
    v_lshlrev_b32 v199, 16, v199
    v_mul_f32 v199, v199, v26
    v_cvt_pk_bf16_f32 v199, v199, v199
    v_lshlrev_b32 v199, 16, v199
    v_sub_f32 v200, v200, v27
    v_cvt_pk_bf16_f32 v200, v200, v200
    v_lshlrev_b32 v200, 16, v200
    v_mul_f32 v200, v200, v26
    v_cvt_pk_bf16_f32 v200, v200, v200
    v_lshlrev_b32 v200, 16, v200
    v_sub_f32 v201, v201, v27
    v_cvt_pk_bf16_f32 v201, v201, v201
    v_lshlrev_b32 v201, 16, v201
    v_mul_f32 v201, v201, v26
    v_cvt_pk_bf16_f32 v201, v201, v201
    v_lshlrev_b32 v201, 16, v201
    v_sub_f32 v202, v202, v27
    v_cvt_pk_bf16_f32 v202, v202, v202
    v_lshlrev_b32 v202, 16, v202
    v_mul_f32 v202, v202, v26
    v_cvt_pk_bf16_f32 v202, v202, v202
    v_lshlrev_b32 v202, 16, v202
    v_sub_f32 v203, v203, v27
    v_cvt_pk_bf16_f32 v203, v203, v203
    v_lshlrev_b32 v203, 16, v203
    v_mul_f32 v203, v203, v26
    v_cvt_pk_bf16_f32 v203, v203, v203
    v_lshlrev_b32 v203, 16, v203
    v_sub_f32 v204, v204, v27
    v_cvt_pk_bf16_f32 v204, v204, v204
    v_lshlrev_b32 v204, 16, v204
    v_mul_f32 v204, v204, v26
    v_cvt_pk_bf16_f32 v204, v204, v204
    v_lshlrev_b32 v204, 16, v204
    v_sub_f32 v205, v205, v27
    v_cvt_pk_bf16_f32 v205, v205, v205
    v_lshlrev_b32 v205, 16, v205
    v_mul_f32 v205, v205, v26
    v_cvt_pk_bf16_f32 v205, v205, v205
    v_lshlrev_b32 v205, 16, v205
    v_sub_f32 v206, v206, v27
    v_cvt_pk_bf16_f32 v206, v206, v206
    v_lshlrev_b32 v206, 16, v206
    v_mul_f32 v206, v206, v26
    v_cvt_pk_bf16_f32 v206, v206, v206
    v_lshlrev_b32 v206, 16, v206
    v_sub_f32 v207, v207, v27
    v_cvt_pk_bf16_f32 v207, v207, v207
    v_lshlrev_b32 v207, 16, v207
    v_mul_f32 v207, v207, v26
    v_cvt_pk_bf16_f32 v207, v207, v207
    v_lshlrev_b32 v207, 16, v207
    v_lshlrev_b32 v208, 16, v136
    v_and_b32 v209, 0xffff0000, v136
    v_lshlrev_b32 v210, 16, v137
    v_and_b32 v211, 0xffff0000, v137
    v_lshlrev_b32 v212, 16, v138
    v_and_b32 v213, 0xffff0000, v138
    v_lshlrev_b32 v214, 16, v139
    v_and_b32 v215, 0xffff0000, v139
    v_lshlrev_b32 v216, 16, v140
    v_and_b32 v217, 0xffff0000, v140
    v_lshlrev_b32 v218, 16, v141
    v_and_b32 v219, 0xffff0000, v141
    v_lshlrev_b32 v220, 16, v142
    v_and_b32 v221, 0xffff0000, v142
    v_lshlrev_b32 v222, 16, v143
    v_and_b32 v223, 0xffff0000, v143
    v_add_f32 v26, v208, v209
    v_add_f32 v26, v26, v210
    v_add_f32 v26, v26, v211
    v_add_f32 v26, v26, v212
    v_add_f32 v26, v26, v213
    v_add_f32 v26, v26, v214
    v_add_f32 v26, v26, v215
    v_add_f32 v26, v26, v216
    v_add_f32 v26, v26, v217
    v_add_f32 v26, v26, v218
    v_add_f32 v26, v26, v219
    v_add_f32 v26, v26, v220
    v_add_f32 v26, v26, v221
    v_add_f32 v26, v26, v222
    v_add_f32 v26, v26, v223
    s_nop 1
    v_add_f32_dpp v26, v26, v26 row_shr:1 row_mask:0xf bank_mask:0xf bound_ctrl:0
    s_nop 1
    v_add_f32_dpp v26, v26, v26 row_shr:2 row_mask:0xf bank_mask:0xf bound_ctrl:0
    s_nop 1
    v_add_f32_dpp v26, v26, v26 row_shr:4 row_mask:0xf bank_mask:0xf bound_ctrl:0
    s_nop 1
    v_add_f32_dpp v26, v26, v26 row_shr:8 row_mask:0xf bank_mask:0xf bound_ctrl:0
    s_nop 1
    v_add_f32_dpp v26, v26, v26 row_bcast:15 row_mask:0xa bank_mask:0xf
    s_nop 1
    v_add_f32_dpp v26, v26, v26 row_bcast:31 row_mask:0xc bank_mask:0xf
    s_nop 1
    v_readlane_b32 s66, v26, 63
    s_nop 1
    v_mov_b32 v27, s66
    v_mul_f32 v27, 0x3a800000, v27
    v_mov_b32 v26, 0
    v_sub_f32 v28, v208, v27
    v_fmac_f32 v26, v28, v28
    v_sub_f32 v28, v209, v27
    v_fmac_f32 v26, v28, v28
    v_sub_f32 v28, v210, v27
    v_fmac_f32 v26, v28, v28
    v_sub_f32 v28, v211, v27
    v_fmac_f32 v26, v28, v28
    v_sub_f32 v28, v212, v27
    v_fmac_f32 v26, v28, v28
    v_sub_f32 v28, v213, v27
    v_fmac_f32 v26, v28, v28
    v_sub_f32 v28, v214, v27
    v_fmac_f32 v26, v28, v28
    v_sub_f32 v28, v215, v27
    v_fmac_f32 v26, v28, v28
    v_sub_f32 v28, v216, v27
    v_fmac_f32 v26, v28, v28
    v_sub_f32 v28, v217, v27
    v_fmac_f32 v26, v28, v28
    v_sub_f32 v28, v218, v27
    v_fmac_f32 v26, v28, v28
    v_sub_f32 v28, v219, v27
    v_fmac_f32 v26, v28, v28
    v_sub_f32 v28, v220, v27
    v_fmac_f32 v26, v28, v28
    v_sub_f32 v28, v221, v27
    v_fmac_f32 v26, v28, v28
    v_sub_f32 v28, v222, v27
    v_fmac_f32 v26, v28, v28
    v_sub_f32 v28, v223, v27
    v_fmac_f32 v26, v28, v28
    s_nop 1
    v_add_f32_dpp v26, v26, v26 row_shr:1 row_mask:0xf bank_mask:0xf bound_ctrl:0
    s_nop 1
    v_add_f32_dpp v26, v26, v26 row_shr:2 row_mask:0xf bank_mask:0xf bound_ctrl:0
    s_nop 1
    v_add_f32_dpp v26, v26, v26 row_shr:4 row_mask:0xf bank_mask:0xf bound_ctrl:0
    s_nop 1
    v_add_f32_dpp v26, v26, v26 row_shr:8 row_mask:0xf bank_mask:0xf bound_ctrl:0
    s_nop 1
    v_add_f32_dpp v26, v26, v26 row_bcast:15 row_mask:0xa bank_mask:0xf
    s_nop 1
    v_add_f32_dpp v26, v26, v26 row_bcast:31 row_mask:0xc bank_mask:0xf
    s_nop 1
    v_readlane_b32 s66, v26, 63
    s_nop 1
    v_mov_b32 v26, s66
    v_mul_f32 v26, 0x3a800000, v26
    v_cvt_pk_bf16_f32 v26, v26, v26
    v_lshlrev_b32 v26, 16, v26
    v_cvt_pk_bf16_f32 v27, v27, v27
    v_lshlrev_b32 v27, 16, v27
    v_add_f32 v26, 0x3727c5ac, v26
    v_cvt_pk_bf16_f32 v26, v26, v26
    v_lshlrev_b32 v26, 16, v26
    v_sqrt_f32 v26, v26
    s_nop 0
    v_cvt_pk_bf16_f32 v26, v26, v26
    v_lshlrev_b32 v26, 16, v26
    v_rcp_f32 v26, v26
    s_nop 0
    v_sub_f32 v208, v208, v27
    v_cvt_pk_bf16_f32 v208, v208, v208
    v_lshlrev_b32 v208, 16, v208
    v_mul_f32 v208, v208, v26
    v_cvt_pk_bf16_f32 v208, v208, v208
    v_lshlrev_b32 v208, 16, v208
    v_sub_f32 v209, v209, v27
    v_cvt_pk_bf16_f32 v209, v209, v209
    v_lshlrev_b32 v209, 16, v209
    v_mul_f32 v209, v209, v26
    v_cvt_pk_bf16_f32 v209, v209, v209
    v_lshlrev_b32 v209, 16, v209
    v_sub_f32 v210, v210, v27
    v_cvt_pk_bf16_f32 v210, v210, v210
    v_lshlrev_b32 v210, 16, v210
    v_mul_f32 v210, v210, v26
    v_cvt_pk_bf16_f32 v210, v210, v210
    v_lshlrev_b32 v210, 16, v210
    v_sub_f32 v211, v211, v27
    v_cvt_pk_bf16_f32 v211, v211, v211
    v_lshlrev_b32 v211, 16, v211
    v_mul_f32 v211, v211, v26
    v_cvt_pk_bf16_f32 v211, v211, v211
    v_lshlrev_b32 v211, 16, v211
    v_sub_f32 v212, v212, v27
    v_cvt_pk_bf16_f32 v212, v212, v212
    v_lshlrev_b32 v212, 16, v212
    v_mul_f32 v212, v212, v26
    v_cvt_pk_bf16_f32 v212, v212, v212
    v_lshlrev_b32 v212, 16, v212
    v_sub_f32 v213, v213, v27
    v_cvt_pk_bf16_f32 v213, v213, v213
    v_lshlrev_b32 v213, 16, v213
    v_mul_f32 v213, v213, v26
    v_cvt_pk_bf16_f32 v213, v213, v213
    v_lshlrev_b32 v213, 16, v213
    v_sub_f32 v214, v214, v27
    v_cvt_pk_bf16_f32 v214, v214, v214
    v_lshlrev_b32 v214, 16, v214
    v_mul_f32 v214, v214, v26
    v_cvt_pk_bf16_f32 v214, v214, v214
    v_lshlrev_b32 v214, 16, v214
    v_sub_f32 v215, v215, v27
    v_cvt_pk_bf16_f32 v215, v215, v215
    v_lshlrev_b32 v215, 16, v215
    v_mul_f32 v215, v215, v26
    v_cvt_pk_bf16_f32 v215, v215, v215
    v_lshlrev_b32 v215, 16, v215
    v_sub_f32 v216, v216, v27
    v_cvt_pk_bf16_f32 v216, v216, v216
    v_lshlrev_b32 v216, 16, v216
    v_mul_f32 v216, v216, v26
    v_cvt_pk_bf16_f32 v216, v216, v216
    v_lshlrev_b32 v216, 16, v216
    v_sub_f32 v217, v217, v27
    v_cvt_pk_bf16_f32 v217, v217, v217
    v_lshlrev_b32 v217, 16, v217
    v_mul_f32 v217, v217, v26
    v_cvt_pk_bf16_f32 v217, v217, v217
    v_lshlrev_b32 v217, 16, v217
    v_sub_f32 v218, v218, v27
    v_cvt_pk_bf16_f32 v218, v218, v218
    v_lshlrev_b32 v218, 16, v218
    v_mul_f32 v218, v218, v26
    v_cvt_pk_bf16_f32 v218, v218, v218
    v_lshlrev_b32 v218, 16, v218
    v_sub_f32 v219, v219, v27
    v_cvt_pk_bf16_f32 v219, v219, v219
    v_lshlrev_b32 v219, 16, v219
    v_mul_f32 v219, v219, v26
    v_cvt_pk_bf16_f32 v219, v219, v219
    v_lshlrev_b32 v219, 16, v219
    v_sub_f32 v220, v220, v27
    v_cvt_pk_bf16_f32 v220, v220, v220
    v_lshlrev_b32 v220, 16, v220
    v_mul_f32 v220, v220, v26
    v_cvt_pk_bf16_f32 v220, v220, v220
    v_lshlrev_b32 v220, 16, v220
    v_sub_f32 v221, v221, v27
    v_cvt_pk_bf16_f32 v221, v221, v221
    v_lshlrev_b32 v221, 16, v221
    v_mul_f32 v221, v221, v26
    v_cvt_pk_bf16_f32 v221, v221, v221
    v_lshlrev_b32 v221, 16, v221
    v_sub_f32 v222, v222, v27
    v_cvt_pk_bf16_f32 v222, v222, v222
    v_lshlrev_b32 v222, 16, v222
    v_mul_f32 v222, v222, v26
    v_cvt_pk_bf16_f32 v222, v222, v222
    v_lshlrev_b32 v222, 16, v222
    v_sub_f32 v223, v223, v27
    v_cvt_pk_bf16_f32 v223, v223, v223
    v_lshlrev_b32 v223, 16, v223
    v_mul_f32 v223, v223, v26
    v_cvt_pk_bf16_f32 v223, v223, v223
    v_lshlrev_b32 v223, 16, v223
    s_cmp_lg_u32 s44, 0
    s_cbranch_scc1 L_pd_101
    v_mov_b32 v29, 8
    s_mov_b32 s46, 32
    s_mov_b64 exec, 1
    s_mov_b32 s70, 0
L_wp_102:
    buffer_load_dword v31, v29, s[16:19], 0 offen sc1
    s_add_u32 s70, s70, 1
    s_cmp_ge_u32 s70, 0x200000
    s_cbranch_scc1 L_w_done_96
L_wp_102_c:
    s_waitcnt vmcnt(0)
    v_cmp_gt_u32 vcc, s46, v31
    s_nop 1
    s_cbranch_vccz L_wp_102_ok
    s_sleep 3
    s_branch L_wp_102
L_wp_102_ok:
    s_mov_b64 exec, -1
L_pd_101:
    s_barrier
    s_cmp_lg_u32 s44, 0
    s_cbranch_scc1 L_pd_103
    v_mov_b32 v29, 128
    s_mov_b32 s46, 96
    s_mov_b64 exec, 1
    s_mov_b32 s70, 0
L_wp_104:
    buffer_load_dword v31, v29, s[16:19], 0 offen sc1
    s_add_u32 s70, s70, 1
    s_cmp_ge_u32 s70, 0x200000
    s_cbranch_scc1 L_w_done_96
L_wp_104_c:
    s_waitcnt vmcnt(0)
    v_cmp_gt_u32 vcc, s46, v31
    s_nop 1
    s_cbranch_vccz L_wp_104_ok
    s_sleep 1
    s_branch L_wp_104
L_wp_104_ok:
    s_mov_b64 exec, -1
L_pd_103:
    s_barrier
    v_lshlrev_b32 v29, 5, v1
    s_mov_b32 s45, 0
    buffer_load_dwordx4 v[96:99], v29, s[12:15], s45 offen offset:0 sc1
    buffer_load_dwordx4 v[100:103], v29, s[12:15], s45 offen offset:16 sc1
    buffer_load_dwordx4 v[104:107], v29, s[12:15], s45 offen offset:2048 sc1
    buffer_load_dwordx4 v[108:111], v29, s[12:15], s45 offen offset:2064 sc1
    s_mov_b32 s45, 24576
    buffer_load_dwordx4 v[32:35], v29, s[12:15], s45 offen offset:0 sc1
    buffer_load_dwordx4 v[36:39], v29, s[12:15], s45 offen offset:16 sc1
    buffer_load_dwordx4 v[40:43], v29, s[12:15], s45 offen offset:2048 sc1
    buffer_load_dwordx4 v[44:47], v29, s[12:15], s45 offen offset:2064 sc1
    s_mov_b32 s45, 4096
    buffer_load_dwordx4 v[112:115], v29, s[12:15], s45 offen offset:0 sc1
    buffer_load_dwordx4 v[116:119], v29, s[12:15], s45 offen offset:16 sc1
    buffer_load_dwordx4 v[120:123], v29, s[12:15], s45 offen offset:2048 sc1
    buffer_load_dwordx4 v[124:127], v29, s[12:15], s45 offen offset:2064 sc1
    s_mov_b32 s45, 28672
    buffer_load_dwordx4 v[48:51], v29, s[12:15], s45 offen offset:0 sc1
    buffer_load_dwordx4 v[52:55], v29, s[12:15], s45 offen offset:16 sc1
    buffer_load_dwordx4 v[56:59], v29, s[12:15], s45 offen offset:2048 sc1
    buffer_load_dwordx4 v[60:63], v29, s[12:15], s45 offen offset:2064 sc1
    s_waitcnt vmcnt(0)
    v_add_f32 v96, v96, v32
    v_cvt_pk_bf16_f32 v96, v96, v96
    v_lshlrev_b32 v96, 16, v96
    v_add_f32 v97, v97, v33
    v_cvt_pk_bf16_f32 v97, v97, v97
    v_lshlrev_b32 v97, 16, v97
    v_add_f32 v98, v98, v34
    v_cvt_pk_bf16_f32 v98, v98, v98
    v_lshlrev_b32 v98, 16, v98
    v_add_f32 v99, v99, v35
    v_cvt_pk_bf16_f32 v99, v99, v99
    v_lshlrev_b32 v99, 16, v99
    v_add_f32 v100, v100, v36
    v_cvt_pk_bf16_f32 v100, v100, v100
    v_lshlrev_b32 v100, 16, v100
    v_add_f32 v101, v101, v37
    v_cvt_pk_bf16_f32 v101, v101, v101
    v_lshlrev_b32 v101, 16, v101
    v_add_f32 v102, v102, v38
    v_cvt_pk_bf16_f32 v102, v102, v102
    v_lshlrev_b32 v102, 16, v102
    v_add_f32 v103, v103, v39
    v_cvt_pk_bf16_f32 v103, v103, v103
    v_lshlrev_b32 v103, 16, v103
    v_add_f32 v104, v104, v40
    v_cvt_pk_bf16_f32 v104, v104, v104
    v_lshlrev_b32 v104, 16, v104
    v_add_f32 v105, v105, v41
    v_cvt_pk_bf16_f32 v105, v105, v105
    v_lshlrev_b32 v105, 16, v105
    v_add_f32 v106, v106, v42
    v_cvt_pk_bf16_f32 v106, v106, v106
    v_lshlrev_b32 v106, 16, v106
    v_add_f32 v107, v107, v43
    v_cvt_pk_bf16_f32 v107, v107, v107
    v_lshlrev_b32 v107, 16, v107
    v_add_f32 v108, v108, v44
    v_cvt_pk_bf16_f32 v108, v108, v108
    v_lshlrev_b32 v108, 16, v108
    v_add_f32 v109, v109, v45
    v_cvt_pk_bf16_f32 v109, v109, v109
    v_lshlrev_b32 v109, 16, v109
    v_add_f32 v110, v110, v46
    v_cvt_pk_bf16_f32 v110, v110, v110
    v_lshlrev_b32 v110, 16, v110
    v_add_f32 v111, v111, v47
    v_cvt_pk_bf16_f32 v111, v111, v111
    v_lshlrev_b32 v111, 16, v111
    v_add_f32 v112, v112, v48
    v_cvt_pk_bf16_f32 v112, v112, v112
    v_lshlrev_b32 v112, 16, v112
    v_add_f32 v112, 1.0, v112
    v_cvt_pk_bf16_f32 v112, v112, v112
    v_lshlrev_b32 v112, 16, v112
    v_add_f32 v113, v113, v49
    v_cvt_pk_bf16_f32 v113, v113, v113
    v_lshlrev_b32 v113, 16, v113
    v_add_f32 v113, 1.0, v113
    v_cvt_pk_bf16_f32 v113, v113, v113
    v_lshlrev_b32 v113, 16, v113
    v_add_f32 v114, v114, v50
    v_cvt_pk_bf16_f32 v114, v114, v114
    v_lshlrev_b32 v114, 16, v114
    v_add_f32 v114, 1.0, v114
    v_cvt_pk_bf16_f32 v114, v114, v114
    v_lshlrev_b32 v114, 16, v114
    v_add_f32 v115, v115, v51
    v_cvt_pk_bf16_f32 v115, v115, v115
    v_lshlrev_b32 v115, 16, v115
    v_add_f32 v115, 1.0, v115
    v_cvt_pk_bf16_f32 v115, v115, v115
    v_lshlrev_b32 v115, 16, v115
    v_add_f32 v116, v116, v52
    v_cvt_pk_bf16_f32 v116, v116, v116
    v_lshlrev_b32 v116, 16, v116
    v_add_f32 v116, 1.0, v116
    v_cvt_pk_bf16_f32 v116, v116, v116
    v_lshlrev_b32 v116, 16, v116
    v_add_f32 v117, v117, v53
    v_cvt_pk_bf16_f32 v117, v117, v117
    v_lshlrev_b32 v117, 16, v117
    v_add_f32 v117, 1.0, v117
    v_cvt_pk_bf16_f32 v117, v117, v117
    v_lshlrev_b32 v117, 16, v117
    v_add_f32 v118, v118, v54
    v_cvt_pk_bf16_f32 v118, v118, v118
    v_lshlrev_b32 v118, 16, v118
    v_add_f32 v118, 1.0, v118
    v_cvt_pk_bf16_f32 v118, v118, v118
    v_lshlrev_b32 v118, 16, v118
    v_add_f32 v119, v119, v55
    v_cvt_pk_bf16_f32 v119, v119, v119
    v_lshlrev_b32 v119, 16, v119
    v_add_f32 v119, 1.0, v119
    v_cvt_pk_bf16_f32 v119, v119, v119
    v_lshlrev_b32 v119, 16, v119
    v_add_f32 v120, v120, v56
    v_cvt_pk_bf16_f32 v120, v120, v120
    v_lshlrev_b32 v120, 16, v120
    v_add_f32 v120, 1.0, v120
    v_cvt_pk_bf16_f32 v120, v120, v120
    v_lshlrev_b32 v120, 16, v120
    v_add_f32 v121, v121, v57
    v_cvt_pk_bf16_f32 v121, v121, v121
    v_lshlrev_b32 v121, 16, v121
    v_add_f32 v121, 1.0, v121
    v_cvt_pk_bf16_f32 v121, v121, v121
    v_lshlrev_b32 v121, 16, v121
    v_add_f32 v122, v122, v58
    v_cvt_pk_bf16_f32 v122, v122, v122
    v_lshlrev_b32 v122, 16, v122
    v_add_f32 v122, 1.0, v122
    v_cvt_pk_bf16_f32 v122, v122, v122
    v_lshlrev_b32 v122, 16, v122
    v_add_f32 v123, v123, v59
    v_cvt_pk_bf16_f32 v123, v123, v123
    v_lshlrev_b32 v123, 16, v123
    v_add_f32 v123, 1.0, v123
    v_cvt_pk_bf16_f32 v123, v123, v123
    v_lshlrev_b32 v123, 16, v123
    v_add_f32 v124, v124, v60
    v_cvt_pk_bf16_f32 v124, v124, v124
    v_lshlrev_b32 v124, 16, v124
    v_add_f32 v124, 1.0, v124
    v_cvt_pk_bf16_f32 v124, v124, v124
    v_lshlrev_b32 v124, 16, v124
    v_add_f32 v125, v125, v61
    v_cvt_pk_bf16_f32 v125, v125, v125
    v_lshlrev_b32 v125, 16, v125
    v_add_f32 v125, 1.0, v125
    v_cvt_pk_bf16_f32 v125, v125, v125
    v_lshlrev_b32 v125, 16, v125
    v_add_f32 v126, v126, v62
    v_cvt_pk_bf16_f32 v126, v126, v126
    v_lshlrev_b32 v126, 16, v126
    v_add_f32 v126, 1.0, v126
    v_cvt_pk_bf16_f32 v126, v126, v126
    v_lshlrev_b32 v126, 16, v126
    v_add_f32 v127, v127, v63
    v_cvt_pk_bf16_f32 v127, v127, v127
    v_lshlrev_b32 v127, 16, v127
    v_add_f32 v127, 1.0, v127
    v_cvt_pk_bf16_f32 v127, v127, v127
    v_lshlrev_b32 v127, 16, v127
    v_mul_f32 v192, v192, v112
    v_cvt_pk_bf16_f32 v192, v192, v192
    v_lshlrev_b32 v192, 16, v192
    v_add_f32 v192, v192, v96
    v_mul_f32 v193, v193, v113
    v_cvt_pk_bf16_f32 v193, v193, v193
    v_lshlrev_b32 v193, 16, v193
    v_add_f32 v193, v193, v97
    v_mul_f32 v194, v194, v114
    v_cvt_pk_bf16_f32 v194, v194, v194
    v_lshlrev_b32 v194, 16, v194
    v_add_f32 v194, v194, v98
    v_mul_f32 v195, v195, v115
    v_cvt_pk_bf16_f32 v195, v195, v195
    v_lshlrev_b32 v195, 16, v195
    v_add_f32 v195, v195, v99
    v_mul_f32 v196, v196, v116
    v_cvt_pk_bf16_f32 v196, v196, v196
    v_lshlrev_b32 v196, 16, v196
    v_add_f32 v196, v196, v100
    v_mul_f32 v197, v197, v117
    v_cvt_pk_bf16_f32 v197, v197, v197
    v_lshlrev_b32 v197, 16, v197
    v_add_f32 v197, v197, v101
    v_mul_f32 v198, v198, v118
    v_cvt_pk_bf16_f32 v198, v198, v198
    v_lshlrev_b32 v198, 16, v198
    v_add_f32 v198, v198, v102
    v_mul_f32 v199, v199, v119
    v_cvt_pk_bf16_f32 v199, v199, v199
    v_lshlrev_b32 v199, 16, v199
    v_add_f32 v199, v199, v103
    v_mul_f32 v200, v200, v120
    v_cvt_pk_bf16_f32 v200, v200, v200
    v_lshlrev_b32 v200, 16, v200
    v_add_f32 v200, v200, v104
    v_mul_f32 v201, v201, v121
    v_cvt_pk_bf16_f32 v201, v201, v201
    v_lshlrev_b32 v201, 16, v201
    v_add_f32 v201, v201, v105
    v_mul_f32 v202, v202, v122
    v_cvt_pk_bf16_f32 v202, v202, v202
    v_lshlrev_b32 v202, 16, v202
    v_add_f32 v202, v202, v106
    v_mul_f32 v203, v203, v123
    v_cvt_pk_bf16_f32 v203, v203, v203
    v_lshlrev_b32 v203, 16, v203
    v_add_f32 v203, v203, v107
    v_mul_f32 v204, v204, v124
    v_cvt_pk_bf16_f32 v204, v204, v204
    v_lshlrev_b32 v204, 16, v204
    v_add_f32 v204, v204, v108
    v_mul_f32 v205, v205, v125
    v_cvt_pk_bf16_f32 v205, v205, v205
    v_lshlrev_b32 v205, 16, v205
    v_add_f32 v205, v205, v109
    v_mul_f32 v206, v206, v126
    v_cvt_pk_bf16_f32 v206, v206, v206
    v_lshlrev_b32 v206, 16, v206
    v_add_f32 v206, v206, v110
    v_mul_f32 v207, v207, v127
    v_cvt_pk_bf16_f32 v207, v207, v207
    v_lshlrev_b32 v207, 16, v207
    v_add_f32 v207, v207, v111
    v_cvt_pk_bf16_f32 v80, v192, v193
    v_cvt_pk_bf16_f32 v81, v194, v195
    v_cvt_pk_bf16_f32 v82, v196, v197
    v_cvt_pk_bf16_f32 v83, v198, v199
    v_cvt_pk_bf16_f32 v84, v200, v201
    v_cvt_pk_bf16_f32 v85, v202, v203
    v_cvt_pk_bf16_f32 v86, v204, v205
    v_cvt_pk_bf16_f32 v87, v206, v207
    s_lshr_b32 s45, s63, 5
    s_lshl_b32 s45, s45, 16
    s_and_b32 s46, s63, 31
    s_lshl_b32 s46, s46, 8
    s_add_u32 s45, s45, s46
    s_add_u32 s45, s45, 0x400000
    s_add_u32 s46, s45, 32768
    buffer_store_dwordx4 v[80:83], v2, s[12:15], s45 offen sc1
    buffer_store_dwordx4 v[84:87], v2, s[12:15], s46 offen sc1
    s_add_u32 s63, s63, 384
    v_mul_f32 v208, v208, v112
    v_cvt_pk_bf16_f32 v208, v208, v208
    v_lshlrev_b32 v208, 16, v208
    v_add_f32 v208, v208, v96
    v_mul_f32 v209, v209, v113
    v_cvt_pk_bf16_f32 v209, v209, v209
    v_lshlrev_b32 v209, 16, v209
    v_add_f32 v209, v209, v97
    v_mul_f32 v210, v210, v114
    v_cvt_pk_bf16_f32 v210, v210, v210
    v_lshlrev_b32 v210, 16, v210
    v_add_f32 v210, v210, v98
    v_mul_f32 v211, v211, v115
    v_cvt_pk_bf16_f32 v211, v211, v211
    v_lshlrev_b32 v211, 16, v211
    v_add_f32 v211, v211, v99
    v_mul_f32 v212, v212, v116
    v_cvt_pk_bf16_f32 v212, v212, v212
    v_lshlrev_b32 v212, 16, v212
    v_add_f32 v212, v212, v100
    v_mul_f32 v213, v213, v117
    v_cvt_pk_bf16_f32 v213, v213, v213
    v_lshlrev_b32 v213, 16, v213
    v_add_f32 v213, v213, v101
    v_mul_f32 v214, v214, v118
    v_cvt_pk_bf16_f32 v214, v214, v214
    v_lshlrev_b32 v214, 16, v214
    v_add_f32 v214, v214, v102
    v_mul_f32 v215, v215, v119
    v_cvt_pk_bf16_f32 v215, v215, v215
    v_lshlrev_b32 v215, 16, v215
    v_add_f32 v215, v215, v103
    v_mul_f32 v216, v216, v120
    v_cvt_pk_bf16_f32 v216, v216, v216
    v_lshlrev_b32 v216, 16, v216
    v_add_f32 v216, v216, v104
    v_mul_f32 v217, v217, v121
    v_cvt_pk_bf16_f32 v217, v217, v217
    v_lshlrev_b32 v217, 16, v217
    v_add_f32 v217, v217, v105
    v_mul_f32 v218, v218, v122
    v_cvt_pk_bf16_f32 v218, v218, v218
    v_lshlrev_b32 v218, 16, v218
    v_add_f32 v218, v218, v106
    v_mul_f32 v219, v219, v123
    v_cvt_pk_bf16_f32 v219, v219, v219
    v_lshlrev_b32 v219, 16, v219
    v_add_f32 v219, v219, v107
    v_mul_f32 v220, v220, v124
    v_cvt_pk_bf16_f32 v220, v220, v220
    v_lshlrev_b32 v220, 16, v220
    v_add_f32 v220, v220, v108
    v_mul_f32 v221, v221, v125
    v_cvt_pk_bf16_f32 v221, v221, v221
    v_lshlrev_b32 v221, 16, v221
    v_add_f32 v221, v221, v109
    v_mul_f32 v222, v222, v126
    v_cvt_pk_bf16_f32 v222, v222, v222
    v_lshlrev_b32 v222, 16, v222
    v_add_f32 v222, v222, v110
    v_mul_f32 v223, v223, v127
    v_cvt_pk_bf16_f32 v223, v223, v223
    v_lshlrev_b32 v223, 16, v223
    v_add_f32 v223, v223, v111
    v_cvt_pk_bf16_f32 v88, v208, v209
    v_cvt_pk_bf16_f32 v89, v210, v211
    v_cvt_pk_bf16_f32 v90, v212, v213
    v_cvt_pk_bf16_f32 v91, v214, v215
    v_cvt_pk_bf16_f32 v92, v216, v217
    v_cvt_pk_bf16_f32 v93, v218, v219
    v_cvt_pk_bf16_f32 v94, v220, v221
    v_cvt_pk_bf16_f32 v95, v222, v223
    s_lshr_b32 s45, s63, 5
    s_lshl_b32 s45, s45, 16
    s_and_b32 s46, s63, 31
    s_lshl_b32 s46, s46, 8
    s_add_u32 s45, s45, s46
    s_add_u32 s45, s45, 0x400000
    s_add_u32 s46, s45, 32768
    buffer_store_dwordx4 v[88:91], v2, s[12:15], s45 offen sc1
    buffer_store_dwordx4 v[92:95], v2, s[12:15], s46 offen sc1
    s_waitcnt vmcnt(2)
    s_barrier
    s_cmp_lg_u32 s44, 0
    s_cbranch_scc1 L_cnt_106
    v_mov_b32 v30, 1
    v_mov_b32 v31, 126976
    s_mov_b64 exec, 1
    buffer_atomic_add v30, v31, s[12:15], 0 offen sc1
    s_mov_b64 exec, -1
L_cnt_106:
    s_add_u32 s63, s63, 384
    v_lshlrev_b32 v64, 16, v144
    v_and_b32 v65, 0xffff0000, v144
    v_lshlrev_b32 v66, 16, v145
    v_and_b32 v67, 0xffff0000, v145
    v_lshlrev_b32 v68, 16, v146
    v_and_b32 v69, 0xffff0000, v146
    v_lshlrev_b32 v70, 16, v147
    v_and_b32 v71, 0xffff0000, v147
    v_lshlrev_b32 v72, 16, v148
    v_and_b32 v73, 0xffff0000, v148
    v_lshlrev_b32 v74, 16, v149
    v_and_b32 v75, 0xffff0000, v149
    v_lshlrev_b32 v76, 16, v150
    v_and_b32 v77, 0xffff0000, v150
    v_lshlrev_b32 v78, 16, v151
    v_and_b32 v79, 0xffff0000, v151
    v_add_f32 v26, v64, v65
    v_add_f32 v26, v26, v66
    v_add_f32 v26, v26, v67
    v_add_f32 v26, v26, v68
    v_add_f32 v26, v26, v69
    v_add_f32 v26, v26, v70
    v_add_f32 v26, v26, v71
    v_add_f32 v26, v26, v72
    v_add_f32 v26, v26, v73
    v_add_f32 v26, v26, v74
    v_add_f32 v26, v26, v75
    v_add_f32 v26, v26, v76
    v_add_f32 v26, v26, v77
    v_add_f32 v26, v26, v78
    v_add_f32 v26, v26, v79
    s_nop 1
    v_add_f32_dpp v26, v26, v26 row_shr:1 row_mask:0xf bank_mask:0xf bound_ctrl:0
    s_nop 1
    v_add_f32_dpp v26, v26, v26 row_shr:2 row_mask:0xf bank_mask:0xf bound_ctrl:0
    s_nop 1
    v_add_f32_dpp v26, v26, v26 row_shr:4 row_mask:0xf bank_mask:0xf bound_ctrl:0
    s_nop 1
    v_add_f32_dpp v26, v26, v26 row_shr:8 row_mask:0xf bank_mask:0xf bound_ctrl:0
    s_nop 1
    v_add_f32_dpp v26, v26, v26 row_bcast:15 row_mask:0xa bank_mask:0xf
    s_nop 1
    v_add_f32_dpp v26, v26, v26 row_bcast:31 row_mask:0xc bank_mask:0xf
    s_nop 1
    v_readlane_b32 s66, v26, 63
    s_nop 1
    v_mov_b32 v27, s66
    v_mul_f32 v27, 0x3a800000, v27
    v_mov_b32 v26, 0
    v_sub_f32 v28, v64, v27
    v_fmac_f32 v26, v28, v28
    v_sub_f32 v28, v65, v27
    v_fmac_f32 v26, v28, v28
    v_sub_f32 v28, v66, v27
    v_fmac_f32 v26, v28, v28
    v_sub_f32 v28, v67, v27
    v_fmac_f32 v26, v28, v28
    v_sub_f32 v28, v68, v27
    v_fmac_f32 v26, v28, v28
    v_sub_f32 v28, v69, v27
    v_fmac_f32 v26, v28, v28
    v_sub_f32 v28, v70, v27
    v_fmac_f32 v26, v28, v28
    v_sub_f32 v28, v71, v27
    v_fmac_f32 v26, v28, v28
    v_sub_f32 v28, v72, v27
    v_fmac_f32 v26, v28, v28
    v_sub_f32 v28, v73, v27
    v_fmac_f32 v26, v28, v28
    v_sub_f32 v28, v74, v27
    v_fmac_f32 v26, v28, v28
    v_sub_f32 v28, v75, v27
    v_fmac_f32 v26, v28, v28
    v_sub_f32 v28, v76, v27
    v_fmac_f32 v26, v28, v28
    v_sub_f32 v28, v77, v27
    v_fmac_f32 v26, v28, v28
    v_sub_f32 v28, v78, v27
    v_fmac_f32 v26, v28, v28
    v_sub_f32 v28, v79, v27
    v_fmac_f32 v26, v28, v28
    s_nop 1
    v_add_f32_dpp v26, v26, v26 row_shr:1 row_mask:0xf bank_mask:0xf bound_ctrl:0
    s_nop 1
    v_add_f32_dpp v26, v26, v26 row_shr:2 row_mask:0xf bank_mask:0xf bound_ctrl:0
    s_nop 1
    v_add_f32_dpp v26, v26, v26 row_shr:4 row_mask:0xf bank_mask:0xf bound_ctrl:0
    s_nop 1
    v_add_f32_dpp v26, v26, v26 row_shr:8 row_mask:0xf bank_mask:0xf bound_ctrl:0
    s_nop 1
    v_add_f32_dpp v26, v26, v26 row_bcast:15 row_mask:0xa bank_mask:0xf
    s_nop 1
    v_add_f32_dpp v26, v26, v26 row_bcast:31 row_mask:0xc bank_mask:0xf
    s_nop 1
    v_readlane_b32 s66, v26, 63
    s_nop 1
    v_mov_b32 v26, s66
    v_mul_f32 v26, 0x3a800000, v26
    v_cvt_pk_bf16_f32 v26, v26, v26
    v_lshlrev_b32 v26, 16, v26
    v_cvt_pk_bf16_f32 v27, v27, v27
    v_lshlrev_b32 v27, 16, v27
    v_add_f32 v26, 0x3727c5ac, v26
    v_cvt_pk_bf16_f32 v26, v26, v26
    v_lshlrev_b32 v26, 16, v26
    v_sqrt_f32 v26, v26
    s_nop 0
    v_cvt_pk_bf16_f32 v26, v26, v26
    v_lshlrev_b32 v26, 16, v26
    v_rcp_f32 v26, v26
    s_nop 0
    v_sub_f32 v64, v64, v27
    v_cvt_pk_bf16_f32 v64, v64, v64
    v_lshlrev_b32 v64, 16, v64
    v_mul_f32 v64, v64, v26
    v_cvt_pk_bf16_f32 v64, v64, v64
    v_lshlrev_b32 v64, 16, v64
    v_sub_f32 v65, v65, v27
    v_cvt_pk_bf16_f32 v65, v65, v65
    v_lshlrev_b32 v65, 16, v65
    v_mul_f32 v65, v65, v26
    v_cvt_pk_bf16_f32 v65, v65, v65
    v_lshlrev_b32 v65, 16, v65
    v_sub_f32 v66, v66, v27
    v_cvt_pk_bf16_f32 v66, v66, v66
    v_lshlrev_b32 v66, 16, v66
    v_mul_f32 v66, v66, v26
    v_cvt_pk_bf16_f32 v66, v66, v66
    v_lshlrev_b32 v66, 16, v66
    v_sub_f32 v67, v67, v27
    v_cvt_pk_bf16_f32 v67, v67, v67
    v_lshlrev_b32 v67, 16, v67
    v_mul_f32 v67, v67, v26
    v_cvt_pk_bf16_f32 v67, v67, v67
    v_lshlrev_b32 v67, 16, v67
    v_sub_f32 v68, v68, v27
    v_cvt_pk_bf16_f32 v68, v68, v68
    v_lshlrev_b32 v68, 16, v68
    v_mul_f32 v68, v68, v26
    v_cvt_pk_bf16_f32 v68, v68, v68
    v_lshlrev_b32 v68, 16, v68
    v_sub_f32 v69, v69, v27
    v_cvt_pk_bf16_f32 v69, v69, v69
    v_lshlrev_b32 v69, 16, v69
    v_mul_f32 v69, v69, v26
    v_cvt_pk_bf16_f32 v69, v69, v69
    v_lshlrev_b32 v69, 16, v69
    v_sub_f32 v70, v70, v27
    v_cvt_pk_bf16_f32 v70, v70, v70
    v_lshlrev_b32 v70, 16, v70
    v_mul_f32 v70, v70, v26
    v_cvt_pk_bf16_f32 v70, v70, v70
    v_lshlrev_b32 v70, 16, v70
    v_sub_f32 v71, v71, v27
    v_cvt_pk_bf16_f32 v71, v71, v71
    v_lshlrev_b32 v71, 16, v71
    v_mul_f32 v71, v71, v26
    v_cvt_pk_bf16_f32 v71, v71, v71
    v_lshlrev_b32 v71, 16, v71
    v_sub_f32 v72, v72, v27
    v_cvt_pk_bf16_f32 v72, v72, v72
    v_lshlrev_b32 v72, 16, v72
    v_mul_f32 v72, v72, v26
    v_cvt_pk_bf16_f32 v72, v72, v72
    v_lshlrev_b32 v72, 16, v72
    v_sub_f32 v73, v73, v27
    v_cvt_pk_bf16_f32 v73, v73, v73
    v_lshlrev_b32 v73, 16, v73
    v_mul_f32 v73, v73, v26
    v_cvt_pk_bf16_f32 v73, v73, v73
    v_lshlrev_b32 v73, 16, v73
    v_sub_f32 v74, v74, v27
    v_cvt_pk_bf16_f32 v74, v74, v74
    v_lshlrev_b32 v74, 16, v74
    v_mul_f32 v74, v74, v26
    v_cvt_pk_bf16_f32 v74, v74, v74
    v_lshlrev_b32 v74, 16, v74
    v_sub_f32 v75, v75, v27
    v_cvt_pk_bf16_f32 v75, v75, v75
    v_lshlrev_b32 v75, 16, v75
    v_mul_f32 v75, v75, v26
    v_cvt_pk_bf16_f32 v75, v75, v75
    v_lshlrev_b32 v75, 16, v75
    v_sub_f32 v76, v76, v27
    v_cvt_pk_bf16_f32 v76, v76, v76
    v_lshlrev_b32 v76, 16, v76
    v_mul_f32 v76, v76, v26
    v_cvt_pk_bf16_f32 v76, v76, v76
    v_lshlrev_b32 v76, 16, v76
    v_sub_f32 v77, v77, v27
    v_cvt_pk_bf16_f32 v77, v77, v77
    v_lshlrev_b32 v77, 16, v77
    v_mul_f32 v77, v77, v26
    v_cvt_pk_bf16_f32 v77, v77, v77
    v_lshlrev_b32 v77, 16, v77
    v_sub_f32 v78, v78, v27
    v_cvt_pk_bf16_f32 v78, v78, v78
    v_lshlrev_b32 v78, 16, v78
    v_mul_f32 v78, v78, v26
    v_cvt_pk_bf16_f32 v78, v78, v78
    v_lshlrev_b32 v78, 16, v78
    v_sub_f32 v79, v79, v27
    v_cvt_pk_bf16_f32 v79, v79, v79
    v_lshlrev_b32 v79, 16, v79
    v_mul_f32 v79, v79, v26
    v_cvt_pk_bf16_f32 v79, v79, v79
    v_lshlrev_b32 v79, 16, v79
    v_mul_f32 v64, v64, v112
    v_cvt_pk_bf16_f32 v64, v64, v64
    v_lshlrev_b32 v64, 16, v64
    v_add_f32 v64, v64, v96
    v_mul_f32 v65, v65, v113
    v_cvt_pk_bf16_f32 v65, v65, v65
    v_lshlrev_b32 v65, 16, v65
    v_add_f32 v65, v65, v97
    v_mul_f32 v66, v66, v114
    v_cvt_pk_bf16_f32 v66, v66, v66
    v_lshlrev_b32 v66, 16, v66
    v_add_f32 v66, v66, v98
    v_mul_f32 v67, v67, v115
    v_cvt_pk_bf16_f32 v67, v67, v67
    v_lshlrev_b32 v67, 16, v67
    v_add_f32 v67, v67, v99
    v_mul_f32 v68, v68, v116
    v_cvt_pk_bf16_f32 v68, v68, v68
    v_lshlrev_b32 v68, 16, v68
    v_add_f32 v68, v68, v100
    v_mul_f32 v69, v69, v117
    v_cvt_pk_bf16_f32 v69, v69, v69
    v_lshlrev_b32 v69, 16, v69
    v_add_f32 v69, v69, v101
    v_mul_f32 v70, v70, v118
    v_cvt_pk_bf16_f32 v70, v70, v70
    v_lshlrev_b32 v70, 16, v70
    v_add_f32 v70, v70, v102
    v_mul_f32 v71, v71, v119
    v_cvt_pk_bf16_f32 v71, v71, v71
    v_lshlrev_b32 v71, 16, v71
    v_add_f32 v71, v71, v103
    v_mul_f32 v72, v72, v120
    v_cvt_pk_bf16_f32 v72, v72, v72
    v_lshlrev_b32 v72, 16, v72
    v_add_f32 v72, v72, v104
    v_mul_f32 v73, v73, v121
    v_cvt_pk_bf16_f32 v73, v73, v73
    v_lshlrev_b32 v73, 16, v73
    v_add_f32 v73, v73, v105
    v_mul_f32 v74, v74, v122
    v_cvt_pk_bf16_f32 v74, v74, v74
    v_lshlrev_b32 v74, 16, v74
    v_add_f32 v74, v74, v106
    v_mul_f32 v75, v75, v123
    v_cvt_pk_bf16_f32 v75, v75, v75
    v_lshlrev_b32 v75, 16, v75
    v_add_f32 v75, v75, v107
    v_mul_f32 v76, v76, v124
    v_cvt_pk_bf16_f32 v76, v76, v76
    v_lshlrev_b32 v76, 16, v76
    v_add_f32 v76, v76, v108
    v_mul_f32 v77, v77, v125
    v_cvt_pk_bf16_f32 v77, v77, v77
    v_lshlrev_b32 v77, 16, v77
    v_add_f32 v77, v77, v109
    v_mul_f32 v78, v78, v126
    v_cvt_pk_bf16_f32 v78, v78, v78
    v_lshlrev_b32 v78, 16, v78
    v_add_f32 v78, v78, v110
    v_mul_f32 v79, v79, v127
    v_cvt_pk_bf16_f32 v79, v79, v79
    v_lshlrev_b32 v79, 16, v79
    v_add_f32 v79, v79, v111
    v_cvt_pk_bf16_f32 v80, v64, v65
    v_cvt_pk_bf16_f32 v81, v66, v67
    v_cvt_pk_bf16_f32 v82, v68, v69
    v_cvt_pk_bf16_f32 v83, v70, v71
    v_cvt_pk_bf16_f32 v84, v72, v73
    v_cvt_pk_bf16_f32 v85, v74, v75
    v_cvt_pk_bf16_f32 v86, v76, v77
    v_cvt_pk_bf16_f32 v87, v78, v79
    s_lshr_b32 s45, s63, 5
    s_lshl_b32 s45, s45, 16
    s_and_b32 s46, s63, 31
    s_lshl_b32 s46, s46, 8
    s_add_u32 s45, s45, s46
    s_add_u32 s45, s45, 0x400000
    s_add_u32 s46, s45, 32768
    buffer_store_dwordx4 v[80:83], v2, s[12:15], s45 offen sc1
    buffer_store_dwordx4 v[84:87], v2, s[12:15], s46 offen sc1
    s_add_u32 s63, s63, 384
    v_lshlrev_b32 v64, 16, v152
    v_and_b32 v65, 0xffff0000, v152
    v_lshlrev_b32 v66, 16, v153
    v_and_b32 v67, 0xffff0000, v153
    v_lshlrev_b32 v68, 16, v154
    v_and_b32 v69, 0xffff0000, v154
    v_lshlrev_b32 v70, 16, v155
    v_and_b32 v71, 0xffff0000, v155
    v_lshlrev_b32 v72, 16, v156
    v_and_b32 v73, 0xffff0000, v156
    v_lshlrev_b32 v74, 16, v157
    v_and_b32 v75, 0xffff0000, v157
    v_lshlrev_b32 v76, 16, v158
    v_and_b32 v77, 0xffff0000, v158
    v_lshlrev_b32 v78, 16, v159
    v_and_b32 v79, 0xffff0000, v159
    v_add_f32 v26, v64, v65
    v_add_f32 v26, v26, v66
    v_add_f32 v26, v26, v67
    v_add_f32 v26, v26, v68
    v_add_f32 v26, v26, v69
    v_add_f32 v26, v26, v70
    v_add_f32 v26, v26, v71
    v_add_f32 v26, v26, v72
    v_add_f32 v26, v26, v73
    v_add_f32 v26, v26, v74
    v_add_f32 v26, v26, v75
    v_add_f32 v26, v26, v76
    v_add_f32 v26, v26, v77
    v_add_f32 v26, v26, v78
    v_add_f32 v26, v26, v79
    s_nop 1
    v_add_f32_dpp v26, v26, v26 row_shr:1 row_mask:0xf bank_mask:0xf bound_ctrl:0
    s_nop 1
    v_add_f32_dpp v26, v26, v26 row_shr:2 row_mask:0xf bank_mask:0xf bound_ctrl:0
    s_nop 1
    v_add_f32_dpp v26, v26, v26 row_shr:4 row_mask:0xf bank_mask:0xf bound_ctrl:0
    s_nop 1
    v_add_f32_dpp v26, v26, v26 row_shr:8 row_mask:0xf bank_mask:0xf bound_ctrl:0
    s_nop 1
    v_add_f32_dpp v26, v26, v26 row_bcast:15 row_mask:0xa bank_mask:0xf
    s_nop 1
    v_add_f32_dpp v26, v26, v26 row_bcast:31 row_mask:0xc bank_mask:0xf
    s_nop 1
    v_readlane_b32 s66, v26, 63
    s_nop 1
    v_mov_b32 v27, s66
    v_mul_f32 v27, 0x3a800000, v27
    v_mov_b32 v26, 0
    v_sub_f32 v28, v64, v27
    v_fmac_f32 v26, v28, v28
    v_sub_f32 v28, v65, v27
    v_fmac_f32 v26, v28, v28
    v_sub_f32 v28, v66, v27
    v_fmac_f32 v26, v28, v28
    v_sub_f32 v28, v67, v27
    v_fmac_f32 v26, v28, v28
    v_sub_f32 v28, v68, v27
    v_fmac_f32 v26, v28, v28
    v_sub_f32 v28, v69, v27
    v_fmac_f32 v26, v28, v28
    v_sub_f32 v28, v70, v27
    v_fmac_f32 v26, v28, v28
    v_sub_f32 v28, v71, v27
    v_fmac_f32 v26, v28, v28
    v_sub_f32 v28, v72, v27
    v_fmac_f32 v26, v28, v28
    v_sub_f32 v28, v73, v27
    v_fmac_f32 v26, v28, v28
    v_sub_f32 v28, v74, v27
    v_fmac_f32 v26, v28, v28
    v_sub_f32 v28, v75, v27
    v_fmac_f32 v26, v28, v28
    v_sub_f32 v28, v76, v27
    v_fmac_f32 v26, v28, v28
    v_sub_f32 v28, v77, v27
    v_fmac_f32 v26, v28, v28
    v_sub_f32 v28, v78, v27
    v_fmac_f32 v26, v28, v28
    v_sub_f32 v28, v79, v27
    v_fmac_f32 v26, v28, v28
    s_nop 1
    v_add_f32_dpp v26, v26, v26 row_shr:1 row_mask:0xf bank_mask:0xf bound_ctrl:0
    s_nop 1
    v_add_f32_dpp v26, v26, v26 row_shr:2 row_mask:0xf bank_mask:0xf bound_ctrl:0
    s_nop 1
    v_add_f32_dpp v26, v26, v26 row_shr:4 row_mask:0xf bank_mask:0xf bound_ctrl:0
    s_nop 1
    v_add_f32_dpp v26, v26, v26 row_shr:8 row_mask:0xf bank_mask:0xf bound_ctrl:0
    s_nop 1
    v_add_f32_dpp v26, v26, v26 row_bcast:15 row_mask:0xa bank_mask:0xf
    s_nop 1
    v_add_f32_dpp v26, v26, v26 row_bcast:31 row_mask:0xc bank_mask:0xf
    s_nop 1
    v_readlane_b32 s66, v26, 63
    s_nop 1
    v_mov_b32 v26, s66
    v_mul_f32 v26, 0x3a800000, v26
    v_cvt_pk_bf16_f32 v26, v26, v26
    v_lshlrev_b32 v26, 16, v26
    v_cvt_pk_bf16_f32 v27, v27, v27
    v_lshlrev_b32 v27, 16, v27
    v_add_f32 v26, 0x3727c5ac, v26
    v_cvt_pk_bf16_f32 v26, v26, v26
    v_lshlrev_b32 v26, 16, v26
    v_sqrt_f32 v26, v26
    s_nop 0
    v_cvt_pk_bf16_f32 v26, v26, v26
    v_lshlrev_b32 v26, 16, v26
    v_rcp_f32 v26, v26
    s_nop 0
    v_sub_f32 v64, v64, v27
    v_cvt_pk_bf16_f32 v64, v64, v64
    v_lshlrev_b32 v64, 16, v64
    v_mul_f32 v64, v64, v26
    v_cvt_pk_bf16_f32 v64, v64, v64
    v_lshlrev_b32 v64, 16, v64
    v_sub_f32 v65, v65, v27
    v_cvt_pk_bf16_f32 v65, v65, v65
    v_lshlrev_b32 v65, 16, v65
    v_mul_f32 v65, v65, v26
    v_cvt_pk_bf16_f32 v65, v65, v65
    v_lshlrev_b32 v65, 16, v65
    v_sub_f32 v66, v66, v27
    v_cvt_pk_bf16_f32 v66, v66, v66
    v_lshlrev_b32 v66, 16, v66
    v_mul_f32 v66, v66, v26
    v_cvt_pk_bf16_f32 v66, v66, v66
    v_lshlrev_b32 v66, 16, v66
    v_sub_f32 v67, v67, v27
    v_cvt_pk_bf16_f32 v67, v67, v67
    v_lshlrev_b32 v67, 16, v67
    v_mul_f32 v67, v67, v26
    v_cvt_pk_bf16_f32 v67, v67, v67
    v_lshlrev_b32 v67, 16, v67
    v_sub_f32 v68, v68, v27
    v_cvt_pk_bf16_f32 v68, v68, v68
    v_lshlrev_b32 v68, 16, v68
    v_mul_f32 v68, v68, v26
    v_cvt_pk_bf16_f32 v68, v68, v68
    v_lshlrev_b32 v68, 16, v68
    v_sub_f32 v69, v69, v27
    v_cvt_pk_bf16_f32 v69, v69, v69
    v_lshlrev_b32 v69, 16, v69
    v_mul_f32 v69, v69, v26
    v_cvt_pk_bf16_f32 v69, v69, v69
    v_lshlrev_b32 v69, 16, v69
    v_sub_f32 v70, v70, v27
    v_cvt_pk_bf16_f32 v70, v70, v70
    v_lshlrev_b32 v70, 16, v70
    v_mul_f32 v70, v70, v26
    v_cvt_pk_bf16_f32 v70, v70, v70
    v_lshlrev_b32 v70, 16, v70
    v_sub_f32 v71, v71, v27
    v_cvt_pk_bf16_f32 v71, v71, v71
    v_lshlrev_b32 v71, 16, v71
    v_mul_f32 v71, v71, v26
    v_cvt_pk_bf16_f32 v71, v71, v71
    v_lshlrev_b32 v71, 16, v71
    v_sub_f32 v72, v72, v27
    v_cvt_pk_bf16_f32 v72, v72, v72
    v_lshlrev_b32 v72, 16, v72
    v_mul_f32 v72, v72, v26
    v_cvt_pk_bf16_f32 v72, v72, v72
    v_lshlrev_b32 v72, 16, v72
    v_sub_f32 v73, v73, v27
    v_cvt_pk_bf16_f32 v73, v73, v73
    v_lshlrev_b32 v73, 16, v73
    v_mul_f32 v73, v73, v26
    v_cvt_pk_bf16_f32 v73, v73, v73
    v_lshlrev_b32 v73, 16, v73
    v_sub_f32 v74, v74, v27
    v_cvt_pk_bf16_f32 v74, v74, v74
    v_lshlrev_b32 v74, 16, v74
    v_mul_f32 v74, v74, v26
    v_cvt_pk_bf16_f32 v74, v74, v74
    v_lshlrev_b32 v74, 16, v74
    v_sub_f32 v75, v75, v27
    v_cvt_pk_bf16_f32 v75, v75, v75
    v_lshlrev_b32 v75, 16, v75
    v_mul_f32 v75, v75, v26
    v_cvt_pk_bf16_f32 v75, v75, v75
    v_lshlrev_b32 v75, 16, v75
    v_sub_f32 v76, v76, v27
    v_cvt_pk_bf16_f32 v76, v76, v76
    v_lshlrev_b32 v76, 16, v76
    v_mul_f32 v76, v76, v26
    v_cvt_pk_bf16_f32 v76, v76, v76
    v_lshlrev_b32 v76, 16, v76
    v_sub_f32 v77, v77, v27
    v_cvt_pk_bf16_f32 v77, v77, v77
    v_lshlrev_b32 v77, 16, v77
    v_mul_f32 v77, v77, v26
    v_cvt_pk_bf16_f32 v77, v77, v77
    v_lshlrev_b32 v77, 16, v77
    v_sub_f32 v78, v78, v27
    v_cvt_pk_bf16_f32 v78, v78, v78
    v_lshlrev_b32 v78, 16, v78
    v_mul_f32 v78, v78, v26
    v_cvt_pk_bf16_f32 v78, v78, v78
    v_lshlrev_b32 v78, 16, v78
    v_sub_f32 v79, v79, v27
    v_cvt_pk_bf16_f32 v79, v79, v79
    v_lshlrev_b32 v79, 16, v79
    v_mul_f32 v79, v79, v26
    v_cvt_pk_bf16_f32 v79, v79, v79
    v_lshlrev_b32 v79, 16, v79
    v_mul_f32 v64, v64, v112
    v_cvt_pk_bf16_f32 v64, v64, v64
    v_lshlrev_b32 v64, 16, v64
    v_add_f32 v64, v64, v96
    v_mul_f32 v65, v65, v113
    v_cvt_pk_bf16_f32 v65, v65, v65
    v_lshlrev_b32 v65, 16, v65
    v_add_f32 v65, v65, v97
    v_mul_f32 v66, v66, v114
    v_cvt_pk_bf16_f32 v66, v66, v66
    v_lshlrev_b32 v66, 16, v66
    v_add_f32 v66, v66, v98
    v_mul_f32 v67, v67, v115
    v_cvt_pk_bf16_f32 v67, v67, v67
    v_lshlrev_b32 v67, 16, v67
    v_add_f32 v67, v67, v99
    v_mul_f32 v68, v68, v116
    v_cvt_pk_bf16_f32 v68, v68, v68
    v_lshlrev_b32 v68, 16, v68
    v_add_f32 v68, v68, v100
    v_mul_f32 v69, v69, v117
    v_cvt_pk_bf16_f32 v69, v69, v69
    v_lshlrev_b32 v69, 16, v69
    v_add_f32 v69, v69, v101
    v_mul_f32 v70, v70, v118
    v_cvt_pk_bf16_f32 v70, v70, v70
    v_lshlrev_b32 v70, 16, v70
    v_add_f32 v70, v70, v102
    v_mul_f32 v71, v71, v119
    v_cvt_pk_bf16_f32 v71, v71, v71
    v_lshlrev_b32 v71, 16, v71
    v_add_f32 v71, v71, v103
    v_mul_f32 v72, v72, v120
    v_cvt_pk_bf16_f32 v72, v72, v72
    v_lshlrev_b32 v72, 16, v72
    v_add_f32 v72, v72, v104
    v_mul_f32 v73, v73, v121
    v_cvt_pk_bf16_f32 v73, v73, v73
    v_lshlrev_b32 v73, 16, v73
    v_add_f32 v73, v73, v105
    v_mul_f32 v74, v74, v122
    v_cvt_pk_bf16_f32 v74, v74, v74
    v_lshlrev_b32 v74, 16, v74
    v_add_f32 v74, v74, v106
    v_mul_f32 v75, v75, v123
    v_cvt_pk_bf16_f32 v75, v75, v75
    v_lshlrev_b32 v75, 16, v75
    v_add_f32 v75, v75, v107
    v_mul_f32 v76, v76, v124
    v_cvt_pk_bf16_f32 v76, v76, v76
    v_lshlrev_b32 v76, 16, v76
    v_add_f32 v76, v76, v108
    v_mul_f32 v77, v77, v125
    v_cvt_pk_bf16_f32 v77, v77, v77
    v_lshlrev_b32 v77, 16, v77
    v_add_f32 v77, v77, v109
    v_mul_f32 v78, v78, v126
    v_cvt_pk_bf16_f32 v78, v78, v78
    v_lshlrev_b32 v78, 16, v78
    v_add_f32 v78, v78, v110
    v_mul_f32 v79, v79, v127
    v_cvt_pk_bf16_f32 v79, v79, v79
    v_lshlrev_b32 v79, 16, v79
    v_add_f32 v79, v79, v111
    v_cvt_pk_bf16_f32 v80, v64, v65
    v_cvt_pk_bf16_f32 v81, v66, v67
    v_cvt_pk_bf16_f32 v82, v68, v69
    v_cvt_pk_bf16_f32 v83, v70, v71
    v_cvt_pk_bf16_f32 v84, v72, v73
    v_cvt_pk_bf16_f32 v85, v74, v75
    v_cvt_pk_bf16_f32 v86, v76, v77
    v_cvt_pk_bf16_f32 v87, v78, v79
    s_lshr_b32 s45, s63, 5
    s_lshl_b32 s45, s45, 16
    s_and_b32 s46, s63, 31
    s_lshl_b32 s46, s46, 8
    s_add_u32 s45, s45, s46
    s_add_u32 s45, s45, 0x400000
    s_add_u32 s46, s45, 32768
    buffer_store_dwordx4 v[80:83], v2, s[12:15], s45 offen sc1
    buffer_store_dwordx4 v[84:87], v2, s[12:15], s46 offen sc1
    s_add_u32 s63, s63, 384
    v_lshlrev_b32 v64, 16, v160
    v_and_b32 v65, 0xffff0000, v160
    v_lshlrev_b32 v66, 16, v161
    v_and_b32 v67, 0xffff0000, v161
    v_lshlrev_b32 v68, 16, v162
    v_and_b32 v69, 0xffff0000, v162
    v_lshlrev_b32 v70, 16, v163
    v_and_b32 v71, 0xffff0000, v163
    v_lshlrev_b32 v72, 16, v164
    v_and_b32 v73, 0xffff0000, v164
    v_lshlrev_b32 v74, 16, v165
    v_and_b32 v75, 0xffff0000, v165
    v_lshlrev_b32 v76, 16, v166
    v_and_b32 v77, 0xffff0000, v166
    v_lshlrev_b32 v78, 16, v167
    v_and_b32 v79, 0xffff0000, v167
    v_add_f32 v26, v64, v65
    v_add_f32 v26, v26, v66
    v_add_f32 v26, v26, v67
    v_add_f32 v26, v26, v68
    v_add_f32 v26, v26, v69
    v_add_f32 v26, v26, v70
    v_add_f32 v26, v26, v71
    v_add_f32 v26, v26, v72
    v_add_f32 v26, v26, v73
    v_add_f32 v26, v26, v74
    v_add_f32 v26, v26, v75
    v_add_f32 v26, v26, v76
    v_add_f32 v26, v26, v77
    v_add_f32 v26, v26, v78
    v_add_f32 v26, v26, v79
    s_nop 1
    v_add_f32_dpp v26, v26, v26 row_shr:1 row_mask:0xf bank_mask:0xf bound_ctrl:0
    s_nop 1
    v_add_f32_dpp v26, v26, v26 row_shr:2 row_mask:0xf bank_mask:0xf bound_ctrl:0
    s_nop 1
    v_add_f32_dpp v26, v26, v26 row_shr:4 row_mask:0xf bank_mask:0xf bound_ctrl:0
    s_nop 1
    v_add_f32_dpp v26, v26, v26 row_shr:8 row_mask:0xf bank_mask:0xf bound_ctrl:0
    s_nop 1
    v_add_f32_dpp v26, v26, v26 row_bcast:15 row_mask:0xa bank_mask:0xf
    s_nop 1
    v_add_f32_dpp v26, v26, v26 row_bcast:31 row_mask:0xc bank_mask:0xf
    s_nop 1
    v_readlane_b32 s66, v26, 63
    s_nop 1
    v_mov_b32 v27, s66
    v_mul_f32 v27, 0x3a800000, v27
    v_mov_b32 v26, 0
    v_sub_f32 v28, v64, v27
    v_fmac_f32 v26, v28, v28
    v_sub_f32 v28, v65, v27
    v_fmac_f32 v26, v28, v28
    v_sub_f32 v28, v66, v27
    v_fmac_f32 v26, v28, v28
    v_sub_f32 v28, v67, v27
    v_fmac_f32 v26, v28, v28
    v_sub_f32 v28, v68, v27
    v_fmac_f32 v26, v28, v28
    v_sub_f32 v28, v69, v27
    v_fmac_f32 v26, v28, v28
    v_sub_f32 v28, v70, v27
    v_fmac_f32 v26, v28, v28
    v_sub_f32 v28, v71, v27
    v_fmac_f32 v26, v28, v28
    v_sub_f32 v28, v72, v27
    v_fmac_f32 v26, v28, v28
    v_sub_f32 v28, v73, v27
    v_fmac_f32 v26, v28, v28
    v_sub_f32 v28, v74, v27
    v_fmac_f32 v26, v28, v28
    v_sub_f32 v28, v75, v27
    v_fmac_f32 v26, v28, v28
    v_sub_f32 v28, v76, v27
    v_fmac_f32 v26, v28, v28
    v_sub_f32 v28, v77, v27
    v_fmac_f32 v26, v28, v28
    v_sub_f32 v28, v78, v27
    v_fmac_f32 v26, v28, v28
    v_sub_f32 v28, v79, v27
    v_fmac_f32 v26, v28, v28
    s_nop 1
    v_add_f32_dpp v26, v26, v26 row_shr:1 row_mask:0xf bank_mask:0xf bound_ctrl:0
    s_nop 1
    v_add_f32_dpp v26, v26, v26 row_shr:2 row_mask:0xf bank_mask:0xf bound_ctrl:0
    s_nop 1
    v_add_f32_dpp v26, v26, v26 row_shr:4 row_mask:0xf bank_mask:0xf bound_ctrl:0
    s_nop 1
    v_add_f32_dpp v26, v26, v26 row_shr:8 row_mask:0xf bank_mask:0xf bound_ctrl:0
    s_nop 1
    v_add_f32_dpp v26, v26, v26 row_bcast:15 row_mask:0xa bank_mask:0xf
    s_nop 1
    v_add_f32_dpp v26, v26, v26 row_bcast:31 row_mask:0xc bank_mask:0xf
    s_nop 1
    v_readlane_b32 s66, v26, 63
    s_nop 1
    v_mov_b32 v26, s66
    v_mul_f32 v26, 0x3a800000, v26
    v_cvt_pk_bf16_f32 v26, v26, v26
    v_lshlrev_b32 v26, 16, v26
    v_cvt_pk_bf16_f32 v27, v27, v27
    v_lshlrev_b32 v27, 16, v27
    v_add_f32 v26, 0x3727c5ac, v26
    v_cvt_pk_bf16_f32 v26, v26, v26
    v_lshlrev_b32 v26, 16, v26
    v_sqrt_f32 v26, v26
    s_nop 0
    v_cvt_pk_bf16_f32 v26, v26, v26
    v_lshlrev_b32 v26, 16, v26
    v_rcp_f32 v26, v26
    s_nop 0
    v_sub_f32 v64, v64, v27
    v_cvt_pk_bf16_f32 v64, v64, v64
    v_lshlrev_b32 v64, 16, v64
    v_mul_f32 v64, v64, v26
    v_cvt_pk_bf16_f32 v64, v64, v64
    v_lshlrev_b32 v64, 16, v64
    v_sub_f32 v65, v65, v27
    v_cvt_pk_bf16_f32 v65, v65, v65
    v_lshlrev_b32 v65, 16, v65
    v_mul_f32 v65, v65, v26
    v_cvt_pk_bf16_f32 v65, v65, v65
    v_lshlrev_b32 v65, 16, v65
    v_sub_f32 v66, v66, v27
    v_cvt_pk_bf16_f32 v66, v66, v66
    v_lshlrev_b32 v66, 16, v66
    v_mul_f32 v66, v66, v26
    v_cvt_pk_bf16_f32 v66, v66, v66
    v_lshlrev_b32 v66, 16, v66
    v_sub_f32 v67, v67, v27
    v_cvt_pk_bf16_f32 v67, v67, v67
    v_lshlrev_b32 v67, 16, v67
    v_mul_f32 v67, v67, v26
    v_cvt_pk_bf16_f32 v67, v67, v67
    v_lshlrev_b32 v67, 16, v67
    v_sub_f32 v68, v68, v27
    v_cvt_pk_bf16_f32 v68, v68, v68
    v_lshlrev_b32 v68, 16, v68
    v_mul_f32 v68, v68, v26
    v_cvt_pk_bf16_f32 v68, v68, v68
    v_lshlrev_b32 v68, 16, v68
    v_sub_f32 v69, v69, v27
    v_cvt_pk_bf16_f32 v69, v69, v69
    v_lshlrev_b32 v69, 16, v69
    v_mul_f32 v69, v69, v26
    v_cvt_pk_bf16_f32 v69, v69, v69
    v_lshlrev_b32 v69, 16, v69
    v_sub_f32 v70, v70, v27
    v_cvt_pk_bf16_f32 v70, v70, v70
    v_lshlrev_b32 v70, 16, v70
    v_mul_f32 v70, v70, v26
    v_cvt_pk_bf16_f32 v70, v70, v70
    v_lshlrev_b32 v70, 16, v70
    v_sub_f32 v71, v71, v27
    v_cvt_pk_bf16_f32 v71, v71, v71
    v_lshlrev_b32 v71, 16, v71
    v_mul_f32 v71, v71, v26
    v_cvt_pk_bf16_f32 v71, v71, v71
    v_lshlrev_b32 v71, 16, v71
    v_sub_f32 v72, v72, v27
    v_cvt_pk_bf16_f32 v72, v72, v72
    v_lshlrev_b32 v72, 16, v72
    v_mul_f32 v72, v72, v26
    v_cvt_pk_bf16_f32 v72, v72, v72
    v_lshlrev_b32 v72, 16, v72
    v_sub_f32 v73, v73, v27
    v_cvt_pk_bf16_f32 v73, v73, v73
    v_lshlrev_b32 v73, 16, v73
    v_mul_f32 v73, v73, v26
    v_cvt_pk_bf16_f32 v73, v73, v73
    v_lshlrev_b32 v73, 16, v73
    v_sub_f32 v74, v74, v27
    v_cvt_pk_bf16_f32 v74, v74, v74
    v_lshlrev_b32 v74, 16, v74
    v_mul_f32 v74, v74, v26
    v_cvt_pk_bf16_f32 v74, v74, v74
    v_lshlrev_b32 v74, 16, v74
    v_sub_f32 v75, v75, v27
    v_cvt_pk_bf16_f32 v75, v75, v75
    v_lshlrev_b32 v75, 16, v75
    v_mul_f32 v75, v75, v26
    v_cvt_pk_bf16_f32 v75, v75, v75
    v_lshlrev_b32 v75, 16, v75
    v_sub_f32 v76, v76, v27
    v_cvt_pk_bf16_f32 v76, v76, v76
    v_lshlrev_b32 v76, 16, v76
    v_mul_f32 v76, v76, v26
    v_cvt_pk_bf16_f32 v76, v76, v76
    v_lshlrev_b32 v76, 16, v76
    v_sub_f32 v77, v77, v27
    v_cvt_pk_bf16_f32 v77, v77, v77
    v_lshlrev_b32 v77, 16, v77
    v_mul_f32 v77, v77, v26
    v_cvt_pk_bf16_f32 v77, v77, v77
    v_lshlrev_b32 v77, 16, v77
    v_sub_f32 v78, v78, v27
    v_cvt_pk_bf16_f32 v78, v78, v78
    v_lshlrev_b32 v78, 16, v78
    v_mul_f32 v78, v78, v26
    v_cvt_pk_bf16_f32 v78, v78, v78
    v_lshlrev_b32 v78, 16, v78
    v_sub_f32 v79, v79, v27
    v_cvt_pk_bf16_f32 v79, v79, v79
    v_lshlrev_b32 v79, 16, v79
    v_mul_f32 v79, v79, v26
    v_cvt_pk_bf16_f32 v79, v79, v79
    v_lshlrev_b32 v79, 16, v79
    v_mul_f32 v64, v64, v112
    v_cvt_pk_bf16_f32 v64, v64, v64
    v_lshlrev_b32 v64, 16, v64
    v_add_f32 v64, v64, v96
    v_mul_f32 v65, v65, v113
    v_cvt_pk_bf16_f32 v65, v65, v65
    v_lshlrev_b32 v65, 16, v65
    v_add_f32 v65, v65, v97
    v_mul_f32 v66, v66, v114
    v_cvt_pk_bf16_f32 v66, v66, v66
    v_lshlrev_b32 v66, 16, v66
    v_add_f32 v66, v66, v98
    v_mul_f32 v67, v67, v115
    v_cvt_pk_bf16_f32 v67, v67, v67
    v_lshlrev_b32 v67, 16, v67
    v_add_f32 v67, v67, v99
    v_mul_f32 v68, v68, v116
    v_cvt_pk_bf16_f32 v68, v68, v68
    v_lshlrev_b32 v68, 16, v68
    v_add_f32 v68, v68, v100
    v_mul_f32 v69, v69, v117
    v_cvt_pk_bf16_f32 v69, v69, v69
    v_lshlrev_b32 v69, 16, v69
    v_add_f32 v69, v69, v101
    v_mul_f32 v70, v70, v118
    v_cvt_pk_bf16_f32 v70, v70, v70
    v_lshlrev_b32 v70, 16, v70
    v_add_f32 v70, v70, v102
    v_mul_f32 v71, v71, v119
    v_cvt_pk_bf16_f32 v71, v71, v71
    v_lshlrev_b32 v71, 16, v71
    v_add_f32 v71, v71, v103
    v_mul_f32 v72, v72, v120
    v_cvt_pk_bf16_f32 v72, v72, v72
    v_lshlrev_b32 v72, 16, v72
    v_add_f32 v72, v72, v104
    v_mul_f32 v73, v73, v121
    v_cvt_pk_bf16_f32 v73, v73, v73
    v_lshlrev_b32 v73, 16, v73
    v_add_f32 v73, v73, v105
    v_mul_f32 v74, v74, v122
    v_cvt_pk_bf16_f32 v74, v74, v74
    v_lshlrev_b32 v74, 16, v74
    v_add_f32 v74, v74, v106
    v_mul_f32 v75, v75, v123
    v_cvt_pk_bf16_f32 v75, v75, v75
    v_lshlrev_b32 v75, 16, v75
    v_add_f32 v75, v75, v107
    v_mul_f32 v76, v76, v124
    v_cvt_pk_bf16_f32 v76, v76, v76
    v_lshlrev_b32 v76, 16, v76
    v_add_f32 v76, v76, v108
    v_mul_f32 v77, v77, v125
    v_cvt_pk_bf16_f32 v77, v77, v77
    v_lshlrev_b32 v77, 16, v77
    v_add_f32 v77, v77, v109
    v_mul_f32 v78, v78, v126
    v_cvt_pk_bf16_f32 v78, v78, v78
    v_lshlrev_b32 v78, 16, v78
    v_add_f32 v78, v78, v110
    v_mul_f32 v79, v79, v127
    v_cvt_pk_bf16_f32 v79, v79, v79
    v_lshlrev_b32 v79, 16, v79
    v_add_f32 v79, v79, v111
    v_cvt_pk_bf16_f32 v80, v64, v65
    v_cvt_pk_bf16_f32 v81, v66, v67
    v_cvt_pk_bf16_f32 v82, v68, v69
    v_cvt_pk_bf16_f32 v83, v70, v71
    v_cvt_pk_bf16_f32 v84, v72, v73
    v_cvt_pk_bf16_f32 v85, v74, v75
    v_cvt_pk_bf16_f32 v86, v76, v77
    v_cvt_pk_bf16_f32 v87, v78, v79
    s_lshr_b32 s45, s63, 5
    s_lshl_b32 s45, s45, 16
    s_and_b32 s46, s63, 31
    s_lshl_b32 s46, s46, 8
    s_add_u32 s45, s45, s46
    s_add_u32 s45, s45, 0x400000
    s_add_u32 s46, s45, 32768
    buffer_store_dwordx4 v[80:83], v2, s[12:15], s45 offen sc1
    buffer_store_dwordx4 v[84:87], v2, s[12:15], s46 offen sc1
    s_add_u32 s63, s63, 384
    s_cmp_ge_u32 s63, 2048
    s_cbranch_scc1 L_ln_done_105
    v_lshlrev_b32 v64, 16, v168
    v_and_b32 v65, 0xffff0000, v168
    v_lshlrev_b32 v66, 16, v169
    v_and_b32 v67, 0xffff0000, v169
    v_lshlrev_b32 v68, 16, v170
    v_and_b32 v69, 0xffff0000, v170
    v_lshlrev_b32 v70, 16, v171
    v_and_b32 v71, 0xffff0000, v171
    v_lshlrev_b32 v72, 16, v172
    v_and_b32 v73, 0xffff0000, v172
    v_lshlrev_b32 v74, 16, v173
    v_and_b32 v75, 0xffff0000, v173
    v_lshlrev_b32 v76, 16, v174
    v_and_b32 v77, 0xffff0000, v174
    v_lshlrev_b32 v78, 16, v175
    v_and_b32 v79, 0xffff0000, v175
    v_add_f32 v26, v64, v65
    v_add_f32 v26, v26, v66
    v_add_f32 v26, v26, v67
    v_add_f32 v26, v26, v68
    v_add_f32 v26, v26, v69
    v_add_f32 v26, v26, v70
    v_add_f32 v26, v26, v71
    v_add_f32 v26, v26, v72
    v_add_f32 v26, v26, v73
    v_add_f32 v26, v26, v74
    v_add_f32 v26, v26, v75
    v_add_f32 v26, v26, v76
    v_add_f32 v26, v26, v77
    v_add_f32 v26, v26, v78
    v_add_f32 v26, v26, v79
    s_nop 1
    v_add_f32_dpp v26, v26, v26 row_shr:1 row_mask:0xf bank_mask:0xf bound_ctrl:0
    s_nop 1
    v_add_f32_dpp v26, v26, v26 row_shr:2 row_mask:0xf bank_mask:0xf bound_ctrl:0
    s_nop 1
    v_add_f32_dpp v26, v26, v26 row_shr:4 row_mask:0xf bank_mask:0xf bound_ctrl:0
    s_nop 1
    v_add_f32_dpp v26, v26, v26 row_shr:8 row_mask:0xf bank_mask:0xf bound_ctrl:0
    s_nop 1
    v_add_f32_dpp v26, v26, v26 row_bcast:15 row_mask:0xa bank_mask:0xf
    s_nop 1
    v_add_f32_dpp v26, v26, v26 row_bcast:31 row_mask:0xc bank_mask:0xf
    s_nop 1
    v_readlane_b32 s66, v26, 63
    s_nop 1
    v_mov_b32 v27, s66
    v_mul_f32 v27, 0x3a800000, v27
    v_mov_b32 v26, 0
    v_sub_f32 v28, v64, v27
    v_fmac_f32 v26, v28, v28
    v_sub_f32 v28, v65, v27
    v_fmac_f32 v26, v28, v28
    v_sub_f32 v28, v66, v27
    v_fmac_f32 v26, v28, v28
    v_sub_f32 v28, v67, v27
    v_fmac_f32 v26, v28, v28
    v_sub_f32 v28, v68, v27
    v_fmac_f32 v26, v28, v28
    v_sub_f32 v28, v69, v27
    v_fmac_f32 v26, v28, v28
    v_sub_f32 v28, v70, v27
    v_fmac_f32 v26, v28, v28
    v_sub_f32 v28, v71, v27
    v_fmac_f32 v26, v28, v28
    v_sub_f32 v28, v72, v27
    v_fmac_f32 v26, v28, v28
    v_sub_f32 v28, v73, v27
    v_fmac_f32 v26, v28, v28
    v_sub_f32 v28, v74, v27
    v_fmac_f32 v26, v28, v28
    v_sub_f32 v28, v75, v27
    v_fmac_f32 v26, v28, v28
    v_sub_f32 v28, v76, v27
    v_fmac_f32 v26, v28, v28
    v_sub_f32 v28, v77, v27
    v_fmac_f32 v26, v28, v28
    v_sub_f32 v28, v78, v27
    v_fmac_f32 v26, v28, v28
    v_sub_f32 v28, v79, v27
    v_fmac_f32 v26, v28, v28
    s_nop 1
    v_add_f32_dpp v26, v26, v26 row_shr:1 row_mask:0xf bank_mask:0xf bound_ctrl:0
    s_nop 1
    v_add_f32_dpp v26, v26, v26 row_shr:2 row_mask:0xf bank_mask:0xf bound_ctrl:0
    s_nop 1
    v_add_f32_dpp v26, v26, v26 row_shr:4 row_mask:0xf bank_mask:0xf bound_ctrl:0
    s_nop 1
    v_add_f32_dpp v26, v26, v26 row_shr:8 row_mask:0xf bank_mask:0xf bound_ctrl:0
    s_nop 1
    v_add_f32_dpp v26, v26, v26 row_bcast:15 row_mask:0xa bank_mask:0xf
    s_nop 1
    v_add_f32_dpp v26, v26, v26 row_bcast:31 row_mask:0xc bank_mask:0xf
    s_nop 1
    v_readlane_b32 s66, v26, 63
    s_nop 1
    v_mov_b32 v26, s66
    v_mul_f32 v26, 0x3a800000, v26
    v_cvt_pk_bf16_f32 v26, v26, v26
    v_lshlrev_b32 v26, 16, v26
    v_cvt_pk_bf16_f32 v27, v27, v27
    v_lshlrev_b32 v27, 16, v27
    v_add_f32 v26, 0x3727c5ac, v26
    v_cvt_pk_bf16_f32 v26, v26, v26
    v_lshlrev_b32 v26, 16, v26
    v_sqrt_f32 v26, v26
    s_nop 0
    v_cvt_pk_bf16_f32 v26, v26, v26
    v_lshlrev_b32 v26, 16, v26
    v_rcp_f32 v26, v26
    s_nop 0
    v_sub_f32 v64, v64, v27
    v_cvt_pk_bf16_f32 v64, v64, v64
    v_lshlrev_b32 v64, 16, v64
    v_mul_f32 v64, v64, v26
    v_cvt_pk_bf16_f32 v64, v64, v64
    v_lshlrev_b32 v64, 16, v64
    v_sub_f32 v65, v65, v27
    v_cvt_pk_bf16_f32 v65, v65, v65
    v_lshlrev_b32 v65, 16, v65
    v_mul_f32 v65, v65, v26
    v_cvt_pk_bf16_f32 v65, v65, v65
    v_lshlrev_b32 v65, 16, v65
    v_sub_f32 v66, v66, v27
    v_cvt_pk_bf16_f32 v66, v66, v66
    v_lshlrev_b32 v66, 16, v66
    v_mul_f32 v66, v66, v26
    v_cvt_pk_bf16_f32 v66, v66, v66
    v_lshlrev_b32 v66, 16, v66
    v_sub_f32 v67, v67, v27
    v_cvt_pk_bf16_f32 v67, v67, v67
    v_lshlrev_b32 v67, 16, v67
    v_mul_f32 v67, v67, v26
    v_cvt_pk_bf16_f32 v67, v67, v67
    v_lshlrev_b32 v67, 16, v67
    v_sub_f32 v68, v68, v27
    v_cvt_pk_bf16_f32 v68, v68, v68
    v_lshlrev_b32 v68, 16, v68
    v_mul_f32 v68, v68, v26
    v_cvt_pk_bf16_f32 v68, v68, v68
    v_lshlrev_b32 v68, 16, v68
    v_sub_f32 v69, v69, v27
    v_cvt_pk_bf16_f32 v69, v69, v69
    v_lshlrev_b32 v69, 16, v69
    v_mul_f32 v69, v69, v26
    v_cvt_pk_bf16_f32 v69, v69, v69
    v_lshlrev_b32 v69, 16, v69
    v_sub_f32 v70, v70, v27
    v_cvt_pk_bf16_f32 v70, v70, v70
    v_lshlrev_b32 v70, 16, v70
    v_mul_f32 v70, v70, v26
    v_cvt_pk_bf16_f32 v70, v70, v70
    v_lshlrev_b32 v70, 16, v70
    v_sub_f32 v71, v71, v27
    v_cvt_pk_bf16_f32 v71, v71, v71
    v_lshlrev_b32 v71, 16, v71
    v_mul_f32 v71, v71, v26
    v_cvt_pk_bf16_f32 v71, v71, v71
    v_lshlrev_b32 v71, 16, v71
    v_sub_f32 v72, v72, v27
    v_cvt_pk_bf16_f32 v72, v72, v72
    v_lshlrev_b32 v72, 16, v72
    v_mul_f32 v72, v72, v26
    v_cvt_pk_bf16_f32 v72, v72, v72
    v_lshlrev_b32 v72, 16, v72
    v_sub_f32 v73, v73, v27
    v_cvt_pk_bf16_f32 v73, v73, v73
    v_lshlrev_b32 v73, 16, v73
    v_mul_f32 v73, v73, v26
    v_cvt_pk_bf16_f32 v73, v73, v73
    v_lshlrev_b32 v73, 16, v73
    v_sub_f32 v74, v74, v27
    v_cvt_pk_bf16_f32 v74, v74, v74
    v_lshlrev_b32 v74, 16, v74
    v_mul_f32 v74, v74, v26
    v_cvt_pk_bf16_f32 v74, v74, v74
    v_lshlrev_b32 v74, 16, v74
    v_sub_f32 v75, v75, v27
    v_cvt_pk_bf16_f32 v75, v75, v75
    v_lshlrev_b32 v75, 16, v75
    v_mul_f32 v75, v75, v26
    v_cvt_pk_bf16_f32 v75, v75, v75
    v_lshlrev_b32 v75, 16, v75
    v_sub_f32 v76, v76, v27
    v_cvt_pk_bf16_f32 v76, v76, v76
    v_lshlrev_b32 v76, 16, v76
    v_mul_f32 v76, v76, v26
    v_cvt_pk_bf16_f32 v76, v76, v76
    v_lshlrev_b32 v76, 16, v76
    v_sub_f32 v77, v77, v27
    v_cvt_pk_bf16_f32 v77, v77, v77
    v_lshlrev_b32 v77, 16, v77
    v_mul_f32 v77, v77, v26
    v_cvt_pk_bf16_f32 v77, v77, v77
    v_lshlrev_b32 v77, 16, v77
    v_sub_f32 v78, v78, v27
    v_cvt_pk_bf16_f32 v78, v78, v78
    v_lshlrev_b32 v78, 16, v78
    v_mul_f32 v78, v78, v26
    v_cvt_pk_bf16_f32 v78, v78, v78
    v_lshlrev_b32 v78, 16, v78
    v_sub_f32 v79, v79, v27
    v_cvt_pk_bf16_f32 v79, v79, v79
    v_lshlrev_b32 v79, 16, v79
    v_mul_f32 v79, v79, v26
    v_cvt_pk_bf16_f32 v79, v79, v79
    v_lshlrev_b32 v79, 16, v79
    v_mul_f32 v64, v64, v112
    v_cvt_pk_bf16_f32 v64, v64, v64
    v_lshlrev_b32 v64, 16, v64
    v_add_f32 v64, v64, v96
    v_mul_f32 v65, v65, v113
    v_cvt_pk_bf16_f32 v65, v65, v65
    v_lshlrev_b32 v65, 16, v65
    v_add_f32 v65, v65, v97
    v_mul_f32 v66, v66, v114
    v_cvt_pk_bf16_f32 v66, v66, v66
    v_lshlrev_b32 v66, 16, v66
    v_add_f32 v66, v66, v98
    v_mul_f32 v67, v67, v115
    v_cvt_pk_bf16_f32 v67, v67, v67
    v_lshlrev_b32 v67, 16, v67
    v_add_f32 v67, v67, v99
    v_mul_f32 v68, v68, v116
    v_cvt_pk_bf16_f32 v68, v68, v68
    v_lshlrev_b32 v68, 16, v68
    v_add_f32 v68, v68, v100
    v_mul_f32 v69, v69, v117
    v_cvt_pk_bf16_f32 v69, v69, v69
    v_lshlrev_b32 v69, 16, v69
    v_add_f32 v69, v69, v101
    v_mul_f32 v70, v70, v118
    v_cvt_pk_bf16_f32 v70, v70, v70
    v_lshlrev_b32 v70, 16, v70
    v_add_f32 v70, v70, v102
    v_mul_f32 v71, v71, v119
    v_cvt_pk_bf16_f32 v71, v71, v71
    v_lshlrev_b32 v71, 16, v71
    v_add_f32 v71, v71, v103
    v_mul_f32 v72, v72, v120
    v_cvt_pk_bf16_f32 v72, v72, v72
    v_lshlrev_b32 v72, 16, v72
    v_add_f32 v72, v72, v104
    v_mul_f32 v73, v73, v121
    v_cvt_pk_bf16_f32 v73, v73, v73
    v_lshlrev_b32 v73, 16, v73
    v_add_f32 v73, v73, v105
    v_mul_f32 v74, v74, v122
    v_cvt_pk_bf16_f32 v74, v74, v74
    v_lshlrev_b32 v74, 16, v74
    v_add_f32 v74, v74, v106
    v_mul_f32 v75, v75, v123
    v_cvt_pk_bf16_f32 v75, v75, v75
    v_lshlrev_b32 v75, 16, v75
    v_add_f32 v75, v75, v107
    v_mul_f32 v76, v76, v124
    v_cvt_pk_bf16_f32 v76, v76, v76
    v_lshlrev_b32 v76, 16, v76
    v_add_f32 v76, v76, v108
    v_mul_f32 v77, v77, v125
    v_cvt_pk_bf16_f32 v77, v77, v77
    v_lshlrev_b32 v77, 16, v77
    v_add_f32 v77, v77, v109
    v_mul_f32 v78, v78, v126
    v_cvt_pk_bf16_f32 v78, v78, v78
    v_lshlrev_b32 v78, 16, v78
    v_add_f32 v78, v78, v110
    v_mul_f32 v79, v79, v127
    v_cvt_pk_bf16_f32 v79, v79, v79
    v_lshlrev_b32 v79, 16, v79
    v_add_f32 v79, v79, v111
    v_cvt_pk_bf16_f32 v80, v64, v65
    v_cvt_pk_bf16_f32 v81, v66, v67
    v_cvt_pk_bf16_f32 v82, v68, v69
    v_cvt_pk_bf16_f32 v83, v70, v71
    v_cvt_pk_bf16_f32 v84, v72, v73
    v_cvt_pk_bf16_f32 v85, v74, v75
    v_cvt_pk_bf16_f32 v86, v76, v77
    v_cvt_pk_bf16_f32 v87, v78, v79
    s_lshr_b32 s45, s63, 5
    s_lshl_b32 s45, s45, 16
    s_and_b32 s46, s63, 31
    s_lshl_b32 s46, s46, 8
    s_add_u32 s45, s45, s46
    s_add_u32 s45, s45, 0x400000
    s_add_u32 s46, s45, 32768
    buffer_store_dwordx4 v[80:83], v2, s[12:15], s45 offen sc1
    buffer_store_dwordx4 v[84:87], v2, s[12:15], s46 offen sc1
    s_add_u32 s63, s63, 384
L_ln_done_105:
    s_waitcnt vmcnt(0)
    s_barrier
    s_cmp_lg_u32 s44, 0
    s_cbranch_scc1 L_cnt_107
    v_mov_b32 v30, 1
    v_mov_b32 v31, 127104
    s_mov_b64 exec, 1
    buffer_atomic_add v30, v31, s[12:15], 0 offen sc1
    s_mov_b64 exec, -1
L_cnt_107:
    s_add_u32 s39, s39, 96
    s_load_dwordx2 s[4:5], s[0:1], 96
    s_load_dwordx2 s[6:7], s[0:1], 104
    v_and_b32 v14, 7, v0
    v_lshrrev_b32 v15, 3, v0
    s_waitcnt lgkmcnt(0)
    s_mov_b32 s32, s4
    s_and_b32 s33, s5, 0xffff
    s_mov_b32 s34, 0x800
    s_mov_b32 s35, 0x00020000
    s_mov_b32 s24, s6
    s_and_b32 s25, s7, 0xffff
    s_mov_b32 s26, 0xc00000
    s_mov_b32 s27, 0x00020000
    s_and_b32 s47, s39, 1
    s_lshl_b32 s45, s47, 10
    v_lshlrev_b32 v16, 5, v15
    buffer_load_dwordx4 v[104:107], v16, s[32:35], s45 offen
    buffer_load_dwordx4 v[108:111], v16, s[32:35], s45 offen offset:16
    s_mov_b32 s45, 196608
    v_mul_lo_u32 v17, v15, s45
    v_lshlrev_b32 v18, 4, v14
    v_add_u32 v17, v17, v18
    s_lshr_b32 s46, s39, 1
    s_lshl_b32 s46, s46, 7
    s_mul_i32 s45, s47, 6291456
    s_add_u32 s46, s46, s45
    buffer_load_dwordx4 v[32:35], v17, s[24:27], s46 offen
    v_add_u32 v17, 12288, v17
    buffer_load_dwordx4 v[36:39], v17, s[24:27], s46 offen
    v_add_u32 v17, 12288, v17
    buffer_load_dwordx4 v[40:43], v17, s[24:27], s46 offen
    v_add_u32 v17, 12288, v17
    buffer_load_dwordx4 v[44:47], v17, s[24:27], s46 offen
    v_add_u32 v17, 12288, v17
    buffer_load_dwordx4 v[48:51], v17, s[24:27], s46 offen
    v_add_u32 v17, 12288, v17
    buffer_load_dwordx4 v[52:55], v17, s[24:27], s46 offen
    v_add_u32 v17, 12288, v17
    buffer_load_dwordx4 v[56:59], v17, s[24:27], s46 offen
    v_add_u32 v17, 12288, v17
    buffer_load_dwordx4 v[60:63], v17, s[24:27], s46 offen
    v_add_u32 v17, 12288, v17
    buffer_load_dwordx4 v[64:67], v17, s[24:27], s46 offen
    v_add_u32 v17, 12288, v17
    buffer_load_dwordx4 v[68:71], v17, s[24:27], s46 offen
    v_add_u32 v17, 12288, v17
    buffer_load_dwordx4 v[72:75], v17, s[24:27], s46 offen
    v_add_u32 v17, 12288, v17
    buffer_load_dwordx4 v[76:79], v17, s[24:27], s46 offen
    v_add_u32 v17, 12288, v17
    buffer_load_dwordx4 v[80:83], v17, s[24:27], s46 offen
    v_add_u32 v17, 12288, v17
    buffer_load_dwordx4 v[84:87], v17, s[24:27], s46 offen
    v_add_u32 v17, 12288, v17
    buffer_load_dwordx4 v[88:91], v17, s[24:27], s46 offen
    v_add_u32 v17, 12288, v17
    buffer_load_dwordx4 v[92:95], v17, s[24:27], s46 offen
    s_waitcnt vmcnt(16)
    v_lshlrev_b32 v112, 16, v104
    v_and_b32 v113, 0xffff0000, v104
    v_lshlrev_b32 v114, 16, v105
    v_and_b32 v115, 0xffff0000, v105
    v_lshlrev_b32 v116, 16, v106
    v_and_b32 v117, 0xffff0000, v106
    v_lshlrev_b32 v118, 16, v107
    v_and_b32 v119, 0xffff0000, v107
    v_lshlrev_b32 v120, 16, v108
    v_and_b32 v121, 0xffff0000, v108
    v_lshlrev_b32 v122, 16, v109
    v_and_b32 v123, 0xffff0000, v109
    v_lshlrev_b32 v124, 16, v110
    v_and_b32 v125, 0xffff0000, v110
    v_lshlrev_b32 v126, 16, v111
    v_and_b32 v127, 0xffff0000, v111
    v_mul_f32 v18, 0xbfb8aa3b, v112
    v_exp_f32 v18, v18
    s_nop 0
    v_add_f32 v18, 1.0, v18
    v_rcp_f32 v18, v18
    s_nop 0
    v_mul_f32 v112, v112, v18
    v_cvt_pk_bf16_f32 v112, v112, v112
    v_lshlrev_b32 v112, 16, v112
    v_mul_f32 v18, 0xbfb8aa3b, v113
    v_exp_f32 v18, v18
    s_nop 0
    v_add_f32 v18, 1.0, v18
    v_rcp_f32 v18, v18
    s_nop 0
    v_mul_f32 v113, v113, v18
    v_cvt_pk_bf16_f32 v113, v113, v113
    v_lshlrev_b32 v113, 16, v113
    v_mul_f32 v18, 0xbfb8aa3b, v114
    v_exp_f32 v18, v18
    s_nop 0
    v_add_f32 v18, 1.0, v18
    v_rcp_f32 v18, v18
    s_nop 0
    v_mul_f32 v114, v114, v18
    v_cvt_pk_bf16_f32 v114, v114, v114
    v_lshlrev_b32 v114, 16, v114
    v_mul_f32 v18, 0xbfb8aa3b, v115
    v_exp_f32 v18, v18
    s_nop 0
    v_add_f32 v18, 1.0, v18
    v_rcp_f32 v18, v18
    s_nop 0
    v_mul_f32 v115, v115, v18
    v_cvt_pk_bf16_f32 v115, v115, v115
    v_lshlrev_b32 v115, 16, v115
    v_mul_f32 v18, 0xbfb8aa3b, v116
    v_exp_f32 v18, v18
    s_nop 0
    v_add_f32 v18, 1.0, v18
    v_rcp_f32 v18, v18
    s_nop 0
    v_mul_f32 v116, v116, v18
    v_cvt_pk_bf16_f32 v116, v116, v116
    v_lshlrev_b32 v116, 16, v116
    v_mul_f32 v18, 0xbfb8aa3b, v117
    v_exp_f32 v18, v18
    s_nop 0
    v_add_f32 v18, 1.0, v18
    v_rcp_f32 v18, v18
    s_nop 0
    v_mul_f32 v117, v117, v18
    v_cvt_pk_bf16_f32 v117, v117, v117
    v_lshlrev_b32 v117, 16, v117
    v_mul_f32 v18, 0xbfb8aa3b, v118
    v_exp_f32 v18, v18
    s_nop 0
    v_add_f32 v18, 1.0, v18
    v_rcp_f32 v18, v18
    s_nop 0
    v_mul_f32 v118, v118, v18
    v_cvt_pk_bf16_f32 v118, v118, v118
    v_lshlrev_b32 v118, 16, v118
    v_mul_f32 v18, 0xbfb8aa3b, v119
    v_exp_f32 v18, v18
    s_nop 0
    v_add_f32 v18, 1.0, v18
    v_rcp_f32 v18, v18
    s_nop 0
    v_mul_f32 v119, v119, v18
    v_cvt_pk_bf16_f32 v119, v119, v119
    v_lshlrev_b32 v119, 16, v119
    v_mul_f32 v18, 0xbfb8aa3b, v120
    v_exp_f32 v18, v18
    s_nop 0
    v_add_f32 v18, 1.0, v18
    v_rcp_f32 v18, v18
    s_nop 0
    v_mul_f32 v120, v120, v18
    v_cvt_pk_bf16_f32 v120, v120, v120
    v_lshlrev_b32 v120, 16, v120
    v_mul_f32 v18, 0xbfb8aa3b, v121
    v_exp_f32 v18, v18
    s_nop 0
    v_add_f32 v18, 1.0, v18
    v_rcp_f32 v18, v18
    s_nop 0
    v_mul_f32 v121, v121, v18
    v_cvt_pk_bf16_f32 v121, v121, v121
    v_lshlrev_b32 v121, 16, v121
    v_mul_f32 v18, 0xbfb8aa3b, v122
    v_exp_f32 v18, v18
    s_nop 0
    v_add_f32 v18, 1.0, v18
    v_rcp_f32 v18, v18
    s_nop 0
    v_mul_f32 v122, v122, v18
    v_cvt_pk_bf16_f32 v122, v122, v122
    v_lshlrev_b32 v122, 16, v122
    v_mul_f32 v18, 0xbfb8aa3b, v123
    v_exp_f32 v18, v18
    s_nop 0
    v_add_f32 v18, 1.0, v18
    v_rcp_f32 v18, v18
    s_nop 0
    v_mul_f32 v123, v123, v18
    v_cvt_pk_bf16_f32 v123, v123, v123
    v_lshlrev_b32 v123, 16, v123
    v_mul_f32 v18, 0xbfb8aa3b, v124
    v_exp_f32 v18, v18
    s_nop 0
    v_add_f32 v18, 1.0, v18
    v_rcp_f32 v18, v18
    s_nop 0
    v_mul_f32 v124, v124, v18
    v_cvt_pk_bf16_f32 v124, v124, v124
    v_lshlrev_b32 v124, 16, v124
    v_mul_f32 v18, 0xbfb8aa3b, v125
    v_exp_f32 v18, v18
    s_nop 0
    v_add_f32 v18, 1.0, v18
    v_rcp_f32 v18, v18
    s_nop 0
    v_mul_f32 v125, v125, v18
    v_cvt_pk_bf16_f32 v125, v125, v125
    v_lshlrev_b32 v125, 16, v125
    v_mul_f32 v18, 0xbfb8aa3b, v126
    v_exp_f32 v18, v18
    s_nop 0
    v_add_f32 v18, 1.0, v18
    v_rcp_f32 v18, v18
    s_nop 0
    v_mul_f32 v126, v126, v18
    v_cvt_pk_bf16_f32 v126, v126, v126
    v_lshlrev_b32 v126, 16, v126
    v_mul_f32 v18, 0xbfb8aa3b, v127
    v_exp_f32 v18, v18
    s_nop 0
    v_add_f32 v18, 1.0, v18
    v_rcp_f32 v18, v18
    s_nop 0
    v_mul_f32 v127, v127, v18
    v_cvt_pk_bf16_f32 v127, v127, v127
    v_lshlrev_b32 v127, 16, v127
    v_mov_b32 v96, 0
    v_mov_b32 v97, 0
    v_mov_b32 v98, 0
    v_mov_b32 v99, 0
    v_mov_b32 v100, 0
    v_mov_b32 v101, 0
    v_mov_b32 v102, 0
    v_mov_b32 v103, 0
    s_waitcnt vmcnt(15)
    v_lshlrev_b32 v18, 16, v32
    v_and_b32 v19, 0xffff0000, v32
    v_fmac_f32 v96, v18, v112
    v_fmac_f32 v97, v19, v112
    v_lshlrev_b32 v18, 16, v33
    v_and_b32 v19, 0xffff0000, v33
    v_fmac_f32 v98, v18, v112
    v_fmac_f32 v99, v19, v112
    v_lshlrev_b32 v18, 16, v34
    v_and_b32 v19, 0xffff0000, v34
    v_fmac_f32 v100, v18, v112
    v_fmac_f32 v101, v19, v112
    v_lshlrev_b32 v18, 16, v35
    v_and_b32 v19, 0xffff0000, v35
    v_fmac_f32 v102, v18, v112
    v_fmac_f32 v103, v19, v112
    s_waitcnt vmcnt(14)
    v_lshlrev_b32 v18, 16, v36
    v_and_b32 v19, 0xffff0000, v36
    v_fmac_f32 v96, v18, v113
    v_fmac_f32 v97, v19, v113
    v_lshlrev_b32 v18, 16, v37
    v_and_b32 v19, 0xffff0000, v37
    v_fmac_f32 v98, v18, v113
    v_fmac_f32 v99, v19, v113
    v_lshlrev_b32 v18, 16, v38
    v_and_b32 v19, 0xffff0000, v38
    v_fmac_f32 v100, v18, v113
    v_fmac_f32 v101, v19, v113
    v_lshlrev_b32 v18, 16, v39
    v_and_b32 v19, 0xffff0000, v39
    v_fmac_f32 v102, v18, v113
    v_fmac_f32 v103, v19, v113
    s_waitcnt vmcnt(13)
    v_lshlrev_b32 v18, 16, v40
    v_and_b32 v19, 0xffff0000, v40
    v_fmac_f32 v96, v18, v114
    v_fmac_f32 v97, v19, v114
    v_lshlrev_b32 v18, 16, v41
    v_and_b32 v19, 0xffff0000, v41
    v_fmac_f32 v98, v18, v114
    v_fmac_f32 v99, v19, v114
    v_lshlrev_b32 v18, 16, v42
    v_and_b32 v19, 0xffff0000, v42
    v_fmac_f32 v100, v18, v114
    v_fmac_f32 v101, v19, v114
    v_lshlrev_b32 v18, 16, v43
    v_and_b32 v19, 0xffff0000, v43
    v_fmac_f32 v102, v18, v114
    v_fmac_f32 v103, v19, v114
    s_waitcnt vmcnt(12)
    v_lshlrev_b32 v18, 16, v44
    v_and_b32 v19, 0xffff0000, v44
    v_fmac_f32 v96, v18, v115
    v_fmac_f32 v97, v19, v115
    v_lshlrev_b32 v18, 16, v45
    v_and_b32 v19, 0xffff0000, v45
    v_fmac_f32 v98, v18, v115
    v_fmac_f32 v99, v19, v115
    v_lshlrev_b32 v18, 16, v46
    v_and_b32 v19, 0xffff0000, v46
    v_fmac_f32 v100, v18, v115
    v_fmac_f32 v101, v19, v115
    v_lshlrev_b32 v18, 16, v47
    v_and_b32 v19, 0xffff0000, v47
    v_fmac_f32 v102, v18, v115
    v_fmac_f32 v103, v19, v115
    s_waitcnt vmcnt(11)
    v_lshlrev_b32 v18, 16, v48
    v_and_b32 v19, 0xffff0000, v48
    v_fmac_f32 v96, v18, v116
    v_fmac_f32 v97, v19, v116
    v_lshlrev_b32 v18, 16, v49
    v_and_b32 v19, 0xffff0000, v49
    v_fmac_f32 v98, v18, v116
    v_fmac_f32 v99, v19, v116
    v_lshlrev_b32 v18, 16, v50
    v_and_b32 v19, 0xffff0000, v50
    v_fmac_f32 v100, v18, v116
    v_fmac_f32 v101, v19, v116
    v_lshlrev_b32 v18, 16, v51
    v_and_b32 v19, 0xffff0000, v51
    v_fmac_f32 v102, v18, v116
    v_fmac_f32 v103, v19, v116
    s_waitcnt vmcnt(10)
    v_lshlrev_b32 v18, 16, v52
    v_and_b32 v19, 0xffff0000, v52
    v_fmac_f32 v96, v18, v117
    v_fmac_f32 v97, v19, v117
    v_lshlrev_b32 v18, 16, v53
    v_and_b32 v19, 0xffff0000, v53
    v_fmac_f32 v98, v18, v117
    v_fmac_f32 v99, v19, v117
    v_lshlrev_b32 v18, 16, v54
    v_and_b32 v19, 0xffff0000, v54
    v_fmac_f32 v100, v18, v117
    v_fmac_f32 v101, v19, v117
    v_lshlrev_b32 v18, 16, v55
    v_and_b32 v19, 0xffff0000, v55
    v_fmac_f32 v102, v18, v117
    v_fmac_f32 v103, v19, v117
    s_waitcnt vmcnt(9)
    v_lshlrev_b32 v18, 16, v56
    v_and_b32 v19, 0xffff0000, v56
    v_fmac_f32 v96, v18, v118
    v_fmac_f32 v97, v19, v118
    v_lshlrev_b32 v18, 16, v57
    v_and_b32 v19, 0xffff0000, v57
    v_fmac_f32 v98, v18, v118
    v_fmac_f32 v99, v19, v118
    v_lshlrev_b32 v18, 16, v58
    v_and_b32 v19, 0xffff0000, v58
    v_fmac_f32 v100, v18, v118
    v_fmac_f32 v101, v19, v118
    v_lshlrev_b32 v18, 16, v59
    v_and_b32 v19, 0xffff0000, v59
    v_fmac_f32 v102, v18, v118
    v_fmac_f32 v103, v19, v118
    s_waitcnt vmcnt(8)
    v_lshlrev_b32 v18, 16, v60
    v_and_b32 v19, 0xffff0000, v60
    v_fmac_f32 v96, v18, v119
    v_fmac_f32 v97, v19, v119
    v_lshlrev_b32 v18, 16, v61
    v_and_b32 v19, 0xffff0000, v61
    v_fmac_f32 v98, v18, v119
    v_fmac_f32 v99, v19, v119
    v_lshlrev_b32 v18, 16, v62
    v_and_b32 v19, 0xffff0000, v62
    v_fmac_f32 v100, v18, v119
    v_fmac_f32 v101, v19, v119
    v_lshlrev_b32 v18, 16, v63
    v_and_b32 v19, 0xffff0000, v63
    v_fmac_f32 v102, v18, v119
    v_fmac_f32 v103, v19, v119
    s_waitcnt vmcnt(7)
    v_lshlrev_b32 v18, 16, v64
    v_and_b32 v19, 0xffff0000, v64
    v_fmac_f32 v96, v18, v120
    v_fmac_f32 v97, v19, v120
    v_lshlrev_b32 v18, 16, v65
    v_and_b32 v19, 0xffff0000, v65
    v_fmac_f32 v98, v18, v120
    v_fmac_f32 v99, v19, v120
    v_lshlrev_b32 v18, 16, v66
    v_and_b32 v19, 0xffff0000, v66
    v_fmac_f32 v100, v18, v120
    v_fmac_f32 v101, v19, v120
    v_lshlrev_b32 v18, 16, v67
    v_and_b32 v19, 0xffff0000, v67
    v_fmac_f32 v102, v18, v120
    v_fmac_f32 v103, v19, v120
    s_waitcnt vmcnt(6)
    v_lshlrev_b32 v18, 16, v68
    v_and_b32 v19, 0xffff0000, v68
    v_fmac_f32 v96, v18, v121
    v_fmac_f32 v97, v19, v121
    v_lshlrev_b32 v18, 16, v69
    v_and_b32 v19, 0xffff0000, v69
    v_fmac_f32 v98, v18, v121
    v_fmac_f32 v99, v19, v121
    v_lshlrev_b32 v18, 16, v70
    v_and_b32 v19, 0xffff0000, v70
    v_fmac_f32 v100, v18, v121
    v_fmac_f32 v101, v19, v121
    v_lshlrev_b32 v18, 16, v71
    v_and_b32 v19, 0xffff0000, v71
    v_fmac_f32 v102, v18, v121
    v_fmac_f32 v103, v19, v121
    s_waitcnt vmcnt(5)
    v_lshlrev_b32 v18, 16, v72
    v_and_b32 v19, 0xffff0000, v72
    v_fmac_f32 v96, v18, v122
    v_fmac_f32 v97, v19, v122
    v_lshlrev_b32 v18, 16, v73
    v_and_b32 v19, 0xffff0000, v73
    v_fmac_f32 v98, v18, v122
    v_fmac_f32 v99, v19, v122
    v_lshlrev_b32 v18, 16, v74
    v_and_b32 v19, 0xffff0000, v74
    v_fmac_f32 v100, v18, v122
    v_fmac_f32 v101, v19, v122
    v_lshlrev_b32 v18, 16, v75
    v_and_b32 v19, 0xffff0000, v75
    v_fmac_f32 v102, v18, v122
    v_fmac_f32 v103, v19, v122
    s_waitcnt vmcnt(4)
    v_lshlrev_b32 v18, 16, v76
    v_and_b32 v19, 0xffff0000, v76
    v_fmac_f32 v96, v18, v123
    v_fmac_f32 v97, v19, v123
    v_lshlrev_b32 v18, 16, v77
    v_and_b32 v19, 0xffff0000, v77
    v_fmac_f32 v98, v18, v123
    v_fmac_f32 v99, v19, v123
    v_lshlrev_b32 v18, 16, v78
    v_and_b32 v19, 0xffff0000, v78
    v_fmac_f32 v100, v18, v123
    v_fmac_f32 v101, v19, v123
    v_lshlrev_b32 v18, 16, v79
    v_and_b32 v19, 0xffff0000, v79
    v_fmac_f32 v102, v18, v123
    v_fmac_f32 v103, v19, v123
    s_waitcnt vmcnt(3)
    v_lshlrev_b32 v18, 16, v80
    v_and_b32 v19, 0xffff0000, v80
    v_fmac_f32 v96, v18, v124
    v_fmac_f32 v97, v19, v124
    v_lshlrev_b32 v18, 16, v81
    v_and_b32 v19, 0xffff0000, v81
    v_fmac_f32 v98, v18, v124
    v_fmac_f32 v99, v19, v124
    v_lshlrev_b32 v18, 16, v82
    v_and_b32 v19, 0xffff0000, v82
    v_fmac_f32 v100, v18, v124
    v_fmac_f32 v101, v19, v124
    v_lshlrev_b32 v18, 16, v83
    v_and_b32 v19, 0xffff0000, v83
    v_fmac_f32 v102, v18, v124
    v_fmac_f32 v103, v19, v124
    s_waitcnt vmcnt(2)
    v_lshlrev_b32 v18, 16, v84
    v_and_b32 v19, 0xffff0000, v84
    v_fmac_f32 v96, v18, v125
    v_fmac_f32 v97, v19, v125
    v_lshlrev_b32 v18, 16, v85
    v_and_b32 v19, 0xffff0000, v85
    v_fmac_f32 v98, v18, v125
    v_fmac_f32 v99, v19, v125
    v_lshlrev_b32 v18, 16, v86
    v_and_b32 v19, 0xffff0000, v86
    v_fmac_f32 v100, v18, v125
    v_fmac_f32 v101, v19, v125
    v_lshlrev_b32 v18, 16, v87
    v_and_b32 v19, 0xffff0000, v87
    v_fmac_f32 v102, v18, v125
    v_fmac_f32 v103, v19, v125
    s_waitcnt vmcnt(1)
    v_lshlrev_b32 v18, 16, v88
    v_and_b32 v19, 0xffff0000, v88
    v_fmac_f32 v96, v18, v126
    v_fmac_f32 v97, v19, v126
    v_lshlrev_b32 v18, 16, v89
    v_and_b32 v19, 0xffff0000, v89
    v_fmac_f32 v98, v18, v126
    v_fmac_f32 v99, v19, v126
    v_lshlrev_b32 v18, 16, v90
    v_and_b32 v19, 0xffff0000, v90
    v_fmac_f32 v100, v18, v126
    v_fmac_f32 v101, v19, v126
    v_lshlrev_b32 v18, 16, v91
    v_and_b32 v19, 0xffff0000, v91
    v_fmac_f32 v102, v18, v126
    v_fmac_f32 v103, v19, v126
    s_waitcnt vmcnt(0)
    v_lshlrev_b32 v18, 16, v92
    v_and_b32 v19, 0xffff0000, v92
    v_fmac_f32 v96, v18, v127
    v_fmac_f32 v97, v19, v127
    v_lshlrev_b32 v18, 16, v93
    v_and_b32 v19, 0xffff0000, v93
    v_fmac_f32 v98, v18, v127
    v_fmac_f32 v99, v19, v127
    v_lshlrev_b32 v18, 16, v94
    v_and_b32 v19, 0xffff0000, v94
    v_fmac_f32 v100, v18, v127
    v_fmac_f32 v101, v19, v127
    v_lshlrev_b32 v18, 16, v95
    v_and_b32 v19, 0xffff0000, v95
    v_fmac_f32 v102, v18, v127
    v_fmac_f32 v103, v19, v127
    v_lshlrev_b32 v16, 5, v0
    ds_write_b128 v16, v[96:99]
    ds_write_b128 v16, v[100:103] offset:16
    s_waitcnt lgkmcnt(0)
    s_barrier
    s_cmp_lg_u32 s44, 0
    s_cbranch_scc1 L_mod_fin_108
    v_mov_b32 v18, 0
    ds_read_b32 v32, v12 offset:0
    ds_read_b32 v33, v12 offset:256
    ds_read_b32 v34, v12 offset:512
    ds_read_b32 v35, v12 offset:768
    ds_read_b32 v36, v12 offset:1024
    ds_read_b32 v37, v12 offset:1280
    ds_read_b32 v38, v12 offset:1536
    ds_read_b32 v39, v12 offset:1792
    ds_read_b32 v40, v12 offset:2048
    ds_read_b32 v41, v12 offset:2304
    ds_read_b32 v42, v12 offset:2560
    ds_read_b32 v43, v12 offset:2816
    ds_read_b32 v44, v12 offset:3072
    ds_read_b32 v45, v12 offset:3328
    ds_read_b32 v46, v12 offset:3584
    ds_read_b32 v47, v12 offset:3840
    s_waitcnt lgkmcnt(0)
    v_add_f32 v18, v18, v32
    v_add_f32 v18, v18, v33
    v_add_f32 v18, v18, v34
    v_add_f32 v18, v18, v35
    v_add_f32 v18, v18, v36
    v_add_f32 v18, v18, v37
    v_add_f32 v18, v18, v38
    v_add_f32 v18, v18, v39
    v_add_f32 v18, v18, v40
    v_add_f32 v18, v18, v41
    v_add_f32 v18, v18, v42
    v_add_f32 v18, v18, v43
    v_add_f32 v18, v18, v44
    v_add_f32 v18, v18, v45
    v_add_f32 v18, v18, v46
    v_add_f32 v18, v18, v47
    ds_read_b32 v32, v12 offset:4096
    ds_read_b32 v33, v12 offset:4352
    ds_read_b32 v34, v12 offset:4608
    ds_read_b32 v35, v12 offset:4864
    ds_read_b32 v36, v12 offset:5120
    ds_read_b32 v37, v12 offset:5376
    ds_read_b32 v38, v12 offset:5632
    ds_read_b32 v39, v12 offset:5888
    ds_read_b32 v40, v12 offset:6144
    ds_read_b32 v41, v12 offset:6400
    ds_read_b32 v42, v12 offset:6656
    ds_read_b32 v43, v12 offset:6912
    ds_read_b32 v44, v12 offset:7168
    ds_read_b32 v45, v12 offset:7424
    ds_read_b32 v46, v12 offset:7680
    ds_read_b32 v47, v12 offset:7936
    s_waitcnt lgkmcnt(0)
    v_add_f32 v18, v18, v32
    v_add_f32 v18, v18, v33
    v_add_f32 v18, v18, v34
    v_add_f32 v18, v18, v35
    v_add_f32 v18, v18, v36
    v_add_f32 v18, v18, v37
    v_add_f32 v18, v18, v38
    v_add_f32 v18, v18, v39
    v_add_f32 v18, v18, v40
    v_add_f32 v18, v18, v41
    v_add_f32 v18, v18, v42
    v_add_f32 v18, v18, v43
    v_add_f32 v18, v18, v44
    v_add_f32 v18, v18, v45
    v_add_f32 v18, v18, v46
    v_add_f32 v18, v18, v47
    s_lshr_b32 s45, s39, 1
    s_lshl_b32 s45, s45, 8
    s_mul_i32 s46, s47, 24576
    s_add_u32 s45, s45, s46
    buffer_store_dword v18, v12, s[12:15], s45 offen sc1
L_mod_fin_108:
    s_waitcnt vmcnt(0)
    s_barrier
    s_cmp_lg_u32 s44, 0
    s_cbranch_scc1 L_cnt_109
    v_mov_b32 v30, 1
    v_mov_b32 v31, 127232
    s_mov_b64 exec, 1
    buffer_atomic_add v30, v31, s[12:15], 0 offen sc1
    s_mov_b64 exec, -1
L_cnt_109:
    s_sub_u32 s90, 2, s43
    s_cmp_eq_u32 s43, 2
    s_cselect_b32 s51, 22, 10
    s_cmp_eq_u32 s43, 0
    s_cselect_b32 s51, 0, s51
    s_cmp_eq_u32 s51, 0
    s_cbranch_scc1 L_w_roles_98
    s_sub_u32 s60, 64, s51
    s_mov_b32 s91, 64
    s_mov_b32 s71, 127104
    s_lshl_b32 s61, s41, 7
    s_lshl_b32 s45, s90, 2
    s_add_u32 s61, s61, s45
    s_add_u32 s61, s61, 0x10020
    s_branch L_w_kv_97_h
L_w_kv_97:
    s_mov_b32 s90, s43
    s_mov_b32 s60, 0
    s_mov_b32 s51, 1
    s_mov_b32 s71, 126976
    s_cmp_eq_u32 s43, 0
    s_cselect_b32 s91, 42, 54
    s_cmp_eq_u32 s43, 2
    s_cselect_b32 s91, 64, s91
L_w_kv_97_h:
    s_lshl_b32 s45, s90, 3
    s_add_u32 s45, s45, 16
    s_load_dwordx2 s[6:7], s[0:1], s45
    s_waitcnt lgkmcnt(0)
    s_mov_b32 s24, s6
    s_and_b32 s25, s7, 0xffff
    s_mov_b32 s26, 0x800000
    s_mov_b32 s27, 0x00020000
    s_lshl_b32 s46, s41, 8
    s_barrier
    v_lshrrev_b32 v20, 4, v1
    s_lshl_b32 s45, s44, 2
    v_add_u32 v21, s45, v20
    s_mov_b32 s45, 8192
    v_mul_lo_u32 v21, v21, s45
    v_lshlrev_b32 v22, 2, v20
    v_and_b32 v23, 15, v1
    v_xor_b32 v22, v22, v23
    v_lshlrev_b32 v22, 4, v22
    v_add_u32 v21, v21, v22
    v_bfe_u32 v22, v1, 2, 2
    v_lshlrev_b32 v23, 3, v20
    v_add_u32 v23, v23, v22
    v_lshlrev_b32 v23, 8, v23
    v_xor_b32 v22, s44, v22
    v_lshlrev_b32 v22, 6, v22
    v_add_u32 v23, v23, v22
    v_and_b32 v22, 3, v1
    v_lshlrev_b32 v22, 4, v22
    v_add_u32 v23, v23, v22
    v_add_u32 v24, 65536, v23
    v_add_u32 v25, 131072, v23
    s_lshl_b32 s47, s44, 10
    s_add_u32 s45, s46, 0x0
    s_add_u32 m0, s47, 0
    s_nop 0
    buffer_load_dwordx4 v21, s[24:27], s45 offen  lds
    s_add_u32 s45, s46, 0x20000
    s_add_u32 m0, s47, 4096
    s_nop 0
    buffer_load_dwordx4 v21, s[24:27], s45 offen  lds
    s_add_u32 s45, s46, 0x40000
    s_add_u32 m0, s47, 8192
    s_nop 0
    buffer_load_dwordx4 v21, s[24:27], s45 offen  lds
    s_add_u32 s45, s46, 0x60000
    s_add_u32 m0, s47, 12288
    s_nop 0
    buffer_load_dwordx4 v21, s[24:27], s45 offen  lds
    s_add_u32 s45, s46, 0x80000
    s_add_u32 m0, s47, 16384
    s_nop 0
    buffer_load_dwordx4 v21, s[24:27], s45 offen  lds
    s_add_u32 s45, s46, 0xa0000
    s_add_u32 m0, s47, 20480
    s_nop 0
    buffer_load_dwordx4 v21, s[24:27], s45 offen  lds
    s_add_u32 s45, s46, 0xc0000
    s_add_u32 m0, s47, 24576
    s_nop 0
    buffer_load_dwordx4 v21, s[24:27], s45 offen  lds
    s_add_u32 s45, s46, 0xe0000
    s_add_u32 m0, s47, 28672
    s_nop 0
    buffer_load_dwordx4 v21, s[24:27], s45 offen  lds
    s_add_u32 s45, s46, 0x100000
    s_add_u32 m0, s47, 32768
    s_nop 0
    buffer_load_dwordx4 v21, s[24:27], s45 offen  lds
    s_add_u32 s45, s46, 0x120000
    s_add_u32 m0, s47, 36864
    s_nop 0
    buffer_load_dwordx4 v21, s[24:27], s45 offen  lds
    s_add_u32 s45, s46, 0x140000
    s_add_u32 m0, s47, 40960
    s_nop 0
    buffer_load_dwordx4 v21, s[24:27], s45 offen  lds
    s_add_u32 s45, s46, 0x160000
    s_add_u32 m0, s47, 45056
    s_nop 0
    buffer_load_dwordx4 v21, s[24:27], s45 offen  lds
    s_add_u32 s45, s46, 0x180000
    s_add_u32 m0, s47, 49152
    s_nop 0
    buffer_load_dwordx4 v21, s[24:27], s45 offen  lds
    s_add_u32 s45, s46, 0x1a0000
    s_add_u32 m0, s47, 53248
    s_nop 0
    buffer_load_dwordx4 v21, s[24:27], s45 offen  lds
    s_add_u32 s45, s46, 0x1c0000
    s_add_u32 m0, s47, 57344
    s_nop 0
    buffer_load_dwordx4 v21, s[24:27], s45 offen  lds
    s_add_u32 s45, s46, 0x1e0000
    s_add_u32 m0, s47, 61440
    s_nop 0
    buffer_load_dwordx4 v21, s[24:27], s45 offen  lds
    s_add_u32 s45, s46, 0x200000
    s_add_u32 m0, s47, 65536
    s_nop 0
    buffer_load_dwordx4 v21, s[24:27], s45 offen  lds
    s_add_u32 s45, s46, 0x220000
    s_add_u32 m0, s47, 69632
    s_nop 0
    buffer_load_dwordx4 v21, s[24:27], s45 offen  lds
    s_add_u32 s45, s46, 0x240000
    s_add_u32 m0, s47, 73728
    s_nop 0
    buffer_load_dwordx4 v21, s[24:27], s45 offen  lds
    s_add_u32 s45, s46, 0x260000
    s_add_u32 m0, s47, 77824
    s_nop 0
    buffer_load_dwordx4 v21, s[24:27], s45 offen  lds
    s_add_u32 s45, s46, 0x280000
    s_add_u32 m0, s47, 81920
    s_nop 0
    buffer_load_dwordx4 v21, s[24:27], s45 offen  lds
    s_add_u32 s45, s46, 0x2a0000
    s_add_u32 m0, s47, 86016
    s_nop 0
    buffer_load_dwordx4 v21, s[24:27], s45 offen  lds
    s_add_u32 s45, s46, 0x2c0000
    s_add_u32 m0, s47, 90112
    s_nop 0
    buffer_load_dwordx4 v21, s[24:27], s45 offen  lds
    s_add_u32 s45, s46, 0x2e0000
    s_add_u32 m0, s47, 94208
    s_nop 0
    buffer_load_dwordx4 v21, s[24:27], s45 offen  lds
    s_add_u32 s45, s46, 0x300000
    s_add_u32 m0, s47, 98304
    s_nop 0
    buffer_load_dwordx4 v21, s[24:27], s45 offen  lds
    s_add_u32 s45, s46, 0x320000
    s_add_u32 m0, s47, 102400
    s_nop 0
    buffer_load_dwordx4 v21, s[24:27], s45 offen  lds
    s_add_u32 s45, s46, 0x340000
    s_add_u32 m0, s47, 106496
    s_nop 0
    buffer_load_dwordx4 v21, s[24:27], s45 offen  lds
    s_add_u32 s45, s46, 0x360000
    s_add_u32 m0, s47, 110592
    s_nop 0
    buffer_load_dwordx4 v21, s[24:27], s45 offen  lds
    s_add_u32 s45, s46, 0x380000
    s_add_u32 m0, s47, 114688
    s_nop 0
    buffer_load_dwordx4 v21, s[24:27], s45 offen  lds
    s_add_u32 s45, s46, 0x3a0000
    s_add_u32 m0, s47, 118784
    s_nop 0
    buffer_load_dwordx4 v21, s[24:27], s45 offen  lds
    s_add_u32 s45, s46, 0x3c0000
    s_add_u32 m0, s47, 122880
    s_nop 0
    buffer_load_dwordx4 v21, s[24:27], s45 offen  lds
    s_add_u32 s45, s46, 0x3e0000
    s_add_u32 m0, s47, 126976
    s_nop 0
    buffer_load_dwordx4 v21, s[24:27], s45 offen  lds
    s_waitcnt vmcnt(28)
    s_barrier
    s_add_u32 s45, s46, 0x400000
    s_add_u32 m0, s47, 131072
    s_nop 0
    buffer_load_dwordx4 v21, s[24:27], s45 offen  lds
    s_add_u32 s45, s46, 0x420000
    s_add_u32 m0, s47, 135168
    s_nop 0
    buffer_load_dwordx4 v21, s[24:27], s45 offen  lds
    s_add_u32 s45, s46, 0x440000
    s_add_u32 m0, s47, 139264
    s_nop 0
    buffer_load_dwordx4 v21, s[24:27], s45 offen  lds
    s_add_u32 s45, s46, 0x460000
    s_add_u32 m0, s47, 143360
    s_nop 0
    buffer_load_dwordx4 v21, s[24:27], s45 offen  lds
    ds_read_b64_tr_b16 a[0:1], v23 offset:0
    ds_read_b64_tr_b16 a[2:3], v23 offset:1024
    ds_read_b64_tr_b16 a[4:5], v23 offset:8
    ds_read_b64_tr_b16 a[6:7], v23 offset:1032
    ds_read_b64_tr_b16 a[8:9], v23 offset:8192
    ds_read_b64_tr_b16 a[10:11], v23 offset:9216
    ds_read_b64_tr_b16 a[12:13], v23 offset:8200
    ds_read_b64_tr_b16 a[14:15], v23 offset:9224
    s_waitcnt lgkmcnt(0)
    s_waitcnt vmcnt(28)
    s_barrier
    s_add_u32 s45, s46, 0x480000
    s_add_u32 m0, s47, 0
    s_nop 0
    buffer_load_dwordx4 v21, s[24:27], s45 offen  lds
    s_add_u32 s45, s46, 0x4a0000
    s_add_u32 m0, s47, 4096
    s_nop 0
    buffer_load_dwordx4 v21, s[24:27], s45 offen  lds
    s_add_u32 s45, s46, 0x4c0000
    s_add_u32 m0, s47, 8192
    s_nop 0
    buffer_load_dwordx4 v21, s[24:27], s45 offen  lds
    s_add_u32 s45, s46, 0x4e0000
    s_add_u32 m0, s47, 12288
    s_nop 0
    buffer_load_dwordx4 v21, s[24:27], s45 offen  lds
    ds_read_b64_tr_b16 a[16:17], v23 offset:16384
    ds_read_b64_tr_b16 a[18:19], v23 offset:17408
    ds_read_b64_tr_b16 a[20:21], v23 offset:16392
    ds_read_b64_tr_b16 a[22:23], v23 offset:17416
    ds_read_b64_tr_b16 a[24:25], v23 offset:24576
    ds_read_b64_tr_b16 a[26:27], v23 offset:25600
    ds_read_b64_tr_b16 a[28:29], v23 offset:24584
    ds_read_b64_tr_b16 a[30:31], v23 offset:25608
    s_waitcnt lgkmcnt(0)
    s_waitcnt vmcnt(28)
    s_barrier
    s_add_u32 s45, s46, 0x500000
    s_add_u32 m0, s47, 16384
    s_nop 0
    buffer_load_dwordx4 v21, s[24:27], s45 offen  lds
    s_add_u32 s45, s46, 0x520000
    s_add_u32 m0, s47, 20480
    s_nop 0
    buffer_load_dwordx4 v21, s[24:27], s45 offen  lds
    s_add_u32 s45, s46, 0x540000
    s_add_u32 m0, s47, 24576
    s_nop 0
    buffer_load_dwordx4 v21, s[24:27], s45 offen  lds
    s_add_u32 s45, s46, 0x560000
    s_add_u32 m0, s47, 28672
    s_nop 0
    buffer_load_dwordx4 v21, s[24:27], s45 offen  lds
    ds_read_b64_tr_b16 a[32:33], v23 offset:32768
    ds_read_b64_tr_b16 a[34:35], v23 offset:33792
    ds_read_b64_tr_b16 a[36:37], v23 offset:32776
    ds_read_b64_tr_b16 a[38:39], v23 offset:33800
    ds_read_b64_tr_b16 a[40:41], v23 offset:40960
    ds_read_b64_tr_b16 a[42:43], v23 offset:41984
    ds_read_b64_tr_b16 a[44:45], v23 offset:40968
    ds_read_b64_tr_b16 a[46:47], v23 offset:41992
    s_waitcnt lgkmcnt(0)
    s_waitcnt vmcnt(28)
    s_barrier
    s_add_u32 s45, s46, 0x580000
    s_add_u32 m0, s47, 32768
    s_nop 0
    buffer_load_dwordx4 v21, s[24:27], s45 offen  lds
    s_add_u32 s45, s46, 0x5a0000
    s_add_u32 m0, s47, 36864
    s_nop 0
    buffer_load_dwordx4 v21, s[24:27], s45 offen  lds
    s_add_u32 s45, s46, 0x5c0000
    s_add_u32 m0, s47, 40960
    s_nop 0
    buffer_load_dwordx4 v21, s[24:27], s45 offen  lds
    s_add_u32 s45, s46, 0x5e0000
    s_add_u32 m0, s47, 45056
    s_nop 0
    buffer_load_dwordx4 v21, s[24:27], s45 offen  lds
    ds_read_b64_tr_b16 a[48:49], v23 offset:49152
    ds_read_b64_tr_b16 a[50:51], v23 offset:50176
    ds_read_b64_tr_b16 a[52:53], v23 offset:49160
    ds_read_b64_tr_b16 a[54:55], v23 offset:50184
    ds_read_b64_tr_b16 a[56:57], v23 offset:57344
    ds_read_b64_tr_b16 a[58:59], v23 offset:58368
    ds_read_b64_tr_b16 a[60:61], v23 offset:57352
    ds_read_b64_tr_b16 a[62:63], v23 offset:58376
    s_waitcnt lgkmcnt(0)
    s_waitcnt vmcnt(28)
    s_barrier
    s_add_u32 s45, s46, 0x600000
    s_add_u32 m0, s47, 49152
    s_nop 0
    buffer_load_dwordx4 v21, s[24:27], s45 offen  lds
    s_add_u32 s45, s46, 0x620000
    s_add_u32 m0, s47, 53248
    s_nop 0
    buffer_load_dwordx4 v21, s[24:27], s45 offen  lds
    s_add_u32 s45, s46, 0x640000
    s_add_u32 m0, s47, 57344
    s_nop 0
    buffer_load_dwordx4 v21, s[24:27], s45 offen  lds
    s_add_u32 s45, s46, 0x660000
    s_add_u32 m0, s47, 61440
    s_nop 0
    buffer_load_dwordx4 v21, s[24:27], s45 offen  lds
    ds_read_b64_tr_b16 a[64:65], v24 offset:0
    ds_read_b64_tr_b16 a[66:67], v24 offset:1024
    ds_read_b64_tr_b16 a[68:69], v24 offset:8
    ds_read_b64_tr_b16 a[70:71], v24 offset:1032
    ds_read_b64_tr_b16 a[72:73], v24 offset:8192
    ds_read_b64_tr_b16 a[74:75], v24 offset:9216
    ds_read_b64_tr_b16 a[76:77], v24 offset:8200
    ds_read_b64_tr_b16 a[78:79], v24 offset:9224
    s_waitcnt lgkmcnt(0)
    s_waitcnt vmcnt(28)
    s_barrier
    s_add_u32 s45, s46, 0x680000
    s_add_u32 m0, s47, 65536
    s_nop 0
    buffer_load_dwordx4 v21, s[24:27], s45 offen  lds
    s_add_u32 s45, s46, 0x6a0000
    s_add_u32 m0, s47, 69632
    s_nop 0
    buffer_load_dwordx4 v21, s[24:27], s45 offen  lds
    s_add_u32 s45, s46, 0x6c0000
    s_add_u32 m0, s47, 73728
    s_nop 0
    buffer_load_dwordx4 v21, s[24:27], s45 offen  lds
    s_add_u32 s45, s46, 0x6e0000
    s_add_u32 m0, s47, 77824
    s_nop 0
    buffer_load_dwordx4 v21, s[24:27], s45 offen  lds
    ds_read_b64_tr_b16 a[80:81], v24 offset:16384
    ds_read_b64_tr_b16 a[82:83], v24 offset:17408
    ds_read_b64_tr_b16 a[84:85], v24 offset:16392
    ds_read_b64_tr_b16 a[86:87], v24 offset:17416
    ds_read_b64_tr_b16 a[88:89], v24 offset:24576
    ds_read_b64_tr_b16 a[90:91], v24 offset:25600
    ds_read_b64_tr_b16 a[92:93], v24 offset:24584
    ds_read_b64_tr_b16 a[94:95], v24 offset:25608
    s_waitcnt lgkmcnt(0)
    s_waitcnt vmcnt(28)
    s_barrier
    s_add_u32 s45, s46, 0x700000
    s_add_u32 m0, s47, 81920
    s_nop 0
    buffer_load_dwordx4 v21, s[24:27], s45 offen  lds
    s_add_u32 s45, s46, 0x720000
    s_add_u32 m0, s47, 86016
    s_nop 0
    buffer_load_dwordx4 v21, s[24:27], s45 offen  lds
    s_add_u32 s45, s46, 0x740000
    s_add_u32 m0, s47, 90112
    s_nop 0
    buffer_load_dwordx4 v21, s[24:27], s45 offen  lds
    s_add_u32 s45, s46, 0x760000
    s_add_u32 m0, s47, 94208
    s_nop 0
    buffer_load_dwordx4 v21, s[24:27], s45 offen  lds
    ds_read_b64_tr_b16 a[96:97], v24 offset:32768
    ds_read_b64_tr_b16 a[98:99], v24 offset:33792
    ds_read_b64_tr_b16 a[100:101], v24 offset:32776
    ds_read_b64_tr_b16 a[102:103], v24 offset:33800
    ds_read_b64_tr_b16 a[104:105], v24 offset:40960
    ds_read_b64_tr_b16 a[106:107], v24 offset:41984
    ds_read_b64_tr_b16 a[108:109], v24 offset:40968
    ds_read_b64_tr_b16 a[110:111], v24 offset:41992
    s_waitcnt lgkmcnt(0)
    s_waitcnt vmcnt(28)
    s_barrier
    s_add_u32 s45, s46, 0x780000
    s_add_u32 m0, s47, 98304
    s_nop 0
    buffer_load_dwordx4 v21, s[24:27], s45 offen  lds
    s_add_u32 s45, s46, 0x7a0000
    s_add_u32 m0, s47, 102400
    s_nop 0
    buffer_load_dwordx4 v21, s[24:27], s45 offen  lds
    s_add_u32 s45, s46, 0x7c0000
    s_add_u32 m0, s47, 106496
    s_nop 0
    buffer_load_dwordx4 v21, s[24:27], s45 offen  lds
    s_add_u32 s45, s46, 0x7e0000
    s_add_u32 m0, s47, 110592
    s_nop 0
    buffer_load_dwordx4 v21, s[24:27], s45 offen  lds
    ds_read_b64_tr_b16 a[112:113], v24 offset:49152
    ds_read_b64_tr_b16 a[114:115], v24 offset:50176
    ds_read_b64_tr_b16 a[116:117], v24 offset:49160
    ds_read_b64_tr_b16 a[118:119], v24 offset:50184
    ds_read_b64_tr_b16 a[120:121], v24 offset:57344
    ds_read_b64_tr_b16 a[122:123], v24 offset:58368
    ds_read_b64_tr_b16 a[124:125], v24 offset:57352
    ds_read_b64_tr_b16 a[126:127], v24 offset:58376
    s_waitcnt lgkmcnt(0)
    s_waitcnt vmcnt(28)
    s_barrier
    ds_read_b64_tr_b16 a[128:129], v25 offset:0
    ds_read_b64_tr_b16 a[130:131], v25 offset:1024
    ds_read_b64_tr_b16 a[132:133], v25 offset:8
    ds_read_b64_tr_b16 a[134:135], v25 offset:1032
    ds_read_b64_tr_b16 a[136:137], v25 offset:8192
    ds_read_b64_tr_b16 a[138:139], v25 offset:9216
    ds_read_b64_tr_b16 a[140:141], v25 offset:8200
    ds_read_b64_tr_b16 a[142:143], v25 offset:9224
    s_waitcnt lgkmcnt(0)
    s_waitcnt vmcnt(24)
    s_barrier
    ds_read_b64_tr_b16 a[144:145], v23 offset:0
    ds_read_b64_tr_b16 a[146:147], v23 offset:1024
    ds_read_b64_tr_b16 a[148:149], v23 offset:8
    ds_read_b64_tr_b16 a[150:151], v23 offset:1032
    ds_read_b64_tr_b16 a[152:153], v23 offset:8192
    ds_read_b64_tr_b16 a[154:155], v23 offset:9216
    ds_read_b64_tr_b16 a[156:157], v23 offset:8200
    ds_read_b64_tr_b16 a[158:159], v23 offset:9224
    s_waitcnt lgkmcnt(0)
    s_waitcnt vmcnt(20)
    s_barrier
    ds_read_b64_tr_b16 a[160:161], v23 offset:16384
    ds_read_b64_tr_b16 a[162:163], v23 offset:17408
    ds_read_b64_tr_b16 a[164:165], v23 offset:16392
    ds_read_b64_tr_b16 a[166:167], v23 offset:17416
    ds_read_b64_tr_b16 a[168:169], v23 offset:24576
    ds_read_b64_tr_b16 a[170:171], v23 offset:25600
    ds_read_b64_tr_b16 a[172:173], v23 offset:24584
    ds_read_b64_tr_b16 a[174:175], v23 offset:25608
    s_waitcnt lgkmcnt(0)
    s_waitcnt vmcnt(16)
    s_barrier
    ds_read_b64_tr_b16 a[176:177], v23 offset:32768
    ds_read_b64_tr_b16 a[178:179], v23 offset:33792
    ds_read_b64_tr_b16 a[180:181], v23 offset:32776
    ds_read_b64_tr_b16 a[182:183], v23 offset:33800
    ds_read_b64_tr_b16 a[184:185], v23 offset:40960
    ds_read_b64_tr_b16 a[186:187], v23 offset:41984
    ds_read_b64_tr_b16 a[188:189], v23 offset:40968
    ds_read_b64_tr_b16 a[190:191], v23 offset:41992
    s_waitcnt lgkmcnt(0)
    s_waitcnt vmcnt(12)
    s_barrier
    ds_read_b64_tr_b16 a[192:193], v23 offset:49152
    ds_read_b64_tr_b16 a[194:195], v23 offset:50176
    ds_read_b64_tr_b16 a[196:197], v23 offset:49160
    ds_read_b64_tr_b16 a[198:199], v23 offset:50184
    ds_read_b64_tr_b16 a[200:201], v23 offset:57344
    ds_read_b64_tr_b16 a[202:203], v23 offset:58368
    ds_read_b64_tr_b16 a[204:205], v23 offset:57352
    ds_read_b64_tr_b16 a[206:207], v23 offset:58376
    s_waitcnt lgkmcnt(0)
    s_waitcnt vmcnt(8)
    s_barrier
    ds_read_b64_tr_b16 a[208:209], v24 offset:0
    ds_read_b64_tr_b16 a[210:211], v24 offset:1024
    ds_read_b64_tr_b16 a[212:213], v24 offset:8
    ds_read_b64_tr_b16 a[214:215], v24 offset:1032
    ds_read_b64_tr_b16 a[216:217], v24 offset:8192
    ds_read_b64_tr_b16 a[218:219], v24 offset:9216
    ds_read_b64_tr_b16 a[220:221], v24 offset:8200
    ds_read_b64_tr_b16 a[222:223], v24 offset:9224
    s_waitcnt lgkmcnt(0)
    s_waitcnt vmcnt(4)
    s_barrier
    ds_read_b64_tr_b16 a[224:225], v24 offset:16384
    ds_read_b64_tr_b16 a[226:227], v24 offset:17408
    ds_read_b64_tr_b16 a[228:229], v24 offset:16392
    ds_read_b64_tr_b16 a[230:231], v24 offset:17416
    ds_read_b64_tr_b16 a[232:233], v24 offset:24576
    ds_read_b64_tr_b16 a[234:235], v24 offset:25600
    ds_read_b64_tr_b16 a[236:237], v24 offset:24584
    ds_read_b64_tr_b16 a[238:239], v24 offset:25608
    s_waitcnt lgkmcnt(0)
    s_waitcnt vmcnt(0)
    s_barrier
    ds_read_b64_tr_b16 a[240:241], v24 offset:32768
    ds_read_b64_tr_b16 a[242:243], v24 offset:33792
    ds_read_b64_tr_b16 a[244:245], v24 offset:32776
    ds_read_b64_tr_b16 a[246:247], v24 offset:33800
    ds_read_b64_tr_b16 a[248:249], v24 offset:40960
    ds_read_b64_tr_b16 a[250:251], v24 offset:41984
    ds_read_b64_tr_b16 a[252:253], v24 offset:40968
    ds_read_b64_tr_b16 a[254:255], v24 offset:41992
    s_waitcnt lgkmcnt(0)
    s_barrier
    s_cmp_lg_u32 s44, 0
    s_cbranch_scc1 L_pd_110
    v_mov_b32 v29, 8
    s_mov_b32 s46, 32
    s_mov_b64 exec, 1
    s_mov_b32 s70, 0
L_wp_111:
    buffer_load_dword v31, v29, s[16:19], 0 offen sc1
    s_add_u32 s70, s70, 1
    s_cmp_ge_u32 s70, 0x200000
    s_cbranch_scc1 L_w_done_96
L_wp_111_c:
    s_waitcnt vmcnt(0)
    v_cmp_gt_u32 vcc, s46, v31
    s_nop 1
    s_cbranch_vccz L_wp_111_ok
    s_sleep 3
    s_branch L_wp_111
L_wp_111_ok:
    s_mov_b64 exec, -1
L_pd_110:
    s_barrier
    s_mov_b32 s52, 0x400000
    s_lshl_b32 s56, s90, 5
    s_add_u32 s56, s56, s41
    s_lshl_b32 s56, s56, 19
    s_add_u32 s56, s56, 0x2000000
L_w_qkv_112:
    s_cmp_lg_u32 s44, 0
    s_cbranch_scc1 L_pd_113
    v_mov_b32 v29, s71
    s_mov_b32 s46, 96
    s_mov_b64 exec, 1
    s_mov_b32 s70, 0
L_wp_114:
    buffer_load_dword v31, v29, s[12:15], 0 offen sc1
    s_add_u32 s70, s70, 1
    s_cmp_ge_u32 s70, 0x200000
    s_cbranch_scc1 L_w_done_96
L_wp_114_c:
    s_waitcnt vmcnt(0)
    v_cmp_gt_u32 vcc, s46, v31
    s_nop 1
    s_cbranch_vccz L_wp_114_ok
    s_sleep 2
    s_branch L_wp_114
L_wp_114_ok:
    s_mov_b64 exec, -1
L_pd_113:
    s_barrier
L_w_qkv_112_n:
    s_mov_b32 s50, s60
    s_mul_i32 s53, s50, 65536
    s_add_u32 s53, s53, s52
    s_lshl_b32 s54, s44, 13
    s_add_u32 s53, s53, s54
    s_mul_i32 s57, s50, 8192
    s_add_u32 s57, s57, s56
    s_lshl_b32 s45, s44, 11
    s_add_u32 s57, s57, s45
    s_add_u32 s55, s54, 65536
    s_mov_b32 s58, 0
    v_mov_b32 v13, v3
    v_add_u32 v14, 65536, v13
    v_xor_b32 v15, 64, v13
    v_xor_b32 v16, 64, v14
    s_mov_b32 s76, 0x20000000
    s_add_u32 s48, s53, 0
    s_add_u32 s49, s48, 4096
    s_add_u32 m0, s54, 0
    s_nop 0
    buffer_load_dwordx4 v6, s[12:15], s48 offen offset:0 sc1 lds
    s_add_u32 m0, s54, 1024
    s_nop 0
    buffer_load_dwordx4 v9, s[12:15], s48 offen offset:0 sc1 lds
    s_add_u32 m0, s54, 2048
    s_nop 0
    buffer_load_dwordx4 v6, s[12:15], s49 offen offset:0 sc1 lds
    s_add_u32 m0, s54, 3072
    s_nop 0
    buffer_load_dwordx4 v9, s[12:15], s49 offen offset:0 sc1 lds
    s_add_u32 m0, s54, 3968
    s_nop 0
    buffer_load_dwordx4 v6, s[12:15], s48 offen offset:128 sc1 lds
    s_add_u32 m0, s54, 4992
    s_nop 0
    buffer_load_dwordx4 v9, s[12:15], s48 offen offset:128 sc1 lds
    s_add_u32 m0, s54, 6016
    s_nop 0
    buffer_load_dwordx4 v6, s[12:15], s49 offen offset:128 sc1 lds
    s_add_u32 m0, s54, 7040
    s_nop 0
    buffer_load_dwordx4 v9, s[12:15], s49 offen offset:128 sc1 lds
    s_add_u32 s48, s53, 32768
    s_add_u32 s49, s48, 4096
    s_add_u32 s46, s54, 32768
    s_add_u32 m0, s46, 0
    s_nop 0
    buffer_load_dwordx4 v6, s[12:15], s48 offen offset:0 sc1 lds
    s_add_u32 m0, s46, 1024
    s_nop 0
    buffer_load_dwordx4 v9, s[12:15], s48 offen offset:0 sc1 lds
    s_add_u32 m0, s46, 2048
    s_nop 0
    buffer_load_dwordx4 v6, s[12:15], s49 offen offset:0 sc1 lds
    s_add_u32 m0, s46, 3072
    s_nop 0
    buffer_load_dwordx4 v9, s[12:15], s49 offen offset:0 sc1 lds
    s_add_u32 m0, s46, 3968
    s_nop 0
    buffer_load_dwordx4 v6, s[12:15], s48 offen offset:128 sc1 lds
    s_add_u32 m0, s46, 4992
    s_nop 0
    buffer_load_dwordx4 v9, s[12:15], s48 offen offset:128 sc1 lds
    s_add_u32 m0, s46, 6016
    s_nop 0
    buffer_load_dwordx4 v6, s[12:15], s49 offen offset:128 sc1 lds
    s_add_u32 m0, s46, 7040
    s_nop 0
    buffer_load_dwordx4 v9, s[12:15], s49 offen offset:128 sc1 lds
    s_cmp_eq_u32 s51, 1
    s_cbranch_scc1 L_e_one_116
    s_add_u32 s48, s53, 65536
    s_add_u32 s49, s48, 4096
    s_add_u32 m0, s55, 0
    s_nop 0
    buffer_load_dwordx4 v6, s[12:15], s48 offen offset:0 sc1 lds
    s_add_u32 m0, s55, 1024
    s_nop 0
    buffer_load_dwordx4 v9, s[12:15], s48 offen offset:0 sc1 lds
    s_add_u32 m0, s55, 2048
    s_nop 0
    buffer_load_dwordx4 v6, s[12:15], s49 offen offset:0 sc1 lds
    s_add_u32 m0, s55, 3072
    s_nop 0
    buffer_load_dwordx4 v9, s[12:15], s49 offen offset:0 sc1 lds
    s_add_u32 m0, s55, 3968
    s_nop 0
    buffer_load_dwordx4 v6, s[12:15], s48 offen offset:128 sc1 lds
    s_add_u32 m0, s55, 4992
    s_nop 0
    buffer_load_dwordx4 v9, s[12:15], s48 offen offset:128 sc1 lds
    s_add_u32 m0, s55, 6016
    s_nop 0
    buffer_load_dwordx4 v6, s[12:15], s49 offen offset:128 sc1 lds
    s_add_u32 m0, s55, 7040
    s_nop 0
    buffer_load_dwordx4 v9, s[12:15], s49 offen offset:128 sc1 lds
    s_waitcnt vmcnt(16)
    s_barrier
    ds_read_b128 v[32:35], v13 offset:0
    ds_read_b128 v[36:39], v13 offset:2048
    ds_read_b128 v[40:43], v15 offset:0
    ds_read_b128 v[44:47], v15 offset:2048
    s_add_u32 s48, s53, 98304
    s_add_u32 s46, s58, 1
    s_cmp_lt_u32 s46, s51
    s_cselect_b32 s48, s48, 0x20000000
    s_add_u32 s49, s48, 4096
    s_add_u32 s59, s55, 32768
L_e_loop_115:
    s_waitcnt lgkmcnt(2)
    v_mfma_f32_16x16x32_bf16 v[80:83], a[0:3], v[32:35], 0
    ds_read_b128 v[48:51], v13 offset:4096
    v_mfma_f32_16x16x32_bf16 v[84:87], a[4:7], v[32:35], 0
    ds_read_b128 v[52:55], v13 offset:6144
    v_mfma_f32_16x16x32_bf16 v[88:91], a[0:3], v[36:39], 0
    ds_read_b128 v[56:59], v15 offset:4096
    s_add_u32 m0, s59, 0
    v_mfma_f32_16x16x32_bf16 v[92:95], a[4:7], v[36:39], 0
    ds_read_b128 v[60:63], v15 offset:6144
    buffer_load_dwordx4 v6, s[12:15], s48 offen offset:0 sc1 lds
    s_waitcnt lgkmcnt(4)
    v_mfma_f32_16x16x32_bf16 v[80:83], a[8:11], v[40:43], v[80:83]
    ds_read_b128 v[32:35], v13 offset:8192
    v_mfma_f32_16x16x32_bf16 v[84:87], a[12:15], v[40:43], v[84:87]
    ds_read_b128 v[36:39], v13 offset:10240
    v_mfma_f32_16x16x32_bf16 v[88:91], a[8:11], v[44:47], v[88:91]
    s_add_u32 m0, s59, 1024
    v_mfma_f32_16x16x32_bf16 v[92:95], a[12:15], v[44:47], v[92:95]
    buffer_load_dwordx4 v9, s[12:15], s48 offen offset:0 sc1 lds
    s_waitcnt lgkmcnt(4)
    v_mfma_f32_16x16x32_bf16 v[80:83], a[16:19], v[48:51], v[80:83]
    ds_read_b128 v[40:43], v15 offset:8192
    v_mfma_f32_16x16x32_bf16 v[84:87], a[20:23], v[48:51], v[84:87]
    ds_read_b128 v[44:47], v15 offset:10240
    v_mfma_f32_16x16x32_bf16 v[88:91], a[16:19], v[52:55], v[88:91]
    s_add_u32 m0, s59, 2048
    v_mfma_f32_16x16x32_bf16 v[92:95], a[20:23], v[52:55], v[92:95]
    buffer_load_dwordx4 v6, s[12:15], s49 offen offset:0 sc1 lds
    s_waitcnt lgkmcnt(4)
    v_mfma_f32_16x16x32_bf16 v[80:83], a[24:27], v[56:59], v[80:83]
    ds_read_b128 v[48:51], v13 offset:12288
    v_mfma_f32_16x16x32_bf16 v[84:87], a[28:31], v[56:59], v[84:87]
    ds_read_b128 v[52:55], v13 offset:14336
    v_mfma_f32_16x16x32_bf16 v[88:91], a[24:27], v[60:63], v[88:91]
    s_add_u32 m0, s59, 3072
    v_mfma_f32_16x16x32_bf16 v[92:95], a[28:31], v[60:63], v[92:95]
    buffer_load_dwordx4 v9, s[12:15], s49 offen offset:0 sc1 lds
    s_waitcnt lgkmcnt(4)
    v_mfma_f32_16x16x32_bf16 v[80:83], a[32:35], v[32:35], v[80:83]
    ds_read_b128 v[56:59], v15 offset:12288
    v_mfma_f32_16x16x32_bf16 v[84:87], a[36:39], v[32:35], v[84:87]
    ds_read_b128 v[60:63], v15 offset:14336
    v_mfma_f32_16x16x32_bf16 v[88:91], a[32:35], v[36:39], v[88:91]
    s_add_u32 m0, s59, 3968
    v_mfma_f32_16x16x32_bf16 v[92:95], a[36:39], v[36:39], v[92:95]
    buffer_load_dwordx4 v6, s[12:15], s48 offen offset:128 sc1 lds
    s_waitcnt lgkmcnt(4)
    v_mfma_f32_16x16x32_bf16 v[80:83], a[40:43], v[40:43], v[80:83]
    ds_read_b128 v[32:35], v13 offset:16384
    v_mfma_f32_16x16x32_bf16 v[84:87], a[44:47], v[40:43], v[84:87]
    ds_read_b128 v[36:39], v13 offset:18432
    v_mfma_f32_16x16x32_bf16 v[88:91], a[40:43], v[44:47], v[88:91]
    s_add_u32 m0, s59, 4992
    v_mfma_f32_16x16x32_bf16 v[92:95], a[44:47], v[44:47], v[92:95]
    buffer_load_dwordx4 v9, s[12:15], s48 offen offset:128 sc1 lds
    s_waitcnt lgkmcnt(4)
    v_mfma_f32_16x16x32_bf16 v[80:83], a[48:51], v[48:51], v[80:83]
    ds_read_b128 v[40:43], v15 offset:16384
    v_mfma_f32_16x16x32_bf16 v[84:87], a[52:55], v[48:51], v[84:87]
    ds_read_b128 v[44:47], v15 offset:18432
    v_mfma_f32_16x16x32_bf16 v[88:91], a[48:51], v[52:55], v[88:91]
    s_add_u32 m0, s59, 6016
    v_mfma_f32_16x16x32_bf16 v[92:95], a[52:55], v[52:55], v[92:95]
    buffer_load_dwordx4 v6, s[12:15], s49 offen offset:128 sc1 lds
    s_waitcnt lgkmcnt(4)
    v_mfma_f32_16x16x32_bf16 v[80:83], a[56:59], v[56:59], v[80:83]
    ds_read_b128 v[48:51], v13 offset:20480
    v_mfma_f32_16x16x32_bf16 v[84:87], a[60:63], v[56:59], v[84:87]
    ds_read_b128 v[52:55], v13 offset:22528
    v_mfma_f32_16x16x32_bf16 v[88:91], a[56:59], v[60:63], v[88:91]
    s_add_u32 m0, s59, 7040
    v_mfma_f32_16x16x32_bf16 v[92:95], a[60:63], v[60:63], v[92:95]
    buffer_load_dwordx4 v9, s[12:15], s49 offen offset:128 sc1 lds
    s_waitcnt lgkmcnt(4)
    v_mfma_f32_16x16x32_bf16 v[80:83], a[64:67], v[32:35], v[80:83]
    ds_read_b128 v[56:59], v15 offset:20480
    v_mfma_f32_16x16x32_bf16 v[84:87], a[68:71], v[32:35], v[84:87]
    ds_read_b128 v[60:63], v15 offset:22528
    v_mfma_f32_16x16x32_bf16 v[88:91], a[64:67], v[36:39], v[88:91]
    s_add_u32 s48, s53, 131072
    v_mfma_f32_16x16x32_bf16 v[92:95], a[68:71], v[36:39], v[92:95]
    s_add_u32 s46, s58, 2
    s_waitcnt lgkmcnt(4)
    v_mfma_f32_16x16x32_bf16 v[80:83], a[72:75], v[40:43], v[80:83]
    ds_read_b128 v[32:35], v13 offset:24576
    v_mfma_f32_16x16x32_bf16 v[84:87], a[76:79], v[40:43], v[84:87]
    ds_read_b128 v[36:39], v13 offset:26624
    v_mfma_f32_16x16x32_bf16 v[88:91], a[72:75], v[44:47], v[88:91]
    s_cmp_lt_u32 s46, s51
    s_cselect_b32 s48, s48, 0x20000000
    v_mfma_f32_16x16x32_bf16 v[92:95], a[76:79], v[44:47], v[92:95]
    s_add_u32 s49, s48, 4096
    s_waitcnt lgkmcnt(4)
    v_mfma_f32_16x16x32_bf16 v[80:83], a[80:83], v[48:51], v[80:83]
    ds_read_b128 v[40:43], v15 offset:24576
    v_mfma_f32_16x16x32_bf16 v[84:87], a[84:87], v[48:51], v[84:87]
    ds_read_b128 v[44:47], v15 offset:26624
    v_mfma_f32_16x16x32_bf16 v[88:91], a[80:83], v[52:55], v[88:91]
    s_mov_b32 s59, s54
    v_mfma_f32_16x16x32_bf16 v[92:95], a[84:87], v[52:55], v[92:95]
    s_waitcnt lgkmcnt(4)
    v_mfma_f32_16x16x32_bf16 v[80:83], a[88:91], v[56:59], v[80:83]
    ds_read_b128 v[48:51], v13 offset:28672
    v_mfma_f32_16x16x32_bf16 v[84:87], a[92:95], v[56:59], v[84:87]
    ds_read_b128 v[52:55], v13 offset:30720
    v_mfma_f32_16x16x32_bf16 v[88:91], a[88:91], v[60:63], v[88:91]
    v_mfma_f32_16x16x32_bf16 v[92:95], a[92:95], v[60:63], v[92:95]
    s_waitcnt lgkmcnt(4)
    v_mfma_f32_16x16x32_bf16 v[80:83], a[96:99], v[32:35], v[80:83]
    ds_read_b128 v[56:59], v15 offset:28672
    v_mfma_f32_16x16x32_bf16 v[84:87], a[100:103], v[32:35], v[84:87]
    ds_read_b128 v[60:63], v15 offset:30720
    v_mfma_f32_16x16x32_bf16 v[88:91], a[96:99], v[36:39], v[88:91]
    v_mfma_f32_16x16x32_bf16 v[92:95], a[100:103], v[36:39], v[92:95]
    s_waitcnt lgkmcnt(4)
    v_mfma_f32_16x16x32_bf16 v[80:83], a[104:107], v[40:43], v[80:83]
    v_mfma_f32_16x16x32_bf16 v[84:87], a[108:111], v[40:43], v[84:87]
    v_mfma_f32_16x16x32_bf16 v[88:91], a[104:107], v[44:47], v[88:91]
    v_mfma_f32_16x16x32_bf16 v[92:95], a[108:111], v[44:47], v[92:95]
    s_waitcnt vmcnt(16) lgkmcnt(0)
    s_barrier
    v_mfma_f32_16x16x32_bf16 v[80:83], a[112:115], v[48:51], v[80:83]
    ds_read_b128 v[32:35], v13 offset:32768
    v_mfma_f32_16x16x32_bf16 v[84:87], a[116:119], v[48:51], v[84:87]
    ds_read_b128 v[36:39], v13 offset:34816
    v_mfma_f32_16x16x32_bf16 v[88:91], a[112:115], v[52:55], v[88:91]
    v_mfma_f32_16x16x32_bf16 v[92:95], a[116:119], v[52:55], v[92:95]
    v_mfma_f32_16x16x32_bf16 v[80:83], a[120:123], v[56:59], v[80:83]
    ds_read_b128 v[40:43], v15 offset:32768
    v_mfma_f32_16x16x32_bf16 v[84:87], a[124:127], v[56:59], v[84:87]
    ds_read_b128 v[44:47], v15 offset:34816
    v_mfma_f32_16x16x32_bf16 v[88:91], a[120:123], v[60:63], v[88:91]
    v_mfma_f32_16x16x32_bf16 v[92:95], a[124:127], v[60:63], v[92:95]
    s_waitcnt lgkmcnt(2)
    v_mfma_f32_16x16x32_bf16 v[80:83], a[128:131], v[32:35], v[80:83]
    ds_read_b128 v[48:51], v13 offset:36864
    v_mfma_f32_16x16x32_bf16 v[84:87], a[132:135], v[32:35], v[84:87]
    ds_read_b128 v[52:55], v13 offset:38912
    v_mfma_f32_16x16x32_bf16 v[88:91], a[128:131], v[36:39], v[88:91]
    ds_read_b128 v[56:59], v15 offset:36864
    s_add_u32 m0, s59, 0
    v_mfma_f32_16x16x32_bf16 v[92:95], a[132:135], v[36:39], v[92:95]
    ds_read_b128 v[60:63], v15 offset:38912
    buffer_load_dwordx4 v6, s[12:15], s48 offen offset:0 sc1 lds
    s_waitcnt lgkmcnt(4)
    v_mfma_f32_16x16x32_bf16 v[80:83], a[136:139], v[40:43], v[80:83]
    ds_read_b128 v[32:35], v13 offset:40960
    v_mfma_f32_16x16x32_bf16 v[84:87], a[140:143], v[40:43], v[84:87]
    ds_read_b128 v[36:39], v13 offset:43008
    v_mfma_f32_16x16x32_bf16 v[88:91], a[136:139], v[44:47], v[88:91]
    s_add_u32 m0, s59, 1024
    v_mfma_f32_16x16x32_bf16 v[92:95], a[140:143], v[44:47], v[92:95]
    buffer_load_dwordx4 v9, s[12:15], s48 offen offset:0 sc1 lds
    s_waitcnt lgkmcnt(4)
    v_mfma_f32_16x16x32_bf16 v[80:83], a[144:147], v[48:51], v[80:83]
    ds_read_b128 v[40:43], v15 offset:40960
    v_mfma_f32_16x16x32_bf16 v[84:87], a[148:151], v[48:51], v[84:87]
    ds_read_b128 v[44:47], v15 offset:43008
    v_mfma_f32_16x16x32_bf16 v[88:91], a[144:147], v[52:55], v[88:91]
    s_add_u32 m0, s59, 2048
    v_mfma_f32_16x16x32_bf16 v[92:95], a[148:151], v[52:55], v[92:95]
    buffer_load_dwordx4 v6, s[12:15], s49 offen offset:0 sc1 lds
    s_waitcnt lgkmcnt(4)
    v_mfma_f32_16x16x32_bf16 v[80:83], a[152:155], v[56:59], v[80:83]
    ds_read_b128 v[48:51], v13 offset:45056
    v_mfma_f32_16x16x32_bf16 v[84:87], a[156:159], v[56:59], v[84:87]
    ds_read_b128 v[52:55], v13 offset:47104
    v_mfma_f32_16x16x32_bf16 v[88:91], a[152:155], v[60:63], v[88:91]
    s_add_u32 m0, s59, 3072
    v_mfma_f32_16x16x32_bf16 v[92:95], a[156:159], v[60:63], v[92:95]
    buffer_load_dwordx4 v9, s[12:15], s49 offen offset:0 sc1 lds
    s_waitcnt lgkmcnt(4)
    v_mfma_f32_16x16x32_bf16 v[80:83], a[160:163], v[32:35], v[80:83]
    ds_read_b128 v[56:59], v15 offset:45056
    v_mfma_f32_16x16x32_bf16 v[84:87], a[164:167], v[32:35], v[84:87]
    ds_read_b128 v[60:63], v15 offset:47104
    v_mfma_f32_16x16x32_bf16 v[88:91], a[160:163], v[36:39], v[88:91]
    s_add_u32 m0, s59, 3968
    v_mfma_f32_16x16x32_bf16 v[92:95], a[164:167], v[36:39], v[92:95]
    buffer_load_dwordx4 v6, s[12:15], s48 offen offset:128 sc1 lds
    s_waitcnt lgkmcnt(4)
    v_mfma_f32_16x16x32_bf16 v[80:83], a[168:171], v[40:43], v[80:83]
    ds_read_b128 v[32:35], v13 offset:49152
    v_mfma_f32_16x16x32_bf16 v[84:87], a[172:175], v[40:43], v[84:87]
    ds_read_b128 v[36:39], v13 offset:51200
    v_mfma_f32_16x16x32_bf16 v[88:91], a[168:171], v[44:47], v[88:91]
    s_add_u32 m0, s59, 4992
    v_mfma_f32_16x16x32_bf16 v[92:95], a[172:175], v[44:47], v[92:95]
    buffer_load_dwordx4 v9, s[12:15], s48 offen offset:128 sc1 lds
    s_waitcnt lgkmcnt(4)
    v_mfma_f32_16x16x32_bf16 v[80:83], a[176:179], v[48:51], v[80:83]
    ds_read_b128 v[40:43], v15 offset:49152
    v_mfma_f32_16x16x32_bf16 v[84:87], a[180:183], v[48:51], v[84:87]
    ds_read_b128 v[44:47], v15 offset:51200
    v_mfma_f32_16x16x32_bf16 v[88:91], a[176:179], v[52:55], v[88:91]
    s_add_u32 m0, s59, 6016
    v_mfma_f32_16x16x32_bf16 v[92:95], a[180:183], v[52:55], v[92:95]
    buffer_load_dwordx4 v6, s[12:15], s49 offen offset:128 sc1 lds
    s_waitcnt lgkmcnt(4)
    v_mfma_f32_16x16x32_bf16 v[80:83], a[184:187], v[56:59], v[80:83]
    ds_read_b128 v[48:51], v13 offset:53248
    v_mfma_f32_16x16x32_bf16 v[84:87], a[188:191], v[56:59], v[84:87]
    ds_read_b128 v[52:55], v13 offset:55296
    v_mfma_f32_16x16x32_bf16 v[88:91], a[184:187], v[60:63], v[88:91]
    s_add_u32 m0, s59, 7040
    v_mfma_f32_16x16x32_bf16 v[92:95], a[188:191], v[60:63], v[92:95]
    buffer_load_dwordx4 v9, s[12:15], s49 offen offset:128 sc1 lds
    s_waitcnt lgkmcnt(4)
    v_mfma_f32_16x16x32_bf16 v[80:83], a[192:195], v[32:35], v[80:83]
    ds_read_b128 v[56:59], v15 offset:53248
    v_mfma_f32_16x16x32_bf16 v[84:87], a[196:199], v[32:35], v[84:87]
    ds_read_b128 v[60:63], v15 offset:55296
    v_mfma_f32_16x16x32_bf16 v[88:91], a[192:195], v[36:39], v[88:91]
    s_add_u32 s48, s53, 163840
    v_mfma_f32_16x16x32_bf16 v[92:95], a[196:199], v[36:39], v[92:95]
    s_add_u32 s46, s58, 2
    s_waitcnt lgkmcnt(4)
    v_mfma_f32_16x16x32_bf16 v[80:83], a[200:203], v[40:43], v[80:83]
    ds_read_b128 v[32:35], v13 offset:57344
    v_mfma_f32_16x16x32_bf16 v[84:87], a[204:207], v[40:43], v[84:87]
    ds_read_b128 v[36:39], v13 offset:59392
    v_mfma_f32_16x16x32_bf16 v[88:91], a[200:203], v[44:47], v[88:91]
    s_cmp_lt_u32 s46, s51
    s_cselect_b32 s48, s48, 0x20000000
    v_mfma_f32_16x16x32_bf16 v[92:95], a[204:207], v[44:47], v[92:95]
    s_add_u32 s49, s48, 4096
    s_waitcnt lgkmcnt(4)
    v_mfma_f32_16x16x32_bf16 v[80:83], a[208:211], v[48:51], v[80:83]
    ds_read_b128 v[40:43], v15 offset:57344
    v_mfma_f32_16x16x32_bf16 v[84:87], a[212:215], v[48:51], v[84:87]
    ds_read_b128 v[44:47], v15 offset:59392
    v_mfma_f32_16x16x32_bf16 v[88:91], a[208:211], v[52:55], v[88:91]
    s_add_u32 s59, s54, 32768
    v_mfma_f32_16x16x32_bf16 v[92:95], a[212:215], v[52:55], v[92:95]
    s_waitcnt lgkmcnt(4)
    v_mfma_f32_16x16x32_bf16 v[80:83], a[216:219], v[56:59], v[80:83]
    ds_read_b128 v[48:51], v13 offset:61440
    v_mfma_f32_16x16x32_bf16 v[84:87], a[220:223], v[56:59], v[84:87]
    ds_read_b128 v[52:55], v13 offset:63488
    v_mfma_f32_16x16x32_bf16 v[88:91], a[216:219], v[60:63], v[88:91]
    v_mfma_f32_16x16x32_bf16 v[92:95], a[220:223], v[60:63], v[92:95]
    s_waitcnt lgkmcnt(4)
    v_mfma_f32_16x16x32_bf16 v[80:83], a[224:227], v[32:35], v[80:83]
    ds_read_b128 v[56:59], v15 offset:61440
    v_mfma_f32_16x16x32_bf16 v[84:87], a[228:231], v[32:35], v[84:87]
    ds_read_b128 v[60:63], v15 offset:63488
    v_mfma_f32_16x16x32_bf16 v[88:91], a[224:227], v[36:39], v[88:91]
    v_mfma_f32_16x16x32_bf16 v[92:95], a[228:231], v[36:39], v[92:95]
    s_waitcnt lgkmcnt(4)
    v_mfma_f32_16x16x32_bf16 v[80:83], a[232:235], v[40:43], v[80:83]
    v_mfma_f32_16x16x32_bf16 v[84:87], a[236:239], v[40:43], v[84:87]
    v_mfma_f32_16x16x32_bf16 v[88:91], a[232:235], v[44:47], v[88:91]
    v_mfma_f32_16x16x32_bf16 v[92:95], a[236:239], v[44:47], v[92:95]
    s_waitcnt vmcnt(16) lgkmcnt(0)
    s_barrier
    s_cmp_lg_u32 s44, 0
    s_cbranch_scc1 L_e_pr_118
    s_add_u32 s45, s58, s60
    v_mov_b32 v30, s45
    v_mov_b32 v31, 0
    s_mov_b64 exec, 1
    buffer_store_dword v30, v31, s[12:15], s61 offen sc1
    s_mov_b64 exec, -1
L_e_pr_118:
    v_mfma_f32_16x16x32_bf16 v[80:83], a[240:243], v[48:51], v[80:83]
    ds_read_b128 v[32:35], v14 offset:0
    v_mfma_f32_16x16x32_bf16 v[84:87], a[244:247], v[48:51], v[84:87]
    ds_read_b128 v[36:39], v14 offset:2048
    v_mfma_f32_16x16x32_bf16 v[88:91], a[240:243], v[52:55], v[88:91]
    v_mfma_f32_16x16x32_bf16 v[92:95], a[244:247], v[52:55], v[92:95]
    v_mfma_f32_16x16x32_bf16 v[80:83], a[248:251], v[56:59], v[80:83]
    ds_read_b128 v[40:43], v16 offset:0
    v_mfma_f32_16x16x32_bf16 v[84:87], a[252:255], v[56:59], v[84:87]
    ds_read_b128 v[44:47], v16 offset:2048
    v_mfma_f32_16x16x32_bf16 v[88:91], a[248:251], v[60:63], v[88:91]
    v_mfma_f32_16x16x32_bf16 v[92:95], a[252:255], v[60:63], v[92:95]
    s_add_u32 s53, s53, 65536
    s_add_u32 s58, s58, 1
    v_swap_b32 v13, v14
    s_xor_b32 s54, s54, 65536
    s_xor_b32 s55, s55, 65536
    s_mov_b32 s76, s57
    v_swap_b32 v15, v16
    s_add_u32 s57, s57, 8192
    v_cvt_pk_bf16_f32 v216, v80, v81
    v_cvt_pk_bf16_f32 v217, v82, v83
    v_cvt_pk_bf16_f32 v218, v84, v85
    v_cvt_pk_bf16_f32 v219, v86, v87
    v_cvt_pk_bf16_f32 v220, v88, v89
    v_cvt_pk_bf16_f32 v221, v90, v91
    v_cvt_pk_bf16_f32 v222, v92, v93
    v_cvt_pk_bf16_f32 v223, v94, v95
    buffer_store_dwordx4 v[216:219], v10, s[12:15], s76 offen sc1
    buffer_store_dwordx4 v[220:223], v10, s[12:15], s76 offen offset:1024 sc1
    s_cmp_lt_u32 s58, s51
    s_cbranch_scc1 L_e_loop_115
    s_branch L_e_fin_117
L_e_one_116:
    s_waitcnt vmcnt(8)
    s_barrier
    ds_read_b128 v[32:35], v13 offset:0
    ds_read_b128 v[36:39], v13 offset:2048
    ds_read_b128 v[40:43], v15 offset:0
    ds_read_b128 v[44:47], v15 offset:2048
    s_waitcnt lgkmcnt(2)
    v_mfma_f32_16x16x32_bf16 v[80:83], a[0:3], v[32:35], 0
    ds_read_b128 v[48:51], v13 offset:4096
    v_mfma_f32_16x16x32_bf16 v[84:87], a[4:7], v[32:35], 0
    ds_read_b128 v[52:55], v13 offset:6144
    v_mfma_f32_16x16x32_bf16 v[88:91], a[0:3], v[36:39], 0
    ds_read_b128 v[56:59], v15 offset:4096
    v_mfma_f32_16x16x32_bf16 v[92:95], a[4:7], v[36:39], 0
    ds_read_b128 v[60:63], v15 offset:6144
    s_waitcnt lgkmcnt(4)
    v_mfma_f32_16x16x32_bf16 v[80:83], a[8:11], v[40:43], v[80:83]
    ds_read_b128 v[32:35], v13 offset:8192
    v_mfma_f32_16x16x32_bf16 v[84:87], a[12:15], v[40:43], v[84:87]
    ds_read_b128 v[36:39], v13 offset:10240
    v_mfma_f32_16x16x32_bf16 v[88:91], a[8:11], v[44:47], v[88:91]
    v_mfma_f32_16x16x32_bf16 v[92:95], a[12:15], v[44:47], v[92:95]
    s_waitcnt lgkmcnt(4)
    v_mfma_f32_16x16x32_bf16 v[80:83], a[16:19], v[48:51], v[80:83]
    ds_read_b128 v[40:43], v15 offset:8192
    v_mfma_f32_16x16x32_bf16 v[84:87], a[20:23], v[48:51], v[84:87]
    ds_read_b128 v[44:47], v15 offset:10240
    v_mfma_f32_16x16x32_bf16 v[88:91], a[16:19], v[52:55], v[88:91]
    v_mfma_f32_16x16x32_bf16 v[92:95], a[20:23], v[52:55], v[92:95]
    s_waitcnt lgkmcnt(4)
    v_mfma_f32_16x16x32_bf16 v[80:83], a[24:27], v[56:59], v[80:83]
    ds_read_b128 v[48:51], v13 offset:12288
    v_mfma_f32_16x16x32_bf16 v[84:87], a[28:31], v[56:59], v[84:87]
    ds_read_b128 v[52:55], v13 offset:14336
    v_mfma_f32_16x16x32_bf16 v[88:91], a[24:27], v[60:63], v[88:91]
    v_mfma_f32_16x16x32_bf16 v[92:95], a[28:31], v[60:63], v[92:95]
    s_waitcnt lgkmcnt(4)
    v_mfma_f32_16x16x32_bf16 v[80:83], a[32:35], v[32:35], v[80:83]
    ds_read_b128 v[56:59], v15 offset:12288
    v_mfma_f32_16x16x32_bf16 v[84:87], a[36:39], v[32:35], v[84:87]
    ds_read_b128 v[60:63], v15 offset:14336
    v_mfma_f32_16x16x32_bf16 v[88:91], a[32:35], v[36:39], v[88:91]
    v_mfma_f32_16x16x32_bf16 v[92:95], a[36:39], v[36:39], v[92:95]
    s_waitcnt lgkmcnt(4)
    v_mfma_f32_16x16x32_bf16 v[80:83], a[40:43], v[40:43], v[80:83]
    ds_read_b128 v[32:35], v13 offset:16384
    v_mfma_f32_16x16x32_bf16 v[84:87], a[44:47], v[40:43], v[84:87]
    ds_read_b128 v[36:39], v13 offset:18432
    v_mfma_f32_16x16x32_bf16 v[88:91], a[40:43], v[44:47], v[88:91]
    v_mfma_f32_16x16x32_bf16 v[92:95], a[44:47], v[44:47], v[92:95]
    s_waitcnt lgkmcnt(4)
    v_mfma_f32_16x16x32_bf16 v[80:83], a[48:51], v[48:51], v[80:83]
    ds_read_b128 v[40:43], v15 offset:16384
    v_mfma_f32_16x16x32_bf16 v[84:87], a[52:55], v[48:51], v[84:87]
    ds_read_b128 v[44:47], v15 offset:18432
    v_mfma_f32_16x16x32_bf16 v[88:91], a[48:51], v[52:55], v[88:91]
    v_mfma_f32_16x16x32_bf16 v[92:95], a[52:55], v[52:55], v[92:95]
    s_waitcnt lgkmcnt(4)
    v_mfma_f32_16x16x32_bf16 v[80:83], a[56:59], v[56:59], v[80:83]
    ds_read_b128 v[48:51], v13 offset:20480
    v_mfma_f32_16x16x32_bf16 v[84:87], a[60:63], v[56:59], v[84:87]
    ds_read_b128 v[52:55], v13 offset:22528
    v_mfma_f32_16x16x32_bf16 v[88:91], a[56:59], v[60:63], v[88:91]
    v_mfma_f32_16x16x32_bf16 v[92:95], a[60:63], v[60:63], v[92:95]
    s_waitcnt lgkmcnt(4)
    v_mfma_f32_16x16x32_bf16 v[80:83], a[64:67], v[32:35], v[80:83]
    ds_read_b128 v[56:59], v15 offset:20480
    v_mfma_f32_16x16x32_bf16 v[84:87], a[68:71], v[32:35], v[84:87]
    ds_read_b128 v[60:63], v15 offset:22528
    v_mfma_f32_16x16x32_bf16 v[88:91], a[64:67], v[36:39], v[88:91]
    v_mfma_f32_16x16x32_bf16 v[92:95], a[68:71], v[36:39], v[92:95]
    s_waitcnt lgkmcnt(4)
    v_mfma_f32_16x16x32_bf16 v[80:83], a[72:75], v[40:43], v[80:83]
    ds_read_b128 v[32:35], v13 offset:24576
    v_mfma_f32_16x16x32_bf16 v[84:87], a[76:79], v[40:43], v[84:87]
    ds_read_b128 v[36:39], v13 offset:26624
    v_mfma_f32_16x16x32_bf16 v[88:91], a[72:75], v[44:47], v[88:91]
    v_mfma_f32_16x16x32_bf16 v[92:95], a[76:79], v[44:47], v[92:95]
    s_waitcnt lgkmcnt(4)
    v_mfma_f32_16x16x32_bf16 v[80:83], a[80:83], v[48:51], v[80:83]
    ds_read_b128 v[40:43], v15 offset:24576
    v_mfma_f32_16x16x32_bf16 v[84:87], a[84:87], v[48:51], v[84:87]
    ds_read_b128 v[44:47], v15 offset:26624
    v_mfma_f32_16x16x32_bf16 v[88:91], a[80:83], v[52:55], v[88:91]
    v_mfma_f32_16x16x32_bf16 v[92:95], a[84:87], v[52:55], v[92:95]
    s_waitcnt lgkmcnt(4)
    v_mfma_f32_16x16x32_bf16 v[80:83], a[88:91], v[56:59], v[80:83]
    ds_read_b128 v[48:51], v13 offset:28672
    v_mfma_f32_16x16x32_bf16 v[84:87], a[92:95], v[56:59], v[84:87]
    ds_read_b128 v[52:55], v13 offset:30720
    v_mfma_f32_16x16x32_bf16 v[88:91], a[88:91], v[60:63], v[88:91]
    v_mfma_f32_16x16x32_bf16 v[92:95], a[92:95], v[60:63], v[92:95]
    s_waitcnt lgkmcnt(4)
    v_mfma_f32_16x16x32_bf16 v[80:83], a[96:99], v[32:35], v[80:83]
    ds_read_b128 v[56:59], v15 offset:28672
    v_mfma_f32_16x16x32_bf16 v[84:87], a[100:103], v[32:35], v[84:87]
    ds_read_b128 v[60:63], v15 offset:30720
    v_mfma_f32_16x16x32_bf16 v[88:91], a[96:99], v[36:39], v[88:91]
    v_mfma_f32_16x16x32_bf16 v[92:95], a[100:103], v[36:39], v[92:95]
    s_waitcnt lgkmcnt(4)
    v_mfma_f32_16x16x32_bf16 v[80:83], a[104:107], v[40:43], v[80:83]
    v_mfma_f32_16x16x32_bf16 v[84:87], a[108:111], v[40:43], v[84:87]
    v_mfma_f32_16x16x32_bf16 v[88:91], a[104:107], v[44:47], v[88:91]
    v_mfma_f32_16x16x32_bf16 v[92:95], a[108:111], v[44:47], v[92:95]
    s_waitcnt vmcnt(0) lgkmcnt(0)
    s_barrier
    v_mfma_f32_16x16x32_bf16 v[80:83], a[112:115], v[48:51], v[80:83]
    ds_read_b128 v[32:35], v13 offset:32768
    v_mfma_f32_16x16x32_bf16 v[84:87], a[116:119], v[48:51], v[84:87]
    ds_read_b128 v[36:39], v13 offset:34816
    v_mfma_f32_16x16x32_bf16 v[88:91], a[112:115], v[52:55], v[88:91]
    v_mfma_f32_16x16x32_bf16 v[92:95], a[116:119], v[52:55], v[92:95]
    v_mfma_f32_16x16x32_bf16 v[80:83], a[120:123], v[56:59], v[80:83]
    ds_read_b128 v[40:43], v15 offset:32768
    v_mfma_f32_16x16x32_bf16 v[84:87], a[124:127], v[56:59], v[84:87]
    ds_read_b128 v[44:47], v15 offset:34816
    v_mfma_f32_16x16x32_bf16 v[88:91], a[120:123], v[60:63], v[88:91]
    v_mfma_f32_16x16x32_bf16 v[92:95], a[124:127], v[60:63], v[92:95]
    s_waitcnt lgkmcnt(2)
    v_mfma_f32_16x16x32_bf16 v[80:83], a[128:131], v[32:35], v[80:83]
    ds_read_b128 v[48:51], v13 offset:36864
    v_mfma_f32_16x16x32_bf16 v[84:87], a[132:135], v[32:35], v[84:87]
    ds_read_b128 v[52:55], v13 offset:38912
    v_mfma_f32_16x16x32_bf16 v[88:91], a[128:131], v[36:39], v[88:91]
    ds_read_b128 v[56:59], v15 offset:36864
    v_mfma_f32_16x16x32_bf16 v[92:95], a[132:135], v[36:39], v[92:95]
    ds_read_b128 v[60:63], v15 offset:38912
    s_waitcnt lgkmcnt(4)
    v_mfma_f32_16x16x32_bf16 v[80:83], a[136:139], v[40:43], v[80:83]
    ds_read_b128 v[32:35], v13 offset:40960
    v_mfma_f32_16x16x32_bf16 v[84:87], a[140:143], v[40:43], v[84:87]
    ds_read_b128 v[36:39], v13 offset:43008
    v_mfma_f32_16x16x32_bf16 v[88:91], a[136:139], v[44:47], v[88:91]
    v_mfma_f32_16x16x32_bf16 v[92:95], a[140:143], v[44:47], v[92:95]
    s_waitcnt lgkmcnt(4)
    v_mfma_f32_16x16x32_bf16 v[80:83], a[144:147], v[48:51], v[80:83]
    ds_read_b128 v[40:43], v15 offset:40960
    v_mfma_f32_16x16x32_bf16 v[84:87], a[148:151], v[48:51], v[84:87]
    ds_read_b128 v[44:47], v15 offset:43008
    v_mfma_f32_16x16x32_bf16 v[88:91], a[144:147], v[52:55], v[88:91]
    v_mfma_f32_16x16x32_bf16 v[92:95], a[148:151], v[52:55], v[92:95]
    s_waitcnt lgkmcnt(4)
    v_mfma_f32_16x16x32_bf16 v[80:83], a[152:155], v[56:59], v[80:83]
    ds_read_b128 v[48:51], v13 offset:45056
    v_mfma_f32_16x16x32_bf16 v[84:87], a[156:159], v[56:59], v[84:87]
    ds_read_b128 v[52:55], v13 offset:47104
    v_mfma_f32_16x16x32_bf16 v[88:91], a[152:155], v[60:63], v[88:91]
    v_mfma_f32_16x16x32_bf16 v[92:95], a[156:159], v[60:63], v[92:95]
    s_waitcnt lgkmcnt(4)
    v_mfma_f32_16x16x32_bf16 v[80:83], a[160:163], v[32:35], v[80:83]
    ds_read_b128 v[56:59], v15 offset:45056
    v_mfma_f32_16x16x32_bf16 v[84:87], a[164:167], v[32:35], v[84:87]
    ds_read_b128 v[60:63], v15 offset:47104
    v_mfma_f32_16x16x32_bf16 v[88:91], a[160:163], v[36:39], v[88:91]
    v_mfma_f32_16x16x32_bf16 v[92:95], a[164:167], v[36:39], v[92:95]
    s_waitcnt lgkmcnt(4)
    v_mfma_f32_16x16x32_bf16 v[80:83], a[168:171], v[40:43], v[80:83]
    ds_read_b128 v[32:35], v13 offset:49152
    v_mfma_f32_16x16x32_bf16 v[84:87], a[172:175], v[40:43], v[84:87]
    ds_read_b128 v[36:39], v13 offset:51200
    v_mfma_f32_16x16x32_bf16 v[88:91], a[168:171], v[44:47], v[88:91]
    v_mfma_f32_16x16x32_bf16 v[92:95], a[172:175], v[44:47], v[92:95]
    s_waitcnt lgkmcnt(4)
    v_mfma_f32_16x16x32_bf16 v[80:83], a[176:179], v[48:51], v[80:83]
    ds_read_b128 v[40:43], v15 offset:49152
    v_mfma_f32_16x16x32_bf16 v[84:87], a[180:183], v[48:51], v[84:87]
    ds_read_b128 v[44:47], v15 offset:51200
    v_mfma_f32_16x16x32_bf16 v[88:91], a[176:179], v[52:55], v[88:91]
    v_mfma_f32_16x16x32_bf16 v[92:95], a[180:183], v[52:55], v[92:95]
    s_waitcnt lgkmcnt(4)
    v_mfma_f32_16x16x32_bf16 v[80:83], a[184:187], v[56:59], v[80:83]
    ds_read_b128 v[48:51], v13 offset:53248
    v_mfma_f32_16x16x32_bf16 v[84:87], a[188:191], v[56:59], v[84:87]
    ds_read_b128 v[52:55], v13 offset:55296
    v_mfma_f32_16x16x32_bf16 v[88:91], a[184:187], v[60:63], v[88:91]
    v_mfma_f32_16x16x32_bf16 v[92:95], a[188:191], v[60:63], v[92:95]
    s_waitcnt lgkmcnt(4)
    v_mfma_f32_16x16x32_bf16 v[80:83], a[192:195], v[32:35], v[80:83]
    ds_read_b128 v[56:59], v15 offset:53248
    v_mfma_f32_16x16x32_bf16 v[84:87], a[196:199], v[32:35], v[84:87]
    ds_read_b128 v[60:63], v15 offset:55296
    v_mfma_f32_16x16x32_bf16 v[88:91], a[192:195], v[36:39], v[88:91]
    v_mfma_f32_16x16x32_bf16 v[92:95], a[196:199], v[36:39], v[92:95]
    s_waitcnt lgkmcnt(4)
    v_mfma_f32_16x16x32_bf16 v[80:83], a[200:203], v[40:43], v[80:83]
    ds_read_b128 v[32:35], v13 offset:57344
    v_mfma_f32_16x16x32_bf16 v[84:87], a[204:207], v[40:43], v[84:87]
    ds_read_b128 v[36:39], v13 offset:59392
    v_mfma_f32_16x16x32_bf16 v[88:91], a[200:203], v[44:47], v[88:91]
    v_mfma_f32_16x16x32_bf16 v[92:95], a[204:207], v[44:47], v[92:95]
    s_waitcnt lgkmcnt(4)
    v_mfma_f32_16x16x32_bf16 v[80:83], a[208:211], v[48:51], v[80:83]
    ds_read_b128 v[40:43], v15 offset:57344
    v_mfma_f32_16x16x32_bf16 v[84:87], a[212:215], v[48:51], v[84:87]
    ds_read_b128 v[44:47], v15 offset:59392
    v_mfma_f32_16x16x32_bf16 v[88:91], a[208:211], v[52:55], v[88:91]
    v_mfma_f32_16x16x32_bf16 v[92:95], a[212:215], v[52:55], v[92:95]
    s_waitcnt lgkmcnt(4)
    v_mfma_f32_16x16x32_bf16 v[80:83], a[216:219], v[56:59], v[80:83]
    ds_read_b128 v[48:51], v13 offset:61440
    v_mfma_f32_16x16x32_bf16 v[84:87], a[220:223], v[56:59], v[84:87]
    ds_read_b128 v[52:55], v13 offset:63488
    v_mfma_f32_16x16x32_bf16 v[88:91], a[216:219], v[60:63], v[88:91]
    v_mfma_f32_16x16x32_bf16 v[92:95], a[220:223], v[60:63], v[92:95]
    s_waitcnt lgkmcnt(4)
    v_mfma_f32_16x16x32_bf16 v[80:83], a[224:227], v[32:35], v[80:83]
    ds_read_b128 v[56:59], v15 offset:61440
    v_mfma_f32_16x16x32_bf16 v[84:87], a[228:231], v[32:35], v[84:87]
    ds_read_b128 v[60:63], v15 offset:63488
    v_mfma_f32_16x16x32_bf16 v[88:91], a[224:227], v[36:39], v[88:91]
    v_mfma_f32_16x16x32_bf16 v[92:95], a[228:231], v[36:39], v[92:95]
    s_waitcnt lgkmcnt(4)
    v_mfma_f32_16x16x32_bf16 v[80:83], a[232:235], v[40:43], v[80:83]
    v_mfma_f32_16x16x32_bf16 v[84:87], a[236:239], v[40:43], v[84:87]
    v_mfma_f32_16x16x32_bf16 v[88:91], a[232:235], v[44:47], v[88:91]
    v_mfma_f32_16x16x32_bf16 v[92:95], a[236:239], v[44:47], v[92:95]
    s_waitcnt lgkmcnt(0)
    v_mfma_f32_16x16x32_bf16 v[80:83], a[240:243], v[48:51], v[80:83]
    v_mfma_f32_16x16x32_bf16 v[84:87], a[244:247], v[48:51], v[84:87]
    v_mfma_f32_16x16x32_bf16 v[88:91], a[240:243], v[52:55], v[88:91]
    v_mfma_f32_16x16x32_bf16 v[92:95], a[244:247], v[52:55], v[92:95]
    v_mfma_f32_16x16x32_bf16 v[80:83], a[248:251], v[56:59], v[80:83]
    v_mfma_f32_16x16x32_bf16 v[84:87], a[252:255], v[56:59], v[84:87]
    v_mfma_f32_16x16x32_bf16 v[88:91], a[248:251], v[60:63], v[88:91]
    v_mfma_f32_16x16x32_bf16 v[92:95], a[252:255], v[60:63], v[92:95]
    s_mov_b32 s76, s57
    s_nop 6
    v_cvt_pk_bf16_f32 v216, v80, v81
    v_cvt_pk_bf16_f32 v217, v82, v83
    v_cvt_pk_bf16_f32 v218, v84, v85
    v_cvt_pk_bf16_f32 v219, v86, v87
    v_cvt_pk_bf16_f32 v220, v88, v89
    v_cvt_pk_bf16_f32 v221, v90, v91
    v_cvt_pk_bf16_f32 v222, v92, v93
    v_cvt_pk_bf16_f32 v223, v94, v95
    buffer_store_dwordx4 v[216:219], v10, s[12:15], s76 offen sc1
    buffer_store_dwordx4 v[220:223], v10, s[12:15], s76 offen offset:1024 sc1
L_e_fin_117:
    s_waitcnt lgkmcnt(0)
    s_add_u32 s60, s60, s51
    s_waitcnt vmcnt(0)
    s_barrier
    s_cmp_lg_u32 s44, 0
    s_cbranch_scc1 L_pub_119
    v_mov_b32 v30, s60
    v_mov_b32 v31, 0
    s_mov_b64 exec, 1
    buffer_store_dword v30, v31, s[12:15], s61 offen sc1
    s_mov_b64 exec, -1
L_pub_119:
    s_cmp_eq_u32 s60, 2
    s_cselect_b32 s51, 10, s51
    s_sub_u32 s45, s91, 12
    s_cmp_eq_u32 s60, 12
    s_cselect_b32 s51, s45, s51
    s_cselect_b32 s71, 127104, s71
    s_cbranch_scc1 L_w_qkv_112
    s_cmp_lt_u32 s60, s91
    s_cbranch_scc1 L_w_qkv_112_n
    s_cmp_eq_u32 s60, 64
    s_cbranch_scc1 L_w_qkv_112_e
    s_add_u32 s45, s61, 16
    s_mov_b32 s47, 64
    s_cmp_lg_u32 s44, 1
    s_cbranch_scc1 L_pw_120
    s_mov_b64 exec, 1
    s_mov_b32 s70, 0
L_wp_121:
    buffer_load_dword v31, v12, s[12:15], s45 offen sc1
    s_add_u32 s70, s70, 1
    s_cmp_ge_u32 s70, 0x200000
    s_cbranch_scc1 L_w_done_96
L_wp_121_c:
    s_waitcnt vmcnt(0)
    v_cmp_gt_u32 vcc, s47, v31
    s_nop 1
    s_cbranch_vccz L_wp_121_ok
    s_sleep 2
    s_branch L_wp_121
L_wp_121_ok:
    s_mov_b64 exec, -1
L_pw_120:
    s_barrier
    s_waitcnt vmcnt(0)
    s_barrier
    s_cmp_lg_u32 s44, 0
    s_cbranch_scc1 L_pub_122
    v_mov_b32 v30, 64
    v_mov_b32 v31, 0
    s_mov_b64 exec, 1
    buffer_store_dword v30, v31, s[12:15], s61 offen sc1
    s_mov_b64 exec, -1
L_pub_122:
L_w_qkv_112_e:
L_w_roles_98:
    s_cmp_lg_u32 s44, 0
    s_cbranch_scc1 L_gj_123
    s_getreg_b32 s45, hwreg(HW_REG_XCC_ID)
    s_and_b32 s45, s45, 15
    s_mul_i32 s46, s45, s45
    s_lshl_b32 s46, s46, 9
    s_add_u32 s45, s45, s46
    s_add_u32 s45, s45, 16777216
    v_mov_b32 v30, s45
    s_lshl_b32 s45, s40, 7
    v_mov_b32 v31, 127488
    s_mov_b64 exec, 1
    buffer_atomic_add v30, v31, s[12:15], s45 offen sc1
    s_mov_b64 exec, -1
L_gj_123:
    s_mov_b32 s36, 0x1011111
    s_mov_b32 s37, 0x55222081
    s_cmp_eq_u32 s42, 0
    s_cselect_b32 s36, s36, 0x10100000
    s_cselect_b32 s37, s37, 0xaa888410
    s_mov_b32 s72, 0x88888888
    s_mov_b32 s73, 0xffd55248
    s_lshr_b32 s38, s41, 3
    s_and_b32 s68, s41, 7
    s_cmp_eq_u32 s43, 1
    s_cbranch_scc1 L_role_b_124
    s_cmp_eq_u32 s43, 2
    s_cbranch_scc1 L_role_c_125
    s_load_dwordx2 s[6:7], s[0:1], 40
    s_waitcnt lgkmcnt(0)
    s_mov_b32 s24, s6
    s_and_b32 s25, s7, 0xffff
    s_mov_b32 s26, 0x800000
    s_mov_b32 s27, 0x00020000
    s_lshl_b32 s46, s38, 21
    s_lshl_b32 s45, s68, 8
    s_add_u32 s46, s46, s45
    s_waitcnt vmcnt(0)
    s_barrier
    v_lshrrev_b32 v20, 4, v1
    s_lshl_b32 s45, s44, 2
    v_add_u32 v21, s45, v20
    s_mov_b32 s45, 2048
    v_mul_lo_u32 v21, v21, s45
    v_lshlrev_b32 v22, 2, v20
    v_and_b32 v23, 15, v1
    v_xor_b32 v22, v22, v23
    v_lshlrev_b32 v22, 4, v22
    v_add_u32 v21, v21, v22
    v_bfe_u32 v22, v1, 2, 2
    v_lshlrev_b32 v23, 2, v20
    v_add_u32 v23, v23, v22
    v_lshlrev_b32 v23, 8, v23
    v_xor_b32 v22, s44, v22
    v_lshlrev_b32 v22, 6, v22
    v_add_u32 v23, v23, v22
    v_and_b32 v22, 3, v1
    v_lshlrev_b32 v22, 3, v22
    v_add_u32 v23, v23, v22
    v_add_u32 v24, 65536, v23
    v_add_u32 v25, 131072, v23
    s_lshl_b32 s47, s44, 10
    s_add_u32 s45, s46, 0x0
    s_add_u32 m0, s47, 0
    s_nop 0
    buffer_load_dwordx4 v21, s[24:27], s45 offen  lds
    s_add_u32 s45, s46, 0x8000
    s_add_u32 m0, s47, 4096
    s_nop 0
    buffer_load_dwordx4 v21, s[24:27], s45 offen  lds
    s_add_u32 s45, s46, 0x10000
    s_add_u32 m0, s47, 8192
    s_nop 0
    buffer_load_dwordx4 v21, s[24:27], s45 offen  lds
    s_add_u32 s45, s46, 0x18000
    s_add_u32 m0, s47, 12288
    s_nop 0
    buffer_load_dwordx4 v21, s[24:27], s45 offen  lds
    s_add_u32 s45, s46, 0x20000
    s_add_u32 m0, s47, 16384
    s_nop 0
    buffer_load_dwordx4 v21, s[24:27], s45 offen  lds
    s_add_u32 s45, s46, 0x28000
    s_add_u32 m0, s47, 20480
    s_nop 0
    buffer_load_dwordx4 v21, s[24:27], s45 offen  lds
    s_add_u32 s45, s46, 0x30000
    s_add_u32 m0, s47, 24576
    s_nop 0
    buffer_load_dwordx4 v21, s[24:27], s45 offen  lds
    s_add_u32 s45, s46, 0x38000
    s_add_u32 m0, s47, 28672
    s_nop 0
    buffer_load_dwordx4 v21, s[24:27], s45 offen  lds
    s_add_u32 s45, s46, 0x40000
    s_add_u32 m0, s47, 32768
    s_nop 0
    buffer_load_dwordx4 v21, s[24:27], s45 offen  lds
    s_add_u32 s45, s46, 0x48000
    s_add_u32 m0, s47, 36864
    s_nop 0
    buffer_load_dwordx4 v21, s[24:27], s45 offen  lds
    s_add_u32 s45, s46, 0x50000
    s_add_u32 m0, s47, 40960
    s_nop 0
    buffer_load_dwordx4 v21, s[24:27], s45 offen  lds
    s_add_u32 s45, s46, 0x58000
    s_add_u32 m0, s47, 45056
    s_nop 0
    buffer_load_dwordx4 v21, s[24:27], s45 offen  lds
    s_add_u32 s45, s46, 0x60000
    s_add_u32 m0, s47, 49152
    s_nop 0
    buffer_load_dwordx4 v21, s[24:27], s45 offen  lds
    s_add_u32 s45, s46, 0x68000
    s_add_u32 m0, s47, 53248
    s_nop 0
    buffer_load_dwordx4 v21, s[24:27], s45 offen  lds
    s_add_u32 s45, s46, 0x70000
    s_add_u32 m0, s47, 57344
    s_nop 0
    buffer_load_dwordx4 v21, s[24:27], s45 offen  lds
    s_add_u32 s45, s46, 0x78000
    s_add_u32 m0, s47, 61440
    s_nop 0
    buffer_load_dwordx4 v21, s[24:27], s45 offen  lds
    s_add_u32 s45, s46, 0x80000
    s_add_u32 m0, s47, 65536
    s_nop 0
    buffer_load_dwordx4 v21, s[24:27], s45 offen  lds
    s_add_u32 s45, s46, 0x88000
    s_add_u32 m0, s47, 69632
    s_nop 0
    buffer_load_dwordx4 v21, s[24:27], s45 offen  lds
    s_add_u32 s45, s46, 0x90000
    s_add_u32 m0, s47, 73728
    s_nop 0
    buffer_load_dwordx4 v21, s[24:27], s45 offen  lds
    s_add_u32 s45, s46, 0x98000
    s_add_u32 m0, s47, 77824
    s_nop 0
    buffer_load_dwordx4 v21, s[24:27], s45 offen  lds
    s_add_u32 s45, s46, 0xa0000
    s_add_u32 m0, s47, 81920
    s_nop 0
    buffer_load_dwordx4 v21, s[24:27], s45 offen  lds
    s_add_u32 s45, s46, 0xa8000
    s_add_u32 m0, s47, 86016
    s_nop 0
    buffer_load_dwordx4 v21, s[24:27], s45 offen  lds
    s_add_u32 s45, s46, 0xb0000
    s_add_u32 m0, s47, 90112
    s_nop 0
    buffer_load_dwordx4 v21, s[24:27], s45 offen  lds
    s_add_u32 s45, s46, 0xb8000
    s_add_u32 m0, s47, 94208
    s_nop 0
    buffer_load_dwordx4 v21, s[24:27], s45 offen  lds
    s_add_u32 s45, s46, 0xc0000
    s_add_u32 m0, s47, 98304
    s_nop 0
    buffer_load_dwordx4 v21, s[24:27], s45 offen  lds
    s_add_u32 s45, s46, 0xc8000
    s_add_u32 m0, s47, 102400
    s_nop 0
    buffer_load_dwordx4 v21, s[24:27], s45 offen  lds
    s_add_u32 s45, s46, 0xd0000
    s_add_u32 m0, s47, 106496
    s_nop 0
    buffer_load_dwordx4 v21, s[24:27], s45 offen  lds
    s_add_u32 s45, s46, 0xd8000
    s_add_u32 m0, s47, 110592
    s_nop 0
    buffer_load_dwordx4 v21, s[24:27], s45 offen  lds
    s_add_u32 s45, s46, 0xe0000
    s_add_u32 m0, s47, 114688
    s_nop 0
    buffer_load_dwordx4 v21, s[24:27], s45 offen  lds
    s_add_u32 s45, s46, 0xe8000
    s_add_u32 m0, s47, 118784
    s_nop 0
    buffer_load_dwordx4 v21, s[24:27], s45 offen  lds
    s_add_u32 s45, s46, 0xf0000
    s_add_u32 m0, s47, 122880
    s_nop 0
    buffer_load_dwordx4 v21, s[24:27], s45 offen  lds
    s_add_u32 s45, s46, 0xf8000
    s_add_u32 m0, s47, 126976
    s_nop 0
    buffer_load_dwordx4 v21, s[24:27], s45 offen  lds
    s_waitcnt vmcnt(28)
    s_barrier
    s_add_u32 s45, s46, 0x100000
    s_add_u32 m0, s47, 131072
    s_nop 0
    buffer_load_dwordx4 v21, s[24:27], s45 offen  lds
    s_add_u32 s45, s46, 0x108000
    s_add_u32 m0, s47, 135168
    s_nop 0
    buffer_load_dwordx4 v21, s[24:27], s45 offen  lds
    s_add_u32 s45, s46, 0x110000
    s_add_u32 m0, s47, 139264
    s_nop 0
    buffer_load_dwordx4 v21, s[24:27], s45 offen  lds
    s_add_u32 s45, s46, 0x118000
    s_add_u32 m0, s47, 143360
    s_nop 0
    buffer_load_dwordx4 v21, s[24:27], s45 offen  lds
    ds_read_b64_tr_b16 a[0:1], v23 offset:0
    ds_read_b64_tr_b16 a[2:3], v23 offset:4096
    ds_read_b64_tr_b16 a[4:5], v23 offset:32
    ds_read_b64_tr_b16 a[6:7], v23 offset:4128
    ds_read_b64_tr_b16 a[8:9], v23 offset:8192
    ds_read_b64_tr_b16 a[10:11], v23 offset:12288
    ds_read_b64_tr_b16 a[12:13], v23 offset:8224
    ds_read_b64_tr_b16 a[14:15], v23 offset:12320
    s_waitcnt lgkmcnt(0)
    s_waitcnt vmcnt(28)
    s_barrier
    s_add_u32 s45, s46, 0x120000
    s_add_u32 m0, s47, 0
    s_nop 0
    buffer_load_dwordx4 v21, s[24:27], s45 offen  lds
    s_add_u32 s45, s46, 0x128000
    s_add_u32 m0, s47, 4096
    s_nop 0
    buffer_load_dwordx4 v21, s[24:27], s45 offen  lds
    s_add_u32 s45, s46, 0x130000
    s_add_u32 m0, s47, 8192
    s_nop 0
    buffer_load_dwordx4 v21, s[24:27], s45 offen  lds
    s_add_u32 s45, s46, 0x138000
    s_add_u32 m0, s47, 12288
    s_nop 0
    buffer_load_dwordx4 v21, s[24:27], s45 offen  lds
    ds_read_b64_tr_b16 a[16:17], v23 offset:16384
    ds_read_b64_tr_b16 a[18:19], v23 offset:20480
    ds_read_b64_tr_b16 a[20:21], v23 offset:16416
    ds_read_b64_tr_b16 a[22:23], v23 offset:20512
    ds_read_b64_tr_b16 a[24:25], v23 offset:24576
    ds_read_b64_tr_b16 a[26:27], v23 offset:28672
    ds_read_b64_tr_b16 a[28:29], v23 offset:24608
    ds_read_b64_tr_b16 a[30:31], v23 offset:28704
    s_waitcnt lgkmcnt(0)
    s_waitcnt vmcnt(28)
    s_barrier
    s_add_u32 s45, s46, 0x140000
    s_add_u32 m0, s47, 16384
    s_nop 0
    buffer_load_dwordx4 v21, s[24:27], s45 offen  lds
    s_add_u32 s45, s46, 0x148000
    s_add_u32 m0, s47, 20480
    s_nop 0
    buffer_load_dwordx4 v21, s[24:27], s45 offen  lds
    s_add_u32 s45, s46, 0x150000
    s_add_u32 m0, s47, 24576
    s_nop 0
    buffer_load_dwordx4 v21, s[24:27], s45 offen  lds
    s_add_u32 s45, s46, 0x158000
    s_add_u32 m0, s47, 28672
    s_nop 0
    buffer_load_dwordx4 v21, s[24:27], s45 offen  lds
    ds_read_b64_tr_b16 a[32:33], v23 offset:32768
    ds_read_b64_tr_b16 a[34:35], v23 offset:36864
    ds_read_b64_tr_b16 a[36:37], v23 offset:32800
    ds_read_b64_tr_b16 a[38:39], v23 offset:36896
    ds_read_b64_tr_b16 a[40:41], v23 offset:40960
    ds_read_b64_tr_b16 a[42:43], v23 offset:45056
    ds_read_b64_tr_b16 a[44:45], v23 offset:40992
    ds_read_b64_tr_b16 a[46:47], v23 offset:45088
    s_waitcnt lgkmcnt(0)
    s_waitcnt vmcnt(28)
    s_barrier
    s_add_u32 s45, s46, 0x160000
    s_add_u32 m0, s47, 32768
    s_nop 0
    buffer_load_dwordx4 v21, s[24:27], s45 offen  lds
    s_add_u32 s45, s46, 0x168000
    s_add_u32 m0, s47, 36864
    s_nop 0
    buffer_load_dwordx4 v21, s[24:27], s45 offen  lds
    s_add_u32 s45, s46, 0x170000
    s_add_u32 m0, s47, 40960
    s_nop 0
    buffer_load_dwordx4 v21, s[24:27], s45 offen  lds
    s_add_u32 s45, s46, 0x178000
    s_add_u32 m0, s47, 45056
    s_nop 0
    buffer_load_dwordx4 v21, s[24:27], s45 offen  lds
    ds_read_b64_tr_b16 a[48:49], v23 offset:49152
    ds_read_b64_tr_b16 a[50:51], v23 offset:53248
    ds_read_b64_tr_b16 a[52:53], v23 offset:49184
    ds_read_b64_tr_b16 a[54:55], v23 offset:53280
    ds_read_b64_tr_b16 a[56:57], v23 offset:57344
    ds_read_b64_tr_b16 a[58:59], v23 offset:61440
    ds_read_b64_tr_b16 a[60:61], v23 offset:57376
    ds_read_b64_tr_b16 a[62:63], v23 offset:61472
    s_waitcnt lgkmcnt(0)
    s_waitcnt vmcnt(28)
    s_barrier
    s_add_u32 s45, s46, 0x180000
    s_add_u32 m0, s47, 49152
    s_nop 0
    buffer_load_dwordx4 v21, s[24:27], s45 offen  lds
    s_add_u32 s45, s46, 0x188000
    s_add_u32 m0, s47, 53248
    s_nop 0
    buffer_load_dwordx4 v21, s[24:27], s45 offen  lds
    s_add_u32 s45, s46, 0x190000
    s_add_u32 m0, s47, 57344
    s_nop 0
    buffer_load_dwordx4 v21, s[24:27], s45 offen  lds
    s_add_u32 s45, s46, 0x198000
    s_add_u32 m0, s47, 61440
    s_nop 0
    buffer_load_dwordx4 v21, s[24:27], s45 offen  lds
    ds_read_b64_tr_b16 a[64:65], v24 offset:0
    ds_read_b64_tr_b16 a[66:67], v24 offset:4096
    ds_read_b64_tr_b16 a[68:69], v24 offset:32
    ds_read_b64_tr_b16 a[70:71], v24 offset:4128
    ds_read_b64_tr_b16 a[72:73], v24 offset:8192
    ds_read_b64_tr_b16 a[74:75], v24 offset:12288
    ds_read_b64_tr_b16 a[76:77], v24 offset:8224
    ds_read_b64_tr_b16 a[78:79], v24 offset:12320
    s_waitcnt lgkmcnt(0)
    s_waitcnt vmcnt(28)
    s_barrier
    s_add_u32 s45, s46, 0x1a0000
    s_add_u32 m0, s47, 65536
    s_nop 0
    buffer_load_dwordx4 v21, s[24:27], s45 offen  lds
    s_add_u32 s45, s46, 0x1a8000
    s_add_u32 m0, s47, 69632
    s_nop 0
    buffer_load_dwordx4 v21, s[24:27], s45 offen  lds
    s_add_u32 s45, s46, 0x1b0000
    s_add_u32 m0, s47, 73728
    s_nop 0
    buffer_load_dwordx4 v21, s[24:27], s45 offen  lds
    s_add_u32 s45, s46, 0x1b8000
    s_add_u32 m0, s47, 77824
    s_nop 0
    buffer_load_dwordx4 v21, s[24:27], s45 offen  lds
    ds_read_b64_tr_b16 a[80:81], v24 offset:16384
    ds_read_b64_tr_b16 a[82:83], v24 offset:20480
    ds_read_b64_tr_b16 a[84:85], v24 offset:16416
    ds_read_b64_tr_b16 a[86:87], v24 offset:20512
    ds_read_b64_tr_b16 a[88:89], v24 offset:24576
    ds_read_b64_tr_b16 a[90:91], v24 offset:28672
    ds_read_b64_tr_b16 a[92:93], v24 offset:24608
    ds_read_b64_tr_b16 a[94:95], v24 offset:28704
    s_waitcnt lgkmcnt(0)
    s_waitcnt vmcnt(28)
    s_barrier
    s_add_u32 s45, s46, 0x1c0000
    s_add_u32 m0, s47, 81920
    s_nop 0
    buffer_load_dwordx4 v21, s[24:27], s45 offen  lds
    s_add_u32 s45, s46, 0x1c8000
    s_add_u32 m0, s47, 86016
    s_nop 0
    buffer_load_dwordx4 v21, s[24:27], s45 offen  lds
    s_add_u32 s45, s46, 0x1d0000
    s_add_u32 m0, s47, 90112
    s_nop 0
    buffer_load_dwordx4 v21, s[24:27], s45 offen  lds
    s_add_u32 s45, s46, 0x1d8000
    s_add_u32 m0, s47, 94208
    s_nop 0
    buffer_load_dwordx4 v21, s[24:27], s45 offen  lds
    ds_read_b64_tr_b16 a[96:97], v24 offset:32768
    ds_read_b64_tr_b16 a[98:99], v24 offset:36864
    ds_read_b64_tr_b16 a[100:101], v24 offset:32800
    ds_read_b64_tr_b16 a[102:103], v24 offset:36896
    ds_read_b64_tr_b16 a[104:105], v24 offset:40960
    ds_read_b64_tr_b16 a[106:107], v24 offset:45056
    ds_read_b64_tr_b16 a[108:109], v24 offset:40992
    ds_read_b64_tr_b16 a[110:111], v24 offset:45088
    s_waitcnt lgkmcnt(0)
    s_waitcnt vmcnt(28)
    s_barrier
    s_add_u32 s45, s46, 0x1e0000
    s_add_u32 m0, s47, 98304
    s_nop 0
    buffer_load_dwordx4 v21, s[24:27], s45 offen  lds
    s_add_u32 s45, s46, 0x1e8000
    s_add_u32 m0, s47, 102400
    s_nop 0
    buffer_load_dwordx4 v21, s[24:27], s45 offen  lds
    s_add_u32 s45, s46, 0x1f0000
    s_add_u32 m0, s47, 106496
    s_nop 0
    buffer_load_dwordx4 v21, s[24:27], s45 offen  lds
    s_add_u32 s45, s46, 0x1f8000
    s_add_u32 m0, s47, 110592
    s_nop 0
    buffer_load_dwordx4 v21, s[24:27], s45 offen  lds
    ds_read_b64_tr_b16 a[112:113], v24 offset:49152
    ds_read_b64_tr_b16 a[114:115], v24 offset:53248
    ds_read_b64_tr_b16 a[116:117], v24 offset:49184
    ds_read_b64_tr_b16 a[118:119], v24 offset:53280
    ds_read_b64_tr_b16 a[120:121], v24 offset:57344
    ds_read_b64_tr_b16 a[122:123], v24 offset:61440
    ds_read_b64_tr_b16 a[124:125], v24 offset:57376
    ds_read_b64_tr_b16 a[126:127], v24 offset:61472
    s_waitcnt lgkmcnt(0)
    s_waitcnt vmcnt(28)
    s_barrier
    ds_read_b64_tr_b16 a[128:129], v25 offset:0
    ds_read_b64_tr_b16 a[130:131], v25 offset:4096
    ds_read_b64_tr_b16 a[132:133], v25 offset:32
    ds_read_b64_tr_b16 a[134:135], v25 offset:4128
    ds_read_b64_tr_b16 a[136:137], v25 offset:8192
    ds_read_b64_tr_b16 a[138:139], v25 offset:12288
    ds_read_b64_tr_b16 a[140:141], v25 offset:8224
    ds_read_b64_tr_b16 a[142:143], v25 offset:12320
    s_waitcnt lgkmcnt(0)
    s_waitcnt vmcnt(24)
    s_barrier
    ds_read_b64_tr_b16 a[144:145], v23 offset:0
    ds_read_b64_tr_b16 a[146:147], v23 offset:4096
    ds_read_b64_tr_b16 a[148:149], v23 offset:32
    ds_read_b64_tr_b16 a[150:151], v23 offset:4128
    ds_read_b64_tr_b16 a[152:153], v23 offset:8192
    ds_read_b64_tr_b16 a[154:155], v23 offset:12288
    ds_read_b64_tr_b16 a[156:157], v23 offset:8224
    ds_read_b64_tr_b16 a[158:159], v23 offset:12320
    s_waitcnt lgkmcnt(0)
    s_waitcnt vmcnt(20)
    s_barrier
    ds_read_b64_tr_b16 a[160:161], v23 offset:16384
    ds_read_b64_tr_b16 a[162:163], v23 offset:20480
    ds_read_b64_tr_b16 a[164:165], v23 offset:16416
    ds_read_b64_tr_b16 a[166:167], v23 offset:20512
    ds_read_b64_tr_b16 a[168:169], v23 offset:24576
    ds_read_b64_tr_b16 a[170:171], v23 offset:28672
    ds_read_b64_tr_b16 a[172:173], v23 offset:24608
    ds_read_b64_tr_b16 a[174:175], v23 offset:28704
    s_waitcnt lgkmcnt(0)
    s_waitcnt vmcnt(16)
    s_barrier
    ds_read_b64_tr_b16 a[176:177], v23 offset:32768
    ds_read_b64_tr_b16 a[178:179], v23 offset:36864
    ds_read_b64_tr_b16 a[180:181], v23 offset:32800
    ds_read_b64_tr_b16 a[182:183], v23 offset:36896
    ds_read_b64_tr_b16 a[184:185], v23 offset:40960
    ds_read_b64_tr_b16 a[186:187], v23 offset:45056
    ds_read_b64_tr_b16 a[188:189], v23 offset:40992
    ds_read_b64_tr_b16 a[190:191], v23 offset:45088
    s_waitcnt lgkmcnt(0)
    s_waitcnt vmcnt(12)
    s_barrier
    ds_read_b64_tr_b16 a[192:193], v23 offset:49152
    ds_read_b64_tr_b16 a[194:195], v23 offset:53248
    ds_read_b64_tr_b16 a[196:197], v23 offset:49184
    ds_read_b64_tr_b16 a[198:199], v23 offset:53280
    ds_read_b64_tr_b16 a[200:201], v23 offset:57344
    ds_read_b64_tr_b16 a[202:203], v23 offset:61440
    ds_read_b64_tr_b16 a[204:205], v23 offset:57376
    ds_read_b64_tr_b16 a[206:207], v23 offset:61472
    s_waitcnt lgkmcnt(0)
    s_waitcnt vmcnt(8)
    s_barrier
    ds_read_b64_tr_b16 a[208:209], v24 offset:0
    ds_read_b64_tr_b16 a[210:211], v24 offset:4096
    ds_read_b64_tr_b16 a[212:213], v24 offset:32
    ds_read_b64_tr_b16 a[214:215], v24 offset:4128
    ds_read_b64_tr_b16 a[216:217], v24 offset:8192
    ds_read_b64_tr_b16 a[218:219], v24 offset:12288
    ds_read_b64_tr_b16 a[220:221], v24 offset:8224
    ds_read_b64_tr_b16 a[222:223], v24 offset:12320
    s_waitcnt lgkmcnt(0)
    s_waitcnt vmcnt(4)
    s_barrier
    ds_read_b64_tr_b16 a[224:225], v24 offset:16384
    ds_read_b64_tr_b16 a[226:227], v24 offset:20480
    ds_read_b64_tr_b16 a[228:229], v24 offset:16416
    ds_read_b64_tr_b16 a[230:231], v24 offset:20512
    ds_read_b64_tr_b16 a[232:233], v24 offset:24576
    ds_read_b64_tr_b16 a[234:235], v24 offset:28672
    ds_read_b64_tr_b16 a[236:237], v24 offset:24608
    ds_read_b64_tr_b16 a[238:239], v24 offset:28704
    s_waitcnt lgkmcnt(0)
    s_waitcnt vmcnt(0)
    s_barrier
    ds_read_b64_tr_b16 a[240:241], v24 offset:32768
    ds_read_b64_tr_b16 a[242:243], v24 offset:36864
    ds_read_b64_tr_b16 a[244:245], v24 offset:32800
    ds_read_b64_tr_b16 a[246:247], v24 offset:36896
    ds_read_b64_tr_b16 a[248:249], v24 offset:40960
    ds_read_b64_tr_b16 a[250:251], v24 offset:45056
    ds_read_b64_tr_b16 a[252:253], v24 offset:40992
    ds_read_b64_tr_b16 a[254:255], v24 offset:45088
    s_waitcnt lgkmcnt(0)
    s_barrier
    s_lshl_b32 s52, s38, 16
    s_add_u32 s52, s52, 0x5000000
    s_lshl_b32 s56, s38, 23
    s_lshl_b32 s45, s68, 9
    s_add_u32 s56, s56, s45
    s_add_u32 s56, s56, 0x8000000
    s_lshl_b32 s45, s40, 7
    s_add_u32 s45, s45, 127488
    v_mov_b32 v29, s45
    s_mov_b32 s46, 536870912
    s_mov_b64 exec, 1
    s_mov_b32 s70, 0
L_wp_128:
    buffer_load_dword v31, v29, s[12:15], 0 offen sc1
    s_add_u32 s70, s70, 1
    s_cmp_ge_u32 s70, 0x200000
    s_cbranch_scc1 L_w_done_96
L_wp_128_c:
    s_waitcnt vmcnt(0)
    v_cmp_gt_u32 vcc, s46, v31
    s_nop 1
    s_cbranch_vccz L_wp_128_ok
    s_sleep 2
    s_branch L_wp_128
L_wp_128_ok:
    s_mov_b64 exec, -1
    v_readfirstlane_b32 s45, v31
    s_nop 3
    s_and_b32 s46, s45, 511
    s_mul_i32 s46, s46, s46
    s_bfe_u32 s45, s45, 0xf0009
    s_lshl_b32 s45, s45, 5
    s_mov_b32 s80, s12
    s_mov_b32 s81, s13
    s_mov_b32 s83, 0x00020000
    s_mov_b32 s84, s12
    s_mov_b32 s85, s13
    s_mov_b32 s87, 0x00020000
    s_cmp_eq_u32 s45, s46
    s_cselect_b32 s82, s14, 0
    s_cselect_b32 s86, 0, s14
    s_sub_u32 s79, 3, s44
    s_mov_b32 s78, 0
    s_mov_b32 s92, 0
    s_cmp_eq_u64 s[36:37], 0
    s_cbranch_scc1 L_xl_129
    s_ff1_i32_b64 s47, s[36:37]
    s_lshr_b64 s[74:75], s[72:73], s47
    s_ff1_i32_b64 s48, s[74:75]
    s_cmp_gt_u32 s79, s48
    s_cbranch_scc1 L_xl_129
    s_add_u32 s47, s47, s79
    s_cmp_lt_u32 s47, s78
    s_cbranch_scc1 L_xl_129_go
    s_lshl_b32 s45, s41, 7
    s_add_u32 s45, s45, 0x10010
    s_add_u32 s46, s47, 1
    s_mov_b64 exec, 7
    s_mov_b32 s70, 0
L_wp_130:
    buffer_load_dword v31, v12, s[12:15], s45 offen sc1
    s_add_u32 s70, s70, 1
    s_cmp_ge_u32 s70, 0x200000
    s_cbranch_scc1 L_w_done_96
L_wp_130_c:
    s_waitcnt vmcnt(0)
    v_cmp_gt_u32 vcc, s46, v31
    s_nop 1
    s_cbranch_vccz L_wp_130_ok
    s_sleep 2
    s_branch L_wp_130
L_wp_130_ok:
    s_mov_b64 exec, -1
    v_readlane_b32 s78, v31, 0
    v_readlane_b32 s45, v31, 1
    v_readlane_b32 s46, v31, 2
    s_nop 3
    s_min_u32 s78, s78, s45
    s_min_u32 s78, s78, s46
L_xl_129_go:
    s_lshl_b32 s45, s41, 19
    s_lshl_b32 s46, s47, 13
    s_add_u32 s45, s45, s46
    s_add_u32 s45, s45, 0x2000000
    s_add_u32 s46, s45, 4096
    s_add_u32 s48, s45, 16777216
    s_add_u32 s49, s48, 4096
    s_add_u32 s76, s48, 16777216
    s_add_u32 s77, s76, 4096
    buffer_load_dwordx4 v[96:99], v10, s[12:15], s76 offen offset:0 sc1
    buffer_load_dwordx4 v[128:131], v10, s[12:15], s45 offen offset:0 sc1
    buffer_load_dwordx4 v[160:163], v10, s[12:15], s48 offen offset:0 sc1
    buffer_load_dwordx4 v[100:103], v10, s[12:15], s76 offen offset:1024 sc1
    buffer_load_dwordx4 v[144:147], v10, s[12:15], s45 offen offset:1024 sc1
    buffer_load_dwordx4 v[176:179], v10, s[12:15], s48 offen offset:1024 sc1
    buffer_load_dwordx4 v[104:107], v10, s[12:15], s76 offen offset:2048 sc1
    buffer_load_dwordx4 v[132:135], v10, s[12:15], s45 offen offset:2048 sc1
    buffer_load_dwordx4 v[164:167], v10, s[12:15], s48 offen offset:2048 sc1
    buffer_load_dwordx4 v[108:111], v10, s[12:15], s76 offen offset:3072 sc1
    buffer_load_dwordx4 v[148:151], v10, s[12:15], s45 offen offset:3072 sc1
    buffer_load_dwordx4 v[180:183], v10, s[12:15], s48 offen offset:3072 sc1
    buffer_load_dwordx4 v[112:115], v10, s[12:15], s77 offen offset:0 sc1
    buffer_load_dwordx4 v[136:139], v10, s[12:15], s46 offen offset:0 sc1
    buffer_load_dwordx4 v[168:171], v10, s[12:15], s49 offen offset:0 sc1
    buffer_load_dwordx4 v[116:119], v10, s[12:15], s77 offen offset:1024 sc1
    buffer_load_dwordx4 v[152:155], v10, s[12:15], s46 offen offset:1024 sc1
    buffer_load_dwordx4 v[184:187], v10, s[12:15], s49 offen offset:1024 sc1
    buffer_load_dwordx4 v[120:123], v10, s[12:15], s77 offen offset:2048 sc1
    buffer_load_dwordx4 v[140:143], v10, s[12:15], s46 offen offset:2048 sc1
    buffer_load_dwordx4 v[172:175], v10, s[12:15], s49 offen offset:2048 sc1
    buffer_load_dwordx4 v[124:127], v10, s[12:15], s77 offen offset:3072 sc1
    buffer_load_dwordx4 v[156:159], v10, s[12:15], s46 offen offset:3072 sc1
    buffer_load_dwordx4 v[188:191], v10, s[12:15], s49 offen offset:3072 sc1
L_xl_129:
    s_waitcnt vmcnt(0)
L_a_loop_126:
    s_cmp_eq_u64 s[36:37], 0
    s_cbranch_scc1 L_a_fin_131
    s_ff1_i32_b64 s50, s[36:37]
    s_bitset0_b64 s[36:37], s50
    s_lshr_b64 s[74:75], s[72:73], s50
    s_ff1_i32_b64 s51, s[74:75]
    s_add_u32 s51, s51, 1
    s_add_u32 s62, s50, s51
    s_add_u32 s63, s50, s79
    s_cmp_ge_u32 s79, s51
    s_cbranch_scc1 L_xs1_132
    s_lshl_b32 s47, s44, 13
    v_add_u32 v18, s47, v10
    v_and_b32 v14, 15, v1
    v_lshrrev_b32 v16, 4, v1
    ds_write_b128 v18, v[96:99] offset:0
    ds_write_b128 v18, v[100:103] offset:1024
    ds_write_b128 v18, v[104:107] offset:2048
    ds_write_b128 v18, v[108:111] offset:3072
    ds_write_b128 v18, v[112:115] offset:4096
    ds_write_b128 v18, v[116:119] offset:5120
    ds_write_b128 v18, v[120:123] offset:6144
    ds_write_b128 v18, v[124:127] offset:7168
    v_mfma_f32_16x16x32_bf16 v[32:35], v[160:163], v[128:131], 0
    v_mfma_f32_16x16x32_bf16 v[36:39], v[160:163], v[144:147], 0
    v_mfma_f32_16x16x32_bf16 v[44:47], v[176:179], v[144:147], 0
    v_mfma_f32_16x16x32_bf16 v[32:35], v[164:167], v[132:135], v[32:35]
    v_mfma_f32_16x16x32_bf16 v[36:39], v[164:167], v[148:151], v[36:39]
    v_mfma_f32_16x16x32_bf16 v[44:47], v[180:183], v[148:151], v[44:47]
    v_mfma_f32_16x16x32_bf16 v[32:35], v[168:171], v[136:139], v[32:35]
    v_mfma_f32_16x16x32_bf16 v[36:39], v[168:171], v[152:155], v[36:39]
    v_mfma_f32_16x16x32_bf16 v[44:47], v[184:187], v[152:155], v[44:47]
    v_mfma_f32_16x16x32_bf16 v[32:35], v[172:175], v[140:143], v[32:35]
    v_mfma_f32_16x16x32_bf16 v[36:39], v[172:175], v[156:159], v[36:39]
    v_mfma_f32_16x16x32_bf16 v[44:47], v[188:191], v[156:159], v[44:47]
    v_lshlrev_b32 v19, 2, v16
    v_lshrrev_b32 v20, 2, v1
    v_lshlrev_b32 v20, 4, v20
    v_and_b32 v21, 1, v1
    v_lshlrev_b32 v21, 3, v21
    v_add3_u32 v20, v20, v21, s47
    v_and_b32 v21, 2, v1
    v_lshlrev_b32 v21, 7, v21
    v_add_u32 v20, v20, v21
    v_mov_b32 v22, 0xff800000
    s_waitcnt lgkmcnt(0)
    ds_read_b64_tr_b16 v[208:209], v20 offset:0
    ds_read_b64_tr_b16 v[210:211], v20 offset:1024
    ds_read_b64_tr_b16 v[212:213], v20 offset:512
    ds_read_b64_tr_b16 v[214:215], v20 offset:1536
    ds_read_b64_tr_b16 v[216:217], v20 offset:2048
    ds_read_b64_tr_b16 v[218:219], v20 offset:3072
    ds_read_b64_tr_b16 v[220:221], v20 offset:2560
    ds_read_b64_tr_b16 v[222:223], v20 offset:3584
    ds_read_b64_tr_b16 v[224:225], v20 offset:4096
    ds_read_b64_tr_b16 v[226:227], v20 offset:5120
    ds_read_b64_tr_b16 v[228:229], v20 offset:4608
    ds_read_b64_tr_b16 v[230:231], v20 offset:5632
    ds_read_b64_tr_b16 v[232:233], v20 offset:6144
    ds_read_b64_tr_b16 v[234:235], v20 offset:7168
    ds_read_b64_tr_b16 v[236:237], v20 offset:6656
    ds_read_b64_tr_b16 v[238:239], v20 offset:7680
    v_add_u32 v21, 0, v19
    v_cmp_gt_u32 vcc, v21, v14
    s_nop 1
    v_cndmask_b32 v32, v32, v22, vcc
    v_cndmask_b32 v44, v44, v22, vcc
    v_add_u32 v21, 1, v19
    v_cmp_gt_u32 vcc, v21, v14
    s_nop 1
    v_cndmask_b32 v33, v33, v22, vcc
    v_cndmask_b32 v45, v45, v22, vcc
    v_add_u32 v21, 2, v19
    v_cmp_gt_u32 vcc, v21, v14
    s_nop 1
    v_cndmask_b32 v34, v34, v22, vcc
    v_cndmask_b32 v46, v46, v22, vcc
    v_add_u32 v21, 3, v19
    v_cmp_gt_u32 vcc, v21, v14
    s_nop 1
    v_cndmask_b32 v35, v35, v22, vcc
    v_cndmask_b32 v47, v47, v22, vcc
L_xs1_132:
    s_lshl_b32 s45, s41, 7
    s_add_u32 s45, s45, 0x11000
    s_cmp_lg_u32 s44, 1
    s_cbranch_scc1 L_pi_134
    s_mov_b64 exec, 255
    buffer_load_dword v31, v12, s[12:15], s45 offen sc1
    s_mov_b64 exec, -1
L_pi_134:
    s_waitcnt vmcnt(0)
    s_barrier
    s_cmp_lg_u32 s44, 0
    s_cbranch_scc1 L_pub_135
    v_mov_b32 v30, s92
    v_mov_b32 v31, 0
    s_mov_b64 exec, 1
    buffer_store_dword v30, v31, s[12:15], s67 offen sc1
    s_mov_b64 exec, -1
L_pub_135:
    s_cmp_lg_u32 s44, 1
    s_cbranch_scc1 L_pw_136
    s_mov_b64 exec, 255
    s_mov_b32 s70, 0
    s_branch L_wp_137_c
L_wp_137:
    buffer_load_dword v31, v12, s[12:15], s45 offen sc1
    s_add_u32 s70, s70, 1
    s_cmp_ge_u32 s70, 0x200000
    s_cbranch_scc1 L_w_done_96
L_wp_137_c:
    s_waitcnt vmcnt(0)
    v_cmp_gt_u32 vcc, s62, v31
    s_nop 1
    s_cbranch_vccz L_wp_137_ok
    s_sleep 1
    s_branch L_wp_137
L_wp_137_ok:
    s_mov_b64 exec, -1
L_pw_136:
    s_barrier
    s_cmp_ge_u32 s79, s51
    s_cbranch_scc1 L_xs2_133
    s_lshl_b32 s45, s63, 17
    s_lshl_b32 s46, s41, 12
    s_add_u32 s45, s45, s46
    s_lshr_b32 s46, s45, 1
    s_add_u32 s45, s45, 0x1000000
    s_add_u32 s46, s46, 0x1800000
    v_lshlrev_b32 v21, 3, v1
    buffer_load_dwordx4 v[192:195], v10, s[12:15], s45 offen offset:0 sc1
    buffer_load_dwordx4 v[196:199], v10, s[12:15], s45 offen offset:1024 sc1
    buffer_load_dwordx4 v[200:203], v10, s[12:15], s45 offen offset:2048 sc1
    buffer_load_dwordx4 v[204:207], v10, s[12:15], s45 offen offset:3072 sc1
    buffer_load_dwordx2 v[240:241], v21, s[12:15], s46 offen offset:0 sc1
    buffer_load_dwordx2 v[242:243], v21, s[12:15], s46 offen offset:512 sc1
    buffer_load_dwordx2 v[244:245], v21, s[12:15], s46 offen offset:1024 sc1
    buffer_load_dwordx2 v[246:247], v21, s[12:15], s46 offen offset:1536 sc1
    s_waitcnt vmcnt(4)
    v_mfma_f32_16x16x32_bf16 v[48:51], v[192:195], v[128:131], 0
    v_mfma_f32_16x16x32_bf16 v[52:55], v[192:195], v[144:147], 0
    v_mfma_f32_16x16x32_bf16 v[48:51], v[196:199], v[132:135], v[48:51]
    v_mfma_f32_16x16x32_bf16 v[52:55], v[196:199], v[148:151], v[52:55]
    v_mfma_f32_16x16x32_bf16 v[48:51], v[200:203], v[136:139], v[48:51]
    v_mfma_f32_16x16x32_bf16 v[52:55], v[200:203], v[152:155], v[52:55]
    v_mfma_f32_16x16x32_bf16 v[48:51], v[204:207], v[140:143], v[48:51]
    v_mfma_f32_16x16x32_bf16 v[52:55], v[204:207], v[156:159], v[52:55]
    s_mov_b32 s45, 0x3e0293ee
    s_nop 6
    v_permlane32_swap_b32 v48, v50
    v_permlane32_swap_b32 v49, v51
    v_pk_add_f32 v[48:49], v[48:49], v[50:51]
    v_permlane32_swap_b32 v52, v54
    v_permlane32_swap_b32 v53, v55
    v_pk_add_f32 v[52:53], v[52:53], v[54:55]
    v_max_f32 v22, v32, v33
    v_max3_f32 v22, v22, v34, v35
    v_max3_f32 v22, v22, v48, v49
    v_max_f32 v23, v36, v37
    v_max3_f32 v23, v23, v38, v39
    v_max3_f32 v23, v23, v44, v45
    v_max3_f32 v23, v23, v46, v47
    v_max3_f32 v23, v23, v52, v53
    v_mov_b32 v24, v22
    v_mov_b32 v25, v23
    s_nop 0
    v_permlane32_swap_b32 v22, v24
    v_permlane32_swap_b32 v23, v25
    v_max_f32 v22, v22, v24
    v_max_f32 v23, v23, v25
    v_mov_b32 v24, v22
    v_mov_b32 v25, v23
    s_nop 0
    v_permlane16_swap_b32 v22, v24
    v_permlane16_swap_b32 v23, v25
    v_max_f32 v22, v22, v24
    v_max_f32 v23, v23, v25
    v_mul_f32 v22, s45, v22
    v_mul_f32 v23, s45, v23
    v_fma_f32 v32, v32, s45, -v22
    v_fma_f32 v33, v33, s45, -v22
    v_fma_f32 v34, v34, s45, -v22
    v_fma_f32 v35, v35, s45, -v22
    v_fma_f32 v48, v48, s45, -v22
    v_fma_f32 v49, v49, s45, -v22
    v_exp_f32 v32, v32
    v_exp_f32 v33, v33
    v_exp_f32 v34, v34
    v_exp_f32 v35, v35
    v_exp_f32 v48, v48
    v_exp_f32 v49, v49
    v_fma_f32 v36, v36, s45, -v23
    v_fma_f32 v37, v37, s45, -v23
    v_fma_f32 v38, v38, s45, -v23
    v_fma_f32 v39, v39, s45, -v23
    v_fma_f32 v44, v44, s45, -v23
    v_fma_f32 v45, v45, s45, -v23
    v_fma_f32 v46, v46, s45, -v23
    v_fma_f32 v47, v47, s45, -v23
    v_fma_f32 v52, v52, s45, -v23
    v_fma_f32 v53, v53, s45, -v23
    v_exp_f32 v36, v36
    v_exp_f32 v37, v37
    v_exp_f32 v38, v38
    v_exp_f32 v39, v39
    v_exp_f32 v44, v44
    v_exp_f32 v45, v45
    v_exp_f32 v46, v46
    v_exp_f32 v47, v47
    v_exp_f32 v52, v52
    v_exp_f32 v53, v53
    v_add_f32 v22, v32, v33
    v_add_f32 v22, v22, v34
    v_add_f32 v22, v22, v35
    v_add_f32 v22, v22, v48
    v_add_f32 v22, v22, v49
    v_add_f32 v23, v36, v37
    v_add_f32 v23, v23, v38
    v_add_f32 v23, v23, v39
    v_add_f32 v23, v23, v44
    v_add_f32 v23, v23, v45
    v_add_f32 v23, v23, v46
    v_add_f32 v23, v23, v47
    v_add_f32 v23, v23, v52
    v_add_f32 v23, v23, v53
    v_mov_b32 v24, v22
    v_mov_b32 v25, v23
    s_nop 0
    v_permlane32_swap_b32 v22, v24
    v_permlane32_swap_b32 v23, v25
    v_add_f32 v22, v22, v24
    v_add_f32 v23, v23, v25
    v_mov_b32 v24, v22
    v_mov_b32 v25, v23
    s_nop 0
    v_permlane16_swap_b32 v22, v24
    v_permlane16_swap_b32 v23, v25
    v_add_f32 v22, v22, v24
    v_add_f32 v23, v23, v25
    v_rcp_f32 v22, v22
    v_rcp_f32 v23, v23
    s_nop 0
    v_mul_f32 v32, v32, v22
    v_mul_f32 v33, v33, v22
    v_mul_f32 v34, v34, v22
    v_mul_f32 v35, v35, v22
    v_mul_f32 v48, v48, v22
    v_mul_f32 v49, v49, v22
    v_mul_f32 v36, v36, v23
    v_mul_f32 v37, v37, v23
    v_mul_f32 v38, v38, v23
    v_mul_f32 v39, v39, v23
    v_mul_f32 v44, v44, v23
    v_mul_f32 v45, v45, v23
    v_mul_f32 v46, v46, v23
    v_mul_f32 v47, v47, v23
    v_mul_f32 v52, v52, v23
    v_mul_f32 v53, v53, v23
    v_cvt_pk_bf16_f32 v128, v32, v33
    v_cvt_pk_bf16_f32 v129, v34, v35
    v_mov_b32 v130, 0
    v_mov_b32 v131, 0
    v_cvt_pk_bf16_f32 v132, v48, v49
    v_mov_b32 v133, 0
    v_mov_b32 v134, 0
    v_cvt_pk_bf16_f32 v135, v48, v49
    v_cvt_pk_bf16_f32 v136, v36, v37
    v_cvt_pk_bf16_f32 v137, v38, v39
    v_cvt_pk_bf16_f32 v138, v44, v45
    v_cvt_pk_bf16_f32 v139, v46, v47
    v_cvt_pk_bf16_f32 v140, v52, v53
    v_mov_b32 v141, 0
    v_mov_b32 v142, 0
    v_cvt_pk_bf16_f32 v143, v52, v53
    s_waitcnt vmcnt(0) lgkmcnt(0)
    s_nop 0
    v_mfma_f32_16x16x32_bf16 v[64:67], v[208:211], v[128:131], 0
    v_mfma_f32_16x16x32_bf16 v[68:71], v[212:215], v[128:131], 0
    v_mfma_f32_16x16x32_bf16 v[72:75], v[216:219], v[128:131], 0
    v_mfma_f32_16x16x32_bf16 v[76:79], v[220:223], v[128:131], 0
    v_mfma_f32_16x16x32_bf16 v[80:83], v[224:227], v[128:131], 0
    v_mfma_f32_16x16x32_bf16 v[84:87], v[228:231], v[128:131], 0
    v_mfma_f32_16x16x32_bf16 v[88:91], v[232:235], v[128:131], 0
    v_mfma_f32_16x16x32_bf16 v[92:95], v[236:239], v[128:131], 0
    v_mfma_f32_16x16x16_bf16 v[64:67], v[240:241], v[132:133], v[64:67]
    v_mfma_f32_16x16x16_bf16 v[68:71], v[240:241], v[134:135], v[68:71]
    v_mfma_f32_16x16x16_bf16 v[72:75], v[242:243], v[132:133], v[72:75]
    v_mfma_f32_16x16x16_bf16 v[76:79], v[242:243], v[134:135], v[76:79]
    v_mfma_f32_16x16x16_bf16 v[80:83], v[244:245], v[132:133], v[80:83]
    v_mfma_f32_16x16x16_bf16 v[84:87], v[244:245], v[134:135], v[84:87]
    v_mfma_f32_16x16x16_bf16 v[88:91], v[246:247], v[132:133], v[88:91]
    v_mfma_f32_16x16x16_bf16 v[92:95], v[246:247], v[134:135], v[92:95]
    v_mfma_f32_16x16x32_bf16 v[96:99], v[208:211], v[136:139], 0
    v_mfma_f32_16x16x32_bf16 v[100:103], v[212:215], v[136:139], 0
    v_mfma_f32_16x16x32_bf16 v[104:107], v[216:219], v[136:139], 0
    v_mfma_f32_16x16x32_bf16 v[108:111], v[220:223], v[136:139], 0
    v_mfma_f32_16x16x32_bf16 v[112:115], v[224:227], v[136:139], 0
    v_mfma_f32_16x16x32_bf16 v[116:119], v[228:231], v[136:139], 0
    v_mfma_f32_16x16x32_bf16 v[120:123], v[232:235], v[136:139], 0
    v_mfma_f32_16x16x32_bf16 v[124:127], v[236:239], v[136:139], 0
    v_mfma_f32_16x16x16_bf16 v[96:99], v[240:241], v[140:141], v[96:99]
    v_mfma_f32_16x16x16_bf16 v[100:103], v[240:241], v[142:143], v[100:103]
    v_mfma_f32_16x16x16_bf16 v[104:107], v[242:243], v[140:141], v[104:107]
    v_mfma_f32_16x16x16_bf16 v[108:111], v[242:243], v[142:143], v[108:111]
    v_mfma_f32_16x16x16_bf16 v[112:115], v[244:245], v[140:141], v[112:115]
    v_mfma_f32_16x16x16_bf16 v[116:119], v[244:245], v[142:143], v[116:119]
    v_mfma_f32_16x16x16_bf16 v[120:123], v[246:247], v[140:141], v[120:123]
    v_mfma_f32_16x16x16_bf16 v[124:127], v[246:247], v[142:143], v[124:127]
    s_lshl_b32 s45, s63, 18
    s_lshl_b32 s46, s41, 13
    s_add_u32 s45, s45, s46
    s_add_u32 s45, s45, 0x5000000
    s_add_u32 s46, s45, 4096
    v_cvt_pk_bf16_f32 v64, v64, v65
    v_cvt_pk_bf16_f32 v65, v66, v67
    v_cvt_pk_bf16_f32 v66, v68, v69
    v_cvt_pk_bf16_f32 v67, v70, v71
    buffer_store_dwordx4 v[64:67], v10, s[12:15], s45 offen offset:0 sc1
    v_cvt_pk_bf16_f32 v72, v72, v73
    v_cvt_pk_bf16_f32 v73, v74, v75
    v_cvt_pk_bf16_f32 v74, v76, v77
    v_cvt_pk_bf16_f32 v75, v78, v79
    buffer_store_dwordx4 v[72:75], v10, s[12:15], s45 offen offset:2048 sc1
    v_cvt_pk_bf16_f32 v80, v80, v81
    v_cvt_pk_bf16_f32 v81, v82, v83
    v_cvt_pk_bf16_f32 v82, v84, v85
    v_cvt_pk_bf16_f32 v83, v86, v87
    buffer_store_dwordx4 v[80:83], v10, s[12:15], s46 offen offset:0 sc1
    v_cvt_pk_bf16_f32 v88, v88, v89
    v_cvt_pk_bf16_f32 v89, v90, v91
    v_cvt_pk_bf16_f32 v90, v92, v93
    v_cvt_pk_bf16_f32 v91, v94, v95
    buffer_store_dwordx4 v[88:91], v10, s[12:15], s46 offen offset:2048 sc1
    v_cvt_pk_bf16_f32 v96, v96, v97
    v_cvt_pk_bf16_f32 v97, v98, v99
    v_cvt_pk_bf16_f32 v98, v100, v101
    v_cvt_pk_bf16_f32 v99, v102, v103
    buffer_store_dwordx4 v[96:99], v10, s[12:15], s45 offen offset:1024 sc1
    v_cvt_pk_bf16_f32 v104, v104, v105
    v_cvt_pk_bf16_f32 v105, v106, v107
    v_cvt_pk_bf16_f32 v106, v108, v109
    v_cvt_pk_bf16_f32 v107, v110, v111
    buffer_store_dwordx4 v[104:107], v10, s[12:15], s45 offen offset:3072 sc1
    v_cvt_pk_bf16_f32 v112, v112, v113
    v_cvt_pk_bf16_f32 v113, v114, v115
    v_cvt_pk_bf16_f32 v114, v116, v117
    v_cvt_pk_bf16_f32 v115, v118, v119
    buffer_store_dwordx4 v[112:115], v10, s[12:15], s46 offen offset:1024 sc1
    v_cvt_pk_bf16_f32 v120, v120, v121
    v_cvt_pk_bf16_f32 v121, v122, v123
    v_cvt_pk_bf16_f32 v122, v124, v125
    v_cvt_pk_bf16_f32 v123, v126, v127
    buffer_store_dwordx4 v[120:123], v10, s[12:15], s46 offen offset:3072 sc1
L_xs2_133:
    s_waitcnt vmcnt(0)
    s_barrier
    s_cmp_lg_u32 s44, 0
    s_cbranch_scc1 L_pub_138
    v_mov_b32 v30, s62
    v_mov_b32 v31, 0
    s_mov_b64 exec, 1
    buffer_store_dword v30, v31, s[80:83], s65 offen
    buffer_store_dword v30, v31, s[84:87], s65 offen sc1
    s_mov_b64 exec, -1
L_pub_138:
    s_cmp_eq_u64 s[36:37], 0
    s_cbranch_scc1 L_xl_139
    s_ff1_i32_b64 s47, s[36:37]
    s_lshr_b64 s[74:75], s[72:73], s47
    s_ff1_i32_b64 s48, s[74:75]
    s_cmp_gt_u32 s79, s48
    s_cbranch_scc1 L_xl_139
    s_add_u32 s47, s47, s79
    s_cmp_lt_u32 s47, s78
    s_cbranch_scc1 L_xl_139_go
    s_lshl_b32 s45, s41, 7
    s_add_u32 s45, s45, 0x10010
    s_add_u32 s46, s47, 1
    s_mov_b64 exec, 7
    s_mov_b32 s70, 0
L_wp_140:
    buffer_load_dword v31, v12, s[12:15], s45 offen sc1
    s_add_u32 s70, s70, 1
    s_cmp_ge_u32 s70, 0x200000
    s_cbranch_scc1 L_w_done_96
L_wp_140_c:
    s_waitcnt vmcnt(0)
    v_cmp_gt_u32 vcc, s46, v31
    s_nop 1
    s_cbranch_vccz L_wp_140_ok
    s_sleep 2
    s_branch L_wp_140
L_wp_140_ok:
    s_mov_b64 exec, -1
    v_readlane_b32 s78, v31, 0
    v_readlane_b32 s45, v31, 1
    v_readlane_b32 s46, v31, 2
    s_nop 3
    s_min_u32 s78, s78, s45
    s_min_u32 s78, s78, s46
L_xl_139_go:
    s_lshl_b32 s45, s41, 19
    s_lshl_b32 s46, s47, 13
    s_add_u32 s45, s45, s46
    s_add_u32 s45, s45, 0x2000000
    s_add_u32 s46, s45, 4096
    s_add_u32 s48, s45, 16777216
    s_add_u32 s49, s48, 4096
    s_add_u32 s76, s48, 16777216
    s_add_u32 s77, s76, 4096
    buffer_load_dwordx4 v[96:99], v10, s[12:15], s76 offen offset:0 sc1
    buffer_load_dwordx4 v[128:131], v10, s[12:15], s45 offen offset:0 sc1
    buffer_load_dwordx4 v[160:163], v10, s[12:15], s48 offen offset:0 sc1
    buffer_load_dwordx4 v[100:103], v10, s[12:15], s76 offen offset:1024 sc1
    buffer_load_dwordx4 v[144:147], v10, s[12:15], s45 offen offset:1024 sc1
    buffer_load_dwordx4 v[176:179], v10, s[12:15], s48 offen offset:1024 sc1
    buffer_load_dwordx4 v[104:107], v10, s[12:15], s76 offen offset:2048 sc1
    buffer_load_dwordx4 v[132:135], v10, s[12:15], s45 offen offset:2048 sc1
    buffer_load_dwordx4 v[164:167], v10, s[12:15], s48 offen offset:2048 sc1
    buffer_load_dwordx4 v[108:111], v10, s[12:15], s76 offen offset:3072 sc1
    buffer_load_dwordx4 v[148:151], v10, s[12:15], s45 offen offset:3072 sc1
    buffer_load_dwordx4 v[180:183], v10, s[12:15], s48 offen offset:3072 sc1
    buffer_load_dwordx4 v[112:115], v10, s[12:15], s77 offen offset:0 sc1
    buffer_load_dwordx4 v[136:139], v10, s[12:15], s46 offen offset:0 sc1
    buffer_load_dwordx4 v[168:171], v10, s[12:15], s49 offen offset:0 sc1
    buffer_load_dwordx4 v[116:119], v10, s[12:15], s77 offen offset:1024 sc1
    buffer_load_dwordx4 v[152:155], v10, s[12:15], s46 offen offset:1024 sc1
    buffer_load_dwordx4 v[184:187], v10, s[12:15], s49 offen offset:1024 sc1
    buffer_load_dwordx4 v[120:123], v10, s[12:15], s77 offen offset:2048 sc1
    buffer_load_dwordx4 v[140:143], v10, s[12:15], s46 offen offset:2048 sc1
    buffer_load_dwordx4 v[172:175], v10, s[12:15], s49 offen offset:2048 sc1
    buffer_load_dwordx4 v[124:127], v10, s[12:15], s77 offen offset:3072 sc1
    buffer_load_dwordx4 v[156:159], v10, s[12:15], s46 offen offset:3072 sc1
    buffer_load_dwordx4 v[188:191], v10, s[12:15], s49 offen offset:3072 sc1
L_xl_139:
    s_lshl_b32 s45, s38, 10
    s_add_u32 s45, s45, s64
    s_cmp_lg_u32 s44, 0
    s_cbranch_scc1 L_pw_141
    s_mov_b64 exec, 255
    s_mov_b32 s70, 0
L_wp_142:
    buffer_load_dword v31, v5, s[12:15], s45 offen sc1
    s_add_u32 s70, s70, 1
    s_cmp_ge_u32 s70, 0x200000
    s_cbranch_scc1 L_w_done_96
L_wp_142_c:
    s_waitcnt vmcnt(0)
    v_cmp_gt_u32 vcc, s62, v31
    s_nop 1
    s_cbranch_vccz L_wp_142_ok
    s_sleep 1
    s_branch L_wp_142
L_wp_142_ok:
    s_mov_b64 exec, -1
L_pw_141:
    s_barrier
    s_mul_i32 s53, s50, 262144
    s_add_u32 s53, s53, s52
    s_lshl_b32 s54, s44, 13
    s_add_u32 s53, s53, s54
    s_mul_i32 s57, s50, 131072
    s_add_u32 s57, s57, s56
    s_lshl_b32 s45, s44, 7
    s_add_u32 s57, s57, s45
    s_add_u32 s55, s54, 65536
    s_mov_b32 s58, 0
    v_mov_b32 v13, v10
    v_add_u32 v14, 65536, v13
    v_xor_b32 v15, 64, v13
    v_xor_b32 v16, 64, v14
    s_mov_b32 s76, 0x20000000
    s_add_u32 s48, s53, 0
    s_add_u32 s49, s48, 4096
    s_add_u32 m0, s54, 0
    s_nop 0
    buffer_load_dwordx4 v10, s[12:15], s48 offen offset:0 sc1 lds
    buffer_load_dwordx4 v10, s[12:15], s48 offen offset:1024 sc1 lds
    buffer_load_dwordx4 v10, s[12:15], s48 offen offset:2048 sc1 lds
    buffer_load_dwordx4 v10, s[12:15], s48 offen offset:3072 sc1 lds
    s_add_u32 m0, s54, 4096
    s_nop 0
    buffer_load_dwordx4 v10, s[12:15], s49 offen offset:0 sc1 lds
    buffer_load_dwordx4 v10, s[12:15], s49 offen offset:1024 sc1 lds
    buffer_load_dwordx4 v10, s[12:15], s49 offen offset:2048 sc1 lds
    buffer_load_dwordx4 v10, s[12:15], s49 offen offset:3072 sc1 lds
    s_add_u32 s48, s53, 32768
    s_add_u32 s49, s48, 4096
    s_add_u32 s46, s54, 32768
    s_add_u32 m0, s46, 0
    s_nop 0
    buffer_load_dwordx4 v10, s[12:15], s48 offen offset:0 sc1 lds
    buffer_load_dwordx4 v10, s[12:15], s48 offen offset:1024 sc1 lds
    buffer_load_dwordx4 v10, s[12:15], s48 offen offset:2048 sc1 lds
    buffer_load_dwordx4 v10, s[12:15], s48 offen offset:3072 sc1 lds
    s_add_u32 m0, s46, 4096
    s_nop 0
    buffer_load_dwordx4 v10, s[12:15], s49 offen offset:0 sc1 lds
    buffer_load_dwordx4 v10, s[12:15], s49 offen offset:1024 sc1 lds
    buffer_load_dwordx4 v10, s[12:15], s49 offen offset:2048 sc1 lds
    buffer_load_dwordx4 v10, s[12:15], s49 offen offset:3072 sc1 lds
    s_cmp_eq_u32 s51, 1
    s_cbranch_scc1 L_e_one_144
    s_add_u32 s48, s53, 262144
    s_add_u32 s49, s48, 4096
    s_add_u32 m0, s55, 0
    s_nop 0
    buffer_load_dwordx4 v10, s[12:15], s48 offen offset:0 sc1 lds
    buffer_load_dwordx4 v10, s[12:15], s48 offen offset:1024 sc1 lds
    buffer_load_dwordx4 v10, s[12:15], s48 offen offset:2048 sc1 lds
    buffer_load_dwordx4 v10, s[12:15], s48 offen offset:3072 sc1 lds
    s_add_u32 m0, s55, 4096
    s_nop 0
    buffer_load_dwordx4 v10, s[12:15], s49 offen offset:0 sc1 lds
    buffer_load_dwordx4 v10, s[12:15], s49 offen offset:1024 sc1 lds
    buffer_load_dwordx4 v10, s[12:15], s49 offen offset:2048 sc1 lds
    buffer_load_dwordx4 v10, s[12:15], s49 offen offset:3072 sc1 lds
    s_waitcnt vmcnt(16)
    s_barrier
    ds_read_b128 v[32:35], v13 offset:0
    ds_read_b128 v[36:39], v13 offset:1024
    ds_read_b128 v[40:43], v13 offset:2048
    ds_read_b128 v[44:47], v13 offset:3072
    s_add_u32 s48, s53, 294912
    s_add_u32 s46, s58, 1
    s_cmp_lt_u32 s46, s51
    s_cselect_b32 s48, s48, 0x20000000
    s_add_u32 s49, s48, 4096
    s_add_u32 s59, s55, 32768
L_e_loop_143:
    s_waitcnt lgkmcnt(2)
    v_mfma_f32_16x16x32_bf16 v[80:83], a[0:3], v[32:35], 0
    ds_read_b128 v[48:51], v13 offset:4096
    v_mfma_f32_16x16x32_bf16 v[84:87], a[4:7], v[32:35], 0
    ds_read_b128 v[52:55], v13 offset:5120
    v_mfma_f32_16x16x32_bf16 v[88:91], a[0:3], v[36:39], 0
    ds_read_b128 v[56:59], v13 offset:6144
    s_add_u32 m0, s59, 0
    v_mfma_f32_16x16x32_bf16 v[92:95], a[4:7], v[36:39], 0
    ds_read_b128 v[60:63], v13 offset:7168
    buffer_load_dwordx4 v10, s[12:15], s48 offen offset:0 sc1 lds
    s_waitcnt lgkmcnt(4)
    v_mfma_f32_16x16x32_bf16 v[80:83], a[8:11], v[40:43], v[80:83]
    ds_read_b128 v[32:35], v13 offset:8192
    v_mfma_f32_16x16x32_bf16 v[84:87], a[12:15], v[40:43], v[84:87]
    ds_read_b128 v[36:39], v13 offset:9216
    v_mfma_f32_16x16x32_bf16 v[88:91], a[8:11], v[44:47], v[88:91]
    v_mfma_f32_16x16x32_bf16 v[92:95], a[12:15], v[44:47], v[92:95]
    buffer_load_dwordx4 v10, s[12:15], s48 offen offset:1024 sc1 lds
    s_waitcnt lgkmcnt(4)
    v_mfma_f32_16x16x32_bf16 v[80:83], a[16:19], v[48:51], v[80:83]
    ds_read_b128 v[40:43], v13 offset:10240
    v_mfma_f32_16x16x32_bf16 v[84:87], a[20:23], v[48:51], v[84:87]
    ds_read_b128 v[44:47], v13 offset:11264
    v_mfma_f32_16x16x32_bf16 v[88:91], a[16:19], v[52:55], v[88:91]
    v_mfma_f32_16x16x32_bf16 v[92:95], a[20:23], v[52:55], v[92:95]
    buffer_load_dwordx4 v10, s[12:15], s48 offen offset:2048 sc1 lds
    s_waitcnt lgkmcnt(4)
    v_mfma_f32_16x16x32_bf16 v[80:83], a[24:27], v[56:59], v[80:83]
    ds_read_b128 v[48:51], v13 offset:12288
    v_mfma_f32_16x16x32_bf16 v[84:87], a[28:31], v[56:59], v[84:87]
    ds_read_b128 v[52:55], v13 offset:13312
    v_mfma_f32_16x16x32_bf16 v[88:91], a[24:27], v[60:63], v[88:91]
    v_mfma_f32_16x16x32_bf16 v[92:95], a[28:31], v[60:63], v[92:95]
    buffer_load_dwordx4 v10, s[12:15], s48 offen offset:3072 sc1 lds
    s_waitcnt lgkmcnt(4)
    v_mfma_f32_16x16x32_bf16 v[80:83], a[32:35], v[32:35], v[80:83]
    ds_read_b128 v[56:59], v13 offset:14336
    v_mfma_f32_16x16x32_bf16 v[84:87], a[36:39], v[32:35], v[84:87]
    ds_read_b128 v[60:63], v13 offset:15360
    v_mfma_f32_16x16x32_bf16 v[88:91], a[32:35], v[36:39], v[88:91]
    s_add_u32 m0, s59, 4096
    v_mfma_f32_16x16x32_bf16 v[92:95], a[36:39], v[36:39], v[92:95]
    buffer_load_dwordx4 v10, s[12:15], s49 offen offset:0 sc1 lds
    s_waitcnt lgkmcnt(4)
    v_mfma_f32_16x16x32_bf16 v[80:83], a[40:43], v[40:43], v[80:83]
    ds_read_b128 v[32:35], v13 offset:16384
    v_mfma_f32_16x16x32_bf16 v[84:87], a[44:47], v[40:43], v[84:87]
    ds_read_b128 v[36:39], v13 offset:17408
    v_mfma_f32_16x16x32_bf16 v[88:91], a[40:43], v[44:47], v[88:91]
    v_mfma_f32_16x16x32_bf16 v[92:95], a[44:47], v[44:47], v[92:95]
    buffer_load_dwordx4 v10, s[12:15], s49 offen offset:1024 sc1 lds
    s_waitcnt lgkmcnt(4)
    v_mfma_f32_16x16x32_bf16 v[80:83], a[48:51], v[48:51], v[80:83]
    ds_read_b128 v[40:43], v13 offset:18432
    v_mfma_f32_16x16x32_bf16 v[84:87], a[52:55], v[48:51], v[84:87]
    ds_read_b128 v[44:47], v13 offset:19456
    v_mfma_f32_16x16x32_bf16 v[88:91], a[48:51], v[52:55], v[88:91]
    v_mfma_f32_16x16x32_bf16 v[92:95], a[52:55], v[52:55], v[92:95]
    buffer_load_dwordx4 v10, s[12:15], s49 offen offset:2048 sc1 lds
    s_waitcnt lgkmcnt(4)
    v_mfma_f32_16x16x32_bf16 v[80:83], a[56:59], v[56:59], v[80:83]
    ds_read_b128 v[48:51], v13 offset:20480
    v_mfma_f32_16x16x32_bf16 v[84:87], a[60:63], v[56:59], v[84:87]
    ds_read_b128 v[52:55], v13 offset:21504
    v_mfma_f32_16x16x32_bf16 v[88:91], a[56:59], v[60:63], v[88:91]
    v_mfma_f32_16x16x32_bf16 v[92:95], a[60:63], v[60:63], v[92:95]
    buffer_load_dwordx4 v10, s[12:15], s49 offen offset:3072 sc1 lds
    s_waitcnt lgkmcnt(4)
    v_mfma_f32_16x16x32_bf16 v[80:83], a[64:67], v[32:35], v[80:83]
    ds_read_b128 v[56:59], v13 offset:22528
    v_mfma_f32_16x16x32_bf16 v[84:87], a[68:71], v[32:35], v[84:87]
    ds_read_b128 v[60:63], v13 offset:23552
    v_mfma_f32_16x16x32_bf16 v[88:91], a[64:67], v[36:39], v[88:91]
    s_add_u32 s48, s53, 524288
    v_mfma_f32_16x16x32_bf16 v[92:95], a[68:71], v[36:39], v[92:95]
    s_add_u32 s46, s58, 2
    s_waitcnt lgkmcnt(4)
    v_mfma_f32_16x16x32_bf16 v[80:83], a[72:75], v[40:43], v[80:83]
    ds_read_b128 v[32:35], v13 offset:24576
    v_mfma_f32_16x16x32_bf16 v[84:87], a[76:79], v[40:43], v[84:87]
    ds_read_b128 v[36:39], v13 offset:25600
    v_mfma_f32_16x16x32_bf16 v[88:91], a[72:75], v[44:47], v[88:91]
    s_cmp_lt_u32 s46, s51
    s_cselect_b32 s48, s48, 0x20000000
    v_mfma_f32_16x16x32_bf16 v[92:95], a[76:79], v[44:47], v[92:95]
    s_add_u32 s49, s48, 4096
    s_waitcnt lgkmcnt(4)
    v_mfma_f32_16x16x32_bf16 v[80:83], a[80:83], v[48:51], v[80:83]
    ds_read_b128 v[40:43], v13 offset:26624
    v_mfma_f32_16x16x32_bf16 v[84:87], a[84:87], v[48:51], v[84:87]
    ds_read_b128 v[44:47], v13 offset:27648
    v_mfma_f32_16x16x32_bf16 v[88:91], a[80:83], v[52:55], v[88:91]
    s_mov_b32 s59, s54
    v_mfma_f32_16x16x32_bf16 v[92:95], a[84:87], v[52:55], v[92:95]
    s_waitcnt lgkmcnt(4)
    v_mfma_f32_16x16x32_bf16 v[80:83], a[88:91], v[56:59], v[80:83]
    ds_read_b128 v[48:51], v13 offset:28672
    v_mfma_f32_16x16x32_bf16 v[84:87], a[92:95], v[56:59], v[84:87]
    ds_read_b128 v[52:55], v13 offset:29696
    v_mfma_f32_16x16x32_bf16 v[88:91], a[88:91], v[60:63], v[88:91]
    v_mfma_f32_16x16x32_bf16 v[92:95], a[92:95], v[60:63], v[92:95]
    s_waitcnt lgkmcnt(4)
    v_mfma_f32_16x16x32_bf16 v[80:83], a[96:99], v[32:35], v[80:83]
    ds_read_b128 v[56:59], v13 offset:30720
    v_mfma_f32_16x16x32_bf16 v[84:87], a[100:103], v[32:35], v[84:87]
    ds_read_b128 v[60:63], v13 offset:31744
    v_mfma_f32_16x16x32_bf16 v[88:91], a[96:99], v[36:39], v[88:91]
    v_mfma_f32_16x16x32_bf16 v[92:95], a[100:103], v[36:39], v[92:95]
    s_waitcnt lgkmcnt(4)
    v_mfma_f32_16x16x32_bf16 v[80:83], a[104:107], v[40:43], v[80:83]
    ds_read_b128 v[216:219], v8 offset:0
    v_mfma_f32_16x16x32_bf16 v[84:87], a[108:111], v[40:43], v[84:87]
    ds_read_b128 v[220:223], v8 offset:1152
    v_mfma_f32_16x16x32_bf16 v[88:91], a[104:107], v[44:47], v[88:91]
    ds_read_b128 v[224:227], v8 offset:2304
    v_mfma_f32_16x16x32_bf16 v[92:95], a[108:111], v[44:47], v[92:95]
    ds_read_b128 v[228:231], v8 offset:3456
    s_waitcnt vmcnt(16) lgkmcnt(0)
    s_barrier
    v_mfma_f32_16x16x32_bf16 v[80:83], a[112:115], v[48:51], v[80:83]
    ds_read_b128 v[32:35], v13 offset:32768
    buffer_store_dwordx4 v[216:219], v11, s[12:15], s76 offen sc1
    v_mfma_f32_16x16x32_bf16 v[84:87], a[116:119], v[48:51], v[84:87]
    ds_read_b128 v[36:39], v13 offset:33792
    s_add_u32 s76, s76, 32768
    v_mfma_f32_16x16x32_bf16 v[88:91], a[112:115], v[52:55], v[88:91]
    buffer_store_dwordx4 v[220:223], v11, s[12:15], s76 offen sc1
    s_add_u32 s76, s76, 32768
    v_mfma_f32_16x16x32_bf16 v[92:95], a[116:119], v[52:55], v[92:95]
    buffer_store_dwordx4 v[224:227], v11, s[12:15], s76 offen sc1
    v_mfma_f32_16x16x32_bf16 v[80:83], a[120:123], v[56:59], v[80:83]
    ds_read_b128 v[40:43], v13 offset:34816
    s_add_u32 s76, s76, 32768
    v_mfma_f32_16x16x32_bf16 v[84:87], a[124:127], v[56:59], v[84:87]
    ds_read_b128 v[44:47], v13 offset:35840
    buffer_store_dwordx4 v[228:231], v11, s[12:15], s76 offen sc1
    v_mfma_f32_16x16x32_bf16 v[88:91], a[120:123], v[60:63], v[88:91]
    v_mfma_f32_16x16x32_bf16 v[92:95], a[124:127], v[60:63], v[92:95]
    s_waitcnt lgkmcnt(2)
    v_mfma_f32_16x16x32_bf16 v[80:83], a[128:131], v[32:35], v[80:83]
    ds_read_b128 v[48:51], v13 offset:36864
    v_mfma_f32_16x16x32_bf16 v[84:87], a[132:135], v[32:35], v[84:87]
    ds_read_b128 v[52:55], v13 offset:37888
    v_mfma_f32_16x16x32_bf16 v[88:91], a[128:131], v[36:39], v[88:91]
    ds_read_b128 v[56:59], v13 offset:38912
    s_add_u32 m0, s59, 0
    v_mfma_f32_16x16x32_bf16 v[92:95], a[132:135], v[36:39], v[92:95]
    ds_read_b128 v[60:63], v13 offset:39936
    buffer_load_dwordx4 v10, s[12:15], s48 offen offset:0 sc1 lds
    s_waitcnt lgkmcnt(4)
    v_mfma_f32_16x16x32_bf16 v[80:83], a[136:139], v[40:43], v[80:83]
    ds_read_b128 v[32:35], v13 offset:40960
    v_mfma_f32_16x16x32_bf16 v[84:87], a[140:143], v[40:43], v[84:87]
    ds_read_b128 v[36:39], v13 offset:41984
    v_mfma_f32_16x16x32_bf16 v[88:91], a[136:139], v[44:47], v[88:91]
    v_mfma_f32_16x16x32_bf16 v[92:95], a[140:143], v[44:47], v[92:95]
    buffer_load_dwordx4 v10, s[12:15], s48 offen offset:1024 sc1 lds
    s_waitcnt lgkmcnt(4)
    v_mfma_f32_16x16x32_bf16 v[80:83], a[144:147], v[48:51], v[80:83]
    ds_read_b128 v[40:43], v13 offset:43008
    v_mfma_f32_16x16x32_bf16 v[84:87], a[148:151], v[48:51], v[84:87]
    ds_read_b128 v[44:47], v13 offset:44032
    v_mfma_f32_16x16x32_bf16 v[88:91], a[144:147], v[52:55], v[88:91]
    v_mfma_f32_16x16x32_bf16 v[92:95], a[148:151], v[52:55], v[92:95]
    buffer_load_dwordx4 v10, s[12:15], s48 offen offset:2048 sc1 lds
    s_waitcnt lgkmcnt(4)
    v_mfma_f32_16x16x32_bf16 v[80:83], a[152:155], v[56:59], v[80:83]
    ds_read_b128 v[48:51], v13 offset:45056
    v_mfma_f32_16x16x32_bf16 v[84:87], a[156:159], v[56:59], v[84:87]
    ds_read_b128 v[52:55], v13 offset:46080
    v_mfma_f32_16x16x32_bf16 v[88:91], a[152:155], v[60:63], v[88:91]
    v_mfma_f32_16x16x32_bf16 v[92:95], a[156:159], v[60:63], v[92:95]
    buffer_load_dwordx4 v10, s[12:15], s48 offen offset:3072 sc1 lds
    s_waitcnt lgkmcnt(4)
    v_mfma_f32_16x16x32_bf16 v[80:83], a[160:163], v[32:35], v[80:83]
    ds_read_b128 v[56:59], v13 offset:47104
    v_mfma_f32_16x16x32_bf16 v[84:87], a[164:167], v[32:35], v[84:87]
    ds_read_b128 v[60:63], v13 offset:48128
    v_mfma_f32_16x16x32_bf16 v[88:91], a[160:163], v[36:39], v[88:91]
    s_add_u32 m0, s59, 4096
    v_mfma_f32_16x16x32_bf16 v[92:95], a[164:167], v[36:39], v[92:95]
    buffer_load_dwordx4 v10, s[12:15], s49 offen offset:0 sc1 lds
    s_waitcnt lgkmcnt(4)
    v_mfma_f32_16x16x32_bf16 v[80:83], a[168:171], v[40:43], v[80:83]
    ds_read_b128 v[32:35], v13 offset:49152
    v_mfma_f32_16x16x32_bf16 v[84:87], a[172:175], v[40:43], v[84:87]
    ds_read_b128 v[36:39], v13 offset:50176
    v_mfma_f32_16x16x32_bf16 v[88:91], a[168:171], v[44:47], v[88:91]
    v_mfma_f32_16x16x32_bf16 v[92:95], a[172:175], v[44:47], v[92:95]
    buffer_load_dwordx4 v10, s[12:15], s49 offen offset:1024 sc1 lds
    s_waitcnt lgkmcnt(4)
    v_mfma_f32_16x16x32_bf16 v[80:83], a[176:179], v[48:51], v[80:83]
    ds_read_b128 v[40:43], v13 offset:51200
    v_mfma_f32_16x16x32_bf16 v[84:87], a[180:183], v[48:51], v[84:87]
    ds_read_b128 v[44:47], v13 offset:52224
    v_mfma_f32_16x16x32_bf16 v[88:91], a[176:179], v[52:55], v[88:91]
    v_mfma_f32_16x16x32_bf16 v[92:95], a[180:183], v[52:55], v[92:95]
    buffer_load_dwordx4 v10, s[12:15], s49 offen offset:2048 sc1 lds
    s_waitcnt lgkmcnt(4)
    v_mfma_f32_16x16x32_bf16 v[80:83], a[184:187], v[56:59], v[80:83]
    ds_read_b128 v[48:51], v13 offset:53248
    v_mfma_f32_16x16x32_bf16 v[84:87], a[188:191], v[56:59], v[84:87]
    ds_read_b128 v[52:55], v13 offset:54272
    v_mfma_f32_16x16x32_bf16 v[88:91], a[184:187], v[60:63], v[88:91]
    v_mfma_f32_16x16x32_bf16 v[92:95], a[188:191], v[60:63], v[92:95]
    buffer_load_dwordx4 v10, s[12:15], s49 offen offset:3072 sc1 lds
    s_waitcnt lgkmcnt(4)
    v_mfma_f32_16x16x32_bf16 v[80:83], a[192:195], v[32:35], v[80:83]
    ds_read_b128 v[56:59], v13 offset:55296
    v_mfma_f32_16x16x32_bf16 v[84:87], a[196:199], v[32:35], v[84:87]
    ds_read_b128 v[60:63], v13 offset:56320
    v_mfma_f32_16x16x32_bf16 v[88:91], a[192:195], v[36:39], v[88:91]
    s_add_u32 s48, s53, 557056
    v_mfma_f32_16x16x32_bf16 v[92:95], a[196:199], v[36:39], v[92:95]
    s_add_u32 s46, s58, 2
    s_waitcnt lgkmcnt(4)
    v_mfma_f32_16x16x32_bf16 v[80:83], a[200:203], v[40:43], v[80:83]
    ds_read_b128 v[32:35], v13 offset:57344
    v_mfma_f32_16x16x32_bf16 v[84:87], a[204:207], v[40:43], v[84:87]
    ds_read_b128 v[36:39], v13 offset:58368
    v_mfma_f32_16x16x32_bf16 v[88:91], a[200:203], v[44:47], v[88:91]
    s_cmp_lt_u32 s46, s51
    s_cselect_b32 s48, s48, 0x20000000
    v_mfma_f32_16x16x32_bf16 v[92:95], a[204:207], v[44:47], v[92:95]
    s_add_u32 s49, s48, 4096
    s_waitcnt lgkmcnt(4)
    v_mfma_f32_16x16x32_bf16 v[80:83], a[208:211], v[48:51], v[80:83]
    ds_read_b128 v[40:43], v13 offset:59392
    v_mfma_f32_16x16x32_bf16 v[84:87], a[212:215], v[48:51], v[84:87]
    ds_read_b128 v[44:47], v13 offset:60416
    v_mfma_f32_16x16x32_bf16 v[88:91], a[208:211], v[52:55], v[88:91]
    s_add_u32 s59, s54, 32768
    v_mfma_f32_16x16x32_bf16 v[92:95], a[212:215], v[52:55], v[92:95]
    s_waitcnt lgkmcnt(4)
    v_mfma_f32_16x16x32_bf16 v[80:83], a[216:219], v[56:59], v[80:83]
    ds_read_b128 v[48:51], v13 offset:61440
    v_mfma_f32_16x16x32_bf16 v[84:87], a[220:223], v[56:59], v[84:87]
    ds_read_b128 v[52:55], v13 offset:62464
    v_mfma_f32_16x16x32_bf16 v[88:91], a[216:219], v[60:63], v[88:91]
    v_mfma_f32_16x16x32_bf16 v[92:95], a[220:223], v[60:63], v[92:95]
    s_waitcnt lgkmcnt(4)
    v_mfma_f32_16x16x32_bf16 v[80:83], a[224:227], v[32:35], v[80:83]
    ds_read_b128 v[56:59], v13 offset:63488
    v_mfma_f32_16x16x32_bf16 v[84:87], a[228:231], v[32:35], v[84:87]
    ds_read_b128 v[60:63], v13 offset:64512
    v_mfma_f32_16x16x32_bf16 v[88:91], a[224:227], v[36:39], v[88:91]
    v_mfma_f32_16x16x32_bf16 v[92:95], a[228:231], v[36:39], v[92:95]
    s_waitcnt lgkmcnt(4)
    v_mfma_f32_16x16x32_bf16 v[80:83], a[232:235], v[40:43], v[80:83]
    v_mfma_f32_16x16x32_bf16 v[84:87], a[236:239], v[40:43], v[84:87]
    v_mfma_f32_16x16x32_bf16 v[88:91], a[232:235], v[44:47], v[88:91]
    v_mfma_f32_16x16x32_bf16 v[92:95], a[236:239], v[44:47], v[92:95]
    s_waitcnt vmcnt(16) lgkmcnt(0)
    s_barrier
    v_mfma_f32_16x16x32_bf16 v[80:83], a[240:243], v[48:51], v[80:83]
    ds_read_b128 v[32:35], v14 offset:0
    v_mfma_f32_16x16x32_bf16 v[84:87], a[244:247], v[48:51], v[84:87]
    ds_read_b128 v[36:39], v14 offset:1024
    v_mfma_f32_16x16x32_bf16 v[88:91], a[240:243], v[52:55], v[88:91]
    v_mfma_f32_16x16x32_bf16 v[92:95], a[244:247], v[52:55], v[92:95]
    v_mfma_f32_16x16x32_bf16 v[80:83], a[248:251], v[56:59], v[80:83]
    ds_read_b128 v[40:43], v14 offset:2048
    v_mfma_f32_16x16x32_bf16 v[84:87], a[252:255], v[56:59], v[84:87]
    ds_read_b128 v[44:47], v14 offset:3072
    v_mfma_f32_16x16x32_bf16 v[88:91], a[248:251], v[60:63], v[88:91]
    v_mfma_f32_16x16x32_bf16 v[92:95], a[252:255], v[60:63], v[92:95]
    s_add_u32 s53, s53, 262144
    s_add_u32 s58, s58, 1
    v_swap_b32 v13, v14
    s_xor_b32 s54, s54, 65536
    s_xor_b32 s55, s55, 65536
    s_mov_b32 s76, s57
    v_swap_b32 v15, v16
    s_add_u32 s57, s57, 131072
    ds_write_b128 v7, v[80:83] offset:0
    ds_write_b128 v7, v[84:87] offset:64
    ds_write_b128 v7, v[88:91] offset:2304
    ds_write_b128 v7, v[92:95] offset:2368
    s_cmp_lt_u32 s58, s51
    s_cbranch_scc1 L_e_loop_143
    s_branch L_e_fin_145
L_e_one_144:
    s_waitcnt vmcnt(8)
    s_barrier
    ds_read_b128 v[32:35], v13 offset:0
    ds_read_b128 v[36:39], v13 offset:1024
    ds_read_b128 v[40:43], v13 offset:2048
    ds_read_b128 v[44:47], v13 offset:3072
    s_waitcnt lgkmcnt(2)
    v_mfma_f32_16x16x32_bf16 v[80:83], a[0:3], v[32:35], 0
    ds_read_b128 v[48:51], v13 offset:4096
    v_mfma_f32_16x16x32_bf16 v[84:87], a[4:7], v[32:35], 0
    ds_read_b128 v[52:55], v13 offset:5120
    v_mfma_f32_16x16x32_bf16 v[88:91], a[0:3], v[36:39], 0
    ds_read_b128 v[56:59], v13 offset:6144
    v_mfma_f32_16x16x32_bf16 v[92:95], a[4:7], v[36:39], 0
    ds_read_b128 v[60:63], v13 offset:7168
    s_waitcnt lgkmcnt(4)
    v_mfma_f32_16x16x32_bf16 v[80:83], a[8:11], v[40:43], v[80:83]
    ds_read_b128 v[32:35], v13 offset:8192
    v_mfma_f32_16x16x32_bf16 v[84:87], a[12:15], v[40:43], v[84:87]
    ds_read_b128 v[36:39], v13 offset:9216
    v_mfma_f32_16x16x32_bf16 v[88:91], a[8:11], v[44:47], v[88:91]
    v_mfma_f32_16x16x32_bf16 v[92:95], a[12:15], v[44:47], v[92:95]
    s_waitcnt lgkmcnt(4)
    v_mfma_f32_16x16x32_bf16 v[80:83], a[16:19], v[48:51], v[80:83]
    ds_read_b128 v[40:43], v13 offset:10240
    v_mfma_f32_16x16x32_bf16 v[84:87], a[20:23], v[48:51], v[84:87]
    ds_read_b128 v[44:47], v13 offset:11264
    v_mfma_f32_16x16x32_bf16 v[88:91], a[16:19], v[52:55], v[88:91]
    v_mfma_f32_16x16x32_bf16 v[92:95], a[20:23], v[52:55], v[92:95]
    s_waitcnt lgkmcnt(4)
    v_mfma_f32_16x16x32_bf16 v[80:83], a[24:27], v[56:59], v[80:83]
    ds_read_b128 v[48:51], v13 offset:12288
    v_mfma_f32_16x16x32_bf16 v[84:87], a[28:31], v[56:59], v[84:87]
    ds_read_b128 v[52:55], v13 offset:13312
    v_mfma_f32_16x16x32_bf16 v[88:91], a[24:27], v[60:63], v[88:91]
    v_mfma_f32_16x16x32_bf16 v[92:95], a[28:31], v[60:63], v[92:95]
    s_waitcnt lgkmcnt(4)
    v_mfma_f32_16x16x32_bf16 v[80:83], a[32:35], v[32:35], v[80:83]
    ds_read_b128 v[56:59], v13 offset:14336
    v_mfma_f32_16x16x32_bf16 v[84:87], a[36:39], v[32:35], v[84:87]
    ds_read_b128 v[60:63], v13 offset:15360
    v_mfma_f32_16x16x32_bf16 v[88:91], a[32:35], v[36:39], v[88:91]
    v_mfma_f32_16x16x32_bf16 v[92:95], a[36:39], v[36:39], v[92:95]
    s_waitcnt lgkmcnt(4)
    v_mfma_f32_16x16x32_bf16 v[80:83], a[40:43], v[40:43], v[80:83]
    ds_read_b128 v[32:35], v13 offset:16384
    v_mfma_f32_16x16x32_bf16 v[84:87], a[44:47], v[40:43], v[84:87]
    ds_read_b128 v[36:39], v13 offset:17408
    v_mfma_f32_16x16x32_bf16 v[88:91], a[40:43], v[44:47], v[88:91]
    v_mfma_f32_16x16x32_bf16 v[92:95], a[44:47], v[44:47], v[92:95]
    s_waitcnt lgkmcnt(4)
    v_mfma_f32_16x16x32_bf16 v[80:83], a[48:51], v[48:51], v[80:83]
    ds_read_b128 v[40:43], v13 offset:18432
    v_mfma_f32_16x16x32_bf16 v[84:87], a[52:55], v[48:51], v[84:87]
    ds_read_b128 v[44:47], v13 offset:19456
    v_mfma_f32_16x16x32_bf16 v[88:91], a[48:51], v[52:55], v[88:91]
    v_mfma_f32_16x16x32_bf16 v[92:95], a[52:55], v[52:55], v[92:95]
    s_waitcnt lgkmcnt(4)
    v_mfma_f32_16x16x32_bf16 v[80:83], a[56:59], v[56:59], v[80:83]
    ds_read_b128 v[48:51], v13 offset:20480
    v_mfma_f32_16x16x32_bf16 v[84:87], a[60:63], v[56:59], v[84:87]
    ds_read_b128 v[52:55], v13 offset:21504
    v_mfma_f32_16x16x32_bf16 v[88:91], a[56:59], v[60:63], v[88:91]
    v_mfma_f32_16x16x32_bf16 v[92:95], a[60:63], v[60:63], v[92:95]
    s_waitcnt lgkmcnt(4)
    v_mfma_f32_16x16x32_bf16 v[80:83], a[64:67], v[32:35], v[80:83]
    ds_read_b128 v[56:59], v13 offset:22528
    v_mfma_f32_16x16x32_bf16 v[84:87], a[68:71], v[32:35], v[84:87]
    ds_read_b128 v[60:63], v13 offset:23552
    v_mfma_f32_16x16x32_bf16 v[88:91], a[64:67], v[36:39], v[88:91]
    v_mfma_f32_16x16x32_bf16 v[92:95], a[68:71], v[36:39], v[92:95]
    s_waitcnt lgkmcnt(4)
    v_mfma_f32_16x16x32_bf16 v[80:83], a[72:75], v[40:43], v[80:83]
    ds_read_b128 v[32:35], v13 offset:24576
    v_mfma_f32_16x16x32_bf16 v[84:87], a[76:79], v[40:43], v[84:87]
    ds_read_b128 v[36:39], v13 offset:25600
    v_mfma_f32_16x16x32_bf16 v[88:91], a[72:75], v[44:47], v[88:91]
    v_mfma_f32_16x16x32_bf16 v[92:95], a[76:79], v[44:47], v[92:95]
    s_waitcnt lgkmcnt(4)
    v_mfma_f32_16x16x32_bf16 v[80:83], a[80:83], v[48:51], v[80:83]
    ds_read_b128 v[40:43], v13 offset:26624
    v_mfma_f32_16x16x32_bf16 v[84:87], a[84:87], v[48:51], v[84:87]
    ds_read_b128 v[44:47], v13 offset:27648
    v_mfma_f32_16x16x32_bf16 v[88:91], a[80:83], v[52:55], v[88:91]
    v_mfma_f32_16x16x32_bf16 v[92:95], a[84:87], v[52:55], v[92:95]
    s_waitcnt lgkmcnt(4)
    v_mfma_f32_16x16x32_bf16 v[80:83], a[88:91], v[56:59], v[80:83]
    ds_read_b128 v[48:51], v13 offset:28672
    v_mfma_f32_16x16x32_bf16 v[84:87], a[92:95], v[56:59], v[84:87]
    ds_read_b128 v[52:55], v13 offset:29696
    v_mfma_f32_16x16x32_bf16 v[88:91], a[88:91], v[60:63], v[88:91]
    v_mfma_f32_16x16x32_bf16 v[92:95], a[92:95], v[60:63], v[92:95]
    s_waitcnt lgkmcnt(4)
    v_mfma_f32_16x16x32_bf16 v[80:83], a[96:99], v[32:35], v[80:83]
    ds_read_b128 v[56:59], v13 offset:30720
    v_mfma_f32_16x16x32_bf16 v[84:87], a[100:103], v[32:35], v[84:87]
    ds_read_b128 v[60:63], v13 offset:31744
    v_mfma_f32_16x16x32_bf16 v[88:91], a[96:99], v[36:39], v[88:91]
    v_mfma_f32_16x16x32_bf16 v[92:95], a[100:103], v[36:39], v[92:95]
    s_waitcnt lgkmcnt(4)
    v_mfma_f32_16x16x32_bf16 v[80:83], a[104:107], v[40:43], v[80:83]
    v_mfma_f32_16x16x32_bf16 v[84:87], a[108:111], v[40:43], v[84:87]
    v_mfma_f32_16x16x32_bf16 v[88:91], a[104:107], v[44:47], v[88:91]
    v_mfma_f32_16x16x32_bf16 v[92:95], a[108:111], v[44:47], v[92:95]
    s_waitcnt vmcnt(0) lgkmcnt(0)
    s_barrier
    v_mfma_f32_16x16x32_bf16 v[80:83], a[112:115], v[48:51], v[80:83]
    ds_read_b128 v[32:35], v13 offset:32768
    v_mfma_f32_16x16x32_bf16 v[84:87], a[116:119], v[48:51], v[84:87]
    ds_read_b128 v[36:39], v13 offset:33792
    v_mfma_f32_16x16x32_bf16 v[88:91], a[112:115], v[52:55], v[88:91]
    v_mfma_f32_16x16x32_bf16 v[92:95], a[116:119], v[52:55], v[92:95]
    v_mfma_f32_16x16x32_bf16 v[80:83], a[120:123], v[56:59], v[80:83]
    ds_read_b128 v[40:43], v13 offset:34816
    v_mfma_f32_16x16x32_bf16 v[84:87], a[124:127], v[56:59], v[84:87]
    ds_read_b128 v[44:47], v13 offset:35840
    v_mfma_f32_16x16x32_bf16 v[88:91], a[120:123], v[60:63], v[88:91]
    v_mfma_f32_16x16x32_bf16 v[92:95], a[124:127], v[60:63], v[92:95]
    s_waitcnt lgkmcnt(2)
    v_mfma_f32_16x16x32_bf16 v[80:83], a[128:131], v[32:35], v[80:83]
    ds_read_b128 v[48:51], v13 offset:36864
    v_mfma_f32_16x16x32_bf16 v[84:87], a[132:135], v[32:35], v[84:87]
    ds_read_b128 v[52:55], v13 offset:37888
    v_mfma_f32_16x16x32_bf16 v[88:91], a[128:131], v[36:39], v[88:91]
    ds_read_b128 v[56:59], v13 offset:38912
    v_mfma_f32_16x16x32_bf16 v[92:95], a[132:135], v[36:39], v[92:95]
    ds_read_b128 v[60:63], v13 offset:39936
    s_waitcnt lgkmcnt(4)
    v_mfma_f32_16x16x32_bf16 v[80:83], a[136:139], v[40:43], v[80:83]
    ds_read_b128 v[32:35], v13 offset:40960
    v_mfma_f32_16x16x32_bf16 v[84:87], a[140:143], v[40:43], v[84:87]
    ds_read_b128 v[36:39], v13 offset:41984
    v_mfma_f32_16x16x32_bf16 v[88:91], a[136:139], v[44:47], v[88:91]
    v_mfma_f32_16x16x32_bf16 v[92:95], a[140:143], v[44:47], v[92:95]
    s_waitcnt lgkmcnt(4)
    v_mfma_f32_16x16x32_bf16 v[80:83], a[144:147], v[48:51], v[80:83]
    ds_read_b128 v[40:43], v13 offset:43008
    v_mfma_f32_16x16x32_bf16 v[84:87], a[148:151], v[48:51], v[84:87]
    ds_read_b128 v[44:47], v13 offset:44032
    v_mfma_f32_16x16x32_bf16 v[88:91], a[144:147], v[52:55], v[88:91]
    v_mfma_f32_16x16x32_bf16 v[92:95], a[148:151], v[52:55], v[92:95]
    s_waitcnt lgkmcnt(4)
    v_mfma_f32_16x16x32_bf16 v[80:83], a[152:155], v[56:59], v[80:83]
    ds_read_b128 v[48:51], v13 offset:45056
    v_mfma_f32_16x16x32_bf16 v[84:87], a[156:159], v[56:59], v[84:87]
    ds_read_b128 v[52:55], v13 offset:46080
    v_mfma_f32_16x16x32_bf16 v[88:91], a[152:155], v[60:63], v[88:91]
    v_mfma_f32_16x16x32_bf16 v[92:95], a[156:159], v[60:63], v[92:95]
    s_waitcnt lgkmcnt(4)
    v_mfma_f32_16x16x32_bf16 v[80:83], a[160:163], v[32:35], v[80:83]
    ds_read_b128 v[56:59], v13 offset:47104
    v_mfma_f32_16x16x32_bf16 v[84:87], a[164:167], v[32:35], v[84:87]
    ds_read_b128 v[60:63], v13 offset:48128
    v_mfma_f32_16x16x32_bf16 v[88:91], a[160:163], v[36:39], v[88:91]
    v_mfma_f32_16x16x32_bf16 v[92:95], a[164:167], v[36:39], v[92:95]
    s_waitcnt lgkmcnt(4)
    v_mfma_f32_16x16x32_bf16 v[80:83], a[168:171], v[40:43], v[80:83]
    ds_read_b128 v[32:35], v13 offset:49152
    v_mfma_f32_16x16x32_bf16 v[84:87], a[172:175], v[40:43], v[84:87]
    ds_read_b128 v[36:39], v13 offset:50176
    v_mfma_f32_16x16x32_bf16 v[88:91], a[168:171], v[44:47], v[88:91]
    v_mfma_f32_16x16x32_bf16 v[92:95], a[172:175], v[44:47], v[92:95]
    s_waitcnt lgkmcnt(4)
    v_mfma_f32_16x16x32_bf16 v[80:83], a[176:179], v[48:51], v[80:83]
    ds_read_b128 v[40:43], v13 offset:51200
    v_mfma_f32_16x16x32_bf16 v[84:87], a[180:183], v[48:51], v[84:87]
    ds_read_b128 v[44:47], v13 offset:52224
    v_mfma_f32_16x16x32_bf16 v[88:91], a[176:179], v[52:55], v[88:91]
    v_mfma_f32_16x16x32_bf16 v[92:95], a[180:183], v[52:55], v[92:95]
    s_waitcnt lgkmcnt(4)
    v_mfma_f32_16x16x32_bf16 v[80:83], a[184:187], v[56:59], v[80:83]
    ds_read_b128 v[48:51], v13 offset:53248
    v_mfma_f32_16x16x32_bf16 v[84:87], a[188:191], v[56:59], v[84:87]
    ds_read_b128 v[52:55], v13 offset:54272
    v_mfma_f32_16x16x32_bf16 v[88:91], a[184:187], v[60:63], v[88:91]
    v_mfma_f32_16x16x32_bf16 v[92:95], a[188:191], v[60:63], v[92:95]
    s_waitcnt lgkmcnt(4)
    v_mfma_f32_16x16x32_bf16 v[80:83], a[192:195], v[32:35], v[80:83]
    ds_read_b128 v[56:59], v13 offset:55296
    v_mfma_f32_16x16x32_bf16 v[84:87], a[196:199], v[32:35], v[84:87]
    ds_read_b128 v[60:63], v13 offset:56320
    v_mfma_f32_16x16x32_bf16 v[88:91], a[192:195], v[36:39], v[88:91]
    v_mfma_f32_16x16x32_bf16 v[92:95], a[196:199], v[36:39], v[92:95]
    s_waitcnt lgkmcnt(4)
    v_mfma_f32_16x16x32_bf16 v[80:83], a[200:203], v[40:43], v[80:83]
    ds_read_b128 v[32:35], v13 offset:57344
    v_mfma_f32_16x16x32_bf16 v[84:87], a[204:207], v[40:43], v[84:87]
    ds_read_b128 v[36:39], v13 offset:58368
    v_mfma_f32_16x16x32_bf16 v[88:91], a[200:203], v[44:47], v[88:91]
    v_mfma_f32_16x16x32_bf16 v[92:95], a[204:207], v[44:47], v[92:95]
    s_waitcnt lgkmcnt(4)
    v_mfma_f32_16x16x32_bf16 v[80:83], a[208:211], v[48:51], v[80:83]
    ds_read_b128 v[40:43], v13 offset:59392
    v_mfma_f32_16x16x32_bf16 v[84:87], a[212:215], v[48:51], v[84:87]
    ds_read_b128 v[44:47], v13 offset:60416
    v_mfma_f32_16x16x32_bf16 v[88:91], a[208:211], v[52:55], v[88:91]
    v_mfma_f32_16x16x32_bf16 v[92:95], a[212:215], v[52:55], v[92:95]
    s_waitcnt lgkmcnt(4)
    v_mfma_f32_16x16x32_bf16 v[80:83], a[216:219], v[56:59], v[80:83]
    ds_read_b128 v[48:51], v13 offset:61440
    v_mfma_f32_16x16x32_bf16 v[84:87], a[220:223], v[56:59], v[84:87]
    ds_read_b128 v[52:55], v13 offset:62464
    v_mfma_f32_16x16x32_bf16 v[88:91], a[216:219], v[60:63], v[88:91]
    v_mfma_f32_16x16x32_bf16 v[92:95], a[220:223], v[60:63], v[92:95]
    s_waitcnt lgkmcnt(4)
    v_mfma_f32_16x16x32_bf16 v[80:83], a[224:227], v[32:35], v[80:83]
    ds_read_b128 v[56:59], v13 offset:63488
    v_mfma_f32_16x16x32_bf16 v[84:87], a[228:231], v[32:35], v[84:87]
    ds_read_b128 v[60:63], v13 offset:64512
    v_mfma_f32_16x16x32_bf16 v[88:91], a[224:227], v[36:39], v[88:91]
    v_mfma_f32_16x16x32_bf16 v[92:95], a[228:231], v[36:39], v[92:95]
    s_waitcnt lgkmcnt(4)
    v_mfma_f32_16x16x32_bf16 v[80:83], a[232:235], v[40:43], v[80:83]
    v_mfma_f32_16x16x32_bf16 v[84:87], a[236:239], v[40:43], v[84:87]
    v_mfma_f32_16x16x32_bf16 v[88:91], a[232:235], v[44:47], v[88:91]
    v_mfma_f32_16x16x32_bf16 v[92:95], a[236:239], v[44:47], v[92:95]
    s_waitcnt lgkmcnt(0)
    v_mfma_f32_16x16x32_bf16 v[80:83], a[240:243], v[48:51], v[80:83]
    v_mfma_f32_16x16x32_bf16 v[84:87], a[244:247], v[48:51], v[84:87]
    v_mfma_f32_16x16x32_bf16 v[88:91], a[240:243], v[52:55], v[88:91]
    v_mfma_f32_16x16x32_bf16 v[92:95], a[244:247], v[52:55], v[92:95]
    v_mfma_f32_16x16x32_bf16 v[80:83], a[248:251], v[56:59], v[80:83]
    v_mfma_f32_16x16x32_bf16 v[84:87], a[252:255], v[56:59], v[84:87]
    v_mfma_f32_16x16x32_bf16 v[88:91], a[248:251], v[60:63], v[88:91]
    v_mfma_f32_16x16x32_bf16 v[92:95], a[252:255], v[60:63], v[92:95]
    s_mov_b32 s76, s57
    s_nop 6
    ds_write_b128 v7, v[80:83] offset:0
    ds_write_b128 v7, v[84:87] offset:64
    ds_write_b128 v7, v[88:91] offset:2304
    ds_write_b128 v7, v[92:95] offset:2368
L_e_fin_145:
    s_waitcnt lgkmcnt(0)
    ds_read_b128 v[216:219], v8 offset:0
    ds_read_b128 v[220:223], v8 offset:1152
    ds_read_b128 v[224:227], v8 offset:2304
    ds_read_b128 v[228:231], v8 offset:3456
    s_waitcnt lgkmcnt(0)
    buffer_store_dwordx4 v[216:219], v11, s[12:15], s76 offen sc1
    s_add_u32 s76, s76, 32768
    buffer_store_dwordx4 v[220:223], v11, s[12:15], s76 offen sc1
    s_add_u32 s76, s76, 32768
    buffer_store_dwordx4 v[224:227], v11, s[12:15], s76 offen sc1
    s_add_u32 s76, s76, 32768
    buffer_store_dwordx4 v[228:231], v11, s[12:15], s76 offen sc1
    s_mov_b32 s92, s62
    s_cmp_eq_u32 s51, 1
    s_cbranch_scc1 L_a_loop_126_b
    s_waitcnt vmcnt(4)
L_a_loop_126_b:
    s_barrier
    s_branch L_a_loop_126
L_a_fin_131:
    s_waitcnt vmcnt(0)
    s_barrier
    s_cmp_lg_u32 s44, 0
    s_cbranch_scc1 L_pub_146
    v_mov_b32 v30, s92
    v_mov_b32 v31, 0
    s_mov_b64 exec, 1
    buffer_store_dword v30, v31, s[12:15], s67 offen sc1
    s_mov_b64 exec, -1
L_pub_146:
    s_branch L_w_done_96
L_role_b_124:
    s_load_dwordx2 s[6:7], s[0:1], 64
    s_load_dwordx2 s[8:9], s[0:1], 72
    s_waitcnt lgkmcnt(0)
    s_mov_b32 s24, s6
    s_and_b32 s25, s7, 0xffff
    s_mov_b32 s26, 0x700000
    s_mov_b32 s27, 0x00020000
    s_mov_b32 s32, s8
    s_and_b32 s33, s9, 0xffff
    s_mov_b32 s34, 0x1c00
    s_mov_b32 s35, 0x00020000
    s_min_u32 s45, s41, 27
    s_lshl_b32 s46, s45, 8
    s_waitcnt vmcnt(0)
    s_barrier
    v_lshrrev_b32 v20, 4, v1
    s_lshl_b32 s45, s44, 2
    v_add_u32 v21, s45, v20
    s_mov_b32 s45, 7168
    v_mul_lo_u32 v21, v21, s45
    v_lshlrev_b32 v22, 2, v20
    v_and_b32 v23, 15, v1
    v_xor_b32 v22, v22, v23
    v_lshlrev_b32 v22, 4, v22
    v_add_u32 v21, v21, v22
    v_bfe_u32 v22, v1, 2, 2
    v_lshlrev_b32 v23, 3, v20
    v_add_u32 v23, v23, v22
    v_lshlrev_b32 v23, 8, v23
    v_xor_b32 v22, s44, v22
    v_lshlrev_b32 v22, 6, v22
    v_add_u32 v23, v23, v22
    v_and_b32 v22, 3, v1
    v_lshlrev_b32 v22, 4, v22
    v_add_u32 v23, v23, v22
    v_add_u32 v24, 65536, v23
    v_add_u32 v25, 131072, v23
    s_lshl_b32 s47, s44, 10
    s_add_u32 s45, s46, 0x0
    s_add_u32 m0, s47, 0
    s_nop 0
    buffer_load_dwordx4 v21, s[24:27], s45 offen  lds
    s_add_u32 s45, s46, 0x1c000
    s_add_u32 m0, s47, 4096
    s_nop 0
    buffer_load_dwordx4 v21, s[24:27], s45 offen  lds
    s_add_u32 s45, s46, 0x38000
    s_add_u32 m0, s47, 8192
    s_nop 0
    buffer_load_dwordx4 v21, s[24:27], s45 offen  lds
    s_add_u32 s45, s46, 0x54000
    s_add_u32 m0, s47, 12288
    s_nop 0
    buffer_load_dwordx4 v21, s[24:27], s45 offen  lds
    s_add_u32 s45, s46, 0x70000
    s_add_u32 m0, s47, 16384
    s_nop 0
    buffer_load_dwordx4 v21, s[24:27], s45 offen  lds
    s_add_u32 s45, s46, 0x8c000
    s_add_u32 m0, s47, 20480
    s_nop 0
    buffer_load_dwordx4 v21, s[24:27], s45 offen  lds
    s_add_u32 s45, s46, 0xa8000
    s_add_u32 m0, s47, 24576
    s_nop 0
    buffer_load_dwordx4 v21, s[24:27], s45 offen  lds
    s_add_u32 s45, s46, 0xc4000
    s_add_u32 m0, s47, 28672
    s_nop 0
    buffer_load_dwordx4 v21, s[24:27], s45 offen  lds
    s_add_u32 s45, s46, 0xe0000
    s_add_u32 m0, s47, 32768
    s_nop 0
    buffer_load_dwordx4 v21, s[24:27], s45 offen  lds
    s_add_u32 s45, s46, 0xfc000
    s_add_u32 m0, s47, 36864
    s_nop 0
    buffer_load_dwordx4 v21, s[24:27], s45 offen  lds
    s_add_u32 s45, s46, 0x118000
    s_add_u32 m0, s47, 40960
    s_nop 0
    buffer_load_dwordx4 v21, s[24:27], s45 offen  lds
    s_add_u32 s45, s46, 0x134000
    s_add_u32 m0, s47, 45056
    s_nop 0
    buffer_load_dwordx4 v21, s[24:27], s45 offen  lds
    s_add_u32 s45, s46, 0x150000
    s_add_u32 m0, s47, 49152
    s_nop 0
    buffer_load_dwordx4 v21, s[24:27], s45 offen  lds
    s_add_u32 s45, s46, 0x16c000
    s_add_u32 m0, s47, 53248
    s_nop 0
    buffer_load_dwordx4 v21, s[24:27], s45 offen  lds
    s_add_u32 s45, s46, 0x188000
    s_add_u32 m0, s47, 57344
    s_nop 0
    buffer_load_dwordx4 v21, s[24:27], s45 offen  lds
    s_add_u32 s45, s46, 0x1a4000
    s_add_u32 m0, s47, 61440
    s_nop 0
    buffer_load_dwordx4 v21, s[24:27], s45 offen  lds
    s_add_u32 s45, s46, 0x1c0000
    s_add_u32 m0, s47, 65536
    s_nop 0
    buffer_load_dwordx4 v21, s[24:27], s45 offen  lds
    s_add_u32 s45, s46, 0x1dc000
    s_add_u32 m0, s47, 69632
    s_nop 0
    buffer_load_dwordx4 v21, s[24:27], s45 offen  lds
    s_add_u32 s45, s46, 0x1f8000
    s_add_u32 m0, s47, 73728
    s_nop 0
    buffer_load_dwordx4 v21, s[24:27], s45 offen  lds
    s_add_u32 s45, s46, 0x214000
    s_add_u32 m0, s47, 77824
    s_nop 0
    buffer_load_dwordx4 v21, s[24:27], s45 offen  lds
    s_add_u32 s45, s46, 0x230000
    s_add_u32 m0, s47, 81920
    s_nop 0
    buffer_load_dwordx4 v21, s[24:27], s45 offen  lds
    s_add_u32 s45, s46, 0x24c000
    s_add_u32 m0, s47, 86016
    s_nop 0
    buffer_load_dwordx4 v21, s[24:27], s45 offen  lds
    s_add_u32 s45, s46, 0x268000
    s_add_u32 m0, s47, 90112
    s_nop 0
    buffer_load_dwordx4 v21, s[24:27], s45 offen  lds
    s_add_u32 s45, s46, 0x284000
    s_add_u32 m0, s47, 94208
    s_nop 0
    buffer_load_dwordx4 v21, s[24:27], s45 offen  lds
    s_add_u32 s45, s46, 0x2a0000
    s_add_u32 m0, s47, 98304
    s_nop 0
    buffer_load_dwordx4 v21, s[24:27], s45 offen  lds
    s_add_u32 s45, s46, 0x2bc000
    s_add_u32 m0, s47, 102400
    s_nop 0
    buffer_load_dwordx4 v21, s[24:27], s45 offen  lds
    s_add_u32 s45, s46, 0x2d8000
    s_add_u32 m0, s47, 106496
    s_nop 0
    buffer_load_dwordx4 v21, s[24:27], s45 offen  lds
    s_add_u32 s45, s46, 0x2f4000
    s_add_u32 m0, s47, 110592
    s_nop 0
    buffer_load_dwordx4 v21, s[24:27], s45 offen  lds
    s_add_u32 s45, s46, 0x310000
    s_add_u32 m0, s47, 114688
    s_nop 0
    buffer_load_dwordx4 v21, s[24:27], s45 offen  lds
    s_add_u32 s45, s46, 0x32c000
    s_add_u32 m0, s47, 118784
    s_nop 0
    buffer_load_dwordx4 v21, s[24:27], s45 offen  lds
    s_add_u32 s45, s46, 0x348000
    s_add_u32 m0, s47, 122880
    s_nop 0
    buffer_load_dwordx4 v21, s[24:27], s45 offen  lds
    s_add_u32 s45, s46, 0x364000
    s_add_u32 m0, s47, 126976
    s_nop 0
    buffer_load_dwordx4 v21, s[24:27], s45 offen  lds
    s_waitcnt vmcnt(28)
    s_barrier
    s_add_u32 s45, s46, 0x380000
    s_add_u32 m0, s47, 131072
    s_nop 0
    buffer_load_dwordx4 v21, s[24:27], s45 offen  lds
    s_add_u32 s45, s46, 0x39c000
    s_add_u32 m0, s47, 135168
    s_nop 0
    buffer_load_dwordx4 v21, s[24:27], s45 offen  lds
    s_add_u32 s45, s46, 0x3b8000
    s_add_u32 m0, s47, 139264
    s_nop 0
    buffer_load_dwordx4 v21, s[24:27], s45 offen  lds
    s_add_u32 s45, s46, 0x3d4000
    s_add_u32 m0, s47, 143360
    s_nop 0
    buffer_load_dwordx4 v21, s[24:27], s45 offen  lds
    ds_read_b64_tr_b16 a[0:1], v23 offset:0
    ds_read_b64_tr_b16 a[2:3], v23 offset:1024
    ds_read_b64_tr_b16 a[4:5], v23 offset:8
    ds_read_b64_tr_b16 a[6:7], v23 offset:1032
    ds_read_b64_tr_b16 a[8:9], v23 offset:8192
    ds_read_b64_tr_b16 a[10:11], v23 offset:9216
    ds_read_b64_tr_b16 a[12:13], v23 offset:8200
    ds_read_b64_tr_b16 a[14:15], v23 offset:9224
    s_waitcnt lgkmcnt(0)
    s_waitcnt vmcnt(28)
    s_barrier
    s_add_u32 s45, s46, 0x3f0000
    s_add_u32 m0, s47, 0
    s_nop 0
    buffer_load_dwordx4 v21, s[24:27], s45 offen  lds
    s_add_u32 s45, s46, 0x40c000
    s_add_u32 m0, s47, 4096
    s_nop 0
    buffer_load_dwordx4 v21, s[24:27], s45 offen  lds
    s_add_u32 s45, s46, 0x428000
    s_add_u32 m0, s47, 8192
    s_nop 0
    buffer_load_dwordx4 v21, s[24:27], s45 offen  lds
    s_add_u32 s45, s46, 0x444000
    s_add_u32 m0, s47, 12288
    s_nop 0
    buffer_load_dwordx4 v21, s[24:27], s45 offen  lds
    ds_read_b64_tr_b16 a[16:17], v23 offset:16384
    ds_read_b64_tr_b16 a[18:19], v23 offset:17408
    ds_read_b64_tr_b16 a[20:21], v23 offset:16392
    ds_read_b64_tr_b16 a[22:23], v23 offset:17416
    ds_read_b64_tr_b16 a[24:25], v23 offset:24576
    ds_read_b64_tr_b16 a[26:27], v23 offset:25600
    ds_read_b64_tr_b16 a[28:29], v23 offset:24584
    ds_read_b64_tr_b16 a[30:31], v23 offset:25608
    s_waitcnt lgkmcnt(0)
    s_waitcnt vmcnt(28)
    s_barrier
    s_add_u32 s45, s46, 0x460000
    s_add_u32 m0, s47, 16384
    s_nop 0
    buffer_load_dwordx4 v21, s[24:27], s45 offen  lds
    s_add_u32 s45, s46, 0x47c000
    s_add_u32 m0, s47, 20480
    s_nop 0
    buffer_load_dwordx4 v21, s[24:27], s45 offen  lds
    s_add_u32 s45, s46, 0x498000
    s_add_u32 m0, s47, 24576
    s_nop 0
    buffer_load_dwordx4 v21, s[24:27], s45 offen  lds
    s_add_u32 s45, s46, 0x4b4000
    s_add_u32 m0, s47, 28672
    s_nop 0
    buffer_load_dwordx4 v21, s[24:27], s45 offen  lds
    ds_read_b64_tr_b16 a[32:33], v23 offset:32768
    ds_read_b64_tr_b16 a[34:35], v23 offset:33792
    ds_read_b64_tr_b16 a[36:37], v23 offset:32776
    ds_read_b64_tr_b16 a[38:39], v23 offset:33800
    ds_read_b64_tr_b16 a[40:41], v23 offset:40960
    ds_read_b64_tr_b16 a[42:43], v23 offset:41984
    ds_read_b64_tr_b16 a[44:45], v23 offset:40968
    ds_read_b64_tr_b16 a[46:47], v23 offset:41992
    s_waitcnt lgkmcnt(0)
    s_waitcnt vmcnt(28)
    s_barrier
    s_add_u32 s45, s46, 0x4d0000
    s_add_u32 m0, s47, 32768
    s_nop 0
    buffer_load_dwordx4 v21, s[24:27], s45 offen  lds
    s_add_u32 s45, s46, 0x4ec000
    s_add_u32 m0, s47, 36864
    s_nop 0
    buffer_load_dwordx4 v21, s[24:27], s45 offen  lds
    s_add_u32 s45, s46, 0x508000
    s_add_u32 m0, s47, 40960
    s_nop 0
    buffer_load_dwordx4 v21, s[24:27], s45 offen  lds
    s_add_u32 s45, s46, 0x524000
    s_add_u32 m0, s47, 45056
    s_nop 0
    buffer_load_dwordx4 v21, s[24:27], s45 offen  lds
    ds_read_b64_tr_b16 a[48:49], v23 offset:49152
    ds_read_b64_tr_b16 a[50:51], v23 offset:50176
    ds_read_b64_tr_b16 a[52:53], v23 offset:49160
    ds_read_b64_tr_b16 a[54:55], v23 offset:50184
    ds_read_b64_tr_b16 a[56:57], v23 offset:57344
    ds_read_b64_tr_b16 a[58:59], v23 offset:58368
    ds_read_b64_tr_b16 a[60:61], v23 offset:57352
    ds_read_b64_tr_b16 a[62:63], v23 offset:58376
    s_waitcnt lgkmcnt(0)
    s_waitcnt vmcnt(28)
    s_barrier
    s_add_u32 s45, s46, 0x540000
    s_add_u32 m0, s47, 49152
    s_nop 0
    buffer_load_dwordx4 v21, s[24:27], s45 offen  lds
    s_add_u32 s45, s46, 0x55c000
    s_add_u32 m0, s47, 53248
    s_nop 0
    buffer_load_dwordx4 v21, s[24:27], s45 offen  lds
    s_add_u32 s45, s46, 0x578000
    s_add_u32 m0, s47, 57344
    s_nop 0
    buffer_load_dwordx4 v21, s[24:27], s45 offen  lds
    s_add_u32 s45, s46, 0x594000
    s_add_u32 m0, s47, 61440
    s_nop 0
    buffer_load_dwordx4 v21, s[24:27], s45 offen  lds
    ds_read_b64_tr_b16 a[64:65], v24 offset:0
    ds_read_b64_tr_b16 a[66:67], v24 offset:1024
    ds_read_b64_tr_b16 a[68:69], v24 offset:8
    ds_read_b64_tr_b16 a[70:71], v24 offset:1032
    ds_read_b64_tr_b16 a[72:73], v24 offset:8192
    ds_read_b64_tr_b16 a[74:75], v24 offset:9216
    ds_read_b64_tr_b16 a[76:77], v24 offset:8200
    ds_read_b64_tr_b16 a[78:79], v24 offset:9224
    s_waitcnt lgkmcnt(0)
    s_waitcnt vmcnt(28)
    s_barrier
    s_add_u32 s45, s46, 0x5b0000
    s_add_u32 m0, s47, 65536
    s_nop 0
    buffer_load_dwordx4 v21, s[24:27], s45 offen  lds
    s_add_u32 s45, s46, 0x5cc000
    s_add_u32 m0, s47, 69632
    s_nop 0
    buffer_load_dwordx4 v21, s[24:27], s45 offen  lds
    s_add_u32 s45, s46, 0x5e8000
    s_add_u32 m0, s47, 73728
    s_nop 0
    buffer_load_dwordx4 v21, s[24:27], s45 offen  lds
    s_add_u32 s45, s46, 0x604000
    s_add_u32 m0, s47, 77824
    s_nop 0
    buffer_load_dwordx4 v21, s[24:27], s45 offen  lds
    ds_read_b64_tr_b16 a[80:81], v24 offset:16384
    ds_read_b64_tr_b16 a[82:83], v24 offset:17408
    ds_read_b64_tr_b16 a[84:85], v24 offset:16392
    ds_read_b64_tr_b16 a[86:87], v24 offset:17416
    ds_read_b64_tr_b16 a[88:89], v24 offset:24576
    ds_read_b64_tr_b16 a[90:91], v24 offset:25600
    ds_read_b64_tr_b16 a[92:93], v24 offset:24584
    ds_read_b64_tr_b16 a[94:95], v24 offset:25608
    s_waitcnt lgkmcnt(0)
    s_waitcnt vmcnt(28)
    s_barrier
    s_add_u32 s45, s46, 0x620000
    s_add_u32 m0, s47, 81920
    s_nop 0
    buffer_load_dwordx4 v21, s[24:27], s45 offen  lds
    s_add_u32 s45, s46, 0x63c000
    s_add_u32 m0, s47, 86016
    s_nop 0
    buffer_load_dwordx4 v21, s[24:27], s45 offen  lds
    s_add_u32 s45, s46, 0x658000
    s_add_u32 m0, s47, 90112
    s_nop 0
    buffer_load_dwordx4 v21, s[24:27], s45 offen  lds
    s_add_u32 s45, s46, 0x674000
    s_add_u32 m0, s47, 94208
    s_nop 0
    buffer_load_dwordx4 v21, s[24:27], s45 offen  lds
    ds_read_b64_tr_b16 a[96:97], v24 offset:32768
    ds_read_b64_tr_b16 a[98:99], v24 offset:33792
    ds_read_b64_tr_b16 a[100:101], v24 offset:32776
    ds_read_b64_tr_b16 a[102:103], v24 offset:33800
    ds_read_b64_tr_b16 a[104:105], v24 offset:40960
    ds_read_b64_tr_b16 a[106:107], v24 offset:41984
    ds_read_b64_tr_b16 a[108:109], v24 offset:40968
    ds_read_b64_tr_b16 a[110:111], v24 offset:41992
    s_waitcnt lgkmcnt(0)
    s_waitcnt vmcnt(28)
    s_barrier
    s_add_u32 s45, s46, 0x690000
    s_add_u32 m0, s47, 98304
    s_nop 0
    buffer_load_dwordx4 v21, s[24:27], s45 offen  lds
    s_add_u32 s45, s46, 0x6ac000
    s_add_u32 m0, s47, 102400
    s_nop 0
    buffer_load_dwordx4 v21, s[24:27], s45 offen  lds
    s_add_u32 s45, s46, 0x6c8000
    s_add_u32 m0, s47, 106496
    s_nop 0
    buffer_load_dwordx4 v21, s[24:27], s45 offen  lds
    s_add_u32 s45, s46, 0x6e4000
    s_add_u32 m0, s47, 110592
    s_nop 0
    buffer_load_dwordx4 v21, s[24:27], s45 offen  lds
    ds_read_b64_tr_b16 a[112:113], v24 offset:49152
    ds_read_b64_tr_b16 a[114:115], v24 offset:50176
    ds_read_b64_tr_b16 a[116:117], v24 offset:49160
    ds_read_b64_tr_b16 a[118:119], v24 offset:50184
    ds_read_b64_tr_b16 a[120:121], v24 offset:57344
    ds_read_b64_tr_b16 a[122:123], v24 offset:58368
    ds_read_b64_tr_b16 a[124:125], v24 offset:57352
    ds_read_b64_tr_b16 a[126:127], v24 offset:58376
    s_waitcnt lgkmcnt(0)
    s_waitcnt vmcnt(28)
    s_barrier
    ds_read_b64_tr_b16 a[128:129], v25 offset:0
    ds_read_b64_tr_b16 a[130:131], v25 offset:1024
    ds_read_b64_tr_b16 a[132:133], v25 offset:8
    ds_read_b64_tr_b16 a[134:135], v25 offset:1032
    ds_read_b64_tr_b16 a[136:137], v25 offset:8192
    ds_read_b64_tr_b16 a[138:139], v25 offset:9216
    ds_read_b64_tr_b16 a[140:141], v25 offset:8200
    ds_read_b64_tr_b16 a[142:143], v25 offset:9224
    s_waitcnt lgkmcnt(0)
    s_waitcnt vmcnt(24)
    s_barrier
    ds_read_b64_tr_b16 a[144:145], v23 offset:0
    ds_read_b64_tr_b16 a[146:147], v23 offset:1024
    ds_read_b64_tr_b16 a[148:149], v23 offset:8
    ds_read_b64_tr_b16 a[150:151], v23 offset:1032
    ds_read_b64_tr_b16 a[152:153], v23 offset:8192
    ds_read_b64_tr_b16 a[154:155], v23 offset:9216
    ds_read_b64_tr_b16 a[156:157], v23 offset:8200
    ds_read_b64_tr_b16 a[158:159], v23 offset:9224
    s_waitcnt lgkmcnt(0)
    s_waitcnt vmcnt(20)
    s_barrier
    ds_read_b64_tr_b16 a[160:161], v23 offset:16384
    ds_read_b64_tr_b16 a[162:163], v23 offset:17408
    ds_read_b64_tr_b16 a[164:165], v23 offset:16392
    ds_read_b64_tr_b16 a[166:167], v23 offset:17416
    ds_read_b64_tr_b16 a[168:169], v23 offset:24576
    ds_read_b64_tr_b16 a[170:171], v23 offset:25600
    ds_read_b64_tr_b16 a[172:173], v23 offset:24584
    ds_read_b64_tr_b16 a[174:175], v23 offset:25608
    s_waitcnt lgkmcnt(0)
    s_waitcnt vmcnt(16)
    s_barrier
    ds_read_b64_tr_b16 a[176:177], v23 offset:32768
    ds_read_b64_tr_b16 a[178:179], v23 offset:33792
    ds_read_b64_tr_b16 a[180:181], v23 offset:32776
    ds_read_b64_tr_b16 a[182:183], v23 offset:33800
    ds_read_b64_tr_b16 a[184:185], v23 offset:40960
    ds_read_b64_tr_b16 a[186:187], v23 offset:41984
    ds_read_b64_tr_b16 a[188:189], v23 offset:40968
    ds_read_b64_tr_b16 a[190:191], v23 offset:41992
    s_waitcnt lgkmcnt(0)
    s_waitcnt vmcnt(12)
    s_barrier
    ds_read_b64_tr_b16 a[192:193], v23 offset:49152
    ds_read_b64_tr_b16 a[194:195], v23 offset:50176
    ds_read_b64_tr_b16 a[196:197], v23 offset:49160
    ds_read_b64_tr_b16 a[198:199], v23 offset:50184
    ds_read_b64_tr_b16 a[200:201], v23 offset:57344
    ds_read_b64_tr_b16 a[202:203], v23 offset:58368
    ds_read_b64_tr_b16 a[204:205], v23 offset:57352
    ds_read_b64_tr_b16 a[206:207], v23 offset:58376
    s_waitcnt lgkmcnt(0)
    s_waitcnt vmcnt(8)
    s_barrier
    ds_read_b64_tr_b16 a[208:209], v24 offset:0
    ds_read_b64_tr_b16 a[210:211], v24 offset:1024
    ds_read_b64_tr_b16 a[212:213], v24 offset:8
    ds_read_b64_tr_b16 a[214:215], v24 offset:1032
    ds_read_b64_tr_b16 a[216:217], v24 offset:8192
    ds_read_b64_tr_b16 a[218:219], v24 offset:9216
    ds_read_b64_tr_b16 a[220:221], v24 offset:8200
    ds_read_b64_tr_b16 a[222:223], v24 offset:9224
    s_waitcnt lgkmcnt(0)
    s_waitcnt vmcnt(4)
    s_barrier
    ds_read_b64_tr_b16 a[224:225], v24 offset:16384
    ds_read_b64_tr_b16 a[226:227], v24 offset:17408
    ds_read_b64_tr_b16 a[228:229], v24 offset:16392
    ds_read_b64_tr_b16 a[230:231], v24 offset:17416
    ds_read_b64_tr_b16 a[232:233], v24 offset:24576
    ds_read_b64_tr_b16 a[234:235], v24 offset:25600
    ds_read_b64_tr_b16 a[236:237], v24 offset:24584
    ds_read_b64_tr_b16 a[238:239], v24 offset:25608
    s_waitcnt lgkmcnt(0)
    s_waitcnt vmcnt(0)
    s_barrier
    ds_read_b64_tr_b16 a[240:241], v24 offset:32768
    ds_read_b64_tr_b16 a[242:243], v24 offset:33792
    ds_read_b64_tr_b16 a[244:245], v24 offset:32776
    ds_read_b64_tr_b16 a[246:247], v24 offset:33800
    ds_read_b64_tr_b16 a[248:249], v24 offset:40960
    ds_read_b64_tr_b16 a[250:251], v24 offset:41984
    ds_read_b64_tr_b16 a[252:253], v24 offset:40968
    ds_read_b64_tr_b16 a[254:255], v24 offset:41992
    s_waitcnt lgkmcnt(0)
    s_barrier
    s_min_u32 s45, s41, 27
    s_lshl_b32 s45, s45, 8
    s_lshl_b32 s46, s44, 6
    s_add_u32 s45, s45, s46
    v_lshrrev_b32 v29, 4, v1
    v_lshlrev_b32 v29, 4, v29
    buffer_load_dwordx4 v[80:83], v29, s[32:35], s45 offen
    s_waitcnt vmcnt(0)
    v_lshlrev_b32 v96, 16, v80
    v_and_b32 v97, 0xffff0000, v80
    v_lshlrev_b32 v98, 16, v81
    v_and_b32 v99, 0xffff0000, v81
    v_lshlrev_b32 v100, 16, v82
    v_and_b32 v101, 0xffff0000, v82
    v_lshlrev_b32 v102, 16, v83
    v_and_b32 v103, 0xffff0000, v83
    v_mov_b32 v104, 0xbdd2d3e8
    v_mov_b32 v105, v104
    v_mov_b32 v106, 0xc0135761
    v_mov_b32 v107, v106
    s_cmp_lg_u32 s44, 0
    s_cbranch_scc1 L_pd_147
    v_mov_b32 v29, 127232
    s_mov_b32 s46, 96
    s_mov_b64 exec, 1
    s_mov_b32 s70, 0
L_wp_148:
    buffer_load_dword v31, v29, s[12:15], 0 offen sc1
    s_add_u32 s70, s70, 1
    s_cmp_ge_u32 s70, 0x200000
    s_cbranch_scc1 L_w_done_96
L_wp_148_c:
    s_waitcnt vmcnt(0)
    v_cmp_gt_u32 vcc, s46, v31
    s_nop 1
    s_cbranch_vccz L_wp_148_ok
    s_sleep 3
    s_branch L_wp_148
L_wp_148_ok:
    s_mov_b64 exec, -1
L_pd_147:
    s_barrier
    v_lshlrev_b32 v29, 5, v1
    s_mov_b32 s45, 8192
    buffer_load_dwordx4 v[112:115], v29, s[12:15], s45 offen offset:0 sc1
    buffer_load_dwordx4 v[116:119], v29, s[12:15], s45 offen offset:16 sc1
    buffer_load_dwordx4 v[120:123], v29, s[12:15], s45 offen offset:2048 sc1
    buffer_load_dwordx4 v[124:127], v29, s[12:15], s45 offen offset:2064 sc1
    s_mov_b32 s45, 32768
    buffer_load_dwordx4 v[32:35], v29, s[12:15], s45 offen offset:0 sc1
    buffer_load_dwordx4 v[36:39], v29, s[12:15], s45 offen offset:16 sc1
    buffer_load_dwordx4 v[40:43], v29, s[12:15], s45 offen offset:2048 sc1
    buffer_load_dwordx4 v[44:47], v29, s[12:15], s45 offen offset:2064 sc1
    s_mov_b32 s45, 12288
    buffer_load_dwordx4 v[128:131], v29, s[12:15], s45 offen offset:0 sc1
    buffer_load_dwordx4 v[132:135], v29, s[12:15], s45 offen offset:16 sc1
    buffer_load_dwordx4 v[136:139], v29, s[12:15], s45 offen offset:2048 sc1
    buffer_load_dwordx4 v[140:143], v29, s[12:15], s45 offen offset:2064 sc1
    s_mov_b32 s45, 36864
    buffer_load_dwordx4 v[48:51], v29, s[12:15], s45 offen offset:0 sc1
    buffer_load_dwordx4 v[52:55], v29, s[12:15], s45 offen offset:16 sc1
    buffer_load_dwordx4 v[56:59], v29, s[12:15], s45 offen offset:2048 sc1
    buffer_load_dwordx4 v[60:63], v29, s[12:15], s45 offen offset:2064 sc1
    s_mov_b32 s45, 16384
    buffer_load_dwordx4 v[144:147], v29, s[12:15], s45 offen offset:0 sc1
    buffer_load_dwordx4 v[148:151], v29, s[12:15], s45 offen offset:16 sc1
    buffer_load_dwordx4 v[152:155], v29, s[12:15], s45 offen offset:2048 sc1
    buffer_load_dwordx4 v[156:159], v29, s[12:15], s45 offen offset:2064 sc1
    s_mov_b32 s45, 40960
    buffer_load_dwordx4 v[64:67], v29, s[12:15], s45 offen offset:0 sc1
    buffer_load_dwordx4 v[68:71], v29, s[12:15], s45 offen offset:16 sc1
    buffer_load_dwordx4 v[72:75], v29, s[12:15], s45 offen offset:2048 sc1
    buffer_load_dwordx4 v[76:79], v29, s[12:15], s45 offen offset:2064 sc1
    s_waitcnt vmcnt(0)
    v_add_f32 v112, v112, v32
    v_cvt_pk_bf16_f32 v112, v112, v112
    v_lshlrev_b32 v112, 16, v112
    v_add_f32 v113, v113, v33
    v_cvt_pk_bf16_f32 v113, v113, v113
    v_lshlrev_b32 v113, 16, v113
    v_add_f32 v114, v114, v34
    v_cvt_pk_bf16_f32 v114, v114, v114
    v_lshlrev_b32 v114, 16, v114
    v_add_f32 v115, v115, v35
    v_cvt_pk_bf16_f32 v115, v115, v115
    v_lshlrev_b32 v115, 16, v115
    v_add_f32 v116, v116, v36
    v_cvt_pk_bf16_f32 v116, v116, v116
    v_lshlrev_b32 v116, 16, v116
    v_add_f32 v117, v117, v37
    v_cvt_pk_bf16_f32 v117, v117, v117
    v_lshlrev_b32 v117, 16, v117
    v_add_f32 v118, v118, v38
    v_cvt_pk_bf16_f32 v118, v118, v118
    v_lshlrev_b32 v118, 16, v118
    v_add_f32 v119, v119, v39
    v_cvt_pk_bf16_f32 v119, v119, v119
    v_lshlrev_b32 v119, 16, v119
    v_add_f32 v120, v120, v40
    v_cvt_pk_bf16_f32 v120, v120, v120
    v_lshlrev_b32 v120, 16, v120
    v_add_f32 v121, v121, v41
    v_cvt_pk_bf16_f32 v121, v121, v121
    v_lshlrev_b32 v121, 16, v121
    v_add_f32 v122, v122, v42
    v_cvt_pk_bf16_f32 v122, v122, v122
    v_lshlrev_b32 v122, 16, v122
    v_add_f32 v123, v123, v43
    v_cvt_pk_bf16_f32 v123, v123, v123
    v_lshlrev_b32 v123, 16, v123
    v_add_f32 v124, v124, v44
    v_cvt_pk_bf16_f32 v124, v124, v124
    v_lshlrev_b32 v124, 16, v124
    v_add_f32 v125, v125, v45
    v_cvt_pk_bf16_f32 v125, v125, v125
    v_lshlrev_b32 v125, 16, v125
    v_add_f32 v126, v126, v46
    v_cvt_pk_bf16_f32 v126, v126, v126
    v_lshlrev_b32 v126, 16, v126
    v_add_f32 v127, v127, v47
    v_cvt_pk_bf16_f32 v127, v127, v127
    v_lshlrev_b32 v127, 16, v127
    v_add_f32 v128, v128, v48
    v_cvt_pk_bf16_f32 v128, v128, v128
    v_lshlrev_b32 v128, 16, v128
    v_add_f32 v129, v129, v49
    v_cvt_pk_bf16_f32 v129, v129, v129
    v_lshlrev_b32 v129, 16, v129
    v_add_f32 v130, v130, v50
    v_cvt_pk_bf16_f32 v130, v130, v130
    v_lshlrev_b32 v130, 16, v130
    v_add_f32 v131, v131, v51
    v_cvt_pk_bf16_f32 v131, v131, v131
    v_lshlrev_b32 v131, 16, v131
    v_add_f32 v132, v132, v52
    v_cvt_pk_bf16_f32 v132, v132, v132
    v_lshlrev_b32 v132, 16, v132
    v_add_f32 v133, v133, v53
    v_cvt_pk_bf16_f32 v133, v133, v133
    v_lshlrev_b32 v133, 16, v133
    v_add_f32 v134, v134, v54
    v_cvt_pk_bf16_f32 v134, v134, v134
    v_lshlrev_b32 v134, 16, v134
    v_add_f32 v135, v135, v55
    v_cvt_pk_bf16_f32 v135, v135, v135
    v_lshlrev_b32 v135, 16, v135
    v_add_f32 v136, v136, v56
    v_cvt_pk_bf16_f32 v136, v136, v136
    v_lshlrev_b32 v136, 16, v136
    v_add_f32 v137, v137, v57
    v_cvt_pk_bf16_f32 v137, v137, v137
    v_lshlrev_b32 v137, 16, v137
    v_add_f32 v138, v138, v58
    v_cvt_pk_bf16_f32 v138, v138, v138
    v_lshlrev_b32 v138, 16, v138
    v_add_f32 v139, v139, v59
    v_cvt_pk_bf16_f32 v139, v139, v139
    v_lshlrev_b32 v139, 16, v139
    v_add_f32 v140, v140, v60
    v_cvt_pk_bf16_f32 v140, v140, v140
    v_lshlrev_b32 v140, 16, v140
    v_add_f32 v141, v141, v61
    v_cvt_pk_bf16_f32 v141, v141, v141
    v_lshlrev_b32 v141, 16, v141
    v_add_f32 v142, v142, v62
    v_cvt_pk_bf16_f32 v142, v142, v142
    v_lshlrev_b32 v142, 16, v142
    v_add_f32 v143, v143, v63
    v_cvt_pk_bf16_f32 v143, v143, v143
    v_lshlrev_b32 v143, 16, v143
    v_add_f32 v144, v144, v64
    v_cvt_pk_bf16_f32 v144, v144, v144
    v_lshlrev_b32 v144, 16, v144
    v_add_f32 v144, 1.0, v144
    v_cvt_pk_bf16_f32 v144, v144, v144
    v_lshlrev_b32 v144, 16, v144
    v_add_f32 v145, v145, v65
    v_cvt_pk_bf16_f32 v145, v145, v145
    v_lshlrev_b32 v145, 16, v145
    v_add_f32 v145, 1.0, v145
    v_cvt_pk_bf16_f32 v145, v145, v145
    v_lshlrev_b32 v145, 16, v145
    v_add_f32 v146, v146, v66
    v_cvt_pk_bf16_f32 v146, v146, v146
    v_lshlrev_b32 v146, 16, v146
    v_add_f32 v146, 1.0, v146
    v_cvt_pk_bf16_f32 v146, v146, v146
    v_lshlrev_b32 v146, 16, v146
    v_add_f32 v147, v147, v67
    v_cvt_pk_bf16_f32 v147, v147, v147
    v_lshlrev_b32 v147, 16, v147
    v_add_f32 v147, 1.0, v147
    v_cvt_pk_bf16_f32 v147, v147, v147
    v_lshlrev_b32 v147, 16, v147
    v_add_f32 v148, v148, v68
    v_cvt_pk_bf16_f32 v148, v148, v148
    v_lshlrev_b32 v148, 16, v148
    v_add_f32 v148, 1.0, v148
    v_cvt_pk_bf16_f32 v148, v148, v148
    v_lshlrev_b32 v148, 16, v148
    v_add_f32 v149, v149, v69
    v_cvt_pk_bf16_f32 v149, v149, v149
    v_lshlrev_b32 v149, 16, v149
    v_add_f32 v149, 1.0, v149
    v_cvt_pk_bf16_f32 v149, v149, v149
    v_lshlrev_b32 v149, 16, v149
    v_add_f32 v150, v150, v70
    v_cvt_pk_bf16_f32 v150, v150, v150
    v_lshlrev_b32 v150, 16, v150
    v_add_f32 v150, 1.0, v150
    v_cvt_pk_bf16_f32 v150, v150, v150
    v_lshlrev_b32 v150, 16, v150
    v_add_f32 v151, v151, v71
    v_cvt_pk_bf16_f32 v151, v151, v151
    v_lshlrev_b32 v151, 16, v151
    v_add_f32 v151, 1.0, v151
    v_cvt_pk_bf16_f32 v151, v151, v151
    v_lshlrev_b32 v151, 16, v151
    v_add_f32 v152, v152, v72
    v_cvt_pk_bf16_f32 v152, v152, v152
    v_lshlrev_b32 v152, 16, v152
    v_add_f32 v152, 1.0, v152
    v_cvt_pk_bf16_f32 v152, v152, v152
    v_lshlrev_b32 v152, 16, v152
    v_add_f32 v153, v153, v73
    v_cvt_pk_bf16_f32 v153, v153, v153
    v_lshlrev_b32 v153, 16, v153
    v_add_f32 v153, 1.0, v153
    v_cvt_pk_bf16_f32 v153, v153, v153
    v_lshlrev_b32 v153, 16, v153
    v_add_f32 v154, v154, v74
    v_cvt_pk_bf16_f32 v154, v154, v154
    v_lshlrev_b32 v154, 16, v154
    v_add_f32 v154, 1.0, v154
    v_cvt_pk_bf16_f32 v154, v154, v154
    v_lshlrev_b32 v154, 16, v154
    v_add_f32 v155, v155, v75
    v_cvt_pk_bf16_f32 v155, v155, v155
    v_lshlrev_b32 v155, 16, v155
    v_add_f32 v155, 1.0, v155
    v_cvt_pk_bf16_f32 v155, v155, v155
    v_lshlrev_b32 v155, 16, v155
    v_add_f32 v156, v156, v76
    v_cvt_pk_bf16_f32 v156, v156, v156
    v_lshlrev_b32 v156, 16, v156
    v_add_f32 v156, 1.0, v156
    v_cvt_pk_bf16_f32 v156, v156, v156
    v_lshlrev_b32 v156, 16, v156
    v_add_f32 v157, v157, v77
    v_cvt_pk_bf16_f32 v157, v157, v157
    v_lshlrev_b32 v157, 16, v157
    v_add_f32 v157, 1.0, v157
    v_cvt_pk_bf16_f32 v157, v157, v157
    v_lshlrev_b32 v157, 16, v157
    v_add_f32 v158, v158, v78
    v_cvt_pk_bf16_f32 v158, v158, v158
    v_lshlrev_b32 v158, 16, v158
    v_add_f32 v158, 1.0, v158
    v_cvt_pk_bf16_f32 v158, v158, v158
    v_lshlrev_b32 v158, 16, v158
    v_add_f32 v159, v159, v79
    v_cvt_pk_bf16_f32 v159, v159, v159
    v_lshlrev_b32 v159, 16, v159
    v_add_f32 v159, 1.0, v159
    v_cvt_pk_bf16_f32 v159, v159, v159
    v_lshlrev_b32 v159, 16, v159
    s_lshl_b32 s46, s44, 10
    s_add_u32 s45, s46, 8192
    buffer_load_dwordx4 v[18:21], v10, s[12:15], s45 offen sc1
    s_add_u32 s45, s46, 32768
    buffer_load_dwordx4 v[32:35], v10, s[12:15], s45 offen sc1
    s_add_u32 s45, s46, 12288
    buffer_load_dwordx4 v[22:25], v10, s[12:15], s45 offen sc1
    s_add_u32 s45, s46, 36864
    buffer_load_dwordx4 v[36:39], v10, s[12:15], s45 offen sc1
    s_add_u32 s45, s46, 16384
    buffer_load_dwordx4 v[108:111], v10, s[12:15], s45 offen sc1
    s_add_u32 s45, s46, 40960
    buffer_load_dwordx4 v[40:43], v10, s[12:15], s45 offen sc1
    s_waitcnt vmcnt(0)
    v_add_f32 v18, v18, v32
    v_cvt_pk_bf16_f32 v18, v18, v18
    v_lshlrev_b32 v18, 16, v18
    v_add_f32 v19, v19, v33
    v_cvt_pk_bf16_f32 v19, v19, v19
    v_lshlrev_b32 v19, 16, v19
    v_add_f32 v20, v20, v34
    v_cvt_pk_bf16_f32 v20, v20, v20
    v_lshlrev_b32 v20, 16, v20
    v_add_f32 v21, v21, v35
    v_cvt_pk_bf16_f32 v21, v21, v21
    v_lshlrev_b32 v21, 16, v21
    v_add_f32 v22, v22, v36
    v_cvt_pk_bf16_f32 v22, v22, v22
    v_lshlrev_b32 v22, 16, v22
    v_add_f32 v23, v23, v37
    v_cvt_pk_bf16_f32 v23, v23, v23
    v_lshlrev_b32 v23, 16, v23
    v_add_f32 v24, v24, v38
    v_cvt_pk_bf16_f32 v24, v24, v24
    v_lshlrev_b32 v24, 16, v24
    v_add_f32 v25, v25, v39
    v_cvt_pk_bf16_f32 v25, v25, v25
    v_lshlrev_b32 v25, 16, v25
    v_add_f32 v108, v108, v40
    v_cvt_pk_bf16_f32 v108, v108, v108
    v_lshlrev_b32 v108, 16, v108
    v_add_f32 v108, 1.0, v108
    v_cvt_pk_bf16_f32 v108, v108, v108
    v_lshlrev_b32 v108, 16, v108
    v_add_f32 v109, v109, v41
    v_cvt_pk_bf16_f32 v109, v109, v109
    v_lshlrev_b32 v109, 16, v109
    v_add_f32 v109, 1.0, v109
    v_cvt_pk_bf16_f32 v109, v109, v109
    v_lshlrev_b32 v109, 16, v109
    v_add_f32 v110, v110, v42
    v_cvt_pk_bf16_f32 v110, v110, v110
    v_lshlrev_b32 v110, 16, v110
    v_add_f32 v110, 1.0, v110
    v_cvt_pk_bf16_f32 v110, v110, v110
    v_lshlrev_b32 v110, 16, v110
    v_add_f32 v111, v111, v43
    v_cvt_pk_bf16_f32 v111, v111, v111
    v_lshlrev_b32 v111, 16, v111
    v_add_f32 v111, 1.0, v111
    v_cvt_pk_bf16_f32 v111, v111, v111
    v_lshlrev_b32 v111, 16, v111
    s_mov_b32 s52, 0xc00000
    s_lshl_b32 s56, s41, 13
    s_add_u32 s56, s56, 0x6000000
    s_lshl_b32 s45, s40, 7
    s_add_u32 s45, s45, 127488
    v_mov_b32 v29, s45
    s_mov_b32 s46, 536870912
    s_mov_b64 exec, 1
    s_mov_b32 s70, 0
L_wp_152:
    buffer_load_dword v31, v29, s[12:15], 0 offen sc1
    s_add_u32 s70, s70, 1
    s_cmp_ge_u32 s70, 0x200000
    s_cbranch_scc1 L_w_done_96
L_wp_152_c:
    s_waitcnt vmcnt(0)
    v_cmp_gt_u32 vcc, s46, v31
    s_nop 1
    s_cbranch_vccz L_wp_152_ok
    s_sleep 2
    s_branch L_wp_152
L_wp_152_ok:
    s_mov_b64 exec, -1
    v_readfirstlane_b32 s45, v31
    s_nop 3
    s_and_b32 s46, s45, 511
    s_mul_i32 s46, s46, s46
    s_bfe_u32 s45, s45, 0xf0009
    s_lshl_b32 s45, s45, 5
    s_mov_b32 s80, s12
    s_mov_b32 s81, s13
    s_mov_b32 s83, 0x00020000
    s_mov_b32 s84, s12
    s_mov_b32 s85, s13
    s_mov_b32 s87, 0x00020000
    s_cmp_eq_u32 s45, s46
    s_cselect_b32 s82, s14, 0
    s_cselect_b32 s86, 0, s14
    s_mov_b32 s92, 0
L_b_loop_149:
    s_cmp_eq_u64 s[36:37], 0
    s_cbranch_scc1 L_a_fin_131
    s_ff1_i32_b64 s50, s[36:37]
    s_bitset0_b64 s[36:37], s50
    s_lshr_b64 s[74:75], s[72:73], s50
    s_ff1_i32_b64 s51, s[74:75]
    s_add_u32 s51, s51, 1
    s_add_u32 s62, s50, s51
    s_cmp_lg_u32 s51, 1
    s_cbranch_scc1 L_b_skip2_151
    s_lshl_b32 s63, s50, 5
    s_add_u32 s63, s63, s41
    s_lshl_b32 s47, s63, 11
    s_lshl_b32 s45, s44, 9
    s_add_u32 s47, s47, s45
    v_lshlrev_b32 v17, 3, v1
    buffer_load_dwordx2 v[208:209], v17, s[28:31], s47 offen
    s_add_u32 s45, s64, 4096
    s_cmp_lg_u32 s44, 1
    s_cbranch_scc1 L_pi_153
    s_mov_b32 exec_hi, 0
    buffer_load_dword v31, v5, s[12:15], s45 offen sc1
    s_mov_b64 exec, -1
L_pi_153:
    s_waitcnt vmcnt(0)
    s_barrier
    s_cmp_lg_u32 s44, 0
    s_cbranch_scc1 L_pub_154
    v_mov_b32 v30, s92
    v_mov_b32 v31, 0
    s_mov_b64 exec, 1
    buffer_store_dword v30, v31, s[12:15], s67 offen sc1
    s_mov_b64 exec, -1
L_pub_154:
    s_cmp_lg_u32 s44, 1
    s_cbranch_scc1 L_pw_155
    s_mov_b32 exec_hi, 0
    s_mov_b32 s70, 0
    s_branch L_wp_156_c
L_wp_156:
    buffer_load_dword v31, v5, s[12:15], s45 offen sc1
    s_add_u32 s70, s70, 1
    s_cmp_ge_u32 s70, 0x200000
    s_cbranch_scc1 L_w_done_96
L_wp_156_c:
    s_waitcnt vmcnt(0)
    v_cmp_gt_u32 vcc, s62, v31
    s_nop 1
    s_cbranch_vccz L_wp_156_ok
    s_sleep 1
    s_branch L_wp_156
L_wp_156_ok:
    s_mov_b64 exec, -1
L_pw_155:
    s_barrier
    s_lshl_b32 s45, s63, 12
    s_lshl_b32 s46, s44, 10
    s_add_u32 s45, s45, s46
    s_add_u32 s45, s45, 0x8000000
    buffer_load_dwordx4 v[64:67], v10, s[12:15], s45 offen sc1
    s_add_u32 s45, s45, 0x800000
    buffer_load_dwordx4 v[68:71], v10, s[12:15], s45 offen sc1
    s_add_u32 s45, s45, 0x800000
    buffer_load_dwordx4 v[72:75], v10, s[12:15], s45 offen sc1
    s_add_u32 s45, s45, 0x800000
    buffer_load_dwordx4 v[76:79], v10, s[12:15], s45 offen sc1
    s_waitcnt vmcnt(4)
    v_lshlrev_b32 v160, 16, v208
    v_and_b32 v161, 0xffff0000, v208
    v_lshlrev_b32 v162, 16, v209
    v_and_b32 v163, 0xffff0000, v209
    s_waitcnt vmcnt(0)
    v_pk_add_f32 v[64:65], v[64:65], v[68:69]
    v_pk_add_f32 v[72:73], v[72:73], v[76:77]
    v_pk_add_f32 v[66:67], v[66:67], v[70:71]
    v_pk_add_f32 v[74:75], v[74:75], v[78:79]
    v_pk_add_f32 v[64:65], v[64:65], v[72:73]
    v_pk_add_f32 v[66:67], v[66:67], v[74:75]
    v_cvt_pk_bf16_f32 v64, v64, v64
    v_lshlrev_b32 v64, 16, v64
    v_cvt_pk_bf16_f32 v65, v65, v65
    v_lshlrev_b32 v65, 16, v65
    v_cvt_pk_bf16_f32 v66, v66, v66
    v_lshlrev_b32 v66, 16, v66
    v_cvt_pk_bf16_f32 v67, v67, v67
    v_lshlrev_b32 v67, 16, v67
    v_mul_f32 v64, v64, v18
    v_cvt_pk_bf16_f32 v64, v64, v64
    v_lshlrev_b32 v64, 16, v64
    v_add_f32 v64, v64, v160
    v_mul_f32 v65, v65, v19
    v_cvt_pk_bf16_f32 v65, v65, v65
    v_lshlrev_b32 v65, 16, v65
    v_add_f32 v65, v65, v161
    v_mul_f32 v66, v66, v20
    v_cvt_pk_bf16_f32 v66, v66, v66
    v_lshlrev_b32 v66, 16, v66
    v_add_f32 v66, v66, v162
    v_mul_f32 v67, v67, v21
    v_cvt_pk_bf16_f32 v67, v67, v67
    v_lshlrev_b32 v67, 16, v67
    v_add_f32 v67, v67, v163
    v_cvt_pk_bf16_f32 v208, v64, v65
    v_cvt_pk_bf16_f32 v209, v66, v67
    s_add_u32 s47, s47, 0x800000
    buffer_store_dwordx2 v[208:209], v17, s[12:15], s47 offen sc1
    v_lshlrev_b32 v64, 16, v208
    v_and_b32 v65, 0xffff0000, v208
    v_lshlrev_b32 v66, 16, v209
    v_and_b32 v67, 0xffff0000, v209
    v_add_f32 v26, v64, v65
    v_add_f32 v27, v66, v67
    v_add_f32 v26, v26, v27
    s_nop 1
    v_add_f32_dpp v26, v26, v26 row_shr:1 row_mask:0xf bank_mask:0xf bound_ctrl:0
    s_nop 1
    v_add_f32_dpp v26, v26, v26 row_shr:2 row_mask:0xf bank_mask:0xf bound_ctrl:0
    s_nop 1
    v_add_f32_dpp v26, v26, v26 row_shr:4 row_mask:0xf bank_mask:0xf bound_ctrl:0
    s_nop 1
    v_add_f32_dpp v26, v26, v26 row_shr:8 row_mask:0xf bank_mask:0xf bound_ctrl:0
    s_nop 1
    v_add_f32_dpp v26, v26, v26 row_bcast:15 row_mask:0xa bank_mask:0xf
    s_nop 1
    v_add_f32_dpp v26, v26, v26 row_bcast:31 row_mask:0xc bank_mask:0xf
    s_nop 1
    v_readlane_b32 s66, v26, 63
    s_nop 1
    v_mov_b32 v28, s66
    v_mul_f32 v28, 0x3b800000, v28
    v_mov_b32 v26, 0
    v_sub_f32 v27, v64, v28
    v_fmac_f32 v26, v27, v27
    v_sub_f32 v27, v65, v28
    v_fmac_f32 v26, v27, v27
    v_sub_f32 v27, v66, v28
    v_fmac_f32 v26, v27, v27
    v_sub_f32 v27, v67, v28
    v_fmac_f32 v26, v27, v27
    s_nop 1
    v_add_f32_dpp v26, v26, v26 row_shr:1 row_mask:0xf bank_mask:0xf bound_ctrl:0
    s_nop 1
    v_add_f32_dpp v26, v26, v26 row_shr:2 row_mask:0xf bank_mask:0xf bound_ctrl:0
    s_nop 1
    v_add_f32_dpp v26, v26, v26 row_shr:4 row_mask:0xf bank_mask:0xf bound_ctrl:0
    s_nop 1
    v_add_f32_dpp v26, v26, v26 row_shr:8 row_mask:0xf bank_mask:0xf bound_ctrl:0
    s_nop 1
    v_add_f32_dpp v26, v26, v26 row_bcast:15 row_mask:0xa bank_mask:0xf
    s_nop 1
    v_add_f32_dpp v26, v26, v26 row_bcast:31 row_mask:0xc bank_mask:0xf
    s_nop 1
    v_readlane_b32 s66, v26, 63
    s_lshl_b32 s45, s44, 3
    s_add_u32 s45, s45, 131072
    v_mov_b32 v29, s66
    v_mov_b32 v27, s45
    ds_write_b64 v27, v[28:29]
    v_mov_b32 v27, 131072
    s_waitcnt lgkmcnt(0)
    s_barrier
    ds_read_b128 v[68:71], v27
    ds_read_b128 v[72:75], v27 offset:16
    s_waitcnt lgkmcnt(0)
    v_add_f32 v27, v68, v70
    v_add_f32 v26, v72, v74
    v_add_f32 v27, v27, v26
    v_mul_f32 v27, 0x3e800000, v27
    v_add_f32 v26, v69, v71
    v_add_f32 v28, v73, v75
    v_add_f32 v26, v26, v28
    v_mov_b32 v28, 0
    v_sub_f32 v68, v68, v27
    v_fmac_f32 v28, v68, v68
    v_sub_f32 v70, v70, v27
    v_fmac_f32 v28, v70, v70
    v_sub_f32 v72, v72, v27
    v_fmac_f32 v28, v72, v72
    v_sub_f32 v74, v74, v27
    v_fmac_f32 v28, v74, v74
    v_mul_f32 v28, 0x43800000, v28
    v_add_f32 v26, v26, v28
    v_mul_f32 v26, 0x3a800000, v26
    v_cvt_pk_bf16_f32 v26, v26, v26
    v_lshlrev_b32 v26, 16, v26
    v_cvt_pk_bf16_f32 v27, v27, v27
    v_lshlrev_b32 v27, 16, v27
    v_add_f32 v26, 0x3727c5ac, v26
    v_cvt_pk_bf16_f32 v26, v26, v26
    v_lshlrev_b32 v26, 16, v26
    v_sqrt_f32 v26, v26
    s_nop 0
    v_cvt_pk_bf16_f32 v26, v26, v26
    v_lshlrev_b32 v26, 16, v26
    v_rcp_f32 v26, v26
    s_nop 0
    v_sub_f32 v64, v64, v27
    v_cvt_pk_bf16_f32 v64, v64, v64
    v_lshlrev_b32 v64, 16, v64
    v_mul_f32 v64, v64, v26
    v_cvt_pk_bf16_f32 v64, v64, v64
    v_lshlrev_b32 v64, 16, v64
    v_mul_f32 v64, v64, v108
    v_cvt_pk_bf16_f32 v64, v64, v64
    v_lshlrev_b32 v64, 16, v64
    v_add_f32 v64, v64, v22
    v_sub_f32 v65, v65, v27
    v_cvt_pk_bf16_f32 v65, v65, v65
    v_lshlrev_b32 v65, 16, v65
    v_mul_f32 v65, v65, v26
    v_cvt_pk_bf16_f32 v65, v65, v65
    v_lshlrev_b32 v65, 16, v65
    v_mul_f32 v65, v65, v109
    v_cvt_pk_bf16_f32 v65, v65, v65
    v_lshlrev_b32 v65, 16, v65
    v_add_f32 v65, v65, v23
    v_sub_f32 v66, v66, v27
    v_cvt_pk_bf16_f32 v66, v66, v66
    v_lshlrev_b32 v66, 16, v66
    v_mul_f32 v66, v66, v26
    v_cvt_pk_bf16_f32 v66, v66, v66
    v_lshlrev_b32 v66, 16, v66
    v_mul_f32 v66, v66, v110
    v_cvt_pk_bf16_f32 v66, v66, v66
    v_lshlrev_b32 v66, 16, v66
    v_add_f32 v66, v66, v24
    v_sub_f32 v67, v67, v27
    v_cvt_pk_bf16_f32 v67, v67, v67
    v_lshlrev_b32 v67, 16, v67
    v_mul_f32 v67, v67, v26
    v_cvt_pk_bf16_f32 v67, v67, v67
    v_lshlrev_b32 v67, 16, v67
    v_mul_f32 v67, v67, v111
    v_cvt_pk_bf16_f32 v67, v67, v67
    v_lshlrev_b32 v67, 16, v67
    v_add_f32 v67, v67, v25
    v_cvt_pk_bf16_f32 v64, v64, v65
    v_cvt_pk_bf16_f32 v65, v66, v67
    v_lshrrev_b32 v26, 5, v1
    v_lshlrev_b32 v26, 13, v26
    v_and_b32 v27, 255, v17
    v_add_u32 v26, v26, v27
    s_lshl_b32 s45, s50, 16
    s_lshl_b32 s46, s41, 8
    s_add_u32 s45, s45, s46
    s_lshl_b32 s46, s44, 14
    s_add_u32 s45, s45, s46
    s_add_u32 s45, s45, 0xc00000
    buffer_store_dwordx2 v[64:65], v26, s[12:15], s45 offen sc1
    s_branch L_b_skip_150
L_b_skip2_151:
    s_add_u32 s63, s50, s44
    s_lshl_b32 s63, s63, 5
    s_add_u32 s63, s63, s41
    s_lshl_b32 s47, s63, 11
    buffer_load_dwordx4 v[208:211], v10, s[28:31], s47 offen
    buffer_load_dwordx4 v[212:215], v10, s[28:31], s47 offen offset:1024
    s_add_u32 s45, s64, 4096
    s_cmp_lg_u32 s44, 1
    s_cbranch_scc1 L_pi_157
    s_mov_b32 exec_hi, 0
    buffer_load_dword v31, v5, s[12:15], s45 offen sc1
    s_mov_b64 exec, -1
L_pi_157:
    s_waitcnt vmcnt(0)
    s_barrier
    s_cmp_lg_u32 s44, 0
    s_cbranch_scc1 L_pub_158
    v_mov_b32 v30, s92
    v_mov_b32 v31, 0
    s_mov_b64 exec, 1
    buffer_store_dword v30, v31, s[12:15], s67 offen sc1
    s_mov_b64 exec, -1
L_pub_158:
    s_cmp_lg_u32 s44, 1
    s_cbranch_scc1 L_pw_159
    s_mov_b32 exec_hi, 0
    s_mov_b32 s70, 0
    s_branch L_wp_160_c
L_wp_160:
    buffer_load_dword v31, v5, s[12:15], s45 offen sc1
    s_add_u32 s70, s70, 1
    s_cmp_ge_u32 s70, 0x200000
    s_cbranch_scc1 L_w_done_96
L_wp_160_c:
    s_waitcnt vmcnt(0)
    v_cmp_gt_u32 vcc, s62, v31
    s_nop 1
    s_cbranch_vccz L_wp_160_ok
    s_sleep 2
    s_branch L_wp_160
L_wp_160_ok:
    s_mov_b64 exec, -1
L_pw_159:
    s_barrier
    s_cmp_ge_u32 s44, s51
    s_cbranch_scc1 L_b_skip_150
    s_lshl_b32 s45, s63, 12
    s_add_u32 s45, s45, 0x8000000
    v_lshlrev_b32 v29, 5, v1
    buffer_load_dwordx4 v[64:67], v29, s[12:15], s45 offen offset:0 sc1
    buffer_load_dwordx4 v[68:71], v29, s[12:15], s45 offen offset:16 sc1
    buffer_load_dwordx4 v[72:75], v29, s[12:15], s45 offen offset:2048 sc1
    buffer_load_dwordx4 v[76:79], v29, s[12:15], s45 offen offset:2064 sc1
    s_add_u32 s45, s45, 0x800000
    buffer_load_dwordx4 v[160:163], v29, s[12:15], s45 offen offset:0 sc1
    buffer_load_dwordx4 v[164:167], v29, s[12:15], s45 offen offset:16 sc1
    buffer_load_dwordx4 v[168:171], v29, s[12:15], s45 offen offset:2048 sc1
    buffer_load_dwordx4 v[172:175], v29, s[12:15], s45 offen offset:2064 sc1
    s_add_u32 s45, s45, 0x800000
    buffer_load_dwordx4 v[176:179], v29, s[12:15], s45 offen offset:0 sc1
    buffer_load_dwordx4 v[180:183], v29, s[12:15], s45 offen offset:16 sc1
    buffer_load_dwordx4 v[184:187], v29, s[12:15], s45 offen offset:2048 sc1
    buffer_load_dwordx4 v[188:191], v29, s[12:15], s45 offen offset:2064 sc1
    s_add_u32 s45, s45, 0x800000
    buffer_load_dwordx4 v[192:195], v29, s[12:15], s45 offen offset:0 sc1
    buffer_load_dwordx4 v[196:199], v29, s[12:15], s45 offen offset:16 sc1
    buffer_load_dwordx4 v[200:203], v29, s[12:15], s45 offen offset:2048 sc1
    buffer_load_dwordx4 v[204:207], v29, s[12:15], s45 offen offset:2064 sc1
    s_waitcnt vmcnt(0)
    v_pk_add_f32 v[64:65], v[64:65], v[160:161]
    v_pk_add_f32 v[176:177], v[176:177], v[192:193]
    v_pk_add_f32 v[66:67], v[66:67], v[162:163]
    v_pk_add_f32 v[178:179], v[178:179], v[194:195]
    v_pk_add_f32 v[68:69], v[68:69], v[164:165]
    v_pk_add_f32 v[180:181], v[180:181], v[196:197]
    v_pk_add_f32 v[70:71], v[70:71], v[166:167]
    v_pk_add_f32 v[182:183], v[182:183], v[198:199]
    v_pk_add_f32 v[72:73], v[72:73], v[168:169]
    v_pk_add_f32 v[184:185], v[184:185], v[200:201]
    v_pk_add_f32 v[74:75], v[74:75], v[170:171]
    v_pk_add_f32 v[186:187], v[186:187], v[202:203]
    v_pk_add_f32 v[76:77], v[76:77], v[172:173]
    v_pk_add_f32 v[188:189], v[188:189], v[204:205]
    v_pk_add_f32 v[78:79], v[78:79], v[174:175]
    v_pk_add_f32 v[190:191], v[190:191], v[206:207]
    v_pk_add_f32 v[64:65], v[64:65], v[176:177]
    v_pk_add_f32 v[66:67], v[66:67], v[178:179]
    v_pk_add_f32 v[68:69], v[68:69], v[180:181]
    v_pk_add_f32 v[70:71], v[70:71], v[182:183]
    v_pk_add_f32 v[72:73], v[72:73], v[184:185]
    v_pk_add_f32 v[74:75], v[74:75], v[186:187]
    v_pk_add_f32 v[76:77], v[76:77], v[188:189]
    v_pk_add_f32 v[78:79], v[78:79], v[190:191]
    v_cvt_pk_bf16_f32 v64, v64, v64
    v_lshlrev_b32 v64, 16, v64
    v_cvt_pk_bf16_f32 v65, v65, v65
    v_lshlrev_b32 v65, 16, v65
    v_cvt_pk_bf16_f32 v66, v66, v66
    v_lshlrev_b32 v66, 16, v66
    v_cvt_pk_bf16_f32 v67, v67, v67
    v_lshlrev_b32 v67, 16, v67
    v_cvt_pk_bf16_f32 v68, v68, v68
    v_lshlrev_b32 v68, 16, v68
    v_cvt_pk_bf16_f32 v69, v69, v69
    v_lshlrev_b32 v69, 16, v69
    v_cvt_pk_bf16_f32 v70, v70, v70
    v_lshlrev_b32 v70, 16, v70
    v_cvt_pk_bf16_f32 v71, v71, v71
    v_lshlrev_b32 v71, 16, v71
    v_cvt_pk_bf16_f32 v72, v72, v72
    v_lshlrev_b32 v72, 16, v72
    v_cvt_pk_bf16_f32 v73, v73, v73
    v_lshlrev_b32 v73, 16, v73
    v_cvt_pk_bf16_f32 v74, v74, v74
    v_lshlrev_b32 v74, 16, v74
    v_cvt_pk_bf16_f32 v75, v75, v75
    v_lshlrev_b32 v75, 16, v75
    v_cvt_pk_bf16_f32 v76, v76, v76
    v_lshlrev_b32 v76, 16, v76
    v_cvt_pk_bf16_f32 v77, v77, v77
    v_lshlrev_b32 v77, 16, v77
    v_cvt_pk_bf16_f32 v78, v78, v78
    v_lshlrev_b32 v78, 16, v78
    v_cvt_pk_bf16_f32 v79, v79, v79
    v_lshlrev_b32 v79, 16, v79
    v_lshlrev_b32 v160, 16, v208
    v_and_b32 v161, 0xffff0000, v208
    v_lshlrev_b32 v162, 16, v209
    v_and_b32 v163, 0xffff0000, v209
    v_lshlrev_b32 v164, 16, v210
    v_and_b32 v165, 0xffff0000, v210
    v_lshlrev_b32 v166, 16, v211
    v_and_b32 v167, 0xffff0000, v211
    v_lshlrev_b32 v168, 16, v212
    v_and_b32 v169, 0xffff0000, v212
    v_lshlrev_b32 v170, 16, v213
    v_and_b32 v171, 0xffff0000, v213
    v_lshlrev_b32 v172, 16, v214
    v_and_b32 v173, 0xffff0000, v214
    v_lshlrev_b32 v174, 16, v215
    v_and_b32 v175, 0xffff0000, v215
    v_mul_f32 v64, v64, v112
    v_cvt_pk_bf16_f32 v64, v64, v64
    v_lshlrev_b32 v64, 16, v64
    v_add_f32 v64, v64, v160
    v_mul_f32 v65, v65, v113
    v_cvt_pk_bf16_f32 v65, v65, v65
    v_lshlrev_b32 v65, 16, v65
    v_add_f32 v65, v65, v161
    v_mul_f32 v66, v66, v114
    v_cvt_pk_bf16_f32 v66, v66, v66
    v_lshlrev_b32 v66, 16, v66
    v_add_f32 v66, v66, v162
    v_mul_f32 v67, v67, v115
    v_cvt_pk_bf16_f32 v67, v67, v67
    v_lshlrev_b32 v67, 16, v67
    v_add_f32 v67, v67, v163
    v_mul_f32 v68, v68, v116
    v_cvt_pk_bf16_f32 v68, v68, v68
    v_lshlrev_b32 v68, 16, v68
    v_add_f32 v68, v68, v164
    v_mul_f32 v69, v69, v117
    v_cvt_pk_bf16_f32 v69, v69, v69
    v_lshlrev_b32 v69, 16, v69
    v_add_f32 v69, v69, v165
    v_mul_f32 v70, v70, v118
    v_cvt_pk_bf16_f32 v70, v70, v70
    v_lshlrev_b32 v70, 16, v70
    v_add_f32 v70, v70, v166
    v_mul_f32 v71, v71, v119
    v_cvt_pk_bf16_f32 v71, v71, v71
    v_lshlrev_b32 v71, 16, v71
    v_add_f32 v71, v71, v167
    v_mul_f32 v72, v72, v120
    v_cvt_pk_bf16_f32 v72, v72, v72
    v_lshlrev_b32 v72, 16, v72
    v_add_f32 v72, v72, v168
    v_mul_f32 v73, v73, v121
    v_cvt_pk_bf16_f32 v73, v73, v73
    v_lshlrev_b32 v73, 16, v73
    v_add_f32 v73, v73, v169
    v_mul_f32 v74, v74, v122
    v_cvt_pk_bf16_f32 v74, v74, v74
    v_lshlrev_b32 v74, 16, v74
    v_add_f32 v74, v74, v170
    v_mul_f32 v75, v75, v123
    v_cvt_pk_bf16_f32 v75, v75, v75
    v_lshlrev_b32 v75, 16, v75
    v_add_f32 v75, v75, v171
    v_mul_f32 v76, v76, v124
    v_cvt_pk_bf16_f32 v76, v76, v76
    v_lshlrev_b32 v76, 16, v76
    v_add_f32 v76, v76, v172
    v_mul_f32 v77, v77, v125
    v_cvt_pk_bf16_f32 v77, v77, v77
    v_lshlrev_b32 v77, 16, v77
    v_add_f32 v77, v77, v173
    v_mul_f32 v78, v78, v126
    v_cvt_pk_bf16_f32 v78, v78, v78
    v_lshlrev_b32 v78, 16, v78
    v_add_f32 v78, v78, v174
    v_mul_f32 v79, v79, v127
    v_cvt_pk_bf16_f32 v79, v79, v79
    v_lshlrev_b32 v79, 16, v79
    v_add_f32 v79, v79, v175
    v_cvt_pk_bf16_f32 v208, v64, v65
    v_cvt_pk_bf16_f32 v209, v66, v67
    v_cvt_pk_bf16_f32 v210, v68, v69
    v_cvt_pk_bf16_f32 v211, v70, v71
    v_cvt_pk_bf16_f32 v212, v72, v73
    v_cvt_pk_bf16_f32 v213, v74, v75
    v_cvt_pk_bf16_f32 v214, v76, v77
    v_cvt_pk_bf16_f32 v215, v78, v79
    s_add_u32 s47, s47, 0x800000
    buffer_store_dwordx4 v[208:211], v10, s[12:15], s47 offen sc1
    buffer_store_dwordx4 v[212:215], v10, s[12:15], s47 offen offset:1024 sc1
    v_lshlrev_b32 v64, 16, v208
    v_and_b32 v65, 0xffff0000, v208
    v_lshlrev_b32 v66, 16, v209
    v_and_b32 v67, 0xffff0000, v209
    v_lshlrev_b32 v68, 16, v210
    v_and_b32 v69, 0xffff0000, v210
    v_lshlrev_b32 v70, 16, v211
    v_and_b32 v71, 0xffff0000, v211
    v_lshlrev_b32 v72, 16, v212
    v_and_b32 v73, 0xffff0000, v212
    v_lshlrev_b32 v74, 16, v213
    v_and_b32 v75, 0xffff0000, v213
    v_lshlrev_b32 v76, 16, v214
    v_and_b32 v77, 0xffff0000, v214
    v_lshlrev_b32 v78, 16, v215
    v_and_b32 v79, 0xffff0000, v215
    v_add_f32 v26, v64, v65
    v_add_f32 v26, v26, v66
    v_add_f32 v26, v26, v67
    v_add_f32 v26, v26, v68
    v_add_f32 v26, v26, v69
    v_add_f32 v26, v26, v70
    v_add_f32 v26, v26, v71
    v_add_f32 v26, v26, v72
    v_add_f32 v26, v26, v73
    v_add_f32 v26, v26, v74
    v_add_f32 v26, v26, v75
    v_add_f32 v26, v26, v76
    v_add_f32 v26, v26, v77
    v_add_f32 v26, v26, v78
    v_add_f32 v26, v26, v79
    s_nop 1
    v_add_f32_dpp v26, v26, v26 row_shr:1 row_mask:0xf bank_mask:0xf bound_ctrl:0
    s_nop 1
    v_add_f32_dpp v26, v26, v26 row_shr:2 row_mask:0xf bank_mask:0xf bound_ctrl:0
    s_nop 1
    v_add_f32_dpp v26, v26, v26 row_shr:4 row_mask:0xf bank_mask:0xf bound_ctrl:0
    s_nop 1
    v_add_f32_dpp v26, v26, v26 row_shr:8 row_mask:0xf bank_mask:0xf bound_ctrl:0
    s_nop 1
    v_add_f32_dpp v26, v26, v26 row_bcast:15 row_mask:0xa bank_mask:0xf
    s_nop 1
    v_add_f32_dpp v26, v26, v26 row_bcast:31 row_mask:0xc bank_mask:0xf
    s_nop 1
    v_readlane_b32 s66, v26, 63
    s_nop 1
    v_mov_b32 v27, s66
    v_mul_f32 v27, 0x3a800000, v27
    v_mov_b32 v26, 0
    v_sub_f32 v28, v64, v27
    v_fmac_f32 v26, v28, v28
    v_sub_f32 v28, v65, v27
    v_fmac_f32 v26, v28, v28
    v_sub_f32 v28, v66, v27
    v_fmac_f32 v26, v28, v28
    v_sub_f32 v28, v67, v27
    v_fmac_f32 v26, v28, v28
    v_sub_f32 v28, v68, v27
    v_fmac_f32 v26, v28, v28
    v_sub_f32 v28, v69, v27
    v_fmac_f32 v26, v28, v28
    v_sub_f32 v28, v70, v27
    v_fmac_f32 v26, v28, v28
    v_sub_f32 v28, v71, v27
    v_fmac_f32 v26, v28, v28
    v_sub_f32 v28, v72, v27
    v_fmac_f32 v26, v28, v28
    v_sub_f32 v28, v73, v27
    v_fmac_f32 v26, v28, v28
    v_sub_f32 v28, v74, v27
    v_fmac_f32 v26, v28, v28
    v_sub_f32 v28, v75, v27
    v_fmac_f32 v26, v28, v28
    v_sub_f32 v28, v76, v27
    v_fmac_f32 v26, v28, v28
    v_sub_f32 v28, v77, v27
    v_fmac_f32 v26, v28, v28
    v_sub_f32 v28, v78, v27
    v_fmac_f32 v26, v28, v28
    v_sub_f32 v28, v79, v27
    v_fmac_f32 v26, v28, v28
    s_nop 1
    v_add_f32_dpp v26, v26, v26 row_shr:1 row_mask:0xf bank_mask:0xf bound_ctrl:0
    s_nop 1
    v_add_f32_dpp v26, v26, v26 row_shr:2 row_mask:0xf bank_mask:0xf bound_ctrl:0
    s_nop 1
    v_add_f32_dpp v26, v26, v26 row_shr:4 row_mask:0xf bank_mask:0xf bound_ctrl:0
    s_nop 1
    v_add_f32_dpp v26, v26, v26 row_shr:8 row_mask:0xf bank_mask:0xf bound_ctrl:0
    s_nop 1
    v_add_f32_dpp v26, v26, v26 row_bcast:15 row_mask:0xa bank_mask:0xf
    s_nop 1
    v_add_f32_dpp v26, v26, v26 row_bcast:31 row_mask:0xc bank_mask:0xf
    s_nop 1
    v_readlane_b32 s66, v26, 63
    s_nop 1
    v_mov_b32 v26, s66
    v_mul_f32 v26, 0x3a800000, v26
    v_cvt_pk_bf16_f32 v26, v26, v26
    v_lshlrev_b32 v26, 16, v26
    v_cvt_pk_bf16_f32 v27, v27, v27
    v_lshlrev_b32 v27, 16, v27
    v_add_f32 v26, 0x3727c5ac, v26
    v_cvt_pk_bf16_f32 v26, v26, v26
    v_lshlrev_b32 v26, 16, v26
    v_sqrt_f32 v26, v26
    s_nop 0
    v_cvt_pk_bf16_f32 v26, v26, v26
    v_lshlrev_b32 v26, 16, v26
    v_rcp_f32 v26, v26
    s_nop 0
    v_sub_f32 v64, v64, v27
    v_cvt_pk_bf16_f32 v64, v64, v64
    v_lshlrev_b32 v64, 16, v64
    v_mul_f32 v64, v64, v26
    v_cvt_pk_bf16_f32 v64, v64, v64
    v_lshlrev_b32 v64, 16, v64
    v_sub_f32 v65, v65, v27
    v_cvt_pk_bf16_f32 v65, v65, v65
    v_lshlrev_b32 v65, 16, v65
    v_mul_f32 v65, v65, v26
    v_cvt_pk_bf16_f32 v65, v65, v65
    v_lshlrev_b32 v65, 16, v65
    v_sub_f32 v66, v66, v27
    v_cvt_pk_bf16_f32 v66, v66, v66
    v_lshlrev_b32 v66, 16, v66
    v_mul_f32 v66, v66, v26
    v_cvt_pk_bf16_f32 v66, v66, v66
    v_lshlrev_b32 v66, 16, v66
    v_sub_f32 v67, v67, v27
    v_cvt_pk_bf16_f32 v67, v67, v67
    v_lshlrev_b32 v67, 16, v67
    v_mul_f32 v67, v67, v26
    v_cvt_pk_bf16_f32 v67, v67, v67
    v_lshlrev_b32 v67, 16, v67
    v_sub_f32 v68, v68, v27
    v_cvt_pk_bf16_f32 v68, v68, v68
    v_lshlrev_b32 v68, 16, v68
    v_mul_f32 v68, v68, v26
    v_cvt_pk_bf16_f32 v68, v68, v68
    v_lshlrev_b32 v68, 16, v68
    v_sub_f32 v69, v69, v27
    v_cvt_pk_bf16_f32 v69, v69, v69
    v_lshlrev_b32 v69, 16, v69
    v_mul_f32 v69, v69, v26
    v_cvt_pk_bf16_f32 v69, v69, v69
    v_lshlrev_b32 v69, 16, v69
    v_sub_f32 v70, v70, v27
    v_cvt_pk_bf16_f32 v70, v70, v70
    v_lshlrev_b32 v70, 16, v70
    v_mul_f32 v70, v70, v26
    v_cvt_pk_bf16_f32 v70, v70, v70
    v_lshlrev_b32 v70, 16, v70
    v_sub_f32 v71, v71, v27
    v_cvt_pk_bf16_f32 v71, v71, v71
    v_lshlrev_b32 v71, 16, v71
    v_mul_f32 v71, v71, v26
    v_cvt_pk_bf16_f32 v71, v71, v71
    v_lshlrev_b32 v71, 16, v71
    v_sub_f32 v72, v72, v27
    v_cvt_pk_bf16_f32 v72, v72, v72
    v_lshlrev_b32 v72, 16, v72
    v_mul_f32 v72, v72, v26
    v_cvt_pk_bf16_f32 v72, v72, v72
    v_lshlrev_b32 v72, 16, v72
    v_sub_f32 v73, v73, v27
    v_cvt_pk_bf16_f32 v73, v73, v73
    v_lshlrev_b32 v73, 16, v73
    v_mul_f32 v73, v73, v26
    v_cvt_pk_bf16_f32 v73, v73, v73
    v_lshlrev_b32 v73, 16, v73
    v_sub_f32 v74, v74, v27
    v_cvt_pk_bf16_f32 v74, v74, v74
    v_lshlrev_b32 v74, 16, v74
    v_mul_f32 v74, v74, v26
    v_cvt_pk_bf16_f32 v74, v74, v74
    v_lshlrev_b32 v74, 16, v74
    v_sub_f32 v75, v75, v27
    v_cvt_pk_bf16_f32 v75, v75, v75
    v_lshlrev_b32 v75, 16, v75
    v_mul_f32 v75, v75, v26
    v_cvt_pk_bf16_f32 v75, v75, v75
    v_lshlrev_b32 v75, 16, v75
    v_sub_f32 v76, v76, v27
    v_cvt_pk_bf16_f32 v76, v76, v76
    v_lshlrev_b32 v76, 16, v76
    v_mul_f32 v76, v76, v26
    v_cvt_pk_bf16_f32 v76, v76, v76
    v_lshlrev_b32 v76, 16, v76
    v_sub_f32 v77, v77, v27
    v_cvt_pk_bf16_f32 v77, v77, v77
    v_lshlrev_b32 v77, 16, v77
    v_mul_f32 v77, v77, v26
    v_cvt_pk_bf16_f32 v77, v77, v77
    v_lshlrev_b32 v77, 16, v77
    v_sub_f32 v78, v78, v27
    v_cvt_pk_bf16_f32 v78, v78, v78
    v_lshlrev_b32 v78, 16, v78
    v_mul_f32 v78, v78, v26
    v_cvt_pk_bf16_f32 v78, v78, v78
    v_lshlrev_b32 v78, 16, v78
    v_sub_f32 v79, v79, v27
    v_cvt_pk_bf16_f32 v79, v79, v79
    v_lshlrev_b32 v79, 16, v79
    v_mul_f32 v79, v79, v26
    v_cvt_pk_bf16_f32 v79, v79, v79
    v_lshlrev_b32 v79, 16, v79
    v_mul_f32 v64, v64, v144
    v_cvt_pk_bf16_f32 v64, v64, v64
    v_lshlrev_b32 v64, 16, v64
    v_add_f32 v64, v64, v128
    v_mul_f32 v65, v65, v145
    v_cvt_pk_bf16_f32 v65, v65, v65
    v_lshlrev_b32 v65, 16, v65
    v_add_f32 v65, v65, v129
    v_mul_f32 v66, v66, v146
    v_cvt_pk_bf16_f32 v66, v66, v66
    v_lshlrev_b32 v66, 16, v66
    v_add_f32 v66, v66, v130
    v_mul_f32 v67, v67, v147
    v_cvt_pk_bf16_f32 v67, v67, v67
    v_lshlrev_b32 v67, 16, v67
    v_add_f32 v67, v67, v131
    v_mul_f32 v68, v68, v148
    v_cvt_pk_bf16_f32 v68, v68, v68
    v_lshlrev_b32 v68, 16, v68
    v_add_f32 v68, v68, v132
    v_mul_f32 v69, v69, v149
    v_cvt_pk_bf16_f32 v69, v69, v69
    v_lshlrev_b32 v69, 16, v69
    v_add_f32 v69, v69, v133
    v_mul_f32 v70, v70, v150
    v_cvt_pk_bf16_f32 v70, v70, v70
    v_lshlrev_b32 v70, 16, v70
    v_add_f32 v70, v70, v134
    v_mul_f32 v71, v71, v151
    v_cvt_pk_bf16_f32 v71, v71, v71
    v_lshlrev_b32 v71, 16, v71
    v_add_f32 v71, v71, v135
    v_mul_f32 v72, v72, v152
    v_cvt_pk_bf16_f32 v72, v72, v72
    v_lshlrev_b32 v72, 16, v72
    v_add_f32 v72, v72, v136
    v_mul_f32 v73, v73, v153
    v_cvt_pk_bf16_f32 v73, v73, v73
    v_lshlrev_b32 v73, 16, v73
    v_add_f32 v73, v73, v137
    v_mul_f32 v74, v74, v154
    v_cvt_pk_bf16_f32 v74, v74, v74
    v_lshlrev_b32 v74, 16, v74
    v_add_f32 v74, v74, v138
    v_mul_f32 v75, v75, v155
    v_cvt_pk_bf16_f32 v75, v75, v75
    v_lshlrev_b32 v75, 16, v75
    v_add_f32 v75, v75, v139
    v_mul_f32 v76, v76, v156
    v_cvt_pk_bf16_f32 v76, v76, v76
    v_lshlrev_b32 v76, 16, v76
    v_add_f32 v76, v76, v140
    v_mul_f32 v77, v77, v157
    v_cvt_pk_bf16_f32 v77, v77, v77
    v_lshlrev_b32 v77, 16, v77
    v_add_f32 v77, v77, v141
    v_mul_f32 v78, v78, v158
    v_cvt_pk_bf16_f32 v78, v78, v78
    v_lshlrev_b32 v78, 16, v78
    v_add_f32 v78, v78, v142
    v_mul_f32 v79, v79, v159
    v_cvt_pk_bf16_f32 v79, v79, v79
    v_lshlrev_b32 v79, 16, v79
    v_add_f32 v79, v79, v143
    v_cvt_pk_bf16_f32 v80, v64, v65
    v_cvt_pk_bf16_f32 v81, v66, v67
    v_cvt_pk_bf16_f32 v82, v68, v69
    v_cvt_pk_bf16_f32 v83, v70, v71
    v_cvt_pk_bf16_f32 v84, v72, v73
    v_cvt_pk_bf16_f32 v85, v74, v75
    v_cvt_pk_bf16_f32 v86, v76, v77
    v_cvt_pk_bf16_f32 v87, v78, v79
    s_lshr_b32 s45, s63, 5
    s_lshl_b32 s45, s45, 16
    s_and_b32 s46, s63, 31
    s_lshl_b32 s46, s46, 8
    s_add_u32 s45, s45, s46
    s_add_u32 s45, s45, 0xc00000
    s_add_u32 s46, s45, 32768
    buffer_store_dwordx4 v[80:83], v2, s[12:15], s45 offen sc1
    buffer_store_dwordx4 v[84:87], v2, s[12:15], s46 offen sc1
L_b_skip_150:
    s_waitcnt vmcnt(0)
    s_barrier
    s_cmp_lg_u32 s44, 0
    s_cbranch_scc1 L_pub_161
    v_mov_b32 v30, s62
    v_mov_b32 v31, 0
    s_mov_b64 exec, 1
    buffer_store_dword v30, v31, s[80:83], s65 offen
    buffer_store_dword v30, v31, s[84:87], s65 offen sc1
    s_mov_b64 exec, -1
L_pub_161:
    s_cmp_ge_u32 s41, 28
    s_cbranch_scc1 L_b_loop_149
    s_add_u32 s45, s64, 8192
    s_cmp_lg_u32 s44, 1
    s_cbranch_scc1 L_pw_162
    s_mov_b32 exec_hi, 0
    s_mov_b32 s70, 0
L_wp_163:
    buffer_load_dword v31, v5, s[12:15], s45 offen sc1
    s_add_u32 s70, s70, 1
    s_cmp_ge_u32 s70, 0x200000
    s_cbranch_scc1 L_w_done_96
L_wp_163_c:
    s_waitcnt vmcnt(0)
    v_cmp_gt_u32 vcc, s62, v31
    s_nop 1
    s_cbranch_vccz L_wp_163_ok
    s_sleep 1
    s_branch L_wp_163
L_wp_163_ok:
    s_mov_b64 exec, -1
L_pw_162:
    s_barrier
    s_mul_i32 s53, s50, 65536
    s_add_u32 s53, s53, s52
    s_lshl_b32 s54, s44, 13
    s_add_u32 s53, s53, s54
    s_mul_i32 s57, s50, 229376
    s_add_u32 s57, s57, s56
    s_lshl_b32 s45, s44, 11
    s_add_u32 s57, s57, s45
    s_add_u32 s55, s54, 65536
    s_mov_b32 s58, 0
    v_mov_b32 v13, v3
    v_add_u32 v14, 65536, v13
    v_xor_b32 v15, 64, v13
    v_xor_b32 v16, 64, v14
    s_mov_b32 s76, 0x20000000
    s_add_u32 s48, s53, 0
    s_add_u32 s49, s48, 4096
    s_add_u32 m0, s54, 0
    s_nop 0
    buffer_load_dwordx4 v6, s[12:15], s48 offen offset:0 sc1 lds
    s_add_u32 m0, s54, 1024
    s_nop 0
    buffer_load_dwordx4 v9, s[12:15], s48 offen offset:0 sc1 lds
    s_add_u32 m0, s54, 2048
    s_nop 0
    buffer_load_dwordx4 v6, s[12:15], s49 offen offset:0 sc1 lds
    s_add_u32 m0, s54, 3072
    s_nop 0
    buffer_load_dwordx4 v9, s[12:15], s49 offen offset:0 sc1 lds
    s_add_u32 m0, s54, 3968
    s_nop 0
    buffer_load_dwordx4 v6, s[12:15], s48 offen offset:128 sc1 lds
    s_add_u32 m0, s54, 4992
    s_nop 0
    buffer_load_dwordx4 v9, s[12:15], s48 offen offset:128 sc1 lds
    s_add_u32 m0, s54, 6016
    s_nop 0
    buffer_load_dwordx4 v6, s[12:15], s49 offen offset:128 sc1 lds
    s_add_u32 m0, s54, 7040
    s_nop 0
    buffer_load_dwordx4 v9, s[12:15], s49 offen offset:128 sc1 lds
    s_add_u32 s48, s53, 32768
    s_add_u32 s49, s48, 4096
    s_add_u32 s46, s54, 32768
    s_add_u32 m0, s46, 0
    s_nop 0
    buffer_load_dwordx4 v6, s[12:15], s48 offen offset:0 sc1 lds
    s_add_u32 m0, s46, 1024
    s_nop 0
    buffer_load_dwordx4 v9, s[12:15], s48 offen offset:0 sc1 lds
    s_add_u32 m0, s46, 2048
    s_nop 0
    buffer_load_dwordx4 v6, s[12:15], s49 offen offset:0 sc1 lds
    s_add_u32 m0, s46, 3072
    s_nop 0
    buffer_load_dwordx4 v9, s[12:15], s49 offen offset:0 sc1 lds
    s_add_u32 m0, s46, 3968
    s_nop 0
    buffer_load_dwordx4 v6, s[12:15], s48 offen offset:128 sc1 lds
    s_add_u32 m0, s46, 4992
    s_nop 0
    buffer_load_dwordx4 v9, s[12:15], s48 offen offset:128 sc1 lds
    s_add_u32 m0, s46, 6016
    s_nop 0
    buffer_load_dwordx4 v6, s[12:15], s49 offen offset:128 sc1 lds
    s_add_u32 m0, s46, 7040
    s_nop 0
    buffer_load_dwordx4 v9, s[12:15], s49 offen offset:128 sc1 lds
    s_cmp_eq_u32 s51, 1
    s_cbranch_scc1 L_e_one_165
    s_add_u32 s48, s53, 65536
    s_add_u32 s49, s48, 4096
    s_add_u32 m0, s55, 0
    s_nop 0
    buffer_load_dwordx4 v6, s[12:15], s48 offen offset:0 sc1 lds
    s_add_u32 m0, s55, 1024
    s_nop 0
    buffer_load_dwordx4 v9, s[12:15], s48 offen offset:0 sc1 lds
    s_add_u32 m0, s55, 2048
    s_nop 0
    buffer_load_dwordx4 v6, s[12:15], s49 offen offset:0 sc1 lds
    s_add_u32 m0, s55, 3072
    s_nop 0
    buffer_load_dwordx4 v9, s[12:15], s49 offen offset:0 sc1 lds
    s_add_u32 m0, s55, 3968
    s_nop 0
    buffer_load_dwordx4 v6, s[12:15], s48 offen offset:128 sc1 lds
    s_add_u32 m0, s55, 4992
    s_nop 0
    buffer_load_dwordx4 v9, s[12:15], s48 offen offset:128 sc1 lds
    s_add_u32 m0, s55, 6016
    s_nop 0
    buffer_load_dwordx4 v6, s[12:15], s49 offen offset:128 sc1 lds
    s_add_u32 m0, s55, 7040
    s_nop 0
    buffer_load_dwordx4 v9, s[12:15], s49 offen offset:128 sc1 lds
    s_waitcnt vmcnt(16)
    s_barrier
    ds_read_b128 v[32:35], v13 offset:0
    ds_read_b128 v[36:39], v13 offset:2048
    ds_read_b128 v[40:43], v15 offset:0
    ds_read_b128 v[44:47], v15 offset:2048
    s_add_u32 s48, s53, 98304
    s_add_u32 s46, s58, 1
    s_cmp_lt_u32 s46, s51
    s_cselect_b32 s48, s48, 0x20000000
    s_add_u32 s49, s48, 4096
    s_add_u32 s59, s55, 32768
L_e_loop_164:
    s_waitcnt lgkmcnt(2)
    v_mfma_f32_16x16x32_bf16 v[80:83], a[0:3], v[32:35], 0
    ds_read_b128 v[48:51], v13 offset:4096
    v_mul_f32 v240, v224, v224
    v_mfma_f32_16x16x32_bf16 v[84:87], a[4:7], v[32:35], 0
    ds_read_b128 v[52:55], v13 offset:6144
    v_mul_f32 v241, v225, v225
    v_mfma_f32_16x16x32_bf16 v[88:91], a[0:3], v[36:39], 0
    ds_read_b128 v[56:59], v15 offset:4096
    s_add_u32 m0, s59, 0
    v_mul_f32 v242, v226, v226
    v_mfma_f32_16x16x32_bf16 v[92:95], a[4:7], v[36:39], 0
    ds_read_b128 v[60:63], v15 offset:6144
    buffer_load_dwordx4 v6, s[12:15], s48 offen offset:0 sc1 lds
    s_waitcnt lgkmcnt(4)
    v_mfma_f32_16x16x32_bf16 v[80:83], a[8:11], v[40:43], v[80:83]
    ds_read_b128 v[32:35], v13 offset:8192
    v_mul_f32 v243, v227, v227
    v_mfma_f32_16x16x32_bf16 v[84:87], a[12:15], v[40:43], v[84:87]
    ds_read_b128 v[36:39], v13 offset:10240
    v_mul_f32 v244, v228, v228
    v_mfma_f32_16x16x32_bf16 v[88:91], a[8:11], v[44:47], v[88:91]
    s_add_u32 m0, s59, 1024
    v_mul_f32 v245, v229, v229
    v_mul_f32 v246, v230, v230
    v_mfma_f32_16x16x32_bf16 v[92:95], a[12:15], v[44:47], v[92:95]
    buffer_load_dwordx4 v9, s[12:15], s48 offen offset:0 sc1 lds
    s_waitcnt lgkmcnt(4)
    v_mfma_f32_16x16x32_bf16 v[80:83], a[16:19], v[48:51], v[80:83]
    ds_read_b128 v[40:43], v15 offset:8192
    v_mul_f32 v247, v231, v231
    v_mfma_f32_16x16x32_bf16 v[84:87], a[20:23], v[48:51], v[84:87]
    ds_read_b128 v[44:47], v15 offset:10240
    v_mul_f32 v248, v232, v232
    v_mfma_f32_16x16x32_bf16 v[88:91], a[16:19], v[52:55], v[88:91]
    s_add_u32 m0, s59, 2048
    v_mul_f32 v249, v233, v233
    v_mul_f32 v250, v234, v234
    v_mfma_f32_16x16x32_bf16 v[92:95], a[20:23], v[52:55], v[92:95]
    buffer_load_dwordx4 v6, s[12:15], s49 offen offset:0 sc1 lds
    s_waitcnt lgkmcnt(4)
    v_mfma_f32_16x16x32_bf16 v[80:83], a[24:27], v[56:59], v[80:83]
    ds_read_b128 v[48:51], v13 offset:12288
    v_mul_f32 v251, v235, v235
    v_mfma_f32_16x16x32_bf16 v[84:87], a[28:31], v[56:59], v[84:87]
    ds_read_b128 v[52:55], v13 offset:14336
    v_mul_f32 v252, v236, v236
    v_mfma_f32_16x16x32_bf16 v[88:91], a[24:27], v[60:63], v[88:91]
    s_add_u32 m0, s59, 3072
    v_mul_f32 v253, v237, v237
    v_mul_f32 v254, v238, v238
    v_mfma_f32_16x16x32_bf16 v[92:95], a[28:31], v[60:63], v[92:95]
    buffer_load_dwordx4 v9, s[12:15], s49 offen offset:0 sc1 lds
    s_waitcnt lgkmcnt(4)
    v_mfma_f32_16x16x32_bf16 v[80:83], a[32:35], v[32:35], v[80:83]
    ds_read_b128 v[56:59], v15 offset:12288
    v_mul_f32 v255, v239, v239
    v_mfma_f32_16x16x32_bf16 v[84:87], a[36:39], v[32:35], v[84:87]
    ds_read_b128 v[60:63], v15 offset:14336
    v_fma_f32 v240, v240, v104, v106
    v_mfma_f32_16x16x32_bf16 v[88:91], a[32:35], v[36:39], v[88:91]
    s_add_u32 m0, s59, 3968
    v_fma_f32 v241, v241, v105, v107
    v_fma_f32 v242, v242, v104, v106
    v_mfma_f32_16x16x32_bf16 v[92:95], a[36:39], v[36:39], v[92:95]
    buffer_load_dwordx4 v6, s[12:15], s48 offen offset:128 sc1 lds
    s_waitcnt lgkmcnt(4)
    v_mfma_f32_16x16x32_bf16 v[80:83], a[40:43], v[40:43], v[80:83]
    ds_read_b128 v[32:35], v13 offset:16384
    v_fma_f32 v243, v243, v105, v107
    v_mfma_f32_16x16x32_bf16 v[84:87], a[44:47], v[40:43], v[84:87]
    ds_read_b128 v[36:39], v13 offset:18432
    v_fma_f32 v244, v244, v104, v106
    v_mfma_f32_16x16x32_bf16 v[88:91], a[40:43], v[44:47], v[88:91]
    s_add_u32 m0, s59, 4992
    v_fma_f32 v245, v245, v105, v107
    v_fma_f32 v246, v246, v104, v106
    v_mfma_f32_16x16x32_bf16 v[92:95], a[44:47], v[44:47], v[92:95]
    buffer_load_dwordx4 v9, s[12:15], s48 offen offset:128 sc1 lds
    s_waitcnt lgkmcnt(4)
    v_mfma_f32_16x16x32_bf16 v[80:83], a[48:51], v[48:51], v[80:83]
    ds_read_b128 v[40:43], v15 offset:16384
    v_fma_f32 v247, v247, v105, v107
    v_mfma_f32_16x16x32_bf16 v[84:87], a[52:55], v[48:51], v[84:87]
    ds_read_b128 v[44:47], v15 offset:18432
    v_fma_f32 v248, v248, v104, v106
    v_mfma_f32_16x16x32_bf16 v[88:91], a[48:51], v[52:55], v[88:91]
    s_add_u32 m0, s59, 6016
    v_fma_f32 v249, v249, v105, v107
    v_fma_f32 v250, v250, v104, v106
    v_mfma_f32_16x16x32_bf16 v[92:95], a[52:55], v[52:55], v[92:95]
    buffer_load_dwordx4 v6, s[12:15], s49 offen offset:128 sc1 lds
    s_waitcnt lgkmcnt(4)
    v_mfma_f32_16x16x32_bf16 v[80:83], a[56:59], v[56:59], v[80:83]
    ds_read_b128 v[48:51], v13 offset:20480
    v_fma_f32 v251, v251, v105, v107
    v_mfma_f32_16x16x32_bf16 v[84:87], a[60:63], v[56:59], v[84:87]
    ds_read_b128 v[52:55], v13 offset:22528
    v_fma_f32 v252, v252, v104, v106
    v_mfma_f32_16x16x32_bf16 v[88:91], a[56:59], v[60:63], v[88:91]
    s_add_u32 m0, s59, 7040
    v_fma_f32 v253, v253, v105, v107
    v_fma_f32 v254, v254, v104, v106
    v_mfma_f32_16x16x32_bf16 v[92:95], a[60:63], v[60:63], v[92:95]
    buffer_load_dwordx4 v9, s[12:15], s49 offen offset:128 sc1 lds
    s_waitcnt lgkmcnt(4)
    v_mfma_f32_16x16x32_bf16 v[80:83], a[64:67], v[32:35], v[80:83]
    ds_read_b128 v[56:59], v15 offset:20480
    v_fma_f32 v255, v255, v105, v107
    v_mfma_f32_16x16x32_bf16 v[84:87], a[68:71], v[32:35], v[84:87]
    ds_read_b128 v[60:63], v15 offset:22528
    v_mul_f32 v240, v240, v224
    v_mfma_f32_16x16x32_bf16 v[88:91], a[64:67], v[36:39], v[88:91]
    s_add_u32 s48, s53, 131072
    v_mul_f32 v241, v241, v225
    v_mul_f32 v242, v242, v226
    v_mul_f32 v243, v243, v227
    v_mfma_f32_16x16x32_bf16 v[92:95], a[68:71], v[36:39], v[92:95]
    s_add_u32 s46, s58, 2
    v_mul_f32 v244, v244, v228
    s_waitcnt lgkmcnt(4)
    v_mfma_f32_16x16x32_bf16 v[80:83], a[72:75], v[40:43], v[80:83]
    ds_read_b128 v[32:35], v13 offset:24576
    v_mul_f32 v245, v245, v229
    v_mfma_f32_16x16x32_bf16 v[84:87], a[76:79], v[40:43], v[84:87]
    ds_read_b128 v[36:39], v13 offset:26624
    v_mul_f32 v246, v246, v230
    v_mfma_f32_16x16x32_bf16 v[88:91], a[72:75], v[44:47], v[88:91]
    s_cmp_lt_u32 s46, s51
    s_cselect_b32 s48, s48, 0x20000000
    v_mul_f32 v247, v247, v231
    v_mul_f32 v248, v248, v232
    v_mfma_f32_16x16x32_bf16 v[92:95], a[76:79], v[44:47], v[92:95]
    s_add_u32 s49, s48, 4096
    v_mul_f32 v249, v249, v233
    s_waitcnt lgkmcnt(4)
    v_mfma_f32_16x16x32_bf16 v[80:83], a[80:83], v[48:51], v[80:83]
    ds_read_b128 v[40:43], v15 offset:24576
    v_mul_f32 v250, v250, v234
    v_mfma_f32_16x16x32_bf16 v[84:87], a[84:87], v[48:51], v[84:87]
    ds_read_b128 v[44:47], v15 offset:26624
    v_mul_f32 v251, v251, v235
    v_mfma_f32_16x16x32_bf16 v[88:91], a[80:83], v[52:55], v[88:91]
    s_mov_b32 s59, s54
    v_mul_f32 v252, v252, v236
    v_mul_f32 v253, v253, v237
    v_mfma_f32_16x16x32_bf16 v[92:95], a[84:87], v[52:55], v[92:95]
    v_mul_f32 v254, v254, v238
    s_waitcnt lgkmcnt(4)
    v_mfma_f32_16x16x32_bf16 v[80:83], a[88:91], v[56:59], v[80:83]
    ds_read_b128 v[48:51], v13 offset:28672
    v_mul_f32 v255, v255, v239
    v_mfma_f32_16x16x32_bf16 v[84:87], a[92:95], v[56:59], v[84:87]
    ds_read_b128 v[52:55], v13 offset:30720
    v_exp_f32 v240, v240
    v_mfma_f32_16x16x32_bf16 v[88:91], a[88:91], v[60:63], v[88:91]
    v_exp_f32 v241, v241
    v_mfma_f32_16x16x32_bf16 v[92:95], a[92:95], v[60:63], v[92:95]
    v_exp_f32 v242, v242
    s_waitcnt lgkmcnt(4)
    v_mfma_f32_16x16x32_bf16 v[80:83], a[96:99], v[32:35], v[80:83]
    ds_read_b128 v[56:59], v15 offset:28672
    v_exp_f32 v243, v243
    v_mfma_f32_16x16x32_bf16 v[84:87], a[100:103], v[32:35], v[84:87]
    ds_read_b128 v[60:63], v15 offset:30720
    v_exp_f32 v244, v244
    v_mfma_f32_16x16x32_bf16 v[88:91], a[96:99], v[36:39], v[88:91]
    v_exp_f32 v245, v245
    v_mfma_f32_16x16x32_bf16 v[92:95], a[100:103], v[36:39], v[92:95]
    v_exp_f32 v246, v246
    s_waitcnt lgkmcnt(4)
    v_mfma_f32_16x16x32_bf16 v[80:83], a[104:107], v[40:43], v[80:83]
    v_exp_f32 v247, v247
    v_mfma_f32_16x16x32_bf16 v[84:87], a[108:111], v[40:43], v[84:87]
    v_exp_f32 v248, v248
    v_mfma_f32_16x16x32_bf16 v[88:91], a[104:107], v[44:47], v[88:91]
    v_exp_f32 v249, v249
    v_mfma_f32_16x16x32_bf16 v[92:95], a[108:111], v[44:47], v[92:95]
    v_exp_f32 v250, v250
    s_waitcnt vmcnt(16) lgkmcnt(0)
    s_barrier
    v_mfma_f32_16x16x32_bf16 v[80:83], a[112:115], v[48:51], v[80:83]
    ds_read_b128 v[32:35], v13 offset:32768
    v_exp_f32 v251, v251
    v_mfma_f32_16x16x32_bf16 v[84:87], a[116:119], v[48:51], v[84:87]
    ds_read_b128 v[36:39], v13 offset:34816
    v_exp_f32 v252, v252
    v_mfma_f32_16x16x32_bf16 v[88:91], a[112:115], v[52:55], v[88:91]
    v_exp_f32 v253, v253
    v_mfma_f32_16x16x32_bf16 v[92:95], a[116:119], v[52:55], v[92:95]
    v_exp_f32 v254, v254
    v_mfma_f32_16x16x32_bf16 v[80:83], a[120:123], v[56:59], v[80:83]
    ds_read_b128 v[40:43], v15 offset:32768
    v_exp_f32 v255, v255
    v_mfma_f32_16x16x32_bf16 v[84:87], a[124:127], v[56:59], v[84:87]
    ds_read_b128 v[44:47], v15 offset:34816
    v_add_f32 v240, 1.0, v240
    v_mfma_f32_16x16x32_bf16 v[88:91], a[120:123], v[60:63], v[88:91]
    v_add_f32 v241, 1.0, v241
    v_add_f32 v242, 1.0, v242
    v_mfma_f32_16x16x32_bf16 v[92:95], a[124:127], v[60:63], v[92:95]
    v_add_f32 v243, 1.0, v243
    s_waitcnt lgkmcnt(2)
    v_mfma_f32_16x16x32_bf16 v[80:83], a[128:131], v[32:35], v[80:83]
    ds_read_b128 v[48:51], v13 offset:36864
    v_add_f32 v244, 1.0, v244
    v_mfma_f32_16x16x32_bf16 v[84:87], a[132:135], v[32:35], v[84:87]
    ds_read_b128 v[52:55], v13 offset:38912
    v_add_f32 v245, 1.0, v245
    v_mfma_f32_16x16x32_bf16 v[88:91], a[128:131], v[36:39], v[88:91]
    ds_read_b128 v[56:59], v15 offset:36864
    s_add_u32 m0, s59, 0
    v_add_f32 v246, 1.0, v246
    v_mfma_f32_16x16x32_bf16 v[92:95], a[132:135], v[36:39], v[92:95]
    ds_read_b128 v[60:63], v15 offset:38912
    buffer_load_dwordx4 v6, s[12:15], s48 offen offset:0 sc1 lds
    s_waitcnt lgkmcnt(4)
    v_mfma_f32_16x16x32_bf16 v[80:83], a[136:139], v[40:43], v[80:83]
    ds_read_b128 v[32:35], v13 offset:40960
    v_add_f32 v247, 1.0, v247
    v_mfma_f32_16x16x32_bf16 v[84:87], a[140:143], v[40:43], v[84:87]
    ds_read_b128 v[36:39], v13 offset:43008
    v_add_f32 v248, 1.0, v248
    v_mfma_f32_16x16x32_bf16 v[88:91], a[136:139], v[44:47], v[88:91]
    s_add_u32 m0, s59, 1024
    v_add_f32 v249, 1.0, v249
    v_add_f32 v250, 1.0, v250
    v_mfma_f32_16x16x32_bf16 v[92:95], a[140:143], v[44:47], v[92:95]
    buffer_load_dwordx4 v9, s[12:15], s48 offen offset:0 sc1 lds
    s_waitcnt lgkmcnt(4)
    v_mfma_f32_16x16x32_bf16 v[80:83], a[144:147], v[48:51], v[80:83]
    ds_read_b128 v[40:43], v15 offset:40960
    v_add_f32 v251, 1.0, v251
    v_mfma_f32_16x16x32_bf16 v[84:87], a[148:151], v[48:51], v[84:87]
    ds_read_b128 v[44:47], v15 offset:43008
    v_add_f32 v252, 1.0, v252
    v_mfma_f32_16x16x32_bf16 v[88:91], a[144:147], v[52:55], v[88:91]
    s_add_u32 m0, s59, 2048
    v_add_f32 v253, 1.0, v253
    v_add_f32 v254, 1.0, v254
    v_mfma_f32_16x16x32_bf16 v[92:95], a[148:151], v[52:55], v[92:95]
    buffer_load_dwordx4 v6, s[12:15], s49 offen offset:0 sc1 lds
    s_waitcnt lgkmcnt(4)
    v_mfma_f32_16x16x32_bf16 v[80:83], a[152:155], v[56:59], v[80:83]
    ds_read_b128 v[48:51], v13 offset:45056
    v_add_f32 v255, 1.0, v255
    v_mfma_f32_16x16x32_bf16 v[84:87], a[156:159], v[56:59], v[84:87]
    ds_read_b128 v[52:55], v13 offset:47104
    v_rcp_f32 v240, v240
    v_mfma_f32_16x16x32_bf16 v[88:91], a[152:155], v[60:63], v[88:91]
    s_add_u32 m0, s59, 3072
    v_rcp_f32 v241, v241
    v_mfma_f32_16x16x32_bf16 v[92:95], a[156:159], v[60:63], v[92:95]
    buffer_load_dwordx4 v9, s[12:15], s49 offen offset:0 sc1 lds
    s_waitcnt lgkmcnt(4)
    v_mfma_f32_16x16x32_bf16 v[80:83], a[160:163], v[32:35], v[80:83]
    ds_read_b128 v[56:59], v15 offset:45056
    v_rcp_f32 v242, v242
    v_mfma_f32_16x16x32_bf16 v[84:87], a[164:167], v[32:35], v[84:87]
    ds_read_b128 v[60:63], v15 offset:47104
    v_rcp_f32 v243, v243
    v_mfma_f32_16x16x32_bf16 v[88:91], a[160:163], v[36:39], v[88:91]
    s_add_u32 m0, s59, 3968
    v_rcp_f32 v244, v244
    v_mfma_f32_16x16x32_bf16 v[92:95], a[164:167], v[36:39], v[92:95]
    buffer_load_dwordx4 v6, s[12:15], s48 offen offset:128 sc1 lds
    s_waitcnt lgkmcnt(4)
    v_mfma_f32_16x16x32_bf16 v[80:83], a[168:171], v[40:43], v[80:83]
    ds_read_b128 v[32:35], v13 offset:49152
    v_rcp_f32 v245, v245
    v_mfma_f32_16x16x32_bf16 v[84:87], a[172:175], v[40:43], v[84:87]
    ds_read_b128 v[36:39], v13 offset:51200
    v_rcp_f32 v246, v246
    v_mfma_f32_16x16x32_bf16 v[88:91], a[168:171], v[44:47], v[88:91]
    s_add_u32 m0, s59, 4992
    v_rcp_f32 v247, v247
    v_mfma_f32_16x16x32_bf16 v[92:95], a[172:175], v[44:47], v[92:95]
    buffer_load_dwordx4 v9, s[12:15], s48 offen offset:128 sc1 lds
    s_waitcnt lgkmcnt(4)
    v_mfma_f32_16x16x32_bf16 v[80:83], a[176:179], v[48:51], v[80:83]
    ds_read_b128 v[40:43], v15 offset:49152
    v_rcp_f32 v248, v248
    v_mfma_f32_16x16x32_bf16 v[84:87], a[180:183], v[48:51], v[84:87]
    ds_read_b128 v[44:47], v15 offset:51200
    v_rcp_f32 v249, v249
    v_mfma_f32_16x16x32_bf16 v[88:91], a[176:179], v[52:55], v[88:91]
    s_add_u32 m0, s59, 6016
    v_rcp_f32 v250, v250
    v_mfma_f32_16x16x32_bf16 v[92:95], a[180:183], v[52:55], v[92:95]
    buffer_load_dwordx4 v6, s[12:15], s49 offen offset:128 sc1 lds
    s_waitcnt lgkmcnt(4)
    v_mfma_f32_16x16x32_bf16 v[80:83], a[184:187], v[56:59], v[80:83]
    ds_read_b128 v[48:51], v13 offset:53248
    v_rcp_f32 v251, v251
    v_mfma_f32_16x16x32_bf16 v[84:87], a[188:191], v[56:59], v[84:87]
    ds_read_b128 v[52:55], v13 offset:55296
    v_mfma_f32_16x16x32_bf16 v[88:91], a[184:187], v[60:63], v[88:91]
    s_add_u32 m0, s59, 7040
    v_rcp_f32 v252, v252
    v_mfma_f32_16x16x32_bf16 v[92:95], a[188:191], v[60:63], v[92:95]
    buffer_load_dwordx4 v9, s[12:15], s49 offen offset:128 sc1 lds
    s_waitcnt lgkmcnt(4)
    v_mfma_f32_16x16x32_bf16 v[80:83], a[192:195], v[32:35], v[80:83]
    ds_read_b128 v[56:59], v15 offset:53248
    v_rcp_f32 v253, v253
    v_mfma_f32_16x16x32_bf16 v[84:87], a[196:199], v[32:35], v[84:87]
    ds_read_b128 v[60:63], v15 offset:55296
    v_mfma_f32_16x16x32_bf16 v[88:91], a[192:195], v[36:39], v[88:91]
    s_add_u32 s48, s53, 163840
    v_rcp_f32 v254, v254
    v_mfma_f32_16x16x32_bf16 v[92:95], a[196:199], v[36:39], v[92:95]
    s_add_u32 s46, s58, 2
    s_waitcnt lgkmcnt(4)
    v_mfma_f32_16x16x32_bf16 v[80:83], a[200:203], v[40:43], v[80:83]
    ds_read_b128 v[32:35], v13 offset:57344
    v_rcp_f32 v255, v255
    v_mfma_f32_16x16x32_bf16 v[84:87], a[204:207], v[40:43], v[84:87]
    ds_read_b128 v[36:39], v13 offset:59392
    v_mul_f32 v224, v224, v240
    v_mfma_f32_16x16x32_bf16 v[88:91], a[200:203], v[44:47], v[88:91]
    s_cmp_lt_u32 s46, s51
    s_cselect_b32 s48, s48, 0x20000000
    v_mul_f32 v225, v225, v241
    v_mul_f32 v226, v226, v242
    v_mfma_f32_16x16x32_bf16 v[92:95], a[204:207], v[44:47], v[92:95]
    s_add_u32 s49, s48, 4096
    v_mul_f32 v227, v227, v243
    s_waitcnt lgkmcnt(4)
    v_mfma_f32_16x16x32_bf16 v[80:83], a[208:211], v[48:51], v[80:83]
    ds_read_b128 v[40:43], v15 offset:57344
    v_mul_f32 v228, v228, v244
    v_mfma_f32_16x16x32_bf16 v[84:87], a[212:215], v[48:51], v[84:87]
    ds_read_b128 v[44:47], v15 offset:59392
    v_mul_f32 v229, v229, v245
    v_mfma_f32_16x16x32_bf16 v[88:91], a[208:211], v[52:55], v[88:91]
    s_add_u32 s59, s54, 32768
    v_mul_f32 v230, v230, v246
    v_mul_f32 v231, v231, v247
    v_mfma_f32_16x16x32_bf16 v[92:95], a[212:215], v[52:55], v[92:95]
    v_mul_f32 v232, v232, v248
    s_waitcnt lgkmcnt(4)
    v_mfma_f32_16x16x32_bf16 v[80:83], a[216:219], v[56:59], v[80:83]
    ds_read_b128 v[48:51], v13 offset:61440
    v_mul_f32 v233, v233, v249
    v_mfma_f32_16x16x32_bf16 v[84:87], a[220:223], v[56:59], v[84:87]
    ds_read_b128 v[52:55], v13 offset:63488
    v_mul_f32 v234, v234, v250
    v_mfma_f32_16x16x32_bf16 v[88:91], a[216:219], v[60:63], v[88:91]
    v_mul_f32 v235, v235, v251
    v_mul_f32 v236, v236, v252
    v_mfma_f32_16x16x32_bf16 v[92:95], a[220:223], v[60:63], v[92:95]
    v_mul_f32 v237, v237, v253
    s_waitcnt lgkmcnt(4)
    v_mfma_f32_16x16x32_bf16 v[80:83], a[224:227], v[32:35], v[80:83]
    ds_read_b128 v[56:59], v15 offset:61440
    v_mul_f32 v238, v238, v254
    v_mfma_f32_16x16x32_bf16 v[84:87], a[228:231], v[32:35], v[84:87]
    ds_read_b128 v[60:63], v15 offset:63488
    v_mul_f32 v239, v239, v255
    v_mfma_f32_16x16x32_bf16 v[88:91], a[224:227], v[36:39], v[88:91]
    v_cvt_pk_bf16_f32 v240, v224, v225
    v_cvt_pk_bf16_f32 v241, v226, v227
    v_mfma_f32_16x16x32_bf16 v[92:95], a[228:231], v[36:39], v[92:95]
    v_cvt_pk_bf16_f32 v242, v228, v229
    s_waitcnt lgkmcnt(4)
    v_mfma_f32_16x16x32_bf16 v[80:83], a[232:235], v[40:43], v[80:83]
    v_cvt_pk_bf16_f32 v243, v230, v231
    v_cvt_pk_bf16_f32 v244, v232, v233
    v_mfma_f32_16x16x32_bf16 v[84:87], a[236:239], v[40:43], v[84:87]
    v_cvt_pk_bf16_f32 v245, v234, v235
    v_cvt_pk_bf16_f32 v246, v236, v237
    v_mfma_f32_16x16x32_bf16 v[88:91], a[232:235], v[44:47], v[88:91]
    v_cvt_pk_bf16_f32 v247, v238, v239
    buffer_store_dwordx4 v[240:243], v10, s[12:15], s76 offen sc1
    v_mfma_f32_16x16x32_bf16 v[92:95], a[236:239], v[44:47], v[92:95]
    buffer_store_dwordx4 v[244:247], v10, s[12:15], s76 offen offset:1024 sc1
    s_waitcnt vmcnt(16) lgkmcnt(0)
    s_barrier
    v_mfma_f32_16x16x32_bf16 v[80:83], a[240:243], v[48:51], v[80:83]
    ds_read_b128 v[32:35], v14 offset:0
    v_mfma_f32_16x16x32_bf16 v[84:87], a[244:247], v[48:51], v[84:87]
    ds_read_b128 v[36:39], v14 offset:2048
    v_mfma_f32_16x16x32_bf16 v[88:91], a[240:243], v[52:55], v[88:91]
    v_mfma_f32_16x16x32_bf16 v[92:95], a[244:247], v[52:55], v[92:95]
    v_mfma_f32_16x16x32_bf16 v[80:83], a[248:251], v[56:59], v[80:83]
    ds_read_b128 v[40:43], v16 offset:0
    v_mfma_f32_16x16x32_bf16 v[84:87], a[252:255], v[56:59], v[84:87]
    ds_read_b128 v[44:47], v16 offset:2048
    v_mfma_f32_16x16x32_bf16 v[88:91], a[248:251], v[60:63], v[88:91]
    v_mfma_f32_16x16x32_bf16 v[92:95], a[252:255], v[60:63], v[92:95]
    s_add_u32 s53, s53, 65536
    s_add_u32 s58, s58, 1
    v_swap_b32 v13, v14
    s_xor_b32 s54, s54, 65536
    s_xor_b32 s55, s55, 65536
    s_mov_b32 s76, s57
    v_swap_b32 v15, v16
    s_add_u32 s57, s57, 229376
    v_pk_add_f32 v[224:225], v[80:81], v[96:97]
    v_pk_add_f32 v[226:227], v[82:83], v[98:99]
    v_pk_add_f32 v[228:229], v[84:85], v[100:101]
    v_pk_add_f32 v[230:231], v[86:87], v[102:103]
    v_pk_add_f32 v[232:233], v[88:89], v[96:97]
    v_pk_add_f32 v[234:235], v[90:91], v[98:99]
    v_pk_add_f32 v[236:237], v[92:93], v[100:101]
    v_pk_add_f32 v[238:239], v[94:95], v[102:103]
    s_cmp_lt_u32 s58, s51
    s_cbranch_scc1 L_e_loop_164
    s_branch L_e_fin_166
L_e_one_165:
    s_waitcnt vmcnt(8)
    s_barrier
    ds_read_b128 v[32:35], v13 offset:0
    ds_read_b128 v[36:39], v13 offset:2048
    ds_read_b128 v[40:43], v15 offset:0
    ds_read_b128 v[44:47], v15 offset:2048
    s_waitcnt lgkmcnt(2)
    v_mfma_f32_16x16x32_bf16 v[80:83], a[0:3], v[32:35], 0
    ds_read_b128 v[48:51], v13 offset:4096
    v_mfma_f32_16x16x32_bf16 v[84:87], a[4:7], v[32:35], 0
    ds_read_b128 v[52:55], v13 offset:6144
    v_mfma_f32_16x16x32_bf16 v[88:91], a[0:3], v[36:39], 0
    ds_read_b128 v[56:59], v15 offset:4096
    v_mfma_f32_16x16x32_bf16 v[92:95], a[4:7], v[36:39], 0
    ds_read_b128 v[60:63], v15 offset:6144
    s_waitcnt lgkmcnt(4)
    v_mfma_f32_16x16x32_bf16 v[80:83], a[8:11], v[40:43], v[80:83]
    ds_read_b128 v[32:35], v13 offset:8192
    v_mfma_f32_16x16x32_bf16 v[84:87], a[12:15], v[40:43], v[84:87]
    ds_read_b128 v[36:39], v13 offset:10240
    v_mfma_f32_16x16x32_bf16 v[88:91], a[8:11], v[44:47], v[88:91]
    v_mfma_f32_16x16x32_bf16 v[92:95], a[12:15], v[44:47], v[92:95]
    s_waitcnt lgkmcnt(4)
    v_mfma_f32_16x16x32_bf16 v[80:83], a[16:19], v[48:51], v[80:83]
    ds_read_b128 v[40:43], v15 offset:8192
    v_mfma_f32_16x16x32_bf16 v[84:87], a[20:23], v[48:51], v[84:87]
    ds_read_b128 v[44:47], v15 offset:10240
    v_mfma_f32_16x16x32_bf16 v[88:91], a[16:19], v[52:55], v[88:91]
    v_mfma_f32_16x16x32_bf16 v[92:95], a[20:23], v[52:55], v[92:95]
    s_waitcnt lgkmcnt(4)
    v_mfma_f32_16x16x32_bf16 v[80:83], a[24:27], v[56:59], v[80:83]
    ds_read_b128 v[48:51], v13 offset:12288
    v_mfma_f32_16x16x32_bf16 v[84:87], a[28:31], v[56:59], v[84:87]
    ds_read_b128 v[52:55], v13 offset:14336
    v_mfma_f32_16x16x32_bf16 v[88:91], a[24:27], v[60:63], v[88:91]
    v_mfma_f32_16x16x32_bf16 v[92:95], a[28:31], v[60:63], v[92:95]
    s_waitcnt lgkmcnt(4)
    v_mfma_f32_16x16x32_bf16 v[80:83], a[32:35], v[32:35], v[80:83]
    ds_read_b128 v[56:59], v15 offset:12288
    v_mfma_f32_16x16x32_bf16 v[84:87], a[36:39], v[32:35], v[84:87]
    ds_read_b128 v[60:63], v15 offset:14336
    v_mfma_f32_16x16x32_bf16 v[88:91], a[32:35], v[36:39], v[88:91]
    v_mfma_f32_16x16x32_bf16 v[92:95], a[36:39], v[36:39], v[92:95]
    s_waitcnt lgkmcnt(4)
    v_mfma_f32_16x16x32_bf16 v[80:83], a[40:43], v[40:43], v[80:83]
    ds_read_b128 v[32:35], v13 offset:16384
    v_mfma_f32_16x16x32_bf16 v[84:87], a[44:47], v[40:43], v[84:87]
    ds_read_b128 v[36:39], v13 offset:18432
    v_mfma_f32_16x16x32_bf16 v[88:91], a[40:43], v[44:47], v[88:91]
    v_mfma_f32_16x16x32_bf16 v[92:95], a[44:47], v[44:47], v[92:95]
    s_waitcnt lgkmcnt(4)
    v_mfma_f32_16x16x32_bf16 v[80:83], a[48:51], v[48:51], v[80:83]
    ds_read_b128 v[40:43], v15 offset:16384
    v_mfma_f32_16x16x32_bf16 v[84:87], a[52:55], v[48:51], v[84:87]
    ds_read_b128 v[44:47], v15 offset:18432
    v_mfma_f32_16x16x32_bf16 v[88:91], a[48:51], v[52:55], v[88:91]
    v_mfma_f32_16x16x32_bf16 v[92:95], a[52:55], v[52:55], v[92:95]
    s_waitcnt lgkmcnt(4)
    v_mfma_f32_16x16x32_bf16 v[80:83], a[56:59], v[56:59], v[80:83]
    ds_read_b128 v[48:51], v13 offset:20480
    v_mfma_f32_16x16x32_bf16 v[84:87], a[60:63], v[56:59], v[84:87]
    ds_read_b128 v[52:55], v13 offset:22528
    v_mfma_f32_16x16x32_bf16 v[88:91], a[56:59], v[60:63], v[88:91]
    v_mfma_f32_16x16x32_bf16 v[92:95], a[60:63], v[60:63], v[92:95]
    s_waitcnt lgkmcnt(4)
    v_mfma_f32_16x16x32_bf16 v[80:83], a[64:67], v[32:35], v[80:83]
    ds_read_b128 v[56:59], v15 offset:20480
    v_mfma_f32_16x16x32_bf16 v[84:87], a[68:71], v[32:35], v[84:87]
    ds_read_b128 v[60:63], v15 offset:22528
    v_mfma_f32_16x16x32_bf16 v[88:91], a[64:67], v[36:39], v[88:91]
    v_mfma_f32_16x16x32_bf16 v[92:95], a[68:71], v[36:39], v[92:95]
    s_waitcnt lgkmcnt(4)
    v_mfma_f32_16x16x32_bf16 v[80:83], a[72:75], v[40:43], v[80:83]
    ds_read_b128 v[32:35], v13 offset:24576
    v_mfma_f32_16x16x32_bf16 v[84:87], a[76:79], v[40:43], v[84:87]
    ds_read_b128 v[36:39], v13 offset:26624
    v_mfma_f32_16x16x32_bf16 v[88:91], a[72:75], v[44:47], v[88:91]
    v_mfma_f32_16x16x32_bf16 v[92:95], a[76:79], v[44:47], v[92:95]
    s_waitcnt lgkmcnt(4)
    v_mfma_f32_16x16x32_bf16 v[80:83], a[80:83], v[48:51], v[80:83]
    ds_read_b128 v[40:43], v15 offset:24576
    v_mfma_f32_16x16x32_bf16 v[84:87], a[84:87], v[48:51], v[84:87]
    ds_read_b128 v[44:47], v15 offset:26624
    v_mfma_f32_16x16x32_bf16 v[88:91], a[80:83], v[52:55], v[88:91]
    v_mfma_f32_16x16x32_bf16 v[92:95], a[84:87], v[52:55], v[92:95]
    s_waitcnt lgkmcnt(4)
    v_mfma_f32_16x16x32_bf16 v[80:83], a[88:91], v[56:59], v[80:83]
    ds_read_b128 v[48:51], v13 offset:28672
    v_mfma_f32_16x16x32_bf16 v[84:87], a[92:95], v[56:59], v[84:87]
    ds_read_b128 v[52:55], v13 offset:30720
    v_mfma_f32_16x16x32_bf16 v[88:91], a[88:91], v[60:63], v[88:91]
    v_mfma_f32_16x16x32_bf16 v[92:95], a[92:95], v[60:63], v[92:95]
    s_waitcnt lgkmcnt(4)
    v_mfma_f32_16x16x32_bf16 v[80:83], a[96:99], v[32:35], v[80:83]
    ds_read_b128 v[56:59], v15 offset:28672
    v_mfma_f32_16x16x32_bf16 v[84:87], a[100:103], v[32:35], v[84:87]
    ds_read_b128 v[60:63], v15 offset:30720
    v_mfma_f32_16x16x32_bf16 v[88:91], a[96:99], v[36:39], v[88:91]
    v_mfma_f32_16x16x32_bf16 v[92:95], a[100:103], v[36:39], v[92:95]
    s_waitcnt lgkmcnt(4)
    v_mfma_f32_16x16x32_bf16 v[80:83], a[104:107], v[40:43], v[80:83]
    v_mfma_f32_16x16x32_bf16 v[84:87], a[108:111], v[40:43], v[84:87]
    v_mfma_f32_16x16x32_bf16 v[88:91], a[104:107], v[44:47], v[88:91]
    v_mfma_f32_16x16x32_bf16 v[92:95], a[108:111], v[44:47], v[92:95]
    s_waitcnt vmcnt(0) lgkmcnt(0)
    s_barrier
    v_mfma_f32_16x16x32_bf16 v[80:83], a[112:115], v[48:51], v[80:83]
    ds_read_b128 v[32:35], v13 offset:32768
    v_mfma_f32_16x16x32_bf16 v[84:87], a[116:119], v[48:51], v[84:87]
    ds_read_b128 v[36:39], v13 offset:34816
    v_mfma_f32_16x16x32_bf16 v[88:91], a[112:115], v[52:55], v[88:91]
    v_mfma_f32_16x16x32_bf16 v[92:95], a[116:119], v[52:55], v[92:95]
    v_mfma_f32_16x16x32_bf16 v[80:83], a[120:123], v[56:59], v[80:83]
    ds_read_b128 v[40:43], v15 offset:32768
    v_mfma_f32_16x16x32_bf16 v[84:87], a[124:127], v[56:59], v[84:87]
    ds_read_b128 v[44:47], v15 offset:34816
    v_mfma_f32_16x16x32_bf16 v[88:91], a[120:123], v[60:63], v[88:91]
    v_mfma_f32_16x16x32_bf16 v[92:95], a[124:127], v[60:63], v[92:95]
    s_waitcnt lgkmcnt(2)
    v_mfma_f32_16x16x32_bf16 v[80:83], a[128:131], v[32:35], v[80:83]
    ds_read_b128 v[48:51], v13 offset:36864
    v_mfma_f32_16x16x32_bf16 v[84:87], a[132:135], v[32:35], v[84:87]
    ds_read_b128 v[52:55], v13 offset:38912
    v_mfma_f32_16x16x32_bf16 v[88:91], a[128:131], v[36:39], v[88:91]
    ds_read_b128 v[56:59], v15 offset:36864
    v_mfma_f32_16x16x32_bf16 v[92:95], a[132:135], v[36:39], v[92:95]
    ds_read_b128 v[60:63], v15 offset:38912
    s_waitcnt lgkmcnt(4)
    v_mfma_f32_16x16x32_bf16 v[80:83], a[136:139], v[40:43], v[80:83]
    ds_read_b128 v[32:35], v13 offset:40960
    v_mfma_f32_16x16x32_bf16 v[84:87], a[140:143], v[40:43], v[84:87]
    ds_read_b128 v[36:39], v13 offset:43008
    v_mfma_f32_16x16x32_bf16 v[88:91], a[136:139], v[44:47], v[88:91]
    v_mfma_f32_16x16x32_bf16 v[92:95], a[140:143], v[44:47], v[92:95]
    s_waitcnt lgkmcnt(4)
    v_mfma_f32_16x16x32_bf16 v[80:83], a[144:147], v[48:51], v[80:83]
    ds_read_b128 v[40:43], v15 offset:40960
    v_mfma_f32_16x16x32_bf16 v[84:87], a[148:151], v[48:51], v[84:87]
    ds_read_b128 v[44:47], v15 offset:43008
    v_mfma_f32_16x16x32_bf16 v[88:91], a[144:147], v[52:55], v[88:91]
    v_mfma_f32_16x16x32_bf16 v[92:95], a[148:151], v[52:55], v[92:95]
    s_waitcnt lgkmcnt(4)
    v_mfma_f32_16x16x32_bf16 v[80:83], a[152:155], v[56:59], v[80:83]
    ds_read_b128 v[48:51], v13 offset:45056
    v_mfma_f32_16x16x32_bf16 v[84:87], a[156:159], v[56:59], v[84:87]
    ds_read_b128 v[52:55], v13 offset:47104
    v_mfma_f32_16x16x32_bf16 v[88:91], a[152:155], v[60:63], v[88:91]
    v_mfma_f32_16x16x32_bf16 v[92:95], a[156:159], v[60:63], v[92:95]
    s_waitcnt lgkmcnt(4)
    v_mfma_f32_16x16x32_bf16 v[80:83], a[160:163], v[32:35], v[80:83]
    ds_read_b128 v[56:59], v15 offset:45056
    v_mfma_f32_16x16x32_bf16 v[84:87], a[164:167], v[32:35], v[84:87]
    ds_read_b128 v[60:63], v15 offset:47104
    v_mfma_f32_16x16x32_bf16 v[88:91], a[160:163], v[36:39], v[88:91]
    v_mfma_f32_16x16x32_bf16 v[92:95], a[164:167], v[36:39], v[92:95]
    s_waitcnt lgkmcnt(4)
    v_mfma_f32_16x16x32_bf16 v[80:83], a[168:171], v[40:43], v[80:83]
    ds_read_b128 v[32:35], v13 offset:49152
    v_mfma_f32_16x16x32_bf16 v[84:87], a[172:175], v[40:43], v[84:87]
    ds_read_b128 v[36:39], v13 offset:51200
    v_mfma_f32_16x16x32_bf16 v[88:91], a[168:171], v[44:47], v[88:91]
    v_mfma_f32_16x16x32_bf16 v[92:95], a[172:175], v[44:47], v[92:95]
    s_waitcnt lgkmcnt(4)
    v_mfma_f32_16x16x32_bf16 v[80:83], a[176:179], v[48:51], v[80:83]
    ds_read_b128 v[40:43], v15 offset:49152
    v_mfma_f32_16x16x32_bf16 v[84:87], a[180:183], v[48:51], v[84:87]
    ds_read_b128 v[44:47], v15 offset:51200
    v_mfma_f32_16x16x32_bf16 v[88:91], a[176:179], v[52:55], v[88:91]
    v_mfma_f32_16x16x32_bf16 v[92:95], a[180:183], v[52:55], v[92:95]
    s_waitcnt lgkmcnt(4)
    v_mfma_f32_16x16x32_bf16 v[80:83], a[184:187], v[56:59], v[80:83]
    ds_read_b128 v[48:51], v13 offset:53248
    v_mfma_f32_16x16x32_bf16 v[84:87], a[188:191], v[56:59], v[84:87]
    ds_read_b128 v[52:55], v13 offset:55296
    v_mfma_f32_16x16x32_bf16 v[88:91], a[184:187], v[60:63], v[88:91]
    v_mfma_f32_16x16x32_bf16 v[92:95], a[188:191], v[60:63], v[92:95]
    s_waitcnt lgkmcnt(4)
    v_mfma_f32_16x16x32_bf16 v[80:83], a[192:195], v[32:35], v[80:83]
    ds_read_b128 v[56:59], v15 offset:53248
    v_mfma_f32_16x16x32_bf16 v[84:87], a[196:199], v[32:35], v[84:87]
    ds_read_b128 v[60:63], v15 offset:55296
    v_mfma_f32_16x16x32_bf16 v[88:91], a[192:195], v[36:39], v[88:91]
    v_mfma_f32_16x16x32_bf16 v[92:95], a[196:199], v[36:39], v[92:95]
    s_waitcnt lgkmcnt(4)
    v_mfma_f32_16x16x32_bf16 v[80:83], a[200:203], v[40:43], v[80:83]
    ds_read_b128 v[32:35], v13 offset:57344
    v_mfma_f32_16x16x32_bf16 v[84:87], a[204:207], v[40:43], v[84:87]
    ds_read_b128 v[36:39], v13 offset:59392
    v_mfma_f32_16x16x32_bf16 v[88:91], a[200:203], v[44:47], v[88:91]
    v_mfma_f32_16x16x32_bf16 v[92:95], a[204:207], v[44:47], v[92:95]
    s_waitcnt lgkmcnt(4)
    v_mfma_f32_16x16x32_bf16 v[80:83], a[208:211], v[48:51], v[80:83]
    ds_read_b128 v[40:43], v15 offset:57344
    v_mfma_f32_16x16x32_bf16 v[84:87], a[212:215], v[48:51], v[84:87]
    ds_read_b128 v[44:47], v15 offset:59392
    v_mfma_f32_16x16x32_bf16 v[88:91], a[208:211], v[52:55], v[88:91]
    v_mfma_f32_16x16x32_bf16 v[92:95], a[212:215], v[52:55], v[92:95]
    s_waitcnt lgkmcnt(4)
    v_mfma_f32_16x16x32_bf16 v[80:83], a[216:219], v[56:59], v[80:83]
    ds_read_b128 v[48:51], v13 offset:61440
    v_mfma_f32_16x16x32_bf16 v[84:87], a[220:223], v[56:59], v[84:87]
    ds_read_b128 v[52:55], v13 offset:63488
    v_mfma_f32_16x16x32_bf16 v[88:91], a[216:219], v[60:63], v[88:91]
    v_mfma_f32_16x16x32_bf16 v[92:95], a[220:223], v[60:63], v[92:95]
    s_waitcnt lgkmcnt(4)
    v_mfma_f32_16x16x32_bf16 v[80:83], a[224:227], v[32:35], v[80:83]
    ds_read_b128 v[56:59], v15 offset:61440
    v_mfma_f32_16x16x32_bf16 v[84:87], a[228:231], v[32:35], v[84:87]
    ds_read_b128 v[60:63], v15 offset:63488
    v_mfma_f32_16x16x32_bf16 v[88:91], a[224:227], v[36:39], v[88:91]
    v_mfma_f32_16x16x32_bf16 v[92:95], a[228:231], v[36:39], v[92:95]
    s_waitcnt lgkmcnt(4)
    v_mfma_f32_16x16x32_bf16 v[80:83], a[232:235], v[40:43], v[80:83]
    v_mfma_f32_16x16x32_bf16 v[84:87], a[236:239], v[40:43], v[84:87]
    v_mfma_f32_16x16x32_bf16 v[88:91], a[232:235], v[44:47], v[88:91]
    v_mfma_f32_16x16x32_bf16 v[92:95], a[236:239], v[44:47], v[92:95]
    s_waitcnt lgkmcnt(0)
    v_mfma_f32_16x16x32_bf16 v[80:83], a[240:243], v[48:51], v[80:83]
    v_mfma_f32_16x16x32_bf16 v[84:87], a[244:247], v[48:51], v[84:87]
    v_mfma_f32_16x16x32_bf16 v[88:91], a[240:243], v[52:55], v[88:91]
    v_mfma_f32_16x16x32_bf16 v[92:95], a[244:247], v[52:55], v[92:95]
    v_mfma_f32_16x16x32_bf16 v[80:83], a[248:251], v[56:59], v[80:83]
    v_mfma_f32_16x16x32_bf16 v[84:87], a[252:255], v[56:59], v[84:87]
    v_mfma_f32_16x16x32_bf16 v[88:91], a[248:251], v[60:63], v[88:91]
    v_mfma_f32_16x16x32_bf16 v[92:95], a[252:255], v[60:63], v[92:95]
    s_mov_b32 s76, s57
    s_nop 6
    v_pk_add_f32 v[224:225], v[80:81], v[96:97]
    v_pk_add_f32 v[226:227], v[82:83], v[98:99]
    v_pk_add_f32 v[228:229], v[84:85], v[100:101]
    v_pk_add_f32 v[230:231], v[86:87], v[102:103]
    v_pk_add_f32 v[232:233], v[88:89], v[96:97]
    v_pk_add_f32 v[234:235], v[90:91], v[98:99]
    v_pk_add_f32 v[236:237], v[92:93], v[100:101]
    v_pk_add_f32 v[238:239], v[94:95], v[102:103]
L_e_fin_166:
    v_pk_mul_f32 v[240:241], v[224:225], v[224:225]
    v_pk_mul_f32 v[242:243], v[226:227], v[226:227]
    v_pk_mul_f32 v[244:245], v[228:229], v[228:229]
    v_pk_mul_f32 v[246:247], v[230:231], v[230:231]
    v_pk_mul_f32 v[248:249], v[232:233], v[232:233]
    v_pk_mul_f32 v[250:251], v[234:235], v[234:235]
    v_pk_mul_f32 v[252:253], v[236:237], v[236:237]
    v_pk_mul_f32 v[254:255], v[238:239], v[238:239]
    v_pk_fma_f32 v[240:241], v[240:241], v[104:105], v[106:107]
    v_pk_fma_f32 v[242:243], v[242:243], v[104:105], v[106:107]
    v_pk_fma_f32 v[244:245], v[244:245], v[104:105], v[106:107]
    v_pk_fma_f32 v[246:247], v[246:247], v[104:105], v[106:107]
    v_pk_fma_f32 v[248:249], v[248:249], v[104:105], v[106:107]
    v_pk_fma_f32 v[250:251], v[250:251], v[104:105], v[106:107]
    v_pk_fma_f32 v[252:253], v[252:253], v[104:105], v[106:107]
    v_pk_fma_f32 v[254:255], v[254:255], v[104:105], v[106:107]
    v_pk_mul_f32 v[240:241], v[240:241], v[224:225]
    v_pk_mul_f32 v[242:243], v[242:243], v[226:227]
    v_pk_mul_f32 v[244:245], v[244:245], v[228:229]
    v_pk_mul_f32 v[246:247], v[246:247], v[230:231]
    v_pk_mul_f32 v[248:249], v[248:249], v[232:233]
    v_pk_mul_f32 v[250:251], v[250:251], v[234:235]
    v_pk_mul_f32 v[252:253], v[252:253], v[236:237]
    v_pk_mul_f32 v[254:255], v[254:255], v[238:239]
    v_exp_f32 v240, v240
    v_exp_f32 v241, v241
    v_exp_f32 v242, v242
    v_exp_f32 v243, v243
    v_exp_f32 v244, v244
    v_exp_f32 v245, v245
    v_exp_f32 v246, v246
    v_exp_f32 v247, v247
    v_exp_f32 v248, v248
    v_exp_f32 v249, v249
    v_exp_f32 v250, v250
    v_exp_f32 v251, v251
    v_exp_f32 v252, v252
    v_exp_f32 v253, v253
    v_exp_f32 v254, v254
    v_exp_f32 v255, v255
    v_add_f32 v240, 1.0, v240
    v_add_f32 v241, 1.0, v241
    v_add_f32 v242, 1.0, v242
    v_add_f32 v243, 1.0, v243
    v_add_f32 v244, 1.0, v244
    v_add_f32 v245, 1.0, v245
    v_add_f32 v246, 1.0, v246
    v_add_f32 v247, 1.0, v247
    v_add_f32 v248, 1.0, v248
    v_add_f32 v249, 1.0, v249
    v_add_f32 v250, 1.0, v250
    v_add_f32 v251, 1.0, v251
    v_add_f32 v252, 1.0, v252
    v_add_f32 v253, 1.0, v253
    v_add_f32 v254, 1.0, v254
    v_add_f32 v255, 1.0, v255
    v_rcp_f32 v240, v240
    v_rcp_f32 v241, v241
    v_rcp_f32 v242, v242
    v_rcp_f32 v243, v243
    v_rcp_f32 v244, v244
    v_rcp_f32 v245, v245
    v_rcp_f32 v246, v246
    v_rcp_f32 v247, v247
    v_rcp_f32 v248, v248
    v_rcp_f32 v249, v249
    v_rcp_f32 v250, v250
    v_rcp_f32 v251, v251
    v_rcp_f32 v252, v252
    v_rcp_f32 v253, v253
    v_rcp_f32 v254, v254
    v_rcp_f32 v255, v255
    v_pk_mul_f32 v[224:225], v[224:225], v[240:241]
    v_pk_mul_f32 v[226:227], v[226:227], v[242:243]
    v_pk_mul_f32 v[228:229], v[228:229], v[244:245]
    v_pk_mul_f32 v[230:231], v[230:231], v[246:247]
    v_pk_mul_f32 v[232:233], v[232:233], v[248:249]
    v_pk_mul_f32 v[234:235], v[234:235], v[250:251]
    v_pk_mul_f32 v[236:237], v[236:237], v[252:253]
    v_pk_mul_f32 v[238:239], v[238:239], v[254:255]
    v_cvt_pk_bf16_f32 v240, v224, v225
    v_cvt_pk_bf16_f32 v241, v226, v227
    v_cvt_pk_bf16_f32 v242, v228, v229
    v_cvt_pk_bf16_f32 v243, v230, v231
    v_cvt_pk_bf16_f32 v244, v232, v233
    v_cvt_pk_bf16_f32 v245, v234, v235
    v_cvt_pk_bf16_f32 v246, v236, v237
    v_cvt_pk_bf16_f32 v247, v238, v239
    buffer_store_dwordx4 v[240:243], v10, s[12:15], s76 offen sc1
    buffer_store_dwordx4 v[244:247], v10, s[12:15], s76 offen offset:1024 sc1
    s_waitcnt lgkmcnt(0)
    s_mov_b32 s92, s62
    s_branch L_b_loop_149
L_role_c_125:
    s_load_dwordx2 s[6:7], s[0:1], 80
    s_load_dwordx2 s[8:9], s[0:1], 88
    s_load_dwordx2 s[10:11], s[0:1], 112
    s_waitcnt lgkmcnt(0)
    s_mov_b32 s24, s6
    s_and_b32 s25, s7, 0xffff
    s_mov_b32 s26, 0x700000
    s_mov_b32 s27, 0x00020000
    s_mov_b32 s28, s8
    s_and_b32 s29, s9, 0xffff
    s_mov_b32 s30, 0x800
    s_mov_b32 s31, 0x00020000
    s_mov_b32 s32, s10
    s_and_b32 s33, s11, 0xffff
    s_mov_b32 s34, 0x400000
    s_mov_b32 s35, 0x00020000
    s_mul_i32 s46, s38, 1835008
    s_lshl_b32 s45, s68, 8
    s_add_u32 s46, s46, s45
    s_waitcnt vmcnt(0)
    s_barrier
    v_lshrrev_b32 v20, 4, v1
    s_lshl_b32 s45, s44, 2
    v_add_u32 v21, s45, v20
    s_mov_b32 s45, 2048
    v_mul_lo_u32 v21, v21, s45
    v_lshlrev_b32 v22, 2, v20
    v_and_b32 v23, 15, v1
    v_xor_b32 v22, v22, v23
    v_lshlrev_b32 v22, 4, v22
    v_add_u32 v21, v21, v22
    v_bfe_u32 v22, v1, 2, 2
    v_lshlrev_b32 v23, 3, v20
    v_add_u32 v23, v23, v22
    v_lshlrev_b32 v23, 8, v23
    v_xor_b32 v22, s44, v22
    v_lshlrev_b32 v22, 6, v22
    v_add_u32 v23, v23, v22
    v_and_b32 v22, 3, v1
    v_lshlrev_b32 v22, 3, v22
    v_add_u32 v23, v23, v22
    v_add_u32 v24, 65536, v23
    v_add_u32 v25, 131072, v23
    s_lshl_b32 s47, s44, 10
    s_add_u32 s45, s46, 0x0
    s_add_u32 m0, s47, 0
    s_nop 0
    buffer_load_dwordx4 v21, s[24:27], s45 offen  lds
    s_add_u32 s45, s46, 0x8000
    s_add_u32 m0, s47, 4096
    s_nop 0
    buffer_load_dwordx4 v21, s[24:27], s45 offen  lds
    s_add_u32 s45, s46, 0x10000
    s_add_u32 m0, s47, 8192
    s_nop 0
    buffer_load_dwordx4 v21, s[24:27], s45 offen  lds
    s_add_u32 s45, s46, 0x18000
    s_add_u32 m0, s47, 12288
    s_nop 0
    buffer_load_dwordx4 v21, s[24:27], s45 offen  lds
    s_add_u32 s45, s46, 0x20000
    s_add_u32 m0, s47, 16384
    s_nop 0
    buffer_load_dwordx4 v21, s[24:27], s45 offen  lds
    s_add_u32 s45, s46, 0x28000
    s_add_u32 m0, s47, 20480
    s_nop 0
    buffer_load_dwordx4 v21, s[24:27], s45 offen  lds
    s_add_u32 s45, s46, 0x30000
    s_add_u32 m0, s47, 24576
    s_nop 0
    buffer_load_dwordx4 v21, s[24:27], s45 offen  lds
    s_add_u32 s45, s46, 0x38000
    s_add_u32 m0, s47, 28672
    s_nop 0
    buffer_load_dwordx4 v21, s[24:27], s45 offen  lds
    s_add_u32 s45, s46, 0x40000
    s_add_u32 m0, s47, 32768
    s_nop 0
    buffer_load_dwordx4 v21, s[24:27], s45 offen  lds
    s_add_u32 s45, s46, 0x48000
    s_add_u32 m0, s47, 36864
    s_nop 0
    buffer_load_dwordx4 v21, s[24:27], s45 offen  lds
    s_add_u32 s45, s46, 0x50000
    s_add_u32 m0, s47, 40960
    s_nop 0
    buffer_load_dwordx4 v21, s[24:27], s45 offen  lds
    s_add_u32 s45, s46, 0x58000
    s_add_u32 m0, s47, 45056
    s_nop 0
    buffer_load_dwordx4 v21, s[24:27], s45 offen  lds
    s_add_u32 s45, s46, 0x60000
    s_add_u32 m0, s47, 49152
    s_nop 0
    buffer_load_dwordx4 v21, s[24:27], s45 offen  lds
    s_add_u32 s45, s46, 0x68000
    s_add_u32 m0, s47, 53248
    s_nop 0
    buffer_load_dwordx4 v21, s[24:27], s45 offen  lds
    s_add_u32 s45, s46, 0x70000
    s_add_u32 m0, s47, 57344
    s_nop 0
    buffer_load_dwordx4 v21, s[24:27], s45 offen  lds
    s_add_u32 s45, s46, 0x78000
    s_add_u32 m0, s47, 61440
    s_nop 0
    buffer_load_dwordx4 v21, s[24:27], s45 offen  lds
    s_add_u32 s45, s46, 0x80000
    s_add_u32 m0, s47, 65536
    s_nop 0
    buffer_load_dwordx4 v21, s[24:27], s45 offen  lds
    s_add_u32 s45, s46, 0x88000
    s_add_u32 m0, s47, 69632
    s_nop 0
    buffer_load_dwordx4 v21, s[24:27], s45 offen  lds
    s_add_u32 s45, s46, 0x90000
    s_add_u32 m0, s47, 73728
    s_nop 0
    buffer_load_dwordx4 v21, s[24:27], s45 offen  lds
    s_add_u32 s45, s46, 0x98000
    s_add_u32 m0, s47, 77824
    s_nop 0
    buffer_load_dwordx4 v21, s[24:27], s45 offen  lds
    s_add_u32 s45, s46, 0xa0000
    s_add_u32 m0, s47, 81920
    s_nop 0
    buffer_load_dwordx4 v21, s[24:27], s45 offen  lds
    s_add_u32 s45, s46, 0xa8000
    s_add_u32 m0, s47, 86016
    s_nop 0
    buffer_load_dwordx4 v21, s[24:27], s45 offen  lds
    s_add_u32 s45, s46, 0xb0000
    s_add_u32 m0, s47, 90112
    s_nop 0
    buffer_load_dwordx4 v21, s[24:27], s45 offen  lds
    s_add_u32 s45, s46, 0xb8000
    s_add_u32 m0, s47, 94208
    s_nop 0
    buffer_load_dwordx4 v21, s[24:27], s45 offen  lds
    s_add_u32 s45, s46, 0xc0000
    s_add_u32 m0, s47, 98304
    s_nop 0
    buffer_load_dwordx4 v21, s[24:27], s45 offen  lds
    s_add_u32 s45, s46, 0xc8000
    s_add_u32 m0, s47, 102400
    s_nop 0
    buffer_load_dwordx4 v21, s[24:27], s45 offen  lds
    s_add_u32 s45, s46, 0xd0000
    s_add_u32 m0, s47, 106496
    s_nop 0
    buffer_load_dwordx4 v21, s[24:27], s45 offen  lds
    s_add_u32 s45, s46, 0xd8000
    s_add_u32 m0, s47, 110592
    s_nop 0
    buffer_load_dwordx4 v21, s[24:27], s45 offen  lds
    s_add_u32 s45, s46, 0xe0000
    s_add_u32 m0, s47, 114688
    s_nop 0
    buffer_load_dwordx4 v21, s[24:27], s45 offen  lds
    s_add_u32 s45, s46, 0xe8000
    s_add_u32 m0, s47, 118784
    s_nop 0
    buffer_load_dwordx4 v21, s[24:27], s45 offen  lds
    s_add_u32 s45, s46, 0xf0000
    s_add_u32 m0, s47, 122880
    s_nop 0
    buffer_load_dwordx4 v21, s[24:27], s45 offen  lds
    s_add_u32 s45, s46, 0xf8000
    s_add_u32 m0, s47, 126976
    s_nop 0
    buffer_load_dwordx4 v21, s[24:27], s45 offen  lds
    s_waitcnt vmcnt(28)
    s_barrier
    s_add_u32 s45, s46, 0x100000
    s_add_u32 m0, s47, 131072
    s_nop 0
    buffer_load_dwordx4 v21, s[24:27], s45 offen  lds
    s_add_u32 s45, s46, 0x108000
    s_add_u32 m0, s47, 135168
    s_nop 0
    buffer_load_dwordx4 v21, s[24:27], s45 offen  lds
    s_add_u32 s45, s46, 0x110000
    s_add_u32 m0, s47, 139264
    s_nop 0
    buffer_load_dwordx4 v21, s[24:27], s45 offen  lds
    s_add_u32 s45, s46, 0x118000
    s_add_u32 m0, s47, 143360
    s_nop 0
    buffer_load_dwordx4 v21, s[24:27], s45 offen  lds
    ds_read_b64_tr_b16 a[0:1], v23 offset:0
    ds_read_b64_tr_b16 a[2:3], v23 offset:1024
    ds_read_b64_tr_b16 a[4:5], v23 offset:32
    ds_read_b64_tr_b16 a[6:7], v23 offset:1056
    ds_read_b64_tr_b16 a[8:9], v23 offset:8192
    ds_read_b64_tr_b16 a[10:11], v23 offset:9216
    ds_read_b64_tr_b16 a[12:13], v23 offset:8224
    ds_read_b64_tr_b16 a[14:15], v23 offset:9248
    s_waitcnt lgkmcnt(0)
    s_waitcnt vmcnt(28)
    s_barrier
    s_add_u32 s45, s46, 0x120000
    s_add_u32 m0, s47, 0
    s_nop 0
    buffer_load_dwordx4 v21, s[24:27], s45 offen  lds
    s_add_u32 s45, s46, 0x128000
    s_add_u32 m0, s47, 4096
    s_nop 0
    buffer_load_dwordx4 v21, s[24:27], s45 offen  lds
    s_add_u32 s45, s46, 0x130000
    s_add_u32 m0, s47, 8192
    s_nop 0
    buffer_load_dwordx4 v21, s[24:27], s45 offen  lds
    s_add_u32 s45, s46, 0x138000
    s_add_u32 m0, s47, 12288
    s_nop 0
    buffer_load_dwordx4 v21, s[24:27], s45 offen  lds
    ds_read_b64_tr_b16 a[16:17], v23 offset:16384
    ds_read_b64_tr_b16 a[18:19], v23 offset:17408
    ds_read_b64_tr_b16 a[20:21], v23 offset:16416
    ds_read_b64_tr_b16 a[22:23], v23 offset:17440
    ds_read_b64_tr_b16 a[24:25], v23 offset:24576
    ds_read_b64_tr_b16 a[26:27], v23 offset:25600
    ds_read_b64_tr_b16 a[28:29], v23 offset:24608
    ds_read_b64_tr_b16 a[30:31], v23 offset:25632
    s_waitcnt lgkmcnt(0)
    s_waitcnt vmcnt(28)
    s_barrier
    s_add_u32 s45, s46, 0x140000
    s_add_u32 m0, s47, 16384
    s_nop 0
    buffer_load_dwordx4 v21, s[24:27], s45 offen  lds
    s_add_u32 s45, s46, 0x148000
    s_add_u32 m0, s47, 20480
    s_nop 0
    buffer_load_dwordx4 v21, s[24:27], s45 offen  lds
    s_add_u32 s45, s46, 0x150000
    s_add_u32 m0, s47, 24576
    s_nop 0
    buffer_load_dwordx4 v21, s[24:27], s45 offen  lds
    s_add_u32 s45, s46, 0x158000
    s_add_u32 m0, s47, 28672
    s_nop 0
    buffer_load_dwordx4 v21, s[24:27], s45 offen  lds
    ds_read_b64_tr_b16 a[32:33], v23 offset:32768
    ds_read_b64_tr_b16 a[34:35], v23 offset:33792
    ds_read_b64_tr_b16 a[36:37], v23 offset:32800
    ds_read_b64_tr_b16 a[38:39], v23 offset:33824
    ds_read_b64_tr_b16 a[40:41], v23 offset:40960
    ds_read_b64_tr_b16 a[42:43], v23 offset:41984
    ds_read_b64_tr_b16 a[44:45], v23 offset:40992
    ds_read_b64_tr_b16 a[46:47], v23 offset:42016
    s_waitcnt lgkmcnt(0)
    s_waitcnt vmcnt(28)
    s_barrier
    s_add_u32 s45, s46, 0x160000
    s_add_u32 m0, s47, 32768
    s_nop 0
    buffer_load_dwordx4 v21, s[24:27], s45 offen  lds
    s_add_u32 s45, s46, 0x168000
    s_add_u32 m0, s47, 36864
    s_nop 0
    buffer_load_dwordx4 v21, s[24:27], s45 offen  lds
    s_add_u32 s45, s46, 0x170000
    s_add_u32 m0, s47, 40960
    s_nop 0
    buffer_load_dwordx4 v21, s[24:27], s45 offen  lds
    s_add_u32 s45, s46, 0x178000
    s_add_u32 m0, s47, 45056
    s_nop 0
    buffer_load_dwordx4 v21, s[24:27], s45 offen  lds
    ds_read_b64_tr_b16 a[48:49], v23 offset:49152
    ds_read_b64_tr_b16 a[50:51], v23 offset:50176
    ds_read_b64_tr_b16 a[52:53], v23 offset:49184
    ds_read_b64_tr_b16 a[54:55], v23 offset:50208
    ds_read_b64_tr_b16 a[56:57], v23 offset:57344
    ds_read_b64_tr_b16 a[58:59], v23 offset:58368
    ds_read_b64_tr_b16 a[60:61], v23 offset:57376
    ds_read_b64_tr_b16 a[62:63], v23 offset:58400
    s_waitcnt lgkmcnt(0)
    s_waitcnt vmcnt(28)
    s_barrier
    s_add_u32 s45, s46, 0x180000
    s_add_u32 m0, s47, 49152
    s_nop 0
    buffer_load_dwordx4 v21, s[24:27], s45 offen  lds
    s_add_u32 s45, s46, 0x188000
    s_add_u32 m0, s47, 53248
    s_nop 0
    buffer_load_dwordx4 v21, s[24:27], s45 offen  lds
    s_add_u32 s45, s46, 0x190000
    s_add_u32 m0, s47, 57344
    s_nop 0
    buffer_load_dwordx4 v21, s[24:27], s45 offen  lds
    s_add_u32 s45, s46, 0x198000
    s_add_u32 m0, s47, 61440
    s_nop 0
    buffer_load_dwordx4 v21, s[24:27], s45 offen  lds
    ds_read_b64_tr_b16 a[64:65], v24 offset:0
    ds_read_b64_tr_b16 a[66:67], v24 offset:1024
    ds_read_b64_tr_b16 a[68:69], v24 offset:32
    ds_read_b64_tr_b16 a[70:71], v24 offset:1056
    ds_read_b64_tr_b16 a[72:73], v24 offset:8192
    ds_read_b64_tr_b16 a[74:75], v24 offset:9216
    ds_read_b64_tr_b16 a[76:77], v24 offset:8224
    ds_read_b64_tr_b16 a[78:79], v24 offset:9248
    s_waitcnt lgkmcnt(0)
    s_waitcnt vmcnt(28)
    s_barrier
    s_add_u32 s45, s46, 0x1a0000
    s_add_u32 m0, s47, 65536
    s_nop 0
    buffer_load_dwordx4 v21, s[24:27], s45 offen  lds
    s_add_u32 s45, s46, 0x1a8000
    s_add_u32 m0, s47, 69632
    s_nop 0
    buffer_load_dwordx4 v21, s[24:27], s45 offen  lds
    s_add_u32 s45, s46, 0x1b0000
    s_add_u32 m0, s47, 73728
    s_nop 0
    buffer_load_dwordx4 v21, s[24:27], s45 offen  lds
    s_add_u32 s45, s46, 0x1b8000
    s_add_u32 m0, s47, 77824
    s_nop 0
    buffer_load_dwordx4 v21, s[24:27], s45 offen  lds
    ds_read_b64_tr_b16 a[80:81], v24 offset:16384
    ds_read_b64_tr_b16 a[82:83], v24 offset:17408
    ds_read_b64_tr_b16 a[84:85], v24 offset:16416
    ds_read_b64_tr_b16 a[86:87], v24 offset:17440
    ds_read_b64_tr_b16 a[88:89], v24 offset:24576
    ds_read_b64_tr_b16 a[90:91], v24 offset:25600
    ds_read_b64_tr_b16 a[92:93], v24 offset:24608
    ds_read_b64_tr_b16 a[94:95], v24 offset:25632
    s_waitcnt lgkmcnt(0)
    s_waitcnt vmcnt(28)
    s_barrier
    ds_read_b64_tr_b16 a[96:97], v24 offset:32768
    ds_read_b64_tr_b16 a[98:99], v24 offset:33792
    ds_read_b64_tr_b16 a[100:101], v24 offset:32800
    ds_read_b64_tr_b16 a[102:103], v24 offset:33824
    ds_read_b64_tr_b16 a[104:105], v24 offset:40960
    ds_read_b64_tr_b16 a[106:107], v24 offset:41984
    ds_read_b64_tr_b16 a[108:109], v24 offset:40992
    ds_read_b64_tr_b16 a[110:111], v24 offset:42016
    s_waitcnt lgkmcnt(0)
    s_waitcnt vmcnt(24)
    s_barrier
    ds_read_b64_tr_b16 a[112:113], v24 offset:49152
    ds_read_b64_tr_b16 a[114:115], v24 offset:50176
    ds_read_b64_tr_b16 a[116:117], v24 offset:49184
    ds_read_b64_tr_b16 a[118:119], v24 offset:50208
    ds_read_b64_tr_b16 a[120:121], v24 offset:57344
    ds_read_b64_tr_b16 a[122:123], v24 offset:58368
    ds_read_b64_tr_b16 a[124:125], v24 offset:57376
    ds_read_b64_tr_b16 a[126:127], v24 offset:58400
    s_waitcnt lgkmcnt(0)
    s_waitcnt vmcnt(20)
    s_barrier
    ds_read_b64_tr_b16 a[128:129], v25 offset:0
    ds_read_b64_tr_b16 a[130:131], v25 offset:1024
    ds_read_b64_tr_b16 a[132:133], v25 offset:32
    ds_read_b64_tr_b16 a[134:135], v25 offset:1056
    ds_read_b64_tr_b16 a[136:137], v25 offset:8192
    ds_read_b64_tr_b16 a[138:139], v25 offset:9216
    ds_read_b64_tr_b16 a[140:141], v25 offset:8224
    ds_read_b64_tr_b16 a[142:143], v25 offset:9248
    s_waitcnt lgkmcnt(0)
    s_waitcnt vmcnt(16)
    s_barrier
    ds_read_b64_tr_b16 a[144:145], v23 offset:0
    ds_read_b64_tr_b16 a[146:147], v23 offset:1024
    ds_read_b64_tr_b16 a[148:149], v23 offset:32
    ds_read_b64_tr_b16 a[150:151], v23 offset:1056
    ds_read_b64_tr_b16 a[152:153], v23 offset:8192
    ds_read_b64_tr_b16 a[154:155], v23 offset:9216
    ds_read_b64_tr_b16 a[156:157], v23 offset:8224
    ds_read_b64_tr_b16 a[158:159], v23 offset:9248
    s_waitcnt lgkmcnt(0)
    s_waitcnt vmcnt(12)
    s_barrier
    ds_read_b64_tr_b16 a[160:161], v23 offset:16384
    ds_read_b64_tr_b16 a[162:163], v23 offset:17408
    ds_read_b64_tr_b16 a[164:165], v23 offset:16416
    ds_read_b64_tr_b16 a[166:167], v23 offset:17440
    ds_read_b64_tr_b16 a[168:169], v23 offset:24576
    ds_read_b64_tr_b16 a[170:171], v23 offset:25600
    ds_read_b64_tr_b16 a[172:173], v23 offset:24608
    ds_read_b64_tr_b16 a[174:175], v23 offset:25632
    s_waitcnt lgkmcnt(0)
    s_waitcnt vmcnt(8)
    s_barrier
    ds_read_b64_tr_b16 a[176:177], v23 offset:32768
    ds_read_b64_tr_b16 a[178:179], v23 offset:33792
    ds_read_b64_tr_b16 a[180:181], v23 offset:32800
    ds_read_b64_tr_b16 a[182:183], v23 offset:33824
    ds_read_b64_tr_b16 a[184:185], v23 offset:40960
    ds_read_b64_tr_b16 a[186:187], v23 offset:41984
    ds_read_b64_tr_b16 a[188:189], v23 offset:40992
    ds_read_b64_tr_b16 a[190:191], v23 offset:42016
    s_waitcnt lgkmcnt(0)
    s_waitcnt vmcnt(4)
    s_barrier
    ds_read_b64_tr_b16 a[192:193], v23 offset:49152
    ds_read_b64_tr_b16 a[194:195], v23 offset:50176
    ds_read_b64_tr_b16 a[196:197], v23 offset:49184
    ds_read_b64_tr_b16 a[198:199], v23 offset:50208
    ds_read_b64_tr_b16 a[200:201], v23 offset:57344
    ds_read_b64_tr_b16 a[202:203], v23 offset:58368
    ds_read_b64_tr_b16 a[204:205], v23 offset:57376
    ds_read_b64_tr_b16 a[206:207], v23 offset:58400
    s_waitcnt lgkmcnt(0)
    s_waitcnt vmcnt(0)
    s_barrier
    ds_read_b64_tr_b16 a[208:209], v24 offset:0
    ds_read_b64_tr_b16 a[210:211], v24 offset:1024
    ds_read_b64_tr_b16 a[212:213], v24 offset:32
    ds_read_b64_tr_b16 a[214:215], v24 offset:1056
    ds_read_b64_tr_b16 a[216:217], v24 offset:8192
    ds_read_b64_tr_b16 a[218:219], v24 offset:9216
    ds_read_b64_tr_b16 a[220:221], v24 offset:8224
    ds_read_b64_tr_b16 a[222:223], v24 offset:9248
    s_waitcnt lgkmcnt(0)
    s_barrier
    buffer_load_dwordx4 v[80:83], v10, s[28:31], 0 offen
    buffer_load_dwordx4 v[84:87], v10, s[28:31], 0 offen offset:1024
    s_waitcnt vmcnt(0)
    v_lshlrev_b32 v96, 16, v80
    v_and_b32 v97, 0xffff0000, v80
    v_lshlrev_b32 v98, 16, v81
    v_and_b32 v99, 0xffff0000, v81
    v_lshlrev_b32 v100, 16, v82
    v_and_b32 v101, 0xffff0000, v82
    v_lshlrev_b32 v102, 16, v83
    v_and_b32 v103, 0xffff0000, v83
    v_lshlrev_b32 v104, 16, v84
    v_and_b32 v105, 0xffff0000, v84
    v_lshlrev_b32 v106, 16, v85
    v_and_b32 v107, 0xffff0000, v85
    v_lshlrev_b32 v108, 16, v86
    v_and_b32 v109, 0xffff0000, v86
    v_lshlrev_b32 v110, 16, v87
    v_and_b32 v111, 0xffff0000, v87
    s_cmp_lg_u32 s44, 0
    s_cbranch_scc1 L_pd_167
    v_mov_b32 v29, 127232
    s_mov_b32 s46, 96
    s_mov_b64 exec, 1
    s_mov_b32 s70, 0
L_wp_168:
    buffer_load_dword v31, v29, s[12:15], 0 offen sc1
    s_add_u32 s70, s70, 1
    s_cmp_ge_u32 s70, 0x200000
    s_cbranch_scc1 L_w_done_96
L_wp_168_c:
    s_waitcnt vmcnt(0)
    v_cmp_gt_u32 vcc, s46, v31
    s_nop 1
    s_cbranch_vccz L_wp_168_ok
    s_sleep 3
    s_branch L_wp_168
L_wp_168_ok:
    s_mov_b64 exec, -1
L_pd_167:
    s_barrier
    v_lshlrev_b32 v29, 5, v1
    s_mov_b32 s45, 20480
    buffer_load_dwordx4 v[112:115], v29, s[12:15], s45 offen offset:0 sc1
    buffer_load_dwordx4 v[116:119], v29, s[12:15], s45 offen offset:16 sc1
    buffer_load_dwordx4 v[120:123], v29, s[12:15], s45 offen offset:2048 sc1
    buffer_load_dwordx4 v[124:127], v29, s[12:15], s45 offen offset:2064 sc1
    s_mov_b32 s45, 45056
    buffer_load_dwordx4 v[32:35], v29, s[12:15], s45 offen offset:0 sc1
    buffer_load_dwordx4 v[36:39], v29, s[12:15], s45 offen offset:16 sc1
    buffer_load_dwordx4 v[40:43], v29, s[12:15], s45 offen offset:2048 sc1
    buffer_load_dwordx4 v[44:47], v29, s[12:15], s45 offen offset:2064 sc1
    s_waitcnt vmcnt(0)
    v_add_f32 v112, v112, v32
    v_cvt_pk_bf16_f32 v112, v112, v112
    v_lshlrev_b32 v112, 16, v112
    v_add_f32 v113, v113, v33
    v_cvt_pk_bf16_f32 v113, v113, v113
    v_lshlrev_b32 v113, 16, v113
    v_add_f32 v114, v114, v34
    v_cvt_pk_bf16_f32 v114, v114, v114
    v_lshlrev_b32 v114, 16, v114
    v_add_f32 v115, v115, v35
    v_cvt_pk_bf16_f32 v115, v115, v115
    v_lshlrev_b32 v115, 16, v115
    v_add_f32 v116, v116, v36
    v_cvt_pk_bf16_f32 v116, v116, v116
    v_lshlrev_b32 v116, 16, v116
    v_add_f32 v117, v117, v37
    v_cvt_pk_bf16_f32 v117, v117, v117
    v_lshlrev_b32 v117, 16, v117
    v_add_f32 v118, v118, v38
    v_cvt_pk_bf16_f32 v118, v118, v118
    v_lshlrev_b32 v118, 16, v118
    v_add_f32 v119, v119, v39
    v_cvt_pk_bf16_f32 v119, v119, v119
    v_lshlrev_b32 v119, 16, v119
    v_add_f32 v120, v120, v40
    v_cvt_pk_bf16_f32 v120, v120, v120
    v_lshlrev_b32 v120, 16, v120
    v_add_f32 v121, v121, v41
    v_cvt_pk_bf16_f32 v121, v121, v121
    v_lshlrev_b32 v121, 16, v121
    v_add_f32 v122, v122, v42
    v_cvt_pk_bf16_f32 v122, v122, v122
    v_lshlrev_b32 v122, 16, v122
    v_add_f32 v123, v123, v43
    v_cvt_pk_bf16_f32 v123, v123, v123
    v_lshlrev_b32 v123, 16, v123
    v_add_f32 v124, v124, v44
    v_cvt_pk_bf16_f32 v124, v124, v124
    v_lshlrev_b32 v124, 16, v124
    v_add_f32 v125, v125, v45
    v_cvt_pk_bf16_f32 v125, v125, v125
    v_lshlrev_b32 v125, 16, v125
    v_add_f32 v126, v126, v46
    v_cvt_pk_bf16_f32 v126, v126, v126
    v_lshlrev_b32 v126, 16, v126
    v_add_f32 v127, v127, v47
    v_cvt_pk_bf16_f32 v127, v127, v127
    v_lshlrev_b32 v127, 16, v127
    s_lshl_b32 s46, s44, 10
    s_add_u32 s45, s46, 20480
    buffer_load_dwordx4 v[22:25], v10, s[12:15], s45 offen sc1
    s_add_u32 s45, s46, 45056
    buffer_load_dwordx4 v[32:35], v10, s[12:15], s45 offen sc1
    s_waitcnt vmcnt(0)
    v_add_f32 v22, v22, v32
    v_cvt_pk_bf16_f32 v22, v22, v22
    v_lshlrev_b32 v22, 16, v22
    v_add_f32 v23, v23, v33
    v_cvt_pk_bf16_f32 v23, v23, v23
    v_lshlrev_b32 v23, 16, v23
    v_add_f32 v24, v24, v34
    v_cvt_pk_bf16_f32 v24, v24, v24
    v_lshlrev_b32 v24, 16, v24
    v_add_f32 v25, v25, v35
    v_cvt_pk_bf16_f32 v25, v25, v25
    v_lshlrev_b32 v25, 16, v25
    v_lshlrev_b32 v17, 3, v1
    s_lshl_b32 s45, s44, 9
    buffer_load_dwordx2 v[80:81], v17, s[28:31], s45 offen
    s_waitcnt vmcnt(0)
    v_lshlrev_b32 v18, 16, v80
    v_and_b32 v19, 0xffff0000, v80
    v_lshlrev_b32 v20, 16, v81
    v_and_b32 v21, 0xffff0000, v81
    s_mul_i32 s52, s38, 57344
    s_add_u32 s52, s52, 0x6000000
    s_lshl_b32 s56, s38, 23
    s_lshl_b32 s45, s68, 9
    s_add_u32 s56, s56, s45
    s_add_u32 s56, s56, 0xc000000
    s_lshl_b32 s45, s40, 7
    s_add_u32 s45, s45, 127488
    v_mov_b32 v29, s45
    s_mov_b32 s46, 536870912
    s_mov_b64 exec, 1
    s_mov_b32 s70, 0
L_wp_171:
    buffer_load_dword v31, v29, s[12:15], 0 offen sc1
    s_add_u32 s70, s70, 1
    s_cmp_ge_u32 s70, 0x200000
    s_cbranch_scc1 L_w_done_96
L_wp_171_c:
    s_waitcnt vmcnt(0)
    v_cmp_gt_u32 vcc, s46, v31
    s_nop 1
    s_cbranch_vccz L_wp_171_ok
    s_sleep 2
    s_branch L_wp_171
L_wp_171_ok:
    s_mov_b64 exec, -1
    v_readfirstlane_b32 s45, v31
    s_nop 3
    s_and_b32 s46, s45, 511
    s_mul_i32 s46, s46, s46
    s_bfe_u32 s45, s45, 0xf0009
    s_lshl_b32 s45, s45, 5
    s_mov_b32 s80, s12
    s_mov_b32 s81, s13
    s_mov_b32 s83, 0x00020000
    s_mov_b32 s84, s12
    s_mov_b32 s85, s13
    s_mov_b32 s87, 0x00020000
    s_cmp_eq_u32 s45, s46
    s_cselect_b32 s82, s14, 0
    s_cselect_b32 s86, 0, s14
L_c_loop_169:
    s_cmp_eq_u64 s[36:37], 0
    s_cbranch_scc1 L_w_done_96
    s_ff1_i32_b64 s50, s[36:37]
    s_bitset0_b64 s[36:37], s50
    s_lshr_b64 s[74:75], s[72:73], s50
    s_ff1_i32_b64 s51, s[74:75]
    s_add_u32 s51, s51, 1
    s_add_u32 s62, s50, s51
    s_mul_i32 s45, s38, 896
    s_add_u32 s45, s45, s64
    s_add_u32 s45, s45, 12288
    s_cmp_lg_u32 s44, 1
    s_cbranch_scc1 L_pw_172
    s_mov_b64 exec, 127
    s_mov_b32 s70, 0
L_wp_173:
    buffer_load_dword v31, v5, s[12:15], s45 offen sc1
    s_add_u32 s70, s70, 1
    s_cmp_ge_u32 s70, 0x200000
    s_cbranch_scc1 L_w_done_96
L_wp_173_c:
    s_waitcnt vmcnt(0)
    v_cmp_gt_u32 vcc, s62, v31
    s_nop 1
    s_cbranch_vccz L_wp_173_ok
    s_sleep 2
    s_branch L_wp_173
L_wp_173_ok:
    s_mov_b64 exec, -1
L_pw_172:
    s_barrier
    s_mul_i32 s53, s50, 229376
    s_add_u32 s53, s53, s52
    s_lshl_b32 s54, s44, 13
    s_add_u32 s53, s53, s54
    s_mul_i32 s57, s50, 131072
    s_add_u32 s57, s57, s56
    s_lshl_b32 s45, s44, 7
    s_add_u32 s57, s57, s45
    s_add_u32 s55, s54, 65536
    s_mov_b32 s58, 0
    v_mov_b32 v13, v10
    v_add_u32 v14, 65536, v13
    v_xor_b32 v15, 64, v13
    v_xor_b32 v16, 64, v14
    s_mov_b32 s76, 0x20000000
    s_add_u32 s48, s53, 0
    s_add_u32 s49, s48, 4096
    s_add_u32 m0, s54, 0
    s_nop 0
    buffer_load_dwordx4 v10, s[12:15], s48 offen offset:0 sc1 lds
    buffer_load_dwordx4 v10, s[12:15], s48 offen offset:1024 sc1 lds
    buffer_load_dwordx4 v10, s[12:15], s48 offen offset:2048 sc1 lds
    buffer_load_dwordx4 v10, s[12:15], s48 offen offset:3072 sc1 lds
    s_add_u32 m0, s54, 4096
    s_nop 0
    buffer_load_dwordx4 v10, s[12:15], s49 offen offset:0 sc1 lds
    buffer_load_dwordx4 v10, s[12:15], s49 offen offset:1024 sc1 lds
    buffer_load_dwordx4 v10, s[12:15], s49 offen offset:2048 sc1 lds
    buffer_load_dwordx4 v10, s[12:15], s49 offen offset:3072 sc1 lds
    s_add_u32 s48, s53, 32768
    s_cmp_lt_u32 s44, 3
    s_cselect_b32 s48, s48, 0x20000000
    s_add_u32 s49, s48, 4096
    s_add_u32 s46, s54, 32768
    s_add_u32 m0, s46, 0
    s_nop 0
    buffer_load_dwordx4 v10, s[12:15], s48 offen offset:0 sc1 lds
    buffer_load_dwordx4 v10, s[12:15], s48 offen offset:1024 sc1 lds
    buffer_load_dwordx4 v10, s[12:15], s48 offen offset:2048 sc1 lds
    buffer_load_dwordx4 v10, s[12:15], s48 offen offset:3072 sc1 lds
    s_add_u32 m0, s46, 4096
    s_nop 0
    buffer_load_dwordx4 v10, s[12:15], s49 offen offset:0 sc1 lds
    buffer_load_dwordx4 v10, s[12:15], s49 offen offset:1024 sc1 lds
    buffer_load_dwordx4 v10, s[12:15], s49 offen offset:2048 sc1 lds
    buffer_load_dwordx4 v10, s[12:15], s49 offen offset:3072 sc1 lds
    s_cmp_eq_u32 s51, 1
    s_cbranch_scc1 L_e_one_175
    s_add_u32 s48, s53, 229376
    s_add_u32 s49, s48, 4096
    s_add_u32 m0, s55, 0
    s_nop 0
    buffer_load_dwordx4 v10, s[12:15], s48 offen offset:0 sc1 lds
    buffer_load_dwordx4 v10, s[12:15], s48 offen offset:1024 sc1 lds
    buffer_load_dwordx4 v10, s[12:15], s48 offen offset:2048 sc1 lds
    buffer_load_dwordx4 v10, s[12:15], s48 offen offset:3072 sc1 lds
    s_add_u32 m0, s55, 4096
    s_nop 0
    buffer_load_dwordx4 v10, s[12:15], s49 offen offset:0 sc1 lds
    buffer_load_dwordx4 v10, s[12:15], s49 offen offset:1024 sc1 lds
    buffer_load_dwordx4 v10, s[12:15], s49 offen offset:2048 sc1 lds
    buffer_load_dwordx4 v10, s[12:15], s49 offen offset:3072 sc1 lds
    s_waitcnt vmcnt(16)
    s_barrier
    ds_read_b128 v[32:35], v13 offset:0
    ds_read_b128 v[36:39], v13 offset:1024
    ds_read_b128 v[40:43], v13 offset:2048
    ds_read_b128 v[44:47], v13 offset:3072
    s_add_u32 s48, s53, 262144
    s_add_u32 s46, s58, 1
    s_cmp_lt_u32 s46, s51
    s_cselect_b32 s48, s48, 0x20000000
    s_cmp_lt_u32 s44, 3
    s_cselect_b32 s48, s48, 0x20000000
    s_add_u32 s49, s48, 4096
    s_add_u32 s59, s55, 32768
L_e_loop_174:
    s_waitcnt lgkmcnt(2)
    v_mfma_f32_16x16x32_bf16 v[80:83], a[0:3], v[32:35], 0
    ds_read_b128 v[48:51], v13 offset:4096
    v_mfma_f32_16x16x32_bf16 v[84:87], a[4:7], v[32:35], 0
    ds_read_b128 v[52:55], v13 offset:5120
    v_mfma_f32_16x16x32_bf16 v[88:91], a[0:3], v[36:39], 0
    ds_read_b128 v[56:59], v13 offset:6144
    s_add_u32 m0, s59, 0
    v_mfma_f32_16x16x32_bf16 v[92:95], a[4:7], v[36:39], 0
    ds_read_b128 v[60:63], v13 offset:7168
    buffer_load_dwordx4 v10, s[12:15], s48 offen offset:0 sc1 lds
    s_waitcnt lgkmcnt(4)
    v_mfma_f32_16x16x32_bf16 v[80:83], a[8:11], v[40:43], v[80:83]
    ds_read_b128 v[32:35], v13 offset:8192
    v_mfma_f32_16x16x32_bf16 v[84:87], a[12:15], v[40:43], v[84:87]
    ds_read_b128 v[36:39], v13 offset:9216
    v_mfma_f32_16x16x32_bf16 v[88:91], a[8:11], v[44:47], v[88:91]
    v_mfma_f32_16x16x32_bf16 v[92:95], a[12:15], v[44:47], v[92:95]
    buffer_load_dwordx4 v10, s[12:15], s48 offen offset:1024 sc1 lds
    s_waitcnt lgkmcnt(4)
    v_mfma_f32_16x16x32_bf16 v[80:83], a[16:19], v[48:51], v[80:83]
    ds_read_b128 v[40:43], v13 offset:10240
    v_mfma_f32_16x16x32_bf16 v[84:87], a[20:23], v[48:51], v[84:87]
    ds_read_b128 v[44:47], v13 offset:11264
    v_mfma_f32_16x16x32_bf16 v[88:91], a[16:19], v[52:55], v[88:91]
    v_mfma_f32_16x16x32_bf16 v[92:95], a[20:23], v[52:55], v[92:95]
    buffer_load_dwordx4 v10, s[12:15], s48 offen offset:2048 sc1 lds
    s_waitcnt lgkmcnt(4)
    v_mfma_f32_16x16x32_bf16 v[80:83], a[24:27], v[56:59], v[80:83]
    ds_read_b128 v[48:51], v13 offset:12288
    v_mfma_f32_16x16x32_bf16 v[84:87], a[28:31], v[56:59], v[84:87]
    ds_read_b128 v[52:55], v13 offset:13312
    v_mfma_f32_16x16x32_bf16 v[88:91], a[24:27], v[60:63], v[88:91]
    v_mfma_f32_16x16x32_bf16 v[92:95], a[28:31], v[60:63], v[92:95]
    buffer_load_dwordx4 v10, s[12:15], s48 offen offset:3072 sc1 lds
    s_waitcnt lgkmcnt(4)
    v_mfma_f32_16x16x32_bf16 v[80:83], a[32:35], v[32:35], v[80:83]
    ds_read_b128 v[56:59], v13 offset:14336
    v_mfma_f32_16x16x32_bf16 v[84:87], a[36:39], v[32:35], v[84:87]
    ds_read_b128 v[60:63], v13 offset:15360
    v_mfma_f32_16x16x32_bf16 v[88:91], a[32:35], v[36:39], v[88:91]
    s_add_u32 m0, s59, 4096
    v_mfma_f32_16x16x32_bf16 v[92:95], a[36:39], v[36:39], v[92:95]
    buffer_load_dwordx4 v10, s[12:15], s49 offen offset:0 sc1 lds
    s_waitcnt lgkmcnt(4)
    v_mfma_f32_16x16x32_bf16 v[80:83], a[40:43], v[40:43], v[80:83]
    ds_read_b128 v[32:35], v13 offset:16384
    v_mfma_f32_16x16x32_bf16 v[84:87], a[44:47], v[40:43], v[84:87]
    ds_read_b128 v[36:39], v13 offset:17408
    v_mfma_f32_16x16x32_bf16 v[88:91], a[40:43], v[44:47], v[88:91]
    v_mfma_f32_16x16x32_bf16 v[92:95], a[44:47], v[44:47], v[92:95]
    buffer_load_dwordx4 v10, s[12:15], s49 offen offset:1024 sc1 lds
    s_waitcnt lgkmcnt(4)
    v_mfma_f32_16x16x32_bf16 v[80:83], a[48:51], v[48:51], v[80:83]
    ds_read_b128 v[40:43], v13 offset:18432
    v_mfma_f32_16x16x32_bf16 v[84:87], a[52:55], v[48:51], v[84:87]
    ds_read_b128 v[44:47], v13 offset:19456
    v_mfma_f32_16x16x32_bf16 v[88:91], a[48:51], v[52:55], v[88:91]
    v_mfma_f32_16x16x32_bf16 v[92:95], a[52:55], v[52:55], v[92:95]
    buffer_load_dwordx4 v10, s[12:15], s49 offen offset:2048 sc1 lds
    s_waitcnt lgkmcnt(4)
    v_mfma_f32_16x16x32_bf16 v[80:83], a[56:59], v[56:59], v[80:83]
    ds_read_b128 v[48:51], v13 offset:20480
    v_mfma_f32_16x16x32_bf16 v[84:87], a[60:63], v[56:59], v[84:87]
    ds_read_b128 v[52:55], v13 offset:21504
    v_mfma_f32_16x16x32_bf16 v[88:91], a[56:59], v[60:63], v[88:91]
    v_mfma_f32_16x16x32_bf16 v[92:95], a[60:63], v[60:63], v[92:95]
    buffer_load_dwordx4 v10, s[12:15], s49 offen offset:3072 sc1 lds
    s_waitcnt lgkmcnt(4)
    v_mfma_f32_16x16x32_bf16 v[80:83], a[64:67], v[32:35], v[80:83]
    ds_read_b128 v[56:59], v13 offset:22528
    v_mfma_f32_16x16x32_bf16 v[84:87], a[68:71], v[32:35], v[84:87]
    ds_read_b128 v[60:63], v13 offset:23552
    v_mfma_f32_16x16x32_bf16 v[88:91], a[64:67], v[36:39], v[88:91]
    s_add_u32 s48, s53, 458752
    v_mfma_f32_16x16x32_bf16 v[92:95], a[68:71], v[36:39], v[92:95]
    s_add_u32 s46, s58, 2
    s_waitcnt lgkmcnt(4)
    v_mfma_f32_16x16x32_bf16 v[80:83], a[72:75], v[40:43], v[80:83]
    ds_read_b128 v[32:35], v13 offset:24576
    v_mfma_f32_16x16x32_bf16 v[84:87], a[76:79], v[40:43], v[84:87]
    ds_read_b128 v[36:39], v13 offset:25600
    v_mfma_f32_16x16x32_bf16 v[88:91], a[72:75], v[44:47], v[88:91]
    s_cmp_lt_u32 s46, s51
    s_cselect_b32 s48, s48, 0x20000000
    v_mfma_f32_16x16x32_bf16 v[92:95], a[76:79], v[44:47], v[92:95]
    s_add_u32 s49, s48, 4096
    s_waitcnt lgkmcnt(4)
    v_mfma_f32_16x16x32_bf16 v[80:83], a[80:83], v[48:51], v[80:83]
    ds_read_b128 v[40:43], v13 offset:26624
    v_mfma_f32_16x16x32_bf16 v[84:87], a[84:87], v[48:51], v[84:87]
    ds_read_b128 v[44:47], v13 offset:27648
    v_mfma_f32_16x16x32_bf16 v[88:91], a[80:83], v[52:55], v[88:91]
    s_mov_b32 s59, s54
    v_mfma_f32_16x16x32_bf16 v[92:95], a[84:87], v[52:55], v[92:95]
    s_waitcnt lgkmcnt(4)
    v_mfma_f32_16x16x32_bf16 v[80:83], a[88:91], v[56:59], v[80:83]
    ds_read_b128 v[48:51], v13 offset:28672
    v_mfma_f32_16x16x32_bf16 v[84:87], a[92:95], v[56:59], v[84:87]
    ds_read_b128 v[52:55], v13 offset:29696
    v_mfma_f32_16x16x32_bf16 v[88:91], a[88:91], v[60:63], v[88:91]
    v_mfma_f32_16x16x32_bf16 v[92:95], a[92:95], v[60:63], v[92:95]
    s_waitcnt lgkmcnt(4)
    v_mfma_f32_16x16x32_bf16 v[80:83], a[96:99], v[32:35], v[80:83]
    ds_read_b128 v[56:59], v13 offset:30720
    v_mfma_f32_16x16x32_bf16 v[84:87], a[100:103], v[32:35], v[84:87]
    ds_read_b128 v[60:63], v13 offset:31744
    v_mfma_f32_16x16x32_bf16 v[88:91], a[96:99], v[36:39], v[88:91]
    v_mfma_f32_16x16x32_bf16 v[92:95], a[100:103], v[36:39], v[92:95]
    s_waitcnt lgkmcnt(4)
    v_mfma_f32_16x16x32_bf16 v[80:83], a[104:107], v[40:43], v[80:83]
    ds_read_b128 v[216:219], v8 offset:0
    v_mfma_f32_16x16x32_bf16 v[84:87], a[108:111], v[40:43], v[84:87]
    ds_read_b128 v[220:223], v8 offset:1152
    v_mfma_f32_16x16x32_bf16 v[88:91], a[104:107], v[44:47], v[88:91]
    ds_read_b128 v[224:227], v8 offset:2304
    v_mfma_f32_16x16x32_bf16 v[92:95], a[108:111], v[44:47], v[92:95]
    ds_read_b128 v[228:231], v8 offset:3456
    s_waitcnt vmcnt(16) lgkmcnt(0)
    s_barrier
    v_mfma_f32_16x16x32_bf16 v[80:83], a[112:115], v[48:51], v[80:83]
    ds_read_b128 v[32:35], v13 offset:32768
    buffer_store_dwordx4 v[216:219], v11, s[12:15], s76 offen sc1
    v_mfma_f32_16x16x32_bf16 v[84:87], a[116:119], v[48:51], v[84:87]
    ds_read_b128 v[36:39], v13 offset:33792
    s_add_u32 s76, s76, 32768
    v_mfma_f32_16x16x32_bf16 v[88:91], a[112:115], v[52:55], v[88:91]
    buffer_store_dwordx4 v[220:223], v11, s[12:15], s76 offen sc1
    s_add_u32 s76, s76, 32768
    v_mfma_f32_16x16x32_bf16 v[92:95], a[116:119], v[52:55], v[92:95]
    buffer_store_dwordx4 v[224:227], v11, s[12:15], s76 offen sc1
    v_mfma_f32_16x16x32_bf16 v[80:83], a[120:123], v[56:59], v[80:83]
    ds_read_b128 v[40:43], v13 offset:34816
    s_add_u32 s76, s76, 32768
    v_mfma_f32_16x16x32_bf16 v[84:87], a[124:127], v[56:59], v[84:87]
    ds_read_b128 v[44:47], v13 offset:35840
    buffer_store_dwordx4 v[228:231], v11, s[12:15], s76 offen sc1
    v_mfma_f32_16x16x32_bf16 v[88:91], a[120:123], v[60:63], v[88:91]
    v_mfma_f32_16x16x32_bf16 v[92:95], a[124:127], v[60:63], v[92:95]
    s_waitcnt lgkmcnt(2)
    v_mfma_f32_16x16x32_bf16 v[80:83], a[128:131], v[32:35], v[80:83]
    ds_read_b128 v[48:51], v13 offset:36864
    v_mfma_f32_16x16x32_bf16 v[84:87], a[132:135], v[32:35], v[84:87]
    ds_read_b128 v[52:55], v13 offset:37888
    v_mfma_f32_16x16x32_bf16 v[88:91], a[128:131], v[36:39], v[88:91]
    ds_read_b128 v[56:59], v13 offset:38912
    s_add_u32 m0, s59, 0
    v_mfma_f32_16x16x32_bf16 v[92:95], a[132:135], v[36:39], v[92:95]
    ds_read_b128 v[60:63], v13 offset:39936
    buffer_load_dwordx4 v10, s[12:15], s48 offen offset:0 sc1 lds
    s_waitcnt lgkmcnt(4)
    v_mfma_f32_16x16x32_bf16 v[80:83], a[136:139], v[40:43], v[80:83]
    ds_read_b128 v[32:35], v13 offset:40960
    v_mfma_f32_16x16x32_bf16 v[84:87], a[140:143], v[40:43], v[84:87]
    ds_read_b128 v[36:39], v13 offset:41984
    v_mfma_f32_16x16x32_bf16 v[88:91], a[136:139], v[44:47], v[88:91]
    v_mfma_f32_16x16x32_bf16 v[92:95], a[140:143], v[44:47], v[92:95]
    buffer_load_dwordx4 v10, s[12:15], s48 offen offset:1024 sc1 lds
    s_waitcnt lgkmcnt(4)
    v_mfma_f32_16x16x32_bf16 v[80:83], a[144:147], v[48:51], v[80:83]
    ds_read_b128 v[40:43], v13 offset:43008
    v_mfma_f32_16x16x32_bf16 v[84:87], a[148:151], v[48:51], v[84:87]
    ds_read_b128 v[44:47], v13 offset:44032
    v_mfma_f32_16x16x32_bf16 v[88:91], a[144:147], v[52:55], v[88:91]
    v_mfma_f32_16x16x32_bf16 v[92:95], a[148:151], v[52:55], v[92:95]
    buffer_load_dwordx4 v10, s[12:15], s48 offen offset:2048 sc1 lds
    s_waitcnt lgkmcnt(4)
    v_mfma_f32_16x16x32_bf16 v[80:83], a[152:155], v[56:59], v[80:83]
    ds_read_b128 v[48:51], v13 offset:45056
    v_mfma_f32_16x16x32_bf16 v[84:87], a[156:159], v[56:59], v[84:87]
    ds_read_b128 v[52:55], v13 offset:46080
    v_mfma_f32_16x16x32_bf16 v[88:91], a[152:155], v[60:63], v[88:91]
    v_mfma_f32_16x16x32_bf16 v[92:95], a[156:159], v[60:63], v[92:95]
    buffer_load_dwordx4 v10, s[12:15], s48 offen offset:3072 sc1 lds
    s_waitcnt lgkmcnt(4)
    v_mfma_f32_16x16x32_bf16 v[80:83], a[160:163], v[32:35], v[80:83]
    ds_read_b128 v[56:59], v13 offset:47104
    v_mfma_f32_16x16x32_bf16 v[84:87], a[164:167], v[32:35], v[84:87]
    ds_read_b128 v[60:63], v13 offset:48128
    v_mfma_f32_16x16x32_bf16 v[88:91], a[160:163], v[36:39], v[88:91]
    s_add_u32 m0, s59, 4096
    v_mfma_f32_16x16x32_bf16 v[92:95], a[164:167], v[36:39], v[92:95]
    buffer_load_dwordx4 v10, s[12:15], s49 offen offset:0 sc1 lds
    s_waitcnt lgkmcnt(4)
    v_mfma_f32_16x16x32_bf16 v[80:83], a[168:171], v[40:43], v[80:83]
    ds_read_b128 v[32:35], v13 offset:49152
    v_mfma_f32_16x16x32_bf16 v[84:87], a[172:175], v[40:43], v[84:87]
    ds_read_b128 v[36:39], v13 offset:50176
    v_mfma_f32_16x16x32_bf16 v[88:91], a[168:171], v[44:47], v[88:91]
    v_mfma_f32_16x16x32_bf16 v[92:95], a[172:175], v[44:47], v[92:95]
    buffer_load_dwordx4 v10, s[12:15], s49 offen offset:1024 sc1 lds
    s_waitcnt lgkmcnt(4)
    v_mfma_f32_16x16x32_bf16 v[80:83], a[176:179], v[48:51], v[80:83]
    ds_read_b128 v[40:43], v13 offset:51200
    v_mfma_f32_16x16x32_bf16 v[84:87], a[180:183], v[48:51], v[84:87]
    ds_read_b128 v[44:47], v13 offset:52224
    v_mfma_f32_16x16x32_bf16 v[88:91], a[176:179], v[52:55], v[88:91]
    v_mfma_f32_16x16x32_bf16 v[92:95], a[180:183], v[52:55], v[92:95]
    buffer_load_dwordx4 v10, s[12:15], s49 offen offset:2048 sc1 lds
    s_waitcnt lgkmcnt(4)
    v_mfma_f32_16x16x32_bf16 v[80:83], a[184:187], v[56:59], v[80:83]
    ds_read_b128 v[48:51], v13 offset:53248
    v_mfma_f32_16x16x32_bf16 v[84:87], a[188:191], v[56:59], v[84:87]
    ds_read_b128 v[52:55], v13 offset:54272
    v_mfma_f32_16x16x32_bf16 v[88:91], a[184:187], v[60:63], v[88:91]
    v_mfma_f32_16x16x32_bf16 v[92:95], a[188:191], v[60:63], v[92:95]
    buffer_load_dwordx4 v10, s[12:15], s49 offen offset:3072 sc1 lds
    s_waitcnt lgkmcnt(4)
    v_mfma_f32_16x16x32_bf16 v[80:83], a[192:195], v[32:35], v[80:83]
    ds_read_b128 v[56:59], v13 offset:55296
    v_mfma_f32_16x16x32_bf16 v[84:87], a[196:199], v[32:35], v[84:87]
    ds_read_b128 v[60:63], v13 offset:56320
    v_mfma_f32_16x16x32_bf16 v[88:91], a[192:195], v[36:39], v[88:91]
    s_add_u32 s48, s53, 491520
    v_mfma_f32_16x16x32_bf16 v[92:95], a[196:199], v[36:39], v[92:95]
    s_add_u32 s46, s58, 2
    s_waitcnt lgkmcnt(4)
    v_mfma_f32_16x16x32_bf16 v[80:83], a[200:203], v[40:43], v[80:83]
    v_mfma_f32_16x16x32_bf16 v[84:87], a[204:207], v[40:43], v[84:87]
    v_mfma_f32_16x16x32_bf16 v[88:91], a[200:203], v[44:47], v[88:91]
    s_cmp_lt_u32 s46, s51
    s_cselect_b32 s48, s48, 0x20000000
    v_mfma_f32_16x16x32_bf16 v[92:95], a[204:207], v[44:47], v[92:95]
    s_cmp_lt_u32 s44, 3
    s_cselect_b32 s48, s48, 0x20000000
    s_waitcnt vmcnt(16) lgkmcnt(0)
    s_barrier
    v_mfma_f32_16x16x32_bf16 v[80:83], a[208:211], v[48:51], v[80:83]
    ds_read_b128 v[32:35], v14 offset:0
    v_mfma_f32_16x16x32_bf16 v[84:87], a[212:215], v[48:51], v[84:87]
    ds_read_b128 v[36:39], v14 offset:1024
    v_mfma_f32_16x16x32_bf16 v[88:91], a[208:211], v[52:55], v[88:91]
    s_add_u32 s49, s48, 4096
    v_mfma_f32_16x16x32_bf16 v[92:95], a[212:215], v[52:55], v[92:95]
    s_add_u32 s59, s54, 32768
    v_mfma_f32_16x16x32_bf16 v[80:83], a[216:219], v[56:59], v[80:83]
    ds_read_b128 v[40:43], v14 offset:2048
    v_mfma_f32_16x16x32_bf16 v[84:87], a[220:223], v[56:59], v[84:87]
    ds_read_b128 v[44:47], v14 offset:3072
    v_mfma_f32_16x16x32_bf16 v[88:91], a[216:219], v[60:63], v[88:91]
    v_mfma_f32_16x16x32_bf16 v[92:95], a[220:223], v[60:63], v[92:95]
    s_add_u32 s53, s53, 229376
    s_add_u32 s58, s58, 1
    v_swap_b32 v13, v14
    s_xor_b32 s54, s54, 65536
    s_xor_b32 s55, s55, 65536
    s_mov_b32 s76, s57
    v_swap_b32 v15, v16
    s_add_u32 s57, s57, 131072
    ds_write_b128 v7, v[80:83] offset:0
    ds_write_b128 v7, v[84:87] offset:64
    ds_write_b128 v7, v[88:91] offset:2304
    ds_write_b128 v7, v[92:95] offset:2368
    s_cmp_lt_u32 s58, s51
    s_cbranch_scc1 L_e_loop_174
    s_branch L_e_fin_176
L_e_one_175:
    s_waitcnt vmcnt(8)
    s_barrier
    ds_read_b128 v[32:35], v13 offset:0
    ds_read_b128 v[36:39], v13 offset:1024
    ds_read_b128 v[40:43], v13 offset:2048
    ds_read_b128 v[44:47], v13 offset:3072
    s_waitcnt lgkmcnt(2)
    v_mfma_f32_16x16x32_bf16 v[80:83], a[0:3], v[32:35], 0
    ds_read_b128 v[48:51], v13 offset:4096
    v_mfma_f32_16x16x32_bf16 v[84:87], a[4:7], v[32:35], 0
    ds_read_b128 v[52:55], v13 offset:5120
    v_mfma_f32_16x16x32_bf16 v[88:91], a[0:3], v[36:39], 0
    ds_read_b128 v[56:59], v13 offset:6144
    v_mfma_f32_16x16x32_bf16 v[92:95], a[4:7], v[36:39], 0
    ds_read_b128 v[60:63], v13 offset:7168
    s_waitcnt lgkmcnt(4)
    v_mfma_f32_16x16x32_bf16 v[80:83], a[8:11], v[40:43], v[80:83]
    ds_read_b128 v[32:35], v13 offset:8192
    v_mfma_f32_16x16x32_bf16 v[84:87], a[12:15], v[40:43], v[84:87]
    ds_read_b128 v[36:39], v13 offset:9216
    v_mfma_f32_16x16x32_bf16 v[88:91], a[8:11], v[44:47], v[88:91]
    v_mfma_f32_16x16x32_bf16 v[92:95], a[12:15], v[44:47], v[92:95]
    s_waitcnt lgkmcnt(4)
    v_mfma_f32_16x16x32_bf16 v[80:83], a[16:19], v[48:51], v[80:83]
    ds_read_b128 v[40:43], v13 offset:10240
    v_mfma_f32_16x16x32_bf16 v[84:87], a[20:23], v[48:51], v[84:87]
    ds_read_b128 v[44:47], v13 offset:11264
    v_mfma_f32_16x16x32_bf16 v[88:91], a[16:19], v[52:55], v[88:91]
    v_mfma_f32_16x16x32_bf16 v[92:95], a[20:23], v[52:55], v[92:95]
    s_waitcnt lgkmcnt(4)
    v_mfma_f32_16x16x32_bf16 v[80:83], a[24:27], v[56:59], v[80:83]
    ds_read_b128 v[48:51], v13 offset:12288
    v_mfma_f32_16x16x32_bf16 v[84:87], a[28:31], v[56:59], v[84:87]
    ds_read_b128 v[52:55], v13 offset:13312
    v_mfma_f32_16x16x32_bf16 v[88:91], a[24:27], v[60:63], v[88:91]
    v_mfma_f32_16x16x32_bf16 v[92:95], a[28:31], v[60:63], v[92:95]
    s_waitcnt lgkmcnt(4)
    v_mfma_f32_16x16x32_bf16 v[80:83], a[32:35], v[32:35], v[80:83]
    ds_read_b128 v[56:59], v13 offset:14336
    v_mfma_f32_16x16x32_bf16 v[84:87], a[36:39], v[32:35], v[84:87]
    ds_read_b128 v[60:63], v13 offset:15360
    v_mfma_f32_16x16x32_bf16 v[88:91], a[32:35], v[36:39], v[88:91]
    v_mfma_f32_16x16x32_bf16 v[92:95], a[36:39], v[36:39], v[92:95]
    s_waitcnt lgkmcnt(4)
    v_mfma_f32_16x16x32_bf16 v[80:83], a[40:43], v[40:43], v[80:83]
    ds_read_b128 v[32:35], v13 offset:16384
    v_mfma_f32_16x16x32_bf16 v[84:87], a[44:47], v[40:43], v[84:87]
    ds_read_b128 v[36:39], v13 offset:17408
    v_mfma_f32_16x16x32_bf16 v[88:91], a[40:43], v[44:47], v[88:91]
    v_mfma_f32_16x16x32_bf16 v[92:95], a[44:47], v[44:47], v[92:95]
    s_waitcnt lgkmcnt(4)
    v_mfma_f32_16x16x32_bf16 v[80:83], a[48:51], v[48:51], v[80:83]
    ds_read_b128 v[40:43], v13 offset:18432
    v_mfma_f32_16x16x32_bf16 v[84:87], a[52:55], v[48:51], v[84:87]
    ds_read_b128 v[44:47], v13 offset:19456
    v_mfma_f32_16x16x32_bf16 v[88:91], a[48:51], v[52:55], v[88:91]
    v_mfma_f32_16x16x32_bf16 v[92:95], a[52:55], v[52:55], v[92:95]
    s_waitcnt lgkmcnt(4)
    v_mfma_f32_16x16x32_bf16 v[80:83], a[56:59], v[56:59], v[80:83]
    ds_read_b128 v[48:51], v13 offset:20480
    v_mfma_f32_16x16x32_bf16 v[84:87], a[60:63], v[56:59], v[84:87]
    ds_read_b128 v[52:55], v13 offset:21504
    v_mfma_f32_16x16x32_bf16 v[88:91], a[56:59], v[60:63], v[88:91]
    v_mfma_f32_16x16x32_bf16 v[92:95], a[60:63], v[60:63], v[92:95]
    s_waitcnt lgkmcnt(4)
    v_mfma_f32_16x16x32_bf16 v[80:83], a[64:67], v[32:35], v[80:83]
    ds_read_b128 v[56:59], v13 offset:22528
    v_mfma_f32_16x16x32_bf16 v[84:87], a[68:71], v[32:35], v[84:87]
    ds_read_b128 v[60:63], v13 offset:23552
    v_mfma_f32_16x16x32_bf16 v[88:91], a[64:67], v[36:39], v[88:91]
    v_mfma_f32_16x16x32_bf16 v[92:95], a[68:71], v[36:39], v[92:95]
    s_waitcnt lgkmcnt(4)
    v_mfma_f32_16x16x32_bf16 v[80:83], a[72:75], v[40:43], v[80:83]
    ds_read_b128 v[32:35], v13 offset:24576
    v_mfma_f32_16x16x32_bf16 v[84:87], a[76:79], v[40:43], v[84:87]
    ds_read_b128 v[36:39], v13 offset:25600
    v_mfma_f32_16x16x32_bf16 v[88:91], a[72:75], v[44:47], v[88:91]
    v_mfma_f32_16x16x32_bf16 v[92:95], a[76:79], v[44:47], v[92:95]
    s_waitcnt lgkmcnt(4)
    v_mfma_f32_16x16x32_bf16 v[80:83], a[80:83], v[48:51], v[80:83]
    ds_read_b128 v[40:43], v13 offset:26624
    v_mfma_f32_16x16x32_bf16 v[84:87], a[84:87], v[48:51], v[84:87]
    ds_read_b128 v[44:47], v13 offset:27648
    v_mfma_f32_16x16x32_bf16 v[88:91], a[80:83], v[52:55], v[88:91]
    v_mfma_f32_16x16x32_bf16 v[92:95], a[84:87], v[52:55], v[92:95]
    s_waitcnt lgkmcnt(4)
    v_mfma_f32_16x16x32_bf16 v[80:83], a[88:91], v[56:59], v[80:83]
    ds_read_b128 v[48:51], v13 offset:28672
    v_mfma_f32_16x16x32_bf16 v[84:87], a[92:95], v[56:59], v[84:87]
    ds_read_b128 v[52:55], v13 offset:29696
    v_mfma_f32_16x16x32_bf16 v[88:91], a[88:91], v[60:63], v[88:91]
    v_mfma_f32_16x16x32_bf16 v[92:95], a[92:95], v[60:63], v[92:95]
    s_waitcnt lgkmcnt(4)
    v_mfma_f32_16x16x32_bf16 v[80:83], a[96:99], v[32:35], v[80:83]
    ds_read_b128 v[56:59], v13 offset:30720
    v_mfma_f32_16x16x32_bf16 v[84:87], a[100:103], v[32:35], v[84:87]
    ds_read_b128 v[60:63], v13 offset:31744
    v_mfma_f32_16x16x32_bf16 v[88:91], a[96:99], v[36:39], v[88:91]
    v_mfma_f32_16x16x32_bf16 v[92:95], a[100:103], v[36:39], v[92:95]
    s_waitcnt lgkmcnt(4)
    v_mfma_f32_16x16x32_bf16 v[80:83], a[104:107], v[40:43], v[80:83]
    v_mfma_f32_16x16x32_bf16 v[84:87], a[108:111], v[40:43], v[84:87]
    v_mfma_f32_16x16x32_bf16 v[88:91], a[104:107], v[44:47], v[88:91]
    v_mfma_f32_16x16x32_bf16 v[92:95], a[108:111], v[44:47], v[92:95]
    s_waitcnt vmcnt(0) lgkmcnt(0)
    s_barrier
    v_mfma_f32_16x16x32_bf16 v[80:83], a[112:115], v[48:51], v[80:83]
    ds_read_b128 v[32:35], v13 offset:32768
    v_mfma_f32_16x16x32_bf16 v[84:87], a[116:119], v[48:51], v[84:87]
    ds_read_b128 v[36:39], v13 offset:33792
    v_mfma_f32_16x16x32_bf16 v[88:91], a[112:115], v[52:55], v[88:91]
    v_mfma_f32_16x16x32_bf16 v[92:95], a[116:119], v[52:55], v[92:95]
    v_mfma_f32_16x16x32_bf16 v[80:83], a[120:123], v[56:59], v[80:83]
    ds_read_b128 v[40:43], v13 offset:34816
    v_mfma_f32_16x16x32_bf16 v[84:87], a[124:127], v[56:59], v[84:87]
    ds_read_b128 v[44:47], v13 offset:35840
    v_mfma_f32_16x16x32_bf16 v[88:91], a[120:123], v[60:63], v[88:91]
    v_mfma_f32_16x16x32_bf16 v[92:95], a[124:127], v[60:63], v[92:95]
    s_waitcnt lgkmcnt(2)
    v_mfma_f32_16x16x32_bf16 v[80:83], a[128:131], v[32:35], v[80:83]
    ds_read_b128 v[48:51], v13 offset:36864
    v_mfma_f32_16x16x32_bf16 v[84:87], a[132:135], v[32:35], v[84:87]
    ds_read_b128 v[52:55], v13 offset:37888
    v_mfma_f32_16x16x32_bf16 v[88:91], a[128:131], v[36:39], v[88:91]
    ds_read_b128 v[56:59], v13 offset:38912
    v_mfma_f32_16x16x32_bf16 v[92:95], a[132:135], v[36:39], v[92:95]
    ds_read_b128 v[60:63], v13 offset:39936
    s_waitcnt lgkmcnt(4)
    v_mfma_f32_16x16x32_bf16 v[80:83], a[136:139], v[40:43], v[80:83]
    ds_read_b128 v[32:35], v13 offset:40960
    v_mfma_f32_16x16x32_bf16 v[84:87], a[140:143], v[40:43], v[84:87]
    ds_read_b128 v[36:39], v13 offset:41984
    v_mfma_f32_16x16x32_bf16 v[88:91], a[136:139], v[44:47], v[88:91]
    v_mfma_f32_16x16x32_bf16 v[92:95], a[140:143], v[44:47], v[92:95]
    s_waitcnt lgkmcnt(4)
    v_mfma_f32_16x16x32_bf16 v[80:83], a[144:147], v[48:51], v[80:83]
    ds_read_b128 v[40:43], v13 offset:43008
    v_mfma_f32_16x16x32_bf16 v[84:87], a[148:151], v[48:51], v[84:87]
    ds_read_b128 v[44:47], v13 offset:44032
    v_mfma_f32_16x16x32_bf16 v[88:91], a[144:147], v[52:55], v[88:91]
    v_mfma_f32_16x16x32_bf16 v[92:95], a[148:151], v[52:55], v[92:95]
    s_waitcnt lgkmcnt(4)
    v_mfma_f32_16x16x32_bf16 v[80:83], a[152:155], v[56:59], v[80:83]
    ds_read_b128 v[48:51], v13 offset:45056
    v_mfma_f32_16x16x32_bf16 v[84:87], a[156:159], v[56:59], v[84:87]
    ds_read_b128 v[52:55], v13 offset:46080
    v_mfma_f32_16x16x32_bf16 v[88:91], a[152:155], v[60:63], v[88:91]
    v_mfma_f32_16x16x32_bf16 v[92:95], a[156:159], v[60:63], v[92:95]
    s_waitcnt lgkmcnt(4)
    v_mfma_f32_16x16x32_bf16 v[80:83], a[160:163], v[32:35], v[80:83]
    ds_read_b128 v[56:59], v13 offset:47104
    v_mfma_f32_16x16x32_bf16 v[84:87], a[164:167], v[32:35], v[84:87]
    ds_read_b128 v[60:63], v13 offset:48128
    v_mfma_f32_16x16x32_bf16 v[88:91], a[160:163], v[36:39], v[88:91]
    v_mfma_f32_16x16x32_bf16 v[92:95], a[164:167], v[36:39], v[92:95]
    s_waitcnt lgkmcnt(4)
    v_mfma_f32_16x16x32_bf16 v[80:83], a[168:171], v[40:43], v[80:83]
    ds_read_b128 v[32:35], v13 offset:49152
    v_mfma_f32_16x16x32_bf16 v[84:87], a[172:175], v[40:43], v[84:87]
    ds_read_b128 v[36:39], v13 offset:50176
    v_mfma_f32_16x16x32_bf16 v[88:91], a[168:171], v[44:47], v[88:91]
    v_mfma_f32_16x16x32_bf16 v[92:95], a[172:175], v[44:47], v[92:95]
    s_waitcnt lgkmcnt(4)
    v_mfma_f32_16x16x32_bf16 v[80:83], a[176:179], v[48:51], v[80:83]
    ds_read_b128 v[40:43], v13 offset:51200
    v_mfma_f32_16x16x32_bf16 v[84:87], a[180:183], v[48:51], v[84:87]
    ds_read_b128 v[44:47], v13 offset:52224
    v_mfma_f32_16x16x32_bf16 v[88:91], a[176:179], v[52:55], v[88:91]
    v_mfma_f32_16x16x32_bf16 v[92:95], a[180:183], v[52:55], v[92:95]
    s_waitcnt lgkmcnt(4)
    v_mfma_f32_16x16x32_bf16 v[80:83], a[184:187], v[56:59], v[80:83]
    ds_read_b128 v[48:51], v13 offset:53248
    v_mfma_f32_16x16x32_bf16 v[84:87], a[188:191], v[56:59], v[84:87]
    ds_read_b128 v[52:55], v13 offset:54272
    v_mfma_f32_16x16x32_bf16 v[88:91], a[184:187], v[60:63], v[88:91]
    v_mfma_f32_16x16x32_bf16 v[92:95], a[188:191], v[60:63], v[92:95]
    s_waitcnt lgkmcnt(4)
    v_mfma_f32_16x16x32_bf16 v[80:83], a[192:195], v[32:35], v[80:83]
    ds_read_b128 v[56:59], v13 offset:55296
    v_mfma_f32_16x16x32_bf16 v[84:87], a[196:199], v[32:35], v[84:87]
    ds_read_b128 v[60:63], v13 offset:56320
    v_mfma_f32_16x16x32_bf16 v[88:91], a[192:195], v[36:39], v[88:91]
    v_mfma_f32_16x16x32_bf16 v[92:95], a[196:199], v[36:39], v[92:95]
    s_waitcnt lgkmcnt(4)
    v_mfma_f32_16x16x32_bf16 v[80:83], a[200:203], v[40:43], v[80:83]
    v_mfma_f32_16x16x32_bf16 v[84:87], a[204:207], v[40:43], v[84:87]
    v_mfma_f32_16x16x32_bf16 v[88:91], a[200:203], v[44:47], v[88:91]
    v_mfma_f32_16x16x32_bf16 v[92:95], a[204:207], v[44:47], v[92:95]
    s_waitcnt lgkmcnt(0)
    v_mfma_f32_16x16x32_bf16 v[80:83], a[208:211], v[48:51], v[80:83]
    v_mfma_f32_16x16x32_bf16 v[84:87], a[212:215], v[48:51], v[84:87]
    v_mfma_f32_16x16x32_bf16 v[88:91], a[208:211], v[52:55], v[88:91]
    v_mfma_f32_16x16x32_bf16 v[92:95], a[212:215], v[52:55], v[92:95]
    v_mfma_f32_16x16x32_bf16 v[80:83], a[216:219], v[56:59], v[80:83]
    v_mfma_f32_16x16x32_bf16 v[84:87], a[220:223], v[56:59], v[84:87]
    v_mfma_f32_16x16x32_bf16 v[88:91], a[216:219], v[60:63], v[88:91]
    v_mfma_f32_16x16x32_bf16 v[92:95], a[220:223], v[60:63], v[92:95]
    s_mov_b32 s76, s57
    s_nop 6
    ds_write_b128 v7, v[80:83] offset:0
    ds_write_b128 v7, v[84:87] offset:64
    ds_write_b128 v7, v[88:91] offset:2304
    ds_write_b128 v7, v[92:95] offset:2368
L_e_fin_176:
    s_waitcnt lgkmcnt(0)
    ds_read_b128 v[216:219], v8 offset:0
    ds_read_b128 v[220:223], v8 offset:1152
    ds_read_b128 v[224:227], v8 offset:2304
    ds_read_b128 v[228:231], v8 offset:3456
    s_waitcnt lgkmcnt(0)
    buffer_store_dwordx4 v[216:219], v11, s[12:15], s76 offen sc1
    s_add_u32 s76, s76, 32768
    buffer_store_dwordx4 v[220:223], v11, s[12:15], s76 offen sc1
    s_add_u32 s76, s76, 32768
    buffer_store_dwordx4 v[224:227], v11, s[12:15], s76 offen sc1
    s_add_u32 s76, s76, 32768
    buffer_store_dwordx4 v[228:231], v11, s[12:15], s76 offen sc1
    s_waitcnt vmcnt(0)
    s_barrier
    s_cmp_lg_u32 s44, 0
    s_cbranch_scc1 L_pub_177
    v_mov_b32 v30, s62
    v_mov_b32 v31, 0
    s_mov_b64 exec, 1
    buffer_store_dword v30, v31, s[80:83], s65 offen
    buffer_store_dword v30, v31, s[84:87], s65 offen sc1
    s_mov_b64 exec, -1
L_pub_177:
    s_cmp_lg_u32 s51, 1
    s_cbranch_scc1 L_c_skip_170
    s_lshl_b32 s63, s50, 5
    s_add_u32 s63, s63, s41
    s_lshl_b32 s47, s63, 11
    s_lshl_b32 s45, s44, 9
    s_add_u32 s47, s47, s45
    s_add_u32 s46, s47, 0x800000
    v_lshlrev_b32 v17, 3, v1
    buffer_load_dwordx2 v[208:209], v17, s[12:15], s46 offen sc1
    s_add_u32 s45, s64, 16384
    s_cmp_lg_u32 s44, 1
    s_cbranch_scc1 L_pw_178
    s_mov_b32 exec_hi, 0
    s_mov_b32 s70, 0
L_wp_179:
    buffer_load_dword v31, v5, s[12:15], s45 offen sc1
    s_add_u32 s70, s70, 1
    s_cmp_ge_u32 s70, 0x200000
    s_cbranch_scc1 L_w_done_96
L_wp_179_c:
    s_waitcnt vmcnt(0)
    v_cmp_gt_u32 vcc, s62, v31
    s_nop 1
    s_cbranch_vccz L_wp_179_ok
    s_sleep 1
    s_branch L_wp_179
L_wp_179_ok:
    s_mov_b64 exec, -1
L_pw_178:
    s_barrier
    s_lshl_b32 s45, s63, 12
    s_lshl_b32 s46, s44, 10
    s_add_u32 s45, s45, s46
    s_add_u32 s45, s45, 0xc000000
    buffer_load_dwordx4 v[64:67], v10, s[12:15], s45 offen sc1
    s_add_u32 s45, s45, 0x800000
    buffer_load_dwordx4 v[68:71], v10, s[12:15], s45 offen sc1
    s_add_u32 s45, s45, 0x800000
    buffer_load_dwordx4 v[72:75], v10, s[12:15], s45 offen sc1
    s_add_u32 s45, s45, 0x800000
    buffer_load_dwordx4 v[76:79], v10, s[12:15], s45 offen sc1
    s_waitcnt vmcnt(4)
    v_lshlrev_b32 v160, 16, v208
    v_and_b32 v161, 0xffff0000, v208
    v_lshlrev_b32 v162, 16, v209
    v_and_b32 v163, 0xffff0000, v209
    s_waitcnt vmcnt(0)
    v_pk_add_f32 v[64:65], v[64:65], v[68:69]
    v_pk_add_f32 v[72:73], v[72:73], v[76:77]
    v_pk_add_f32 v[66:67], v[66:67], v[70:71]
    v_pk_add_f32 v[74:75], v[74:75], v[78:79]
    v_pk_add_f32 v[64:65], v[64:65], v[72:73]
    v_pk_add_f32 v[66:67], v[66:67], v[74:75]
    v_cvt_pk_bf16_f32 v64, v64, v64
    v_lshlrev_b32 v64, 16, v64
    v_cvt_pk_bf16_f32 v65, v65, v65
    v_lshlrev_b32 v65, 16, v65
    v_cvt_pk_bf16_f32 v66, v66, v66
    v_lshlrev_b32 v66, 16, v66
    v_cvt_pk_bf16_f32 v67, v67, v67
    v_lshlrev_b32 v67, 16, v67
    v_add_f32 v64, v64, v18
    v_cvt_pk_bf16_f32 v64, v64, v64
    v_lshlrev_b32 v64, 16, v64
    v_mul_f32 v64, v64, v22
    v_cvt_pk_bf16_f32 v64, v64, v64
    v_lshlrev_b32 v64, 16, v64
    v_add_f32 v64, v64, v160
    v_add_f32 v65, v65, v19
    v_cvt_pk_bf16_f32 v65, v65, v65
    v_lshlrev_b32 v65, 16, v65
    v_mul_f32 v65, v65, v23
    v_cvt_pk_bf16_f32 v65, v65, v65
    v_lshlrev_b32 v65, 16, v65
    v_add_f32 v65, v65, v161
    v_add_f32 v66, v66, v20
    v_cvt_pk_bf16_f32 v66, v66, v66
    v_lshlrev_b32 v66, 16, v66
    v_mul_f32 v66, v66, v24
    v_cvt_pk_bf16_f32 v66, v66, v66
    v_lshlrev_b32 v66, 16, v66
    v_add_f32 v66, v66, v162
    v_add_f32 v67, v67, v21
    v_cvt_pk_bf16_f32 v67, v67, v67
    v_lshlrev_b32 v67, 16, v67
    v_mul_f32 v67, v67, v25
    v_cvt_pk_bf16_f32 v67, v67, v67
    v_lshlrev_b32 v67, 16, v67
    v_add_f32 v67, v67, v163
    v_cvt_pk_bf16_f32 v208, v64, v65
    v_cvt_pk_bf16_f32 v209, v66, v67
    buffer_store_dwordx2 v[208:209], v17, s[32:35], s47 offen
    s_branch L_c_loop_169
L_c_skip_170:
    s_add_u32 s63, s50, s44
    s_lshl_b32 s63, s63, 5
    s_add_u32 s63, s63, s41
    s_lshl_b32 s47, s63, 11
    s_add_u32 s46, s47, 0x800000
    s_cmp_lt_u32 s44, s51
    s_cselect_b32 s46, s46, 0x20000000
    buffer_load_dwordx4 v[208:211], v10, s[12:15], s46 offen sc1
    buffer_load_dwordx4 v[212:215], v10, s[12:15], s46 offen offset:1024 sc1
    s_add_u32 s45, s64, 16384
    s_cmp_lg_u32 s44, 1
    s_cbranch_scc1 L_pw_180
    s_mov_b32 exec_hi, 0
    s_mov_b32 s70, 0
L_wp_181:
    buffer_load_dword v31, v5, s[12:15], s45 offen sc1
    s_add_u32 s70, s70, 1
    s_cmp_ge_u32 s70, 0x200000
    s_cbranch_scc1 L_w_done_96
L_wp_181_c:
    s_waitcnt vmcnt(0)
    v_cmp_gt_u32 vcc, s62, v31
    s_nop 1
    s_cbranch_vccz L_wp_181_ok
    s_sleep 1
    s_branch L_wp_181
L_wp_181_ok:
    s_mov_b64 exec, -1
L_pw_180:
    s_barrier
    s_cmp_ge_u32 s44, s51
    s_cbranch_scc1 L_c_loop_169
    s_lshl_b32 s45, s63, 12
    s_add_u32 s45, s45, 0xc000000
    v_lshlrev_b32 v29, 5, v1
    buffer_load_dwordx4 v[64:67], v29, s[12:15], s45 offen offset:0 sc1
    buffer_load_dwordx4 v[68:71], v29, s[12:15], s45 offen offset:16 sc1
    buffer_load_dwordx4 v[72:75], v29, s[12:15], s45 offen offset:2048 sc1
    buffer_load_dwordx4 v[76:79], v29, s[12:15], s45 offen offset:2064 sc1
    s_add_u32 s45, s45, 0x800000
    buffer_load_dwordx4 v[160:163], v29, s[12:15], s45 offen offset:0 sc1
    buffer_load_dwordx4 v[164:167], v29, s[12:15], s45 offen offset:16 sc1
    buffer_load_dwordx4 v[168:171], v29, s[12:15], s45 offen offset:2048 sc1
    buffer_load_dwordx4 v[172:175], v29, s[12:15], s45 offen offset:2064 sc1
    s_add_u32 s45, s45, 0x800000
    buffer_load_dwordx4 v[176:179], v29, s[12:15], s45 offen offset:0 sc1
    buffer_load_dwordx4 v[180:183], v29, s[12:15], s45 offen offset:16 sc1
    buffer_load_dwordx4 v[184:187], v29, s[12:15], s45 offen offset:2048 sc1
    buffer_load_dwordx4 v[188:191], v29, s[12:15], s45 offen offset:2064 sc1
    s_add_u32 s45, s45, 0x800000
    buffer_load_dwordx4 v[192:195], v29, s[12:15], s45 offen offset:0 sc1
    buffer_load_dwordx4 v[196:199], v29, s[12:15], s45 offen offset:16 sc1
    buffer_load_dwordx4 v[200:203], v29, s[12:15], s45 offen offset:2048 sc1
    buffer_load_dwordx4 v[204:207], v29, s[12:15], s45 offen offset:2064 sc1
    s_waitcnt vmcnt(0)
    v_pk_add_f32 v[64:65], v[64:65], v[160:161]
    v_pk_add_f32 v[176:177], v[176:177], v[192:193]
    v_pk_add_f32 v[66:67], v[66:67], v[162:163]
    v_pk_add_f32 v[178:179], v[178:179], v[194:195]
    v_pk_add_f32 v[68:69], v[68:69], v[164:165]
    v_pk_add_f32 v[180:181], v[180:181], v[196:197]
    v_pk_add_f32 v[70:71], v[70:71], v[166:167]
    v_pk_add_f32 v[182:183], v[182:183], v[198:199]
    v_pk_add_f32 v[72:73], v[72:73], v[168:169]
    v_pk_add_f32 v[184:185], v[184:185], v[200:201]
    v_pk_add_f32 v[74:75], v[74:75], v[170:171]
    v_pk_add_f32 v[186:187], v[186:187], v[202:203]
    v_pk_add_f32 v[76:77], v[76:77], v[172:173]
    v_pk_add_f32 v[188:189], v[188:189], v[204:205]
    v_pk_add_f32 v[78:79], v[78:79], v[174:175]
    v_pk_add_f32 v[190:191], v[190:191], v[206:207]
    v_pk_add_f32 v[64:65], v[64:65], v[176:177]
    v_pk_add_f32 v[66:67], v[66:67], v[178:179]
    v_pk_add_f32 v[68:69], v[68:69], v[180:181]
    v_pk_add_f32 v[70:71], v[70:71], v[182:183]
    v_pk_add_f32 v[72:73], v[72:73], v[184:185]
    v_pk_add_f32 v[74:75], v[74:75], v[186:187]
    v_pk_add_f32 v[76:77], v[76:77], v[188:189]
    v_pk_add_f32 v[78:79], v[78:79], v[190:191]
    v_cvt_pk_bf16_f32 v64, v64, v64
    v_lshlrev_b32 v64, 16, v64
    v_cvt_pk_bf16_f32 v65, v65, v65
    v_lshlrev_b32 v65, 16, v65
    v_cvt_pk_bf16_f32 v66, v66, v66
    v_lshlrev_b32 v66, 16, v66
    v_cvt_pk_bf16_f32 v67, v67, v67
    v_lshlrev_b32 v67, 16, v67
    v_cvt_pk_bf16_f32 v68, v68, v68
    v_lshlrev_b32 v68, 16, v68
    v_cvt_pk_bf16_f32 v69, v69, v69
    v_lshlrev_b32 v69, 16, v69
    v_cvt_pk_bf16_f32 v70, v70, v70
    v_lshlrev_b32 v70, 16, v70
    v_cvt_pk_bf16_f32 v71, v71, v71
    v_lshlrev_b32 v71, 16, v71
    v_cvt_pk_bf16_f32 v72, v72, v72
    v_lshlrev_b32 v72, 16, v72
    v_cvt_pk_bf16_f32 v73, v73, v73
    v_lshlrev_b32 v73, 16, v73
    v_cvt_pk_bf16_f32 v74, v74, v74
    v_lshlrev_b32 v74, 16, v74
    v_cvt_pk_bf16_f32 v75, v75, v75
    v_lshlrev_b32 v75, 16, v75
    v_cvt_pk_bf16_f32 v76, v76, v76
    v_lshlrev_b32 v76, 16, v76
    v_cvt_pk_bf16_f32 v77, v77, v77
    v_lshlrev_b32 v77, 16, v77
    v_cvt_pk_bf16_f32 v78, v78, v78
    v_lshlrev_b32 v78, 16, v78
    v_cvt_pk_bf16_f32 v79, v79, v79
    v_lshlrev_b32 v79, 16, v79
    v_lshlrev_b32 v160, 16, v208
    v_and_b32 v161, 0xffff0000, v208
    v_lshlrev_b32 v162, 16, v209
    v_and_b32 v163, 0xffff0000, v209
    v_lshlrev_b32 v164, 16, v210
    v_and_b32 v165, 0xffff0000, v210
    v_lshlrev_b32 v166, 16, v211
    v_and_b32 v167, 0xffff0000, v211
    v_lshlrev_b32 v168, 16, v212
    v_and_b32 v169, 0xffff0000, v212
    v_lshlrev_b32 v170, 16, v213
    v_and_b32 v171, 0xffff0000, v213
    v_lshlrev_b32 v172, 16, v214
    v_and_b32 v173, 0xffff0000, v214
    v_lshlrev_b32 v174, 16, v215
    v_and_b32 v175, 0xffff0000, v215
    v_add_f32 v64, v64, v96
    v_cvt_pk_bf16_f32 v64, v64, v64
    v_lshlrev_b32 v64, 16, v64
    v_mul_f32 v64, v64, v112
    v_cvt_pk_bf16_f32 v64, v64, v64
    v_lshlrev_b32 v64, 16, v64
    v_add_f32 v64, v64, v160
    v_add_f32 v65, v65, v97
    v_cvt_pk_bf16_f32 v65, v65, v65
    v_lshlrev_b32 v65, 16, v65
    v_mul_f32 v65, v65, v113
    v_cvt_pk_bf16_f32 v65, v65, v65
    v_lshlrev_b32 v65, 16, v65
    v_add_f32 v65, v65, v161
    v_add_f32 v66, v66, v98
    v_cvt_pk_bf16_f32 v66, v66, v66
    v_lshlrev_b32 v66, 16, v66
    v_mul_f32 v66, v66, v114
    v_cvt_pk_bf16_f32 v66, v66, v66
    v_lshlrev_b32 v66, 16, v66
    v_add_f32 v66, v66, v162
    v_add_f32 v67, v67, v99
    v_cvt_pk_bf16_f32 v67, v67, v67
    v_lshlrev_b32 v67, 16, v67
    v_mul_f32 v67, v67, v115
    v_cvt_pk_bf16_f32 v67, v67, v67
    v_lshlrev_b32 v67, 16, v67
    v_add_f32 v67, v67, v163
    v_add_f32 v68, v68, v100
    v_cvt_pk_bf16_f32 v68, v68, v68
    v_lshlrev_b32 v68, 16, v68
    v_mul_f32 v68, v68, v116
    v_cvt_pk_bf16_f32 v68, v68, v68
    v_lshlrev_b32 v68, 16, v68
    v_add_f32 v68, v68, v164
    v_add_f32 v69, v69, v101
    v_cvt_pk_bf16_f32 v69, v69, v69
    v_lshlrev_b32 v69, 16, v69
    v_mul_f32 v69, v69, v117
    v_cvt_pk_bf16_f32 v69, v69, v69
    v_lshlrev_b32 v69, 16, v69
    v_add_f32 v69, v69, v165
    v_add_f32 v70, v70, v102
    v_cvt_pk_bf16_f32 v70, v70, v70
    v_lshlrev_b32 v70, 16, v70
    v_mul_f32 v70, v70, v118
    v_cvt_pk_bf16_f32 v70, v70, v70
    v_lshlrev_b32 v70, 16, v70
    v_add_f32 v70, v70, v166
    v_add_f32 v71, v71, v103
    v_cvt_pk_bf16_f32 v71, v71, v71
    v_lshlrev_b32 v71, 16, v71
    v_mul_f32 v71, v71, v119
    v_cvt_pk_bf16_f32 v71, v71, v71
    v_lshlrev_b32 v71, 16, v71
    v_add_f32 v71, v71, v167
    v_add_f32 v72, v72, v104
    v_cvt_pk_bf16_f32 v72, v72, v72
    v_lshlrev_b32 v72, 16, v72
    v_mul_f32 v72, v72, v120
    v_cvt_pk_bf16_f32 v72, v72, v72
    v_lshlrev_b32 v72, 16, v72
    v_add_f32 v72, v72, v168
    v_add_f32 v73, v73, v105
    v_cvt_pk_bf16_f32 v73, v73, v73
    v_lshlrev_b32 v73, 16, v73
    v_mul_f32 v73, v73, v121
    v_cvt_pk_bf16_f32 v73, v73, v73
    v_lshlrev_b32 v73, 16, v73
    v_add_f32 v73, v73, v169
    v_add_f32 v74, v74, v106
    v_cvt_pk_bf16_f32 v74, v74, v74
    v_lshlrev_b32 v74, 16, v74
    v_mul_f32 v74, v74, v122
    v_cvt_pk_bf16_f32 v74, v74, v74
    v_lshlrev_b32 v74, 16, v74
    v_add_f32 v74, v74, v170
    v_add_f32 v75, v75, v107
    v_cvt_pk_bf16_f32 v75, v75, v75
    v_lshlrev_b32 v75, 16, v75
    v_mul_f32 v75, v75, v123
    v_cvt_pk_bf16_f32 v75, v75, v75
    v_lshlrev_b32 v75, 16, v75
    v_add_f32 v75, v75, v171
    v_add_f32 v76, v76, v108
    v_cvt_pk_bf16_f32 v76, v76, v76
    v_lshlrev_b32 v76, 16, v76
    v_mul_f32 v76, v76, v124
    v_cvt_pk_bf16_f32 v76, v76, v76
    v_lshlrev_b32 v76, 16, v76
    v_add_f32 v76, v76, v172
    v_add_f32 v77, v77, v109
    v_cvt_pk_bf16_f32 v77, v77, v77
    v_lshlrev_b32 v77, 16, v77
    v_mul_f32 v77, v77, v125
    v_cvt_pk_bf16_f32 v77, v77, v77
    v_lshlrev_b32 v77, 16, v77
    v_add_f32 v77, v77, v173
    v_add_f32 v78, v78, v110
    v_cvt_pk_bf16_f32 v78, v78, v78
    v_lshlrev_b32 v78, 16, v78
    v_mul_f32 v78, v78, v126
    v_cvt_pk_bf16_f32 v78, v78, v78
    v_lshlrev_b32 v78, 16, v78
    v_add_f32 v78, v78, v174
    v_add_f32 v79, v79, v111
    v_cvt_pk_bf16_f32 v79, v79, v79
    v_lshlrev_b32 v79, 16, v79
    v_mul_f32 v79, v79, v127
    v_cvt_pk_bf16_f32 v79, v79, v79
    v_lshlrev_b32 v79, 16, v79
    v_add_f32 v79, v79, v175
    v_cvt_pk_bf16_f32 v208, v64, v65
    v_cvt_pk_bf16_f32 v209, v66, v67
    v_cvt_pk_bf16_f32 v210, v68, v69
    v_cvt_pk_bf16_f32 v211, v70, v71
    v_cvt_pk_bf16_f32 v212, v72, v73
    v_cvt_pk_bf16_f32 v213, v74, v75
    v_cvt_pk_bf16_f32 v214, v76, v77
    v_cvt_pk_bf16_f32 v215, v78, v79
    buffer_store_dwordx4 v[208:211], v10, s[32:35], s47 offen
    buffer_store_dwordx4 v[212:215], v10, s[32:35], s47 offen offset:1024
    s_branch L_c_loop_169
L_w_done_96:
    s_endpgm
.section .rodata,"a"
.p2align 6
.amdhsa_kernel adaLN_cond__memory_aug_recurrent_mem_tr__dense_activation_gelu__prompt_kernel
  .amdhsa_next_free_vgpr 512
  .amdhsa_next_free_sgpr 102
  .amdhsa_accum_offset 256
  .amdhsa_group_segment_fixed_size 0
  .amdhsa_kernarg_size 136
  .amdhsa_user_sgpr_count 2
  .amdhsa_user_sgpr_kernarg_segment_ptr 1
  .amdhsa_system_sgpr_workgroup_id_x 1
.end_amdhsa_kernel
```
